```python
import torch

def _softmax(x, axis=-1):
    return torch.softmax(x, dim=axis)

def _gelu(x):
    return torch.nn.functional.gelu(x, approximate='tanh')

def _silu(x):
    return torch.nn.functional.silu(x)

def _sigmoid(x):
    return torch.sigmoid(x)

def _layernorm(x, axis=-1, eps=1e-05):
    m = x.mean(dim=axis, keepdim=True)
    v = x.var(dim=axis, keepdim=True, unbiased=False)
    return (x - m) / torch.sqrt(v + eps)

def _scatter_add(tgt, idx, src, axis=0):
    return tgt.clone().index_add_(axis, idx, src)

def _segment_sum(src, seg, n):
    out = torch.zeros((n,) + src.shape[1:], dtype=src.dtype)
    return out.index_add_(0, seg, src)

def _pad(x, pw):
    flat = tuple((v for pair in reversed(pw) for v in pair))
    return torch.nn.functional.pad(x, flat)
kernel_name = 'recurrent_scan__memory_aug_recurrent_mem_tr__glu_gated_glu__prompt'

def setup_inputs():

    _w = lambda a: (lambda t: t.to(torch.bfloat16) if t.is_floating_point() else t)(torch.as_tensor(a))

    def _A_setup():
        B, S, Dm = (1, 2048, 1024)
        H, Dh = (32, 128)
        M, seg = (8, 32)
        seg = min(seg, S)
        S = S // seg * seg
        return {'x': _w((lambda *s: torch.randn(*s, dtype=torch.bfloat16) * 0.05)(B, S, Dm)), 'mem0': _w((lambda *s: torch.randn(*s, dtype=torch.bfloat16) * 0.2)(B, M, Dm)), 'Wq': _w((lambda *s: torch.randn(*s, dtype=torch.bfloat16) * 0.8)(Dm, H, Dh) * Dm ** (-0.5)), 'Wk': _w((lambda *s: torch.randn(*s, dtype=torch.bfloat16) * 0.8)(Dm, H, Dh) * Dm ** (-0.5)), 'Wv': _w((lambda *s: torch.randn(*s, dtype=torch.bfloat16) * 0.2)(Dm, H, Dh) * Dm ** (-0.5)), 'Wo': _w((lambda *s: torch.randn(*s, dtype=torch.bfloat16) * 0.2)(H, Dh, Dm) * (H * Dh) ** (-0.5)), 'seg_len': seg}
    _A_in = _A_setup()

    def _B_setup():
        B, S, D, F = (1, 2048, 1024, 3584)
        return {'x': _w((lambda *s: torch.randn(*s, dtype=torch.bfloat16) * 0.05)(B, S, D)), 'w_gate': _w((lambda *s: torch.randn(*s, dtype=torch.bfloat16) * 0.2)(D, F)), 'w_up': _w((lambda *s: torch.randn(*s, dtype=torch.bfloat16) * 0.1)(D, F)), 'w_down': _w((lambda *s: torch.randn(*s, dtype=torch.bfloat16) * 0.1)(F, D))}
    _B_in = _B_setup()
    return {'A_x': _A_in['x'], 'A_mem0': _A_in['mem0'], 'A_Wq': _A_in['Wq'], 'A_Wk': _A_in['Wk'], 'A_Wv': _A_in['Wv'], 'A_Wo': _A_in['Wo'], 'A_seg_len': _A_in['seg_len'], 'B_x': _B_in['x'], 'B_w_gate': _B_in['w_gate'], 'B_w_up': _B_in['w_up'], 'B_w_down': _B_in['w_down']}

def reference(A_x, A_mem0, A_Wq, A_Wk, A_Wv, A_Wo, A_seg_len, B_x, B_w_gate, B_w_up, B_w_down):

    def _A_ref(x, mem0, Wq, Wk, Wv, Wo, seg_len):
        B, S, Dm = x.shape
        H, Dh = (Wq.shape[1], Wq.shape[2])
        M = mem0.shape[1]
        scale = Dh ** (-0.5)
        n_seg = S // seg_len
        L = M + seg_len
        idx = torch.arange(L)
        mask = (idx[:, None] < M) | (idx[:, None] >= idx[None, :])
        mem = mem0
        outs = []
        for s in range(n_seg):
            xs = x[:, s * seg_len:(s + 1) * seg_len, :].clone()
            h = torch.concatenate([mem, xs], axis=1)
            q = torch.einsum('btd,dhe->bhte', h, Wq)
            k = torch.einsum('btd,dhe->bhte', h, Wk)
            v = torch.einsum('btd,dhe->bhte', h, Wv)
            scores = torch.einsum('bhqe,bhke->bhqk', q, k) * scale
            scores = torch.where(mask[None, None], scores, -1000000000.0)
            p = _softmax(scores, axis=-1)
            o = torch.einsum('bhqk,bhke->bhqe', p, v)
            o = torch.einsum('bhte,hed->btd', o, Wo)
            mem = o[:, :M, :].clone()
            outs.append(o[:, M:, :])
        return torch.concatenate(outs, axis=1)

    def _B_ref(x, w_gate, w_up, w_down):
        g = torch.einsum('bsd,df->bsf', x, w_gate)
        u = torch.einsum('bsd,df->bsf', x, w_up)
        h = _sigmoid(g) * u
        return torch.einsum('bsf,fd->bsd', h, w_down)
    x = A_x
    xn = _layernorm(x, axis=-1)
    s = _A_ref(xn, A_mem0, A_Wq, A_Wk, A_Wv, A_Wo, A_seg_len)
    g = _silu(_B_ref(xn, B_w_gate, B_w_up, B_w_down))
    return x + s * g
```

```asm
; @launch grid=(256,1,1) block=(512,1,1) lds=163840
.amdgcn_target "amdgcn-amd-amdhsa--gfx950"
.text
.globl recurrent_scan__memory_aug_recurrent_mem_tr__glu_gated_glu__prompt_kernel
.p2align 8
.type recurrent_scan__memory_aug_recurrent_mem_tr__glu_gated_glu__prompt_kernel,@function
recurrent_scan__memory_aug_recurrent_mem_tr__glu_gated_glu__prompt_kernel:
    s_cmp_ge_u32 s2, 256
    s_cbranch_scc1 k_exit
    s_mov_b32 s99, s2
    s_load_dwordx2 s[4:5], s[0:1], 104
    s_load_dwordx2 s[64:65], s[0:1], 96
    v_lshrrev_b32 v2, 6, v0
    s_mov_b32 s6, 268435456
    s_mov_b32 s7, 131072
    s_mov_b32 s66, 256
    s_mov_b32 s67, 131072
    v_readfirstlane_b32 s3, v2
    s_lshr_b32 s12, s2, 3
    s_and_b32 s13, s2, 3
    s_waitcnt lgkmcnt(0)
    s_bitcmp0_b32 s2, 2
    s_cbranch_scc1 chain_map
    s_lshl_b32 s63, s12, 2
    s_add_u32 s63, s63, s13
    s_cmp_ge_u32 s3, 4
    s_cbranch_scc1 ln_touch
    s_load_dwordx2 s[8:9], s[0:1], 0
    v_and_b32 v1, 63, v0
    s_mov_b32 s10, 4194304
    s_mov_b32 s11, 131072
    v_and_b32 v3, 15, v1
    v_lshrrev_b32 v4, 4, v1
    v_lshlrev_b32 v5, 11, v3
    v_lshl_add_u32 v5, v4, 4, v5
    s_lshl_b32 s12, s63, 15
    s_lshl_b32 s13, s3, 9
    s_add_u32 s12, s12, s13
    s_waitcnt lgkmcnt(0)
    buffer_load_dwordx4 v[16:19], v5, s[8:11], s12 offen offset:0
    buffer_load_dwordx4 v[20:23], v5, s[8:11], s12 offen offset:64
    buffer_load_dwordx4 v[24:27], v5, s[8:11], s12 offen offset:128
    buffer_load_dwordx4 v[28:31], v5, s[8:11], s12 offen offset:192
    buffer_load_dwordx4 v[32:35], v5, s[8:11], s12 offen offset:256
    buffer_load_dwordx4 v[36:39], v5, s[8:11], s12 offen offset:320
    buffer_load_dwordx4 v[40:43], v5, s[8:11], s12 offen offset:384
    buffer_load_dwordx4 v[44:47], v5, s[8:11], s12 offen offset:448
    v_mov_b32 v14, 0
    s_lshl_b32 s13, s63, 7
    s_add_u32 s13, s13, 218103808
    v_lshlrev_b32 v13, 2, v0
    v_cmp_gt_u32 vcc, 32, v0
    s_and_saveexec_b64 s[22:23], vcc
    s_cbranch_execz ln_nz
    buffer_store_dword v14, v13, s[4:7], s13 offen sc1
ln_nz:
    s_mov_b64 exec, -1
    v_lshlrev_b32 v6, 4, v3
    s_lshl_b32 s14, s3, 2
    v_add_u32 v7, s14, v6
    v_lshlrev_b32 v8, 4, v1
    s_lshl_b32 s15, s63, 15
    s_lshl_b32 s16, s3, 13
    s_add_u32 s15, s15, s16
    s_add_u32 s16, s15, 4096
    v_and_b32 v9, 1, v4
    v_cmp_eq_u32 s[20:21], 1, v9
    s_waitcnt vmcnt(1)
    v_lshlrev_b32 v48, 16, v16
    v_and_b32 v49, 0xffff0000, v16
    v_lshlrev_b32 v50, 16, v17
    v_and_b32 v51, 0xffff0000, v17
    v_lshlrev_b32 v52, 16, v18
    v_and_b32 v53, 0xffff0000, v18
    v_lshlrev_b32 v54, 16, v19
    v_and_b32 v55, 0xffff0000, v19
    v_lshlrev_b32 v56, 16, v20
    v_and_b32 v57, 0xffff0000, v20
    v_lshlrev_b32 v58, 16, v21
    v_and_b32 v59, 0xffff0000, v21
    v_lshlrev_b32 v60, 16, v22
    v_and_b32 v61, 0xffff0000, v22
    v_lshlrev_b32 v62, 16, v23
    v_and_b32 v63, 0xffff0000, v23
    v_lshlrev_b32 v64, 16, v24
    v_and_b32 v65, 0xffff0000, v24
    v_lshlrev_b32 v66, 16, v25
    v_and_b32 v67, 0xffff0000, v25
    v_lshlrev_b32 v68, 16, v26
    v_and_b32 v69, 0xffff0000, v26
    v_lshlrev_b32 v70, 16, v27
    v_and_b32 v71, 0xffff0000, v27
    v_lshlrev_b32 v72, 16, v28
    v_and_b32 v73, 0xffff0000, v28
    v_lshlrev_b32 v74, 16, v29
    v_and_b32 v75, 0xffff0000, v29
    v_lshlrev_b32 v76, 16, v30
    v_and_b32 v77, 0xffff0000, v30
    v_lshlrev_b32 v78, 16, v31
    v_and_b32 v79, 0xffff0000, v31
    v_lshlrev_b32 v80, 16, v32
    v_and_b32 v81, 0xffff0000, v32
    v_lshlrev_b32 v82, 16, v33
    v_and_b32 v83, 0xffff0000, v33
    v_lshlrev_b32 v84, 16, v34
    v_and_b32 v85, 0xffff0000, v34
    v_lshlrev_b32 v86, 16, v35
    v_and_b32 v87, 0xffff0000, v35
    v_lshlrev_b32 v88, 16, v36
    v_and_b32 v89, 0xffff0000, v36
    v_lshlrev_b32 v90, 16, v37
    v_and_b32 v91, 0xffff0000, v37
    v_lshlrev_b32 v92, 16, v38
    v_and_b32 v93, 0xffff0000, v38
    v_lshlrev_b32 v94, 16, v39
    v_and_b32 v95, 0xffff0000, v39
    v_lshlrev_b32 v96, 16, v40
    v_and_b32 v97, 0xffff0000, v40
    v_lshlrev_b32 v98, 16, v41
    v_and_b32 v99, 0xffff0000, v41
    v_lshlrev_b32 v100, 16, v42
    v_and_b32 v101, 0xffff0000, v42
    v_lshlrev_b32 v102, 16, v43
    v_and_b32 v103, 0xffff0000, v43
    v_lshlrev_b32 v104, 16, v44
    v_and_b32 v105, 0xffff0000, v44
    v_lshlrev_b32 v106, 16, v45
    v_and_b32 v107, 0xffff0000, v45
    v_lshlrev_b32 v108, 16, v46
    v_and_b32 v109, 0xffff0000, v46
    v_lshlrev_b32 v110, 16, v47
    v_and_b32 v111, 0xffff0000, v47
    v_add_f32 v112, v48, v80
    v_add_f32 v113, v49, v81
    v_add_f32 v114, v50, v82
    v_add_f32 v115, v51, v83
    v_add_f32 v116, v52, v84
    v_add_f32 v117, v53, v85
    v_add_f32 v118, v54, v86
    v_add_f32 v119, v55, v87
    v_add_f32 v120, v56, v88
    v_add_f32 v121, v57, v89
    v_add_f32 v122, v58, v90
    v_add_f32 v123, v59, v91
    v_add_f32 v124, v60, v92
    v_add_f32 v125, v61, v93
    v_add_f32 v126, v62, v94
    v_add_f32 v127, v63, v95
    v_add_f32 v128, v64, v96
    v_add_f32 v129, v65, v97
    v_add_f32 v130, v66, v98
    v_add_f32 v131, v67, v99
    v_add_f32 v132, v68, v100
    v_add_f32 v133, v69, v101
    v_add_f32 v134, v70, v102
    v_add_f32 v135, v71, v103
    v_add_f32 v136, v72, v104
    v_add_f32 v137, v73, v105
    v_add_f32 v138, v74, v106
    v_add_f32 v139, v75, v107
    v_add_f32 v140, v76, v108
    v_add_f32 v141, v77, v109
    v_add_f32 v142, v78, v110
    v_add_f32 v143, v79, v111
    v_add_f32 v112, v112, v128
    v_add_f32 v113, v113, v129
    v_add_f32 v114, v114, v130
    v_add_f32 v115, v115, v131
    v_add_f32 v116, v116, v132
    v_add_f32 v117, v117, v133
    v_add_f32 v118, v118, v134
    v_add_f32 v119, v119, v135
    v_add_f32 v120, v120, v136
    v_add_f32 v121, v121, v137
    v_add_f32 v122, v122, v138
    v_add_f32 v123, v123, v139
    v_add_f32 v124, v124, v140
    v_add_f32 v125, v125, v141
    v_add_f32 v126, v126, v142
    v_add_f32 v127, v127, v143
    v_add_f32 v112, v112, v120
    v_add_f32 v113, v113, v121
    v_add_f32 v114, v114, v122
    v_add_f32 v115, v115, v123
    v_add_f32 v116, v116, v124
    v_add_f32 v117, v117, v125
    v_add_f32 v118, v118, v126
    v_add_f32 v119, v119, v127
    v_add_f32 v112, v112, v116
    v_add_f32 v113, v113, v117
    v_add_f32 v114, v114, v118
    v_add_f32 v115, v115, v119
    v_add_f32 v112, v112, v114
    v_add_f32 v113, v113, v115
    v_add_f32 v112, v112, v113
    v_mov_b32 v113, v112
    s_nop 1
    v_permlane16_swap_b32 v113, v112
    v_add_f32 v112, v112, v113
    v_mov_b32 v113, v112
    s_nop 1
    v_permlane32_swap_b32 v113, v112
    v_add_f32 v112, v112, v113
    ds_write_b32 v7, v112
    s_waitcnt lgkmcnt(0)
    s_barrier
    ds_read_b128 v[112:115], v6
    s_waitcnt lgkmcnt(0)
    v_add_f32 v112, v112, v114
    v_add_f32 v113, v113, v115
    v_add_f32 v112, v112, v113
    v_mul_f32 v10, 0x3a800000, v112
    v_sub_f32 v176, v48, v10
    v_sub_f32 v177, v49, v10
    v_sub_f32 v178, v50, v10
    v_sub_f32 v179, v51, v10
    v_sub_f32 v180, v52, v10
    v_sub_f32 v181, v53, v10
    v_sub_f32 v182, v54, v10
    v_sub_f32 v183, v55, v10
    v_sub_f32 v184, v56, v10
    v_sub_f32 v185, v57, v10
    v_sub_f32 v186, v58, v10
    v_sub_f32 v187, v59, v10
    v_sub_f32 v188, v60, v10
    v_sub_f32 v189, v61, v10
    v_sub_f32 v190, v62, v10
    v_sub_f32 v191, v63, v10
    v_sub_f32 v192, v64, v10
    v_sub_f32 v193, v65, v10
    v_sub_f32 v194, v66, v10
    v_sub_f32 v195, v67, v10
    v_sub_f32 v196, v68, v10
    v_sub_f32 v197, v69, v10
    v_sub_f32 v198, v70, v10
    v_sub_f32 v199, v71, v10
    v_sub_f32 v200, v72, v10
    v_sub_f32 v201, v73, v10
    v_sub_f32 v202, v74, v10
    v_sub_f32 v203, v75, v10
    v_sub_f32 v204, v76, v10
    v_sub_f32 v205, v77, v10
    v_sub_f32 v206, v78, v10
    v_sub_f32 v207, v79, v10
    v_sub_f32 v208, v80, v10
    v_sub_f32 v209, v81, v10
    v_sub_f32 v210, v82, v10
    v_sub_f32 v211, v83, v10
    v_sub_f32 v212, v84, v10
    v_sub_f32 v213, v85, v10
    v_sub_f32 v214, v86, v10
    v_sub_f32 v215, v87, v10
    v_sub_f32 v216, v88, v10
    v_sub_f32 v217, v89, v10
    v_sub_f32 v218, v90, v10
    v_sub_f32 v219, v91, v10
    v_sub_f32 v220, v92, v10
    v_sub_f32 v221, v93, v10
    v_sub_f32 v222, v94, v10
    v_sub_f32 v223, v95, v10
    v_sub_f32 v224, v96, v10
    v_sub_f32 v225, v97, v10
    v_sub_f32 v226, v98, v10
    v_sub_f32 v227, v99, v10
    v_sub_f32 v228, v100, v10
    v_sub_f32 v229, v101, v10
    v_sub_f32 v230, v102, v10
    v_sub_f32 v231, v103, v10
    v_sub_f32 v232, v104, v10
    v_sub_f32 v233, v105, v10
    v_sub_f32 v234, v106, v10
    v_sub_f32 v235, v107, v10
    v_sub_f32 v236, v108, v10
    v_sub_f32 v237, v109, v10
    v_sub_f32 v238, v110, v10
    v_sub_f32 v239, v111, v10
    v_mul_f32 v112, v176, v176
    v_fmac_f32 v112, v208, v208
    v_mul_f32 v113, v177, v177
    v_fmac_f32 v113, v209, v209
    v_mul_f32 v114, v178, v178
    v_fmac_f32 v114, v210, v210
    v_mul_f32 v115, v179, v179
    v_fmac_f32 v115, v211, v211
    v_mul_f32 v116, v180, v180
    v_fmac_f32 v116, v212, v212
    v_mul_f32 v117, v181, v181
    v_fmac_f32 v117, v213, v213
    v_mul_f32 v118, v182, v182
    v_fmac_f32 v118, v214, v214
    v_mul_f32 v119, v183, v183
    v_fmac_f32 v119, v215, v215
    v_mul_f32 v120, v184, v184
    v_fmac_f32 v120, v216, v216
    v_mul_f32 v121, v185, v185
    v_fmac_f32 v121, v217, v217
    v_mul_f32 v122, v186, v186
    v_fmac_f32 v122, v218, v218
    v_mul_f32 v123, v187, v187
    v_fmac_f32 v123, v219, v219
    v_mul_f32 v124, v188, v188
    v_fmac_f32 v124, v220, v220
    v_mul_f32 v125, v189, v189
    v_fmac_f32 v125, v221, v221
    v_mul_f32 v126, v190, v190
    v_fmac_f32 v126, v222, v222
    v_mul_f32 v127, v191, v191
    v_fmac_f32 v127, v223, v223
    v_mul_f32 v128, v192, v192
    v_fmac_f32 v128, v224, v224
    v_mul_f32 v129, v193, v193
    v_fmac_f32 v129, v225, v225
    v_mul_f32 v130, v194, v194
    v_fmac_f32 v130, v226, v226
    v_mul_f32 v131, v195, v195
    v_fmac_f32 v131, v227, v227
    v_mul_f32 v132, v196, v196
    v_fmac_f32 v132, v228, v228
    v_mul_f32 v133, v197, v197
    v_fmac_f32 v133, v229, v229
    v_mul_f32 v134, v198, v198
    v_fmac_f32 v134, v230, v230
    v_mul_f32 v135, v199, v199
    v_fmac_f32 v135, v231, v231
    v_mul_f32 v136, v200, v200
    v_fmac_f32 v136, v232, v232
    v_mul_f32 v137, v201, v201
    v_fmac_f32 v137, v233, v233
    v_mul_f32 v138, v202, v202
    v_fmac_f32 v138, v234, v234
    v_mul_f32 v139, v203, v203
    v_fmac_f32 v139, v235, v235
    v_mul_f32 v140, v204, v204
    v_fmac_f32 v140, v236, v236
    v_mul_f32 v141, v205, v205
    v_fmac_f32 v141, v237, v237
    v_mul_f32 v142, v206, v206
    v_fmac_f32 v142, v238, v238
    v_mul_f32 v143, v207, v207
    v_fmac_f32 v143, v239, v239
    v_add_f32 v112, v112, v128
    v_add_f32 v113, v113, v129
    v_add_f32 v114, v114, v130
    v_add_f32 v115, v115, v131
    v_add_f32 v116, v116, v132
    v_add_f32 v117, v117, v133
    v_add_f32 v118, v118, v134
    v_add_f32 v119, v119, v135
    v_add_f32 v120, v120, v136
    v_add_f32 v121, v121, v137
    v_add_f32 v122, v122, v138
    v_add_f32 v123, v123, v139
    v_add_f32 v124, v124, v140
    v_add_f32 v125, v125, v141
    v_add_f32 v126, v126, v142
    v_add_f32 v127, v127, v143
    v_add_f32 v112, v112, v120
    v_add_f32 v113, v113, v121
    v_add_f32 v114, v114, v122
    v_add_f32 v115, v115, v123
    v_add_f32 v116, v116, v124
    v_add_f32 v117, v117, v125
    v_add_f32 v118, v118, v126
    v_add_f32 v119, v119, v127
    v_add_f32 v112, v112, v116
    v_add_f32 v113, v113, v117
    v_add_f32 v114, v114, v118
    v_add_f32 v115, v115, v119
    v_add_f32 v112, v112, v114
    v_add_f32 v113, v113, v115
    v_add_f32 v112, v112, v113
    v_mov_b32 v113, v112
    s_nop 1
    v_permlane16_swap_b32 v113, v112
    v_add_f32 v112, v112, v113
    v_mov_b32 v113, v112
    s_nop 1
    v_permlane32_swap_b32 v113, v112
    v_add_f32 v112, v112, v113
    ds_write_b32 v7, v112 offset:512
    s_waitcnt lgkmcnt(0)
    s_barrier
    ds_read_b128 v[112:115], v6 offset:512
    s_waitcnt lgkmcnt(0)
    v_add_f32 v112, v112, v114
    v_add_f32 v113, v113, v115
    v_add_f32 v112, v112, v113
    v_mul_f32 v11, 0x3a800000, v112
    v_cvt_pk_bf16_f32 v10, v10, v10
    v_lshlrev_b32 v10, 16, v10
    v_cvt_pk_bf16_f32 v11, v11, v11
    v_lshlrev_b32 v11, 16, v11
    v_add_f32 v11, 0x3727c5ac, v11
    v_cvt_pk_bf16_f32 v11, v11, v11
    v_lshlrev_b32 v11, 16, v11
    v_sqrt_f32 v11, v11
    s_nop 0
    v_cvt_pk_bf16_f32 v11, v11, v11
    v_lshlrev_b32 v11, 16, v11
    v_rcp_f32 v11, v11
    s_nop 0
    v_sub_f32 v48, v48, v10
    v_sub_f32 v49, v49, v10
    v_cvt_pk_bf16_f32 v16, v48, v49
    v_lshlrev_b32 v48, 16, v16
    v_and_b32 v49, 0xffff0000, v16
    v_mul_f32 v48, v48, v11
    v_mul_f32 v49, v49, v11
    v_cvt_pk_bf16_f32 v16, v48, v49
    v_sub_f32 v50, v50, v10
    v_sub_f32 v51, v51, v10
    v_cvt_pk_bf16_f32 v17, v50, v51
    v_lshlrev_b32 v50, 16, v17
    v_and_b32 v51, 0xffff0000, v17
    v_mul_f32 v50, v50, v11
    v_mul_f32 v51, v51, v11
    v_cvt_pk_bf16_f32 v17, v50, v51
    v_sub_f32 v52, v52, v10
    v_sub_f32 v53, v53, v10
    v_cvt_pk_bf16_f32 v18, v52, v53
    v_lshlrev_b32 v52, 16, v18
    v_and_b32 v53, 0xffff0000, v18
    v_mul_f32 v52, v52, v11
    v_mul_f32 v53, v53, v11
    v_cvt_pk_bf16_f32 v18, v52, v53
    v_sub_f32 v54, v54, v10
    v_sub_f32 v55, v55, v10
    v_cvt_pk_bf16_f32 v19, v54, v55
    v_lshlrev_b32 v54, 16, v19
    v_and_b32 v55, 0xffff0000, v19
    v_mul_f32 v54, v54, v11
    v_mul_f32 v55, v55, v11
    v_cvt_pk_bf16_f32 v19, v54, v55
    v_cndmask_b32 v112, v16, v18, s[20:21]
    v_cndmask_b32 v113, v17, v19, s[20:21]
    v_cndmask_b32 v114, v18, v16, s[20:21]
    v_cndmask_b32 v115, v19, v17, s[20:21]
    buffer_store_dwordx4 v[112:115], v8, s[4:7], s15 offen offset:0 sc1
    v_sub_f32 v56, v56, v10
    v_sub_f32 v57, v57, v10
    v_cvt_pk_bf16_f32 v20, v56, v57
    v_lshlrev_b32 v56, 16, v20
    v_and_b32 v57, 0xffff0000, v20
    v_mul_f32 v56, v56, v11
    v_mul_f32 v57, v57, v11
    v_cvt_pk_bf16_f32 v20, v56, v57
    v_sub_f32 v58, v58, v10
    v_sub_f32 v59, v59, v10
    v_cvt_pk_bf16_f32 v21, v58, v59
    v_lshlrev_b32 v58, 16, v21
    v_and_b32 v59, 0xffff0000, v21
    v_mul_f32 v58, v58, v11
    v_mul_f32 v59, v59, v11
    v_cvt_pk_bf16_f32 v21, v58, v59
    v_sub_f32 v60, v60, v10
    v_sub_f32 v61, v61, v10
    v_cvt_pk_bf16_f32 v22, v60, v61
    v_lshlrev_b32 v60, 16, v22
    v_and_b32 v61, 0xffff0000, v22
    v_mul_f32 v60, v60, v11
    v_mul_f32 v61, v61, v11
    v_cvt_pk_bf16_f32 v22, v60, v61
    v_sub_f32 v62, v62, v10
    v_sub_f32 v63, v63, v10
    v_cvt_pk_bf16_f32 v23, v62, v63
    v_lshlrev_b32 v62, 16, v23
    v_and_b32 v63, 0xffff0000, v23
    v_mul_f32 v62, v62, v11
    v_mul_f32 v63, v63, v11
    v_cvt_pk_bf16_f32 v23, v62, v63
    v_cndmask_b32 v116, v20, v22, s[20:21]
    v_cndmask_b32 v117, v21, v23, s[20:21]
    v_cndmask_b32 v118, v22, v20, s[20:21]
    v_cndmask_b32 v119, v23, v21, s[20:21]
    buffer_store_dwordx4 v[116:119], v8, s[4:7], s15 offen offset:1024 sc1
    v_sub_f32 v64, v64, v10
    v_sub_f32 v65, v65, v10
    v_cvt_pk_bf16_f32 v24, v64, v65
    v_lshlrev_b32 v64, 16, v24
    v_and_b32 v65, 0xffff0000, v24
    v_mul_f32 v64, v64, v11
    v_mul_f32 v65, v65, v11
    v_cvt_pk_bf16_f32 v24, v64, v65
    v_sub_f32 v66, v66, v10
    v_sub_f32 v67, v67, v10
    v_cvt_pk_bf16_f32 v25, v66, v67
    v_lshlrev_b32 v66, 16, v25
    v_and_b32 v67, 0xffff0000, v25
    v_mul_f32 v66, v66, v11
    v_mul_f32 v67, v67, v11
    v_cvt_pk_bf16_f32 v25, v66, v67
    v_sub_f32 v68, v68, v10
    v_sub_f32 v69, v69, v10
    v_cvt_pk_bf16_f32 v26, v68, v69
    v_lshlrev_b32 v68, 16, v26
    v_and_b32 v69, 0xffff0000, v26
    v_mul_f32 v68, v68, v11
    v_mul_f32 v69, v69, v11
    v_cvt_pk_bf16_f32 v26, v68, v69
    v_sub_f32 v70, v70, v10
    v_sub_f32 v71, v71, v10
    v_cvt_pk_bf16_f32 v27, v70, v71
    v_lshlrev_b32 v70, 16, v27
    v_and_b32 v71, 0xffff0000, v27
    v_mul_f32 v70, v70, v11
    v_mul_f32 v71, v71, v11
    v_cvt_pk_bf16_f32 v27, v70, v71
    v_cndmask_b32 v120, v24, v26, s[20:21]
    v_cndmask_b32 v121, v25, v27, s[20:21]
    v_cndmask_b32 v122, v26, v24, s[20:21]
    v_cndmask_b32 v123, v27, v25, s[20:21]
    buffer_store_dwordx4 v[120:123], v8, s[4:7], s15 offen offset:2048 sc1
    v_sub_f32 v72, v72, v10
    v_sub_f32 v73, v73, v10
    v_cvt_pk_bf16_f32 v28, v72, v73
    v_lshlrev_b32 v72, 16, v28
    v_and_b32 v73, 0xffff0000, v28
    v_mul_f32 v72, v72, v11
    v_mul_f32 v73, v73, v11
    v_cvt_pk_bf16_f32 v28, v72, v73
    v_sub_f32 v74, v74, v10
    v_sub_f32 v75, v75, v10
    v_cvt_pk_bf16_f32 v29, v74, v75
    v_lshlrev_b32 v74, 16, v29
    v_and_b32 v75, 0xffff0000, v29
    v_mul_f32 v74, v74, v11
    v_mul_f32 v75, v75, v11
    v_cvt_pk_bf16_f32 v29, v74, v75
    v_sub_f32 v76, v76, v10
    v_sub_f32 v77, v77, v10
    v_cvt_pk_bf16_f32 v30, v76, v77
    v_lshlrev_b32 v76, 16, v30
    v_and_b32 v77, 0xffff0000, v30
    v_mul_f32 v76, v76, v11
    v_mul_f32 v77, v77, v11
    v_cvt_pk_bf16_f32 v30, v76, v77
    v_sub_f32 v78, v78, v10
    v_sub_f32 v79, v79, v10
    v_cvt_pk_bf16_f32 v31, v78, v79
    v_lshlrev_b32 v78, 16, v31
    v_and_b32 v79, 0xffff0000, v31
    v_mul_f32 v78, v78, v11
    v_mul_f32 v79, v79, v11
    v_cvt_pk_bf16_f32 v31, v78, v79
    v_cndmask_b32 v124, v28, v30, s[20:21]
    v_cndmask_b32 v125, v29, v31, s[20:21]
    v_cndmask_b32 v126, v30, v28, s[20:21]
    v_cndmask_b32 v127, v31, v29, s[20:21]
    buffer_store_dwordx4 v[124:127], v8, s[4:7], s15 offen offset:3072 sc1
    v_sub_f32 v80, v80, v10
    v_sub_f32 v81, v81, v10
    v_cvt_pk_bf16_f32 v32, v80, v81
    v_lshlrev_b32 v80, 16, v32
    v_and_b32 v81, 0xffff0000, v32
    v_mul_f32 v80, v80, v11
    v_mul_f32 v81, v81, v11
    v_cvt_pk_bf16_f32 v32, v80, v81
    v_sub_f32 v82, v82, v10
    v_sub_f32 v83, v83, v10
    v_cvt_pk_bf16_f32 v33, v82, v83
    v_lshlrev_b32 v82, 16, v33
    v_and_b32 v83, 0xffff0000, v33
    v_mul_f32 v82, v82, v11
    v_mul_f32 v83, v83, v11
    v_cvt_pk_bf16_f32 v33, v82, v83
    v_sub_f32 v84, v84, v10
    v_sub_f32 v85, v85, v10
    v_cvt_pk_bf16_f32 v34, v84, v85
    v_lshlrev_b32 v84, 16, v34
    v_and_b32 v85, 0xffff0000, v34
    v_mul_f32 v84, v84, v11
    v_mul_f32 v85, v85, v11
    v_cvt_pk_bf16_f32 v34, v84, v85
    v_sub_f32 v86, v86, v10
    v_sub_f32 v87, v87, v10
    v_cvt_pk_bf16_f32 v35, v86, v87
    v_lshlrev_b32 v86, 16, v35
    v_and_b32 v87, 0xffff0000, v35
    v_mul_f32 v86, v86, v11
    v_mul_f32 v87, v87, v11
    v_cvt_pk_bf16_f32 v35, v86, v87
    v_cndmask_b32 v128, v32, v34, s[20:21]
    v_cndmask_b32 v129, v33, v35, s[20:21]
    v_cndmask_b32 v130, v34, v32, s[20:21]
    v_cndmask_b32 v131, v35, v33, s[20:21]
    buffer_store_dwordx4 v[128:131], v8, s[4:7], s16 offen offset:0 sc1
    v_sub_f32 v88, v88, v10
    v_sub_f32 v89, v89, v10
    v_cvt_pk_bf16_f32 v36, v88, v89
    v_lshlrev_b32 v88, 16, v36
    v_and_b32 v89, 0xffff0000, v36
    v_mul_f32 v88, v88, v11
    v_mul_f32 v89, v89, v11
    v_cvt_pk_bf16_f32 v36, v88, v89
    v_sub_f32 v90, v90, v10
    v_sub_f32 v91, v91, v10
    v_cvt_pk_bf16_f32 v37, v90, v91
    v_lshlrev_b32 v90, 16, v37
    v_and_b32 v91, 0xffff0000, v37
    v_mul_f32 v90, v90, v11
    v_mul_f32 v91, v91, v11
    v_cvt_pk_bf16_f32 v37, v90, v91
    v_sub_f32 v92, v92, v10
    v_sub_f32 v93, v93, v10
    v_cvt_pk_bf16_f32 v38, v92, v93
    v_lshlrev_b32 v92, 16, v38
    v_and_b32 v93, 0xffff0000, v38
    v_mul_f32 v92, v92, v11
    v_mul_f32 v93, v93, v11
    v_cvt_pk_bf16_f32 v38, v92, v93
    v_sub_f32 v94, v94, v10
    v_sub_f32 v95, v95, v10
    v_cvt_pk_bf16_f32 v39, v94, v95
    v_lshlrev_b32 v94, 16, v39
    v_and_b32 v95, 0xffff0000, v39
    v_mul_f32 v94, v94, v11
    v_mul_f32 v95, v95, v11
    v_cvt_pk_bf16_f32 v39, v94, v95
    v_cndmask_b32 v132, v36, v38, s[20:21]
    v_cndmask_b32 v133, v37, v39, s[20:21]
    v_cndmask_b32 v134, v38, v36, s[20:21]
    v_cndmask_b32 v135, v39, v37, s[20:21]
    buffer_store_dwordx4 v[132:135], v8, s[4:7], s16 offen offset:1024 sc1
    v_sub_f32 v96, v96, v10
    v_sub_f32 v97, v97, v10
    v_cvt_pk_bf16_f32 v40, v96, v97
    v_lshlrev_b32 v96, 16, v40
    v_and_b32 v97, 0xffff0000, v40
    v_mul_f32 v96, v96, v11
    v_mul_f32 v97, v97, v11
    v_cvt_pk_bf16_f32 v40, v96, v97
    v_sub_f32 v98, v98, v10
    v_sub_f32 v99, v99, v10
    v_cvt_pk_bf16_f32 v41, v98, v99
    v_lshlrev_b32 v98, 16, v41
    v_and_b32 v99, 0xffff0000, v41
    v_mul_f32 v98, v98, v11
    v_mul_f32 v99, v99, v11
    v_cvt_pk_bf16_f32 v41, v98, v99
    v_sub_f32 v100, v100, v10
    v_sub_f32 v101, v101, v10
    v_cvt_pk_bf16_f32 v42, v100, v101
    v_lshlrev_b32 v100, 16, v42
    v_and_b32 v101, 0xffff0000, v42
    v_mul_f32 v100, v100, v11
    v_mul_f32 v101, v101, v11
    v_cvt_pk_bf16_f32 v42, v100, v101
    v_sub_f32 v102, v102, v10
    v_sub_f32 v103, v103, v10
    v_cvt_pk_bf16_f32 v43, v102, v103
    v_lshlrev_b32 v102, 16, v43
    v_and_b32 v103, 0xffff0000, v43
    v_mul_f32 v102, v102, v11
    v_mul_f32 v103, v103, v11
    v_cvt_pk_bf16_f32 v43, v102, v103
    v_cndmask_b32 v136, v40, v42, s[20:21]
    v_cndmask_b32 v137, v41, v43, s[20:21]
    v_cndmask_b32 v138, v42, v40, s[20:21]
    v_cndmask_b32 v139, v43, v41, s[20:21]
    buffer_store_dwordx4 v[136:139], v8, s[4:7], s16 offen offset:2048 sc1
    v_sub_f32 v104, v104, v10
    v_sub_f32 v105, v105, v10
    v_cvt_pk_bf16_f32 v44, v104, v105
    v_lshlrev_b32 v104, 16, v44
    v_and_b32 v105, 0xffff0000, v44
    v_mul_f32 v104, v104, v11
    v_mul_f32 v105, v105, v11
    v_cvt_pk_bf16_f32 v44, v104, v105
    v_sub_f32 v106, v106, v10
    v_sub_f32 v107, v107, v10
    v_cvt_pk_bf16_f32 v45, v106, v107
    v_lshlrev_b32 v106, 16, v45
    v_and_b32 v107, 0xffff0000, v45
    v_mul_f32 v106, v106, v11
    v_mul_f32 v107, v107, v11
    v_cvt_pk_bf16_f32 v45, v106, v107
    v_sub_f32 v108, v108, v10
    v_sub_f32 v109, v109, v10
    v_cvt_pk_bf16_f32 v46, v108, v109
    v_lshlrev_b32 v108, 16, v46
    v_and_b32 v109, 0xffff0000, v46
    v_mul_f32 v108, v108, v11
    v_mul_f32 v109, v109, v11
    v_cvt_pk_bf16_f32 v46, v108, v109
    v_sub_f32 v110, v110, v10
    v_sub_f32 v111, v111, v10
    v_cvt_pk_bf16_f32 v47, v110, v111
    v_lshlrev_b32 v110, 16, v47
    v_and_b32 v111, 0xffff0000, v47
    v_mul_f32 v110, v110, v11
    v_mul_f32 v111, v111, v11
    v_cvt_pk_bf16_f32 v47, v110, v111
    v_cndmask_b32 v140, v44, v46, s[20:21]
    v_cndmask_b32 v141, v45, v47, s[20:21]
    v_cndmask_b32 v142, v46, v44, s[20:21]
    v_cndmask_b32 v143, v47, v45, s[20:21]
    buffer_store_dwordx4 v[140:143], v8, s[4:7], s16 offen offset:3072 sc1
    s_waitcnt vmcnt(0)
    s_barrier
    s_cmp_lg_u32 s3, 0
    s_cbranch_scc1 ln_sig
    v_mov_b32 v2, 1
    s_mov_b64 exec, 1
    s_cmp_ge_u32 s63, 8
    s_cbranch_scc1 ln_sb
    buffer_atomic_add v2, off, s[64:67], 0 offset:192 sc1
ln_sb:
    buffer_atomic_add v2, off, s[64:67], 0 offset:0 sc1
    s_mov_b64 exec, -1
    s_branch ln_sig
ln_touch:
    s_getpc_b64 s[24:25]
    s_add_u32 s24, s24, jobtab@rel32@lo+4
    s_addc_u32 s25, s25, jobtab@rel32@hi+12
    s_mul_i32 s30, s63, 640
    s_add_u32 s24, s24, s30
    s_addc_u32 s25, s25, 0
    s_load_dwordx16 s[32:47], s[24:25], 0
    s_mov_b32 s11, 131072
    v_and_b32 v20, 63, v0
    s_waitcnt lgkmcnt(0)
    s_load_dwordx2 s[8:9], s[0:1], s33
    s_mov_b32 s10, s38
    s_lshl_b32 s30, s35, 4
    v_mul_lo_u32 v21, s30, v20
    v_and_b32 v22, 15, v20
    v_mul_lo_u32 v22, s43, v22
    s_waitcnt lgkmcnt(0)
    s_cmp_eq_u32 s3, 4
    s_cbranch_scc0 tlb_1_1
    buffer_load_dword v23, v21, s[8:11], s36 offen
    s_branch tlb_1
tlb_1_1:
    s_cmp_eq_u32 s3, 5
    s_cbranch_scc0 tlb_1
    buffer_load_dword v23, v22, s[4:7], s42 offen
    buffer_load_dword v23, off, s[4:7], s46
tlb_1:
    s_barrier
    s_barrier
    s_barrier
ln_sig:
    s_cmp_lt_u32 s63, 120
    s_cbranch_scc1 prb_done
    s_cmp_lg_u32 s3, 0
    s_cbranch_scc1 prb_bar
    s_sub_u32 s12, s63, 120
    s_lshl_b32 s62, s12, 7
    s_add_u32 s62, s62, 218112000
    s_lshl_b32 s21, s12, 10
    s_add_u32 s21, s21, 209715200
    s_mov_b32 s80, -1
    s_mov_b32 s81, -1
    s_mov_b64 exec, 1
    s_memtime s[74:75]
    s_add_u32 s24, s21, 0
    s_waitcnt lgkmcnt(0)
    buffer_load_dword v3, off, s[4:7], s24 sc1
    s_waitcnt vmcnt(0)
    s_memtime s[76:77]
    s_waitcnt lgkmcnt(0)
    s_sub_u32 s24, s76, s74
    s_min_u32 s80, s80, s24
    s_memtime s[74:75]
    s_add_u32 s24, s21, 8192
    s_waitcnt lgkmcnt(0)
    buffer_load_dword v3, off, s[4:7], s24 sc1
    s_waitcnt vmcnt(0)
    s_memtime s[76:77]
    s_waitcnt lgkmcnt(0)
    s_sub_u32 s24, s76, s74
    s_min_u32 s81, s81, s24
    s_memtime s[74:75]
    s_add_u32 s24, s21, 16384
    s_waitcnt lgkmcnt(0)
    buffer_load_dword v3, off, s[4:7], s24 sc1
    s_waitcnt vmcnt(0)
    s_memtime s[76:77]
    s_waitcnt lgkmcnt(0)
    s_sub_u32 s24, s76, s74
    s_min_u32 s80, s80, s24
    s_memtime s[74:75]
    s_add_u32 s24, s21, 24576
    s_waitcnt lgkmcnt(0)
    buffer_load_dword v3, off, s[4:7], s24 sc1
    s_waitcnt vmcnt(0)
    s_memtime s[76:77]
    s_waitcnt lgkmcnt(0)
    s_sub_u32 s24, s76, s74
    s_min_u32 s81, s81, s24
    s_memtime s[74:75]
    s_add_u32 s24, s21, 32768
    s_waitcnt lgkmcnt(0)
    buffer_load_dword v3, off, s[4:7], s24 sc1
    s_waitcnt vmcnt(0)
    s_memtime s[76:77]
    s_waitcnt lgkmcnt(0)
    s_sub_u32 s24, s76, s74
    s_min_u32 s80, s80, s24
    s_memtime s[74:75]
    s_add_u32 s24, s21, 40960
    s_waitcnt lgkmcnt(0)
    buffer_load_dword v3, off, s[4:7], s24 sc1
    s_waitcnt vmcnt(0)
    s_memtime s[76:77]
    s_waitcnt lgkmcnt(0)
    s_sub_u32 s24, s76, s74
    s_min_u32 s81, s81, s24
    s_memtime s[74:75]
    s_add_u32 s24, s21, 49152
    s_waitcnt lgkmcnt(0)
    buffer_load_dword v3, off, s[4:7], s24 sc1
    s_waitcnt vmcnt(0)
    s_memtime s[76:77]
    s_waitcnt lgkmcnt(0)
    s_sub_u32 s24, s76, s74
    s_min_u32 s80, s80, s24
    s_memtime s[74:75]
    s_add_u32 s24, s21, 57344
    s_waitcnt lgkmcnt(0)
    buffer_load_dword v3, off, s[4:7], s24 sc1
    s_waitcnt vmcnt(0)
    s_memtime s[76:77]
    s_waitcnt lgkmcnt(0)
    s_sub_u32 s24, s76, s74
    s_min_u32 s81, s81, s24
    s_memtime s[74:75]
    s_add_u32 s24, s21, 65536
    s_waitcnt lgkmcnt(0)
    buffer_load_dword v3, off, s[4:7], s24 sc1
    s_waitcnt vmcnt(0)
    s_memtime s[76:77]
    s_waitcnt lgkmcnt(0)
    s_sub_u32 s24, s76, s74
    s_min_u32 s80, s80, s24
    s_memtime s[74:75]
    s_add_u32 s24, s21, 73728
    s_waitcnt lgkmcnt(0)
    buffer_load_dword v3, off, s[4:7], s24 sc1
    s_waitcnt vmcnt(0)
    s_memtime s[76:77]
    s_waitcnt lgkmcnt(0)
    s_sub_u32 s24, s76, s74
    s_min_u32 s81, s81, s24
    s_memtime s[74:75]
    s_add_u32 s24, s21, 81920
    s_waitcnt lgkmcnt(0)
    buffer_load_dword v3, off, s[4:7], s24 sc1
    s_waitcnt vmcnt(0)
    s_memtime s[76:77]
    s_waitcnt lgkmcnt(0)
    s_sub_u32 s24, s76, s74
    s_min_u32 s80, s80, s24
    s_memtime s[74:75]
    s_add_u32 s24, s21, 90112
    s_waitcnt lgkmcnt(0)
    buffer_load_dword v3, off, s[4:7], s24 sc1
    s_waitcnt vmcnt(0)
    s_memtime s[76:77]
    s_waitcnt lgkmcnt(0)
    s_sub_u32 s24, s76, s74
    s_min_u32 s81, s81, s24
    s_sub_i32 s22, s80, s81
    s_min_i32 s22, s22, 400
    s_max_i32 s22, s22, -400
    s_lshl_b32 s22, s22, 8
    s_getreg_b32 s23, hwreg(HW_REG_XCC_ID)
    s_bfe_u32 s23, s23, 0x10002
    s_lshl_b32 s23, s23, 1
    s_or_b32 s22, s22, s23
    s_or_b32 s22, s22, 1
    s_mov_b32 s23, 65536
prb_i:
    buffer_load_dword v3, off, s[64:67], 0 offset:0 sc1
    s_waitcnt vmcnt(0)
    v_readfirstlane_b32 s21, v3
    s_cmp_ge_u32 s21, 128
    s_cbranch_scc1 prb_i_ok
    s_sleep 8
    s_sub_u32 s23, s23, 1
    s_cbranch_scc0 prb_i
prb_i_ok:
    v_mov_b32 v3, s22
    buffer_store_dword v3, off, s[4:7], s62 offset:8 sc1
    s_mov_b64 exec, -1
prb_bar:
    s_barrier
prb_done:
    s_mov_b32 s29, s63
    v_and_b32 v20, 63, v0
    v_lshlrev_b32 v1, 4, v20
    v_add_u32 v19, 0x1000, v1
    v_lshrrev_b32 v4, 4, v20
    v_mov_b32 v17, 0
    v_mov_b32 v18, 1
    s_lshr_b32 s26, s3, 2
    s_and_b32 s27, s3, 3
    s_lshl_b32 s21, s3, 11
    s_lshl_b32 s22, s3, 10
    s_add_u32 s22, s22, 16384
    s_mov_b32 s11, 131072
    s_mov_b32 s15, 131072
    s_mov_b32 s28, 0
    v_and_b32 v21, 15, v20
    v_lshlrev_b32 v22, 2, v4
    v_xor_b32 v21, v21, v22
    s_lshr_b32 s30, s3, 1
    s_and_b32 s30, s30, 1
    v_xor_b32 v21, s30, v21
    v_lshlrev_b32 v3, 4, v21
    s_lshl_b32 s30, s26, 13
    v_add_u32 v5, s30, v1
    v_add_u32 v6, 0x10000, v5
    v_bfe_u32 v21, v20, 2, 2
    v_and_b32 v22, 3, v20
    v_and_b32 v23, 1, v4
    v_xor_b32 v24, s27, v21
    v_xor_b32 v25, v22, v23
    v_lshl_add_u32 v24, v24, 2, v25
    v_lshlrev_b32 v24, 4, v24
    v_lshl_add_u32 v25, v4, 3, v21
    v_lshl_add_u32 v24, v25, 8, v24
    v_and_b32 v22, 1, v22
    v_xor_b32 v25, 0, v23
    v_lshl_add_u32 v8, v25, 10, v24
    v_xor_b32 v25, 0, v22
    v_lshl_add_u32 v8, v25, 3, v8
    v_add_u32 v12, 0x10000, v8
    v_xor_b32 v25, 1, v23
    v_lshl_add_u32 v9, v25, 10, v24
    v_xor_b32 v25, 0, v22
    v_lshl_add_u32 v9, v25, 3, v9
    v_add_u32 v13, 0x10000, v9
    v_xor_b32 v25, 0, v23
    v_lshl_add_u32 v10, v25, 10, v24
    v_xor_b32 v25, 1, v22
    v_lshl_add_u32 v10, v25, 3, v10
    v_add_u32 v14, 0x10000, v10
    v_xor_b32 v25, 1, v23
    v_lshl_add_u32 v11, v25, 10, v24
    v_xor_b32 v25, 1, v22
    v_lshl_add_u32 v11, v25, 3, v11
    v_add_u32 v15, 0x10000, v11
    s_lshl_b32 s30, s3, 2
    s_add_u32 s30, s30, 131072
    v_mov_b32 v7, s30
    s_getpc_b64 s[24:25]
    s_add_u32 s24, s24, jobtab@rel32@lo+4
    s_addc_u32 s25, s25, jobtab@rel32@hi+12
    s_mul_i32 s30, s29, 640
    s_add_u32 s24, s24, s30
    s_addc_u32 s25, s25, 0
    s_load_dwordx16 s[32:47], s[24:25], 0
    s_add_u32 s24, s24, 64
    s_addc_u32 s25, s25, 0
    s_waitcnt lgkmcnt(0)
    s_cmp_lg_u32 s32, 4
    s_cbranch_scc1 w_nopre
    s_load_dwordx2 s[8:9], s[0:1], s33
    s_load_dwordx2 s[12:13], s[0:1], s34
    s_mov_b32 s10, s38
    s_mov_b32 s14, s38
    s_cmp_eq_u32 s32, 4
    s_cselect_b32 s31, 0, 1
    s_lshl_b32 s30, s3, s31
    s_mul_i32 s30, s30, s40
    s_add_u32 s16, s39, s30
    s_cmp_eq_u32 s32, 4
    s_cselect_b32 s30, 1024, s40
    s_cselect_b32 s31, 6, 5
    s_lshl_b32 s62, 32, s31
    s_add_u32 s17, s16, s30
    s_lshl_b32 s30, s3, 2
    s_mul_i32 s30, s30, s35
    s_add_u32 s18, s36, s30
    s_add_u32 s19, s37, s30
    s_lshl_b32 s20, s35, s31
    v_mul_u32_u24 v2, s35, v4
    v_add_u32 v2, v2, v3
    s_waitcnt lgkmcnt(0)
    s_add_u32 m0, s22, 0
    s_nop 0
    buffer_load_dwordx4 v2, s[8:11], s18 offen lds
    s_add_u32 s18, s18, s20
    s_add_u32 m0, s22, 8192
    s_nop 0
    buffer_load_dwordx4 v2, s[12:15], s19 offen lds
    s_add_u32 s19, s19, s20
    s_add_u32 m0, s22, 32768
    s_nop 0
    buffer_load_dwordx4 v2, s[8:11], s18 offen lds
    s_add_u32 s18, s18, s20
    s_add_u32 m0, s22, 40960
    s_nop 0
    buffer_load_dwordx4 v2, s[12:15], s19 offen lds
    s_add_u32 s19, s19, s20
    s_add_u32 m0, s22, 65536
    s_nop 0
    buffer_load_dwordx4 v2, s[8:11], s18 offen lds
    s_add_u32 s18, s18, s20
    s_add_u32 m0, s22, 73728
    s_nop 0
    buffer_load_dwordx4 v2, s[12:15], s19 offen lds
    s_add_u32 s19, s19, s20
    s_add_u32 m0, s22, 98304
    s_nop 0
    buffer_load_dwordx4 v2, s[8:11], s18 offen lds
    s_add_u32 s18, s18, s20
    s_add_u32 m0, s22, 106496
    s_nop 0
    buffer_load_dwordx4 v2, s[12:15], s19 offen lds
    s_add_u32 s19, s19, s20
    s_cmp_eq_u32 s32, 4
    s_cselect_b32 s70, 1, 0
    s_cmp_eq_u32 s39, 0
    s_cselect_b32 s70, s70, 0
    s_cmp_lg_u32 s3, 0
    s_cbranch_scc1 lnwp_ok
    s_cmp_eq_u32 s70, 0
    s_cbranch_scc1 lnwp_full
    s_mov_b32 s69, 65536
lnwap:
    buffer_load_dword v20, off, s[64:67], 0 offset:192 sc1
    s_waitcnt vmcnt(0)
    v_readfirstlane_b32 s68, v20
    s_cmp_ge_u32 s68, 8
    s_cbranch_scc1 lnwap_ok
    s_sleep 8
    s_sub_u32 s69, s69, 1
    s_cbranch_scc0 lnwap
lnwap_ok:
    s_branch lnwp_ok
lnwp_full:
    s_mov_b32 s69, 65536
lnwp:
    buffer_load_dword v20, off, s[64:67], 0 offset:0 sc1
    s_waitcnt vmcnt(0)
    v_readfirstlane_b32 s68, v20
    s_cmp_ge_u32 s68, 128
    s_cbranch_scc1 lnwp_ok
    s_sleep 8
    s_sub_u32 s69, s69, 1
    s_cbranch_scc0 lnwp
lnwp_ok:
    s_barrier
    s_add_u32 m0, s21, 0
    s_nop 0
    buffer_load_dwordx4 v1, s[4:7], s16 offen sc1 lds
    s_add_u32 s16, s16, s62
    s_add_u32 m0, s21, 1024
    s_nop 0
    buffer_load_dwordx4 v1, s[4:7], s17 offen sc1 lds
    s_add_u32 s17, s17, s62
    s_add_u32 m0, s21, 32768
    s_nop 0
    buffer_load_dwordx4 v1, s[4:7], s16 offen sc1 lds
    s_add_u32 s16, s16, s62
    s_add_u32 m0, s21, 33792
    s_nop 0
    buffer_load_dwordx4 v1, s[4:7], s17 offen sc1 lds
    s_add_u32 s17, s17, s62
    s_add_u32 m0, s21, 65536
    s_nop 0
    buffer_load_dwordx4 v1, s[4:7], s16 offen sc1 lds
    s_add_u32 s16, s16, s62
    s_add_u32 m0, s21, 66560
    s_nop 0
    buffer_load_dwordx4 v1, s[4:7], s17 offen sc1 lds
    s_add_u32 s17, s17, s62
    s_add_u32 m0, s21, 98304
    s_nop 0
    buffer_load_dwordx4 v1, s[4:7], s16 offen sc1 lds
    s_add_u32 s16, s16, s62
    s_add_u32 m0, s21, 99328
    s_nop 0
    buffer_load_dwordx4 v1, s[4:7], s17 offen sc1 lds
    s_add_u32 s17, s17, s62
    s_branch w_adopt
w_nopre:
    s_cmp_eq_u32 s32, 4
    s_cselect_b32 s70, 1, 0
    s_cmp_eq_u32 s39, 0
    s_cselect_b32 s70, s70, 0
    s_cmp_lg_u32 s3, 0
    s_cbranch_scc1 lnw_ok
    s_cmp_eq_u32 s70, 0
    s_cbranch_scc1 lnw_full
    s_mov_b32 s69, 65536
lnwa:
    buffer_load_dword v20, off, s[64:67], 0 offset:192 sc1
    s_waitcnt vmcnt(0)
    v_readfirstlane_b32 s68, v20
    s_cmp_ge_u32 s68, 8
    s_cbranch_scc1 lnwa_ok
    s_sleep 8
    s_sub_u32 s69, s69, 1
    s_cbranch_scc0 lnwa
lnwa_ok:
    s_branch lnw_ok
lnw_full:
    s_mov_b32 s69, 65536
lnw:
    buffer_load_dword v20, off, s[64:67], 0 offset:0 sc1
    s_waitcnt vmcnt(0)
    v_readfirstlane_b32 s68, v20
    s_cmp_ge_u32 s68, 128
    s_cbranch_scc1 lnw_ok
    s_sleep 8
    s_sub_u32 s69, s69, 1
    s_cbranch_scc0 lnw
lnw_ok:
    s_barrier
w_cold:
    s_cmp_eq_u32 s32, 0
    s_cbranch_scc1 fin_entry
    s_cmp_lg_u32 s3, 0
    s_cbranch_scc1 w_depok
    s_cmp_eq_u32 s45, 0
    s_cbranch_scc1 w_depok
    s_mov_b32 s31, 0x40000
w_waitdep:
    buffer_load_dword v16, v17, s[4:7], s44 offen sc1
    s_waitcnt vmcnt(0)
    v_readfirstlane_b32 s30, v16
    s_cmp_ge_u32 s30, s45
    s_cbranch_scc1 w_depok
    s_sleep 16
    s_sub_u32 s31, s31, 1
    s_cbranch_scc0 w_waitdep
w_depok:
    s_load_dwordx2 s[8:9], s[0:1], s33
    s_load_dwordx2 s[12:13], s[0:1], s34
    s_mov_b32 s10, s38
    s_mov_b32 s14, s38
    s_cmp_eq_u32 s32, 4
    s_cselect_b32 s31, 0, 1
    s_lshl_b32 s30, s3, s31
    s_mul_i32 s30, s30, s40
    s_add_u32 s16, s39, s30
    s_cmp_eq_u32 s32, 4
    s_cselect_b32 s30, 1024, s40
    s_cselect_b32 s31, 6, 5
    s_lshl_b32 s62, 32, s31
    s_add_u32 s17, s16, s30
    s_lshl_b32 s30, s3, 2
    s_mul_i32 s30, s30, s35
    s_add_u32 s18, s36, s30
    s_add_u32 s19, s37, s30
    s_lshl_b32 s20, s35, s31
    v_mul_u32_u24 v2, s35, v4
    v_add_u32 v2, v2, v3
    s_waitcnt lgkmcnt(0)
    s_barrier
    s_add_u32 m0, s21, 0
    s_nop 0
    buffer_load_dwordx4 v1, s[4:7], s16 offen sc1 lds
    s_add_u32 s16, s16, s62
    s_add_u32 m0, s21, 1024
    s_nop 0
    buffer_load_dwordx4 v1, s[4:7], s17 offen sc1 lds
    s_add_u32 s17, s17, s62
    s_add_u32 m0, s22, 0
    s_nop 0
    buffer_load_dwordx4 v2, s[8:11], s18 offen lds
    s_add_u32 s18, s18, s20
    s_add_u32 m0, s22, 8192
    s_nop 0
    buffer_load_dwordx4 v2, s[12:15], s19 offen lds
    s_add_u32 s19, s19, s20
    s_add_u32 m0, s21, 32768
    s_nop 0
    buffer_load_dwordx4 v1, s[4:7], s16 offen sc1 lds
    s_add_u32 s16, s16, s62
    s_add_u32 m0, s21, 33792
    s_nop 0
    buffer_load_dwordx4 v1, s[4:7], s17 offen sc1 lds
    s_add_u32 s17, s17, s62
    s_add_u32 m0, s22, 32768
    s_nop 0
    buffer_load_dwordx4 v2, s[8:11], s18 offen lds
    s_add_u32 s18, s18, s20
    s_add_u32 m0, s22, 40960
    s_nop 0
    buffer_load_dwordx4 v2, s[12:15], s19 offen lds
    s_add_u32 s19, s19, s20
    s_add_u32 m0, s21, 65536
    s_nop 0
    buffer_load_dwordx4 v1, s[4:7], s16 offen sc1 lds
    s_add_u32 s16, s16, s62
    s_add_u32 m0, s21, 66560
    s_nop 0
    buffer_load_dwordx4 v1, s[4:7], s17 offen sc1 lds
    s_add_u32 s17, s17, s62
    s_add_u32 m0, s22, 65536
    s_nop 0
    buffer_load_dwordx4 v2, s[8:11], s18 offen lds
    s_add_u32 s18, s18, s20
    s_add_u32 m0, s22, 73728
    s_nop 0
    buffer_load_dwordx4 v2, s[12:15], s19 offen lds
    s_add_u32 s19, s19, s20
    s_add_u32 m0, s21, 98304
    s_nop 0
    buffer_load_dwordx4 v1, s[4:7], s16 offen sc1 lds
    s_add_u32 s16, s16, s62
    s_add_u32 m0, s21, 99328
    s_nop 0
    buffer_load_dwordx4 v1, s[4:7], s17 offen sc1 lds
    s_add_u32 s17, s17, s62
    s_add_u32 m0, s22, 98304
    s_nop 0
    buffer_load_dwordx4 v2, s[8:11], s18 offen lds
    s_add_u32 s18, s18, s20
    s_add_u32 m0, s22, 106496
    s_nop 0
    buffer_load_dwordx4 v2, s[12:15], s19 offen lds
    s_add_u32 s19, s19, s20
w_adopt:
    s_mov_b32 s48, s32
    s_cmp_eq_u32 s32, 4
    s_cselect_b32 s30, 2, 3
    s_lshl_b32 s30, s26, s30
    s_mul_i32 s30, s30, s43
    s_add_u32 s49, s42, s30
    s_mov_b32 s50, s43
    s_mov_b32 s51, s46
    s_mov_b32 s23, s41
    s_mov_b32 s53, s47
    s_nop 0
    s_load_dwordx16 s[32:47], s[24:25], 0
    s_add_u32 s24, s24, 64
    s_addc_u32 s25, s25, 0
    s_waitcnt vmcnt(0)
    s_barrier
    ds_read_b64_tr_b16 v[64:65], v8 offset:16384
    ds_read_b64_tr_b16 v[66:67], v9 offset:16384
    ds_read_b64_tr_b16 v[68:69], v10 offset:16384
    ds_read_b64_tr_b16 v[70:71], v11 offset:16384
    ds_read_b64_tr_b16 v[72:73], v8 offset:24576
    ds_read_b64_tr_b16 v[74:75], v9 offset:24576
    ds_read_b64_tr_b16 v[76:77], v10 offset:24576
    ds_read_b64_tr_b16 v[78:79], v11 offset:24576
    ds_read_b128 v[32:35], v5 offset:0
    ds_read_b128 v[36:39], v5 offset:1024
    ds_read_b128 v[40:43], v5 offset:2048
    ds_read_b128 v[44:47], v5 offset:3072
    ds_read_b128 v[48:51], v5 offset:4096
    ds_read_b128 v[52:55], v5 offset:5120
    ds_read_b128 v[56:59], v5 offset:6144
    ds_read_b128 v[60:63], v5 offset:7168
    s_waitcnt lgkmcnt(0)
    s_cmp_eq_u32 s48, 4
    s_cbranch_scc1 w_firstH
    s_branch w_first16
w_first4:
    s_waitcnt vmcnt(12)
    s_barrier
    v_mfma_f32_16x16x32_bf16 v[128:131], v[64:67], v[32:35], 0
    ds_read_b64_tr_b16 v[112:113], v8 offset:49152
    v_mfma_f32_16x16x32_bf16 v[132:135], v[68:71], v[32:35], 0
    ds_read_b64_tr_b16 v[114:115], v9 offset:49152
    v_mfma_f32_16x16x32_bf16 v[136:139], v[72:75], v[32:35], 0
    ds_read_b64_tr_b16 v[116:117], v10 offset:49152
    v_mfma_f32_16x16x32_bf16 v[140:143], v[76:79], v[32:35], 0
    ds_read_b64_tr_b16 v[118:119], v11 offset:49152
    v_mfma_f32_16x16x32_bf16 v[144:147], v[64:67], v[36:39], 0
    ds_read_b64_tr_b16 v[120:121], v8 offset:57344
    v_mfma_f32_16x16x32_bf16 v[148:151], v[68:71], v[36:39], 0
    ds_read_b64_tr_b16 v[122:123], v9 offset:57344
    v_mfma_f32_16x16x32_bf16 v[152:155], v[72:75], v[36:39], 0
    ds_read_b64_tr_b16 v[124:125], v10 offset:57344
    v_mfma_f32_16x16x32_bf16 v[156:159], v[76:79], v[36:39], 0
    ds_read_b64_tr_b16 v[126:127], v11 offset:57344
    v_mfma_f32_16x16x32_bf16 v[160:163], v[64:67], v[40:43], 0
    ds_read_b128 v[80:83], v5 offset:32768
    v_mfma_f32_16x16x32_bf16 v[164:167], v[68:71], v[40:43], 0
    ds_read_b128 v[84:87], v5 offset:33792
    v_mfma_f32_16x16x32_bf16 v[168:171], v[72:75], v[40:43], 0
    ds_read_b128 v[88:91], v5 offset:34816
    v_mfma_f32_16x16x32_bf16 v[172:175], v[76:79], v[40:43], 0
    ds_read_b128 v[92:95], v5 offset:35840
    v_mfma_f32_16x16x32_bf16 v[176:179], v[64:67], v[44:47], 0
    ds_read_b128 v[96:99], v5 offset:36864
    v_mfma_f32_16x16x32_bf16 v[180:183], v[68:71], v[44:47], 0
    ds_read_b128 v[100:103], v5 offset:37888
    v_mfma_f32_16x16x32_bf16 v[184:187], v[72:75], v[44:47], 0
    ds_read_b128 v[104:107], v5 offset:38912
    v_mfma_f32_16x16x32_bf16 v[188:191], v[76:79], v[44:47], 0
    ds_read_b128 v[108:111], v5 offset:39936
    v_mfma_f32_16x16x32_bf16 v[192:195], v[64:67], v[48:51], 0
    v_mfma_f32_16x16x32_bf16 v[196:199], v[68:71], v[48:51], 0
    s_add_u32 m0, s21, 0
    s_nop 0
    buffer_load_dwordx4 v1, s[4:7], s16 offen sc1 lds
    s_add_u32 s16, s16, s62
    v_mfma_f32_16x16x32_bf16 v[200:203], v[72:75], v[48:51], 0
    v_mfma_f32_16x16x32_bf16 v[204:207], v[76:79], v[48:51], 0
    v_mfma_f32_16x16x32_bf16 v[208:211], v[64:67], v[52:55], 0
    s_add_u32 m0, s21, 1024
    s_nop 0
    buffer_load_dwordx4 v1, s[4:7], s17 offen sc1 lds
    s_add_u32 s17, s17, s62
    v_mfma_f32_16x16x32_bf16 v[212:215], v[68:71], v[52:55], 0
    v_mfma_f32_16x16x32_bf16 v[216:219], v[72:75], v[52:55], 0
    v_mfma_f32_16x16x32_bf16 v[220:223], v[76:79], v[52:55], 0
    s_add_u32 m0, s22, 0
    s_nop 0
    buffer_load_dwordx4 v2, s[8:11], s18 offen lds
    s_add_u32 s18, s18, s20
    v_mfma_f32_16x16x32_bf16 v[224:227], v[64:67], v[56:59], 0
    v_mfma_f32_16x16x32_bf16 v[228:231], v[68:71], v[56:59], 0
    v_mfma_f32_16x16x32_bf16 v[232:235], v[72:75], v[56:59], 0
    s_add_u32 m0, s22, 8192
    s_nop 0
    buffer_load_dwordx4 v2, s[12:15], s19 offen lds
    s_add_u32 s19, s19, s20
    v_mfma_f32_16x16x32_bf16 v[236:239], v[76:79], v[56:59], 0
    v_mfma_f32_16x16x32_bf16 v[240:243], v[64:67], v[60:63], 0
    v_mfma_f32_16x16x32_bf16 v[244:247], v[68:71], v[60:63], 0
    v_mfma_f32_16x16x32_bf16 v[248:251], v[72:75], v[60:63], 0
    v_mfma_f32_16x16x32_bf16 v[252:255], v[76:79], v[60:63], 0
    s_waitcnt lgkmcnt(0)
    s_waitcnt vmcnt(12)
    s_barrier
    v_mfma_f32_16x16x32_bf16 v[128:131], v[112:115], v[80:83], v[128:131]
    ds_read_b64_tr_b16 v[64:65], v12 offset:16384
    v_mfma_f32_16x16x32_bf16 v[132:135], v[116:119], v[80:83], v[132:135]
    ds_read_b64_tr_b16 v[66:67], v13 offset:16384
    v_mfma_f32_16x16x32_bf16 v[136:139], v[120:123], v[80:83], v[136:139]
    ds_read_b64_tr_b16 v[68:69], v14 offset:16384
    v_mfma_f32_16x16x32_bf16 v[140:143], v[124:127], v[80:83], v[140:143]
    ds_read_b64_tr_b16 v[70:71], v15 offset:16384
    v_mfma_f32_16x16x32_bf16 v[144:147], v[112:115], v[84:87], v[144:147]
    ds_read_b64_tr_b16 v[72:73], v12 offset:24576
    v_mfma_f32_16x16x32_bf16 v[148:151], v[116:119], v[84:87], v[148:151]
    ds_read_b64_tr_b16 v[74:75], v13 offset:24576
    v_mfma_f32_16x16x32_bf16 v[152:155], v[120:123], v[84:87], v[152:155]
    ds_read_b64_tr_b16 v[76:77], v14 offset:24576
    v_mfma_f32_16x16x32_bf16 v[156:159], v[124:127], v[84:87], v[156:159]
    ds_read_b64_tr_b16 v[78:79], v15 offset:24576
    v_mfma_f32_16x16x32_bf16 v[160:163], v[112:115], v[88:91], v[160:163]
    ds_read_b128 v[32:35], v6 offset:0
    v_mfma_f32_16x16x32_bf16 v[164:167], v[116:119], v[88:91], v[164:167]
    ds_read_b128 v[36:39], v6 offset:1024
    v_mfma_f32_16x16x32_bf16 v[168:171], v[120:123], v[88:91], v[168:171]
    ds_read_b128 v[40:43], v6 offset:2048
    v_mfma_f32_16x16x32_bf16 v[172:175], v[124:127], v[88:91], v[172:175]
    ds_read_b128 v[44:47], v6 offset:3072
    v_mfma_f32_16x16x32_bf16 v[176:179], v[112:115], v[92:95], v[176:179]
    ds_read_b128 v[48:51], v6 offset:4096
    v_mfma_f32_16x16x32_bf16 v[180:183], v[116:119], v[92:95], v[180:183]
    ds_read_b128 v[52:55], v6 offset:5120
    v_mfma_f32_16x16x32_bf16 v[184:187], v[120:123], v[92:95], v[184:187]
    ds_read_b128 v[56:59], v6 offset:6144
    v_mfma_f32_16x16x32_bf16 v[188:191], v[124:127], v[92:95], v[188:191]
    ds_read_b128 v[60:63], v6 offset:7168
    v_mfma_f32_16x16x32_bf16 v[192:195], v[112:115], v[96:99], v[192:195]
    v_mfma_f32_16x16x32_bf16 v[196:199], v[116:119], v[96:99], v[196:199]
    s_add_u32 m0, s21, 32768
    s_nop 0
    buffer_load_dwordx4 v1, s[4:7], s16 offen sc1 lds
    s_add_u32 s16, s16, s62
    v_mfma_f32_16x16x32_bf16 v[200:203], v[120:123], v[96:99], v[200:203]
    v_mfma_f32_16x16x32_bf16 v[204:207], v[124:127], v[96:99], v[204:207]
    v_mfma_f32_16x16x32_bf16 v[208:211], v[112:115], v[100:103], v[208:211]
    s_add_u32 m0, s21, 33792
    s_nop 0
    buffer_load_dwordx4 v1, s[4:7], s17 offen sc1 lds
    s_add_u32 s17, s17, s62
    v_mfma_f32_16x16x32_bf16 v[212:215], v[116:119], v[100:103], v[212:215]
    v_mfma_f32_16x16x32_bf16 v[216:219], v[120:123], v[100:103], v[216:219]
    v_mfma_f32_16x16x32_bf16 v[220:223], v[124:127], v[100:103], v[220:223]
    s_add_u32 m0, s22, 32768
    s_nop 0
    buffer_load_dwordx4 v2, s[8:11], s18 offen lds
    s_add_u32 s18, s18, s20
    v_mfma_f32_16x16x32_bf16 v[224:227], v[112:115], v[104:107], v[224:227]
    v_mfma_f32_16x16x32_bf16 v[228:231], v[116:119], v[104:107], v[228:231]
    v_mfma_f32_16x16x32_bf16 v[232:235], v[120:123], v[104:107], v[232:235]
    s_add_u32 m0, s22, 40960
    s_nop 0
    buffer_load_dwordx4 v2, s[12:15], s19 offen lds
    s_add_u32 s19, s19, s20
    v_mfma_f32_16x16x32_bf16 v[236:239], v[124:127], v[104:107], v[236:239]
    v_mfma_f32_16x16x32_bf16 v[240:243], v[112:115], v[108:111], v[240:243]
    v_mfma_f32_16x16x32_bf16 v[244:247], v[116:119], v[108:111], v[244:247]
    v_mfma_f32_16x16x32_bf16 v[248:251], v[120:123], v[108:111], v[248:251]
    v_mfma_f32_16x16x32_bf16 v[252:255], v[124:127], v[108:111], v[252:255]
    s_waitcnt lgkmcnt(0)
    s_waitcnt vmcnt(12)
    s_barrier
    v_mfma_f32_16x16x32_bf16 v[128:131], v[64:67], v[32:35], v[128:131]
    ds_read_b64_tr_b16 v[112:113], v12 offset:49152
    v_mfma_f32_16x16x32_bf16 v[132:135], v[68:71], v[32:35], v[132:135]
    ds_read_b64_tr_b16 v[114:115], v13 offset:49152
    v_mfma_f32_16x16x32_bf16 v[136:139], v[72:75], v[32:35], v[136:139]
    ds_read_b64_tr_b16 v[116:117], v14 offset:49152
    v_mfma_f32_16x16x32_bf16 v[140:143], v[76:79], v[32:35], v[140:143]
    ds_read_b64_tr_b16 v[118:119], v15 offset:49152
    v_mfma_f32_16x16x32_bf16 v[144:147], v[64:67], v[36:39], v[144:147]
    ds_read_b64_tr_b16 v[120:121], v12 offset:57344
    v_mfma_f32_16x16x32_bf16 v[148:151], v[68:71], v[36:39], v[148:151]
    ds_read_b64_tr_b16 v[122:123], v13 offset:57344
    v_mfma_f32_16x16x32_bf16 v[152:155], v[72:75], v[36:39], v[152:155]
    ds_read_b64_tr_b16 v[124:125], v14 offset:57344
    v_mfma_f32_16x16x32_bf16 v[156:159], v[76:79], v[36:39], v[156:159]
    ds_read_b64_tr_b16 v[126:127], v15 offset:57344
    v_mfma_f32_16x16x32_bf16 v[160:163], v[64:67], v[40:43], v[160:163]
    ds_read_b128 v[80:83], v6 offset:32768
    v_mfma_f32_16x16x32_bf16 v[164:167], v[68:71], v[40:43], v[164:167]
    ds_read_b128 v[84:87], v6 offset:33792
    v_mfma_f32_16x16x32_bf16 v[168:171], v[72:75], v[40:43], v[168:171]
    ds_read_b128 v[88:91], v6 offset:34816
    v_mfma_f32_16x16x32_bf16 v[172:175], v[76:79], v[40:43], v[172:175]
    ds_read_b128 v[92:95], v6 offset:35840
    v_mfma_f32_16x16x32_bf16 v[176:179], v[64:67], v[44:47], v[176:179]
    ds_read_b128 v[96:99], v6 offset:36864
    v_mfma_f32_16x16x32_bf16 v[180:183], v[68:71], v[44:47], v[180:183]
    ds_read_b128 v[100:103], v6 offset:37888
    v_mfma_f32_16x16x32_bf16 v[184:187], v[72:75], v[44:47], v[184:187]
    ds_read_b128 v[104:107], v6 offset:38912
    v_mfma_f32_16x16x32_bf16 v[188:191], v[76:79], v[44:47], v[188:191]
    ds_read_b128 v[108:111], v6 offset:39936
    v_mfma_f32_16x16x32_bf16 v[192:195], v[64:67], v[48:51], v[192:195]
    v_mfma_f32_16x16x32_bf16 v[196:199], v[68:71], v[48:51], v[196:199]
    s_add_u32 m0, s21, 65536
    s_nop 0
    buffer_load_dwordx4 v1, s[4:7], s16 offen sc1 lds
    s_add_u32 s16, s16, s62
    v_mfma_f32_16x16x32_bf16 v[200:203], v[72:75], v[48:51], v[200:203]
    v_mfma_f32_16x16x32_bf16 v[204:207], v[76:79], v[48:51], v[204:207]
    v_mfma_f32_16x16x32_bf16 v[208:211], v[64:67], v[52:55], v[208:211]
    s_add_u32 m0, s21, 66560
    s_nop 0
    buffer_load_dwordx4 v1, s[4:7], s17 offen sc1 lds
    s_add_u32 s17, s17, s62
    v_mfma_f32_16x16x32_bf16 v[212:215], v[68:71], v[52:55], v[212:215]
    v_mfma_f32_16x16x32_bf16 v[216:219], v[72:75], v[52:55], v[216:219]
    v_mfma_f32_16x16x32_bf16 v[220:223], v[76:79], v[52:55], v[220:223]
    s_add_u32 m0, s22, 65536
    s_nop 0
    buffer_load_dwordx4 v2, s[8:11], s18 offen lds
    s_add_u32 s18, s18, s20
    v_mfma_f32_16x16x32_bf16 v[224:227], v[64:67], v[56:59], v[224:227]
    v_mfma_f32_16x16x32_bf16 v[228:231], v[68:71], v[56:59], v[228:231]
    v_mfma_f32_16x16x32_bf16 v[232:235], v[72:75], v[56:59], v[232:235]
    s_add_u32 m0, s22, 73728
    s_nop 0
    buffer_load_dwordx4 v2, s[12:15], s19 offen lds
    s_add_u32 s19, s19, s20
    v_mfma_f32_16x16x32_bf16 v[236:239], v[76:79], v[56:59], v[236:239]
    v_mfma_f32_16x16x32_bf16 v[240:243], v[64:67], v[60:63], v[240:243]
    v_mfma_f32_16x16x32_bf16 v[244:247], v[68:71], v[60:63], v[244:247]
    v_mfma_f32_16x16x32_bf16 v[248:251], v[72:75], v[60:63], v[248:251]
    v_mfma_f32_16x16x32_bf16 v[252:255], v[76:79], v[60:63], v[252:255]
    s_waitcnt lgkmcnt(0)
    s_waitcnt vmcnt(8)
    s_barrier
    s_cmp_eq_u32 s28, 0
    s_cbranch_scc1 sig_2
    s_cmp_lg_u32 s3, 0
    s_cbranch_scc1 sig_2
    s_mov_b64 exec, 1
    v_mov_b32 v18, s57
    buffer_atomic_add v18, v17, s[4:7], s28 offen sc1
    s_mov_b64 exec, -1
sig_2:
    s_mov_b32 s28, 0
    v_mfma_f32_16x16x32_bf16 v[128:131], v[112:115], v[80:83], v[128:131]
    ds_read_b64_tr_b16 v[64:65], v8 offset:16384
    v_mfma_f32_16x16x32_bf16 v[132:135], v[116:119], v[80:83], v[132:135]
    ds_read_b64_tr_b16 v[66:67], v9 offset:16384
    v_mfma_f32_16x16x32_bf16 v[136:139], v[120:123], v[80:83], v[136:139]
    ds_read_b64_tr_b16 v[68:69], v10 offset:16384
    v_mfma_f32_16x16x32_bf16 v[140:143], v[124:127], v[80:83], v[140:143]
    ds_read_b64_tr_b16 v[70:71], v11 offset:16384
    v_mfma_f32_16x16x32_bf16 v[144:147], v[112:115], v[84:87], v[144:147]
    ds_read_b64_tr_b16 v[72:73], v8 offset:24576
    v_mfma_f32_16x16x32_bf16 v[148:151], v[116:119], v[84:87], v[148:151]
    ds_read_b64_tr_b16 v[74:75], v9 offset:24576
    v_mfma_f32_16x16x32_bf16 v[152:155], v[120:123], v[84:87], v[152:155]
    ds_read_b64_tr_b16 v[76:77], v10 offset:24576
    v_mfma_f32_16x16x32_bf16 v[156:159], v[124:127], v[84:87], v[156:159]
    ds_read_b64_tr_b16 v[78:79], v11 offset:24576
    v_mfma_f32_16x16x32_bf16 v[160:163], v[112:115], v[88:91], v[160:163]
    ds_read_b128 v[32:35], v5 offset:0
    v_mfma_f32_16x16x32_bf16 v[164:167], v[116:119], v[88:91], v[164:167]
    ds_read_b128 v[36:39], v5 offset:1024
    v_mfma_f32_16x16x32_bf16 v[168:171], v[120:123], v[88:91], v[168:171]
    ds_read_b128 v[40:43], v5 offset:2048
    v_mfma_f32_16x16x32_bf16 v[172:175], v[124:127], v[88:91], v[172:175]
    ds_read_b128 v[44:47], v5 offset:3072
    v_mfma_f32_16x16x32_bf16 v[176:179], v[112:115], v[92:95], v[176:179]
    ds_read_b128 v[48:51], v5 offset:4096
    v_mfma_f32_16x16x32_bf16 v[180:183], v[116:119], v[92:95], v[180:183]
    ds_read_b128 v[52:55], v5 offset:5120
    v_mfma_f32_16x16x32_bf16 v[184:187], v[120:123], v[92:95], v[184:187]
    ds_read_b128 v[56:59], v5 offset:6144
    v_mfma_f32_16x16x32_bf16 v[188:191], v[124:127], v[92:95], v[188:191]
    ds_read_b128 v[60:63], v5 offset:7168
    v_mfma_f32_16x16x32_bf16 v[192:195], v[112:115], v[96:99], v[192:195]
    v_mfma_f32_16x16x32_bf16 v[196:199], v[116:119], v[96:99], v[196:199]
    s_add_u32 m0, s21, 98304
    s_nop 0
    buffer_load_dwordx4 v1, s[4:7], s16 offen sc1 lds
    s_add_u32 s16, s16, s62
    v_mfma_f32_16x16x32_bf16 v[200:203], v[120:123], v[96:99], v[200:203]
    v_mfma_f32_16x16x32_bf16 v[204:207], v[124:127], v[96:99], v[204:207]
    v_mfma_f32_16x16x32_bf16 v[208:211], v[112:115], v[100:103], v[208:211]
    s_add_u32 m0, s21, 99328
    s_nop 0
    buffer_load_dwordx4 v1, s[4:7], s17 offen sc1 lds
    s_add_u32 s17, s17, s62
    v_mfma_f32_16x16x32_bf16 v[212:215], v[116:119], v[100:103], v[212:215]
    v_mfma_f32_16x16x32_bf16 v[216:219], v[120:123], v[100:103], v[216:219]
    v_mfma_f32_16x16x32_bf16 v[220:223], v[124:127], v[100:103], v[220:223]
    s_add_u32 m0, s22, 98304
    s_nop 0
    buffer_load_dwordx4 v2, s[8:11], s18 offen lds
    s_add_u32 s18, s18, s20
    v_mfma_f32_16x16x32_bf16 v[224:227], v[112:115], v[104:107], v[224:227]
    v_mfma_f32_16x16x32_bf16 v[228:231], v[116:119], v[104:107], v[228:231]
    v_mfma_f32_16x16x32_bf16 v[232:235], v[120:123], v[104:107], v[232:235]
    s_add_u32 m0, s22, 106496
    s_nop 0
    buffer_load_dwordx4 v2, s[12:15], s19 offen lds
    s_add_u32 s19, s19, s20
    v_mfma_f32_16x16x32_bf16 v[236:239], v[124:127], v[104:107], v[236:239]
    v_mfma_f32_16x16x32_bf16 v[240:243], v[112:115], v[108:111], v[240:243]
    v_mfma_f32_16x16x32_bf16 v[244:247], v[116:119], v[108:111], v[244:247]
    v_mfma_f32_16x16x32_bf16 v[248:251], v[120:123], v[108:111], v[248:251]
    v_mfma_f32_16x16x32_bf16 v[252:255], v[124:127], v[108:111], v[252:255]
    s_waitcnt lgkmcnt(0)
    s_branch w_loop_chk
w_first8:
    s_waitcnt vmcnt(16)
    s_barrier
    v_mfma_f32_16x16x32_bf16 v[128:131], v[64:67], v[32:35], 0
    ds_read_b64_tr_b16 v[112:113], v8 offset:49152
    v_mfma_f32_16x16x32_bf16 v[132:135], v[68:71], v[32:35], 0
    ds_read_b64_tr_b16 v[114:115], v9 offset:49152
    v_mfma_f32_16x16x32_bf16 v[136:139], v[72:75], v[32:35], 0
    ds_read_b64_tr_b16 v[116:117], v10 offset:49152
    v_mfma_f32_16x16x32_bf16 v[140:143], v[76:79], v[32:35], 0
    ds_read_b64_tr_b16 v[118:119], v11 offset:49152
    v_mfma_f32_16x16x32_bf16 v[144:147], v[64:67], v[36:39], 0
    ds_read_b64_tr_b16 v[120:121], v8 offset:57344
    v_mfma_f32_16x16x32_bf16 v[148:151], v[68:71], v[36:39], 0
    ds_read_b64_tr_b16 v[122:123], v9 offset:57344
    v_mfma_f32_16x16x32_bf16 v[152:155], v[72:75], v[36:39], 0
    ds_read_b64_tr_b16 v[124:125], v10 offset:57344
    v_mfma_f32_16x16x32_bf16 v[156:159], v[76:79], v[36:39], 0
    ds_read_b64_tr_b16 v[126:127], v11 offset:57344
    v_mfma_f32_16x16x32_bf16 v[160:163], v[64:67], v[40:43], 0
    ds_read_b128 v[80:83], v5 offset:32768
    v_mfma_f32_16x16x32_bf16 v[164:167], v[68:71], v[40:43], 0
    ds_read_b128 v[84:87], v5 offset:33792
    v_mfma_f32_16x16x32_bf16 v[168:171], v[72:75], v[40:43], 0
    ds_read_b128 v[88:91], v5 offset:34816
    v_mfma_f32_16x16x32_bf16 v[172:175], v[76:79], v[40:43], 0
    ds_read_b128 v[92:95], v5 offset:35840
    v_mfma_f32_16x16x32_bf16 v[176:179], v[64:67], v[44:47], 0
    ds_read_b128 v[96:99], v5 offset:36864
    v_mfma_f32_16x16x32_bf16 v[180:183], v[68:71], v[44:47], 0
    ds_read_b128 v[100:103], v5 offset:37888
    v_mfma_f32_16x16x32_bf16 v[184:187], v[72:75], v[44:47], 0
    ds_read_b128 v[104:107], v5 offset:38912
    v_mfma_f32_16x16x32_bf16 v[188:191], v[76:79], v[44:47], 0
    ds_read_b128 v[108:111], v5 offset:39936
    v_mfma_f32_16x16x32_bf16 v[192:195], v[64:67], v[48:51], 0
    v_mfma_f32_16x16x32_bf16 v[196:199], v[68:71], v[48:51], 0
    s_add_u32 m0, s21, 0
    s_nop 0
    buffer_load_dwordx4 v1, s[4:7], s16 offen sc1 lds
    s_add_u32 s16, s16, s62
    v_mfma_f32_16x16x32_bf16 v[200:203], v[72:75], v[48:51], 0
    v_mfma_f32_16x16x32_bf16 v[204:207], v[76:79], v[48:51], 0
    v_mfma_f32_16x16x32_bf16 v[208:211], v[64:67], v[52:55], 0
    s_add_u32 m0, s21, 1024
    s_nop 0
    buffer_load_dwordx4 v1, s[4:7], s17 offen sc1 lds
    s_add_u32 s17, s17, s62
    v_mfma_f32_16x16x32_bf16 v[212:215], v[68:71], v[52:55], 0
    v_mfma_f32_16x16x32_bf16 v[216:219], v[72:75], v[52:55], 0
    v_mfma_f32_16x16x32_bf16 v[220:223], v[76:79], v[52:55], 0
    s_add_u32 m0, s22, 0
    s_nop 0
    buffer_load_dwordx4 v2, s[8:11], s18 offen lds
    s_add_u32 s18, s18, s20
    v_mfma_f32_16x16x32_bf16 v[224:227], v[64:67], v[56:59], 0
    v_mfma_f32_16x16x32_bf16 v[228:231], v[68:71], v[56:59], 0
    v_mfma_f32_16x16x32_bf16 v[232:235], v[72:75], v[56:59], 0
    s_add_u32 m0, s22, 8192
    s_nop 0
    buffer_load_dwordx4 v2, s[12:15], s19 offen lds
    s_add_u32 s19, s19, s20
    v_mfma_f32_16x16x32_bf16 v[236:239], v[76:79], v[56:59], 0
    v_mfma_f32_16x16x32_bf16 v[240:243], v[64:67], v[60:63], 0
    v_mfma_f32_16x16x32_bf16 v[244:247], v[68:71], v[60:63], 0
    v_mfma_f32_16x16x32_bf16 v[248:251], v[72:75], v[60:63], 0
    v_mfma_f32_16x16x32_bf16 v[252:255], v[76:79], v[60:63], 0
    s_waitcnt lgkmcnt(0)
    s_waitcnt vmcnt(16)
    s_barrier
    v_mfma_f32_16x16x32_bf16 v[128:131], v[112:115], v[80:83], v[128:131]
    ds_read_b64_tr_b16 v[64:65], v12 offset:16384
    v_mfma_f32_16x16x32_bf16 v[132:135], v[116:119], v[80:83], v[132:135]
    ds_read_b64_tr_b16 v[66:67], v13 offset:16384
    v_mfma_f32_16x16x32_bf16 v[136:139], v[120:123], v[80:83], v[136:139]
    ds_read_b64_tr_b16 v[68:69], v14 offset:16384
    v_mfma_f32_16x16x32_bf16 v[140:143], v[124:127], v[80:83], v[140:143]
    ds_read_b64_tr_b16 v[70:71], v15 offset:16384
    v_mfma_f32_16x16x32_bf16 v[144:147], v[112:115], v[84:87], v[144:147]
    ds_read_b64_tr_b16 v[72:73], v12 offset:24576
    v_mfma_f32_16x16x32_bf16 v[148:151], v[116:119], v[84:87], v[148:151]
    ds_read_b64_tr_b16 v[74:75], v13 offset:24576
    v_mfma_f32_16x16x32_bf16 v[152:155], v[120:123], v[84:87], v[152:155]
    ds_read_b64_tr_b16 v[76:77], v14 offset:24576
    v_mfma_f32_16x16x32_bf16 v[156:159], v[124:127], v[84:87], v[156:159]
    ds_read_b64_tr_b16 v[78:79], v15 offset:24576
    v_mfma_f32_16x16x32_bf16 v[160:163], v[112:115], v[88:91], v[160:163]
    ds_read_b128 v[32:35], v6 offset:0
    v_mfma_f32_16x16x32_bf16 v[164:167], v[116:119], v[88:91], v[164:167]
    ds_read_b128 v[36:39], v6 offset:1024
    v_mfma_f32_16x16x32_bf16 v[168:171], v[120:123], v[88:91], v[168:171]
    ds_read_b128 v[40:43], v6 offset:2048
    v_mfma_f32_16x16x32_bf16 v[172:175], v[124:127], v[88:91], v[172:175]
    ds_read_b128 v[44:47], v6 offset:3072
    v_mfma_f32_16x16x32_bf16 v[176:179], v[112:115], v[92:95], v[176:179]
    ds_read_b128 v[48:51], v6 offset:4096
    v_mfma_f32_16x16x32_bf16 v[180:183], v[116:119], v[92:95], v[180:183]
    ds_read_b128 v[52:55], v6 offset:5120
    v_mfma_f32_16x16x32_bf16 v[184:187], v[120:123], v[92:95], v[184:187]
    ds_read_b128 v[56:59], v6 offset:6144
    v_mfma_f32_16x16x32_bf16 v[188:191], v[124:127], v[92:95], v[188:191]
    ds_read_b128 v[60:63], v6 offset:7168
    v_mfma_f32_16x16x32_bf16 v[192:195], v[112:115], v[96:99], v[192:195]
    v_mfma_f32_16x16x32_bf16 v[196:199], v[116:119], v[96:99], v[196:199]
    s_add_u32 m0, s21, 32768
    s_nop 0
    buffer_load_dwordx4 v1, s[4:7], s16 offen sc1 lds
    s_add_u32 s16, s16, s62
    v_mfma_f32_16x16x32_bf16 v[200:203], v[120:123], v[96:99], v[200:203]
    v_mfma_f32_16x16x32_bf16 v[204:207], v[124:127], v[96:99], v[204:207]
    v_mfma_f32_16x16x32_bf16 v[208:211], v[112:115], v[100:103], v[208:211]
    s_add_u32 m0, s21, 33792
    s_nop 0
    buffer_load_dwordx4 v1, s[4:7], s17 offen sc1 lds
    s_add_u32 s17, s17, s62
    v_mfma_f32_16x16x32_bf16 v[212:215], v[116:119], v[100:103], v[212:215]
    v_mfma_f32_16x16x32_bf16 v[216:219], v[120:123], v[100:103], v[216:219]
    v_mfma_f32_16x16x32_bf16 v[220:223], v[124:127], v[100:103], v[220:223]
    s_add_u32 m0, s22, 32768
    s_nop 0
    buffer_load_dwordx4 v2, s[8:11], s18 offen lds
    s_add_u32 s18, s18, s20
    v_mfma_f32_16x16x32_bf16 v[224:227], v[112:115], v[104:107], v[224:227]
    v_mfma_f32_16x16x32_bf16 v[228:231], v[116:119], v[104:107], v[228:231]
    v_mfma_f32_16x16x32_bf16 v[232:235], v[120:123], v[104:107], v[232:235]
    s_add_u32 m0, s22, 40960
    s_nop 0
    buffer_load_dwordx4 v2, s[12:15], s19 offen lds
    s_add_u32 s19, s19, s20
    v_mfma_f32_16x16x32_bf16 v[236:239], v[124:127], v[104:107], v[236:239]
    v_mfma_f32_16x16x32_bf16 v[240:243], v[112:115], v[108:111], v[240:243]
    v_mfma_f32_16x16x32_bf16 v[244:247], v[116:119], v[108:111], v[244:247]
    v_mfma_f32_16x16x32_bf16 v[248:251], v[120:123], v[108:111], v[248:251]
    v_mfma_f32_16x16x32_bf16 v[252:255], v[124:127], v[108:111], v[252:255]
    s_waitcnt lgkmcnt(0)
    s_waitcnt vmcnt(16)
    s_barrier
    v_mfma_f32_16x16x32_bf16 v[128:131], v[64:67], v[32:35], v[128:131]
    ds_read_b64_tr_b16 v[112:113], v12 offset:49152
    v_mfma_f32_16x16x32_bf16 v[132:135], v[68:71], v[32:35], v[132:135]
    ds_read_b64_tr_b16 v[114:115], v13 offset:49152
    v_mfma_f32_16x16x32_bf16 v[136:139], v[72:75], v[32:35], v[136:139]
    ds_read_b64_tr_b16 v[116:117], v14 offset:49152
    v_mfma_f32_16x16x32_bf16 v[140:143], v[76:79], v[32:35], v[140:143]
    ds_read_b64_tr_b16 v[118:119], v15 offset:49152
    v_mfma_f32_16x16x32_bf16 v[144:147], v[64:67], v[36:39], v[144:147]
    ds_read_b64_tr_b16 v[120:121], v12 offset:57344
    v_mfma_f32_16x16x32_bf16 v[148:151], v[68:71], v[36:39], v[148:151]
    ds_read_b64_tr_b16 v[122:123], v13 offset:57344
    v_mfma_f32_16x16x32_bf16 v[152:155], v[72:75], v[36:39], v[152:155]
    ds_read_b64_tr_b16 v[124:125], v14 offset:57344
    v_mfma_f32_16x16x32_bf16 v[156:159], v[76:79], v[36:39], v[156:159]
    ds_read_b64_tr_b16 v[126:127], v15 offset:57344
    v_mfma_f32_16x16x32_bf16 v[160:163], v[64:67], v[40:43], v[160:163]
    ds_read_b128 v[80:83], v6 offset:32768
    v_mfma_f32_16x16x32_bf16 v[164:167], v[68:71], v[40:43], v[164:167]
    ds_read_b128 v[84:87], v6 offset:33792
    v_mfma_f32_16x16x32_bf16 v[168:171], v[72:75], v[40:43], v[168:171]
    ds_read_b128 v[88:91], v6 offset:34816
    v_mfma_f32_16x16x32_bf16 v[172:175], v[76:79], v[40:43], v[172:175]
    ds_read_b128 v[92:95], v6 offset:35840
    v_mfma_f32_16x16x32_bf16 v[176:179], v[64:67], v[44:47], v[176:179]
    ds_read_b128 v[96:99], v6 offset:36864
    v_mfma_f32_16x16x32_bf16 v[180:183], v[68:71], v[44:47], v[180:183]
    ds_read_b128 v[100:103], v6 offset:37888
    v_mfma_f32_16x16x32_bf16 v[184:187], v[72:75], v[44:47], v[184:187]
    ds_read_b128 v[104:107], v6 offset:38912
    v_mfma_f32_16x16x32_bf16 v[188:191], v[76:79], v[44:47], v[188:191]
    ds_read_b128 v[108:111], v6 offset:39936
    v_mfma_f32_16x16x32_bf16 v[192:195], v[64:67], v[48:51], v[192:195]
    v_mfma_f32_16x16x32_bf16 v[196:199], v[68:71], v[48:51], v[196:199]
    s_add_u32 m0, s21, 65536
    s_nop 0
    buffer_load_dwordx4 v1, s[4:7], s16 offen sc1 lds
    s_add_u32 s16, s16, s62
    v_mfma_f32_16x16x32_bf16 v[200:203], v[72:75], v[48:51], v[200:203]
    v_mfma_f32_16x16x32_bf16 v[204:207], v[76:79], v[48:51], v[204:207]
    v_mfma_f32_16x16x32_bf16 v[208:211], v[64:67], v[52:55], v[208:211]
    s_add_u32 m0, s21, 66560
    s_nop 0
    buffer_load_dwordx4 v1, s[4:7], s17 offen sc1 lds
    s_add_u32 s17, s17, s62
    v_mfma_f32_16x16x32_bf16 v[212:215], v[68:71], v[52:55], v[212:215]
    v_mfma_f32_16x16x32_bf16 v[216:219], v[72:75], v[52:55], v[216:219]
    v_mfma_f32_16x16x32_bf16 v[220:223], v[76:79], v[52:55], v[220:223]
    s_add_u32 m0, s22, 65536
    s_nop 0
    buffer_load_dwordx4 v2, s[8:11], s18 offen lds
    s_add_u32 s18, s18, s20
    v_mfma_f32_16x16x32_bf16 v[224:227], v[64:67], v[56:59], v[224:227]
    v_mfma_f32_16x16x32_bf16 v[228:231], v[68:71], v[56:59], v[228:231]
    v_mfma_f32_16x16x32_bf16 v[232:235], v[72:75], v[56:59], v[232:235]
    s_add_u32 m0, s22, 73728
    s_nop 0
    buffer_load_dwordx4 v2, s[12:15], s19 offen lds
    s_add_u32 s19, s19, s20
    v_mfma_f32_16x16x32_bf16 v[236:239], v[76:79], v[56:59], v[236:239]
    v_mfma_f32_16x16x32_bf16 v[240:243], v[64:67], v[60:63], v[240:243]
    v_mfma_f32_16x16x32_bf16 v[244:247], v[68:71], v[60:63], v[244:247]
    v_mfma_f32_16x16x32_bf16 v[248:251], v[72:75], v[60:63], v[248:251]
    v_mfma_f32_16x16x32_bf16 v[252:255], v[76:79], v[60:63], v[252:255]
    s_waitcnt lgkmcnt(0)
    s_waitcnt vmcnt(8)
    s_barrier
    s_cmp_eq_u32 s28, 0
    s_cbranch_scc1 sig_3
    s_cmp_lg_u32 s3, 0
    s_cbranch_scc1 sig_3
    s_mov_b64 exec, 1
    v_mov_b32 v18, s57
    buffer_atomic_add v18, v17, s[4:7], s28 offen sc1
    s_mov_b64 exec, -1
sig_3:
    s_mov_b32 s28, 0
    v_mfma_f32_16x16x32_bf16 v[128:131], v[112:115], v[80:83], v[128:131]
    ds_read_b64_tr_b16 v[64:65], v8 offset:16384
    v_mfma_f32_16x16x32_bf16 v[132:135], v[116:119], v[80:83], v[132:135]
    ds_read_b64_tr_b16 v[66:67], v9 offset:16384
    v_mfma_f32_16x16x32_bf16 v[136:139], v[120:123], v[80:83], v[136:139]
    ds_read_b64_tr_b16 v[68:69], v10 offset:16384
    v_mfma_f32_16x16x32_bf16 v[140:143], v[124:127], v[80:83], v[140:143]
    ds_read_b64_tr_b16 v[70:71], v11 offset:16384
    v_mfma_f32_16x16x32_bf16 v[144:147], v[112:115], v[84:87], v[144:147]
    ds_read_b64_tr_b16 v[72:73], v8 offset:24576
    v_mfma_f32_16x16x32_bf16 v[148:151], v[116:119], v[84:87], v[148:151]
    ds_read_b64_tr_b16 v[74:75], v9 offset:24576
    v_mfma_f32_16x16x32_bf16 v[152:155], v[120:123], v[84:87], v[152:155]
    ds_read_b64_tr_b16 v[76:77], v10 offset:24576
    v_mfma_f32_16x16x32_bf16 v[156:159], v[124:127], v[84:87], v[156:159]
    ds_read_b64_tr_b16 v[78:79], v11 offset:24576
    v_mfma_f32_16x16x32_bf16 v[160:163], v[112:115], v[88:91], v[160:163]
    ds_read_b128 v[32:35], v5 offset:0
    v_mfma_f32_16x16x32_bf16 v[164:167], v[116:119], v[88:91], v[164:167]
    ds_read_b128 v[36:39], v5 offset:1024
    v_mfma_f32_16x16x32_bf16 v[168:171], v[120:123], v[88:91], v[168:171]
    ds_read_b128 v[40:43], v5 offset:2048
    v_mfma_f32_16x16x32_bf16 v[172:175], v[124:127], v[88:91], v[172:175]
    ds_read_b128 v[44:47], v5 offset:3072
    v_mfma_f32_16x16x32_bf16 v[176:179], v[112:115], v[92:95], v[176:179]
    ds_read_b128 v[48:51], v5 offset:4096
    v_mfma_f32_16x16x32_bf16 v[180:183], v[116:119], v[92:95], v[180:183]
    ds_read_b128 v[52:55], v5 offset:5120
    v_mfma_f32_16x16x32_bf16 v[184:187], v[120:123], v[92:95], v[184:187]
    ds_read_b128 v[56:59], v5 offset:6144
    v_mfma_f32_16x16x32_bf16 v[188:191], v[124:127], v[92:95], v[188:191]
    ds_read_b128 v[60:63], v5 offset:7168
    v_mfma_f32_16x16x32_bf16 v[192:195], v[112:115], v[96:99], v[192:195]
    v_mfma_f32_16x16x32_bf16 v[196:199], v[116:119], v[96:99], v[196:199]
    s_add_u32 m0, s21, 98304
    s_nop 0
    buffer_load_dwordx4 v1, s[4:7], s16 offen sc1 lds
    s_add_u32 s16, s16, s62
    v_mfma_f32_16x16x32_bf16 v[200:203], v[120:123], v[96:99], v[200:203]
    v_mfma_f32_16x16x32_bf16 v[204:207], v[124:127], v[96:99], v[204:207]
    v_mfma_f32_16x16x32_bf16 v[208:211], v[112:115], v[100:103], v[208:211]
    s_add_u32 m0, s21, 99328
    s_nop 0
    buffer_load_dwordx4 v1, s[4:7], s17 offen sc1 lds
    s_add_u32 s17, s17, s62
    v_mfma_f32_16x16x32_bf16 v[212:215], v[116:119], v[100:103], v[212:215]
    v_mfma_f32_16x16x32_bf16 v[216:219], v[120:123], v[100:103], v[216:219]
    v_mfma_f32_16x16x32_bf16 v[220:223], v[124:127], v[100:103], v[220:223]
    s_add_u32 m0, s22, 98304
    s_nop 0
    buffer_load_dwordx4 v2, s[8:11], s18 offen lds
    s_add_u32 s18, s18, s20
    v_mfma_f32_16x16x32_bf16 v[224:227], v[112:115], v[104:107], v[224:227]
    v_mfma_f32_16x16x32_bf16 v[228:231], v[116:119], v[104:107], v[228:231]
    v_mfma_f32_16x16x32_bf16 v[232:235], v[120:123], v[104:107], v[232:235]
    s_add_u32 m0, s22, 106496
    s_nop 0
    buffer_load_dwordx4 v2, s[12:15], s19 offen lds
    s_add_u32 s19, s19, s20
    v_mfma_f32_16x16x32_bf16 v[236:239], v[124:127], v[104:107], v[236:239]
    v_mfma_f32_16x16x32_bf16 v[240:243], v[112:115], v[108:111], v[240:243]
    v_mfma_f32_16x16x32_bf16 v[244:247], v[116:119], v[108:111], v[244:247]
    v_mfma_f32_16x16x32_bf16 v[248:251], v[120:123], v[108:111], v[248:251]
    v_mfma_f32_16x16x32_bf16 v[252:255], v[124:127], v[108:111], v[252:255]
    s_waitcnt lgkmcnt(0)
    s_branch w_loop_chk
w_first16:
    s_waitcnt vmcnt(24)
    s_barrier
    v_mfma_f32_16x16x32_bf16 v[128:131], v[64:67], v[32:35], 0
    ds_read_b64_tr_b16 v[112:113], v8 offset:49152
    v_mfma_f32_16x16x32_bf16 v[132:135], v[68:71], v[32:35], 0
    ds_read_b64_tr_b16 v[114:115], v9 offset:49152
    v_mfma_f32_16x16x32_bf16 v[136:139], v[72:75], v[32:35], 0
    ds_read_b64_tr_b16 v[116:117], v10 offset:49152
    v_mfma_f32_16x16x32_bf16 v[140:143], v[76:79], v[32:35], 0
    ds_read_b64_tr_b16 v[118:119], v11 offset:49152
    v_mfma_f32_16x16x32_bf16 v[144:147], v[64:67], v[36:39], 0
    ds_read_b64_tr_b16 v[120:121], v8 offset:57344
    v_mfma_f32_16x16x32_bf16 v[148:151], v[68:71], v[36:39], 0
    ds_read_b64_tr_b16 v[122:123], v9 offset:57344
    v_mfma_f32_16x16x32_bf16 v[152:155], v[72:75], v[36:39], 0
    ds_read_b64_tr_b16 v[124:125], v10 offset:57344
    v_mfma_f32_16x16x32_bf16 v[156:159], v[76:79], v[36:39], 0
    ds_read_b64_tr_b16 v[126:127], v11 offset:57344
    v_mfma_f32_16x16x32_bf16 v[160:163], v[64:67], v[40:43], 0
    ds_read_b128 v[80:83], v5 offset:32768
    v_mfma_f32_16x16x32_bf16 v[164:167], v[68:71], v[40:43], 0
    ds_read_b128 v[84:87], v5 offset:33792
    v_mfma_f32_16x16x32_bf16 v[168:171], v[72:75], v[40:43], 0
    ds_read_b128 v[88:91], v5 offset:34816
    v_mfma_f32_16x16x32_bf16 v[172:175], v[76:79], v[40:43], 0
    ds_read_b128 v[92:95], v5 offset:35840
    v_mfma_f32_16x16x32_bf16 v[176:179], v[64:67], v[44:47], 0
    ds_read_b128 v[96:99], v5 offset:36864
    v_mfma_f32_16x16x32_bf16 v[180:183], v[68:71], v[44:47], 0
    ds_read_b128 v[100:103], v5 offset:37888
    v_mfma_f32_16x16x32_bf16 v[184:187], v[72:75], v[44:47], 0
    ds_read_b128 v[104:107], v5 offset:38912
    v_mfma_f32_16x16x32_bf16 v[188:191], v[76:79], v[44:47], 0
    ds_read_b128 v[108:111], v5 offset:39936
    v_mfma_f32_16x16x32_bf16 v[192:195], v[64:67], v[48:51], 0
    v_mfma_f32_16x16x32_bf16 v[196:199], v[68:71], v[48:51], 0
    s_add_u32 m0, s21, 0
    s_nop 0
    buffer_load_dwordx4 v1, s[4:7], s16 offen sc1 lds
    s_add_u32 s16, s16, s62
    v_mfma_f32_16x16x32_bf16 v[200:203], v[72:75], v[48:51], 0
    v_mfma_f32_16x16x32_bf16 v[204:207], v[76:79], v[48:51], 0
    v_mfma_f32_16x16x32_bf16 v[208:211], v[64:67], v[52:55], 0
    s_add_u32 m0, s21, 1024
    s_nop 0
    buffer_load_dwordx4 v1, s[4:7], s17 offen sc1 lds
    s_add_u32 s17, s17, s62
    v_mfma_f32_16x16x32_bf16 v[212:215], v[68:71], v[52:55], 0
    v_mfma_f32_16x16x32_bf16 v[216:219], v[72:75], v[52:55], 0
    v_mfma_f32_16x16x32_bf16 v[220:223], v[76:79], v[52:55], 0
    s_add_u32 m0, s22, 0
    s_nop 0
    buffer_load_dwordx4 v2, s[8:11], s18 offen lds
    s_add_u32 s18, s18, s20
    v_mfma_f32_16x16x32_bf16 v[224:227], v[64:67], v[56:59], 0
    v_mfma_f32_16x16x32_bf16 v[228:231], v[68:71], v[56:59], 0
    v_mfma_f32_16x16x32_bf16 v[232:235], v[72:75], v[56:59], 0
    s_add_u32 m0, s22, 8192
    s_nop 0
    buffer_load_dwordx4 v2, s[12:15], s19 offen lds
    s_add_u32 s19, s19, s20
    v_mfma_f32_16x16x32_bf16 v[236:239], v[76:79], v[56:59], 0
    v_mfma_f32_16x16x32_bf16 v[240:243], v[64:67], v[60:63], 0
    v_mfma_f32_16x16x32_bf16 v[244:247], v[68:71], v[60:63], 0
    v_mfma_f32_16x16x32_bf16 v[248:251], v[72:75], v[60:63], 0
    v_mfma_f32_16x16x32_bf16 v[252:255], v[76:79], v[60:63], 0
    s_waitcnt lgkmcnt(0)
    s_waitcnt vmcnt(24)
    s_barrier
    v_mfma_f32_16x16x32_bf16 v[128:131], v[112:115], v[80:83], v[128:131]
    ds_read_b64_tr_b16 v[64:65], v12 offset:16384
    v_mfma_f32_16x16x32_bf16 v[132:135], v[116:119], v[80:83], v[132:135]
    ds_read_b64_tr_b16 v[66:67], v13 offset:16384
    v_mfma_f32_16x16x32_bf16 v[136:139], v[120:123], v[80:83], v[136:139]
    ds_read_b64_tr_b16 v[68:69], v14 offset:16384
    v_mfma_f32_16x16x32_bf16 v[140:143], v[124:127], v[80:83], v[140:143]
    ds_read_b64_tr_b16 v[70:71], v15 offset:16384
    v_mfma_f32_16x16x32_bf16 v[144:147], v[112:115], v[84:87], v[144:147]
    ds_read_b64_tr_b16 v[72:73], v12 offset:24576
    v_mfma_f32_16x16x32_bf16 v[148:151], v[116:119], v[84:87], v[148:151]
    ds_read_b64_tr_b16 v[74:75], v13 offset:24576
    v_mfma_f32_16x16x32_bf16 v[152:155], v[120:123], v[84:87], v[152:155]
    ds_read_b64_tr_b16 v[76:77], v14 offset:24576
    v_mfma_f32_16x16x32_bf16 v[156:159], v[124:127], v[84:87], v[156:159]
    ds_read_b64_tr_b16 v[78:79], v15 offset:24576
    v_mfma_f32_16x16x32_bf16 v[160:163], v[112:115], v[88:91], v[160:163]
    ds_read_b128 v[32:35], v6 offset:0
    v_mfma_f32_16x16x32_bf16 v[164:167], v[116:119], v[88:91], v[164:167]
    ds_read_b128 v[36:39], v6 offset:1024
    v_mfma_f32_16x16x32_bf16 v[168:171], v[120:123], v[88:91], v[168:171]
    ds_read_b128 v[40:43], v6 offset:2048
    v_mfma_f32_16x16x32_bf16 v[172:175], v[124:127], v[88:91], v[172:175]
    ds_read_b128 v[44:47], v6 offset:3072
    v_mfma_f32_16x16x32_bf16 v[176:179], v[112:115], v[92:95], v[176:179]
    ds_read_b128 v[48:51], v6 offset:4096
    v_mfma_f32_16x16x32_bf16 v[180:183], v[116:119], v[92:95], v[180:183]
    ds_read_b128 v[52:55], v6 offset:5120
    v_mfma_f32_16x16x32_bf16 v[184:187], v[120:123], v[92:95], v[184:187]
    ds_read_b128 v[56:59], v6 offset:6144
    v_mfma_f32_16x16x32_bf16 v[188:191], v[124:127], v[92:95], v[188:191]
    ds_read_b128 v[60:63], v6 offset:7168
    v_mfma_f32_16x16x32_bf16 v[192:195], v[112:115], v[96:99], v[192:195]
    v_mfma_f32_16x16x32_bf16 v[196:199], v[116:119], v[96:99], v[196:199]
    s_add_u32 m0, s21, 32768
    s_nop 0
    buffer_load_dwordx4 v1, s[4:7], s16 offen sc1 lds
    s_add_u32 s16, s16, s62
    v_mfma_f32_16x16x32_bf16 v[200:203], v[120:123], v[96:99], v[200:203]
    v_mfma_f32_16x16x32_bf16 v[204:207], v[124:127], v[96:99], v[204:207]
    v_mfma_f32_16x16x32_bf16 v[208:211], v[112:115], v[100:103], v[208:211]
    s_add_u32 m0, s21, 33792
    s_nop 0
    buffer_load_dwordx4 v1, s[4:7], s17 offen sc1 lds
    s_add_u32 s17, s17, s62
    v_mfma_f32_16x16x32_bf16 v[212:215], v[116:119], v[100:103], v[212:215]
    v_mfma_f32_16x16x32_bf16 v[216:219], v[120:123], v[100:103], v[216:219]
    v_mfma_f32_16x16x32_bf16 v[220:223], v[124:127], v[100:103], v[220:223]
    s_add_u32 m0, s22, 32768
    s_nop 0
    buffer_load_dwordx4 v2, s[8:11], s18 offen lds
    s_add_u32 s18, s18, s20
    v_mfma_f32_16x16x32_bf16 v[224:227], v[112:115], v[104:107], v[224:227]
    v_mfma_f32_16x16x32_bf16 v[228:231], v[116:119], v[104:107], v[228:231]
    v_mfma_f32_16x16x32_bf16 v[232:235], v[120:123], v[104:107], v[232:235]
    s_add_u32 m0, s22, 40960
    s_nop 0
    buffer_load_dwordx4 v2, s[12:15], s19 offen lds
    s_add_u32 s19, s19, s20
    v_mfma_f32_16x16x32_bf16 v[236:239], v[124:127], v[104:107], v[236:239]
    v_mfma_f32_16x16x32_bf16 v[240:243], v[112:115], v[108:111], v[240:243]
    v_mfma_f32_16x16x32_bf16 v[244:247], v[116:119], v[108:111], v[244:247]
    v_mfma_f32_16x16x32_bf16 v[248:251], v[120:123], v[108:111], v[248:251]
    v_mfma_f32_16x16x32_bf16 v[252:255], v[124:127], v[108:111], v[252:255]
    s_waitcnt lgkmcnt(0)
    s_waitcnt vmcnt(24)
    s_barrier
    v_mfma_f32_16x16x32_bf16 v[128:131], v[64:67], v[32:35], v[128:131]
    ds_read_b64_tr_b16 v[112:113], v12 offset:49152
    v_mfma_f32_16x16x32_bf16 v[132:135], v[68:71], v[32:35], v[132:135]
    ds_read_b64_tr_b16 v[114:115], v13 offset:49152
    v_mfma_f32_16x16x32_bf16 v[136:139], v[72:75], v[32:35], v[136:139]
    ds_read_b64_tr_b16 v[116:117], v14 offset:49152
    v_mfma_f32_16x16x32_bf16 v[140:143], v[76:79], v[32:35], v[140:143]
    ds_read_b64_tr_b16 v[118:119], v15 offset:49152
    v_mfma_f32_16x16x32_bf16 v[144:147], v[64:67], v[36:39], v[144:147]
    ds_read_b64_tr_b16 v[120:121], v12 offset:57344
    v_mfma_f32_16x16x32_bf16 v[148:151], v[68:71], v[36:39], v[148:151]
    ds_read_b64_tr_b16 v[122:123], v13 offset:57344
    v_mfma_f32_16x16x32_bf16 v[152:155], v[72:75], v[36:39], v[152:155]
    ds_read_b64_tr_b16 v[124:125], v14 offset:57344
    v_mfma_f32_16x16x32_bf16 v[156:159], v[76:79], v[36:39], v[156:159]
    ds_read_b64_tr_b16 v[126:127], v15 offset:57344
    v_mfma_f32_16x16x32_bf16 v[160:163], v[64:67], v[40:43], v[160:163]
    ds_read_b128 v[80:83], v6 offset:32768
    v_mfma_f32_16x16x32_bf16 v[164:167], v[68:71], v[40:43], v[164:167]
    ds_read_b128 v[84:87], v6 offset:33792
    v_mfma_f32_16x16x32_bf16 v[168:171], v[72:75], v[40:43], v[168:171]
    ds_read_b128 v[88:91], v6 offset:34816
    v_mfma_f32_16x16x32_bf16 v[172:175], v[76:79], v[40:43], v[172:175]
    ds_read_b128 v[92:95], v6 offset:35840
    v_mfma_f32_16x16x32_bf16 v[176:179], v[64:67], v[44:47], v[176:179]
    ds_read_b128 v[96:99], v6 offset:36864
    v_mfma_f32_16x16x32_bf16 v[180:183], v[68:71], v[44:47], v[180:183]
    ds_read_b128 v[100:103], v6 offset:37888
    v_mfma_f32_16x16x32_bf16 v[184:187], v[72:75], v[44:47], v[184:187]
    ds_read_b128 v[104:107], v6 offset:38912
    v_mfma_f32_16x16x32_bf16 v[188:191], v[76:79], v[44:47], v[188:191]
    ds_read_b128 v[108:111], v6 offset:39936
    v_mfma_f32_16x16x32_bf16 v[192:195], v[64:67], v[48:51], v[192:195]
    v_mfma_f32_16x16x32_bf16 v[196:199], v[68:71], v[48:51], v[196:199]
    s_add_u32 m0, s21, 65536
    s_nop 0
    buffer_load_dwordx4 v1, s[4:7], s16 offen sc1 lds
    s_add_u32 s16, s16, s62
    v_mfma_f32_16x16x32_bf16 v[200:203], v[72:75], v[48:51], v[200:203]
    v_mfma_f32_16x16x32_bf16 v[204:207], v[76:79], v[48:51], v[204:207]
    v_mfma_f32_16x16x32_bf16 v[208:211], v[64:67], v[52:55], v[208:211]
    s_add_u32 m0, s21, 66560
    s_nop 0
    buffer_load_dwordx4 v1, s[4:7], s17 offen sc1 lds
    s_add_u32 s17, s17, s62
    v_mfma_f32_16x16x32_bf16 v[212:215], v[68:71], v[52:55], v[212:215]
    v_mfma_f32_16x16x32_bf16 v[216:219], v[72:75], v[52:55], v[216:219]
    v_mfma_f32_16x16x32_bf16 v[220:223], v[76:79], v[52:55], v[220:223]
    s_add_u32 m0, s22, 65536
    s_nop 0
    buffer_load_dwordx4 v2, s[8:11], s18 offen lds
    s_add_u32 s18, s18, s20
    v_mfma_f32_16x16x32_bf16 v[224:227], v[64:67], v[56:59], v[224:227]
    v_mfma_f32_16x16x32_bf16 v[228:231], v[68:71], v[56:59], v[228:231]
    v_mfma_f32_16x16x32_bf16 v[232:235], v[72:75], v[56:59], v[232:235]
    s_add_u32 m0, s22, 73728
    s_nop 0
    buffer_load_dwordx4 v2, s[12:15], s19 offen lds
    s_add_u32 s19, s19, s20
    v_mfma_f32_16x16x32_bf16 v[236:239], v[76:79], v[56:59], v[236:239]
    v_mfma_f32_16x16x32_bf16 v[240:243], v[64:67], v[60:63], v[240:243]
    v_mfma_f32_16x16x32_bf16 v[244:247], v[68:71], v[60:63], v[244:247]
    v_mfma_f32_16x16x32_bf16 v[248:251], v[72:75], v[60:63], v[248:251]
    v_mfma_f32_16x16x32_bf16 v[252:255], v[76:79], v[60:63], v[252:255]
    s_waitcnt lgkmcnt(0)
    s_waitcnt vmcnt(8)
    s_barrier
    s_cmp_eq_u32 s28, 0
    s_cbranch_scc1 sig_4
    s_cmp_lg_u32 s3, 0
    s_cbranch_scc1 sig_4
    s_mov_b64 exec, 1
    v_mov_b32 v18, s57
    buffer_atomic_add v18, v17, s[4:7], s28 offen sc1
    s_mov_b64 exec, -1
sig_4:
    s_mov_b32 s28, 0
    v_mfma_f32_16x16x32_bf16 v[128:131], v[112:115], v[80:83], v[128:131]
    ds_read_b64_tr_b16 v[64:65], v8 offset:16384
    v_mfma_f32_16x16x32_bf16 v[132:135], v[116:119], v[80:83], v[132:135]
    ds_read_b64_tr_b16 v[66:67], v9 offset:16384
    v_mfma_f32_16x16x32_bf16 v[136:139], v[120:123], v[80:83], v[136:139]
    ds_read_b64_tr_b16 v[68:69], v10 offset:16384
    v_mfma_f32_16x16x32_bf16 v[140:143], v[124:127], v[80:83], v[140:143]
    ds_read_b64_tr_b16 v[70:71], v11 offset:16384
    v_mfma_f32_16x16x32_bf16 v[144:147], v[112:115], v[84:87], v[144:147]
    ds_read_b64_tr_b16 v[72:73], v8 offset:24576
    v_mfma_f32_16x16x32_bf16 v[148:151], v[116:119], v[84:87], v[148:151]
    ds_read_b64_tr_b16 v[74:75], v9 offset:24576
    v_mfma_f32_16x16x32_bf16 v[152:155], v[120:123], v[84:87], v[152:155]
    ds_read_b64_tr_b16 v[76:77], v10 offset:24576
    v_mfma_f32_16x16x32_bf16 v[156:159], v[124:127], v[84:87], v[156:159]
    ds_read_b64_tr_b16 v[78:79], v11 offset:24576
    v_mfma_f32_16x16x32_bf16 v[160:163], v[112:115], v[88:91], v[160:163]
    ds_read_b128 v[32:35], v5 offset:0
    v_mfma_f32_16x16x32_bf16 v[164:167], v[116:119], v[88:91], v[164:167]
    ds_read_b128 v[36:39], v5 offset:1024
    v_mfma_f32_16x16x32_bf16 v[168:171], v[120:123], v[88:91], v[168:171]
    ds_read_b128 v[40:43], v5 offset:2048
    v_mfma_f32_16x16x32_bf16 v[172:175], v[124:127], v[88:91], v[172:175]
    ds_read_b128 v[44:47], v5 offset:3072
    v_mfma_f32_16x16x32_bf16 v[176:179], v[112:115], v[92:95], v[176:179]
    ds_read_b128 v[48:51], v5 offset:4096
    v_mfma_f32_16x16x32_bf16 v[180:183], v[116:119], v[92:95], v[180:183]
    ds_read_b128 v[52:55], v5 offset:5120
    v_mfma_f32_16x16x32_bf16 v[184:187], v[120:123], v[92:95], v[184:187]
    ds_read_b128 v[56:59], v5 offset:6144
    v_mfma_f32_16x16x32_bf16 v[188:191], v[124:127], v[92:95], v[188:191]
    ds_read_b128 v[60:63], v5 offset:7168
    v_mfma_f32_16x16x32_bf16 v[192:195], v[112:115], v[96:99], v[192:195]
    v_mfma_f32_16x16x32_bf16 v[196:199], v[116:119], v[96:99], v[196:199]
    s_add_u32 m0, s21, 98304
    s_nop 0
    buffer_load_dwordx4 v1, s[4:7], s16 offen sc1 lds
    s_add_u32 s16, s16, s62
    v_mfma_f32_16x16x32_bf16 v[200:203], v[120:123], v[96:99], v[200:203]
    v_mfma_f32_16x16x32_bf16 v[204:207], v[124:127], v[96:99], v[204:207]
    v_mfma_f32_16x16x32_bf16 v[208:211], v[112:115], v[100:103], v[208:211]
    s_add_u32 m0, s21, 99328
    s_nop 0
    buffer_load_dwordx4 v1, s[4:7], s17 offen sc1 lds
    s_add_u32 s17, s17, s62
    v_mfma_f32_16x16x32_bf16 v[212:215], v[116:119], v[100:103], v[212:215]
    v_mfma_f32_16x16x32_bf16 v[216:219], v[120:123], v[100:103], v[216:219]
    v_mfma_f32_16x16x32_bf16 v[220:223], v[124:127], v[100:103], v[220:223]
    s_add_u32 m0, s22, 98304
    s_nop 0
    buffer_load_dwordx4 v2, s[8:11], s18 offen lds
    s_add_u32 s18, s18, s20
    v_mfma_f32_16x16x32_bf16 v[224:227], v[112:115], v[104:107], v[224:227]
    v_mfma_f32_16x16x32_bf16 v[228:231], v[116:119], v[104:107], v[228:231]
    v_mfma_f32_16x16x32_bf16 v[232:235], v[120:123], v[104:107], v[232:235]
    s_add_u32 m0, s22, 106496
    s_nop 0
    buffer_load_dwordx4 v2, s[12:15], s19 offen lds
    s_add_u32 s19, s19, s20
    v_mfma_f32_16x16x32_bf16 v[236:239], v[124:127], v[104:107], v[236:239]
    v_mfma_f32_16x16x32_bf16 v[240:243], v[112:115], v[108:111], v[240:243]
    v_mfma_f32_16x16x32_bf16 v[244:247], v[116:119], v[108:111], v[244:247]
    v_mfma_f32_16x16x32_bf16 v[248:251], v[120:123], v[108:111], v[248:251]
    v_mfma_f32_16x16x32_bf16 v[252:255], v[124:127], v[108:111], v[252:255]
    s_waitcnt lgkmcnt(0)
w_loop_chk:
    s_sub_u32 s23, s23, 1
w_loop:
    s_cmp_lg_u32 s23, 1
    s_cbranch_scc1 w_body
    v_readfirstlane_b32 s30, v16
    s_cmp_ge_u32 s30, s45
    s_cselect_b32 s30, 0, 1
    s_or_b32 s30, s30, s70
    s_cmp_eq_u32 s32, 4
    s_cselect_b32 s30, 1, s30
    s_cmp_eq_u32 s32, 0
    s_cselect_b32 s30, 1, s30
    v_mov_b32 v20, s30
    ds_write_b32 v7, v20
    s_cbranch_scc1 w_body
    s_load_dwordx2 s[8:9], s[0:1], s33
    s_load_dwordx2 s[12:13], s[0:1], s34
    s_mov_b32 s10, s38
    s_mov_b32 s14, s38
    s_cmp_eq_u32 s32, 4
    s_cselect_b32 s31, 0, 1
    s_lshl_b32 s30, s3, s31
    s_mul_i32 s30, s30, s40
    s_add_u32 s16, s39, s30
    s_cmp_eq_u32 s32, 4
    s_cselect_b32 s30, 1024, s40
    s_cselect_b32 s31, 6, 5
    s_lshl_b32 s62, 32, s31
    s_add_u32 s17, s16, s30
    s_lshl_b32 s30, s3, 2
    s_mul_i32 s30, s30, s35
    s_add_u32 s18, s36, s30
    s_add_u32 s19, s37, s30
    s_lshl_b32 s20, s35, s31
    v_mul_u32_u24 v2, s35, v4
    v_add_u32 v2, v2, v3
    s_waitcnt lgkmcnt(0)
w_body:
    s_waitcnt vmcnt(8)
    s_barrier
    v_mfma_f32_16x16x32_bf16 v[128:131], v[64:67], v[32:35], v[128:131]
    ds_read_b64_tr_b16 v[112:113], v8 offset:49152
    v_mfma_f32_16x16x32_bf16 v[132:135], v[68:71], v[32:35], v[132:135]
    ds_read_b64_tr_b16 v[114:115], v9 offset:49152
    v_mfma_f32_16x16x32_bf16 v[136:139], v[72:75], v[32:35], v[136:139]
    ds_read_b64_tr_b16 v[116:117], v10 offset:49152
    v_mfma_f32_16x16x32_bf16 v[140:143], v[76:79], v[32:35], v[140:143]
    ds_read_b64_tr_b16 v[118:119], v11 offset:49152
    v_mfma_f32_16x16x32_bf16 v[144:147], v[64:67], v[36:39], v[144:147]
    ds_read_b64_tr_b16 v[120:121], v8 offset:57344
    v_mfma_f32_16x16x32_bf16 v[148:151], v[68:71], v[36:39], v[148:151]
    ds_read_b64_tr_b16 v[122:123], v9 offset:57344
    v_mfma_f32_16x16x32_bf16 v[152:155], v[72:75], v[36:39], v[152:155]
    ds_read_b64_tr_b16 v[124:125], v10 offset:57344
    v_mfma_f32_16x16x32_bf16 v[156:159], v[76:79], v[36:39], v[156:159]
    ds_read_b64_tr_b16 v[126:127], v11 offset:57344
    v_mfma_f32_16x16x32_bf16 v[160:163], v[64:67], v[40:43], v[160:163]
    ds_read_b128 v[80:83], v5 offset:32768
    v_mfma_f32_16x16x32_bf16 v[164:167], v[68:71], v[40:43], v[164:167]
    ds_read_b128 v[84:87], v5 offset:33792
    v_mfma_f32_16x16x32_bf16 v[168:171], v[72:75], v[40:43], v[168:171]
    ds_read_b128 v[88:91], v5 offset:34816
    v_mfma_f32_16x16x32_bf16 v[172:175], v[76:79], v[40:43], v[172:175]
    ds_read_b128 v[92:95], v5 offset:35840
    v_mfma_f32_16x16x32_bf16 v[176:179], v[64:67], v[44:47], v[176:179]
    ds_read_b128 v[96:99], v5 offset:36864
    v_mfma_f32_16x16x32_bf16 v[180:183], v[68:71], v[44:47], v[180:183]
    ds_read_b128 v[100:103], v5 offset:37888
    v_mfma_f32_16x16x32_bf16 v[184:187], v[72:75], v[44:47], v[184:187]
    ds_read_b128 v[104:107], v5 offset:38912
    v_mfma_f32_16x16x32_bf16 v[188:191], v[76:79], v[44:47], v[188:191]
    ds_read_b128 v[108:111], v5 offset:39936
    v_mfma_f32_16x16x32_bf16 v[192:195], v[64:67], v[48:51], v[192:195]
    v_mfma_f32_16x16x32_bf16 v[196:199], v[68:71], v[48:51], v[196:199]
    s_add_u32 m0, s21, 0
    s_nop 0
    buffer_load_dwordx4 v1, s[4:7], s16 offen sc1 lds
    s_add_u32 s16, s16, s62
    v_mfma_f32_16x16x32_bf16 v[200:203], v[72:75], v[48:51], v[200:203]
    v_mfma_f32_16x16x32_bf16 v[204:207], v[76:79], v[48:51], v[204:207]
    v_mfma_f32_16x16x32_bf16 v[208:211], v[64:67], v[52:55], v[208:211]
    s_add_u32 m0, s21, 1024
    s_nop 0
    buffer_load_dwordx4 v1, s[4:7], s17 offen sc1 lds
    s_add_u32 s17, s17, s62
    v_mfma_f32_16x16x32_bf16 v[212:215], v[68:71], v[52:55], v[212:215]
    v_mfma_f32_16x16x32_bf16 v[216:219], v[72:75], v[52:55], v[216:219]
    v_mfma_f32_16x16x32_bf16 v[220:223], v[76:79], v[52:55], v[220:223]
    s_add_u32 m0, s22, 0
    s_nop 0
    buffer_load_dwordx4 v2, s[8:11], s18 offen lds
    s_add_u32 s18, s18, s20
    v_mfma_f32_16x16x32_bf16 v[224:227], v[64:67], v[56:59], v[224:227]
    v_mfma_f32_16x16x32_bf16 v[228:231], v[68:71], v[56:59], v[228:231]
    v_mfma_f32_16x16x32_bf16 v[232:235], v[72:75], v[56:59], v[232:235]
    s_add_u32 m0, s22, 8192
    s_nop 0
    buffer_load_dwordx4 v2, s[12:15], s19 offen lds
    s_add_u32 s19, s19, s20
    v_mfma_f32_16x16x32_bf16 v[236:239], v[76:79], v[56:59], v[236:239]
    v_mfma_f32_16x16x32_bf16 v[240:243], v[64:67], v[60:63], v[240:243]
    v_mfma_f32_16x16x32_bf16 v[244:247], v[68:71], v[60:63], v[244:247]
    buffer_load_dword v16, v17, s[4:7], s44 offen sc1
    v_mfma_f32_16x16x32_bf16 v[248:251], v[72:75], v[60:63], v[248:251]
    v_mfma_f32_16x16x32_bf16 v[252:255], v[76:79], v[60:63], v[252:255]
    s_waitcnt lgkmcnt(0)
    s_waitcnt vmcnt(8)
    s_barrier
    v_mfma_f32_16x16x32_bf16 v[128:131], v[112:115], v[80:83], v[128:131]
    ds_read_b64_tr_b16 v[64:65], v12 offset:16384
    v_mfma_f32_16x16x32_bf16 v[132:135], v[116:119], v[80:83], v[132:135]
    ds_read_b64_tr_b16 v[66:67], v13 offset:16384
    v_mfma_f32_16x16x32_bf16 v[136:139], v[120:123], v[80:83], v[136:139]
    ds_read_b64_tr_b16 v[68:69], v14 offset:16384
    v_mfma_f32_16x16x32_bf16 v[140:143], v[124:127], v[80:83], v[140:143]
    ds_read_b64_tr_b16 v[70:71], v15 offset:16384
    v_mfma_f32_16x16x32_bf16 v[144:147], v[112:115], v[84:87], v[144:147]
    ds_read_b64_tr_b16 v[72:73], v12 offset:24576
    v_mfma_f32_16x16x32_bf16 v[148:151], v[116:119], v[84:87], v[148:151]
    ds_read_b64_tr_b16 v[74:75], v13 offset:24576
    v_mfma_f32_16x16x32_bf16 v[152:155], v[120:123], v[84:87], v[152:155]
    ds_read_b64_tr_b16 v[76:77], v14 offset:24576
    v_mfma_f32_16x16x32_bf16 v[156:159], v[124:127], v[84:87], v[156:159]
    ds_read_b64_tr_b16 v[78:79], v15 offset:24576
    v_mfma_f32_16x16x32_bf16 v[160:163], v[112:115], v[88:91], v[160:163]
    ds_read_b128 v[32:35], v6 offset:0
    v_mfma_f32_16x16x32_bf16 v[164:167], v[116:119], v[88:91], v[164:167]
    ds_read_b128 v[36:39], v6 offset:1024
    v_mfma_f32_16x16x32_bf16 v[168:171], v[120:123], v[88:91], v[168:171]
    ds_read_b128 v[40:43], v6 offset:2048
    v_mfma_f32_16x16x32_bf16 v[172:175], v[124:127], v[88:91], v[172:175]
    ds_read_b128 v[44:47], v6 offset:3072
    v_mfma_f32_16x16x32_bf16 v[176:179], v[112:115], v[92:95], v[176:179]
    ds_read_b128 v[48:51], v6 offset:4096
    v_mfma_f32_16x16x32_bf16 v[180:183], v[116:119], v[92:95], v[180:183]
    ds_read_b128 v[52:55], v6 offset:5120
    v_mfma_f32_16x16x32_bf16 v[184:187], v[120:123], v[92:95], v[184:187]
    ds_read_b128 v[56:59], v6 offset:6144
    v_mfma_f32_16x16x32_bf16 v[188:191], v[124:127], v[92:95], v[188:191]
    ds_read_b128 v[60:63], v6 offset:7168
    v_mfma_f32_16x16x32_bf16 v[192:195], v[112:115], v[96:99], v[192:195]
    v_mfma_f32_16x16x32_bf16 v[196:199], v[116:119], v[96:99], v[196:199]
    s_add_u32 m0, s21, 32768
    s_nop 0
    buffer_load_dwordx4 v1, s[4:7], s16 offen sc1 lds
    s_add_u32 s16, s16, s62
    v_mfma_f32_16x16x32_bf16 v[200:203], v[120:123], v[96:99], v[200:203]
    v_mfma_f32_16x16x32_bf16 v[204:207], v[124:127], v[96:99], v[204:207]
    v_mfma_f32_16x16x32_bf16 v[208:211], v[112:115], v[100:103], v[208:211]
    s_add_u32 m0, s21, 33792
    s_nop 0
    buffer_load_dwordx4 v1, s[4:7], s17 offen sc1 lds
    s_add_u32 s17, s17, s62
    v_mfma_f32_16x16x32_bf16 v[212:215], v[116:119], v[100:103], v[212:215]
    v_mfma_f32_16x16x32_bf16 v[216:219], v[120:123], v[100:103], v[216:219]
    v_mfma_f32_16x16x32_bf16 v[220:223], v[124:127], v[100:103], v[220:223]
    s_add_u32 m0, s22, 32768
    s_nop 0
    buffer_load_dwordx4 v2, s[8:11], s18 offen lds
    s_add_u32 s18, s18, s20
    v_mfma_f32_16x16x32_bf16 v[224:227], v[112:115], v[104:107], v[224:227]
    v_mfma_f32_16x16x32_bf16 v[228:231], v[116:119], v[104:107], v[228:231]
    v_mfma_f32_16x16x32_bf16 v[232:235], v[120:123], v[104:107], v[232:235]
    s_add_u32 m0, s22, 40960
    s_nop 0
    buffer_load_dwordx4 v2, s[12:15], s19 offen lds
    s_add_u32 s19, s19, s20
    v_mfma_f32_16x16x32_bf16 v[236:239], v[124:127], v[104:107], v[236:239]
    v_mfma_f32_16x16x32_bf16 v[240:243], v[112:115], v[108:111], v[240:243]
    v_mfma_f32_16x16x32_bf16 v[244:247], v[116:119], v[108:111], v[244:247]
    v_mfma_f32_16x16x32_bf16 v[248:251], v[120:123], v[108:111], v[248:251]
    v_mfma_f32_16x16x32_bf16 v[252:255], v[124:127], v[108:111], v[252:255]
    s_waitcnt lgkmcnt(0)
    s_waitcnt vmcnt(8)
    s_barrier
    v_mfma_f32_16x16x32_bf16 v[128:131], v[64:67], v[32:35], v[128:131]
    ds_read_b64_tr_b16 v[112:113], v12 offset:49152
    v_mfma_f32_16x16x32_bf16 v[132:135], v[68:71], v[32:35], v[132:135]
    ds_read_b64_tr_b16 v[114:115], v13 offset:49152
    v_mfma_f32_16x16x32_bf16 v[136:139], v[72:75], v[32:35], v[136:139]
    ds_read_b64_tr_b16 v[116:117], v14 offset:49152
    v_mfma_f32_16x16x32_bf16 v[140:143], v[76:79], v[32:35], v[140:143]
    ds_read_b64_tr_b16 v[118:119], v15 offset:49152
    v_mfma_f32_16x16x32_bf16 v[144:147], v[64:67], v[36:39], v[144:147]
    ds_read_b64_tr_b16 v[120:121], v12 offset:57344
    v_mfma_f32_16x16x32_bf16 v[148:151], v[68:71], v[36:39], v[148:151]
    ds_read_b64_tr_b16 v[122:123], v13 offset:57344
    v_mfma_f32_16x16x32_bf16 v[152:155], v[72:75], v[36:39], v[152:155]
    ds_read_b64_tr_b16 v[124:125], v14 offset:57344
    v_mfma_f32_16x16x32_bf16 v[156:159], v[76:79], v[36:39], v[156:159]
    ds_read_b64_tr_b16 v[126:127], v15 offset:57344
    v_mfma_f32_16x16x32_bf16 v[160:163], v[64:67], v[40:43], v[160:163]
    ds_read_b128 v[80:83], v6 offset:32768
    v_mfma_f32_16x16x32_bf16 v[164:167], v[68:71], v[40:43], v[164:167]
    ds_read_b128 v[84:87], v6 offset:33792
    v_mfma_f32_16x16x32_bf16 v[168:171], v[72:75], v[40:43], v[168:171]
    ds_read_b128 v[88:91], v6 offset:34816
    v_mfma_f32_16x16x32_bf16 v[172:175], v[76:79], v[40:43], v[172:175]
    ds_read_b128 v[92:95], v6 offset:35840
    v_mfma_f32_16x16x32_bf16 v[176:179], v[64:67], v[44:47], v[176:179]
    ds_read_b128 v[96:99], v6 offset:36864
    v_mfma_f32_16x16x32_bf16 v[180:183], v[68:71], v[44:47], v[180:183]
    ds_read_b128 v[100:103], v6 offset:37888
    v_mfma_f32_16x16x32_bf16 v[184:187], v[72:75], v[44:47], v[184:187]
    ds_read_b128 v[104:107], v6 offset:38912
    v_mfma_f32_16x16x32_bf16 v[188:191], v[76:79], v[44:47], v[188:191]
    ds_read_b128 v[108:111], v6 offset:39936
    v_mfma_f32_16x16x32_bf16 v[192:195], v[64:67], v[48:51], v[192:195]
    v_mfma_f32_16x16x32_bf16 v[196:199], v[68:71], v[48:51], v[196:199]
    s_add_u32 m0, s21, 65536
    s_nop 0
    buffer_load_dwordx4 v1, s[4:7], s16 offen sc1 lds
    s_add_u32 s16, s16, s62
    v_mfma_f32_16x16x32_bf16 v[200:203], v[72:75], v[48:51], v[200:203]
    v_mfma_f32_16x16x32_bf16 v[204:207], v[76:79], v[48:51], v[204:207]
    v_mfma_f32_16x16x32_bf16 v[208:211], v[64:67], v[52:55], v[208:211]
    s_add_u32 m0, s21, 66560
    s_nop 0
    buffer_load_dwordx4 v1, s[4:7], s17 offen sc1 lds
    s_add_u32 s17, s17, s62
    v_mfma_f32_16x16x32_bf16 v[212:215], v[68:71], v[52:55], v[212:215]
    v_mfma_f32_16x16x32_bf16 v[216:219], v[72:75], v[52:55], v[216:219]
    v_mfma_f32_16x16x32_bf16 v[220:223], v[76:79], v[52:55], v[220:223]
    s_add_u32 m0, s22, 65536
    s_nop 0
    buffer_load_dwordx4 v2, s[8:11], s18 offen lds
    s_add_u32 s18, s18, s20
    v_mfma_f32_16x16x32_bf16 v[224:227], v[64:67], v[56:59], v[224:227]
    v_mfma_f32_16x16x32_bf16 v[228:231], v[68:71], v[56:59], v[228:231]
    v_mfma_f32_16x16x32_bf16 v[232:235], v[72:75], v[56:59], v[232:235]
    s_add_u32 m0, s22, 73728
    s_nop 0
    buffer_load_dwordx4 v2, s[12:15], s19 offen lds
    s_add_u32 s19, s19, s20
    v_mfma_f32_16x16x32_bf16 v[236:239], v[76:79], v[56:59], v[236:239]
    v_mfma_f32_16x16x32_bf16 v[240:243], v[64:67], v[60:63], v[240:243]
    v_mfma_f32_16x16x32_bf16 v[244:247], v[68:71], v[60:63], v[244:247]
    v_mfma_f32_16x16x32_bf16 v[248:251], v[72:75], v[60:63], v[248:251]
    v_mfma_f32_16x16x32_bf16 v[252:255], v[76:79], v[60:63], v[252:255]
    s_waitcnt lgkmcnt(0)
    s_waitcnt vmcnt(8)
    s_barrier
    v_mfma_f32_16x16x32_bf16 v[128:131], v[112:115], v[80:83], v[128:131]
    ds_read_b64_tr_b16 v[64:65], v8 offset:16384
    v_mfma_f32_16x16x32_bf16 v[132:135], v[116:119], v[80:83], v[132:135]
    ds_read_b64_tr_b16 v[66:67], v9 offset:16384
    v_mfma_f32_16x16x32_bf16 v[136:139], v[120:123], v[80:83], v[136:139]
    ds_read_b64_tr_b16 v[68:69], v10 offset:16384
    v_mfma_f32_16x16x32_bf16 v[140:143], v[124:127], v[80:83], v[140:143]
    ds_read_b64_tr_b16 v[70:71], v11 offset:16384
    v_mfma_f32_16x16x32_bf16 v[144:147], v[112:115], v[84:87], v[144:147]
    ds_read_b64_tr_b16 v[72:73], v8 offset:24576
    v_mfma_f32_16x16x32_bf16 v[148:151], v[116:119], v[84:87], v[148:151]
    ds_read_b64_tr_b16 v[74:75], v9 offset:24576
    v_mfma_f32_16x16x32_bf16 v[152:155], v[120:123], v[84:87], v[152:155]
    ds_read_b64_tr_b16 v[76:77], v10 offset:24576
    v_mfma_f32_16x16x32_bf16 v[156:159], v[124:127], v[84:87], v[156:159]
    ds_read_b64_tr_b16 v[78:79], v11 offset:24576
    v_mfma_f32_16x16x32_bf16 v[160:163], v[112:115], v[88:91], v[160:163]
    ds_read_b128 v[32:35], v5 offset:0
    v_mfma_f32_16x16x32_bf16 v[164:167], v[116:119], v[88:91], v[164:167]
    ds_read_b128 v[36:39], v5 offset:1024
    v_mfma_f32_16x16x32_bf16 v[168:171], v[120:123], v[88:91], v[168:171]
    ds_read_b128 v[40:43], v5 offset:2048
    v_mfma_f32_16x16x32_bf16 v[172:175], v[124:127], v[88:91], v[172:175]
    ds_read_b128 v[44:47], v5 offset:3072
    v_mfma_f32_16x16x32_bf16 v[176:179], v[112:115], v[92:95], v[176:179]
    ds_read_b128 v[48:51], v5 offset:4096
    v_mfma_f32_16x16x32_bf16 v[180:183], v[116:119], v[92:95], v[180:183]
    ds_read_b128 v[52:55], v5 offset:5120
    v_mfma_f32_16x16x32_bf16 v[184:187], v[120:123], v[92:95], v[184:187]
    ds_read_b128 v[56:59], v5 offset:6144
    v_mfma_f32_16x16x32_bf16 v[188:191], v[124:127], v[92:95], v[188:191]
    ds_read_b128 v[60:63], v5 offset:7168
    v_mfma_f32_16x16x32_bf16 v[192:195], v[112:115], v[96:99], v[192:195]
    v_mfma_f32_16x16x32_bf16 v[196:199], v[116:119], v[96:99], v[196:199]
    s_add_u32 m0, s21, 98304
    s_nop 0
    buffer_load_dwordx4 v1, s[4:7], s16 offen sc1 lds
    s_add_u32 s16, s16, s62
    v_mfma_f32_16x16x32_bf16 v[200:203], v[120:123], v[96:99], v[200:203]
    v_mfma_f32_16x16x32_bf16 v[204:207], v[124:127], v[96:99], v[204:207]
    v_mfma_f32_16x16x32_bf16 v[208:211], v[112:115], v[100:103], v[208:211]
    s_add_u32 m0, s21, 99328
    s_nop 0
    buffer_load_dwordx4 v1, s[4:7], s17 offen sc1 lds
    s_add_u32 s17, s17, s62
    v_mfma_f32_16x16x32_bf16 v[212:215], v[116:119], v[100:103], v[212:215]
    v_mfma_f32_16x16x32_bf16 v[216:219], v[120:123], v[100:103], v[216:219]
    v_mfma_f32_16x16x32_bf16 v[220:223], v[124:127], v[100:103], v[220:223]
    s_add_u32 m0, s22, 98304
    s_nop 0
    buffer_load_dwordx4 v2, s[8:11], s18 offen lds
    s_add_u32 s18, s18, s20
    v_mfma_f32_16x16x32_bf16 v[224:227], v[112:115], v[104:107], v[224:227]
    v_mfma_f32_16x16x32_bf16 v[228:231], v[116:119], v[104:107], v[228:231]
    v_mfma_f32_16x16x32_bf16 v[232:235], v[120:123], v[104:107], v[232:235]
    s_add_u32 m0, s22, 106496
    s_nop 0
    buffer_load_dwordx4 v2, s[12:15], s19 offen lds
    s_add_u32 s19, s19, s20
    v_mfma_f32_16x16x32_bf16 v[236:239], v[124:127], v[104:107], v[236:239]
    v_mfma_f32_16x16x32_bf16 v[240:243], v[112:115], v[108:111], v[240:243]
    v_mfma_f32_16x16x32_bf16 v[244:247], v[116:119], v[108:111], v[244:247]
    v_mfma_f32_16x16x32_bf16 v[248:251], v[120:123], v[108:111], v[248:251]
    v_mfma_f32_16x16x32_bf16 v[252:255], v[124:127], v[108:111], v[252:255]
    s_waitcnt lgkmcnt(0)
    s_sub_u32 s23, s23, 1
    s_cmp_lg_u32 s23, 0
    s_cbranch_scc1 w_loop
    v_mov_b32 v20, 131072
    ds_read_b128 v[24:27], v20
    ds_read_b128 v[28:31], v20 offset:16
    s_cmp_eq_u32 s48, 2
    s_cbranch_scc1 w_epi_glu
    s_cmp_eq_u32 s48, 3
    s_cbranch_scc1 w_epi_silu
    s_lshl_b32 s30, s27, 10
    s_add_u32 s30, s30, s49
    s_nop 7
    v_cvt_pk_bf16_f32 v80, v128, v129
    v_cvt_pk_bf16_f32 v81, v130, v131
    v_cvt_pk_bf16_f32 v82, v132, v133
    v_cvt_pk_bf16_f32 v83, v134, v135
    buffer_store_dwordx4 v[80:83], v1, s[4:7], s30 offen sc1
    v_cvt_pk_bf16_f32 v84, v136, v137
    v_cvt_pk_bf16_f32 v85, v138, v139
    v_cvt_pk_bf16_f32 v86, v140, v141
    v_cvt_pk_bf16_f32 v87, v142, v143
    buffer_store_dwordx4 v[84:87], v19, s[4:7], s30 offen sc1
    s_add_u32 s30, s30, s50
    v_cvt_pk_bf16_f32 v88, v144, v145
    v_cvt_pk_bf16_f32 v89, v146, v147
    v_cvt_pk_bf16_f32 v90, v148, v149
    v_cvt_pk_bf16_f32 v91, v150, v151
    buffer_store_dwordx4 v[88:91], v1, s[4:7], s30 offen sc1
    v_cvt_pk_bf16_f32 v92, v152, v153
    v_cvt_pk_bf16_f32 v93, v154, v155
    v_cvt_pk_bf16_f32 v94, v156, v157
    v_cvt_pk_bf16_f32 v95, v158, v159
    buffer_store_dwordx4 v[92:95], v19, s[4:7], s30 offen sc1
    s_add_u32 s30, s30, s50
    v_cvt_pk_bf16_f32 v80, v160, v161
    v_cvt_pk_bf16_f32 v81, v162, v163
    v_cvt_pk_bf16_f32 v82, v164, v165
    v_cvt_pk_bf16_f32 v83, v166, v167
    buffer_store_dwordx4 v[80:83], v1, s[4:7], s30 offen sc1
    v_cvt_pk_bf16_f32 v84, v168, v169
    v_cvt_pk_bf16_f32 v85, v170, v171
    v_cvt_pk_bf16_f32 v86, v172, v173
    v_cvt_pk_bf16_f32 v87, v174, v175
    buffer_store_dwordx4 v[84:87], v19, s[4:7], s30 offen sc1
    s_add_u32 s30, s30, s50
    v_cvt_pk_bf16_f32 v88, v176, v177
    v_cvt_pk_bf16_f32 v89, v178, v179
    v_cvt_pk_bf16_f32 v90, v180, v181
    v_cvt_pk_bf16_f32 v91, v182, v183
    buffer_store_dwordx4 v[88:91], v1, s[4:7], s30 offen sc1
    v_cvt_pk_bf16_f32 v92, v184, v185
    v_cvt_pk_bf16_f32 v93, v186, v187
    v_cvt_pk_bf16_f32 v94, v188, v189
    v_cvt_pk_bf16_f32 v95, v190, v191
    buffer_store_dwordx4 v[92:95], v19, s[4:7], s30 offen sc1
    s_add_u32 s30, s30, s50
    v_cvt_pk_bf16_f32 v80, v192, v193
    v_cvt_pk_bf16_f32 v81, v194, v195
    v_cvt_pk_bf16_f32 v82, v196, v197
    v_cvt_pk_bf16_f32 v83, v198, v199
    buffer_store_dwordx4 v[80:83], v1, s[4:7], s30 offen sc1
    v_cvt_pk_bf16_f32 v84, v200, v201
    v_cvt_pk_bf16_f32 v85, v202, v203
    v_cvt_pk_bf16_f32 v86, v204, v205
    v_cvt_pk_bf16_f32 v87, v206, v207
    buffer_store_dwordx4 v[84:87], v19, s[4:7], s30 offen sc1
    s_add_u32 s30, s30, s50
    v_cvt_pk_bf16_f32 v88, v208, v209
    v_cvt_pk_bf16_f32 v89, v210, v211
    v_cvt_pk_bf16_f32 v90, v212, v213
    v_cvt_pk_bf16_f32 v91, v214, v215
    buffer_store_dwordx4 v[88:91], v1, s[4:7], s30 offen sc1
    v_cvt_pk_bf16_f32 v92, v216, v217
    v_cvt_pk_bf16_f32 v93, v218, v219
    v_cvt_pk_bf16_f32 v94, v220, v221
    v_cvt_pk_bf16_f32 v95, v222, v223
    buffer_store_dwordx4 v[92:95], v19, s[4:7], s30 offen sc1
    s_add_u32 s30, s30, s50
    v_cvt_pk_bf16_f32 v80, v224, v225
    v_cvt_pk_bf16_f32 v81, v226, v227
    v_cvt_pk_bf16_f32 v82, v228, v229
    v_cvt_pk_bf16_f32 v83, v230, v231
    buffer_store_dwordx4 v[80:83], v1, s[4:7], s30 offen sc1
    v_cvt_pk_bf16_f32 v84, v232, v233
    v_cvt_pk_bf16_f32 v85, v234, v235
    v_cvt_pk_bf16_f32 v86, v236, v237
    v_cvt_pk_bf16_f32 v87, v238, v239
    buffer_store_dwordx4 v[84:87], v19, s[4:7], s30 offen sc1
    s_add_u32 s30, s30, s50
    v_cvt_pk_bf16_f32 v88, v240, v241
    v_cvt_pk_bf16_f32 v89, v242, v243
    v_cvt_pk_bf16_f32 v90, v244, v245
    v_cvt_pk_bf16_f32 v91, v246, v247
    buffer_store_dwordx4 v[88:91], v1, s[4:7], s30 offen sc1
    v_cvt_pk_bf16_f32 v92, v248, v249
    v_cvt_pk_bf16_f32 v93, v250, v251
    v_cvt_pk_bf16_f32 v94, v252, v253
    v_cvt_pk_bf16_f32 v95, v254, v255
    buffer_store_dwordx4 v[92:95], v19, s[4:7], s30 offen sc1
    s_waitcnt lgkmcnt(0)
    v_or3_b32 v24, v24, v25, v26
    v_or3_b32 v28, v28, v29, v30
    v_or3_b32 v24, v24, v27, v31
    v_or_b32 v24, v24, v28
    s_mov_b32 s28, s51
    s_mov_b32 s57, s53
    v_readfirstlane_b32 s30, v24
    s_cmp_lg_u32 s30, 0
    s_cbranch_scc1 w_drain
    s_mov_b32 s48, s32
    s_cmp_eq_u32 s32, 4
    s_cselect_b32 s30, 2, 3
    s_lshl_b32 s30, s26, s30
    s_mul_i32 s30, s30, s43
    s_add_u32 s49, s42, s30
    s_mov_b32 s50, s43
    s_mov_b32 s51, s46
    s_mov_b32 s23, s41
    s_mov_b32 s53, s47
    s_nop 0
    s_load_dwordx16 s[32:47], s[24:25], 0
    s_add_u32 s24, s24, 64
    s_addc_u32 s25, s25, 0
    s_branch w_first16
w_epi_glu:
    s_lshl_b32 s30, s27, 10
    s_add_u32 s30, s30, s49
    s_mov_b32 s54, 0xbfb8aa3b
    s_nop 7
    v_cvt_pk_bf16_f32 v80, v128, v129
    v_cvt_pk_bf16_f32 v81, v130, v131
    v_cvt_pk_bf16_f32 v82, v132, v133
    v_cvt_pk_bf16_f32 v83, v134, v135
    v_lshlrev_b32 v96, 16, v80
    v_and_b32 v97, 0xffff0000, v80
    v_lshlrev_b32 v98, 16, v81
    v_and_b32 v99, 0xffff0000, v81
    v_lshlrev_b32 v100, 16, v82
    v_and_b32 v101, 0xffff0000, v82
    v_lshlrev_b32 v102, 16, v83
    v_and_b32 v103, 0xffff0000, v83
    v_mul_f32 v96, s54, v96
    v_mul_f32 v97, s54, v97
    v_mul_f32 v98, s54, v98
    v_mul_f32 v99, s54, v99
    v_mul_f32 v100, s54, v100
    v_mul_f32 v101, s54, v101
    v_mul_f32 v102, s54, v102
    v_mul_f32 v103, s54, v103
    v_exp_f32 v96, v96
    v_exp_f32 v97, v97
    v_exp_f32 v98, v98
    v_exp_f32 v99, v99
    v_exp_f32 v100, v100
    v_exp_f32 v101, v101
    v_exp_f32 v102, v102
    v_exp_f32 v103, v103
    v_add_f32 v96, 1.0, v96
    v_add_f32 v97, 1.0, v97
    v_add_f32 v98, 1.0, v98
    v_add_f32 v99, 1.0, v99
    v_add_f32 v100, 1.0, v100
    v_add_f32 v101, 1.0, v101
    v_add_f32 v102, 1.0, v102
    v_add_f32 v103, 1.0, v103
    v_rcp_f32 v96, v96
    v_rcp_f32 v97, v97
    v_rcp_f32 v98, v98
    v_rcp_f32 v99, v99
    v_rcp_f32 v100, v100
    v_rcp_f32 v101, v101
    v_rcp_f32 v102, v102
    v_rcp_f32 v103, v103
    v_mul_f32 v96, v96, v136
    v_mul_f32 v97, v97, v137
    v_mul_f32 v98, v98, v138
    v_mul_f32 v99, v99, v139
    v_mul_f32 v100, v100, v140
    v_mul_f32 v101, v101, v141
    v_mul_f32 v102, v102, v142
    v_mul_f32 v103, v103, v143
    v_cvt_pk_bf16_f32 v80, v96, v97
    v_cvt_pk_bf16_f32 v81, v98, v99
    v_cvt_pk_bf16_f32 v82, v100, v101
    v_cvt_pk_bf16_f32 v83, v102, v103
    buffer_store_dwordx4 v[80:83], v1, s[4:7], s30 offen sc1
    s_add_u32 s30, s30, s50
    v_cvt_pk_bf16_f32 v84, v144, v145
    v_cvt_pk_bf16_f32 v85, v146, v147
    v_cvt_pk_bf16_f32 v86, v148, v149
    v_cvt_pk_bf16_f32 v87, v150, v151
    v_lshlrev_b32 v104, 16, v84
    v_and_b32 v105, 0xffff0000, v84
    v_lshlrev_b32 v106, 16, v85
    v_and_b32 v107, 0xffff0000, v85
    v_lshlrev_b32 v108, 16, v86
    v_and_b32 v109, 0xffff0000, v86
    v_lshlrev_b32 v110, 16, v87
    v_and_b32 v111, 0xffff0000, v87
    v_mul_f32 v104, s54, v104
    v_mul_f32 v105, s54, v105
    v_mul_f32 v106, s54, v106
    v_mul_f32 v107, s54, v107
    v_mul_f32 v108, s54, v108
    v_mul_f32 v109, s54, v109
    v_mul_f32 v110, s54, v110
    v_mul_f32 v111, s54, v111
    v_exp_f32 v104, v104
    v_exp_f32 v105, v105
    v_exp_f32 v106, v106
    v_exp_f32 v107, v107
    v_exp_f32 v108, v108
    v_exp_f32 v109, v109
    v_exp_f32 v110, v110
    v_exp_f32 v111, v111
    v_add_f32 v104, 1.0, v104
    v_add_f32 v105, 1.0, v105
    v_add_f32 v106, 1.0, v106
    v_add_f32 v107, 1.0, v107
    v_add_f32 v108, 1.0, v108
    v_add_f32 v109, 1.0, v109
    v_add_f32 v110, 1.0, v110
    v_add_f32 v111, 1.0, v111
    v_rcp_f32 v104, v104
    v_rcp_f32 v105, v105
    v_rcp_f32 v106, v106
    v_rcp_f32 v107, v107
    v_rcp_f32 v108, v108
    v_rcp_f32 v109, v109
    v_rcp_f32 v110, v110
    v_rcp_f32 v111, v111
    v_mul_f32 v104, v104, v152
    v_mul_f32 v105, v105, v153
    v_mul_f32 v106, v106, v154
    v_mul_f32 v107, v107, v155
    v_mul_f32 v108, v108, v156
    v_mul_f32 v109, v109, v157
    v_mul_f32 v110, v110, v158
    v_mul_f32 v111, v111, v159
    v_cvt_pk_bf16_f32 v84, v104, v105
    v_cvt_pk_bf16_f32 v85, v106, v107
    v_cvt_pk_bf16_f32 v86, v108, v109
    v_cvt_pk_bf16_f32 v87, v110, v111
    buffer_store_dwordx4 v[84:87], v1, s[4:7], s30 offen sc1
    s_add_u32 s30, s30, s50
    v_cvt_pk_bf16_f32 v88, v160, v161
    v_cvt_pk_bf16_f32 v89, v162, v163
    v_cvt_pk_bf16_f32 v90, v164, v165
    v_cvt_pk_bf16_f32 v91, v166, v167
    v_lshlrev_b32 v96, 16, v88
    v_and_b32 v97, 0xffff0000, v88
    v_lshlrev_b32 v98, 16, v89
    v_and_b32 v99, 0xffff0000, v89
    v_lshlrev_b32 v100, 16, v90
    v_and_b32 v101, 0xffff0000, v90
    v_lshlrev_b32 v102, 16, v91
    v_and_b32 v103, 0xffff0000, v91
    v_mul_f32 v96, s54, v96
    v_mul_f32 v97, s54, v97
    v_mul_f32 v98, s54, v98
    v_mul_f32 v99, s54, v99
    v_mul_f32 v100, s54, v100
    v_mul_f32 v101, s54, v101
    v_mul_f32 v102, s54, v102
    v_mul_f32 v103, s54, v103
    v_exp_f32 v96, v96
    v_exp_f32 v97, v97
    v_exp_f32 v98, v98
    v_exp_f32 v99, v99
    v_exp_f32 v100, v100
    v_exp_f32 v101, v101
    v_exp_f32 v102, v102
    v_exp_f32 v103, v103
    v_add_f32 v96, 1.0, v96
    v_add_f32 v97, 1.0, v97
    v_add_f32 v98, 1.0, v98
    v_add_f32 v99, 1.0, v99
    v_add_f32 v100, 1.0, v100
    v_add_f32 v101, 1.0, v101
    v_add_f32 v102, 1.0, v102
    v_add_f32 v103, 1.0, v103
    v_rcp_f32 v96, v96
    v_rcp_f32 v97, v97
    v_rcp_f32 v98, v98
    v_rcp_f32 v99, v99
    v_rcp_f32 v100, v100
    v_rcp_f32 v101, v101
    v_rcp_f32 v102, v102
    v_rcp_f32 v103, v103
    v_mul_f32 v96, v96, v168
    v_mul_f32 v97, v97, v169
    v_mul_f32 v98, v98, v170
    v_mul_f32 v99, v99, v171
    v_mul_f32 v100, v100, v172
    v_mul_f32 v101, v101, v173
    v_mul_f32 v102, v102, v174
    v_mul_f32 v103, v103, v175
    v_cvt_pk_bf16_f32 v88, v96, v97
    v_cvt_pk_bf16_f32 v89, v98, v99
    v_cvt_pk_bf16_f32 v90, v100, v101
    v_cvt_pk_bf16_f32 v91, v102, v103
    buffer_store_dwordx4 v[88:91], v1, s[4:7], s30 offen sc1
    s_add_u32 s30, s30, s50
    v_cvt_pk_bf16_f32 v92, v176, v177
    v_cvt_pk_bf16_f32 v93, v178, v179
    v_cvt_pk_bf16_f32 v94, v180, v181
    v_cvt_pk_bf16_f32 v95, v182, v183
    v_lshlrev_b32 v104, 16, v92
    v_and_b32 v105, 0xffff0000, v92
    v_lshlrev_b32 v106, 16, v93
    v_and_b32 v107, 0xffff0000, v93
    v_lshlrev_b32 v108, 16, v94
    v_and_b32 v109, 0xffff0000, v94
    v_lshlrev_b32 v110, 16, v95
    v_and_b32 v111, 0xffff0000, v95
    v_mul_f32 v104, s54, v104
    v_mul_f32 v105, s54, v105
    v_mul_f32 v106, s54, v106
    v_mul_f32 v107, s54, v107
    v_mul_f32 v108, s54, v108
    v_mul_f32 v109, s54, v109
    v_mul_f32 v110, s54, v110
    v_mul_f32 v111, s54, v111
    v_exp_f32 v104, v104
    v_exp_f32 v105, v105
    v_exp_f32 v106, v106
    v_exp_f32 v107, v107
    v_exp_f32 v108, v108
    v_exp_f32 v109, v109
    v_exp_f32 v110, v110
    v_exp_f32 v111, v111
    v_add_f32 v104, 1.0, v104
    v_add_f32 v105, 1.0, v105
    v_add_f32 v106, 1.0, v106
    v_add_f32 v107, 1.0, v107
    v_add_f32 v108, 1.0, v108
    v_add_f32 v109, 1.0, v109
    v_add_f32 v110, 1.0, v110
    v_add_f32 v111, 1.0, v111
    v_rcp_f32 v104, v104
    v_rcp_f32 v105, v105
    v_rcp_f32 v106, v106
    v_rcp_f32 v107, v107
    v_rcp_f32 v108, v108
    v_rcp_f32 v109, v109
    v_rcp_f32 v110, v110
    v_rcp_f32 v111, v111
    v_mul_f32 v104, v104, v184
    v_mul_f32 v105, v105, v185
    v_mul_f32 v106, v106, v186
    v_mul_f32 v107, v107, v187
    v_mul_f32 v108, v108, v188
    v_mul_f32 v109, v109, v189
    v_mul_f32 v110, v110, v190
    v_mul_f32 v111, v111, v191
    v_cvt_pk_bf16_f32 v92, v104, v105
    v_cvt_pk_bf16_f32 v93, v106, v107
    v_cvt_pk_bf16_f32 v94, v108, v109
    v_cvt_pk_bf16_f32 v95, v110, v111
    buffer_store_dwordx4 v[92:95], v1, s[4:7], s30 offen sc1
    s_add_u32 s30, s30, s50
    v_cvt_pk_bf16_f32 v80, v192, v193
    v_cvt_pk_bf16_f32 v81, v194, v195
    v_cvt_pk_bf16_f32 v82, v196, v197
    v_cvt_pk_bf16_f32 v83, v198, v199
    v_lshlrev_b32 v96, 16, v80
    v_and_b32 v97, 0xffff0000, v80
    v_lshlrev_b32 v98, 16, v81
    v_and_b32 v99, 0xffff0000, v81
    v_lshlrev_b32 v100, 16, v82
    v_and_b32 v101, 0xffff0000, v82
    v_lshlrev_b32 v102, 16, v83
    v_and_b32 v103, 0xffff0000, v83
    v_mul_f32 v96, s54, v96
    v_mul_f32 v97, s54, v97
    v_mul_f32 v98, s54, v98
    v_mul_f32 v99, s54, v99
    v_mul_f32 v100, s54, v100
    v_mul_f32 v101, s54, v101
    v_mul_f32 v102, s54, v102
    v_mul_f32 v103, s54, v103
    v_exp_f32 v96, v96
    v_exp_f32 v97, v97
    v_exp_f32 v98, v98
    v_exp_f32 v99, v99
    v_exp_f32 v100, v100
    v_exp_f32 v101, v101
    v_exp_f32 v102, v102
    v_exp_f32 v103, v103
    v_add_f32 v96, 1.0, v96
    v_add_f32 v97, 1.0, v97
    v_add_f32 v98, 1.0, v98
    v_add_f32 v99, 1.0, v99
    v_add_f32 v100, 1.0, v100
    v_add_f32 v101, 1.0, v101
    v_add_f32 v102, 1.0, v102
    v_add_f32 v103, 1.0, v103
    v_rcp_f32 v96, v96
    v_rcp_f32 v97, v97
    v_rcp_f32 v98, v98
    v_rcp_f32 v99, v99
    v_rcp_f32 v100, v100
    v_rcp_f32 v101, v101
    v_rcp_f32 v102, v102
    v_rcp_f32 v103, v103
    v_mul_f32 v96, v96, v200
    v_mul_f32 v97, v97, v201
    v_mul_f32 v98, v98, v202
    v_mul_f32 v99, v99, v203
    v_mul_f32 v100, v100, v204
    v_mul_f32 v101, v101, v205
    v_mul_f32 v102, v102, v206
    v_mul_f32 v103, v103, v207
    v_cvt_pk_bf16_f32 v80, v96, v97
    v_cvt_pk_bf16_f32 v81, v98, v99
    v_cvt_pk_bf16_f32 v82, v100, v101
    v_cvt_pk_bf16_f32 v83, v102, v103
    buffer_store_dwordx4 v[80:83], v1, s[4:7], s30 offen sc1
    s_add_u32 s30, s30, s50
    v_cvt_pk_bf16_f32 v84, v208, v209
    v_cvt_pk_bf16_f32 v85, v210, v211
    v_cvt_pk_bf16_f32 v86, v212, v213
    v_cvt_pk_bf16_f32 v87, v214, v215
    v_lshlrev_b32 v104, 16, v84
    v_and_b32 v105, 0xffff0000, v84
    v_lshlrev_b32 v106, 16, v85
    v_and_b32 v107, 0xffff0000, v85
    v_lshlrev_b32 v108, 16, v86
    v_and_b32 v109, 0xffff0000, v86
    v_lshlrev_b32 v110, 16, v87
    v_and_b32 v111, 0xffff0000, v87
    v_mul_f32 v104, s54, v104
    v_mul_f32 v105, s54, v105
    v_mul_f32 v106, s54, v106
    v_mul_f32 v107, s54, v107
    v_mul_f32 v108, s54, v108
    v_mul_f32 v109, s54, v109
    v_mul_f32 v110, s54, v110
    v_mul_f32 v111, s54, v111
    v_exp_f32 v104, v104
    v_exp_f32 v105, v105
    v_exp_f32 v106, v106
    v_exp_f32 v107, v107
    v_exp_f32 v108, v108
    v_exp_f32 v109, v109
    v_exp_f32 v110, v110
    v_exp_f32 v111, v111
    v_add_f32 v104, 1.0, v104
    v_add_f32 v105, 1.0, v105
    v_add_f32 v106, 1.0, v106
    v_add_f32 v107, 1.0, v107
    v_add_f32 v108, 1.0, v108
    v_add_f32 v109, 1.0, v109
    v_add_f32 v110, 1.0, v110
    v_add_f32 v111, 1.0, v111
    v_rcp_f32 v104, v104
    v_rcp_f32 v105, v105
    v_rcp_f32 v106, v106
    v_rcp_f32 v107, v107
    v_rcp_f32 v108, v108
    v_rcp_f32 v109, v109
    v_rcp_f32 v110, v110
    v_rcp_f32 v111, v111
    v_mul_f32 v104, v104, v216
    v_mul_f32 v105, v105, v217
    v_mul_f32 v106, v106, v218
    v_mul_f32 v107, v107, v219
    v_mul_f32 v108, v108, v220
    v_mul_f32 v109, v109, v221
    v_mul_f32 v110, v110, v222
    v_mul_f32 v111, v111, v223
    v_cvt_pk_bf16_f32 v84, v104, v105
    v_cvt_pk_bf16_f32 v85, v106, v107
    v_cvt_pk_bf16_f32 v86, v108, v109
    v_cvt_pk_bf16_f32 v87, v110, v111
    buffer_store_dwordx4 v[84:87], v1, s[4:7], s30 offen sc1
    s_add_u32 s30, s30, s50
    v_cvt_pk_bf16_f32 v88, v224, v225
    v_cvt_pk_bf16_f32 v89, v226, v227
    v_cvt_pk_bf16_f32 v90, v228, v229
    v_cvt_pk_bf16_f32 v91, v230, v231
    v_lshlrev_b32 v96, 16, v88
    v_and_b32 v97, 0xffff0000, v88
    v_lshlrev_b32 v98, 16, v89
    v_and_b32 v99, 0xffff0000, v89
    v_lshlrev_b32 v100, 16, v90
    v_and_b32 v101, 0xffff0000, v90
    v_lshlrev_b32 v102, 16, v91
    v_and_b32 v103, 0xffff0000, v91
    v_mul_f32 v96, s54, v96
    v_mul_f32 v97, s54, v97
    v_mul_f32 v98, s54, v98
    v_mul_f32 v99, s54, v99
    v_mul_f32 v100, s54, v100
    v_mul_f32 v101, s54, v101
    v_mul_f32 v102, s54, v102
    v_mul_f32 v103, s54, v103
    v_exp_f32 v96, v96
    v_exp_f32 v97, v97
    v_exp_f32 v98, v98
    v_exp_f32 v99, v99
    v_exp_f32 v100, v100
    v_exp_f32 v101, v101
    v_exp_f32 v102, v102
    v_exp_f32 v103, v103
    v_add_f32 v96, 1.0, v96
    v_add_f32 v97, 1.0, v97
    v_add_f32 v98, 1.0, v98
    v_add_f32 v99, 1.0, v99
    v_add_f32 v100, 1.0, v100
    v_add_f32 v101, 1.0, v101
    v_add_f32 v102, 1.0, v102
    v_add_f32 v103, 1.0, v103
    v_rcp_f32 v96, v96
    v_rcp_f32 v97, v97
    v_rcp_f32 v98, v98
    v_rcp_f32 v99, v99
    v_rcp_f32 v100, v100
    v_rcp_f32 v101, v101
    v_rcp_f32 v102, v102
    v_rcp_f32 v103, v103
    v_mul_f32 v96, v96, v232
    v_mul_f32 v97, v97, v233
    v_mul_f32 v98, v98, v234
    v_mul_f32 v99, v99, v235
    v_mul_f32 v100, v100, v236
    v_mul_f32 v101, v101, v237
    v_mul_f32 v102, v102, v238
    v_mul_f32 v103, v103, v239
    v_cvt_pk_bf16_f32 v88, v96, v97
    v_cvt_pk_bf16_f32 v89, v98, v99
    v_cvt_pk_bf16_f32 v90, v100, v101
    v_cvt_pk_bf16_f32 v91, v102, v103
    buffer_store_dwordx4 v[88:91], v1, s[4:7], s30 offen sc1
    s_add_u32 s30, s30, s50
    v_cvt_pk_bf16_f32 v92, v240, v241
    v_cvt_pk_bf16_f32 v93, v242, v243
    v_cvt_pk_bf16_f32 v94, v244, v245
    v_cvt_pk_bf16_f32 v95, v246, v247
    v_lshlrev_b32 v104, 16, v92
    v_and_b32 v105, 0xffff0000, v92
    v_lshlrev_b32 v106, 16, v93
    v_and_b32 v107, 0xffff0000, v93
    v_lshlrev_b32 v108, 16, v94
    v_and_b32 v109, 0xffff0000, v94
    v_lshlrev_b32 v110, 16, v95
    v_and_b32 v111, 0xffff0000, v95
    v_mul_f32 v104, s54, v104
    v_mul_f32 v105, s54, v105
    v_mul_f32 v106, s54, v106
    v_mul_f32 v107, s54, v107
    v_mul_f32 v108, s54, v108
    v_mul_f32 v109, s54, v109
    v_mul_f32 v110, s54, v110
    v_mul_f32 v111, s54, v111
    v_exp_f32 v104, v104
    v_exp_f32 v105, v105
    v_exp_f32 v106, v106
    v_exp_f32 v107, v107
    v_exp_f32 v108, v108
    v_exp_f32 v109, v109
    v_exp_f32 v110, v110
    v_exp_f32 v111, v111
    v_add_f32 v104, 1.0, v104
    v_add_f32 v105, 1.0, v105
    v_add_f32 v106, 1.0, v106
    v_add_f32 v107, 1.0, v107
    v_add_f32 v108, 1.0, v108
    v_add_f32 v109, 1.0, v109
    v_add_f32 v110, 1.0, v110
    v_add_f32 v111, 1.0, v111
    v_rcp_f32 v104, v104
    v_rcp_f32 v105, v105
    v_rcp_f32 v106, v106
    v_rcp_f32 v107, v107
    v_rcp_f32 v108, v108
    v_rcp_f32 v109, v109
    v_rcp_f32 v110, v110
    v_rcp_f32 v111, v111
    v_mul_f32 v104, v104, v248
    v_mul_f32 v105, v105, v249
    v_mul_f32 v106, v106, v250
    v_mul_f32 v107, v107, v251
    v_mul_f32 v108, v108, v252
    v_mul_f32 v109, v109, v253
    v_mul_f32 v110, v110, v254
    v_mul_f32 v111, v111, v255
    v_cvt_pk_bf16_f32 v92, v104, v105
    v_cvt_pk_bf16_f32 v93, v106, v107
    v_cvt_pk_bf16_f32 v94, v108, v109
    v_cvt_pk_bf16_f32 v95, v110, v111
    buffer_store_dwordx4 v[92:95], v1, s[4:7], s30 offen sc1
    s_waitcnt lgkmcnt(0)
    v_or3_b32 v24, v24, v25, v26
    v_or3_b32 v28, v28, v29, v30
    v_or3_b32 v24, v24, v27, v31
    v_or_b32 v24, v24, v28
    s_mov_b32 s28, s51
    s_mov_b32 s57, s53
    v_readfirstlane_b32 s30, v24
    s_cmp_lg_u32 s30, 0
    s_cbranch_scc1 w_drain
    s_mov_b32 s48, s32
    s_cmp_eq_u32 s32, 4
    s_cselect_b32 s30, 2, 3
    s_lshl_b32 s30, s26, s30
    s_mul_i32 s30, s30, s43
    s_add_u32 s49, s42, s30
    s_mov_b32 s50, s43
    s_mov_b32 s51, s46
    s_mov_b32 s23, s41
    s_mov_b32 s53, s47
    s_nop 0
    s_load_dwordx16 s[32:47], s[24:25], 0
    s_add_u32 s24, s24, 64
    s_addc_u32 s25, s25, 0
    s_branch w_first8
w_epi_silu:
    s_lshl_b32 s30, s27, 10
    s_add_u32 s30, s30, s49
    s_mov_b32 s54, 0xbfb8aa3b
    s_nop 7
    v_cvt_pk_bf16_f32 v80, v128, v129
    v_cvt_pk_bf16_f32 v81, v130, v131
    v_cvt_pk_bf16_f32 v82, v132, v133
    v_cvt_pk_bf16_f32 v83, v134, v135
    v_lshlrev_b32 v128, 16, v80
    v_and_b32 v129, 0xffff0000, v80
    v_lshlrev_b32 v130, 16, v81
    v_and_b32 v131, 0xffff0000, v81
    v_lshlrev_b32 v132, 16, v82
    v_and_b32 v133, 0xffff0000, v82
    v_lshlrev_b32 v134, 16, v83
    v_and_b32 v135, 0xffff0000, v83
    v_mul_f32 v104, s54, v128
    v_mul_f32 v105, s54, v129
    v_mul_f32 v106, s54, v130
    v_mul_f32 v107, s54, v131
    v_mul_f32 v108, s54, v132
    v_mul_f32 v109, s54, v133
    v_mul_f32 v110, s54, v134
    v_mul_f32 v111, s54, v135
    v_exp_f32 v104, v104
    v_exp_f32 v105, v105
    v_exp_f32 v106, v106
    v_exp_f32 v107, v107
    v_exp_f32 v108, v108
    v_exp_f32 v109, v109
    v_exp_f32 v110, v110
    v_exp_f32 v111, v111
    v_add_f32 v104, 1.0, v104
    v_add_f32 v105, 1.0, v105
    v_add_f32 v106, 1.0, v106
    v_add_f32 v107, 1.0, v107
    v_add_f32 v108, 1.0, v108
    v_add_f32 v109, 1.0, v109
    v_add_f32 v110, 1.0, v110
    v_add_f32 v111, 1.0, v111
    v_rcp_f32 v104, v104
    v_rcp_f32 v105, v105
    v_rcp_f32 v106, v106
    v_rcp_f32 v107, v107
    v_rcp_f32 v108, v108
    v_rcp_f32 v109, v109
    v_rcp_f32 v110, v110
    v_rcp_f32 v111, v111
    v_mul_f32 v128, v128, v104
    v_mul_f32 v129, v129, v105
    v_mul_f32 v130, v130, v106
    v_mul_f32 v131, v131, v107
    v_mul_f32 v132, v132, v108
    v_mul_f32 v133, v133, v109
    v_mul_f32 v134, v134, v110
    v_mul_f32 v135, v135, v111
    v_cvt_pk_bf16_f32 v80, v128, v129
    v_cvt_pk_bf16_f32 v81, v130, v131
    v_cvt_pk_bf16_f32 v82, v132, v133
    v_cvt_pk_bf16_f32 v83, v134, v135
    buffer_store_dwordx4 v[80:83], v1, s[4:7], s30 offen sc1
    v_cvt_pk_bf16_f32 v84, v136, v137
    v_cvt_pk_bf16_f32 v85, v138, v139
    v_cvt_pk_bf16_f32 v86, v140, v141
    v_cvt_pk_bf16_f32 v87, v142, v143
    v_lshlrev_b32 v136, 16, v84
    v_and_b32 v137, 0xffff0000, v84
    v_lshlrev_b32 v138, 16, v85
    v_and_b32 v139, 0xffff0000, v85
    v_lshlrev_b32 v140, 16, v86
    v_and_b32 v141, 0xffff0000, v86
    v_lshlrev_b32 v142, 16, v87
    v_and_b32 v143, 0xffff0000, v87
    v_mul_f32 v96, s54, v136
    v_mul_f32 v97, s54, v137
    v_mul_f32 v98, s54, v138
    v_mul_f32 v99, s54, v139
    v_mul_f32 v100, s54, v140
    v_mul_f32 v101, s54, v141
    v_mul_f32 v102, s54, v142
    v_mul_f32 v103, s54, v143
    v_exp_f32 v96, v96
    v_exp_f32 v97, v97
    v_exp_f32 v98, v98
    v_exp_f32 v99, v99
    v_exp_f32 v100, v100
    v_exp_f32 v101, v101
    v_exp_f32 v102, v102
    v_exp_f32 v103, v103
    v_add_f32 v96, 1.0, v96
    v_add_f32 v97, 1.0, v97
    v_add_f32 v98, 1.0, v98
    v_add_f32 v99, 1.0, v99
    v_add_f32 v100, 1.0, v100
    v_add_f32 v101, 1.0, v101
    v_add_f32 v102, 1.0, v102
    v_add_f32 v103, 1.0, v103
    v_rcp_f32 v96, v96
    v_rcp_f32 v97, v97
    v_rcp_f32 v98, v98
    v_rcp_f32 v99, v99
    v_rcp_f32 v100, v100
    v_rcp_f32 v101, v101
    v_rcp_f32 v102, v102
    v_rcp_f32 v103, v103
    v_mul_f32 v136, v136, v96
    v_mul_f32 v137, v137, v97
    v_mul_f32 v138, v138, v98
    v_mul_f32 v139, v139, v99
    v_mul_f32 v140, v140, v100
    v_mul_f32 v141, v141, v101
    v_mul_f32 v142, v142, v102
    v_mul_f32 v143, v143, v103
    v_cvt_pk_bf16_f32 v84, v136, v137
    v_cvt_pk_bf16_f32 v85, v138, v139
    v_cvt_pk_bf16_f32 v86, v140, v141
    v_cvt_pk_bf16_f32 v87, v142, v143
    buffer_store_dwordx4 v[84:87], v19, s[4:7], s30 offen sc1
    s_add_u32 s30, s30, s50
    v_cvt_pk_bf16_f32 v88, v144, v145
    v_cvt_pk_bf16_f32 v89, v146, v147
    v_cvt_pk_bf16_f32 v90, v148, v149
    v_cvt_pk_bf16_f32 v91, v150, v151
    v_lshlrev_b32 v144, 16, v88
    v_and_b32 v145, 0xffff0000, v88
    v_lshlrev_b32 v146, 16, v89
    v_and_b32 v147, 0xffff0000, v89
    v_lshlrev_b32 v148, 16, v90
    v_and_b32 v149, 0xffff0000, v90
    v_lshlrev_b32 v150, 16, v91
    v_and_b32 v151, 0xffff0000, v91
    v_mul_f32 v104, s54, v144
    v_mul_f32 v105, s54, v145
    v_mul_f32 v106, s54, v146
    v_mul_f32 v107, s54, v147
    v_mul_f32 v108, s54, v148
    v_mul_f32 v109, s54, v149
    v_mul_f32 v110, s54, v150
    v_mul_f32 v111, s54, v151
    v_exp_f32 v104, v104
    v_exp_f32 v105, v105
    v_exp_f32 v106, v106
    v_exp_f32 v107, v107
    v_exp_f32 v108, v108
    v_exp_f32 v109, v109
    v_exp_f32 v110, v110
    v_exp_f32 v111, v111
    v_add_f32 v104, 1.0, v104
    v_add_f32 v105, 1.0, v105
    v_add_f32 v106, 1.0, v106
    v_add_f32 v107, 1.0, v107
    v_add_f32 v108, 1.0, v108
    v_add_f32 v109, 1.0, v109
    v_add_f32 v110, 1.0, v110
    v_add_f32 v111, 1.0, v111
    v_rcp_f32 v104, v104
    v_rcp_f32 v105, v105
    v_rcp_f32 v106, v106
    v_rcp_f32 v107, v107
    v_rcp_f32 v108, v108
    v_rcp_f32 v109, v109
    v_rcp_f32 v110, v110
    v_rcp_f32 v111, v111
    v_mul_f32 v144, v144, v104
    v_mul_f32 v145, v145, v105
    v_mul_f32 v146, v146, v106
    v_mul_f32 v147, v147, v107
    v_mul_f32 v148, v148, v108
    v_mul_f32 v149, v149, v109
    v_mul_f32 v150, v150, v110
    v_mul_f32 v151, v151, v111
    v_cvt_pk_bf16_f32 v88, v144, v145
    v_cvt_pk_bf16_f32 v89, v146, v147
    v_cvt_pk_bf16_f32 v90, v148, v149
    v_cvt_pk_bf16_f32 v91, v150, v151
    buffer_store_dwordx4 v[88:91], v1, s[4:7], s30 offen sc1
    v_cvt_pk_bf16_f32 v92, v152, v153
    v_cvt_pk_bf16_f32 v93, v154, v155
    v_cvt_pk_bf16_f32 v94, v156, v157
    v_cvt_pk_bf16_f32 v95, v158, v159
    v_lshlrev_b32 v152, 16, v92
    v_and_b32 v153, 0xffff0000, v92
    v_lshlrev_b32 v154, 16, v93
    v_and_b32 v155, 0xffff0000, v93
    v_lshlrev_b32 v156, 16, v94
    v_and_b32 v157, 0xffff0000, v94
    v_lshlrev_b32 v158, 16, v95
    v_and_b32 v159, 0xffff0000, v95
    v_mul_f32 v96, s54, v152
    v_mul_f32 v97, s54, v153
    v_mul_f32 v98, s54, v154
    v_mul_f32 v99, s54, v155
    v_mul_f32 v100, s54, v156
    v_mul_f32 v101, s54, v157
    v_mul_f32 v102, s54, v158
    v_mul_f32 v103, s54, v159
    v_exp_f32 v96, v96
    v_exp_f32 v97, v97
    v_exp_f32 v98, v98
    v_exp_f32 v99, v99
    v_exp_f32 v100, v100
    v_exp_f32 v101, v101
    v_exp_f32 v102, v102
    v_exp_f32 v103, v103
    v_add_f32 v96, 1.0, v96
    v_add_f32 v97, 1.0, v97
    v_add_f32 v98, 1.0, v98
    v_add_f32 v99, 1.0, v99
    v_add_f32 v100, 1.0, v100
    v_add_f32 v101, 1.0, v101
    v_add_f32 v102, 1.0, v102
    v_add_f32 v103, 1.0, v103
    v_rcp_f32 v96, v96
    v_rcp_f32 v97, v97
    v_rcp_f32 v98, v98
    v_rcp_f32 v99, v99
    v_rcp_f32 v100, v100
    v_rcp_f32 v101, v101
    v_rcp_f32 v102, v102
    v_rcp_f32 v103, v103
    v_mul_f32 v152, v152, v96
    v_mul_f32 v153, v153, v97
    v_mul_f32 v154, v154, v98
    v_mul_f32 v155, v155, v99
    v_mul_f32 v156, v156, v100
    v_mul_f32 v157, v157, v101
    v_mul_f32 v158, v158, v102
    v_mul_f32 v159, v159, v103
    v_cvt_pk_bf16_f32 v92, v152, v153
    v_cvt_pk_bf16_f32 v93, v154, v155
    v_cvt_pk_bf16_f32 v94, v156, v157
    v_cvt_pk_bf16_f32 v95, v158, v159
    buffer_store_dwordx4 v[92:95], v19, s[4:7], s30 offen sc1
    s_add_u32 s30, s30, s50
    v_cvt_pk_bf16_f32 v80, v160, v161
    v_cvt_pk_bf16_f32 v81, v162, v163
    v_cvt_pk_bf16_f32 v82, v164, v165
    v_cvt_pk_bf16_f32 v83, v166, v167
    v_lshlrev_b32 v160, 16, v80
    v_and_b32 v161, 0xffff0000, v80
    v_lshlrev_b32 v162, 16, v81
    v_and_b32 v163, 0xffff0000, v81
    v_lshlrev_b32 v164, 16, v82
    v_and_b32 v165, 0xffff0000, v82
    v_lshlrev_b32 v166, 16, v83
    v_and_b32 v167, 0xffff0000, v83
    v_mul_f32 v104, s54, v160
    v_mul_f32 v105, s54, v161
    v_mul_f32 v106, s54, v162
    v_mul_f32 v107, s54, v163
    v_mul_f32 v108, s54, v164
    v_mul_f32 v109, s54, v165
    v_mul_f32 v110, s54, v166
    v_mul_f32 v111, s54, v167
    v_exp_f32 v104, v104
    v_exp_f32 v105, v105
    v_exp_f32 v106, v106
    v_exp_f32 v107, v107
    v_exp_f32 v108, v108
    v_exp_f32 v109, v109
    v_exp_f32 v110, v110
    v_exp_f32 v111, v111
    v_add_f32 v104, 1.0, v104
    v_add_f32 v105, 1.0, v105
    v_add_f32 v106, 1.0, v106
    v_add_f32 v107, 1.0, v107
    v_add_f32 v108, 1.0, v108
    v_add_f32 v109, 1.0, v109
    v_add_f32 v110, 1.0, v110
    v_add_f32 v111, 1.0, v111
    v_rcp_f32 v104, v104
    v_rcp_f32 v105, v105
    v_rcp_f32 v106, v106
    v_rcp_f32 v107, v107
    v_rcp_f32 v108, v108
    v_rcp_f32 v109, v109
    v_rcp_f32 v110, v110
    v_rcp_f32 v111, v111
    v_mul_f32 v160, v160, v104
    v_mul_f32 v161, v161, v105
    v_mul_f32 v162, v162, v106
    v_mul_f32 v163, v163, v107
    v_mul_f32 v164, v164, v108
    v_mul_f32 v165, v165, v109
    v_mul_f32 v166, v166, v110
    v_mul_f32 v167, v167, v111
    v_cvt_pk_bf16_f32 v80, v160, v161
    v_cvt_pk_bf16_f32 v81, v162, v163
    v_cvt_pk_bf16_f32 v82, v164, v165
    v_cvt_pk_bf16_f32 v83, v166, v167
    buffer_store_dwordx4 v[80:83], v1, s[4:7], s30 offen sc1
    v_cvt_pk_bf16_f32 v84, v168, v169
    v_cvt_pk_bf16_f32 v85, v170, v171
    v_cvt_pk_bf16_f32 v86, v172, v173
    v_cvt_pk_bf16_f32 v87, v174, v175
    v_lshlrev_b32 v168, 16, v84
    v_and_b32 v169, 0xffff0000, v84
    v_lshlrev_b32 v170, 16, v85
    v_and_b32 v171, 0xffff0000, v85
    v_lshlrev_b32 v172, 16, v86
    v_and_b32 v173, 0xffff0000, v86
    v_lshlrev_b32 v174, 16, v87
    v_and_b32 v175, 0xffff0000, v87
    v_mul_f32 v96, s54, v168
    v_mul_f32 v97, s54, v169
    v_mul_f32 v98, s54, v170
    v_mul_f32 v99, s54, v171
    v_mul_f32 v100, s54, v172
    v_mul_f32 v101, s54, v173
    v_mul_f32 v102, s54, v174
    v_mul_f32 v103, s54, v175
    v_exp_f32 v96, v96
    v_exp_f32 v97, v97
    v_exp_f32 v98, v98
    v_exp_f32 v99, v99
    v_exp_f32 v100, v100
    v_exp_f32 v101, v101
    v_exp_f32 v102, v102
    v_exp_f32 v103, v103
    v_add_f32 v96, 1.0, v96
    v_add_f32 v97, 1.0, v97
    v_add_f32 v98, 1.0, v98
    v_add_f32 v99, 1.0, v99
    v_add_f32 v100, 1.0, v100
    v_add_f32 v101, 1.0, v101
    v_add_f32 v102, 1.0, v102
    v_add_f32 v103, 1.0, v103
    v_rcp_f32 v96, v96
    v_rcp_f32 v97, v97
    v_rcp_f32 v98, v98
    v_rcp_f32 v99, v99
    v_rcp_f32 v100, v100
    v_rcp_f32 v101, v101
    v_rcp_f32 v102, v102
    v_rcp_f32 v103, v103
    v_mul_f32 v168, v168, v96
    v_mul_f32 v169, v169, v97
    v_mul_f32 v170, v170, v98
    v_mul_f32 v171, v171, v99
    v_mul_f32 v172, v172, v100
    v_mul_f32 v173, v173, v101
    v_mul_f32 v174, v174, v102
    v_mul_f32 v175, v175, v103
    v_cvt_pk_bf16_f32 v84, v168, v169
    v_cvt_pk_bf16_f32 v85, v170, v171
    v_cvt_pk_bf16_f32 v86, v172, v173
    v_cvt_pk_bf16_f32 v87, v174, v175
    buffer_store_dwordx4 v[84:87], v19, s[4:7], s30 offen sc1
    s_add_u32 s30, s30, s50
    v_cvt_pk_bf16_f32 v88, v176, v177
    v_cvt_pk_bf16_f32 v89, v178, v179
    v_cvt_pk_bf16_f32 v90, v180, v181
    v_cvt_pk_bf16_f32 v91, v182, v183
    v_lshlrev_b32 v176, 16, v88
    v_and_b32 v177, 0xffff0000, v88
    v_lshlrev_b32 v178, 16, v89
    v_and_b32 v179, 0xffff0000, v89
    v_lshlrev_b32 v180, 16, v90
    v_and_b32 v181, 0xffff0000, v90
    v_lshlrev_b32 v182, 16, v91
    v_and_b32 v183, 0xffff0000, v91
    v_mul_f32 v104, s54, v176
    v_mul_f32 v105, s54, v177
    v_mul_f32 v106, s54, v178
    v_mul_f32 v107, s54, v179
    v_mul_f32 v108, s54, v180
    v_mul_f32 v109, s54, v181
    v_mul_f32 v110, s54, v182
    v_mul_f32 v111, s54, v183
    v_exp_f32 v104, v104
    v_exp_f32 v105, v105
    v_exp_f32 v106, v106
    v_exp_f32 v107, v107
    v_exp_f32 v108, v108
    v_exp_f32 v109, v109
    v_exp_f32 v110, v110
    v_exp_f32 v111, v111
    v_add_f32 v104, 1.0, v104
    v_add_f32 v105, 1.0, v105
    v_add_f32 v106, 1.0, v106
    v_add_f32 v107, 1.0, v107
    v_add_f32 v108, 1.0, v108
    v_add_f32 v109, 1.0, v109
    v_add_f32 v110, 1.0, v110
    v_add_f32 v111, 1.0, v111
    v_rcp_f32 v104, v104
    v_rcp_f32 v105, v105
    v_rcp_f32 v106, v106
    v_rcp_f32 v107, v107
    v_rcp_f32 v108, v108
    v_rcp_f32 v109, v109
    v_rcp_f32 v110, v110
    v_rcp_f32 v111, v111
    v_mul_f32 v176, v176, v104
    v_mul_f32 v177, v177, v105
    v_mul_f32 v178, v178, v106
    v_mul_f32 v179, v179, v107
    v_mul_f32 v180, v180, v108
    v_mul_f32 v181, v181, v109
    v_mul_f32 v182, v182, v110
    v_mul_f32 v183, v183, v111
    v_cvt_pk_bf16_f32 v88, v176, v177
    v_cvt_pk_bf16_f32 v89, v178, v179
    v_cvt_pk_bf16_f32 v90, v180, v181
    v_cvt_pk_bf16_f32 v91, v182, v183
    buffer_store_dwordx4 v[88:91], v1, s[4:7], s30 offen sc1
    v_cvt_pk_bf16_f32 v92, v184, v185
    v_cvt_pk_bf16_f32 v93, v186, v187
    v_cvt_pk_bf16_f32 v94, v188, v189
    v_cvt_pk_bf16_f32 v95, v190, v191
    v_lshlrev_b32 v184, 16, v92
    v_and_b32 v185, 0xffff0000, v92
    v_lshlrev_b32 v186, 16, v93
    v_and_b32 v187, 0xffff0000, v93
    v_lshlrev_b32 v188, 16, v94
    v_and_b32 v189, 0xffff0000, v94
    v_lshlrev_b32 v190, 16, v95
    v_and_b32 v191, 0xffff0000, v95
    v_mul_f32 v96, s54, v184
    v_mul_f32 v97, s54, v185
    v_mul_f32 v98, s54, v186
    v_mul_f32 v99, s54, v187
    v_mul_f32 v100, s54, v188
    v_mul_f32 v101, s54, v189
    v_mul_f32 v102, s54, v190
    v_mul_f32 v103, s54, v191
    v_exp_f32 v96, v96
    v_exp_f32 v97, v97
    v_exp_f32 v98, v98
    v_exp_f32 v99, v99
    v_exp_f32 v100, v100
    v_exp_f32 v101, v101
    v_exp_f32 v102, v102
    v_exp_f32 v103, v103
    v_add_f32 v96, 1.0, v96
    v_add_f32 v97, 1.0, v97
    v_add_f32 v98, 1.0, v98
    v_add_f32 v99, 1.0, v99
    v_add_f32 v100, 1.0, v100
    v_add_f32 v101, 1.0, v101
    v_add_f32 v102, 1.0, v102
    v_add_f32 v103, 1.0, v103
    v_rcp_f32 v96, v96
    v_rcp_f32 v97, v97
    v_rcp_f32 v98, v98
    v_rcp_f32 v99, v99
    v_rcp_f32 v100, v100
    v_rcp_f32 v101, v101
    v_rcp_f32 v102, v102
    v_rcp_f32 v103, v103
    v_mul_f32 v184, v184, v96
    v_mul_f32 v185, v185, v97
    v_mul_f32 v186, v186, v98
    v_mul_f32 v187, v187, v99
    v_mul_f32 v188, v188, v100
    v_mul_f32 v189, v189, v101
    v_mul_f32 v190, v190, v102
    v_mul_f32 v191, v191, v103
    v_cvt_pk_bf16_f32 v92, v184, v185
    v_cvt_pk_bf16_f32 v93, v186, v187
    v_cvt_pk_bf16_f32 v94, v188, v189
    v_cvt_pk_bf16_f32 v95, v190, v191
    buffer_store_dwordx4 v[92:95], v19, s[4:7], s30 offen sc1
    s_add_u32 s30, s30, s50
    v_cvt_pk_bf16_f32 v80, v192, v193
    v_cvt_pk_bf16_f32 v81, v194, v195
    v_cvt_pk_bf16_f32 v82, v196, v197
    v_cvt_pk_bf16_f32 v83, v198, v199
    v_lshlrev_b32 v192, 16, v80
    v_and_b32 v193, 0xffff0000, v80
    v_lshlrev_b32 v194, 16, v81
    v_and_b32 v195, 0xffff0000, v81
    v_lshlrev_b32 v196, 16, v82
    v_and_b32 v197, 0xffff0000, v82
    v_lshlrev_b32 v198, 16, v83
    v_and_b32 v199, 0xffff0000, v83
    v_mul_f32 v104, s54, v192
    v_mul_f32 v105, s54, v193
    v_mul_f32 v106, s54, v194
    v_mul_f32 v107, s54, v195
    v_mul_f32 v108, s54, v196
    v_mul_f32 v109, s54, v197
    v_mul_f32 v110, s54, v198
    v_mul_f32 v111, s54, v199
    v_exp_f32 v104, v104
    v_exp_f32 v105, v105
    v_exp_f32 v106, v106
    v_exp_f32 v107, v107
    v_exp_f32 v108, v108
    v_exp_f32 v109, v109
    v_exp_f32 v110, v110
    v_exp_f32 v111, v111
    v_add_f32 v104, 1.0, v104
    v_add_f32 v105, 1.0, v105
    v_add_f32 v106, 1.0, v106
    v_add_f32 v107, 1.0, v107
    v_add_f32 v108, 1.0, v108
    v_add_f32 v109, 1.0, v109
    v_add_f32 v110, 1.0, v110
    v_add_f32 v111, 1.0, v111
    v_rcp_f32 v104, v104
    v_rcp_f32 v105, v105
    v_rcp_f32 v106, v106
    v_rcp_f32 v107, v107
    v_rcp_f32 v108, v108
    v_rcp_f32 v109, v109
    v_rcp_f32 v110, v110
    v_rcp_f32 v111, v111
    v_mul_f32 v192, v192, v104
    v_mul_f32 v193, v193, v105
    v_mul_f32 v194, v194, v106
    v_mul_f32 v195, v195, v107
    v_mul_f32 v196, v196, v108
    v_mul_f32 v197, v197, v109
    v_mul_f32 v198, v198, v110
    v_mul_f32 v199, v199, v111
    v_cvt_pk_bf16_f32 v80, v192, v193
    v_cvt_pk_bf16_f32 v81, v194, v195
    v_cvt_pk_bf16_f32 v82, v196, v197
    v_cvt_pk_bf16_f32 v83, v198, v199
    buffer_store_dwordx4 v[80:83], v1, s[4:7], s30 offen sc1
    v_cvt_pk_bf16_f32 v84, v200, v201
    v_cvt_pk_bf16_f32 v85, v202, v203
    v_cvt_pk_bf16_f32 v86, v204, v205
    v_cvt_pk_bf16_f32 v87, v206, v207
    v_lshlrev_b32 v200, 16, v84
    v_and_b32 v201, 0xffff0000, v84
    v_lshlrev_b32 v202, 16, v85
    v_and_b32 v203, 0xffff0000, v85
    v_lshlrev_b32 v204, 16, v86
    v_and_b32 v205, 0xffff0000, v86
    v_lshlrev_b32 v206, 16, v87
    v_and_b32 v207, 0xffff0000, v87
    v_mul_f32 v96, s54, v200
    v_mul_f32 v97, s54, v201
    v_mul_f32 v98, s54, v202
    v_mul_f32 v99, s54, v203
    v_mul_f32 v100, s54, v204
    v_mul_f32 v101, s54, v205
    v_mul_f32 v102, s54, v206
    v_mul_f32 v103, s54, v207
    v_exp_f32 v96, v96
    v_exp_f32 v97, v97
    v_exp_f32 v98, v98
    v_exp_f32 v99, v99
    v_exp_f32 v100, v100
    v_exp_f32 v101, v101
    v_exp_f32 v102, v102
    v_exp_f32 v103, v103
    v_add_f32 v96, 1.0, v96
    v_add_f32 v97, 1.0, v97
    v_add_f32 v98, 1.0, v98
    v_add_f32 v99, 1.0, v99
    v_add_f32 v100, 1.0, v100
    v_add_f32 v101, 1.0, v101
    v_add_f32 v102, 1.0, v102
    v_add_f32 v103, 1.0, v103
    v_rcp_f32 v96, v96
    v_rcp_f32 v97, v97
    v_rcp_f32 v98, v98
    v_rcp_f32 v99, v99
    v_rcp_f32 v100, v100
    v_rcp_f32 v101, v101
    v_rcp_f32 v102, v102
    v_rcp_f32 v103, v103
    v_mul_f32 v200, v200, v96
    v_mul_f32 v201, v201, v97
    v_mul_f32 v202, v202, v98
    v_mul_f32 v203, v203, v99
    v_mul_f32 v204, v204, v100
    v_mul_f32 v205, v205, v101
    v_mul_f32 v206, v206, v102
    v_mul_f32 v207, v207, v103
    v_cvt_pk_bf16_f32 v84, v200, v201
    v_cvt_pk_bf16_f32 v85, v202, v203
    v_cvt_pk_bf16_f32 v86, v204, v205
    v_cvt_pk_bf16_f32 v87, v206, v207
    buffer_store_dwordx4 v[84:87], v19, s[4:7], s30 offen sc1
    s_add_u32 s30, s30, s50
    v_cvt_pk_bf16_f32 v88, v208, v209
    v_cvt_pk_bf16_f32 v89, v210, v211
    v_cvt_pk_bf16_f32 v90, v212, v213
    v_cvt_pk_bf16_f32 v91, v214, v215
    v_lshlrev_b32 v208, 16, v88
    v_and_b32 v209, 0xffff0000, v88
    v_lshlrev_b32 v210, 16, v89
    v_and_b32 v211, 0xffff0000, v89
    v_lshlrev_b32 v212, 16, v90
    v_and_b32 v213, 0xffff0000, v90
    v_lshlrev_b32 v214, 16, v91
    v_and_b32 v215, 0xffff0000, v91
    v_mul_f32 v104, s54, v208
    v_mul_f32 v105, s54, v209
    v_mul_f32 v106, s54, v210
    v_mul_f32 v107, s54, v211
    v_mul_f32 v108, s54, v212
    v_mul_f32 v109, s54, v213
    v_mul_f32 v110, s54, v214
    v_mul_f32 v111, s54, v215
    v_exp_f32 v104, v104
    v_exp_f32 v105, v105
    v_exp_f32 v106, v106
    v_exp_f32 v107, v107
    v_exp_f32 v108, v108
    v_exp_f32 v109, v109
    v_exp_f32 v110, v110
    v_exp_f32 v111, v111
    v_add_f32 v104, 1.0, v104
    v_add_f32 v105, 1.0, v105
    v_add_f32 v106, 1.0, v106
    v_add_f32 v107, 1.0, v107
    v_add_f32 v108, 1.0, v108
    v_add_f32 v109, 1.0, v109
    v_add_f32 v110, 1.0, v110
    v_add_f32 v111, 1.0, v111
    v_rcp_f32 v104, v104
    v_rcp_f32 v105, v105
    v_rcp_f32 v106, v106
    v_rcp_f32 v107, v107
    v_rcp_f32 v108, v108
    v_rcp_f32 v109, v109
    v_rcp_f32 v110, v110
    v_rcp_f32 v111, v111
    v_mul_f32 v208, v208, v104
    v_mul_f32 v209, v209, v105
    v_mul_f32 v210, v210, v106
    v_mul_f32 v211, v211, v107
    v_mul_f32 v212, v212, v108
    v_mul_f32 v213, v213, v109
    v_mul_f32 v214, v214, v110
    v_mul_f32 v215, v215, v111
    v_cvt_pk_bf16_f32 v88, v208, v209
    v_cvt_pk_bf16_f32 v89, v210, v211
    v_cvt_pk_bf16_f32 v90, v212, v213
    v_cvt_pk_bf16_f32 v91, v214, v215
    buffer_store_dwordx4 v[88:91], v1, s[4:7], s30 offen sc1
    v_cvt_pk_bf16_f32 v92, v216, v217
    v_cvt_pk_bf16_f32 v93, v218, v219
    v_cvt_pk_bf16_f32 v94, v220, v221
    v_cvt_pk_bf16_f32 v95, v222, v223
    v_lshlrev_b32 v216, 16, v92
    v_and_b32 v217, 0xffff0000, v92
    v_lshlrev_b32 v218, 16, v93
    v_and_b32 v219, 0xffff0000, v93
    v_lshlrev_b32 v220, 16, v94
    v_and_b32 v221, 0xffff0000, v94
    v_lshlrev_b32 v222, 16, v95
    v_and_b32 v223, 0xffff0000, v95
    v_mul_f32 v96, s54, v216
    v_mul_f32 v97, s54, v217
    v_mul_f32 v98, s54, v218
    v_mul_f32 v99, s54, v219
    v_mul_f32 v100, s54, v220
    v_mul_f32 v101, s54, v221
    v_mul_f32 v102, s54, v222
    v_mul_f32 v103, s54, v223
    v_exp_f32 v96, v96
    v_exp_f32 v97, v97
    v_exp_f32 v98, v98
    v_exp_f32 v99, v99
    v_exp_f32 v100, v100
    v_exp_f32 v101, v101
    v_exp_f32 v102, v102
    v_exp_f32 v103, v103
    v_add_f32 v96, 1.0, v96
    v_add_f32 v97, 1.0, v97
    v_add_f32 v98, 1.0, v98
    v_add_f32 v99, 1.0, v99
    v_add_f32 v100, 1.0, v100
    v_add_f32 v101, 1.0, v101
    v_add_f32 v102, 1.0, v102
    v_add_f32 v103, 1.0, v103
    v_rcp_f32 v96, v96
    v_rcp_f32 v97, v97
    v_rcp_f32 v98, v98
    v_rcp_f32 v99, v99
    v_rcp_f32 v100, v100
    v_rcp_f32 v101, v101
    v_rcp_f32 v102, v102
    v_rcp_f32 v103, v103
    v_mul_f32 v216, v216, v96
    v_mul_f32 v217, v217, v97
    v_mul_f32 v218, v218, v98
    v_mul_f32 v219, v219, v99
    v_mul_f32 v220, v220, v100
    v_mul_f32 v221, v221, v101
    v_mul_f32 v222, v222, v102
    v_mul_f32 v223, v223, v103
    v_cvt_pk_bf16_f32 v92, v216, v217
    v_cvt_pk_bf16_f32 v93, v218, v219
    v_cvt_pk_bf16_f32 v94, v220, v221
    v_cvt_pk_bf16_f32 v95, v222, v223
    buffer_store_dwordx4 v[92:95], v19, s[4:7], s30 offen sc1
    s_add_u32 s30, s30, s50
    v_cvt_pk_bf16_f32 v80, v224, v225
    v_cvt_pk_bf16_f32 v81, v226, v227
    v_cvt_pk_bf16_f32 v82, v228, v229
    v_cvt_pk_bf16_f32 v83, v230, v231
    v_lshlrev_b32 v224, 16, v80
    v_and_b32 v225, 0xffff0000, v80
    v_lshlrev_b32 v226, 16, v81
    v_and_b32 v227, 0xffff0000, v81
    v_lshlrev_b32 v228, 16, v82
    v_and_b32 v229, 0xffff0000, v82
    v_lshlrev_b32 v230, 16, v83
    v_and_b32 v231, 0xffff0000, v83
    v_mul_f32 v104, s54, v224
    v_mul_f32 v105, s54, v225
    v_mul_f32 v106, s54, v226
    v_mul_f32 v107, s54, v227
    v_mul_f32 v108, s54, v228
    v_mul_f32 v109, s54, v229
    v_mul_f32 v110, s54, v230
    v_mul_f32 v111, s54, v231
    v_exp_f32 v104, v104
    v_exp_f32 v105, v105
    v_exp_f32 v106, v106
    v_exp_f32 v107, v107
    v_exp_f32 v108, v108
    v_exp_f32 v109, v109
    v_exp_f32 v110, v110
    v_exp_f32 v111, v111
    v_add_f32 v104, 1.0, v104
    v_add_f32 v105, 1.0, v105
    v_add_f32 v106, 1.0, v106
    v_add_f32 v107, 1.0, v107
    v_add_f32 v108, 1.0, v108
    v_add_f32 v109, 1.0, v109
    v_add_f32 v110, 1.0, v110
    v_add_f32 v111, 1.0, v111
    v_rcp_f32 v104, v104
    v_rcp_f32 v105, v105
    v_rcp_f32 v106, v106
    v_rcp_f32 v107, v107
    v_rcp_f32 v108, v108
    v_rcp_f32 v109, v109
    v_rcp_f32 v110, v110
    v_rcp_f32 v111, v111
    v_mul_f32 v224, v224, v104
    v_mul_f32 v225, v225, v105
    v_mul_f32 v226, v226, v106
    v_mul_f32 v227, v227, v107
    v_mul_f32 v228, v228, v108
    v_mul_f32 v229, v229, v109
    v_mul_f32 v230, v230, v110
    v_mul_f32 v231, v231, v111
    v_cvt_pk_bf16_f32 v80, v224, v225
    v_cvt_pk_bf16_f32 v81, v226, v227
    v_cvt_pk_bf16_f32 v82, v228, v229
    v_cvt_pk_bf16_f32 v83, v230, v231
    buffer_store_dwordx4 v[80:83], v1, s[4:7], s30 offen sc1
    v_cvt_pk_bf16_f32 v84, v232, v233
    v_cvt_pk_bf16_f32 v85, v234, v235
    v_cvt_pk_bf16_f32 v86, v236, v237
    v_cvt_pk_bf16_f32 v87, v238, v239
    v_lshlrev_b32 v232, 16, v84
    v_and_b32 v233, 0xffff0000, v84
    v_lshlrev_b32 v234, 16, v85
    v_and_b32 v235, 0xffff0000, v85
    v_lshlrev_b32 v236, 16, v86
    v_and_b32 v237, 0xffff0000, v86
    v_lshlrev_b32 v238, 16, v87
    v_and_b32 v239, 0xffff0000, v87
    v_mul_f32 v96, s54, v232
    v_mul_f32 v97, s54, v233
    v_mul_f32 v98, s54, v234
    v_mul_f32 v99, s54, v235
    v_mul_f32 v100, s54, v236
    v_mul_f32 v101, s54, v237
    v_mul_f32 v102, s54, v238
    v_mul_f32 v103, s54, v239
    v_exp_f32 v96, v96
    v_exp_f32 v97, v97
    v_exp_f32 v98, v98
    v_exp_f32 v99, v99
    v_exp_f32 v100, v100
    v_exp_f32 v101, v101
    v_exp_f32 v102, v102
    v_exp_f32 v103, v103
    v_add_f32 v96, 1.0, v96
    v_add_f32 v97, 1.0, v97
    v_add_f32 v98, 1.0, v98
    v_add_f32 v99, 1.0, v99
    v_add_f32 v100, 1.0, v100
    v_add_f32 v101, 1.0, v101
    v_add_f32 v102, 1.0, v102
    v_add_f32 v103, 1.0, v103
    v_rcp_f32 v96, v96
    v_rcp_f32 v97, v97
    v_rcp_f32 v98, v98
    v_rcp_f32 v99, v99
    v_rcp_f32 v100, v100
    v_rcp_f32 v101, v101
    v_rcp_f32 v102, v102
    v_rcp_f32 v103, v103
    v_mul_f32 v232, v232, v96
    v_mul_f32 v233, v233, v97
    v_mul_f32 v234, v234, v98
    v_mul_f32 v235, v235, v99
    v_mul_f32 v236, v236, v100
    v_mul_f32 v237, v237, v101
    v_mul_f32 v238, v238, v102
    v_mul_f32 v239, v239, v103
    v_cvt_pk_bf16_f32 v84, v232, v233
    v_cvt_pk_bf16_f32 v85, v234, v235
    v_cvt_pk_bf16_f32 v86, v236, v237
    v_cvt_pk_bf16_f32 v87, v238, v239
    buffer_store_dwordx4 v[84:87], v19, s[4:7], s30 offen sc1
    s_add_u32 s30, s30, s50
    v_cvt_pk_bf16_f32 v88, v240, v241
    v_cvt_pk_bf16_f32 v89, v242, v243
    v_cvt_pk_bf16_f32 v90, v244, v245
    v_cvt_pk_bf16_f32 v91, v246, v247
    v_lshlrev_b32 v240, 16, v88
    v_and_b32 v241, 0xffff0000, v88
    v_lshlrev_b32 v242, 16, v89
    v_and_b32 v243, 0xffff0000, v89
    v_lshlrev_b32 v244, 16, v90
    v_and_b32 v245, 0xffff0000, v90
    v_lshlrev_b32 v246, 16, v91
    v_and_b32 v247, 0xffff0000, v91
    v_mul_f32 v104, s54, v240
    v_mul_f32 v105, s54, v241
    v_mul_f32 v106, s54, v242
    v_mul_f32 v107, s54, v243
    v_mul_f32 v108, s54, v244
    v_mul_f32 v109, s54, v245
    v_mul_f32 v110, s54, v246
    v_mul_f32 v111, s54, v247
    v_exp_f32 v104, v104
    v_exp_f32 v105, v105
    v_exp_f32 v106, v106
    v_exp_f32 v107, v107
    v_exp_f32 v108, v108
    v_exp_f32 v109, v109
    v_exp_f32 v110, v110
    v_exp_f32 v111, v111
    v_add_f32 v104, 1.0, v104
    v_add_f32 v105, 1.0, v105
    v_add_f32 v106, 1.0, v106
    v_add_f32 v107, 1.0, v107
    v_add_f32 v108, 1.0, v108
    v_add_f32 v109, 1.0, v109
    v_add_f32 v110, 1.0, v110
    v_add_f32 v111, 1.0, v111
    v_rcp_f32 v104, v104
    v_rcp_f32 v105, v105
    v_rcp_f32 v106, v106
    v_rcp_f32 v107, v107
    v_rcp_f32 v108, v108
    v_rcp_f32 v109, v109
    v_rcp_f32 v110, v110
    v_rcp_f32 v111, v111
    v_mul_f32 v240, v240, v104
    v_mul_f32 v241, v241, v105
    v_mul_f32 v242, v242, v106
    v_mul_f32 v243, v243, v107
    v_mul_f32 v244, v244, v108
    v_mul_f32 v245, v245, v109
    v_mul_f32 v246, v246, v110
    v_mul_f32 v247, v247, v111
    v_cvt_pk_bf16_f32 v88, v240, v241
    v_cvt_pk_bf16_f32 v89, v242, v243
    v_cvt_pk_bf16_f32 v90, v244, v245
    v_cvt_pk_bf16_f32 v91, v246, v247
    buffer_store_dwordx4 v[88:91], v1, s[4:7], s30 offen sc1
    v_cvt_pk_bf16_f32 v92, v248, v249
    v_cvt_pk_bf16_f32 v93, v250, v251
    v_cvt_pk_bf16_f32 v94, v252, v253
    v_cvt_pk_bf16_f32 v95, v254, v255
    v_lshlrev_b32 v248, 16, v92
    v_and_b32 v249, 0xffff0000, v92
    v_lshlrev_b32 v250, 16, v93
    v_and_b32 v251, 0xffff0000, v93
    v_lshlrev_b32 v252, 16, v94
    v_and_b32 v253, 0xffff0000, v94
    v_lshlrev_b32 v254, 16, v95
    v_and_b32 v255, 0xffff0000, v95
    v_mul_f32 v96, s54, v248
    v_mul_f32 v97, s54, v249
    v_mul_f32 v98, s54, v250
    v_mul_f32 v99, s54, v251
    v_mul_f32 v100, s54, v252
    v_mul_f32 v101, s54, v253
    v_mul_f32 v102, s54, v254
    v_mul_f32 v103, s54, v255
    v_exp_f32 v96, v96
    v_exp_f32 v97, v97
    v_exp_f32 v98, v98
    v_exp_f32 v99, v99
    v_exp_f32 v100, v100
    v_exp_f32 v101, v101
    v_exp_f32 v102, v102
    v_exp_f32 v103, v103
    v_add_f32 v96, 1.0, v96
    v_add_f32 v97, 1.0, v97
    v_add_f32 v98, 1.0, v98
    v_add_f32 v99, 1.0, v99
    v_add_f32 v100, 1.0, v100
    v_add_f32 v101, 1.0, v101
    v_add_f32 v102, 1.0, v102
    v_add_f32 v103, 1.0, v103
    v_rcp_f32 v96, v96
    v_rcp_f32 v97, v97
    v_rcp_f32 v98, v98
    v_rcp_f32 v99, v99
    v_rcp_f32 v100, v100
    v_rcp_f32 v101, v101
    v_rcp_f32 v102, v102
    v_rcp_f32 v103, v103
    v_mul_f32 v248, v248, v96
    v_mul_f32 v249, v249, v97
    v_mul_f32 v250, v250, v98
    v_mul_f32 v251, v251, v99
    v_mul_f32 v252, v252, v100
    v_mul_f32 v253, v253, v101
    v_mul_f32 v254, v254, v102
    v_mul_f32 v255, v255, v103
    v_cvt_pk_bf16_f32 v92, v248, v249
    v_cvt_pk_bf16_f32 v93, v250, v251
    v_cvt_pk_bf16_f32 v94, v252, v253
    v_cvt_pk_bf16_f32 v95, v254, v255
    buffer_store_dwordx4 v[92:95], v19, s[4:7], s30 offen sc1
    s_waitcnt lgkmcnt(0)
    v_or3_b32 v24, v24, v25, v26
    v_or3_b32 v28, v28, v29, v30
    v_or3_b32 v24, v24, v27, v31
    v_or_b32 v24, v24, v28
    s_mov_b32 s28, s51
    s_mov_b32 s57, s53
    v_readfirstlane_b32 s30, v24
    s_cmp_lg_u32 s30, 0
    s_cbranch_scc1 w_drain
    s_mov_b32 s48, s32
    s_cmp_eq_u32 s32, 4
    s_cselect_b32 s30, 2, 3
    s_lshl_b32 s30, s26, s30
    s_mul_i32 s30, s30, s43
    s_add_u32 s49, s42, s30
    s_mov_b32 s50, s43
    s_mov_b32 s51, s46
    s_mov_b32 s23, s41
    s_mov_b32 s53, s47
    s_nop 0
    s_load_dwordx16 s[32:47], s[24:25], 0
    s_add_u32 s24, s24, 64
    s_addc_u32 s25, s25, 0
    s_branch w_first16
w_firstH:
    s_waitcnt vmcnt(8)
    s_barrier
    s_add_u32 m0, s21, 0
    s_nop 0
    buffer_load_dwordx4 v1, s[4:7], s16 offen sc1 lds
    s_add_u32 s16, s16, s62
    s_add_u32 m0, s21, 1024
    s_nop 0
    buffer_load_dwordx4 v1, s[4:7], s17 offen sc1 lds
    s_add_u32 s17, s17, s62
    s_add_u32 m0, s22, 0
    s_nop 0
    buffer_load_dwordx4 v2, s[8:11], s18 offen lds
    s_add_u32 s18, s18, s20
    s_add_u32 m0, s22, 8192
    s_nop 0
    buffer_load_dwordx4 v2, s[12:15], s19 offen lds
    s_add_u32 s19, s19, s20
    v_mfma_f32_16x16x32_bf16 v[128:131], v[64:67], v[32:35], 0
    ds_read_b64_tr_b16 v[112:113], v8 offset:49152
    v_mfma_f32_16x16x32_bf16 v[132:135], v[68:71], v[32:35], 0
    ds_read_b64_tr_b16 v[114:115], v9 offset:49152
    v_mfma_f32_16x16x32_bf16 v[144:147], v[64:67], v[40:43], 0
    ds_read_b64_tr_b16 v[116:117], v10 offset:49152
    v_mfma_f32_16x16x32_bf16 v[148:151], v[68:71], v[40:43], 0
    ds_read_b64_tr_b16 v[118:119], v11 offset:49152
    v_mfma_f32_16x16x32_bf16 v[160:163], v[64:67], v[48:51], 0
    ds_read_b64_tr_b16 v[120:121], v8 offset:57344
    v_mfma_f32_16x16x32_bf16 v[164:167], v[68:71], v[48:51], 0
    ds_read_b64_tr_b16 v[122:123], v9 offset:57344
    v_mfma_f32_16x16x32_bf16 v[176:179], v[64:67], v[56:59], 0
    ds_read_b64_tr_b16 v[124:125], v10 offset:57344
    v_mfma_f32_16x16x32_bf16 v[180:183], v[68:71], v[56:59], 0
    ds_read_b64_tr_b16 v[126:127], v11 offset:57344
    v_mfma_f32_16x16x32_bf16 v[128:131], v[72:75], v[36:39], v[128:131]
    ds_read_b128 v[80:83], v5 offset:32768
    v_mfma_f32_16x16x32_bf16 v[132:135], v[76:79], v[36:39], v[132:135]
    ds_read_b128 v[84:87], v5 offset:33792
    v_mfma_f32_16x16x32_bf16 v[144:147], v[72:75], v[44:47], v[144:147]
    ds_read_b128 v[88:91], v5 offset:34816
    v_mfma_f32_16x16x32_bf16 v[148:151], v[76:79], v[44:47], v[148:151]
    ds_read_b128 v[92:95], v5 offset:35840
    v_mfma_f32_16x16x32_bf16 v[160:163], v[72:75], v[52:55], v[160:163]
    ds_read_b128 v[96:99], v5 offset:36864
    v_mfma_f32_16x16x32_bf16 v[164:167], v[76:79], v[52:55], v[164:167]
    ds_read_b128 v[100:103], v5 offset:37888
    v_mfma_f32_16x16x32_bf16 v[176:179], v[72:75], v[60:63], v[176:179]
    ds_read_b128 v[104:107], v5 offset:38912
    v_mfma_f32_16x16x32_bf16 v[180:183], v[76:79], v[60:63], v[180:183]
    ds_read_b128 v[108:111], v5 offset:39936
    s_waitcnt lgkmcnt(0)
    s_waitcnt vmcnt(8)
    s_barrier
    s_add_u32 m0, s21, 32768
    s_nop 0
    buffer_load_dwordx4 v1, s[4:7], s16 offen sc1 lds
    s_add_u32 s16, s16, s62
    s_add_u32 m0, s21, 33792
    s_nop 0
    buffer_load_dwordx4 v1, s[4:7], s17 offen sc1 lds
    s_add_u32 s17, s17, s62
    s_add_u32 m0, s22, 32768
    s_nop 0
    buffer_load_dwordx4 v2, s[8:11], s18 offen lds
    s_add_u32 s18, s18, s20
    s_add_u32 m0, s22, 40960
    s_nop 0
    buffer_load_dwordx4 v2, s[12:15], s19 offen lds
    s_add_u32 s19, s19, s20
    v_mfma_f32_16x16x32_bf16 v[128:131], v[112:115], v[80:83], v[128:131]
    ds_read_b64_tr_b16 v[64:65], v12 offset:16384
    v_mfma_f32_16x16x32_bf16 v[132:135], v[116:119], v[80:83], v[132:135]
    ds_read_b64_tr_b16 v[66:67], v13 offset:16384
    v_mfma_f32_16x16x32_bf16 v[144:147], v[112:115], v[88:91], v[144:147]
    ds_read_b64_tr_b16 v[68:69], v14 offset:16384
    v_mfma_f32_16x16x32_bf16 v[148:151], v[116:119], v[88:91], v[148:151]
    ds_read_b64_tr_b16 v[70:71], v15 offset:16384
    v_mfma_f32_16x16x32_bf16 v[160:163], v[112:115], v[96:99], v[160:163]
    ds_read_b64_tr_b16 v[72:73], v12 offset:24576
    v_mfma_f32_16x16x32_bf16 v[164:167], v[116:119], v[96:99], v[164:167]
    ds_read_b64_tr_b16 v[74:75], v13 offset:24576
    v_mfma_f32_16x16x32_bf16 v[176:179], v[112:115], v[104:107], v[176:179]
    ds_read_b64_tr_b16 v[76:77], v14 offset:24576
    v_mfma_f32_16x16x32_bf16 v[180:183], v[116:119], v[104:107], v[180:183]
    ds_read_b64_tr_b16 v[78:79], v15 offset:24576
    v_mfma_f32_16x16x32_bf16 v[128:131], v[120:123], v[84:87], v[128:131]
    ds_read_b128 v[32:35], v6 offset:0
    v_mfma_f32_16x16x32_bf16 v[132:135], v[124:127], v[84:87], v[132:135]
    ds_read_b128 v[36:39], v6 offset:1024
    v_mfma_f32_16x16x32_bf16 v[144:147], v[120:123], v[92:95], v[144:147]
    ds_read_b128 v[40:43], v6 offset:2048
    v_mfma_f32_16x16x32_bf16 v[148:151], v[124:127], v[92:95], v[148:151]
    ds_read_b128 v[44:47], v6 offset:3072
    v_mfma_f32_16x16x32_bf16 v[160:163], v[120:123], v[100:103], v[160:163]
    ds_read_b128 v[48:51], v6 offset:4096
    v_mfma_f32_16x16x32_bf16 v[164:167], v[124:127], v[100:103], v[164:167]
    ds_read_b128 v[52:55], v6 offset:5120
    v_mfma_f32_16x16x32_bf16 v[176:179], v[120:123], v[108:111], v[176:179]
    ds_read_b128 v[56:59], v6 offset:6144
    v_mfma_f32_16x16x32_bf16 v[180:183], v[124:127], v[108:111], v[180:183]
    ds_read_b128 v[60:63], v6 offset:7168
    s_waitcnt lgkmcnt(0)
    s_waitcnt vmcnt(8)
    s_barrier
    s_add_u32 m0, s21, 65536
    s_nop 0
    buffer_load_dwordx4 v1, s[4:7], s16 offen sc1 lds
    s_add_u32 s16, s16, s62
    s_add_u32 m0, s21, 66560
    s_nop 0
    buffer_load_dwordx4 v1, s[4:7], s17 offen sc1 lds
    s_add_u32 s17, s17, s62
    s_add_u32 m0, s22, 65536
    s_nop 0
    buffer_load_dwordx4 v2, s[8:11], s18 offen lds
    s_add_u32 s18, s18, s20
    s_add_u32 m0, s22, 73728
    s_nop 0
    buffer_load_dwordx4 v2, s[12:15], s19 offen lds
    s_add_u32 s19, s19, s20
    v_mfma_f32_16x16x32_bf16 v[128:131], v[64:67], v[32:35], v[128:131]
    ds_read_b64_tr_b16 v[112:113], v12 offset:49152
    v_mfma_f32_16x16x32_bf16 v[132:135], v[68:71], v[32:35], v[132:135]
    ds_read_b64_tr_b16 v[114:115], v13 offset:49152
    v_mfma_f32_16x16x32_bf16 v[144:147], v[64:67], v[40:43], v[144:147]
    ds_read_b64_tr_b16 v[116:117], v14 offset:49152
    v_mfma_f32_16x16x32_bf16 v[148:151], v[68:71], v[40:43], v[148:151]
    ds_read_b64_tr_b16 v[118:119], v15 offset:49152
    v_mfma_f32_16x16x32_bf16 v[160:163], v[64:67], v[48:51], v[160:163]
    ds_read_b64_tr_b16 v[120:121], v12 offset:57344
    v_mfma_f32_16x16x32_bf16 v[164:167], v[68:71], v[48:51], v[164:167]
    ds_read_b64_tr_b16 v[122:123], v13 offset:57344
    v_mfma_f32_16x16x32_bf16 v[176:179], v[64:67], v[56:59], v[176:179]
    ds_read_b64_tr_b16 v[124:125], v14 offset:57344
    v_mfma_f32_16x16x32_bf16 v[180:183], v[68:71], v[56:59], v[180:183]
    ds_read_b64_tr_b16 v[126:127], v15 offset:57344
    v_mfma_f32_16x16x32_bf16 v[128:131], v[72:75], v[36:39], v[128:131]
    ds_read_b128 v[80:83], v6 offset:32768
    v_mfma_f32_16x16x32_bf16 v[132:135], v[76:79], v[36:39], v[132:135]
    ds_read_b128 v[84:87], v6 offset:33792
    v_mfma_f32_16x16x32_bf16 v[144:147], v[72:75], v[44:47], v[144:147]
    ds_read_b128 v[88:91], v6 offset:34816
    v_mfma_f32_16x16x32_bf16 v[148:151], v[76:79], v[44:47], v[148:151]
    ds_read_b128 v[92:95], v6 offset:35840
    v_mfma_f32_16x16x32_bf16 v[160:163], v[72:75], v[52:55], v[160:163]
    ds_read_b128 v[96:99], v6 offset:36864
    v_mfma_f32_16x16x32_bf16 v[164:167], v[76:79], v[52:55], v[164:167]
    ds_read_b128 v[100:103], v6 offset:37888
    v_mfma_f32_16x16x32_bf16 v[176:179], v[72:75], v[60:63], v[176:179]
    ds_read_b128 v[104:107], v6 offset:38912
    v_mfma_f32_16x16x32_bf16 v[180:183], v[76:79], v[60:63], v[180:183]
    ds_read_b128 v[108:111], v6 offset:39936
    s_waitcnt lgkmcnt(0)
    s_waitcnt vmcnt(8)
    s_barrier
    s_add_u32 m0, s21, 98304
    s_nop 0
    buffer_load_dwordx4 v1, s[4:7], s16 offen sc1 lds
    s_add_u32 s16, s16, s62
    s_add_u32 m0, s21, 99328
    s_nop 0
    buffer_load_dwordx4 v1, s[4:7], s17 offen sc1 lds
    s_add_u32 s17, s17, s62
    s_add_u32 m0, s22, 98304
    s_nop 0
    buffer_load_dwordx4 v2, s[8:11], s18 offen lds
    s_add_u32 s18, s18, s20
    s_add_u32 m0, s22, 106496
    s_nop 0
    buffer_load_dwordx4 v2, s[12:15], s19 offen lds
    s_add_u32 s19, s19, s20
    v_mfma_f32_16x16x32_bf16 v[128:131], v[112:115], v[80:83], v[128:131]
    ds_read_b64_tr_b16 v[64:65], v8 offset:16384
    v_mfma_f32_16x16x32_bf16 v[132:135], v[116:119], v[80:83], v[132:135]
    ds_read_b64_tr_b16 v[66:67], v9 offset:16384
    v_mfma_f32_16x16x32_bf16 v[144:147], v[112:115], v[88:91], v[144:147]
    ds_read_b64_tr_b16 v[68:69], v10 offset:16384
    v_mfma_f32_16x16x32_bf16 v[148:151], v[116:119], v[88:91], v[148:151]
    ds_read_b64_tr_b16 v[70:71], v11 offset:16384
    v_mfma_f32_16x16x32_bf16 v[160:163], v[112:115], v[96:99], v[160:163]
    ds_read_b64_tr_b16 v[72:73], v8 offset:24576
    v_mfma_f32_16x16x32_bf16 v[164:167], v[116:119], v[96:99], v[164:167]
    ds_read_b64_tr_b16 v[74:75], v9 offset:24576
    v_mfma_f32_16x16x32_bf16 v[176:179], v[112:115], v[104:107], v[176:179]
    ds_read_b64_tr_b16 v[76:77], v10 offset:24576
    v_mfma_f32_16x16x32_bf16 v[180:183], v[116:119], v[104:107], v[180:183]
    ds_read_b64_tr_b16 v[78:79], v11 offset:24576
    v_mfma_f32_16x16x32_bf16 v[128:131], v[120:123], v[84:87], v[128:131]
    ds_read_b128 v[32:35], v5 offset:0
    v_mfma_f32_16x16x32_bf16 v[132:135], v[124:127], v[84:87], v[132:135]
    ds_read_b128 v[36:39], v5 offset:1024
    v_mfma_f32_16x16x32_bf16 v[144:147], v[120:123], v[92:95], v[144:147]
    ds_read_b128 v[40:43], v5 offset:2048
    v_mfma_f32_16x16x32_bf16 v[148:151], v[124:127], v[92:95], v[148:151]
    ds_read_b128 v[44:47], v5 offset:3072
    v_mfma_f32_16x16x32_bf16 v[160:163], v[120:123], v[100:103], v[160:163]
    ds_read_b128 v[48:51], v5 offset:4096
    v_mfma_f32_16x16x32_bf16 v[164:167], v[124:127], v[100:103], v[164:167]
    ds_read_b128 v[52:55], v5 offset:5120
    v_mfma_f32_16x16x32_bf16 v[176:179], v[120:123], v[108:111], v[176:179]
    ds_read_b128 v[56:59], v5 offset:6144
    v_mfma_f32_16x16x32_bf16 v[180:183], v[124:127], v[108:111], v[180:183]
    ds_read_b128 v[60:63], v5 offset:7168
    s_waitcnt lgkmcnt(0)
w_loop_chkH:
    s_sub_u32 s23, s23, 1
w_loopH:
    s_cmp_lg_u32 s23, 1
    s_cbranch_scc1 w_bodyH
    buffer_load_dword v22, off, s[64:67], 0 sc1
    v_readfirstlane_b32 s30, v16
    s_cmp_ge_u32 s30, s45
    s_cselect_b32 s30, 0, 1
    s_or_b32 s30, s30, s70
    s_cmp_eq_u32 s32, 4
    s_cselect_b32 s30, 1, s30
    s_cmp_eq_u32 s32, 0
    s_cselect_b32 s30, 1, s30
    v_mov_b32 v20, s30
    ds_write_b32 v7, v20
    s_cbranch_scc1 w_bodyH
    s_load_dwordx2 s[8:9], s[0:1], s33
    s_load_dwordx2 s[12:13], s[0:1], s34
    s_mov_b32 s10, s38
    s_mov_b32 s14, s38
    s_cmp_eq_u32 s32, 4
    s_cselect_b32 s31, 0, 1
    s_lshl_b32 s30, s3, s31
    s_mul_i32 s30, s30, s40
    s_add_u32 s16, s39, s30
    s_cmp_eq_u32 s32, 4
    s_cselect_b32 s30, 1024, s40
    s_cselect_b32 s31, 6, 5
    s_lshl_b32 s62, 32, s31
    s_add_u32 s17, s16, s30
    s_lshl_b32 s30, s3, 2
    s_mul_i32 s30, s30, s35
    s_add_u32 s18, s36, s30
    s_add_u32 s19, s37, s30
    s_lshl_b32 s20, s35, s31
    v_mul_u32_u24 v2, s35, v4
    v_add_u32 v2, v2, v3
    s_waitcnt lgkmcnt(0)
w_bodyH:
    s_waitcnt vmcnt(8)
    s_barrier
    s_add_u32 m0, s21, 0
    s_nop 0
    buffer_load_dwordx4 v1, s[4:7], s16 offen sc1 lds
    s_add_u32 s16, s16, s62
    s_add_u32 m0, s21, 1024
    s_nop 0
    buffer_load_dwordx4 v1, s[4:7], s17 offen sc1 lds
    s_add_u32 s17, s17, s62
    s_add_u32 m0, s22, 0
    s_nop 0
    buffer_load_dwordx4 v2, s[8:11], s18 offen lds
    s_add_u32 s18, s18, s20
    s_add_u32 m0, s22, 8192
    s_nop 0
    buffer_load_dwordx4 v2, s[12:15], s19 offen lds
    s_add_u32 s19, s19, s20
    v_mfma_f32_16x16x32_bf16 v[128:131], v[64:67], v[32:35], v[128:131]
    ds_read_b64_tr_b16 v[112:113], v8 offset:49152
    v_mfma_f32_16x16x32_bf16 v[132:135], v[68:71], v[32:35], v[132:135]
    ds_read_b64_tr_b16 v[114:115], v9 offset:49152
    v_mfma_f32_16x16x32_bf16 v[144:147], v[64:67], v[40:43], v[144:147]
    ds_read_b64_tr_b16 v[116:117], v10 offset:49152
    v_mfma_f32_16x16x32_bf16 v[148:151], v[68:71], v[40:43], v[148:151]
    ds_read_b64_tr_b16 v[118:119], v11 offset:49152
    v_mfma_f32_16x16x32_bf16 v[160:163], v[64:67], v[48:51], v[160:163]
    ds_read_b64_tr_b16 v[120:121], v8 offset:57344
    v_mfma_f32_16x16x32_bf16 v[164:167], v[68:71], v[48:51], v[164:167]
    ds_read_b64_tr_b16 v[122:123], v9 offset:57344
    v_mfma_f32_16x16x32_bf16 v[176:179], v[64:67], v[56:59], v[176:179]
    ds_read_b64_tr_b16 v[124:125], v10 offset:57344
    v_mfma_f32_16x16x32_bf16 v[180:183], v[68:71], v[56:59], v[180:183]
    ds_read_b64_tr_b16 v[126:127], v11 offset:57344
    v_mfma_f32_16x16x32_bf16 v[128:131], v[72:75], v[36:39], v[128:131]
    ds_read_b128 v[80:83], v5 offset:32768
    v_mfma_f32_16x16x32_bf16 v[132:135], v[76:79], v[36:39], v[132:135]
    ds_read_b128 v[84:87], v5 offset:33792
    v_mfma_f32_16x16x32_bf16 v[144:147], v[72:75], v[44:47], v[144:147]
    ds_read_b128 v[88:91], v5 offset:34816
    v_mfma_f32_16x16x32_bf16 v[148:151], v[76:79], v[44:47], v[148:151]
    ds_read_b128 v[92:95], v5 offset:35840
    v_mfma_f32_16x16x32_bf16 v[160:163], v[72:75], v[52:55], v[160:163]
    ds_read_b128 v[96:99], v5 offset:36864
    v_mfma_f32_16x16x32_bf16 v[164:167], v[76:79], v[52:55], v[164:167]
    ds_read_b128 v[100:103], v5 offset:37888
    v_mfma_f32_16x16x32_bf16 v[176:179], v[72:75], v[60:63], v[176:179]
    ds_read_b128 v[104:107], v5 offset:38912
    v_mfma_f32_16x16x32_bf16 v[180:183], v[76:79], v[60:63], v[180:183]
    ds_read_b128 v[108:111], v5 offset:39936
    buffer_load_dword v16, v17, s[4:7], s44 offen sc1
    s_waitcnt lgkmcnt(0)
    s_waitcnt vmcnt(8)
    s_barrier
    s_add_u32 m0, s21, 32768
    s_nop 0
    buffer_load_dwordx4 v1, s[4:7], s16 offen sc1 lds
    s_add_u32 s16, s16, s62
    s_add_u32 m0, s21, 33792
    s_nop 0
    buffer_load_dwordx4 v1, s[4:7], s17 offen sc1 lds
    s_add_u32 s17, s17, s62
    s_add_u32 m0, s22, 32768
    s_nop 0
    buffer_load_dwordx4 v2, s[8:11], s18 offen lds
    s_add_u32 s18, s18, s20
    s_add_u32 m0, s22, 40960
    s_nop 0
    buffer_load_dwordx4 v2, s[12:15], s19 offen lds
    s_add_u32 s19, s19, s20
    v_mfma_f32_16x16x32_bf16 v[128:131], v[112:115], v[80:83], v[128:131]
    ds_read_b64_tr_b16 v[64:65], v12 offset:16384
    v_mfma_f32_16x16x32_bf16 v[132:135], v[116:119], v[80:83], v[132:135]
    ds_read_b64_tr_b16 v[66:67], v13 offset:16384
    v_mfma_f32_16x16x32_bf16 v[144:147], v[112:115], v[88:91], v[144:147]
    ds_read_b64_tr_b16 v[68:69], v14 offset:16384
    v_mfma_f32_16x16x32_bf16 v[148:151], v[116:119], v[88:91], v[148:151]
    ds_read_b64_tr_b16 v[70:71], v15 offset:16384
    v_mfma_f32_16x16x32_bf16 v[160:163], v[112:115], v[96:99], v[160:163]
    ds_read_b64_tr_b16 v[72:73], v12 offset:24576
    v_mfma_f32_16x16x32_bf16 v[164:167], v[116:119], v[96:99], v[164:167]
    ds_read_b64_tr_b16 v[74:75], v13 offset:24576
    v_mfma_f32_16x16x32_bf16 v[176:179], v[112:115], v[104:107], v[176:179]
    ds_read_b64_tr_b16 v[76:77], v14 offset:24576
    v_mfma_f32_16x16x32_bf16 v[180:183], v[116:119], v[104:107], v[180:183]
    ds_read_b64_tr_b16 v[78:79], v15 offset:24576
    v_mfma_f32_16x16x32_bf16 v[128:131], v[120:123], v[84:87], v[128:131]
    ds_read_b128 v[32:35], v6 offset:0
    v_mfma_f32_16x16x32_bf16 v[132:135], v[124:127], v[84:87], v[132:135]
    ds_read_b128 v[36:39], v6 offset:1024
    v_mfma_f32_16x16x32_bf16 v[144:147], v[120:123], v[92:95], v[144:147]
    ds_read_b128 v[40:43], v6 offset:2048
    v_mfma_f32_16x16x32_bf16 v[148:151], v[124:127], v[92:95], v[148:151]
    ds_read_b128 v[44:47], v6 offset:3072
    v_mfma_f32_16x16x32_bf16 v[160:163], v[120:123], v[100:103], v[160:163]
    ds_read_b128 v[48:51], v6 offset:4096
    v_mfma_f32_16x16x32_bf16 v[164:167], v[124:127], v[100:103], v[164:167]
    ds_read_b128 v[52:55], v6 offset:5120
    v_mfma_f32_16x16x32_bf16 v[176:179], v[120:123], v[108:111], v[176:179]
    ds_read_b128 v[56:59], v6 offset:6144
    v_mfma_f32_16x16x32_bf16 v[180:183], v[124:127], v[108:111], v[180:183]
    ds_read_b128 v[60:63], v6 offset:7168
    s_waitcnt lgkmcnt(0)
    s_waitcnt vmcnt(8)
    s_barrier
    s_add_u32 m0, s21, 65536
    s_nop 0
    buffer_load_dwordx4 v1, s[4:7], s16 offen sc1 lds
    s_add_u32 s16, s16, s62
    s_add_u32 m0, s21, 66560
    s_nop 0
    buffer_load_dwordx4 v1, s[4:7], s17 offen sc1 lds
    s_add_u32 s17, s17, s62
    s_add_u32 m0, s22, 65536
    s_nop 0
    buffer_load_dwordx4 v2, s[8:11], s18 offen lds
    s_add_u32 s18, s18, s20
    s_add_u32 m0, s22, 73728
    s_nop 0
    buffer_load_dwordx4 v2, s[12:15], s19 offen lds
    s_add_u32 s19, s19, s20
    v_mfma_f32_16x16x32_bf16 v[128:131], v[64:67], v[32:35], v[128:131]
    ds_read_b64_tr_b16 v[112:113], v12 offset:49152
    v_mfma_f32_16x16x32_bf16 v[132:135], v[68:71], v[32:35], v[132:135]
    ds_read_b64_tr_b16 v[114:115], v13 offset:49152
    v_mfma_f32_16x16x32_bf16 v[144:147], v[64:67], v[40:43], v[144:147]
    ds_read_b64_tr_b16 v[116:117], v14 offset:49152
    v_mfma_f32_16x16x32_bf16 v[148:151], v[68:71], v[40:43], v[148:151]
    ds_read_b64_tr_b16 v[118:119], v15 offset:49152
    v_mfma_f32_16x16x32_bf16 v[160:163], v[64:67], v[48:51], v[160:163]
    ds_read_b64_tr_b16 v[120:121], v12 offset:57344
    v_mfma_f32_16x16x32_bf16 v[164:167], v[68:71], v[48:51], v[164:167]
    ds_read_b64_tr_b16 v[122:123], v13 offset:57344
    v_mfma_f32_16x16x32_bf16 v[176:179], v[64:67], v[56:59], v[176:179]
    ds_read_b64_tr_b16 v[124:125], v14 offset:57344
    v_mfma_f32_16x16x32_bf16 v[180:183], v[68:71], v[56:59], v[180:183]
    ds_read_b64_tr_b16 v[126:127], v15 offset:57344
    v_mfma_f32_16x16x32_bf16 v[128:131], v[72:75], v[36:39], v[128:131]
    ds_read_b128 v[80:83], v6 offset:32768
    v_mfma_f32_16x16x32_bf16 v[132:135], v[76:79], v[36:39], v[132:135]
    ds_read_b128 v[84:87], v6 offset:33792
    v_mfma_f32_16x16x32_bf16 v[144:147], v[72:75], v[44:47], v[144:147]
    ds_read_b128 v[88:91], v6 offset:34816
    v_mfma_f32_16x16x32_bf16 v[148:151], v[76:79], v[44:47], v[148:151]
    ds_read_b128 v[92:95], v6 offset:35840
    v_mfma_f32_16x16x32_bf16 v[160:163], v[72:75], v[52:55], v[160:163]
    ds_read_b128 v[96:99], v6 offset:36864
    v_mfma_f32_16x16x32_bf16 v[164:167], v[76:79], v[52:55], v[164:167]
    ds_read_b128 v[100:103], v6 offset:37888
    v_mfma_f32_16x16x32_bf16 v[176:179], v[72:75], v[60:63], v[176:179]
    ds_read_b128 v[104:107], v6 offset:38912
    v_mfma_f32_16x16x32_bf16 v[180:183], v[76:79], v[60:63], v[180:183]
    ds_read_b128 v[108:111], v6 offset:39936
    s_waitcnt lgkmcnt(0)
    s_waitcnt vmcnt(8)
    s_barrier
    s_add_u32 m0, s21, 98304
    s_nop 0
    buffer_load_dwordx4 v1, s[4:7], s16 offen sc1 lds
    s_add_u32 s16, s16, s62
    s_add_u32 m0, s21, 99328
    s_nop 0
    buffer_load_dwordx4 v1, s[4:7], s17 offen sc1 lds
    s_add_u32 s17, s17, s62
    s_add_u32 m0, s22, 98304
    s_nop 0
    buffer_load_dwordx4 v2, s[8:11], s18 offen lds
    s_add_u32 s18, s18, s20
    s_add_u32 m0, s22, 106496
    s_nop 0
    buffer_load_dwordx4 v2, s[12:15], s19 offen lds
    s_add_u32 s19, s19, s20
    v_mfma_f32_16x16x32_bf16 v[128:131], v[112:115], v[80:83], v[128:131]
    ds_read_b64_tr_b16 v[64:65], v8 offset:16384
    v_mfma_f32_16x16x32_bf16 v[132:135], v[116:119], v[80:83], v[132:135]
    ds_read_b64_tr_b16 v[66:67], v9 offset:16384
    v_mfma_f32_16x16x32_bf16 v[144:147], v[112:115], v[88:91], v[144:147]
    ds_read_b64_tr_b16 v[68:69], v10 offset:16384
    v_mfma_f32_16x16x32_bf16 v[148:151], v[116:119], v[88:91], v[148:151]
    ds_read_b64_tr_b16 v[70:71], v11 offset:16384
    v_mfma_f32_16x16x32_bf16 v[160:163], v[112:115], v[96:99], v[160:163]
    ds_read_b64_tr_b16 v[72:73], v8 offset:24576
    v_mfma_f32_16x16x32_bf16 v[164:167], v[116:119], v[96:99], v[164:167]
    ds_read_b64_tr_b16 v[74:75], v9 offset:24576
    v_mfma_f32_16x16x32_bf16 v[176:179], v[112:115], v[104:107], v[176:179]
    ds_read_b64_tr_b16 v[76:77], v10 offset:24576
    v_mfma_f32_16x16x32_bf16 v[180:183], v[116:119], v[104:107], v[180:183]
    ds_read_b64_tr_b16 v[78:79], v11 offset:24576
    v_mfma_f32_16x16x32_bf16 v[128:131], v[120:123], v[84:87], v[128:131]
    ds_read_b128 v[32:35], v5 offset:0
    v_mfma_f32_16x16x32_bf16 v[132:135], v[124:127], v[84:87], v[132:135]
    ds_read_b128 v[36:39], v5 offset:1024
    v_mfma_f32_16x16x32_bf16 v[144:147], v[120:123], v[92:95], v[144:147]
    ds_read_b128 v[40:43], v5 offset:2048
    v_mfma_f32_16x16x32_bf16 v[148:151], v[124:127], v[92:95], v[148:151]
    ds_read_b128 v[44:47], v5 offset:3072
    v_mfma_f32_16x16x32_bf16 v[160:163], v[120:123], v[100:103], v[160:163]
    ds_read_b128 v[48:51], v5 offset:4096
    v_mfma_f32_16x16x32_bf16 v[164:167], v[124:127], v[100:103], v[164:167]
    ds_read_b128 v[52:55], v5 offset:5120
    v_mfma_f32_16x16x32_bf16 v[176:179], v[120:123], v[108:111], v[176:179]
    ds_read_b128 v[56:59], v5 offset:6144
    v_mfma_f32_16x16x32_bf16 v[180:183], v[124:127], v[108:111], v[180:183]
    ds_read_b128 v[60:63], v5 offset:7168
    s_waitcnt lgkmcnt(0)
    s_sub_u32 s23, s23, 1
    s_cmp_lg_u32 s23, 0
    s_cbranch_scc1 w_loopH
    v_mov_b32 v20, 131072
    ds_read_b128 v[24:27], v20
    ds_read_b128 v[28:31], v20 offset:16
    s_cmp_lg_u32 s53, s53
    s_cbranch_scc1 w_epi_siluH
    s_lshl_b32 s30, s27, 10
    s_add_u32 s30, s30, s49
    s_nop 7
    v_cvt_pk_bf16_f32 v80, v128, v129
    v_cvt_pk_bf16_f32 v81, v130, v131
    v_cvt_pk_bf16_f32 v82, v132, v133
    v_cvt_pk_bf16_f32 v83, v134, v135
    buffer_store_dwordx4 v[80:83], v1, s[4:7], s30 offen sc1
    s_add_u32 s30, s30, s50
    v_cvt_pk_bf16_f32 v84, v144, v145
    v_cvt_pk_bf16_f32 v85, v146, v147
    v_cvt_pk_bf16_f32 v86, v148, v149
    v_cvt_pk_bf16_f32 v87, v150, v151
    buffer_store_dwordx4 v[84:87], v1, s[4:7], s30 offen sc1
    s_add_u32 s30, s30, s50
    v_cvt_pk_bf16_f32 v88, v160, v161
    v_cvt_pk_bf16_f32 v89, v162, v163
    v_cvt_pk_bf16_f32 v90, v164, v165
    v_cvt_pk_bf16_f32 v91, v166, v167
    buffer_store_dwordx4 v[88:91], v1, s[4:7], s30 offen sc1
    s_add_u32 s30, s30, s50
    v_cvt_pk_bf16_f32 v92, v176, v177
    v_cvt_pk_bf16_f32 v93, v178, v179
    v_cvt_pk_bf16_f32 v94, v180, v181
    v_cvt_pk_bf16_f32 v95, v182, v183
    buffer_store_dwordx4 v[92:95], v1, s[4:7], s30 offen sc1
    s_add_u32 s30, s30, s50
    s_waitcnt lgkmcnt(0)
    v_or3_b32 v24, v24, v25, v26
    v_or3_b32 v28, v28, v29, v30
    v_or3_b32 v24, v24, v27, v31
    v_or_b32 v24, v24, v28
    s_mov_b32 s28, s51
    s_mov_b32 s57, s53
    v_readfirstlane_b32 s30, v24
    s_cmp_lg_u32 s30, 0
    s_cbranch_scc1 w_drain
    s_mov_b32 s48, s32
    s_cmp_eq_u32 s32, 4
    s_cselect_b32 s30, 2, 3
    s_lshl_b32 s30, s26, s30
    s_mul_i32 s30, s30, s43
    s_add_u32 s49, s42, s30
    s_mov_b32 s50, s43
    s_mov_b32 s51, s46
    s_mov_b32 s23, s41
    s_mov_b32 s53, s47
    s_nop 0
    s_load_dwordx16 s[32:47], s[24:25], 0
    s_add_u32 s24, s24, 64
    s_addc_u32 s25, s25, 0
    s_branch w_first4
w_epi_siluH:
    s_lshl_b32 s30, s27, 10
    s_add_u32 s30, s30, s49
    s_mov_b32 s54, 0xbfb8aa3b
    s_nop 7
    v_cvt_pk_bf16_f32 v80, v128, v129
    v_cvt_pk_bf16_f32 v81, v130, v131
    v_cvt_pk_bf16_f32 v82, v132, v133
    v_cvt_pk_bf16_f32 v83, v134, v135
    v_lshlrev_b32 v128, 16, v80
    v_and_b32 v129, 0xffff0000, v80
    v_lshlrev_b32 v130, 16, v81
    v_and_b32 v131, 0xffff0000, v81
    v_lshlrev_b32 v132, 16, v82
    v_and_b32 v133, 0xffff0000, v82
    v_lshlrev_b32 v134, 16, v83
    v_and_b32 v135, 0xffff0000, v83
    v_mul_f32 v104, s54, v128
    v_mul_f32 v105, s54, v129
    v_mul_f32 v106, s54, v130
    v_mul_f32 v107, s54, v131
    v_mul_f32 v108, s54, v132
    v_mul_f32 v109, s54, v133
    v_mul_f32 v110, s54, v134
    v_mul_f32 v111, s54, v135
    v_exp_f32 v104, v104
    v_exp_f32 v105, v105
    v_exp_f32 v106, v106
    v_exp_f32 v107, v107
    v_exp_f32 v108, v108
    v_exp_f32 v109, v109
    v_exp_f32 v110, v110
    v_exp_f32 v111, v111
    v_add_f32 v104, 1.0, v104
    v_add_f32 v105, 1.0, v105
    v_add_f32 v106, 1.0, v106
    v_add_f32 v107, 1.0, v107
    v_add_f32 v108, 1.0, v108
    v_add_f32 v109, 1.0, v109
    v_add_f32 v110, 1.0, v110
    v_add_f32 v111, 1.0, v111
    v_rcp_f32 v104, v104
    v_rcp_f32 v105, v105
    v_rcp_f32 v106, v106
    v_rcp_f32 v107, v107
    v_rcp_f32 v108, v108
    v_rcp_f32 v109, v109
    v_rcp_f32 v110, v110
    v_rcp_f32 v111, v111
    v_mul_f32 v128, v128, v104
    v_mul_f32 v129, v129, v105
    v_mul_f32 v130, v130, v106
    v_mul_f32 v131, v131, v107
    v_mul_f32 v132, v132, v108
    v_mul_f32 v133, v133, v109
    v_mul_f32 v134, v134, v110
    v_mul_f32 v135, v135, v111
    v_cvt_pk_bf16_f32 v80, v128, v129
    v_cvt_pk_bf16_f32 v81, v130, v131
    v_cvt_pk_bf16_f32 v82, v132, v133
    v_cvt_pk_bf16_f32 v83, v134, v135
    buffer_store_dwordx4 v[80:83], v1, s[4:7], s30 offen sc1
    s_add_u32 s30, s30, s50
    v_cvt_pk_bf16_f32 v84, v144, v145
    v_cvt_pk_bf16_f32 v85, v146, v147
    v_cvt_pk_bf16_f32 v86, v148, v149
    v_cvt_pk_bf16_f32 v87, v150, v151
    v_lshlrev_b32 v144, 16, v84
    v_and_b32 v145, 0xffff0000, v84
    v_lshlrev_b32 v146, 16, v85
    v_and_b32 v147, 0xffff0000, v85
    v_lshlrev_b32 v148, 16, v86
    v_and_b32 v149, 0xffff0000, v86
    v_lshlrev_b32 v150, 16, v87
    v_and_b32 v151, 0xffff0000, v87
    v_mul_f32 v96, s54, v144
    v_mul_f32 v97, s54, v145
    v_mul_f32 v98, s54, v146
    v_mul_f32 v99, s54, v147
    v_mul_f32 v100, s54, v148
    v_mul_f32 v101, s54, v149
    v_mul_f32 v102, s54, v150
    v_mul_f32 v103, s54, v151
    v_exp_f32 v96, v96
    v_exp_f32 v97, v97
    v_exp_f32 v98, v98
    v_exp_f32 v99, v99
    v_exp_f32 v100, v100
    v_exp_f32 v101, v101
    v_exp_f32 v102, v102
    v_exp_f32 v103, v103
    v_add_f32 v96, 1.0, v96
    v_add_f32 v97, 1.0, v97
    v_add_f32 v98, 1.0, v98
    v_add_f32 v99, 1.0, v99
    v_add_f32 v100, 1.0, v100
    v_add_f32 v101, 1.0, v101
    v_add_f32 v102, 1.0, v102
    v_add_f32 v103, 1.0, v103
    v_rcp_f32 v96, v96
    v_rcp_f32 v97, v97
    v_rcp_f32 v98, v98
    v_rcp_f32 v99, v99
    v_rcp_f32 v100, v100
    v_rcp_f32 v101, v101
    v_rcp_f32 v102, v102
    v_rcp_f32 v103, v103
    v_mul_f32 v144, v144, v96
    v_mul_f32 v145, v145, v97
    v_mul_f32 v146, v146, v98
    v_mul_f32 v147, v147, v99
    v_mul_f32 v148, v148, v100
    v_mul_f32 v149, v149, v101
    v_mul_f32 v150, v150, v102
    v_mul_f32 v151, v151, v103
    v_cvt_pk_bf16_f32 v84, v144, v145
    v_cvt_pk_bf16_f32 v85, v146, v147
    v_cvt_pk_bf16_f32 v86, v148, v149
    v_cvt_pk_bf16_f32 v87, v150, v151
    buffer_store_dwordx4 v[84:87], v1, s[4:7], s30 offen sc1
    s_add_u32 s30, s30, s50
    v_cvt_pk_bf16_f32 v88, v160, v161
    v_cvt_pk_bf16_f32 v89, v162, v163
    v_cvt_pk_bf16_f32 v90, v164, v165
    v_cvt_pk_bf16_f32 v91, v166, v167
    v_lshlrev_b32 v160, 16, v88
    v_and_b32 v161, 0xffff0000, v88
    v_lshlrev_b32 v162, 16, v89
    v_and_b32 v163, 0xffff0000, v89
    v_lshlrev_b32 v164, 16, v90
    v_and_b32 v165, 0xffff0000, v90
    v_lshlrev_b32 v166, 16, v91
    v_and_b32 v167, 0xffff0000, v91
    v_mul_f32 v104, s54, v160
    v_mul_f32 v105, s54, v161
    v_mul_f32 v106, s54, v162
    v_mul_f32 v107, s54, v163
    v_mul_f32 v108, s54, v164
    v_mul_f32 v109, s54, v165
    v_mul_f32 v110, s54, v166
    v_mul_f32 v111, s54, v167
    v_exp_f32 v104, v104
    v_exp_f32 v105, v105
    v_exp_f32 v106, v106
    v_exp_f32 v107, v107
    v_exp_f32 v108, v108
    v_exp_f32 v109, v109
    v_exp_f32 v110, v110
    v_exp_f32 v111, v111
    v_add_f32 v104, 1.0, v104
    v_add_f32 v105, 1.0, v105
    v_add_f32 v106, 1.0, v106
    v_add_f32 v107, 1.0, v107
    v_add_f32 v108, 1.0, v108
    v_add_f32 v109, 1.0, v109
    v_add_f32 v110, 1.0, v110
    v_add_f32 v111, 1.0, v111
    v_rcp_f32 v104, v104
    v_rcp_f32 v105, v105
    v_rcp_f32 v106, v106
    v_rcp_f32 v107, v107
    v_rcp_f32 v108, v108
    v_rcp_f32 v109, v109
    v_rcp_f32 v110, v110
    v_rcp_f32 v111, v111
    v_mul_f32 v160, v160, v104
    v_mul_f32 v161, v161, v105
    v_mul_f32 v162, v162, v106
    v_mul_f32 v163, v163, v107
    v_mul_f32 v164, v164, v108
    v_mul_f32 v165, v165, v109
    v_mul_f32 v166, v166, v110
    v_mul_f32 v167, v167, v111
    v_cvt_pk_bf16_f32 v88, v160, v161
    v_cvt_pk_bf16_f32 v89, v162, v163
    v_cvt_pk_bf16_f32 v90, v164, v165
    v_cvt_pk_bf16_f32 v91, v166, v167
    buffer_store_dwordx4 v[88:91], v1, s[4:7], s30 offen sc1
    s_add_u32 s30, s30, s50
    v_cvt_pk_bf16_f32 v92, v176, v177
    v_cvt_pk_bf16_f32 v93, v178, v179
    v_cvt_pk_bf16_f32 v94, v180, v181
    v_cvt_pk_bf16_f32 v95, v182, v183
    v_lshlrev_b32 v176, 16, v92
    v_and_b32 v177, 0xffff0000, v92
    v_lshlrev_b32 v178, 16, v93
    v_and_b32 v179, 0xffff0000, v93
    v_lshlrev_b32 v180, 16, v94
    v_and_b32 v181, 0xffff0000, v94
    v_lshlrev_b32 v182, 16, v95
    v_and_b32 v183, 0xffff0000, v95
    v_mul_f32 v96, s54, v176
    v_mul_f32 v97, s54, v177
    v_mul_f32 v98, s54, v178
    v_mul_f32 v99, s54, v179
    v_mul_f32 v100, s54, v180
    v_mul_f32 v101, s54, v181
    v_mul_f32 v102, s54, v182
    v_mul_f32 v103, s54, v183
    v_exp_f32 v96, v96
    v_exp_f32 v97, v97
    v_exp_f32 v98, v98
    v_exp_f32 v99, v99
    v_exp_f32 v100, v100
    v_exp_f32 v101, v101
    v_exp_f32 v102, v102
    v_exp_f32 v103, v103
    v_add_f32 v96, 1.0, v96
    v_add_f32 v97, 1.0, v97
    v_add_f32 v98, 1.0, v98
    v_add_f32 v99, 1.0, v99
    v_add_f32 v100, 1.0, v100
    v_add_f32 v101, 1.0, v101
    v_add_f32 v102, 1.0, v102
    v_add_f32 v103, 1.0, v103
    v_rcp_f32 v96, v96
    v_rcp_f32 v97, v97
    v_rcp_f32 v98, v98
    v_rcp_f32 v99, v99
    v_rcp_f32 v100, v100
    v_rcp_f32 v101, v101
    v_rcp_f32 v102, v102
    v_rcp_f32 v103, v103
    v_mul_f32 v176, v176, v96
    v_mul_f32 v177, v177, v97
    v_mul_f32 v178, v178, v98
    v_mul_f32 v179, v179, v99
    v_mul_f32 v180, v180, v100
    v_mul_f32 v181, v181, v101
    v_mul_f32 v182, v182, v102
    v_mul_f32 v183, v183, v103
    v_cvt_pk_bf16_f32 v92, v176, v177
    v_cvt_pk_bf16_f32 v93, v178, v179
    v_cvt_pk_bf16_f32 v94, v180, v181
    v_cvt_pk_bf16_f32 v95, v182, v183
    buffer_store_dwordx4 v[92:95], v1, s[4:7], s30 offen sc1
    s_add_u32 s30, s30, s50
    s_waitcnt lgkmcnt(0)
    v_or3_b32 v24, v24, v25, v26
    v_or3_b32 v28, v28, v29, v30
    v_or3_b32 v24, v24, v27, v31
    v_or_b32 v24, v24, v28
    s_mov_b32 s28, s51
    s_mov_b32 s57, s53
    v_readfirstlane_b32 s30, v24
    s_cmp_lg_u32 s30, 0
    s_cbranch_scc1 w_drain
    s_mov_b32 s48, s32
    s_cmp_eq_u32 s32, 4
    s_cselect_b32 s30, 2, 3
    s_lshl_b32 s30, s26, s30
    s_mul_i32 s30, s30, s43
    s_add_u32 s49, s42, s30
    s_mov_b32 s50, s43
    s_mov_b32 s51, s46
    s_mov_b32 s23, s41
    s_mov_b32 s53, s47
    s_nop 0
    s_load_dwordx16 s[32:47], s[24:25], 0
    s_add_u32 s24, s24, 64
    s_addc_u32 s25, s25, 0
    s_branch w_first4
w_drain:
    s_waitcnt vmcnt(0)
    s_barrier
    s_cmp_eq_u32 s70, 0
    s_cbranch_scc1 drw_ok
    s_mov_b32 s70, 0
    s_cmp_lg_u32 s3, 0
    s_cbranch_scc1 drw_ok
    v_readfirstlane_b32 s68, v22
    s_cmp_ge_u32 s68, 128
    s_cbranch_scc1 drw_ok
    s_mov_b32 s69, 65536
drw:
    buffer_load_dword v20, off, s[64:67], 0 offset:0 sc1
    s_waitcnt vmcnt(0)
    v_readfirstlane_b32 s68, v20
    s_cmp_ge_u32 s68, 128
    s_cbranch_scc1 drw_ok
    s_sleep 8
    s_sub_u32 s69, s69, 1
    s_cbranch_scc0 drw
drw_ok:
    s_cmp_eq_u32 s28, 0
    s_cbranch_scc1 sig_5
    s_cmp_lg_u32 s3, 0
    s_cbranch_scc1 sig_5
    s_mov_b64 exec, 1
    v_mov_b32 v18, s57
    buffer_atomic_add v18, v17, s[4:7], s28 offen sc1
    s_mov_b64 exec, -1
sig_5:
    s_mov_b32 s28, 0
    s_branch w_cold
fin_entry:
    s_load_dwordx2 s[8:9], s[0:1], 0
    s_load_dwordx2 s[12:13], s[0:1], 88
    v_mbcnt_lo_u32_b32 v1, -1, 0
    v_mbcnt_hi_u32_b32 v1, -1, v1
    s_mov_b32 s10, 4194304
    s_mov_b32 s11, 131072
    s_mov_b32 s14, 4194304
    s_mov_b32 s15, 131072
    v_lshlrev_b32 v3, 4, v1
    v_and_b32 v4, 15, v1
    v_lshrrev_b32 v5, 4, v1
    v_lshlrev_b32 v4, 11, v4
    v_lshl_add_u32 v4, v5, 4, v4
    v_and_b32 v5, 1, v5
    v_cmp_eq_u32 s[20:21], 1, v5
    v_and_b32 v6, 7, v1
    v_lshlrev_b32 v6, 7, v6
    s_lshr_b32 s24, s63, 2
    s_and_b32 s25, s63, 3
    s_lshl_b32 s25, s25, 2
    s_and_b32 s26, s3, 3
    s_add_u32 s25, s25, s26
    s_lshr_b32 s26, s3, 2
    s_mov_b32 s28, 65536
    s_waitcnt lgkmcnt(0)
fin_job:
    s_lshl_b32 s16, s24, 1
    s_add_u32 s16, s16, s26
    s_lshl_b32 s18, s16, 15
    s_lshl_b32 s17, s25, 11
    s_add_u32 s17, s17, s18
    s_lshl_b32 s19, s25, 7
    s_add_u32 s18, s18, s19
    s_add_u32 s22, s17, 167772160
    s_add_u32 s23, s17, 75497472
    s_lshr_b32 s27, s24, 3
    s_lshl_b32 s27, s27, 6
    s_add_u32 s27, s27, 218106368
    s_cmp_ge_u32 s24, 64
    s_cselect_b32 s29, 16, 16
    s_mov_b32 s30, 218112000
    s_add_u32 s32, s24, 1
    s_mov_b32 s33, 0
    s_mov_b32 s34, 255
    s_cmp_lt_u32 s24, 62
    s_cbranch_scc1 fin_tg
    s_mov_b32 s32, 16
    s_add_u32 s30, s30, 4
    s_sub_u32 s33, s24, 62
    s_lshl_b32 s33, s33, 3
fin_tg:
    buffer_load_dwordx4 v[88:91], v4, s[8:11], s18 offen offset:0
    buffer_load_dwordx4 v[92:95], v4, s[8:11], s18 offen offset:64
    s_cmp_lg_u32 s3, 0
    s_cbranch_scc1 fin_ws_ok
fin_wd:
    buffer_load_dword v7, off, s[4:7], s27 sc1
    s_waitcnt vmcnt(0)
    v_readfirstlane_b32 s31, v7
    s_cmp_ge_u32 s31, s29
    s_cbranch_scc1 fin_wd_ok
    s_sleep 127
    s_sub_u32 s28, s28, 1
    s_cbranch_scc0 fin_wd
    s_mov_b32 s28, 0
fin_wd_ok:
fin_ws:
    buffer_load_dword v7, v6, s[4:7], s30 offen sc1
    s_waitcnt vmcnt(0)
    v_lshrrev_b32 v7, s33, v7
    v_and_b32 v7, s34, v7
    v_cmp_gt_u32 vcc, s32, v7
    s_cbranch_vccz fin_ws_ok
    s_sleep 12
    s_cmp_ge_u32 s24, 61
    s_cbranch_scc1 fin_ws_f
    s_sleep 48
    s_cmp_ge_u32 s24, 57
    s_cbranch_scc1 fin_ws_f
    s_sleep 127
    s_sleep 127
fin_ws_f:
    s_sub_u32 s28, s28, 1
    s_cbranch_scc0 fin_ws
    s_mov_b32 s28, 0
fin_ws_ok:
    s_barrier
    buffer_load_dwordx4 v[144:147], v3, s[4:7], s22 offen offset:0 sc1
    buffer_load_dwordx4 v[160:163], v3, s[4:7], s22 offen offset:1024 sc1
    s_add_u32 s22, s22, 4194304
    buffer_load_dwordx4 v[148:151], v3, s[4:7], s22 offen offset:0 sc1
    buffer_load_dwordx4 v[164:167], v3, s[4:7], s22 offen offset:1024 sc1
    s_add_u32 s22, s22, 4194304
    buffer_load_dwordx4 v[152:155], v3, s[4:7], s22 offen offset:0 sc1
    buffer_load_dwordx4 v[168:171], v3, s[4:7], s22 offen offset:1024 sc1
    s_add_u32 s22, s22, 4194304
    buffer_load_dwordx4 v[156:159], v3, s[4:7], s22 offen offset:0 sc1
    buffer_load_dwordx4 v[172:175], v3, s[4:7], s22 offen offset:1024 sc1
    buffer_load_dwordx4 v[16:19], v3, s[4:7], s23 offen offset:0 sc1
    buffer_load_dwordx4 v[48:51], v3, s[4:7], s23 offen offset:1024 sc1
    s_add_u32 s23, s23, 4194304
    buffer_load_dwordx4 v[20:23], v3, s[4:7], s23 offen offset:0 sc1
    buffer_load_dwordx4 v[52:55], v3, s[4:7], s23 offen offset:1024 sc1
    s_add_u32 s23, s23, 4194304
    buffer_load_dwordx4 v[24:27], v3, s[4:7], s23 offen offset:0 sc1
    buffer_load_dwordx4 v[56:59], v3, s[4:7], s23 offen offset:1024 sc1
    s_add_u32 s23, s23, 4194304
    buffer_load_dwordx4 v[28:31], v3, s[4:7], s23 offen offset:0 sc1
    buffer_load_dwordx4 v[60:63], v3, s[4:7], s23 offen offset:1024 sc1
    s_add_u32 s23, s23, 4194304
    buffer_load_dwordx4 v[32:35], v3, s[4:7], s23 offen offset:0 sc1
    buffer_load_dwordx4 v[64:67], v3, s[4:7], s23 offen offset:1024 sc1
    s_add_u32 s23, s23, 4194304
    buffer_load_dwordx4 v[36:39], v3, s[4:7], s23 offen offset:0 sc1
    buffer_load_dwordx4 v[68:71], v3, s[4:7], s23 offen offset:1024 sc1
    s_add_u32 s23, s23, 4194304
    buffer_load_dwordx4 v[40:43], v3, s[4:7], s23 offen offset:0 sc1
    buffer_load_dwordx4 v[72:75], v3, s[4:7], s23 offen offset:1024 sc1
    s_add_u32 s23, s23, 4194304
    buffer_load_dwordx4 v[44:47], v3, s[4:7], s23 offen offset:0 sc1
    buffer_load_dwordx4 v[76:79], v3, s[4:7], s23 offen offset:1024 sc1
    s_add_u32 s23, s23, 4194304
    s_waitcnt vmcnt(16)
    v_lshlrev_b32 v96, 16, v144
    v_and_b32 v97, 0xffff0000, v144
    v_lshlrev_b32 v98, 16, v145
    v_and_b32 v99, 0xffff0000, v145
    v_lshlrev_b32 v100, 16, v146
    v_and_b32 v101, 0xffff0000, v146
    v_lshlrev_b32 v102, 16, v147
    v_and_b32 v103, 0xffff0000, v147
    v_lshlrev_b32 v120, 16, v148
    v_and_b32 v121, 0xffff0000, v148
    v_lshlrev_b32 v122, 16, v149
    v_and_b32 v123, 0xffff0000, v149
    v_lshlrev_b32 v124, 16, v150
    v_and_b32 v125, 0xffff0000, v150
    v_lshlrev_b32 v126, 16, v151
    v_and_b32 v127, 0xffff0000, v151
    v_add_f32 v96, v96, v120
    v_add_f32 v97, v97, v121
    v_add_f32 v98, v98, v122
    v_add_f32 v99, v99, v123
    v_add_f32 v100, v100, v124
    v_add_f32 v101, v101, v125
    v_add_f32 v102, v102, v126
    v_add_f32 v103, v103, v127
    v_lshlrev_b32 v120, 16, v152
    v_and_b32 v121, 0xffff0000, v152
    v_lshlrev_b32 v122, 16, v153
    v_and_b32 v123, 0xffff0000, v153
    v_lshlrev_b32 v124, 16, v154
    v_and_b32 v125, 0xffff0000, v154
    v_lshlrev_b32 v126, 16, v155
    v_and_b32 v127, 0xffff0000, v155
    v_add_f32 v96, v96, v120
    v_add_f32 v97, v97, v121
    v_add_f32 v98, v98, v122
    v_add_f32 v99, v99, v123
    v_add_f32 v100, v100, v124
    v_add_f32 v101, v101, v125
    v_add_f32 v102, v102, v126
    v_add_f32 v103, v103, v127
    v_lshlrev_b32 v120, 16, v156
    v_and_b32 v121, 0xffff0000, v156
    v_lshlrev_b32 v122, 16, v157
    v_and_b32 v123, 0xffff0000, v157
    v_lshlrev_b32 v124, 16, v158
    v_and_b32 v125, 0xffff0000, v158
    v_lshlrev_b32 v126, 16, v159
    v_and_b32 v127, 0xffff0000, v159
    v_add_f32 v96, v96, v120
    v_add_f32 v97, v97, v121
    v_add_f32 v98, v98, v122
    v_add_f32 v99, v99, v123
    v_add_f32 v100, v100, v124
    v_add_f32 v101, v101, v125
    v_add_f32 v102, v102, v126
    v_add_f32 v103, v103, v127
    v_cvt_pk_bf16_f32 v120, v96, v97
    v_cvt_pk_bf16_f32 v121, v98, v99
    v_cvt_pk_bf16_f32 v122, v100, v101
    v_cvt_pk_bf16_f32 v123, v102, v103
    v_lshlrev_b32 v96, 16, v120
    v_and_b32 v97, 0xffff0000, v120
    v_lshlrev_b32 v98, 16, v121
    v_and_b32 v99, 0xffff0000, v121
    v_lshlrev_b32 v100, 16, v122
    v_and_b32 v101, 0xffff0000, v122
    v_lshlrev_b32 v102, 16, v123
    v_and_b32 v103, 0xffff0000, v123
    v_mul_f32 v104, 0xbfb8aa3b, v96
    v_mul_f32 v105, 0xbfb8aa3b, v97
    v_mul_f32 v106, 0xbfb8aa3b, v98
    v_mul_f32 v107, 0xbfb8aa3b, v99
    v_mul_f32 v108, 0xbfb8aa3b, v100
    v_mul_f32 v109, 0xbfb8aa3b, v101
    v_mul_f32 v110, 0xbfb8aa3b, v102
    v_mul_f32 v111, 0xbfb8aa3b, v103
    v_exp_f32 v104, v104
    v_exp_f32 v105, v105
    v_exp_f32 v106, v106
    v_exp_f32 v107, v107
    v_exp_f32 v108, v108
    v_exp_f32 v109, v109
    v_exp_f32 v110, v110
    v_exp_f32 v111, v111
    v_add_f32 v104, 1.0, v104
    v_add_f32 v105, 1.0, v105
    v_add_f32 v106, 1.0, v106
    v_add_f32 v107, 1.0, v107
    v_add_f32 v108, 1.0, v108
    v_add_f32 v109, 1.0, v109
    v_add_f32 v110, 1.0, v110
    v_add_f32 v111, 1.0, v111
    v_rcp_f32 v104, v104
    v_rcp_f32 v105, v105
    v_rcp_f32 v106, v106
    v_rcp_f32 v107, v107
    v_rcp_f32 v108, v108
    v_rcp_f32 v109, v109
    v_rcp_f32 v110, v110
    v_rcp_f32 v111, v111
    v_mul_f32 v96, v96, v104
    v_mul_f32 v97, v97, v105
    v_mul_f32 v98, v98, v106
    v_mul_f32 v99, v99, v107
    v_mul_f32 v100, v100, v108
    v_mul_f32 v101, v101, v109
    v_mul_f32 v102, v102, v110
    v_mul_f32 v103, v103, v111
    v_cvt_pk_bf16_f32 v80, v96, v97
    v_cvt_pk_bf16_f32 v81, v98, v99
    v_cvt_pk_bf16_f32 v82, v100, v101
    v_cvt_pk_bf16_f32 v83, v102, v103
    v_lshlrev_b32 v96, 16, v160
    v_and_b32 v97, 0xffff0000, v160
    v_lshlrev_b32 v98, 16, v161
    v_and_b32 v99, 0xffff0000, v161
    v_lshlrev_b32 v100, 16, v162
    v_and_b32 v101, 0xffff0000, v162
    v_lshlrev_b32 v102, 16, v163
    v_and_b32 v103, 0xffff0000, v163
    v_lshlrev_b32 v120, 16, v164
    v_and_b32 v121, 0xffff0000, v164
    v_lshlrev_b32 v122, 16, v165
    v_and_b32 v123, 0xffff0000, v165
    v_lshlrev_b32 v124, 16, v166
    v_and_b32 v125, 0xffff0000, v166
    v_lshlrev_b32 v126, 16, v167
    v_and_b32 v127, 0xffff0000, v167
    v_add_f32 v96, v96, v120
    v_add_f32 v97, v97, v121
    v_add_f32 v98, v98, v122
    v_add_f32 v99, v99, v123
    v_add_f32 v100, v100, v124
    v_add_f32 v101, v101, v125
    v_add_f32 v102, v102, v126
    v_add_f32 v103, v103, v127
    v_lshlrev_b32 v120, 16, v168
    v_and_b32 v121, 0xffff0000, v168
    v_lshlrev_b32 v122, 16, v169
    v_and_b32 v123, 0xffff0000, v169
    v_lshlrev_b32 v124, 16, v170
    v_and_b32 v125, 0xffff0000, v170
    v_lshlrev_b32 v126, 16, v171
    v_and_b32 v127, 0xffff0000, v171
    v_add_f32 v96, v96, v120
    v_add_f32 v97, v97, v121
    v_add_f32 v98, v98, v122
    v_add_f32 v99, v99, v123
    v_add_f32 v100, v100, v124
    v_add_f32 v101, v101, v125
    v_add_f32 v102, v102, v126
    v_add_f32 v103, v103, v127
    v_lshlrev_b32 v120, 16, v172
    v_and_b32 v121, 0xffff0000, v172
    v_lshlrev_b32 v122, 16, v173
    v_and_b32 v123, 0xffff0000, v173
    v_lshlrev_b32 v124, 16, v174
    v_and_b32 v125, 0xffff0000, v174
    v_lshlrev_b32 v126, 16, v175
    v_and_b32 v127, 0xffff0000, v175
    v_add_f32 v96, v96, v120
    v_add_f32 v97, v97, v121
    v_add_f32 v98, v98, v122
    v_add_f32 v99, v99, v123
    v_add_f32 v100, v100, v124
    v_add_f32 v101, v101, v125
    v_add_f32 v102, v102, v126
    v_add_f32 v103, v103, v127
    v_cvt_pk_bf16_f32 v120, v96, v97
    v_cvt_pk_bf16_f32 v121, v98, v99
    v_cvt_pk_bf16_f32 v122, v100, v101
    v_cvt_pk_bf16_f32 v123, v102, v103
    v_lshlrev_b32 v96, 16, v120
    v_and_b32 v97, 0xffff0000, v120
    v_lshlrev_b32 v98, 16, v121
    v_and_b32 v99, 0xffff0000, v121
    v_lshlrev_b32 v100, 16, v122
    v_and_b32 v101, 0xffff0000, v122
    v_lshlrev_b32 v102, 16, v123
    v_and_b32 v103, 0xffff0000, v123
    v_mul_f32 v104, 0xbfb8aa3b, v96
    v_mul_f32 v105, 0xbfb8aa3b, v97
    v_mul_f32 v106, 0xbfb8aa3b, v98
    v_mul_f32 v107, 0xbfb8aa3b, v99
    v_mul_f32 v108, 0xbfb8aa3b, v100
    v_mul_f32 v109, 0xbfb8aa3b, v101
    v_mul_f32 v110, 0xbfb8aa3b, v102
    v_mul_f32 v111, 0xbfb8aa3b, v103
    v_exp_f32 v104, v104
    v_exp_f32 v105, v105
    v_exp_f32 v106, v106
    v_exp_f32 v107, v107
    v_exp_f32 v108, v108
    v_exp_f32 v109, v109
    v_exp_f32 v110, v110
    v_exp_f32 v111, v111
    v_add_f32 v104, 1.0, v104
    v_add_f32 v105, 1.0, v105
    v_add_f32 v106, 1.0, v106
    v_add_f32 v107, 1.0, v107
    v_add_f32 v108, 1.0, v108
    v_add_f32 v109, 1.0, v109
    v_add_f32 v110, 1.0, v110
    v_add_f32 v111, 1.0, v111
    v_rcp_f32 v104, v104
    v_rcp_f32 v105, v105
    v_rcp_f32 v106, v106
    v_rcp_f32 v107, v107
    v_rcp_f32 v108, v108
    v_rcp_f32 v109, v109
    v_rcp_f32 v110, v110
    v_rcp_f32 v111, v111
    v_mul_f32 v96, v96, v104
    v_mul_f32 v97, v97, v105
    v_mul_f32 v98, v98, v106
    v_mul_f32 v99, v99, v107
    v_mul_f32 v100, v100, v108
    v_mul_f32 v101, v101, v109
    v_mul_f32 v102, v102, v110
    v_mul_f32 v103, v103, v111
    v_cvt_pk_bf16_f32 v84, v96, v97
    v_cvt_pk_bf16_f32 v85, v98, v99
    v_cvt_pk_bf16_f32 v86, v100, v101
    v_cvt_pk_bf16_f32 v87, v102, v103
    s_waitcnt vmcnt(0)
    v_lshlrev_b32 v96, 16, v16
    v_and_b32 v97, 0xffff0000, v16
    v_lshlrev_b32 v98, 16, v17
    v_and_b32 v99, 0xffff0000, v17
    v_lshlrev_b32 v100, 16, v18
    v_and_b32 v101, 0xffff0000, v18
    v_lshlrev_b32 v102, 16, v19
    v_and_b32 v103, 0xffff0000, v19
    v_lshlrev_b32 v120, 16, v20
    v_and_b32 v121, 0xffff0000, v20
    v_lshlrev_b32 v122, 16, v21
    v_and_b32 v123, 0xffff0000, v21
    v_lshlrev_b32 v124, 16, v22
    v_and_b32 v125, 0xffff0000, v22
    v_lshlrev_b32 v126, 16, v23
    v_and_b32 v127, 0xffff0000, v23
    v_add_f32 v96, v96, v120
    v_add_f32 v97, v97, v121
    v_add_f32 v98, v98, v122
    v_add_f32 v99, v99, v123
    v_add_f32 v100, v100, v124
    v_add_f32 v101, v101, v125
    v_add_f32 v102, v102, v126
    v_add_f32 v103, v103, v127
    v_lshlrev_b32 v120, 16, v24
    v_and_b32 v121, 0xffff0000, v24
    v_lshlrev_b32 v122, 16, v25
    v_and_b32 v123, 0xffff0000, v25
    v_lshlrev_b32 v124, 16, v26
    v_and_b32 v125, 0xffff0000, v26
    v_lshlrev_b32 v126, 16, v27
    v_and_b32 v127, 0xffff0000, v27
    v_add_f32 v96, v96, v120
    v_add_f32 v97, v97, v121
    v_add_f32 v98, v98, v122
    v_add_f32 v99, v99, v123
    v_add_f32 v100, v100, v124
    v_add_f32 v101, v101, v125
    v_add_f32 v102, v102, v126
    v_add_f32 v103, v103, v127
    v_lshlrev_b32 v120, 16, v28
    v_and_b32 v121, 0xffff0000, v28
    v_lshlrev_b32 v122, 16, v29
    v_and_b32 v123, 0xffff0000, v29
    v_lshlrev_b32 v124, 16, v30
    v_and_b32 v125, 0xffff0000, v30
    v_lshlrev_b32 v126, 16, v31
    v_and_b32 v127, 0xffff0000, v31
    v_add_f32 v96, v96, v120
    v_add_f32 v97, v97, v121
    v_add_f32 v98, v98, v122
    v_add_f32 v99, v99, v123
    v_add_f32 v100, v100, v124
    v_add_f32 v101, v101, v125
    v_add_f32 v102, v102, v126
    v_add_f32 v103, v103, v127
    v_lshlrev_b32 v120, 16, v32
    v_and_b32 v121, 0xffff0000, v32
    v_lshlrev_b32 v122, 16, v33
    v_and_b32 v123, 0xffff0000, v33
    v_lshlrev_b32 v124, 16, v34
    v_and_b32 v125, 0xffff0000, v34
    v_lshlrev_b32 v126, 16, v35
    v_and_b32 v127, 0xffff0000, v35
    v_add_f32 v96, v96, v120
    v_add_f32 v97, v97, v121
    v_add_f32 v98, v98, v122
    v_add_f32 v99, v99, v123
    v_add_f32 v100, v100, v124
    v_add_f32 v101, v101, v125
    v_add_f32 v102, v102, v126
    v_add_f32 v103, v103, v127
    v_lshlrev_b32 v120, 16, v36
    v_and_b32 v121, 0xffff0000, v36
    v_lshlrev_b32 v122, 16, v37
    v_and_b32 v123, 0xffff0000, v37
    v_lshlrev_b32 v124, 16, v38
    v_and_b32 v125, 0xffff0000, v38
    v_lshlrev_b32 v126, 16, v39
    v_and_b32 v127, 0xffff0000, v39
    v_add_f32 v96, v96, v120
    v_add_f32 v97, v97, v121
    v_add_f32 v98, v98, v122
    v_add_f32 v99, v99, v123
    v_add_f32 v100, v100, v124
    v_add_f32 v101, v101, v125
    v_add_f32 v102, v102, v126
    v_add_f32 v103, v103, v127
    v_lshlrev_b32 v120, 16, v40
    v_and_b32 v121, 0xffff0000, v40
    v_lshlrev_b32 v122, 16, v41
    v_and_b32 v123, 0xffff0000, v41
    v_lshlrev_b32 v124, 16, v42
    v_and_b32 v125, 0xffff0000, v42
    v_lshlrev_b32 v126, 16, v43
    v_and_b32 v127, 0xffff0000, v43
    v_add_f32 v96, v96, v120
    v_add_f32 v97, v97, v121
    v_add_f32 v98, v98, v122
    v_add_f32 v99, v99, v123
    v_add_f32 v100, v100, v124
    v_add_f32 v101, v101, v125
    v_add_f32 v102, v102, v126
    v_add_f32 v103, v103, v127
    v_lshlrev_b32 v120, 16, v44
    v_and_b32 v121, 0xffff0000, v44
    v_lshlrev_b32 v122, 16, v45
    v_and_b32 v123, 0xffff0000, v45
    v_lshlrev_b32 v124, 16, v46
    v_and_b32 v125, 0xffff0000, v46
    v_lshlrev_b32 v126, 16, v47
    v_and_b32 v127, 0xffff0000, v47
    v_add_f32 v96, v96, v120
    v_add_f32 v97, v97, v121
    v_add_f32 v98, v98, v122
    v_add_f32 v99, v99, v123
    v_add_f32 v100, v100, v124
    v_add_f32 v101, v101, v125
    v_add_f32 v102, v102, v126
    v_add_f32 v103, v103, v127
    v_cndmask_b32 v108, v88, v90, s[20:21]
    v_cndmask_b32 v109, v89, v91, s[20:21]
    v_cndmask_b32 v110, v90, v88, s[20:21]
    v_cndmask_b32 v111, v91, v89, s[20:21]
    v_cvt_pk_bf16_f32 v104, v96, v97
    v_lshlrev_b32 v96, 16, v104
    v_and_b32 v97, 0xffff0000, v104
    v_lshlrev_b32 v104, 16, v80
    v_and_b32 v105, 0xffff0000, v80
    v_mul_f32 v96, v96, v104
    v_mul_f32 v97, v97, v105
    v_cvt_pk_bf16_f32 v104, v96, v97
    v_lshlrev_b32 v96, 16, v104
    v_and_b32 v97, 0xffff0000, v104
    v_lshlrev_b32 v104, 16, v108
    v_and_b32 v105, 0xffff0000, v108
    v_add_f32 v96, v96, v104
    v_add_f32 v97, v97, v105
    v_cvt_pk_bf16_f32 v112, v96, v97
    v_cvt_pk_bf16_f32 v104, v98, v99
    v_lshlrev_b32 v98, 16, v104
    v_and_b32 v99, 0xffff0000, v104
    v_lshlrev_b32 v104, 16, v81
    v_and_b32 v105, 0xffff0000, v81
    v_mul_f32 v98, v98, v104
    v_mul_f32 v99, v99, v105
    v_cvt_pk_bf16_f32 v104, v98, v99
    v_lshlrev_b32 v98, 16, v104
    v_and_b32 v99, 0xffff0000, v104
    v_lshlrev_b32 v104, 16, v109
    v_and_b32 v105, 0xffff0000, v109
    v_add_f32 v98, v98, v104
    v_add_f32 v99, v99, v105
    v_cvt_pk_bf16_f32 v113, v98, v99
    v_cvt_pk_bf16_f32 v104, v100, v101
    v_lshlrev_b32 v100, 16, v104
    v_and_b32 v101, 0xffff0000, v104
    v_lshlrev_b32 v104, 16, v82
    v_and_b32 v105, 0xffff0000, v82
    v_mul_f32 v100, v100, v104
    v_mul_f32 v101, v101, v105
    v_cvt_pk_bf16_f32 v104, v100, v101
    v_lshlrev_b32 v100, 16, v104
    v_and_b32 v101, 0xffff0000, v104
    v_lshlrev_b32 v104, 16, v110
    v_and_b32 v105, 0xffff0000, v110
    v_add_f32 v100, v100, v104
    v_add_f32 v101, v101, v105
    v_cvt_pk_bf16_f32 v114, v100, v101
    v_cvt_pk_bf16_f32 v104, v102, v103
    v_lshlrev_b32 v102, 16, v104
    v_and_b32 v103, 0xffff0000, v104
    v_lshlrev_b32 v104, 16, v83
    v_and_b32 v105, 0xffff0000, v83
    v_mul_f32 v102, v102, v104
    v_mul_f32 v103, v103, v105
    v_cvt_pk_bf16_f32 v104, v102, v103
    v_lshlrev_b32 v102, 16, v104
    v_and_b32 v103, 0xffff0000, v104
    v_lshlrev_b32 v104, 16, v111
    v_and_b32 v105, 0xffff0000, v111
    v_add_f32 v102, v102, v104
    v_add_f32 v103, v103, v105
    v_cvt_pk_bf16_f32 v115, v102, v103
    v_cndmask_b32 v128, v112, v114, s[20:21]
    v_cndmask_b32 v129, v113, v115, s[20:21]
    v_cndmask_b32 v130, v114, v112, s[20:21]
    v_cndmask_b32 v131, v115, v113, s[20:21]
    buffer_store_dwordx4 v[128:131], v4, s[12:15], s18 offen offset:0
    v_lshlrev_b32 v96, 16, v48
    v_and_b32 v97, 0xffff0000, v48
    v_lshlrev_b32 v98, 16, v49
    v_and_b32 v99, 0xffff0000, v49
    v_lshlrev_b32 v100, 16, v50
    v_and_b32 v101, 0xffff0000, v50
    v_lshlrev_b32 v102, 16, v51
    v_and_b32 v103, 0xffff0000, v51
    v_lshlrev_b32 v120, 16, v52
    v_and_b32 v121, 0xffff0000, v52
    v_lshlrev_b32 v122, 16, v53
    v_and_b32 v123, 0xffff0000, v53
    v_lshlrev_b32 v124, 16, v54
    v_and_b32 v125, 0xffff0000, v54
    v_lshlrev_b32 v126, 16, v55
    v_and_b32 v127, 0xffff0000, v55
    v_add_f32 v96, v96, v120
    v_add_f32 v97, v97, v121
    v_add_f32 v98, v98, v122
    v_add_f32 v99, v99, v123
    v_add_f32 v100, v100, v124
    v_add_f32 v101, v101, v125
    v_add_f32 v102, v102, v126
    v_add_f32 v103, v103, v127
    v_lshlrev_b32 v120, 16, v56
    v_and_b32 v121, 0xffff0000, v56
    v_lshlrev_b32 v122, 16, v57
    v_and_b32 v123, 0xffff0000, v57
    v_lshlrev_b32 v124, 16, v58
    v_and_b32 v125, 0xffff0000, v58
    v_lshlrev_b32 v126, 16, v59
    v_and_b32 v127, 0xffff0000, v59
    v_add_f32 v96, v96, v120
    v_add_f32 v97, v97, v121
    v_add_f32 v98, v98, v122
    v_add_f32 v99, v99, v123
    v_add_f32 v100, v100, v124
    v_add_f32 v101, v101, v125
    v_add_f32 v102, v102, v126
    v_add_f32 v103, v103, v127
    v_lshlrev_b32 v120, 16, v60
    v_and_b32 v121, 0xffff0000, v60
    v_lshlrev_b32 v122, 16, v61
    v_and_b32 v123, 0xffff0000, v61
    v_lshlrev_b32 v124, 16, v62
    v_and_b32 v125, 0xffff0000, v62
    v_lshlrev_b32 v126, 16, v63
    v_and_b32 v127, 0xffff0000, v63
    v_add_f32 v96, v96, v120
    v_add_f32 v97, v97, v121
    v_add_f32 v98, v98, v122
    v_add_f32 v99, v99, v123
    v_add_f32 v100, v100, v124
    v_add_f32 v101, v101, v125
    v_add_f32 v102, v102, v126
    v_add_f32 v103, v103, v127
    v_lshlrev_b32 v120, 16, v64
    v_and_b32 v121, 0xffff0000, v64
    v_lshlrev_b32 v122, 16, v65
    v_and_b32 v123, 0xffff0000, v65
    v_lshlrev_b32 v124, 16, v66
    v_and_b32 v125, 0xffff0000, v66
    v_lshlrev_b32 v126, 16, v67
    v_and_b32 v127, 0xffff0000, v67
    v_add_f32 v96, v96, v120
    v_add_f32 v97, v97, v121
    v_add_f32 v98, v98, v122
    v_add_f32 v99, v99, v123
    v_add_f32 v100, v100, v124
    v_add_f32 v101, v101, v125
    v_add_f32 v102, v102, v126
    v_add_f32 v103, v103, v127
    v_lshlrev_b32 v120, 16, v68
    v_and_b32 v121, 0xffff0000, v68
    v_lshlrev_b32 v122, 16, v69
    v_and_b32 v123, 0xffff0000, v69
    v_lshlrev_b32 v124, 16, v70
    v_and_b32 v125, 0xffff0000, v70
    v_lshlrev_b32 v126, 16, v71
    v_and_b32 v127, 0xffff0000, v71
    v_add_f32 v96, v96, v120
    v_add_f32 v97, v97, v121
    v_add_f32 v98, v98, v122
    v_add_f32 v99, v99, v123
    v_add_f32 v100, v100, v124
    v_add_f32 v101, v101, v125
    v_add_f32 v102, v102, v126
    v_add_f32 v103, v103, v127
    v_lshlrev_b32 v120, 16, v72
    v_and_b32 v121, 0xffff0000, v72
    v_lshlrev_b32 v122, 16, v73
    v_and_b32 v123, 0xffff0000, v73
    v_lshlrev_b32 v124, 16, v74
    v_and_b32 v125, 0xffff0000, v74
    v_lshlrev_b32 v126, 16, v75
    v_and_b32 v127, 0xffff0000, v75
    v_add_f32 v96, v96, v120
    v_add_f32 v97, v97, v121
    v_add_f32 v98, v98, v122
    v_add_f32 v99, v99, v123
    v_add_f32 v100, v100, v124
    v_add_f32 v101, v101, v125
    v_add_f32 v102, v102, v126
    v_add_f32 v103, v103, v127
    v_lshlrev_b32 v120, 16, v76
    v_and_b32 v121, 0xffff0000, v76
    v_lshlrev_b32 v122, 16, v77
    v_and_b32 v123, 0xffff0000, v77
    v_lshlrev_b32 v124, 16, v78
    v_and_b32 v125, 0xffff0000, v78
    v_lshlrev_b32 v126, 16, v79
    v_and_b32 v127, 0xffff0000, v79
    v_add_f32 v96, v96, v120
    v_add_f32 v97, v97, v121
    v_add_f32 v98, v98, v122
    v_add_f32 v99, v99, v123
    v_add_f32 v100, v100, v124
    v_add_f32 v101, v101, v125
    v_add_f32 v102, v102, v126
    v_add_f32 v103, v103, v127
    v_cndmask_b32 v108, v92, v94, s[20:21]
    v_cndmask_b32 v109, v93, v95, s[20:21]
    v_cndmask_b32 v110, v94, v92, s[20:21]
    v_cndmask_b32 v111, v95, v93, s[20:21]
    v_cvt_pk_bf16_f32 v104, v96, v97
    v_lshlrev_b32 v96, 16, v104
    v_and_b32 v97, 0xffff0000, v104
    v_lshlrev_b32 v104, 16, v84
    v_and_b32 v105, 0xffff0000, v84
    v_mul_f32 v96, v96, v104
    v_mul_f32 v97, v97, v105
    v_cvt_pk_bf16_f32 v104, v96, v97
    v_lshlrev_b32 v96, 16, v104
    v_and_b32 v97, 0xffff0000, v104
    v_lshlrev_b32 v104, 16, v108
    v_and_b32 v105, 0xffff0000, v108
    v_add_f32 v96, v96, v104
    v_add_f32 v97, v97, v105
    v_cvt_pk_bf16_f32 v112, v96, v97
    v_cvt_pk_bf16_f32 v104, v98, v99
    v_lshlrev_b32 v98, 16, v104
    v_and_b32 v99, 0xffff0000, v104
    v_lshlrev_b32 v104, 16, v85
    v_and_b32 v105, 0xffff0000, v85
    v_mul_f32 v98, v98, v104
    v_mul_f32 v99, v99, v105
    v_cvt_pk_bf16_f32 v104, v98, v99
    v_lshlrev_b32 v98, 16, v104
    v_and_b32 v99, 0xffff0000, v104
    v_lshlrev_b32 v104, 16, v109
    v_and_b32 v105, 0xffff0000, v109
    v_add_f32 v98, v98, v104
    v_add_f32 v99, v99, v105
    v_cvt_pk_bf16_f32 v113, v98, v99
    v_cvt_pk_bf16_f32 v104, v100, v101
    v_lshlrev_b32 v100, 16, v104
    v_and_b32 v101, 0xffff0000, v104
    v_lshlrev_b32 v104, 16, v86
    v_and_b32 v105, 0xffff0000, v86
    v_mul_f32 v100, v100, v104
    v_mul_f32 v101, v101, v105
    v_cvt_pk_bf16_f32 v104, v100, v101
    v_lshlrev_b32 v100, 16, v104
    v_and_b32 v101, 0xffff0000, v104
    v_lshlrev_b32 v104, 16, v110
    v_and_b32 v105, 0xffff0000, v110
    v_add_f32 v100, v100, v104
    v_add_f32 v101, v101, v105
    v_cvt_pk_bf16_f32 v114, v100, v101
    v_cvt_pk_bf16_f32 v104, v102, v103
    v_lshlrev_b32 v102, 16, v104
    v_and_b32 v103, 0xffff0000, v104
    v_lshlrev_b32 v104, 16, v87
    v_and_b32 v105, 0xffff0000, v87
    v_mul_f32 v102, v102, v104
    v_mul_f32 v103, v103, v105
    v_cvt_pk_bf16_f32 v104, v102, v103
    v_lshlrev_b32 v102, 16, v104
    v_and_b32 v103, 0xffff0000, v104
    v_lshlrev_b32 v104, 16, v111
    v_and_b32 v105, 0xffff0000, v111
    v_add_f32 v102, v102, v104
    v_add_f32 v103, v103, v105
    v_cvt_pk_bf16_f32 v115, v102, v103
    v_cndmask_b32 v132, v112, v114, s[20:21]
    v_cndmask_b32 v133, v113, v115, s[20:21]
    v_cndmask_b32 v134, v114, v112, s[20:21]
    v_cndmask_b32 v135, v115, v113, s[20:21]
    buffer_store_dwordx4 v[132:135], v4, s[12:15], s18 offen offset:64
    s_add_u32 s24, s24, 32
    s_cmp_lt_u32 s24, 61
    s_cbranch_scc1 fin_job
    s_cmp_ge_u32 s63, 48
    s_cbranch_scc1 k_end
    s_lshr_b32 s24, s63, 4
    s_sub_u32 s24, 63, s24
    s_and_b32 s25, s63, 15
    s_lshl_b32 s25, s25, 2
    s_and_b32 s26, s3, 3
    s_add_u32 s25, s25, s26
    s_lshr_b32 s26, s25, 5
    s_and_b32 s25, s25, 31
    s_lshl_b32 s16, s24, 1
    s_add_u32 s16, s16, s26
    s_lshl_b32 s18, s16, 15
    s_lshl_b32 s17, s25, 10
    s_add_u32 s17, s17, s18
    s_lshl_b32 s19, s25, 6
    s_add_u32 s18, s18, s19
    s_add_u32 s22, s17, 167772160
    s_add_u32 s23, s17, 75497472
    s_mov_b32 s27, 218106816
    s_mov_b32 s30, 218112000
    s_mov_b32 s28, 65536
    v_and_b32 v8, 7, v1
    v_lshlrev_b32 v8, 22, v8
    s_cmp_lg_u32 s3, 0
    s_cbranch_scc1 ft_ok
ft_wd:
    buffer_load_dword v7, off, s[4:7], s27 sc1
    s_waitcnt vmcnt(0)
    v_readfirstlane_b32 s31, v7
    s_cmp_ge_u32 s31, 16
    s_cbranch_scc1 ft_ws
    s_sleep 127
    s_sub_u32 s28, s28, 1
    s_cbranch_scc0 ft_wd
    s_mov_b32 s28, 0
ft_ws:
    buffer_load_dword v7, v6, s[4:7], s30 offen sc1
    s_waitcnt vmcnt(0)
    v_cmp_gt_u32 vcc, 61, v7
    s_cbranch_vccz ft_ok
    s_sleep 12
    v_cmp_gt_u32 vcc, 59, v7
    s_cbranch_vccz ft_wsf
    s_sleep 64
    v_cmp_gt_u32 vcc, 56, v7
    s_cbranch_vccz ft_wsf
    s_sleep 127
    s_sleep 127
ft_wsf:
    s_sub_u32 s28, s28, 1
    s_cbranch_scc0 ft_ws
    s_mov_b32 s28, 0
ft_ok:
    s_barrier
    s_cmp_ge_u32 s3, 4
    s_cbranch_scc1 k_end
    buffer_load_dwordx4 v[88:91], v4, s[8:11], s18 offen
    buffer_load_dwordx4 v[144:147], v3, s[4:7], s22 offen offset:0 sc1
    s_add_u32 s22, s22, 4194304
    buffer_load_dwordx4 v[148:151], v3, s[4:7], s22 offen offset:0 sc1
    s_add_u32 s22, s22, 4194304
    buffer_load_dwordx4 v[152:155], v3, s[4:7], s22 offen offset:0 sc1
    s_add_u32 s22, s22, 4194304
    buffer_load_dwordx4 v[156:159], v3, s[4:7], s22 offen offset:0 sc1
    s_waitcnt vmcnt(0)
    v_lshlrev_b32 v96, 16, v144
    v_and_b32 v97, 0xffff0000, v144
    v_lshlrev_b32 v98, 16, v145
    v_and_b32 v99, 0xffff0000, v145
    v_lshlrev_b32 v100, 16, v146
    v_and_b32 v101, 0xffff0000, v146
    v_lshlrev_b32 v102, 16, v147
    v_and_b32 v103, 0xffff0000, v147
    v_lshlrev_b32 v120, 16, v148
    v_and_b32 v121, 0xffff0000, v148
    v_lshlrev_b32 v122, 16, v149
    v_and_b32 v123, 0xffff0000, v149
    v_lshlrev_b32 v124, 16, v150
    v_and_b32 v125, 0xffff0000, v150
    v_lshlrev_b32 v126, 16, v151
    v_and_b32 v127, 0xffff0000, v151
    v_add_f32 v96, v96, v120
    v_add_f32 v97, v97, v121
    v_add_f32 v98, v98, v122
    v_add_f32 v99, v99, v123
    v_add_f32 v100, v100, v124
    v_add_f32 v101, v101, v125
    v_add_f32 v102, v102, v126
    v_add_f32 v103, v103, v127
    v_lshlrev_b32 v120, 16, v152
    v_and_b32 v121, 0xffff0000, v152
    v_lshlrev_b32 v122, 16, v153
    v_and_b32 v123, 0xffff0000, v153
    v_lshlrev_b32 v124, 16, v154
    v_and_b32 v125, 0xffff0000, v154
    v_lshlrev_b32 v126, 16, v155
    v_and_b32 v127, 0xffff0000, v155
    v_add_f32 v96, v96, v120
    v_add_f32 v97, v97, v121
    v_add_f32 v98, v98, v122
    v_add_f32 v99, v99, v123
    v_add_f32 v100, v100, v124
    v_add_f32 v101, v101, v125
    v_add_f32 v102, v102, v126
    v_add_f32 v103, v103, v127
    v_lshlrev_b32 v120, 16, v156
    v_and_b32 v121, 0xffff0000, v156
    v_lshlrev_b32 v122, 16, v157
    v_and_b32 v123, 0xffff0000, v157
    v_lshlrev_b32 v124, 16, v158
    v_and_b32 v125, 0xffff0000, v158
    v_lshlrev_b32 v126, 16, v159
    v_and_b32 v127, 0xffff0000, v159
    v_add_f32 v96, v96, v120
    v_add_f32 v97, v97, v121
    v_add_f32 v98, v98, v122
    v_add_f32 v99, v99, v123
    v_add_f32 v100, v100, v124
    v_add_f32 v101, v101, v125
    v_add_f32 v102, v102, v126
    v_add_f32 v103, v103, v127
    v_cvt_pk_bf16_f32 v120, v96, v97
    v_cvt_pk_bf16_f32 v121, v98, v99
    v_cvt_pk_bf16_f32 v122, v100, v101
    v_cvt_pk_bf16_f32 v123, v102, v103
    v_lshlrev_b32 v96, 16, v120
    v_and_b32 v97, 0xffff0000, v120
    v_lshlrev_b32 v98, 16, v121
    v_and_b32 v99, 0xffff0000, v121
    v_lshlrev_b32 v100, 16, v122
    v_and_b32 v101, 0xffff0000, v122
    v_lshlrev_b32 v102, 16, v123
    v_and_b32 v103, 0xffff0000, v123
    v_mul_f32 v104, 0xbfb8aa3b, v96
    v_mul_f32 v105, 0xbfb8aa3b, v97
    v_mul_f32 v106, 0xbfb8aa3b, v98
    v_mul_f32 v107, 0xbfb8aa3b, v99
    v_mul_f32 v108, 0xbfb8aa3b, v100
    v_mul_f32 v109, 0xbfb8aa3b, v101
    v_mul_f32 v110, 0xbfb8aa3b, v102
    v_mul_f32 v111, 0xbfb8aa3b, v103
    v_exp_f32 v104, v104
    v_exp_f32 v105, v105
    v_exp_f32 v106, v106
    v_exp_f32 v107, v107
    v_exp_f32 v108, v108
    v_exp_f32 v109, v109
    v_exp_f32 v110, v110
    v_exp_f32 v111, v111
    v_add_f32 v104, 1.0, v104
    v_add_f32 v105, 1.0, v105
    v_add_f32 v106, 1.0, v106
    v_add_f32 v107, 1.0, v107
    v_add_f32 v108, 1.0, v108
    v_add_f32 v109, 1.0, v109
    v_add_f32 v110, 1.0, v110
    v_add_f32 v111, 1.0, v111
    v_rcp_f32 v104, v104
    v_rcp_f32 v105, v105
    v_rcp_f32 v106, v106
    v_rcp_f32 v107, v107
    v_rcp_f32 v108, v108
    v_rcp_f32 v109, v109
    v_rcp_f32 v110, v110
    v_rcp_f32 v111, v111
    v_mul_f32 v96, v96, v104
    v_mul_f32 v97, v97, v105
    v_mul_f32 v98, v98, v106
    v_mul_f32 v99, v99, v107
    v_mul_f32 v100, v100, v108
    v_mul_f32 v101, v101, v109
    v_mul_f32 v102, v102, v110
    v_mul_f32 v103, v103, v111
    v_cvt_pk_bf16_f32 v80, v96, v97
    v_cvt_pk_bf16_f32 v81, v98, v99
    v_cvt_pk_bf16_f32 v82, v100, v101
    v_cvt_pk_bf16_f32 v83, v102, v103
ft_p:
    buffer_load_dword v7, v8, s[4:7], s23 offen offset:1020 sc1
    s_waitcnt vmcnt(0)
    v_cmp_eq_u32 vcc, -1, v7
    s_cbranch_vccz ft_l
    s_sleep 4
    s_sub_u32 s28, s28, 1
    s_cbranch_scc0 ft_p
    s_mov_b32 s28, 0
ft_l:
    s_mov_b32 s31, s23
    buffer_load_dwordx4 v[16:19], v3, s[4:7], s31 offen sc1
    s_add_u32 s31, s31, 4194304
    buffer_load_dwordx4 v[20:23], v3, s[4:7], s31 offen sc1
    s_add_u32 s31, s31, 4194304
    buffer_load_dwordx4 v[24:27], v3, s[4:7], s31 offen sc1
    s_add_u32 s31, s31, 4194304
    buffer_load_dwordx4 v[28:31], v3, s[4:7], s31 offen sc1
    s_add_u32 s31, s31, 4194304
    buffer_load_dwordx4 v[32:35], v3, s[4:7], s31 offen sc1
    s_add_u32 s31, s31, 4194304
    buffer_load_dwordx4 v[36:39], v3, s[4:7], s31 offen sc1
    s_add_u32 s31, s31, 4194304
    buffer_load_dwordx4 v[40:43], v3, s[4:7], s31 offen sc1
    s_add_u32 s31, s31, 4194304
    buffer_load_dwordx4 v[44:47], v3, s[4:7], s31 offen sc1
    s_waitcnt vmcnt(0)
    v_max3_u32 v7, v16, v17, v18
    v_max3_u32 v7, v7, v19, v20
    v_max3_u32 v7, v7, v21, v22
    v_max3_u32 v7, v7, v23, v24
    v_max3_u32 v7, v7, v25, v26
    v_max3_u32 v7, v7, v27, v28
    v_max3_u32 v7, v7, v29, v30
    v_max3_u32 v7, v7, v31, v32
    v_max3_u32 v7, v7, v33, v34
    v_max3_u32 v7, v7, v35, v36
    v_max3_u32 v7, v7, v37, v38
    v_max3_u32 v7, v7, v39, v40
    v_max3_u32 v7, v7, v41, v42
    v_max3_u32 v7, v7, v43, v44
    v_max3_u32 v7, v7, v45, v46
    v_max_u32 v7, v7, v47
    v_cmp_eq_u32 vcc, -1, v7
    s_cbranch_vccz ft_go
    s_sub_u32 s28, s28, 1
    s_cbranch_scc0 ft_l
ft_go:
    v_lshlrev_b32 v96, 16, v16
    v_and_b32 v97, 0xffff0000, v16
    v_lshlrev_b32 v98, 16, v17
    v_and_b32 v99, 0xffff0000, v17
    v_lshlrev_b32 v100, 16, v18
    v_and_b32 v101, 0xffff0000, v18
    v_lshlrev_b32 v102, 16, v19
    v_and_b32 v103, 0xffff0000, v19
    v_lshlrev_b32 v120, 16, v20
    v_and_b32 v121, 0xffff0000, v20
    v_lshlrev_b32 v122, 16, v21
    v_and_b32 v123, 0xffff0000, v21
    v_lshlrev_b32 v124, 16, v22
    v_and_b32 v125, 0xffff0000, v22
    v_lshlrev_b32 v126, 16, v23
    v_and_b32 v127, 0xffff0000, v23
    v_add_f32 v96, v96, v120
    v_add_f32 v97, v97, v121
    v_add_f32 v98, v98, v122
    v_add_f32 v99, v99, v123
    v_add_f32 v100, v100, v124
    v_add_f32 v101, v101, v125
    v_add_f32 v102, v102, v126
    v_add_f32 v103, v103, v127
    v_lshlrev_b32 v120, 16, v24
    v_and_b32 v121, 0xffff0000, v24
    v_lshlrev_b32 v122, 16, v25
    v_and_b32 v123, 0xffff0000, v25
    v_lshlrev_b32 v124, 16, v26
    v_and_b32 v125, 0xffff0000, v26
    v_lshlrev_b32 v126, 16, v27
    v_and_b32 v127, 0xffff0000, v27
    v_add_f32 v96, v96, v120
    v_add_f32 v97, v97, v121
    v_add_f32 v98, v98, v122
    v_add_f32 v99, v99, v123
    v_add_f32 v100, v100, v124
    v_add_f32 v101, v101, v125
    v_add_f32 v102, v102, v126
    v_add_f32 v103, v103, v127
    v_lshlrev_b32 v120, 16, v28
    v_and_b32 v121, 0xffff0000, v28
    v_lshlrev_b32 v122, 16, v29
    v_and_b32 v123, 0xffff0000, v29
    v_lshlrev_b32 v124, 16, v30
    v_and_b32 v125, 0xffff0000, v30
    v_lshlrev_b32 v126, 16, v31
    v_and_b32 v127, 0xffff0000, v31
    v_add_f32 v96, v96, v120
    v_add_f32 v97, v97, v121
    v_add_f32 v98, v98, v122
    v_add_f32 v99, v99, v123
    v_add_f32 v100, v100, v124
    v_add_f32 v101, v101, v125
    v_add_f32 v102, v102, v126
    v_add_f32 v103, v103, v127
    v_lshlrev_b32 v120, 16, v32
    v_and_b32 v121, 0xffff0000, v32
    v_lshlrev_b32 v122, 16, v33
    v_and_b32 v123, 0xffff0000, v33
    v_lshlrev_b32 v124, 16, v34
    v_and_b32 v125, 0xffff0000, v34
    v_lshlrev_b32 v126, 16, v35
    v_and_b32 v127, 0xffff0000, v35
    v_add_f32 v96, v96, v120
    v_add_f32 v97, v97, v121
    v_add_f32 v98, v98, v122
    v_add_f32 v99, v99, v123
    v_add_f32 v100, v100, v124
    v_add_f32 v101, v101, v125
    v_add_f32 v102, v102, v126
    v_add_f32 v103, v103, v127
    v_lshlrev_b32 v120, 16, v36
    v_and_b32 v121, 0xffff0000, v36
    v_lshlrev_b32 v122, 16, v37
    v_and_b32 v123, 0xffff0000, v37
    v_lshlrev_b32 v124, 16, v38
    v_and_b32 v125, 0xffff0000, v38
    v_lshlrev_b32 v126, 16, v39
    v_and_b32 v127, 0xffff0000, v39
    v_add_f32 v96, v96, v120
    v_add_f32 v97, v97, v121
    v_add_f32 v98, v98, v122
    v_add_f32 v99, v99, v123
    v_add_f32 v100, v100, v124
    v_add_f32 v101, v101, v125
    v_add_f32 v102, v102, v126
    v_add_f32 v103, v103, v127
    v_lshlrev_b32 v120, 16, v40
    v_and_b32 v121, 0xffff0000, v40
    v_lshlrev_b32 v122, 16, v41
    v_and_b32 v123, 0xffff0000, v41
    v_lshlrev_b32 v124, 16, v42
    v_and_b32 v125, 0xffff0000, v42
    v_lshlrev_b32 v126, 16, v43
    v_and_b32 v127, 0xffff0000, v43
    v_add_f32 v96, v96, v120
    v_add_f32 v97, v97, v121
    v_add_f32 v98, v98, v122
    v_add_f32 v99, v99, v123
    v_add_f32 v100, v100, v124
    v_add_f32 v101, v101, v125
    v_add_f32 v102, v102, v126
    v_add_f32 v103, v103, v127
    v_lshlrev_b32 v120, 16, v44
    v_and_b32 v121, 0xffff0000, v44
    v_lshlrev_b32 v122, 16, v45
    v_and_b32 v123, 0xffff0000, v45
    v_lshlrev_b32 v124, 16, v46
    v_and_b32 v125, 0xffff0000, v46
    v_lshlrev_b32 v126, 16, v47
    v_and_b32 v127, 0xffff0000, v47
    v_add_f32 v96, v96, v120
    v_add_f32 v97, v97, v121
    v_add_f32 v98, v98, v122
    v_add_f32 v99, v99, v123
    v_add_f32 v100, v100, v124
    v_add_f32 v101, v101, v125
    v_add_f32 v102, v102, v126
    v_add_f32 v103, v103, v127
    v_cndmask_b32 v108, v88, v90, s[20:21]
    v_cndmask_b32 v109, v89, v91, s[20:21]
    v_cndmask_b32 v110, v90, v88, s[20:21]
    v_cndmask_b32 v111, v91, v89, s[20:21]
    v_cvt_pk_bf16_f32 v104, v96, v97
    v_lshlrev_b32 v96, 16, v104
    v_and_b32 v97, 0xffff0000, v104
    v_lshlrev_b32 v104, 16, v80
    v_and_b32 v105, 0xffff0000, v80
    v_mul_f32 v96, v96, v104
    v_mul_f32 v97, v97, v105
    v_cvt_pk_bf16_f32 v104, v96, v97
    v_lshlrev_b32 v96, 16, v104
    v_and_b32 v97, 0xffff0000, v104
    v_lshlrev_b32 v104, 16, v108
    v_and_b32 v105, 0xffff0000, v108
    v_add_f32 v96, v96, v104
    v_add_f32 v97, v97, v105
    v_cvt_pk_bf16_f32 v112, v96, v97
    v_cvt_pk_bf16_f32 v104, v98, v99
    v_lshlrev_b32 v98, 16, v104
    v_and_b32 v99, 0xffff0000, v104
    v_lshlrev_b32 v104, 16, v81
    v_and_b32 v105, 0xffff0000, v81
    v_mul_f32 v98, v98, v104
    v_mul_f32 v99, v99, v105
    v_cvt_pk_bf16_f32 v104, v98, v99
    v_lshlrev_b32 v98, 16, v104
    v_and_b32 v99, 0xffff0000, v104
    v_lshlrev_b32 v104, 16, v109
    v_and_b32 v105, 0xffff0000, v109
    v_add_f32 v98, v98, v104
    v_add_f32 v99, v99, v105
    v_cvt_pk_bf16_f32 v113, v98, v99
    v_cvt_pk_bf16_f32 v104, v100, v101
    v_lshlrev_b32 v100, 16, v104
    v_and_b32 v101, 0xffff0000, v104
    v_lshlrev_b32 v104, 16, v82
    v_and_b32 v105, 0xffff0000, v82
    v_mul_f32 v100, v100, v104
    v_mul_f32 v101, v101, v105
    v_cvt_pk_bf16_f32 v104, v100, v101
    v_lshlrev_b32 v100, 16, v104
    v_and_b32 v101, 0xffff0000, v104
    v_lshlrev_b32 v104, 16, v110
    v_and_b32 v105, 0xffff0000, v110
    v_add_f32 v100, v100, v104
    v_add_f32 v101, v101, v105
    v_cvt_pk_bf16_f32 v114, v100, v101
    v_cvt_pk_bf16_f32 v104, v102, v103
    v_lshlrev_b32 v102, 16, v104
    v_and_b32 v103, 0xffff0000, v104
    v_lshlrev_b32 v104, 16, v83
    v_and_b32 v105, 0xffff0000, v83
    v_mul_f32 v102, v102, v104
    v_mul_f32 v103, v103, v105
    v_cvt_pk_bf16_f32 v104, v102, v103
    v_lshlrev_b32 v102, 16, v104
    v_and_b32 v103, 0xffff0000, v104
    v_lshlrev_b32 v104, 16, v111
    v_and_b32 v105, 0xffff0000, v111
    v_add_f32 v102, v102, v104
    v_add_f32 v103, v103, v105
    v_cvt_pk_bf16_f32 v115, v102, v103
    v_cndmask_b32 v128, v112, v114, s[20:21]
    v_cndmask_b32 v129, v113, v115, s[20:21]
    v_cndmask_b32 v130, v114, v112, s[20:21]
    v_cndmask_b32 v131, v115, v113, s[20:21]
    buffer_store_dwordx4 v[128:131], v4, s[12:15], s18 offen offset:0
    s_branch k_end
chain_map:
    s_and_b32 s14, s12, 1
    s_lshl_b32 s13, s13, 1
    s_lshr_b32 s15, s12, 1
    s_add_u32 s12, s13, s14
    s_mov_b32 s13, s15
    s_lshl_b32 s2, s13, 3
    s_add_u32 s2, s2, s12
    s_lshr_b32 s14, s13, 2
    s_and_b32 s15, s13, 3
    s_mov_b32 s16, 0
    s_mov_b32 s17, 209715200
    s_mov_b32 s18, 209977344
    s_mov_b32 s19, 210239488
    s_mov_b32 s20, 210501632
    s_mov_b32 s26, 131072
    s_mov_b32 s68, 0
    s_getreg_b32 s29, hwreg(HW_REG_XCC_ID)
    s_and_b32 s29, s29, 15
    s_mul_i32 s23, s29, s29
    s_lshl_b32 s23, s23, 18
    s_lshl_b32 s29, s29, 8
    s_add_u32 s29, s29, s23
    s_add_u32 s29, s29, 1
    s_lshr_b32 s28, s12, 1
    s_lshl_b32 s28, s28, 2
    s_add_u32 s28, s28, 128
    s_cmp_ge_u32 s3, 4
    s_cbranch_scc1 ch_a_pro
    s_lshl_b32 s32, s12, 15
    s_lshl_b32 s21, s14, 13
    s_add_u32 s32, s32, s21
    s_lshl_b32 s21, s15, 10
    s_add_u32 s32, s32, s21
    s_add_u32 s32, s32, 2097152
    s_lshr_b32 s33, s12, 1
    s_lshl_b32 s33, s33, 14
    s_add_u32 s33, s33, 1048576
    s_lshl_b32 s21, s13, 10
    s_add_u32 s36, s33, s21
    s_lshl_b32 s21, s3, 12
    s_add_u32 s33, s33, s21
    s_lshl_b32 s34, s13, 14
    s_lshl_b32 s21, s12, 10
    s_add_u32 s35, s34, s21
    s_lshl_b32 s37, s12, 22
    s_lshl_b32 s21, s13, 11
    s_add_u32 s37, s37, s21
    s_and_b32 s21, s3, 1
    s_lshl_b32 s21, s21, 15
    s_add_u32 s37, s37, s21
    s_lshr_b32 s21, s3, 1
    s_lshl_b32 s21, s21, 10
    s_add_u32 s37, s37, s21
    s_add_u32 s37, s37, 75497472
    v_and_b32 v20, 63, v0
    v_lshlrev_b32 v1, 4, v20
    v_mov_b32 v10, -1
    v_mov_b32 v11, -1
    v_lshrrev_b32 v21, 2, v20
    v_and_b32 v22, 3, v20
    v_lshlrev_b32 v21, 13, v21
    v_lshl_add_u32 v21, v22, 4, v21
    s_lshl_b32 s21, s3, 21
    s_lshl_b32 s22, s12, 10
    s_add_u32 s21, s21, s22
    s_lshl_b32 s23, s3, 15
    s_mov_b32 s10, 8388608
    s_mov_b32 s11, 131072
    v_lshrrev_b32 v24, 4, v20
    v_bfe_u32 v25, v20, 2, 2
    v_lshl_add_u32 v24, v24, 4, v25
    v_lshlrev_b32 v24, 6, v24
    v_lshl_add_u32 v24, v22, 3, v24
    v_add_u32 v24, s23, v24
    s_load_dwordx2 s[8:9], s[0:1], 16
    s_lshl_b32 s25, s13, 6
    s_add_u32 s24, s21, s25
    s_waitcnt lgkmcnt(0)
    s_add_u32 m0, s23, 0
    s_nop 0
    buffer_load_dwordx4 v21, s[8:11], s24 offen lds
    s_add_u32 s24, s24, 131072
    s_add_u32 m0, s23, 1024
    s_nop 0
    buffer_load_dwordx4 v21, s[8:11], s24 offen lds
    s_add_u32 s24, s24, 131072
    s_add_u32 m0, s23, 2048
    s_nop 0
    buffer_load_dwordx4 v21, s[8:11], s24 offen lds
    s_add_u32 s24, s24, 131072
    s_add_u32 m0, s23, 3072
    s_nop 0
    buffer_load_dwordx4 v21, s[8:11], s24 offen lds
    s_add_u32 s24, s24, 131072
    s_add_u32 m0, s23, 4096
    s_nop 0
    buffer_load_dwordx4 v21, s[8:11], s24 offen lds
    s_add_u32 s24, s24, 131072
    s_add_u32 m0, s23, 5120
    s_nop 0
    buffer_load_dwordx4 v21, s[8:11], s24 offen lds
    s_add_u32 s24, s24, 131072
    s_add_u32 m0, s23, 6144
    s_nop 0
    buffer_load_dwordx4 v21, s[8:11], s24 offen lds
    s_add_u32 s24, s24, 131072
    s_add_u32 m0, s23, 7168
    s_nop 0
    buffer_load_dwordx4 v21, s[8:11], s24 offen lds
    s_add_u32 s24, s24, 131072
    s_add_u32 m0, s23, 8192
    s_nop 0
    buffer_load_dwordx4 v21, s[8:11], s24 offen lds
    s_add_u32 s24, s24, 131072
    s_add_u32 m0, s23, 9216
    s_nop 0
    buffer_load_dwordx4 v21, s[8:11], s24 offen lds
    s_add_u32 s24, s24, 131072
    s_add_u32 m0, s23, 10240
    s_nop 0
    buffer_load_dwordx4 v21, s[8:11], s24 offen lds
    s_add_u32 s24, s24, 131072
    s_add_u32 m0, s23, 11264
    s_nop 0
    buffer_load_dwordx4 v21, s[8:11], s24 offen lds
    s_add_u32 s24, s24, 131072
    s_add_u32 m0, s23, 12288
    s_nop 0
    buffer_load_dwordx4 v21, s[8:11], s24 offen lds
    s_add_u32 s24, s24, 131072
    s_add_u32 m0, s23, 13312
    s_nop 0
    buffer_load_dwordx4 v21, s[8:11], s24 offen lds
    s_add_u32 s24, s24, 131072
    s_add_u32 m0, s23, 14336
    s_nop 0
    buffer_load_dwordx4 v21, s[8:11], s24 offen lds
    s_add_u32 s24, s24, 131072
    s_add_u32 m0, s23, 15360
    s_nop 0
    buffer_load_dwordx4 v21, s[8:11], s24 offen lds
    s_add_u32 s24, s24, 131072
    s_load_dwordx2 s[8:9], s[0:1], 24
    s_lshl_b32 s25, s13, 6
    s_add_u32 s24, s21, s25
    s_waitcnt lgkmcnt(0)
    s_add_u32 m0, s23, 16384
    s_nop 0
    buffer_load_dwordx4 v21, s[8:11], s24 offen lds
    s_add_u32 s24, s24, 131072
    s_add_u32 m0, s23, 17408
    s_nop 0
    buffer_load_dwordx4 v21, s[8:11], s24 offen lds
    s_add_u32 s24, s24, 131072
    s_add_u32 m0, s23, 18432
    s_nop 0
    buffer_load_dwordx4 v21, s[8:11], s24 offen lds
    s_add_u32 s24, s24, 131072
    s_add_u32 m0, s23, 19456
    s_nop 0
    buffer_load_dwordx4 v21, s[8:11], s24 offen lds
    s_add_u32 s24, s24, 131072
    s_add_u32 m0, s23, 20480
    s_nop 0
    buffer_load_dwordx4 v21, s[8:11], s24 offen lds
    s_add_u32 s24, s24, 131072
    s_add_u32 m0, s23, 21504
    s_nop 0
    buffer_load_dwordx4 v21, s[8:11], s24 offen lds
    s_add_u32 s24, s24, 131072
    s_add_u32 m0, s23, 22528
    s_nop 0
    buffer_load_dwordx4 v21, s[8:11], s24 offen lds
    s_add_u32 s24, s24, 131072
    s_add_u32 m0, s23, 23552
    s_nop 0
    buffer_load_dwordx4 v21, s[8:11], s24 offen lds
    s_add_u32 s24, s24, 131072
    s_add_u32 m0, s23, 24576
    s_nop 0
    buffer_load_dwordx4 v21, s[8:11], s24 offen lds
    s_add_u32 s24, s24, 131072
    s_add_u32 m0, s23, 25600
    s_nop 0
    buffer_load_dwordx4 v21, s[8:11], s24 offen lds
    s_add_u32 s24, s24, 131072
    s_add_u32 m0, s23, 26624
    s_nop 0
    buffer_load_dwordx4 v21, s[8:11], s24 offen lds
    s_add_u32 s24, s24, 131072
    s_add_u32 m0, s23, 27648
    s_nop 0
    buffer_load_dwordx4 v21, s[8:11], s24 offen lds
    s_add_u32 s24, s24, 131072
    s_add_u32 m0, s23, 28672
    s_nop 0
    buffer_load_dwordx4 v21, s[8:11], s24 offen lds
    s_add_u32 s24, s24, 131072
    s_add_u32 m0, s23, 29696
    s_nop 0
    buffer_load_dwordx4 v21, s[8:11], s24 offen lds
    s_add_u32 s24, s24, 131072
    s_add_u32 m0, s23, 30720
    s_nop 0
    buffer_load_dwordx4 v21, s[8:11], s24 offen lds
    s_add_u32 s24, s24, 131072
    s_add_u32 m0, s23, 31744
    s_nop 0
    buffer_load_dwordx4 v21, s[8:11], s24 offen lds
    s_add_u32 s24, s24, 131072
    s_load_dwordx2 s[8:9], s[0:1], 32
    s_lshl_b32 s25, s13, 6
    s_add_u32 s24, s21, s25
    s_waitcnt lgkmcnt(0)
    buffer_load_dwordx4 v[96:99], v21, s[8:11], s24 offen
    s_add_u32 s24, s24, 131072
    buffer_load_dwordx4 v[100:103], v21, s[8:11], s24 offen
    s_add_u32 s24, s24, 131072
    buffer_load_dwordx4 v[104:107], v21, s[8:11], s24 offen
    s_add_u32 s24, s24, 131072
    buffer_load_dwordx4 v[108:111], v21, s[8:11], s24 offen
    s_add_u32 s24, s24, 131072
    buffer_load_dwordx4 v[144:147], v21, s[8:11], s24 offen
    s_add_u32 s24, s24, 131072
    buffer_load_dwordx4 v[148:151], v21, s[8:11], s24 offen
    s_add_u32 s24, s24, 131072
    buffer_load_dwordx4 v[152:155], v21, s[8:11], s24 offen
    s_add_u32 s24, s24, 131072
    buffer_load_dwordx4 v[156:159], v21, s[8:11], s24 offen
    s_add_u32 s24, s24, 131072
    buffer_load_dwordx4 v[192:195], v21, s[8:11], s24 offen
    s_add_u32 s24, s24, 131072
    buffer_load_dwordx4 v[196:199], v21, s[8:11], s24 offen
    s_add_u32 s24, s24, 131072
    buffer_load_dwordx4 v[200:203], v21, s[8:11], s24 offen
    s_add_u32 s24, s24, 131072
    buffer_load_dwordx4 v[204:207], v21, s[8:11], s24 offen
    s_add_u32 s24, s24, 131072
    buffer_load_dwordx4 v[240:243], v21, s[8:11], s24 offen
    s_add_u32 s24, s24, 131072
    buffer_load_dwordx4 v[244:247], v21, s[8:11], s24 offen
    s_add_u32 s24, s24, 131072
    buffer_load_dwordx4 v[248:251], v21, s[8:11], s24 offen
    s_add_u32 s24, s24, 131072
    buffer_load_dwordx4 v[252:255], v21, s[8:11], s24 offen
    s_add_u32 s24, s24, 131072
    s_load_dwordx2 s[8:9], s[0:1], 8
    s_mov_b32 s10, 16384
    v_bfe_u32 v57, v20, 4, 1
    v_lshrrev_b32 v58, 5, v20
    v_and_b32 v59, 1, v20
    v_bfe_u32 v60, v20, 1, 3
    v_lshlrev_b32 v60, 11, v60
    v_lshl_add_u32 v60, v57, 6, v60
    v_lshl_add_u32 v60, v58, 4, v60
    v_lshl_add_u32 v15, v59, 2, v60
    s_lshl_b32 s24, s3, 9
    s_waitcnt lgkmcnt(0)
    buffer_load_dword v32, v15, s[8:11], s24 offen offset:0
    buffer_load_dword v33, v15, s[8:11], s24 offen offset:8
    buffer_load_dword v34, v15, s[8:11], s24 offen offset:32
    buffer_load_dword v35, v15, s[8:11], s24 offen offset:40
    buffer_load_dword v36, v15, s[8:11], s24 offen offset:128
    buffer_load_dword v37, v15, s[8:11], s24 offen offset:136
    buffer_load_dword v38, v15, s[8:11], s24 offen offset:160
    buffer_load_dword v39, v15, s[8:11], s24 offen offset:168
    buffer_load_dword v40, v15, s[8:11], s24 offen offset:256
    buffer_load_dword v41, v15, s[8:11], s24 offen offset:264
    buffer_load_dword v42, v15, s[8:11], s24 offen offset:288
    buffer_load_dword v43, v15, s[8:11], s24 offen offset:296
    buffer_load_dword v44, v15, s[8:11], s24 offen offset:384
    buffer_load_dword v45, v15, s[8:11], s24 offen offset:392
    buffer_load_dword v46, v15, s[8:11], s24 offen offset:416
    buffer_load_dword v47, v15, s[8:11], s24 offen offset:424
    s_barrier
    v_add_u32 v56, s23, v1
    s_waitcnt vmcnt(48)
    ds_read_b64_tr_b16 v[64:65], v24 offset:0
    ds_read_b64_tr_b16 v[66:67], v24 offset:256
    ds_read_b64_tr_b16 v[68:69], v24 offset:512
    ds_read_b64_tr_b16 v[70:71], v24 offset:768
    ds_read_b64_tr_b16 v[72:73], v24 offset:32
    ds_read_b64_tr_b16 v[74:75], v24 offset:288
    ds_read_b64_tr_b16 v[76:77], v24 offset:544
    ds_read_b64_tr_b16 v[78:79], v24 offset:800
    s_waitcnt lgkmcnt(0)
    ds_read_b64_tr_b16 v[112:113], v24 offset:4096
    ds_read_b64_tr_b16 v[114:115], v24 offset:4352
    ds_read_b64_tr_b16 v[116:117], v24 offset:4608
    ds_read_b64_tr_b16 v[118:119], v24 offset:4864
    ds_read_b64_tr_b16 v[120:121], v24 offset:4128
    ds_read_b64_tr_b16 v[122:123], v24 offset:4384
    ds_read_b64_tr_b16 v[124:125], v24 offset:4640
    ds_read_b64_tr_b16 v[126:127], v24 offset:4896
    s_waitcnt lgkmcnt(0)
    ds_read_b64_tr_b16 v[160:161], v24 offset:8192
    ds_read_b64_tr_b16 v[162:163], v24 offset:8448
    ds_read_b64_tr_b16 v[164:165], v24 offset:8704
    ds_read_b64_tr_b16 v[166:167], v24 offset:8960
    ds_read_b64_tr_b16 v[168:169], v24 offset:8224
    ds_read_b64_tr_b16 v[170:171], v24 offset:8480
    ds_read_b64_tr_b16 v[172:173], v24 offset:8736
    ds_read_b64_tr_b16 v[174:175], v24 offset:8992
    s_waitcnt lgkmcnt(0)
    ds_read_b64_tr_b16 v[208:209], v24 offset:12288
    ds_read_b64_tr_b16 v[210:211], v24 offset:12544
    ds_read_b64_tr_b16 v[212:213], v24 offset:12800
    ds_read_b64_tr_b16 v[214:215], v24 offset:13056
    ds_read_b64_tr_b16 v[216:217], v24 offset:12320
    ds_read_b64_tr_b16 v[218:219], v24 offset:12576
    ds_read_b64_tr_b16 v[220:221], v24 offset:12832
    ds_read_b64_tr_b16 v[222:223], v24 offset:13088
    s_waitcnt lgkmcnt(0)
    s_waitcnt vmcnt(32)
    ds_read_b64_tr_b16 v[80:81], v24 offset:16384
    ds_read_b64_tr_b16 v[82:83], v24 offset:16640
    ds_read_b64_tr_b16 v[84:85], v24 offset:16896
    ds_read_b64_tr_b16 v[86:87], v24 offset:17152
    ds_read_b64_tr_b16 v[88:89], v24 offset:16416
    ds_read_b64_tr_b16 v[90:91], v24 offset:16672
    ds_read_b64_tr_b16 v[92:93], v24 offset:16928
    ds_read_b64_tr_b16 v[94:95], v24 offset:17184
    s_waitcnt lgkmcnt(0)
    ds_read_b64_tr_b16 v[128:129], v24 offset:20480
    ds_read_b64_tr_b16 v[130:131], v24 offset:20736
    ds_read_b64_tr_b16 v[132:133], v24 offset:20992
    ds_read_b64_tr_b16 v[134:135], v24 offset:21248
    ds_read_b64_tr_b16 v[136:137], v24 offset:20512
    ds_read_b64_tr_b16 v[138:139], v24 offset:20768
    ds_read_b64_tr_b16 v[140:141], v24 offset:21024
    ds_read_b64_tr_b16 v[142:143], v24 offset:21280
    s_waitcnt lgkmcnt(0)
    ds_read_b64_tr_b16 v[176:177], v24 offset:24576
    ds_read_b64_tr_b16 v[178:179], v24 offset:24832
    ds_read_b64_tr_b16 v[180:181], v24 offset:25088
    ds_read_b64_tr_b16 v[182:183], v24 offset:25344
    ds_read_b64_tr_b16 v[184:185], v24 offset:24608
    ds_read_b64_tr_b16 v[186:187], v24 offset:24864
    ds_read_b64_tr_b16 v[188:189], v24 offset:25120
    ds_read_b64_tr_b16 v[190:191], v24 offset:25376
    s_waitcnt lgkmcnt(0)
    ds_read_b64_tr_b16 v[224:225], v24 offset:28672
    ds_read_b64_tr_b16 v[226:227], v24 offset:28928
    ds_read_b64_tr_b16 v[228:229], v24 offset:29184
    ds_read_b64_tr_b16 v[230:231], v24 offset:29440
    ds_read_b64_tr_b16 v[232:233], v24 offset:28704
    ds_read_b64_tr_b16 v[234:235], v24 offset:28960
    ds_read_b64_tr_b16 v[236:237], v24 offset:29216
    ds_read_b64_tr_b16 v[238:239], v24 offset:29472
    s_waitcnt lgkmcnt(0)
    s_waitcnt vmcnt(16)
    ds_write_b128 v56, v[96:99] offset:0
    ds_write_b128 v56, v[100:103] offset:1024
    ds_write_b128 v56, v[104:107] offset:2048
    ds_write_b128 v56, v[108:111] offset:3072
    ds_write_b128 v56, v[144:147] offset:4096
    ds_write_b128 v56, v[148:151] offset:5120
    ds_write_b128 v56, v[152:155] offset:6144
    ds_write_b128 v56, v[156:159] offset:7168
    ds_write_b128 v56, v[192:195] offset:8192
    ds_write_b128 v56, v[196:199] offset:9216
    ds_write_b128 v56, v[200:203] offset:10240
    ds_write_b128 v56, v[204:207] offset:11264
    ds_write_b128 v56, v[240:243] offset:12288
    ds_write_b128 v56, v[244:247] offset:13312
    ds_write_b128 v56, v[248:251] offset:14336
    ds_write_b128 v56, v[252:255] offset:15360
    s_waitcnt lgkmcnt(0)
    ds_read_b64_tr_b16 v[96:97], v24 offset:0
    ds_read_b64_tr_b16 v[98:99], v24 offset:256
    ds_read_b64_tr_b16 v[100:101], v24 offset:512
    ds_read_b64_tr_b16 v[102:103], v24 offset:768
    ds_read_b64_tr_b16 v[104:105], v24 offset:32
    ds_read_b64_tr_b16 v[106:107], v24 offset:288
    ds_read_b64_tr_b16 v[108:109], v24 offset:544
    ds_read_b64_tr_b16 v[110:111], v24 offset:800
    s_waitcnt lgkmcnt(0)
    ds_read_b64_tr_b16 v[144:145], v24 offset:4096
    ds_read_b64_tr_b16 v[146:147], v24 offset:4352
    ds_read_b64_tr_b16 v[148:149], v24 offset:4608
    ds_read_b64_tr_b16 v[150:151], v24 offset:4864
    ds_read_b64_tr_b16 v[152:153], v24 offset:4128
    ds_read_b64_tr_b16 v[154:155], v24 offset:4384
    ds_read_b64_tr_b16 v[156:157], v24 offset:4640
    ds_read_b64_tr_b16 v[158:159], v24 offset:4896
    s_waitcnt lgkmcnt(0)
    ds_read_b64_tr_b16 v[192:193], v24 offset:8192
    ds_read_b64_tr_b16 v[194:195], v24 offset:8448
    ds_read_b64_tr_b16 v[196:197], v24 offset:8704
    ds_read_b64_tr_b16 v[198:199], v24 offset:8960
    ds_read_b64_tr_b16 v[200:201], v24 offset:8224
    ds_read_b64_tr_b16 v[202:203], v24 offset:8480
    ds_read_b64_tr_b16 v[204:205], v24 offset:8736
    ds_read_b64_tr_b16 v[206:207], v24 offset:8992
    s_waitcnt lgkmcnt(0)
    ds_read_b64_tr_b16 v[240:241], v24 offset:12288
    ds_read_b64_tr_b16 v[242:243], v24 offset:12544
    ds_read_b64_tr_b16 v[244:245], v24 offset:12800
    ds_read_b64_tr_b16 v[246:247], v24 offset:13056
    ds_read_b64_tr_b16 v[248:249], v24 offset:12320
    ds_read_b64_tr_b16 v[250:251], v24 offset:12576
    ds_read_b64_tr_b16 v[252:253], v24 offset:12832
    ds_read_b64_tr_b16 v[254:255], v24 offset:13088
    s_waitcnt lgkmcnt(0)
    v_mov_b32 v21, 0x44444444
    v_mov_b32 v22, 0xeeeeeeee
    v_and_b32 v23, 1, v20
    v_cmp_eq_u32 vcc, 0, v23
    v_and_b32 v27, 255, v0
    v_lshlrev_b32 v2, 2, v27
    v_cndmask_b32 v62, v22, v21, vcc
    s_lshr_b32 s21, s15, 1
    s_sub_u32 s21, s21, s15
    s_add_u32 s21, s21, 4
    s_lshl_b32 s21, s21, 10
    s_and_b32 s22, s15, 1
    s_lshl_b32 s22, s22, 9
    s_add_u32 s21, s21, s22
    s_lshl_b32 s22, s3, 7
    s_add_u32 s21, s21, s22
    v_and_b32 v21, 31, v20
    v_lshlrev_b32 v21, 2, v21
    v_add_u32 v3, s21, v21
    v_lshrrev_b32 v21, 4, v20
    v_and_b32 v22, 15, v20
    v_mul_u32_u24 v21, 208, v21
    v_add_lshl_u32 v21, v21, v22, 2
    s_mul_i32 s21, s3, 3328
    v_add_u32 v4, s21, v21
    v_lshrrev_b32 v21, 4, v20
    v_bfe_u32 v22, v20, 2, 1
    v_lshl_add_u32 v21, v21, 1, v22
    v_mul_u32_u24 v21, 104, v21
    v_bfe_u32 v22, v20, 3, 1
    v_xor_b32 v22, 1, v22
    v_lshl_add_u32 v21, v22, 5, v21
    v_and_b32 v22, 3, v20
    v_lshlrev_b32 v22, 1, v22
    s_and_b32 s21, s3, 1
    s_lshl_b32 s21, s21, 2
    v_xor_b32 v22, s21, v22
    v_add_u32 v21, v21, v22
    s_lshl_b32 s21, s3, 3
    v_add_u32 v21, s21, v21
    v_lshlrev_b32 v5, 2, v21
    s_and_b32 s21, s3, 1
    s_lshl_b32 s21, s21, 2
    v_bfe_u32 v21, v20, 3, 2
    v_add_u32 v21, s21, v21
    v_mul_u32_u24 v21, 104, v21
    v_bfe_u32 v22, v20, 1, 1
    v_lshl_add_u32 v21, v22, 3, v21
    v_and_b32 v23, 1, v20
    v_xor_b32 v22, v22, v23
    v_lshl_add_u32 v21, v22, 2, v21
    v_bfe_u32 v22, v20, 2, 1
    v_lshl_add_u32 v21, v22, 1, v21
    s_lshr_b32 s21, s3, 1
    s_lshl_b32 s21, s21, 4
    s_add_u32 s21, s21, 64
    v_add_u32 v21, s21, v21
    v_lshlrev_b32 v6, 2, v21
    v_lshrrev_b32 v21, 6, v27
    v_bfe_u32 v22, v27, 1, 1
    v_lshrrev_b32 v23, 1, v21
    v_lshl_add_u32 v22, v22, 1, v23
    v_xor_b32 v23, v27, v22
    v_and_b32 v23, 1, v23
    v_and_b32 v21, 1, v21
    v_lshl_add_u32 v21, v21, 1, v23
    v_mul_u32_u24 v21, 544, v21
    v_lshl_add_u32 v21, v22, 5, v21
    v_bfe_u32 v23, v27, 4, 2
    v_mul_u32_u24 v23, 136, v23
    v_add_u32 v21, v21, v23
    v_bfe_u32 v24, v27, 3, 1
    v_lshl_add_u32 v21, v24, 2, v21
    v_bfe_u32 v24, v27, 2, 1
    v_lshl_add_u32 v21, v24, 4, v21
    v_add_u32 v7, 16384, v21
    v_lshlrev_b32 v8, 2, v20
    s_and_b32 s21, s12, 1
    s_lshl_b32 s21, s21, 9
    s_lshl_b32 s22, s3, 7
    s_add_u32 s21, s21, s22
    v_and_b32 v21, 7, v20
    v_lshlrev_b32 v21, 4, v21
    v_add_u32 v21, s21, v21
    v_lshrrev_b32 v22, 3, v20
    v_lshl_add_u32 v12, v22, 10, v21
    v_bfe_u32 v22, v20, 4, 1
    v_lshl_add_u32 v13, v22, 3, v21
    s_and_b32 s21, s3, 1
    s_lshl_b32 s21, s21, 12
    s_lshr_b32 s22, s3, 1
    s_lshl_b32 s22, s22, 11
    s_add_u32 s21, s21, s22
    s_add_u32 s21, s21, 18560
    v_add_u32 v61, s21, v1
    s_lshl_b32 s21, s3, 2
    s_add_u32 s21, s21, 13312
    v_mov_b32 v14, s21
    v_and_b32 v21, 15, v20
    v_and_b32 v22, 1, v20
    v_lshlrev_b32 v22, 4, v22
    v_mov_b32 v23, 0x3f80
    v_lshlrev_b32 v22, v22, v23
    v_lshrrev_b32 v21, 1, v21
    v_cmp_eq_u32 vcc, 0, v21
    s_nop 1
    v_cndmask_b32 v56, 0, v22, vcc
    v_cmp_eq_u32 vcc, 1, v21
    s_nop 1
    v_cndmask_b32 v57, 0, v22, vcc
    v_cmp_eq_u32 vcc, 2, v21
    s_nop 1
    v_cndmask_b32 v58, 0, v22, vcc
    v_cmp_eq_u32 vcc, 3, v21
    s_nop 1
    v_cndmask_b32 v59, 0, v22, vcc
    v_and_b32 v21, 7, v20
    v_lshlrev_b32 v21, 7, v21
    v_bfe_u32 v22, v20, 3, 1
    v_lshl_add_u32 v21, v22, 17, v21
    s_lshl_b32 s21, s12, 14
    s_lshl_b32 s22, s13, 10
    s_add_u32 s21, s21, s22
    s_add_u32 s21, s21, 4980736
    v_lshrrev_b32 v22, 4, v20
    v_lshl_add_u32 v21, v22, 24, v21
    v_add_u32 v63, s21, v21
    s_mov_b32 s47, 0x3e0293ee
    s_lshl_b32 s14, s12, 2
    s_add_u32 s14, s14, s3
    s_lshl_b32 s61, s14, 13
    s_add_u32 s61, s61, 2097152
    s_lshl_b32 s14, s14, 12
    s_and_b32 s22, s13, 1
    s_lshl_b32 s69, s22, 17
    s_add_u32 s69, s69, s14
    s_add_u32 s69, s69, 4194304
    s_add_u32 s52, s14, 20971520
    s_lshl_b32 s21, s22, 11
    s_add_u32 s14, s14, s21
    s_add_u32 s14, s14, 1179648
    s_lshr_b32 s21, s13, 1
    s_sub_u32 s21, s21, 0
    s_cmp_eq_u32 s21, s3
    s_cselect_b32 s15, 1, 0
    v_lshrrev_b32 v21, 4, v20
    v_and_b32 v23, 15, v20
    v_lshlrev_b32 v21, 2, v21
    v_add_u32 v24, 0, v21
    v_cmp_gt_u32 vcc, v24, v23
    s_cmp_eq_u32 s22, 0
    s_cselect_b64 s[38:39], vcc, 0
    s_cselect_b64 s[48:49], -1, vcc
    v_add_u32 v24, 1, v21
    v_cmp_gt_u32 vcc, v24, v23
    s_cmp_eq_u32 s22, 0
    s_cselect_b64 s[40:41], vcc, 0
    s_cselect_b64 s[50:51], -1, vcc
    v_add_u32 v24, 2, v21
    v_cmp_gt_u32 vcc, v24, v23
    s_cmp_eq_u32 s22, 0
    s_cselect_b64 s[42:43], vcc, 0
    s_cselect_b64 s[54:55], -1, vcc
    v_add_u32 v24, 3, v21
    v_cmp_gt_u32 vcc, v24, v23
    s_cmp_eq_u32 s22, 0
    s_cselect_b64 s[44:45], vcc, 0
    s_cselect_b64 s[56:57], -1, vcc
    s_waitcnt vmcnt(0)
    v_mov_b32 v16, v32
    v_mov_b32 v17, v33
    v_mov_b32 v18, v34
    v_mov_b32 v19, v35
    v_mov_b32 v20, v36
    v_mov_b32 v21, v37
    v_mov_b32 v22, v38
    v_mov_b32 v23, v39
    v_mov_b32 v24, v40
    v_mov_b32 v25, v41
    v_mov_b32 v26, v42
    v_mov_b32 v27, v43
    v_mov_b32 v28, v44
    v_mov_b32 v29, v45
    v_mov_b32 v30, v46
    v_mov_b32 v31, v47
    v_mov_b32 v32, -1
    v_mov_b32 v33, -1
    v_mov_b32 v34, -1
    v_mov_b32 v35, -1
    s_add_u32 s21, s37, 3997696
    buffer_store_dwordx4 v[32:35], v1, s[4:7], s21 offen sc1
    s_add_u32 s21, s37, 4063232
    buffer_store_dwordx4 v[32:35], v1, s[4:7], s21 offen sc1
    s_add_u32 s21, s37, 4128768
    buffer_store_dwordx4 v[32:35], v1, s[4:7], s21 offen sc1
    s_lshl_b32 s29, s29, 5
    s_barrier
    ds_write_b32 v14, v10
    ds_write_b32 v14, v10 offset:16
    s_lshl_b32 s53, s3, 13
    s_add_u32 s53, s53, 92160
    v_add_u32 v32, 14336, v1
    ds_write_b128 v32, v[56:59]
    s_lshl_b32 s60, s12, 4
    s_add_u32 s60, s60, 218104320
    v_mov_b32 v15, 0
    s_add_u32 s25, s16, 0
    s_min_u32 s25, s25, 63
    s_cmp_lt_u32 s25, 8
    s_cselect_b32 s59, 12, 24
    s_cselect_b32 s58, -4, -8
    s_and_b32 s25, s25, s58
    s_lshl_b32 s25, s25, 5
    s_add_u32 s58, s25, s60
    v_mov_b32 v32, 131072
    s_waitcnt vmcnt(0) lgkmcnt(0)
    s_barrier
    ds_read_b64 v[32:33], v32
    s_waitcnt lgkmcnt(0)
    v_cmp_ne_u32 vcc, s29, v32
    s_setprio 3
    v_readfirstlane_b32 s63, v33
    s_add_u32 s34, s34, s63
    s_add_u32 s35, s35, s63
gate_6:
    v_readfirstlane_b32 s25, v15
    s_cmp_ge_u32 s25, s59
    s_cbranch_scc1 gate_6_ok
    s_sleep 8
    buffer_load_dword v15, off, s[4:7], s58 sc1
    s_waitcnt vmcnt(0)
    s_sub_u32 s26, s26, 1
    s_cbranch_scc0 gate_6
    s_mov_b32 s26, 0
gate_6_ok:
    s_add_u32 m0, s53, 0
    s_add_u32 s22, s52, 0
    buffer_load_dwordx4 v1, s[4:7], s22 offen offset:0 sc1 lds
    buffer_load_dwordx4 v1, s[4:7], s22 offen offset:1024 sc1 lds
    buffer_load_dwordx4 v1, s[4:7], s22 offen offset:2048 sc1 lds
    buffer_load_dwordx4 v1, s[4:7], s22 offen offset:3072 sc1 lds
    s_add_u32 m0, s53, 4096
    s_add_u32 s22, s52, 131072
    buffer_load_dwordx4 v1, s[4:7], s22 offen offset:0 sc1 lds
    buffer_load_dwordx4 v1, s[4:7], s22 offen offset:1024 sc1 lds
    buffer_load_dwordx4 v1, s[4:7], s22 offen offset:2048 sc1 lds
    buffer_load_dwordx4 v1, s[4:7], s22 offen offset:3072 sc1 lds
    s_add_u32 s52, s52, 262144
    s_cmp_eq_u32 s15, 0
    s_cbranch_scc1 ch_p_nd
    s_mov_b32 m0, 124928
    s_nop 0
    buffer_load_dwordx4 v1, s[4:7], s69 offen offset:0 sc1 lds
    buffer_load_dwordx4 v1, s[4:7], s69 offen offset:1024 sc1 lds
    buffer_load_dwordx4 v1, s[4:7], s69 offen offset:2048 sc1 lds
    buffer_load_dwordx4 v1, s[4:7], s69 offen offset:3072 sc1 lds
    s_add_u32 s69, s69, 262144
ch_p_nd:
    s_cbranch_vccnz ch_p_slow
    v_mov_b32 v32, 0
    v_mov_b32 v33, 0
    v_mov_b32 v34, 0
    v_mov_b32 v35, 0
    v_mov_b32 v36, 0
    v_mov_b32 v37, 0
    v_mov_b32 v38, 0
    v_mov_b32 v39, 0
    v_mov_b32 v40, 0
    v_mov_b32 v41, 0
    v_mov_b32 v42, 0
    v_mov_b32 v43, 0
    v_mov_b32 v44, 0
    v_mov_b32 v45, 0
    v_mov_b32 v46, 0
    v_mov_b32 v47, 0
    v_mov_b32 v48, 0
    v_mov_b32 v49, 0
    v_mov_b32 v50, 0
    v_mov_b32 v51, 0
    v_mov_b32 v52, 0
    v_mov_b32 v53, 0
    v_mov_b32 v54, 0
    v_mov_b32 v55, 0
    v_mov_b32 v60, s16
    s_branch pnc_8
.p2align 6
ploop_7:
    s_add_u32 s21, s17, s33
    v_mov_b32 v32, 0
    v_mov_b32 v33, 0
    v_mov_b32 v34, 0
    v_mov_b32 v35, 0
    v_mov_b32 v36, 0
    v_mov_b32 v37, 0
    v_mov_b32 v38, 0
    v_mov_b32 v39, 0
    v_mov_b32 v40, 0
    v_mov_b32 v41, 0
    v_mov_b32 v42, 0
    v_mov_b32 v43, 0
    v_mov_b32 v44, 0
    v_mov_b32 v45, 0
    v_mov_b32 v46, 0
    v_mov_b32 v47, 0
    v_mov_b32 v48, 0
    v_mov_b32 v49, 0
    v_mov_b32 v50, 0
    v_mov_b32 v51, 0
    v_mov_b32 v52, 0
    v_mov_b32 v53, 0
    v_mov_b32 v54, 0
    v_mov_b32 v55, 0
    s_nop 15
    s_nop 8
    buffer_load_dwordx4 v[16:19], v1, s[4:7], s21 offen offset:0 sc1
    s_nop 7
    buffer_load_dwordx4 v[20:23], v1, s[4:7], s21 offen offset:1024 sc1
    s_nop 7
    buffer_load_dwordx4 v[24:27], v1, s[4:7], s21 offen offset:2048 sc1
    s_nop 7
    buffer_load_dwordx4 v[28:31], v1, s[4:7], s21 offen offset:3072 sc1
    s_waitcnt vmcnt(3)
    v_max3_u32 v9, v16, v17, v18
    v_max_u32 v9, v9, v19
    v_cmp_eq_u32 vcc, -1, v9
    s_cbranch_vccnz prm_10_0
prm_10_0ok:
    v_smfmac_f32_16x16x64_bf16 v[32:35], v[16:19], v[64:71], v62
    v_smfmac_f32_16x16x64_bf16 v[36:39], v[16:19], v[72:79], v62
    s_waitcnt vmcnt(2)
    v_max3_u32 v9, v20, v21, v22
    v_max_u32 v9, v9, v23
    v_cmp_eq_u32 vcc, -1, v9
    v_smfmac_f32_16x16x64_bf16 v[40:43], v[16:19], v[80:87], v62
    v_smfmac_f32_16x16x64_bf16 v[44:47], v[16:19], v[88:95], v62
    v_smfmac_f32_16x16x64_bf16 v[48:51], v[16:19], v[96:103], v62
    v_smfmac_f32_16x16x64_bf16 v[52:55], v[16:19], v[104:111], v62
    s_cbranch_vccnz prm_10_1
prm_10_1ok:
    v_smfmac_f32_16x16x64_bf16 v[32:35], v[20:23], v[112:119], v62
    v_smfmac_f32_16x16x64_bf16 v[36:39], v[20:23], v[120:127], v62
    s_waitcnt vmcnt(1)
    v_max3_u32 v9, v24, v25, v26
    v_max_u32 v9, v9, v27
    v_cmp_eq_u32 vcc, -1, v9
    v_smfmac_f32_16x16x64_bf16 v[40:43], v[20:23], v[128:135], v62
    v_smfmac_f32_16x16x64_bf16 v[44:47], v[20:23], v[136:143], v62
    v_smfmac_f32_16x16x64_bf16 v[48:51], v[20:23], v[144:151], v62
    v_smfmac_f32_16x16x64_bf16 v[52:55], v[20:23], v[152:159], v62
    s_cbranch_vccnz prm_10_2
prm_10_2ok:
    v_smfmac_f32_16x16x64_bf16 v[32:35], v[24:27], v[160:167], v62
    v_smfmac_f32_16x16x64_bf16 v[36:39], v[24:27], v[168:175], v62
    s_waitcnt vmcnt(0)
    v_max3_u32 v9, v28, v29, v30
    v_max_u32 v9, v9, v31
    v_cmp_eq_u32 vcc, -1, v9
    v_smfmac_f32_16x16x64_bf16 v[40:43], v[24:27], v[176:183], v62
    v_smfmac_f32_16x16x64_bf16 v[44:47], v[24:27], v[184:191], v62
    v_smfmac_f32_16x16x64_bf16 v[48:51], v[24:27], v[192:199], v62
    v_smfmac_f32_16x16x64_bf16 v[52:55], v[24:27], v[200:207], v62
    s_cbranch_vccnz prm_10_3
prm_10_3ok:
    v_smfmac_f32_16x16x64_bf16 v[32:35], v[28:31], v[208:215], v62
    ds_write_b32 v14, v60
    v_smfmac_f32_16x16x64_bf16 v[36:39], v[28:31], v[216:223], v62
    v_smfmac_f32_16x16x64_bf16 v[40:43], v[28:31], v[224:231], v62
    v_smfmac_f32_16x16x64_bf16 v[44:47], v[28:31], v[232:239], v62
    v_smfmac_f32_16x16x64_bf16 v[48:51], v[28:31], v[240:247], v62
    v_add_f32 v32, v32, v33
    v_add_f32 v34, v34, v35
    ds_write2_b32 v4, v32, v34 offset0:0 offset1:104
    v_smfmac_f32_16x16x64_bf16 v[52:55], v[28:31], v[248:255], v62
    v_add_f32 v36, v36, v37
    v_add_f32 v38, v38, v39
    ds_write2_b32 v4, v36, v38 offset0:16 offset1:120
    v_add_f32 v40, v40, v41
    v_add_f32 v42, v42, v43
    ds_write2_b32 v4, v40, v42 offset0:32 offset1:136
    v_add_f32 v44, v44, v45
    v_add_f32 v46, v46, v47
    ds_write2_b32 v4, v44, v46 offset0:48 offset1:152
    v_add_f32 v48, v48, v49
    v_add_f32 v50, v50, v51
    ds_write2_b32 v4, v48, v50 offset0:64 offset1:168
    v_add_f32 v52, v52, v53
    v_add_f32 v54, v54, v55
    ds_write2_b32 v4, v52, v54 offset0:80 offset1:184
    s_branch pnc_8_done
pnc_8:
    v_smfmac_f32_16x16x64_bf16 v[32:35], v[16:19], v[64:71], v62
    v_smfmac_f32_16x16x64_bf16 v[36:39], v[16:19], v[72:79], v62
    v_smfmac_f32_16x16x64_bf16 v[40:43], v[16:19], v[80:87], v62
    v_smfmac_f32_16x16x64_bf16 v[44:47], v[16:19], v[88:95], v62
    v_smfmac_f32_16x16x64_bf16 v[48:51], v[16:19], v[96:103], v62
    v_smfmac_f32_16x16x64_bf16 v[52:55], v[16:19], v[104:111], v62
    v_smfmac_f32_16x16x64_bf16 v[32:35], v[20:23], v[112:119], v62
    v_smfmac_f32_16x16x64_bf16 v[36:39], v[20:23], v[120:127], v62
    v_smfmac_f32_16x16x64_bf16 v[40:43], v[20:23], v[128:135], v62
    v_smfmac_f32_16x16x64_bf16 v[44:47], v[20:23], v[136:143], v62
    v_smfmac_f32_16x16x64_bf16 v[48:51], v[20:23], v[144:151], v62
    v_smfmac_f32_16x16x64_bf16 v[52:55], v[20:23], v[152:159], v62
    v_smfmac_f32_16x16x64_bf16 v[32:35], v[24:27], v[160:167], v62
    v_smfmac_f32_16x16x64_bf16 v[36:39], v[24:27], v[168:175], v62
    v_smfmac_f32_16x16x64_bf16 v[40:43], v[24:27], v[176:183], v62
    v_smfmac_f32_16x16x64_bf16 v[44:47], v[24:27], v[184:191], v62
    v_smfmac_f32_16x16x64_bf16 v[48:51], v[24:27], v[192:199], v62
    v_smfmac_f32_16x16x64_bf16 v[52:55], v[24:27], v[200:207], v62
    v_smfmac_f32_16x16x64_bf16 v[32:35], v[28:31], v[208:215], v62
    ds_write_b32 v14, v60
    v_smfmac_f32_16x16x64_bf16 v[36:39], v[28:31], v[216:223], v62
    v_smfmac_f32_16x16x64_bf16 v[40:43], v[28:31], v[224:231], v62
    v_smfmac_f32_16x16x64_bf16 v[44:47], v[28:31], v[232:239], v62
    v_smfmac_f32_16x16x64_bf16 v[48:51], v[28:31], v[240:247], v62
    v_add_f32 v32, v32, v33
    v_add_f32 v34, v34, v35
    ds_write2_b32 v4, v32, v34 offset0:0 offset1:104
    v_smfmac_f32_16x16x64_bf16 v[52:55], v[28:31], v[248:255], v62
    v_add_f32 v36, v36, v37
    v_add_f32 v38, v38, v39
    ds_write2_b32 v4, v36, v38 offset0:16 offset1:120
    v_add_f32 v40, v40, v41
    v_add_f32 v42, v42, v43
    ds_write2_b32 v4, v40, v42 offset0:32 offset1:136
    v_add_f32 v44, v44, v45
    v_add_f32 v46, v46, v47
    ds_write2_b32 v4, v44, v46 offset0:48 offset1:152
    v_add_f32 v48, v48, v49
    v_add_f32 v50, v50, v51
    ds_write2_b32 v4, v48, v50 offset0:64 offset1:168
    v_add_f32 v52, v52, v53
    v_add_f32 v54, v54, v55
    ds_write2_b32 v4, v52, v54 offset0:80 offset1:184
    s_waitcnt vmcnt(0)
pnc_8_done:
    s_add_u32 s21, s17, s32
    s_add_u32 s22, s19, s32
    s_add_u32 s24, s19, s35
    s_waitcnt lgkmcnt(0)
    s_barrier
    ds_read_b64 v[16:17], v5 offset:0
    ds_read_b64 v[18:19], v5 offset:3328
    ds_read_b64 v[20:21], v5 offset:6656
    ds_read_b64 v[22:23], v5 offset:9984
    ds_read_b64 v[24:25], v6 offset:0
    ds_read_b64 v[26:27], v6 offset:3328
    ds_read_b64 v[28:29], v6 offset:6656
    ds_read_b64 v[30:31], v6 offset:9984
    s_waitcnt lgkmcnt(6)
    v_add_f32 v16, v16, v18
    v_add_f32 v17, v17, v19
    s_waitcnt lgkmcnt(4)
    v_add_f32 v20, v20, v22
    v_add_f32 v21, v21, v23
    v_add_f32 v16, v16, v20
    v_add_f32 v17, v17, v21
    v_cvt_pk_bf16_f32 v16, v16, v17
    v_min_u32 v16, -2, v16
    buffer_store_dword v16, v2, s[4:7], s21 offen
    s_waitcnt lgkmcnt(2)
    v_add_f32 v24, v24, v26
    v_add_f32 v25, v25, v27
    s_waitcnt lgkmcnt(0)
    v_add_f32 v28, v28, v30
    v_add_f32 v29, v29, v31
    v_add_f32 v24, v24, v28
    v_add_f32 v25, v25, v29
    v_cvt_pk_bf16_f32 v24, v24, v25
    v_min_u32 v24, -2, v24
    s_mov_b32 exec_hi, 0
    buffer_store_dword v24, v3, s[4:7], s21 offen
    s_setprio 0
    s_add_u32 s23, s20, s36
    buffer_store_dword v10, v3, s[4:7], s22 offen
    s_mov_b32 exec_lo, 0x00ff00ff
    buffer_store_dwordx2 v[10:11], v13, s[4:7], s23 offen
    s_mov_b64 exec, -1
    buffer_store_dword v10, v2, s[4:7], s22 offen
    s_add_u32 s21, s17, s35
    s_add_u32 s30, s17, s34
    s_add_u32 s23, s18, s36
gate_12:
    v_readfirstlane_b32 s25, v15
    s_cmp_ge_u32 s25, s59
    s_cbranch_scc1 gate_12_ok
    s_sleep 8
    buffer_load_dword v15, off, s[4:7], s58 sc1
    s_waitcnt vmcnt(0)
    s_sub_u32 s26, s26, 1
    s_cbranch_scc0 gate_12
    s_mov_b32 s26, 0
gate_12_ok:
    s_add_u32 s25, s16, 3
    s_min_u32 s25, s25, 63
    s_cmp_lt_u32 s25, 8
    s_cselect_b32 s59, 12, 24
    s_cselect_b32 s58, -4, -8
    s_and_b32 s25, s25, s58
    s_lshl_b32 s25, s25, 5
    s_add_u32 s58, s25, s60
    s_cmp_eq_u32 s15, 0
    s_cbranch_scc1 ploop_7_nd
    v_add_u32 v9, s53, v1
    v_add_u32 v0, 124928, v1
    ds_read_b128 v[16:19], v0 offset:0
    ds_read_b128 v[32:35], v9 offset:0
    ds_read_b128 v[20:23], v0 offset:1024
    ds_read_b128 v[36:39], v9 offset:1024
    ds_read_b128 v[24:27], v0 offset:2048
    ds_read_b128 v[40:43], v9 offset:2048
    ds_read_b128 v[28:31], v0 offset:3072
    ds_read_b128 v[44:47], v9 offset:3072
    s_add_u32 s22, s17, s61
    s_waitcnt lgkmcnt(6)
    v_mfma_f32_16x16x32_bf16 v[48:51], v[32:35], v[16:19], 0
    ds_read_b128 v[32:35], v9 offset:4096
    s_waitcnt lgkmcnt(5)
    v_mfma_f32_16x16x32_bf16 v[48:51], v[36:39], v[20:23], v[48:51]
    ds_read_b128 v[36:39], v9 offset:5120
    s_waitcnt lgkmcnt(4)
    v_mfma_f32_16x16x32_bf16 v[48:51], v[40:43], v[24:27], v[48:51]
    ds_read_b128 v[40:43], v9 offset:6144
    s_waitcnt lgkmcnt(3)
    v_mfma_f32_16x16x32_bf16 v[48:51], v[44:47], v[28:31], v[48:51]
    ds_read_b128 v[44:47], v9 offset:7168
    s_waitcnt lgkmcnt(3)
    v_mfma_f32_16x16x32_bf16 v[52:55], v[32:35], v[16:19], 0
    s_waitcnt lgkmcnt(2)
    v_mfma_f32_16x16x32_bf16 v[52:55], v[36:39], v[20:23], v[52:55]
    s_waitcnt lgkmcnt(1)
    v_mfma_f32_16x16x32_bf16 v[52:55], v[40:43], v[24:27], v[52:55]
    s_waitcnt lgkmcnt(0)
    v_mfma_f32_16x16x32_bf16 v[52:55], v[44:47], v[28:31], v[52:55]
    buffer_load_dwordx4 v[32:35], v1, s[4:7], s22 offen offset:0 sc1
    buffer_load_dwordx4 v[36:39], v1, s[4:7], s22 offen offset:1024 sc1
    buffer_load_dwordx4 v[40:43], v1, s[4:7], s22 offen offset:2048 sc1
    buffer_load_dwordx4 v[44:47], v1, s[4:7], s22 offen offset:3072 sc1
    v_mov_b32 v60, 0xff61b1e6
    s_nop 2
    v_cndmask_b32 v48, v48, v60, s[38:39]
    v_cndmask_b32 v49, v49, v60, s[40:41]
    v_cndmask_b32 v50, v50, v60, s[42:43]
    v_cndmask_b32 v51, v51, v60, s[44:45]
    v_cndmask_b32 v52, v52, v60, s[48:49]
    v_cndmask_b32 v53, v53, v60, s[50:51]
    v_cndmask_b32 v54, v54, v60, s[54:55]
    v_cndmask_b32 v55, v55, v60, s[56:57]
    v_max3_f32 v0, v48, v49, v50
    v_max3_f32 v9, v51, v52, v53
    v_max3_f32 v0, v0, v54, v55
    v_max_f32 v0, v0, v9
    v_mov_b32 v9, v0
    s_nop 1
    v_permlane16_swap_b32 v9, v0
    v_max_f32 v0, v0, v9
    v_mov_b32 v9, v0
    s_nop 1
    v_permlane32_swap_b32 v9, v0
    v_max_f32 v0, v0, v9
    v_mul_f32 v0, s47, v0
    v_fma_f32 v48, v48, s47, -v0
    v_fma_f32 v49, v49, s47, -v0
    v_fma_f32 v50, v50, s47, -v0
    v_fma_f32 v51, v51, s47, -v0
    v_fma_f32 v52, v52, s47, -v0
    v_fma_f32 v53, v53, s47, -v0
    v_fma_f32 v54, v54, s47, -v0
    v_fma_f32 v55, v55, s47, -v0
    v_exp_f32 v48, v48
    v_exp_f32 v49, v49
    v_exp_f32 v50, v50
    v_exp_f32 v51, v51
    v_exp_f32 v52, v52
    v_exp_f32 v53, v53
    v_exp_f32 v54, v54
    v_exp_f32 v55, v55
    v_add_f32 v15, v48, v49
    v_add_f32 v15, v15, v50
    v_add_f32 v15, v15, v51
    v_add_f32 v15, v15, v52
    v_add_f32 v15, v15, v53
    v_add_f32 v15, v15, v54
    v_add_f32 v15, v15, v55
ploop_7_za:
    s_waitcnt vmcnt(0)
    v_max3_u32 v9, v32, v33, v34
    v_max3_u32 v9, v9, v35, v36
    v_max3_u32 v9, v9, v37, v38
    v_max3_u32 v9, v9, v39, v40
    v_max3_u32 v9, v9, v41, v42
    v_max3_u32 v9, v9, v43, v44
    v_max3_u32 v9, v9, v45, v46
    v_max_u32 v9, v9, v47
    v_cmp_eq_u32 vcc, -1, v9
    s_cbranch_vccnz ploop_7_zr
ploop_7_zok:
    v_mfma_f32_16x16x32_bf16 v[56:59], v[32:35], v[16:19], 0
    v_mfma_f32_16x16x32_bf16 v[56:59], v[36:39], v[20:23], v[56:59]
    v_mfma_f32_16x16x32_bf16 v[56:59], v[40:43], v[24:27], v[56:59]
    v_mfma_f32_16x16x32_bf16 v[56:59], v[44:47], v[28:31], v[56:59]
    s_nop 7
    v_max_f32 v60, v56, v57
    v_mov_b32 v9, v60
    s_nop 1
    v_permlane16_swap_b32 v9, v60
    v_max_f32 v60, v60, v9
    v_mov_b32 v9, v60
    s_nop 1
    v_permlane32_swap_b32 v9, v60
    v_max_f32 v60, v60, v9
    v_mul_f32 v60, s47, v60
    v_max_f32 v58, v60, v0
    v_sub_f32 v60, v0, v58
    v_fma_f32 v56, v56, s47, -v58
    v_fma_f32 v57, v57, s47, -v58
    v_exp_f32 v60, v60
    v_exp_f32 v56, v56
    v_exp_f32 v57, v57
    v_fma_f32 v15, v15, v60, v56
    v_add_f32 v15, v15, v57
    v_mov_b32 v9, v15
    s_nop 1
    v_permlane16_swap_b32 v9, v15
    v_add_f32 v15, v15, v9
    v_mov_b32 v9, v15
    s_nop 1
    v_permlane32_swap_b32 v9, v15
    v_add_f32 v15, v15, v9
    v_rcp_f32 v15, v15
    s_add_u32 s22, s17, s14
    s_add_u32 s25, s19, s14
    v_add_u32 v9, 14336, v1
    v_mul_f32 v60, v60, v15
    v_mul_f32 v56, v56, v15
    v_mul_f32 v57, v57, v15
    v_mul_f32 v48, v48, v60
    v_mul_f32 v49, v49, v60
    v_mul_f32 v50, v50, v60
    v_mul_f32 v51, v51, v60
    v_mul_f32 v52, v52, v60
    v_mul_f32 v53, v53, v60
    v_mul_f32 v54, v54, v60
    v_mul_f32 v55, v55, v60
    v_cvt_pk_bf16_f32 v48, v48, v49
    v_cvt_pk_bf16_f32 v49, v50, v51
    v_cvt_pk_bf16_f32 v50, v52, v53
    v_cvt_pk_bf16_f32 v51, v54, v55
    v_cvt_pk_bf16_f32 v52, v56, v57
    v_min_u32 v48, -2, v48
    v_min_u32 v49, -2, v49
    v_min_u32 v50, -2, v50
    v_min_u32 v51, -2, v51
    v_min_u32 v52, -2, v52
    buffer_store_dwordx4 v[48:51], v1, s[4:7], s22 offen
    buffer_store_dword v52, v8, s[4:7], s22 offen offset:1024
    ds_read_b128 v[56:59], v9
    s_branch ploop_7_nd2
ploop_7_nd:
ploop_7_flag:
    ds_read_b32 v9, v14 offset:16
    s_waitcnt lgkmcnt(0)
    v_readfirstlane_b32 s25, v9
    s_cmp_eq_u32 s25, s16
    s_cbranch_scc0 ploop_7_flag
    s_add_u32 m0, s53, 0
    s_add_u32 s22, s52, 0
    buffer_load_dwordx4 v1, s[4:7], s22 offen offset:0 sc1 lds
    buffer_load_dwordx4 v1, s[4:7], s22 offen offset:1024 sc1 lds
    buffer_load_dwordx4 v1, s[4:7], s22 offen offset:2048 sc1 lds
    buffer_load_dwordx4 v1, s[4:7], s22 offen offset:3072 sc1 lds
    s_add_u32 m0, s53, 4096
    s_add_u32 s22, s52, 131072
    buffer_load_dwordx4 v1, s[4:7], s22 offen offset:0 sc1 lds
    buffer_load_dwordx4 v1, s[4:7], s22 offen offset:1024 sc1 lds
    buffer_load_dwordx4 v1, s[4:7], s22 offen offset:2048 sc1 lds
    buffer_load_dwordx4 v1, s[4:7], s22 offen offset:3072 sc1 lds
    s_add_u32 s52, s52, 262144
ploop_7_nd2:
    s_cmp_lg_u32 s3, 2
    s_cbranch_scc1 ppf_13
    s_lshl_b32 s22, s16, 18
    s_mov_b32 exec_hi, 0xffff
    buffer_load_dword v0, v63, s[4:7], s22 offen sc1
    buffer_load_dword v0, v63, s[4:7], s22 offen offset:64 sc1
    s_mov_b32 exec_hi, -1
ppf_13:
    v_add_u32 v24, 18560, v7
    v_add_u32 v25, 37120, v7
    v_add_u32 v26, 55680, v7
    s_cmp_eq_u32 s16, 63
    s_setprio 3
    s_barrier
    s_cbranch_scc1 ptail_9
    ds_read2_b32 v[16:17], v7 offset0:0 offset1:2
    ds_read2_b32 v[18:19], v24 offset0:0 offset1:2
    ds_read2_b32 v[20:21], v25 offset0:0 offset1:2
    ds_read2_b32 v[22:23], v26 offset0:0 offset1:2
    s_waitcnt lgkmcnt(2)
    v_add_f32 v16, v16, v18
    v_add_f32 v17, v17, v19
    s_waitcnt lgkmcnt(0)
    v_add_f32 v20, v20, v22
    v_add_f32 v21, v21, v23
    v_add_f32 v16, v16, v20
    v_add_f32 v17, v17, v21
    v_cvt_pk_bf16_f32 v16, v16, v17
    v_min_u32 v16, -2, v16
    buffer_store_dword v16, v2, s[4:7], s21 offen sc1
    buffer_store_dword v10, v2, s[4:7], s24 offen sc1
    s_cmp_eq_u32 s15, 0
    s_cbranch_scc1 ploop_7_pnd
    s_sleep 6
    s_nop 8
    buffer_load_dwordx4 v[16:19], v12, s[4:7], s30 offen sc1
    buffer_load_dword v15, off, s[4:7], s58 sc1
    v_mov_b32 v20, -1
    v_mov_b32 v21, -1
    v_mov_b32 v22, -1
    v_mov_b32 v23, -1
    buffer_store_dwordx4 v[20:23], v1, s[4:7], s25 offen
    buffer_store_dword v20, v8, s[4:7], s25 offen offset:1024
    s_mov_b32 m0, 124928
    s_nop 0
    buffer_load_dwordx4 v1, s[4:7], s69 offen offset:0 sc1 lds
    buffer_load_dwordx4 v1, s[4:7], s69 offen offset:1024 sc1 lds
    buffer_load_dwordx4 v1, s[4:7], s69 offen offset:2048 sc1 lds
    buffer_load_dwordx4 v1, s[4:7], s69 offen offset:3072 sc1 lds
    s_add_u32 s69, s69, 262144
    s_add_u32 m0, s53, 0
    s_add_u32 s22, s52, 0
    buffer_load_dwordx4 v1, s[4:7], s22 offen offset:0 sc1 lds
    buffer_load_dwordx4 v1, s[4:7], s22 offen offset:1024 sc1 lds
    buffer_load_dwordx4 v1, s[4:7], s22 offen offset:2048 sc1 lds
    buffer_load_dwordx4 v1, s[4:7], s22 offen offset:3072 sc1 lds
    s_add_u32 m0, s53, 4096
    s_add_u32 s22, s52, 131072
    buffer_load_dwordx4 v1, s[4:7], s22 offen offset:0 sc1 lds
    buffer_load_dwordx4 v1, s[4:7], s22 offen offset:1024 sc1 lds
    buffer_load_dwordx4 v1, s[4:7], s22 offen offset:2048 sc1 lds
    buffer_load_dwordx4 v1, s[4:7], s22 offen offset:3072 sc1 lds
    s_add_u32 s52, s52, 262144
    s_add_u32 s22, s16, 1
    v_mov_b32 v60, s22
    s_cmp_eq_u32 s16, 0
    s_cbranch_scc1 ploop_7_pagain
    v_add_u32 v55, s68, v61
    s_xor_b32 s68, s68, 8192
    ds_read_b128 v[24:27], v55 offset:0
    ds_read_b128 v[28:31], v55 offset:1024
    ds_read_b128 v[32:35], v55 offset:18560
    ds_read_b128 v[36:39], v55 offset:19584
    ds_read_b128 v[40:43], v55 offset:37120
    ds_read_b128 v[44:47], v55 offset:38144
    ds_read_b128 v[48:51], v55 offset:55680
    ds_read_b128 v[52:55], v55 offset:56704
    s_waitcnt lgkmcnt(4)
    v_add_f32 v24, v24, v32
    v_add_f32 v25, v25, v33
    v_add_f32 v26, v26, v34
    v_add_f32 v27, v27, v35
    v_add_f32 v28, v28, v36
    v_add_f32 v29, v29, v37
    v_add_f32 v30, v30, v38
    v_add_f32 v31, v31, v39
    s_waitcnt lgkmcnt(0)
    v_add_f32 v40, v40, v48
    v_add_f32 v41, v41, v49
    v_add_f32 v42, v42, v50
    v_add_f32 v43, v43, v51
    v_add_f32 v44, v44, v52
    v_add_f32 v45, v45, v53
    v_add_f32 v46, v46, v54
    v_add_f32 v47, v47, v55
    v_add_f32 v24, v24, v40
    v_add_f32 v25, v25, v41
    v_add_f32 v26, v26, v42
    v_add_f32 v27, v27, v43
    v_add_f32 v28, v28, v44
    v_add_f32 v29, v29, v45
    v_add_f32 v30, v30, v46
    v_add_f32 v31, v31, v47
    v_cvt_pk_bf16_f32 v24, v24, v25
    v_cvt_pk_bf16_f32 v25, v26, v27
    v_cvt_pk_bf16_f32 v26, v28, v29
    v_cvt_pk_bf16_f32 v27, v30, v31
    v_min_u32 v24, -2, v24
    v_min_u32 v25, -2, v25
    v_min_u32 v26, -2, v26
    v_min_u32 v27, -2, v27
    buffer_store_dwordx4 v[24:27], v1, s[4:7], s37 offen sc1
    s_add_u32 s37, s37, 65536
    s_waitcnt vmcnt(16) lgkmcnt(0)
    s_branch ploop_7_pchk
ploop_7_pnd:
    s_sleep 6
    s_nop 8
    buffer_load_dwordx4 v[16:19], v12, s[4:7], s30 offen sc1
    buffer_load_dword v15, off, s[4:7], s58 sc1
    s_add_u32 s22, s16, 1
    v_mov_b32 v60, s22
    s_cmp_eq_u32 s16, 0
    s_cbranch_scc1 ploop_7_pagain
    v_add_u32 v55, s68, v61
    s_xor_b32 s68, s68, 8192
    ds_read_b128 v[24:27], v55 offset:0
    ds_read_b128 v[28:31], v55 offset:1024
    ds_read_b128 v[32:35], v55 offset:18560
    ds_read_b128 v[36:39], v55 offset:19584
    ds_read_b128 v[40:43], v55 offset:37120
    ds_read_b128 v[44:47], v55 offset:38144
    ds_read_b128 v[48:51], v55 offset:55680
    ds_read_b128 v[52:55], v55 offset:56704
    s_waitcnt lgkmcnt(4)
    v_add_f32 v24, v24, v32
    v_add_f32 v25, v25, v33
    v_add_f32 v26, v26, v34
    v_add_f32 v27, v27, v35
    v_add_f32 v28, v28, v36
    v_add_f32 v29, v29, v37
    v_add_f32 v30, v30, v38
    v_add_f32 v31, v31, v39
    s_waitcnt lgkmcnt(0)
    v_add_f32 v40, v40, v48
    v_add_f32 v41, v41, v49
    v_add_f32 v42, v42, v50
    v_add_f32 v43, v43, v51
    v_add_f32 v44, v44, v52
    v_add_f32 v45, v45, v53
    v_add_f32 v46, v46, v54
    v_add_f32 v47, v47, v55
    v_add_f32 v24, v24, v40
    v_add_f32 v25, v25, v41
    v_add_f32 v26, v26, v42
    v_add_f32 v27, v27, v43
    v_add_f32 v28, v28, v44
    v_add_f32 v29, v29, v45
    v_add_f32 v30, v30, v46
    v_add_f32 v31, v31, v47
    v_cvt_pk_bf16_f32 v24, v24, v25
    v_cvt_pk_bf16_f32 v25, v26, v27
    v_cvt_pk_bf16_f32 v26, v28, v29
    v_cvt_pk_bf16_f32 v27, v30, v31
    v_min_u32 v24, -2, v24
    v_min_u32 v25, -2, v25
    v_min_u32 v26, -2, v26
    v_min_u32 v27, -2, v27
    buffer_store_dwordx4 v[24:27], v1, s[4:7], s37 offen sc1
    s_add_u32 s37, s37, 65536
    s_waitcnt vmcnt(2) lgkmcnt(0)
    s_branch ploop_7_pchk
ploop_7_pagain:
    s_waitcnt vmcnt(1) lgkmcnt(0)
ploop_7_pchk:
    v_mfma_f32_16x16x32_bf16 v[20:23], v[56:59], v[16:19], 0
    v_max3_u32 v9, v16, v17, v18
    v_max_u32 v9, v9, v19
    v_cmp_eq_u32 vcc, -1, v9
    s_cbranch_vccnz prp_11
ploop_7_pgo:
    s_nop 3
    v_add_f32_dpp v20, v20, v20 row_ror:8 row_mask:0xf bank_mask:0xf
    v_add_f32_dpp v21, v21, v21 row_ror:8 row_mask:0xf bank_mask:0xf
    v_add_f32_dpp v22, v22, v22 row_ror:8 row_mask:0xf bank_mask:0xf
    v_add_f32_dpp v23, v23, v23 row_ror:8 row_mask:0xf bank_mask:0xf
    v_cvt_pk_bf16_f32 v20, v20, v21
    v_cvt_pk_bf16_f32 v21, v22, v23
    s_mov_b32 exec_hi, 0
    v_min_u32 v20, -2, v20
    v_min_u32 v21, -2, v21
    s_mov_b32 exec_lo, 0x00ff00ff
    buffer_store_dwordx2 v[20:21], v13, s[4:7], s23 offen
    s_mov_b64 exec, -1
    s_add_u32 s16, s16, 1
    s_mov_b32 s17, s18
    s_mov_b32 s18, s19
    s_mov_b32 s19, s20
    s_add_u32 s20, s20, 262144
    s_cmp_eq_u32 s20, 210763776
    s_cselect_b32 s20, 209715200, s20
    s_branch ploop_7
prm_10_0:
    s_sub_u32 s26, s26, 1
    s_cbranch_scc1 prm_10_0_g
    buffer_load_dwordx4 v[16:19], v1, s[4:7], s21 offen offset:0 sc1
    buffer_load_dwordx4 v[20:23], v1, s[4:7], s21 offen offset:1024 sc1
    buffer_load_dwordx4 v[24:27], v1, s[4:7], s21 offen offset:2048 sc1
    buffer_load_dwordx4 v[28:31], v1, s[4:7], s21 offen offset:3072 sc1
    s_waitcnt vmcnt(3)
    v_max3_u32 v9, v16, v17, v18
    v_max_u32 v9, v9, v19
    v_cmp_eq_u32 vcc, -1, v9
    s_cbranch_vccnz prm_10_0
    s_branch prm_10_0ok
prm_10_0_g:
    s_mov_b32 s26, 0
    s_waitcnt vmcnt(0)
    s_branch prm_10_0ok
prm_10_1:
    s_sub_u32 s26, s26, 1
    s_cbranch_scc1 prm_10_1_g
    buffer_load_dwordx4 v[20:23], v1, s[4:7], s21 offen offset:1024 sc1
    buffer_load_dwordx4 v[24:27], v1, s[4:7], s21 offen offset:2048 sc1
    buffer_load_dwordx4 v[28:31], v1, s[4:7], s21 offen offset:3072 sc1
    s_waitcnt vmcnt(2)
    v_max3_u32 v9, v20, v21, v22
    v_max_u32 v9, v9, v23
    v_cmp_eq_u32 vcc, -1, v9
    s_cbranch_vccnz prm_10_1
    s_branch prm_10_1ok
prm_10_1_g:
    s_mov_b32 s26, 0
    s_waitcnt vmcnt(0)
    s_branch prm_10_1ok
prm_10_2:
    s_sub_u32 s26, s26, 1
    s_cbranch_scc1 prm_10_2_g
    buffer_load_dwordx4 v[24:27], v1, s[4:7], s21 offen offset:2048 sc1
    buffer_load_dwordx4 v[28:31], v1, s[4:7], s21 offen offset:3072 sc1
    s_waitcnt vmcnt(1)
    v_max3_u32 v9, v24, v25, v26
    v_max_u32 v9, v9, v27
    v_cmp_eq_u32 vcc, -1, v9
    s_cbranch_vccnz prm_10_2
    s_branch prm_10_2ok
prm_10_2_g:
    s_mov_b32 s26, 0
    s_waitcnt vmcnt(0)
    s_branch prm_10_2ok
prm_10_3:
    s_sub_u32 s26, s26, 1
    s_cbranch_scc1 prm_10_3_g
    buffer_load_dwordx4 v[28:31], v1, s[4:7], s21 offen offset:3072 sc1
    s_waitcnt vmcnt(0)
    v_max3_u32 v9, v28, v29, v30
    v_max_u32 v9, v9, v31
    v_cmp_eq_u32 vcc, -1, v9
    s_cbranch_vccnz prm_10_3
    s_branch prm_10_3ok
prm_10_3_g:
    s_mov_b32 s26, 0
    s_waitcnt vmcnt(0)
    s_branch prm_10_3ok
prp_11:
    s_sub_u32 s26, s26, 1
    s_nop 3
    s_cbranch_scc1 prp_11_g
    buffer_load_dwordx4 v[16:19], v12, s[4:7], s30 offen sc1
    buffer_load_dword v15, off, s[4:7], s58 sc1
    s_branch ploop_7_pagain
prp_11_g:
    s_mov_b32 s26, 0
    s_branch ploop_7_pgo
ploop_7_zr:
    s_sub_u32 s26, s26, 1
    s_cbranch_scc1 ploop_7_zg
    buffer_load_dwordx4 v[32:35], v1, s[4:7], s22 offen offset:0 sc1
    buffer_load_dwordx4 v[36:39], v1, s[4:7], s22 offen offset:1024 sc1
    buffer_load_dwordx4 v[40:43], v1, s[4:7], s22 offen offset:2048 sc1
    buffer_load_dwordx4 v[44:47], v1, s[4:7], s22 offen offset:3072 sc1
    s_branch ploop_7_za
ploop_7_zg:
    s_mov_b32 s26, 0
    s_branch ploop_7_zok
ptail_9:
    s_cmp_eq_u32 s15, 0
    s_cbranch_scc1 ptail_9_nd
    s_nop 0
ptail_9_nd:
    v_add_u32 v55, s68, v61
    s_xor_b32 s68, s68, 8192
    ds_read_b128 v[24:27], v55 offset:0
    ds_read_b128 v[28:31], v55 offset:1024
    ds_read_b128 v[32:35], v55 offset:18560
    ds_read_b128 v[36:39], v55 offset:19584
    ds_read_b128 v[40:43], v55 offset:37120
    ds_read_b128 v[44:47], v55 offset:38144
    ds_read_b128 v[48:51], v55 offset:55680
    ds_read_b128 v[52:55], v55 offset:56704
    s_waitcnt lgkmcnt(4)
    v_add_f32 v24, v24, v32
    v_add_f32 v25, v25, v33
    v_add_f32 v26, v26, v34
    v_add_f32 v27, v27, v35
    v_add_f32 v28, v28, v36
    v_add_f32 v29, v29, v37
    v_add_f32 v30, v30, v38
    v_add_f32 v31, v31, v39
    s_waitcnt lgkmcnt(0)
    v_add_f32 v40, v40, v48
    v_add_f32 v41, v41, v49
    v_add_f32 v42, v42, v50
    v_add_f32 v43, v43, v51
    v_add_f32 v44, v44, v52
    v_add_f32 v45, v45, v53
    v_add_f32 v46, v46, v54
    v_add_f32 v47, v47, v55
    v_add_f32 v24, v24, v40
    v_add_f32 v25, v25, v41
    v_add_f32 v26, v26, v42
    v_add_f32 v27, v27, v43
    v_add_f32 v28, v28, v44
    v_add_f32 v29, v29, v45
    v_add_f32 v30, v30, v46
    v_add_f32 v31, v31, v47
    v_cvt_pk_bf16_f32 v24, v24, v25
    v_cvt_pk_bf16_f32 v25, v26, v27
    v_cvt_pk_bf16_f32 v26, v28, v29
    v_cvt_pk_bf16_f32 v27, v30, v31
    v_min_u32 v24, -2, v24
    v_min_u32 v25, -2, v25
    v_min_u32 v26, -2, v26
    v_min_u32 v27, -2, v27
    buffer_store_dwordx4 v[24:27], v1, s[4:7], s37 offen sc1
    s_add_u32 s37, s37, 65536
    s_barrier
    s_nop 0
    v_add_u32 v55, s68, v61
    s_xor_b32 s68, s68, 8192
    ds_read_b128 v[24:27], v55 offset:0
    ds_read_b128 v[28:31], v55 offset:1024
    ds_read_b128 v[32:35], v55 offset:18560
    ds_read_b128 v[36:39], v55 offset:19584
    ds_read_b128 v[40:43], v55 offset:37120
    ds_read_b128 v[44:47], v55 offset:38144
    ds_read_b128 v[48:51], v55 offset:55680
    ds_read_b128 v[52:55], v55 offset:56704
    s_waitcnt lgkmcnt(4)
    v_add_f32 v24, v24, v32
    v_add_f32 v25, v25, v33
    v_add_f32 v26, v26, v34
    v_add_f32 v27, v27, v35
    v_add_f32 v28, v28, v36
    v_add_f32 v29, v29, v37
    v_add_f32 v30, v30, v38
    v_add_f32 v31, v31, v39
    s_waitcnt lgkmcnt(0)
    v_add_f32 v40, v40, v48
    v_add_f32 v41, v41, v49
    v_add_f32 v42, v42, v50
    v_add_f32 v43, v43, v51
    v_add_f32 v44, v44, v52
    v_add_f32 v45, v45, v53
    v_add_f32 v46, v46, v54
    v_add_f32 v47, v47, v55
    v_add_f32 v24, v24, v40
    v_add_f32 v25, v25, v41
    v_add_f32 v26, v26, v42
    v_add_f32 v27, v27, v43
    v_add_f32 v28, v28, v44
    v_add_f32 v29, v29, v45
    v_add_f32 v30, v30, v46
    v_add_f32 v31, v31, v47
    v_cvt_pk_bf16_f32 v24, v24, v25
    v_cvt_pk_bf16_f32 v25, v26, v27
    v_cvt_pk_bf16_f32 v26, v28, v29
    v_cvt_pk_bf16_f32 v27, v30, v31
    v_min_u32 v24, -2, v24
    v_min_u32 v25, -2, v25
    v_min_u32 v26, -2, v26
    v_min_u32 v27, -2, v27
    buffer_store_dwordx4 v[24:27], v1, s[4:7], s37 offen sc1
    s_add_u32 s37, s37, 65536
    s_branch k_end
ch_p_slow:
    v_mov_b32 v32, 0
    v_mov_b32 v33, 0
    v_mov_b32 v34, 0
    v_mov_b32 v35, 0
    v_mov_b32 v36, 0
    v_mov_b32 v37, 0
    v_mov_b32 v38, 0
    v_mov_b32 v39, 0
    v_mov_b32 v40, 0
    v_mov_b32 v41, 0
    v_mov_b32 v42, 0
    v_mov_b32 v43, 0
    v_mov_b32 v44, 0
    v_mov_b32 v45, 0
    v_mov_b32 v46, 0
    v_mov_b32 v47, 0
    v_mov_b32 v48, 0
    v_mov_b32 v49, 0
    v_mov_b32 v50, 0
    v_mov_b32 v51, 0
    v_mov_b32 v52, 0
    v_mov_b32 v53, 0
    v_mov_b32 v54, 0
    v_mov_b32 v55, 0
    v_mov_b32 v60, s16
    s_branch pnc_15
.p2align 6
ploop_14:
    s_add_u32 s21, s17, s33
    v_mov_b32 v32, 0
    v_mov_b32 v33, 0
    v_mov_b32 v34, 0
    v_mov_b32 v35, 0
    v_mov_b32 v36, 0
    v_mov_b32 v37, 0
    v_mov_b32 v38, 0
    v_mov_b32 v39, 0
    v_mov_b32 v40, 0
    v_mov_b32 v41, 0
    v_mov_b32 v42, 0
    v_mov_b32 v43, 0
    v_mov_b32 v44, 0
    v_mov_b32 v45, 0
    v_mov_b32 v46, 0
    v_mov_b32 v47, 0
    v_mov_b32 v48, 0
    v_mov_b32 v49, 0
    v_mov_b32 v50, 0
    v_mov_b32 v51, 0
    v_mov_b32 v52, 0
    v_mov_b32 v53, 0
    v_mov_b32 v54, 0
    v_mov_b32 v55, 0
    s_nop 15
    s_nop 8
    buffer_load_dwordx4 v[16:19], v1, s[4:7], s21 offen offset:0 sc1
    s_nop 7
    buffer_load_dwordx4 v[20:23], v1, s[4:7], s21 offen offset:1024 sc1
    s_nop 7
    buffer_load_dwordx4 v[24:27], v1, s[4:7], s21 offen offset:2048 sc1
    s_nop 7
    buffer_load_dwordx4 v[28:31], v1, s[4:7], s21 offen offset:3072 sc1
    s_waitcnt vmcnt(3)
    v_max3_u32 v9, v16, v17, v18
    v_max_u32 v9, v9, v19
    v_cmp_eq_u32 vcc, -1, v9
    s_cbranch_vccnz prm_17_0
prm_17_0ok:
    v_smfmac_f32_16x16x64_bf16 v[32:35], v[16:19], v[64:71], v62
    v_smfmac_f32_16x16x64_bf16 v[36:39], v[16:19], v[72:79], v62
    s_waitcnt vmcnt(2)
    v_max3_u32 v9, v20, v21, v22
    v_max_u32 v9, v9, v23
    v_cmp_eq_u32 vcc, -1, v9
    v_smfmac_f32_16x16x64_bf16 v[40:43], v[16:19], v[80:87], v62
    v_smfmac_f32_16x16x64_bf16 v[44:47], v[16:19], v[88:95], v62
    v_smfmac_f32_16x16x64_bf16 v[48:51], v[16:19], v[96:103], v62
    v_smfmac_f32_16x16x64_bf16 v[52:55], v[16:19], v[104:111], v62
    s_cbranch_vccnz prm_17_1
prm_17_1ok:
    v_smfmac_f32_16x16x64_bf16 v[32:35], v[20:23], v[112:119], v62
    v_smfmac_f32_16x16x64_bf16 v[36:39], v[20:23], v[120:127], v62
    s_waitcnt vmcnt(1)
    v_max3_u32 v9, v24, v25, v26
    v_max_u32 v9, v9, v27
    v_cmp_eq_u32 vcc, -1, v9
    v_smfmac_f32_16x16x64_bf16 v[40:43], v[20:23], v[128:135], v62
    v_smfmac_f32_16x16x64_bf16 v[44:47], v[20:23], v[136:143], v62
    v_smfmac_f32_16x16x64_bf16 v[48:51], v[20:23], v[144:151], v62
    v_smfmac_f32_16x16x64_bf16 v[52:55], v[20:23], v[152:159], v62
    s_cbranch_vccnz prm_17_2
prm_17_2ok:
    v_smfmac_f32_16x16x64_bf16 v[32:35], v[24:27], v[160:167], v62
    v_smfmac_f32_16x16x64_bf16 v[36:39], v[24:27], v[168:175], v62
    s_waitcnt vmcnt(0)
    v_max3_u32 v9, v28, v29, v30
    v_max_u32 v9, v9, v31
    v_cmp_eq_u32 vcc, -1, v9
    v_smfmac_f32_16x16x64_bf16 v[40:43], v[24:27], v[176:183], v62
    v_smfmac_f32_16x16x64_bf16 v[44:47], v[24:27], v[184:191], v62
    v_smfmac_f32_16x16x64_bf16 v[48:51], v[24:27], v[192:199], v62
    v_smfmac_f32_16x16x64_bf16 v[52:55], v[24:27], v[200:207], v62
    s_cbranch_vccnz prm_17_3
prm_17_3ok:
    v_smfmac_f32_16x16x64_bf16 v[32:35], v[28:31], v[208:215], v62
    ds_write_b32 v14, v60
    v_smfmac_f32_16x16x64_bf16 v[36:39], v[28:31], v[216:223], v62
    v_smfmac_f32_16x16x64_bf16 v[40:43], v[28:31], v[224:231], v62
    v_smfmac_f32_16x16x64_bf16 v[44:47], v[28:31], v[232:239], v62
    v_smfmac_f32_16x16x64_bf16 v[48:51], v[28:31], v[240:247], v62
    v_add_f32 v32, v32, v33
    v_add_f32 v34, v34, v35
    ds_write2_b32 v4, v32, v34 offset0:0 offset1:104
    v_smfmac_f32_16x16x64_bf16 v[52:55], v[28:31], v[248:255], v62
    v_add_f32 v36, v36, v37
    v_add_f32 v38, v38, v39
    ds_write2_b32 v4, v36, v38 offset0:16 offset1:120
    v_add_f32 v40, v40, v41
    v_add_f32 v42, v42, v43
    ds_write2_b32 v4, v40, v42 offset0:32 offset1:136
    v_add_f32 v44, v44, v45
    v_add_f32 v46, v46, v47
    ds_write2_b32 v4, v44, v46 offset0:48 offset1:152
    v_add_f32 v48, v48, v49
    v_add_f32 v50, v50, v51
    ds_write2_b32 v4, v48, v50 offset0:64 offset1:168
    v_add_f32 v52, v52, v53
    v_add_f32 v54, v54, v55
    ds_write2_b32 v4, v52, v54 offset0:80 offset1:184
    s_branch pnc_15_done
pnc_15:
    v_smfmac_f32_16x16x64_bf16 v[32:35], v[16:19], v[64:71], v62
    v_smfmac_f32_16x16x64_bf16 v[36:39], v[16:19], v[72:79], v62
    v_smfmac_f32_16x16x64_bf16 v[40:43], v[16:19], v[80:87], v62
    v_smfmac_f32_16x16x64_bf16 v[44:47], v[16:19], v[88:95], v62
    v_smfmac_f32_16x16x64_bf16 v[48:51], v[16:19], v[96:103], v62
    v_smfmac_f32_16x16x64_bf16 v[52:55], v[16:19], v[104:111], v62
    v_smfmac_f32_16x16x64_bf16 v[32:35], v[20:23], v[112:119], v62
    v_smfmac_f32_16x16x64_bf16 v[36:39], v[20:23], v[120:127], v62
    v_smfmac_f32_16x16x64_bf16 v[40:43], v[20:23], v[128:135], v62
    v_smfmac_f32_16x16x64_bf16 v[44:47], v[20:23], v[136:143], v62
    v_smfmac_f32_16x16x64_bf16 v[48:51], v[20:23], v[144:151], v62
    v_smfmac_f32_16x16x64_bf16 v[52:55], v[20:23], v[152:159], v62
    v_smfmac_f32_16x16x64_bf16 v[32:35], v[24:27], v[160:167], v62
    v_smfmac_f32_16x16x64_bf16 v[36:39], v[24:27], v[168:175], v62
    v_smfmac_f32_16x16x64_bf16 v[40:43], v[24:27], v[176:183], v62
    v_smfmac_f32_16x16x64_bf16 v[44:47], v[24:27], v[184:191], v62
    v_smfmac_f32_16x16x64_bf16 v[48:51], v[24:27], v[192:199], v62
    v_smfmac_f32_16x16x64_bf16 v[52:55], v[24:27], v[200:207], v62
    v_smfmac_f32_16x16x64_bf16 v[32:35], v[28:31], v[208:215], v62
    ds_write_b32 v14, v60
    v_smfmac_f32_16x16x64_bf16 v[36:39], v[28:31], v[216:223], v62
    v_smfmac_f32_16x16x64_bf16 v[40:43], v[28:31], v[224:231], v62
    v_smfmac_f32_16x16x64_bf16 v[44:47], v[28:31], v[232:239], v62
    v_smfmac_f32_16x16x64_bf16 v[48:51], v[28:31], v[240:247], v62
    v_add_f32 v32, v32, v33
    v_add_f32 v34, v34, v35
    ds_write2_b32 v4, v32, v34 offset0:0 offset1:104
    v_smfmac_f32_16x16x64_bf16 v[52:55], v[28:31], v[248:255], v62
    v_add_f32 v36, v36, v37
    v_add_f32 v38, v38, v39
    ds_write2_b32 v4, v36, v38 offset0:16 offset1:120
    v_add_f32 v40, v40, v41
    v_add_f32 v42, v42, v43
    ds_write2_b32 v4, v40, v42 offset0:32 offset1:136
    v_add_f32 v44, v44, v45
    v_add_f32 v46, v46, v47
    ds_write2_b32 v4, v44, v46 offset0:48 offset1:152
    v_add_f32 v48, v48, v49
    v_add_f32 v50, v50, v51
    ds_write2_b32 v4, v48, v50 offset0:64 offset1:168
    v_add_f32 v52, v52, v53
    v_add_f32 v54, v54, v55
    ds_write2_b32 v4, v52, v54 offset0:80 offset1:184
    s_waitcnt vmcnt(0)
pnc_15_done:
    s_add_u32 s21, s17, s32
    s_add_u32 s22, s19, s32
    s_add_u32 s24, s19, s35
    s_waitcnt lgkmcnt(0)
    s_barrier
    ds_read_b64 v[16:17], v5 offset:0
    ds_read_b64 v[18:19], v5 offset:3328
    ds_read_b64 v[20:21], v5 offset:6656
    ds_read_b64 v[22:23], v5 offset:9984
    ds_read_b64 v[24:25], v6 offset:0
    ds_read_b64 v[26:27], v6 offset:3328
    ds_read_b64 v[28:29], v6 offset:6656
    ds_read_b64 v[30:31], v6 offset:9984
    s_waitcnt lgkmcnt(6)
    v_add_f32 v16, v16, v18
    v_add_f32 v17, v17, v19
    s_waitcnt lgkmcnt(4)
    v_add_f32 v20, v20, v22
    v_add_f32 v21, v21, v23
    v_add_f32 v16, v16, v20
    v_add_f32 v17, v17, v21
    v_cvt_pk_bf16_f32 v16, v16, v17
    v_min_u32 v16, -2, v16
    buffer_store_dword v16, v2, s[4:7], s21 offen sc1
    s_waitcnt lgkmcnt(2)
    v_add_f32 v24, v24, v26
    v_add_f32 v25, v25, v27
    s_waitcnt lgkmcnt(0)
    v_add_f32 v28, v28, v30
    v_add_f32 v29, v29, v31
    v_add_f32 v24, v24, v28
    v_add_f32 v25, v25, v29
    v_cvt_pk_bf16_f32 v24, v24, v25
    v_min_u32 v24, -2, v24
    s_mov_b32 exec_hi, 0
    buffer_store_dword v24, v3, s[4:7], s21 offen sc1
    s_setprio 0
    s_add_u32 s23, s20, s36
    buffer_store_dword v10, v3, s[4:7], s22 offen sc1
    s_mov_b32 exec_lo, 0x00ff00ff
    buffer_store_dwordx2 v[10:11], v13, s[4:7], s23 offen sc1
    s_mov_b64 exec, -1
    buffer_store_dword v10, v2, s[4:7], s22 offen sc1
    s_add_u32 s21, s17, s35
    s_add_u32 s30, s17, s34
    s_add_u32 s23, s18, s36
gate_19:
    v_readfirstlane_b32 s25, v15
    s_cmp_ge_u32 s25, s59
    s_cbranch_scc1 gate_19_ok
    s_sleep 8
    buffer_load_dword v15, off, s[4:7], s58 sc1
    s_waitcnt vmcnt(0)
    s_sub_u32 s26, s26, 1
    s_cbranch_scc0 gate_19
    s_mov_b32 s26, 0
gate_19_ok:
    s_add_u32 s25, s16, 3
    s_min_u32 s25, s25, 63
    s_cmp_lt_u32 s25, 8
    s_cselect_b32 s59, 12, 24
    s_cselect_b32 s58, -4, -8
    s_and_b32 s25, s25, s58
    s_lshl_b32 s25, s25, 5
    s_add_u32 s58, s25, s60
    s_cmp_eq_u32 s15, 0
    s_cbranch_scc1 ploop_14_nd
    v_add_u32 v9, s53, v1
    v_add_u32 v0, 124928, v1
    ds_read_b128 v[16:19], v0 offset:0
    ds_read_b128 v[32:35], v9 offset:0
    ds_read_b128 v[20:23], v0 offset:1024
    ds_read_b128 v[36:39], v9 offset:1024
    ds_read_b128 v[24:27], v0 offset:2048
    ds_read_b128 v[40:43], v9 offset:2048
    ds_read_b128 v[28:31], v0 offset:3072
    ds_read_b128 v[44:47], v9 offset:3072
    s_add_u32 s22, s17, s61
    s_waitcnt lgkmcnt(6)
    v_mfma_f32_16x16x32_bf16 v[48:51], v[32:35], v[16:19], 0
    ds_read_b128 v[32:35], v9 offset:4096
    s_waitcnt lgkmcnt(5)
    v_mfma_f32_16x16x32_bf16 v[48:51], v[36:39], v[20:23], v[48:51]
    ds_read_b128 v[36:39], v9 offset:5120
    s_waitcnt lgkmcnt(4)
    v_mfma_f32_16x16x32_bf16 v[48:51], v[40:43], v[24:27], v[48:51]
    ds_read_b128 v[40:43], v9 offset:6144
    s_waitcnt lgkmcnt(3)
    v_mfma_f32_16x16x32_bf16 v[48:51], v[44:47], v[28:31], v[48:51]
    ds_read_b128 v[44:47], v9 offset:7168
    s_waitcnt lgkmcnt(3)
    v_mfma_f32_16x16x32_bf16 v[52:55], v[32:35], v[16:19], 0
    s_waitcnt lgkmcnt(2)
    v_mfma_f32_16x16x32_bf16 v[52:55], v[36:39], v[20:23], v[52:55]
    s_waitcnt lgkmcnt(1)
    v_mfma_f32_16x16x32_bf16 v[52:55], v[40:43], v[24:27], v[52:55]
    s_waitcnt lgkmcnt(0)
    v_mfma_f32_16x16x32_bf16 v[52:55], v[44:47], v[28:31], v[52:55]
    buffer_load_dwordx4 v[32:35], v1, s[4:7], s22 offen offset:0 sc1
    buffer_load_dwordx4 v[36:39], v1, s[4:7], s22 offen offset:1024 sc1
    buffer_load_dwordx4 v[40:43], v1, s[4:7], s22 offen offset:2048 sc1
    buffer_load_dwordx4 v[44:47], v1, s[4:7], s22 offen offset:3072 sc1
    v_mov_b32 v60, 0xff61b1e6
    s_nop 2
    v_cndmask_b32 v48, v48, v60, s[38:39]
    v_cndmask_b32 v49, v49, v60, s[40:41]
    v_cndmask_b32 v50, v50, v60, s[42:43]
    v_cndmask_b32 v51, v51, v60, s[44:45]
    v_cndmask_b32 v52, v52, v60, s[48:49]
    v_cndmask_b32 v53, v53, v60, s[50:51]
    v_cndmask_b32 v54, v54, v60, s[54:55]
    v_cndmask_b32 v55, v55, v60, s[56:57]
    v_max3_f32 v0, v48, v49, v50
    v_max3_f32 v9, v51, v52, v53
    v_max3_f32 v0, v0, v54, v55
    v_max_f32 v0, v0, v9
    v_mov_b32 v9, v0
    s_nop 1
    v_permlane16_swap_b32 v9, v0
    v_max_f32 v0, v0, v9
    v_mov_b32 v9, v0
    s_nop 1
    v_permlane32_swap_b32 v9, v0
    v_max_f32 v0, v0, v9
    v_mul_f32 v0, s47, v0
    v_fma_f32 v48, v48, s47, -v0
    v_fma_f32 v49, v49, s47, -v0
    v_fma_f32 v50, v50, s47, -v0
    v_fma_f32 v51, v51, s47, -v0
    v_fma_f32 v52, v52, s47, -v0
    v_fma_f32 v53, v53, s47, -v0
    v_fma_f32 v54, v54, s47, -v0
    v_fma_f32 v55, v55, s47, -v0
    v_exp_f32 v48, v48
    v_exp_f32 v49, v49
    v_exp_f32 v50, v50
    v_exp_f32 v51, v51
    v_exp_f32 v52, v52
    v_exp_f32 v53, v53
    v_exp_f32 v54, v54
    v_exp_f32 v55, v55
    v_add_f32 v15, v48, v49
    v_add_f32 v15, v15, v50
    v_add_f32 v15, v15, v51
    v_add_f32 v15, v15, v52
    v_add_f32 v15, v15, v53
    v_add_f32 v15, v15, v54
    v_add_f32 v15, v15, v55
ploop_14_za:
    s_waitcnt vmcnt(0)
    v_max3_u32 v9, v32, v33, v34
    v_max3_u32 v9, v9, v35, v36
    v_max3_u32 v9, v9, v37, v38
    v_max3_u32 v9, v9, v39, v40
    v_max3_u32 v9, v9, v41, v42
    v_max3_u32 v9, v9, v43, v44
    v_max3_u32 v9, v9, v45, v46
    v_max_u32 v9, v9, v47
    v_cmp_eq_u32 vcc, -1, v9
    s_cbranch_vccnz ploop_14_zr
ploop_14_zok:
    v_mfma_f32_16x16x32_bf16 v[56:59], v[32:35], v[16:19], 0
    v_mfma_f32_16x16x32_bf16 v[56:59], v[36:39], v[20:23], v[56:59]
    v_mfma_f32_16x16x32_bf16 v[56:59], v[40:43], v[24:27], v[56:59]
    v_mfma_f32_16x16x32_bf16 v[56:59], v[44:47], v[28:31], v[56:59]
    s_nop 7
    v_max_f32 v60, v56, v57
    v_mov_b32 v9, v60
    s_nop 1
    v_permlane16_swap_b32 v9, v60
    v_max_f32 v60, v60, v9
    v_mov_b32 v9, v60
    s_nop 1
    v_permlane32_swap_b32 v9, v60
    v_max_f32 v60, v60, v9
    v_mul_f32 v60, s47, v60
    v_max_f32 v58, v60, v0
    v_sub_f32 v60, v0, v58
    v_fma_f32 v56, v56, s47, -v58
    v_fma_f32 v57, v57, s47, -v58
    v_exp_f32 v60, v60
    v_exp_f32 v56, v56
    v_exp_f32 v57, v57
    v_fma_f32 v15, v15, v60, v56
    v_add_f32 v15, v15, v57
    v_mov_b32 v9, v15
    s_nop 1
    v_permlane16_swap_b32 v9, v15
    v_add_f32 v15, v15, v9
    v_mov_b32 v9, v15
    s_nop 1
    v_permlane32_swap_b32 v9, v15
    v_add_f32 v15, v15, v9
    v_rcp_f32 v15, v15
    s_add_u32 s22, s17, s14
    s_add_u32 s25, s19, s14
    v_add_u32 v9, 14336, v1
    v_mul_f32 v60, v60, v15
    v_mul_f32 v56, v56, v15
    v_mul_f32 v57, v57, v15
    v_mul_f32 v48, v48, v60
    v_mul_f32 v49, v49, v60
    v_mul_f32 v50, v50, v60
    v_mul_f32 v51, v51, v60
    v_mul_f32 v52, v52, v60
    v_mul_f32 v53, v53, v60
    v_mul_f32 v54, v54, v60
    v_mul_f32 v55, v55, v60
    v_cvt_pk_bf16_f32 v48, v48, v49
    v_cvt_pk_bf16_f32 v49, v50, v51
    v_cvt_pk_bf16_f32 v50, v52, v53
    v_cvt_pk_bf16_f32 v51, v54, v55
    v_cvt_pk_bf16_f32 v52, v56, v57
    v_min_u32 v48, -2, v48
    v_min_u32 v49, -2, v49
    v_min_u32 v50, -2, v50
    v_min_u32 v51, -2, v51
    v_min_u32 v52, -2, v52
    buffer_store_dwordx4 v[48:51], v1, s[4:7], s22 offen sc1
    buffer_store_dword v52, v8, s[4:7], s22 offen offset:1024 sc1
    ds_read_b128 v[56:59], v9
    s_branch ploop_14_nd2
ploop_14_nd:
ploop_14_flag:
    ds_read_b32 v9, v14 offset:16
    s_waitcnt lgkmcnt(0)
    v_readfirstlane_b32 s25, v9
    s_cmp_eq_u32 s25, s16
    s_cbranch_scc0 ploop_14_flag
    s_add_u32 m0, s53, 0
    s_add_u32 s22, s52, 0
    buffer_load_dwordx4 v1, s[4:7], s22 offen offset:0 sc1 lds
    buffer_load_dwordx4 v1, s[4:7], s22 offen offset:1024 sc1 lds
    buffer_load_dwordx4 v1, s[4:7], s22 offen offset:2048 sc1 lds
    buffer_load_dwordx4 v1, s[4:7], s22 offen offset:3072 sc1 lds
    s_add_u32 m0, s53, 4096
    s_add_u32 s22, s52, 131072
    buffer_load_dwordx4 v1, s[4:7], s22 offen offset:0 sc1 lds
    buffer_load_dwordx4 v1, s[4:7], s22 offen offset:1024 sc1 lds
    buffer_load_dwordx4 v1, s[4:7], s22 offen offset:2048 sc1 lds
    buffer_load_dwordx4 v1, s[4:7], s22 offen offset:3072 sc1 lds
    s_add_u32 s52, s52, 262144
ploop_14_nd2:
    s_cmp_lg_u32 s3, 2
    s_cbranch_scc1 ppf_20
    s_lshl_b32 s22, s16, 18
    s_mov_b32 exec_hi, 0xffff
    buffer_load_dword v0, v63, s[4:7], s22 offen sc1
    buffer_load_dword v0, v63, s[4:7], s22 offen offset:64 sc1
    s_mov_b32 exec_hi, -1
ppf_20:
    v_add_u32 v24, 18560, v7
    v_add_u32 v25, 37120, v7
    v_add_u32 v26, 55680, v7
    s_cmp_eq_u32 s16, 63
    s_setprio 3
    s_barrier
    s_cbranch_scc1 ptail_16
    ds_read2_b32 v[16:17], v7 offset0:0 offset1:2
    ds_read2_b32 v[18:19], v24 offset0:0 offset1:2
    ds_read2_b32 v[20:21], v25 offset0:0 offset1:2
    ds_read2_b32 v[22:23], v26 offset0:0 offset1:2
    s_waitcnt lgkmcnt(2)
    v_add_f32 v16, v16, v18
    v_add_f32 v17, v17, v19
    s_waitcnt lgkmcnt(0)
    v_add_f32 v20, v20, v22
    v_add_f32 v21, v21, v23
    v_add_f32 v16, v16, v20
    v_add_f32 v17, v17, v21
    v_cvt_pk_bf16_f32 v16, v16, v17
    v_min_u32 v16, -2, v16
    buffer_store_dword v16, v2, s[4:7], s21 offen sc1
    buffer_store_dword v10, v2, s[4:7], s24 offen sc1
    s_cmp_eq_u32 s15, 0
    s_cbranch_scc1 ploop_14_pnd
    s_sleep 6
    s_nop 8
    buffer_load_dwordx4 v[16:19], v12, s[4:7], s30 offen sc1
    buffer_load_dword v15, off, s[4:7], s58 sc1
    v_mov_b32 v20, -1
    v_mov_b32 v21, -1
    v_mov_b32 v22, -1
    v_mov_b32 v23, -1
    buffer_store_dwordx4 v[20:23], v1, s[4:7], s25 offen sc1
    buffer_store_dword v20, v8, s[4:7], s25 offen offset:1024 sc1
    s_mov_b32 m0, 124928
    s_nop 0
    buffer_load_dwordx4 v1, s[4:7], s69 offen offset:0 sc1 lds
    buffer_load_dwordx4 v1, s[4:7], s69 offen offset:1024 sc1 lds
    buffer_load_dwordx4 v1, s[4:7], s69 offen offset:2048 sc1 lds
    buffer_load_dwordx4 v1, s[4:7], s69 offen offset:3072 sc1 lds
    s_add_u32 s69, s69, 262144
    s_add_u32 m0, s53, 0
    s_add_u32 s22, s52, 0
    buffer_load_dwordx4 v1, s[4:7], s22 offen offset:0 sc1 lds
    buffer_load_dwordx4 v1, s[4:7], s22 offen offset:1024 sc1 lds
    buffer_load_dwordx4 v1, s[4:7], s22 offen offset:2048 sc1 lds
    buffer_load_dwordx4 v1, s[4:7], s22 offen offset:3072 sc1 lds
    s_add_u32 m0, s53, 4096
    s_add_u32 s22, s52, 131072
    buffer_load_dwordx4 v1, s[4:7], s22 offen offset:0 sc1 lds
    buffer_load_dwordx4 v1, s[4:7], s22 offen offset:1024 sc1 lds
    buffer_load_dwordx4 v1, s[4:7], s22 offen offset:2048 sc1 lds
    buffer_load_dwordx4 v1, s[4:7], s22 offen offset:3072 sc1 lds
    s_add_u32 s52, s52, 262144
    s_add_u32 s22, s16, 1
    v_mov_b32 v60, s22
    s_cmp_eq_u32 s16, 0
    s_cbranch_scc1 ploop_14_pagain
    v_add_u32 v55, s68, v61
    s_xor_b32 s68, s68, 8192
    ds_read_b128 v[24:27], v55 offset:0
    ds_read_b128 v[28:31], v55 offset:1024
    ds_read_b128 v[32:35], v55 offset:18560
    ds_read_b128 v[36:39], v55 offset:19584
    ds_read_b128 v[40:43], v55 offset:37120
    ds_read_b128 v[44:47], v55 offset:38144
    ds_read_b128 v[48:51], v55 offset:55680
    ds_read_b128 v[52:55], v55 offset:56704
    s_waitcnt lgkmcnt(4)
    v_add_f32 v24, v24, v32
    v_add_f32 v25, v25, v33
    v_add_f32 v26, v26, v34
    v_add_f32 v27, v27, v35
    v_add_f32 v28, v28, v36
    v_add_f32 v29, v29, v37
    v_add_f32 v30, v30, v38
    v_add_f32 v31, v31, v39
    s_waitcnt lgkmcnt(0)
    v_add_f32 v40, v40, v48
    v_add_f32 v41, v41, v49
    v_add_f32 v42, v42, v50
    v_add_f32 v43, v43, v51
    v_add_f32 v44, v44, v52
    v_add_f32 v45, v45, v53
    v_add_f32 v46, v46, v54
    v_add_f32 v47, v47, v55
    v_add_f32 v24, v24, v40
    v_add_f32 v25, v25, v41
    v_add_f32 v26, v26, v42
    v_add_f32 v27, v27, v43
    v_add_f32 v28, v28, v44
    v_add_f32 v29, v29, v45
    v_add_f32 v30, v30, v46
    v_add_f32 v31, v31, v47
    v_cvt_pk_bf16_f32 v24, v24, v25
    v_cvt_pk_bf16_f32 v25, v26, v27
    v_cvt_pk_bf16_f32 v26, v28, v29
    v_cvt_pk_bf16_f32 v27, v30, v31
    v_min_u32 v24, -2, v24
    v_min_u32 v25, -2, v25
    v_min_u32 v26, -2, v26
    v_min_u32 v27, -2, v27
    buffer_store_dwordx4 v[24:27], v1, s[4:7], s37 offen sc1
    s_add_u32 s37, s37, 65536
    s_waitcnt vmcnt(16) lgkmcnt(0)
    s_branch ploop_14_pchk
ploop_14_pnd:
    s_sleep 6
    s_nop 8
    buffer_load_dwordx4 v[16:19], v12, s[4:7], s30 offen sc1
    buffer_load_dword v15, off, s[4:7], s58 sc1
    s_add_u32 s22, s16, 1
    v_mov_b32 v60, s22
    s_cmp_eq_u32 s16, 0
    s_cbranch_scc1 ploop_14_pagain
    v_add_u32 v55, s68, v61
    s_xor_b32 s68, s68, 8192
    ds_read_b128 v[24:27], v55 offset:0
    ds_read_b128 v[28:31], v55 offset:1024
    ds_read_b128 v[32:35], v55 offset:18560
    ds_read_b128 v[36:39], v55 offset:19584
    ds_read_b128 v[40:43], v55 offset:37120
    ds_read_b128 v[44:47], v55 offset:38144
    ds_read_b128 v[48:51], v55 offset:55680
    ds_read_b128 v[52:55], v55 offset:56704
    s_waitcnt lgkmcnt(4)
    v_add_f32 v24, v24, v32
    v_add_f32 v25, v25, v33
    v_add_f32 v26, v26, v34
    v_add_f32 v27, v27, v35
    v_add_f32 v28, v28, v36
    v_add_f32 v29, v29, v37
    v_add_f32 v30, v30, v38
    v_add_f32 v31, v31, v39
    s_waitcnt lgkmcnt(0)
    v_add_f32 v40, v40, v48
    v_add_f32 v41, v41, v49
    v_add_f32 v42, v42, v50
    v_add_f32 v43, v43, v51
    v_add_f32 v44, v44, v52
    v_add_f32 v45, v45, v53
    v_add_f32 v46, v46, v54
    v_add_f32 v47, v47, v55
    v_add_f32 v24, v24, v40
    v_add_f32 v25, v25, v41
    v_add_f32 v26, v26, v42
    v_add_f32 v27, v27, v43
    v_add_f32 v28, v28, v44
    v_add_f32 v29, v29, v45
    v_add_f32 v30, v30, v46
    v_add_f32 v31, v31, v47
    v_cvt_pk_bf16_f32 v24, v24, v25
    v_cvt_pk_bf16_f32 v25, v26, v27
    v_cvt_pk_bf16_f32 v26, v28, v29
    v_cvt_pk_bf16_f32 v27, v30, v31
    v_min_u32 v24, -2, v24
    v_min_u32 v25, -2, v25
    v_min_u32 v26, -2, v26
    v_min_u32 v27, -2, v27
    buffer_store_dwordx4 v[24:27], v1, s[4:7], s37 offen sc1
    s_add_u32 s37, s37, 65536
    s_waitcnt vmcnt(2) lgkmcnt(0)
    s_branch ploop_14_pchk
ploop_14_pagain:
    s_waitcnt vmcnt(1) lgkmcnt(0)
ploop_14_pchk:
    v_mfma_f32_16x16x32_bf16 v[20:23], v[56:59], v[16:19], 0
    v_max3_u32 v9, v16, v17, v18
    v_max_u32 v9, v9, v19
    v_cmp_eq_u32 vcc, -1, v9
    s_cbranch_vccnz prp_18
ploop_14_pgo:
    s_nop 3
    v_add_f32_dpp v20, v20, v20 row_ror:8 row_mask:0xf bank_mask:0xf
    v_add_f32_dpp v21, v21, v21 row_ror:8 row_mask:0xf bank_mask:0xf
    v_add_f32_dpp v22, v22, v22 row_ror:8 row_mask:0xf bank_mask:0xf
    v_add_f32_dpp v23, v23, v23 row_ror:8 row_mask:0xf bank_mask:0xf
    v_cvt_pk_bf16_f32 v20, v20, v21
    v_cvt_pk_bf16_f32 v21, v22, v23
    s_mov_b32 exec_hi, 0
    v_min_u32 v20, -2, v20
    v_min_u32 v21, -2, v21
    s_mov_b32 exec_lo, 0x00ff00ff
    buffer_store_dwordx2 v[20:21], v13, s[4:7], s23 offen sc1
    s_mov_b64 exec, -1
    s_add_u32 s16, s16, 1
    s_mov_b32 s17, s18
    s_mov_b32 s18, s19
    s_mov_b32 s19, s20
    s_add_u32 s20, s20, 262144
    s_cmp_eq_u32 s20, 210763776
    s_cselect_b32 s20, 209715200, s20
    s_branch ploop_14
prm_17_0:
    s_sub_u32 s26, s26, 1
    s_cbranch_scc1 prm_17_0_g
    buffer_load_dwordx4 v[16:19], v1, s[4:7], s21 offen offset:0 sc1
    buffer_load_dwordx4 v[20:23], v1, s[4:7], s21 offen offset:1024 sc1
    buffer_load_dwordx4 v[24:27], v1, s[4:7], s21 offen offset:2048 sc1
    buffer_load_dwordx4 v[28:31], v1, s[4:7], s21 offen offset:3072 sc1
    s_waitcnt vmcnt(3)
    v_max3_u32 v9, v16, v17, v18
    v_max_u32 v9, v9, v19
    v_cmp_eq_u32 vcc, -1, v9
    s_cbranch_vccnz prm_17_0
    s_branch prm_17_0ok
prm_17_0_g:
    s_mov_b32 s26, 0
    s_waitcnt vmcnt(0)
    s_branch prm_17_0ok
prm_17_1:
    s_sub_u32 s26, s26, 1
    s_cbranch_scc1 prm_17_1_g
    buffer_load_dwordx4 v[20:23], v1, s[4:7], s21 offen offset:1024 sc1
    buffer_load_dwordx4 v[24:27], v1, s[4:7], s21 offen offset:2048 sc1
    buffer_load_dwordx4 v[28:31], v1, s[4:7], s21 offen offset:3072 sc1
    s_waitcnt vmcnt(2)
    v_max3_u32 v9, v20, v21, v22
    v_max_u32 v9, v9, v23
    v_cmp_eq_u32 vcc, -1, v9
    s_cbranch_vccnz prm_17_1
    s_branch prm_17_1ok
prm_17_1_g:
    s_mov_b32 s26, 0
    s_waitcnt vmcnt(0)
    s_branch prm_17_1ok
prm_17_2:
    s_sub_u32 s26, s26, 1
    s_cbranch_scc1 prm_17_2_g
    buffer_load_dwordx4 v[24:27], v1, s[4:7], s21 offen offset:2048 sc1
    buffer_load_dwordx4 v[28:31], v1, s[4:7], s21 offen offset:3072 sc1
    s_waitcnt vmcnt(1)
    v_max3_u32 v9, v24, v25, v26
    v_max_u32 v9, v9, v27
    v_cmp_eq_u32 vcc, -1, v9
    s_cbranch_vccnz prm_17_2
    s_branch prm_17_2ok
prm_17_2_g:
    s_mov_b32 s26, 0
    s_waitcnt vmcnt(0)
    s_branch prm_17_2ok
prm_17_3:
    s_sub_u32 s26, s26, 1
    s_cbranch_scc1 prm_17_3_g
    buffer_load_dwordx4 v[28:31], v1, s[4:7], s21 offen offset:3072 sc1
    s_waitcnt vmcnt(0)
    v_max3_u32 v9, v28, v29, v30
    v_max_u32 v9, v9, v31
    v_cmp_eq_u32 vcc, -1, v9
    s_cbranch_vccnz prm_17_3
    s_branch prm_17_3ok
prm_17_3_g:
    s_mov_b32 s26, 0
    s_waitcnt vmcnt(0)
    s_branch prm_17_3ok
prp_18:
    s_sub_u32 s26, s26, 1
    s_nop 3
    s_cbranch_scc1 prp_18_g
    buffer_load_dwordx4 v[16:19], v12, s[4:7], s30 offen sc1
    buffer_load_dword v15, off, s[4:7], s58 sc1
    s_branch ploop_14_pagain
prp_18_g:
    s_mov_b32 s26, 0
    s_branch ploop_14_pgo
ploop_14_zr:
    s_sub_u32 s26, s26, 1
    s_cbranch_scc1 ploop_14_zg
    buffer_load_dwordx4 v[32:35], v1, s[4:7], s22 offen offset:0 sc1
    buffer_load_dwordx4 v[36:39], v1, s[4:7], s22 offen offset:1024 sc1
    buffer_load_dwordx4 v[40:43], v1, s[4:7], s22 offen offset:2048 sc1
    buffer_load_dwordx4 v[44:47], v1, s[4:7], s22 offen offset:3072 sc1
    s_branch ploop_14_za
ploop_14_zg:
    s_mov_b32 s26, 0
    s_branch ploop_14_zok
ptail_16:
    s_cmp_eq_u32 s15, 0
    s_cbranch_scc1 ptail_16_nd
    s_nop 0
ptail_16_nd:
    v_add_u32 v55, s68, v61
    s_xor_b32 s68, s68, 8192
    ds_read_b128 v[24:27], v55 offset:0
    ds_read_b128 v[28:31], v55 offset:1024
    ds_read_b128 v[32:35], v55 offset:18560
    ds_read_b128 v[36:39], v55 offset:19584
    ds_read_b128 v[40:43], v55 offset:37120
    ds_read_b128 v[44:47], v55 offset:38144
    ds_read_b128 v[48:51], v55 offset:55680
    ds_read_b128 v[52:55], v55 offset:56704
    s_waitcnt lgkmcnt(4)
    v_add_f32 v24, v24, v32
    v_add_f32 v25, v25, v33
    v_add_f32 v26, v26, v34
    v_add_f32 v27, v27, v35
    v_add_f32 v28, v28, v36
    v_add_f32 v29, v29, v37
    v_add_f32 v30, v30, v38
    v_add_f32 v31, v31, v39
    s_waitcnt lgkmcnt(0)
    v_add_f32 v40, v40, v48
    v_add_f32 v41, v41, v49
    v_add_f32 v42, v42, v50
    v_add_f32 v43, v43, v51
    v_add_f32 v44, v44, v52
    v_add_f32 v45, v45, v53
    v_add_f32 v46, v46, v54
    v_add_f32 v47, v47, v55
    v_add_f32 v24, v24, v40
    v_add_f32 v25, v25, v41
    v_add_f32 v26, v26, v42
    v_add_f32 v27, v27, v43
    v_add_f32 v28, v28, v44
    v_add_f32 v29, v29, v45
    v_add_f32 v30, v30, v46
    v_add_f32 v31, v31, v47
    v_cvt_pk_bf16_f32 v24, v24, v25
    v_cvt_pk_bf16_f32 v25, v26, v27
    v_cvt_pk_bf16_f32 v26, v28, v29
    v_cvt_pk_bf16_f32 v27, v30, v31
    v_min_u32 v24, -2, v24
    v_min_u32 v25, -2, v25
    v_min_u32 v26, -2, v26
    v_min_u32 v27, -2, v27
    buffer_store_dwordx4 v[24:27], v1, s[4:7], s37 offen sc1
    s_add_u32 s37, s37, 65536
    s_barrier
    s_nop 0
    v_add_u32 v55, s68, v61
    s_xor_b32 s68, s68, 8192
    ds_read_b128 v[24:27], v55 offset:0
    ds_read_b128 v[28:31], v55 offset:1024
    ds_read_b128 v[32:35], v55 offset:18560
    ds_read_b128 v[36:39], v55 offset:19584
    ds_read_b128 v[40:43], v55 offset:37120
    ds_read_b128 v[44:47], v55 offset:38144
    ds_read_b128 v[48:51], v55 offset:55680
    ds_read_b128 v[52:55], v55 offset:56704
    s_waitcnt lgkmcnt(4)
    v_add_f32 v24, v24, v32
    v_add_f32 v25, v25, v33
    v_add_f32 v26, v26, v34
    v_add_f32 v27, v27, v35
    v_add_f32 v28, v28, v36
    v_add_f32 v29, v29, v37
    v_add_f32 v30, v30, v38
    v_add_f32 v31, v31, v39
    s_waitcnt lgkmcnt(0)
    v_add_f32 v40, v40, v48
    v_add_f32 v41, v41, v49
    v_add_f32 v42, v42, v50
    v_add_f32 v43, v43, v51
    v_add_f32 v44, v44, v52
    v_add_f32 v45, v45, v53
    v_add_f32 v46, v46, v54
    v_add_f32 v47, v47, v55
    v_add_f32 v24, v24, v40
    v_add_f32 v25, v25, v41
    v_add_f32 v26, v26, v42
    v_add_f32 v27, v27, v43
    v_add_f32 v28, v28, v44
    v_add_f32 v29, v29, v45
    v_add_f32 v30, v30, v46
    v_add_f32 v31, v31, v47
    v_cvt_pk_bf16_f32 v24, v24, v25
    v_cvt_pk_bf16_f32 v25, v26, v27
    v_cvt_pk_bf16_f32 v26, v28, v29
    v_cvt_pk_bf16_f32 v27, v30, v31
    v_min_u32 v24, -2, v24
    v_min_u32 v25, -2, v25
    v_min_u32 v26, -2, v26
    v_min_u32 v27, -2, v27
    buffer_store_dwordx4 v[24:27], v1, s[4:7], s37 offen sc1
    s_add_u32 s37, s37, 65536
    s_branch k_end
ch_a_pro:
    s_min_u32 s25, s3, 6
    s_lshl_b32 s22, s25, 3
    s_add_u32 s22, s22, -16
    s_load_dwordx2 s[8:9], s[0:1], s22
    s_mov_b32 s10, 8388608
    s_mov_b32 s11, 131072
    v_and_b32 v20, 63, v0
    v_lshlrev_b32 v21, 13, v20
    s_lshl_b32 s21, s13, 19
    s_lshl_b32 s22, s12, 10
    s_add_u32 s21, s21, s22
    s_waitcnt lgkmcnt(0)
    buffer_load_dword v23, v21, s[8:11], s21 offen offset:384
    s_mul_i32 s21, s2, 24576
    s_add_u32 s21, s21, 209711104
    v_lshlrev_b32 v1, 4, v0
    v_mov_b32 v4, -1
    v_mov_b32 v5, -1
    v_mov_b32 v6, -1
    v_mov_b32 v7, -1
    buffer_store_dwordx4 v[4:7], v1, s[4:7], s21 offen sc1
    s_add_u32 s21, s21, 4096
    buffer_store_dwordx4 v[4:7], v1, s[4:7], s21 offen sc1
    s_add_u32 s21, s21, 4096
    buffer_store_dwordx4 v[4:7], v1, s[4:7], s21 offen sc1
    s_add_u32 s21, s21, 4096
    buffer_store_dwordx4 v[4:7], v1, s[4:7], s21 offen sc1
    s_add_u32 s21, s21, 4096
    buffer_store_dwordx4 v[4:7], v1, s[4:7], s21 offen sc1
    s_add_u32 s21, s21, 4096
    buffer_store_dwordx4 v[4:7], v1, s[4:7], s21 offen sc1
    s_add_u32 s21, s21, 4096
    v_mov_b32 v2, s29
    s_waitcnt vmcnt(0)
    s_barrier
    s_cmp_lg_u32 s3, 4
    s_cbranch_scc1 ch_nox
    s_mov_b64 exec, 1
    buffer_atomic_add v2, off, s[64:67], s28 sc1
    s_mov_b64 exec, -1
ch_nox:
    v_and_b32 v20, 63, v0
    v_lshlrev_b32 v0, 4, v20
    s_sub_u32 s25, s3, 4
    s_lshl_b32 s46, s12, 2
    s_add_u32 s46, s46, s25
    s_lshl_b32 s21, s46, 18
    s_lshl_b32 s22, s13, 7
    s_add_u32 s21, s21, s22
    s_lshl_b32 s46, s46, 12
    s_lshl_b32 s23, s25, 13
    s_add_u32 s23, s23, 131072
    s_load_dwordx2 s[8:9], s[0:1], 40
    s_mov_b32 s10, 8388608
    s_mov_b32 s11, 131072
    v_lshrrev_b32 v21, 3, v20
    v_and_b32 v22, 7, v20
    v_lshlrev_b32 v21, 11, v21
    v_lshl_add_u32 v21, v22, 4, v21
    v_lshrrev_b32 v28, 4, v20
    v_and_b32 v29, 1, v28
    v_xor_b32 v29, 0, v29
    v_lshlrev_b32 v29, 2, v29
    v_lshl_add_u32 v29, v28, 3, v29
    v_bfe_u32 v28, v20, 2, 2
    v_add_u32 v29, v29, v28
    v_lshlrev_b32 v29, 7, v29
    v_and_b32 v28, 3, v20
    v_lshl_add_u32 v29, v28, 4, v29
    v_and_b32 v28, 1, v28
    v_xor_b32 v28, 0, v28
    v_lshl_add_u32 v24, v28, 3, v29
    v_add_u32 v24, s23, v24
    v_lshrrev_b32 v28, 4, v20
    v_and_b32 v29, 1, v28
    v_xor_b32 v29, 1, v29
    v_lshlrev_b32 v29, 2, v29
    v_lshl_add_u32 v29, v28, 3, v29
    v_bfe_u32 v28, v20, 2, 2
    v_add_u32 v29, v29, v28
    v_lshlrev_b32 v29, 7, v29
    v_and_b32 v28, 3, v20
    v_lshl_add_u32 v29, v28, 4, v29
    v_and_b32 v28, 1, v28
    v_xor_b32 v28, 0, v28
    v_lshl_add_u32 v25, v28, 3, v29
    v_add_u32 v25, s23, v25
    v_lshrrev_b32 v28, 4, v20
    v_and_b32 v29, 1, v28
    v_xor_b32 v29, 0, v29
    v_lshlrev_b32 v29, 2, v29
    v_lshl_add_u32 v29, v28, 3, v29
    v_bfe_u32 v28, v20, 2, 2
    v_add_u32 v29, v29, v28
    v_lshlrev_b32 v29, 7, v29
    v_and_b32 v28, 3, v20
    v_lshl_add_u32 v29, v28, 4, v29
    v_and_b32 v28, 1, v28
    v_xor_b32 v28, 1, v28
    v_lshl_add_u32 v26, v28, 3, v29
    v_add_u32 v26, s23, v26
    v_lshrrev_b32 v28, 4, v20
    v_and_b32 v29, 1, v28
    v_xor_b32 v29, 1, v29
    v_lshlrev_b32 v29, 2, v29
    v_lshl_add_u32 v29, v28, 3, v29
    v_bfe_u32 v28, v20, 2, 2
    v_add_u32 v29, v29, v28
    v_lshlrev_b32 v29, 7, v29
    v_and_b32 v28, 3, v20
    v_lshl_add_u32 v29, v28, 4, v29
    v_and_b32 v28, 1, v28
    v_xor_b32 v28, 1, v28
    v_lshl_add_u32 v27, v28, 3, v29
    v_add_u32 v27, s23, v27
    s_waitcnt lgkmcnt(0)
    s_add_u32 m0, s23, 0
    s_nop 0
    buffer_load_dwordx4 v21, s[8:11], s21 offen lds
    s_add_u32 s21, s21, 16384
    s_add_u32 m0, s23, 1024
    s_nop 0
    buffer_load_dwordx4 v21, s[8:11], s21 offen lds
    s_add_u32 s21, s21, 16384
    s_add_u32 m0, s23, 2048
    s_nop 0
    buffer_load_dwordx4 v21, s[8:11], s21 offen lds
    s_add_u32 s21, s21, 16384
    s_add_u32 m0, s23, 3072
    s_nop 0
    buffer_load_dwordx4 v21, s[8:11], s21 offen lds
    s_add_u32 s21, s21, 16384
    s_add_u32 m0, s23, 4096
    s_nop 0
    buffer_load_dwordx4 v21, s[8:11], s21 offen lds
    s_add_u32 s21, s21, 16384
    s_add_u32 m0, s23, 5120
    s_nop 0
    buffer_load_dwordx4 v21, s[8:11], s21 offen lds
    s_add_u32 s21, s21, 16384
    s_add_u32 m0, s23, 6144
    s_nop 0
    buffer_load_dwordx4 v21, s[8:11], s21 offen lds
    s_add_u32 s21, s21, 16384
    s_add_u32 m0, s23, 7168
    s_nop 0
    buffer_load_dwordx4 v21, s[8:11], s21 offen lds
    s_add_u32 s21, s21, 16384
    buffer_load_dwordx4 v[98:101], v21, s[8:11], s21 offen
    s_add_u32 s21, s21, 16384
    buffer_load_dwordx4 v[102:105], v21, s[8:11], s21 offen
    s_add_u32 s21, s21, 16384
    buffer_load_dwordx4 v[106:109], v21, s[8:11], s21 offen
    s_add_u32 s21, s21, 16384
    buffer_load_dwordx4 v[110:113], v21, s[8:11], s21 offen
    s_add_u32 s21, s21, 16384
    buffer_load_dwordx4 v[114:117], v21, s[8:11], s21 offen
    s_add_u32 s21, s21, 16384
    buffer_load_dwordx4 v[118:121], v21, s[8:11], s21 offen
    s_add_u32 s21, s21, 16384
    buffer_load_dwordx4 v[122:125], v21, s[8:11], s21 offen
    s_add_u32 s21, s21, 16384
    buffer_load_dwordx4 v[126:129], v21, s[8:11], s21 offen
    s_add_u32 s21, s21, 16384
    v_add_u32 v30, s23, v0
    s_waitcnt vmcnt(8)
    ds_read_b64_tr_b16 v[192:193], v24 offset:0
    ds_read_b64_tr_b16 v[194:195], v25 offset:0
    ds_read_b64_tr_b16 v[200:201], v26 offset:0
    ds_read_b64_tr_b16 v[202:203], v27 offset:0
    ds_read_b64_tr_b16 v[208:209], v24 offset:64
    ds_read_b64_tr_b16 v[210:211], v25 offset:64
    ds_read_b64_tr_b16 v[216:217], v26 offset:64
    ds_read_b64_tr_b16 v[218:219], v27 offset:64
    s_waitcnt lgkmcnt(0)
    ds_read_b64_tr_b16 v[196:197], v24 offset:4096
    ds_read_b64_tr_b16 v[198:199], v25 offset:4096
    ds_read_b64_tr_b16 v[204:205], v26 offset:4096
    ds_read_b64_tr_b16 v[206:207], v27 offset:4096
    ds_read_b64_tr_b16 v[212:213], v24 offset:4160
    ds_read_b64_tr_b16 v[214:215], v25 offset:4160
    ds_read_b64_tr_b16 v[220:221], v26 offset:4160
    ds_read_b64_tr_b16 v[222:223], v27 offset:4160
    s_waitcnt lgkmcnt(0)
    s_waitcnt vmcnt(0)
    ds_write_b128 v30, v[98:101] offset:0
    ds_write_b128 v30, v[102:105] offset:1024
    ds_write_b128 v30, v[106:109] offset:2048
    ds_write_b128 v30, v[110:113] offset:3072
    ds_write_b128 v30, v[114:117] offset:4096
    ds_write_b128 v30, v[118:121] offset:5120
    ds_write_b128 v30, v[122:125] offset:6144
    ds_write_b128 v30, v[126:129] offset:7168
    s_waitcnt lgkmcnt(0)
    ds_read_b64_tr_b16 v[224:225], v24 offset:0
    ds_read_b64_tr_b16 v[226:227], v25 offset:0
    ds_read_b64_tr_b16 v[232:233], v26 offset:0
    ds_read_b64_tr_b16 v[234:235], v27 offset:0
    ds_read_b64_tr_b16 v[240:241], v24 offset:64
    ds_read_b64_tr_b16 v[242:243], v25 offset:64
    ds_read_b64_tr_b16 v[248:249], v26 offset:64
    ds_read_b64_tr_b16 v[250:251], v27 offset:64
    s_waitcnt lgkmcnt(0)
    ds_read_b64_tr_b16 v[228:229], v24 offset:4096
    ds_read_b64_tr_b16 v[230:231], v25 offset:4096
    ds_read_b64_tr_b16 v[236:237], v26 offset:4096
    ds_read_b64_tr_b16 v[238:239], v27 offset:4096
    ds_read_b64_tr_b16 v[244:245], v24 offset:4160
    ds_read_b64_tr_b16 v[246:247], v25 offset:4160
    ds_read_b64_tr_b16 v[252:253], v26 offset:4160
    ds_read_b64_tr_b16 v[254:255], v27 offset:4160
    s_waitcnt lgkmcnt(0)
    v_lshrrev_b32 v21, 4, v20
    s_mul_i32 s21, s25, 18560
    s_add_u32 s21, s21, 16384
    v_add_u32 v1, s21, v0
    v_and_b32 v23, 15, v20
    v_mul_u32_u24 v21, 136, v21
    v_lshl_add_u32 v21, v23, 3, v21
    v_add_u32 v45, s21, v21
    s_lshl_b32 s53, s25, 13
    s_add_u32 s53, s53, 92160
    v_add_u32 v49, s53, v0
    v_mov_b32 v48, 0
    v_mov_b32 v4, 0x3f803f80
    v_mov_b32 v5, 0x3f803f80
    v_mov_b32 v6, 0x3f803f80
    v_mov_b32 v7, 0x3f803f80
    v_mov_b32 v8, 0
    v_mov_b32 v9, 0
    v_mov_b32 v10, 0
    v_mov_b32 v11, 0
    v_lshlrev_b32 v43, 2, v20
    v_mov_b32 v26, 0x44444444
    v_mov_b32 v27, 0xeeeeeeee
    v_and_b32 v28, 1, v20
    v_cmp_eq_u32 vcc, 0, v28
    s_mov_b32 s47, 0x3e0293ee
    s_lshl_b32 s32, s12, 15
    v_cndmask_b32 v41, v27, v26, vcc
    s_lshl_b32 s21, s25, 13
    s_add_u32 s32, s32, s21
    s_add_u32 s32, s32, 2097152
    s_lshl_b32 s21, s25, 2
    s_add_u32 s21, s21, 13312
    v_mov_b32 v47, s21
    s_lshl_b32 s27, s13, 2
    s_add_u32 s27, s27, s25
    s_lshl_b32 s62, s12, 7
    s_add_u32 s62, s62, 218112000
    s_lshl_b32 s33, s12, 14
    s_lshl_b32 s21, s25, 12
    s_add_u32 s33, s33, s21
    s_add_u32 s33, s33, 1179648
    v_mov_b32 v139, 0
    v_mov_b32 v140, 0
    v_mov_b32 v141, 0
    v_mov_b32 v143, 0
    v_mov_b32 v144, 0
    v_mov_b32 v145, 0
    v_mov_b32 v40, 0
    v_mov_b32 v42, 0
    v_mov_b32 v44, 0
    v_mov_b32 v46, 0
    s_cmp_lg_u32 s3, 4
    s_cbranch_scc1 ch_xcc_skip
    v_add_u32 v56, 128, v43
    v_writelane_b32 v56, 0, 4
    v_mov_b32 v59, 63
    v_writelane_b32 v59, -1, 4
    v_mov_b32 v60, 32
    s_movk_i32 s21, 128
    v_writelane_b32 v60, s21, 4
    s_mov_b64 exec, 0x1f
ch_xcc:
    buffer_load_dword v57, v56, s[64:67], 0 offen sc1
    s_waitcnt vmcnt(0)
    v_and_b32 v62, v59, v57
    v_cmp_ne_u32 vcc, v62, v60
    s_cbranch_vccz ch_xcc_ok
    s_sleep 16
    s_sub_u32 s26, s26, 1
    s_cbranch_scc0 ch_xcc
    s_mov_b32 s26, 0
ch_xcc_ok:
    s_lshr_b32 s22, s12, 1
    v_readlane_b32 s23, v57, 0
    s_nop 2
    v_readlane_b32 s21, v57, s22
    s_mov_b64 exec, -1
    v_mov_b32 v58, 131072
    v_mov_b32 v57, s21
    ds_write_b32 v58, v57
    s_bfe_u32 s23, s23, 0x1000f
    v_and_b32 v60, 0x70, v0
    v_lshlrev_b32 v60, 3, v60
    s_mov_b32 s22, 218112000
ch_pgv:
    buffer_load_dword v61, v60, s[4:7], s22 offen offset:8 sc1
    s_waitcnt vmcnt(0) lgkmcnt(0)
    v_and_b32 v62, 1, v61
    v_cmp_eq_u32 vcc, 0, v62
    s_cbranch_vccz ch_pgvok
    s_sleep 8
    s_sub_u32 s26, s26, 1
    s_cbranch_scc0 ch_pgv
    s_mov_b32 s26, 0
ch_pgvok:
    v_bfe_u32 v62, v61, 1, 1
    v_ashrrev_i32 v61, 8, v61
    v_sub_u32 v59, 0, v61
    v_cmp_eq_u32 vcc, s23, v62
    s_mov_b32 s21, 0
    s_nop 1
    v_cndmask_b32 v61, v59, v61, vcc
    s_nop 1
    v_readlane_b32 s22, v61, 0
    s_add_i32 s21, s21, s22
    v_readlane_b32 s22, v61, 1
    s_add_i32 s21, s21, s22
    v_readlane_b32 s22, v61, 2
    s_add_i32 s21, s21, s22
    v_readlane_b32 s22, v61, 3
    s_add_i32 s21, s21, s22
    v_readlane_b32 s22, v61, 4
    s_add_i32 s21, s21, s22
    v_readlane_b32 s22, v61, 5
    s_add_i32 s21, s21, s22
    v_readlane_b32 s22, v61, 6
    s_add_i32 s21, s21, s22
    v_readlane_b32 s22, v61, 7
    s_add_i32 s21, s21, s22
    s_cmp_gt_i32 s21, 0
    s_cselect_b32 s21, 0x2000, 0
    v_mov_b32 v59, s21
    ds_write_b32 v58, v59 offset:4
    s_waitcnt lgkmcnt(0)
ch_xcc_skip:
    s_barrier
    s_barrier
    s_lshl_b32 s60, s12, 4
    s_add_u32 s60, s60, 218104320
ch_g0:
    buffer_load_dword v57, off, s[4:7], s60 sc1
    s_waitcnt vmcnt(0)
    v_readfirstlane_b32 s21, v57
    s_cmp_ge_u32 s21, 12
    s_cbranch_scc1 ch_g0b
    s_sleep 12
    s_sub_u32 s26, s26, 1
    s_cbranch_scc0 ch_g0
    s_mov_b32 s26, 0
ch_g0b:
    s_add_u32 s21, s16, 0
    s_lshl_b32 s21, s21, 18
    s_add_u32 s21, s21, s46
    s_add_u32 s21, s21, 37748736
    s_add_u32 s22, s21, 131072
    buffer_load_dwordx4 v[160:163], v0, s[4:7], s21 offen offset:0 sc1
    buffer_load_dwordx4 v[164:167], v0, s[4:7], s21 offen offset:1024 sc1
    buffer_load_dwordx4 v[168:171], v0, s[4:7], s21 offen offset:2048 sc1
    buffer_load_dwordx4 v[172:175], v0, s[4:7], s21 offen offset:3072 sc1
    buffer_load_dwordx4 v[176:179], v0, s[4:7], s22 offen offset:0 sc1
    buffer_load_dwordx4 v[180:183], v0, s[4:7], s22 offen offset:1024 sc1
    buffer_load_dwordx4 v[184:187], v0, s[4:7], s22 offen offset:2048 sc1
    buffer_load_dwordx4 v[188:191], v0, s[4:7], s22 offen offset:3072 sc1
    s_waitcnt vmcnt(0)
    v_mfma_f32_16x16x32_bf16 v[50:53], v[160:163], v[192:195], 0
    v_mfma_f32_16x16x32_bf16 v[54:57], v[160:163], v[200:203], 0
    v_mfma_f32_16x16x32_bf16 v[58:61], v[160:163], v[208:211], 0
    v_mfma_f32_16x16x32_bf16 v[62:65], v[160:163], v[216:219], 0
    v_mfma_f32_16x16x32_bf16 v[66:69], v[176:179], v[192:195], 0
    v_mfma_f32_16x16x32_bf16 v[70:73], v[176:179], v[200:203], 0
    v_mfma_f32_16x16x32_bf16 v[74:77], v[176:179], v[208:211], 0
    v_mfma_f32_16x16x32_bf16 v[78:81], v[176:179], v[216:219], 0
    v_mfma_f32_16x16x32_bf16 v[50:53], v[164:167], v[196:199], v[50:53]
    v_mfma_f32_16x16x32_bf16 v[54:57], v[164:167], v[204:207], v[54:57]
    v_mfma_f32_16x16x32_bf16 v[58:61], v[164:167], v[212:215], v[58:61]
    v_mfma_f32_16x16x32_bf16 v[62:65], v[164:167], v[220:223], v[62:65]
    v_mfma_f32_16x16x32_bf16 v[66:69], v[180:183], v[196:199], v[66:69]
    v_mfma_f32_16x16x32_bf16 v[70:73], v[180:183], v[204:207], v[70:73]
    v_mfma_f32_16x16x32_bf16 v[74:77], v[180:183], v[212:215], v[74:77]
    v_mfma_f32_16x16x32_bf16 v[78:81], v[180:183], v[220:223], v[78:81]
    v_mfma_f32_16x16x32_bf16 v[50:53], v[168:171], v[224:227], v[50:53]
    v_mfma_f32_16x16x32_bf16 v[54:57], v[168:171], v[232:235], v[54:57]
    v_mfma_f32_16x16x32_bf16 v[58:61], v[168:171], v[240:243], v[58:61]
    v_mfma_f32_16x16x32_bf16 v[62:65], v[168:171], v[248:251], v[62:65]
    v_mfma_f32_16x16x32_bf16 v[66:69], v[184:187], v[224:227], v[66:69]
    v_mfma_f32_16x16x32_bf16 v[70:73], v[184:187], v[232:235], v[70:73]
    v_mfma_f32_16x16x32_bf16 v[74:77], v[184:187], v[240:243], v[74:77]
    v_mfma_f32_16x16x32_bf16 v[78:81], v[184:187], v[248:251], v[78:81]
    v_mfma_f32_16x16x32_bf16 v[50:53], v[172:175], v[228:231], v[50:53]
    v_mfma_f32_16x16x32_bf16 v[54:57], v[172:175], v[236:239], v[54:57]
    v_mfma_f32_16x16x32_bf16 v[58:61], v[172:175], v[244:247], v[58:61]
    v_mfma_f32_16x16x32_bf16 v[62:65], v[172:175], v[252:255], v[62:65]
    v_mfma_f32_16x16x32_bf16 v[66:69], v[188:191], v[228:231], v[66:69]
    v_mfma_f32_16x16x32_bf16 v[70:73], v[188:191], v[236:239], v[70:73]
    v_mfma_f32_16x16x32_bf16 v[74:77], v[188:191], v[244:247], v[74:77]
    v_mfma_f32_16x16x32_bf16 v[78:81], v[188:191], v[252:255], v[78:81]
    s_nop 7
    v_cvt_pk_bf16_f32 v82, v50, v51
    v_cvt_pk_bf16_f32 v83, v52, v53
    v_cvt_pk_bf16_f32 v84, v66, v67
    v_cvt_pk_bf16_f32 v85, v68, v69
    v_cvt_pk_bf16_f32 v86, v54, v55
    v_cvt_pk_bf16_f32 v87, v56, v57
    v_cvt_pk_bf16_f32 v88, v70, v71
    v_cvt_pk_bf16_f32 v89, v72, v73
    v_cvt_pk_bf16_f32 v90, v58, v59
    v_cvt_pk_bf16_f32 v91, v60, v61
    v_cvt_pk_bf16_f32 v92, v74, v75
    v_cvt_pk_bf16_f32 v93, v76, v77
    v_cvt_pk_bf16_f32 v94, v62, v63
    v_cvt_pk_bf16_f32 v95, v64, v65
    v_cvt_pk_bf16_f32 v96, v78, v79
    v_cvt_pk_bf16_f32 v97, v80, v81
.p2align 6
aloop_21:
    s_add_u32 s21, s17, s32
    s_add_u32 s22, s21, 4096
    v_mov_b32 v74, 0
    v_mov_b32 v75, 0
    v_mov_b32 v76, 0
    v_mov_b32 v77, 0
    v_mov_b32 v78, 0
    v_mov_b32 v79, 0
    v_mov_b32 v80, 0
    v_mov_b32 v81, 0
    v_mov_b32 v146, 0
    v_mov_b32 v147, 0
    v_mov_b32 v148, 0
    v_mov_b32 v149, 0
    v_mov_b32 v150, 0
    v_mov_b32 v151, 0
    v_mov_b32 v152, 0
    v_mov_b32 v153, 0
    s_add_u32 s30, s16, 1
    s_lshl_b32 s30, s30, 18
    s_add_u32 s30, s30, s46
    s_add_u32 s30, s30, 37748736
    s_add_u32 s31, s30, 131072
aloop_21_wm:
    ds_read_b32 v3, v47
    s_waitcnt lgkmcnt(0)
    v_readfirstlane_b32 s23, v3
    s_cmp_eq_u32 s23, s16
    s_cbranch_scc1 aloop_21_wmok
    s_sleep 1
    s_branch aloop_21_wm
aloop_21_wmok:
    buffer_load_dwordx4 v[160:163], v0, s[4:7], s30 offen offset:0 sc1
    buffer_load_dwordx4 v[164:167], v0, s[4:7], s30 offen offset:1024 sc1
    buffer_load_dwordx4 v[168:171], v0, s[4:7], s30 offen offset:2048 sc1
    buffer_load_dwordx4 v[172:175], v0, s[4:7], s30 offen offset:3072 sc1
    buffer_load_dwordx4 v[176:179], v0, s[4:7], s31 offen offset:0 sc1
    buffer_load_dwordx4 v[180:183], v0, s[4:7], s31 offen offset:1024 sc1
    buffer_load_dwordx4 v[184:187], v0, s[4:7], s31 offen offset:2048 sc1
    buffer_load_dwordx4 v[188:191], v0, s[4:7], s31 offen offset:3072 sc1
    s_setprio 2
    v_mov_b32 v2, s16
    s_barrier
    s_nop 15
    s_nop 13
    ds_read_b128 v[98:101], v49 offset:0
    ds_read_b128 v[102:105], v49 offset:1024
    ds_read_b128 v[106:109], v49 offset:2048
    ds_read_b128 v[110:113], v49 offset:3072
    ds_read_b128 v[114:117], v49 offset:4096
    ds_read_b128 v[118:121], v49 offset:5120
    ds_read_b128 v[122:125], v49 offset:6144
    ds_read_b128 v[126:129], v49 offset:7168
    s_sleep 4
    s_nop 5
    buffer_load_dwordx4 v[50:53], v0, s[4:7], s21 offen offset:0 sc1
    s_nop 7
    buffer_load_dwordx4 v[54:57], v0, s[4:7], s21 offen offset:1024 sc1
    s_nop 7
    buffer_load_dwordx4 v[58:61], v0, s[4:7], s21 offen offset:2048 sc1
    s_nop 7
    buffer_load_dwordx4 v[62:65], v0, s[4:7], s21 offen offset:3072 sc1
    s_nop 7
    buffer_load_dwordx4 v[66:69], v0, s[4:7], s22 offen offset:0 sc1
    s_nop 7
    buffer_load_dwordx4 v[70:73], v0, s[4:7], s22 offen offset:1024 sc1
    s_waitcnt lgkmcnt(0)
aloop_21_again:
    s_cmp_eq_u32 s16, 63
    s_waitcnt vmcnt(5)
    v_mfma_f32_16x16x32_bf16 v[12:15], v[98:101], v[50:53], 0
    v_max3_u32 v3, v50, v51, v52
    v_max_u32 v3, v3, v53
    v_mfma_f32_16x16x32_bf16 v[16:19], v[114:117], v[50:53], 0
    v_cmp_eq_u32 vcc, -1, v3
    v_mfma_f32_16x16x32_bf16 v[20:23], v[50:53], v[50:53], 0
    s_cbranch_vccnz arq_22_0
    s_waitcnt vmcnt(4)
    v_mfma_f32_16x16x32_bf16 v[12:15], v[102:105], v[54:57], v[12:15]
    v_max3_u32 v3, v54, v55, v56
    v_max_u32 v3, v3, v57
    v_mfma_f32_16x16x32_bf16 v[16:19], v[118:121], v[54:57], v[16:19]
    v_cmp_eq_u32 vcc, -1, v3
    v_mfma_f32_16x16x32_bf16 v[20:23], v[54:57], v[54:57], v[20:23]
    s_cbranch_vccnz arq_22_1
    s_waitcnt vmcnt(3)
    v_mfma_f32_16x16x32_bf16 v[12:15], v[106:109], v[58:61], v[12:15]
    v_max3_u32 v3, v58, v59, v60
    v_max_u32 v3, v3, v61
    v_mfma_f32_16x16x32_bf16 v[16:19], v[122:125], v[58:61], v[16:19]
    v_cmp_eq_u32 vcc, -1, v3
    v_mfma_f32_16x16x32_bf16 v[20:23], v[58:61], v[58:61], v[20:23]
    s_cbranch_vccnz arq_22_2
    s_waitcnt vmcnt(2)
    v_mfma_f32_16x16x32_bf16 v[12:15], v[110:113], v[62:65], v[12:15]
    v_max3_u32 v3, v62, v63, v64
    v_max_u32 v3, v3, v65
    v_mfma_f32_16x16x32_bf16 v[16:19], v[126:129], v[62:65], v[16:19]
    v_cmp_eq_u32 vcc, -1, v3
    v_mfma_f32_16x16x32_bf16 v[20:23], v[62:65], v[62:65], v[20:23]
    s_cbranch_vccnz arq_22_3
aloop_21_sdone:
    ds_write_b32 v47, v2 offset:16
    s_cbranch_scc1 aloop_21_lsk
    s_nop 1
    v_max3_f32 v2, v12, v13, v14
    v_max3_f32 v3, v15, v16, v17
    v_max3_f32 v2, v2, v18, v19
    s_nop 0
    v_max3_f32 v3, v3, v20, v21
    v_max_f32 v2, v2, v3
    v_mov_b32 v3, v2
    s_nop 1
    v_permlane16_swap_b32 v3, v2
    v_max_f32 v2, v2, v3
    v_mov_b32 v3, v2
    s_nop 1
    v_permlane32_swap_b32 v3, v2
    v_max_f32 v2, v2, v3
    v_mul_f32 v2, s47, v2
    v_fma_f32 v12, v12, s47, -v2
    v_fma_f32 v13, v13, s47, -v2
    s_waitcnt vmcnt(0)
    v_max3_u32 v24, v66, v67, v68
    v_max3_u32 v24, v24, v69, v70
    v_max3_u32 v24, v24, v71, v72
    v_max_u32 v24, v24, v73
    v_cmp_eq_u32 vcc, -1, v24
    s_cbranch_vccnz arq_22_v
    v_fma_f32 v14, v14, s47, -v2
    v_smfmac_f32_16x16x64_bf16 v[74:77], v[66:69], v[192:199], v41
    v_exp_f32 v12, v12
    v_fma_f32 v15, v15, s47, -v2
    v_smfmac_f32_16x16x64_bf16 v[78:81], v[66:69], v[200:207], v41
    v_exp_f32 v13, v13
    v_fma_f32 v16, v16, s47, -v2
    v_smfmac_f32_16x16x64_bf16 v[146:149], v[66:69], v[208:215], v41
    v_exp_f32 v14, v14
    v_fma_f32 v17, v17, s47, -v2
    v_smfmac_f32_16x16x64_bf16 v[150:153], v[66:69], v[216:223], v41
    v_exp_f32 v15, v15
    v_fma_f32 v18, v18, s47, -v2
    v_smfmac_f32_16x16x64_bf16 v[74:77], v[70:73], v[224:231], v41
    v_exp_f32 v16, v16
    v_fma_f32 v19, v19, s47, -v2
    v_smfmac_f32_16x16x64_bf16 v[78:81], v[70:73], v[232:239], v41
    v_exp_f32 v17, v17
    v_fma_f32 v20, v20, s47, -v2
    v_smfmac_f32_16x16x64_bf16 v[146:149], v[70:73], v[240:247], v41
    v_exp_f32 v18, v18
    v_fma_f32 v21, v21, s47, -v2
    v_smfmac_f32_16x16x64_bf16 v[150:153], v[70:73], v[248:255], v41
    v_exp_f32 v19, v19
    v_exp_f32 v20, v20
    v_exp_f32 v21, v21
    v_cvt_pk_bf16_f32 v12, v12, v13
    v_cvt_pk_bf16_f32 v13, v14, v15
    v_cvt_pk_bf16_f32 v14, v16, v17
    v_cvt_pk_bf16_f32 v15, v18, v19
    v_cvt_pk_bf16_f32 v8, v20, v21
    v_add_f32 v74, v74, v75
    v_mfma_f32_16x16x32_bf16 v[16:19], v[12:15], v[4:7], 0
    v_add_f32 v76, v76, v77
    v_mfma_f32_16x16x32_bf16 v[16:19], v[8:11], v[4:7], v[16:19]
    v_cvt_pk_bf16_f32 v40, v74, v76
    v_mfma_f32_16x16x32_bf16 v[24:27], v[12:15], v[82:85], 0
    v_add_f32 v78, v78, v79
    v_add_f32 v80, v80, v81
    v_mfma_f32_16x16x32_bf16 v[24:27], v[8:11], v[40:43], v[24:27]
    v_cvt_pk_bf16_f32 v42, v78, v80
    v_add_f32 v146, v146, v147
    v_mfma_f32_16x16x32_bf16 v[28:31], v[12:15], v[86:89], 0
    v_add_f32 v148, v148, v149
    v_cvt_pk_bf16_f32 v44, v146, v148
    v_mfma_f32_16x16x32_bf16 v[28:31], v[8:11], v[42:45], v[28:31]
    v_add_f32 v150, v150, v151
    v_add_f32 v152, v152, v153
    v_mfma_f32_16x16x32_bf16 v[32:35], v[12:15], v[90:93], 0
    v_cvt_pk_bf16_f32 v46, v150, v152
    v_rcp_f32 v18, v18
    v_mfma_f32_16x16x32_bf16 v[32:35], v[8:11], v[44:47], v[32:35]
    v_rcp_f32 v19, v19
    v_mfma_f32_16x16x32_bf16 v[36:39], v[12:15], v[94:97], 0
    v_mul_f32 v26, v26, v18
    v_mul_f32 v27, v27, v19
    v_mfma_f32_16x16x32_bf16 v[36:39], v[8:11], v[46:49], v[36:39]
    ds_write_b64 v45, v[26:27] offset:0
    v_mul_f32 v30, v30, v18
    v_mul_f32 v31, v31, v19
    ds_write_b64 v45, v[30:31] offset:544
aloop_21_pvd:
    v_mul_f32 v34, v34, v18
    v_mul_f32 v35, v35, v19
    ds_write_b64 v45, v[34:35] offset:1088
    s_nop 0
    v_mul_f32 v38, v38, v18
    v_mul_f32 v39, v39, v19
    ds_write_b64 v45, v[38:39] offset:1632
aloop_21_lskb:
    s_waitcnt lgkmcnt(0)
    s_barrier
    s_setprio 0
    s_add_u32 s21, s17, s33
    s_cmp_eq_u32 s16, 63
    s_cbranch_scc1 aloop_21_nvw
    v_mfma_f32_16x16x32_bf16 v[50:53], v[160:163], v[192:195], 0
    v_mfma_f32_16x16x32_bf16 v[54:57], v[160:163], v[200:203], 0
    v_mfma_f32_16x16x32_bf16 v[58:61], v[160:163], v[208:211], 0
    v_mfma_f32_16x16x32_bf16 v[62:65], v[160:163], v[216:219], 0
    v_mfma_f32_16x16x32_bf16 v[66:69], v[176:179], v[192:195], 0
    v_mfma_f32_16x16x32_bf16 v[70:73], v[176:179], v[200:203], 0
    v_mfma_f32_16x16x32_bf16 v[74:77], v[176:179], v[208:211], 0
    v_mfma_f32_16x16x32_bf16 v[78:81], v[176:179], v[216:219], 0
    v_mfma_f32_16x16x32_bf16 v[50:53], v[164:167], v[196:199], v[50:53]
    v_mfma_f32_16x16x32_bf16 v[54:57], v[164:167], v[204:207], v[54:57]
    v_mfma_f32_16x16x32_bf16 v[58:61], v[164:167], v[212:215], v[58:61]
    v_mfma_f32_16x16x32_bf16 v[62:65], v[164:167], v[220:223], v[62:65]
    v_mfma_f32_16x16x32_bf16 v[66:69], v[180:183], v[196:199], v[66:69]
    v_mfma_f32_16x16x32_bf16 v[70:73], v[180:183], v[204:207], v[70:73]
    v_mfma_f32_16x16x32_bf16 v[74:77], v[180:183], v[212:215], v[74:77]
    v_mfma_f32_16x16x32_bf16 v[78:81], v[180:183], v[220:223], v[78:81]
    v_mfma_f32_16x16x32_bf16 v[50:53], v[168:171], v[224:227], v[50:53]
    v_mfma_f32_16x16x32_bf16 v[54:57], v[168:171], v[232:235], v[54:57]
    v_mfma_f32_16x16x32_bf16 v[58:61], v[168:171], v[240:243], v[58:61]
    v_mfma_f32_16x16x32_bf16 v[62:65], v[168:171], v[248:251], v[62:65]
    v_mfma_f32_16x16x32_bf16 v[66:69], v[184:187], v[224:227], v[66:69]
    v_mfma_f32_16x16x32_bf16 v[70:73], v[184:187], v[232:235], v[70:73]
    v_mfma_f32_16x16x32_bf16 v[74:77], v[184:187], v[240:243], v[74:77]
    v_mfma_f32_16x16x32_bf16 v[78:81], v[184:187], v[248:251], v[78:81]
    v_mfma_f32_16x16x32_bf16 v[50:53], v[172:175], v[228:231], v[50:53]
    v_mfma_f32_16x16x32_bf16 v[54:57], v[172:175], v[236:239], v[54:57]
    v_mfma_f32_16x16x32_bf16 v[58:61], v[172:175], v[244:247], v[58:61]
    v_mfma_f32_16x16x32_bf16 v[62:65], v[172:175], v[252:255], v[62:65]
    v_mfma_f32_16x16x32_bf16 v[66:69], v[188:191], v[228:231], v[66:69]
    v_mfma_f32_16x16x32_bf16 v[70:73], v[188:191], v[236:239], v[70:73]
    v_mfma_f32_16x16x32_bf16 v[74:77], v[188:191], v[244:247], v[74:77]
    v_mfma_f32_16x16x32_bf16 v[78:81], v[188:191], v[252:255], v[78:81]
aloop_21_nvw:
    buffer_load_dwordx4 v[130:133], v0, s[4:7], s21 offen sc1
    buffer_load_dword v138, v43, s[4:7], s21 offen offset:1024 sc1
    buffer_load_dwordx4 v[134:137], v0, s[4:7], s21 offen offset:2048 sc1
    buffer_load_dword v142, v43, s[4:7], s21 offen offset:3072 sc1
    s_cmp_lg_u32 s27, 0
    s_cbranch_scc1 pg_23
    s_sub_u32 s25, s16, 2
    s_cbranch_scc1 pg_23
    v_mov_b32 v3, s25
    s_mov_b64 exec, 1
    buffer_store_dword v3, off, s[4:7], s62 sc1
    s_mov_b64 exec, -1
pg_23:
    v_add_u32 v48, s68, v1
    s_xor_b32 s68, s68, 8192
aloop_21_psa:
    s_waitcnt vmcnt(0)
    v_max3_u32 v3, v130, v131, v132
    v_max3_u32 v3, v3, v133, v134
    v_max3_u32 v3, v3, v135, v136
    v_max3_u32 v3, v3, v137, v138
    v_max_u32 v3, v3, v142
    v_cmp_eq_u32 vcc, -1, v3
    s_cbranch_vccnz arq_22_ps
aloop_21_psok:
    v_mfma_f32_16x16x32_bf16 v[24:27], v[82:85], v[130:133], 0
    v_mfma_f32_16x16x32_bf16 v[24:27], v[40:43], v[138:141], v[24:27]
    v_mfma_f32_16x16x32_bf16 v[28:31], v[86:89], v[130:133], 0
    v_mfma_f32_16x16x32_bf16 v[28:31], v[42:45], v[138:141], v[28:31]
    v_mfma_f32_16x16x32_bf16 v[32:35], v[90:93], v[130:133], 0
    v_mfma_f32_16x16x32_bf16 v[32:35], v[44:47], v[138:141], v[32:35]
    v_mfma_f32_16x16x32_bf16 v[36:39], v[94:97], v[130:133], 0
    v_mfma_f32_16x16x32_bf16 v[36:39], v[46:49], v[138:141], v[36:39]
    v_mfma_f32_16x16x32_bf16 v[12:15], v[82:85], v[134:137], 0
    v_mfma_f32_16x16x32_bf16 v[12:15], v[40:43], v[142:145], v[12:15]
    v_mfma_f32_16x16x32_bf16 v[16:19], v[86:89], v[134:137], 0
    v_mfma_f32_16x16x32_bf16 v[16:19], v[42:45], v[142:145], v[16:19]
    v_mfma_f32_16x16x32_bf16 v[20:23], v[90:93], v[134:137], 0
    v_mfma_f32_16x16x32_bf16 v[20:23], v[44:47], v[142:145], v[20:23]
    v_mfma_f32_16x16x32_bf16 v[154:157], v[94:97], v[134:137], 0
    v_mfma_f32_16x16x32_bf16 v[154:157], v[46:49], v[142:145], v[154:157]
    ds_write_b128 v48, v[24:27] offset:2176
    v_cvt_pk_bf16_f32 v82, v50, v51
    v_cvt_pk_bf16_f32 v83, v52, v53
    ds_write_b128 v48, v[28:31] offset:3200
    v_cvt_pk_bf16_f32 v84, v66, v67
    v_cvt_pk_bf16_f32 v85, v68, v69
    ds_write_b128 v48, v[32:35] offset:4224
    v_cvt_pk_bf16_f32 v86, v54, v55
    v_cvt_pk_bf16_f32 v87, v56, v57
    ds_write_b128 v48, v[36:39] offset:5248
    v_cvt_pk_bf16_f32 v88, v70, v71
    v_cvt_pk_bf16_f32 v89, v72, v73
    ds_write_b128 v48, v[12:15] offset:6272
    v_cvt_pk_bf16_f32 v90, v58, v59
    v_cvt_pk_bf16_f32 v91, v60, v61
    ds_write_b128 v48, v[16:19] offset:7296
    v_cvt_pk_bf16_f32 v92, v74, v75
    v_cvt_pk_bf16_f32 v93, v76, v77
    ds_write_b128 v48, v[20:23] offset:8320
    v_cvt_pk_bf16_f32 v94, v62, v63
    v_cvt_pk_bf16_f32 v95, v64, v65
    ds_write_b128 v48, v[154:157] offset:9344
    v_cvt_pk_bf16_f32 v96, v78, v79
    v_cvt_pk_bf16_f32 v97, v80, v81
aloop_21_bgskip:
    s_waitcnt lgkmcnt(0)
    s_cmp_eq_u32 s16, 63
    s_cbranch_scc1 aloop_21_fin
    s_add_u32 s16, s16, 1
    s_mov_b32 s17, s18
    s_mov_b32 s18, s19
    s_mov_b32 s19, s20
    s_add_u32 s20, s20, 262144
    s_cmp_eq_u32 s20, 210763776
    s_cselect_b32 s20, 209715200, s20
    s_branch aloop_21
arq_22_0:
    s_sub_u32 s26, s26, 1
    s_cbranch_scc1 arq_22_0_g
    buffer_load_dwordx4 v[50:53], v0, s[4:7], s21 offen offset:0 sc1
    buffer_load_dwordx4 v[54:57], v0, s[4:7], s21 offen offset:1024 sc1
    buffer_load_dwordx4 v[58:61], v0, s[4:7], s21 offen offset:2048 sc1
    buffer_load_dwordx4 v[62:65], v0, s[4:7], s21 offen offset:3072 sc1
    buffer_load_dwordx4 v[66:69], v0, s[4:7], s22 offen offset:0 sc1
    buffer_load_dwordx4 v[70:73], v0, s[4:7], s22 offen offset:1024 sc1
    s_waitcnt vmcnt(5)
    v_max3_u32 v3, v50, v51, v52
    v_max_u32 v3, v3, v53
    v_cmp_eq_u32 vcc, -1, v3
    s_cbranch_vccnz arq_22_0
    s_branch aloop_21_again
arq_22_0_g:
    s_mov_b32 s26, 0
    s_waitcnt vmcnt(0)
    s_branch aloop_21_nochk
arq_22_1:
    s_sub_u32 s26, s26, 1
    s_cbranch_scc1 arq_22_1_g
    buffer_load_dwordx4 v[54:57], v0, s[4:7], s21 offen offset:1024 sc1
    buffer_load_dwordx4 v[58:61], v0, s[4:7], s21 offen offset:2048 sc1
    buffer_load_dwordx4 v[62:65], v0, s[4:7], s21 offen offset:3072 sc1
    buffer_load_dwordx4 v[66:69], v0, s[4:7], s22 offen offset:0 sc1
    buffer_load_dwordx4 v[70:73], v0, s[4:7], s22 offen offset:1024 sc1
    s_waitcnt vmcnt(4)
    v_max3_u32 v3, v54, v55, v56
    v_max_u32 v3, v3, v57
    v_cmp_eq_u32 vcc, -1, v3
    s_cbranch_vccnz arq_22_1
    s_branch aloop_21_again
arq_22_1_g:
    s_mov_b32 s26, 0
    s_waitcnt vmcnt(0)
    s_branch aloop_21_nochk
arq_22_2:
    s_sub_u32 s26, s26, 1
    s_cbranch_scc1 arq_22_2_g
    buffer_load_dwordx4 v[58:61], v0, s[4:7], s21 offen offset:2048 sc1
    buffer_load_dwordx4 v[62:65], v0, s[4:7], s21 offen offset:3072 sc1
    buffer_load_dwordx4 v[66:69], v0, s[4:7], s22 offen offset:0 sc1
    buffer_load_dwordx4 v[70:73], v0, s[4:7], s22 offen offset:1024 sc1
    s_waitcnt vmcnt(3)
    v_max3_u32 v3, v58, v59, v60
    v_max_u32 v3, v3, v61
    v_cmp_eq_u32 vcc, -1, v3
    s_cbranch_vccnz arq_22_2
    s_branch aloop_21_again
arq_22_2_g:
    s_mov_b32 s26, 0
    s_waitcnt vmcnt(0)
    s_branch aloop_21_nochk
arq_22_3:
    s_sub_u32 s26, s26, 1
    s_cbranch_scc1 arq_22_3_g
    buffer_load_dwordx4 v[62:65], v0, s[4:7], s21 offen offset:3072 sc1
    buffer_load_dwordx4 v[66:69], v0, s[4:7], s22 offen offset:0 sc1
    buffer_load_dwordx4 v[70:73], v0, s[4:7], s22 offen offset:1024 sc1
    s_waitcnt vmcnt(2)
    v_max3_u32 v3, v62, v63, v64
    v_max_u32 v3, v3, v65
    v_cmp_eq_u32 vcc, -1, v3
    s_cbranch_vccnz arq_22_3
    s_branch aloop_21_again
arq_22_3_g:
    s_mov_b32 s26, 0
    s_waitcnt vmcnt(0)
    s_branch aloop_21_nochk
aloop_21_nochk:
    s_cmp_eq_u32 s16, 63
    v_mfma_f32_16x16x32_bf16 v[12:15], v[98:101], v[50:53], 0
    v_mfma_f32_16x16x32_bf16 v[16:19], v[114:117], v[50:53], 0
    v_mfma_f32_16x16x32_bf16 v[20:23], v[50:53], v[50:53], 0
    v_mfma_f32_16x16x32_bf16 v[12:15], v[102:105], v[54:57], v[12:15]
    v_mfma_f32_16x16x32_bf16 v[16:19], v[118:121], v[54:57], v[16:19]
    v_mfma_f32_16x16x32_bf16 v[20:23], v[54:57], v[54:57], v[20:23]
    v_mfma_f32_16x16x32_bf16 v[12:15], v[106:109], v[58:61], v[12:15]
    v_mfma_f32_16x16x32_bf16 v[16:19], v[122:125], v[58:61], v[16:19]
    v_mfma_f32_16x16x32_bf16 v[20:23], v[58:61], v[58:61], v[20:23]
    v_mfma_f32_16x16x32_bf16 v[12:15], v[110:113], v[62:65], v[12:15]
    v_mfma_f32_16x16x32_bf16 v[16:19], v[126:129], v[62:65], v[16:19]
    v_mfma_f32_16x16x32_bf16 v[20:23], v[62:65], v[62:65], v[20:23]
    s_nop 1
    s_branch aloop_21_sdone
arq_22_v:
    buffer_load_dwordx4 v[66:69], v0, s[4:7], s22 offen offset:0 sc1
    buffer_load_dwordx4 v[70:73], v0, s[4:7], s22 offen offset:1024 sc1
    v_fma_f32 v14, v14, s47, -v2
    v_exp_f32 v12, v12
    v_fma_f32 v15, v15, s47, -v2
    v_exp_f32 v13, v13
    v_fma_f32 v16, v16, s47, -v2
    v_exp_f32 v14, v14
    v_fma_f32 v17, v17, s47, -v2
    v_exp_f32 v15, v15
    v_fma_f32 v18, v18, s47, -v2
    v_exp_f32 v16, v16
    v_fma_f32 v19, v19, s47, -v2
    v_exp_f32 v17, v17
    v_fma_f32 v20, v20, s47, -v2
    v_exp_f32 v18, v18
    v_fma_f32 v21, v21, s47, -v2
    v_exp_f32 v19, v19
    v_exp_f32 v20, v20
    v_exp_f32 v21, v21
    v_cvt_pk_bf16_f32 v12, v12, v13
    v_cvt_pk_bf16_f32 v13, v14, v15
    v_cvt_pk_bf16_f32 v14, v16, v17
    v_cvt_pk_bf16_f32 v15, v18, v19
    v_cvt_pk_bf16_f32 v8, v20, v21
    s_nop 0
    v_mfma_f32_16x16x32_bf16 v[16:19], v[12:15], v[4:7], 0
    v_mfma_f32_16x16x32_bf16 v[16:19], v[8:11], v[4:7], v[16:19]
    v_mfma_f32_16x16x32_bf16 v[24:27], v[12:15], v[82:85], 0
    v_mfma_f32_16x16x32_bf16 v[28:31], v[12:15], v[86:89], 0
    v_mfma_f32_16x16x32_bf16 v[32:35], v[12:15], v[90:93], 0
    v_mfma_f32_16x16x32_bf16 v[36:39], v[12:15], v[94:97], 0
arq_22_vs:
    s_waitcnt vmcnt(0)
    v_max3_u32 v3, v66, v67, v68
    v_max3_u32 v3, v3, v69, v70
    v_max3_u32 v3, v3, v71, v72
    v_max_u32 v3, v3, v73
    v_cmp_eq_u32 vcc, -1, v3
    s_cbranch_vccnz arq_22_vsr
    s_branch arq_22_vsok
arq_22_vsr:
    s_sub_u32 s26, s26, 1
    s_cbranch_scc1 arq_22_vsg
    buffer_load_dwordx4 v[66:69], v0, s[4:7], s22 offen offset:0 sc1
    buffer_load_dwordx4 v[70:73], v0, s[4:7], s22 offen offset:1024 sc1
    s_branch arq_22_vs
arq_22_vsg:
    s_mov_b32 s26, 0
arq_22_vsok:
    v_smfmac_f32_16x16x64_bf16 v[74:77], v[66:69], v[192:199], v41
    v_smfmac_f32_16x16x64_bf16 v[78:81], v[66:69], v[200:207], v41
    v_smfmac_f32_16x16x64_bf16 v[146:149], v[66:69], v[208:215], v41
    v_smfmac_f32_16x16x64_bf16 v[150:153], v[66:69], v[216:223], v41
    v_smfmac_f32_16x16x64_bf16 v[74:77], v[70:73], v[224:231], v41
    v_smfmac_f32_16x16x64_bf16 v[78:81], v[70:73], v[232:239], v41
    v_smfmac_f32_16x16x64_bf16 v[146:149], v[70:73], v[240:247], v41
    v_smfmac_f32_16x16x64_bf16 v[150:153], v[70:73], v[248:255], v41
    v_rcp_f32 v18, v18
    v_rcp_f32 v19, v19
    s_nop 2
    v_add_f32 v74, v74, v75
    v_add_f32 v76, v76, v77
    v_cvt_pk_bf16_f32 v40, v74, v76
    v_add_f32 v78, v78, v79
    v_add_f32 v80, v80, v81
    v_cvt_pk_bf16_f32 v42, v78, v80
    v_add_f32 v146, v146, v147
    v_add_f32 v148, v148, v149
    v_cvt_pk_bf16_f32 v44, v146, v148
    v_add_f32 v150, v150, v151
    v_add_f32 v152, v152, v153
    v_cvt_pk_bf16_f32 v46, v150, v152
    s_nop 1
    v_mfma_f32_16x16x32_bf16 v[24:27], v[8:11], v[40:43], v[24:27]
    v_mfma_f32_16x16x32_bf16 v[28:31], v[8:11], v[42:45], v[28:31]
    v_mfma_f32_16x16x32_bf16 v[32:35], v[8:11], v[44:47], v[32:35]
    v_mfma_f32_16x16x32_bf16 v[36:39], v[8:11], v[46:49], v[36:39]
    s_nop 4
    v_mul_f32 v26, v26, v18
    v_mul_f32 v27, v27, v19
    ds_write_b64 v45, v[26:27] offset:0
    v_mul_f32 v30, v30, v18
    v_mul_f32 v31, v31, v19
    ds_write_b64 v45, v[30:31] offset:544
    s_branch aloop_21_pvd
aloop_21_lsk:
arq_22_vl:
    s_waitcnt vmcnt(0)
    v_max3_u32 v3, v66, v67, v68
    v_max3_u32 v3, v3, v69, v70
    v_max3_u32 v3, v3, v71, v72
    v_max_u32 v3, v3, v73
    v_cmp_eq_u32 vcc, -1, v3
    s_cbranch_vccnz arq_22_vlr
    s_branch arq_22_vlok
arq_22_vlr:
    s_sub_u32 s26, s26, 1
    s_cbranch_scc1 arq_22_vlg
    buffer_load_dwordx4 v[66:69], v0, s[4:7], s22 offen offset:0 sc1
    buffer_load_dwordx4 v[70:73], v0, s[4:7], s22 offen offset:1024 sc1
    s_branch arq_22_vl
arq_22_vlg:
    s_mov_b32 s26, 0
arq_22_vlok:
    v_smfmac_f32_16x16x64_bf16 v[74:77], v[66:69], v[192:199], v41
    v_smfmac_f32_16x16x64_bf16 v[78:81], v[66:69], v[200:207], v41
    v_smfmac_f32_16x16x64_bf16 v[146:149], v[66:69], v[208:215], v41
    v_smfmac_f32_16x16x64_bf16 v[150:153], v[66:69], v[216:223], v41
    v_smfmac_f32_16x16x64_bf16 v[74:77], v[70:73], v[224:231], v41
    v_smfmac_f32_16x16x64_bf16 v[78:81], v[70:73], v[232:239], v41
    v_smfmac_f32_16x16x64_bf16 v[146:149], v[70:73], v[240:247], v41
    v_smfmac_f32_16x16x64_bf16 v[150:153], v[70:73], v[248:255], v41
    s_nop 4
    v_add_f32 v74, v74, v75
    v_add_f32 v76, v76, v77
    v_cvt_pk_bf16_f32 v40, v74, v76
    v_add_f32 v78, v78, v79
    v_add_f32 v80, v80, v81
    v_cvt_pk_bf16_f32 v42, v78, v80
    v_add_f32 v146, v146, v147
    v_add_f32 v148, v148, v149
    v_cvt_pk_bf16_f32 v44, v146, v148
    v_add_f32 v150, v150, v151
    v_add_f32 v152, v152, v153
    v_cvt_pk_bf16_f32 v46, v150, v152
    s_branch aloop_21_lskb
arq_22_ps:
    s_sub_u32 s26, s26, 1
    s_cbranch_scc1 arq_22_psg
    s_sleep 2
    buffer_load_dwordx4 v[130:133], v0, s[4:7], s21 offen sc1
    buffer_load_dword v138, v43, s[4:7], s21 offen offset:1024 sc1
    buffer_load_dwordx4 v[134:137], v0, s[4:7], s21 offen offset:2048 sc1
    buffer_load_dword v142, v43, s[4:7], s21 offen offset:3072 sc1
    s_branch aloop_21_psa
arq_22_psg:
    s_mov_b32 s26, 0
    s_branch aloop_21_psok
aloop_21_fin:
    s_barrier
    s_branch k_end
k_end:
k_exit:
    s_endpgm
.section .rodata,"a"
.p2align 6
jobtab:
    .long 4, 24, 24, 8192, 0, 262144, 8388608, 0, 32768, 4, 20971520, 131072, 0, 0, 218104320, 1
    .long 4, 24, 24, 8192, 0, 262144, 8388608, 262144, 32768, 4, 22020096, 131072, 0, 0, 218104448, 1
    .long 1, 32, 32, 8192, 0, 256, 8388608, 1048576, 32768, 8, 41943040, 131072, 0, 0, 218104832, 4
    .long 1, 32, 32, 8192, 0, 256, 8388608, 2097152, 32768, 8, 46137344, 131072, 0, 0, 218105344, 4
    .long 1, 32, 32, 8192, 0, 256, 8388608, 2621440, 32768, 8, 48234496, 131072, 0, 0, 218105600, 4
    .long 1, 32, 32, 8192, 0, 256, 8388608, 3145728, 32768, 8, 50331648, 131072, 0, 0, 218105856, 4
    .long 1, 32, 32, 8192, 0, 256, 8388608, 3670016, 32768, 8, 52428800, 131072, 0, 0, 218106112, 4
    .long 0, 0, 0, 0, 0, 0, 0, 0, 0, 0, 0, 0, 0, 0, 0, 0
    .long 0, 0, 0, 0, 0, 0, 0, 0, 0, 0, 0, 0, 0, 0, 0, 0
    .long 0, 0, 0, 0, 0, 0, 0, 0, 0, 0, 0, 0, 0, 0, 0, 0
    .long 4, 24, 24, 8192, 2048, 264192, 8388608, 0, 32768, 4, 21004288, 131072, 0, 0, 218104352, 1
    .long 4, 24, 24, 8192, 2048, 264192, 8388608, 262144, 32768, 4, 22052864, 131072, 0, 0, 218104480, 1
    .long 1, 32, 32, 8192, 2048, 2304, 8388608, 1048576, 32768, 8, 41975808, 131072, 0, 0, 218104864, 4
    .long 1, 32, 32, 8192, 2048, 2304, 8388608, 2097152, 32768, 8, 46170112, 131072, 0, 0, 218105376, 4
    .long 1, 32, 32, 8192, 2048, 2304, 8388608, 2621440, 32768, 8, 48267264, 131072, 0, 0, 218105632, 4
    .long 1, 32, 32, 8192, 2048, 2304, 8388608, 3145728, 32768, 8, 50364416, 131072, 0, 0, 218105888, 4
    .long 1, 32, 32, 8192, 2048, 2304, 8388608, 3670016, 32768, 8, 52461568, 131072, 0, 0, 218106144, 4
    .long 0, 0, 0, 0, 0, 0, 0, 0, 0, 0, 0, 0, 0, 0, 0, 0
    .long 0, 0, 0, 0, 0, 0, 0, 0, 0, 0, 0, 0, 0, 0, 0, 0
    .long 0, 0, 0, 0, 0, 0, 0, 0, 0, 0, 0, 0, 0, 0, 0, 0
    .long 4, 24, 24, 8192, 4096, 266240, 8388608, 0, 32768, 4, 21037056, 131072, 0, 0, 218104384, 1
    .long 4, 24, 24, 8192, 4096, 266240, 8388608, 262144, 32768, 4, 22085632, 131072, 0, 0, 218104512, 1
    .long 1, 32, 32, 8192, 4096, 4352, 8388608, 1048576, 32768, 8, 42008576, 131072, 0, 0, 218104896, 4
    .long 1, 32, 32, 8192, 4096, 4352, 8388608, 2097152, 32768, 8, 46202880, 131072, 0, 0, 218105408, 4
    .long 1, 32, 32, 8192, 4096, 4352, 8388608, 2621440, 32768, 8, 48300032, 131072, 0, 0, 218105664, 4
    .long 1, 32, 32, 8192, 4096, 4352, 8388608, 3145728, 32768, 8, 50397184, 131072, 0, 0, 218105920, 4
    .long 1, 32, 32, 8192, 4096, 4352, 8388608, 3670016, 32768, 8, 52494336, 131072, 0, 0, 218106176, 4
    .long 0, 0, 0, 0, 0, 0, 0, 0, 0, 0, 0, 0, 0, 0, 0, 0
    .long 0, 0, 0, 0, 0, 0, 0, 0, 0, 0, 0, 0, 0, 0, 0, 0
    .long 0, 0, 0, 0, 0, 0, 0, 0, 0, 0, 0, 0, 0, 0, 0, 0
    .long 4, 24, 24, 8192, 6144, 268288, 8388608, 0, 32768, 4, 21069824, 131072, 0, 0, 218104416, 1
    .long 4, 24, 24, 8192, 6144, 268288, 8388608, 262144, 32768, 4, 22118400, 131072, 0, 0, 218104544, 1
    .long 1, 32, 32, 8192, 6144, 6400, 8388608, 1048576, 32768, 8, 42041344, 131072, 0, 0, 218104928, 4
    .long 1, 32, 32, 8192, 6144, 6400, 8388608, 2097152, 32768, 8, 46235648, 131072, 0, 0, 218105440, 4
    .long 1, 32, 32, 8192, 6144, 6400, 8388608, 2621440, 32768, 8, 48332800, 131072, 0, 0, 218105696, 4
    .long 1, 32, 32, 8192, 6144, 6400, 8388608, 3145728, 32768, 8, 50429952, 131072, 0, 0, 218105952, 4
    .long 1, 32, 32, 8192, 6144, 6400, 8388608, 3670016, 32768, 8, 52527104, 131072, 0, 0, 218106208, 4
    .long 0, 0, 0, 0, 0, 0, 0, 0, 0, 0, 0, 0, 0, 0, 0, 0
    .long 0, 0, 0, 0, 0, 0, 0, 0, 0, 0, 0, 0, 0, 0, 0, 0
    .long 0, 0, 0, 0, 0, 0, 0, 0, 0, 0, 0, 0, 0, 0, 0, 0
    .long 4, 24, 24, 8192, 256, 262400, 8388608, 0, 32768, 4, 20975616, 131072, 0, 0, 218104320, 1
    .long 4, 24, 24, 8192, 256, 262400, 8388608, 262144, 32768, 4, 22024192, 131072, 0, 0, 218104448, 1
    .long 1, 32, 32, 8192, 512, 768, 8388608, 1048576, 32768, 8, 41951232, 131072, 0, 0, 218104832, 4
    .long 1, 32, 32, 8192, 512, 768, 8388608, 2097152, 32768, 8, 46145536, 131072, 0, 0, 218105344, 4
    .long 1, 32, 32, 8192, 512, 768, 8388608, 2621440, 32768, 8, 48242688, 131072, 0, 0, 218105600, 4
    .long 1, 32, 32, 8192, 512, 768, 8388608, 3145728, 32768, 8, 50339840, 131072, 0, 0, 218105856, 4
    .long 1, 32, 32, 8192, 512, 768, 8388608, 3670016, 32768, 8, 52436992, 131072, 0, 0, 218106112, 4
    .long 0, 0, 0, 0, 0, 0, 0, 0, 0, 0, 0, 0, 0, 0, 0, 0
    .long 0, 0, 0, 0, 0, 0, 0, 0, 0, 0, 0, 0, 0, 0, 0, 0
    .long 0, 0, 0, 0, 0, 0, 0, 0, 0, 0, 0, 0, 0, 0, 0, 0
    .long 4, 24, 24, 8192, 2304, 264448, 8388608, 0, 32768, 4, 21008384, 131072, 0, 0, 218104352, 1
    .long 4, 24, 24, 8192, 2304, 264448, 8388608, 262144, 32768, 4, 22056960, 131072, 0, 0, 218104480, 1
    .long 1, 32, 32, 8192, 2560, 2816, 8388608, 1048576, 32768, 8, 41984000, 131072, 0, 0, 218104864, 4
    .long 1, 32, 32, 8192, 2560, 2816, 8388608, 2097152, 32768, 8, 46178304, 131072, 0, 0, 218105376, 4
    .long 1, 32, 32, 8192, 2560, 2816, 8388608, 2621440, 32768, 8, 48275456, 131072, 0, 0, 218105632, 4
    .long 1, 32, 32, 8192, 2560, 2816, 8388608, 3145728, 32768, 8, 50372608, 131072, 0, 0, 218105888, 4
    .long 1, 32, 32, 8192, 2560, 2816, 8388608, 3670016, 32768, 8, 52469760, 131072, 0, 0, 218106144, 4
    .long 0, 0, 0, 0, 0, 0, 0, 0, 0, 0, 0, 0, 0, 0, 0, 0
    .long 0, 0, 0, 0, 0, 0, 0, 0, 0, 0, 0, 0, 0, 0, 0, 0
    .long 0, 0, 0, 0, 0, 0, 0, 0, 0, 0, 0, 0, 0, 0, 0, 0
    .long 4, 24, 24, 8192, 4352, 266496, 8388608, 0, 32768, 4, 21041152, 131072, 0, 0, 218104384, 1
    .long 4, 24, 24, 8192, 4352, 266496, 8388608, 262144, 32768, 4, 22089728, 131072, 0, 0, 218104512, 1
    .long 1, 32, 32, 8192, 4608, 4864, 8388608, 1048576, 32768, 8, 42016768, 131072, 0, 0, 218104896, 4
    .long 1, 32, 32, 8192, 4608, 4864, 8388608, 2097152, 32768, 8, 46211072, 131072, 0, 0, 218105408, 4
    .long 1, 32, 32, 8192, 4608, 4864, 8388608, 2621440, 32768, 8, 48308224, 131072, 0, 0, 218105664, 4
    .long 1, 32, 32, 8192, 4608, 4864, 8388608, 3145728, 32768, 8, 50405376, 131072, 0, 0, 218105920, 4
    .long 1, 32, 32, 8192, 4608, 4864, 8388608, 3670016, 32768, 8, 52502528, 131072, 0, 0, 218106176, 4
    .long 0, 0, 0, 0, 0, 0, 0, 0, 0, 0, 0, 0, 0, 0, 0, 0
    .long 0, 0, 0, 0, 0, 0, 0, 0, 0, 0, 0, 0, 0, 0, 0, 0
    .long 0, 0, 0, 0, 0, 0, 0, 0, 0, 0, 0, 0, 0, 0, 0, 0
    .long 4, 24, 24, 8192, 6400, 268544, 8388608, 0, 32768, 4, 21073920, 131072, 0, 0, 218104416, 1
    .long 4, 24, 24, 8192, 6400, 268544, 8388608, 262144, 32768, 4, 22122496, 131072, 0, 0, 218104544, 1
    .long 1, 32, 32, 8192, 6656, 6912, 8388608, 1048576, 32768, 8, 42049536, 131072, 0, 0, 218104928, 4
    .long 1, 32, 32, 8192, 6656, 6912, 8388608, 2097152, 32768, 8, 46243840, 131072, 0, 0, 218105440, 4
    .long 1, 32, 32, 8192, 6656, 6912, 8388608, 2621440, 32768, 8, 48340992, 131072, 0, 0, 218105696, 4
    .long 1, 32, 32, 8192, 6656, 6912, 8388608, 3145728, 32768, 8, 50438144, 131072, 0, 0, 218105952, 4
    .long 1, 32, 32, 8192, 6656, 6912, 8388608, 3670016, 32768, 8, 52535296, 131072, 0, 0, 218106208, 4
    .long 0, 0, 0, 0, 0, 0, 0, 0, 0, 0, 0, 0, 0, 0, 0, 0
    .long 0, 0, 0, 0, 0, 0, 0, 0, 0, 0, 0, 0, 0, 0, 0, 0
    .long 0, 0, 0, 0, 0, 0, 0, 0, 0, 0, 0, 0, 0, 0, 0, 0
    .long 4, 24, 24, 8192, 512, 262656, 8388608, 0, 32768, 4, 20979712, 131072, 0, 0, 218104320, 1
    .long 4, 24, 24, 8192, 512, 262656, 8388608, 262144, 32768, 4, 22028288, 131072, 0, 0, 218104448, 1
    .long 1, 32, 32, 8192, 1024, 1280, 8388608, 1048576, 32768, 8, 41959424, 131072, 0, 0, 218104848, 4
    .long 1, 32, 32, 8192, 1024, 1280, 8388608, 2097152, 32768, 8, 46153728, 131072, 0, 0, 218105360, 4
    .long 1, 32, 32, 8192, 1024, 1280, 8388608, 2621440, 32768, 8, 48250880, 131072, 0, 0, 218105616, 4
    .long 1, 32, 32, 8192, 1024, 1280, 8388608, 3145728, 32768, 8, 50348032, 131072, 0, 0, 218105872, 4
    .long 1, 32, 32, 8192, 1024, 1280, 8388608, 3670016, 32768, 8, 52445184, 131072, 0, 0, 218106128, 4
    .long 0, 0, 0, 0, 0, 0, 0, 0, 0, 0, 0, 0, 0, 0, 0, 0
    .long 0, 0, 0, 0, 0, 0, 0, 0, 0, 0, 0, 0, 0, 0, 0, 0
    .long 0, 0, 0, 0, 0, 0, 0, 0, 0, 0, 0, 0, 0, 0, 0, 0
    .long 4, 24, 24, 8192, 2560, 264704, 8388608, 0, 32768, 4, 21012480, 131072, 0, 0, 218104352, 1
    .long 4, 24, 24, 8192, 2560, 264704, 8388608, 262144, 32768, 4, 22061056, 131072, 0, 0, 218104480, 1
    .long 1, 32, 32, 8192, 3072, 3328, 8388608, 1048576, 32768, 8, 41992192, 131072, 0, 0, 218104880, 4
    .long 1, 32, 32, 8192, 3072, 3328, 8388608, 2097152, 32768, 8, 46186496, 131072, 0, 0, 218105392, 4
    .long 1, 32, 32, 8192, 3072, 3328, 8388608, 2621440, 32768, 8, 48283648, 131072, 0, 0, 218105648, 4
    .long 1, 32, 32, 8192, 3072, 3328, 8388608, 3145728, 32768, 8, 50380800, 131072, 0, 0, 218105904, 4
    .long 1, 32, 32, 8192, 3072, 3328, 8388608, 3670016, 32768, 8, 52477952, 131072, 0, 0, 218106160, 4
    .long 0, 0, 0, 0, 0, 0, 0, 0, 0, 0, 0, 0, 0, 0, 0, 0
    .long 0, 0, 0, 0, 0, 0, 0, 0, 0, 0, 0, 0, 0, 0, 0, 0
    .long 0, 0, 0, 0, 0, 0, 0, 0, 0, 0, 0, 0, 0, 0, 0, 0
    .long 4, 24, 24, 8192, 4608, 266752, 8388608, 0, 32768, 4, 21045248, 131072, 0, 0, 218104384, 1
    .long 4, 24, 24, 8192, 4608, 266752, 8388608, 262144, 32768, 4, 22093824, 131072, 0, 0, 218104512, 1
    .long 1, 32, 32, 8192, 5120, 5376, 8388608, 1048576, 32768, 8, 42024960, 131072, 0, 0, 218104912, 4
    .long 1, 32, 32, 8192, 5120, 5376, 8388608, 2097152, 32768, 8, 46219264, 131072, 0, 0, 218105424, 4
    .long 1, 32, 32, 8192, 5120, 5376, 8388608, 2621440, 32768, 8, 48316416, 131072, 0, 0, 218105680, 4
    .long 1, 32, 32, 8192, 5120, 5376, 8388608, 3145728, 32768, 8, 50413568, 131072, 0, 0, 218105936, 4
    .long 1, 32, 32, 8192, 5120, 5376, 8388608, 3670016, 32768, 8, 52510720, 131072, 0, 0, 218106192, 4
    .long 0, 0, 0, 0, 0, 0, 0, 0, 0, 0, 0, 0, 0, 0, 0, 0
    .long 0, 0, 0, 0, 0, 0, 0, 0, 0, 0, 0, 0, 0, 0, 0, 0
    .long 0, 0, 0, 0, 0, 0, 0, 0, 0, 0, 0, 0, 0, 0, 0, 0
    .long 4, 24, 24, 8192, 6656, 268800, 8388608, 0, 32768, 4, 21078016, 131072, 0, 0, 218104416, 1
    .long 4, 24, 24, 8192, 6656, 268800, 8388608, 262144, 32768, 4, 22126592, 131072, 0, 0, 218104544, 1
    .long 1, 32, 32, 8192, 7168, 7424, 8388608, 1048576, 32768, 8, 42057728, 131072, 0, 0, 218104944, 4
    .long 1, 32, 32, 8192, 7168, 7424, 8388608, 2097152, 32768, 8, 46252032, 131072, 0, 0, 218105456, 4
    .long 1, 32, 32, 8192, 7168, 7424, 8388608, 2621440, 32768, 8, 48349184, 131072, 0, 0, 218105712, 4
    .long 1, 32, 32, 8192, 7168, 7424, 8388608, 3145728, 32768, 8, 50446336, 131072, 0, 0, 218105968, 4
    .long 1, 32, 32, 8192, 7168, 7424, 8388608, 3670016, 32768, 8, 52543488, 131072, 0, 0, 218106224, 4
    .long 0, 0, 0, 0, 0, 0, 0, 0, 0, 0, 0, 0, 0, 0, 0, 0
    .long 0, 0, 0, 0, 0, 0, 0, 0, 0, 0, 0, 0, 0, 0, 0, 0
    .long 0, 0, 0, 0, 0, 0, 0, 0, 0, 0, 0, 0, 0, 0, 0, 0
    .long 4, 24, 24, 8192, 768, 262912, 8388608, 0, 32768, 4, 20983808, 131072, 0, 0, 218104320, 1
    .long 4, 24, 24, 8192, 768, 262912, 8388608, 262144, 32768, 4, 22032384, 131072, 0, 0, 218104448, 1
    .long 1, 32, 32, 8192, 1536, 1792, 8388608, 1048576, 32768, 8, 41967616, 131072, 0, 0, 218104848, 4
    .long 1, 32, 32, 8192, 1536, 1792, 8388608, 2097152, 32768, 8, 46161920, 131072, 0, 0, 218105360, 4
    .long 1, 32, 32, 8192, 1536, 1792, 8388608, 2621440, 32768, 8, 48259072, 131072, 0, 0, 218105616, 4
    .long 1, 32, 32, 8192, 1536, 1792, 8388608, 3145728, 32768, 8, 50356224, 131072, 0, 0, 218105872, 4
    .long 1, 32, 32, 8192, 1536, 1792, 8388608, 3670016, 32768, 8, 52453376, 131072, 0, 0, 218106128, 4
    .long 0, 0, 0, 0, 0, 0, 0, 0, 0, 0, 0, 0, 0, 0, 0, 0
    .long 0, 0, 0, 0, 0, 0, 0, 0, 0, 0, 0, 0, 0, 0, 0, 0
    .long 0, 0, 0, 0, 0, 0, 0, 0, 0, 0, 0, 0, 0, 0, 0, 0
    .long 4, 24, 24, 8192, 2816, 264960, 8388608, 0, 32768, 4, 21016576, 131072, 0, 0, 218104352, 1
    .long 4, 24, 24, 8192, 2816, 264960, 8388608, 262144, 32768, 4, 22065152, 131072, 0, 0, 218104480, 1
    .long 1, 32, 32, 8192, 3584, 3840, 8388608, 1048576, 32768, 8, 42000384, 131072, 0, 0, 218104880, 4
    .long 1, 32, 32, 8192, 3584, 3840, 8388608, 2097152, 32768, 8, 46194688, 131072, 0, 0, 218105392, 4
    .long 1, 32, 32, 8192, 3584, 3840, 8388608, 2621440, 32768, 8, 48291840, 131072, 0, 0, 218105648, 4
    .long 1, 32, 32, 8192, 3584, 3840, 8388608, 3145728, 32768, 8, 50388992, 131072, 0, 0, 218105904, 4
    .long 1, 32, 32, 8192, 3584, 3840, 8388608, 3670016, 32768, 8, 52486144, 131072, 0, 0, 218106160, 4
    .long 0, 0, 0, 0, 0, 0, 0, 0, 0, 0, 0, 0, 0, 0, 0, 0
    .long 0, 0, 0, 0, 0, 0, 0, 0, 0, 0, 0, 0, 0, 0, 0, 0
    .long 0, 0, 0, 0, 0, 0, 0, 0, 0, 0, 0, 0, 0, 0, 0, 0
    .long 4, 24, 24, 8192, 4864, 267008, 8388608, 0, 32768, 4, 21049344, 131072, 0, 0, 218104384, 1
    .long 4, 24, 24, 8192, 4864, 267008, 8388608, 262144, 32768, 4, 22097920, 131072, 0, 0, 218104512, 1
    .long 1, 32, 32, 8192, 5632, 5888, 8388608, 1048576, 32768, 8, 42033152, 131072, 0, 0, 218104912, 4
    .long 1, 32, 32, 8192, 5632, 5888, 8388608, 2097152, 32768, 8, 46227456, 131072, 0, 0, 218105424, 4
    .long 1, 32, 32, 8192, 5632, 5888, 8388608, 2621440, 32768, 8, 48324608, 131072, 0, 0, 218105680, 4
    .long 1, 32, 32, 8192, 5632, 5888, 8388608, 3145728, 32768, 8, 50421760, 131072, 0, 0, 218105936, 4
    .long 1, 32, 32, 8192, 5632, 5888, 8388608, 3670016, 32768, 8, 52518912, 131072, 0, 0, 218106192, 4
    .long 0, 0, 0, 0, 0, 0, 0, 0, 0, 0, 0, 0, 0, 0, 0, 0
    .long 0, 0, 0, 0, 0, 0, 0, 0, 0, 0, 0, 0, 0, 0, 0, 0
    .long 0, 0, 0, 0, 0, 0, 0, 0, 0, 0, 0, 0, 0, 0, 0, 0
    .long 4, 24, 24, 8192, 6912, 269056, 8388608, 0, 32768, 4, 21082112, 131072, 0, 0, 218104416, 1
    .long 4, 24, 24, 8192, 6912, 269056, 8388608, 262144, 32768, 4, 22130688, 131072, 0, 0, 218104544, 1
    .long 1, 32, 32, 8192, 7680, 7936, 8388608, 1048576, 32768, 8, 42065920, 131072, 0, 0, 218104944, 4
    .long 1, 32, 32, 8192, 7680, 7936, 8388608, 2097152, 32768, 8, 46260224, 131072, 0, 0, 218105456, 4
    .long 1, 32, 32, 8192, 7680, 7936, 8388608, 2621440, 32768, 8, 48357376, 131072, 0, 0, 218105712, 4
    .long 1, 32, 32, 8192, 7680, 7936, 8388608, 3145728, 32768, 8, 50454528, 131072, 0, 0, 218105968, 4
    .long 1, 32, 32, 8192, 7680, 7936, 8388608, 3670016, 32768, 8, 52551680, 131072, 0, 0, 218106224, 4
    .long 0, 0, 0, 0, 0, 0, 0, 0, 0, 0, 0, 0, 0, 0, 0, 0
    .long 0, 0, 0, 0, 0, 0, 0, 0, 0, 0, 0, 0, 0, 0, 0, 0
    .long 0, 0, 0, 0, 0, 0, 0, 0, 0, 0, 0, 0, 0, 0, 0, 0
    .long 4, 24, 24, 8192, 1024, 263168, 8388608, 0, 32768, 4, 20987904, 131072, 0, 0, 218104336, 1
    .long 4, 24, 24, 8192, 1024, 263168, 8388608, 262144, 32768, 4, 22036480, 131072, 0, 0, 218104464, 1
    .long 1, 24, 24, 8192, 0, 256, 8388608, 1048576, 32768, 8, 25165824, 131072, 0, 0, 218104832, 4
    .long 1, 24, 24, 8192, 0, 256, 8388608, 2097152, 32768, 8, 29360128, 131072, 0, 0, 218105344, 4
    .long 1, 24, 24, 8192, 0, 256, 8388608, 2621440, 32768, 8, 31457280, 131072, 0, 0, 218105600, 4
    .long 1, 24, 24, 8192, 0, 256, 8388608, 3145728, 32768, 8, 33554432, 131072, 0, 0, 218105856, 4
    .long 1, 24, 24, 8192, 0, 256, 8388608, 3670016, 32768, 8, 35651584, 131072, 0, 0, 218106112, 4
    .long 0, 0, 0, 0, 0, 0, 0, 0, 0, 0, 0, 0, 0, 0, 0, 0
    .long 0, 0, 0, 0, 0, 0, 0, 0, 0, 0, 0, 0, 0, 0, 0, 0
    .long 0, 0, 0, 0, 0, 0, 0, 0, 0, 0, 0, 0, 0, 0, 0, 0
    .long 4, 24, 24, 8192, 3072, 265216, 8388608, 0, 32768, 4, 21020672, 131072, 0, 0, 218104368, 1
    .long 4, 24, 24, 8192, 3072, 265216, 8388608, 262144, 32768, 4, 22069248, 131072, 0, 0, 218104496, 1
    .long 1, 24, 24, 8192, 2048, 2304, 8388608, 1048576, 32768, 8, 25198592, 131072, 0, 0, 218104864, 4
    .long 1, 24, 24, 8192, 2048, 2304, 8388608, 2097152, 32768, 8, 29392896, 131072, 0, 0, 218105376, 4
    .long 1, 24, 24, 8192, 2048, 2304, 8388608, 2621440, 32768, 8, 31490048, 131072, 0, 0, 218105632, 4
    .long 1, 24, 24, 8192, 2048, 2304, 8388608, 3145728, 32768, 8, 33587200, 131072, 0, 0, 218105888, 4
    .long 1, 24, 24, 8192, 2048, 2304, 8388608, 3670016, 32768, 8, 35684352, 131072, 0, 0, 218106144, 4
    .long 0, 0, 0, 0, 0, 0, 0, 0, 0, 0, 0, 0, 0, 0, 0, 0
    .long 0, 0, 0, 0, 0, 0, 0, 0, 0, 0, 0, 0, 0, 0, 0, 0
    .long 0, 0, 0, 0, 0, 0, 0, 0, 0, 0, 0, 0, 0, 0, 0, 0
    .long 4, 24, 24, 8192, 5120, 267264, 8388608, 0, 32768, 4, 21053440, 131072, 0, 0, 218104400, 1
    .long 4, 24, 24, 8192, 5120, 267264, 8388608, 262144, 32768, 4, 22102016, 131072, 0, 0, 218104528, 1
    .long 1, 24, 24, 8192, 4096, 4352, 8388608, 1048576, 32768, 8, 25231360, 131072, 0, 0, 218104896, 4
    .long 1, 24, 24, 8192, 4096, 4352, 8388608, 2097152, 32768, 8, 29425664, 131072, 0, 0, 218105408, 4
    .long 1, 24, 24, 8192, 4096, 4352, 8388608, 2621440, 32768, 8, 31522816, 131072, 0, 0, 218105664, 4
    .long 1, 24, 24, 8192, 4096, 4352, 8388608, 3145728, 32768, 8, 33619968, 131072, 0, 0, 218105920, 4
    .long 1, 24, 24, 8192, 4096, 4352, 8388608, 3670016, 32768, 8, 35717120, 131072, 0, 0, 218106176, 4
    .long 0, 0, 0, 0, 0, 0, 0, 0, 0, 0, 0, 0, 0, 0, 0, 0
    .long 0, 0, 0, 0, 0, 0, 0, 0, 0, 0, 0, 0, 0, 0, 0, 0
    .long 0, 0, 0, 0, 0, 0, 0, 0, 0, 0, 0, 0, 0, 0, 0, 0
    .long 4, 24, 24, 8192, 7168, 269312, 8388608, 0, 32768, 4, 21086208, 131072, 0, 0, 218104432, 1
    .long 4, 24, 24, 8192, 7168, 269312, 8388608, 262144, 32768, 4, 22134784, 131072, 0, 0, 218104560, 1
    .long 1, 24, 24, 8192, 6144, 6400, 8388608, 1048576, 32768, 8, 25264128, 131072, 0, 0, 218104928, 4
    .long 1, 24, 24, 8192, 6144, 6400, 8388608, 2097152, 32768, 8, 29458432, 131072, 0, 0, 218105440, 4
    .long 1, 24, 24, 8192, 6144, 6400, 8388608, 2621440, 32768, 8, 31555584, 131072, 0, 0, 218105696, 4
    .long 1, 24, 24, 8192, 6144, 6400, 8388608, 3145728, 32768, 8, 33652736, 131072, 0, 0, 218105952, 4
    .long 1, 24, 24, 8192, 6144, 6400, 8388608, 3670016, 32768, 8, 35749888, 131072, 0, 0, 218106208, 4
    .long 0, 0, 0, 0, 0, 0, 0, 0, 0, 0, 0, 0, 0, 0, 0, 0
    .long 0, 0, 0, 0, 0, 0, 0, 0, 0, 0, 0, 0, 0, 0, 0, 0
    .long 0, 0, 0, 0, 0, 0, 0, 0, 0, 0, 0, 0, 0, 0, 0, 0
    .long 4, 24, 24, 8192, 1280, 263424, 8388608, 0, 32768, 4, 20992000, 131072, 0, 0, 218104336, 1
    .long 4, 24, 24, 8192, 1280, 263424, 8388608, 262144, 32768, 4, 22040576, 131072, 0, 0, 218104464, 1
    .long 1, 24, 24, 8192, 512, 768, 8388608, 1048576, 32768, 8, 25174016, 131072, 0, 0, 218104832, 4
    .long 1, 24, 24, 8192, 512, 768, 8388608, 2097152, 32768, 8, 29368320, 131072, 0, 0, 218105344, 4
    .long 1, 24, 24, 8192, 512, 768, 8388608, 2621440, 32768, 8, 31465472, 131072, 0, 0, 218105600, 4
    .long 1, 24, 24, 8192, 512, 768, 8388608, 3145728, 32768, 8, 33562624, 131072, 0, 0, 218105856, 4
    .long 1, 24, 24, 8192, 512, 768, 8388608, 3670016, 32768, 8, 35659776, 131072, 0, 0, 218106112, 4
    .long 0, 0, 0, 0, 0, 0, 0, 0, 0, 0, 0, 0, 0, 0, 0, 0
    .long 0, 0, 0, 0, 0, 0, 0, 0, 0, 0, 0, 0, 0, 0, 0, 0
    .long 0, 0, 0, 0, 0, 0, 0, 0, 0, 0, 0, 0, 0, 0, 0, 0
    .long 4, 24, 24, 8192, 3328, 265472, 8388608, 0, 32768, 4, 21024768, 131072, 0, 0, 218104368, 1
    .long 4, 24, 24, 8192, 3328, 265472, 8388608, 262144, 32768, 4, 22073344, 131072, 0, 0, 218104496, 1
    .long 1, 24, 24, 8192, 2560, 2816, 8388608, 1048576, 32768, 8, 25206784, 131072, 0, 0, 218104864, 4
    .long 1, 24, 24, 8192, 2560, 2816, 8388608, 2097152, 32768, 8, 29401088, 131072, 0, 0, 218105376, 4
    .long 1, 24, 24, 8192, 2560, 2816, 8388608, 2621440, 32768, 8, 31498240, 131072, 0, 0, 218105632, 4
    .long 1, 24, 24, 8192, 2560, 2816, 8388608, 3145728, 32768, 8, 33595392, 131072, 0, 0, 218105888, 4
    .long 1, 24, 24, 8192, 2560, 2816, 8388608, 3670016, 32768, 8, 35692544, 131072, 0, 0, 218106144, 4
    .long 0, 0, 0, 0, 0, 0, 0, 0, 0, 0, 0, 0, 0, 0, 0, 0
    .long 0, 0, 0, 0, 0, 0, 0, 0, 0, 0, 0, 0, 0, 0, 0, 0
    .long 0, 0, 0, 0, 0, 0, 0, 0, 0, 0, 0, 0, 0, 0, 0, 0
    .long 4, 24, 24, 8192, 5376, 267520, 8388608, 0, 32768, 4, 21057536, 131072, 0, 0, 218104400, 1
    .long 4, 24, 24, 8192, 5376, 267520, 8388608, 262144, 32768, 4, 22106112, 131072, 0, 0, 218104528, 1
    .long 1, 24, 24, 8192, 4608, 4864, 8388608, 1048576, 32768, 8, 25239552, 131072, 0, 0, 218104896, 4
    .long 1, 24, 24, 8192, 4608, 4864, 8388608, 2097152, 32768, 8, 29433856, 131072, 0, 0, 218105408, 4
    .long 1, 24, 24, 8192, 4608, 4864, 8388608, 2621440, 32768, 8, 31531008, 131072, 0, 0, 218105664, 4
    .long 1, 24, 24, 8192, 4608, 4864, 8388608, 3145728, 32768, 8, 33628160, 131072, 0, 0, 218105920, 4
    .long 1, 24, 24, 8192, 4608, 4864, 8388608, 3670016, 32768, 8, 35725312, 131072, 0, 0, 218106176, 4
    .long 0, 0, 0, 0, 0, 0, 0, 0, 0, 0, 0, 0, 0, 0, 0, 0
    .long 0, 0, 0, 0, 0, 0, 0, 0, 0, 0, 0, 0, 0, 0, 0, 0
    .long 0, 0, 0, 0, 0, 0, 0, 0, 0, 0, 0, 0, 0, 0, 0, 0
    .long 4, 24, 24, 8192, 7424, 269568, 8388608, 0, 32768, 4, 21090304, 131072, 0, 0, 218104432, 1
    .long 4, 24, 24, 8192, 7424, 269568, 8388608, 262144, 32768, 4, 22138880, 131072, 0, 0, 218104560, 1
    .long 1, 24, 24, 8192, 6656, 6912, 8388608, 1048576, 32768, 8, 25272320, 131072, 0, 0, 218104928, 4
    .long 1, 24, 24, 8192, 6656, 6912, 8388608, 2097152, 32768, 8, 29466624, 131072, 0, 0, 218105440, 4
    .long 1, 24, 24, 8192, 6656, 6912, 8388608, 2621440, 32768, 8, 31563776, 131072, 0, 0, 218105696, 4
    .long 1, 24, 24, 8192, 6656, 6912, 8388608, 3145728, 32768, 8, 33660928, 131072, 0, 0, 218105952, 4
    .long 1, 24, 24, 8192, 6656, 6912, 8388608, 3670016, 32768, 8, 35758080, 131072, 0, 0, 218106208, 4
    .long 0, 0, 0, 0, 0, 0, 0, 0, 0, 0, 0, 0, 0, 0, 0, 0
    .long 0, 0, 0, 0, 0, 0, 0, 0, 0, 0, 0, 0, 0, 0, 0, 0
    .long 0, 0, 0, 0, 0, 0, 0, 0, 0, 0, 0, 0, 0, 0, 0, 0
    .long 4, 24, 24, 8192, 1536, 263680, 8388608, 0, 32768, 4, 20996096, 131072, 0, 0, 218104336, 1
    .long 4, 24, 24, 8192, 1536, 263680, 8388608, 262144, 32768, 4, 22044672, 131072, 0, 0, 218104464, 1
    .long 1, 24, 24, 8192, 1024, 1280, 8388608, 1048576, 32768, 8, 25182208, 131072, 0, 0, 218104848, 4
    .long 1, 24, 24, 8192, 1024, 1280, 8388608, 2097152, 32768, 8, 29376512, 131072, 0, 0, 218105360, 4
    .long 1, 24, 24, 8192, 1024, 1280, 8388608, 2621440, 32768, 8, 31473664, 131072, 0, 0, 218105616, 4
    .long 1, 24, 24, 8192, 1024, 1280, 8388608, 3145728, 32768, 8, 33570816, 131072, 0, 0, 218105872, 4
    .long 1, 24, 24, 8192, 1024, 1280, 8388608, 3670016, 32768, 8, 35667968, 131072, 0, 0, 218106128, 4
    .long 0, 0, 0, 0, 0, 0, 0, 0, 0, 0, 0, 0, 0, 0, 0, 0
    .long 0, 0, 0, 0, 0, 0, 0, 0, 0, 0, 0, 0, 0, 0, 0, 0
    .long 0, 0, 0, 0, 0, 0, 0, 0, 0, 0, 0, 0, 0, 0, 0, 0
    .long 4, 24, 24, 8192, 3584, 265728, 8388608, 0, 32768, 4, 21028864, 131072, 0, 0, 218104368, 1
    .long 4, 24, 24, 8192, 3584, 265728, 8388608, 262144, 32768, 4, 22077440, 131072, 0, 0, 218104496, 1
    .long 1, 24, 24, 8192, 3072, 3328, 8388608, 1048576, 32768, 8, 25214976, 131072, 0, 0, 218104880, 4
    .long 1, 24, 24, 8192, 3072, 3328, 8388608, 2097152, 32768, 8, 29409280, 131072, 0, 0, 218105392, 4
    .long 1, 24, 24, 8192, 3072, 3328, 8388608, 2621440, 32768, 8, 31506432, 131072, 0, 0, 218105648, 4
    .long 1, 24, 24, 8192, 3072, 3328, 8388608, 3145728, 32768, 8, 33603584, 131072, 0, 0, 218105904, 4
    .long 1, 24, 24, 8192, 3072, 3328, 8388608, 3670016, 32768, 8, 35700736, 131072, 0, 0, 218106160, 4
    .long 0, 0, 0, 0, 0, 0, 0, 0, 0, 0, 0, 0, 0, 0, 0, 0
    .long 0, 0, 0, 0, 0, 0, 0, 0, 0, 0, 0, 0, 0, 0, 0, 0
    .long 0, 0, 0, 0, 0, 0, 0, 0, 0, 0, 0, 0, 0, 0, 0, 0
    .long 4, 24, 24, 8192, 5632, 267776, 8388608, 0, 32768, 4, 21061632, 131072, 0, 0, 218104400, 1
    .long 4, 24, 24, 8192, 5632, 267776, 8388608, 262144, 32768, 4, 22110208, 131072, 0, 0, 218104528, 1
    .long 1, 24, 24, 8192, 5120, 5376, 8388608, 1048576, 32768, 8, 25247744, 131072, 0, 0, 218104912, 4
    .long 1, 24, 24, 8192, 5120, 5376, 8388608, 2097152, 32768, 8, 29442048, 131072, 0, 0, 218105424, 4
    .long 1, 24, 24, 8192, 5120, 5376, 8388608, 2621440, 32768, 8, 31539200, 131072, 0, 0, 218105680, 4
    .long 1, 24, 24, 8192, 5120, 5376, 8388608, 3145728, 32768, 8, 33636352, 131072, 0, 0, 218105936, 4
    .long 1, 24, 24, 8192, 5120, 5376, 8388608, 3670016, 32768, 8, 35733504, 131072, 0, 0, 218106192, 4
    .long 0, 0, 0, 0, 0, 0, 0, 0, 0, 0, 0, 0, 0, 0, 0, 0
    .long 0, 0, 0, 0, 0, 0, 0, 0, 0, 0, 0, 0, 0, 0, 0, 0
    .long 0, 0, 0, 0, 0, 0, 0, 0, 0, 0, 0, 0, 0, 0, 0, 0
    .long 4, 24, 24, 8192, 7680, 269824, 8388608, 0, 32768, 4, 21094400, 131072, 0, 0, 218104432, 1
    .long 4, 24, 24, 8192, 7680, 269824, 8388608, 262144, 32768, 4, 22142976, 131072, 0, 0, 218104560, 1
    .long 1, 24, 24, 8192, 7168, 7424, 8388608, 1048576, 32768, 8, 25280512, 131072, 0, 0, 218104944, 4
    .long 1, 24, 24, 8192, 7168, 7424, 8388608, 2097152, 32768, 8, 29474816, 131072, 0, 0, 218105456, 4
    .long 1, 24, 24, 8192, 7168, 7424, 8388608, 2621440, 32768, 8, 31571968, 131072, 0, 0, 218105712, 4
    .long 1, 24, 24, 8192, 7168, 7424, 8388608, 3145728, 32768, 8, 33669120, 131072, 0, 0, 218105968, 4
    .long 1, 24, 24, 8192, 7168, 7424, 8388608, 3670016, 32768, 8, 35766272, 131072, 0, 0, 218106224, 4
    .long 0, 0, 0, 0, 0, 0, 0, 0, 0, 0, 0, 0, 0, 0, 0, 0
    .long 0, 0, 0, 0, 0, 0, 0, 0, 0, 0, 0, 0, 0, 0, 0, 0
    .long 0, 0, 0, 0, 0, 0, 0, 0, 0, 0, 0, 0, 0, 0, 0, 0
    .long 4, 24, 24, 8192, 1792, 263936, 8388608, 0, 32768, 4, 21000192, 131072, 0, 0, 218104336, 1
    .long 4, 24, 24, 8192, 1792, 263936, 8388608, 262144, 32768, 4, 22048768, 131072, 0, 0, 218104464, 1
    .long 1, 24, 24, 8192, 1536, 1792, 8388608, 1048576, 32768, 8, 25190400, 131072, 0, 0, 218104848, 4
    .long 1, 24, 24, 8192, 1536, 1792, 8388608, 2097152, 32768, 8, 29384704, 131072, 0, 0, 218105360, 4
    .long 1, 24, 24, 8192, 1536, 1792, 8388608, 2621440, 32768, 8, 31481856, 131072, 0, 0, 218105616, 4
    .long 1, 24, 24, 8192, 1536, 1792, 8388608, 3145728, 32768, 8, 33579008, 131072, 0, 0, 218105872, 4
    .long 1, 24, 24, 8192, 1536, 1792, 8388608, 3670016, 32768, 8, 35676160, 131072, 0, 0, 218106128, 4
    .long 0, 0, 0, 0, 0, 0, 0, 0, 0, 0, 0, 0, 0, 0, 0, 0
    .long 0, 0, 0, 0, 0, 0, 0, 0, 0, 0, 0, 0, 0, 0, 0, 0
    .long 0, 0, 0, 0, 0, 0, 0, 0, 0, 0, 0, 0, 0, 0, 0, 0
    .long 4, 24, 24, 8192, 3840, 265984, 8388608, 0, 32768, 4, 21032960, 131072, 0, 0, 218104368, 1
    .long 4, 24, 24, 8192, 3840, 265984, 8388608, 262144, 32768, 4, 22081536, 131072, 0, 0, 218104496, 1
    .long 1, 24, 24, 8192, 3584, 3840, 8388608, 1048576, 32768, 8, 25223168, 131072, 0, 0, 218104880, 4
    .long 1, 24, 24, 8192, 3584, 3840, 8388608, 2097152, 32768, 8, 29417472, 131072, 0, 0, 218105392, 4
    .long 1, 24, 24, 8192, 3584, 3840, 8388608, 2621440, 32768, 8, 31514624, 131072, 0, 0, 218105648, 4
    .long 1, 24, 24, 8192, 3584, 3840, 8388608, 3145728, 32768, 8, 33611776, 131072, 0, 0, 218105904, 4
    .long 1, 24, 24, 8192, 3584, 3840, 8388608, 3670016, 32768, 8, 35708928, 131072, 0, 0, 218106160, 4
    .long 0, 0, 0, 0, 0, 0, 0, 0, 0, 0, 0, 0, 0, 0, 0, 0
    .long 0, 0, 0, 0, 0, 0, 0, 0, 0, 0, 0, 0, 0, 0, 0, 0
    .long 0, 0, 0, 0, 0, 0, 0, 0, 0, 0, 0, 0, 0, 0, 0, 0
    .long 4, 24, 24, 8192, 5888, 268032, 8388608, 0, 32768, 4, 21065728, 131072, 0, 0, 218104400, 1
    .long 4, 24, 24, 8192, 5888, 268032, 8388608, 262144, 32768, 4, 22114304, 131072, 0, 0, 218104528, 1
    .long 1, 24, 24, 8192, 5632, 5888, 8388608, 1048576, 32768, 8, 25255936, 131072, 0, 0, 218104912, 4
    .long 1, 24, 24, 8192, 5632, 5888, 8388608, 2097152, 32768, 8, 29450240, 131072, 0, 0, 218105424, 4
    .long 1, 24, 24, 8192, 5632, 5888, 8388608, 2621440, 32768, 8, 31547392, 131072, 0, 0, 218105680, 4
    .long 1, 24, 24, 8192, 5632, 5888, 8388608, 3145728, 32768, 8, 33644544, 131072, 0, 0, 218105936, 4
    .long 1, 24, 24, 8192, 5632, 5888, 8388608, 3670016, 32768, 8, 35741696, 131072, 0, 0, 218106192, 4
    .long 0, 0, 0, 0, 0, 0, 0, 0, 0, 0, 0, 0, 0, 0, 0, 0
    .long 0, 0, 0, 0, 0, 0, 0, 0, 0, 0, 0, 0, 0, 0, 0, 0
    .long 0, 0, 0, 0, 0, 0, 0, 0, 0, 0, 0, 0, 0, 0, 0, 0
    .long 4, 24, 24, 8192, 7936, 270080, 8388608, 0, 32768, 4, 21098496, 131072, 0, 0, 218104432, 1
    .long 4, 24, 24, 8192, 7936, 270080, 8388608, 262144, 32768, 4, 22147072, 131072, 0, 0, 218104560, 1
    .long 1, 24, 24, 8192, 7680, 7936, 8388608, 1048576, 32768, 8, 25288704, 131072, 0, 0, 218104944, 4
    .long 1, 24, 24, 8192, 7680, 7936, 8388608, 2097152, 32768, 8, 29483008, 131072, 0, 0, 218105456, 4
    .long 1, 24, 24, 8192, 7680, 7936, 8388608, 2621440, 32768, 8, 31580160, 131072, 0, 0, 218105712, 4
    .long 1, 24, 24, 8192, 7680, 7936, 8388608, 3145728, 32768, 8, 33677312, 131072, 0, 0, 218105968, 4
    .long 1, 24, 24, 8192, 7680, 7936, 8388608, 3670016, 32768, 8, 35774464, 131072, 0, 0, 218106224, 4
    .long 0, 0, 0, 0, 0, 0, 0, 0, 0, 0, 0, 0, 0, 0, 0, 0
    .long 0, 0, 0, 0, 0, 0, 0, 0, 0, 0, 0, 0, 0, 0, 0, 0
    .long 0, 0, 0, 0, 0, 0, 0, 0, 0, 0, 0, 0, 0, 0, 0, 0
    .long 4, 32, 32, 8192, 0, 262144, 8388608, 0, 32768, 4, 37748736, 131072, 0, 0, 218104320, 1
    .long 4, 32, 32, 8192, 0, 262144, 8388608, 262144, 32768, 4, 38797312, 131072, 0, 0, 218104448, 1
    .long 4, 16, 16, 8192, 1792, 263936, 8388608, 786432, 32768, 4, 7368704, 131072, 0, 0, 218104592, 1
    .long 1, 32, 32, 8192, 1024, 1280, 8388608, 1572864, 32768, 8, 44056576, 131072, 0, 0, 218105104, 4
    .long 2, 64, 72, 7168, 3072, 3072, 7340032, 524288, 32768, 8, 56410112, 114688, 0, 0, 218103888, 1
    .long 2, 64, 72, 7168, 2048, 2048, 7340032, 2097152, 32768, 8, 61898752, 114688, 0, 0, 218104080, 1
    .long 1, 80, 80, 2048, 3670016, 3670272, 7340032, 54583296, 114688, 7, 176160768, 32768, 218103840, 7, 218106368, 1
    .long 1, 80, 80, 2048, 3670016, 3670272, 7340032, 60088320, 114688, 7, 177733632, 32768, 218104032, 7, 218106560, 1
    .long 0, 0, 0, 0, 0, 0, 0, 0, 0, 0, 0, 0, 0, 0, 0, 0
    .long 0, 0, 0, 0, 0, 0, 0, 0, 0, 0, 0, 0, 0, 0, 0, 0
    .long 4, 32, 32, 8192, 2048, 264192, 8388608, 0, 32768, 4, 37781504, 131072, 0, 0, 218104352, 1
    .long 4, 32, 32, 8192, 2048, 264192, 8388608, 262144, 32768, 4, 38830080, 131072, 0, 0, 218104480, 1
    .long 4, 16, 16, 8192, 3840, 265984, 8388608, 786432, 32768, 4, 7401472, 131072, 0, 0, 218104624, 1
    .long 1, 32, 32, 8192, 3072, 3328, 8388608, 1572864, 32768, 8, 44089344, 131072, 0, 0, 218105136, 4
    .long 2, 64, 72, 7168, 3328, 3328, 7340032, 524288, 32768, 8, 56414208, 114688, 0, 0, 218103888, 1
    .long 2, 64, 72, 7168, 2304, 2304, 7340032, 2097152, 32768, 8, 61902848, 114688, 0, 0, 218104080, 1
    .long 1, 80, 80, 2048, 3670528, 3670784, 7340032, 54583296, 114688, 7, 176168960, 32768, 218103840, 7, 218106368, 1
    .long 1, 80, 80, 2048, 3670528, 3670784, 7340032, 60088320, 114688, 7, 177741824, 32768, 218104032, 7, 218106560, 1
    .long 0, 0, 0, 0, 0, 0, 0, 0, 0, 0, 0, 0, 0, 0, 0, 0
    .long 0, 0, 0, 0, 0, 0, 0, 0, 0, 0, 0, 0, 0, 0, 0, 0
    .long 4, 32, 32, 8192, 4096, 266240, 8388608, 0, 32768, 4, 37814272, 131072, 0, 0, 218104384, 1
    .long 4, 32, 32, 8192, 4096, 266240, 8388608, 262144, 32768, 4, 38862848, 131072, 0, 0, 218104512, 1
    .long 4, 16, 16, 8192, 5888, 268032, 8388608, 786432, 32768, 4, 7434240, 131072, 0, 0, 218104656, 1
    .long 1, 32, 32, 8192, 5120, 5376, 8388608, 1572864, 32768, 8, 44122112, 131072, 0, 0, 218105168, 4
    .long 2, 64, 72, 7168, 3584, 3584, 7340032, 524288, 32768, 8, 56418304, 114688, 0, 0, 218103904, 1
    .long 2, 64, 72, 7168, 2560, 2560, 7340032, 2097152, 32768, 8, 61906944, 114688, 0, 0, 218104080, 1
    .long 1, 80, 80, 2048, 3671040, 3671296, 7340032, 54583296, 114688, 7, 176177152, 32768, 218103840, 7, 218106368, 1
    .long 1, 80, 80, 2048, 3671040, 3671296, 7340032, 60088320, 114688, 7, 177750016, 32768, 218104032, 7, 218106560, 1
    .long 0, 0, 0, 0, 0, 0, 0, 0, 0, 0, 0, 0, 0, 0, 0, 0
    .long 0, 0, 0, 0, 0, 0, 0, 0, 0, 0, 0, 0, 0, 0, 0, 0
    .long 4, 32, 32, 8192, 6144, 268288, 8388608, 0, 32768, 4, 37847040, 131072, 0, 0, 218104416, 1
    .long 4, 32, 32, 8192, 6144, 268288, 8388608, 262144, 32768, 4, 38895616, 131072, 0, 0, 218104544, 1
    .long 4, 16, 16, 8192, 7936, 270080, 8388608, 786432, 32768, 4, 7467008, 131072, 0, 0, 218104688, 1
    .long 1, 32, 32, 8192, 7168, 7424, 8388608, 1572864, 32768, 8, 44154880, 131072, 0, 0, 218105200, 4
    .long 2, 64, 72, 7168, 3840, 3840, 7340032, 524288, 32768, 8, 56422400, 114688, 0, 0, 218103904, 1
    .long 2, 64, 72, 7168, 2816, 2816, 7340032, 2097152, 32768, 8, 61911040, 114688, 0, 0, 218104080, 1
    .long 1, 80, 80, 2048, 3671552, 3671808, 7340032, 54583296, 114688, 7, 176185344, 32768, 218103840, 7, 218106368, 1
    .long 1, 80, 80, 2048, 3671552, 3671808, 7340032, 60088320, 114688, 7, 177758208, 32768, 218104032, 7, 218106560, 1
    .long 0, 0, 0, 0, 0, 0, 0, 0, 0, 0, 0, 0, 0, 0, 0, 0
    .long 0, 0, 0, 0, 0, 0, 0, 0, 0, 0, 0, 0, 0, 0, 0, 0
    .long 4, 32, 32, 8192, 256, 262400, 8388608, 0, 32768, 4, 37752832, 131072, 0, 0, 218104320, 1
    .long 4, 32, 32, 8192, 256, 262400, 8388608, 262144, 32768, 4, 38801408, 131072, 0, 0, 218104448, 1
    .long 4, 16, 16, 8192, 1792, 263936, 8388608, 524288, 32768, 4, 6320128, 131072, 0, 0, 218104592, 1
    .long 1, 32, 32, 8192, 1536, 1792, 8388608, 1572864, 32768, 8, 44064768, 131072, 0, 0, 218105104, 4
    .long 2, 64, 72, 7168, 4096, 4096, 7340032, 524288, 32768, 8, 56426496, 114688, 0, 0, 218103904, 1
    .long 2, 64, 72, 7168, 3072, 3072, 7340032, 2097152, 32768, 8, 61915136, 114688, 0, 0, 218104080, 1
    .long 1, 80, 80, 2048, 5505024, 5505280, 7340032, 54611968, 114688, 7, 180355072, 32768, 218103856, 7, 218106368, 1
    .long 1, 80, 80, 2048, 5505024, 5505280, 7340032, 60116992, 114688, 7, 181927936, 32768, 218104048, 7, 218106560, 1
    .long 0, 0, 0, 0, 0, 0, 0, 0, 0, 0, 0, 0, 0, 0, 0, 0
    .long 0, 0, 0, 0, 0, 0, 0, 0, 0, 0, 0, 0, 0, 0, 0, 0
    .long 4, 32, 32, 8192, 2304, 264448, 8388608, 0, 32768, 4, 37785600, 131072, 0, 0, 218104352, 1
    .long 4, 32, 32, 8192, 2304, 264448, 8388608, 262144, 32768, 4, 38834176, 131072, 0, 0, 218104480, 1
    .long 4, 16, 16, 8192, 3840, 265984, 8388608, 524288, 32768, 4, 6352896, 131072, 0, 0, 218104624, 1
    .long 1, 32, 32, 8192, 3584, 3840, 8388608, 1572864, 32768, 8, 44097536, 131072, 0, 0, 218105136, 4
    .long 2, 64, 72, 7168, 4352, 4352, 7340032, 524288, 32768, 8, 56430592, 114688, 0, 0, 218103904, 1
    .long 2, 64, 72, 7168, 3328, 3328, 7340032, 2097152, 32768, 8, 61919232, 114688, 0, 0, 218104080, 1
    .long 1, 80, 80, 2048, 5505536, 5505792, 7340032, 54611968, 114688, 7, 180363264, 32768, 218103856, 7, 218106368, 1
    .long 1, 80, 80, 2048, 5505536, 5505792, 7340032, 60116992, 114688, 7, 181936128, 32768, 218104048, 7, 218106560, 1
    .long 0, 0, 0, 0, 0, 0, 0, 0, 0, 0, 0, 0, 0, 0, 0, 0
    .long 0, 0, 0, 0, 0, 0, 0, 0, 0, 0, 0, 0, 0, 0, 0, 0
    .long 4, 32, 32, 8192, 4352, 266496, 8388608, 0, 32768, 4, 37818368, 131072, 0, 0, 218104384, 1
    .long 4, 32, 32, 8192, 4352, 266496, 8388608, 262144, 32768, 4, 38866944, 131072, 0, 0, 218104512, 1
    .long 4, 16, 16, 8192, 5888, 268032, 8388608, 524288, 32768, 4, 6385664, 131072, 0, 0, 218104656, 1
    .long 1, 32, 32, 8192, 5632, 5888, 8388608, 1572864, 32768, 8, 44130304, 131072, 0, 0, 218105168, 4
    .long 2, 64, 72, 7168, 4608, 4608, 7340032, 524288, 32768, 8, 56434688, 114688, 0, 0, 218103904, 1
    .long 2, 64, 72, 7168, 3584, 3584, 7340032, 2097152, 32768, 8, 61923328, 114688, 0, 0, 218104096, 1
    .long 1, 80, 80, 2048, 5506048, 5506304, 7340032, 54611968, 114688, 7, 180371456, 32768, 218103856, 7, 218106368, 1
    .long 1, 80, 80, 2048, 5506048, 5506304, 7340032, 60116992, 114688, 7, 181944320, 32768, 218104048, 7, 218106560, 1
    .long 0, 0, 0, 0, 0, 0, 0, 0, 0, 0, 0, 0, 0, 0, 0, 0
    .long 0, 0, 0, 0, 0, 0, 0, 0, 0, 0, 0, 0, 0, 0, 0, 0
    .long 4, 32, 32, 8192, 6400, 268544, 8388608, 0, 32768, 4, 37851136, 131072, 0, 0, 218104416, 1
    .long 4, 32, 32, 8192, 6400, 268544, 8388608, 262144, 32768, 4, 38899712, 131072, 0, 0, 218104544, 1
    .long 4, 16, 16, 8192, 7936, 270080, 8388608, 524288, 32768, 4, 6418432, 131072, 0, 0, 218104688, 1
    .long 1, 32, 32, 8192, 7680, 7936, 8388608, 1572864, 32768, 8, 44163072, 131072, 0, 0, 218105200, 4
    .long 2, 64, 72, 7168, 4864, 4864, 7340032, 524288, 32768, 8, 56438784, 114688, 0, 0, 218103904, 1
    .long 2, 64, 72, 7168, 3840, 3840, 7340032, 2097152, 32768, 8, 61927424, 114688, 0, 0, 218104096, 1
    .long 1, 80, 80, 2048, 5506560, 5506816, 7340032, 54611968, 114688, 7, 180379648, 32768, 218103856, 7, 218106368, 1
    .long 1, 80, 80, 2048, 5506560, 5506816, 7340032, 60116992, 114688, 7, 181952512, 32768, 218104048, 7, 218106560, 1
    .long 0, 0, 0, 0, 0, 0, 0, 0, 0, 0, 0, 0, 0, 0, 0, 0
    .long 0, 0, 0, 0, 0, 0, 0, 0, 0, 0, 0, 0, 0, 0, 0, 0
    .long 4, 32, 32, 8192, 512, 262656, 8388608, 0, 32768, 4, 37756928, 131072, 0, 0, 218104320, 1
    .long 4, 32, 32, 8192, 512, 262656, 8388608, 262144, 32768, 4, 38805504, 131072, 0, 0, 218104448, 1
    .long 4, 16, 16, 8192, 1536, 263680, 8388608, 786432, 32768, 4, 7364608, 131072, 0, 0, 218104592, 1
    .long 1, 24, 24, 8192, 0, 256, 8388608, 1572864, 32768, 8, 27262976, 131072, 0, 0, 218105088, 4
    .long 2, 64, 72, 7168, 5120, 5120, 7340032, 524288, 32768, 8, 56442880, 114688, 0, 0, 218103904, 1
    .long 2, 64, 72, 7168, 4096, 4096, 7340032, 2097152, 32768, 8, 61931520, 114688, 0, 0, 218104096, 1
    .long 1, 80, 80, 2048, 0, 256, 7340032, 56360960, 114688, 7, 168296448, 32768, 218103872, 7, 218106432, 1
    .long 1, 80, 80, 2048, 0, 256, 7340032, 61865984, 114688, 7, 169869312, 32768, 218104064, 7, 218106624, 1
    .long 0, 0, 0, 0, 0, 0, 0, 0, 0, 0, 0, 0, 0, 0, 0, 0
    .long 0, 0, 0, 0, 0, 0, 0, 0, 0, 0, 0, 0, 0, 0, 0, 0
    .long 4, 32, 32, 8192, 2560, 264704, 8388608, 0, 32768, 4, 37789696, 131072, 0, 0, 218104352, 1
    .long 4, 32, 32, 8192, 2560, 264704, 8388608, 262144, 32768, 4, 38838272, 131072, 0, 0, 218104480, 1
    .long 4, 16, 16, 8192, 3584, 265728, 8388608, 786432, 32768, 4, 7397376, 131072, 0, 0, 218104624, 1
    .long 1, 24, 24, 8192, 2048, 2304, 8388608, 1572864, 32768, 8, 27295744, 131072, 0, 0, 218105120, 4
    .long 2, 64, 72, 7168, 5376, 5376, 7340032, 524288, 32768, 8, 56446976, 114688, 0, 0, 218103920, 1
    .long 2, 64, 72, 7168, 4352, 4352, 7340032, 2097152, 32768, 8, 61935616, 114688, 0, 0, 218104096, 1
    .long 1, 80, 80, 2048, 512, 768, 7340032, 56360960, 114688, 7, 168304640, 32768, 218103872, 7, 218106432, 1
    .long 1, 80, 80, 2048, 512, 768, 7340032, 61865984, 114688, 7, 169877504, 32768, 218104064, 7, 218106624, 1
    .long 0, 0, 0, 0, 0, 0, 0, 0, 0, 0, 0, 0, 0, 0, 0, 0
    .long 0, 0, 0, 0, 0, 0, 0, 0, 0, 0, 0, 0, 0, 0, 0, 0
    .long 4, 32, 32, 8192, 4608, 266752, 8388608, 0, 32768, 4, 37822464, 131072, 0, 0, 218104384, 1
    .long 4, 32, 32, 8192, 4608, 266752, 8388608, 262144, 32768, 4, 38871040, 131072, 0, 0, 218104512, 1
    .long 4, 16, 16, 8192, 5632, 267776, 8388608, 786432, 32768, 4, 7430144, 131072, 0, 0, 218104656, 1
    .long 1, 24, 24, 8192, 4096, 4352, 8388608, 1572864, 32768, 8, 27328512, 131072, 0, 0, 218105152, 4
    .long 2, 64, 72, 7168, 5632, 5632, 7340032, 524288, 32768, 8, 56451072, 114688, 0, 0, 218103920, 1
    .long 2, 64, 72, 7168, 4608, 4608, 7340032, 2097152, 32768, 8, 61939712, 114688, 0, 0, 218104096, 1
    .long 1, 80, 80, 2048, 1024, 1280, 7340032, 56360960, 114688, 7, 168312832, 32768, 218103872, 7, 218106432, 1
    .long 1, 80, 80, 2048, 1024, 1280, 7340032, 61865984, 114688, 7, 169885696, 32768, 218104064, 7, 218106624, 1
    .long 0, 0, 0, 0, 0, 0, 0, 0, 0, 0, 0, 0, 0, 0, 0, 0
    .long 0, 0, 0, 0, 0, 0, 0, 0, 0, 0, 0, 0, 0, 0, 0, 0
    .long 4, 32, 32, 8192, 6656, 268800, 8388608, 0, 32768, 4, 37855232, 131072, 0, 0, 218104416, 1
    .long 4, 32, 32, 8192, 6656, 268800, 8388608, 262144, 32768, 4, 38903808, 131072, 0, 0, 218104544, 1
    .long 4, 16, 16, 8192, 7680, 269824, 8388608, 786432, 32768, 4, 7462912, 131072, 0, 0, 218104688, 1
    .long 1, 24, 24, 8192, 6144, 6400, 8388608, 1572864, 32768, 8, 27361280, 131072, 0, 0, 218105184, 4
    .long 2, 64, 72, 7168, 5888, 5888, 7340032, 524288, 32768, 8, 56455168, 114688, 0, 0, 218103920, 1
    .long 2, 64, 72, 7168, 4864, 4864, 7340032, 2097152, 32768, 8, 61943808, 114688, 0, 0, 218104096, 1
    .long 1, 80, 80, 2048, 1536, 1792, 7340032, 56360960, 114688, 7, 168321024, 32768, 218103872, 7, 218106432, 1
    .long 1, 80, 80, 2048, 1536, 1792, 7340032, 61865984, 114688, 7, 169893888, 32768, 218104064, 7, 218106624, 1
    .long 0, 0, 0, 0, 0, 0, 0, 0, 0, 0, 0, 0, 0, 0, 0, 0
    .long 0, 0, 0, 0, 0, 0, 0, 0, 0, 0, 0, 0, 0, 0, 0, 0
    .long 4, 32, 32, 8192, 768, 262912, 8388608, 0, 32768, 4, 37761024, 131072, 0, 0, 218104320, 1
    .long 4, 32, 32, 8192, 768, 262912, 8388608, 262144, 32768, 4, 38809600, 131072, 0, 0, 218104448, 1
    .long 4, 16, 16, 8192, 1536, 263680, 8388608, 524288, 32768, 4, 6316032, 131072, 0, 0, 218104592, 1
    .long 1, 24, 24, 8192, 512, 768, 8388608, 1572864, 32768, 8, 27271168, 131072, 0, 0, 218105088, 4
    .long 2, 64, 72, 7168, 6144, 6144, 7340032, 524288, 32768, 8, 56459264, 114688, 0, 0, 218103920, 1
    .long 2, 64, 72, 7168, 5120, 5120, 7340032, 2097152, 32768, 8, 61947904, 114688, 0, 0, 218104096, 1
    .long 1, 80, 80, 2048, 1835008, 1835264, 7340032, 56389632, 114688, 7, 172490752, 32768, 218103888, 7, 218106432, 1
    .long 1, 80, 80, 2048, 1835008, 1835264, 7340032, 61894656, 114688, 7, 174063616, 32768, 218104080, 7, 218106624, 1
    .long 0, 0, 0, 0, 0, 0, 0, 0, 0, 0, 0, 0, 0, 0, 0, 0
    .long 0, 0, 0, 0, 0, 0, 0, 0, 0, 0, 0, 0, 0, 0, 0, 0
    .long 4, 32, 32, 8192, 2816, 264960, 8388608, 0, 32768, 4, 37793792, 131072, 0, 0, 218104352, 1
    .long 4, 32, 32, 8192, 2816, 264960, 8388608, 262144, 32768, 4, 38842368, 131072, 0, 0, 218104480, 1
    .long 4, 16, 16, 8192, 3584, 265728, 8388608, 524288, 32768, 4, 6348800, 131072, 0, 0, 218104624, 1
    .long 1, 24, 24, 8192, 2560, 2816, 8388608, 1572864, 32768, 8, 27303936, 131072, 0, 0, 218105120, 4
    .long 2, 64, 72, 7168, 6400, 6400, 7340032, 524288, 32768, 8, 56463360, 114688, 0, 0, 218103920, 1
    .long 2, 64, 72, 7168, 5376, 5376, 7340032, 2097152, 32768, 8, 61952000, 114688, 0, 0, 218104112, 1
    .long 1, 80, 80, 2048, 1835520, 1835776, 7340032, 56389632, 114688, 7, 172498944, 32768, 218103888, 7, 218106432, 1
    .long 1, 80, 80, 2048, 1835520, 1835776, 7340032, 61894656, 114688, 7, 174071808, 32768, 218104080, 7, 218106624, 1
    .long 0, 0, 0, 0, 0, 0, 0, 0, 0, 0, 0, 0, 0, 0, 0, 0
    .long 0, 0, 0, 0, 0, 0, 0, 0, 0, 0, 0, 0, 0, 0, 0, 0
    .long 4, 32, 32, 8192, 4864, 267008, 8388608, 0, 32768, 4, 37826560, 131072, 0, 0, 218104384, 1
    .long 4, 32, 32, 8192, 4864, 267008, 8388608, 262144, 32768, 4, 38875136, 131072, 0, 0, 218104512, 1
    .long 4, 16, 16, 8192, 5632, 267776, 8388608, 524288, 32768, 4, 6381568, 131072, 0, 0, 218104656, 1
    .long 1, 24, 24, 8192, 4608, 4864, 8388608, 1572864, 32768, 8, 27336704, 131072, 0, 0, 218105152, 4
    .long 2, 64, 72, 7168, 6656, 6656, 7340032, 524288, 32768, 8, 56467456, 114688, 0, 0, 218103920, 1
    .long 2, 64, 72, 7168, 5632, 5632, 7340032, 2097152, 32768, 8, 61956096, 114688, 0, 0, 218104112, 1
    .long 1, 80, 80, 2048, 1836032, 1836288, 7340032, 56389632, 114688, 7, 172507136, 32768, 218103888, 7, 218106432, 1
    .long 1, 80, 80, 2048, 1836032, 1836288, 7340032, 61894656, 114688, 7, 174080000, 32768, 218104080, 7, 218106624, 1
    .long 0, 0, 0, 0, 0, 0, 0, 0, 0, 0, 0, 0, 0, 0, 0, 0
    .long 0, 0, 0, 0, 0, 0, 0, 0, 0, 0, 0, 0, 0, 0, 0, 0
    .long 4, 32, 32, 8192, 6912, 269056, 8388608, 0, 32768, 4, 37859328, 131072, 0, 0, 218104416, 1
    .long 4, 32, 32, 8192, 6912, 269056, 8388608, 262144, 32768, 4, 38907904, 131072, 0, 0, 218104544, 1
    .long 4, 16, 16, 8192, 7680, 269824, 8388608, 524288, 32768, 4, 6414336, 131072, 0, 0, 218104688, 1
    .long 1, 24, 24, 8192, 6656, 6912, 8388608, 1572864, 32768, 8, 27369472, 131072, 0, 0, 218105184, 4
    .long 2, 64, 72, 7168, 6912, 6912, 7340032, 524288, 32768, 8, 56471552, 114688, 0, 0, 218103920, 1
    .long 2, 64, 72, 7168, 5888, 5888, 7340032, 2097152, 32768, 8, 61960192, 114688, 0, 0, 218104112, 1
    .long 1, 80, 80, 2048, 1836544, 1836800, 7340032, 56389632, 114688, 7, 172515328, 32768, 218103888, 7, 218106432, 1
    .long 1, 80, 80, 2048, 1836544, 1836800, 7340032, 61894656, 114688, 7, 174088192, 32768, 218104080, 7, 218106624, 1
    .long 0, 0, 0, 0, 0, 0, 0, 0, 0, 0, 0, 0, 0, 0, 0, 0
    .long 0, 0, 0, 0, 0, 0, 0, 0, 0, 0, 0, 0, 0, 0, 0, 0
    .long 4, 32, 32, 8192, 1024, 263168, 8388608, 0, 32768, 4, 37765120, 131072, 0, 0, 218104336, 1
    .long 4, 32, 32, 8192, 1024, 263168, 8388608, 262144, 32768, 4, 38813696, 131072, 0, 0, 218104464, 1
    .long 4, 16, 16, 8192, 1280, 263424, 8388608, 786432, 32768, 4, 7360512, 131072, 0, 0, 218104592, 1
    .long 1, 24, 24, 8192, 1024, 1280, 8388608, 1572864, 32768, 8, 27279360, 131072, 0, 0, 218105104, 4
    .long 2, 64, 72, 7168, 0, 0, 7340032, 1048576, 32768, 8, 58195968, 114688, 0, 0, 218103936, 1
    .long 2, 64, 72, 7168, 6144, 6144, 7340032, 2097152, 32768, 8, 61964288, 114688, 0, 0, 218104112, 1
    .long 1, 80, 80, 2048, 3670016, 3670272, 7340032, 56418304, 114688, 7, 176685056, 32768, 218103904, 7, 218106432, 1
    .long 1, 80, 80, 2048, 3670016, 3670272, 7340032, 61923328, 114688, 7, 178257920, 32768, 218104096, 7, 218106624, 1
    .long 0, 0, 0, 0, 0, 0, 0, 0, 0, 0, 0, 0, 0, 0, 0, 0
    .long 0, 0, 0, 0, 0, 0, 0, 0, 0, 0, 0, 0, 0, 0, 0, 0
    .long 4, 32, 32, 8192, 3072, 265216, 8388608, 0, 32768, 4, 37797888, 131072, 0, 0, 218104368, 1
    .long 4, 32, 32, 8192, 3072, 265216, 8388608, 262144, 32768, 4, 38846464, 131072, 0, 0, 218104496, 1
    .long 4, 16, 16, 8192, 3328, 265472, 8388608, 786432, 32768, 4, 7393280, 131072, 0, 0, 218104624, 1
    .long 1, 24, 24, 8192, 3072, 3328, 8388608, 1572864, 32768, 8, 27312128, 131072, 0, 0, 218105136, 4
    .long 2, 64, 72, 7168, 256, 256, 7340032, 1048576, 32768, 8, 58200064, 114688, 0, 0, 218103936, 1
    .long 2, 64, 72, 7168, 6400, 6400, 7340032, 2097152, 32768, 8, 61968384, 114688, 0, 0, 218104112, 1
    .long 1, 80, 80, 2048, 3670528, 3670784, 7340032, 56418304, 114688, 7, 176693248, 32768, 218103904, 7, 218106432, 1
    .long 1, 80, 80, 2048, 3670528, 3670784, 7340032, 61923328, 114688, 7, 178266112, 32768, 218104096, 7, 218106624, 1
    .long 0, 0, 0, 0, 0, 0, 0, 0, 0, 0, 0, 0, 0, 0, 0, 0
    .long 0, 0, 0, 0, 0, 0, 0, 0, 0, 0, 0, 0, 0, 0, 0, 0
    .long 4, 32, 32, 8192, 5120, 267264, 8388608, 0, 32768, 4, 37830656, 131072, 0, 0, 218104400, 1
    .long 4, 32, 32, 8192, 5120, 267264, 8388608, 262144, 32768, 4, 38879232, 131072, 0, 0, 218104528, 1
    .long 4, 16, 16, 8192, 5376, 267520, 8388608, 786432, 32768, 4, 7426048, 131072, 0, 0, 218104656, 1
    .long 1, 24, 24, 8192, 5120, 5376, 8388608, 1572864, 32768, 8, 27344896, 131072, 0, 0, 218105168, 4
    .long 2, 64, 72, 7168, 512, 512, 7340032, 1048576, 32768, 8, 58204160, 114688, 0, 0, 218103936, 1
    .long 2, 64, 72, 7168, 6656, 6656, 7340032, 2097152, 32768, 8, 61972480, 114688, 0, 0, 218104112, 1
    .long 1, 80, 80, 2048, 3671040, 3671296, 7340032, 56418304, 114688, 7, 176701440, 32768, 218103904, 7, 218106432, 1
    .long 1, 80, 80, 2048, 3671040, 3671296, 7340032, 61923328, 114688, 7, 178274304, 32768, 218104096, 7, 218106624, 1
    .long 0, 0, 0, 0, 0, 0, 0, 0, 0, 0, 0, 0, 0, 0, 0, 0
    .long 0, 0, 0, 0, 0, 0, 0, 0, 0, 0, 0, 0, 0, 0, 0, 0
    .long 4, 32, 32, 8192, 7168, 269312, 8388608, 0, 32768, 4, 37863424, 131072, 0, 0, 218104432, 1
    .long 4, 32, 32, 8192, 7168, 269312, 8388608, 262144, 32768, 4, 38912000, 131072, 0, 0, 218104560, 1
    .long 4, 16, 16, 8192, 7424, 269568, 8388608, 786432, 32768, 4, 7458816, 131072, 0, 0, 218104688, 1
    .long 1, 24, 24, 8192, 7168, 7424, 8388608, 1572864, 32768, 8, 27377664, 131072, 0, 0, 218105200, 4
    .long 2, 64, 72, 7168, 768, 768, 7340032, 1048576, 32768, 8, 58208256, 114688, 0, 0, 218103936, 1
    .long 2, 64, 72, 7168, 6912, 6912, 7340032, 2097152, 32768, 8, 61976576, 114688, 0, 0, 218104112, 1
    .long 1, 80, 80, 2048, 3671552, 3671808, 7340032, 56418304, 114688, 7, 176709632, 32768, 218103904, 7, 218106432, 1
    .long 1, 80, 80, 2048, 3671552, 3671808, 7340032, 61923328, 114688, 7, 178282496, 32768, 218104096, 7, 218106624, 1
    .long 0, 0, 0, 0, 0, 0, 0, 0, 0, 0, 0, 0, 0, 0, 0, 0
    .long 0, 0, 0, 0, 0, 0, 0, 0, 0, 0, 0, 0, 0, 0, 0, 0
    .long 4, 32, 32, 8192, 1280, 263424, 8388608, 0, 32768, 4, 37769216, 131072, 0, 0, 218104336, 1
    .long 4, 32, 32, 8192, 1280, 263424, 8388608, 262144, 32768, 4, 38817792, 131072, 0, 0, 218104464, 1
    .long 4, 16, 16, 8192, 1280, 263424, 8388608, 524288, 32768, 4, 6311936, 131072, 0, 0, 218104592, 1
    .long 1, 24, 24, 8192, 1536, 1792, 8388608, 1572864, 32768, 8, 27287552, 131072, 0, 0, 218105104, 4
    .long 2, 64, 72, 7168, 1024, 1024, 7340032, 1048576, 32768, 8, 58212352, 114688, 0, 0, 218103936, 1
    .long 2, 64, 72, 7168, 0, 0, 7340032, 2621440, 32768, 8, 63700992, 114688, 0, 0, 218104128, 1
    .long 1, 80, 80, 2048, 5505024, 5505280, 7340032, 56446976, 114688, 7, 180879360, 32768, 218103920, 7, 218106432, 1
    .long 1, 80, 80, 2048, 5505024, 5505280, 7340032, 61952000, 114688, 7, 182452224, 32768, 218104112, 7, 218106624, 1
    .long 0, 0, 0, 0, 0, 0, 0, 0, 0, 0, 0, 0, 0, 0, 0, 0
    .long 0, 0, 0, 0, 0, 0, 0, 0, 0, 0, 0, 0, 0, 0, 0, 0
    .long 4, 32, 32, 8192, 3328, 265472, 8388608, 0, 32768, 4, 37801984, 131072, 0, 0, 218104368, 1
    .long 4, 32, 32, 8192, 3328, 265472, 8388608, 262144, 32768, 4, 38850560, 131072, 0, 0, 218104496, 1
    .long 4, 16, 16, 8192, 3328, 265472, 8388608, 524288, 32768, 4, 6344704, 131072, 0, 0, 218104624, 1
    .long 1, 24, 24, 8192, 3584, 3840, 8388608, 1572864, 32768, 8, 27320320, 131072, 0, 0, 218105136, 4
    .long 2, 64, 72, 7168, 1280, 1280, 7340032, 1048576, 32768, 8, 58216448, 114688, 0, 0, 218103936, 1
    .long 2, 64, 72, 7168, 256, 256, 7340032, 2621440, 32768, 8, 63705088, 114688, 0, 0, 218104128, 1
    .long 1, 80, 80, 2048, 5505536, 5505792, 7340032, 56446976, 114688, 7, 180887552, 32768, 218103920, 7, 218106432, 1
    .long 1, 80, 80, 2048, 5505536, 5505792, 7340032, 61952000, 114688, 7, 182460416, 32768, 218104112, 7, 218106624, 1
    .long 0, 0, 0, 0, 0, 0, 0, 0, 0, 0, 0, 0, 0, 0, 0, 0
    .long 0, 0, 0, 0, 0, 0, 0, 0, 0, 0, 0, 0, 0, 0, 0, 0
    .long 4, 32, 32, 8192, 5376, 267520, 8388608, 0, 32768, 4, 37834752, 131072, 0, 0, 218104400, 1
    .long 4, 32, 32, 8192, 5376, 267520, 8388608, 262144, 32768, 4, 38883328, 131072, 0, 0, 218104528, 1
    .long 4, 16, 16, 8192, 5376, 267520, 8388608, 524288, 32768, 4, 6377472, 131072, 0, 0, 218104656, 1
    .long 1, 24, 24, 8192, 5632, 5888, 8388608, 1572864, 32768, 8, 27353088, 131072, 0, 0, 218105168, 4
    .long 2, 64, 72, 7168, 1536, 1536, 7340032, 1048576, 32768, 8, 58220544, 114688, 0, 0, 218103936, 1
    .long 2, 64, 72, 7168, 512, 512, 7340032, 2621440, 32768, 8, 63709184, 114688, 0, 0, 218104128, 1
    .long 1, 80, 80, 2048, 5506048, 5506304, 7340032, 56446976, 114688, 7, 180895744, 32768, 218103920, 7, 218106432, 1
    .long 1, 80, 80, 2048, 5506048, 5506304, 7340032, 61952000, 114688, 7, 182468608, 32768, 218104112, 7, 218106624, 1
    .long 0, 0, 0, 0, 0, 0, 0, 0, 0, 0, 0, 0, 0, 0, 0, 0
    .long 0, 0, 0, 0, 0, 0, 0, 0, 0, 0, 0, 0, 0, 0, 0, 0
    .long 4, 32, 32, 8192, 7424, 269568, 8388608, 0, 32768, 4, 37867520, 131072, 0, 0, 218104432, 1
    .long 4, 32, 32, 8192, 7424, 269568, 8388608, 262144, 32768, 4, 38916096, 131072, 0, 0, 218104560, 1
    .long 4, 16, 16, 8192, 7424, 269568, 8388608, 524288, 32768, 4, 6410240, 131072, 0, 0, 218104688, 1
    .long 1, 24, 24, 8192, 7680, 7936, 8388608, 1572864, 32768, 8, 27385856, 131072, 0, 0, 218105200, 4
    .long 2, 64, 72, 7168, 1792, 1792, 7340032, 1048576, 32768, 8, 58224640, 114688, 0, 0, 218103952, 1
    .long 2, 64, 72, 7168, 768, 768, 7340032, 2621440, 32768, 8, 63713280, 114688, 0, 0, 218104128, 1
    .long 1, 80, 80, 2048, 5506560, 5506816, 7340032, 56446976, 114688, 7, 180903936, 32768, 218103920, 7, 218106432, 1
    .long 1, 80, 80, 2048, 5506560, 5506816, 7340032, 61952000, 114688, 7, 182476800, 32768, 218104112, 7, 218106624, 1
    .long 0, 0, 0, 0, 0, 0, 0, 0, 0, 0, 0, 0, 0, 0, 0, 0
    .long 0, 0, 0, 0, 0, 0, 0, 0, 0, 0, 0, 0, 0, 0, 0, 0
    .long 4, 32, 32, 8192, 1536, 263680, 8388608, 0, 32768, 4, 37773312, 131072, 0, 0, 218104336, 1
    .long 4, 32, 32, 8192, 1536, 263680, 8388608, 262144, 32768, 4, 38821888, 131072, 0, 0, 218104464, 1
    .long 4, 16, 16, 8192, 1024, 263168, 8388608, 786432, 32768, 4, 7356416, 131072, 0, 0, 218104592, 1
    .long 1, 16, 16, 8192, 0, 256, 8388608, 1572864, 32768, 8, 10485760, 131072, 0, 0, 218105088, 4
    .long 2, 64, 72, 7168, 2048, 2048, 7340032, 1048576, 32768, 8, 58228736, 114688, 0, 0, 218103952, 1
    .long 2, 64, 72, 7168, 1024, 1024, 7340032, 2621440, 32768, 8, 63717376, 114688, 0, 0, 218104128, 1
    .long 1, 80, 80, 2048, 0, 256, 7340032, 58195968, 114688, 7, 168820736, 32768, 218103936, 7, 218106496, 1
    .long 1, 80, 80, 2048, 0, 256, 7340032, 63700992, 114688, 7, 170393600, 32768, 218104128, 7, 218106688, 1
    .long 0, 0, 0, 0, 0, 0, 0, 0, 0, 0, 0, 0, 0, 0, 0, 0
    .long 0, 0, 0, 0, 0, 0, 0, 0, 0, 0, 0, 0, 0, 0, 0, 0
    .long 4, 32, 32, 8192, 3584, 265728, 8388608, 0, 32768, 4, 37806080, 131072, 0, 0, 218104368, 1
    .long 4, 32, 32, 8192, 3584, 265728, 8388608, 262144, 32768, 4, 38854656, 131072, 0, 0, 218104496, 1
    .long 4, 16, 16, 8192, 3072, 265216, 8388608, 786432, 32768, 4, 7389184, 131072, 0, 0, 218104624, 1
    .long 1, 16, 16, 8192, 2048, 2304, 8388608, 1572864, 32768, 8, 10518528, 131072, 0, 0, 218105120, 4
    .long 2, 64, 72, 7168, 2304, 2304, 7340032, 1048576, 32768, 8, 58232832, 114688, 0, 0, 218103952, 1
    .long 2, 64, 72, 7168, 1280, 1280, 7340032, 2621440, 32768, 8, 63721472, 114688, 0, 0, 218104128, 1
    .long 1, 80, 80, 2048, 512, 768, 7340032, 58195968, 114688, 7, 168828928, 32768, 218103936, 7, 218106496, 1
    .long 1, 80, 80, 2048, 512, 768, 7340032, 63700992, 114688, 7, 170401792, 32768, 218104128, 7, 218106688, 1
    .long 0, 0, 0, 0, 0, 0, 0, 0, 0, 0, 0, 0, 0, 0, 0, 0
    .long 0, 0, 0, 0, 0, 0, 0, 0, 0, 0, 0, 0, 0, 0, 0, 0
    .long 4, 32, 32, 8192, 5632, 267776, 8388608, 0, 32768, 4, 37838848, 131072, 0, 0, 218104400, 1
    .long 4, 32, 32, 8192, 5632, 267776, 8388608, 262144, 32768, 4, 38887424, 131072, 0, 0, 218104528, 1
    .long 4, 16, 16, 8192, 5120, 267264, 8388608, 786432, 32768, 4, 7421952, 131072, 0, 0, 218104656, 1
    .long 1, 16, 16, 8192, 4096, 4352, 8388608, 1572864, 32768, 8, 10551296, 131072, 0, 0, 218105152, 4
    .long 2, 64, 72, 7168, 2560, 2560, 7340032, 1048576, 32768, 8, 58236928, 114688, 0, 0, 218103952, 1
    .long 2, 64, 72, 7168, 1536, 1536, 7340032, 2621440, 32768, 8, 63725568, 114688, 0, 0, 218104128, 1
    .long 1, 80, 80, 2048, 1024, 1280, 7340032, 58195968, 114688, 7, 168837120, 32768, 218103936, 7, 218106496, 1
    .long 1, 80, 80, 2048, 1024, 1280, 7340032, 63700992, 114688, 7, 170409984, 32768, 218104128, 7, 218106688, 1
    .long 0, 0, 0, 0, 0, 0, 0, 0, 0, 0, 0, 0, 0, 0, 0, 0
    .long 0, 0, 0, 0, 0, 0, 0, 0, 0, 0, 0, 0, 0, 0, 0, 0
    .long 4, 32, 32, 8192, 7680, 269824, 8388608, 0, 32768, 4, 37871616, 131072, 0, 0, 218104432, 1
    .long 4, 32, 32, 8192, 7680, 269824, 8388608, 262144, 32768, 4, 38920192, 131072, 0, 0, 218104560, 1
    .long 4, 16, 16, 8192, 7168, 269312, 8388608, 786432, 32768, 4, 7454720, 131072, 0, 0, 218104688, 1
    .long 1, 16, 16, 8192, 6144, 6400, 8388608, 1572864, 32768, 8, 10584064, 131072, 0, 0, 218105184, 4
    .long 2, 64, 72, 7168, 2816, 2816, 7340032, 1048576, 32768, 8, 58241024, 114688, 0, 0, 218103952, 1
    .long 2, 64, 72, 7168, 1792, 1792, 7340032, 2621440, 32768, 8, 63729664, 114688, 0, 0, 218104144, 1
    .long 1, 80, 80, 2048, 1536, 1792, 7340032, 58195968, 114688, 7, 168845312, 32768, 218103936, 7, 218106496, 1
    .long 1, 80, 80, 2048, 1536, 1792, 7340032, 63700992, 114688, 7, 170418176, 32768, 218104128, 7, 218106688, 1
    .long 0, 0, 0, 0, 0, 0, 0, 0, 0, 0, 0, 0, 0, 0, 0, 0
    .long 0, 0, 0, 0, 0, 0, 0, 0, 0, 0, 0, 0, 0, 0, 0, 0
    .long 4, 32, 32, 8192, 1792, 263936, 8388608, 0, 32768, 4, 37777408, 131072, 0, 0, 218104336, 1
    .long 4, 32, 32, 8192, 1792, 263936, 8388608, 262144, 32768, 4, 38825984, 131072, 0, 0, 218104464, 1
    .long 4, 16, 16, 8192, 1024, 263168, 8388608, 524288, 32768, 4, 6307840, 131072, 0, 0, 218104592, 1
    .long 1, 16, 16, 8192, 512, 768, 8388608, 1572864, 32768, 8, 10493952, 131072, 0, 0, 218105088, 4
    .long 2, 64, 72, 7168, 3072, 3072, 7340032, 1048576, 32768, 8, 58245120, 114688, 0, 0, 218103952, 1
    .long 2, 64, 72, 7168, 2048, 2048, 7340032, 2621440, 32768, 8, 63733760, 114688, 0, 0, 218104144, 1
    .long 1, 80, 80, 2048, 1835008, 1835264, 7340032, 58224640, 114688, 7, 173015040, 32768, 218103952, 7, 218106496, 1
    .long 1, 80, 80, 2048, 1835008, 1835264, 7340032, 63729664, 114688, 7, 174587904, 32768, 218104144, 7, 218106688, 1
    .long 0, 0, 0, 0, 0, 0, 0, 0, 0, 0, 0, 0, 0, 0, 0, 0
    .long 0, 0, 0, 0, 0, 0, 0, 0, 0, 0, 0, 0, 0, 0, 0, 0
    .long 4, 32, 32, 8192, 3840, 265984, 8388608, 0, 32768, 4, 37810176, 131072, 0, 0, 218104368, 1
    .long 4, 32, 32, 8192, 3840, 265984, 8388608, 262144, 32768, 4, 38858752, 131072, 0, 0, 218104496, 1
    .long 4, 16, 16, 8192, 3072, 265216, 8388608, 524288, 32768, 4, 6340608, 131072, 0, 0, 218104624, 1
    .long 1, 16, 16, 8192, 2560, 2816, 8388608, 1572864, 32768, 8, 10526720, 131072, 0, 0, 218105120, 4
    .long 2, 64, 72, 7168, 3328, 3328, 7340032, 1048576, 32768, 8, 58249216, 114688, 0, 0, 218103952, 1
    .long 2, 64, 72, 7168, 2304, 2304, 7340032, 2621440, 32768, 8, 63737856, 114688, 0, 0, 218104144, 1
    .long 1, 80, 80, 2048, 1835520, 1835776, 7340032, 58224640, 114688, 7, 173023232, 32768, 218103952, 7, 218106496, 1
    .long 1, 80, 80, 2048, 1835520, 1835776, 7340032, 63729664, 114688, 7, 174596096, 32768, 218104144, 7, 218106688, 1
    .long 0, 0, 0, 0, 0, 0, 0, 0, 0, 0, 0, 0, 0, 0, 0, 0
    .long 0, 0, 0, 0, 0, 0, 0, 0, 0, 0, 0, 0, 0, 0, 0, 0
    .long 4, 32, 32, 8192, 5888, 268032, 8388608, 0, 32768, 4, 37842944, 131072, 0, 0, 218104400, 1
    .long 4, 32, 32, 8192, 5888, 268032, 8388608, 262144, 32768, 4, 38891520, 131072, 0, 0, 218104528, 1
    .long 4, 16, 16, 8192, 5120, 267264, 8388608, 524288, 32768, 4, 6373376, 131072, 0, 0, 218104656, 1
    .long 1, 16, 16, 8192, 4608, 4864, 8388608, 1572864, 32768, 8, 10559488, 131072, 0, 0, 218105152, 4
    .long 2, 64, 72, 7168, 3584, 3584, 7340032, 1048576, 32768, 8, 58253312, 114688, 0, 0, 218103968, 1
    .long 2, 64, 72, 7168, 2560, 2560, 7340032, 2621440, 32768, 8, 63741952, 114688, 0, 0, 218104144, 1
    .long 1, 80, 80, 2048, 1836032, 1836288, 7340032, 58224640, 114688, 7, 173031424, 32768, 218103952, 7, 218106496, 1
    .long 1, 80, 80, 2048, 1836032, 1836288, 7340032, 63729664, 114688, 7, 174604288, 32768, 218104144, 7, 218106688, 1
    .long 0, 0, 0, 0, 0, 0, 0, 0, 0, 0, 0, 0, 0, 0, 0, 0
    .long 0, 0, 0, 0, 0, 0, 0, 0, 0, 0, 0, 0, 0, 0, 0, 0
    .long 4, 32, 32, 8192, 7936, 270080, 8388608, 0, 32768, 4, 37875712, 131072, 0, 0, 218104432, 1
    .long 4, 32, 32, 8192, 7936, 270080, 8388608, 262144, 32768, 4, 38924288, 131072, 0, 0, 218104560, 1
    .long 4, 16, 16, 8192, 7168, 269312, 8388608, 524288, 32768, 4, 6406144, 131072, 0, 0, 218104688, 1
    .long 1, 16, 16, 8192, 6656, 6912, 8388608, 1572864, 32768, 8, 10592256, 131072, 0, 0, 218105184, 4
    .long 2, 64, 72, 7168, 3840, 3840, 7340032, 1048576, 32768, 8, 58257408, 114688, 0, 0, 218103968, 1
    .long 2, 64, 72, 7168, 2816, 2816, 7340032, 2621440, 32768, 8, 63746048, 114688, 0, 0, 218104144, 1
    .long 1, 80, 80, 2048, 1836544, 1836800, 7340032, 58224640, 114688, 7, 173039616, 32768, 218103952, 7, 218106496, 1
    .long 1, 80, 80, 2048, 1836544, 1836800, 7340032, 63729664, 114688, 7, 174612480, 32768, 218104144, 7, 218106688, 1
    .long 0, 0, 0, 0, 0, 0, 0, 0, 0, 0, 0, 0, 0, 0, 0, 0
    .long 0, 0, 0, 0, 0, 0, 0, 0, 0, 0, 0, 0, 0, 0, 0, 0
    .long 4, 16, 16, 8192, 0, 262144, 8388608, 0, 32768, 4, 4194304, 131072, 0, 0, 218104320, 1
    .long 4, 16, 16, 8192, 0, 262144, 8388608, 262144, 32768, 4, 5242880, 131072, 0, 0, 218104448, 1
    .long 4, 16, 16, 8192, 0, 262144, 8388608, 524288, 32768, 4, 6291456, 131072, 0, 0, 218104576, 1
    .long 1, 16, 16, 8192, 1024, 1280, 8388608, 1572864, 32768, 8, 10502144, 131072, 0, 0, 218105104, 4
    .long 2, 64, 72, 7168, 4096, 4096, 7340032, 1048576, 32768, 8, 58261504, 114688, 0, 0, 218103968, 1
    .long 2, 64, 72, 7168, 3072, 3072, 7340032, 2621440, 32768, 8, 63750144, 114688, 0, 0, 218104144, 1
    .long 1, 80, 80, 2048, 3670016, 3670272, 7340032, 58253312, 114688, 7, 177209344, 32768, 218103968, 7, 218106496, 1
    .long 1, 80, 80, 2048, 3670016, 3670272, 7340032, 63758336, 114688, 7, 178782208, 32768, 218104160, 7, 218106688, 1
    .long 0, 0, 0, 0, 0, 0, 0, 0, 0, 0, 0, 0, 0, 0, 0, 0
    .long 0, 0, 0, 0, 0, 0, 0, 0, 0, 0, 0, 0, 0, 0, 0, 0
    .long 4, 16, 16, 8192, 2048, 264192, 8388608, 0, 32768, 4, 4227072, 131072, 0, 0, 218104352, 1
    .long 4, 16, 16, 8192, 2048, 264192, 8388608, 262144, 32768, 4, 5275648, 131072, 0, 0, 218104480, 1
    .long 4, 16, 16, 8192, 2048, 264192, 8388608, 524288, 32768, 4, 6324224, 131072, 0, 0, 218104608, 1
    .long 1, 16, 16, 8192, 3072, 3328, 8388608, 1572864, 32768, 8, 10534912, 131072, 0, 0, 218105136, 4
    .long 2, 64, 72, 7168, 4352, 4352, 7340032, 1048576, 32768, 8, 58265600, 114688, 0, 0, 218103968, 1
    .long 2, 64, 72, 7168, 3328, 3328, 7340032, 2621440, 32768, 8, 63754240, 114688, 0, 0, 218104144, 1
    .long 1, 80, 80, 2048, 3670528, 3670784, 7340032, 58253312, 114688, 7, 177217536, 32768, 218103968, 7, 218106496, 1
    .long 1, 80, 80, 2048, 3670528, 3670784, 7340032, 63758336, 114688, 7, 178790400, 32768, 218104160, 7, 218106688, 1
    .long 0, 0, 0, 0, 0, 0, 0, 0, 0, 0, 0, 0, 0, 0, 0, 0
    .long 0, 0, 0, 0, 0, 0, 0, 0, 0, 0, 0, 0, 0, 0, 0, 0
    .long 4, 16, 16, 8192, 4096, 266240, 8388608, 0, 32768, 4, 4259840, 131072, 0, 0, 218104384, 1
    .long 4, 16, 16, 8192, 4096, 266240, 8388608, 262144, 32768, 4, 5308416, 131072, 0, 0, 218104512, 1
    .long 4, 16, 16, 8192, 4096, 266240, 8388608, 524288, 32768, 4, 6356992, 131072, 0, 0, 218104640, 1
    .long 1, 16, 16, 8192, 5120, 5376, 8388608, 1572864, 32768, 8, 10567680, 131072, 0, 0, 218105168, 4
    .long 2, 64, 72, 7168, 4608, 4608, 7340032, 1048576, 32768, 8, 58269696, 114688, 0, 0, 218103968, 1
    .long 2, 64, 72, 7168, 3584, 3584, 7340032, 2621440, 32768, 8, 63758336, 114688, 0, 0, 218104160, 1
    .long 1, 80, 80, 2048, 3671040, 3671296, 7340032, 58253312, 114688, 7, 177225728, 32768, 218103968, 7, 218106496, 1
    .long 1, 80, 80, 2048, 3671040, 3671296, 7340032, 63758336, 114688, 7, 178798592, 32768, 218104160, 7, 218106688, 1
    .long 0, 0, 0, 0, 0, 0, 0, 0, 0, 0, 0, 0, 0, 0, 0, 0
    .long 0, 0, 0, 0, 0, 0, 0, 0, 0, 0, 0, 0, 0, 0, 0, 0
    .long 4, 16, 16, 8192, 6144, 268288, 8388608, 0, 32768, 4, 4292608, 131072, 0, 0, 218104416, 1
    .long 4, 16, 16, 8192, 6144, 268288, 8388608, 262144, 32768, 4, 5341184, 131072, 0, 0, 218104544, 1
    .long 4, 16, 16, 8192, 6144, 268288, 8388608, 524288, 32768, 4, 6389760, 131072, 0, 0, 218104672, 1
    .long 1, 16, 16, 8192, 7168, 7424, 8388608, 1572864, 32768, 8, 10600448, 131072, 0, 0, 218105200, 4
    .long 2, 64, 72, 7168, 4864, 4864, 7340032, 1048576, 32768, 8, 58273792, 114688, 0, 0, 218103968, 1
    .long 2, 64, 72, 7168, 3840, 3840, 7340032, 2621440, 32768, 8, 63762432, 114688, 0, 0, 218104160, 1
    .long 1, 80, 80, 2048, 3671552, 3671808, 7340032, 58253312, 114688, 7, 177233920, 32768, 218103968, 7, 218106496, 1
    .long 1, 80, 80, 2048, 3671552, 3671808, 7340032, 63758336, 114688, 7, 178806784, 32768, 218104160, 7, 218106688, 1
    .long 0, 0, 0, 0, 0, 0, 0, 0, 0, 0, 0, 0, 0, 0, 0, 0
    .long 0, 0, 0, 0, 0, 0, 0, 0, 0, 0, 0, 0, 0, 0, 0, 0
    .long 4, 16, 16, 8192, 256, 262400, 8388608, 0, 32768, 4, 4198400, 131072, 0, 0, 218104320, 1
    .long 4, 16, 16, 8192, 256, 262400, 8388608, 262144, 32768, 4, 5246976, 131072, 0, 0, 218104448, 1
    .long 4, 16, 16, 8192, 256, 262400, 8388608, 524288, 32768, 4, 6295552, 131072, 0, 0, 218104576, 1
    .long 1, 16, 16, 8192, 1536, 1792, 8388608, 1572864, 32768, 8, 10510336, 131072, 0, 0, 218105104, 4
    .long 2, 64, 72, 7168, 5120, 5120, 7340032, 1048576, 32768, 8, 58277888, 114688, 0, 0, 218103968, 1
    .long 2, 64, 72, 7168, 4096, 4096, 7340032, 2621440, 32768, 8, 63766528, 114688, 0, 0, 218104160, 1
    .long 1, 80, 80, 2048, 5505024, 5505280, 7340032, 58281984, 114688, 7, 181403648, 32768, 218103984, 7, 218106496, 1
    .long 1, 80, 80, 2048, 5505024, 5505280, 7340032, 63787008, 114688, 7, 182976512, 32768, 218104176, 7, 218106688, 1
    .long 0, 0, 0, 0, 0, 0, 0, 0, 0, 0, 0, 0, 0, 0, 0, 0
    .long 0, 0, 0, 0, 0, 0, 0, 0, 0, 0, 0, 0, 0, 0, 0, 0
    .long 4, 16, 16, 8192, 2304, 264448, 8388608, 0, 32768, 4, 4231168, 131072, 0, 0, 218104352, 1
    .long 4, 16, 16, 8192, 2304, 264448, 8388608, 262144, 32768, 4, 5279744, 131072, 0, 0, 218104480, 1
    .long 4, 16, 16, 8192, 2304, 264448, 8388608, 524288, 32768, 4, 6328320, 131072, 0, 0, 218104608, 1
    .long 1, 16, 16, 8192, 3584, 3840, 8388608, 1572864, 32768, 8, 10543104, 131072, 0, 0, 218105136, 4
    .long 2, 64, 72, 7168, 5376, 5376, 7340032, 1048576, 32768, 8, 58281984, 114688, 0, 0, 218103984, 1
    .long 2, 64, 72, 7168, 4352, 4352, 7340032, 2621440, 32768, 8, 63770624, 114688, 0, 0, 218104160, 1
    .long 1, 80, 80, 2048, 5505536, 5505792, 7340032, 58281984, 114688, 7, 181411840, 32768, 218103984, 7, 218106496, 1
    .long 1, 80, 80, 2048, 5505536, 5505792, 7340032, 63787008, 114688, 7, 182984704, 32768, 218104176, 7, 218106688, 1
    .long 0, 0, 0, 0, 0, 0, 0, 0, 0, 0, 0, 0, 0, 0, 0, 0
    .long 0, 0, 0, 0, 0, 0, 0, 0, 0, 0, 0, 0, 0, 0, 0, 0
    .long 4, 16, 16, 8192, 4352, 266496, 8388608, 0, 32768, 4, 4263936, 131072, 0, 0, 218104384, 1
    .long 4, 16, 16, 8192, 4352, 266496, 8388608, 262144, 32768, 4, 5312512, 131072, 0, 0, 218104512, 1
    .long 4, 16, 16, 8192, 4352, 266496, 8388608, 524288, 32768, 4, 6361088, 131072, 0, 0, 218104640, 1
    .long 1, 16, 16, 8192, 5632, 5888, 8388608, 1572864, 32768, 8, 10575872, 131072, 0, 0, 218105168, 4
    .long 2, 64, 72, 7168, 5632, 5632, 7340032, 1048576, 32768, 8, 58286080, 114688, 0, 0, 218103984, 1
    .long 2, 64, 72, 7168, 4608, 4608, 7340032, 2621440, 32768, 8, 63774720, 114688, 0, 0, 218104160, 1
    .long 1, 80, 80, 2048, 5506048, 5506304, 7340032, 58281984, 114688, 7, 181420032, 32768, 218103984, 7, 218106496, 1
    .long 1, 80, 80, 2048, 5506048, 5506304, 7340032, 63787008, 114688, 7, 182992896, 32768, 218104176, 7, 218106688, 1
    .long 0, 0, 0, 0, 0, 0, 0, 0, 0, 0, 0, 0, 0, 0, 0, 0
    .long 0, 0, 0, 0, 0, 0, 0, 0, 0, 0, 0, 0, 0, 0, 0, 0
    .long 4, 16, 16, 8192, 6400, 268544, 8388608, 0, 32768, 4, 4296704, 131072, 0, 0, 218104416, 1
    .long 4, 16, 16, 8192, 6400, 268544, 8388608, 262144, 32768, 4, 5345280, 131072, 0, 0, 218104544, 1
    .long 4, 16, 16, 8192, 6400, 268544, 8388608, 524288, 32768, 4, 6393856, 131072, 0, 0, 218104672, 1
    .long 1, 16, 16, 8192, 7680, 7936, 8388608, 1572864, 32768, 8, 10608640, 131072, 0, 0, 218105200, 4
    .long 2, 64, 72, 7168, 5888, 5888, 7340032, 1048576, 32768, 8, 58290176, 114688, 0, 0, 218103984, 1
    .long 2, 64, 72, 7168, 4864, 4864, 7340032, 2621440, 32768, 8, 63778816, 114688, 0, 0, 218104160, 1
    .long 1, 80, 80, 2048, 5506560, 5506816, 7340032, 58281984, 114688, 7, 181428224, 32768, 218103984, 7, 218106496, 1
    .long 1, 80, 80, 2048, 5506560, 5506816, 7340032, 63787008, 114688, 7, 183001088, 32768, 218104176, 7, 218106688, 1
    .long 0, 0, 0, 0, 0, 0, 0, 0, 0, 0, 0, 0, 0, 0, 0, 0
    .long 0, 0, 0, 0, 0, 0, 0, 0, 0, 0, 0, 0, 0, 0, 0, 0
    .long 4, 16, 16, 8192, 512, 262656, 8388608, 0, 32768, 4, 4202496, 131072, 0, 0, 218104320, 1
    .long 4, 16, 16, 8192, 512, 262656, 8388608, 262144, 32768, 4, 5251072, 131072, 0, 0, 218104448, 1
    .long 4, 16, 16, 8192, 512, 262656, 8388608, 524288, 32768, 4, 6299648, 131072, 0, 0, 218104576, 1
    .long 2, 64, 72, 7168, 0, 0, 7340032, 0, 32768, 8, 54525952, 114688, 0, 0, 218103808, 1
    .long 2, 64, 72, 7168, 6144, 6144, 7340032, 1048576, 32768, 8, 58294272, 114688, 0, 0, 218103984, 1
    .long 2, 64, 72, 7168, 5120, 5120, 7340032, 2621440, 32768, 8, 63782912, 114688, 0, 0, 218104160, 1
    .long 2, 64, 72, 7168, 6144, 6144, 7340032, 3145728, 32768, 8, 65634304, 114688, 0, 0, 218104240, 1
    .long 1, 80, 80, 2048, 0, 256, 7340032, 65536000, 114688, 7, 170917888, 32768, 218104192, 7, 218106752, 1
    .long 0, 0, 0, 0, 0, 0, 0, 0, 0, 0, 0, 0, 0, 0, 0, 0
    .long 0, 0, 0, 0, 0, 0, 0, 0, 0, 0, 0, 0, 0, 0, 0, 0
    .long 4, 16, 16, 8192, 2560, 264704, 8388608, 0, 32768, 4, 4235264, 131072, 0, 0, 218104352, 1
    .long 4, 16, 16, 8192, 2560, 264704, 8388608, 262144, 32768, 4, 5283840, 131072, 0, 0, 218104480, 1
    .long 4, 16, 16, 8192, 2560, 264704, 8388608, 524288, 32768, 4, 6332416, 131072, 0, 0, 218104608, 1
    .long 2, 64, 72, 7168, 256, 256, 7340032, 0, 32768, 8, 54530048, 114688, 0, 0, 218103808, 1
    .long 2, 64, 72, 7168, 6400, 6400, 7340032, 1048576, 32768, 8, 58298368, 114688, 0, 0, 218103984, 1
    .long 2, 64, 72, 7168, 5376, 5376, 7340032, 2621440, 32768, 8, 63787008, 114688, 0, 0, 218104176, 1
    .long 2, 64, 72, 7168, 6400, 6400, 7340032, 3145728, 32768, 8, 65638400, 114688, 0, 0, 218104240, 1
    .long 1, 80, 80, 2048, 512, 768, 7340032, 65536000, 114688, 7, 170926080, 32768, 218104192, 7, 218106752, 1
    .long 0, 0, 0, 0, 0, 0, 0, 0, 0, 0, 0, 0, 0, 0, 0, 0
    .long 0, 0, 0, 0, 0, 0, 0, 0, 0, 0, 0, 0, 0, 0, 0, 0
    .long 4, 16, 16, 8192, 4608, 266752, 8388608, 0, 32768, 4, 4268032, 131072, 0, 0, 218104384, 1
    .long 4, 16, 16, 8192, 4608, 266752, 8388608, 262144, 32768, 4, 5316608, 131072, 0, 0, 218104512, 1
    .long 4, 16, 16, 8192, 4608, 266752, 8388608, 524288, 32768, 4, 6365184, 131072, 0, 0, 218104640, 1
    .long 2, 64, 72, 7168, 512, 512, 7340032, 0, 32768, 8, 54534144, 114688, 0, 0, 218103808, 1
    .long 2, 64, 72, 7168, 6656, 6656, 7340032, 1048576, 32768, 8, 58302464, 114688, 0, 0, 218103984, 1
    .long 2, 64, 72, 7168, 5632, 5632, 7340032, 2621440, 32768, 8, 63791104, 114688, 0, 0, 218104176, 1
    .long 2, 64, 72, 7168, 6656, 6656, 7340032, 3145728, 32768, 8, 65642496, 114688, 0, 0, 218104240, 1
    .long 1, 80, 80, 2048, 1024, 1280, 7340032, 65536000, 114688, 7, 170934272, 32768, 218104192, 7, 218106752, 1
    .long 0, 0, 0, 0, 0, 0, 0, 0, 0, 0, 0, 0, 0, 0, 0, 0
    .long 0, 0, 0, 0, 0, 0, 0, 0, 0, 0, 0, 0, 0, 0, 0, 0
    .long 4, 16, 16, 8192, 6656, 268800, 8388608, 0, 32768, 4, 4300800, 131072, 0, 0, 218104416, 1
    .long 4, 16, 16, 8192, 6656, 268800, 8388608, 262144, 32768, 4, 5349376, 131072, 0, 0, 218104544, 1
    .long 4, 16, 16, 8192, 6656, 268800, 8388608, 524288, 32768, 4, 6397952, 131072, 0, 0, 218104672, 1
    .long 2, 64, 72, 7168, 768, 768, 7340032, 0, 32768, 8, 54538240, 114688, 0, 0, 218103808, 1
    .long 2, 64, 72, 7168, 6912, 6912, 7340032, 1048576, 32768, 8, 58306560, 114688, 0, 0, 218103984, 1
    .long 2, 64, 72, 7168, 5888, 5888, 7340032, 2621440, 32768, 8, 63795200, 114688, 0, 0, 218104176, 1
    .long 2, 64, 72, 7168, 6912, 6912, 7340032, 3145728, 32768, 8, 65646592, 114688, 0, 0, 218104240, 1
    .long 1, 80, 80, 2048, 1536, 1792, 7340032, 65536000, 114688, 7, 170942464, 32768, 218104192, 7, 218106752, 1
    .long 0, 0, 0, 0, 0, 0, 0, 0, 0, 0, 0, 0, 0, 0, 0, 0
    .long 0, 0, 0, 0, 0, 0, 0, 0, 0, 0, 0, 0, 0, 0, 0, 0
    .long 4, 16, 16, 8192, 768, 262912, 8388608, 0, 32768, 4, 4206592, 131072, 0, 0, 218104320, 1
    .long 4, 16, 16, 8192, 768, 262912, 8388608, 262144, 32768, 4, 5255168, 131072, 0, 0, 218104448, 1
    .long 4, 16, 16, 8192, 768, 262912, 8388608, 524288, 32768, 4, 6303744, 131072, 0, 0, 218104576, 1
    .long 2, 64, 72, 7168, 1024, 1024, 7340032, 0, 32768, 8, 54542336, 114688, 0, 0, 218103808, 1
    .long 2, 64, 72, 7168, 0, 0, 7340032, 1572864, 32768, 8, 60030976, 114688, 0, 0, 218104000, 1
    .long 2, 64, 72, 7168, 6144, 6144, 7340032, 2621440, 32768, 8, 63799296, 114688, 0, 0, 218104176, 1
    .long 2, 64, 72, 7168, 0, 0, 7340032, 3670016, 32768, 8, 67371008, 114688, 0, 0, 218104256, 1
    .long 1, 80, 80, 2048, 1835008, 1835264, 7340032, 65564672, 114688, 7, 175112192, 32768, 218104208, 7, 218106752, 1
    .long 0, 0, 0, 0, 0, 0, 0, 0, 0, 0, 0, 0, 0, 0, 0, 0
    .long 0, 0, 0, 0, 0, 0, 0, 0, 0, 0, 0, 0, 0, 0, 0, 0
    .long 4, 16, 16, 8192, 2816, 264960, 8388608, 0, 32768, 4, 4239360, 131072, 0, 0, 218104352, 1
    .long 4, 16, 16, 8192, 2816, 264960, 8388608, 262144, 32768, 4, 5287936, 131072, 0, 0, 218104480, 1
    .long 4, 16, 16, 8192, 2816, 264960, 8388608, 524288, 32768, 4, 6336512, 131072, 0, 0, 218104608, 1
    .long 2, 64, 72, 7168, 1280, 1280, 7340032, 0, 32768, 8, 54546432, 114688, 0, 0, 218103808, 1
    .long 2, 64, 72, 7168, 256, 256, 7340032, 1572864, 32768, 8, 60035072, 114688, 0, 0, 218104000, 1
    .long 2, 64, 72, 7168, 6400, 6400, 7340032, 2621440, 32768, 8, 63803392, 114688, 0, 0, 218104176, 1
    .long 2, 64, 72, 7168, 256, 256, 7340032, 3670016, 32768, 8, 67375104, 114688, 0, 0, 218104256, 1
    .long 1, 80, 80, 2048, 1835520, 1835776, 7340032, 65564672, 114688, 7, 175120384, 32768, 218104208, 7, 218106752, 1
    .long 0, 0, 0, 0, 0, 0, 0, 0, 0, 0, 0, 0, 0, 0, 0, 0
    .long 0, 0, 0, 0, 0, 0, 0, 0, 0, 0, 0, 0, 0, 0, 0, 0
    .long 4, 16, 16, 8192, 4864, 267008, 8388608, 0, 32768, 4, 4272128, 131072, 0, 0, 218104384, 1
    .long 4, 16, 16, 8192, 4864, 267008, 8388608, 262144, 32768, 4, 5320704, 131072, 0, 0, 218104512, 1
    .long 4, 16, 16, 8192, 4864, 267008, 8388608, 524288, 32768, 4, 6369280, 131072, 0, 0, 218104640, 1
    .long 2, 64, 72, 7168, 1536, 1536, 7340032, 0, 32768, 8, 54550528, 114688, 0, 0, 218103808, 1
    .long 2, 64, 72, 7168, 512, 512, 7340032, 1572864, 32768, 8, 60039168, 114688, 0, 0, 218104000, 1
    .long 2, 64, 72, 7168, 6656, 6656, 7340032, 2621440, 32768, 8, 63807488, 114688, 0, 0, 218104176, 1
    .long 2, 64, 72, 7168, 512, 512, 7340032, 3670016, 32768, 8, 67379200, 114688, 0, 0, 218104256, 1
    .long 1, 80, 80, 2048, 1836032, 1836288, 7340032, 65564672, 114688, 7, 175128576, 32768, 218104208, 7, 218106752, 1
    .long 0, 0, 0, 0, 0, 0, 0, 0, 0, 0, 0, 0, 0, 0, 0, 0
    .long 0, 0, 0, 0, 0, 0, 0, 0, 0, 0, 0, 0, 0, 0, 0, 0
    .long 4, 16, 16, 8192, 6912, 269056, 8388608, 0, 32768, 4, 4304896, 131072, 0, 0, 218104416, 1
    .long 4, 16, 16, 8192, 6912, 269056, 8388608, 262144, 32768, 4, 5353472, 131072, 0, 0, 218104544, 1
    .long 4, 16, 16, 8192, 6912, 269056, 8388608, 524288, 32768, 4, 6402048, 131072, 0, 0, 218104672, 1
    .long 2, 64, 72, 7168, 1792, 1792, 7340032, 0, 32768, 8, 54554624, 114688, 0, 0, 218103824, 1
    .long 2, 64, 72, 7168, 768, 768, 7340032, 1572864, 32768, 8, 60043264, 114688, 0, 0, 218104000, 1
    .long 2, 64, 72, 7168, 6912, 6912, 7340032, 2621440, 32768, 8, 63811584, 114688, 0, 0, 218104176, 1
    .long 2, 64, 72, 7168, 768, 768, 7340032, 3670016, 32768, 8, 67383296, 114688, 0, 0, 218104256, 1
    .long 1, 80, 80, 2048, 1836544, 1836800, 7340032, 65564672, 114688, 7, 175136768, 32768, 218104208, 7, 218106752, 1
    .long 0, 0, 0, 0, 0, 0, 0, 0, 0, 0, 0, 0, 0, 0, 0, 0
    .long 0, 0, 0, 0, 0, 0, 0, 0, 0, 0, 0, 0, 0, 0, 0, 0
    .long 4, 16, 16, 8192, 1024, 263168, 8388608, 0, 32768, 4, 4210688, 131072, 0, 0, 218104336, 1
    .long 4, 16, 16, 8192, 1024, 263168, 8388608, 262144, 32768, 4, 5259264, 131072, 0, 0, 218104464, 1
    .long 4, 16, 16, 8192, 768, 262912, 8388608, 786432, 32768, 4, 7352320, 131072, 0, 0, 218104576, 1
    .long 2, 64, 72, 7168, 2048, 2048, 7340032, 0, 32768, 8, 54558720, 114688, 0, 0, 218103824, 1
    .long 2, 64, 72, 7168, 1024, 1024, 7340032, 1572864, 32768, 8, 60047360, 114688, 0, 0, 218104000, 1
    .long 2, 64, 72, 7168, 0, 0, 7340032, 3145728, 32768, 8, 65536000, 114688, 0, 0, 218104192, 1
    .long 2, 64, 72, 7168, 1024, 1024, 7340032, 3670016, 32768, 8, 67387392, 114688, 0, 0, 218104256, 1
    .long 1, 80, 80, 2048, 3670016, 3670272, 7340032, 65593344, 114688, 7, 179306496, 32768, 218104224, 7, 218106752, 1
    .long 0, 0, 0, 0, 0, 0, 0, 0, 0, 0, 0, 0, 0, 0, 0, 0
    .long 0, 0, 0, 0, 0, 0, 0, 0, 0, 0, 0, 0, 0, 0, 0, 0
    .long 4, 16, 16, 8192, 3072, 265216, 8388608, 0, 32768, 4, 4243456, 131072, 0, 0, 218104368, 1
    .long 4, 16, 16, 8192, 3072, 265216, 8388608, 262144, 32768, 4, 5292032, 131072, 0, 0, 218104496, 1
    .long 4, 16, 16, 8192, 2816, 264960, 8388608, 786432, 32768, 4, 7385088, 131072, 0, 0, 218104608, 1
    .long 2, 64, 72, 7168, 2304, 2304, 7340032, 0, 32768, 8, 54562816, 114688, 0, 0, 218103824, 1
    .long 2, 64, 72, 7168, 1280, 1280, 7340032, 1572864, 32768, 8, 60051456, 114688, 0, 0, 218104000, 1
    .long 2, 64, 72, 7168, 256, 256, 7340032, 3145728, 32768, 8, 65540096, 114688, 0, 0, 218104192, 1
    .long 2, 64, 72, 7168, 1280, 1280, 7340032, 3670016, 32768, 8, 67391488, 114688, 0, 0, 218104256, 1
    .long 1, 80, 80, 2048, 3670528, 3670784, 7340032, 65593344, 114688, 7, 179314688, 32768, 218104224, 7, 218106752, 1
    .long 0, 0, 0, 0, 0, 0, 0, 0, 0, 0, 0, 0, 0, 0, 0, 0
    .long 0, 0, 0, 0, 0, 0, 0, 0, 0, 0, 0, 0, 0, 0, 0, 0
    .long 4, 16, 16, 8192, 5120, 267264, 8388608, 0, 32768, 4, 4276224, 131072, 0, 0, 218104400, 1
    .long 4, 16, 16, 8192, 5120, 267264, 8388608, 262144, 32768, 4, 5324800, 131072, 0, 0, 218104528, 1
    .long 4, 16, 16, 8192, 4864, 267008, 8388608, 786432, 32768, 4, 7417856, 131072, 0, 0, 218104640, 1
    .long 2, 64, 72, 7168, 2560, 2560, 7340032, 0, 32768, 8, 54566912, 114688, 0, 0, 218103824, 1
    .long 2, 64, 72, 7168, 1536, 1536, 7340032, 1572864, 32768, 8, 60055552, 114688, 0, 0, 218104000, 1
    .long 2, 64, 72, 7168, 512, 512, 7340032, 3145728, 32768, 8, 65544192, 114688, 0, 0, 218104192, 1
    .long 2, 64, 72, 7168, 1536, 1536, 7340032, 3670016, 32768, 8, 67395584, 114688, 0, 0, 218104256, 1
    .long 1, 80, 80, 2048, 3671040, 3671296, 7340032, 65593344, 114688, 7, 179322880, 32768, 218104224, 7, 218106752, 1
    .long 0, 0, 0, 0, 0, 0, 0, 0, 0, 0, 0, 0, 0, 0, 0, 0
    .long 0, 0, 0, 0, 0, 0, 0, 0, 0, 0, 0, 0, 0, 0, 0, 0
    .long 4, 16, 16, 8192, 7168, 269312, 8388608, 0, 32768, 4, 4308992, 131072, 0, 0, 218104432, 1
    .long 4, 16, 16, 8192, 7168, 269312, 8388608, 262144, 32768, 4, 5357568, 131072, 0, 0, 218104560, 1
    .long 4, 16, 16, 8192, 6912, 269056, 8388608, 786432, 32768, 4, 7450624, 131072, 0, 0, 218104672, 1
    .long 2, 64, 72, 7168, 2816, 2816, 7340032, 0, 32768, 8, 54571008, 114688, 0, 0, 218103824, 1
    .long 2, 64, 72, 7168, 1792, 1792, 7340032, 1572864, 32768, 8, 60059648, 114688, 0, 0, 218104016, 1
    .long 2, 64, 72, 7168, 768, 768, 7340032, 3145728, 32768, 8, 65548288, 114688, 0, 0, 218104192, 1
    .long 2, 64, 72, 7168, 1792, 1792, 7340032, 3670016, 32768, 8, 67399680, 114688, 0, 0, 218104272, 1
    .long 1, 80, 80, 2048, 3671552, 3671808, 7340032, 65593344, 114688, 7, 179331072, 32768, 218104224, 7, 218106752, 1
    .long 0, 0, 0, 0, 0, 0, 0, 0, 0, 0, 0, 0, 0, 0, 0, 0
    .long 0, 0, 0, 0, 0, 0, 0, 0, 0, 0, 0, 0, 0, 0, 0, 0
    .long 4, 16, 16, 8192, 1280, 263424, 8388608, 0, 32768, 4, 4214784, 131072, 0, 0, 218104336, 1
    .long 4, 16, 16, 8192, 1280, 263424, 8388608, 262144, 32768, 4, 5263360, 131072, 0, 0, 218104464, 1
    .long 4, 16, 16, 8192, 512, 262656, 8388608, 786432, 32768, 4, 7348224, 131072, 0, 0, 218104576, 1
    .long 2, 64, 72, 7168, 3072, 3072, 7340032, 0, 32768, 8, 54575104, 114688, 0, 0, 218103824, 1
    .long 2, 64, 72, 7168, 2048, 2048, 7340032, 1572864, 32768, 8, 60063744, 114688, 0, 0, 218104016, 1
    .long 2, 64, 72, 7168, 1024, 1024, 7340032, 3145728, 32768, 8, 65552384, 114688, 0, 0, 218104192, 1
    .long 2, 64, 72, 7168, 2048, 2048, 7340032, 3670016, 32768, 8, 67403776, 114688, 0, 0, 218104272, 1
    .long 1, 80, 80, 2048, 5505024, 5505280, 7340032, 65622016, 114688, 7, 183500800, 32768, 218104240, 7, 218106752, 1
    .long 0, 0, 0, 0, 0, 0, 0, 0, 0, 0, 0, 0, 0, 0, 0, 0
    .long 0, 0, 0, 0, 0, 0, 0, 0, 0, 0, 0, 0, 0, 0, 0, 0
    .long 4, 16, 16, 8192, 3328, 265472, 8388608, 0, 32768, 4, 4247552, 131072, 0, 0, 218104368, 1
    .long 4, 16, 16, 8192, 3328, 265472, 8388608, 262144, 32768, 4, 5296128, 131072, 0, 0, 218104496, 1
    .long 4, 16, 16, 8192, 2560, 264704, 8388608, 786432, 32768, 4, 7380992, 131072, 0, 0, 218104608, 1
    .long 2, 64, 72, 7168, 3328, 3328, 7340032, 0, 32768, 8, 54579200, 114688, 0, 0, 218103824, 1
    .long 2, 64, 72, 7168, 2304, 2304, 7340032, 1572864, 32768, 8, 60067840, 114688, 0, 0, 218104016, 1
    .long 2, 64, 72, 7168, 1280, 1280, 7340032, 3145728, 32768, 8, 65556480, 114688, 0, 0, 218104192, 1
    .long 2, 64, 72, 7168, 2304, 2304, 7340032, 3670016, 32768, 8, 67407872, 114688, 0, 0, 218104272, 1
    .long 1, 80, 80, 2048, 5505536, 5505792, 7340032, 65622016, 114688, 7, 183508992, 32768, 218104240, 7, 218106752, 1
    .long 0, 0, 0, 0, 0, 0, 0, 0, 0, 0, 0, 0, 0, 0, 0, 0
    .long 0, 0, 0, 0, 0, 0, 0, 0, 0, 0, 0, 0, 0, 0, 0, 0
    .long 4, 16, 16, 8192, 5376, 267520, 8388608, 0, 32768, 4, 4280320, 131072, 0, 0, 218104400, 1
    .long 4, 16, 16, 8192, 5376, 267520, 8388608, 262144, 32768, 4, 5328896, 131072, 0, 0, 218104528, 1
    .long 4, 16, 16, 8192, 4608, 266752, 8388608, 786432, 32768, 4, 7413760, 131072, 0, 0, 218104640, 1
    .long 2, 64, 72, 7168, 3584, 3584, 7340032, 0, 32768, 8, 54583296, 114688, 0, 0, 218103840, 1
    .long 2, 64, 72, 7168, 2560, 2560, 7340032, 1572864, 32768, 8, 60071936, 114688, 0, 0, 218104016, 1
    .long 2, 64, 72, 7168, 1536, 1536, 7340032, 3145728, 32768, 8, 65560576, 114688, 0, 0, 218104192, 1
    .long 2, 64, 72, 7168, 2560, 2560, 7340032, 3670016, 32768, 8, 67411968, 114688, 0, 0, 218104272, 1
    .long 1, 80, 80, 2048, 5506048, 5506304, 7340032, 65622016, 114688, 7, 183517184, 32768, 218104240, 7, 218106752, 1
    .long 0, 0, 0, 0, 0, 0, 0, 0, 0, 0, 0, 0, 0, 0, 0, 0
    .long 0, 0, 0, 0, 0, 0, 0, 0, 0, 0, 0, 0, 0, 0, 0, 0
    .long 4, 16, 16, 8192, 7424, 269568, 8388608, 0, 32768, 4, 4313088, 131072, 0, 0, 218104432, 1
    .long 4, 16, 16, 8192, 7424, 269568, 8388608, 262144, 32768, 4, 5361664, 131072, 0, 0, 218104560, 1
    .long 4, 16, 16, 8192, 6656, 268800, 8388608, 786432, 32768, 4, 7446528, 131072, 0, 0, 218104672, 1
    .long 2, 64, 72, 7168, 3840, 3840, 7340032, 0, 32768, 8, 54587392, 114688, 0, 0, 218103840, 1
    .long 2, 64, 72, 7168, 2816, 2816, 7340032, 1572864, 32768, 8, 60076032, 114688, 0, 0, 218104016, 1
    .long 2, 64, 72, 7168, 1792, 1792, 7340032, 3145728, 32768, 8, 65564672, 114688, 0, 0, 218104208, 1
    .long 2, 64, 72, 7168, 2816, 2816, 7340032, 3670016, 32768, 8, 67416064, 114688, 0, 0, 218104272, 1
    .long 1, 80, 80, 2048, 5506560, 5506816, 7340032, 65622016, 114688, 7, 183525376, 32768, 218104240, 7, 218106752, 1
    .long 0, 0, 0, 0, 0, 0, 0, 0, 0, 0, 0, 0, 0, 0, 0, 0
    .long 0, 0, 0, 0, 0, 0, 0, 0, 0, 0, 0, 0, 0, 0, 0, 0
    .long 4, 16, 16, 8192, 1536, 263680, 8388608, 0, 32768, 4, 4218880, 131072, 0, 0, 218104336, 1
    .long 4, 16, 16, 8192, 1536, 263680, 8388608, 262144, 32768, 4, 5267456, 131072, 0, 0, 218104464, 1
    .long 4, 16, 16, 8192, 256, 262400, 8388608, 786432, 32768, 4, 7344128, 131072, 0, 0, 218104576, 1
    .long 2, 64, 72, 7168, 4096, 4096, 7340032, 0, 32768, 8, 54591488, 114688, 0, 0, 218103840, 1
    .long 2, 64, 72, 7168, 3072, 3072, 7340032, 1572864, 32768, 8, 60080128, 114688, 0, 0, 218104016, 1
    .long 2, 64, 72, 7168, 2048, 2048, 7340032, 3145728, 32768, 8, 65568768, 114688, 0, 0, 218104208, 1
    .long 2, 64, 72, 7168, 3072, 3072, 7340032, 3670016, 32768, 8, 67420160, 114688, 0, 0, 218104272, 1
    .long 1, 80, 80, 2048, 0, 256, 7340032, 67371008, 114688, 7, 171442176, 32768, 218104256, 7, 218106816, 1
    .long 0, 0, 0, 0, 0, 0, 0, 0, 0, 0, 0, 0, 0, 0, 0, 0
    .long 0, 0, 0, 0, 0, 0, 0, 0, 0, 0, 0, 0, 0, 0, 0, 0
    .long 4, 16, 16, 8192, 3584, 265728, 8388608, 0, 32768, 4, 4251648, 131072, 0, 0, 218104368, 1
    .long 4, 16, 16, 8192, 3584, 265728, 8388608, 262144, 32768, 4, 5300224, 131072, 0, 0, 218104496, 1
    .long 4, 16, 16, 8192, 2304, 264448, 8388608, 786432, 32768, 4, 7376896, 131072, 0, 0, 218104608, 1
    .long 2, 64, 72, 7168, 4352, 4352, 7340032, 0, 32768, 8, 54595584, 114688, 0, 0, 218103840, 1
    .long 2, 64, 72, 7168, 3328, 3328, 7340032, 1572864, 32768, 8, 60084224, 114688, 0, 0, 218104016, 1
    .long 2, 64, 72, 7168, 2304, 2304, 7340032, 3145728, 32768, 8, 65572864, 114688, 0, 0, 218104208, 1
    .long 2, 64, 72, 7168, 3328, 3328, 7340032, 3670016, 32768, 8, 67424256, 114688, 0, 0, 218104272, 1
    .long 1, 80, 80, 2048, 512, 768, 7340032, 67371008, 114688, 7, 171450368, 32768, 218104256, 7, 218106816, 1
    .long 0, 0, 0, 0, 0, 0, 0, 0, 0, 0, 0, 0, 0, 0, 0, 0
    .long 0, 0, 0, 0, 0, 0, 0, 0, 0, 0, 0, 0, 0, 0, 0, 0
    .long 4, 16, 16, 8192, 5632, 267776, 8388608, 0, 32768, 4, 4284416, 131072, 0, 0, 218104400, 1
    .long 4, 16, 16, 8192, 5632, 267776, 8388608, 262144, 32768, 4, 5332992, 131072, 0, 0, 218104528, 1
    .long 4, 16, 16, 8192, 4352, 266496, 8388608, 786432, 32768, 4, 7409664, 131072, 0, 0, 218104640, 1
    .long 2, 64, 72, 7168, 4608, 4608, 7340032, 0, 32768, 8, 54599680, 114688, 0, 0, 218103840, 1
    .long 2, 64, 72, 7168, 3584, 3584, 7340032, 1572864, 32768, 8, 60088320, 114688, 0, 0, 218104032, 1
    .long 2, 64, 72, 7168, 2560, 2560, 7340032, 3145728, 32768, 8, 65576960, 114688, 0, 0, 218104208, 1
    .long 2, 64, 72, 7168, 3584, 3584, 7340032, 3670016, 32768, 8, 67428352, 114688, 0, 0, 218104288, 1
    .long 1, 80, 80, 2048, 1024, 1280, 7340032, 67371008, 114688, 7, 171458560, 32768, 218104256, 7, 218106816, 1
    .long 0, 0, 0, 0, 0, 0, 0, 0, 0, 0, 0, 0, 0, 0, 0, 0
    .long 0, 0, 0, 0, 0, 0, 0, 0, 0, 0, 0, 0, 0, 0, 0, 0
    .long 4, 16, 16, 8192, 7680, 269824, 8388608, 0, 32768, 4, 4317184, 131072, 0, 0, 218104432, 1
    .long 4, 16, 16, 8192, 7680, 269824, 8388608, 262144, 32768, 4, 5365760, 131072, 0, 0, 218104560, 1
    .long 4, 16, 16, 8192, 6400, 268544, 8388608, 786432, 32768, 4, 7442432, 131072, 0, 0, 218104672, 1
    .long 2, 64, 72, 7168, 4864, 4864, 7340032, 0, 32768, 8, 54603776, 114688, 0, 0, 218103840, 1
    .long 2, 64, 72, 7168, 3840, 3840, 7340032, 1572864, 32768, 8, 60092416, 114688, 0, 0, 218104032, 1
    .long 2, 64, 72, 7168, 2816, 2816, 7340032, 3145728, 32768, 8, 65581056, 114688, 0, 0, 218104208, 1
    .long 2, 64, 72, 7168, 3840, 3840, 7340032, 3670016, 32768, 8, 67432448, 114688, 0, 0, 218104288, 1
    .long 1, 80, 80, 2048, 1536, 1792, 7340032, 67371008, 114688, 7, 171466752, 32768, 218104256, 7, 218106816, 1
    .long 0, 0, 0, 0, 0, 0, 0, 0, 0, 0, 0, 0, 0, 0, 0, 0
    .long 0, 0, 0, 0, 0, 0, 0, 0, 0, 0, 0, 0, 0, 0, 0, 0
    .long 4, 16, 16, 8192, 1792, 263936, 8388608, 0, 32768, 4, 4222976, 131072, 0, 0, 218104336, 1
    .long 4, 16, 16, 8192, 1792, 263936, 8388608, 262144, 32768, 4, 5271552, 131072, 0, 0, 218104464, 1
    .long 4, 16, 16, 8192, 0, 262144, 8388608, 786432, 32768, 4, 7340032, 131072, 0, 0, 218104576, 1
    .long 2, 64, 72, 7168, 5120, 5120, 7340032, 0, 32768, 8, 54607872, 114688, 0, 0, 218103840, 1
    .long 2, 64, 72, 7168, 4096, 4096, 7340032, 1572864, 32768, 8, 60096512, 114688, 0, 0, 218104032, 1
    .long 2, 64, 72, 7168, 3072, 3072, 7340032, 3145728, 32768, 8, 65585152, 114688, 0, 0, 218104208, 1
    .long 2, 64, 72, 7168, 4096, 4096, 7340032, 3670016, 32768, 8, 67436544, 114688, 0, 0, 218104288, 1
    .long 1, 80, 80, 2048, 1835008, 1835264, 7340032, 67399680, 114688, 7, 175636480, 32768, 218104272, 7, 218106816, 1
    .long 0, 0, 0, 0, 0, 0, 0, 0, 0, 0, 0, 0, 0, 0, 0, 0
    .long 0, 0, 0, 0, 0, 0, 0, 0, 0, 0, 0, 0, 0, 0, 0, 0
    .long 4, 16, 16, 8192, 3840, 265984, 8388608, 0, 32768, 4, 4255744, 131072, 0, 0, 218104368, 1
    .long 4, 16, 16, 8192, 3840, 265984, 8388608, 262144, 32768, 4, 5304320, 131072, 0, 0, 218104496, 1
    .long 4, 16, 16, 8192, 2048, 264192, 8388608, 786432, 32768, 4, 7372800, 131072, 0, 0, 218104608, 1
    .long 2, 64, 72, 7168, 5376, 5376, 7340032, 0, 32768, 8, 54611968, 114688, 0, 0, 218103856, 1
    .long 2, 64, 72, 7168, 4352, 4352, 7340032, 1572864, 32768, 8, 60100608, 114688, 0, 0, 218104032, 1
    .long 2, 64, 72, 7168, 3328, 3328, 7340032, 3145728, 32768, 8, 65589248, 114688, 0, 0, 218104208, 1
    .long 2, 64, 72, 7168, 4352, 4352, 7340032, 3670016, 32768, 8, 67440640, 114688, 0, 0, 218104288, 1
    .long 1, 80, 80, 2048, 1835520, 1835776, 7340032, 67399680, 114688, 7, 175644672, 32768, 218104272, 7, 218106816, 1
    .long 0, 0, 0, 0, 0, 0, 0, 0, 0, 0, 0, 0, 0, 0, 0, 0
    .long 0, 0, 0, 0, 0, 0, 0, 0, 0, 0, 0, 0, 0, 0, 0, 0
    .long 4, 16, 16, 8192, 5888, 268032, 8388608, 0, 32768, 4, 4288512, 131072, 0, 0, 218104400, 1
    .long 4, 16, 16, 8192, 5888, 268032, 8388608, 262144, 32768, 4, 5337088, 131072, 0, 0, 218104528, 1
    .long 4, 16, 16, 8192, 4096, 266240, 8388608, 786432, 32768, 4, 7405568, 131072, 0, 0, 218104640, 1
    .long 2, 64, 72, 7168, 5632, 5632, 7340032, 0, 32768, 8, 54616064, 114688, 0, 0, 218103856, 1
    .long 2, 64, 72, 7168, 4608, 4608, 7340032, 1572864, 32768, 8, 60104704, 114688, 0, 0, 218104032, 1
    .long 2, 64, 72, 7168, 3584, 3584, 7340032, 3145728, 32768, 8, 65593344, 114688, 0, 0, 218104224, 1
    .long 2, 64, 72, 7168, 4608, 4608, 7340032, 3670016, 32768, 8, 67444736, 114688, 0, 0, 218104288, 1
    .long 1, 80, 80, 2048, 1836032, 1836288, 7340032, 67399680, 114688, 7, 175652864, 32768, 218104272, 7, 218106816, 1
    .long 0, 0, 0, 0, 0, 0, 0, 0, 0, 0, 0, 0, 0, 0, 0, 0
    .long 0, 0, 0, 0, 0, 0, 0, 0, 0, 0, 0, 0, 0, 0, 0, 0
    .long 4, 16, 16, 8192, 7936, 270080, 8388608, 0, 32768, 4, 4321280, 131072, 0, 0, 218104432, 1
    .long 4, 16, 16, 8192, 7936, 270080, 8388608, 262144, 32768, 4, 5369856, 131072, 0, 0, 218104560, 1
    .long 4, 16, 16, 8192, 6144, 268288, 8388608, 786432, 32768, 4, 7438336, 131072, 0, 0, 218104672, 1
    .long 2, 64, 72, 7168, 5888, 5888, 7340032, 0, 32768, 8, 54620160, 114688, 0, 0, 218103856, 1
    .long 2, 64, 72, 7168, 4864, 4864, 7340032, 1572864, 32768, 8, 60108800, 114688, 0, 0, 218104032, 1
    .long 2, 64, 72, 7168, 3840, 3840, 7340032, 3145728, 32768, 8, 65597440, 114688, 0, 0, 218104224, 1
    .long 2, 64, 72, 7168, 4864, 4864, 7340032, 3670016, 32768, 8, 67448832, 114688, 0, 0, 218104288, 1
    .long 1, 80, 80, 2048, 1836544, 1836800, 7340032, 67399680, 114688, 7, 175661056, 32768, 218104272, 7, 218106816, 1
    .long 0, 0, 0, 0, 0, 0, 0, 0, 0, 0, 0, 0, 0, 0, 0, 0
    .long 0, 0, 0, 0, 0, 0, 0, 0, 0, 0, 0, 0, 0, 0, 0, 0
    .long 1, 32, 32, 8192, 0, 256, 8388608, 524288, 32768, 8, 39845888, 131072, 0, 0, 218104576, 4
    .long 1, 16, 16, 8192, 0, 256, 8388608, 1048576, 32768, 8, 8388608, 131072, 0, 0, 218104832, 4
    .long 1, 16, 16, 8192, 0, 256, 8388608, 2097152, 32768, 8, 12582912, 131072, 0, 0, 218105344, 4
    .long 1, 16, 16, 8192, 0, 256, 8388608, 2621440, 32768, 8, 14680064, 131072, 0, 0, 218105600, 4
    .long 1, 16, 16, 8192, 0, 256, 8388608, 3145728, 32768, 8, 16777216, 131072, 0, 0, 218105856, 4
    .long 1, 16, 16, 8192, 0, 256, 8388608, 3670016, 32768, 8, 18874368, 131072, 0, 0, 218106112, 4
    .long 0, 0, 0, 0, 0, 0, 0, 0, 0, 0, 0, 0, 0, 0, 0, 0
    .long 0, 0, 0, 0, 0, 0, 0, 0, 0, 0, 0, 0, 0, 0, 0, 0
    .long 0, 0, 0, 0, 0, 0, 0, 0, 0, 0, 0, 0, 0, 0, 0, 0
    .long 0, 0, 0, 0, 0, 0, 0, 0, 0, 0, 0, 0, 0, 0, 0, 0
    .long 1, 32, 32, 8192, 2048, 2304, 8388608, 524288, 32768, 8, 39878656, 131072, 0, 0, 218104608, 4
    .long 1, 16, 16, 8192, 2048, 2304, 8388608, 1048576, 32768, 8, 8421376, 131072, 0, 0, 218104864, 4
    .long 1, 16, 16, 8192, 2048, 2304, 8388608, 2097152, 32768, 8, 12615680, 131072, 0, 0, 218105376, 4
    .long 1, 16, 16, 8192, 2048, 2304, 8388608, 2621440, 32768, 8, 14712832, 131072, 0, 0, 218105632, 4
    .long 1, 16, 16, 8192, 2048, 2304, 8388608, 3145728, 32768, 8, 16809984, 131072, 0, 0, 218105888, 4
    .long 1, 16, 16, 8192, 2048, 2304, 8388608, 3670016, 32768, 8, 18907136, 131072, 0, 0, 218106144, 4
    .long 0, 0, 0, 0, 0, 0, 0, 0, 0, 0, 0, 0, 0, 0, 0, 0
    .long 0, 0, 0, 0, 0, 0, 0, 0, 0, 0, 0, 0, 0, 0, 0, 0
    .long 0, 0, 0, 0, 0, 0, 0, 0, 0, 0, 0, 0, 0, 0, 0, 0
    .long 0, 0, 0, 0, 0, 0, 0, 0, 0, 0, 0, 0, 0, 0, 0, 0
    .long 1, 32, 32, 8192, 4096, 4352, 8388608, 524288, 32768, 8, 39911424, 131072, 0, 0, 218104640, 4
    .long 1, 16, 16, 8192, 4096, 4352, 8388608, 1048576, 32768, 8, 8454144, 131072, 0, 0, 218104896, 4
    .long 1, 16, 16, 8192, 4096, 4352, 8388608, 2097152, 32768, 8, 12648448, 131072, 0, 0, 218105408, 4
    .long 1, 16, 16, 8192, 4096, 4352, 8388608, 2621440, 32768, 8, 14745600, 131072, 0, 0, 218105664, 4
    .long 1, 16, 16, 8192, 4096, 4352, 8388608, 3145728, 32768, 8, 16842752, 131072, 0, 0, 218105920, 4
    .long 1, 16, 16, 8192, 4096, 4352, 8388608, 3670016, 32768, 8, 18939904, 131072, 0, 0, 218106176, 4
    .long 0, 0, 0, 0, 0, 0, 0, 0, 0, 0, 0, 0, 0, 0, 0, 0
    .long 0, 0, 0, 0, 0, 0, 0, 0, 0, 0, 0, 0, 0, 0, 0, 0
    .long 0, 0, 0, 0, 0, 0, 0, 0, 0, 0, 0, 0, 0, 0, 0, 0
    .long 0, 0, 0, 0, 0, 0, 0, 0, 0, 0, 0, 0, 0, 0, 0, 0
    .long 1, 32, 32, 8192, 6144, 6400, 8388608, 524288, 32768, 8, 39944192, 131072, 0, 0, 218104672, 4
    .long 1, 16, 16, 8192, 6144, 6400, 8388608, 1048576, 32768, 8, 8486912, 131072, 0, 0, 218104928, 4
    .long 1, 16, 16, 8192, 6144, 6400, 8388608, 2097152, 32768, 8, 12681216, 131072, 0, 0, 218105440, 4
    .long 1, 16, 16, 8192, 6144, 6400, 8388608, 2621440, 32768, 8, 14778368, 131072, 0, 0, 218105696, 4
    .long 1, 16, 16, 8192, 6144, 6400, 8388608, 3145728, 32768, 8, 16875520, 131072, 0, 0, 218105952, 4
    .long 1, 16, 16, 8192, 6144, 6400, 8388608, 3670016, 32768, 8, 18972672, 131072, 0, 0, 218106208, 4
    .long 0, 0, 0, 0, 0, 0, 0, 0, 0, 0, 0, 0, 0, 0, 0, 0
    .long 0, 0, 0, 0, 0, 0, 0, 0, 0, 0, 0, 0, 0, 0, 0, 0
    .long 0, 0, 0, 0, 0, 0, 0, 0, 0, 0, 0, 0, 0, 0, 0, 0
    .long 0, 0, 0, 0, 0, 0, 0, 0, 0, 0, 0, 0, 0, 0, 0, 0
    .long 1, 32, 32, 8192, 512, 768, 8388608, 524288, 32768, 8, 39854080, 131072, 0, 0, 218104576, 4
    .long 1, 16, 16, 8192, 512, 768, 8388608, 1048576, 32768, 8, 8396800, 131072, 0, 0, 218104832, 4
    .long 1, 16, 16, 8192, 512, 768, 8388608, 2097152, 32768, 8, 12591104, 131072, 0, 0, 218105344, 4
    .long 1, 16, 16, 8192, 512, 768, 8388608, 2621440, 32768, 8, 14688256, 131072, 0, 0, 218105600, 4
    .long 1, 16, 16, 8192, 512, 768, 8388608, 3145728, 32768, 8, 16785408, 131072, 0, 0, 218105856, 4
    .long 1, 16, 16, 8192, 512, 768, 8388608, 3670016, 32768, 8, 18882560, 131072, 0, 0, 218106112, 4
    .long 0, 0, 0, 0, 0, 0, 0, 0, 0, 0, 0, 0, 0, 0, 0, 0
    .long 0, 0, 0, 0, 0, 0, 0, 0, 0, 0, 0, 0, 0, 0, 0, 0
    .long 0, 0, 0, 0, 0, 0, 0, 0, 0, 0, 0, 0, 0, 0, 0, 0
    .long 0, 0, 0, 0, 0, 0, 0, 0, 0, 0, 0, 0, 0, 0, 0, 0
    .long 1, 32, 32, 8192, 2560, 2816, 8388608, 524288, 32768, 8, 39886848, 131072, 0, 0, 218104608, 4
    .long 1, 16, 16, 8192, 2560, 2816, 8388608, 1048576, 32768, 8, 8429568, 131072, 0, 0, 218104864, 4
    .long 1, 16, 16, 8192, 2560, 2816, 8388608, 2097152, 32768, 8, 12623872, 131072, 0, 0, 218105376, 4
    .long 1, 16, 16, 8192, 2560, 2816, 8388608, 2621440, 32768, 8, 14721024, 131072, 0, 0, 218105632, 4
    .long 1, 16, 16, 8192, 2560, 2816, 8388608, 3145728, 32768, 8, 16818176, 131072, 0, 0, 218105888, 4
    .long 1, 16, 16, 8192, 2560, 2816, 8388608, 3670016, 32768, 8, 18915328, 131072, 0, 0, 218106144, 4
    .long 0, 0, 0, 0, 0, 0, 0, 0, 0, 0, 0, 0, 0, 0, 0, 0
    .long 0, 0, 0, 0, 0, 0, 0, 0, 0, 0, 0, 0, 0, 0, 0, 0
    .long 0, 0, 0, 0, 0, 0, 0, 0, 0, 0, 0, 0, 0, 0, 0, 0
    .long 0, 0, 0, 0, 0, 0, 0, 0, 0, 0, 0, 0, 0, 0, 0, 0
    .long 1, 32, 32, 8192, 4608, 4864, 8388608, 524288, 32768, 8, 39919616, 131072, 0, 0, 218104640, 4
    .long 1, 16, 16, 8192, 4608, 4864, 8388608, 1048576, 32768, 8, 8462336, 131072, 0, 0, 218104896, 4
    .long 1, 16, 16, 8192, 4608, 4864, 8388608, 2097152, 32768, 8, 12656640, 131072, 0, 0, 218105408, 4
    .long 1, 16, 16, 8192, 4608, 4864, 8388608, 2621440, 32768, 8, 14753792, 131072, 0, 0, 218105664, 4
    .long 1, 16, 16, 8192, 4608, 4864, 8388608, 3145728, 32768, 8, 16850944, 131072, 0, 0, 218105920, 4
    .long 1, 16, 16, 8192, 4608, 4864, 8388608, 3670016, 32768, 8, 18948096, 131072, 0, 0, 218106176, 4
    .long 0, 0, 0, 0, 0, 0, 0, 0, 0, 0, 0, 0, 0, 0, 0, 0
    .long 0, 0, 0, 0, 0, 0, 0, 0, 0, 0, 0, 0, 0, 0, 0, 0
    .long 0, 0, 0, 0, 0, 0, 0, 0, 0, 0, 0, 0, 0, 0, 0, 0
    .long 0, 0, 0, 0, 0, 0, 0, 0, 0, 0, 0, 0, 0, 0, 0, 0
    .long 1, 32, 32, 8192, 6656, 6912, 8388608, 524288, 32768, 8, 39952384, 131072, 0, 0, 218104672, 4
    .long 1, 16, 16, 8192, 6656, 6912, 8388608, 1048576, 32768, 8, 8495104, 131072, 0, 0, 218104928, 4
    .long 1, 16, 16, 8192, 6656, 6912, 8388608, 2097152, 32768, 8, 12689408, 131072, 0, 0, 218105440, 4
    .long 1, 16, 16, 8192, 6656, 6912, 8388608, 2621440, 32768, 8, 14786560, 131072, 0, 0, 218105696, 4
    .long 1, 16, 16, 8192, 6656, 6912, 8388608, 3145728, 32768, 8, 16883712, 131072, 0, 0, 218105952, 4
    .long 1, 16, 16, 8192, 6656, 6912, 8388608, 3670016, 32768, 8, 18980864, 131072, 0, 0, 218106208, 4
    .long 0, 0, 0, 0, 0, 0, 0, 0, 0, 0, 0, 0, 0, 0, 0, 0
    .long 0, 0, 0, 0, 0, 0, 0, 0, 0, 0, 0, 0, 0, 0, 0, 0
    .long 0, 0, 0, 0, 0, 0, 0, 0, 0, 0, 0, 0, 0, 0, 0, 0
    .long 0, 0, 0, 0, 0, 0, 0, 0, 0, 0, 0, 0, 0, 0, 0, 0
    .long 1, 32, 32, 8192, 1024, 1280, 8388608, 524288, 32768, 8, 39862272, 131072, 0, 0, 218104592, 4
    .long 1, 16, 16, 8192, 1024, 1280, 8388608, 1048576, 32768, 8, 8404992, 131072, 0, 0, 218104848, 4
    .long 1, 16, 16, 8192, 1024, 1280, 8388608, 2097152, 32768, 8, 12599296, 131072, 0, 0, 218105360, 4
    .long 1, 16, 16, 8192, 1024, 1280, 8388608, 2621440, 32768, 8, 14696448, 131072, 0, 0, 218105616, 4
    .long 1, 16, 16, 8192, 1024, 1280, 8388608, 3145728, 32768, 8, 16793600, 131072, 0, 0, 218105872, 4
    .long 1, 16, 16, 8192, 1024, 1280, 8388608, 3670016, 32768, 8, 18890752, 131072, 0, 0, 218106128, 4
    .long 0, 0, 0, 0, 0, 0, 0, 0, 0, 0, 0, 0, 0, 0, 0, 0
    .long 0, 0, 0, 0, 0, 0, 0, 0, 0, 0, 0, 0, 0, 0, 0, 0
    .long 0, 0, 0, 0, 0, 0, 0, 0, 0, 0, 0, 0, 0, 0, 0, 0
    .long 0, 0, 0, 0, 0, 0, 0, 0, 0, 0, 0, 0, 0, 0, 0, 0
    .long 1, 32, 32, 8192, 3072, 3328, 8388608, 524288, 32768, 8, 39895040, 131072, 0, 0, 218104624, 4
    .long 1, 16, 16, 8192, 3072, 3328, 8388608, 1048576, 32768, 8, 8437760, 131072, 0, 0, 218104880, 4
    .long 1, 16, 16, 8192, 3072, 3328, 8388608, 2097152, 32768, 8, 12632064, 131072, 0, 0, 218105392, 4
    .long 1, 16, 16, 8192, 3072, 3328, 8388608, 2621440, 32768, 8, 14729216, 131072, 0, 0, 218105648, 4
    .long 1, 16, 16, 8192, 3072, 3328, 8388608, 3145728, 32768, 8, 16826368, 131072, 0, 0, 218105904, 4
    .long 1, 16, 16, 8192, 3072, 3328, 8388608, 3670016, 32768, 8, 18923520, 131072, 0, 0, 218106160, 4
    .long 0, 0, 0, 0, 0, 0, 0, 0, 0, 0, 0, 0, 0, 0, 0, 0
    .long 0, 0, 0, 0, 0, 0, 0, 0, 0, 0, 0, 0, 0, 0, 0, 0
    .long 0, 0, 0, 0, 0, 0, 0, 0, 0, 0, 0, 0, 0, 0, 0, 0
    .long 0, 0, 0, 0, 0, 0, 0, 0, 0, 0, 0, 0, 0, 0, 0, 0
    .long 1, 32, 32, 8192, 5120, 5376, 8388608, 524288, 32768, 8, 39927808, 131072, 0, 0, 218104656, 4
    .long 1, 16, 16, 8192, 5120, 5376, 8388608, 1048576, 32768, 8, 8470528, 131072, 0, 0, 218104912, 4
    .long 1, 16, 16, 8192, 5120, 5376, 8388608, 2097152, 32768, 8, 12664832, 131072, 0, 0, 218105424, 4
    .long 1, 16, 16, 8192, 5120, 5376, 8388608, 2621440, 32768, 8, 14761984, 131072, 0, 0, 218105680, 4
    .long 1, 16, 16, 8192, 5120, 5376, 8388608, 3145728, 32768, 8, 16859136, 131072, 0, 0, 218105936, 4
    .long 1, 16, 16, 8192, 5120, 5376, 8388608, 3670016, 32768, 8, 18956288, 131072, 0, 0, 218106192, 4
    .long 0, 0, 0, 0, 0, 0, 0, 0, 0, 0, 0, 0, 0, 0, 0, 0
    .long 0, 0, 0, 0, 0, 0, 0, 0, 0, 0, 0, 0, 0, 0, 0, 0
    .long 0, 0, 0, 0, 0, 0, 0, 0, 0, 0, 0, 0, 0, 0, 0, 0
    .long 0, 0, 0, 0, 0, 0, 0, 0, 0, 0, 0, 0, 0, 0, 0, 0
    .long 1, 32, 32, 8192, 7168, 7424, 8388608, 524288, 32768, 8, 39960576, 131072, 0, 0, 218104688, 4
    .long 1, 16, 16, 8192, 7168, 7424, 8388608, 1048576, 32768, 8, 8503296, 131072, 0, 0, 218104944, 4
    .long 1, 16, 16, 8192, 7168, 7424, 8388608, 2097152, 32768, 8, 12697600, 131072, 0, 0, 218105456, 4
    .long 1, 16, 16, 8192, 7168, 7424, 8388608, 2621440, 32768, 8, 14794752, 131072, 0, 0, 218105712, 4
    .long 1, 16, 16, 8192, 7168, 7424, 8388608, 3145728, 32768, 8, 16891904, 131072, 0, 0, 218105968, 4
    .long 1, 16, 16, 8192, 7168, 7424, 8388608, 3670016, 32768, 8, 18989056, 131072, 0, 0, 218106224, 4
    .long 0, 0, 0, 0, 0, 0, 0, 0, 0, 0, 0, 0, 0, 0, 0, 0
    .long 0, 0, 0, 0, 0, 0, 0, 0, 0, 0, 0, 0, 0, 0, 0, 0
    .long 0, 0, 0, 0, 0, 0, 0, 0, 0, 0, 0, 0, 0, 0, 0, 0
    .long 0, 0, 0, 0, 0, 0, 0, 0, 0, 0, 0, 0, 0, 0, 0, 0
    .long 1, 32, 32, 8192, 1536, 1792, 8388608, 524288, 32768, 8, 39870464, 131072, 0, 0, 218104592, 4
    .long 1, 16, 16, 8192, 1536, 1792, 8388608, 1048576, 32768, 8, 8413184, 131072, 0, 0, 218104848, 4
    .long 1, 16, 16, 8192, 1536, 1792, 8388608, 2097152, 32768, 8, 12607488, 131072, 0, 0, 218105360, 4
    .long 1, 16, 16, 8192, 1536, 1792, 8388608, 2621440, 32768, 8, 14704640, 131072, 0, 0, 218105616, 4
    .long 1, 16, 16, 8192, 1536, 1792, 8388608, 3145728, 32768, 8, 16801792, 131072, 0, 0, 218105872, 4
    .long 1, 16, 16, 8192, 1536, 1792, 8388608, 3670016, 32768, 8, 18898944, 131072, 0, 0, 218106128, 4
    .long 0, 0, 0, 0, 0, 0, 0, 0, 0, 0, 0, 0, 0, 0, 0, 0
    .long 0, 0, 0, 0, 0, 0, 0, 0, 0, 0, 0, 0, 0, 0, 0, 0
    .long 0, 0, 0, 0, 0, 0, 0, 0, 0, 0, 0, 0, 0, 0, 0, 0
    .long 0, 0, 0, 0, 0, 0, 0, 0, 0, 0, 0, 0, 0, 0, 0, 0
    .long 1, 32, 32, 8192, 3584, 3840, 8388608, 524288, 32768, 8, 39903232, 131072, 0, 0, 218104624, 4
    .long 1, 16, 16, 8192, 3584, 3840, 8388608, 1048576, 32768, 8, 8445952, 131072, 0, 0, 218104880, 4
    .long 1, 16, 16, 8192, 3584, 3840, 8388608, 2097152, 32768, 8, 12640256, 131072, 0, 0, 218105392, 4
    .long 1, 16, 16, 8192, 3584, 3840, 8388608, 2621440, 32768, 8, 14737408, 131072, 0, 0, 218105648, 4
    .long 1, 16, 16, 8192, 3584, 3840, 8388608, 3145728, 32768, 8, 16834560, 131072, 0, 0, 218105904, 4
    .long 1, 16, 16, 8192, 3584, 3840, 8388608, 3670016, 32768, 8, 18931712, 131072, 0, 0, 218106160, 4
    .long 0, 0, 0, 0, 0, 0, 0, 0, 0, 0, 0, 0, 0, 0, 0, 0
    .long 0, 0, 0, 0, 0, 0, 0, 0, 0, 0, 0, 0, 0, 0, 0, 0
    .long 0, 0, 0, 0, 0, 0, 0, 0, 0, 0, 0, 0, 0, 0, 0, 0
    .long 0, 0, 0, 0, 0, 0, 0, 0, 0, 0, 0, 0, 0, 0, 0, 0
    .long 1, 32, 32, 8192, 5632, 5888, 8388608, 524288, 32768, 8, 39936000, 131072, 0, 0, 218104656, 4
    .long 1, 16, 16, 8192, 5632, 5888, 8388608, 1048576, 32768, 8, 8478720, 131072, 0, 0, 218104912, 4
    .long 1, 16, 16, 8192, 5632, 5888, 8388608, 2097152, 32768, 8, 12673024, 131072, 0, 0, 218105424, 4
    .long 1, 16, 16, 8192, 5632, 5888, 8388608, 2621440, 32768, 8, 14770176, 131072, 0, 0, 218105680, 4
    .long 1, 16, 16, 8192, 5632, 5888, 8388608, 3145728, 32768, 8, 16867328, 131072, 0, 0, 218105936, 4
    .long 1, 16, 16, 8192, 5632, 5888, 8388608, 3670016, 32768, 8, 18964480, 131072, 0, 0, 218106192, 4
    .long 0, 0, 0, 0, 0, 0, 0, 0, 0, 0, 0, 0, 0, 0, 0, 0
    .long 0, 0, 0, 0, 0, 0, 0, 0, 0, 0, 0, 0, 0, 0, 0, 0
    .long 0, 0, 0, 0, 0, 0, 0, 0, 0, 0, 0, 0, 0, 0, 0, 0
    .long 0, 0, 0, 0, 0, 0, 0, 0, 0, 0, 0, 0, 0, 0, 0, 0
    .long 1, 32, 32, 8192, 7680, 7936, 8388608, 524288, 32768, 8, 39968768, 131072, 0, 0, 218104688, 4
    .long 1, 16, 16, 8192, 7680, 7936, 8388608, 1048576, 32768, 8, 8511488, 131072, 0, 0, 218104944, 4
    .long 1, 16, 16, 8192, 7680, 7936, 8388608, 2097152, 32768, 8, 12705792, 131072, 0, 0, 218105456, 4
    .long 1, 16, 16, 8192, 7680, 7936, 8388608, 2621440, 32768, 8, 14802944, 131072, 0, 0, 218105712, 4
    .long 1, 16, 16, 8192, 7680, 7936, 8388608, 3145728, 32768, 8, 16900096, 131072, 0, 0, 218105968, 4
    .long 1, 16, 16, 8192, 7680, 7936, 8388608, 3670016, 32768, 8, 18997248, 131072, 0, 0, 218106224, 4
    .long 0, 0, 0, 0, 0, 0, 0, 0, 0, 0, 0, 0, 0, 0, 0, 0
    .long 0, 0, 0, 0, 0, 0, 0, 0, 0, 0, 0, 0, 0, 0, 0, 0
    .long 0, 0, 0, 0, 0, 0, 0, 0, 0, 0, 0, 0, 0, 0, 0, 0
    .long 0, 0, 0, 0, 0, 0, 0, 0, 0, 0, 0, 0, 0, 0, 0, 0
    .long 1, 24, 24, 8192, 0, 256, 8388608, 524288, 32768, 8, 23068672, 131072, 0, 0, 218104576, 4
    .long 1, 32, 32, 8192, 0, 256, 8388608, 1572864, 32768, 8, 44040192, 131072, 0, 0, 218105088, 4
    .long 2, 64, 72, 7168, 1024, 1024, 7340032, 524288, 32768, 8, 56377344, 114688, 0, 0, 218103872, 1
    .long 2, 64, 72, 7168, 0, 0, 7340032, 2097152, 32768, 8, 61865984, 114688, 0, 0, 218104064, 1
    .long 1, 80, 80, 2048, 0, 256, 7340032, 54525952, 114688, 7, 167772160, 32768, 218103808, 7, 218106368, 1
    .long 1, 80, 80, 2048, 0, 256, 7340032, 60030976, 114688, 7, 169345024, 32768, 218104000, 7, 218106560, 1
    .long 0, 0, 0, 0, 0, 0, 0, 0, 0, 0, 0, 0, 0, 0, 0, 0
    .long 0, 0, 0, 0, 0, 0, 0, 0, 0, 0, 0, 0, 0, 0, 0, 0
    .long 0, 0, 0, 0, 0, 0, 0, 0, 0, 0, 0, 0, 0, 0, 0, 0
    .long 0, 0, 0, 0, 0, 0, 0, 0, 0, 0, 0, 0, 0, 0, 0, 0
    .long 1, 24, 24, 8192, 2048, 2304, 8388608, 524288, 32768, 8, 23101440, 131072, 0, 0, 218104608, 4
    .long 1, 32, 32, 8192, 2048, 2304, 8388608, 1572864, 32768, 8, 44072960, 131072, 0, 0, 218105120, 4
    .long 2, 64, 72, 7168, 1280, 1280, 7340032, 524288, 32768, 8, 56381440, 114688, 0, 0, 218103872, 1
    .long 2, 64, 72, 7168, 256, 256, 7340032, 2097152, 32768, 8, 61870080, 114688, 0, 0, 218104064, 1
    .long 1, 80, 80, 2048, 512, 768, 7340032, 54525952, 114688, 7, 167780352, 32768, 218103808, 7, 218106368, 1
    .long 1, 80, 80, 2048, 512, 768, 7340032, 60030976, 114688, 7, 169353216, 32768, 218104000, 7, 218106560, 1
    .long 0, 0, 0, 0, 0, 0, 0, 0, 0, 0, 0, 0, 0, 0, 0, 0
    .long 0, 0, 0, 0, 0, 0, 0, 0, 0, 0, 0, 0, 0, 0, 0, 0
    .long 0, 0, 0, 0, 0, 0, 0, 0, 0, 0, 0, 0, 0, 0, 0, 0
    .long 0, 0, 0, 0, 0, 0, 0, 0, 0, 0, 0, 0, 0, 0, 0, 0
    .long 1, 24, 24, 8192, 4096, 4352, 8388608, 524288, 32768, 8, 23134208, 131072, 0, 0, 218104640, 4
    .long 1, 32, 32, 8192, 4096, 4352, 8388608, 1572864, 32768, 8, 44105728, 131072, 0, 0, 218105152, 4
    .long 2, 64, 72, 7168, 1536, 1536, 7340032, 524288, 32768, 8, 56385536, 114688, 0, 0, 218103872, 1
    .long 2, 64, 72, 7168, 512, 512, 7340032, 2097152, 32768, 8, 61874176, 114688, 0, 0, 218104064, 1
    .long 1, 80, 80, 2048, 1024, 1280, 7340032, 54525952, 114688, 7, 167788544, 32768, 218103808, 7, 218106368, 1
    .long 1, 80, 80, 2048, 1024, 1280, 7340032, 60030976, 114688, 7, 169361408, 32768, 218104000, 7, 218106560, 1
    .long 0, 0, 0, 0, 0, 0, 0, 0, 0, 0, 0, 0, 0, 0, 0, 0
    .long 0, 0, 0, 0, 0, 0, 0, 0, 0, 0, 0, 0, 0, 0, 0, 0
    .long 0, 0, 0, 0, 0, 0, 0, 0, 0, 0, 0, 0, 0, 0, 0, 0
    .long 0, 0, 0, 0, 0, 0, 0, 0, 0, 0, 0, 0, 0, 0, 0, 0
    .long 1, 24, 24, 8192, 6144, 6400, 8388608, 524288, 32768, 8, 23166976, 131072, 0, 0, 218104672, 4
    .long 1, 32, 32, 8192, 6144, 6400, 8388608, 1572864, 32768, 8, 44138496, 131072, 0, 0, 218105184, 4
    .long 2, 64, 72, 7168, 1792, 1792, 7340032, 524288, 32768, 8, 56389632, 114688, 0, 0, 218103888, 1
    .long 2, 64, 72, 7168, 768, 768, 7340032, 2097152, 32768, 8, 61878272, 114688, 0, 0, 218104064, 1
    .long 1, 80, 80, 2048, 1536, 1792, 7340032, 54525952, 114688, 7, 167796736, 32768, 218103808, 7, 218106368, 1
    .long 1, 80, 80, 2048, 1536, 1792, 7340032, 60030976, 114688, 7, 169369600, 32768, 218104000, 7, 218106560, 1
    .long 0, 0, 0, 0, 0, 0, 0, 0, 0, 0, 0, 0, 0, 0, 0, 0
    .long 0, 0, 0, 0, 0, 0, 0, 0, 0, 0, 0, 0, 0, 0, 0, 0
    .long 0, 0, 0, 0, 0, 0, 0, 0, 0, 0, 0, 0, 0, 0, 0, 0
    .long 0, 0, 0, 0, 0, 0, 0, 0, 0, 0, 0, 0, 0, 0, 0, 0
    .long 1, 24, 24, 8192, 512, 768, 8388608, 524288, 32768, 8, 23076864, 131072, 0, 0, 218104576, 4
    .long 1, 32, 32, 8192, 512, 768, 8388608, 1572864, 32768, 8, 44048384, 131072, 0, 0, 218105088, 4
    .long 2, 64, 72, 7168, 2048, 2048, 7340032, 524288, 32768, 8, 56393728, 114688, 0, 0, 218103888, 1
    .long 2, 64, 72, 7168, 1024, 1024, 7340032, 2097152, 32768, 8, 61882368, 114688, 0, 0, 218104064, 1
    .long 1, 80, 80, 2048, 1835008, 1835264, 7340032, 54554624, 114688, 7, 171966464, 32768, 218103824, 7, 218106368, 1
    .long 1, 80, 80, 2048, 1835008, 1835264, 7340032, 60059648, 114688, 7, 173539328, 32768, 218104016, 7, 218106560, 1
    .long 0, 0, 0, 0, 0, 0, 0, 0, 0, 0, 0, 0, 0, 0, 0, 0
    .long 0, 0, 0, 0, 0, 0, 0, 0, 0, 0, 0, 0, 0, 0, 0, 0
    .long 0, 0, 0, 0, 0, 0, 0, 0, 0, 0, 0, 0, 0, 0, 0, 0
    .long 0, 0, 0, 0, 0, 0, 0, 0, 0, 0, 0, 0, 0, 0, 0, 0
    .long 1, 24, 24, 8192, 2560, 2816, 8388608, 524288, 32768, 8, 23109632, 131072, 0, 0, 218104608, 4
    .long 1, 32, 32, 8192, 2560, 2816, 8388608, 1572864, 32768, 8, 44081152, 131072, 0, 0, 218105120, 4
    .long 2, 64, 72, 7168, 2304, 2304, 7340032, 524288, 32768, 8, 56397824, 114688, 0, 0, 218103888, 1
    .long 2, 64, 72, 7168, 1280, 1280, 7340032, 2097152, 32768, 8, 61886464, 114688, 0, 0, 218104064, 1
    .long 1, 80, 80, 2048, 1835520, 1835776, 7340032, 54554624, 114688, 7, 171974656, 32768, 218103824, 7, 218106368, 1
    .long 1, 80, 80, 2048, 1835520, 1835776, 7340032, 60059648, 114688, 7, 173547520, 32768, 218104016, 7, 218106560, 1
    .long 0, 0, 0, 0, 0, 0, 0, 0, 0, 0, 0, 0, 0, 0, 0, 0
    .long 0, 0, 0, 0, 0, 0, 0, 0, 0, 0, 0, 0, 0, 0, 0, 0
    .long 0, 0, 0, 0, 0, 0, 0, 0, 0, 0, 0, 0, 0, 0, 0, 0
    .long 0, 0, 0, 0, 0, 0, 0, 0, 0, 0, 0, 0, 0, 0, 0, 0
    .long 1, 24, 24, 8192, 4608, 4864, 8388608, 524288, 32768, 8, 23142400, 131072, 0, 0, 218104640, 4
    .long 1, 32, 32, 8192, 4608, 4864, 8388608, 1572864, 32768, 8, 44113920, 131072, 0, 0, 218105152, 4
    .long 2, 64, 72, 7168, 2560, 2560, 7340032, 524288, 32768, 8, 56401920, 114688, 0, 0, 218103888, 1
    .long 2, 64, 72, 7168, 1536, 1536, 7340032, 2097152, 32768, 8, 61890560, 114688, 0, 0, 218104064, 1
    .long 1, 80, 80, 2048, 1836032, 1836288, 7340032, 54554624, 114688, 7, 171982848, 32768, 218103824, 7, 218106368, 1
    .long 1, 80, 80, 2048, 1836032, 1836288, 7340032, 60059648, 114688, 7, 173555712, 32768, 218104016, 7, 218106560, 1
    .long 0, 0, 0, 0, 0, 0, 0, 0, 0, 0, 0, 0, 0, 0, 0, 0
    .long 0, 0, 0, 0, 0, 0, 0, 0, 0, 0, 0, 0, 0, 0, 0, 0
    .long 0, 0, 0, 0, 0, 0, 0, 0, 0, 0, 0, 0, 0, 0, 0, 0
    .long 0, 0, 0, 0, 0, 0, 0, 0, 0, 0, 0, 0, 0, 0, 0, 0
    .long 1, 24, 24, 8192, 6656, 6912, 8388608, 524288, 32768, 8, 23175168, 131072, 0, 0, 218104672, 4
    .long 1, 32, 32, 8192, 6656, 6912, 8388608, 1572864, 32768, 8, 44146688, 131072, 0, 0, 218105184, 4
    .long 2, 64, 72, 7168, 2816, 2816, 7340032, 524288, 32768, 8, 56406016, 114688, 0, 0, 218103888, 1
    .long 2, 64, 72, 7168, 1792, 1792, 7340032, 2097152, 32768, 8, 61894656, 114688, 0, 0, 218104080, 1
    .long 1, 80, 80, 2048, 1836544, 1836800, 7340032, 54554624, 114688, 7, 171991040, 32768, 218103824, 7, 218106368, 1
    .long 1, 80, 80, 2048, 1836544, 1836800, 7340032, 60059648, 114688, 7, 173563904, 32768, 218104016, 7, 218106560, 1
    .long 0, 0, 0, 0, 0, 0, 0, 0, 0, 0, 0, 0, 0, 0, 0, 0
    .long 0, 0, 0, 0, 0, 0, 0, 0, 0, 0, 0, 0, 0, 0, 0, 0
    .long 0, 0, 0, 0, 0, 0, 0, 0, 0, 0, 0, 0, 0, 0, 0, 0
    .long 0, 0, 0, 0, 0, 0, 0, 0, 0, 0, 0, 0, 0, 0, 0, 0
    .long 1, 24, 24, 8192, 1024, 1280, 8388608, 524288, 32768, 8, 23085056, 131072, 0, 0, 218104592, 4
    .long 2, 64, 72, 7168, 6144, 6144, 7340032, 0, 32768, 8, 54624256, 114688, 0, 0, 218103856, 1
    .long 2, 64, 72, 7168, 5120, 5120, 7340032, 1572864, 32768, 8, 60112896, 114688, 0, 0, 218104032, 1
    .long 2, 64, 72, 7168, 4096, 4096, 7340032, 3145728, 32768, 8, 65601536, 114688, 0, 0, 218104224, 1
    .long 2, 64, 72, 7168, 5120, 5120, 7340032, 3670016, 32768, 8, 67452928, 114688, 0, 0, 218104288, 1
    .long 1, 80, 80, 2048, 3670016, 3670272, 7340032, 67428352, 114688, 7, 179830784, 32768, 218104288, 7, 218106816, 1
    .long 0, 0, 0, 0, 0, 0, 0, 0, 0, 0, 0, 0, 0, 0, 0, 0
    .long 0, 0, 0, 0, 0, 0, 0, 0, 0, 0, 0, 0, 0, 0, 0, 0
    .long 0, 0, 0, 0, 0, 0, 0, 0, 0, 0, 0, 0, 0, 0, 0, 0
    .long 0, 0, 0, 0, 0, 0, 0, 0, 0, 0, 0, 0, 0, 0, 0, 0
    .long 1, 24, 24, 8192, 3072, 3328, 8388608, 524288, 32768, 8, 23117824, 131072, 0, 0, 218104624, 4
    .long 2, 64, 72, 7168, 6400, 6400, 7340032, 0, 32768, 8, 54628352, 114688, 0, 0, 218103856, 1
    .long 2, 64, 72, 7168, 5376, 5376, 7340032, 1572864, 32768, 8, 60116992, 114688, 0, 0, 218104048, 1
    .long 2, 64, 72, 7168, 4352, 4352, 7340032, 3145728, 32768, 8, 65605632, 114688, 0, 0, 218104224, 1
    .long 2, 64, 72, 7168, 5376, 5376, 7340032, 3670016, 32768, 8, 67457024, 114688, 0, 0, 218104304, 1
    .long 1, 80, 80, 2048, 3670528, 3670784, 7340032, 67428352, 114688, 7, 179838976, 32768, 218104288, 7, 218106816, 1
    .long 0, 0, 0, 0, 0, 0, 0, 0, 0, 0, 0, 0, 0, 0, 0, 0
    .long 0, 0, 0, 0, 0, 0, 0, 0, 0, 0, 0, 0, 0, 0, 0, 0
    .long 0, 0, 0, 0, 0, 0, 0, 0, 0, 0, 0, 0, 0, 0, 0, 0
    .long 0, 0, 0, 0, 0, 0, 0, 0, 0, 0, 0, 0, 0, 0, 0, 0
    .long 1, 24, 24, 8192, 5120, 5376, 8388608, 524288, 32768, 8, 23150592, 131072, 0, 0, 218104656, 4
    .long 2, 64, 72, 7168, 6656, 6656, 7340032, 0, 32768, 8, 54632448, 114688, 0, 0, 218103856, 1
    .long 2, 64, 72, 7168, 5632, 5632, 7340032, 1572864, 32768, 8, 60121088, 114688, 0, 0, 218104048, 1
    .long 2, 64, 72, 7168, 4608, 4608, 7340032, 3145728, 32768, 8, 65609728, 114688, 0, 0, 218104224, 1
    .long 2, 64, 72, 7168, 5632, 5632, 7340032, 3670016, 32768, 8, 67461120, 114688, 0, 0, 218104304, 1
    .long 1, 80, 80, 2048, 3671040, 3671296, 7340032, 67428352, 114688, 7, 179847168, 32768, 218104288, 7, 218106816, 1
    .long 0, 0, 0, 0, 0, 0, 0, 0, 0, 0, 0, 0, 0, 0, 0, 0
    .long 0, 0, 0, 0, 0, 0, 0, 0, 0, 0, 0, 0, 0, 0, 0, 0
    .long 0, 0, 0, 0, 0, 0, 0, 0, 0, 0, 0, 0, 0, 0, 0, 0
    .long 0, 0, 0, 0, 0, 0, 0, 0, 0, 0, 0, 0, 0, 0, 0, 0
    .long 1, 24, 24, 8192, 7168, 7424, 8388608, 524288, 32768, 8, 23183360, 131072, 0, 0, 218104688, 4
    .long 2, 64, 72, 7168, 6912, 6912, 7340032, 0, 32768, 8, 54636544, 114688, 0, 0, 218103856, 1
    .long 2, 64, 72, 7168, 5888, 5888, 7340032, 1572864, 32768, 8, 60125184, 114688, 0, 0, 218104048, 1
    .long 2, 64, 72, 7168, 4864, 4864, 7340032, 3145728, 32768, 8, 65613824, 114688, 0, 0, 218104224, 1
    .long 2, 64, 72, 7168, 5888, 5888, 7340032, 3670016, 32768, 8, 67465216, 114688, 0, 0, 218104304, 1
    .long 1, 80, 80, 2048, 3671552, 3671808, 7340032, 67428352, 114688, 7, 179855360, 32768, 218104288, 7, 218106816, 1
    .long 0, 0, 0, 0, 0, 0, 0, 0, 0, 0, 0, 0, 0, 0, 0, 0
    .long 0, 0, 0, 0, 0, 0, 0, 0, 0, 0, 0, 0, 0, 0, 0, 0
    .long 0, 0, 0, 0, 0, 0, 0, 0, 0, 0, 0, 0, 0, 0, 0, 0
    .long 0, 0, 0, 0, 0, 0, 0, 0, 0, 0, 0, 0, 0, 0, 0, 0
    .long 1, 24, 24, 8192, 1536, 1792, 8388608, 524288, 32768, 8, 23093248, 131072, 0, 0, 218104592, 4
    .long 2, 64, 72, 7168, 0, 0, 7340032, 524288, 32768, 8, 56360960, 114688, 0, 0, 218103872, 1
    .long 2, 64, 72, 7168, 6144, 6144, 7340032, 1572864, 32768, 8, 60129280, 114688, 0, 0, 218104048, 1
    .long 2, 64, 72, 7168, 5120, 5120, 7340032, 3145728, 32768, 8, 65617920, 114688, 0, 0, 218104224, 1
    .long 2, 64, 72, 7168, 6144, 6144, 7340032, 3670016, 32768, 8, 67469312, 114688, 0, 0, 218104304, 1
    .long 1, 80, 80, 2048, 5505024, 5505280, 7340032, 67457024, 114688, 7, 184025088, 32768, 218104304, 7, 218106816, 1
    .long 0, 0, 0, 0, 0, 0, 0, 0, 0, 0, 0, 0, 0, 0, 0, 0
    .long 0, 0, 0, 0, 0, 0, 0, 0, 0, 0, 0, 0, 0, 0, 0, 0
    .long 0, 0, 0, 0, 0, 0, 0, 0, 0, 0, 0, 0, 0, 0, 0, 0
    .long 0, 0, 0, 0, 0, 0, 0, 0, 0, 0, 0, 0, 0, 0, 0, 0
    .long 1, 24, 24, 8192, 3584, 3840, 8388608, 524288, 32768, 8, 23126016, 131072, 0, 0, 218104624, 4
    .long 2, 64, 72, 7168, 256, 256, 7340032, 524288, 32768, 8, 56365056, 114688, 0, 0, 218103872, 1
    .long 2, 64, 72, 7168, 6400, 6400, 7340032, 1572864, 32768, 8, 60133376, 114688, 0, 0, 218104048, 1
    .long 2, 64, 72, 7168, 5376, 5376, 7340032, 3145728, 32768, 8, 65622016, 114688, 0, 0, 218104240, 1
    .long 2, 64, 72, 7168, 6400, 6400, 7340032, 3670016, 32768, 8, 67473408, 114688, 0, 0, 218104304, 1
    .long 1, 80, 80, 2048, 5505536, 5505792, 7340032, 67457024, 114688, 7, 184033280, 32768, 218104304, 7, 218106816, 1
    .long 0, 0, 0, 0, 0, 0, 0, 0, 0, 0, 0, 0, 0, 0, 0, 0
    .long 0, 0, 0, 0, 0, 0, 0, 0, 0, 0, 0, 0, 0, 0, 0, 0
    .long 0, 0, 0, 0, 0, 0, 0, 0, 0, 0, 0, 0, 0, 0, 0, 0
    .long 0, 0, 0, 0, 0, 0, 0, 0, 0, 0, 0, 0, 0, 0, 0, 0
    .long 1, 24, 24, 8192, 5632, 5888, 8388608, 524288, 32768, 8, 23158784, 131072, 0, 0, 218104656, 4
    .long 2, 64, 72, 7168, 512, 512, 7340032, 524288, 32768, 8, 56369152, 114688, 0, 0, 218103872, 1
    .long 2, 64, 72, 7168, 6656, 6656, 7340032, 1572864, 32768, 8, 60137472, 114688, 0, 0, 218104048, 1
    .long 2, 64, 72, 7168, 5632, 5632, 7340032, 3145728, 32768, 8, 65626112, 114688, 0, 0, 218104240, 1
    .long 2, 64, 72, 7168, 6656, 6656, 7340032, 3670016, 32768, 8, 67477504, 114688, 0, 0, 218104304, 1
    .long 1, 80, 80, 2048, 5506048, 5506304, 7340032, 67457024, 114688, 7, 184041472, 32768, 218104304, 7, 218106816, 1
    .long 0, 0, 0, 0, 0, 0, 0, 0, 0, 0, 0, 0, 0, 0, 0, 0
    .long 0, 0, 0, 0, 0, 0, 0, 0, 0, 0, 0, 0, 0, 0, 0, 0
    .long 0, 0, 0, 0, 0, 0, 0, 0, 0, 0, 0, 0, 0, 0, 0, 0
    .long 0, 0, 0, 0, 0, 0, 0, 0, 0, 0, 0, 0, 0, 0, 0, 0
    .long 1, 24, 24, 8192, 7680, 7936, 8388608, 524288, 32768, 8, 23191552, 131072, 0, 0, 218104688, 4
    .long 2, 64, 72, 7168, 768, 768, 7340032, 524288, 32768, 8, 56373248, 114688, 0, 0, 218103872, 1
    .long 2, 64, 72, 7168, 6912, 6912, 7340032, 1572864, 32768, 8, 60141568, 114688, 0, 0, 218104048, 1
    .long 2, 64, 72, 7168, 5888, 5888, 7340032, 3145728, 32768, 8, 65630208, 114688, 0, 0, 218104240, 1
    .long 2, 64, 72, 7168, 6912, 6912, 7340032, 3670016, 32768, 8, 67481600, 114688, 0, 0, 218104304, 1
    .long 1, 80, 80, 2048, 5506560, 5506816, 7340032, 67457024, 114688, 7, 184049664, 32768, 218104304, 7, 218106816, 1
    .long 0, 0, 0, 0, 0, 0, 0, 0, 0, 0, 0, 0, 0, 0, 0, 0
    .long 0, 0, 0, 0, 0, 0, 0, 0, 0, 0, 0, 0, 0, 0, 0, 0
    .long 0, 0, 0, 0, 0, 0, 0, 0, 0, 0, 0, 0, 0, 0, 0, 0
    .long 0, 0, 0, 0, 0, 0, 0, 0, 0, 0, 0, 0, 0, 0, 0, 0
.p2align 6
.amdhsa_kernel recurrent_scan__memory_aug_recurrent_mem_tr__glu_gated_glu__prompt_kernel
  .amdhsa_next_free_vgpr 256
  .amdhsa_next_free_sgpr 102
  .amdhsa_accum_offset 256
  .amdhsa_group_segment_fixed_size 0
  .amdhsa_kernarg_size 112
  .amdhsa_user_sgpr_count 2
  .amdhsa_user_sgpr_kernarg_segment_ptr 1
  .amdhsa_system_sgpr_workgroup_id_x 1
  .amdhsa_float_denorm_mode_32 3
.end_amdhsa_kernel
```

```asm
; @launch grid=(256,1,1) block=(512,1,1) lds=163840
.amdgcn_target "amdgcn-amd-amdhsa--gfx950"
.text
.globl recurrent_scan__memory_aug_recurrent_mem_tr__glu_gated_glu__prompt_kernel
.p2align 8
.type recurrent_scan__memory_aug_recurrent_mem_tr__glu_gated_glu__prompt_kernel,@function
recurrent_scan__memory_aug_recurrent_mem_tr__glu_gated_glu__prompt_kernel:
    s_cmp_ge_u32 s2, 256
    s_cbranch_scc1 k_exit
    s_mov_b32 s99, s2
    s_load_dwordx2 s[4:5], s[0:1], 104
    s_load_dwordx2 s[64:65], s[0:1], 96
    v_lshrrev_b32 v2, 6, v0
    s_mov_b32 s6, 268435456
    s_mov_b32 s7, 131072
    s_mov_b32 s66, 256
    s_mov_b32 s67, 131072
    v_readfirstlane_b32 s3, v2
    s_lshr_b32 s12, s2, 3
    s_and_b32 s13, s2, 3
    s_waitcnt lgkmcnt(0)
    s_bitcmp0_b32 s2, 2
    s_cbranch_scc1 chain_map
    s_lshl_b32 s63, s12, 2
    s_add_u32 s63, s63, s13
    s_cmp_ge_u32 s3, 4
    s_cbranch_scc1 ln_touch
    s_load_dwordx2 s[8:9], s[0:1], 0
    v_and_b32 v1, 63, v0
    s_mov_b32 s10, 4194304
    s_mov_b32 s11, 131072
    v_and_b32 v3, 15, v1
    v_lshrrev_b32 v4, 4, v1
    v_lshlrev_b32 v5, 11, v3
    v_lshl_add_u32 v5, v4, 4, v5
    s_lshl_b32 s12, s63, 15
    s_lshl_b32 s13, s3, 9
    s_add_u32 s12, s12, s13
    s_waitcnt lgkmcnt(0)
    buffer_load_dwordx4 v[16:19], v5, s[8:11], s12 offen offset:0
    buffer_load_dwordx4 v[20:23], v5, s[8:11], s12 offen offset:64
    buffer_load_dwordx4 v[24:27], v5, s[8:11], s12 offen offset:128
    buffer_load_dwordx4 v[28:31], v5, s[8:11], s12 offen offset:192
    buffer_load_dwordx4 v[32:35], v5, s[8:11], s12 offen offset:256
    buffer_load_dwordx4 v[36:39], v5, s[8:11], s12 offen offset:320
    buffer_load_dwordx4 v[40:43], v5, s[8:11], s12 offen offset:384
    buffer_load_dwordx4 v[44:47], v5, s[8:11], s12 offen offset:448
    v_mov_b32 v14, 0
    s_lshl_b32 s13, s63, 7
    s_add_u32 s13, s13, 218103808
    v_lshlrev_b32 v13, 2, v0
    v_cmp_gt_u32 vcc, 32, v0
    s_and_saveexec_b64 s[22:23], vcc
    s_cbranch_execz ln_nz
    buffer_store_dword v14, v13, s[4:7], s13 offen sc1
ln_nz:
    s_mov_b64 exec, -1
    v_lshlrev_b32 v6, 4, v3
    s_lshl_b32 s14, s3, 2
    v_add_u32 v7, s14, v6
    v_lshlrev_b32 v8, 4, v1
    s_lshl_b32 s15, s63, 15
    s_lshl_b32 s16, s3, 13
    s_add_u32 s15, s15, s16
    s_add_u32 s16, s15, 4096
    v_and_b32 v9, 1, v4
    v_cmp_eq_u32 s[20:21], 1, v9
    s_waitcnt vmcnt(1)
    v_lshlrev_b32 v48, 16, v16
    v_and_b32 v49, 0xffff0000, v16
    v_lshlrev_b32 v50, 16, v17
    v_and_b32 v51, 0xffff0000, v17
    v_lshlrev_b32 v52, 16, v18
    v_and_b32 v53, 0xffff0000, v18
    v_lshlrev_b32 v54, 16, v19
    v_and_b32 v55, 0xffff0000, v19
    v_lshlrev_b32 v56, 16, v20
    v_and_b32 v57, 0xffff0000, v20
    v_lshlrev_b32 v58, 16, v21
    v_and_b32 v59, 0xffff0000, v21
    v_lshlrev_b32 v60, 16, v22
    v_and_b32 v61, 0xffff0000, v22
    v_lshlrev_b32 v62, 16, v23
    v_and_b32 v63, 0xffff0000, v23
    v_lshlrev_b32 v64, 16, v24
    v_and_b32 v65, 0xffff0000, v24
    v_lshlrev_b32 v66, 16, v25
    v_and_b32 v67, 0xffff0000, v25
    v_lshlrev_b32 v68, 16, v26
    v_and_b32 v69, 0xffff0000, v26
    v_lshlrev_b32 v70, 16, v27
    v_and_b32 v71, 0xffff0000, v27
    v_lshlrev_b32 v72, 16, v28
    v_and_b32 v73, 0xffff0000, v28
    v_lshlrev_b32 v74, 16, v29
    v_and_b32 v75, 0xffff0000, v29
    v_lshlrev_b32 v76, 16, v30
    v_and_b32 v77, 0xffff0000, v30
    v_lshlrev_b32 v78, 16, v31
    v_and_b32 v79, 0xffff0000, v31
    v_lshlrev_b32 v80, 16, v32
    v_and_b32 v81, 0xffff0000, v32
    v_lshlrev_b32 v82, 16, v33
    v_and_b32 v83, 0xffff0000, v33
    v_lshlrev_b32 v84, 16, v34
    v_and_b32 v85, 0xffff0000, v34
    v_lshlrev_b32 v86, 16, v35
    v_and_b32 v87, 0xffff0000, v35
    v_lshlrev_b32 v88, 16, v36
    v_and_b32 v89, 0xffff0000, v36
    v_lshlrev_b32 v90, 16, v37
    v_and_b32 v91, 0xffff0000, v37
    v_lshlrev_b32 v92, 16, v38
    v_and_b32 v93, 0xffff0000, v38
    v_lshlrev_b32 v94, 16, v39
    v_and_b32 v95, 0xffff0000, v39
    v_lshlrev_b32 v96, 16, v40
    v_and_b32 v97, 0xffff0000, v40
    v_lshlrev_b32 v98, 16, v41
    v_and_b32 v99, 0xffff0000, v41
    v_lshlrev_b32 v100, 16, v42
    v_and_b32 v101, 0xffff0000, v42
    v_lshlrev_b32 v102, 16, v43
    v_and_b32 v103, 0xffff0000, v43
    v_lshlrev_b32 v104, 16, v44
    v_and_b32 v105, 0xffff0000, v44
    v_lshlrev_b32 v106, 16, v45
    v_and_b32 v107, 0xffff0000, v45
    v_lshlrev_b32 v108, 16, v46
    v_and_b32 v109, 0xffff0000, v46
    v_lshlrev_b32 v110, 16, v47
    v_and_b32 v111, 0xffff0000, v47
    v_add_f32 v112, v48, v80
    v_add_f32 v113, v49, v81
    v_add_f32 v114, v50, v82
    v_add_f32 v115, v51, v83
    v_add_f32 v116, v52, v84
    v_add_f32 v117, v53, v85
    v_add_f32 v118, v54, v86
    v_add_f32 v119, v55, v87
    v_add_f32 v120, v56, v88
    v_add_f32 v121, v57, v89
    v_add_f32 v122, v58, v90
    v_add_f32 v123, v59, v91
    v_add_f32 v124, v60, v92
    v_add_f32 v125, v61, v93
    v_add_f32 v126, v62, v94
    v_add_f32 v127, v63, v95
    v_add_f32 v128, v64, v96
    v_add_f32 v129, v65, v97
    v_add_f32 v130, v66, v98
    v_add_f32 v131, v67, v99
    v_add_f32 v132, v68, v100
    v_add_f32 v133, v69, v101
    v_add_f32 v134, v70, v102
    v_add_f32 v135, v71, v103
    v_add_f32 v136, v72, v104
    v_add_f32 v137, v73, v105
    v_add_f32 v138, v74, v106
    v_add_f32 v139, v75, v107
    v_add_f32 v140, v76, v108
    v_add_f32 v141, v77, v109
    v_add_f32 v142, v78, v110
    v_add_f32 v143, v79, v111
    v_add_f32 v112, v112, v128
    v_add_f32 v113, v113, v129
    v_add_f32 v114, v114, v130
    v_add_f32 v115, v115, v131
    v_add_f32 v116, v116, v132
    v_add_f32 v117, v117, v133
    v_add_f32 v118, v118, v134
    v_add_f32 v119, v119, v135
    v_add_f32 v120, v120, v136
    v_add_f32 v121, v121, v137
    v_add_f32 v122, v122, v138
    v_add_f32 v123, v123, v139
    v_add_f32 v124, v124, v140
    v_add_f32 v125, v125, v141
    v_add_f32 v126, v126, v142
    v_add_f32 v127, v127, v143
    v_add_f32 v112, v112, v120
    v_add_f32 v113, v113, v121
    v_add_f32 v114, v114, v122
    v_add_f32 v115, v115, v123
    v_add_f32 v116, v116, v124
    v_add_f32 v117, v117, v125
    v_add_f32 v118, v118, v126
    v_add_f32 v119, v119, v127
    v_add_f32 v112, v112, v116
    v_add_f32 v113, v113, v117
    v_add_f32 v114, v114, v118
    v_add_f32 v115, v115, v119
    v_add_f32 v112, v112, v114
    v_add_f32 v113, v113, v115
    v_add_f32 v112, v112, v113
    v_mov_b32 v113, v112
    s_nop 1
    v_permlane16_swap_b32 v113, v112
    v_add_f32 v112, v112, v113
    v_mov_b32 v113, v112
    s_nop 1
    v_permlane32_swap_b32 v113, v112
    v_add_f32 v112, v112, v113
    ds_write_b32 v7, v112
    s_waitcnt lgkmcnt(0)
    s_barrier
    ds_read_b128 v[112:115], v6
    s_waitcnt lgkmcnt(0)
    v_add_f32 v112, v112, v114
    v_add_f32 v113, v113, v115
    v_add_f32 v112, v112, v113
    v_mul_f32 v10, 0x3a800000, v112
    v_sub_f32 v176, v48, v10
    v_sub_f32 v177, v49, v10
    v_sub_f32 v178, v50, v10
    v_sub_f32 v179, v51, v10
    v_sub_f32 v180, v52, v10
    v_sub_f32 v181, v53, v10
    v_sub_f32 v182, v54, v10
    v_sub_f32 v183, v55, v10
    v_sub_f32 v184, v56, v10
    v_sub_f32 v185, v57, v10
    v_sub_f32 v186, v58, v10
    v_sub_f32 v187, v59, v10
    v_sub_f32 v188, v60, v10
    v_sub_f32 v189, v61, v10
    v_sub_f32 v190, v62, v10
    v_sub_f32 v191, v63, v10
    v_sub_f32 v192, v64, v10
    v_sub_f32 v193, v65, v10
    v_sub_f32 v194, v66, v10
    v_sub_f32 v195, v67, v10
    v_sub_f32 v196, v68, v10
    v_sub_f32 v197, v69, v10
    v_sub_f32 v198, v70, v10
    v_sub_f32 v199, v71, v10
    v_sub_f32 v200, v72, v10
    v_sub_f32 v201, v73, v10
    v_sub_f32 v202, v74, v10
    v_sub_f32 v203, v75, v10
    v_sub_f32 v204, v76, v10
    v_sub_f32 v205, v77, v10
    v_sub_f32 v206, v78, v10
    v_sub_f32 v207, v79, v10
    v_sub_f32 v208, v80, v10
    v_sub_f32 v209, v81, v10
    v_sub_f32 v210, v82, v10
    v_sub_f32 v211, v83, v10
    v_sub_f32 v212, v84, v10
    v_sub_f32 v213, v85, v10
    v_sub_f32 v214, v86, v10
    v_sub_f32 v215, v87, v10
    v_sub_f32 v216, v88, v10
    v_sub_f32 v217, v89, v10
    v_sub_f32 v218, v90, v10
    v_sub_f32 v219, v91, v10
    v_sub_f32 v220, v92, v10
    v_sub_f32 v221, v93, v10
    v_sub_f32 v222, v94, v10
    v_sub_f32 v223, v95, v10
    v_sub_f32 v224, v96, v10
    v_sub_f32 v225, v97, v10
    v_sub_f32 v226, v98, v10
    v_sub_f32 v227, v99, v10
    v_sub_f32 v228, v100, v10
    v_sub_f32 v229, v101, v10
    v_sub_f32 v230, v102, v10
    v_sub_f32 v231, v103, v10
    v_sub_f32 v232, v104, v10
    v_sub_f32 v233, v105, v10
    v_sub_f32 v234, v106, v10
    v_sub_f32 v235, v107, v10
    v_sub_f32 v236, v108, v10
    v_sub_f32 v237, v109, v10
    v_sub_f32 v238, v110, v10
    v_sub_f32 v239, v111, v10
    v_mul_f32 v112, v176, v176
    v_fmac_f32 v112, v208, v208
    v_mul_f32 v113, v177, v177
    v_fmac_f32 v113, v209, v209
    v_mul_f32 v114, v178, v178
    v_fmac_f32 v114, v210, v210
    v_mul_f32 v115, v179, v179
    v_fmac_f32 v115, v211, v211
    v_mul_f32 v116, v180, v180
    v_fmac_f32 v116, v212, v212
    v_mul_f32 v117, v181, v181
    v_fmac_f32 v117, v213, v213
    v_mul_f32 v118, v182, v182
    v_fmac_f32 v118, v214, v214
    v_mul_f32 v119, v183, v183
    v_fmac_f32 v119, v215, v215
    v_mul_f32 v120, v184, v184
    v_fmac_f32 v120, v216, v216
    v_mul_f32 v121, v185, v185
    v_fmac_f32 v121, v217, v217
    v_mul_f32 v122, v186, v186
    v_fmac_f32 v122, v218, v218
    v_mul_f32 v123, v187, v187
    v_fmac_f32 v123, v219, v219
    v_mul_f32 v124, v188, v188
    v_fmac_f32 v124, v220, v220
    v_mul_f32 v125, v189, v189
    v_fmac_f32 v125, v221, v221
    v_mul_f32 v126, v190, v190
    v_fmac_f32 v126, v222, v222
    v_mul_f32 v127, v191, v191
    v_fmac_f32 v127, v223, v223
    v_mul_f32 v128, v192, v192
    v_fmac_f32 v128, v224, v224
    v_mul_f32 v129, v193, v193
    v_fmac_f32 v129, v225, v225
    v_mul_f32 v130, v194, v194
    v_fmac_f32 v130, v226, v226
    v_mul_f32 v131, v195, v195
    v_fmac_f32 v131, v227, v227
    v_mul_f32 v132, v196, v196
    v_fmac_f32 v132, v228, v228
    v_mul_f32 v133, v197, v197
    v_fmac_f32 v133, v229, v229
    v_mul_f32 v134, v198, v198
    v_fmac_f32 v134, v230, v230
    v_mul_f32 v135, v199, v199
    v_fmac_f32 v135, v231, v231
    v_mul_f32 v136, v200, v200
    v_fmac_f32 v136, v232, v232
    v_mul_f32 v137, v201, v201
    v_fmac_f32 v137, v233, v233
    v_mul_f32 v138, v202, v202
    v_fmac_f32 v138, v234, v234
    v_mul_f32 v139, v203, v203
    v_fmac_f32 v139, v235, v235
    v_mul_f32 v140, v204, v204
    v_fmac_f32 v140, v236, v236
    v_mul_f32 v141, v205, v205
    v_fmac_f32 v141, v237, v237
    v_mul_f32 v142, v206, v206
    v_fmac_f32 v142, v238, v238
    v_mul_f32 v143, v207, v207
    v_fmac_f32 v143, v239, v239
    v_add_f32 v112, v112, v128
    v_add_f32 v113, v113, v129
    v_add_f32 v114, v114, v130
    v_add_f32 v115, v115, v131
    v_add_f32 v116, v116, v132
    v_add_f32 v117, v117, v133
    v_add_f32 v118, v118, v134
    v_add_f32 v119, v119, v135
    v_add_f32 v120, v120, v136
    v_add_f32 v121, v121, v137
    v_add_f32 v122, v122, v138
    v_add_f32 v123, v123, v139
    v_add_f32 v124, v124, v140
    v_add_f32 v125, v125, v141
    v_add_f32 v126, v126, v142
    v_add_f32 v127, v127, v143
    v_add_f32 v112, v112, v120
    v_add_f32 v113, v113, v121
    v_add_f32 v114, v114, v122
    v_add_f32 v115, v115, v123
    v_add_f32 v116, v116, v124
    v_add_f32 v117, v117, v125
    v_add_f32 v118, v118, v126
    v_add_f32 v119, v119, v127
    v_add_f32 v112, v112, v116
    v_add_f32 v113, v113, v117
    v_add_f32 v114, v114, v118
    v_add_f32 v115, v115, v119
    v_add_f32 v112, v112, v114
    v_add_f32 v113, v113, v115
    v_add_f32 v112, v112, v113
    v_mov_b32 v113, v112
    s_nop 1
    v_permlane16_swap_b32 v113, v112
    v_add_f32 v112, v112, v113
    v_mov_b32 v113, v112
    s_nop 1
    v_permlane32_swap_b32 v113, v112
    v_add_f32 v112, v112, v113
    ds_write_b32 v7, v112 offset:512
    s_waitcnt lgkmcnt(0)
    s_barrier
    ds_read_b128 v[112:115], v6 offset:512
    s_waitcnt lgkmcnt(0)
    v_add_f32 v112, v112, v114
    v_add_f32 v113, v113, v115
    v_add_f32 v112, v112, v113
    v_mul_f32 v11, 0x3a800000, v112
    v_cvt_pk_bf16_f32 v10, v10, v10
    v_lshlrev_b32 v10, 16, v10
    v_cvt_pk_bf16_f32 v11, v11, v11
    v_lshlrev_b32 v11, 16, v11
    v_add_f32 v11, 0x3727c5ac, v11
    v_cvt_pk_bf16_f32 v11, v11, v11
    v_lshlrev_b32 v11, 16, v11
    v_sqrt_f32 v11, v11
    s_nop 0
    v_cvt_pk_bf16_f32 v11, v11, v11
    v_lshlrev_b32 v11, 16, v11
    v_rcp_f32 v11, v11
    s_nop 0
    v_sub_f32 v48, v48, v10
    v_sub_f32 v49, v49, v10
    v_cvt_pk_bf16_f32 v16, v48, v49
    v_lshlrev_b32 v48, 16, v16
    v_and_b32 v49, 0xffff0000, v16
    v_mul_f32 v48, v48, v11
    v_mul_f32 v49, v49, v11
    v_cvt_pk_bf16_f32 v16, v48, v49
    v_sub_f32 v50, v50, v10
    v_sub_f32 v51, v51, v10
    v_cvt_pk_bf16_f32 v17, v50, v51
    v_lshlrev_b32 v50, 16, v17
    v_and_b32 v51, 0xffff0000, v17
    v_mul_f32 v50, v50, v11
    v_mul_f32 v51, v51, v11
    v_cvt_pk_bf16_f32 v17, v50, v51
    v_sub_f32 v52, v52, v10
    v_sub_f32 v53, v53, v10
    v_cvt_pk_bf16_f32 v18, v52, v53
    v_lshlrev_b32 v52, 16, v18
    v_and_b32 v53, 0xffff0000, v18
    v_mul_f32 v52, v52, v11
    v_mul_f32 v53, v53, v11
    v_cvt_pk_bf16_f32 v18, v52, v53
    v_sub_f32 v54, v54, v10
    v_sub_f32 v55, v55, v10
    v_cvt_pk_bf16_f32 v19, v54, v55
    v_lshlrev_b32 v54, 16, v19
    v_and_b32 v55, 0xffff0000, v19
    v_mul_f32 v54, v54, v11
    v_mul_f32 v55, v55, v11
    v_cvt_pk_bf16_f32 v19, v54, v55
    v_cndmask_b32 v112, v16, v18, s[20:21]
    v_cndmask_b32 v113, v17, v19, s[20:21]
    v_cndmask_b32 v114, v18, v16, s[20:21]
    v_cndmask_b32 v115, v19, v17, s[20:21]
    buffer_store_dwordx4 v[112:115], v8, s[4:7], s15 offen offset:0 sc1
    v_sub_f32 v56, v56, v10
    v_sub_f32 v57, v57, v10
    v_cvt_pk_bf16_f32 v20, v56, v57
    v_lshlrev_b32 v56, 16, v20
    v_and_b32 v57, 0xffff0000, v20
    v_mul_f32 v56, v56, v11
    v_mul_f32 v57, v57, v11
    v_cvt_pk_bf16_f32 v20, v56, v57
    v_sub_f32 v58, v58, v10
    v_sub_f32 v59, v59, v10
    v_cvt_pk_bf16_f32 v21, v58, v59
    v_lshlrev_b32 v58, 16, v21
    v_and_b32 v59, 0xffff0000, v21
    v_mul_f32 v58, v58, v11
    v_mul_f32 v59, v59, v11
    v_cvt_pk_bf16_f32 v21, v58, v59
    v_sub_f32 v60, v60, v10
    v_sub_f32 v61, v61, v10
    v_cvt_pk_bf16_f32 v22, v60, v61
    v_lshlrev_b32 v60, 16, v22
    v_and_b32 v61, 0xffff0000, v22
    v_mul_f32 v60, v60, v11
    v_mul_f32 v61, v61, v11
    v_cvt_pk_bf16_f32 v22, v60, v61
    v_sub_f32 v62, v62, v10
    v_sub_f32 v63, v63, v10
    v_cvt_pk_bf16_f32 v23, v62, v63
    v_lshlrev_b32 v62, 16, v23
    v_and_b32 v63, 0xffff0000, v23
    v_mul_f32 v62, v62, v11
    v_mul_f32 v63, v63, v11
    v_cvt_pk_bf16_f32 v23, v62, v63
    v_cndmask_b32 v116, v20, v22, s[20:21]
    v_cndmask_b32 v117, v21, v23, s[20:21]
    v_cndmask_b32 v118, v22, v20, s[20:21]
    v_cndmask_b32 v119, v23, v21, s[20:21]
    buffer_store_dwordx4 v[116:119], v8, s[4:7], s15 offen offset:1024 sc1
    v_sub_f32 v64, v64, v10
    v_sub_f32 v65, v65, v10
    v_cvt_pk_bf16_f32 v24, v64, v65
    v_lshlrev_b32 v64, 16, v24
    v_and_b32 v65, 0xffff0000, v24
    v_mul_f32 v64, v64, v11
    v_mul_f32 v65, v65, v11
    v_cvt_pk_bf16_f32 v24, v64, v65
    v_sub_f32 v66, v66, v10
    v_sub_f32 v67, v67, v10
    v_cvt_pk_bf16_f32 v25, v66, v67
    v_lshlrev_b32 v66, 16, v25
    v_and_b32 v67, 0xffff0000, v25
    v_mul_f32 v66, v66, v11
    v_mul_f32 v67, v67, v11
    v_cvt_pk_bf16_f32 v25, v66, v67
    v_sub_f32 v68, v68, v10
    v_sub_f32 v69, v69, v10
    v_cvt_pk_bf16_f32 v26, v68, v69
    v_lshlrev_b32 v68, 16, v26
    v_and_b32 v69, 0xffff0000, v26
    v_mul_f32 v68, v68, v11
    v_mul_f32 v69, v69, v11
    v_cvt_pk_bf16_f32 v26, v68, v69
    v_sub_f32 v70, v70, v10
    v_sub_f32 v71, v71, v10
    v_cvt_pk_bf16_f32 v27, v70, v71
    v_lshlrev_b32 v70, 16, v27
    v_and_b32 v71, 0xffff0000, v27
    v_mul_f32 v70, v70, v11
    v_mul_f32 v71, v71, v11
    v_cvt_pk_bf16_f32 v27, v70, v71
    v_cndmask_b32 v120, v24, v26, s[20:21]
    v_cndmask_b32 v121, v25, v27, s[20:21]
    v_cndmask_b32 v122, v26, v24, s[20:21]
    v_cndmask_b32 v123, v27, v25, s[20:21]
    buffer_store_dwordx4 v[120:123], v8, s[4:7], s15 offen offset:2048 sc1
    v_sub_f32 v72, v72, v10
    v_sub_f32 v73, v73, v10
    v_cvt_pk_bf16_f32 v28, v72, v73
    v_lshlrev_b32 v72, 16, v28
    v_and_b32 v73, 0xffff0000, v28
    v_mul_f32 v72, v72, v11
    v_mul_f32 v73, v73, v11
    v_cvt_pk_bf16_f32 v28, v72, v73
    v_sub_f32 v74, v74, v10
    v_sub_f32 v75, v75, v10
    v_cvt_pk_bf16_f32 v29, v74, v75
    v_lshlrev_b32 v74, 16, v29
    v_and_b32 v75, 0xffff0000, v29
    v_mul_f32 v74, v74, v11
    v_mul_f32 v75, v75, v11
    v_cvt_pk_bf16_f32 v29, v74, v75
    v_sub_f32 v76, v76, v10
    v_sub_f32 v77, v77, v10
    v_cvt_pk_bf16_f32 v30, v76, v77
    v_lshlrev_b32 v76, 16, v30
    v_and_b32 v77, 0xffff0000, v30
    v_mul_f32 v76, v76, v11
    v_mul_f32 v77, v77, v11
    v_cvt_pk_bf16_f32 v30, v76, v77
    v_sub_f32 v78, v78, v10
    v_sub_f32 v79, v79, v10
    v_cvt_pk_bf16_f32 v31, v78, v79
    v_lshlrev_b32 v78, 16, v31
    v_and_b32 v79, 0xffff0000, v31
    v_mul_f32 v78, v78, v11
    v_mul_f32 v79, v79, v11
    v_cvt_pk_bf16_f32 v31, v78, v79
    v_cndmask_b32 v124, v28, v30, s[20:21]
    v_cndmask_b32 v125, v29, v31, s[20:21]
    v_cndmask_b32 v126, v30, v28, s[20:21]
    v_cndmask_b32 v127, v31, v29, s[20:21]
    buffer_store_dwordx4 v[124:127], v8, s[4:7], s15 offen offset:3072 sc1
    v_sub_f32 v80, v80, v10
    v_sub_f32 v81, v81, v10
    v_cvt_pk_bf16_f32 v32, v80, v81
    v_lshlrev_b32 v80, 16, v32
    v_and_b32 v81, 0xffff0000, v32
    v_mul_f32 v80, v80, v11
    v_mul_f32 v81, v81, v11
    v_cvt_pk_bf16_f32 v32, v80, v81
    v_sub_f32 v82, v82, v10
    v_sub_f32 v83, v83, v10
    v_cvt_pk_bf16_f32 v33, v82, v83
    v_lshlrev_b32 v82, 16, v33
    v_and_b32 v83, 0xffff0000, v33
    v_mul_f32 v82, v82, v11
    v_mul_f32 v83, v83, v11
    v_cvt_pk_bf16_f32 v33, v82, v83
    v_sub_f32 v84, v84, v10
    v_sub_f32 v85, v85, v10
    v_cvt_pk_bf16_f32 v34, v84, v85
    v_lshlrev_b32 v84, 16, v34
    v_and_b32 v85, 0xffff0000, v34
    v_mul_f32 v84, v84, v11
    v_mul_f32 v85, v85, v11
    v_cvt_pk_bf16_f32 v34, v84, v85
    v_sub_f32 v86, v86, v10
    v_sub_f32 v87, v87, v10
    v_cvt_pk_bf16_f32 v35, v86, v87
    v_lshlrev_b32 v86, 16, v35
    v_and_b32 v87, 0xffff0000, v35
    v_mul_f32 v86, v86, v11
    v_mul_f32 v87, v87, v11
    v_cvt_pk_bf16_f32 v35, v86, v87
    v_cndmask_b32 v128, v32, v34, s[20:21]
    v_cndmask_b32 v129, v33, v35, s[20:21]
    v_cndmask_b32 v130, v34, v32, s[20:21]
    v_cndmask_b32 v131, v35, v33, s[20:21]
    buffer_store_dwordx4 v[128:131], v8, s[4:7], s16 offen offset:0 sc1
    v_sub_f32 v88, v88, v10
    v_sub_f32 v89, v89, v10
    v_cvt_pk_bf16_f32 v36, v88, v89
    v_lshlrev_b32 v88, 16, v36
    v_and_b32 v89, 0xffff0000, v36
    v_mul_f32 v88, v88, v11
    v_mul_f32 v89, v89, v11
    v_cvt_pk_bf16_f32 v36, v88, v89
    v_sub_f32 v90, v90, v10
    v_sub_f32 v91, v91, v10
    v_cvt_pk_bf16_f32 v37, v90, v91
    v_lshlrev_b32 v90, 16, v37
    v_and_b32 v91, 0xffff0000, v37
    v_mul_f32 v90, v90, v11
    v_mul_f32 v91, v91, v11
    v_cvt_pk_bf16_f32 v37, v90, v91
    v_sub_f32 v92, v92, v10
    v_sub_f32 v93, v93, v10
    v_cvt_pk_bf16_f32 v38, v92, v93
    v_lshlrev_b32 v92, 16, v38
    v_and_b32 v93, 0xffff0000, v38
    v_mul_f32 v92, v92, v11
    v_mul_f32 v93, v93, v11
    v_cvt_pk_bf16_f32 v38, v92, v93
    v_sub_f32 v94, v94, v10
    v_sub_f32 v95, v95, v10
    v_cvt_pk_bf16_f32 v39, v94, v95
    v_lshlrev_b32 v94, 16, v39
    v_and_b32 v95, 0xffff0000, v39
    v_mul_f32 v94, v94, v11
    v_mul_f32 v95, v95, v11
    v_cvt_pk_bf16_f32 v39, v94, v95
    v_cndmask_b32 v132, v36, v38, s[20:21]
    v_cndmask_b32 v133, v37, v39, s[20:21]
    v_cndmask_b32 v134, v38, v36, s[20:21]
    v_cndmask_b32 v135, v39, v37, s[20:21]
    buffer_store_dwordx4 v[132:135], v8, s[4:7], s16 offen offset:1024 sc1
    v_sub_f32 v96, v96, v10
    v_sub_f32 v97, v97, v10
    v_cvt_pk_bf16_f32 v40, v96, v97
    v_lshlrev_b32 v96, 16, v40
    v_and_b32 v97, 0xffff0000, v40
    v_mul_f32 v96, v96, v11
    v_mul_f32 v97, v97, v11
    v_cvt_pk_bf16_f32 v40, v96, v97
    v_sub_f32 v98, v98, v10
    v_sub_f32 v99, v99, v10
    v_cvt_pk_bf16_f32 v41, v98, v99
    v_lshlrev_b32 v98, 16, v41
    v_and_b32 v99, 0xffff0000, v41
    v_mul_f32 v98, v98, v11
    v_mul_f32 v99, v99, v11
    v_cvt_pk_bf16_f32 v41, v98, v99
    v_sub_f32 v100, v100, v10
    v_sub_f32 v101, v101, v10
    v_cvt_pk_bf16_f32 v42, v100, v101
    v_lshlrev_b32 v100, 16, v42
    v_and_b32 v101, 0xffff0000, v42
    v_mul_f32 v100, v100, v11
    v_mul_f32 v101, v101, v11
    v_cvt_pk_bf16_f32 v42, v100, v101
    v_sub_f32 v102, v102, v10
    v_sub_f32 v103, v103, v10
    v_cvt_pk_bf16_f32 v43, v102, v103
    v_lshlrev_b32 v102, 16, v43
    v_and_b32 v103, 0xffff0000, v43
    v_mul_f32 v102, v102, v11
    v_mul_f32 v103, v103, v11
    v_cvt_pk_bf16_f32 v43, v102, v103
    v_cndmask_b32 v136, v40, v42, s[20:21]
    v_cndmask_b32 v137, v41, v43, s[20:21]
    v_cndmask_b32 v138, v42, v40, s[20:21]
    v_cndmask_b32 v139, v43, v41, s[20:21]
    buffer_store_dwordx4 v[136:139], v8, s[4:7], s16 offen offset:2048 sc1
    v_sub_f32 v104, v104, v10
    v_sub_f32 v105, v105, v10
    v_cvt_pk_bf16_f32 v44, v104, v105
    v_lshlrev_b32 v104, 16, v44
    v_and_b32 v105, 0xffff0000, v44
    v_mul_f32 v104, v104, v11
    v_mul_f32 v105, v105, v11
    v_cvt_pk_bf16_f32 v44, v104, v105
    v_sub_f32 v106, v106, v10
    v_sub_f32 v107, v107, v10
    v_cvt_pk_bf16_f32 v45, v106, v107
    v_lshlrev_b32 v106, 16, v45
    v_and_b32 v107, 0xffff0000, v45
    v_mul_f32 v106, v106, v11
    v_mul_f32 v107, v107, v11
    v_cvt_pk_bf16_f32 v45, v106, v107
    v_sub_f32 v108, v108, v10
    v_sub_f32 v109, v109, v10
    v_cvt_pk_bf16_f32 v46, v108, v109
    v_lshlrev_b32 v108, 16, v46
    v_and_b32 v109, 0xffff0000, v46
    v_mul_f32 v108, v108, v11
    v_mul_f32 v109, v109, v11
    v_cvt_pk_bf16_f32 v46, v108, v109
    v_sub_f32 v110, v110, v10
    v_sub_f32 v111, v111, v10
    v_cvt_pk_bf16_f32 v47, v110, v111
    v_lshlrev_b32 v110, 16, v47
    v_and_b32 v111, 0xffff0000, v47
    v_mul_f32 v110, v110, v11
    v_mul_f32 v111, v111, v11
    v_cvt_pk_bf16_f32 v47, v110, v111
    v_cndmask_b32 v140, v44, v46, s[20:21]
    v_cndmask_b32 v141, v45, v47, s[20:21]
    v_cndmask_b32 v142, v46, v44, s[20:21]
    v_cndmask_b32 v143, v47, v45, s[20:21]
    buffer_store_dwordx4 v[140:143], v8, s[4:7], s16 offen offset:3072 sc1
    s_waitcnt vmcnt(0)
    s_barrier
    s_cmp_lg_u32 s3, 0
    s_cbranch_scc1 ln_sig
    v_mov_b32 v2, 1
    s_mov_b64 exec, 1
    s_cmp_ge_u32 s63, 8
    s_cbranch_scc1 ln_sb
    buffer_atomic_add v2, off, s[64:67], 0 offset:192 sc1
ln_sb:
    buffer_atomic_add v2, off, s[64:67], 0 offset:0 sc1
    s_mov_b64 exec, -1
    s_branch ln_sig
ln_touch:
    s_getpc_b64 s[24:25]
    s_add_u32 s24, s24, jobtab@rel32@lo+4
    s_addc_u32 s25, s25, jobtab@rel32@hi+12
    s_mul_i32 s30, s63, 640
    s_add_u32 s24, s24, s30
    s_addc_u32 s25, s25, 0
    s_load_dwordx16 s[32:47], s[24:25], 0
    s_mov_b32 s11, 131072
    v_and_b32 v20, 63, v0
    s_waitcnt lgkmcnt(0)
    s_load_dwordx2 s[8:9], s[0:1], s33
    s_mov_b32 s10, s38
    s_lshl_b32 s30, s35, 4
    v_mul_lo_u32 v21, s30, v20
    v_and_b32 v22, 15, v20
    v_mul_lo_u32 v22, s43, v22
    s_waitcnt lgkmcnt(0)
    s_cmp_eq_u32 s3, 4
    s_cbranch_scc0 tlb_1_1
    buffer_load_dword v23, v21, s[8:11], s36 offen
    s_branch tlb_1
tlb_1_1:
    s_cmp_eq_u32 s3, 5
    s_cbranch_scc0 tlb_1
    buffer_load_dword v23, v22, s[4:7], s42 offen
    buffer_load_dword v23, off, s[4:7], s46
tlb_1:
    s_barrier
    s_barrier
    s_barrier
ln_sig:
    s_cmp_lt_u32 s63, 120
    s_cbranch_scc1 prb_done
    s_cmp_lg_u32 s3, 0
    s_cbranch_scc1 prb_bar
    s_sub_u32 s12, s63, 120
    s_lshl_b32 s62, s12, 7
    s_add_u32 s62, s62, 218112000
    s_lshl_b32 s21, s12, 10
    s_add_u32 s21, s21, 209715200
    s_mov_b32 s80, -1
    s_mov_b32 s81, -1
    s_mov_b64 exec, 1
    s_memtime s[74:75]
    s_add_u32 s24, s21, 0
    s_waitcnt lgkmcnt(0)
    buffer_load_dword v3, off, s[4:7], s24 sc1
    s_waitcnt vmcnt(0)
    s_memtime s[76:77]
    s_waitcnt lgkmcnt(0)
    s_sub_u32 s24, s76, s74
    s_min_u32 s80, s80, s24
    s_memtime s[74:75]
    s_add_u32 s24, s21, 8192
    s_waitcnt lgkmcnt(0)
    buffer_load_dword v3, off, s[4:7], s24 sc1
    s_waitcnt vmcnt(0)
    s_memtime s[76:77]
    s_waitcnt lgkmcnt(0)
    s_sub_u32 s24, s76, s74
    s_min_u32 s81, s81, s24
    s_memtime s[74:75]
    s_add_u32 s24, s21, 16384
    s_waitcnt lgkmcnt(0)
    buffer_load_dword v3, off, s[4:7], s24 sc1
    s_waitcnt vmcnt(0)
    s_memtime s[76:77]
    s_waitcnt lgkmcnt(0)
    s_sub_u32 s24, s76, s74
    s_min_u32 s80, s80, s24
    s_memtime s[74:75]
    s_add_u32 s24, s21, 24576
    s_waitcnt lgkmcnt(0)
    buffer_load_dword v3, off, s[4:7], s24 sc1
    s_waitcnt vmcnt(0)
    s_memtime s[76:77]
    s_waitcnt lgkmcnt(0)
    s_sub_u32 s24, s76, s74
    s_min_u32 s81, s81, s24
    s_memtime s[74:75]
    s_add_u32 s24, s21, 32768
    s_waitcnt lgkmcnt(0)
    buffer_load_dword v3, off, s[4:7], s24 sc1
    s_waitcnt vmcnt(0)
    s_memtime s[76:77]
    s_waitcnt lgkmcnt(0)
    s_sub_u32 s24, s76, s74
    s_min_u32 s80, s80, s24
    s_memtime s[74:75]
    s_add_u32 s24, s21, 40960
    s_waitcnt lgkmcnt(0)
    buffer_load_dword v3, off, s[4:7], s24 sc1
    s_waitcnt vmcnt(0)
    s_memtime s[76:77]
    s_waitcnt lgkmcnt(0)
    s_sub_u32 s24, s76, s74
    s_min_u32 s81, s81, s24
    s_memtime s[74:75]
    s_add_u32 s24, s21, 49152
    s_waitcnt lgkmcnt(0)
    buffer_load_dword v3, off, s[4:7], s24 sc1
    s_waitcnt vmcnt(0)
    s_memtime s[76:77]
    s_waitcnt lgkmcnt(0)
    s_sub_u32 s24, s76, s74
    s_min_u32 s80, s80, s24
    s_memtime s[74:75]
    s_add_u32 s24, s21, 57344
    s_waitcnt lgkmcnt(0)
    buffer_load_dword v3, off, s[4:7], s24 sc1
    s_waitcnt vmcnt(0)
    s_memtime s[76:77]
    s_waitcnt lgkmcnt(0)
    s_sub_u32 s24, s76, s74
    s_min_u32 s81, s81, s24
    s_memtime s[74:75]
    s_add_u32 s24, s21, 65536
    s_waitcnt lgkmcnt(0)
    buffer_load_dword v3, off, s[4:7], s24 sc1
    s_waitcnt vmcnt(0)
    s_memtime s[76:77]
    s_waitcnt lgkmcnt(0)
    s_sub_u32 s24, s76, s74
    s_min_u32 s80, s80, s24
    s_memtime s[74:75]
    s_add_u32 s24, s21, 73728
    s_waitcnt lgkmcnt(0)
    buffer_load_dword v3, off, s[4:7], s24 sc1
    s_waitcnt vmcnt(0)
    s_memtime s[76:77]
    s_waitcnt lgkmcnt(0)
    s_sub_u32 s24, s76, s74
    s_min_u32 s81, s81, s24
    s_memtime s[74:75]
    s_add_u32 s24, s21, 81920
    s_waitcnt lgkmcnt(0)
    buffer_load_dword v3, off, s[4:7], s24 sc1
    s_waitcnt vmcnt(0)
    s_memtime s[76:77]
    s_waitcnt lgkmcnt(0)
    s_sub_u32 s24, s76, s74
    s_min_u32 s80, s80, s24
    s_memtime s[74:75]
    s_add_u32 s24, s21, 90112
    s_waitcnt lgkmcnt(0)
    buffer_load_dword v3, off, s[4:7], s24 sc1
    s_waitcnt vmcnt(0)
    s_memtime s[76:77]
    s_waitcnt lgkmcnt(0)
    s_sub_u32 s24, s76, s74
    s_min_u32 s81, s81, s24
    s_sub_i32 s22, s80, s81
    s_min_i32 s22, s22, 400
    s_max_i32 s22, s22, -400
    s_lshl_b32 s22, s22, 8
    s_getreg_b32 s23, hwreg(HW_REG_XCC_ID)
    s_bfe_u32 s23, s23, 0x10002
    s_lshl_b32 s23, s23, 1
    s_or_b32 s22, s22, s23
    s_or_b32 s22, s22, 1
    s_mov_b32 s23, 65536
prb_i:
    buffer_load_dword v3, off, s[64:67], 0 offset:0 sc1
    s_waitcnt vmcnt(0)
    v_readfirstlane_b32 s21, v3
    s_cmp_ge_u32 s21, 128
    s_cbranch_scc1 prb_i_ok
    s_sleep 8
    s_sub_u32 s23, s23, 1
    s_cbranch_scc0 prb_i
prb_i_ok:
    v_mov_b32 v3, s22
    buffer_store_dword v3, off, s[4:7], s62 offset:8 sc1
    s_mov_b64 exec, -1
prb_bar:
    s_barrier
prb_done:
    s_mov_b32 s29, s63
    v_and_b32 v20, 63, v0
    v_lshlrev_b32 v1, 4, v20
    v_add_u32 v19, 0x1000, v1
    v_lshrrev_b32 v4, 4, v20
    v_mov_b32 v17, 0
    v_mov_b32 v18, 1
    s_lshr_b32 s26, s3, 2
    s_and_b32 s27, s3, 3
    s_lshl_b32 s21, s3, 11
    s_lshl_b32 s22, s3, 10
    s_add_u32 s22, s22, 16384
    s_mov_b32 s11, 131072
    s_mov_b32 s15, 131072
    s_mov_b32 s28, 0
    v_and_b32 v21, 15, v20
    v_lshlrev_b32 v22, 2, v4
    v_xor_b32 v21, v21, v22
    s_lshr_b32 s30, s3, 1
    s_and_b32 s30, s30, 1
    v_xor_b32 v21, s30, v21
    v_lshlrev_b32 v3, 4, v21
    s_lshl_b32 s30, s26, 13
    v_add_u32 v5, s30, v1
    v_add_u32 v6, 0x10000, v5
    v_bfe_u32 v21, v20, 2, 2
    v_and_b32 v22, 3, v20
    v_and_b32 v23, 1, v4
    v_xor_b32 v24, s27, v21
    v_xor_b32 v25, v22, v23
    v_lshl_add_u32 v24, v24, 2, v25
    v_lshlrev_b32 v24, 4, v24
    v_lshl_add_u32 v25, v4, 3, v21
    v_lshl_add_u32 v24, v25, 8, v24
    v_and_b32 v22, 1, v22
    v_xor_b32 v25, 0, v23
    v_lshl_add_u32 v8, v25, 10, v24
    v_xor_b32 v25, 0, v22
    v_lshl_add_u32 v8, v25, 3, v8
    v_add_u32 v12, 0x10000, v8
    v_xor_b32 v25, 1, v23
    v_lshl_add_u32 v9, v25, 10, v24
    v_xor_b32 v25, 0, v22
    v_lshl_add_u32 v9, v25, 3, v9
    v_add_u32 v13, 0x10000, v9
    v_xor_b32 v25, 0, v23
    v_lshl_add_u32 v10, v25, 10, v24
    v_xor_b32 v25, 1, v22
    v_lshl_add_u32 v10, v25, 3, v10
    v_add_u32 v14, 0x10000, v10
    v_xor_b32 v25, 1, v23
    v_lshl_add_u32 v11, v25, 10, v24
    v_xor_b32 v25, 1, v22
    v_lshl_add_u32 v11, v25, 3, v11
    v_add_u32 v15, 0x10000, v11
    s_lshl_b32 s30, s3, 2
    s_add_u32 s30, s30, 131072
    v_mov_b32 v7, s30
    s_getpc_b64 s[24:25]
    s_add_u32 s24, s24, jobtab@rel32@lo+4
    s_addc_u32 s25, s25, jobtab@rel32@hi+12
    s_mul_i32 s30, s29, 640
    s_add_u32 s24, s24, s30
    s_addc_u32 s25, s25, 0
    s_load_dwordx16 s[32:47], s[24:25], 0
    s_add_u32 s24, s24, 64
    s_addc_u32 s25, s25, 0
    s_waitcnt lgkmcnt(0)
    s_cmp_lt_u32 s32, 4
    s_cbranch_scc1 w_nopre
    s_load_dwordx2 s[8:9], s[0:1], s33
    s_load_dwordx2 s[12:13], s[0:1], s34
    s_mov_b32 s10, s38
    s_mov_b32 s14, s38
    s_cmp_ge_u32 s32, 4
    s_cselect_b32 s31, 0, 1
    s_lshl_b32 s30, s3, s31
    s_mul_i32 s30, s30, s40
    s_add_u32 s16, s39, s30
    s_cmp_eq_u32 s32, 4
    s_cselect_b32 s30, 1024, s40
    s_cselect_b32 s31, 6, 5
    s_lshl_b32 s62, 32, s31
    s_add_u32 s17, s16, s30
    s_lshl_b32 s30, s3, 2
    s_mul_i32 s30, s30, s35
    s_add_u32 s18, s36, s30
    s_add_u32 s19, s37, s30
    s_lshl_b32 s20, s35, s31
    v_mul_u32_u24 v2, s35, v4
    v_add_u32 v2, v2, v3
    s_waitcnt lgkmcnt(0)
    s_add_u32 m0, s22, 0
    s_nop 0
    buffer_load_dwordx4 v2, s[8:11], s18 offen lds
    s_add_u32 s18, s18, s20
    s_add_u32 m0, s22, 8192
    s_nop 0
    buffer_load_dwordx4 v2, s[12:15], s19 offen lds
    s_add_u32 s19, s19, s20
    s_add_u32 m0, s22, 32768
    s_nop 0
    buffer_load_dwordx4 v2, s[8:11], s18 offen lds
    s_add_u32 s18, s18, s20
    s_add_u32 m0, s22, 40960
    s_nop 0
    buffer_load_dwordx4 v2, s[12:15], s19 offen lds
    s_add_u32 s19, s19, s20
    s_add_u32 m0, s22, 65536
    s_nop 0
    buffer_load_dwordx4 v2, s[8:11], s18 offen lds
    s_add_u32 s18, s18, s20
    s_add_u32 m0, s22, 73728
    s_nop 0
    buffer_load_dwordx4 v2, s[12:15], s19 offen lds
    s_add_u32 s19, s19, s20
    s_add_u32 m0, s22, 98304
    s_nop 0
    buffer_load_dwordx4 v2, s[8:11], s18 offen lds
    s_add_u32 s18, s18, s20
    s_add_u32 m0, s22, 106496
    s_nop 0
    buffer_load_dwordx4 v2, s[12:15], s19 offen lds
    s_add_u32 s19, s19, s20
    s_cmp_ge_u32 s32, 4
    s_cselect_b32 s70, 1, 0
    s_cmp_lt_u32 s39, 262144
    s_cselect_b32 s70, s70, 0
    s_cmp_lg_u32 s3, 0
    s_cbranch_scc1 lnwp_ok
    s_cmp_eq_u32 s70, 0
    s_cbranch_scc1 lnwp_full
    s_mov_b32 s69, 65536
lnwap:
    buffer_load_dword v20, off, s[64:67], 0 offset:192 sc1
    s_waitcnt vmcnt(0)
    v_readfirstlane_b32 s68, v20
    s_cmp_ge_u32 s68, 8
    s_cbranch_scc1 lnwap_ok
    s_sleep 8
    s_sub_u32 s69, s69, 1
    s_cbranch_scc0 lnwap
lnwap_ok:
    s_branch lnwp_ok
lnwp_full:
    s_mov_b32 s69, 65536
lnwp:
    buffer_load_dword v20, off, s[64:67], 0 offset:0 sc1
    s_waitcnt vmcnt(0)
    v_readfirstlane_b32 s68, v20
    s_cmp_ge_u32 s68, 128
    s_cbranch_scc1 lnwp_ok
    s_sleep 8
    s_sub_u32 s69, s69, 1
    s_cbranch_scc0 lnwp
lnwp_ok:
    s_barrier
    s_add_u32 m0, s21, 0
    s_nop 0
    buffer_load_dwordx4 v1, s[4:7], s16 offen sc1 lds
    s_add_u32 s16, s16, s62
    s_add_u32 m0, s21, 1024
    s_nop 0
    buffer_load_dwordx4 v1, s[4:7], s17 offen sc1 lds
    s_add_u32 s17, s17, s62
    s_add_u32 m0, s21, 32768
    s_nop 0
    buffer_load_dwordx4 v1, s[4:7], s16 offen sc1 lds
    s_add_u32 s16, s16, s62
    s_add_u32 m0, s21, 33792
    s_nop 0
    buffer_load_dwordx4 v1, s[4:7], s17 offen sc1 lds
    s_add_u32 s17, s17, s62
    s_add_u32 m0, s21, 65536
    s_nop 0
    buffer_load_dwordx4 v1, s[4:7], s16 offen sc1 lds
    s_add_u32 s16, s16, s62
    s_add_u32 m0, s21, 66560
    s_nop 0
    buffer_load_dwordx4 v1, s[4:7], s17 offen sc1 lds
    s_add_u32 s17, s17, s62
    s_add_u32 m0, s21, 98304
    s_nop 0
    buffer_load_dwordx4 v1, s[4:7], s16 offen sc1 lds
    s_add_u32 s16, s16, s62
    s_add_u32 m0, s21, 99328
    s_nop 0
    buffer_load_dwordx4 v1, s[4:7], s17 offen sc1 lds
    s_add_u32 s17, s17, s62
    s_branch w_adopt
w_nopre:
    s_cmp_ge_u32 s32, 4
    s_cselect_b32 s70, 1, 0
    s_cmp_lt_u32 s39, 262144
    s_cselect_b32 s70, s70, 0
    s_cmp_lg_u32 s3, 0
    s_cbranch_scc1 lnw_ok
    s_cmp_eq_u32 s70, 0
    s_cbranch_scc1 lnw_full
    s_mov_b32 s69, 65536
lnwa:
    buffer_load_dword v20, off, s[64:67], 0 offset:192 sc1
    s_waitcnt vmcnt(0)
    v_readfirstlane_b32 s68, v20
    s_cmp_ge_u32 s68, 8
    s_cbranch_scc1 lnwa_ok
    s_sleep 8
    s_sub_u32 s69, s69, 1
    s_cbranch_scc0 lnwa
lnwa_ok:
    s_branch lnw_ok
lnw_full:
    s_mov_b32 s69, 65536
lnw:
    buffer_load_dword v20, off, s[64:67], 0 offset:0 sc1
    s_waitcnt vmcnt(0)
    v_readfirstlane_b32 s68, v20
    s_cmp_ge_u32 s68, 128
    s_cbranch_scc1 lnw_ok
    s_sleep 8
    s_sub_u32 s69, s69, 1
    s_cbranch_scc0 lnw
lnw_ok:
    s_barrier
w_cold:
    s_cmp_eq_u32 s32, 0
    s_cbranch_scc1 fin_entry
    s_cmp_lg_u32 s3, 0
    s_cbranch_scc1 w_depok
    s_cmp_eq_u32 s45, 0
    s_cbranch_scc1 w_depok
    s_mov_b32 s31, 0x40000
w_waitdep:
    buffer_load_dword v16, v17, s[4:7], s44 offen sc1
    s_waitcnt vmcnt(0)
    v_readfirstlane_b32 s30, v16
    s_cmp_ge_u32 s30, s45
    s_cbranch_scc1 w_depok
    s_sleep 16
    s_sub_u32 s31, s31, 1
    s_cbranch_scc0 w_waitdep
w_depok:
    s_load_dwordx2 s[8:9], s[0:1], s33
    s_load_dwordx2 s[12:13], s[0:1], s34
    s_mov_b32 s10, s38
    s_mov_b32 s14, s38
    s_cmp_ge_u32 s32, 4
    s_cselect_b32 s31, 0, 1
    s_lshl_b32 s30, s3, s31
    s_mul_i32 s30, s30, s40
    s_add_u32 s16, s39, s30
    s_cmp_eq_u32 s32, 4
    s_cselect_b32 s30, 1024, s40
    s_cselect_b32 s31, 6, 5
    s_lshl_b32 s62, 32, s31
    s_add_u32 s17, s16, s30
    s_lshl_b32 s30, s3, 2
    s_mul_i32 s30, s30, s35
    s_add_u32 s18, s36, s30
    s_add_u32 s19, s37, s30
    s_lshl_b32 s20, s35, s31
    v_mul_u32_u24 v2, s35, v4
    v_add_u32 v2, v2, v3
    s_waitcnt lgkmcnt(0)
    s_barrier
    s_add_u32 m0, s21, 0
    s_nop 0
    buffer_load_dwordx4 v1, s[4:7], s16 offen sc1 lds
    s_add_u32 s16, s16, s62
    s_add_u32 m0, s21, 1024
    s_nop 0
    buffer_load_dwordx4 v1, s[4:7], s17 offen sc1 lds
    s_add_u32 s17, s17, s62
    s_add_u32 m0, s22, 0
    s_nop 0
    buffer_load_dwordx4 v2, s[8:11], s18 offen lds
    s_add_u32 s18, s18, s20
    s_add_u32 m0, s22, 8192
    s_nop 0
    buffer_load_dwordx4 v2, s[12:15], s19 offen lds
    s_add_u32 s19, s19, s20
    s_add_u32 m0, s21, 32768
    s_nop 0
    buffer_load_dwordx4 v1, s[4:7], s16 offen sc1 lds
    s_add_u32 s16, s16, s62
    s_add_u32 m0, s21, 33792
    s_nop 0
    buffer_load_dwordx4 v1, s[4:7], s17 offen sc1 lds
    s_add_u32 s17, s17, s62
    s_add_u32 m0, s22, 32768
    s_nop 0
    buffer_load_dwordx4 v2, s[8:11], s18 offen lds
    s_add_u32 s18, s18, s20
    s_add_u32 m0, s22, 40960
    s_nop 0
    buffer_load_dwordx4 v2, s[12:15], s19 offen lds
    s_add_u32 s19, s19, s20
    s_add_u32 m0, s21, 65536
    s_nop 0
    buffer_load_dwordx4 v1, s[4:7], s16 offen sc1 lds
    s_add_u32 s16, s16, s62
    s_add_u32 m0, s21, 66560
    s_nop 0
    buffer_load_dwordx4 v1, s[4:7], s17 offen sc1 lds
    s_add_u32 s17, s17, s62
    s_add_u32 m0, s22, 65536
    s_nop 0
    buffer_load_dwordx4 v2, s[8:11], s18 offen lds
    s_add_u32 s18, s18, s20
    s_add_u32 m0, s22, 73728
    s_nop 0
    buffer_load_dwordx4 v2, s[12:15], s19 offen lds
    s_add_u32 s19, s19, s20
    s_add_u32 m0, s21, 98304
    s_nop 0
    buffer_load_dwordx4 v1, s[4:7], s16 offen sc1 lds
    s_add_u32 s16, s16, s62
    s_add_u32 m0, s21, 99328
    s_nop 0
    buffer_load_dwordx4 v1, s[4:7], s17 offen sc1 lds
    s_add_u32 s17, s17, s62
    s_add_u32 m0, s22, 98304
    s_nop 0
    buffer_load_dwordx4 v2, s[8:11], s18 offen lds
    s_add_u32 s18, s18, s20
    s_add_u32 m0, s22, 106496
    s_nop 0
    buffer_load_dwordx4 v2, s[12:15], s19 offen lds
    s_add_u32 s19, s19, s20
w_adopt:
    s_mov_b32 s48, s32
    s_cmp_ge_u32 s32, 4
    s_cselect_b32 s30, 2, 3
    s_lshl_b32 s30, s26, s30
    s_mul_i32 s30, s30, s43
    s_add_u32 s49, s42, s30
    s_mov_b32 s50, s43
    s_mov_b32 s51, s46
    s_mov_b32 s23, s41
    s_mov_b32 s53, s47
    s_nop 0
    s_load_dwordx16 s[32:47], s[24:25], 0
    s_add_u32 s24, s24, 64
    s_addc_u32 s25, s25, 0
    s_waitcnt vmcnt(0)
    s_barrier
    ds_read_b64_tr_b16 v[64:65], v8 offset:16384
    ds_read_b64_tr_b16 v[66:67], v9 offset:16384
    ds_read_b64_tr_b16 v[68:69], v10 offset:16384
    ds_read_b64_tr_b16 v[70:71], v11 offset:16384
    ds_read_b64_tr_b16 v[72:73], v8 offset:24576
    ds_read_b64_tr_b16 v[74:75], v9 offset:24576
    ds_read_b64_tr_b16 v[76:77], v10 offset:24576
    ds_read_b64_tr_b16 v[78:79], v11 offset:24576
    ds_read_b128 v[32:35], v5 offset:0
    ds_read_b128 v[36:39], v5 offset:1024
    ds_read_b128 v[40:43], v5 offset:2048
    ds_read_b128 v[44:47], v5 offset:3072
    ds_read_b128 v[48:51], v5 offset:4096
    ds_read_b128 v[52:55], v5 offset:5120
    ds_read_b128 v[56:59], v5 offset:6144
    ds_read_b128 v[60:63], v5 offset:7168
    s_waitcnt lgkmcnt(0)
    s_cmp_eq_u32 s48, 4
    s_cbranch_scc1 w_firstH
    s_cmp_eq_u32 s48, 5
    s_cbranch_scc1 w_firstM
    s_branch w_first16
w_first4:
    s_waitcnt vmcnt(12)
    s_barrier
    v_mfma_f32_16x16x32_bf16 v[128:131], v[64:67], v[32:35], 0
    ds_read_b64_tr_b16 v[112:113], v8 offset:49152
    v_mfma_f32_16x16x32_bf16 v[132:135], v[68:71], v[32:35], 0
    ds_read_b64_tr_b16 v[114:115], v9 offset:49152
    v_mfma_f32_16x16x32_bf16 v[136:139], v[72:75], v[32:35], 0
    ds_read_b64_tr_b16 v[116:117], v10 offset:49152
    v_mfma_f32_16x16x32_bf16 v[140:143], v[76:79], v[32:35], 0
    ds_read_b64_tr_b16 v[118:119], v11 offset:49152
    v_mfma_f32_16x16x32_bf16 v[144:147], v[64:67], v[36:39], 0
    ds_read_b64_tr_b16 v[120:121], v8 offset:57344
    v_mfma_f32_16x16x32_bf16 v[148:151], v[68:71], v[36:39], 0
    ds_read_b64_tr_b16 v[122:123], v9 offset:57344
    v_mfma_f32_16x16x32_bf16 v[152:155], v[72:75], v[36:39], 0
    ds_read_b64_tr_b16 v[124:125], v10 offset:57344
    v_mfma_f32_16x16x32_bf16 v[156:159], v[76:79], v[36:39], 0
    ds_read_b64_tr_b16 v[126:127], v11 offset:57344
    v_mfma_f32_16x16x32_bf16 v[160:163], v[64:67], v[40:43], 0
    ds_read_b128 v[80:83], v5 offset:32768
    v_mfma_f32_16x16x32_bf16 v[164:167], v[68:71], v[40:43], 0
    ds_read_b128 v[84:87], v5 offset:33792
    v_mfma_f32_16x16x32_bf16 v[168:171], v[72:75], v[40:43], 0
    ds_read_b128 v[88:91], v5 offset:34816
    v_mfma_f32_16x16x32_bf16 v[172:175], v[76:79], v[40:43], 0
    ds_read_b128 v[92:95], v5 offset:35840
    v_mfma_f32_16x16x32_bf16 v[176:179], v[64:67], v[44:47], 0
    ds_read_b128 v[96:99], v5 offset:36864
    v_mfma_f32_16x16x32_bf16 v[180:183], v[68:71], v[44:47], 0
    ds_read_b128 v[100:103], v5 offset:37888
    v_mfma_f32_16x16x32_bf16 v[184:187], v[72:75], v[44:47], 0
    ds_read_b128 v[104:107], v5 offset:38912
    v_mfma_f32_16x16x32_bf16 v[188:191], v[76:79], v[44:47], 0
    ds_read_b128 v[108:111], v5 offset:39936
    v_mfma_f32_16x16x32_bf16 v[192:195], v[64:67], v[48:51], 0
    v_mfma_f32_16x16x32_bf16 v[196:199], v[68:71], v[48:51], 0
    s_add_u32 m0, s21, 0
    s_nop 0
    buffer_load_dwordx4 v1, s[4:7], s16 offen sc1 lds
    s_add_u32 s16, s16, s62
    v_mfma_f32_16x16x32_bf16 v[200:203], v[72:75], v[48:51], 0
    v_mfma_f32_16x16x32_bf16 v[204:207], v[76:79], v[48:51], 0
    v_mfma_f32_16x16x32_bf16 v[208:211], v[64:67], v[52:55], 0
    s_add_u32 m0, s21, 1024
    s_nop 0
    buffer_load_dwordx4 v1, s[4:7], s17 offen sc1 lds
    s_add_u32 s17, s17, s62
    v_mfma_f32_16x16x32_bf16 v[212:215], v[68:71], v[52:55], 0
    v_mfma_f32_16x16x32_bf16 v[216:219], v[72:75], v[52:55], 0
    v_mfma_f32_16x16x32_bf16 v[220:223], v[76:79], v[52:55], 0
    s_add_u32 m0, s22, 0
    s_nop 0
    buffer_load_dwordx4 v2, s[8:11], s18 offen lds
    s_add_u32 s18, s18, s20
    v_mfma_f32_16x16x32_bf16 v[224:227], v[64:67], v[56:59], 0
    v_mfma_f32_16x16x32_bf16 v[228:231], v[68:71], v[56:59], 0
    v_mfma_f32_16x16x32_bf16 v[232:235], v[72:75], v[56:59], 0
    s_add_u32 m0, s22, 8192
    s_nop 0
    buffer_load_dwordx4 v2, s[12:15], s19 offen lds
    s_add_u32 s19, s19, s20
    v_mfma_f32_16x16x32_bf16 v[236:239], v[76:79], v[56:59], 0
    v_mfma_f32_16x16x32_bf16 v[240:243], v[64:67], v[60:63], 0
    v_mfma_f32_16x16x32_bf16 v[244:247], v[68:71], v[60:63], 0
    v_mfma_f32_16x16x32_bf16 v[248:251], v[72:75], v[60:63], 0
    v_mfma_f32_16x16x32_bf16 v[252:255], v[76:79], v[60:63], 0
    s_waitcnt lgkmcnt(0)
    s_waitcnt vmcnt(12)
    s_barrier
    v_mfma_f32_16x16x32_bf16 v[128:131], v[112:115], v[80:83], v[128:131]
    ds_read_b64_tr_b16 v[64:65], v12 offset:16384
    v_mfma_f32_16x16x32_bf16 v[132:135], v[116:119], v[80:83], v[132:135]
    ds_read_b64_tr_b16 v[66:67], v13 offset:16384
    v_mfma_f32_16x16x32_bf16 v[136:139], v[120:123], v[80:83], v[136:139]
    ds_read_b64_tr_b16 v[68:69], v14 offset:16384
    v_mfma_f32_16x16x32_bf16 v[140:143], v[124:127], v[80:83], v[140:143]
    ds_read_b64_tr_b16 v[70:71], v15 offset:16384
    v_mfma_f32_16x16x32_bf16 v[144:147], v[112:115], v[84:87], v[144:147]
    ds_read_b64_tr_b16 v[72:73], v12 offset:24576
    v_mfma_f32_16x16x32_bf16 v[148:151], v[116:119], v[84:87], v[148:151]
    ds_read_b64_tr_b16 v[74:75], v13 offset:24576
    v_mfma_f32_16x16x32_bf16 v[152:155], v[120:123], v[84:87], v[152:155]
    ds_read_b64_tr_b16 v[76:77], v14 offset:24576
    v_mfma_f32_16x16x32_bf16 v[156:159], v[124:127], v[84:87], v[156:159]
    ds_read_b64_tr_b16 v[78:79], v15 offset:24576
    v_mfma_f32_16x16x32_bf16 v[160:163], v[112:115], v[88:91], v[160:163]
    ds_read_b128 v[32:35], v6 offset:0
    v_mfma_f32_16x16x32_bf16 v[164:167], v[116:119], v[88:91], v[164:167]
    ds_read_b128 v[36:39], v6 offset:1024
    v_mfma_f32_16x16x32_bf16 v[168:171], v[120:123], v[88:91], v[168:171]
    ds_read_b128 v[40:43], v6 offset:2048
    v_mfma_f32_16x16x32_bf16 v[172:175], v[124:127], v[88:91], v[172:175]
    ds_read_b128 v[44:47], v6 offset:3072
    v_mfma_f32_16x16x32_bf16 v[176:179], v[112:115], v[92:95], v[176:179]
    ds_read_b128 v[48:51], v6 offset:4096
    v_mfma_f32_16x16x32_bf16 v[180:183], v[116:119], v[92:95], v[180:183]
    ds_read_b128 v[52:55], v6 offset:5120
    v_mfma_f32_16x16x32_bf16 v[184:187], v[120:123], v[92:95], v[184:187]
    ds_read_b128 v[56:59], v6 offset:6144
    v_mfma_f32_16x16x32_bf16 v[188:191], v[124:127], v[92:95], v[188:191]
    ds_read_b128 v[60:63], v6 offset:7168
    v_mfma_f32_16x16x32_bf16 v[192:195], v[112:115], v[96:99], v[192:195]
    v_mfma_f32_16x16x32_bf16 v[196:199], v[116:119], v[96:99], v[196:199]
    s_add_u32 m0, s21, 32768
    s_nop 0
    buffer_load_dwordx4 v1, s[4:7], s16 offen sc1 lds
    s_add_u32 s16, s16, s62
    v_mfma_f32_16x16x32_bf16 v[200:203], v[120:123], v[96:99], v[200:203]
    v_mfma_f32_16x16x32_bf16 v[204:207], v[124:127], v[96:99], v[204:207]
    v_mfma_f32_16x16x32_bf16 v[208:211], v[112:115], v[100:103], v[208:211]
    s_add_u32 m0, s21, 33792
    s_nop 0
    buffer_load_dwordx4 v1, s[4:7], s17 offen sc1 lds
    s_add_u32 s17, s17, s62
    v_mfma_f32_16x16x32_bf16 v[212:215], v[116:119], v[100:103], v[212:215]
    v_mfma_f32_16x16x32_bf16 v[216:219], v[120:123], v[100:103], v[216:219]
    v_mfma_f32_16x16x32_bf16 v[220:223], v[124:127], v[100:103], v[220:223]
    s_add_u32 m0, s22, 32768
    s_nop 0
    buffer_load_dwordx4 v2, s[8:11], s18 offen lds
    s_add_u32 s18, s18, s20
    v_mfma_f32_16x16x32_bf16 v[224:227], v[112:115], v[104:107], v[224:227]
    v_mfma_f32_16x16x32_bf16 v[228:231], v[116:119], v[104:107], v[228:231]
    v_mfma_f32_16x16x32_bf16 v[232:235], v[120:123], v[104:107], v[232:235]
    s_add_u32 m0, s22, 40960
    s_nop 0
    buffer_load_dwordx4 v2, s[12:15], s19 offen lds
    s_add_u32 s19, s19, s20
    v_mfma_f32_16x16x32_bf16 v[236:239], v[124:127], v[104:107], v[236:239]
    v_mfma_f32_16x16x32_bf16 v[240:243], v[112:115], v[108:111], v[240:243]
    v_mfma_f32_16x16x32_bf16 v[244:247], v[116:119], v[108:111], v[244:247]
    v_mfma_f32_16x16x32_bf16 v[248:251], v[120:123], v[108:111], v[248:251]
    v_mfma_f32_16x16x32_bf16 v[252:255], v[124:127], v[108:111], v[252:255]
    s_waitcnt lgkmcnt(0)
    s_waitcnt vmcnt(12)
    s_barrier
    v_mfma_f32_16x16x32_bf16 v[128:131], v[64:67], v[32:35], v[128:131]
    ds_read_b64_tr_b16 v[112:113], v12 offset:49152
    v_mfma_f32_16x16x32_bf16 v[132:135], v[68:71], v[32:35], v[132:135]
    ds_read_b64_tr_b16 v[114:115], v13 offset:49152
    v_mfma_f32_16x16x32_bf16 v[136:139], v[72:75], v[32:35], v[136:139]
    ds_read_b64_tr_b16 v[116:117], v14 offset:49152
    v_mfma_f32_16x16x32_bf16 v[140:143], v[76:79], v[32:35], v[140:143]
    ds_read_b64_tr_b16 v[118:119], v15 offset:49152
    v_mfma_f32_16x16x32_bf16 v[144:147], v[64:67], v[36:39], v[144:147]
    ds_read_b64_tr_b16 v[120:121], v12 offset:57344
    v_mfma_f32_16x16x32_bf16 v[148:151], v[68:71], v[36:39], v[148:151]
    ds_read_b64_tr_b16 v[122:123], v13 offset:57344
    v_mfma_f32_16x16x32_bf16 v[152:155], v[72:75], v[36:39], v[152:155]
    ds_read_b64_tr_b16 v[124:125], v14 offset:57344
    v_mfma_f32_16x16x32_bf16 v[156:159], v[76:79], v[36:39], v[156:159]
    ds_read_b64_tr_b16 v[126:127], v15 offset:57344
    v_mfma_f32_16x16x32_bf16 v[160:163], v[64:67], v[40:43], v[160:163]
    ds_read_b128 v[80:83], v6 offset:32768
    v_mfma_f32_16x16x32_bf16 v[164:167], v[68:71], v[40:43], v[164:167]
    ds_read_b128 v[84:87], v6 offset:33792
    v_mfma_f32_16x16x32_bf16 v[168:171], v[72:75], v[40:43], v[168:171]
    ds_read_b128 v[88:91], v6 offset:34816
    v_mfma_f32_16x16x32_bf16 v[172:175], v[76:79], v[40:43], v[172:175]
    ds_read_b128 v[92:95], v6 offset:35840
    v_mfma_f32_16x16x32_bf16 v[176:179], v[64:67], v[44:47], v[176:179]
    ds_read_b128 v[96:99], v6 offset:36864
    v_mfma_f32_16x16x32_bf16 v[180:183], v[68:71], v[44:47], v[180:183]
    ds_read_b128 v[100:103], v6 offset:37888
    v_mfma_f32_16x16x32_bf16 v[184:187], v[72:75], v[44:47], v[184:187]
    ds_read_b128 v[104:107], v6 offset:38912
    v_mfma_f32_16x16x32_bf16 v[188:191], v[76:79], v[44:47], v[188:191]
    ds_read_b128 v[108:111], v6 offset:39936
    v_mfma_f32_16x16x32_bf16 v[192:195], v[64:67], v[48:51], v[192:195]
    v_mfma_f32_16x16x32_bf16 v[196:199], v[68:71], v[48:51], v[196:199]
    s_add_u32 m0, s21, 65536
    s_nop 0
    buffer_load_dwordx4 v1, s[4:7], s16 offen sc1 lds
    s_add_u32 s16, s16, s62
    v_mfma_f32_16x16x32_bf16 v[200:203], v[72:75], v[48:51], v[200:203]
    v_mfma_f32_16x16x32_bf16 v[204:207], v[76:79], v[48:51], v[204:207]
    v_mfma_f32_16x16x32_bf16 v[208:211], v[64:67], v[52:55], v[208:211]
    s_add_u32 m0, s21, 66560
    s_nop 0
    buffer_load_dwordx4 v1, s[4:7], s17 offen sc1 lds
    s_add_u32 s17, s17, s62
    v_mfma_f32_16x16x32_bf16 v[212:215], v[68:71], v[52:55], v[212:215]
    v_mfma_f32_16x16x32_bf16 v[216:219], v[72:75], v[52:55], v[216:219]
    v_mfma_f32_16x16x32_bf16 v[220:223], v[76:79], v[52:55], v[220:223]
    s_add_u32 m0, s22, 65536
    s_nop 0
    buffer_load_dwordx4 v2, s[8:11], s18 offen lds
    s_add_u32 s18, s18, s20
    v_mfma_f32_16x16x32_bf16 v[224:227], v[64:67], v[56:59], v[224:227]
    v_mfma_f32_16x16x32_bf16 v[228:231], v[68:71], v[56:59], v[228:231]
    v_mfma_f32_16x16x32_bf16 v[232:235], v[72:75], v[56:59], v[232:235]
    s_add_u32 m0, s22, 73728
    s_nop 0
    buffer_load_dwordx4 v2, s[12:15], s19 offen lds
    s_add_u32 s19, s19, s20
    v_mfma_f32_16x16x32_bf16 v[236:239], v[76:79], v[56:59], v[236:239]
    v_mfma_f32_16x16x32_bf16 v[240:243], v[64:67], v[60:63], v[240:243]
    v_mfma_f32_16x16x32_bf16 v[244:247], v[68:71], v[60:63], v[244:247]
    v_mfma_f32_16x16x32_bf16 v[248:251], v[72:75], v[60:63], v[248:251]
    v_mfma_f32_16x16x32_bf16 v[252:255], v[76:79], v[60:63], v[252:255]
    s_waitcnt lgkmcnt(0)
    s_waitcnt vmcnt(8)
    s_barrier
    s_cmp_eq_u32 s28, 0
    s_cbranch_scc1 sig_2
    s_cmp_lg_u32 s3, 0
    s_cbranch_scc1 sig_2
    s_mov_b64 exec, 1
    v_mov_b32 v18, s57
    buffer_atomic_add v18, v17, s[4:7], s28 offen sc1
    s_mov_b64 exec, -1
sig_2:
    s_mov_b32 s28, 0
    v_mfma_f32_16x16x32_bf16 v[128:131], v[112:115], v[80:83], v[128:131]
    ds_read_b64_tr_b16 v[64:65], v8 offset:16384
    v_mfma_f32_16x16x32_bf16 v[132:135], v[116:119], v[80:83], v[132:135]
    ds_read_b64_tr_b16 v[66:67], v9 offset:16384
    v_mfma_f32_16x16x32_bf16 v[136:139], v[120:123], v[80:83], v[136:139]
    ds_read_b64_tr_b16 v[68:69], v10 offset:16384
    v_mfma_f32_16x16x32_bf16 v[140:143], v[124:127], v[80:83], v[140:143]
    ds_read_b64_tr_b16 v[70:71], v11 offset:16384
    v_mfma_f32_16x16x32_bf16 v[144:147], v[112:115], v[84:87], v[144:147]
    ds_read_b64_tr_b16 v[72:73], v8 offset:24576
    v_mfma_f32_16x16x32_bf16 v[148:151], v[116:119], v[84:87], v[148:151]
    ds_read_b64_tr_b16 v[74:75], v9 offset:24576
    v_mfma_f32_16x16x32_bf16 v[152:155], v[120:123], v[84:87], v[152:155]
    ds_read_b64_tr_b16 v[76:77], v10 offset:24576
    v_mfma_f32_16x16x32_bf16 v[156:159], v[124:127], v[84:87], v[156:159]
    ds_read_b64_tr_b16 v[78:79], v11 offset:24576
    v_mfma_f32_16x16x32_bf16 v[160:163], v[112:115], v[88:91], v[160:163]
    ds_read_b128 v[32:35], v5 offset:0
    v_mfma_f32_16x16x32_bf16 v[164:167], v[116:119], v[88:91], v[164:167]
    ds_read_b128 v[36:39], v5 offset:1024
    v_mfma_f32_16x16x32_bf16 v[168:171], v[120:123], v[88:91], v[168:171]
    ds_read_b128 v[40:43], v5 offset:2048
    v_mfma_f32_16x16x32_bf16 v[172:175], v[124:127], v[88:91], v[172:175]
    ds_read_b128 v[44:47], v5 offset:3072
    v_mfma_f32_16x16x32_bf16 v[176:179], v[112:115], v[92:95], v[176:179]
    ds_read_b128 v[48:51], v5 offset:4096
    v_mfma_f32_16x16x32_bf16 v[180:183], v[116:119], v[92:95], v[180:183]
    ds_read_b128 v[52:55], v5 offset:5120
    v_mfma_f32_16x16x32_bf16 v[184:187], v[120:123], v[92:95], v[184:187]
    ds_read_b128 v[56:59], v5 offset:6144
    v_mfma_f32_16x16x32_bf16 v[188:191], v[124:127], v[92:95], v[188:191]
    ds_read_b128 v[60:63], v5 offset:7168
    v_mfma_f32_16x16x32_bf16 v[192:195], v[112:115], v[96:99], v[192:195]
    v_mfma_f32_16x16x32_bf16 v[196:199], v[116:119], v[96:99], v[196:199]
    s_add_u32 m0, s21, 98304
    s_nop 0
    buffer_load_dwordx4 v1, s[4:7], s16 offen sc1 lds
    s_add_u32 s16, s16, s62
    v_mfma_f32_16x16x32_bf16 v[200:203], v[120:123], v[96:99], v[200:203]
    v_mfma_f32_16x16x32_bf16 v[204:207], v[124:127], v[96:99], v[204:207]
    v_mfma_f32_16x16x32_bf16 v[208:211], v[112:115], v[100:103], v[208:211]
    s_add_u32 m0, s21, 99328
    s_nop 0
    buffer_load_dwordx4 v1, s[4:7], s17 offen sc1 lds
    s_add_u32 s17, s17, s62
    v_mfma_f32_16x16x32_bf16 v[212:215], v[116:119], v[100:103], v[212:215]
    v_mfma_f32_16x16x32_bf16 v[216:219], v[120:123], v[100:103], v[216:219]
    v_mfma_f32_16x16x32_bf16 v[220:223], v[124:127], v[100:103], v[220:223]
    s_add_u32 m0, s22, 98304
    s_nop 0
    buffer_load_dwordx4 v2, s[8:11], s18 offen lds
    s_add_u32 s18, s18, s20
    v_mfma_f32_16x16x32_bf16 v[224:227], v[112:115], v[104:107], v[224:227]
    v_mfma_f32_16x16x32_bf16 v[228:231], v[116:119], v[104:107], v[228:231]
    v_mfma_f32_16x16x32_bf16 v[232:235], v[120:123], v[104:107], v[232:235]
    s_add_u32 m0, s22, 106496
    s_nop 0
    buffer_load_dwordx4 v2, s[12:15], s19 offen lds
    s_add_u32 s19, s19, s20
    v_mfma_f32_16x16x32_bf16 v[236:239], v[124:127], v[104:107], v[236:239]
    v_mfma_f32_16x16x32_bf16 v[240:243], v[112:115], v[108:111], v[240:243]
    v_mfma_f32_16x16x32_bf16 v[244:247], v[116:119], v[108:111], v[244:247]
    v_mfma_f32_16x16x32_bf16 v[248:251], v[120:123], v[108:111], v[248:251]
    v_mfma_f32_16x16x32_bf16 v[252:255], v[124:127], v[108:111], v[252:255]
    s_waitcnt lgkmcnt(0)
    s_branch w_loop_chk
w_first8:
    s_waitcnt vmcnt(16)
    s_barrier
    v_mfma_f32_16x16x32_bf16 v[128:131], v[64:67], v[32:35], 0
    ds_read_b64_tr_b16 v[112:113], v8 offset:49152
    v_mfma_f32_16x16x32_bf16 v[132:135], v[68:71], v[32:35], 0
    ds_read_b64_tr_b16 v[114:115], v9 offset:49152
    v_mfma_f32_16x16x32_bf16 v[136:139], v[72:75], v[32:35], 0
    ds_read_b64_tr_b16 v[116:117], v10 offset:49152
    v_mfma_f32_16x16x32_bf16 v[140:143], v[76:79], v[32:35], 0
    ds_read_b64_tr_b16 v[118:119], v11 offset:49152
    v_mfma_f32_16x16x32_bf16 v[144:147], v[64:67], v[36:39], 0
    ds_read_b64_tr_b16 v[120:121], v8 offset:57344
    v_mfma_f32_16x16x32_bf16 v[148:151], v[68:71], v[36:39], 0
    ds_read_b64_tr_b16 v[122:123], v9 offset:57344
    v_mfma_f32_16x16x32_bf16 v[152:155], v[72:75], v[36:39], 0
    ds_read_b64_tr_b16 v[124:125], v10 offset:57344
    v_mfma_f32_16x16x32_bf16 v[156:159], v[76:79], v[36:39], 0
    ds_read_b64_tr_b16 v[126:127], v11 offset:57344
    v_mfma_f32_16x16x32_bf16 v[160:163], v[64:67], v[40:43], 0
    ds_read_b128 v[80:83], v5 offset:32768
    v_mfma_f32_16x16x32_bf16 v[164:167], v[68:71], v[40:43], 0
    ds_read_b128 v[84:87], v5 offset:33792
    v_mfma_f32_16x16x32_bf16 v[168:171], v[72:75], v[40:43], 0
    ds_read_b128 v[88:91], v5 offset:34816
    v_mfma_f32_16x16x32_bf16 v[172:175], v[76:79], v[40:43], 0
    ds_read_b128 v[92:95], v5 offset:35840
    v_mfma_f32_16x16x32_bf16 v[176:179], v[64:67], v[44:47], 0
    ds_read_b128 v[96:99], v5 offset:36864
    v_mfma_f32_16x16x32_bf16 v[180:183], v[68:71], v[44:47], 0
    ds_read_b128 v[100:103], v5 offset:37888
    v_mfma_f32_16x16x32_bf16 v[184:187], v[72:75], v[44:47], 0
    ds_read_b128 v[104:107], v5 offset:38912
    v_mfma_f32_16x16x32_bf16 v[188:191], v[76:79], v[44:47], 0
    ds_read_b128 v[108:111], v5 offset:39936
    v_mfma_f32_16x16x32_bf16 v[192:195], v[64:67], v[48:51], 0
    v_mfma_f32_16x16x32_bf16 v[196:199], v[68:71], v[48:51], 0
    s_add_u32 m0, s21, 0
    s_nop 0
    buffer_load_dwordx4 v1, s[4:7], s16 offen sc1 lds
    s_add_u32 s16, s16, s62
    v_mfma_f32_16x16x32_bf16 v[200:203], v[72:75], v[48:51], 0
    v_mfma_f32_16x16x32_bf16 v[204:207], v[76:79], v[48:51], 0
    v_mfma_f32_16x16x32_bf16 v[208:211], v[64:67], v[52:55], 0
    s_add_u32 m0, s21, 1024
    s_nop 0
    buffer_load_dwordx4 v1, s[4:7], s17 offen sc1 lds
    s_add_u32 s17, s17, s62
    v_mfma_f32_16x16x32_bf16 v[212:215], v[68:71], v[52:55], 0
    v_mfma_f32_16x16x32_bf16 v[216:219], v[72:75], v[52:55], 0
    v_mfma_f32_16x16x32_bf16 v[220:223], v[76:79], v[52:55], 0
    s_add_u32 m0, s22, 0
    s_nop 0
    buffer_load_dwordx4 v2, s[8:11], s18 offen lds
    s_add_u32 s18, s18, s20
    v_mfma_f32_16x16x32_bf16 v[224:227], v[64:67], v[56:59], 0
    v_mfma_f32_16x16x32_bf16 v[228:231], v[68:71], v[56:59], 0
    v_mfma_f32_16x16x32_bf16 v[232:235], v[72:75], v[56:59], 0
    s_add_u32 m0, s22, 8192
    s_nop 0
    buffer_load_dwordx4 v2, s[12:15], s19 offen lds
    s_add_u32 s19, s19, s20
    v_mfma_f32_16x16x32_bf16 v[236:239], v[76:79], v[56:59], 0
    v_mfma_f32_16x16x32_bf16 v[240:243], v[64:67], v[60:63], 0
    v_mfma_f32_16x16x32_bf16 v[244:247], v[68:71], v[60:63], 0
    v_mfma_f32_16x16x32_bf16 v[248:251], v[72:75], v[60:63], 0
    v_mfma_f32_16x16x32_bf16 v[252:255], v[76:79], v[60:63], 0
    s_waitcnt lgkmcnt(0)
    s_waitcnt vmcnt(16)
    s_barrier
    v_mfma_f32_16x16x32_bf16 v[128:131], v[112:115], v[80:83], v[128:131]
    ds_read_b64_tr_b16 v[64:65], v12 offset:16384
    v_mfma_f32_16x16x32_bf16 v[132:135], v[116:119], v[80:83], v[132:135]
    ds_read_b64_tr_b16 v[66:67], v13 offset:16384
    v_mfma_f32_16x16x32_bf16 v[136:139], v[120:123], v[80:83], v[136:139]
    ds_read_b64_tr_b16 v[68:69], v14 offset:16384
    v_mfma_f32_16x16x32_bf16 v[140:143], v[124:127], v[80:83], v[140:143]
    ds_read_b64_tr_b16 v[70:71], v15 offset:16384
    v_mfma_f32_16x16x32_bf16 v[144:147], v[112:115], v[84:87], v[144:147]
    ds_read_b64_tr_b16 v[72:73], v12 offset:24576
    v_mfma_f32_16x16x32_bf16 v[148:151], v[116:119], v[84:87], v[148:151]
    ds_read_b64_tr_b16 v[74:75], v13 offset:24576
    v_mfma_f32_16x16x32_bf16 v[152:155], v[120:123], v[84:87], v[152:155]
    ds_read_b64_tr_b16 v[76:77], v14 offset:24576
    v_mfma_f32_16x16x32_bf16 v[156:159], v[124:127], v[84:87], v[156:159]
    ds_read_b64_tr_b16 v[78:79], v15 offset:24576
    v_mfma_f32_16x16x32_bf16 v[160:163], v[112:115], v[88:91], v[160:163]
    ds_read_b128 v[32:35], v6 offset:0
    v_mfma_f32_16x16x32_bf16 v[164:167], v[116:119], v[88:91], v[164:167]
    ds_read_b128 v[36:39], v6 offset:1024
    v_mfma_f32_16x16x32_bf16 v[168:171], v[120:123], v[88:91], v[168:171]
    ds_read_b128 v[40:43], v6 offset:2048
    v_mfma_f32_16x16x32_bf16 v[172:175], v[124:127], v[88:91], v[172:175]
    ds_read_b128 v[44:47], v6 offset:3072
    v_mfma_f32_16x16x32_bf16 v[176:179], v[112:115], v[92:95], v[176:179]
    ds_read_b128 v[48:51], v6 offset:4096
    v_mfma_f32_16x16x32_bf16 v[180:183], v[116:119], v[92:95], v[180:183]
    ds_read_b128 v[52:55], v6 offset:5120
    v_mfma_f32_16x16x32_bf16 v[184:187], v[120:123], v[92:95], v[184:187]
    ds_read_b128 v[56:59], v6 offset:6144
    v_mfma_f32_16x16x32_bf16 v[188:191], v[124:127], v[92:95], v[188:191]
    ds_read_b128 v[60:63], v6 offset:7168
    v_mfma_f32_16x16x32_bf16 v[192:195], v[112:115], v[96:99], v[192:195]
    v_mfma_f32_16x16x32_bf16 v[196:199], v[116:119], v[96:99], v[196:199]
    s_add_u32 m0, s21, 32768
    s_nop 0
    buffer_load_dwordx4 v1, s[4:7], s16 offen sc1 lds
    s_add_u32 s16, s16, s62
    v_mfma_f32_16x16x32_bf16 v[200:203], v[120:123], v[96:99], v[200:203]
    v_mfma_f32_16x16x32_bf16 v[204:207], v[124:127], v[96:99], v[204:207]
    v_mfma_f32_16x16x32_bf16 v[208:211], v[112:115], v[100:103], v[208:211]
    s_add_u32 m0, s21, 33792
    s_nop 0
    buffer_load_dwordx4 v1, s[4:7], s17 offen sc1 lds
    s_add_u32 s17, s17, s62
    v_mfma_f32_16x16x32_bf16 v[212:215], v[116:119], v[100:103], v[212:215]
    v_mfma_f32_16x16x32_bf16 v[216:219], v[120:123], v[100:103], v[216:219]
    v_mfma_f32_16x16x32_bf16 v[220:223], v[124:127], v[100:103], v[220:223]
    s_add_u32 m0, s22, 32768
    s_nop 0
    buffer_load_dwordx4 v2, s[8:11], s18 offen lds
    s_add_u32 s18, s18, s20
    v_mfma_f32_16x16x32_bf16 v[224:227], v[112:115], v[104:107], v[224:227]
    v_mfma_f32_16x16x32_bf16 v[228:231], v[116:119], v[104:107], v[228:231]
    v_mfma_f32_16x16x32_bf16 v[232:235], v[120:123], v[104:107], v[232:235]
    s_add_u32 m0, s22, 40960
    s_nop 0
    buffer_load_dwordx4 v2, s[12:15], s19 offen lds
    s_add_u32 s19, s19, s20
    v_mfma_f32_16x16x32_bf16 v[236:239], v[124:127], v[104:107], v[236:239]
    v_mfma_f32_16x16x32_bf16 v[240:243], v[112:115], v[108:111], v[240:243]
    v_mfma_f32_16x16x32_bf16 v[244:247], v[116:119], v[108:111], v[244:247]
    v_mfma_f32_16x16x32_bf16 v[248:251], v[120:123], v[108:111], v[248:251]
    v_mfma_f32_16x16x32_bf16 v[252:255], v[124:127], v[108:111], v[252:255]
    s_waitcnt lgkmcnt(0)
    s_waitcnt vmcnt(16)
    s_barrier
    v_mfma_f32_16x16x32_bf16 v[128:131], v[64:67], v[32:35], v[128:131]
    ds_read_b64_tr_b16 v[112:113], v12 offset:49152
    v_mfma_f32_16x16x32_bf16 v[132:135], v[68:71], v[32:35], v[132:135]
    ds_read_b64_tr_b16 v[114:115], v13 offset:49152
    v_mfma_f32_16x16x32_bf16 v[136:139], v[72:75], v[32:35], v[136:139]
    ds_read_b64_tr_b16 v[116:117], v14 offset:49152
    v_mfma_f32_16x16x32_bf16 v[140:143], v[76:79], v[32:35], v[140:143]
    ds_read_b64_tr_b16 v[118:119], v15 offset:49152
    v_mfma_f32_16x16x32_bf16 v[144:147], v[64:67], v[36:39], v[144:147]
    ds_read_b64_tr_b16 v[120:121], v12 offset:57344
    v_mfma_f32_16x16x32_bf16 v[148:151], v[68:71], v[36:39], v[148:151]
    ds_read_b64_tr_b16 v[122:123], v13 offset:57344
    v_mfma_f32_16x16x32_bf16 v[152:155], v[72:75], v[36:39], v[152:155]
    ds_read_b64_tr_b16 v[124:125], v14 offset:57344
    v_mfma_f32_16x16x32_bf16 v[156:159], v[76:79], v[36:39], v[156:159]
    ds_read_b64_tr_b16 v[126:127], v15 offset:57344
    v_mfma_f32_16x16x32_bf16 v[160:163], v[64:67], v[40:43], v[160:163]
    ds_read_b128 v[80:83], v6 offset:32768
    v_mfma_f32_16x16x32_bf16 v[164:167], v[68:71], v[40:43], v[164:167]
    ds_read_b128 v[84:87], v6 offset:33792
    v_mfma_f32_16x16x32_bf16 v[168:171], v[72:75], v[40:43], v[168:171]
    ds_read_b128 v[88:91], v6 offset:34816
    v_mfma_f32_16x16x32_bf16 v[172:175], v[76:79], v[40:43], v[172:175]
    ds_read_b128 v[92:95], v6 offset:35840
    v_mfma_f32_16x16x32_bf16 v[176:179], v[64:67], v[44:47], v[176:179]
    ds_read_b128 v[96:99], v6 offset:36864
    v_mfma_f32_16x16x32_bf16 v[180:183], v[68:71], v[44:47], v[180:183]
    ds_read_b128 v[100:103], v6 offset:37888
    v_mfma_f32_16x16x32_bf16 v[184:187], v[72:75], v[44:47], v[184:187]
    ds_read_b128 v[104:107], v6 offset:38912
    v_mfma_f32_16x16x32_bf16 v[188:191], v[76:79], v[44:47], v[188:191]
    ds_read_b128 v[108:111], v6 offset:39936
    v_mfma_f32_16x16x32_bf16 v[192:195], v[64:67], v[48:51], v[192:195]
    v_mfma_f32_16x16x32_bf16 v[196:199], v[68:71], v[48:51], v[196:199]
    s_add_u32 m0, s21, 65536
    s_nop 0
    buffer_load_dwordx4 v1, s[4:7], s16 offen sc1 lds
    s_add_u32 s16, s16, s62
    v_mfma_f32_16x16x32_bf16 v[200:203], v[72:75], v[48:51], v[200:203]
    v_mfma_f32_16x16x32_bf16 v[204:207], v[76:79], v[48:51], v[204:207]
    v_mfma_f32_16x16x32_bf16 v[208:211], v[64:67], v[52:55], v[208:211]
    s_add_u32 m0, s21, 66560
    s_nop 0
    buffer_load_dwordx4 v1, s[4:7], s17 offen sc1 lds
    s_add_u32 s17, s17, s62
    v_mfma_f32_16x16x32_bf16 v[212:215], v[68:71], v[52:55], v[212:215]
    v_mfma_f32_16x16x32_bf16 v[216:219], v[72:75], v[52:55], v[216:219]
    v_mfma_f32_16x16x32_bf16 v[220:223], v[76:79], v[52:55], v[220:223]
    s_add_u32 m0, s22, 65536
    s_nop 0
    buffer_load_dwordx4 v2, s[8:11], s18 offen lds
    s_add_u32 s18, s18, s20
    v_mfma_f32_16x16x32_bf16 v[224:227], v[64:67], v[56:59], v[224:227]
    v_mfma_f32_16x16x32_bf16 v[228:231], v[68:71], v[56:59], v[228:231]
    v_mfma_f32_16x16x32_bf16 v[232:235], v[72:75], v[56:59], v[232:235]
    s_add_u32 m0, s22, 73728
    s_nop 0
    buffer_load_dwordx4 v2, s[12:15], s19 offen lds
    s_add_u32 s19, s19, s20
    v_mfma_f32_16x16x32_bf16 v[236:239], v[76:79], v[56:59], v[236:239]
    v_mfma_f32_16x16x32_bf16 v[240:243], v[64:67], v[60:63], v[240:243]
    v_mfma_f32_16x16x32_bf16 v[244:247], v[68:71], v[60:63], v[244:247]
    v_mfma_f32_16x16x32_bf16 v[248:251], v[72:75], v[60:63], v[248:251]
    v_mfma_f32_16x16x32_bf16 v[252:255], v[76:79], v[60:63], v[252:255]
    s_waitcnt lgkmcnt(0)
    s_waitcnt vmcnt(8)
    s_barrier
    s_cmp_eq_u32 s28, 0
    s_cbranch_scc1 sig_3
    s_cmp_lg_u32 s3, 0
    s_cbranch_scc1 sig_3
    s_mov_b64 exec, 1
    v_mov_b32 v18, s57
    buffer_atomic_add v18, v17, s[4:7], s28 offen sc1
    s_mov_b64 exec, -1
sig_3:
    s_mov_b32 s28, 0
    v_mfma_f32_16x16x32_bf16 v[128:131], v[112:115], v[80:83], v[128:131]
    ds_read_b64_tr_b16 v[64:65], v8 offset:16384
    v_mfma_f32_16x16x32_bf16 v[132:135], v[116:119], v[80:83], v[132:135]
    ds_read_b64_tr_b16 v[66:67], v9 offset:16384
    v_mfma_f32_16x16x32_bf16 v[136:139], v[120:123], v[80:83], v[136:139]
    ds_read_b64_tr_b16 v[68:69], v10 offset:16384
    v_mfma_f32_16x16x32_bf16 v[140:143], v[124:127], v[80:83], v[140:143]
    ds_read_b64_tr_b16 v[70:71], v11 offset:16384
    v_mfma_f32_16x16x32_bf16 v[144:147], v[112:115], v[84:87], v[144:147]
    ds_read_b64_tr_b16 v[72:73], v8 offset:24576
    v_mfma_f32_16x16x32_bf16 v[148:151], v[116:119], v[84:87], v[148:151]
    ds_read_b64_tr_b16 v[74:75], v9 offset:24576
    v_mfma_f32_16x16x32_bf16 v[152:155], v[120:123], v[84:87], v[152:155]
    ds_read_b64_tr_b16 v[76:77], v10 offset:24576
    v_mfma_f32_16x16x32_bf16 v[156:159], v[124:127], v[84:87], v[156:159]
    ds_read_b64_tr_b16 v[78:79], v11 offset:24576
    v_mfma_f32_16x16x32_bf16 v[160:163], v[112:115], v[88:91], v[160:163]
    ds_read_b128 v[32:35], v5 offset:0
    v_mfma_f32_16x16x32_bf16 v[164:167], v[116:119], v[88:91], v[164:167]
    ds_read_b128 v[36:39], v5 offset:1024
    v_mfma_f32_16x16x32_bf16 v[168:171], v[120:123], v[88:91], v[168:171]
    ds_read_b128 v[40:43], v5 offset:2048
    v_mfma_f32_16x16x32_bf16 v[172:175], v[124:127], v[88:91], v[172:175]
    ds_read_b128 v[44:47], v5 offset:3072
    v_mfma_f32_16x16x32_bf16 v[176:179], v[112:115], v[92:95], v[176:179]
    ds_read_b128 v[48:51], v5 offset:4096
    v_mfma_f32_16x16x32_bf16 v[180:183], v[116:119], v[92:95], v[180:183]
    ds_read_b128 v[52:55], v5 offset:5120
    v_mfma_f32_16x16x32_bf16 v[184:187], v[120:123], v[92:95], v[184:187]
    ds_read_b128 v[56:59], v5 offset:6144
    v_mfma_f32_16x16x32_bf16 v[188:191], v[124:127], v[92:95], v[188:191]
    ds_read_b128 v[60:63], v5 offset:7168
    v_mfma_f32_16x16x32_bf16 v[192:195], v[112:115], v[96:99], v[192:195]
    v_mfma_f32_16x16x32_bf16 v[196:199], v[116:119], v[96:99], v[196:199]
    s_add_u32 m0, s21, 98304
    s_nop 0
    buffer_load_dwordx4 v1, s[4:7], s16 offen sc1 lds
    s_add_u32 s16, s16, s62
    v_mfma_f32_16x16x32_bf16 v[200:203], v[120:123], v[96:99], v[200:203]
    v_mfma_f32_16x16x32_bf16 v[204:207], v[124:127], v[96:99], v[204:207]
    v_mfma_f32_16x16x32_bf16 v[208:211], v[112:115], v[100:103], v[208:211]
    s_add_u32 m0, s21, 99328
    s_nop 0
    buffer_load_dwordx4 v1, s[4:7], s17 offen sc1 lds
    s_add_u32 s17, s17, s62
    v_mfma_f32_16x16x32_bf16 v[212:215], v[116:119], v[100:103], v[212:215]
    v_mfma_f32_16x16x32_bf16 v[216:219], v[120:123], v[100:103], v[216:219]
    v_mfma_f32_16x16x32_bf16 v[220:223], v[124:127], v[100:103], v[220:223]
    s_add_u32 m0, s22, 98304
    s_nop 0
    buffer_load_dwordx4 v2, s[8:11], s18 offen lds
    s_add_u32 s18, s18, s20
    v_mfma_f32_16x16x32_bf16 v[224:227], v[112:115], v[104:107], v[224:227]
    v_mfma_f32_16x16x32_bf16 v[228:231], v[116:119], v[104:107], v[228:231]
    v_mfma_f32_16x16x32_bf16 v[232:235], v[120:123], v[104:107], v[232:235]
    s_add_u32 m0, s22, 106496
    s_nop 0
    buffer_load_dwordx4 v2, s[12:15], s19 offen lds
    s_add_u32 s19, s19, s20
    v_mfma_f32_16x16x32_bf16 v[236:239], v[124:127], v[104:107], v[236:239]
    v_mfma_f32_16x16x32_bf16 v[240:243], v[112:115], v[108:111], v[240:243]
    v_mfma_f32_16x16x32_bf16 v[244:247], v[116:119], v[108:111], v[244:247]
    v_mfma_f32_16x16x32_bf16 v[248:251], v[120:123], v[108:111], v[248:251]
    v_mfma_f32_16x16x32_bf16 v[252:255], v[124:127], v[108:111], v[252:255]
    s_waitcnt lgkmcnt(0)
    s_branch w_loop_chk
w_first16:
    s_waitcnt vmcnt(24)
    s_barrier
    v_mfma_f32_16x16x32_bf16 v[128:131], v[64:67], v[32:35], 0
    ds_read_b64_tr_b16 v[112:113], v8 offset:49152
    v_mfma_f32_16x16x32_bf16 v[132:135], v[68:71], v[32:35], 0
    ds_read_b64_tr_b16 v[114:115], v9 offset:49152
    v_mfma_f32_16x16x32_bf16 v[136:139], v[72:75], v[32:35], 0
    ds_read_b64_tr_b16 v[116:117], v10 offset:49152
    v_mfma_f32_16x16x32_bf16 v[140:143], v[76:79], v[32:35], 0
    ds_read_b64_tr_b16 v[118:119], v11 offset:49152
    v_mfma_f32_16x16x32_bf16 v[144:147], v[64:67], v[36:39], 0
    ds_read_b64_tr_b16 v[120:121], v8 offset:57344
    v_mfma_f32_16x16x32_bf16 v[148:151], v[68:71], v[36:39], 0
    ds_read_b64_tr_b16 v[122:123], v9 offset:57344
    v_mfma_f32_16x16x32_bf16 v[152:155], v[72:75], v[36:39], 0
    ds_read_b64_tr_b16 v[124:125], v10 offset:57344
    v_mfma_f32_16x16x32_bf16 v[156:159], v[76:79], v[36:39], 0
    ds_read_b64_tr_b16 v[126:127], v11 offset:57344
    v_mfma_f32_16x16x32_bf16 v[160:163], v[64:67], v[40:43], 0
    ds_read_b128 v[80:83], v5 offset:32768
    v_mfma_f32_16x16x32_bf16 v[164:167], v[68:71], v[40:43], 0
    ds_read_b128 v[84:87], v5 offset:33792
    v_mfma_f32_16x16x32_bf16 v[168:171], v[72:75], v[40:43], 0
    ds_read_b128 v[88:91], v5 offset:34816
    v_mfma_f32_16x16x32_bf16 v[172:175], v[76:79], v[40:43], 0
    ds_read_b128 v[92:95], v5 offset:35840
    v_mfma_f32_16x16x32_bf16 v[176:179], v[64:67], v[44:47], 0
    ds_read_b128 v[96:99], v5 offset:36864
    v_mfma_f32_16x16x32_bf16 v[180:183], v[68:71], v[44:47], 0
    ds_read_b128 v[100:103], v5 offset:37888
    v_mfma_f32_16x16x32_bf16 v[184:187], v[72:75], v[44:47], 0
    ds_read_b128 v[104:107], v5 offset:38912
    v_mfma_f32_16x16x32_bf16 v[188:191], v[76:79], v[44:47], 0
    ds_read_b128 v[108:111], v5 offset:39936
    v_mfma_f32_16x16x32_bf16 v[192:195], v[64:67], v[48:51], 0
    v_mfma_f32_16x16x32_bf16 v[196:199], v[68:71], v[48:51], 0
    s_add_u32 m0, s21, 0
    s_nop 0
    buffer_load_dwordx4 v1, s[4:7], s16 offen sc1 lds
    s_add_u32 s16, s16, s62
    v_mfma_f32_16x16x32_bf16 v[200:203], v[72:75], v[48:51], 0
    v_mfma_f32_16x16x32_bf16 v[204:207], v[76:79], v[48:51], 0
    v_mfma_f32_16x16x32_bf16 v[208:211], v[64:67], v[52:55], 0
    s_add_u32 m0, s21, 1024
    s_nop 0
    buffer_load_dwordx4 v1, s[4:7], s17 offen sc1 lds
    s_add_u32 s17, s17, s62
    v_mfma_f32_16x16x32_bf16 v[212:215], v[68:71], v[52:55], 0
    v_mfma_f32_16x16x32_bf16 v[216:219], v[72:75], v[52:55], 0
    v_mfma_f32_16x16x32_bf16 v[220:223], v[76:79], v[52:55], 0
    s_add_u32 m0, s22, 0
    s_nop 0
    buffer_load_dwordx4 v2, s[8:11], s18 offen lds
    s_add_u32 s18, s18, s20
    v_mfma_f32_16x16x32_bf16 v[224:227], v[64:67], v[56:59], 0
    v_mfma_f32_16x16x32_bf16 v[228:231], v[68:71], v[56:59], 0
    v_mfma_f32_16x16x32_bf16 v[232:235], v[72:75], v[56:59], 0
    s_add_u32 m0, s22, 8192
    s_nop 0
    buffer_load_dwordx4 v2, s[12:15], s19 offen lds
    s_add_u32 s19, s19, s20
    v_mfma_f32_16x16x32_bf16 v[236:239], v[76:79], v[56:59], 0
    v_mfma_f32_16x16x32_bf16 v[240:243], v[64:67], v[60:63], 0
    v_mfma_f32_16x16x32_bf16 v[244:247], v[68:71], v[60:63], 0
    v_mfma_f32_16x16x32_bf16 v[248:251], v[72:75], v[60:63], 0
    v_mfma_f32_16x16x32_bf16 v[252:255], v[76:79], v[60:63], 0
    s_waitcnt lgkmcnt(0)
    s_waitcnt vmcnt(24)
    s_barrier
    v_mfma_f32_16x16x32_bf16 v[128:131], v[112:115], v[80:83], v[128:131]
    ds_read_b64_tr_b16 v[64:65], v12 offset:16384
    v_mfma_f32_16x16x32_bf16 v[132:135], v[116:119], v[80:83], v[132:135]
    ds_read_b64_tr_b16 v[66:67], v13 offset:16384
    v_mfma_f32_16x16x32_bf16 v[136:139], v[120:123], v[80:83], v[136:139]
    ds_read_b64_tr_b16 v[68:69], v14 offset:16384
    v_mfma_f32_16x16x32_bf16 v[140:143], v[124:127], v[80:83], v[140:143]
    ds_read_b64_tr_b16 v[70:71], v15 offset:16384
    v_mfma_f32_16x16x32_bf16 v[144:147], v[112:115], v[84:87], v[144:147]
    ds_read_b64_tr_b16 v[72:73], v12 offset:24576
    v_mfma_f32_16x16x32_bf16 v[148:151], v[116:119], v[84:87], v[148:151]
    ds_read_b64_tr_b16 v[74:75], v13 offset:24576
    v_mfma_f32_16x16x32_bf16 v[152:155], v[120:123], v[84:87], v[152:155]
    ds_read_b64_tr_b16 v[76:77], v14 offset:24576
    v_mfma_f32_16x16x32_bf16 v[156:159], v[124:127], v[84:87], v[156:159]
    ds_read_b64_tr_b16 v[78:79], v15 offset:24576
    v_mfma_f32_16x16x32_bf16 v[160:163], v[112:115], v[88:91], v[160:163]
    ds_read_b128 v[32:35], v6 offset:0
    v_mfma_f32_16x16x32_bf16 v[164:167], v[116:119], v[88:91], v[164:167]
    ds_read_b128 v[36:39], v6 offset:1024
    v_mfma_f32_16x16x32_bf16 v[168:171], v[120:123], v[88:91], v[168:171]
    ds_read_b128 v[40:43], v6 offset:2048
    v_mfma_f32_16x16x32_bf16 v[172:175], v[124:127], v[88:91], v[172:175]
    ds_read_b128 v[44:47], v6 offset:3072
    v_mfma_f32_16x16x32_bf16 v[176:179], v[112:115], v[92:95], v[176:179]
    ds_read_b128 v[48:51], v6 offset:4096
    v_mfma_f32_16x16x32_bf16 v[180:183], v[116:119], v[92:95], v[180:183]
    ds_read_b128 v[52:55], v6 offset:5120
    v_mfma_f32_16x16x32_bf16 v[184:187], v[120:123], v[92:95], v[184:187]
    ds_read_b128 v[56:59], v6 offset:6144
    v_mfma_f32_16x16x32_bf16 v[188:191], v[124:127], v[92:95], v[188:191]
    ds_read_b128 v[60:63], v6 offset:7168
    v_mfma_f32_16x16x32_bf16 v[192:195], v[112:115], v[96:99], v[192:195]
    v_mfma_f32_16x16x32_bf16 v[196:199], v[116:119], v[96:99], v[196:199]
    s_add_u32 m0, s21, 32768
    s_nop 0
    buffer_load_dwordx4 v1, s[4:7], s16 offen sc1 lds
    s_add_u32 s16, s16, s62
    v_mfma_f32_16x16x32_bf16 v[200:203], v[120:123], v[96:99], v[200:203]
    v_mfma_f32_16x16x32_bf16 v[204:207], v[124:127], v[96:99], v[204:207]
    v_mfma_f32_16x16x32_bf16 v[208:211], v[112:115], v[100:103], v[208:211]
    s_add_u32 m0, s21, 33792
    s_nop 0
    buffer_load_dwordx4 v1, s[4:7], s17 offen sc1 lds
    s_add_u32 s17, s17, s62
    v_mfma_f32_16x16x32_bf16 v[212:215], v[116:119], v[100:103], v[212:215]
    v_mfma_f32_16x16x32_bf16 v[216:219], v[120:123], v[100:103], v[216:219]
    v_mfma_f32_16x16x32_bf16 v[220:223], v[124:127], v[100:103], v[220:223]
    s_add_u32 m0, s22, 32768
    s_nop 0
    buffer_load_dwordx4 v2, s[8:11], s18 offen lds
    s_add_u32 s18, s18, s20
    v_mfma_f32_16x16x32_bf16 v[224:227], v[112:115], v[104:107], v[224:227]
    v_mfma_f32_16x16x32_bf16 v[228:231], v[116:119], v[104:107], v[228:231]
    v_mfma_f32_16x16x32_bf16 v[232:235], v[120:123], v[104:107], v[232:235]
    s_add_u32 m0, s22, 40960
    s_nop 0
    buffer_load_dwordx4 v2, s[12:15], s19 offen lds
    s_add_u32 s19, s19, s20
    v_mfma_f32_16x16x32_bf16 v[236:239], v[124:127], v[104:107], v[236:239]
    v_mfma_f32_16x16x32_bf16 v[240:243], v[112:115], v[108:111], v[240:243]
    v_mfma_f32_16x16x32_bf16 v[244:247], v[116:119], v[108:111], v[244:247]
    v_mfma_f32_16x16x32_bf16 v[248:251], v[120:123], v[108:111], v[248:251]
    v_mfma_f32_16x16x32_bf16 v[252:255], v[124:127], v[108:111], v[252:255]
    s_waitcnt lgkmcnt(0)
    s_waitcnt vmcnt(24)
    s_barrier
    v_mfma_f32_16x16x32_bf16 v[128:131], v[64:67], v[32:35], v[128:131]
    ds_read_b64_tr_b16 v[112:113], v12 offset:49152
    v_mfma_f32_16x16x32_bf16 v[132:135], v[68:71], v[32:35], v[132:135]
    ds_read_b64_tr_b16 v[114:115], v13 offset:49152
    v_mfma_f32_16x16x32_bf16 v[136:139], v[72:75], v[32:35], v[136:139]
    ds_read_b64_tr_b16 v[116:117], v14 offset:49152
    v_mfma_f32_16x16x32_bf16 v[140:143], v[76:79], v[32:35], v[140:143]
    ds_read_b64_tr_b16 v[118:119], v15 offset:49152
    v_mfma_f32_16x16x32_bf16 v[144:147], v[64:67], v[36:39], v[144:147]
    ds_read_b64_tr_b16 v[120:121], v12 offset:57344
    v_mfma_f32_16x16x32_bf16 v[148:151], v[68:71], v[36:39], v[148:151]
    ds_read_b64_tr_b16 v[122:123], v13 offset:57344
    v_mfma_f32_16x16x32_bf16 v[152:155], v[72:75], v[36:39], v[152:155]
    ds_read_b64_tr_b16 v[124:125], v14 offset:57344
    v_mfma_f32_16x16x32_bf16 v[156:159], v[76:79], v[36:39], v[156:159]
    ds_read_b64_tr_b16 v[126:127], v15 offset:57344
    v_mfma_f32_16x16x32_bf16 v[160:163], v[64:67], v[40:43], v[160:163]
    ds_read_b128 v[80:83], v6 offset:32768
    v_mfma_f32_16x16x32_bf16 v[164:167], v[68:71], v[40:43], v[164:167]
    ds_read_b128 v[84:87], v6 offset:33792
    v_mfma_f32_16x16x32_bf16 v[168:171], v[72:75], v[40:43], v[168:171]
    ds_read_b128 v[88:91], v6 offset:34816
    v_mfma_f32_16x16x32_bf16 v[172:175], v[76:79], v[40:43], v[172:175]
    ds_read_b128 v[92:95], v6 offset:35840
    v_mfma_f32_16x16x32_bf16 v[176:179], v[64:67], v[44:47], v[176:179]
    ds_read_b128 v[96:99], v6 offset:36864
    v_mfma_f32_16x16x32_bf16 v[180:183], v[68:71], v[44:47], v[180:183]
    ds_read_b128 v[100:103], v6 offset:37888
    v_mfma_f32_16x16x32_bf16 v[184:187], v[72:75], v[44:47], v[184:187]
    ds_read_b128 v[104:107], v6 offset:38912
    v_mfma_f32_16x16x32_bf16 v[188:191], v[76:79], v[44:47], v[188:191]
    ds_read_b128 v[108:111], v6 offset:39936
    v_mfma_f32_16x16x32_bf16 v[192:195], v[64:67], v[48:51], v[192:195]
    v_mfma_f32_16x16x32_bf16 v[196:199], v[68:71], v[48:51], v[196:199]
    s_add_u32 m0, s21, 65536
    s_nop 0
    buffer_load_dwordx4 v1, s[4:7], s16 offen sc1 lds
    s_add_u32 s16, s16, s62
    v_mfma_f32_16x16x32_bf16 v[200:203], v[72:75], v[48:51], v[200:203]
    v_mfma_f32_16x16x32_bf16 v[204:207], v[76:79], v[48:51], v[204:207]
    v_mfma_f32_16x16x32_bf16 v[208:211], v[64:67], v[52:55], v[208:211]
    s_add_u32 m0, s21, 66560
    s_nop 0
    buffer_load_dwordx4 v1, s[4:7], s17 offen sc1 lds
    s_add_u32 s17, s17, s62
    v_mfma_f32_16x16x32_bf16 v[212:215], v[68:71], v[52:55], v[212:215]
    v_mfma_f32_16x16x32_bf16 v[216:219], v[72:75], v[52:55], v[216:219]
    v_mfma_f32_16x16x32_bf16 v[220:223], v[76:79], v[52:55], v[220:223]
    s_add_u32 m0, s22, 65536
    s_nop 0
    buffer_load_dwordx4 v2, s[8:11], s18 offen lds
    s_add_u32 s18, s18, s20
    v_mfma_f32_16x16x32_bf16 v[224:227], v[64:67], v[56:59], v[224:227]
    v_mfma_f32_16x16x32_bf16 v[228:231], v[68:71], v[56:59], v[228:231]
    v_mfma_f32_16x16x32_bf16 v[232:235], v[72:75], v[56:59], v[232:235]
    s_add_u32 m0, s22, 73728
    s_nop 0
    buffer_load_dwordx4 v2, s[12:15], s19 offen lds
    s_add_u32 s19, s19, s20
    v_mfma_f32_16x16x32_bf16 v[236:239], v[76:79], v[56:59], v[236:239]
    v_mfma_f32_16x16x32_bf16 v[240:243], v[64:67], v[60:63], v[240:243]
    v_mfma_f32_16x16x32_bf16 v[244:247], v[68:71], v[60:63], v[244:247]
    v_mfma_f32_16x16x32_bf16 v[248:251], v[72:75], v[60:63], v[248:251]
    v_mfma_f32_16x16x32_bf16 v[252:255], v[76:79], v[60:63], v[252:255]
    s_waitcnt lgkmcnt(0)
    s_waitcnt vmcnt(8)
    s_barrier
    s_cmp_eq_u32 s28, 0
    s_cbranch_scc1 sig_4
    s_cmp_lg_u32 s3, 0
    s_cbranch_scc1 sig_4
    s_mov_b64 exec, 1
    v_mov_b32 v18, s57
    buffer_atomic_add v18, v17, s[4:7], s28 offen sc1
    s_mov_b64 exec, -1
sig_4:
    s_mov_b32 s28, 0
    v_mfma_f32_16x16x32_bf16 v[128:131], v[112:115], v[80:83], v[128:131]
    ds_read_b64_tr_b16 v[64:65], v8 offset:16384
    v_mfma_f32_16x16x32_bf16 v[132:135], v[116:119], v[80:83], v[132:135]
    ds_read_b64_tr_b16 v[66:67], v9 offset:16384
    v_mfma_f32_16x16x32_bf16 v[136:139], v[120:123], v[80:83], v[136:139]
    ds_read_b64_tr_b16 v[68:69], v10 offset:16384
    v_mfma_f32_16x16x32_bf16 v[140:143], v[124:127], v[80:83], v[140:143]
    ds_read_b64_tr_b16 v[70:71], v11 offset:16384
    v_mfma_f32_16x16x32_bf16 v[144:147], v[112:115], v[84:87], v[144:147]
    ds_read_b64_tr_b16 v[72:73], v8 offset:24576
    v_mfma_f32_16x16x32_bf16 v[148:151], v[116:119], v[84:87], v[148:151]
    ds_read_b64_tr_b16 v[74:75], v9 offset:24576
    v_mfma_f32_16x16x32_bf16 v[152:155], v[120:123], v[84:87], v[152:155]
    ds_read_b64_tr_b16 v[76:77], v10 offset:24576
    v_mfma_f32_16x16x32_bf16 v[156:159], v[124:127], v[84:87], v[156:159]
    ds_read_b64_tr_b16 v[78:79], v11 offset:24576
    v_mfma_f32_16x16x32_bf16 v[160:163], v[112:115], v[88:91], v[160:163]
    ds_read_b128 v[32:35], v5 offset:0
    v_mfma_f32_16x16x32_bf16 v[164:167], v[116:119], v[88:91], v[164:167]
    ds_read_b128 v[36:39], v5 offset:1024
    v_mfma_f32_16x16x32_bf16 v[168:171], v[120:123], v[88:91], v[168:171]
    ds_read_b128 v[40:43], v5 offset:2048
    v_mfma_f32_16x16x32_bf16 v[172:175], v[124:127], v[88:91], v[172:175]
    ds_read_b128 v[44:47], v5 offset:3072
    v_mfma_f32_16x16x32_bf16 v[176:179], v[112:115], v[92:95], v[176:179]
    ds_read_b128 v[48:51], v5 offset:4096
    v_mfma_f32_16x16x32_bf16 v[180:183], v[116:119], v[92:95], v[180:183]
    ds_read_b128 v[52:55], v5 offset:5120
    v_mfma_f32_16x16x32_bf16 v[184:187], v[120:123], v[92:95], v[184:187]
    ds_read_b128 v[56:59], v5 offset:6144
    v_mfma_f32_16x16x32_bf16 v[188:191], v[124:127], v[92:95], v[188:191]
    ds_read_b128 v[60:63], v5 offset:7168
    v_mfma_f32_16x16x32_bf16 v[192:195], v[112:115], v[96:99], v[192:195]
    v_mfma_f32_16x16x32_bf16 v[196:199], v[116:119], v[96:99], v[196:199]
    s_add_u32 m0, s21, 98304
    s_nop 0
    buffer_load_dwordx4 v1, s[4:7], s16 offen sc1 lds
    s_add_u32 s16, s16, s62
    v_mfma_f32_16x16x32_bf16 v[200:203], v[120:123], v[96:99], v[200:203]
    v_mfma_f32_16x16x32_bf16 v[204:207], v[124:127], v[96:99], v[204:207]
    v_mfma_f32_16x16x32_bf16 v[208:211], v[112:115], v[100:103], v[208:211]
    s_add_u32 m0, s21, 99328
    s_nop 0
    buffer_load_dwordx4 v1, s[4:7], s17 offen sc1 lds
    s_add_u32 s17, s17, s62
    v_mfma_f32_16x16x32_bf16 v[212:215], v[116:119], v[100:103], v[212:215]
    v_mfma_f32_16x16x32_bf16 v[216:219], v[120:123], v[100:103], v[216:219]
    v_mfma_f32_16x16x32_bf16 v[220:223], v[124:127], v[100:103], v[220:223]
    s_add_u32 m0, s22, 98304
    s_nop 0
    buffer_load_dwordx4 v2, s[8:11], s18 offen lds
    s_add_u32 s18, s18, s20
    v_mfma_f32_16x16x32_bf16 v[224:227], v[112:115], v[104:107], v[224:227]
    v_mfma_f32_16x16x32_bf16 v[228:231], v[116:119], v[104:107], v[228:231]
    v_mfma_f32_16x16x32_bf16 v[232:235], v[120:123], v[104:107], v[232:235]
    s_add_u32 m0, s22, 106496
    s_nop 0
    buffer_load_dwordx4 v2, s[12:15], s19 offen lds
    s_add_u32 s19, s19, s20
    v_mfma_f32_16x16x32_bf16 v[236:239], v[124:127], v[104:107], v[236:239]
    v_mfma_f32_16x16x32_bf16 v[240:243], v[112:115], v[108:111], v[240:243]
    v_mfma_f32_16x16x32_bf16 v[244:247], v[116:119], v[108:111], v[244:247]
    v_mfma_f32_16x16x32_bf16 v[248:251], v[120:123], v[108:111], v[248:251]
    v_mfma_f32_16x16x32_bf16 v[252:255], v[124:127], v[108:111], v[252:255]
    s_waitcnt lgkmcnt(0)
w_loop_chk:
    s_sub_u32 s23, s23, 1
w_loop:
    s_cmp_lg_u32 s23, 1
    s_cbranch_scc1 w_body
    v_readfirstlane_b32 s30, v16
    s_cmp_ge_u32 s30, s45
    s_cselect_b32 s30, 0, 1
    s_or_b32 s30, s30, s70
    s_cmp_ge_u32 s32, 4
    s_cselect_b32 s30, 1, s30
    s_cmp_eq_u32 s32, 0
    s_cselect_b32 s30, 1, s30
    v_mov_b32 v20, s30
    ds_write_b32 v7, v20
    s_cbranch_scc1 w_body
    s_load_dwordx2 s[8:9], s[0:1], s33
    s_load_dwordx2 s[12:13], s[0:1], s34
    s_mov_b32 s10, s38
    s_mov_b32 s14, s38
    s_cmp_ge_u32 s32, 4
    s_cselect_b32 s31, 0, 1
    s_lshl_b32 s30, s3, s31
    s_mul_i32 s30, s30, s40
    s_add_u32 s16, s39, s30
    s_cmp_eq_u32 s32, 4
    s_cselect_b32 s30, 1024, s40
    s_cselect_b32 s31, 6, 5
    s_lshl_b32 s62, 32, s31
    s_add_u32 s17, s16, s30
    s_lshl_b32 s30, s3, 2
    s_mul_i32 s30, s30, s35
    s_add_u32 s18, s36, s30
    s_add_u32 s19, s37, s30
    s_lshl_b32 s20, s35, s31
    v_mul_u32_u24 v2, s35, v4
    v_add_u32 v2, v2, v3
    s_waitcnt lgkmcnt(0)
w_body:
    s_waitcnt vmcnt(8)
    s_barrier
    v_mfma_f32_16x16x32_bf16 v[128:131], v[64:67], v[32:35], v[128:131]
    ds_read_b64_tr_b16 v[112:113], v8 offset:49152
    v_mfma_f32_16x16x32_bf16 v[132:135], v[68:71], v[32:35], v[132:135]
    ds_read_b64_tr_b16 v[114:115], v9 offset:49152
    v_mfma_f32_16x16x32_bf16 v[136:139], v[72:75], v[32:35], v[136:139]
    ds_read_b64_tr_b16 v[116:117], v10 offset:49152
    v_mfma_f32_16x16x32_bf16 v[140:143], v[76:79], v[32:35], v[140:143]
    ds_read_b64_tr_b16 v[118:119], v11 offset:49152
    v_mfma_f32_16x16x32_bf16 v[144:147], v[64:67], v[36:39], v[144:147]
    ds_read_b64_tr_b16 v[120:121], v8 offset:57344
    v_mfma_f32_16x16x32_bf16 v[148:151], v[68:71], v[36:39], v[148:151]
    ds_read_b64_tr_b16 v[122:123], v9 offset:57344
    v_mfma_f32_16x16x32_bf16 v[152:155], v[72:75], v[36:39], v[152:155]
    ds_read_b64_tr_b16 v[124:125], v10 offset:57344
    v_mfma_f32_16x16x32_bf16 v[156:159], v[76:79], v[36:39], v[156:159]
    ds_read_b64_tr_b16 v[126:127], v11 offset:57344
    v_mfma_f32_16x16x32_bf16 v[160:163], v[64:67], v[40:43], v[160:163]
    ds_read_b128 v[80:83], v5 offset:32768
    v_mfma_f32_16x16x32_bf16 v[164:167], v[68:71], v[40:43], v[164:167]
    ds_read_b128 v[84:87], v5 offset:33792
    v_mfma_f32_16x16x32_bf16 v[168:171], v[72:75], v[40:43], v[168:171]
    ds_read_b128 v[88:91], v5 offset:34816
    v_mfma_f32_16x16x32_bf16 v[172:175], v[76:79], v[40:43], v[172:175]
    ds_read_b128 v[92:95], v5 offset:35840
    v_mfma_f32_16x16x32_bf16 v[176:179], v[64:67], v[44:47], v[176:179]
    ds_read_b128 v[96:99], v5 offset:36864
    v_mfma_f32_16x16x32_bf16 v[180:183], v[68:71], v[44:47], v[180:183]
    ds_read_b128 v[100:103], v5 offset:37888
    v_mfma_f32_16x16x32_bf16 v[184:187], v[72:75], v[44:47], v[184:187]
    ds_read_b128 v[104:107], v5 offset:38912
    v_mfma_f32_16x16x32_bf16 v[188:191], v[76:79], v[44:47], v[188:191]
    ds_read_b128 v[108:111], v5 offset:39936
    v_mfma_f32_16x16x32_bf16 v[192:195], v[64:67], v[48:51], v[192:195]
    v_mfma_f32_16x16x32_bf16 v[196:199], v[68:71], v[48:51], v[196:199]
    s_add_u32 m0, s21, 0
    s_nop 0
    buffer_load_dwordx4 v1, s[4:7], s16 offen sc1 lds
    s_add_u32 s16, s16, s62
    v_mfma_f32_16x16x32_bf16 v[200:203], v[72:75], v[48:51], v[200:203]
    v_mfma_f32_16x16x32_bf16 v[204:207], v[76:79], v[48:51], v[204:207]
    v_mfma_f32_16x16x32_bf16 v[208:211], v[64:67], v[52:55], v[208:211]
    s_add_u32 m0, s21, 1024
    s_nop 0
    buffer_load_dwordx4 v1, s[4:7], s17 offen sc1 lds
    s_add_u32 s17, s17, s62
    v_mfma_f32_16x16x32_bf16 v[212:215], v[68:71], v[52:55], v[212:215]
    v_mfma_f32_16x16x32_bf16 v[216:219], v[72:75], v[52:55], v[216:219]
    v_mfma_f32_16x16x32_bf16 v[220:223], v[76:79], v[52:55], v[220:223]
    s_add_u32 m0, s22, 0
    s_nop 0
    buffer_load_dwordx4 v2, s[8:11], s18 offen lds
    s_add_u32 s18, s18, s20
    v_mfma_f32_16x16x32_bf16 v[224:227], v[64:67], v[56:59], v[224:227]
    v_mfma_f32_16x16x32_bf16 v[228:231], v[68:71], v[56:59], v[228:231]
    v_mfma_f32_16x16x32_bf16 v[232:235], v[72:75], v[56:59], v[232:235]
    s_add_u32 m0, s22, 8192
    s_nop 0
    buffer_load_dwordx4 v2, s[12:15], s19 offen lds
    s_add_u32 s19, s19, s20
    v_mfma_f32_16x16x32_bf16 v[236:239], v[76:79], v[56:59], v[236:239]
    v_mfma_f32_16x16x32_bf16 v[240:243], v[64:67], v[60:63], v[240:243]
    v_mfma_f32_16x16x32_bf16 v[244:247], v[68:71], v[60:63], v[244:247]
    buffer_load_dword v16, v17, s[4:7], s44 offen sc1
    v_mfma_f32_16x16x32_bf16 v[248:251], v[72:75], v[60:63], v[248:251]
    v_mfma_f32_16x16x32_bf16 v[252:255], v[76:79], v[60:63], v[252:255]
    s_waitcnt lgkmcnt(0)
    s_waitcnt vmcnt(8)
    s_barrier
    v_mfma_f32_16x16x32_bf16 v[128:131], v[112:115], v[80:83], v[128:131]
    ds_read_b64_tr_b16 v[64:65], v12 offset:16384
    v_mfma_f32_16x16x32_bf16 v[132:135], v[116:119], v[80:83], v[132:135]
    ds_read_b64_tr_b16 v[66:67], v13 offset:16384
    v_mfma_f32_16x16x32_bf16 v[136:139], v[120:123], v[80:83], v[136:139]
    ds_read_b64_tr_b16 v[68:69], v14 offset:16384
    v_mfma_f32_16x16x32_bf16 v[140:143], v[124:127], v[80:83], v[140:143]
    ds_read_b64_tr_b16 v[70:71], v15 offset:16384
    v_mfma_f32_16x16x32_bf16 v[144:147], v[112:115], v[84:87], v[144:147]
    ds_read_b64_tr_b16 v[72:73], v12 offset:24576
    v_mfma_f32_16x16x32_bf16 v[148:151], v[116:119], v[84:87], v[148:151]
    ds_read_b64_tr_b16 v[74:75], v13 offset:24576
    v_mfma_f32_16x16x32_bf16 v[152:155], v[120:123], v[84:87], v[152:155]
    ds_read_b64_tr_b16 v[76:77], v14 offset:24576
    v_mfma_f32_16x16x32_bf16 v[156:159], v[124:127], v[84:87], v[156:159]
    ds_read_b64_tr_b16 v[78:79], v15 offset:24576
    v_mfma_f32_16x16x32_bf16 v[160:163], v[112:115], v[88:91], v[160:163]
    ds_read_b128 v[32:35], v6 offset:0
    v_mfma_f32_16x16x32_bf16 v[164:167], v[116:119], v[88:91], v[164:167]
    ds_read_b128 v[36:39], v6 offset:1024
    v_mfma_f32_16x16x32_bf16 v[168:171], v[120:123], v[88:91], v[168:171]
    ds_read_b128 v[40:43], v6 offset:2048
    v_mfma_f32_16x16x32_bf16 v[172:175], v[124:127], v[88:91], v[172:175]
    ds_read_b128 v[44:47], v6 offset:3072
    v_mfma_f32_16x16x32_bf16 v[176:179], v[112:115], v[92:95], v[176:179]
    ds_read_b128 v[48:51], v6 offset:4096
    v_mfma_f32_16x16x32_bf16 v[180:183], v[116:119], v[92:95], v[180:183]
    ds_read_b128 v[52:55], v6 offset:5120
    v_mfma_f32_16x16x32_bf16 v[184:187], v[120:123], v[92:95], v[184:187]
    ds_read_b128 v[56:59], v6 offset:6144
    v_mfma_f32_16x16x32_bf16 v[188:191], v[124:127], v[92:95], v[188:191]
    ds_read_b128 v[60:63], v6 offset:7168
    v_mfma_f32_16x16x32_bf16 v[192:195], v[112:115], v[96:99], v[192:195]
    v_mfma_f32_16x16x32_bf16 v[196:199], v[116:119], v[96:99], v[196:199]
    s_add_u32 m0, s21, 32768
    s_nop 0
    buffer_load_dwordx4 v1, s[4:7], s16 offen sc1 lds
    s_add_u32 s16, s16, s62
    v_mfma_f32_16x16x32_bf16 v[200:203], v[120:123], v[96:99], v[200:203]
    v_mfma_f32_16x16x32_bf16 v[204:207], v[124:127], v[96:99], v[204:207]
    v_mfma_f32_16x16x32_bf16 v[208:211], v[112:115], v[100:103], v[208:211]
    s_add_u32 m0, s21, 33792
    s_nop 0
    buffer_load_dwordx4 v1, s[4:7], s17 offen sc1 lds
    s_add_u32 s17, s17, s62
    v_mfma_f32_16x16x32_bf16 v[212:215], v[116:119], v[100:103], v[212:215]
    v_mfma_f32_16x16x32_bf16 v[216:219], v[120:123], v[100:103], v[216:219]
    v_mfma_f32_16x16x32_bf16 v[220:223], v[124:127], v[100:103], v[220:223]
    s_add_u32 m0, s22, 32768
    s_nop 0
    buffer_load_dwordx4 v2, s[8:11], s18 offen lds
    s_add_u32 s18, s18, s20
    v_mfma_f32_16x16x32_bf16 v[224:227], v[112:115], v[104:107], v[224:227]
    v_mfma_f32_16x16x32_bf16 v[228:231], v[116:119], v[104:107], v[228:231]
    v_mfma_f32_16x16x32_bf16 v[232:235], v[120:123], v[104:107], v[232:235]
    s_add_u32 m0, s22, 40960
    s_nop 0
    buffer_load_dwordx4 v2, s[12:15], s19 offen lds
    s_add_u32 s19, s19, s20
    v_mfma_f32_16x16x32_bf16 v[236:239], v[124:127], v[104:107], v[236:239]
    v_mfma_f32_16x16x32_bf16 v[240:243], v[112:115], v[108:111], v[240:243]
    v_mfma_f32_16x16x32_bf16 v[244:247], v[116:119], v[108:111], v[244:247]
    v_mfma_f32_16x16x32_bf16 v[248:251], v[120:123], v[108:111], v[248:251]
    v_mfma_f32_16x16x32_bf16 v[252:255], v[124:127], v[108:111], v[252:255]
    s_waitcnt lgkmcnt(0)
    s_waitcnt vmcnt(8)
    s_barrier
    v_mfma_f32_16x16x32_bf16 v[128:131], v[64:67], v[32:35], v[128:131]
    ds_read_b64_tr_b16 v[112:113], v12 offset:49152
    v_mfma_f32_16x16x32_bf16 v[132:135], v[68:71], v[32:35], v[132:135]
    ds_read_b64_tr_b16 v[114:115], v13 offset:49152
    v_mfma_f32_16x16x32_bf16 v[136:139], v[72:75], v[32:35], v[136:139]
    ds_read_b64_tr_b16 v[116:117], v14 offset:49152
    v_mfma_f32_16x16x32_bf16 v[140:143], v[76:79], v[32:35], v[140:143]
    ds_read_b64_tr_b16 v[118:119], v15 offset:49152
    v_mfma_f32_16x16x32_bf16 v[144:147], v[64:67], v[36:39], v[144:147]
    ds_read_b64_tr_b16 v[120:121], v12 offset:57344
    v_mfma_f32_16x16x32_bf16 v[148:151], v[68:71], v[36:39], v[148:151]
    ds_read_b64_tr_b16 v[122:123], v13 offset:57344
    v_mfma_f32_16x16x32_bf16 v[152:155], v[72:75], v[36:39], v[152:155]
    ds_read_b64_tr_b16 v[124:125], v14 offset:57344
    v_mfma_f32_16x16x32_bf16 v[156:159], v[76:79], v[36:39], v[156:159]
    ds_read_b64_tr_b16 v[126:127], v15 offset:57344
    v_mfma_f32_16x16x32_bf16 v[160:163], v[64:67], v[40:43], v[160:163]
    ds_read_b128 v[80:83], v6 offset:32768
    v_mfma_f32_16x16x32_bf16 v[164:167], v[68:71], v[40:43], v[164:167]
    ds_read_b128 v[84:87], v6 offset:33792
    v_mfma_f32_16x16x32_bf16 v[168:171], v[72:75], v[40:43], v[168:171]
    ds_read_b128 v[88:91], v6 offset:34816
    v_mfma_f32_16x16x32_bf16 v[172:175], v[76:79], v[40:43], v[172:175]
    ds_read_b128 v[92:95], v6 offset:35840
    v_mfma_f32_16x16x32_bf16 v[176:179], v[64:67], v[44:47], v[176:179]
    ds_read_b128 v[96:99], v6 offset:36864
    v_mfma_f32_16x16x32_bf16 v[180:183], v[68:71], v[44:47], v[180:183]
    ds_read_b128 v[100:103], v6 offset:37888
    v_mfma_f32_16x16x32_bf16 v[184:187], v[72:75], v[44:47], v[184:187]
    ds_read_b128 v[104:107], v6 offset:38912
    v_mfma_f32_16x16x32_bf16 v[188:191], v[76:79], v[44:47], v[188:191]
    ds_read_b128 v[108:111], v6 offset:39936
    v_mfma_f32_16x16x32_bf16 v[192:195], v[64:67], v[48:51], v[192:195]
    v_mfma_f32_16x16x32_bf16 v[196:199], v[68:71], v[48:51], v[196:199]
    s_add_u32 m0, s21, 65536
    s_nop 0
    buffer_load_dwordx4 v1, s[4:7], s16 offen sc1 lds
    s_add_u32 s16, s16, s62
    v_mfma_f32_16x16x32_bf16 v[200:203], v[72:75], v[48:51], v[200:203]
    v_mfma_f32_16x16x32_bf16 v[204:207], v[76:79], v[48:51], v[204:207]
    v_mfma_f32_16x16x32_bf16 v[208:211], v[64:67], v[52:55], v[208:211]
    s_add_u32 m0, s21, 66560
    s_nop 0
    buffer_load_dwordx4 v1, s[4:7], s17 offen sc1 lds
    s_add_u32 s17, s17, s62
    v_mfma_f32_16x16x32_bf16 v[212:215], v[68:71], v[52:55], v[212:215]
    v_mfma_f32_16x16x32_bf16 v[216:219], v[72:75], v[52:55], v[216:219]
    v_mfma_f32_16x16x32_bf16 v[220:223], v[76:79], v[52:55], v[220:223]
    s_add_u32 m0, s22, 65536
    s_nop 0
    buffer_load_dwordx4 v2, s[8:11], s18 offen lds
    s_add_u32 s18, s18, s20
    v_mfma_f32_16x16x32_bf16 v[224:227], v[64:67], v[56:59], v[224:227]
    v_mfma_f32_16x16x32_bf16 v[228:231], v[68:71], v[56:59], v[228:231]
    v_mfma_f32_16x16x32_bf16 v[232:235], v[72:75], v[56:59], v[232:235]
    s_add_u32 m0, s22, 73728
    s_nop 0
    buffer_load_dwordx4 v2, s[12:15], s19 offen lds
    s_add_u32 s19, s19, s20
    v_mfma_f32_16x16x32_bf16 v[236:239], v[76:79], v[56:59], v[236:239]
    v_mfma_f32_16x16x32_bf16 v[240:243], v[64:67], v[60:63], v[240:243]
    v_mfma_f32_16x16x32_bf16 v[244:247], v[68:71], v[60:63], v[244:247]
    v_mfma_f32_16x16x32_bf16 v[248:251], v[72:75], v[60:63], v[248:251]
    v_mfma_f32_16x16x32_bf16 v[252:255], v[76:79], v[60:63], v[252:255]
    s_waitcnt lgkmcnt(0)
    s_waitcnt vmcnt(8)
    s_barrier
    v_mfma_f32_16x16x32_bf16 v[128:131], v[112:115], v[80:83], v[128:131]
    ds_read_b64_tr_b16 v[64:65], v8 offset:16384
    v_mfma_f32_16x16x32_bf16 v[132:135], v[116:119], v[80:83], v[132:135]
    ds_read_b64_tr_b16 v[66:67], v9 offset:16384
    v_mfma_f32_16x16x32_bf16 v[136:139], v[120:123], v[80:83], v[136:139]
    ds_read_b64_tr_b16 v[68:69], v10 offset:16384
    v_mfma_f32_16x16x32_bf16 v[140:143], v[124:127], v[80:83], v[140:143]
    ds_read_b64_tr_b16 v[70:71], v11 offset:16384
    v_mfma_f32_16x16x32_bf16 v[144:147], v[112:115], v[84:87], v[144:147]
    ds_read_b64_tr_b16 v[72:73], v8 offset:24576
    v_mfma_f32_16x16x32_bf16 v[148:151], v[116:119], v[84:87], v[148:151]
    ds_read_b64_tr_b16 v[74:75], v9 offset:24576
    v_mfma_f32_16x16x32_bf16 v[152:155], v[120:123], v[84:87], v[152:155]
    ds_read_b64_tr_b16 v[76:77], v10 offset:24576
    v_mfma_f32_16x16x32_bf16 v[156:159], v[124:127], v[84:87], v[156:159]
    ds_read_b64_tr_b16 v[78:79], v11 offset:24576
    v_mfma_f32_16x16x32_bf16 v[160:163], v[112:115], v[88:91], v[160:163]
    ds_read_b128 v[32:35], v5 offset:0
    v_mfma_f32_16x16x32_bf16 v[164:167], v[116:119], v[88:91], v[164:167]
    ds_read_b128 v[36:39], v5 offset:1024
    v_mfma_f32_16x16x32_bf16 v[168:171], v[120:123], v[88:91], v[168:171]
    ds_read_b128 v[40:43], v5 offset:2048
    v_mfma_f32_16x16x32_bf16 v[172:175], v[124:127], v[88:91], v[172:175]
    ds_read_b128 v[44:47], v5 offset:3072
    v_mfma_f32_16x16x32_bf16 v[176:179], v[112:115], v[92:95], v[176:179]
    ds_read_b128 v[48:51], v5 offset:4096
    v_mfma_f32_16x16x32_bf16 v[180:183], v[116:119], v[92:95], v[180:183]
    ds_read_b128 v[52:55], v5 offset:5120
    v_mfma_f32_16x16x32_bf16 v[184:187], v[120:123], v[92:95], v[184:187]
    ds_read_b128 v[56:59], v5 offset:6144
    v_mfma_f32_16x16x32_bf16 v[188:191], v[124:127], v[92:95], v[188:191]
    ds_read_b128 v[60:63], v5 offset:7168
    v_mfma_f32_16x16x32_bf16 v[192:195], v[112:115], v[96:99], v[192:195]
    v_mfma_f32_16x16x32_bf16 v[196:199], v[116:119], v[96:99], v[196:199]
    s_add_u32 m0, s21, 98304
    s_nop 0
    buffer_load_dwordx4 v1, s[4:7], s16 offen sc1 lds
    s_add_u32 s16, s16, s62
    v_mfma_f32_16x16x32_bf16 v[200:203], v[120:123], v[96:99], v[200:203]
    v_mfma_f32_16x16x32_bf16 v[204:207], v[124:127], v[96:99], v[204:207]
    v_mfma_f32_16x16x32_bf16 v[208:211], v[112:115], v[100:103], v[208:211]
    s_add_u32 m0, s21, 99328
    s_nop 0
    buffer_load_dwordx4 v1, s[4:7], s17 offen sc1 lds
    s_add_u32 s17, s17, s62
    v_mfma_f32_16x16x32_bf16 v[212:215], v[116:119], v[100:103], v[212:215]
    v_mfma_f32_16x16x32_bf16 v[216:219], v[120:123], v[100:103], v[216:219]
    v_mfma_f32_16x16x32_bf16 v[220:223], v[124:127], v[100:103], v[220:223]
    s_add_u32 m0, s22, 98304
    s_nop 0
    buffer_load_dwordx4 v2, s[8:11], s18 offen lds
    s_add_u32 s18, s18, s20
    v_mfma_f32_16x16x32_bf16 v[224:227], v[112:115], v[104:107], v[224:227]
    v_mfma_f32_16x16x32_bf16 v[228:231], v[116:119], v[104:107], v[228:231]
    v_mfma_f32_16x16x32_bf16 v[232:235], v[120:123], v[104:107], v[232:235]
    s_add_u32 m0, s22, 106496
    s_nop 0
    buffer_load_dwordx4 v2, s[12:15], s19 offen lds
    s_add_u32 s19, s19, s20
    v_mfma_f32_16x16x32_bf16 v[236:239], v[124:127], v[104:107], v[236:239]
    v_mfma_f32_16x16x32_bf16 v[240:243], v[112:115], v[108:111], v[240:243]
    v_mfma_f32_16x16x32_bf16 v[244:247], v[116:119], v[108:111], v[244:247]
    v_mfma_f32_16x16x32_bf16 v[248:251], v[120:123], v[108:111], v[248:251]
    v_mfma_f32_16x16x32_bf16 v[252:255], v[124:127], v[108:111], v[252:255]
    s_waitcnt lgkmcnt(0)
    s_sub_u32 s23, s23, 1
    s_cmp_lg_u32 s23, 0
    s_cbranch_scc1 w_loop
    v_mov_b32 v20, 131072
    ds_read_b128 v[24:27], v20
    ds_read_b128 v[28:31], v20 offset:16
    s_cmp_eq_u32 s48, 2
    s_cbranch_scc1 w_epi_glu
    s_cmp_eq_u32 s48, 3
    s_cbranch_scc1 w_epi_silu
    s_lshl_b32 s30, s27, 10
    s_add_u32 s30, s30, s49
    s_nop 7
    v_cvt_pk_bf16_f32 v80, v128, v129
    v_cvt_pk_bf16_f32 v81, v130, v131
    v_cvt_pk_bf16_f32 v82, v132, v133
    v_cvt_pk_bf16_f32 v83, v134, v135
    buffer_store_dwordx4 v[80:83], v1, s[4:7], s30 offen sc1
    v_cvt_pk_bf16_f32 v84, v136, v137
    v_cvt_pk_bf16_f32 v85, v138, v139
    v_cvt_pk_bf16_f32 v86, v140, v141
    v_cvt_pk_bf16_f32 v87, v142, v143
    buffer_store_dwordx4 v[84:87], v19, s[4:7], s30 offen sc1
    s_add_u32 s30, s30, s50
    v_cvt_pk_bf16_f32 v88, v144, v145
    v_cvt_pk_bf16_f32 v89, v146, v147
    v_cvt_pk_bf16_f32 v90, v148, v149
    v_cvt_pk_bf16_f32 v91, v150, v151
    buffer_store_dwordx4 v[88:91], v1, s[4:7], s30 offen sc1
    v_cvt_pk_bf16_f32 v92, v152, v153
    v_cvt_pk_bf16_f32 v93, v154, v155
    v_cvt_pk_bf16_f32 v94, v156, v157
    v_cvt_pk_bf16_f32 v95, v158, v159
    buffer_store_dwordx4 v[92:95], v19, s[4:7], s30 offen sc1
    s_add_u32 s30, s30, s50
    v_cvt_pk_bf16_f32 v80, v160, v161
    v_cvt_pk_bf16_f32 v81, v162, v163
    v_cvt_pk_bf16_f32 v82, v164, v165
    v_cvt_pk_bf16_f32 v83, v166, v167
    buffer_store_dwordx4 v[80:83], v1, s[4:7], s30 offen sc1
    v_cvt_pk_bf16_f32 v84, v168, v169
    v_cvt_pk_bf16_f32 v85, v170, v171
    v_cvt_pk_bf16_f32 v86, v172, v173
    v_cvt_pk_bf16_f32 v87, v174, v175
    buffer_store_dwordx4 v[84:87], v19, s[4:7], s30 offen sc1
    s_add_u32 s30, s30, s50
    v_cvt_pk_bf16_f32 v88, v176, v177
    v_cvt_pk_bf16_f32 v89, v178, v179
    v_cvt_pk_bf16_f32 v90, v180, v181
    v_cvt_pk_bf16_f32 v91, v182, v183
    buffer_store_dwordx4 v[88:91], v1, s[4:7], s30 offen sc1
    v_cvt_pk_bf16_f32 v92, v184, v185
    v_cvt_pk_bf16_f32 v93, v186, v187
    v_cvt_pk_bf16_f32 v94, v188, v189
    v_cvt_pk_bf16_f32 v95, v190, v191
    buffer_store_dwordx4 v[92:95], v19, s[4:7], s30 offen sc1
    s_add_u32 s30, s30, s50
    v_cvt_pk_bf16_f32 v80, v192, v193
    v_cvt_pk_bf16_f32 v81, v194, v195
    v_cvt_pk_bf16_f32 v82, v196, v197
    v_cvt_pk_bf16_f32 v83, v198, v199
    buffer_store_dwordx4 v[80:83], v1, s[4:7], s30 offen sc1
    v_cvt_pk_bf16_f32 v84, v200, v201
    v_cvt_pk_bf16_f32 v85, v202, v203
    v_cvt_pk_bf16_f32 v86, v204, v205
    v_cvt_pk_bf16_f32 v87, v206, v207
    buffer_store_dwordx4 v[84:87], v19, s[4:7], s30 offen sc1
    s_add_u32 s30, s30, s50
    v_cvt_pk_bf16_f32 v88, v208, v209
    v_cvt_pk_bf16_f32 v89, v210, v211
    v_cvt_pk_bf16_f32 v90, v212, v213
    v_cvt_pk_bf16_f32 v91, v214, v215
    buffer_store_dwordx4 v[88:91], v1, s[4:7], s30 offen sc1
    v_cvt_pk_bf16_f32 v92, v216, v217
    v_cvt_pk_bf16_f32 v93, v218, v219
    v_cvt_pk_bf16_f32 v94, v220, v221
    v_cvt_pk_bf16_f32 v95, v222, v223
    buffer_store_dwordx4 v[92:95], v19, s[4:7], s30 offen sc1
    s_add_u32 s30, s30, s50
    v_cvt_pk_bf16_f32 v80, v224, v225
    v_cvt_pk_bf16_f32 v81, v226, v227
    v_cvt_pk_bf16_f32 v82, v228, v229
    v_cvt_pk_bf16_f32 v83, v230, v231
    buffer_store_dwordx4 v[80:83], v1, s[4:7], s30 offen sc1
    v_cvt_pk_bf16_f32 v84, v232, v233
    v_cvt_pk_bf16_f32 v85, v234, v235
    v_cvt_pk_bf16_f32 v86, v236, v237
    v_cvt_pk_bf16_f32 v87, v238, v239
    buffer_store_dwordx4 v[84:87], v19, s[4:7], s30 offen sc1
    s_add_u32 s30, s30, s50
    v_cvt_pk_bf16_f32 v88, v240, v241
    v_cvt_pk_bf16_f32 v89, v242, v243
    v_cvt_pk_bf16_f32 v90, v244, v245
    v_cvt_pk_bf16_f32 v91, v246, v247
    buffer_store_dwordx4 v[88:91], v1, s[4:7], s30 offen sc1
    v_cvt_pk_bf16_f32 v92, v248, v249
    v_cvt_pk_bf16_f32 v93, v250, v251
    v_cvt_pk_bf16_f32 v94, v252, v253
    v_cvt_pk_bf16_f32 v95, v254, v255
    buffer_store_dwordx4 v[92:95], v19, s[4:7], s30 offen sc1
    s_waitcnt lgkmcnt(0)
    v_or3_b32 v24, v24, v25, v26
    v_or3_b32 v28, v28, v29, v30
    v_or3_b32 v24, v24, v27, v31
    v_or_b32 v24, v24, v28
    s_mov_b32 s28, s51
    s_mov_b32 s57, s53
    v_readfirstlane_b32 s30, v24
    s_cmp_lg_u32 s30, 0
    s_cbranch_scc1 w_drain
    s_mov_b32 s48, s32
    s_cmp_ge_u32 s32, 4
    s_cselect_b32 s30, 2, 3
    s_lshl_b32 s30, s26, s30
    s_mul_i32 s30, s30, s43
    s_add_u32 s49, s42, s30
    s_mov_b32 s50, s43
    s_mov_b32 s51, s46
    s_mov_b32 s23, s41
    s_mov_b32 s53, s47
    s_nop 0
    s_load_dwordx16 s[32:47], s[24:25], 0
    s_add_u32 s24, s24, 64
    s_addc_u32 s25, s25, 0
    s_branch w_first16
w_epi_glu:
    s_lshl_b32 s30, s27, 10
    s_add_u32 s30, s30, s49
    s_mov_b32 s54, 0xbfb8aa3b
    s_nop 7
    v_cvt_pk_bf16_f32 v80, v128, v129
    v_cvt_pk_bf16_f32 v81, v130, v131
    v_cvt_pk_bf16_f32 v82, v132, v133
    v_cvt_pk_bf16_f32 v83, v134, v135
    v_lshlrev_b32 v96, 16, v80
    v_and_b32 v97, 0xffff0000, v80
    v_lshlrev_b32 v98, 16, v81
    v_and_b32 v99, 0xffff0000, v81
    v_lshlrev_b32 v100, 16, v82
    v_and_b32 v101, 0xffff0000, v82
    v_lshlrev_b32 v102, 16, v83
    v_and_b32 v103, 0xffff0000, v83
    v_mul_f32 v96, s54, v96
    v_mul_f32 v97, s54, v97
    v_mul_f32 v98, s54, v98
    v_mul_f32 v99, s54, v99
    v_mul_f32 v100, s54, v100
    v_mul_f32 v101, s54, v101
    v_mul_f32 v102, s54, v102
    v_mul_f32 v103, s54, v103
    v_exp_f32 v96, v96
    v_exp_f32 v97, v97
    v_exp_f32 v98, v98
    v_exp_f32 v99, v99
    v_exp_f32 v100, v100
    v_exp_f32 v101, v101
    v_exp_f32 v102, v102
    v_exp_f32 v103, v103
    v_add_f32 v96, 1.0, v96
    v_add_f32 v97, 1.0, v97
    v_add_f32 v98, 1.0, v98
    v_add_f32 v99, 1.0, v99
    v_add_f32 v100, 1.0, v100
    v_add_f32 v101, 1.0, v101
    v_add_f32 v102, 1.0, v102
    v_add_f32 v103, 1.0, v103
    v_rcp_f32 v96, v96
    v_rcp_f32 v97, v97
    v_rcp_f32 v98, v98
    v_rcp_f32 v99, v99
    v_rcp_f32 v100, v100
    v_rcp_f32 v101, v101
    v_rcp_f32 v102, v102
    v_rcp_f32 v103, v103
    v_mul_f32 v96, v96, v136
    v_mul_f32 v97, v97, v137
    v_mul_f32 v98, v98, v138
    v_mul_f32 v99, v99, v139
    v_mul_f32 v100, v100, v140
    v_mul_f32 v101, v101, v141
    v_mul_f32 v102, v102, v142
    v_mul_f32 v103, v103, v143
    v_cvt_pk_bf16_f32 v80, v96, v97
    v_cvt_pk_bf16_f32 v81, v98, v99
    v_cvt_pk_bf16_f32 v82, v100, v101
    v_cvt_pk_bf16_f32 v83, v102, v103
    buffer_store_dwordx4 v[80:83], v1, s[4:7], s30 offen sc1
    s_add_u32 s30, s30, s50
    v_cvt_pk_bf16_f32 v84, v144, v145
    v_cvt_pk_bf16_f32 v85, v146, v147
    v_cvt_pk_bf16_f32 v86, v148, v149
    v_cvt_pk_bf16_f32 v87, v150, v151
    v_lshlrev_b32 v104, 16, v84
    v_and_b32 v105, 0xffff0000, v84
    v_lshlrev_b32 v106, 16, v85
    v_and_b32 v107, 0xffff0000, v85
    v_lshlrev_b32 v108, 16, v86
    v_and_b32 v109, 0xffff0000, v86
    v_lshlrev_b32 v110, 16, v87
    v_and_b32 v111, 0xffff0000, v87
    v_mul_f32 v104, s54, v104
    v_mul_f32 v105, s54, v105
    v_mul_f32 v106, s54, v106
    v_mul_f32 v107, s54, v107
    v_mul_f32 v108, s54, v108
    v_mul_f32 v109, s54, v109
    v_mul_f32 v110, s54, v110
    v_mul_f32 v111, s54, v111
    v_exp_f32 v104, v104
    v_exp_f32 v105, v105
    v_exp_f32 v106, v106
    v_exp_f32 v107, v107
    v_exp_f32 v108, v108
    v_exp_f32 v109, v109
    v_exp_f32 v110, v110
    v_exp_f32 v111, v111
    v_add_f32 v104, 1.0, v104
    v_add_f32 v105, 1.0, v105
    v_add_f32 v106, 1.0, v106
    v_add_f32 v107, 1.0, v107
    v_add_f32 v108, 1.0, v108
    v_add_f32 v109, 1.0, v109
    v_add_f32 v110, 1.0, v110
    v_add_f32 v111, 1.0, v111
    v_rcp_f32 v104, v104
    v_rcp_f32 v105, v105
    v_rcp_f32 v106, v106
    v_rcp_f32 v107, v107
    v_rcp_f32 v108, v108
    v_rcp_f32 v109, v109
    v_rcp_f32 v110, v110
    v_rcp_f32 v111, v111
    v_mul_f32 v104, v104, v152
    v_mul_f32 v105, v105, v153
    v_mul_f32 v106, v106, v154
    v_mul_f32 v107, v107, v155
    v_mul_f32 v108, v108, v156
    v_mul_f32 v109, v109, v157
    v_mul_f32 v110, v110, v158
    v_mul_f32 v111, v111, v159
    v_cvt_pk_bf16_f32 v84, v104, v105
    v_cvt_pk_bf16_f32 v85, v106, v107
    v_cvt_pk_bf16_f32 v86, v108, v109
    v_cvt_pk_bf16_f32 v87, v110, v111
    buffer_store_dwordx4 v[84:87], v1, s[4:7], s30 offen sc1
    s_add_u32 s30, s30, s50
    v_cvt_pk_bf16_f32 v88, v160, v161
    v_cvt_pk_bf16_f32 v89, v162, v163
    v_cvt_pk_bf16_f32 v90, v164, v165
    v_cvt_pk_bf16_f32 v91, v166, v167
    v_lshlrev_b32 v96, 16, v88
    v_and_b32 v97, 0xffff0000, v88
    v_lshlrev_b32 v98, 16, v89
    v_and_b32 v99, 0xffff0000, v89
    v_lshlrev_b32 v100, 16, v90
    v_and_b32 v101, 0xffff0000, v90
    v_lshlrev_b32 v102, 16, v91
    v_and_b32 v103, 0xffff0000, v91
    v_mul_f32 v96, s54, v96
    v_mul_f32 v97, s54, v97
    v_mul_f32 v98, s54, v98
    v_mul_f32 v99, s54, v99
    v_mul_f32 v100, s54, v100
    v_mul_f32 v101, s54, v101
    v_mul_f32 v102, s54, v102
    v_mul_f32 v103, s54, v103
    v_exp_f32 v96, v96
    v_exp_f32 v97, v97
    v_exp_f32 v98, v98
    v_exp_f32 v99, v99
    v_exp_f32 v100, v100
    v_exp_f32 v101, v101
    v_exp_f32 v102, v102
    v_exp_f32 v103, v103
    v_add_f32 v96, 1.0, v96
    v_add_f32 v97, 1.0, v97
    v_add_f32 v98, 1.0, v98
    v_add_f32 v99, 1.0, v99
    v_add_f32 v100, 1.0, v100
    v_add_f32 v101, 1.0, v101
    v_add_f32 v102, 1.0, v102
    v_add_f32 v103, 1.0, v103
    v_rcp_f32 v96, v96
    v_rcp_f32 v97, v97
    v_rcp_f32 v98, v98
    v_rcp_f32 v99, v99
    v_rcp_f32 v100, v100
    v_rcp_f32 v101, v101
    v_rcp_f32 v102, v102
    v_rcp_f32 v103, v103
    v_mul_f32 v96, v96, v168
    v_mul_f32 v97, v97, v169
    v_mul_f32 v98, v98, v170
    v_mul_f32 v99, v99, v171
    v_mul_f32 v100, v100, v172
    v_mul_f32 v101, v101, v173
    v_mul_f32 v102, v102, v174
    v_mul_f32 v103, v103, v175
    v_cvt_pk_bf16_f32 v88, v96, v97
    v_cvt_pk_bf16_f32 v89, v98, v99
    v_cvt_pk_bf16_f32 v90, v100, v101
    v_cvt_pk_bf16_f32 v91, v102, v103
    buffer_store_dwordx4 v[88:91], v1, s[4:7], s30 offen sc1
    s_add_u32 s30, s30, s50
    v_cvt_pk_bf16_f32 v92, v176, v177
    v_cvt_pk_bf16_f32 v93, v178, v179
    v_cvt_pk_bf16_f32 v94, v180, v181
    v_cvt_pk_bf16_f32 v95, v182, v183
    v_lshlrev_b32 v104, 16, v92
    v_and_b32 v105, 0xffff0000, v92
    v_lshlrev_b32 v106, 16, v93
    v_and_b32 v107, 0xffff0000, v93
    v_lshlrev_b32 v108, 16, v94
    v_and_b32 v109, 0xffff0000, v94
    v_lshlrev_b32 v110, 16, v95
    v_and_b32 v111, 0xffff0000, v95
    v_mul_f32 v104, s54, v104
    v_mul_f32 v105, s54, v105
    v_mul_f32 v106, s54, v106
    v_mul_f32 v107, s54, v107
    v_mul_f32 v108, s54, v108
    v_mul_f32 v109, s54, v109
    v_mul_f32 v110, s54, v110
    v_mul_f32 v111, s54, v111
    v_exp_f32 v104, v104
    v_exp_f32 v105, v105
    v_exp_f32 v106, v106
    v_exp_f32 v107, v107
    v_exp_f32 v108, v108
    v_exp_f32 v109, v109
    v_exp_f32 v110, v110
    v_exp_f32 v111, v111
    v_add_f32 v104, 1.0, v104
    v_add_f32 v105, 1.0, v105
    v_add_f32 v106, 1.0, v106
    v_add_f32 v107, 1.0, v107
    v_add_f32 v108, 1.0, v108
    v_add_f32 v109, 1.0, v109
    v_add_f32 v110, 1.0, v110
    v_add_f32 v111, 1.0, v111
    v_rcp_f32 v104, v104
    v_rcp_f32 v105, v105
    v_rcp_f32 v106, v106
    v_rcp_f32 v107, v107
    v_rcp_f32 v108, v108
    v_rcp_f32 v109, v109
    v_rcp_f32 v110, v110
    v_rcp_f32 v111, v111
    v_mul_f32 v104, v104, v184
    v_mul_f32 v105, v105, v185
    v_mul_f32 v106, v106, v186
    v_mul_f32 v107, v107, v187
    v_mul_f32 v108, v108, v188
    v_mul_f32 v109, v109, v189
    v_mul_f32 v110, v110, v190
    v_mul_f32 v111, v111, v191
    v_cvt_pk_bf16_f32 v92, v104, v105
    v_cvt_pk_bf16_f32 v93, v106, v107
    v_cvt_pk_bf16_f32 v94, v108, v109
    v_cvt_pk_bf16_f32 v95, v110, v111
    buffer_store_dwordx4 v[92:95], v1, s[4:7], s30 offen sc1
    s_add_u32 s30, s30, s50
    v_cvt_pk_bf16_f32 v80, v192, v193
    v_cvt_pk_bf16_f32 v81, v194, v195
    v_cvt_pk_bf16_f32 v82, v196, v197
    v_cvt_pk_bf16_f32 v83, v198, v199
    v_lshlrev_b32 v96, 16, v80
    v_and_b32 v97, 0xffff0000, v80
    v_lshlrev_b32 v98, 16, v81
    v_and_b32 v99, 0xffff0000, v81
    v_lshlrev_b32 v100, 16, v82
    v_and_b32 v101, 0xffff0000, v82
    v_lshlrev_b32 v102, 16, v83
    v_and_b32 v103, 0xffff0000, v83
    v_mul_f32 v96, s54, v96
    v_mul_f32 v97, s54, v97
    v_mul_f32 v98, s54, v98
    v_mul_f32 v99, s54, v99
    v_mul_f32 v100, s54, v100
    v_mul_f32 v101, s54, v101
    v_mul_f32 v102, s54, v102
    v_mul_f32 v103, s54, v103
    v_exp_f32 v96, v96
    v_exp_f32 v97, v97
    v_exp_f32 v98, v98
    v_exp_f32 v99, v99
    v_exp_f32 v100, v100
    v_exp_f32 v101, v101
    v_exp_f32 v102, v102
    v_exp_f32 v103, v103
    v_add_f32 v96, 1.0, v96
    v_add_f32 v97, 1.0, v97
    v_add_f32 v98, 1.0, v98
    v_add_f32 v99, 1.0, v99
    v_add_f32 v100, 1.0, v100
    v_add_f32 v101, 1.0, v101
    v_add_f32 v102, 1.0, v102
    v_add_f32 v103, 1.0, v103
    v_rcp_f32 v96, v96
    v_rcp_f32 v97, v97
    v_rcp_f32 v98, v98
    v_rcp_f32 v99, v99
    v_rcp_f32 v100, v100
    v_rcp_f32 v101, v101
    v_rcp_f32 v102, v102
    v_rcp_f32 v103, v103
    v_mul_f32 v96, v96, v200
    v_mul_f32 v97, v97, v201
    v_mul_f32 v98, v98, v202
    v_mul_f32 v99, v99, v203
    v_mul_f32 v100, v100, v204
    v_mul_f32 v101, v101, v205
    v_mul_f32 v102, v102, v206
    v_mul_f32 v103, v103, v207
    v_cvt_pk_bf16_f32 v80, v96, v97
    v_cvt_pk_bf16_f32 v81, v98, v99
    v_cvt_pk_bf16_f32 v82, v100, v101
    v_cvt_pk_bf16_f32 v83, v102, v103
    buffer_store_dwordx4 v[80:83], v1, s[4:7], s30 offen sc1
    s_add_u32 s30, s30, s50
    v_cvt_pk_bf16_f32 v84, v208, v209
    v_cvt_pk_bf16_f32 v85, v210, v211
    v_cvt_pk_bf16_f32 v86, v212, v213
    v_cvt_pk_bf16_f32 v87, v214, v215
    v_lshlrev_b32 v104, 16, v84
    v_and_b32 v105, 0xffff0000, v84
    v_lshlrev_b32 v106, 16, v85
    v_and_b32 v107, 0xffff0000, v85
    v_lshlrev_b32 v108, 16, v86
    v_and_b32 v109, 0xffff0000, v86
    v_lshlrev_b32 v110, 16, v87
    v_and_b32 v111, 0xffff0000, v87
    v_mul_f32 v104, s54, v104
    v_mul_f32 v105, s54, v105
    v_mul_f32 v106, s54, v106
    v_mul_f32 v107, s54, v107
    v_mul_f32 v108, s54, v108
    v_mul_f32 v109, s54, v109
    v_mul_f32 v110, s54, v110
    v_mul_f32 v111, s54, v111
    v_exp_f32 v104, v104
    v_exp_f32 v105, v105
    v_exp_f32 v106, v106
    v_exp_f32 v107, v107
    v_exp_f32 v108, v108
    v_exp_f32 v109, v109
    v_exp_f32 v110, v110
    v_exp_f32 v111, v111
    v_add_f32 v104, 1.0, v104
    v_add_f32 v105, 1.0, v105
    v_add_f32 v106, 1.0, v106
    v_add_f32 v107, 1.0, v107
    v_add_f32 v108, 1.0, v108
    v_add_f32 v109, 1.0, v109
    v_add_f32 v110, 1.0, v110
    v_add_f32 v111, 1.0, v111
    v_rcp_f32 v104, v104
    v_rcp_f32 v105, v105
    v_rcp_f32 v106, v106
    v_rcp_f32 v107, v107
    v_rcp_f32 v108, v108
    v_rcp_f32 v109, v109
    v_rcp_f32 v110, v110
    v_rcp_f32 v111, v111
    v_mul_f32 v104, v104, v216
    v_mul_f32 v105, v105, v217
    v_mul_f32 v106, v106, v218
    v_mul_f32 v107, v107, v219
    v_mul_f32 v108, v108, v220
    v_mul_f32 v109, v109, v221
    v_mul_f32 v110, v110, v222
    v_mul_f32 v111, v111, v223
    v_cvt_pk_bf16_f32 v84, v104, v105
    v_cvt_pk_bf16_f32 v85, v106, v107
    v_cvt_pk_bf16_f32 v86, v108, v109
    v_cvt_pk_bf16_f32 v87, v110, v111
    buffer_store_dwordx4 v[84:87], v1, s[4:7], s30 offen sc1
    s_add_u32 s30, s30, s50
    v_cvt_pk_bf16_f32 v88, v224, v225
    v_cvt_pk_bf16_f32 v89, v226, v227
    v_cvt_pk_bf16_f32 v90, v228, v229
    v_cvt_pk_bf16_f32 v91, v230, v231
    v_lshlrev_b32 v96, 16, v88
    v_and_b32 v97, 0xffff0000, v88
    v_lshlrev_b32 v98, 16, v89
    v_and_b32 v99, 0xffff0000, v89
    v_lshlrev_b32 v100, 16, v90
    v_and_b32 v101, 0xffff0000, v90
    v_lshlrev_b32 v102, 16, v91
    v_and_b32 v103, 0xffff0000, v91
    v_mul_f32 v96, s54, v96
    v_mul_f32 v97, s54, v97
    v_mul_f32 v98, s54, v98
    v_mul_f32 v99, s54, v99
    v_mul_f32 v100, s54, v100
    v_mul_f32 v101, s54, v101
    v_mul_f32 v102, s54, v102
    v_mul_f32 v103, s54, v103
    v_exp_f32 v96, v96
    v_exp_f32 v97, v97
    v_exp_f32 v98, v98
    v_exp_f32 v99, v99
    v_exp_f32 v100, v100
    v_exp_f32 v101, v101
    v_exp_f32 v102, v102
    v_exp_f32 v103, v103
    v_add_f32 v96, 1.0, v96
    v_add_f32 v97, 1.0, v97
    v_add_f32 v98, 1.0, v98
    v_add_f32 v99, 1.0, v99
    v_add_f32 v100, 1.0, v100
    v_add_f32 v101, 1.0, v101
    v_add_f32 v102, 1.0, v102
    v_add_f32 v103, 1.0, v103
    v_rcp_f32 v96, v96
    v_rcp_f32 v97, v97
    v_rcp_f32 v98, v98
    v_rcp_f32 v99, v99
    v_rcp_f32 v100, v100
    v_rcp_f32 v101, v101
    v_rcp_f32 v102, v102
    v_rcp_f32 v103, v103
    v_mul_f32 v96, v96, v232
    v_mul_f32 v97, v97, v233
    v_mul_f32 v98, v98, v234
    v_mul_f32 v99, v99, v235
    v_mul_f32 v100, v100, v236
    v_mul_f32 v101, v101, v237
    v_mul_f32 v102, v102, v238
    v_mul_f32 v103, v103, v239
    v_cvt_pk_bf16_f32 v88, v96, v97
    v_cvt_pk_bf16_f32 v89, v98, v99
    v_cvt_pk_bf16_f32 v90, v100, v101
    v_cvt_pk_bf16_f32 v91, v102, v103
    buffer_store_dwordx4 v[88:91], v1, s[4:7], s30 offen sc1
    s_add_u32 s30, s30, s50
    v_cvt_pk_bf16_f32 v92, v240, v241
    v_cvt_pk_bf16_f32 v93, v242, v243
    v_cvt_pk_bf16_f32 v94, v244, v245
    v_cvt_pk_bf16_f32 v95, v246, v247
    v_lshlrev_b32 v104, 16, v92
    v_and_b32 v105, 0xffff0000, v92
    v_lshlrev_b32 v106, 16, v93
    v_and_b32 v107, 0xffff0000, v93
    v_lshlrev_b32 v108, 16, v94
    v_and_b32 v109, 0xffff0000, v94
    v_lshlrev_b32 v110, 16, v95
    v_and_b32 v111, 0xffff0000, v95
    v_mul_f32 v104, s54, v104
    v_mul_f32 v105, s54, v105
    v_mul_f32 v106, s54, v106
    v_mul_f32 v107, s54, v107
    v_mul_f32 v108, s54, v108
    v_mul_f32 v109, s54, v109
    v_mul_f32 v110, s54, v110
    v_mul_f32 v111, s54, v111
    v_exp_f32 v104, v104
    v_exp_f32 v105, v105
    v_exp_f32 v106, v106
    v_exp_f32 v107, v107
    v_exp_f32 v108, v108
    v_exp_f32 v109, v109
    v_exp_f32 v110, v110
    v_exp_f32 v111, v111
    v_add_f32 v104, 1.0, v104
    v_add_f32 v105, 1.0, v105
    v_add_f32 v106, 1.0, v106
    v_add_f32 v107, 1.0, v107
    v_add_f32 v108, 1.0, v108
    v_add_f32 v109, 1.0, v109
    v_add_f32 v110, 1.0, v110
    v_add_f32 v111, 1.0, v111
    v_rcp_f32 v104, v104
    v_rcp_f32 v105, v105
    v_rcp_f32 v106, v106
    v_rcp_f32 v107, v107
    v_rcp_f32 v108, v108
    v_rcp_f32 v109, v109
    v_rcp_f32 v110, v110
    v_rcp_f32 v111, v111
    v_mul_f32 v104, v104, v248
    v_mul_f32 v105, v105, v249
    v_mul_f32 v106, v106, v250
    v_mul_f32 v107, v107, v251
    v_mul_f32 v108, v108, v252
    v_mul_f32 v109, v109, v253
    v_mul_f32 v110, v110, v254
    v_mul_f32 v111, v111, v255
    v_cvt_pk_bf16_f32 v92, v104, v105
    v_cvt_pk_bf16_f32 v93, v106, v107
    v_cvt_pk_bf16_f32 v94, v108, v109
    v_cvt_pk_bf16_f32 v95, v110, v111
    buffer_store_dwordx4 v[92:95], v1, s[4:7], s30 offen sc1
    s_waitcnt lgkmcnt(0)
    v_or3_b32 v24, v24, v25, v26
    v_or3_b32 v28, v28, v29, v30
    v_or3_b32 v24, v24, v27, v31
    v_or_b32 v24, v24, v28
    s_mov_b32 s28, s51
    s_mov_b32 s57, s53
    v_readfirstlane_b32 s30, v24
    s_cmp_lg_u32 s30, 0
    s_cbranch_scc1 w_drain
    s_mov_b32 s48, s32
    s_cmp_ge_u32 s32, 4
    s_cselect_b32 s30, 2, 3
    s_lshl_b32 s30, s26, s30
    s_mul_i32 s30, s30, s43
    s_add_u32 s49, s42, s30
    s_mov_b32 s50, s43
    s_mov_b32 s51, s46
    s_mov_b32 s23, s41
    s_mov_b32 s53, s47
    s_nop 0
    s_load_dwordx16 s[32:47], s[24:25], 0
    s_add_u32 s24, s24, 64
    s_addc_u32 s25, s25, 0
    s_branch w_first8
w_epi_silu:
    s_lshl_b32 s30, s27, 10
    s_add_u32 s30, s30, s49
    s_mov_b32 s54, 0xbfb8aa3b
    s_nop 7
    v_cvt_pk_bf16_f32 v80, v128, v129
    v_cvt_pk_bf16_f32 v81, v130, v131
    v_cvt_pk_bf16_f32 v82, v132, v133
    v_cvt_pk_bf16_f32 v83, v134, v135
    v_lshlrev_b32 v128, 16, v80
    v_and_b32 v129, 0xffff0000, v80
    v_lshlrev_b32 v130, 16, v81
    v_and_b32 v131, 0xffff0000, v81
    v_lshlrev_b32 v132, 16, v82
    v_and_b32 v133, 0xffff0000, v82
    v_lshlrev_b32 v134, 16, v83
    v_and_b32 v135, 0xffff0000, v83
    v_mul_f32 v104, s54, v128
    v_mul_f32 v105, s54, v129
    v_mul_f32 v106, s54, v130
    v_mul_f32 v107, s54, v131
    v_mul_f32 v108, s54, v132
    v_mul_f32 v109, s54, v133
    v_mul_f32 v110, s54, v134
    v_mul_f32 v111, s54, v135
    v_exp_f32 v104, v104
    v_exp_f32 v105, v105
    v_exp_f32 v106, v106
    v_exp_f32 v107, v107
    v_exp_f32 v108, v108
    v_exp_f32 v109, v109
    v_exp_f32 v110, v110
    v_exp_f32 v111, v111
    v_add_f32 v104, 1.0, v104
    v_add_f32 v105, 1.0, v105
    v_add_f32 v106, 1.0, v106
    v_add_f32 v107, 1.0, v107
    v_add_f32 v108, 1.0, v108
    v_add_f32 v109, 1.0, v109
    v_add_f32 v110, 1.0, v110
    v_add_f32 v111, 1.0, v111
    v_rcp_f32 v104, v104
    v_rcp_f32 v105, v105
    v_rcp_f32 v106, v106
    v_rcp_f32 v107, v107
    v_rcp_f32 v108, v108
    v_rcp_f32 v109, v109
    v_rcp_f32 v110, v110
    v_rcp_f32 v111, v111
    v_mul_f32 v128, v128, v104
    v_mul_f32 v129, v129, v105
    v_mul_f32 v130, v130, v106
    v_mul_f32 v131, v131, v107
    v_mul_f32 v132, v132, v108
    v_mul_f32 v133, v133, v109
    v_mul_f32 v134, v134, v110
    v_mul_f32 v135, v135, v111
    v_cvt_pk_bf16_f32 v80, v128, v129
    v_cvt_pk_bf16_f32 v81, v130, v131
    v_cvt_pk_bf16_f32 v82, v132, v133
    v_cvt_pk_bf16_f32 v83, v134, v135
    buffer_store_dwordx4 v[80:83], v1, s[4:7], s30 offen sc1
    v_cvt_pk_bf16_f32 v84, v136, v137
    v_cvt_pk_bf16_f32 v85, v138, v139
    v_cvt_pk_bf16_f32 v86, v140, v141
    v_cvt_pk_bf16_f32 v87, v142, v143
    v_lshlrev_b32 v136, 16, v84
    v_and_b32 v137, 0xffff0000, v84
    v_lshlrev_b32 v138, 16, v85
    v_and_b32 v139, 0xffff0000, v85
    v_lshlrev_b32 v140, 16, v86
    v_and_b32 v141, 0xffff0000, v86
    v_lshlrev_b32 v142, 16, v87
    v_and_b32 v143, 0xffff0000, v87
    v_mul_f32 v96, s54, v136
    v_mul_f32 v97, s54, v137
    v_mul_f32 v98, s54, v138
    v_mul_f32 v99, s54, v139
    v_mul_f32 v100, s54, v140
    v_mul_f32 v101, s54, v141
    v_mul_f32 v102, s54, v142
    v_mul_f32 v103, s54, v143
    v_exp_f32 v96, v96
    v_exp_f32 v97, v97
    v_exp_f32 v98, v98
    v_exp_f32 v99, v99
    v_exp_f32 v100, v100
    v_exp_f32 v101, v101
    v_exp_f32 v102, v102
    v_exp_f32 v103, v103
    v_add_f32 v96, 1.0, v96
    v_add_f32 v97, 1.0, v97
    v_add_f32 v98, 1.0, v98
    v_add_f32 v99, 1.0, v99
    v_add_f32 v100, 1.0, v100
    v_add_f32 v101, 1.0, v101
    v_add_f32 v102, 1.0, v102
    v_add_f32 v103, 1.0, v103
    v_rcp_f32 v96, v96
    v_rcp_f32 v97, v97
    v_rcp_f32 v98, v98
    v_rcp_f32 v99, v99
    v_rcp_f32 v100, v100
    v_rcp_f32 v101, v101
    v_rcp_f32 v102, v102
    v_rcp_f32 v103, v103
    v_mul_f32 v136, v136, v96
    v_mul_f32 v137, v137, v97
    v_mul_f32 v138, v138, v98
    v_mul_f32 v139, v139, v99
    v_mul_f32 v140, v140, v100
    v_mul_f32 v141, v141, v101
    v_mul_f32 v142, v142, v102
    v_mul_f32 v143, v143, v103
    v_cvt_pk_bf16_f32 v84, v136, v137
    v_cvt_pk_bf16_f32 v85, v138, v139
    v_cvt_pk_bf16_f32 v86, v140, v141
    v_cvt_pk_bf16_f32 v87, v142, v143
    buffer_store_dwordx4 v[84:87], v19, s[4:7], s30 offen sc1
    s_add_u32 s30, s30, s50
    v_cvt_pk_bf16_f32 v88, v144, v145
    v_cvt_pk_bf16_f32 v89, v146, v147
    v_cvt_pk_bf16_f32 v90, v148, v149
    v_cvt_pk_bf16_f32 v91, v150, v151
    v_lshlrev_b32 v144, 16, v88
    v_and_b32 v145, 0xffff0000, v88
    v_lshlrev_b32 v146, 16, v89
    v_and_b32 v147, 0xffff0000, v89
    v_lshlrev_b32 v148, 16, v90
    v_and_b32 v149, 0xffff0000, v90
    v_lshlrev_b32 v150, 16, v91
    v_and_b32 v151, 0xffff0000, v91
    v_mul_f32 v104, s54, v144
    v_mul_f32 v105, s54, v145
    v_mul_f32 v106, s54, v146
    v_mul_f32 v107, s54, v147
    v_mul_f32 v108, s54, v148
    v_mul_f32 v109, s54, v149
    v_mul_f32 v110, s54, v150
    v_mul_f32 v111, s54, v151
    v_exp_f32 v104, v104
    v_exp_f32 v105, v105
    v_exp_f32 v106, v106
    v_exp_f32 v107, v107
    v_exp_f32 v108, v108
    v_exp_f32 v109, v109
    v_exp_f32 v110, v110
    v_exp_f32 v111, v111
    v_add_f32 v104, 1.0, v104
    v_add_f32 v105, 1.0, v105
    v_add_f32 v106, 1.0, v106
    v_add_f32 v107, 1.0, v107
    v_add_f32 v108, 1.0, v108
    v_add_f32 v109, 1.0, v109
    v_add_f32 v110, 1.0, v110
    v_add_f32 v111, 1.0, v111
    v_rcp_f32 v104, v104
    v_rcp_f32 v105, v105
    v_rcp_f32 v106, v106
    v_rcp_f32 v107, v107
    v_rcp_f32 v108, v108
    v_rcp_f32 v109, v109
    v_rcp_f32 v110, v110
    v_rcp_f32 v111, v111
    v_mul_f32 v144, v144, v104
    v_mul_f32 v145, v145, v105
    v_mul_f32 v146, v146, v106
    v_mul_f32 v147, v147, v107
    v_mul_f32 v148, v148, v108
    v_mul_f32 v149, v149, v109
    v_mul_f32 v150, v150, v110
    v_mul_f32 v151, v151, v111
    v_cvt_pk_bf16_f32 v88, v144, v145
    v_cvt_pk_bf16_f32 v89, v146, v147
    v_cvt_pk_bf16_f32 v90, v148, v149
    v_cvt_pk_bf16_f32 v91, v150, v151
    buffer_store_dwordx4 v[88:91], v1, s[4:7], s30 offen sc1
    v_cvt_pk_bf16_f32 v92, v152, v153
    v_cvt_pk_bf16_f32 v93, v154, v155
    v_cvt_pk_bf16_f32 v94, v156, v157
    v_cvt_pk_bf16_f32 v95, v158, v159
    v_lshlrev_b32 v152, 16, v92
    v_and_b32 v153, 0xffff0000, v92
    v_lshlrev_b32 v154, 16, v93
    v_and_b32 v155, 0xffff0000, v93
    v_lshlrev_b32 v156, 16, v94
    v_and_b32 v157, 0xffff0000, v94
    v_lshlrev_b32 v158, 16, v95
    v_and_b32 v159, 0xffff0000, v95
    v_mul_f32 v96, s54, v152
    v_mul_f32 v97, s54, v153
    v_mul_f32 v98, s54, v154
    v_mul_f32 v99, s54, v155
    v_mul_f32 v100, s54, v156
    v_mul_f32 v101, s54, v157
    v_mul_f32 v102, s54, v158
    v_mul_f32 v103, s54, v159
    v_exp_f32 v96, v96
    v_exp_f32 v97, v97
    v_exp_f32 v98, v98
    v_exp_f32 v99, v99
    v_exp_f32 v100, v100
    v_exp_f32 v101, v101
    v_exp_f32 v102, v102
    v_exp_f32 v103, v103
    v_add_f32 v96, 1.0, v96
    v_add_f32 v97, 1.0, v97
    v_add_f32 v98, 1.0, v98
    v_add_f32 v99, 1.0, v99
    v_add_f32 v100, 1.0, v100
    v_add_f32 v101, 1.0, v101
    v_add_f32 v102, 1.0, v102
    v_add_f32 v103, 1.0, v103
    v_rcp_f32 v96, v96
    v_rcp_f32 v97, v97
    v_rcp_f32 v98, v98
    v_rcp_f32 v99, v99
    v_rcp_f32 v100, v100
    v_rcp_f32 v101, v101
    v_rcp_f32 v102, v102
    v_rcp_f32 v103, v103
    v_mul_f32 v152, v152, v96
    v_mul_f32 v153, v153, v97
    v_mul_f32 v154, v154, v98
    v_mul_f32 v155, v155, v99
    v_mul_f32 v156, v156, v100
    v_mul_f32 v157, v157, v101
    v_mul_f32 v158, v158, v102
    v_mul_f32 v159, v159, v103
    v_cvt_pk_bf16_f32 v92, v152, v153
    v_cvt_pk_bf16_f32 v93, v154, v155
    v_cvt_pk_bf16_f32 v94, v156, v157
    v_cvt_pk_bf16_f32 v95, v158, v159
    buffer_store_dwordx4 v[92:95], v19, s[4:7], s30 offen sc1
    s_add_u32 s30, s30, s50
    v_cvt_pk_bf16_f32 v80, v160, v161
    v_cvt_pk_bf16_f32 v81, v162, v163
    v_cvt_pk_bf16_f32 v82, v164, v165
    v_cvt_pk_bf16_f32 v83, v166, v167
    v_lshlrev_b32 v160, 16, v80
    v_and_b32 v161, 0xffff0000, v80
    v_lshlrev_b32 v162, 16, v81
    v_and_b32 v163, 0xffff0000, v81
    v_lshlrev_b32 v164, 16, v82
    v_and_b32 v165, 0xffff0000, v82
    v_lshlrev_b32 v166, 16, v83
    v_and_b32 v167, 0xffff0000, v83
    v_mul_f32 v104, s54, v160
    v_mul_f32 v105, s54, v161
    v_mul_f32 v106, s54, v162
    v_mul_f32 v107, s54, v163
    v_mul_f32 v108, s54, v164
    v_mul_f32 v109, s54, v165
    v_mul_f32 v110, s54, v166
    v_mul_f32 v111, s54, v167
    v_exp_f32 v104, v104
    v_exp_f32 v105, v105
    v_exp_f32 v106, v106
    v_exp_f32 v107, v107
    v_exp_f32 v108, v108
    v_exp_f32 v109, v109
    v_exp_f32 v110, v110
    v_exp_f32 v111, v111
    v_add_f32 v104, 1.0, v104
    v_add_f32 v105, 1.0, v105
    v_add_f32 v106, 1.0, v106
    v_add_f32 v107, 1.0, v107
    v_add_f32 v108, 1.0, v108
    v_add_f32 v109, 1.0, v109
    v_add_f32 v110, 1.0, v110
    v_add_f32 v111, 1.0, v111
    v_rcp_f32 v104, v104
    v_rcp_f32 v105, v105
    v_rcp_f32 v106, v106
    v_rcp_f32 v107, v107
    v_rcp_f32 v108, v108
    v_rcp_f32 v109, v109
    v_rcp_f32 v110, v110
    v_rcp_f32 v111, v111
    v_mul_f32 v160, v160, v104
    v_mul_f32 v161, v161, v105
    v_mul_f32 v162, v162, v106
    v_mul_f32 v163, v163, v107
    v_mul_f32 v164, v164, v108
    v_mul_f32 v165, v165, v109
    v_mul_f32 v166, v166, v110
    v_mul_f32 v167, v167, v111
    v_cvt_pk_bf16_f32 v80, v160, v161
    v_cvt_pk_bf16_f32 v81, v162, v163
    v_cvt_pk_bf16_f32 v82, v164, v165
    v_cvt_pk_bf16_f32 v83, v166, v167
    buffer_store_dwordx4 v[80:83], v1, s[4:7], s30 offen sc1
    v_cvt_pk_bf16_f32 v84, v168, v169
    v_cvt_pk_bf16_f32 v85, v170, v171
    v_cvt_pk_bf16_f32 v86, v172, v173
    v_cvt_pk_bf16_f32 v87, v174, v175
    v_lshlrev_b32 v168, 16, v84
    v_and_b32 v169, 0xffff0000, v84
    v_lshlrev_b32 v170, 16, v85
    v_and_b32 v171, 0xffff0000, v85
    v_lshlrev_b32 v172, 16, v86
    v_and_b32 v173, 0xffff0000, v86
    v_lshlrev_b32 v174, 16, v87
    v_and_b32 v175, 0xffff0000, v87
    v_mul_f32 v96, s54, v168
    v_mul_f32 v97, s54, v169
    v_mul_f32 v98, s54, v170
    v_mul_f32 v99, s54, v171
    v_mul_f32 v100, s54, v172
    v_mul_f32 v101, s54, v173
    v_mul_f32 v102, s54, v174
    v_mul_f32 v103, s54, v175
    v_exp_f32 v96, v96
    v_exp_f32 v97, v97
    v_exp_f32 v98, v98
    v_exp_f32 v99, v99
    v_exp_f32 v100, v100
    v_exp_f32 v101, v101
    v_exp_f32 v102, v102
    v_exp_f32 v103, v103
    v_add_f32 v96, 1.0, v96
    v_add_f32 v97, 1.0, v97
    v_add_f32 v98, 1.0, v98
    v_add_f32 v99, 1.0, v99
    v_add_f32 v100, 1.0, v100
    v_add_f32 v101, 1.0, v101
    v_add_f32 v102, 1.0, v102
    v_add_f32 v103, 1.0, v103
    v_rcp_f32 v96, v96
    v_rcp_f32 v97, v97
    v_rcp_f32 v98, v98
    v_rcp_f32 v99, v99
    v_rcp_f32 v100, v100
    v_rcp_f32 v101, v101
    v_rcp_f32 v102, v102
    v_rcp_f32 v103, v103
    v_mul_f32 v168, v168, v96
    v_mul_f32 v169, v169, v97
    v_mul_f32 v170, v170, v98
    v_mul_f32 v171, v171, v99
    v_mul_f32 v172, v172, v100
    v_mul_f32 v173, v173, v101
    v_mul_f32 v174, v174, v102
    v_mul_f32 v175, v175, v103
    v_cvt_pk_bf16_f32 v84, v168, v169
    v_cvt_pk_bf16_f32 v85, v170, v171
    v_cvt_pk_bf16_f32 v86, v172, v173
    v_cvt_pk_bf16_f32 v87, v174, v175
    buffer_store_dwordx4 v[84:87], v19, s[4:7], s30 offen sc1
    s_add_u32 s30, s30, s50
    v_cvt_pk_bf16_f32 v88, v176, v177
    v_cvt_pk_bf16_f32 v89, v178, v179
    v_cvt_pk_bf16_f32 v90, v180, v181
    v_cvt_pk_bf16_f32 v91, v182, v183
    v_lshlrev_b32 v176, 16, v88
    v_and_b32 v177, 0xffff0000, v88
    v_lshlrev_b32 v178, 16, v89
    v_and_b32 v179, 0xffff0000, v89
    v_lshlrev_b32 v180, 16, v90
    v_and_b32 v181, 0xffff0000, v90
    v_lshlrev_b32 v182, 16, v91
    v_and_b32 v183, 0xffff0000, v91
    v_mul_f32 v104, s54, v176
    v_mul_f32 v105, s54, v177
    v_mul_f32 v106, s54, v178
    v_mul_f32 v107, s54, v179
    v_mul_f32 v108, s54, v180
    v_mul_f32 v109, s54, v181
    v_mul_f32 v110, s54, v182
    v_mul_f32 v111, s54, v183
    v_exp_f32 v104, v104
    v_exp_f32 v105, v105
    v_exp_f32 v106, v106
    v_exp_f32 v107, v107
    v_exp_f32 v108, v108
    v_exp_f32 v109, v109
    v_exp_f32 v110, v110
    v_exp_f32 v111, v111
    v_add_f32 v104, 1.0, v104
    v_add_f32 v105, 1.0, v105
    v_add_f32 v106, 1.0, v106
    v_add_f32 v107, 1.0, v107
    v_add_f32 v108, 1.0, v108
    v_add_f32 v109, 1.0, v109
    v_add_f32 v110, 1.0, v110
    v_add_f32 v111, 1.0, v111
    v_rcp_f32 v104, v104
    v_rcp_f32 v105, v105
    v_rcp_f32 v106, v106
    v_rcp_f32 v107, v107
    v_rcp_f32 v108, v108
    v_rcp_f32 v109, v109
    v_rcp_f32 v110, v110
    v_rcp_f32 v111, v111
    v_mul_f32 v176, v176, v104
    v_mul_f32 v177, v177, v105
    v_mul_f32 v178, v178, v106
    v_mul_f32 v179, v179, v107
    v_mul_f32 v180, v180, v108
    v_mul_f32 v181, v181, v109
    v_mul_f32 v182, v182, v110
    v_mul_f32 v183, v183, v111
    v_cvt_pk_bf16_f32 v88, v176, v177
    v_cvt_pk_bf16_f32 v89, v178, v179
    v_cvt_pk_bf16_f32 v90, v180, v181
    v_cvt_pk_bf16_f32 v91, v182, v183
    buffer_store_dwordx4 v[88:91], v1, s[4:7], s30 offen sc1
    v_cvt_pk_bf16_f32 v92, v184, v185
    v_cvt_pk_bf16_f32 v93, v186, v187
    v_cvt_pk_bf16_f32 v94, v188, v189
    v_cvt_pk_bf16_f32 v95, v190, v191
    v_lshlrev_b32 v184, 16, v92
    v_and_b32 v185, 0xffff0000, v92
    v_lshlrev_b32 v186, 16, v93
    v_and_b32 v187, 0xffff0000, v93
    v_lshlrev_b32 v188, 16, v94
    v_and_b32 v189, 0xffff0000, v94
    v_lshlrev_b32 v190, 16, v95
    v_and_b32 v191, 0xffff0000, v95
    v_mul_f32 v96, s54, v184
    v_mul_f32 v97, s54, v185
    v_mul_f32 v98, s54, v186
    v_mul_f32 v99, s54, v187
    v_mul_f32 v100, s54, v188
    v_mul_f32 v101, s54, v189
    v_mul_f32 v102, s54, v190
    v_mul_f32 v103, s54, v191
    v_exp_f32 v96, v96
    v_exp_f32 v97, v97
    v_exp_f32 v98, v98
    v_exp_f32 v99, v99
    v_exp_f32 v100, v100
    v_exp_f32 v101, v101
    v_exp_f32 v102, v102
    v_exp_f32 v103, v103
    v_add_f32 v96, 1.0, v96
    v_add_f32 v97, 1.0, v97
    v_add_f32 v98, 1.0, v98
    v_add_f32 v99, 1.0, v99
    v_add_f32 v100, 1.0, v100
    v_add_f32 v101, 1.0, v101
    v_add_f32 v102, 1.0, v102
    v_add_f32 v103, 1.0, v103
    v_rcp_f32 v96, v96
    v_rcp_f32 v97, v97
    v_rcp_f32 v98, v98
    v_rcp_f32 v99, v99
    v_rcp_f32 v100, v100
    v_rcp_f32 v101, v101
    v_rcp_f32 v102, v102
    v_rcp_f32 v103, v103
    v_mul_f32 v184, v184, v96
    v_mul_f32 v185, v185, v97
    v_mul_f32 v186, v186, v98
    v_mul_f32 v187, v187, v99
    v_mul_f32 v188, v188, v100
    v_mul_f32 v189, v189, v101
    v_mul_f32 v190, v190, v102
    v_mul_f32 v191, v191, v103
    v_cvt_pk_bf16_f32 v92, v184, v185
    v_cvt_pk_bf16_f32 v93, v186, v187
    v_cvt_pk_bf16_f32 v94, v188, v189
    v_cvt_pk_bf16_f32 v95, v190, v191
    buffer_store_dwordx4 v[92:95], v19, s[4:7], s30 offen sc1
    s_add_u32 s30, s30, s50
    v_cvt_pk_bf16_f32 v80, v192, v193
    v_cvt_pk_bf16_f32 v81, v194, v195
    v_cvt_pk_bf16_f32 v82, v196, v197
    v_cvt_pk_bf16_f32 v83, v198, v199
    v_lshlrev_b32 v192, 16, v80
    v_and_b32 v193, 0xffff0000, v80
    v_lshlrev_b32 v194, 16, v81
    v_and_b32 v195, 0xffff0000, v81
    v_lshlrev_b32 v196, 16, v82
    v_and_b32 v197, 0xffff0000, v82
    v_lshlrev_b32 v198, 16, v83
    v_and_b32 v199, 0xffff0000, v83
    v_mul_f32 v104, s54, v192
    v_mul_f32 v105, s54, v193
    v_mul_f32 v106, s54, v194
    v_mul_f32 v107, s54, v195
    v_mul_f32 v108, s54, v196
    v_mul_f32 v109, s54, v197
    v_mul_f32 v110, s54, v198
    v_mul_f32 v111, s54, v199
    v_exp_f32 v104, v104
    v_exp_f32 v105, v105
    v_exp_f32 v106, v106
    v_exp_f32 v107, v107
    v_exp_f32 v108, v108
    v_exp_f32 v109, v109
    v_exp_f32 v110, v110
    v_exp_f32 v111, v111
    v_add_f32 v104, 1.0, v104
    v_add_f32 v105, 1.0, v105
    v_add_f32 v106, 1.0, v106
    v_add_f32 v107, 1.0, v107
    v_add_f32 v108, 1.0, v108
    v_add_f32 v109, 1.0, v109
    v_add_f32 v110, 1.0, v110
    v_add_f32 v111, 1.0, v111
    v_rcp_f32 v104, v104
    v_rcp_f32 v105, v105
    v_rcp_f32 v106, v106
    v_rcp_f32 v107, v107
    v_rcp_f32 v108, v108
    v_rcp_f32 v109, v109
    v_rcp_f32 v110, v110
    v_rcp_f32 v111, v111
    v_mul_f32 v192, v192, v104
    v_mul_f32 v193, v193, v105
    v_mul_f32 v194, v194, v106
    v_mul_f32 v195, v195, v107
    v_mul_f32 v196, v196, v108
    v_mul_f32 v197, v197, v109
    v_mul_f32 v198, v198, v110
    v_mul_f32 v199, v199, v111
    v_cvt_pk_bf16_f32 v80, v192, v193
    v_cvt_pk_bf16_f32 v81, v194, v195
    v_cvt_pk_bf16_f32 v82, v196, v197
    v_cvt_pk_bf16_f32 v83, v198, v199
    buffer_store_dwordx4 v[80:83], v1, s[4:7], s30 offen sc1
    v_cvt_pk_bf16_f32 v84, v200, v201
    v_cvt_pk_bf16_f32 v85, v202, v203
    v_cvt_pk_bf16_f32 v86, v204, v205
    v_cvt_pk_bf16_f32 v87, v206, v207
    v_lshlrev_b32 v200, 16, v84
    v_and_b32 v201, 0xffff0000, v84
    v_lshlrev_b32 v202, 16, v85
    v_and_b32 v203, 0xffff0000, v85
    v_lshlrev_b32 v204, 16, v86
    v_and_b32 v205, 0xffff0000, v86
    v_lshlrev_b32 v206, 16, v87
    v_and_b32 v207, 0xffff0000, v87
    v_mul_f32 v96, s54, v200
    v_mul_f32 v97, s54, v201
    v_mul_f32 v98, s54, v202
    v_mul_f32 v99, s54, v203
    v_mul_f32 v100, s54, v204
    v_mul_f32 v101, s54, v205
    v_mul_f32 v102, s54, v206
    v_mul_f32 v103, s54, v207
    v_exp_f32 v96, v96
    v_exp_f32 v97, v97
    v_exp_f32 v98, v98
    v_exp_f32 v99, v99
    v_exp_f32 v100, v100
    v_exp_f32 v101, v101
    v_exp_f32 v102, v102
    v_exp_f32 v103, v103
    v_add_f32 v96, 1.0, v96
    v_add_f32 v97, 1.0, v97
    v_add_f32 v98, 1.0, v98
    v_add_f32 v99, 1.0, v99
    v_add_f32 v100, 1.0, v100
    v_add_f32 v101, 1.0, v101
    v_add_f32 v102, 1.0, v102
    v_add_f32 v103, 1.0, v103
    v_rcp_f32 v96, v96
    v_rcp_f32 v97, v97
    v_rcp_f32 v98, v98
    v_rcp_f32 v99, v99
    v_rcp_f32 v100, v100
    v_rcp_f32 v101, v101
    v_rcp_f32 v102, v102
    v_rcp_f32 v103, v103
    v_mul_f32 v200, v200, v96
    v_mul_f32 v201, v201, v97
    v_mul_f32 v202, v202, v98
    v_mul_f32 v203, v203, v99
    v_mul_f32 v204, v204, v100
    v_mul_f32 v205, v205, v101
    v_mul_f32 v206, v206, v102
    v_mul_f32 v207, v207, v103
    v_cvt_pk_bf16_f32 v84, v200, v201
    v_cvt_pk_bf16_f32 v85, v202, v203
    v_cvt_pk_bf16_f32 v86, v204, v205
    v_cvt_pk_bf16_f32 v87, v206, v207
    buffer_store_dwordx4 v[84:87], v19, s[4:7], s30 offen sc1
    s_add_u32 s30, s30, s50
    v_cvt_pk_bf16_f32 v88, v208, v209
    v_cvt_pk_bf16_f32 v89, v210, v211
    v_cvt_pk_bf16_f32 v90, v212, v213
    v_cvt_pk_bf16_f32 v91, v214, v215
    v_lshlrev_b32 v208, 16, v88
    v_and_b32 v209, 0xffff0000, v88
    v_lshlrev_b32 v210, 16, v89
    v_and_b32 v211, 0xffff0000, v89
    v_lshlrev_b32 v212, 16, v90
    v_and_b32 v213, 0xffff0000, v90
    v_lshlrev_b32 v214, 16, v91
    v_and_b32 v215, 0xffff0000, v91
    v_mul_f32 v104, s54, v208
    v_mul_f32 v105, s54, v209
    v_mul_f32 v106, s54, v210
    v_mul_f32 v107, s54, v211
    v_mul_f32 v108, s54, v212
    v_mul_f32 v109, s54, v213
    v_mul_f32 v110, s54, v214
    v_mul_f32 v111, s54, v215
    v_exp_f32 v104, v104
    v_exp_f32 v105, v105
    v_exp_f32 v106, v106
    v_exp_f32 v107, v107
    v_exp_f32 v108, v108
    v_exp_f32 v109, v109
    v_exp_f32 v110, v110
    v_exp_f32 v111, v111
    v_add_f32 v104, 1.0, v104
    v_add_f32 v105, 1.0, v105
    v_add_f32 v106, 1.0, v106
    v_add_f32 v107, 1.0, v107
    v_add_f32 v108, 1.0, v108
    v_add_f32 v109, 1.0, v109
    v_add_f32 v110, 1.0, v110
    v_add_f32 v111, 1.0, v111
    v_rcp_f32 v104, v104
    v_rcp_f32 v105, v105
    v_rcp_f32 v106, v106
    v_rcp_f32 v107, v107
    v_rcp_f32 v108, v108
    v_rcp_f32 v109, v109
    v_rcp_f32 v110, v110
    v_rcp_f32 v111, v111
    v_mul_f32 v208, v208, v104
    v_mul_f32 v209, v209, v105
    v_mul_f32 v210, v210, v106
    v_mul_f32 v211, v211, v107
    v_mul_f32 v212, v212, v108
    v_mul_f32 v213, v213, v109
    v_mul_f32 v214, v214, v110
    v_mul_f32 v215, v215, v111
    v_cvt_pk_bf16_f32 v88, v208, v209
    v_cvt_pk_bf16_f32 v89, v210, v211
    v_cvt_pk_bf16_f32 v90, v212, v213
    v_cvt_pk_bf16_f32 v91, v214, v215
    buffer_store_dwordx4 v[88:91], v1, s[4:7], s30 offen sc1
    v_cvt_pk_bf16_f32 v92, v216, v217
    v_cvt_pk_bf16_f32 v93, v218, v219
    v_cvt_pk_bf16_f32 v94, v220, v221
    v_cvt_pk_bf16_f32 v95, v222, v223
    v_lshlrev_b32 v216, 16, v92
    v_and_b32 v217, 0xffff0000, v92
    v_lshlrev_b32 v218, 16, v93
    v_and_b32 v219, 0xffff0000, v93
    v_lshlrev_b32 v220, 16, v94
    v_and_b32 v221, 0xffff0000, v94
    v_lshlrev_b32 v222, 16, v95
    v_and_b32 v223, 0xffff0000, v95
    v_mul_f32 v96, s54, v216
    v_mul_f32 v97, s54, v217
    v_mul_f32 v98, s54, v218
    v_mul_f32 v99, s54, v219
    v_mul_f32 v100, s54, v220
    v_mul_f32 v101, s54, v221
    v_mul_f32 v102, s54, v222
    v_mul_f32 v103, s54, v223
    v_exp_f32 v96, v96
    v_exp_f32 v97, v97
    v_exp_f32 v98, v98
    v_exp_f32 v99, v99
    v_exp_f32 v100, v100
    v_exp_f32 v101, v101
    v_exp_f32 v102, v102
    v_exp_f32 v103, v103
    v_add_f32 v96, 1.0, v96
    v_add_f32 v97, 1.0, v97
    v_add_f32 v98, 1.0, v98
    v_add_f32 v99, 1.0, v99
    v_add_f32 v100, 1.0, v100
    v_add_f32 v101, 1.0, v101
    v_add_f32 v102, 1.0, v102
    v_add_f32 v103, 1.0, v103
    v_rcp_f32 v96, v96
    v_rcp_f32 v97, v97
    v_rcp_f32 v98, v98
    v_rcp_f32 v99, v99
    v_rcp_f32 v100, v100
    v_rcp_f32 v101, v101
    v_rcp_f32 v102, v102
    v_rcp_f32 v103, v103
    v_mul_f32 v216, v216, v96
    v_mul_f32 v217, v217, v97
    v_mul_f32 v218, v218, v98
    v_mul_f32 v219, v219, v99
    v_mul_f32 v220, v220, v100
    v_mul_f32 v221, v221, v101
    v_mul_f32 v222, v222, v102
    v_mul_f32 v223, v223, v103
    v_cvt_pk_bf16_f32 v92, v216, v217
    v_cvt_pk_bf16_f32 v93, v218, v219
    v_cvt_pk_bf16_f32 v94, v220, v221
    v_cvt_pk_bf16_f32 v95, v222, v223
    buffer_store_dwordx4 v[92:95], v19, s[4:7], s30 offen sc1
    s_add_u32 s30, s30, s50
    v_cvt_pk_bf16_f32 v80, v224, v225
    v_cvt_pk_bf16_f32 v81, v226, v227
    v_cvt_pk_bf16_f32 v82, v228, v229
    v_cvt_pk_bf16_f32 v83, v230, v231
    v_lshlrev_b32 v224, 16, v80
    v_and_b32 v225, 0xffff0000, v80
    v_lshlrev_b32 v226, 16, v81
    v_and_b32 v227, 0xffff0000, v81
    v_lshlrev_b32 v228, 16, v82
    v_and_b32 v229, 0xffff0000, v82
    v_lshlrev_b32 v230, 16, v83
    v_and_b32 v231, 0xffff0000, v83
    v_mul_f32 v104, s54, v224
    v_mul_f32 v105, s54, v225
    v_mul_f32 v106, s54, v226
    v_mul_f32 v107, s54, v227
    v_mul_f32 v108, s54, v228
    v_mul_f32 v109, s54, v229
    v_mul_f32 v110, s54, v230
    v_mul_f32 v111, s54, v231
    v_exp_f32 v104, v104
    v_exp_f32 v105, v105
    v_exp_f32 v106, v106
    v_exp_f32 v107, v107
    v_exp_f32 v108, v108
    v_exp_f32 v109, v109
    v_exp_f32 v110, v110
    v_exp_f32 v111, v111
    v_add_f32 v104, 1.0, v104
    v_add_f32 v105, 1.0, v105
    v_add_f32 v106, 1.0, v106
    v_add_f32 v107, 1.0, v107
    v_add_f32 v108, 1.0, v108
    v_add_f32 v109, 1.0, v109
    v_add_f32 v110, 1.0, v110
    v_add_f32 v111, 1.0, v111
    v_rcp_f32 v104, v104
    v_rcp_f32 v105, v105
    v_rcp_f32 v106, v106
    v_rcp_f32 v107, v107
    v_rcp_f32 v108, v108
    v_rcp_f32 v109, v109
    v_rcp_f32 v110, v110
    v_rcp_f32 v111, v111
    v_mul_f32 v224, v224, v104
    v_mul_f32 v225, v225, v105
    v_mul_f32 v226, v226, v106
    v_mul_f32 v227, v227, v107
    v_mul_f32 v228, v228, v108
    v_mul_f32 v229, v229, v109
    v_mul_f32 v230, v230, v110
    v_mul_f32 v231, v231, v111
    v_cvt_pk_bf16_f32 v80, v224, v225
    v_cvt_pk_bf16_f32 v81, v226, v227
    v_cvt_pk_bf16_f32 v82, v228, v229
    v_cvt_pk_bf16_f32 v83, v230, v231
    buffer_store_dwordx4 v[80:83], v1, s[4:7], s30 offen sc1
    v_cvt_pk_bf16_f32 v84, v232, v233
    v_cvt_pk_bf16_f32 v85, v234, v235
    v_cvt_pk_bf16_f32 v86, v236, v237
    v_cvt_pk_bf16_f32 v87, v238, v239
    v_lshlrev_b32 v232, 16, v84
    v_and_b32 v233, 0xffff0000, v84
    v_lshlrev_b32 v234, 16, v85
    v_and_b32 v235, 0xffff0000, v85
    v_lshlrev_b32 v236, 16, v86
    v_and_b32 v237, 0xffff0000, v86
    v_lshlrev_b32 v238, 16, v87
    v_and_b32 v239, 0xffff0000, v87
    v_mul_f32 v96, s54, v232
    v_mul_f32 v97, s54, v233
    v_mul_f32 v98, s54, v234
    v_mul_f32 v99, s54, v235
    v_mul_f32 v100, s54, v236
    v_mul_f32 v101, s54, v237
    v_mul_f32 v102, s54, v238
    v_mul_f32 v103, s54, v239
    v_exp_f32 v96, v96
    v_exp_f32 v97, v97
    v_exp_f32 v98, v98
    v_exp_f32 v99, v99
    v_exp_f32 v100, v100
    v_exp_f32 v101, v101
    v_exp_f32 v102, v102
    v_exp_f32 v103, v103
    v_add_f32 v96, 1.0, v96
    v_add_f32 v97, 1.0, v97
    v_add_f32 v98, 1.0, v98
    v_add_f32 v99, 1.0, v99
    v_add_f32 v100, 1.0, v100
    v_add_f32 v101, 1.0, v101
    v_add_f32 v102, 1.0, v102
    v_add_f32 v103, 1.0, v103
    v_rcp_f32 v96, v96
    v_rcp_f32 v97, v97
    v_rcp_f32 v98, v98
    v_rcp_f32 v99, v99
    v_rcp_f32 v100, v100
    v_rcp_f32 v101, v101
    v_rcp_f32 v102, v102
    v_rcp_f32 v103, v103
    v_mul_f32 v232, v232, v96
    v_mul_f32 v233, v233, v97
    v_mul_f32 v234, v234, v98
    v_mul_f32 v235, v235, v99
    v_mul_f32 v236, v236, v100
    v_mul_f32 v237, v237, v101
    v_mul_f32 v238, v238, v102
    v_mul_f32 v239, v239, v103
    v_cvt_pk_bf16_f32 v84, v232, v233
    v_cvt_pk_bf16_f32 v85, v234, v235
    v_cvt_pk_bf16_f32 v86, v236, v237
    v_cvt_pk_bf16_f32 v87, v238, v239
    buffer_store_dwordx4 v[84:87], v19, s[4:7], s30 offen sc1
    s_add_u32 s30, s30, s50
    v_cvt_pk_bf16_f32 v88, v240, v241
    v_cvt_pk_bf16_f32 v89, v242, v243
    v_cvt_pk_bf16_f32 v90, v244, v245
    v_cvt_pk_bf16_f32 v91, v246, v247
    v_lshlrev_b32 v240, 16, v88
    v_and_b32 v241, 0xffff0000, v88
    v_lshlrev_b32 v242, 16, v89
    v_and_b32 v243, 0xffff0000, v89
    v_lshlrev_b32 v244, 16, v90
    v_and_b32 v245, 0xffff0000, v90
    v_lshlrev_b32 v246, 16, v91
    v_and_b32 v247, 0xffff0000, v91
    v_mul_f32 v104, s54, v240
    v_mul_f32 v105, s54, v241
    v_mul_f32 v106, s54, v242
    v_mul_f32 v107, s54, v243
    v_mul_f32 v108, s54, v244
    v_mul_f32 v109, s54, v245
    v_mul_f32 v110, s54, v246
    v_mul_f32 v111, s54, v247
    v_exp_f32 v104, v104
    v_exp_f32 v105, v105
    v_exp_f32 v106, v106
    v_exp_f32 v107, v107
    v_exp_f32 v108, v108
    v_exp_f32 v109, v109
    v_exp_f32 v110, v110
    v_exp_f32 v111, v111
    v_add_f32 v104, 1.0, v104
    v_add_f32 v105, 1.0, v105
    v_add_f32 v106, 1.0, v106
    v_add_f32 v107, 1.0, v107
    v_add_f32 v108, 1.0, v108
    v_add_f32 v109, 1.0, v109
    v_add_f32 v110, 1.0, v110
    v_add_f32 v111, 1.0, v111
    v_rcp_f32 v104, v104
    v_rcp_f32 v105, v105
    v_rcp_f32 v106, v106
    v_rcp_f32 v107, v107
    v_rcp_f32 v108, v108
    v_rcp_f32 v109, v109
    v_rcp_f32 v110, v110
    v_rcp_f32 v111, v111
    v_mul_f32 v240, v240, v104
    v_mul_f32 v241, v241, v105
    v_mul_f32 v242, v242, v106
    v_mul_f32 v243, v243, v107
    v_mul_f32 v244, v244, v108
    v_mul_f32 v245, v245, v109
    v_mul_f32 v246, v246, v110
    v_mul_f32 v247, v247, v111
    v_cvt_pk_bf16_f32 v88, v240, v241
    v_cvt_pk_bf16_f32 v89, v242, v243
    v_cvt_pk_bf16_f32 v90, v244, v245
    v_cvt_pk_bf16_f32 v91, v246, v247
    buffer_store_dwordx4 v[88:91], v1, s[4:7], s30 offen sc1
    v_cvt_pk_bf16_f32 v92, v248, v249
    v_cvt_pk_bf16_f32 v93, v250, v251
    v_cvt_pk_bf16_f32 v94, v252, v253
    v_cvt_pk_bf16_f32 v95, v254, v255
    v_lshlrev_b32 v248, 16, v92
    v_and_b32 v249, 0xffff0000, v92
    v_lshlrev_b32 v250, 16, v93
    v_and_b32 v251, 0xffff0000, v93
    v_lshlrev_b32 v252, 16, v94
    v_and_b32 v253, 0xffff0000, v94
    v_lshlrev_b32 v254, 16, v95
    v_and_b32 v255, 0xffff0000, v95
    v_mul_f32 v96, s54, v248
    v_mul_f32 v97, s54, v249
    v_mul_f32 v98, s54, v250
    v_mul_f32 v99, s54, v251
    v_mul_f32 v100, s54, v252
    v_mul_f32 v101, s54, v253
    v_mul_f32 v102, s54, v254
    v_mul_f32 v103, s54, v255
    v_exp_f32 v96, v96
    v_exp_f32 v97, v97
    v_exp_f32 v98, v98
    v_exp_f32 v99, v99
    v_exp_f32 v100, v100
    v_exp_f32 v101, v101
    v_exp_f32 v102, v102
    v_exp_f32 v103, v103
    v_add_f32 v96, 1.0, v96
    v_add_f32 v97, 1.0, v97
    v_add_f32 v98, 1.0, v98
    v_add_f32 v99, 1.0, v99
    v_add_f32 v100, 1.0, v100
    v_add_f32 v101, 1.0, v101
    v_add_f32 v102, 1.0, v102
    v_add_f32 v103, 1.0, v103
    v_rcp_f32 v96, v96
    v_rcp_f32 v97, v97
    v_rcp_f32 v98, v98
    v_rcp_f32 v99, v99
    v_rcp_f32 v100, v100
    v_rcp_f32 v101, v101
    v_rcp_f32 v102, v102
    v_rcp_f32 v103, v103
    v_mul_f32 v248, v248, v96
    v_mul_f32 v249, v249, v97
    v_mul_f32 v250, v250, v98
    v_mul_f32 v251, v251, v99
    v_mul_f32 v252, v252, v100
    v_mul_f32 v253, v253, v101
    v_mul_f32 v254, v254, v102
    v_mul_f32 v255, v255, v103
    v_cvt_pk_bf16_f32 v92, v248, v249
    v_cvt_pk_bf16_f32 v93, v250, v251
    v_cvt_pk_bf16_f32 v94, v252, v253
    v_cvt_pk_bf16_f32 v95, v254, v255
    buffer_store_dwordx4 v[92:95], v19, s[4:7], s30 offen sc1
    s_waitcnt lgkmcnt(0)
    v_or3_b32 v24, v24, v25, v26
    v_or3_b32 v28, v28, v29, v30
    v_or3_b32 v24, v24, v27, v31
    v_or_b32 v24, v24, v28
    s_mov_b32 s28, s51
    s_mov_b32 s57, s53
    v_readfirstlane_b32 s30, v24
    s_cmp_lg_u32 s30, 0
    s_cbranch_scc1 w_drain
    s_mov_b32 s48, s32
    s_cmp_ge_u32 s32, 4
    s_cselect_b32 s30, 2, 3
    s_lshl_b32 s30, s26, s30
    s_mul_i32 s30, s30, s43
    s_add_u32 s49, s42, s30
    s_mov_b32 s50, s43
    s_mov_b32 s51, s46
    s_mov_b32 s23, s41
    s_mov_b32 s53, s47
    s_nop 0
    s_load_dwordx16 s[32:47], s[24:25], 0
    s_add_u32 s24, s24, 64
    s_addc_u32 s25, s25, 0
    s_branch w_first16
w_firstH:
    s_waitcnt vmcnt(8)
    s_barrier
    s_add_u32 m0, s21, 0
    s_nop 0
    buffer_load_dwordx4 v1, s[4:7], s16 offen sc1 lds
    s_add_u32 s16, s16, s62
    s_add_u32 m0, s21, 1024
    s_nop 0
    buffer_load_dwordx4 v1, s[4:7], s17 offen sc1 lds
    s_add_u32 s17, s17, s62
    s_add_u32 m0, s22, 0
    s_nop 0
    buffer_load_dwordx4 v2, s[8:11], s18 offen lds
    s_add_u32 s18, s18, s20
    s_add_u32 m0, s22, 8192
    s_nop 0
    buffer_load_dwordx4 v2, s[12:15], s19 offen lds
    s_add_u32 s19, s19, s20
    v_mfma_f32_16x16x32_bf16 v[128:131], v[64:67], v[32:35], 0
    ds_read_b64_tr_b16 v[112:113], v8 offset:49152
    v_mfma_f32_16x16x32_bf16 v[132:135], v[68:71], v[32:35], 0
    ds_read_b64_tr_b16 v[114:115], v9 offset:49152
    v_mfma_f32_16x16x32_bf16 v[144:147], v[64:67], v[40:43], 0
    ds_read_b64_tr_b16 v[116:117], v10 offset:49152
    v_mfma_f32_16x16x32_bf16 v[148:151], v[68:71], v[40:43], 0
    ds_read_b64_tr_b16 v[118:119], v11 offset:49152
    v_mfma_f32_16x16x32_bf16 v[160:163], v[64:67], v[48:51], 0
    ds_read_b64_tr_b16 v[120:121], v8 offset:57344
    v_mfma_f32_16x16x32_bf16 v[164:167], v[68:71], v[48:51], 0
    ds_read_b64_tr_b16 v[122:123], v9 offset:57344
    v_mfma_f32_16x16x32_bf16 v[176:179], v[64:67], v[56:59], 0
    ds_read_b64_tr_b16 v[124:125], v10 offset:57344
    v_mfma_f32_16x16x32_bf16 v[180:183], v[68:71], v[56:59], 0
    ds_read_b64_tr_b16 v[126:127], v11 offset:57344
    v_mfma_f32_16x16x32_bf16 v[128:131], v[72:75], v[36:39], v[128:131]
    ds_read_b128 v[80:83], v5 offset:32768
    v_mfma_f32_16x16x32_bf16 v[132:135], v[76:79], v[36:39], v[132:135]
    ds_read_b128 v[84:87], v5 offset:33792
    v_mfma_f32_16x16x32_bf16 v[144:147], v[72:75], v[44:47], v[144:147]
    ds_read_b128 v[88:91], v5 offset:34816
    v_mfma_f32_16x16x32_bf16 v[148:151], v[76:79], v[44:47], v[148:151]
    ds_read_b128 v[92:95], v5 offset:35840
    v_mfma_f32_16x16x32_bf16 v[160:163], v[72:75], v[52:55], v[160:163]
    ds_read_b128 v[96:99], v5 offset:36864
    v_mfma_f32_16x16x32_bf16 v[164:167], v[76:79], v[52:55], v[164:167]
    ds_read_b128 v[100:103], v5 offset:37888
    v_mfma_f32_16x16x32_bf16 v[176:179], v[72:75], v[60:63], v[176:179]
    ds_read_b128 v[104:107], v5 offset:38912
    v_mfma_f32_16x16x32_bf16 v[180:183], v[76:79], v[60:63], v[180:183]
    ds_read_b128 v[108:111], v5 offset:39936
    s_waitcnt lgkmcnt(0)
    s_waitcnt vmcnt(8)
    s_barrier
    s_add_u32 m0, s21, 32768
    s_nop 0
    buffer_load_dwordx4 v1, s[4:7], s16 offen sc1 lds
    s_add_u32 s16, s16, s62
    s_add_u32 m0, s21, 33792
    s_nop 0
    buffer_load_dwordx4 v1, s[4:7], s17 offen sc1 lds
    s_add_u32 s17, s17, s62
    s_add_u32 m0, s22, 32768
    s_nop 0
    buffer_load_dwordx4 v2, s[8:11], s18 offen lds
    s_add_u32 s18, s18, s20
    s_add_u32 m0, s22, 40960
    s_nop 0
    buffer_load_dwordx4 v2, s[12:15], s19 offen lds
    s_add_u32 s19, s19, s20
    v_mfma_f32_16x16x32_bf16 v[128:131], v[112:115], v[80:83], v[128:131]
    ds_read_b64_tr_b16 v[64:65], v12 offset:16384
    v_mfma_f32_16x16x32_bf16 v[132:135], v[116:119], v[80:83], v[132:135]
    ds_read_b64_tr_b16 v[66:67], v13 offset:16384
    v_mfma_f32_16x16x32_bf16 v[144:147], v[112:115], v[88:91], v[144:147]
    ds_read_b64_tr_b16 v[68:69], v14 offset:16384
    v_mfma_f32_16x16x32_bf16 v[148:151], v[116:119], v[88:91], v[148:151]
    ds_read_b64_tr_b16 v[70:71], v15 offset:16384
    v_mfma_f32_16x16x32_bf16 v[160:163], v[112:115], v[96:99], v[160:163]
    ds_read_b64_tr_b16 v[72:73], v12 offset:24576
    v_mfma_f32_16x16x32_bf16 v[164:167], v[116:119], v[96:99], v[164:167]
    ds_read_b64_tr_b16 v[74:75], v13 offset:24576
    v_mfma_f32_16x16x32_bf16 v[176:179], v[112:115], v[104:107], v[176:179]
    ds_read_b64_tr_b16 v[76:77], v14 offset:24576
    v_mfma_f32_16x16x32_bf16 v[180:183], v[116:119], v[104:107], v[180:183]
    ds_read_b64_tr_b16 v[78:79], v15 offset:24576
    v_mfma_f32_16x16x32_bf16 v[128:131], v[120:123], v[84:87], v[128:131]
    ds_read_b128 v[32:35], v6 offset:0
    v_mfma_f32_16x16x32_bf16 v[132:135], v[124:127], v[84:87], v[132:135]
    ds_read_b128 v[36:39], v6 offset:1024
    v_mfma_f32_16x16x32_bf16 v[144:147], v[120:123], v[92:95], v[144:147]
    ds_read_b128 v[40:43], v6 offset:2048
    v_mfma_f32_16x16x32_bf16 v[148:151], v[124:127], v[92:95], v[148:151]
    ds_read_b128 v[44:47], v6 offset:3072
    v_mfma_f32_16x16x32_bf16 v[160:163], v[120:123], v[100:103], v[160:163]
    ds_read_b128 v[48:51], v6 offset:4096
    v_mfma_f32_16x16x32_bf16 v[164:167], v[124:127], v[100:103], v[164:167]
    ds_read_b128 v[52:55], v6 offset:5120
    v_mfma_f32_16x16x32_bf16 v[176:179], v[120:123], v[108:111], v[176:179]
    ds_read_b128 v[56:59], v6 offset:6144
    v_mfma_f32_16x16x32_bf16 v[180:183], v[124:127], v[108:111], v[180:183]
    ds_read_b128 v[60:63], v6 offset:7168
    s_waitcnt lgkmcnt(0)
    s_waitcnt vmcnt(8)
    s_barrier
    s_add_u32 m0, s21, 65536
    s_nop 0
    buffer_load_dwordx4 v1, s[4:7], s16 offen sc1 lds
    s_add_u32 s16, s16, s62
    s_add_u32 m0, s21, 66560
    s_nop 0
    buffer_load_dwordx4 v1, s[4:7], s17 offen sc1 lds
    s_add_u32 s17, s17, s62
    s_add_u32 m0, s22, 65536
    s_nop 0
    buffer_load_dwordx4 v2, s[8:11], s18 offen lds
    s_add_u32 s18, s18, s20
    s_add_u32 m0, s22, 73728
    s_nop 0
    buffer_load_dwordx4 v2, s[12:15], s19 offen lds
    s_add_u32 s19, s19, s20
    v_mfma_f32_16x16x32_bf16 v[128:131], v[64:67], v[32:35], v[128:131]
    ds_read_b64_tr_b16 v[112:113], v12 offset:49152
    v_mfma_f32_16x16x32_bf16 v[132:135], v[68:71], v[32:35], v[132:135]
    ds_read_b64_tr_b16 v[114:115], v13 offset:49152
    v_mfma_f32_16x16x32_bf16 v[144:147], v[64:67], v[40:43], v[144:147]
    ds_read_b64_tr_b16 v[116:117], v14 offset:49152
    v_mfma_f32_16x16x32_bf16 v[148:151], v[68:71], v[40:43], v[148:151]
    ds_read_b64_tr_b16 v[118:119], v15 offset:49152
    v_mfma_f32_16x16x32_bf16 v[160:163], v[64:67], v[48:51], v[160:163]
    ds_read_b64_tr_b16 v[120:121], v12 offset:57344
    v_mfma_f32_16x16x32_bf16 v[164:167], v[68:71], v[48:51], v[164:167]
    ds_read_b64_tr_b16 v[122:123], v13 offset:57344
    v_mfma_f32_16x16x32_bf16 v[176:179], v[64:67], v[56:59], v[176:179]
    ds_read_b64_tr_b16 v[124:125], v14 offset:57344
    v_mfma_f32_16x16x32_bf16 v[180:183], v[68:71], v[56:59], v[180:183]
    ds_read_b64_tr_b16 v[126:127], v15 offset:57344
    v_mfma_f32_16x16x32_bf16 v[128:131], v[72:75], v[36:39], v[128:131]
    ds_read_b128 v[80:83], v6 offset:32768
    v_mfma_f32_16x16x32_bf16 v[132:135], v[76:79], v[36:39], v[132:135]
    ds_read_b128 v[84:87], v6 offset:33792
    v_mfma_f32_16x16x32_bf16 v[144:147], v[72:75], v[44:47], v[144:147]
    ds_read_b128 v[88:91], v6 offset:34816
    v_mfma_f32_16x16x32_bf16 v[148:151], v[76:79], v[44:47], v[148:151]
    ds_read_b128 v[92:95], v6 offset:35840
    v_mfma_f32_16x16x32_bf16 v[160:163], v[72:75], v[52:55], v[160:163]
    ds_read_b128 v[96:99], v6 offset:36864
    v_mfma_f32_16x16x32_bf16 v[164:167], v[76:79], v[52:55], v[164:167]
    ds_read_b128 v[100:103], v6 offset:37888
    v_mfma_f32_16x16x32_bf16 v[176:179], v[72:75], v[60:63], v[176:179]
    ds_read_b128 v[104:107], v6 offset:38912
    v_mfma_f32_16x16x32_bf16 v[180:183], v[76:79], v[60:63], v[180:183]
    ds_read_b128 v[108:111], v6 offset:39936
    s_waitcnt lgkmcnt(0)
    s_waitcnt vmcnt(8)
    s_barrier
    s_add_u32 m0, s21, 98304
    s_nop 0
    buffer_load_dwordx4 v1, s[4:7], s16 offen sc1 lds
    s_add_u32 s16, s16, s62
    s_add_u32 m0, s21, 99328
    s_nop 0
    buffer_load_dwordx4 v1, s[4:7], s17 offen sc1 lds
    s_add_u32 s17, s17, s62
    s_add_u32 m0, s22, 98304
    s_nop 0
    buffer_load_dwordx4 v2, s[8:11], s18 offen lds
    s_add_u32 s18, s18, s20
    s_add_u32 m0, s22, 106496
    s_nop 0
    buffer_load_dwordx4 v2, s[12:15], s19 offen lds
    s_add_u32 s19, s19, s20
    v_mfma_f32_16x16x32_bf16 v[128:131], v[112:115], v[80:83], v[128:131]
    ds_read_b64_tr_b16 v[64:65], v8 offset:16384
    v_mfma_f32_16x16x32_bf16 v[132:135], v[116:119], v[80:83], v[132:135]
    ds_read_b64_tr_b16 v[66:67], v9 offset:16384
    v_mfma_f32_16x16x32_bf16 v[144:147], v[112:115], v[88:91], v[144:147]
    ds_read_b64_tr_b16 v[68:69], v10 offset:16384
    v_mfma_f32_16x16x32_bf16 v[148:151], v[116:119], v[88:91], v[148:151]
    ds_read_b64_tr_b16 v[70:71], v11 offset:16384
    v_mfma_f32_16x16x32_bf16 v[160:163], v[112:115], v[96:99], v[160:163]
    ds_read_b64_tr_b16 v[72:73], v8 offset:24576
    v_mfma_f32_16x16x32_bf16 v[164:167], v[116:119], v[96:99], v[164:167]
    ds_read_b64_tr_b16 v[74:75], v9 offset:24576
    v_mfma_f32_16x16x32_bf16 v[176:179], v[112:115], v[104:107], v[176:179]
    ds_read_b64_tr_b16 v[76:77], v10 offset:24576
    v_mfma_f32_16x16x32_bf16 v[180:183], v[116:119], v[104:107], v[180:183]
    ds_read_b64_tr_b16 v[78:79], v11 offset:24576
    v_mfma_f32_16x16x32_bf16 v[128:131], v[120:123], v[84:87], v[128:131]
    ds_read_b128 v[32:35], v5 offset:0
    v_mfma_f32_16x16x32_bf16 v[132:135], v[124:127], v[84:87], v[132:135]
    ds_read_b128 v[36:39], v5 offset:1024
    v_mfma_f32_16x16x32_bf16 v[144:147], v[120:123], v[92:95], v[144:147]
    ds_read_b128 v[40:43], v5 offset:2048
    v_mfma_f32_16x16x32_bf16 v[148:151], v[124:127], v[92:95], v[148:151]
    ds_read_b128 v[44:47], v5 offset:3072
    v_mfma_f32_16x16x32_bf16 v[160:163], v[120:123], v[100:103], v[160:163]
    ds_read_b128 v[48:51], v5 offset:4096
    v_mfma_f32_16x16x32_bf16 v[164:167], v[124:127], v[100:103], v[164:167]
    ds_read_b128 v[52:55], v5 offset:5120
    v_mfma_f32_16x16x32_bf16 v[176:179], v[120:123], v[108:111], v[176:179]
    ds_read_b128 v[56:59], v5 offset:6144
    v_mfma_f32_16x16x32_bf16 v[180:183], v[124:127], v[108:111], v[180:183]
    ds_read_b128 v[60:63], v5 offset:7168
    s_waitcnt lgkmcnt(0)
w_loop_chkH:
    s_sub_u32 s23, s23, 1
w_loopH:
    s_cmp_lg_u32 s23, 1
    s_cbranch_scc1 w_bodyH
    buffer_load_dword v22, off, s[64:67], 0 sc1
    v_readfirstlane_b32 s30, v16
    s_cmp_ge_u32 s30, s45
    s_cselect_b32 s30, 0, 1
    s_or_b32 s30, s30, s70
    s_cmp_ge_u32 s32, 4
    s_cselect_b32 s30, 1, s30
    s_cmp_eq_u32 s32, 0
    s_cselect_b32 s30, 1, s30
    v_mov_b32 v20, s30
    ds_write_b32 v7, v20
    s_cbranch_scc1 w_bodyH
    s_load_dwordx2 s[8:9], s[0:1], s33
    s_load_dwordx2 s[12:13], s[0:1], s34
    s_mov_b32 s10, s38
    s_mov_b32 s14, s38
    s_cmp_ge_u32 s32, 4
    s_cselect_b32 s31, 0, 1
    s_lshl_b32 s30, s3, s31
    s_mul_i32 s30, s30, s40
    s_add_u32 s16, s39, s30
    s_cmp_eq_u32 s32, 4
    s_cselect_b32 s30, 1024, s40
    s_cselect_b32 s31, 6, 5
    s_lshl_b32 s62, 32, s31
    s_add_u32 s17, s16, s30
    s_lshl_b32 s30, s3, 2
    s_mul_i32 s30, s30, s35
    s_add_u32 s18, s36, s30
    s_add_u32 s19, s37, s30
    s_lshl_b32 s20, s35, s31
    v_mul_u32_u24 v2, s35, v4
    v_add_u32 v2, v2, v3
    s_waitcnt lgkmcnt(0)
w_bodyH:
    s_waitcnt vmcnt(8)
    s_barrier
    s_add_u32 m0, s21, 0
    s_nop 0
    buffer_load_dwordx4 v1, s[4:7], s16 offen sc1 lds
    s_add_u32 s16, s16, s62
    s_add_u32 m0, s21, 1024
    s_nop 0
    buffer_load_dwordx4 v1, s[4:7], s17 offen sc1 lds
    s_add_u32 s17, s17, s62
    s_add_u32 m0, s22, 0
    s_nop 0
    buffer_load_dwordx4 v2, s[8:11], s18 offen lds
    s_add_u32 s18, s18, s20
    s_add_u32 m0, s22, 8192
    s_nop 0
    buffer_load_dwordx4 v2, s[12:15], s19 offen lds
    s_add_u32 s19, s19, s20
    v_mfma_f32_16x16x32_bf16 v[128:131], v[64:67], v[32:35], v[128:131]
    ds_read_b64_tr_b16 v[112:113], v8 offset:49152
    v_mfma_f32_16x16x32_bf16 v[132:135], v[68:71], v[32:35], v[132:135]
    ds_read_b64_tr_b16 v[114:115], v9 offset:49152
    v_mfma_f32_16x16x32_bf16 v[144:147], v[64:67], v[40:43], v[144:147]
    ds_read_b64_tr_b16 v[116:117], v10 offset:49152
    v_mfma_f32_16x16x32_bf16 v[148:151], v[68:71], v[40:43], v[148:151]
    ds_read_b64_tr_b16 v[118:119], v11 offset:49152
    v_mfma_f32_16x16x32_bf16 v[160:163], v[64:67], v[48:51], v[160:163]
    ds_read_b64_tr_b16 v[120:121], v8 offset:57344
    v_mfma_f32_16x16x32_bf16 v[164:167], v[68:71], v[48:51], v[164:167]
    ds_read_b64_tr_b16 v[122:123], v9 offset:57344
    v_mfma_f32_16x16x32_bf16 v[176:179], v[64:67], v[56:59], v[176:179]
    ds_read_b64_tr_b16 v[124:125], v10 offset:57344
    v_mfma_f32_16x16x32_bf16 v[180:183], v[68:71], v[56:59], v[180:183]
    ds_read_b64_tr_b16 v[126:127], v11 offset:57344
    v_mfma_f32_16x16x32_bf16 v[128:131], v[72:75], v[36:39], v[128:131]
    ds_read_b128 v[80:83], v5 offset:32768
    v_mfma_f32_16x16x32_bf16 v[132:135], v[76:79], v[36:39], v[132:135]
    ds_read_b128 v[84:87], v5 offset:33792
    v_mfma_f32_16x16x32_bf16 v[144:147], v[72:75], v[44:47], v[144:147]
    ds_read_b128 v[88:91], v5 offset:34816
    v_mfma_f32_16x16x32_bf16 v[148:151], v[76:79], v[44:47], v[148:151]
    ds_read_b128 v[92:95], v5 offset:35840
    v_mfma_f32_16x16x32_bf16 v[160:163], v[72:75], v[52:55], v[160:163]
    ds_read_b128 v[96:99], v5 offset:36864
    v_mfma_f32_16x16x32_bf16 v[164:167], v[76:79], v[52:55], v[164:167]
    ds_read_b128 v[100:103], v5 offset:37888
    v_mfma_f32_16x16x32_bf16 v[176:179], v[72:75], v[60:63], v[176:179]
    ds_read_b128 v[104:107], v5 offset:38912
    v_mfma_f32_16x16x32_bf16 v[180:183], v[76:79], v[60:63], v[180:183]
    ds_read_b128 v[108:111], v5 offset:39936
    buffer_load_dword v16, v17, s[4:7], s44 offen sc1
    s_waitcnt lgkmcnt(0)
    s_waitcnt vmcnt(8)
    s_barrier
    s_add_u32 m0, s21, 32768
    s_nop 0
    buffer_load_dwordx4 v1, s[4:7], s16 offen sc1 lds
    s_add_u32 s16, s16, s62
    s_add_u32 m0, s21, 33792
    s_nop 0
    buffer_load_dwordx4 v1, s[4:7], s17 offen sc1 lds
    s_add_u32 s17, s17, s62
    s_add_u32 m0, s22, 32768
    s_nop 0
    buffer_load_dwordx4 v2, s[8:11], s18 offen lds
    s_add_u32 s18, s18, s20
    s_add_u32 m0, s22, 40960
    s_nop 0
    buffer_load_dwordx4 v2, s[12:15], s19 offen lds
    s_add_u32 s19, s19, s20
    v_mfma_f32_16x16x32_bf16 v[128:131], v[112:115], v[80:83], v[128:131]
    ds_read_b64_tr_b16 v[64:65], v12 offset:16384
    v_mfma_f32_16x16x32_bf16 v[132:135], v[116:119], v[80:83], v[132:135]
    ds_read_b64_tr_b16 v[66:67], v13 offset:16384
    v_mfma_f32_16x16x32_bf16 v[144:147], v[112:115], v[88:91], v[144:147]
    ds_read_b64_tr_b16 v[68:69], v14 offset:16384
    v_mfma_f32_16x16x32_bf16 v[148:151], v[116:119], v[88:91], v[148:151]
    ds_read_b64_tr_b16 v[70:71], v15 offset:16384
    v_mfma_f32_16x16x32_bf16 v[160:163], v[112:115], v[96:99], v[160:163]
    ds_read_b64_tr_b16 v[72:73], v12 offset:24576
    v_mfma_f32_16x16x32_bf16 v[164:167], v[116:119], v[96:99], v[164:167]
    ds_read_b64_tr_b16 v[74:75], v13 offset:24576
    v_mfma_f32_16x16x32_bf16 v[176:179], v[112:115], v[104:107], v[176:179]
    ds_read_b64_tr_b16 v[76:77], v14 offset:24576
    v_mfma_f32_16x16x32_bf16 v[180:183], v[116:119], v[104:107], v[180:183]
    ds_read_b64_tr_b16 v[78:79], v15 offset:24576
    v_mfma_f32_16x16x32_bf16 v[128:131], v[120:123], v[84:87], v[128:131]
    ds_read_b128 v[32:35], v6 offset:0
    v_mfma_f32_16x16x32_bf16 v[132:135], v[124:127], v[84:87], v[132:135]
    ds_read_b128 v[36:39], v6 offset:1024
    v_mfma_f32_16x16x32_bf16 v[144:147], v[120:123], v[92:95], v[144:147]
    ds_read_b128 v[40:43], v6 offset:2048
    v_mfma_f32_16x16x32_bf16 v[148:151], v[124:127], v[92:95], v[148:151]
    ds_read_b128 v[44:47], v6 offset:3072
    v_mfma_f32_16x16x32_bf16 v[160:163], v[120:123], v[100:103], v[160:163]
    ds_read_b128 v[48:51], v6 offset:4096
    v_mfma_f32_16x16x32_bf16 v[164:167], v[124:127], v[100:103], v[164:167]
    ds_read_b128 v[52:55], v6 offset:5120
    v_mfma_f32_16x16x32_bf16 v[176:179], v[120:123], v[108:111], v[176:179]
    ds_read_b128 v[56:59], v6 offset:6144
    v_mfma_f32_16x16x32_bf16 v[180:183], v[124:127], v[108:111], v[180:183]
    ds_read_b128 v[60:63], v6 offset:7168
    s_waitcnt lgkmcnt(0)
    s_waitcnt vmcnt(8)
    s_barrier
    s_add_u32 m0, s21, 65536
    s_nop 0
    buffer_load_dwordx4 v1, s[4:7], s16 offen sc1 lds
    s_add_u32 s16, s16, s62
    s_add_u32 m0, s21, 66560
    s_nop 0
    buffer_load_dwordx4 v1, s[4:7], s17 offen sc1 lds
    s_add_u32 s17, s17, s62
    s_add_u32 m0, s22, 65536
    s_nop 0
    buffer_load_dwordx4 v2, s[8:11], s18 offen lds
    s_add_u32 s18, s18, s20
    s_add_u32 m0, s22, 73728
    s_nop 0
    buffer_load_dwordx4 v2, s[12:15], s19 offen lds
    s_add_u32 s19, s19, s20
    v_mfma_f32_16x16x32_bf16 v[128:131], v[64:67], v[32:35], v[128:131]
    ds_read_b64_tr_b16 v[112:113], v12 offset:49152
    v_mfma_f32_16x16x32_bf16 v[132:135], v[68:71], v[32:35], v[132:135]
    ds_read_b64_tr_b16 v[114:115], v13 offset:49152
    v_mfma_f32_16x16x32_bf16 v[144:147], v[64:67], v[40:43], v[144:147]
    ds_read_b64_tr_b16 v[116:117], v14 offset:49152
    v_mfma_f32_16x16x32_bf16 v[148:151], v[68:71], v[40:43], v[148:151]
    ds_read_b64_tr_b16 v[118:119], v15 offset:49152
    v_mfma_f32_16x16x32_bf16 v[160:163], v[64:67], v[48:51], v[160:163]
    ds_read_b64_tr_b16 v[120:121], v12 offset:57344
    v_mfma_f32_16x16x32_bf16 v[164:167], v[68:71], v[48:51], v[164:167]
    ds_read_b64_tr_b16 v[122:123], v13 offset:57344
    v_mfma_f32_16x16x32_bf16 v[176:179], v[64:67], v[56:59], v[176:179]
    ds_read_b64_tr_b16 v[124:125], v14 offset:57344
    v_mfma_f32_16x16x32_bf16 v[180:183], v[68:71], v[56:59], v[180:183]
    ds_read_b64_tr_b16 v[126:127], v15 offset:57344
    v_mfma_f32_16x16x32_bf16 v[128:131], v[72:75], v[36:39], v[128:131]
    ds_read_b128 v[80:83], v6 offset:32768
    v_mfma_f32_16x16x32_bf16 v[132:135], v[76:79], v[36:39], v[132:135]
    ds_read_b128 v[84:87], v6 offset:33792
    v_mfma_f32_16x16x32_bf16 v[144:147], v[72:75], v[44:47], v[144:147]
    ds_read_b128 v[88:91], v6 offset:34816
    v_mfma_f32_16x16x32_bf16 v[148:151], v[76:79], v[44:47], v[148:151]
    ds_read_b128 v[92:95], v6 offset:35840
    v_mfma_f32_16x16x32_bf16 v[160:163], v[72:75], v[52:55], v[160:163]
    ds_read_b128 v[96:99], v6 offset:36864
    v_mfma_f32_16x16x32_bf16 v[164:167], v[76:79], v[52:55], v[164:167]
    ds_read_b128 v[100:103], v6 offset:37888
    v_mfma_f32_16x16x32_bf16 v[176:179], v[72:75], v[60:63], v[176:179]
    ds_read_b128 v[104:107], v6 offset:38912
    v_mfma_f32_16x16x32_bf16 v[180:183], v[76:79], v[60:63], v[180:183]
    ds_read_b128 v[108:111], v6 offset:39936
    s_waitcnt lgkmcnt(0)
    s_waitcnt vmcnt(8)
    s_barrier
    s_add_u32 m0, s21, 98304
    s_nop 0
    buffer_load_dwordx4 v1, s[4:7], s16 offen sc1 lds
    s_add_u32 s16, s16, s62
    s_add_u32 m0, s21, 99328
    s_nop 0
    buffer_load_dwordx4 v1, s[4:7], s17 offen sc1 lds
    s_add_u32 s17, s17, s62
    s_add_u32 m0, s22, 98304
    s_nop 0
    buffer_load_dwordx4 v2, s[8:11], s18 offen lds
    s_add_u32 s18, s18, s20
    s_add_u32 m0, s22, 106496
    s_nop 0
    buffer_load_dwordx4 v2, s[12:15], s19 offen lds
    s_add_u32 s19, s19, s20
    v_mfma_f32_16x16x32_bf16 v[128:131], v[112:115], v[80:83], v[128:131]
    ds_read_b64_tr_b16 v[64:65], v8 offset:16384
    v_mfma_f32_16x16x32_bf16 v[132:135], v[116:119], v[80:83], v[132:135]
    ds_read_b64_tr_b16 v[66:67], v9 offset:16384
    v_mfma_f32_16x16x32_bf16 v[144:147], v[112:115], v[88:91], v[144:147]
    ds_read_b64_tr_b16 v[68:69], v10 offset:16384
    v_mfma_f32_16x16x32_bf16 v[148:151], v[116:119], v[88:91], v[148:151]
    ds_read_b64_tr_b16 v[70:71], v11 offset:16384
    v_mfma_f32_16x16x32_bf16 v[160:163], v[112:115], v[96:99], v[160:163]
    ds_read_b64_tr_b16 v[72:73], v8 offset:24576
    v_mfma_f32_16x16x32_bf16 v[164:167], v[116:119], v[96:99], v[164:167]
    ds_read_b64_tr_b16 v[74:75], v9 offset:24576
    v_mfma_f32_16x16x32_bf16 v[176:179], v[112:115], v[104:107], v[176:179]
    ds_read_b64_tr_b16 v[76:77], v10 offset:24576
    v_mfma_f32_16x16x32_bf16 v[180:183], v[116:119], v[104:107], v[180:183]
    ds_read_b64_tr_b16 v[78:79], v11 offset:24576
    v_mfma_f32_16x16x32_bf16 v[128:131], v[120:123], v[84:87], v[128:131]
    ds_read_b128 v[32:35], v5 offset:0
    v_mfma_f32_16x16x32_bf16 v[132:135], v[124:127], v[84:87], v[132:135]
    ds_read_b128 v[36:39], v5 offset:1024
    v_mfma_f32_16x16x32_bf16 v[144:147], v[120:123], v[92:95], v[144:147]
    ds_read_b128 v[40:43], v5 offset:2048
    v_mfma_f32_16x16x32_bf16 v[148:151], v[124:127], v[92:95], v[148:151]
    ds_read_b128 v[44:47], v5 offset:3072
    v_mfma_f32_16x16x32_bf16 v[160:163], v[120:123], v[100:103], v[160:163]
    ds_read_b128 v[48:51], v5 offset:4096
    v_mfma_f32_16x16x32_bf16 v[164:167], v[124:127], v[100:103], v[164:167]
    ds_read_b128 v[52:55], v5 offset:5120
    v_mfma_f32_16x16x32_bf16 v[176:179], v[120:123], v[108:111], v[176:179]
    ds_read_b128 v[56:59], v5 offset:6144
    v_mfma_f32_16x16x32_bf16 v[180:183], v[124:127], v[108:111], v[180:183]
    ds_read_b128 v[60:63], v5 offset:7168
    s_waitcnt lgkmcnt(0)
    s_sub_u32 s23, s23, 1
    s_cmp_lg_u32 s23, 0
    s_cbranch_scc1 w_loopH
    v_mov_b32 v20, 131072
    ds_read_b128 v[24:27], v20
    ds_read_b128 v[28:31], v20 offset:16
    s_cmp_lg_u32 s53, s53
    s_cbranch_scc1 w_epi_siluH
    s_lshl_b32 s30, s27, 10
    s_add_u32 s30, s30, s49
    s_nop 7
    v_cvt_pk_bf16_f32 v80, v128, v129
    v_cvt_pk_bf16_f32 v81, v130, v131
    v_cvt_pk_bf16_f32 v82, v132, v133
    v_cvt_pk_bf16_f32 v83, v134, v135
    buffer_store_dwordx4 v[80:83], v1, s[4:7], s30 offen sc1
    s_add_u32 s30, s30, s50
    v_cvt_pk_bf16_f32 v84, v144, v145
    v_cvt_pk_bf16_f32 v85, v146, v147
    v_cvt_pk_bf16_f32 v86, v148, v149
    v_cvt_pk_bf16_f32 v87, v150, v151
    buffer_store_dwordx4 v[84:87], v1, s[4:7], s30 offen sc1
    s_add_u32 s30, s30, s50
    v_cvt_pk_bf16_f32 v88, v160, v161
    v_cvt_pk_bf16_f32 v89, v162, v163
    v_cvt_pk_bf16_f32 v90, v164, v165
    v_cvt_pk_bf16_f32 v91, v166, v167
    buffer_store_dwordx4 v[88:91], v1, s[4:7], s30 offen sc1
    s_add_u32 s30, s30, s50
    v_cvt_pk_bf16_f32 v92, v176, v177
    v_cvt_pk_bf16_f32 v93, v178, v179
    v_cvt_pk_bf16_f32 v94, v180, v181
    v_cvt_pk_bf16_f32 v95, v182, v183
    buffer_store_dwordx4 v[92:95], v1, s[4:7], s30 offen sc1
    s_add_u32 s30, s30, s50
    s_waitcnt lgkmcnt(0)
    v_or3_b32 v24, v24, v25, v26
    v_or3_b32 v28, v28, v29, v30
    v_or3_b32 v24, v24, v27, v31
    v_or_b32 v24, v24, v28
    s_mov_b32 s28, s51
    s_mov_b32 s57, s53
    v_readfirstlane_b32 s30, v24
    s_cmp_lg_u32 s30, 0
    s_cbranch_scc1 w_drain
    s_mov_b32 s48, s32
    s_cmp_ge_u32 s32, 4
    s_cselect_b32 s30, 2, 3
    s_lshl_b32 s30, s26, s30
    s_mul_i32 s30, s30, s43
    s_add_u32 s49, s42, s30
    s_mov_b32 s50, s43
    s_mov_b32 s51, s46
    s_mov_b32 s23, s41
    s_mov_b32 s53, s47
    s_nop 0
    s_load_dwordx16 s[32:47], s[24:25], 0
    s_add_u32 s24, s24, 64
    s_addc_u32 s25, s25, 0
    s_branch w_first4
w_epi_siluH:
    s_lshl_b32 s30, s27, 10
    s_add_u32 s30, s30, s49
    s_mov_b32 s54, 0xbfb8aa3b
    s_nop 7
    v_cvt_pk_bf16_f32 v80, v128, v129
    v_cvt_pk_bf16_f32 v81, v130, v131
    v_cvt_pk_bf16_f32 v82, v132, v133
    v_cvt_pk_bf16_f32 v83, v134, v135
    v_lshlrev_b32 v128, 16, v80
    v_and_b32 v129, 0xffff0000, v80
    v_lshlrev_b32 v130, 16, v81
    v_and_b32 v131, 0xffff0000, v81
    v_lshlrev_b32 v132, 16, v82
    v_and_b32 v133, 0xffff0000, v82
    v_lshlrev_b32 v134, 16, v83
    v_and_b32 v135, 0xffff0000, v83
    v_mul_f32 v104, s54, v128
    v_mul_f32 v105, s54, v129
    v_mul_f32 v106, s54, v130
    v_mul_f32 v107, s54, v131
    v_mul_f32 v108, s54, v132
    v_mul_f32 v109, s54, v133
    v_mul_f32 v110, s54, v134
    v_mul_f32 v111, s54, v135
    v_exp_f32 v104, v104
    v_exp_f32 v105, v105
    v_exp_f32 v106, v106
    v_exp_f32 v107, v107
    v_exp_f32 v108, v108
    v_exp_f32 v109, v109
    v_exp_f32 v110, v110
    v_exp_f32 v111, v111
    v_add_f32 v104, 1.0, v104
    v_add_f32 v105, 1.0, v105
    v_add_f32 v106, 1.0, v106
    v_add_f32 v107, 1.0, v107
    v_add_f32 v108, 1.0, v108
    v_add_f32 v109, 1.0, v109
    v_add_f32 v110, 1.0, v110
    v_add_f32 v111, 1.0, v111
    v_rcp_f32 v104, v104
    v_rcp_f32 v105, v105
    v_rcp_f32 v106, v106
    v_rcp_f32 v107, v107
    v_rcp_f32 v108, v108
    v_rcp_f32 v109, v109
    v_rcp_f32 v110, v110
    v_rcp_f32 v111, v111
    v_mul_f32 v128, v128, v104
    v_mul_f32 v129, v129, v105
    v_mul_f32 v130, v130, v106
    v_mul_f32 v131, v131, v107
    v_mul_f32 v132, v132, v108
    v_mul_f32 v133, v133, v109
    v_mul_f32 v134, v134, v110
    v_mul_f32 v135, v135, v111
    v_cvt_pk_bf16_f32 v80, v128, v129
    v_cvt_pk_bf16_f32 v81, v130, v131
    v_cvt_pk_bf16_f32 v82, v132, v133
    v_cvt_pk_bf16_f32 v83, v134, v135
    buffer_store_dwordx4 v[80:83], v1, s[4:7], s30 offen sc1
    s_add_u32 s30, s30, s50
    v_cvt_pk_bf16_f32 v84, v144, v145
    v_cvt_pk_bf16_f32 v85, v146, v147
    v_cvt_pk_bf16_f32 v86, v148, v149
    v_cvt_pk_bf16_f32 v87, v150, v151
    v_lshlrev_b32 v144, 16, v84
    v_and_b32 v145, 0xffff0000, v84
    v_lshlrev_b32 v146, 16, v85
    v_and_b32 v147, 0xffff0000, v85
    v_lshlrev_b32 v148, 16, v86
    v_and_b32 v149, 0xffff0000, v86
    v_lshlrev_b32 v150, 16, v87
    v_and_b32 v151, 0xffff0000, v87
    v_mul_f32 v96, s54, v144
    v_mul_f32 v97, s54, v145
    v_mul_f32 v98, s54, v146
    v_mul_f32 v99, s54, v147
    v_mul_f32 v100, s54, v148
    v_mul_f32 v101, s54, v149
    v_mul_f32 v102, s54, v150
    v_mul_f32 v103, s54, v151
    v_exp_f32 v96, v96
    v_exp_f32 v97, v97
    v_exp_f32 v98, v98
    v_exp_f32 v99, v99
    v_exp_f32 v100, v100
    v_exp_f32 v101, v101
    v_exp_f32 v102, v102
    v_exp_f32 v103, v103
    v_add_f32 v96, 1.0, v96
    v_add_f32 v97, 1.0, v97
    v_add_f32 v98, 1.0, v98
    v_add_f32 v99, 1.0, v99
    v_add_f32 v100, 1.0, v100
    v_add_f32 v101, 1.0, v101
    v_add_f32 v102, 1.0, v102
    v_add_f32 v103, 1.0, v103
    v_rcp_f32 v96, v96
    v_rcp_f32 v97, v97
    v_rcp_f32 v98, v98
    v_rcp_f32 v99, v99
    v_rcp_f32 v100, v100
    v_rcp_f32 v101, v101
    v_rcp_f32 v102, v102
    v_rcp_f32 v103, v103
    v_mul_f32 v144, v144, v96
    v_mul_f32 v145, v145, v97
    v_mul_f32 v146, v146, v98
    v_mul_f32 v147, v147, v99
    v_mul_f32 v148, v148, v100
    v_mul_f32 v149, v149, v101
    v_mul_f32 v150, v150, v102
    v_mul_f32 v151, v151, v103
    v_cvt_pk_bf16_f32 v84, v144, v145
    v_cvt_pk_bf16_f32 v85, v146, v147
    v_cvt_pk_bf16_f32 v86, v148, v149
    v_cvt_pk_bf16_f32 v87, v150, v151
    buffer_store_dwordx4 v[84:87], v1, s[4:7], s30 offen sc1
    s_add_u32 s30, s30, s50
    v_cvt_pk_bf16_f32 v88, v160, v161
    v_cvt_pk_bf16_f32 v89, v162, v163
    v_cvt_pk_bf16_f32 v90, v164, v165
    v_cvt_pk_bf16_f32 v91, v166, v167
    v_lshlrev_b32 v160, 16, v88
    v_and_b32 v161, 0xffff0000, v88
    v_lshlrev_b32 v162, 16, v89
    v_and_b32 v163, 0xffff0000, v89
    v_lshlrev_b32 v164, 16, v90
    v_and_b32 v165, 0xffff0000, v90
    v_lshlrev_b32 v166, 16, v91
    v_and_b32 v167, 0xffff0000, v91
    v_mul_f32 v104, s54, v160
    v_mul_f32 v105, s54, v161
    v_mul_f32 v106, s54, v162
    v_mul_f32 v107, s54, v163
    v_mul_f32 v108, s54, v164
    v_mul_f32 v109, s54, v165
    v_mul_f32 v110, s54, v166
    v_mul_f32 v111, s54, v167
    v_exp_f32 v104, v104
    v_exp_f32 v105, v105
    v_exp_f32 v106, v106
    v_exp_f32 v107, v107
    v_exp_f32 v108, v108
    v_exp_f32 v109, v109
    v_exp_f32 v110, v110
    v_exp_f32 v111, v111
    v_add_f32 v104, 1.0, v104
    v_add_f32 v105, 1.0, v105
    v_add_f32 v106, 1.0, v106
    v_add_f32 v107, 1.0, v107
    v_add_f32 v108, 1.0, v108
    v_add_f32 v109, 1.0, v109
    v_add_f32 v110, 1.0, v110
    v_add_f32 v111, 1.0, v111
    v_rcp_f32 v104, v104
    v_rcp_f32 v105, v105
    v_rcp_f32 v106, v106
    v_rcp_f32 v107, v107
    v_rcp_f32 v108, v108
    v_rcp_f32 v109, v109
    v_rcp_f32 v110, v110
    v_rcp_f32 v111, v111
    v_mul_f32 v160, v160, v104
    v_mul_f32 v161, v161, v105
    v_mul_f32 v162, v162, v106
    v_mul_f32 v163, v163, v107
    v_mul_f32 v164, v164, v108
    v_mul_f32 v165, v165, v109
    v_mul_f32 v166, v166, v110
    v_mul_f32 v167, v167, v111
    v_cvt_pk_bf16_f32 v88, v160, v161
    v_cvt_pk_bf16_f32 v89, v162, v163
    v_cvt_pk_bf16_f32 v90, v164, v165
    v_cvt_pk_bf16_f32 v91, v166, v167
    buffer_store_dwordx4 v[88:91], v1, s[4:7], s30 offen sc1
    s_add_u32 s30, s30, s50
    v_cvt_pk_bf16_f32 v92, v176, v177
    v_cvt_pk_bf16_f32 v93, v178, v179
    v_cvt_pk_bf16_f32 v94, v180, v181
    v_cvt_pk_bf16_f32 v95, v182, v183
    v_lshlrev_b32 v176, 16, v92
    v_and_b32 v177, 0xffff0000, v92
    v_lshlrev_b32 v178, 16, v93
    v_and_b32 v179, 0xffff0000, v93
    v_lshlrev_b32 v180, 16, v94
    v_and_b32 v181, 0xffff0000, v94
    v_lshlrev_b32 v182, 16, v95
    v_and_b32 v183, 0xffff0000, v95
    v_mul_f32 v96, s54, v176
    v_mul_f32 v97, s54, v177
    v_mul_f32 v98, s54, v178
    v_mul_f32 v99, s54, v179
    v_mul_f32 v100, s54, v180
    v_mul_f32 v101, s54, v181
    v_mul_f32 v102, s54, v182
    v_mul_f32 v103, s54, v183
    v_exp_f32 v96, v96
    v_exp_f32 v97, v97
    v_exp_f32 v98, v98
    v_exp_f32 v99, v99
    v_exp_f32 v100, v100
    v_exp_f32 v101, v101
    v_exp_f32 v102, v102
    v_exp_f32 v103, v103
    v_add_f32 v96, 1.0, v96
    v_add_f32 v97, 1.0, v97
    v_add_f32 v98, 1.0, v98
    v_add_f32 v99, 1.0, v99
    v_add_f32 v100, 1.0, v100
    v_add_f32 v101, 1.0, v101
    v_add_f32 v102, 1.0, v102
    v_add_f32 v103, 1.0, v103
    v_rcp_f32 v96, v96
    v_rcp_f32 v97, v97
    v_rcp_f32 v98, v98
    v_rcp_f32 v99, v99
    v_rcp_f32 v100, v100
    v_rcp_f32 v101, v101
    v_rcp_f32 v102, v102
    v_rcp_f32 v103, v103
    v_mul_f32 v176, v176, v96
    v_mul_f32 v177, v177, v97
    v_mul_f32 v178, v178, v98
    v_mul_f32 v179, v179, v99
    v_mul_f32 v180, v180, v100
    v_mul_f32 v181, v181, v101
    v_mul_f32 v182, v182, v102
    v_mul_f32 v183, v183, v103
    v_cvt_pk_bf16_f32 v92, v176, v177
    v_cvt_pk_bf16_f32 v93, v178, v179
    v_cvt_pk_bf16_f32 v94, v180, v181
    v_cvt_pk_bf16_f32 v95, v182, v183
    buffer_store_dwordx4 v[92:95], v1, s[4:7], s30 offen sc1
    s_add_u32 s30, s30, s50
    s_waitcnt lgkmcnt(0)
    v_or3_b32 v24, v24, v25, v26
    v_or3_b32 v28, v28, v29, v30
    v_or3_b32 v24, v24, v27, v31
    v_or_b32 v24, v24, v28
    s_mov_b32 s28, s51
    s_mov_b32 s57, s53
    v_readfirstlane_b32 s30, v24
    s_cmp_lg_u32 s30, 0
    s_cbranch_scc1 w_drain
    s_mov_b32 s48, s32
    s_cmp_ge_u32 s32, 4
    s_cselect_b32 s30, 2, 3
    s_lshl_b32 s30, s26, s30
    s_mul_i32 s30, s30, s43
    s_add_u32 s49, s42, s30
    s_mov_b32 s50, s43
    s_mov_b32 s51, s46
    s_mov_b32 s23, s41
    s_mov_b32 s53, s47
    s_nop 0
    s_load_dwordx16 s[32:47], s[24:25], 0
    s_add_u32 s24, s24, 64
    s_addc_u32 s25, s25, 0
    s_branch w_first4
w_firstM:
    s_waitcnt vmcnt(6)
    s_barrier
    s_add_u32 m0, s21, 0
    s_nop 0
    buffer_load_dwordx4 v1, s[4:7], s16 offen sc1 lds
    s_add_u32 s16, s16, s62
    s_add_u32 m0, s22, 0
    s_nop 0
    buffer_load_dwordx4 v2, s[8:11], s18 offen lds
    s_add_u32 s18, s18, s20
    s_add_u32 m0, s22, 8192
    s_nop 0
    buffer_load_dwordx4 v2, s[12:15], s19 offen lds
    s_add_u32 s19, s19, s20
    v_mfma_f32_16x16x32_bf16 v[128:131], v[64:67], v[32:35], 0
    ds_read_b64_tr_b16 v[112:113], v8 offset:49152
    v_mfma_f32_16x16x32_bf16 v[132:135], v[68:71], v[32:35], 0
    ds_read_b64_tr_b16 v[114:115], v9 offset:49152
    v_mfma_f32_16x16x32_bf16 v[136:139], v[72:75], v[32:35], 0
    ds_read_b64_tr_b16 v[116:117], v10 offset:49152
    v_mfma_f32_16x16x32_bf16 v[140:143], v[76:79], v[32:35], 0
    ds_read_b64_tr_b16 v[118:119], v11 offset:49152
    v_mfma_f32_16x16x32_bf16 v[144:147], v[64:67], v[40:43], 0
    ds_read_b64_tr_b16 v[120:121], v8 offset:57344
    v_mfma_f32_16x16x32_bf16 v[148:151], v[68:71], v[40:43], 0
    ds_read_b64_tr_b16 v[122:123], v9 offset:57344
    v_mfma_f32_16x16x32_bf16 v[152:155], v[72:75], v[40:43], 0
    ds_read_b64_tr_b16 v[124:125], v10 offset:57344
    v_mfma_f32_16x16x32_bf16 v[156:159], v[76:79], v[40:43], 0
    ds_read_b64_tr_b16 v[126:127], v11 offset:57344
    v_mfma_f32_16x16x32_bf16 v[160:163], v[64:67], v[48:51], 0
    ds_read_b128 v[80:83], v5 offset:32768
    v_mfma_f32_16x16x32_bf16 v[164:167], v[68:71], v[48:51], 0
    ds_read_b128 v[88:91], v5 offset:34816
    v_mfma_f32_16x16x32_bf16 v[168:171], v[72:75], v[48:51], 0
    ds_read_b128 v[96:99], v5 offset:36864
    v_mfma_f32_16x16x32_bf16 v[172:175], v[76:79], v[48:51], 0
    ds_read_b128 v[104:107], v5 offset:38912
    v_mfma_f32_16x16x32_bf16 v[176:179], v[64:67], v[56:59], 0
    v_mfma_f32_16x16x32_bf16 v[180:183], v[68:71], v[56:59], 0
    v_mfma_f32_16x16x32_bf16 v[184:187], v[72:75], v[56:59], 0
    v_mfma_f32_16x16x32_bf16 v[188:191], v[76:79], v[56:59], 0
    s_waitcnt lgkmcnt(0)
    s_waitcnt vmcnt(6)
    s_barrier
    s_add_u32 m0, s21, 32768
    s_nop 0
    buffer_load_dwordx4 v1, s[4:7], s16 offen sc1 lds
    s_add_u32 s16, s16, s62
    s_add_u32 m0, s22, 32768
    s_nop 0
    buffer_load_dwordx4 v2, s[8:11], s18 offen lds
    s_add_u32 s18, s18, s20
    s_add_u32 m0, s22, 40960
    s_nop 0
    buffer_load_dwordx4 v2, s[12:15], s19 offen lds
    s_add_u32 s19, s19, s20
    v_mfma_f32_16x16x32_bf16 v[128:131], v[112:115], v[80:83], v[128:131]
    ds_read_b64_tr_b16 v[64:65], v12 offset:16384
    v_mfma_f32_16x16x32_bf16 v[132:135], v[116:119], v[80:83], v[132:135]
    ds_read_b64_tr_b16 v[66:67], v13 offset:16384
    v_mfma_f32_16x16x32_bf16 v[136:139], v[120:123], v[80:83], v[136:139]
    ds_read_b64_tr_b16 v[68:69], v14 offset:16384
    v_mfma_f32_16x16x32_bf16 v[140:143], v[124:127], v[80:83], v[140:143]
    ds_read_b64_tr_b16 v[70:71], v15 offset:16384
    v_mfma_f32_16x16x32_bf16 v[144:147], v[112:115], v[88:91], v[144:147]
    ds_read_b64_tr_b16 v[72:73], v12 offset:24576
    v_mfma_f32_16x16x32_bf16 v[148:151], v[116:119], v[88:91], v[148:151]
    ds_read_b64_tr_b16 v[74:75], v13 offset:24576
    v_mfma_f32_16x16x32_bf16 v[152:155], v[120:123], v[88:91], v[152:155]
    ds_read_b64_tr_b16 v[76:77], v14 offset:24576
    v_mfma_f32_16x16x32_bf16 v[156:159], v[124:127], v[88:91], v[156:159]
    ds_read_b64_tr_b16 v[78:79], v15 offset:24576
    v_mfma_f32_16x16x32_bf16 v[160:163], v[112:115], v[96:99], v[160:163]
    ds_read_b128 v[32:35], v6 offset:0
    v_mfma_f32_16x16x32_bf16 v[164:167], v[116:119], v[96:99], v[164:167]
    ds_read_b128 v[40:43], v6 offset:2048
    v_mfma_f32_16x16x32_bf16 v[168:171], v[120:123], v[96:99], v[168:171]
    ds_read_b128 v[48:51], v6 offset:4096
    v_mfma_f32_16x16x32_bf16 v[172:175], v[124:127], v[96:99], v[172:175]
    ds_read_b128 v[56:59], v6 offset:6144
    v_mfma_f32_16x16x32_bf16 v[176:179], v[112:115], v[104:107], v[176:179]
    v_mfma_f32_16x16x32_bf16 v[180:183], v[116:119], v[104:107], v[180:183]
    v_mfma_f32_16x16x32_bf16 v[184:187], v[120:123], v[104:107], v[184:187]
    v_mfma_f32_16x16x32_bf16 v[188:191], v[124:127], v[104:107], v[188:191]
    s_waitcnt lgkmcnt(0)
    s_waitcnt vmcnt(6)
    s_barrier
    s_add_u32 m0, s21, 65536
    s_nop 0
    buffer_load_dwordx4 v1, s[4:7], s16 offen sc1 lds
    s_add_u32 s16, s16, s62
    s_add_u32 m0, s22, 65536
    s_nop 0
    buffer_load_dwordx4 v2, s[8:11], s18 offen lds
    s_add_u32 s18, s18, s20
    s_add_u32 m0, s22, 73728
    s_nop 0
    buffer_load_dwordx4 v2, s[12:15], s19 offen lds
    s_add_u32 s19, s19, s20
    v_mfma_f32_16x16x32_bf16 v[128:131], v[64:67], v[32:35], v[128:131]
    ds_read_b64_tr_b16 v[112:113], v12 offset:49152
    v_mfma_f32_16x16x32_bf16 v[132:135], v[68:71], v[32:35], v[132:135]
    ds_read_b64_tr_b16 v[114:115], v13 offset:49152
    v_mfma_f32_16x16x32_bf16 v[136:139], v[72:75], v[32:35], v[136:139]
    ds_read_b64_tr_b16 v[116:117], v14 offset:49152
    v_mfma_f32_16x16x32_bf16 v[140:143], v[76:79], v[32:35], v[140:143]
    ds_read_b64_tr_b16 v[118:119], v15 offset:49152
    v_mfma_f32_16x16x32_bf16 v[144:147], v[64:67], v[40:43], v[144:147]
    ds_read_b64_tr_b16 v[120:121], v12 offset:57344
    v_mfma_f32_16x16x32_bf16 v[148:151], v[68:71], v[40:43], v[148:151]
    ds_read_b64_tr_b16 v[122:123], v13 offset:57344
    v_mfma_f32_16x16x32_bf16 v[152:155], v[72:75], v[40:43], v[152:155]
    ds_read_b64_tr_b16 v[124:125], v14 offset:57344
    v_mfma_f32_16x16x32_bf16 v[156:159], v[76:79], v[40:43], v[156:159]
    ds_read_b64_tr_b16 v[126:127], v15 offset:57344
    v_mfma_f32_16x16x32_bf16 v[160:163], v[64:67], v[48:51], v[160:163]
    ds_read_b128 v[80:83], v6 offset:32768
    v_mfma_f32_16x16x32_bf16 v[164:167], v[68:71], v[48:51], v[164:167]
    ds_read_b128 v[88:91], v6 offset:34816
    v_mfma_f32_16x16x32_bf16 v[168:171], v[72:75], v[48:51], v[168:171]
    ds_read_b128 v[96:99], v6 offset:36864
    v_mfma_f32_16x16x32_bf16 v[172:175], v[76:79], v[48:51], v[172:175]
    ds_read_b128 v[104:107], v6 offset:38912
    v_mfma_f32_16x16x32_bf16 v[176:179], v[64:67], v[56:59], v[176:179]
    v_mfma_f32_16x16x32_bf16 v[180:183], v[68:71], v[56:59], v[180:183]
    v_mfma_f32_16x16x32_bf16 v[184:187], v[72:75], v[56:59], v[184:187]
    v_mfma_f32_16x16x32_bf16 v[188:191], v[76:79], v[56:59], v[188:191]
    s_waitcnt lgkmcnt(0)
    s_waitcnt vmcnt(6)
    s_barrier
    s_add_u32 m0, s21, 98304
    s_nop 0
    buffer_load_dwordx4 v1, s[4:7], s16 offen sc1 lds
    s_add_u32 s16, s16, s62
    s_add_u32 m0, s22, 98304
    s_nop 0
    buffer_load_dwordx4 v2, s[8:11], s18 offen lds
    s_add_u32 s18, s18, s20
    s_add_u32 m0, s22, 106496
    s_nop 0
    buffer_load_dwordx4 v2, s[12:15], s19 offen lds
    s_add_u32 s19, s19, s20
    v_mfma_f32_16x16x32_bf16 v[128:131], v[112:115], v[80:83], v[128:131]
    ds_read_b64_tr_b16 v[64:65], v8 offset:16384
    v_mfma_f32_16x16x32_bf16 v[132:135], v[116:119], v[80:83], v[132:135]
    ds_read_b64_tr_b16 v[66:67], v9 offset:16384
    v_mfma_f32_16x16x32_bf16 v[136:139], v[120:123], v[80:83], v[136:139]
    ds_read_b64_tr_b16 v[68:69], v10 offset:16384
    v_mfma_f32_16x16x32_bf16 v[140:143], v[124:127], v[80:83], v[140:143]
    ds_read_b64_tr_b16 v[70:71], v11 offset:16384
    v_mfma_f32_16x16x32_bf16 v[144:147], v[112:115], v[88:91], v[144:147]
    ds_read_b64_tr_b16 v[72:73], v8 offset:24576
    v_mfma_f32_16x16x32_bf16 v[148:151], v[116:119], v[88:91], v[148:151]
    ds_read_b64_tr_b16 v[74:75], v9 offset:24576
    v_mfma_f32_16x16x32_bf16 v[152:155], v[120:123], v[88:91], v[152:155]
    ds_read_b64_tr_b16 v[76:77], v10 offset:24576
    v_mfma_f32_16x16x32_bf16 v[156:159], v[124:127], v[88:91], v[156:159]
    ds_read_b64_tr_b16 v[78:79], v11 offset:24576
    v_mfma_f32_16x16x32_bf16 v[160:163], v[112:115], v[96:99], v[160:163]
    ds_read_b128 v[32:35], v5 offset:0
    v_mfma_f32_16x16x32_bf16 v[164:167], v[116:119], v[96:99], v[164:167]
    ds_read_b128 v[40:43], v5 offset:2048
    v_mfma_f32_16x16x32_bf16 v[168:171], v[120:123], v[96:99], v[168:171]
    ds_read_b128 v[48:51], v5 offset:4096
    v_mfma_f32_16x16x32_bf16 v[172:175], v[124:127], v[96:99], v[172:175]
    ds_read_b128 v[56:59], v5 offset:6144
    v_mfma_f32_16x16x32_bf16 v[176:179], v[112:115], v[104:107], v[176:179]
    v_mfma_f32_16x16x32_bf16 v[180:183], v[116:119], v[104:107], v[180:183]
    v_mfma_f32_16x16x32_bf16 v[184:187], v[120:123], v[104:107], v[184:187]
    v_mfma_f32_16x16x32_bf16 v[188:191], v[124:127], v[104:107], v[188:191]
    s_waitcnt lgkmcnt(0)
w_loop_chkM:
    s_sub_u32 s23, s23, 1
w_loopM:
    s_cmp_lg_u32 s23, 1
    s_cbranch_scc1 w_bodyM
    v_readfirstlane_b32 s68, v22
    s_cmp_ge_u32 s68, 128
    s_cselect_b32 s70, 0, s70
    v_readfirstlane_b32 s30, v16
    s_cmp_ge_u32 s30, s45
    s_cselect_b32 s30, 0, 1
    s_or_b32 s30, s30, s70
    s_cmp_ge_u32 s32, 4
    s_cselect_b32 s30, 1, s30
    s_cmp_eq_u32 s32, 0
    s_cselect_b32 s30, 1, s30
    v_mov_b32 v20, s30
    ds_write_b32 v7, v20
    s_cbranch_scc1 w_bodyM
    s_load_dwordx2 s[8:9], s[0:1], s33
    s_load_dwordx2 s[12:13], s[0:1], s34
    s_mov_b32 s10, s38
    s_mov_b32 s14, s38
    s_cmp_ge_u32 s32, 4
    s_cselect_b32 s31, 0, 1
    s_lshl_b32 s30, s3, s31
    s_mul_i32 s30, s30, s40
    s_add_u32 s16, s39, s30
    s_cmp_eq_u32 s32, 4
    s_cselect_b32 s30, 1024, s40
    s_cselect_b32 s31, 6, 5
    s_lshl_b32 s62, 32, s31
    s_add_u32 s17, s16, s30
    s_lshl_b32 s30, s3, 2
    s_mul_i32 s30, s30, s35
    s_add_u32 s18, s36, s30
    s_add_u32 s19, s37, s30
    s_lshl_b32 s20, s35, s31
    v_mul_u32_u24 v2, s35, v4
    v_add_u32 v2, v2, v3
    s_waitcnt lgkmcnt(0)
    s_waitcnt vmcnt(6)
    s_barrier
    s_add_u32 m0, s21, 0
    s_nop 0
    buffer_load_dwordx4 v1, s[4:7], s16 offen sc1 lds
    s_add_u32 s16, s16, s62
    s_add_u32 m0, s21, 1024
    s_nop 0
    buffer_load_dwordx4 v1, s[4:7], s17 offen sc1 lds
    s_add_u32 s17, s17, s62
    s_add_u32 m0, s22, 0
    s_nop 0
    buffer_load_dwordx4 v2, s[8:11], s18 offen lds
    s_add_u32 s18, s18, s20
    s_add_u32 m0, s22, 8192
    s_nop 0
    buffer_load_dwordx4 v2, s[12:15], s19 offen lds
    s_add_u32 s19, s19, s20
    v_mfma_f32_16x16x32_bf16 v[128:131], v[64:67], v[32:35], v[128:131]
    ds_read_b64_tr_b16 v[112:113], v8 offset:49152
    v_mfma_f32_16x16x32_bf16 v[132:135], v[68:71], v[32:35], v[132:135]
    ds_read_b64_tr_b16 v[114:115], v9 offset:49152
    v_mfma_f32_16x16x32_bf16 v[136:139], v[72:75], v[32:35], v[136:139]
    ds_read_b64_tr_b16 v[116:117], v10 offset:49152
    v_mfma_f32_16x16x32_bf16 v[140:143], v[76:79], v[32:35], v[140:143]
    ds_read_b64_tr_b16 v[118:119], v11 offset:49152
    v_mfma_f32_16x16x32_bf16 v[144:147], v[64:67], v[40:43], v[144:147]
    ds_read_b64_tr_b16 v[120:121], v8 offset:57344
    v_mfma_f32_16x16x32_bf16 v[148:151], v[68:71], v[40:43], v[148:151]
    ds_read_b64_tr_b16 v[122:123], v9 offset:57344
    v_mfma_f32_16x16x32_bf16 v[152:155], v[72:75], v[40:43], v[152:155]
    ds_read_b64_tr_b16 v[124:125], v10 offset:57344
    v_mfma_f32_16x16x32_bf16 v[156:159], v[76:79], v[40:43], v[156:159]
    ds_read_b64_tr_b16 v[126:127], v11 offset:57344
    v_mfma_f32_16x16x32_bf16 v[160:163], v[64:67], v[48:51], v[160:163]
    ds_read_b128 v[80:83], v5 offset:32768
    v_mfma_f32_16x16x32_bf16 v[164:167], v[68:71], v[48:51], v[164:167]
    ds_read_b128 v[88:91], v5 offset:34816
    v_mfma_f32_16x16x32_bf16 v[168:171], v[72:75], v[48:51], v[168:171]
    ds_read_b128 v[96:99], v5 offset:36864
    v_mfma_f32_16x16x32_bf16 v[172:175], v[76:79], v[48:51], v[172:175]
    ds_read_b128 v[104:107], v5 offset:38912
    v_mfma_f32_16x16x32_bf16 v[176:179], v[64:67], v[56:59], v[176:179]
    v_mfma_f32_16x16x32_bf16 v[180:183], v[68:71], v[56:59], v[180:183]
    v_mfma_f32_16x16x32_bf16 v[184:187], v[72:75], v[56:59], v[184:187]
    v_mfma_f32_16x16x32_bf16 v[188:191], v[76:79], v[56:59], v[188:191]
    s_waitcnt lgkmcnt(0)
    s_waitcnt vmcnt(7)
    s_barrier
    s_add_u32 m0, s21, 32768
    s_nop 0
    buffer_load_dwordx4 v1, s[4:7], s16 offen sc1 lds
    s_add_u32 s16, s16, s62
    s_add_u32 m0, s21, 33792
    s_nop 0
    buffer_load_dwordx4 v1, s[4:7], s17 offen sc1 lds
    s_add_u32 s17, s17, s62
    s_add_u32 m0, s22, 32768
    s_nop 0
    buffer_load_dwordx4 v2, s[8:11], s18 offen lds
    s_add_u32 s18, s18, s20
    s_add_u32 m0, s22, 40960
    s_nop 0
    buffer_load_dwordx4 v2, s[12:15], s19 offen lds
    s_add_u32 s19, s19, s20
    v_mfma_f32_16x16x32_bf16 v[128:131], v[112:115], v[80:83], v[128:131]
    ds_read_b64_tr_b16 v[64:65], v12 offset:16384
    v_mfma_f32_16x16x32_bf16 v[132:135], v[116:119], v[80:83], v[132:135]
    ds_read_b64_tr_b16 v[66:67], v13 offset:16384
    v_mfma_f32_16x16x32_bf16 v[136:139], v[120:123], v[80:83], v[136:139]
    ds_read_b64_tr_b16 v[68:69], v14 offset:16384
    v_mfma_f32_16x16x32_bf16 v[140:143], v[124:127], v[80:83], v[140:143]
    ds_read_b64_tr_b16 v[70:71], v15 offset:16384
    v_mfma_f32_16x16x32_bf16 v[144:147], v[112:115], v[88:91], v[144:147]
    ds_read_b64_tr_b16 v[72:73], v12 offset:24576
    v_mfma_f32_16x16x32_bf16 v[148:151], v[116:119], v[88:91], v[148:151]
    ds_read_b64_tr_b16 v[74:75], v13 offset:24576
    v_mfma_f32_16x16x32_bf16 v[152:155], v[120:123], v[88:91], v[152:155]
    ds_read_b64_tr_b16 v[76:77], v14 offset:24576
    v_mfma_f32_16x16x32_bf16 v[156:159], v[124:127], v[88:91], v[156:159]
    ds_read_b64_tr_b16 v[78:79], v15 offset:24576
    v_mfma_f32_16x16x32_bf16 v[160:163], v[112:115], v[96:99], v[160:163]
    ds_read_b128 v[32:35], v6 offset:0
    v_mfma_f32_16x16x32_bf16 v[164:167], v[116:119], v[96:99], v[164:167]
    ds_read_b128 v[40:43], v6 offset:2048
    v_mfma_f32_16x16x32_bf16 v[168:171], v[120:123], v[96:99], v[168:171]
    ds_read_b128 v[48:51], v6 offset:4096
    v_mfma_f32_16x16x32_bf16 v[172:175], v[124:127], v[96:99], v[172:175]
    ds_read_b128 v[56:59], v6 offset:6144
    v_mfma_f32_16x16x32_bf16 v[176:179], v[112:115], v[104:107], v[176:179]
    v_mfma_f32_16x16x32_bf16 v[180:183], v[116:119], v[104:107], v[180:183]
    v_mfma_f32_16x16x32_bf16 v[184:187], v[120:123], v[104:107], v[184:187]
    v_mfma_f32_16x16x32_bf16 v[188:191], v[124:127], v[104:107], v[188:191]
    s_waitcnt lgkmcnt(0)
    s_waitcnt vmcnt(8)
    s_barrier
    s_add_u32 m0, s21, 65536
    s_nop 0
    buffer_load_dwordx4 v1, s[4:7], s16 offen sc1 lds
    s_add_u32 s16, s16, s62
    s_add_u32 m0, s21, 66560
    s_nop 0
    buffer_load_dwordx4 v1, s[4:7], s17 offen sc1 lds
    s_add_u32 s17, s17, s62
    s_add_u32 m0, s22, 65536
    s_nop 0
    buffer_load_dwordx4 v2, s[8:11], s18 offen lds
    s_add_u32 s18, s18, s20
    s_add_u32 m0, s22, 73728
    s_nop 0
    buffer_load_dwordx4 v2, s[12:15], s19 offen lds
    s_add_u32 s19, s19, s20
    v_mfma_f32_16x16x32_bf16 v[128:131], v[64:67], v[32:35], v[128:131]
    ds_read_b64_tr_b16 v[112:113], v12 offset:49152
    v_mfma_f32_16x16x32_bf16 v[132:135], v[68:71], v[32:35], v[132:135]
    ds_read_b64_tr_b16 v[114:115], v13 offset:49152
    v_mfma_f32_16x16x32_bf16 v[136:139], v[72:75], v[32:35], v[136:139]
    ds_read_b64_tr_b16 v[116:117], v14 offset:49152
    v_mfma_f32_16x16x32_bf16 v[140:143], v[76:79], v[32:35], v[140:143]
    ds_read_b64_tr_b16 v[118:119], v15 offset:49152
    v_mfma_f32_16x16x32_bf16 v[144:147], v[64:67], v[40:43], v[144:147]
    ds_read_b64_tr_b16 v[120:121], v12 offset:57344
    v_mfma_f32_16x16x32_bf16 v[148:151], v[68:71], v[40:43], v[148:151]
    ds_read_b64_tr_b16 v[122:123], v13 offset:57344
    v_mfma_f32_16x16x32_bf16 v[152:155], v[72:75], v[40:43], v[152:155]
    ds_read_b64_tr_b16 v[124:125], v14 offset:57344
    v_mfma_f32_16x16x32_bf16 v[156:159], v[76:79], v[40:43], v[156:159]
    ds_read_b64_tr_b16 v[126:127], v15 offset:57344
    v_mfma_f32_16x16x32_bf16 v[160:163], v[64:67], v[48:51], v[160:163]
    ds_read_b128 v[80:83], v6 offset:32768
    v_mfma_f32_16x16x32_bf16 v[164:167], v[68:71], v[48:51], v[164:167]
    ds_read_b128 v[88:91], v6 offset:34816
    v_mfma_f32_16x16x32_bf16 v[168:171], v[72:75], v[48:51], v[168:171]
    ds_read_b128 v[96:99], v6 offset:36864
    v_mfma_f32_16x16x32_bf16 v[172:175], v[76:79], v[48:51], v[172:175]
    ds_read_b128 v[104:107], v6 offset:38912
    v_mfma_f32_16x16x32_bf16 v[176:179], v[64:67], v[56:59], v[176:179]
    v_mfma_f32_16x16x32_bf16 v[180:183], v[68:71], v[56:59], v[180:183]
    v_mfma_f32_16x16x32_bf16 v[184:187], v[72:75], v[56:59], v[184:187]
    v_mfma_f32_16x16x32_bf16 v[188:191], v[76:79], v[56:59], v[188:191]
    s_waitcnt lgkmcnt(0)
    s_waitcnt vmcnt(8)
    s_barrier
    s_add_u32 m0, s21, 98304
    s_nop 0
    buffer_load_dwordx4 v1, s[4:7], s16 offen sc1 lds
    s_add_u32 s16, s16, s62
    s_add_u32 m0, s21, 99328
    s_nop 0
    buffer_load_dwordx4 v1, s[4:7], s17 offen sc1 lds
    s_add_u32 s17, s17, s62
    s_add_u32 m0, s22, 98304
    s_nop 0
    buffer_load_dwordx4 v2, s[8:11], s18 offen lds
    s_add_u32 s18, s18, s20
    s_add_u32 m0, s22, 106496
    s_nop 0
    buffer_load_dwordx4 v2, s[12:15], s19 offen lds
    s_add_u32 s19, s19, s20
    v_mfma_f32_16x16x32_bf16 v[128:131], v[112:115], v[80:83], v[128:131]
    ds_read_b64_tr_b16 v[64:65], v8 offset:16384
    v_mfma_f32_16x16x32_bf16 v[132:135], v[116:119], v[80:83], v[132:135]
    ds_read_b64_tr_b16 v[66:67], v9 offset:16384
    v_mfma_f32_16x16x32_bf16 v[136:139], v[120:123], v[80:83], v[136:139]
    ds_read_b64_tr_b16 v[68:69], v10 offset:16384
    v_mfma_f32_16x16x32_bf16 v[140:143], v[124:127], v[80:83], v[140:143]
    ds_read_b64_tr_b16 v[70:71], v11 offset:16384
    v_mfma_f32_16x16x32_bf16 v[144:147], v[112:115], v[88:91], v[144:147]
    ds_read_b64_tr_b16 v[72:73], v8 offset:24576
    v_mfma_f32_16x16x32_bf16 v[148:151], v[116:119], v[88:91], v[148:151]
    ds_read_b64_tr_b16 v[74:75], v9 offset:24576
    v_mfma_f32_16x16x32_bf16 v[152:155], v[120:123], v[88:91], v[152:155]
    ds_read_b64_tr_b16 v[76:77], v10 offset:24576
    v_mfma_f32_16x16x32_bf16 v[156:159], v[124:127], v[88:91], v[156:159]
    ds_read_b64_tr_b16 v[78:79], v11 offset:24576
    v_mfma_f32_16x16x32_bf16 v[160:163], v[112:115], v[96:99], v[160:163]
    ds_read_b128 v[32:35], v5 offset:0
    v_mfma_f32_16x16x32_bf16 v[164:167], v[116:119], v[96:99], v[164:167]
    ds_read_b128 v[36:39], v5 offset:1024
    v_mfma_f32_16x16x32_bf16 v[168:171], v[120:123], v[96:99], v[168:171]
    ds_read_b128 v[40:43], v5 offset:2048
    v_mfma_f32_16x16x32_bf16 v[172:175], v[124:127], v[96:99], v[172:175]
    ds_read_b128 v[44:47], v5 offset:3072
    v_mfma_f32_16x16x32_bf16 v[176:179], v[112:115], v[104:107], v[176:179]
    ds_read_b128 v[48:51], v5 offset:4096
    v_mfma_f32_16x16x32_bf16 v[180:183], v[116:119], v[104:107], v[180:183]
    ds_read_b128 v[52:55], v5 offset:5120
    v_mfma_f32_16x16x32_bf16 v[184:187], v[120:123], v[104:107], v[184:187]
    ds_read_b128 v[56:59], v5 offset:6144
    v_mfma_f32_16x16x32_bf16 v[188:191], v[124:127], v[104:107], v[188:191]
    ds_read_b128 v[60:63], v5 offset:7168
    s_waitcnt lgkmcnt(0)
    s_branch w_doneM
w_bodyM:
    buffer_load_dword v22, off, s[64:67], 0 sc1
    s_waitcnt vmcnt(6)
    s_barrier
    s_add_u32 m0, s21, 0
    s_nop 0
    buffer_load_dwordx4 v1, s[4:7], s16 offen sc1 lds
    s_add_u32 s16, s16, s62
    s_add_u32 m0, s22, 0
    s_nop 0
    buffer_load_dwordx4 v2, s[8:11], s18 offen lds
    s_add_u32 s18, s18, s20
    s_add_u32 m0, s22, 8192
    s_nop 0
    buffer_load_dwordx4 v2, s[12:15], s19 offen lds
    s_add_u32 s19, s19, s20
    v_mfma_f32_16x16x32_bf16 v[128:131], v[64:67], v[32:35], v[128:131]
    ds_read_b64_tr_b16 v[112:113], v8 offset:49152
    v_mfma_f32_16x16x32_bf16 v[132:135], v[68:71], v[32:35], v[132:135]
    ds_read_b64_tr_b16 v[114:115], v9 offset:49152
    v_mfma_f32_16x16x32_bf16 v[136:139], v[72:75], v[32:35], v[136:139]
    ds_read_b64_tr_b16 v[116:117], v10 offset:49152
    v_mfma_f32_16x16x32_bf16 v[140:143], v[76:79], v[32:35], v[140:143]
    ds_read_b64_tr_b16 v[118:119], v11 offset:49152
    v_mfma_f32_16x16x32_bf16 v[144:147], v[64:67], v[40:43], v[144:147]
    ds_read_b64_tr_b16 v[120:121], v8 offset:57344
    v_mfma_f32_16x16x32_bf16 v[148:151], v[68:71], v[40:43], v[148:151]
    ds_read_b64_tr_b16 v[122:123], v9 offset:57344
    v_mfma_f32_16x16x32_bf16 v[152:155], v[72:75], v[40:43], v[152:155]
    ds_read_b64_tr_b16 v[124:125], v10 offset:57344
    v_mfma_f32_16x16x32_bf16 v[156:159], v[76:79], v[40:43], v[156:159]
    ds_read_b64_tr_b16 v[126:127], v11 offset:57344
    v_mfma_f32_16x16x32_bf16 v[160:163], v[64:67], v[48:51], v[160:163]
    ds_read_b128 v[80:83], v5 offset:32768
    v_mfma_f32_16x16x32_bf16 v[164:167], v[68:71], v[48:51], v[164:167]
    ds_read_b128 v[88:91], v5 offset:34816
    v_mfma_f32_16x16x32_bf16 v[168:171], v[72:75], v[48:51], v[168:171]
    ds_read_b128 v[96:99], v5 offset:36864
    v_mfma_f32_16x16x32_bf16 v[172:175], v[76:79], v[48:51], v[172:175]
    ds_read_b128 v[104:107], v5 offset:38912
    v_mfma_f32_16x16x32_bf16 v[176:179], v[64:67], v[56:59], v[176:179]
    v_mfma_f32_16x16x32_bf16 v[180:183], v[68:71], v[56:59], v[180:183]
    v_mfma_f32_16x16x32_bf16 v[184:187], v[72:75], v[56:59], v[184:187]
    v_mfma_f32_16x16x32_bf16 v[188:191], v[76:79], v[56:59], v[188:191]
    buffer_load_dword v16, v17, s[4:7], s44 offen sc1
    s_waitcnt lgkmcnt(0)
    s_waitcnt vmcnt(6)
    s_barrier
    s_add_u32 m0, s21, 32768
    s_nop 0
    buffer_load_dwordx4 v1, s[4:7], s16 offen sc1 lds
    s_add_u32 s16, s16, s62
    s_add_u32 m0, s22, 32768
    s_nop 0
    buffer_load_dwordx4 v2, s[8:11], s18 offen lds
    s_add_u32 s18, s18, s20
    s_add_u32 m0, s22, 40960
    s_nop 0
    buffer_load_dwordx4 v2, s[12:15], s19 offen lds
    s_add_u32 s19, s19, s20
    v_mfma_f32_16x16x32_bf16 v[128:131], v[112:115], v[80:83], v[128:131]
    ds_read_b64_tr_b16 v[64:65], v12 offset:16384
    v_mfma_f32_16x16x32_bf16 v[132:135], v[116:119], v[80:83], v[132:135]
    ds_read_b64_tr_b16 v[66:67], v13 offset:16384
    v_mfma_f32_16x16x32_bf16 v[136:139], v[120:123], v[80:83], v[136:139]
    ds_read_b64_tr_b16 v[68:69], v14 offset:16384
    v_mfma_f32_16x16x32_bf16 v[140:143], v[124:127], v[80:83], v[140:143]
    ds_read_b64_tr_b16 v[70:71], v15 offset:16384
    v_mfma_f32_16x16x32_bf16 v[144:147], v[112:115], v[88:91], v[144:147]
    ds_read_b64_tr_b16 v[72:73], v12 offset:24576
    v_mfma_f32_16x16x32_bf16 v[148:151], v[116:119], v[88:91], v[148:151]
    ds_read_b64_tr_b16 v[74:75], v13 offset:24576
    v_mfma_f32_16x16x32_bf16 v[152:155], v[120:123], v[88:91], v[152:155]
    ds_read_b64_tr_b16 v[76:77], v14 offset:24576
    v_mfma_f32_16x16x32_bf16 v[156:159], v[124:127], v[88:91], v[156:159]
    ds_read_b64_tr_b16 v[78:79], v15 offset:24576
    v_mfma_f32_16x16x32_bf16 v[160:163], v[112:115], v[96:99], v[160:163]
    ds_read_b128 v[32:35], v6 offset:0
    v_mfma_f32_16x16x32_bf16 v[164:167], v[116:119], v[96:99], v[164:167]
    ds_read_b128 v[40:43], v6 offset:2048
    v_mfma_f32_16x16x32_bf16 v[168:171], v[120:123], v[96:99], v[168:171]
    ds_read_b128 v[48:51], v6 offset:4096
    v_mfma_f32_16x16x32_bf16 v[172:175], v[124:127], v[96:99], v[172:175]
    ds_read_b128 v[56:59], v6 offset:6144
    v_mfma_f32_16x16x32_bf16 v[176:179], v[112:115], v[104:107], v[176:179]
    v_mfma_f32_16x16x32_bf16 v[180:183], v[116:119], v[104:107], v[180:183]
    v_mfma_f32_16x16x32_bf16 v[184:187], v[120:123], v[104:107], v[184:187]
    v_mfma_f32_16x16x32_bf16 v[188:191], v[124:127], v[104:107], v[188:191]
    s_waitcnt lgkmcnt(0)
    s_waitcnt vmcnt(6)
    s_barrier
    s_add_u32 m0, s21, 65536
    s_nop 0
    buffer_load_dwordx4 v1, s[4:7], s16 offen sc1 lds
    s_add_u32 s16, s16, s62
    s_add_u32 m0, s22, 65536
    s_nop 0
    buffer_load_dwordx4 v2, s[8:11], s18 offen lds
    s_add_u32 s18, s18, s20
    s_add_u32 m0, s22, 73728
    s_nop 0
    buffer_load_dwordx4 v2, s[12:15], s19 offen lds
    s_add_u32 s19, s19, s20
    v_mfma_f32_16x16x32_bf16 v[128:131], v[64:67], v[32:35], v[128:131]
    ds_read_b64_tr_b16 v[112:113], v12 offset:49152
    v_mfma_f32_16x16x32_bf16 v[132:135], v[68:71], v[32:35], v[132:135]
    ds_read_b64_tr_b16 v[114:115], v13 offset:49152
    v_mfma_f32_16x16x32_bf16 v[136:139], v[72:75], v[32:35], v[136:139]
    ds_read_b64_tr_b16 v[116:117], v14 offset:49152
    v_mfma_f32_16x16x32_bf16 v[140:143], v[76:79], v[32:35], v[140:143]
    ds_read_b64_tr_b16 v[118:119], v15 offset:49152
    v_mfma_f32_16x16x32_bf16 v[144:147], v[64:67], v[40:43], v[144:147]
    ds_read_b64_tr_b16 v[120:121], v12 offset:57344
    v_mfma_f32_16x16x32_bf16 v[148:151], v[68:71], v[40:43], v[148:151]
    ds_read_b64_tr_b16 v[122:123], v13 offset:57344
    v_mfma_f32_16x16x32_bf16 v[152:155], v[72:75], v[40:43], v[152:155]
    ds_read_b64_tr_b16 v[124:125], v14 offset:57344
    v_mfma_f32_16x16x32_bf16 v[156:159], v[76:79], v[40:43], v[156:159]
    ds_read_b64_tr_b16 v[126:127], v15 offset:57344
    v_mfma_f32_16x16x32_bf16 v[160:163], v[64:67], v[48:51], v[160:163]
    ds_read_b128 v[80:83], v6 offset:32768
    v_mfma_f32_16x16x32_bf16 v[164:167], v[68:71], v[48:51], v[164:167]
    ds_read_b128 v[88:91], v6 offset:34816
    v_mfma_f32_16x16x32_bf16 v[168:171], v[72:75], v[48:51], v[168:171]
    ds_read_b128 v[96:99], v6 offset:36864
    v_mfma_f32_16x16x32_bf16 v[172:175], v[76:79], v[48:51], v[172:175]
    ds_read_b128 v[104:107], v6 offset:38912
    v_mfma_f32_16x16x32_bf16 v[176:179], v[64:67], v[56:59], v[176:179]
    v_mfma_f32_16x16x32_bf16 v[180:183], v[68:71], v[56:59], v[180:183]
    v_mfma_f32_16x16x32_bf16 v[184:187], v[72:75], v[56:59], v[184:187]
    v_mfma_f32_16x16x32_bf16 v[188:191], v[76:79], v[56:59], v[188:191]
    s_waitcnt lgkmcnt(0)
    s_waitcnt vmcnt(6)
    s_barrier
    s_add_u32 m0, s21, 98304
    s_nop 0
    buffer_load_dwordx4 v1, s[4:7], s16 offen sc1 lds
    s_add_u32 s16, s16, s62
    s_add_u32 m0, s22, 98304
    s_nop 0
    buffer_load_dwordx4 v2, s[8:11], s18 offen lds
    s_add_u32 s18, s18, s20
    s_add_u32 m0, s22, 106496
    s_nop 0
    buffer_load_dwordx4 v2, s[12:15], s19 offen lds
    s_add_u32 s19, s19, s20
    v_mfma_f32_16x16x32_bf16 v[128:131], v[112:115], v[80:83], v[128:131]
    ds_read_b64_tr_b16 v[64:65], v8 offset:16384
    v_mfma_f32_16x16x32_bf16 v[132:135], v[116:119], v[80:83], v[132:135]
    ds_read_b64_tr_b16 v[66:67], v9 offset:16384
    v_mfma_f32_16x16x32_bf16 v[136:139], v[120:123], v[80:83], v[136:139]
    ds_read_b64_tr_b16 v[68:69], v10 offset:16384
    v_mfma_f32_16x16x32_bf16 v[140:143], v[124:127], v[80:83], v[140:143]
    ds_read_b64_tr_b16 v[70:71], v11 offset:16384
    v_mfma_f32_16x16x32_bf16 v[144:147], v[112:115], v[88:91], v[144:147]
    ds_read_b64_tr_b16 v[72:73], v8 offset:24576
    v_mfma_f32_16x16x32_bf16 v[148:151], v[116:119], v[88:91], v[148:151]
    ds_read_b64_tr_b16 v[74:75], v9 offset:24576
    v_mfma_f32_16x16x32_bf16 v[152:155], v[120:123], v[88:91], v[152:155]
    ds_read_b64_tr_b16 v[76:77], v10 offset:24576
    v_mfma_f32_16x16x32_bf16 v[156:159], v[124:127], v[88:91], v[156:159]
    ds_read_b64_tr_b16 v[78:79], v11 offset:24576
    v_mfma_f32_16x16x32_bf16 v[160:163], v[112:115], v[96:99], v[160:163]
    ds_read_b128 v[32:35], v5 offset:0
    v_mfma_f32_16x16x32_bf16 v[164:167], v[116:119], v[96:99], v[164:167]
    ds_read_b128 v[40:43], v5 offset:2048
    v_mfma_f32_16x16x32_bf16 v[168:171], v[120:123], v[96:99], v[168:171]
    ds_read_b128 v[48:51], v5 offset:4096
    v_mfma_f32_16x16x32_bf16 v[172:175], v[124:127], v[96:99], v[172:175]
    ds_read_b128 v[56:59], v5 offset:6144
    v_mfma_f32_16x16x32_bf16 v[176:179], v[112:115], v[104:107], v[176:179]
    v_mfma_f32_16x16x32_bf16 v[180:183], v[116:119], v[104:107], v[180:183]
    v_mfma_f32_16x16x32_bf16 v[184:187], v[120:123], v[104:107], v[184:187]
    v_mfma_f32_16x16x32_bf16 v[188:191], v[124:127], v[104:107], v[188:191]
    s_waitcnt lgkmcnt(0)
    s_sub_u32 s23, s23, 1
    s_cmp_lg_u32 s23, 0
    s_cbranch_scc1 w_loopM
w_doneM:
    v_mov_b32 v20, 131072
    ds_read_b128 v[24:27], v20
    ds_read_b128 v[28:31], v20 offset:16
    s_lshl_b32 s30, s27, 10
    s_add_u32 s30, s30, s49
    s_nop 7
    v_cvt_pk_bf16_f32 v80, v128, v129
    v_cvt_pk_bf16_f32 v81, v130, v131
    v_cvt_pk_bf16_f32 v82, v132, v133
    v_cvt_pk_bf16_f32 v83, v134, v135
    buffer_store_dwordx4 v[80:83], v1, s[4:7], s30 offen sc1
    v_cvt_pk_bf16_f32 v84, v136, v137
    v_cvt_pk_bf16_f32 v85, v138, v139
    v_cvt_pk_bf16_f32 v86, v140, v141
    v_cvt_pk_bf16_f32 v87, v142, v143
    buffer_store_dwordx4 v[84:87], v19, s[4:7], s30 offen sc1
    s_add_u32 s30, s30, s50
    v_cvt_pk_bf16_f32 v88, v144, v145
    v_cvt_pk_bf16_f32 v89, v146, v147
    v_cvt_pk_bf16_f32 v90, v148, v149
    v_cvt_pk_bf16_f32 v91, v150, v151
    buffer_store_dwordx4 v[88:91], v1, s[4:7], s30 offen sc1
    v_cvt_pk_bf16_f32 v92, v152, v153
    v_cvt_pk_bf16_f32 v93, v154, v155
    v_cvt_pk_bf16_f32 v94, v156, v157
    v_cvt_pk_bf16_f32 v95, v158, v159
    buffer_store_dwordx4 v[92:95], v19, s[4:7], s30 offen sc1
    s_add_u32 s30, s30, s50
    v_cvt_pk_bf16_f32 v80, v160, v161
    v_cvt_pk_bf16_f32 v81, v162, v163
    v_cvt_pk_bf16_f32 v82, v164, v165
    v_cvt_pk_bf16_f32 v83, v166, v167
    buffer_store_dwordx4 v[80:83], v1, s[4:7], s30 offen sc1
    v_cvt_pk_bf16_f32 v84, v168, v169
    v_cvt_pk_bf16_f32 v85, v170, v171
    v_cvt_pk_bf16_f32 v86, v172, v173
    v_cvt_pk_bf16_f32 v87, v174, v175
    buffer_store_dwordx4 v[84:87], v19, s[4:7], s30 offen sc1
    s_add_u32 s30, s30, s50
    v_cvt_pk_bf16_f32 v88, v176, v177
    v_cvt_pk_bf16_f32 v89, v178, v179
    v_cvt_pk_bf16_f32 v90, v180, v181
    v_cvt_pk_bf16_f32 v91, v182, v183
    buffer_store_dwordx4 v[88:91], v1, s[4:7], s30 offen sc1
    v_cvt_pk_bf16_f32 v92, v184, v185
    v_cvt_pk_bf16_f32 v93, v186, v187
    v_cvt_pk_bf16_f32 v94, v188, v189
    v_cvt_pk_bf16_f32 v95, v190, v191
    buffer_store_dwordx4 v[92:95], v19, s[4:7], s30 offen sc1
    s_add_u32 s30, s30, s50
    s_waitcnt lgkmcnt(0)
    v_or3_b32 v24, v24, v25, v26
    v_or3_b32 v28, v28, v29, v30
    v_or3_b32 v24, v24, v27, v31
    v_or_b32 v24, v24, v28
    s_mov_b32 s28, s51
    s_mov_b32 s57, s53
    v_readfirstlane_b32 s30, v24
    s_cmp_lg_u32 s30, 0
    s_cbranch_scc1 w_drain
    s_mov_b32 s48, s32
    s_cmp_ge_u32 s32, 4
    s_cselect_b32 s30, 2, 3
    s_lshl_b32 s30, s26, s30
    s_mul_i32 s30, s30, s43
    s_add_u32 s49, s42, s30
    s_mov_b32 s50, s43
    s_mov_b32 s51, s46
    s_mov_b32 s23, s41
    s_mov_b32 s53, s47
    s_nop 0
    s_load_dwordx16 s[32:47], s[24:25], 0
    s_add_u32 s24, s24, 64
    s_addc_u32 s25, s25, 0
    s_branch w_first8
w_drain:
    s_waitcnt vmcnt(0)
    s_barrier
    s_cmp_eq_u32 s70, 0
    s_cbranch_scc1 drw_ok
    s_mov_b32 s70, 0
    s_cmp_lg_u32 s3, 0
    s_cbranch_scc1 drw_ok
    v_readfirstlane_b32 s68, v22
    s_cmp_ge_u32 s68, 128
    s_cbranch_scc1 drw_ok
    s_mov_b32 s69, 65536
drw:
    buffer_load_dword v20, off, s[64:67], 0 offset:0 sc1
    s_waitcnt vmcnt(0)
    v_readfirstlane_b32 s68, v20
    s_cmp_ge_u32 s68, 128
    s_cbranch_scc1 drw_ok
    s_sleep 8
    s_sub_u32 s69, s69, 1
    s_cbranch_scc0 drw
drw_ok:
    s_cmp_eq_u32 s28, 0
    s_cbranch_scc1 sig_5
    s_cmp_lg_u32 s3, 0
    s_cbranch_scc1 sig_5
    s_mov_b64 exec, 1
    v_mov_b32 v18, s57
    buffer_atomic_add v18, v17, s[4:7], s28 offen sc1
    s_mov_b64 exec, -1
sig_5:
    s_mov_b32 s28, 0
    s_branch w_cold
fin_entry:
    s_load_dwordx2 s[8:9], s[0:1], 0
    s_load_dwordx2 s[12:13], s[0:1], 88
    v_mbcnt_lo_u32_b32 v1, -1, 0
    v_mbcnt_hi_u32_b32 v1, -1, v1
    s_mov_b32 s10, 4194304
    s_mov_b32 s11, 131072
    s_mov_b32 s14, 4194304
    s_mov_b32 s15, 131072
    v_lshlrev_b32 v3, 4, v1
    v_and_b32 v4, 15, v1
    v_lshrrev_b32 v5, 4, v1
    v_lshlrev_b32 v4, 11, v4
    v_lshl_add_u32 v4, v5, 4, v4
    v_and_b32 v5, 1, v5
    v_cmp_eq_u32 s[20:21], 1, v5
    v_and_b32 v6, 7, v1
    v_lshlrev_b32 v6, 7, v6
    s_lshr_b32 s24, s63, 2
    s_and_b32 s25, s63, 3
    s_lshl_b32 s25, s25, 2
    s_and_b32 s26, s3, 3
    s_add_u32 s25, s25, s26
    s_lshr_b32 s26, s3, 2
    s_mov_b32 s28, 65536
    s_waitcnt lgkmcnt(0)
fin_job:
    s_lshl_b32 s16, s24, 1
    s_add_u32 s16, s16, s26
    s_lshl_b32 s18, s16, 15
    s_lshl_b32 s17, s25, 11
    s_add_u32 s17, s17, s18
    s_lshl_b32 s19, s25, 7
    s_add_u32 s18, s18, s19
    s_add_u32 s22, s17, 167772160
    s_add_u32 s23, s17, 75497472
    s_lshr_b32 s27, s24, 3
    s_lshl_b32 s27, s27, 6
    s_add_u32 s27, s27, 218106368
    s_cmp_ge_u32 s24, 64
    s_cselect_b32 s29, 16, 16
    s_mov_b32 s30, 218112000
    s_add_u32 s32, s24, 1
    s_mov_b32 s33, 0
    s_mov_b32 s34, 255
    s_cmp_lt_u32 s24, 62
    s_cbranch_scc1 fin_tg
    s_mov_b32 s32, 16
    s_add_u32 s30, s30, 4
    s_sub_u32 s33, s24, 62
    s_lshl_b32 s33, s33, 3
fin_tg:
    s_mul_i32 s35, s24, 3
    s_lshr_b32 s35, s35, 4
    s_add_u32 s35, s35, 49
    s_min_u32 s35, s35, 61
    s_max_u32 s32, s32, s35
    buffer_load_dwordx4 v[88:91], v4, s[8:11], s18 offen offset:0
    buffer_load_dwordx4 v[92:95], v4, s[8:11], s18 offen offset:64
    s_cmp_lg_u32 s3, 0
    s_cbranch_scc1 fin_ws_ok
fin_wd:
    buffer_load_dword v7, off, s[4:7], s27 sc1
    s_waitcnt vmcnt(0)
    v_readfirstlane_b32 s31, v7
    s_cmp_ge_u32 s31, s29
    s_cbranch_scc1 fin_wd_ok
    s_sleep 127
    s_sub_u32 s28, s28, 1
    s_cbranch_scc0 fin_wd
    s_mov_b32 s28, 0
fin_wd_ok:
fin_ws:
    buffer_load_dword v7, v6, s[4:7], s30 offen sc1
    s_waitcnt vmcnt(0)
    v_lshrrev_b32 v7, s33, v7
    v_and_b32 v7, s34, v7
    v_cmp_gt_u32 vcc, s32, v7
    s_cbranch_vccz fin_ws_ok
    s_sleep 12
    v_add_u32 v7, 1, v7
    v_cmp_gt_u32 vcc, s32, v7
    s_cbranch_vccz fin_ws_f
    s_sleep 48
    v_add_u32 v7, 3, v7
    v_cmp_gt_u32 vcc, s32, v7
    s_cbranch_vccz fin_ws_f
    s_sleep 127
    s_sleep 127
fin_ws_f:
    s_sub_u32 s28, s28, 1
    s_cbranch_scc0 fin_ws
    s_mov_b32 s28, 0
fin_ws_ok:
    s_barrier
    buffer_load_dwordx4 v[144:147], v3, s[4:7], s22 offen offset:0 sc1
    buffer_load_dwordx4 v[160:163], v3, s[4:7], s22 offen offset:1024 sc1
    s_add_u32 s22, s22, 4194304
    buffer_load_dwordx4 v[148:151], v3, s[4:7], s22 offen offset:0 sc1
    buffer_load_dwordx4 v[164:167], v3, s[4:7], s22 offen offset:1024 sc1
    s_add_u32 s22, s22, 4194304
    buffer_load_dwordx4 v[152:155], v3, s[4:7], s22 offen offset:0 sc1
    buffer_load_dwordx4 v[168:171], v3, s[4:7], s22 offen offset:1024 sc1
    s_add_u32 s22, s22, 4194304
    buffer_load_dwordx4 v[156:159], v3, s[4:7], s22 offen offset:0 sc1
    buffer_load_dwordx4 v[172:175], v3, s[4:7], s22 offen offset:1024 sc1
    buffer_load_dwordx4 v[16:19], v3, s[4:7], s23 offen offset:0 sc1
    buffer_load_dwordx4 v[48:51], v3, s[4:7], s23 offen offset:1024 sc1
    s_add_u32 s23, s23, 4194304
    buffer_load_dwordx4 v[20:23], v3, s[4:7], s23 offen offset:0 sc1
    buffer_load_dwordx4 v[52:55], v3, s[4:7], s23 offen offset:1024 sc1
    s_add_u32 s23, s23, 4194304
    buffer_load_dwordx4 v[24:27], v3, s[4:7], s23 offen offset:0 sc1
    buffer_load_dwordx4 v[56:59], v3, s[4:7], s23 offen offset:1024 sc1
    s_add_u32 s23, s23, 4194304
    buffer_load_dwordx4 v[28:31], v3, s[4:7], s23 offen offset:0 sc1
    buffer_load_dwordx4 v[60:63], v3, s[4:7], s23 offen offset:1024 sc1
    s_add_u32 s23, s23, 4194304
    buffer_load_dwordx4 v[32:35], v3, s[4:7], s23 offen offset:0 sc1
    buffer_load_dwordx4 v[64:67], v3, s[4:7], s23 offen offset:1024 sc1
    s_add_u32 s23, s23, 4194304
    buffer_load_dwordx4 v[36:39], v3, s[4:7], s23 offen offset:0 sc1
    buffer_load_dwordx4 v[68:71], v3, s[4:7], s23 offen offset:1024 sc1
    s_add_u32 s23, s23, 4194304
    buffer_load_dwordx4 v[40:43], v3, s[4:7], s23 offen offset:0 sc1
    buffer_load_dwordx4 v[72:75], v3, s[4:7], s23 offen offset:1024 sc1
    s_add_u32 s23, s23, 4194304
    buffer_load_dwordx4 v[44:47], v3, s[4:7], s23 offen offset:0 sc1
    buffer_load_dwordx4 v[76:79], v3, s[4:7], s23 offen offset:1024 sc1
    s_add_u32 s23, s23, 4194304
    s_waitcnt vmcnt(16)
    v_lshlrev_b32 v96, 16, v144
    v_and_b32 v97, 0xffff0000, v144
    v_lshlrev_b32 v98, 16, v145
    v_and_b32 v99, 0xffff0000, v145
    v_lshlrev_b32 v100, 16, v146
    v_and_b32 v101, 0xffff0000, v146
    v_lshlrev_b32 v102, 16, v147
    v_and_b32 v103, 0xffff0000, v147
    v_lshlrev_b32 v120, 16, v148
    v_and_b32 v121, 0xffff0000, v148
    v_lshlrev_b32 v122, 16, v149
    v_and_b32 v123, 0xffff0000, v149
    v_lshlrev_b32 v124, 16, v150
    v_and_b32 v125, 0xffff0000, v150
    v_lshlrev_b32 v126, 16, v151
    v_and_b32 v127, 0xffff0000, v151
    v_add_f32 v96, v96, v120
    v_add_f32 v97, v97, v121
    v_add_f32 v98, v98, v122
    v_add_f32 v99, v99, v123
    v_add_f32 v100, v100, v124
    v_add_f32 v101, v101, v125
    v_add_f32 v102, v102, v126
    v_add_f32 v103, v103, v127
    v_lshlrev_b32 v120, 16, v152
    v_and_b32 v121, 0xffff0000, v152
    v_lshlrev_b32 v122, 16, v153
    v_and_b32 v123, 0xffff0000, v153
    v_lshlrev_b32 v124, 16, v154
    v_and_b32 v125, 0xffff0000, v154
    v_lshlrev_b32 v126, 16, v155
    v_and_b32 v127, 0xffff0000, v155
    v_add_f32 v96, v96, v120
    v_add_f32 v97, v97, v121
    v_add_f32 v98, v98, v122
    v_add_f32 v99, v99, v123
    v_add_f32 v100, v100, v124
    v_add_f32 v101, v101, v125
    v_add_f32 v102, v102, v126
    v_add_f32 v103, v103, v127
    v_lshlrev_b32 v120, 16, v156
    v_and_b32 v121, 0xffff0000, v156
    v_lshlrev_b32 v122, 16, v157
    v_and_b32 v123, 0xffff0000, v157
    v_lshlrev_b32 v124, 16, v158
    v_and_b32 v125, 0xffff0000, v158
    v_lshlrev_b32 v126, 16, v159
    v_and_b32 v127, 0xffff0000, v159
    v_add_f32 v96, v96, v120
    v_add_f32 v97, v97, v121
    v_add_f32 v98, v98, v122
    v_add_f32 v99, v99, v123
    v_add_f32 v100, v100, v124
    v_add_f32 v101, v101, v125
    v_add_f32 v102, v102, v126
    v_add_f32 v103, v103, v127
    v_cvt_pk_bf16_f32 v120, v96, v97
    v_cvt_pk_bf16_f32 v121, v98, v99
    v_cvt_pk_bf16_f32 v122, v100, v101
    v_cvt_pk_bf16_f32 v123, v102, v103
    v_lshlrev_b32 v96, 16, v120
    v_and_b32 v97, 0xffff0000, v120
    v_lshlrev_b32 v98, 16, v121
    v_and_b32 v99, 0xffff0000, v121
    v_lshlrev_b32 v100, 16, v122
    v_and_b32 v101, 0xffff0000, v122
    v_lshlrev_b32 v102, 16, v123
    v_and_b32 v103, 0xffff0000, v123
    v_mul_f32 v104, 0xbfb8aa3b, v96
    v_mul_f32 v105, 0xbfb8aa3b, v97
    v_mul_f32 v106, 0xbfb8aa3b, v98
    v_mul_f32 v107, 0xbfb8aa3b, v99
    v_mul_f32 v108, 0xbfb8aa3b, v100
    v_mul_f32 v109, 0xbfb8aa3b, v101
    v_mul_f32 v110, 0xbfb8aa3b, v102
    v_mul_f32 v111, 0xbfb8aa3b, v103
    v_exp_f32 v104, v104
    v_exp_f32 v105, v105
    v_exp_f32 v106, v106
    v_exp_f32 v107, v107
    v_exp_f32 v108, v108
    v_exp_f32 v109, v109
    v_exp_f32 v110, v110
    v_exp_f32 v111, v111
    v_add_f32 v104, 1.0, v104
    v_add_f32 v105, 1.0, v105
    v_add_f32 v106, 1.0, v106
    v_add_f32 v107, 1.0, v107
    v_add_f32 v108, 1.0, v108
    v_add_f32 v109, 1.0, v109
    v_add_f32 v110, 1.0, v110
    v_add_f32 v111, 1.0, v111
    v_rcp_f32 v104, v104
    v_rcp_f32 v105, v105
    v_rcp_f32 v106, v106
    v_rcp_f32 v107, v107
    v_rcp_f32 v108, v108
    v_rcp_f32 v109, v109
    v_rcp_f32 v110, v110
    v_rcp_f32 v111, v111
    v_mul_f32 v96, v96, v104
    v_mul_f32 v97, v97, v105
    v_mul_f32 v98, v98, v106
    v_mul_f32 v99, v99, v107
    v_mul_f32 v100, v100, v108
    v_mul_f32 v101, v101, v109
    v_mul_f32 v102, v102, v110
    v_mul_f32 v103, v103, v111
    v_cvt_pk_bf16_f32 v80, v96, v97
    v_cvt_pk_bf16_f32 v81, v98, v99
    v_cvt_pk_bf16_f32 v82, v100, v101
    v_cvt_pk_bf16_f32 v83, v102, v103
    v_lshlrev_b32 v96, 16, v160
    v_and_b32 v97, 0xffff0000, v160
    v_lshlrev_b32 v98, 16, v161
    v_and_b32 v99, 0xffff0000, v161
    v_lshlrev_b32 v100, 16, v162
    v_and_b32 v101, 0xffff0000, v162
    v_lshlrev_b32 v102, 16, v163
    v_and_b32 v103, 0xffff0000, v163
    v_lshlrev_b32 v120, 16, v164
    v_and_b32 v121, 0xffff0000, v164
    v_lshlrev_b32 v122, 16, v165
    v_and_b32 v123, 0xffff0000, v165
    v_lshlrev_b32 v124, 16, v166
    v_and_b32 v125, 0xffff0000, v166
    v_lshlrev_b32 v126, 16, v167
    v_and_b32 v127, 0xffff0000, v167
    v_add_f32 v96, v96, v120
    v_add_f32 v97, v97, v121
    v_add_f32 v98, v98, v122
    v_add_f32 v99, v99, v123
    v_add_f32 v100, v100, v124
    v_add_f32 v101, v101, v125
    v_add_f32 v102, v102, v126
    v_add_f32 v103, v103, v127
    v_lshlrev_b32 v120, 16, v168
    v_and_b32 v121, 0xffff0000, v168
    v_lshlrev_b32 v122, 16, v169
    v_and_b32 v123, 0xffff0000, v169
    v_lshlrev_b32 v124, 16, v170
    v_and_b32 v125, 0xffff0000, v170
    v_lshlrev_b32 v126, 16, v171
    v_and_b32 v127, 0xffff0000, v171
    v_add_f32 v96, v96, v120
    v_add_f32 v97, v97, v121
    v_add_f32 v98, v98, v122
    v_add_f32 v99, v99, v123
    v_add_f32 v100, v100, v124
    v_add_f32 v101, v101, v125
    v_add_f32 v102, v102, v126
    v_add_f32 v103, v103, v127
    v_lshlrev_b32 v120, 16, v172
    v_and_b32 v121, 0xffff0000, v172
    v_lshlrev_b32 v122, 16, v173
    v_and_b32 v123, 0xffff0000, v173
    v_lshlrev_b32 v124, 16, v174
    v_and_b32 v125, 0xffff0000, v174
    v_lshlrev_b32 v126, 16, v175
    v_and_b32 v127, 0xffff0000, v175
    v_add_f32 v96, v96, v120
    v_add_f32 v97, v97, v121
    v_add_f32 v98, v98, v122
    v_add_f32 v99, v99, v123
    v_add_f32 v100, v100, v124
    v_add_f32 v101, v101, v125
    v_add_f32 v102, v102, v126
    v_add_f32 v103, v103, v127
    v_cvt_pk_bf16_f32 v120, v96, v97
    v_cvt_pk_bf16_f32 v121, v98, v99
    v_cvt_pk_bf16_f32 v122, v100, v101
    v_cvt_pk_bf16_f32 v123, v102, v103
    v_lshlrev_b32 v96, 16, v120
    v_and_b32 v97, 0xffff0000, v120
    v_lshlrev_b32 v98, 16, v121
    v_and_b32 v99, 0xffff0000, v121
    v_lshlrev_b32 v100, 16, v122
    v_and_b32 v101, 0xffff0000, v122
    v_lshlrev_b32 v102, 16, v123
    v_and_b32 v103, 0xffff0000, v123
    v_mul_f32 v104, 0xbfb8aa3b, v96
    v_mul_f32 v105, 0xbfb8aa3b, v97
    v_mul_f32 v106, 0xbfb8aa3b, v98
    v_mul_f32 v107, 0xbfb8aa3b, v99
    v_mul_f32 v108, 0xbfb8aa3b, v100
    v_mul_f32 v109, 0xbfb8aa3b, v101
    v_mul_f32 v110, 0xbfb8aa3b, v102
    v_mul_f32 v111, 0xbfb8aa3b, v103
    v_exp_f32 v104, v104
    v_exp_f32 v105, v105
    v_exp_f32 v106, v106
    v_exp_f32 v107, v107
    v_exp_f32 v108, v108
    v_exp_f32 v109, v109
    v_exp_f32 v110, v110
    v_exp_f32 v111, v111
    v_add_f32 v104, 1.0, v104
    v_add_f32 v105, 1.0, v105
    v_add_f32 v106, 1.0, v106
    v_add_f32 v107, 1.0, v107
    v_add_f32 v108, 1.0, v108
    v_add_f32 v109, 1.0, v109
    v_add_f32 v110, 1.0, v110
    v_add_f32 v111, 1.0, v111
    v_rcp_f32 v104, v104
    v_rcp_f32 v105, v105
    v_rcp_f32 v106, v106
    v_rcp_f32 v107, v107
    v_rcp_f32 v108, v108
    v_rcp_f32 v109, v109
    v_rcp_f32 v110, v110
    v_rcp_f32 v111, v111
    v_mul_f32 v96, v96, v104
    v_mul_f32 v97, v97, v105
    v_mul_f32 v98, v98, v106
    v_mul_f32 v99, v99, v107
    v_mul_f32 v100, v100, v108
    v_mul_f32 v101, v101, v109
    v_mul_f32 v102, v102, v110
    v_mul_f32 v103, v103, v111
    v_cvt_pk_bf16_f32 v84, v96, v97
    v_cvt_pk_bf16_f32 v85, v98, v99
    v_cvt_pk_bf16_f32 v86, v100, v101
    v_cvt_pk_bf16_f32 v87, v102, v103
    s_waitcnt vmcnt(0)
    v_lshlrev_b32 v96, 16, v16
    v_and_b32 v97, 0xffff0000, v16
    v_lshlrev_b32 v98, 16, v17
    v_and_b32 v99, 0xffff0000, v17
    v_lshlrev_b32 v100, 16, v18
    v_and_b32 v101, 0xffff0000, v18
    v_lshlrev_b32 v102, 16, v19
    v_and_b32 v103, 0xffff0000, v19
    v_lshlrev_b32 v120, 16, v20
    v_and_b32 v121, 0xffff0000, v20
    v_lshlrev_b32 v122, 16, v21
    v_and_b32 v123, 0xffff0000, v21
    v_lshlrev_b32 v124, 16, v22
    v_and_b32 v125, 0xffff0000, v22
    v_lshlrev_b32 v126, 16, v23
    v_and_b32 v127, 0xffff0000, v23
    v_add_f32 v96, v96, v120
    v_add_f32 v97, v97, v121
    v_add_f32 v98, v98, v122
    v_add_f32 v99, v99, v123
    v_add_f32 v100, v100, v124
    v_add_f32 v101, v101, v125
    v_add_f32 v102, v102, v126
    v_add_f32 v103, v103, v127
    v_lshlrev_b32 v120, 16, v24
    v_and_b32 v121, 0xffff0000, v24
    v_lshlrev_b32 v122, 16, v25
    v_and_b32 v123, 0xffff0000, v25
    v_lshlrev_b32 v124, 16, v26
    v_and_b32 v125, 0xffff0000, v26
    v_lshlrev_b32 v126, 16, v27
    v_and_b32 v127, 0xffff0000, v27
    v_add_f32 v96, v96, v120
    v_add_f32 v97, v97, v121
    v_add_f32 v98, v98, v122
    v_add_f32 v99, v99, v123
    v_add_f32 v100, v100, v124
    v_add_f32 v101, v101, v125
    v_add_f32 v102, v102, v126
    v_add_f32 v103, v103, v127
    v_lshlrev_b32 v120, 16, v28
    v_and_b32 v121, 0xffff0000, v28
    v_lshlrev_b32 v122, 16, v29
    v_and_b32 v123, 0xffff0000, v29
    v_lshlrev_b32 v124, 16, v30
    v_and_b32 v125, 0xffff0000, v30
    v_lshlrev_b32 v126, 16, v31
    v_and_b32 v127, 0xffff0000, v31
    v_add_f32 v96, v96, v120
    v_add_f32 v97, v97, v121
    v_add_f32 v98, v98, v122
    v_add_f32 v99, v99, v123
    v_add_f32 v100, v100, v124
    v_add_f32 v101, v101, v125
    v_add_f32 v102, v102, v126
    v_add_f32 v103, v103, v127
    v_lshlrev_b32 v120, 16, v32
    v_and_b32 v121, 0xffff0000, v32
    v_lshlrev_b32 v122, 16, v33
    v_and_b32 v123, 0xffff0000, v33
    v_lshlrev_b32 v124, 16, v34
    v_and_b32 v125, 0xffff0000, v34
    v_lshlrev_b32 v126, 16, v35
    v_and_b32 v127, 0xffff0000, v35
    v_add_f32 v96, v96, v120
    v_add_f32 v97, v97, v121
    v_add_f32 v98, v98, v122
    v_add_f32 v99, v99, v123
    v_add_f32 v100, v100, v124
    v_add_f32 v101, v101, v125
    v_add_f32 v102, v102, v126
    v_add_f32 v103, v103, v127
    v_lshlrev_b32 v120, 16, v36
    v_and_b32 v121, 0xffff0000, v36
    v_lshlrev_b32 v122, 16, v37
    v_and_b32 v123, 0xffff0000, v37
    v_lshlrev_b32 v124, 16, v38
    v_and_b32 v125, 0xffff0000, v38
    v_lshlrev_b32 v126, 16, v39
    v_and_b32 v127, 0xffff0000, v39
    v_add_f32 v96, v96, v120
    v_add_f32 v97, v97, v121
    v_add_f32 v98, v98, v122
    v_add_f32 v99, v99, v123
    v_add_f32 v100, v100, v124
    v_add_f32 v101, v101, v125
    v_add_f32 v102, v102, v126
    v_add_f32 v103, v103, v127
    v_lshlrev_b32 v120, 16, v40
    v_and_b32 v121, 0xffff0000, v40
    v_lshlrev_b32 v122, 16, v41
    v_and_b32 v123, 0xffff0000, v41
    v_lshlrev_b32 v124, 16, v42
    v_and_b32 v125, 0xffff0000, v42
    v_lshlrev_b32 v126, 16, v43
    v_and_b32 v127, 0xffff0000, v43
    v_add_f32 v96, v96, v120
    v_add_f32 v97, v97, v121
    v_add_f32 v98, v98, v122
    v_add_f32 v99, v99, v123
    v_add_f32 v100, v100, v124
    v_add_f32 v101, v101, v125
    v_add_f32 v102, v102, v126
    v_add_f32 v103, v103, v127
    v_lshlrev_b32 v120, 16, v44
    v_and_b32 v121, 0xffff0000, v44
    v_lshlrev_b32 v122, 16, v45
    v_and_b32 v123, 0xffff0000, v45
    v_lshlrev_b32 v124, 16, v46
    v_and_b32 v125, 0xffff0000, v46
    v_lshlrev_b32 v126, 16, v47
    v_and_b32 v127, 0xffff0000, v47
    v_add_f32 v96, v96, v120
    v_add_f32 v97, v97, v121
    v_add_f32 v98, v98, v122
    v_add_f32 v99, v99, v123
    v_add_f32 v100, v100, v124
    v_add_f32 v101, v101, v125
    v_add_f32 v102, v102, v126
    v_add_f32 v103, v103, v127
    v_cndmask_b32 v108, v88, v90, s[20:21]
    v_cndmask_b32 v109, v89, v91, s[20:21]
    v_cndmask_b32 v110, v90, v88, s[20:21]
    v_cndmask_b32 v111, v91, v89, s[20:21]
    v_cvt_pk_bf16_f32 v104, v96, v97
    v_lshlrev_b32 v96, 16, v104
    v_and_b32 v97, 0xffff0000, v104
    v_lshlrev_b32 v104, 16, v80
    v_and_b32 v105, 0xffff0000, v80
    v_mul_f32 v96, v96, v104
    v_mul_f32 v97, v97, v105
    v_cvt_pk_bf16_f32 v104, v96, v97
    v_lshlrev_b32 v96, 16, v104
    v_and_b32 v97, 0xffff0000, v104
    v_lshlrev_b32 v104, 16, v108
    v_and_b32 v105, 0xffff0000, v108
    v_add_f32 v96, v96, v104
    v_add_f32 v97, v97, v105
    v_cvt_pk_bf16_f32 v112, v96, v97
    v_cvt_pk_bf16_f32 v104, v98, v99
    v_lshlrev_b32 v98, 16, v104
    v_and_b32 v99, 0xffff0000, v104
    v_lshlrev_b32 v104, 16, v81
    v_and_b32 v105, 0xffff0000, v81
    v_mul_f32 v98, v98, v104
    v_mul_f32 v99, v99, v105
    v_cvt_pk_bf16_f32 v104, v98, v99
    v_lshlrev_b32 v98, 16, v104
    v_and_b32 v99, 0xffff0000, v104
    v_lshlrev_b32 v104, 16, v109
    v_and_b32 v105, 0xffff0000, v109
    v_add_f32 v98, v98, v104
    v_add_f32 v99, v99, v105
    v_cvt_pk_bf16_f32 v113, v98, v99
    v_cvt_pk_bf16_f32 v104, v100, v101
    v_lshlrev_b32 v100, 16, v104
    v_and_b32 v101, 0xffff0000, v104
    v_lshlrev_b32 v104, 16, v82
    v_and_b32 v105, 0xffff0000, v82
    v_mul_f32 v100, v100, v104
    v_mul_f32 v101, v101, v105
    v_cvt_pk_bf16_f32 v104, v100, v101
    v_lshlrev_b32 v100, 16, v104
    v_and_b32 v101, 0xffff0000, v104
    v_lshlrev_b32 v104, 16, v110
    v_and_b32 v105, 0xffff0000, v110
    v_add_f32 v100, v100, v104
    v_add_f32 v101, v101, v105
    v_cvt_pk_bf16_f32 v114, v100, v101
    v_cvt_pk_bf16_f32 v104, v102, v103
    v_lshlrev_b32 v102, 16, v104
    v_and_b32 v103, 0xffff0000, v104
    v_lshlrev_b32 v104, 16, v83
    v_and_b32 v105, 0xffff0000, v83
    v_mul_f32 v102, v102, v104
    v_mul_f32 v103, v103, v105
    v_cvt_pk_bf16_f32 v104, v102, v103
    v_lshlrev_b32 v102, 16, v104
    v_and_b32 v103, 0xffff0000, v104
    v_lshlrev_b32 v104, 16, v111
    v_and_b32 v105, 0xffff0000, v111
    v_add_f32 v102, v102, v104
    v_add_f32 v103, v103, v105
    v_cvt_pk_bf16_f32 v115, v102, v103
    v_cndmask_b32 v128, v112, v114, s[20:21]
    v_cndmask_b32 v129, v113, v115, s[20:21]
    v_cndmask_b32 v130, v114, v112, s[20:21]
    v_cndmask_b32 v131, v115, v113, s[20:21]
    buffer_store_dwordx4 v[128:131], v4, s[12:15], s18 offen offset:0
    v_lshlrev_b32 v96, 16, v48
    v_and_b32 v97, 0xffff0000, v48
    v_lshlrev_b32 v98, 16, v49
    v_and_b32 v99, 0xffff0000, v49
    v_lshlrev_b32 v100, 16, v50
    v_and_b32 v101, 0xffff0000, v50
    v_lshlrev_b32 v102, 16, v51
    v_and_b32 v103, 0xffff0000, v51
    v_lshlrev_b32 v120, 16, v52
    v_and_b32 v121, 0xffff0000, v52
    v_lshlrev_b32 v122, 16, v53
    v_and_b32 v123, 0xffff0000, v53
    v_lshlrev_b32 v124, 16, v54
    v_and_b32 v125, 0xffff0000, v54
    v_lshlrev_b32 v126, 16, v55
    v_and_b32 v127, 0xffff0000, v55
    v_add_f32 v96, v96, v120
    v_add_f32 v97, v97, v121
    v_add_f32 v98, v98, v122
    v_add_f32 v99, v99, v123
    v_add_f32 v100, v100, v124
    v_add_f32 v101, v101, v125
    v_add_f32 v102, v102, v126
    v_add_f32 v103, v103, v127
    v_lshlrev_b32 v120, 16, v56
    v_and_b32 v121, 0xffff0000, v56
    v_lshlrev_b32 v122, 16, v57
    v_and_b32 v123, 0xffff0000, v57
    v_lshlrev_b32 v124, 16, v58
    v_and_b32 v125, 0xffff0000, v58
    v_lshlrev_b32 v126, 16, v59
    v_and_b32 v127, 0xffff0000, v59
    v_add_f32 v96, v96, v120
    v_add_f32 v97, v97, v121
    v_add_f32 v98, v98, v122
    v_add_f32 v99, v99, v123
    v_add_f32 v100, v100, v124
    v_add_f32 v101, v101, v125
    v_add_f32 v102, v102, v126
    v_add_f32 v103, v103, v127
    v_lshlrev_b32 v120, 16, v60
    v_and_b32 v121, 0xffff0000, v60
    v_lshlrev_b32 v122, 16, v61
    v_and_b32 v123, 0xffff0000, v61
    v_lshlrev_b32 v124, 16, v62
    v_and_b32 v125, 0xffff0000, v62
    v_lshlrev_b32 v126, 16, v63
    v_and_b32 v127, 0xffff0000, v63
    v_add_f32 v96, v96, v120
    v_add_f32 v97, v97, v121
    v_add_f32 v98, v98, v122
    v_add_f32 v99, v99, v123
    v_add_f32 v100, v100, v124
    v_add_f32 v101, v101, v125
    v_add_f32 v102, v102, v126
    v_add_f32 v103, v103, v127
    v_lshlrev_b32 v120, 16, v64
    v_and_b32 v121, 0xffff0000, v64
    v_lshlrev_b32 v122, 16, v65
    v_and_b32 v123, 0xffff0000, v65
    v_lshlrev_b32 v124, 16, v66
    v_and_b32 v125, 0xffff0000, v66
    v_lshlrev_b32 v126, 16, v67
    v_and_b32 v127, 0xffff0000, v67
    v_add_f32 v96, v96, v120
    v_add_f32 v97, v97, v121
    v_add_f32 v98, v98, v122
    v_add_f32 v99, v99, v123
    v_add_f32 v100, v100, v124
    v_add_f32 v101, v101, v125
    v_add_f32 v102, v102, v126
    v_add_f32 v103, v103, v127
    v_lshlrev_b32 v120, 16, v68
    v_and_b32 v121, 0xffff0000, v68
    v_lshlrev_b32 v122, 16, v69
    v_and_b32 v123, 0xffff0000, v69
    v_lshlrev_b32 v124, 16, v70
    v_and_b32 v125, 0xffff0000, v70
    v_lshlrev_b32 v126, 16, v71
    v_and_b32 v127, 0xffff0000, v71
    v_add_f32 v96, v96, v120
    v_add_f32 v97, v97, v121
    v_add_f32 v98, v98, v122
    v_add_f32 v99, v99, v123
    v_add_f32 v100, v100, v124
    v_add_f32 v101, v101, v125
    v_add_f32 v102, v102, v126
    v_add_f32 v103, v103, v127
    v_lshlrev_b32 v120, 16, v72
    v_and_b32 v121, 0xffff0000, v72
    v_lshlrev_b32 v122, 16, v73
    v_and_b32 v123, 0xffff0000, v73
    v_lshlrev_b32 v124, 16, v74
    v_and_b32 v125, 0xffff0000, v74
    v_lshlrev_b32 v126, 16, v75
    v_and_b32 v127, 0xffff0000, v75
    v_add_f32 v96, v96, v120
    v_add_f32 v97, v97, v121
    v_add_f32 v98, v98, v122
    v_add_f32 v99, v99, v123
    v_add_f32 v100, v100, v124
    v_add_f32 v101, v101, v125
    v_add_f32 v102, v102, v126
    v_add_f32 v103, v103, v127
    v_lshlrev_b32 v120, 16, v76
    v_and_b32 v121, 0xffff0000, v76
    v_lshlrev_b32 v122, 16, v77
    v_and_b32 v123, 0xffff0000, v77
    v_lshlrev_b32 v124, 16, v78
    v_and_b32 v125, 0xffff0000, v78
    v_lshlrev_b32 v126, 16, v79
    v_and_b32 v127, 0xffff0000, v79
    v_add_f32 v96, v96, v120
    v_add_f32 v97, v97, v121
    v_add_f32 v98, v98, v122
    v_add_f32 v99, v99, v123
    v_add_f32 v100, v100, v124
    v_add_f32 v101, v101, v125
    v_add_f32 v102, v102, v126
    v_add_f32 v103, v103, v127
    v_cndmask_b32 v108, v92, v94, s[20:21]
    v_cndmask_b32 v109, v93, v95, s[20:21]
    v_cndmask_b32 v110, v94, v92, s[20:21]
    v_cndmask_b32 v111, v95, v93, s[20:21]
    v_cvt_pk_bf16_f32 v104, v96, v97
    v_lshlrev_b32 v96, 16, v104
    v_and_b32 v97, 0xffff0000, v104
    v_lshlrev_b32 v104, 16, v84
    v_and_b32 v105, 0xffff0000, v84
    v_mul_f32 v96, v96, v104
    v_mul_f32 v97, v97, v105
    v_cvt_pk_bf16_f32 v104, v96, v97
    v_lshlrev_b32 v96, 16, v104
    v_and_b32 v97, 0xffff0000, v104
    v_lshlrev_b32 v104, 16, v108
    v_and_b32 v105, 0xffff0000, v108
    v_add_f32 v96, v96, v104
    v_add_f32 v97, v97, v105
    v_cvt_pk_bf16_f32 v112, v96, v97
    v_cvt_pk_bf16_f32 v104, v98, v99
    v_lshlrev_b32 v98, 16, v104
    v_and_b32 v99, 0xffff0000, v104
    v_lshlrev_b32 v104, 16, v85
    v_and_b32 v105, 0xffff0000, v85
    v_mul_f32 v98, v98, v104
    v_mul_f32 v99, v99, v105
    v_cvt_pk_bf16_f32 v104, v98, v99
    v_lshlrev_b32 v98, 16, v104
    v_and_b32 v99, 0xffff0000, v104
    v_lshlrev_b32 v104, 16, v109
    v_and_b32 v105, 0xffff0000, v109
    v_add_f32 v98, v98, v104
    v_add_f32 v99, v99, v105
    v_cvt_pk_bf16_f32 v113, v98, v99
    v_cvt_pk_bf16_f32 v104, v100, v101
    v_lshlrev_b32 v100, 16, v104
    v_and_b32 v101, 0xffff0000, v104
    v_lshlrev_b32 v104, 16, v86
    v_and_b32 v105, 0xffff0000, v86
    v_mul_f32 v100, v100, v104
    v_mul_f32 v101, v101, v105
    v_cvt_pk_bf16_f32 v104, v100, v101
    v_lshlrev_b32 v100, 16, v104
    v_and_b32 v101, 0xffff0000, v104
    v_lshlrev_b32 v104, 16, v110
    v_and_b32 v105, 0xffff0000, v110
    v_add_f32 v100, v100, v104
    v_add_f32 v101, v101, v105
    v_cvt_pk_bf16_f32 v114, v100, v101
    v_cvt_pk_bf16_f32 v104, v102, v103
    v_lshlrev_b32 v102, 16, v104
    v_and_b32 v103, 0xffff0000, v104
    v_lshlrev_b32 v104, 16, v87
    v_and_b32 v105, 0xffff0000, v87
    v_mul_f32 v102, v102, v104
    v_mul_f32 v103, v103, v105
    v_cvt_pk_bf16_f32 v104, v102, v103
    v_lshlrev_b32 v102, 16, v104
    v_and_b32 v103, 0xffff0000, v104
    v_lshlrev_b32 v104, 16, v111
    v_and_b32 v105, 0xffff0000, v111
    v_add_f32 v102, v102, v104
    v_add_f32 v103, v103, v105
    v_cvt_pk_bf16_f32 v115, v102, v103
    v_cndmask_b32 v132, v112, v114, s[20:21]
    v_cndmask_b32 v133, v113, v115, s[20:21]
    v_cndmask_b32 v134, v114, v112, s[20:21]
    v_cndmask_b32 v135, v115, v113, s[20:21]
    buffer_store_dwordx4 v[132:135], v4, s[12:15], s18 offen offset:64
    s_add_u32 s24, s24, 32
    s_cmp_lt_u32 s24, 61
    s_cbranch_scc1 fin_job
    s_cmp_ge_u32 s63, 48
    s_cbranch_scc1 k_end
    s_lshr_b32 s24, s63, 4
    s_sub_u32 s24, 63, s24
    s_and_b32 s25, s63, 15
    s_lshl_b32 s25, s25, 2
    s_and_b32 s26, s3, 3
    s_add_u32 s25, s25, s26
    s_lshr_b32 s26, s25, 5
    s_and_b32 s25, s25, 31
    s_lshl_b32 s16, s24, 1
    s_add_u32 s16, s16, s26
    s_lshl_b32 s18, s16, 15
    s_lshl_b32 s17, s25, 10
    s_add_u32 s17, s17, s18
    s_lshl_b32 s19, s25, 6
    s_add_u32 s18, s18, s19
    s_add_u32 s22, s17, 167772160
    s_add_u32 s23, s17, 75497472
    s_mov_b32 s27, 218106816
    s_mov_b32 s30, 218112000
    s_mov_b32 s28, 65536
    v_and_b32 v8, 7, v1
    v_lshlrev_b32 v8, 22, v8
    s_cmp_lg_u32 s3, 0
    s_cbranch_scc1 ft_ok
ft_wd:
    buffer_load_dword v7, off, s[4:7], s27 sc1
    s_waitcnt vmcnt(0)
    v_readfirstlane_b32 s31, v7
    s_cmp_ge_u32 s31, 16
    s_cbranch_scc1 ft_ws
    s_sleep 127
    s_sub_u32 s28, s28, 1
    s_cbranch_scc0 ft_wd
    s_mov_b32 s28, 0
ft_ws:
    buffer_load_dword v7, v6, s[4:7], s30 offen sc1
    s_waitcnt vmcnt(0)
    v_cmp_gt_u32 vcc, 61, v7
    s_cbranch_vccz ft_ok
    s_sleep 12
    v_cmp_gt_u32 vcc, 59, v7
    s_cbranch_vccz ft_wsf
    s_sleep 64
    v_cmp_gt_u32 vcc, 56, v7
    s_cbranch_vccz ft_wsf
    s_sleep 127
    s_sleep 127
ft_wsf:
    s_sub_u32 s28, s28, 1
    s_cbranch_scc0 ft_ws
    s_mov_b32 s28, 0
ft_ok:
    s_barrier
    s_cmp_ge_u32 s3, 4
    s_cbranch_scc1 k_end
    buffer_load_dwordx4 v[88:91], v4, s[8:11], s18 offen
    buffer_load_dwordx4 v[144:147], v3, s[4:7], s22 offen offset:0 sc1
    s_add_u32 s22, s22, 4194304
    buffer_load_dwordx4 v[148:151], v3, s[4:7], s22 offen offset:0 sc1
    s_add_u32 s22, s22, 4194304
    buffer_load_dwordx4 v[152:155], v3, s[4:7], s22 offen offset:0 sc1
    s_add_u32 s22, s22, 4194304
    buffer_load_dwordx4 v[156:159], v3, s[4:7], s22 offen offset:0 sc1
    s_waitcnt vmcnt(0)
    v_lshlrev_b32 v96, 16, v144
    v_and_b32 v97, 0xffff0000, v144
    v_lshlrev_b32 v98, 16, v145
    v_and_b32 v99, 0xffff0000, v145
    v_lshlrev_b32 v100, 16, v146
    v_and_b32 v101, 0xffff0000, v146
    v_lshlrev_b32 v102, 16, v147
    v_and_b32 v103, 0xffff0000, v147
    v_lshlrev_b32 v120, 16, v148
    v_and_b32 v121, 0xffff0000, v148
    v_lshlrev_b32 v122, 16, v149
    v_and_b32 v123, 0xffff0000, v149
    v_lshlrev_b32 v124, 16, v150
    v_and_b32 v125, 0xffff0000, v150
    v_lshlrev_b32 v126, 16, v151
    v_and_b32 v127, 0xffff0000, v151
    v_add_f32 v96, v96, v120
    v_add_f32 v97, v97, v121
    v_add_f32 v98, v98, v122
    v_add_f32 v99, v99, v123
    v_add_f32 v100, v100, v124
    v_add_f32 v101, v101, v125
    v_add_f32 v102, v102, v126
    v_add_f32 v103, v103, v127
    v_lshlrev_b32 v120, 16, v152
    v_and_b32 v121, 0xffff0000, v152
    v_lshlrev_b32 v122, 16, v153
    v_and_b32 v123, 0xffff0000, v153
    v_lshlrev_b32 v124, 16, v154
    v_and_b32 v125, 0xffff0000, v154
    v_lshlrev_b32 v126, 16, v155
    v_and_b32 v127, 0xffff0000, v155
    v_add_f32 v96, v96, v120
    v_add_f32 v97, v97, v121
    v_add_f32 v98, v98, v122
    v_add_f32 v99, v99, v123
    v_add_f32 v100, v100, v124
    v_add_f32 v101, v101, v125
    v_add_f32 v102, v102, v126
    v_add_f32 v103, v103, v127
    v_lshlrev_b32 v120, 16, v156
    v_and_b32 v121, 0xffff0000, v156
    v_lshlrev_b32 v122, 16, v157
    v_and_b32 v123, 0xffff0000, v157
    v_lshlrev_b32 v124, 16, v158
    v_and_b32 v125, 0xffff0000, v158
    v_lshlrev_b32 v126, 16, v159
    v_and_b32 v127, 0xffff0000, v159
    v_add_f32 v96, v96, v120
    v_add_f32 v97, v97, v121
    v_add_f32 v98, v98, v122
    v_add_f32 v99, v99, v123
    v_add_f32 v100, v100, v124
    v_add_f32 v101, v101, v125
    v_add_f32 v102, v102, v126
    v_add_f32 v103, v103, v127
    v_cvt_pk_bf16_f32 v120, v96, v97
    v_cvt_pk_bf16_f32 v121, v98, v99
    v_cvt_pk_bf16_f32 v122, v100, v101
    v_cvt_pk_bf16_f32 v123, v102, v103
    v_lshlrev_b32 v96, 16, v120
    v_and_b32 v97, 0xffff0000, v120
    v_lshlrev_b32 v98, 16, v121
    v_and_b32 v99, 0xffff0000, v121
    v_lshlrev_b32 v100, 16, v122
    v_and_b32 v101, 0xffff0000, v122
    v_lshlrev_b32 v102, 16, v123
    v_and_b32 v103, 0xffff0000, v123
    v_mul_f32 v104, 0xbfb8aa3b, v96
    v_mul_f32 v105, 0xbfb8aa3b, v97
    v_mul_f32 v106, 0xbfb8aa3b, v98
    v_mul_f32 v107, 0xbfb8aa3b, v99
    v_mul_f32 v108, 0xbfb8aa3b, v100
    v_mul_f32 v109, 0xbfb8aa3b, v101
    v_mul_f32 v110, 0xbfb8aa3b, v102
    v_mul_f32 v111, 0xbfb8aa3b, v103
    v_exp_f32 v104, v104
    v_exp_f32 v105, v105
    v_exp_f32 v106, v106
    v_exp_f32 v107, v107
    v_exp_f32 v108, v108
    v_exp_f32 v109, v109
    v_exp_f32 v110, v110
    v_exp_f32 v111, v111
    v_add_f32 v104, 1.0, v104
    v_add_f32 v105, 1.0, v105
    v_add_f32 v106, 1.0, v106
    v_add_f32 v107, 1.0, v107
    v_add_f32 v108, 1.0, v108
    v_add_f32 v109, 1.0, v109
    v_add_f32 v110, 1.0, v110
    v_add_f32 v111, 1.0, v111
    v_rcp_f32 v104, v104
    v_rcp_f32 v105, v105
    v_rcp_f32 v106, v106
    v_rcp_f32 v107, v107
    v_rcp_f32 v108, v108
    v_rcp_f32 v109, v109
    v_rcp_f32 v110, v110
    v_rcp_f32 v111, v111
    v_mul_f32 v96, v96, v104
    v_mul_f32 v97, v97, v105
    v_mul_f32 v98, v98, v106
    v_mul_f32 v99, v99, v107
    v_mul_f32 v100, v100, v108
    v_mul_f32 v101, v101, v109
    v_mul_f32 v102, v102, v110
    v_mul_f32 v103, v103, v111
    v_cvt_pk_bf16_f32 v80, v96, v97
    v_cvt_pk_bf16_f32 v81, v98, v99
    v_cvt_pk_bf16_f32 v82, v100, v101
    v_cvt_pk_bf16_f32 v83, v102, v103
ft_p:
    buffer_load_dword v7, v8, s[4:7], s23 offen offset:1020 sc1
    s_waitcnt vmcnt(0)
    v_cmp_eq_u32 vcc, -1, v7
    s_cbranch_vccz ft_l
    s_sleep 4
    s_sub_u32 s28, s28, 1
    s_cbranch_scc0 ft_p
    s_mov_b32 s28, 0
ft_l:
    s_mov_b32 s31, s23
    buffer_load_dwordx4 v[16:19], v3, s[4:7], s31 offen sc1
    s_add_u32 s31, s31, 4194304
    buffer_load_dwordx4 v[20:23], v3, s[4:7], s31 offen sc1
    s_add_u32 s31, s31, 4194304
    buffer_load_dwordx4 v[24:27], v3, s[4:7], s31 offen sc1
    s_add_u32 s31, s31, 4194304
    buffer_load_dwordx4 v[28:31], v3, s[4:7], s31 offen sc1
    s_add_u32 s31, s31, 4194304
    buffer_load_dwordx4 v[32:35], v3, s[4:7], s31 offen sc1
    s_add_u32 s31, s31, 4194304
    buffer_load_dwordx4 v[36:39], v3, s[4:7], s31 offen sc1
    s_add_u32 s31, s31, 4194304
    buffer_load_dwordx4 v[40:43], v3, s[4:7], s31 offen sc1
    s_add_u32 s31, s31, 4194304
    buffer_load_dwordx4 v[44:47], v3, s[4:7], s31 offen sc1
    s_waitcnt vmcnt(0)
    v_max3_u32 v7, v16, v17, v18
    v_max3_u32 v7, v7, v19, v20
    v_max3_u32 v7, v7, v21, v22
    v_max3_u32 v7, v7, v23, v24
    v_max3_u32 v7, v7, v25, v26
    v_max3_u32 v7, v7, v27, v28
    v_max3_u32 v7, v7, v29, v30
    v_max3_u32 v7, v7, v31, v32
    v_max3_u32 v7, v7, v33, v34
    v_max3_u32 v7, v7, v35, v36
    v_max3_u32 v7, v7, v37, v38
    v_max3_u32 v7, v7, v39, v40
    v_max3_u32 v7, v7, v41, v42
    v_max3_u32 v7, v7, v43, v44
    v_max3_u32 v7, v7, v45, v46
    v_max_u32 v7, v7, v47
    v_cmp_eq_u32 vcc, -1, v7
    s_cbranch_vccz ft_go
    s_sub_u32 s28, s28, 1
    s_cbranch_scc0 ft_l
ft_go:
    v_lshlrev_b32 v96, 16, v16
    v_and_b32 v97, 0xffff0000, v16
    v_lshlrev_b32 v98, 16, v17
    v_and_b32 v99, 0xffff0000, v17
    v_lshlrev_b32 v100, 16, v18
    v_and_b32 v101, 0xffff0000, v18
    v_lshlrev_b32 v102, 16, v19
    v_and_b32 v103, 0xffff0000, v19
    v_lshlrev_b32 v120, 16, v20
    v_and_b32 v121, 0xffff0000, v20
    v_lshlrev_b32 v122, 16, v21
    v_and_b32 v123, 0xffff0000, v21
    v_lshlrev_b32 v124, 16, v22
    v_and_b32 v125, 0xffff0000, v22
    v_lshlrev_b32 v126, 16, v23
    v_and_b32 v127, 0xffff0000, v23
    v_add_f32 v96, v96, v120
    v_add_f32 v97, v97, v121
    v_add_f32 v98, v98, v122
    v_add_f32 v99, v99, v123
    v_add_f32 v100, v100, v124
    v_add_f32 v101, v101, v125
    v_add_f32 v102, v102, v126
    v_add_f32 v103, v103, v127
    v_lshlrev_b32 v120, 16, v24
    v_and_b32 v121, 0xffff0000, v24
    v_lshlrev_b32 v122, 16, v25
    v_and_b32 v123, 0xffff0000, v25
    v_lshlrev_b32 v124, 16, v26
    v_and_b32 v125, 0xffff0000, v26
    v_lshlrev_b32 v126, 16, v27
    v_and_b32 v127, 0xffff0000, v27
    v_add_f32 v96, v96, v120
    v_add_f32 v97, v97, v121
    v_add_f32 v98, v98, v122
    v_add_f32 v99, v99, v123
    v_add_f32 v100, v100, v124
    v_add_f32 v101, v101, v125
    v_add_f32 v102, v102, v126
    v_add_f32 v103, v103, v127
    v_lshlrev_b32 v120, 16, v28
    v_and_b32 v121, 0xffff0000, v28
    v_lshlrev_b32 v122, 16, v29
    v_and_b32 v123, 0xffff0000, v29
    v_lshlrev_b32 v124, 16, v30
    v_and_b32 v125, 0xffff0000, v30
    v_lshlrev_b32 v126, 16, v31
    v_and_b32 v127, 0xffff0000, v31
    v_add_f32 v96, v96, v120
    v_add_f32 v97, v97, v121
    v_add_f32 v98, v98, v122
    v_add_f32 v99, v99, v123
    v_add_f32 v100, v100, v124
    v_add_f32 v101, v101, v125
    v_add_f32 v102, v102, v126
    v_add_f32 v103, v103, v127
    v_lshlrev_b32 v120, 16, v32
    v_and_b32 v121, 0xffff0000, v32
    v_lshlrev_b32 v122, 16, v33
    v_and_b32 v123, 0xffff0000, v33
    v_lshlrev_b32 v124, 16, v34
    v_and_b32 v125, 0xffff0000, v34
    v_lshlrev_b32 v126, 16, v35
    v_and_b32 v127, 0xffff0000, v35
    v_add_f32 v96, v96, v120
    v_add_f32 v97, v97, v121
    v_add_f32 v98, v98, v122
    v_add_f32 v99, v99, v123
    v_add_f32 v100, v100, v124
    v_add_f32 v101, v101, v125
    v_add_f32 v102, v102, v126
    v_add_f32 v103, v103, v127
    v_lshlrev_b32 v120, 16, v36
    v_and_b32 v121, 0xffff0000, v36
    v_lshlrev_b32 v122, 16, v37
    v_and_b32 v123, 0xffff0000, v37
    v_lshlrev_b32 v124, 16, v38
    v_and_b32 v125, 0xffff0000, v38
    v_lshlrev_b32 v126, 16, v39
    v_and_b32 v127, 0xffff0000, v39
    v_add_f32 v96, v96, v120
    v_add_f32 v97, v97, v121
    v_add_f32 v98, v98, v122
    v_add_f32 v99, v99, v123
    v_add_f32 v100, v100, v124
    v_add_f32 v101, v101, v125
    v_add_f32 v102, v102, v126
    v_add_f32 v103, v103, v127
    v_lshlrev_b32 v120, 16, v40
    v_and_b32 v121, 0xffff0000, v40
    v_lshlrev_b32 v122, 16, v41
    v_and_b32 v123, 0xffff0000, v41
    v_lshlrev_b32 v124, 16, v42
    v_and_b32 v125, 0xffff0000, v42
    v_lshlrev_b32 v126, 16, v43
    v_and_b32 v127, 0xffff0000, v43
    v_add_f32 v96, v96, v120
    v_add_f32 v97, v97, v121
    v_add_f32 v98, v98, v122
    v_add_f32 v99, v99, v123
    v_add_f32 v100, v100, v124
    v_add_f32 v101, v101, v125
    v_add_f32 v102, v102, v126
    v_add_f32 v103, v103, v127
    v_lshlrev_b32 v120, 16, v44
    v_and_b32 v121, 0xffff0000, v44
    v_lshlrev_b32 v122, 16, v45
    v_and_b32 v123, 0xffff0000, v45
    v_lshlrev_b32 v124, 16, v46
    v_and_b32 v125, 0xffff0000, v46
    v_lshlrev_b32 v126, 16, v47
    v_and_b32 v127, 0xffff0000, v47
    v_add_f32 v96, v96, v120
    v_add_f32 v97, v97, v121
    v_add_f32 v98, v98, v122
    v_add_f32 v99, v99, v123
    v_add_f32 v100, v100, v124
    v_add_f32 v101, v101, v125
    v_add_f32 v102, v102, v126
    v_add_f32 v103, v103, v127
    v_cndmask_b32 v108, v88, v90, s[20:21]
    v_cndmask_b32 v109, v89, v91, s[20:21]
    v_cndmask_b32 v110, v90, v88, s[20:21]
    v_cndmask_b32 v111, v91, v89, s[20:21]
    v_cvt_pk_bf16_f32 v104, v96, v97
    v_lshlrev_b32 v96, 16, v104
    v_and_b32 v97, 0xffff0000, v104
    v_lshlrev_b32 v104, 16, v80
    v_and_b32 v105, 0xffff0000, v80
    v_mul_f32 v96, v96, v104
    v_mul_f32 v97, v97, v105
    v_cvt_pk_bf16_f32 v104, v96, v97
    v_lshlrev_b32 v96, 16, v104
    v_and_b32 v97, 0xffff0000, v104
    v_lshlrev_b32 v104, 16, v108
    v_and_b32 v105, 0xffff0000, v108
    v_add_f32 v96, v96, v104
    v_add_f32 v97, v97, v105
    v_cvt_pk_bf16_f32 v112, v96, v97
    v_cvt_pk_bf16_f32 v104, v98, v99
    v_lshlrev_b32 v98, 16, v104
    v_and_b32 v99, 0xffff0000, v104
    v_lshlrev_b32 v104, 16, v81
    v_and_b32 v105, 0xffff0000, v81
    v_mul_f32 v98, v98, v104
    v_mul_f32 v99, v99, v105
    v_cvt_pk_bf16_f32 v104, v98, v99
    v_lshlrev_b32 v98, 16, v104
    v_and_b32 v99, 0xffff0000, v104
    v_lshlrev_b32 v104, 16, v109
    v_and_b32 v105, 0xffff0000, v109
    v_add_f32 v98, v98, v104
    v_add_f32 v99, v99, v105
    v_cvt_pk_bf16_f32 v113, v98, v99
    v_cvt_pk_bf16_f32 v104, v100, v101
    v_lshlrev_b32 v100, 16, v104
    v_and_b32 v101, 0xffff0000, v104
    v_lshlrev_b32 v104, 16, v82
    v_and_b32 v105, 0xffff0000, v82
    v_mul_f32 v100, v100, v104
    v_mul_f32 v101, v101, v105
    v_cvt_pk_bf16_f32 v104, v100, v101
    v_lshlrev_b32 v100, 16, v104
    v_and_b32 v101, 0xffff0000, v104
    v_lshlrev_b32 v104, 16, v110
    v_and_b32 v105, 0xffff0000, v110
    v_add_f32 v100, v100, v104
    v_add_f32 v101, v101, v105
    v_cvt_pk_bf16_f32 v114, v100, v101
    v_cvt_pk_bf16_f32 v104, v102, v103
    v_lshlrev_b32 v102, 16, v104
    v_and_b32 v103, 0xffff0000, v104
    v_lshlrev_b32 v104, 16, v83
    v_and_b32 v105, 0xffff0000, v83
    v_mul_f32 v102, v102, v104
    v_mul_f32 v103, v103, v105
    v_cvt_pk_bf16_f32 v104, v102, v103
    v_lshlrev_b32 v102, 16, v104
    v_and_b32 v103, 0xffff0000, v104
    v_lshlrev_b32 v104, 16, v111
    v_and_b32 v105, 0xffff0000, v111
    v_add_f32 v102, v102, v104
    v_add_f32 v103, v103, v105
    v_cvt_pk_bf16_f32 v115, v102, v103
    v_cndmask_b32 v128, v112, v114, s[20:21]
    v_cndmask_b32 v129, v113, v115, s[20:21]
    v_cndmask_b32 v130, v114, v112, s[20:21]
    v_cndmask_b32 v131, v115, v113, s[20:21]
    buffer_store_dwordx4 v[128:131], v4, s[12:15], s18 offen offset:0
    s_branch k_end
chain_map:
    s_and_b32 s14, s12, 1
    s_lshl_b32 s13, s13, 1
    s_lshr_b32 s15, s12, 1
    s_add_u32 s12, s13, s14
    s_mov_b32 s13, s15
    s_lshl_b32 s2, s13, 3
    s_add_u32 s2, s2, s12
    s_lshr_b32 s14, s13, 2
    s_and_b32 s15, s13, 3
    s_mov_b32 s16, 0
    s_mov_b32 s17, 209715200
    s_mov_b32 s18, 209977344
    s_mov_b32 s19, 210239488
    s_mov_b32 s20, 210501632
    s_mov_b32 s26, 131072
    s_mov_b32 s68, 0
    s_getreg_b32 s29, hwreg(HW_REG_XCC_ID)
    s_and_b32 s29, s29, 15
    s_mul_i32 s23, s29, s29
    s_lshl_b32 s23, s23, 18
    s_lshl_b32 s29, s29, 8
    s_add_u32 s29, s29, s23
    s_add_u32 s29, s29, 1
    s_lshr_b32 s28, s12, 1
    s_lshl_b32 s28, s28, 2
    s_add_u32 s28, s28, 128
    s_cmp_ge_u32 s3, 4
    s_cbranch_scc1 ch_a_pro
    s_lshl_b32 s32, s12, 15
    s_lshl_b32 s21, s14, 13
    s_add_u32 s32, s32, s21
    s_lshl_b32 s21, s15, 10
    s_add_u32 s32, s32, s21
    s_add_u32 s32, s32, 2097152
    s_lshr_b32 s33, s12, 1
    s_lshl_b32 s33, s33, 14
    s_add_u32 s33, s33, 1048576
    s_lshl_b32 s21, s13, 10
    s_add_u32 s36, s33, s21
    s_lshl_b32 s21, s3, 12
    s_add_u32 s33, s33, s21
    s_lshl_b32 s34, s13, 14
    s_lshl_b32 s21, s12, 10
    s_add_u32 s35, s34, s21
    s_lshl_b32 s37, s12, 22
    s_lshl_b32 s21, s13, 11
    s_add_u32 s37, s37, s21
    s_and_b32 s21, s3, 1
    s_lshl_b32 s21, s21, 15
    s_add_u32 s37, s37, s21
    s_lshr_b32 s21, s3, 1
    s_lshl_b32 s21, s21, 10
    s_add_u32 s37, s37, s21
    s_add_u32 s37, s37, 75497472
    v_and_b32 v20, 63, v0
    v_lshlrev_b32 v1, 4, v20
    v_mov_b32 v10, -1
    v_mov_b32 v11, -1
    v_lshrrev_b32 v21, 2, v20
    v_and_b32 v22, 3, v20
    v_lshlrev_b32 v21, 13, v21
    v_lshl_add_u32 v21, v22, 4, v21
    s_lshl_b32 s21, s3, 21
    s_lshl_b32 s22, s12, 10
    s_add_u32 s21, s21, s22
    s_lshl_b32 s23, s3, 15
    s_mov_b32 s10, 8388608
    s_mov_b32 s11, 131072
    v_lshrrev_b32 v24, 4, v20
    v_bfe_u32 v25, v20, 2, 2
    v_lshl_add_u32 v24, v24, 4, v25
    v_lshlrev_b32 v24, 6, v24
    v_lshl_add_u32 v24, v22, 3, v24
    v_add_u32 v24, s23, v24
    s_and_b32 s70, s13, 1
    s_lshl_b32 s71, s12, 4
    s_add_u32 s71, s71, s13
    s_cmp_eq_u32 s71, 127
    s_cselect_b32 s70, 1, 0
    s_cmp_eq_u32 s13, 7
    s_cselect_b32 s70, 1, s70
    s_lshl_b32 s72, s70, 20
    s_lshl_b32 s73, s70, 21
    s_lshl_b32 s70, s70, 13
    s_sub_u32 s71, s23, s70
    s_add_u32 s70, s23, s70
    s_load_dwordx2 s[8:9], s[0:1], 16
    s_lshl_b32 s25, s13, 6
    s_add_u32 s24, s21, s25
    s_add_u32 s24, s24, s72
    s_waitcnt lgkmcnt(0)
    s_add_u32 m0, s70, 0
    s_nop 0
    buffer_load_dwordx4 v21, s[8:11], s24 offen lds
    s_add_u32 s24, s24, 131072
    s_add_u32 m0, s70, 1024
    s_nop 0
    buffer_load_dwordx4 v21, s[8:11], s24 offen lds
    s_add_u32 s24, s24, 131072
    s_add_u32 m0, s70, 2048
    s_nop 0
    buffer_load_dwordx4 v21, s[8:11], s24 offen lds
    s_add_u32 s24, s24, 131072
    s_add_u32 m0, s70, 3072
    s_nop 0
    buffer_load_dwordx4 v21, s[8:11], s24 offen lds
    s_add_u32 s24, s24, 131072
    s_add_u32 m0, s70, 4096
    s_nop 0
    buffer_load_dwordx4 v21, s[8:11], s24 offen lds
    s_add_u32 s24, s24, 131072
    s_add_u32 m0, s70, 5120
    s_nop 0
    buffer_load_dwordx4 v21, s[8:11], s24 offen lds
    s_add_u32 s24, s24, 131072
    s_add_u32 m0, s70, 6144
    s_nop 0
    buffer_load_dwordx4 v21, s[8:11], s24 offen lds
    s_add_u32 s24, s24, 131072
    s_add_u32 m0, s70, 7168
    s_nop 0
    buffer_load_dwordx4 v21, s[8:11], s24 offen lds
    s_add_u32 s24, s24, 131072
    s_sub_u32 s24, s24, s73
    s_add_u32 m0, s71, 8192
    s_nop 0
    buffer_load_dwordx4 v21, s[8:11], s24 offen lds
    s_add_u32 s24, s24, 131072
    s_add_u32 m0, s71, 9216
    s_nop 0
    buffer_load_dwordx4 v21, s[8:11], s24 offen lds
    s_add_u32 s24, s24, 131072
    s_add_u32 m0, s71, 10240
    s_nop 0
    buffer_load_dwordx4 v21, s[8:11], s24 offen lds
    s_add_u32 s24, s24, 131072
    s_add_u32 m0, s71, 11264
    s_nop 0
    buffer_load_dwordx4 v21, s[8:11], s24 offen lds
    s_add_u32 s24, s24, 131072
    s_add_u32 m0, s71, 12288
    s_nop 0
    buffer_load_dwordx4 v21, s[8:11], s24 offen lds
    s_add_u32 s24, s24, 131072
    s_add_u32 m0, s71, 13312
    s_nop 0
    buffer_load_dwordx4 v21, s[8:11], s24 offen lds
    s_add_u32 s24, s24, 131072
    s_add_u32 m0, s71, 14336
    s_nop 0
    buffer_load_dwordx4 v21, s[8:11], s24 offen lds
    s_add_u32 s24, s24, 131072
    s_add_u32 m0, s71, 15360
    s_nop 0
    buffer_load_dwordx4 v21, s[8:11], s24 offen lds
    s_add_u32 s24, s24, 131072
    s_load_dwordx2 s[8:9], s[0:1], 24
    s_lshl_b32 s25, s13, 6
    s_add_u32 s24, s21, s25
    s_add_u32 s24, s24, s72
    s_waitcnt lgkmcnt(0)
    s_add_u32 m0, s70, 16384
    s_nop 0
    buffer_load_dwordx4 v21, s[8:11], s24 offen lds
    s_add_u32 s24, s24, 131072
    s_add_u32 m0, s70, 17408
    s_nop 0
    buffer_load_dwordx4 v21, s[8:11], s24 offen lds
    s_add_u32 s24, s24, 131072
    s_add_u32 m0, s70, 18432
    s_nop 0
    buffer_load_dwordx4 v21, s[8:11], s24 offen lds
    s_add_u32 s24, s24, 131072
    s_add_u32 m0, s70, 19456
    s_nop 0
    buffer_load_dwordx4 v21, s[8:11], s24 offen lds
    s_add_u32 s24, s24, 131072
    s_add_u32 m0, s70, 20480
    s_nop 0
    buffer_load_dwordx4 v21, s[8:11], s24 offen lds
    s_add_u32 s24, s24, 131072
    s_add_u32 m0, s70, 21504
    s_nop 0
    buffer_load_dwordx4 v21, s[8:11], s24 offen lds
    s_add_u32 s24, s24, 131072
    s_add_u32 m0, s70, 22528
    s_nop 0
    buffer_load_dwordx4 v21, s[8:11], s24 offen lds
    s_add_u32 s24, s24, 131072
    s_add_u32 m0, s70, 23552
    s_nop 0
    buffer_load_dwordx4 v21, s[8:11], s24 offen lds
    s_add_u32 s24, s24, 131072
    s_sub_u32 s24, s24, s73
    s_add_u32 m0, s71, 24576
    s_nop 0
    buffer_load_dwordx4 v21, s[8:11], s24 offen lds
    s_add_u32 s24, s24, 131072
    s_add_u32 m0, s71, 25600
    s_nop 0
    buffer_load_dwordx4 v21, s[8:11], s24 offen lds
    s_add_u32 s24, s24, 131072
    s_add_u32 m0, s71, 26624
    s_nop 0
    buffer_load_dwordx4 v21, s[8:11], s24 offen lds
    s_add_u32 s24, s24, 131072
    s_add_u32 m0, s71, 27648
    s_nop 0
    buffer_load_dwordx4 v21, s[8:11], s24 offen lds
    s_add_u32 s24, s24, 131072
    s_add_u32 m0, s71, 28672
    s_nop 0
    buffer_load_dwordx4 v21, s[8:11], s24 offen lds
    s_add_u32 s24, s24, 131072
    s_add_u32 m0, s71, 29696
    s_nop 0
    buffer_load_dwordx4 v21, s[8:11], s24 offen lds
    s_add_u32 s24, s24, 131072
    s_add_u32 m0, s71, 30720
    s_nop 0
    buffer_load_dwordx4 v21, s[8:11], s24 offen lds
    s_add_u32 s24, s24, 131072
    s_add_u32 m0, s71, 31744
    s_nop 0
    buffer_load_dwordx4 v21, s[8:11], s24 offen lds
    s_add_u32 s24, s24, 131072
    s_load_dwordx2 s[8:9], s[0:1], 32
    s_lshl_b32 s25, s13, 6
    s_add_u32 s24, s21, s25
    s_add_u32 s24, s24, s72
    s_waitcnt lgkmcnt(0)
    buffer_load_dwordx4 v[96:99], v21, s[8:11], s24 offen
    s_add_u32 s24, s24, 131072
    buffer_load_dwordx4 v[100:103], v21, s[8:11], s24 offen
    s_add_u32 s24, s24, 131072
    buffer_load_dwordx4 v[104:107], v21, s[8:11], s24 offen
    s_add_u32 s24, s24, 131072
    buffer_load_dwordx4 v[108:111], v21, s[8:11], s24 offen
    s_add_u32 s24, s24, 131072
    buffer_load_dwordx4 v[144:147], v21, s[8:11], s24 offen
    s_add_u32 s24, s24, 131072
    buffer_load_dwordx4 v[148:151], v21, s[8:11], s24 offen
    s_add_u32 s24, s24, 131072
    buffer_load_dwordx4 v[152:155], v21, s[8:11], s24 offen
    s_add_u32 s24, s24, 131072
    buffer_load_dwordx4 v[156:159], v21, s[8:11], s24 offen
    s_add_u32 s24, s24, 131072
    s_sub_u32 s24, s24, s73
    buffer_load_dwordx4 v[192:195], v21, s[8:11], s24 offen
    s_add_u32 s24, s24, 131072
    buffer_load_dwordx4 v[196:199], v21, s[8:11], s24 offen
    s_add_u32 s24, s24, 131072
    buffer_load_dwordx4 v[200:203], v21, s[8:11], s24 offen
    s_add_u32 s24, s24, 131072
    buffer_load_dwordx4 v[204:207], v21, s[8:11], s24 offen
    s_add_u32 s24, s24, 131072
    buffer_load_dwordx4 v[240:243], v21, s[8:11], s24 offen
    s_add_u32 s24, s24, 131072
    buffer_load_dwordx4 v[244:247], v21, s[8:11], s24 offen
    s_add_u32 s24, s24, 131072
    buffer_load_dwordx4 v[248:251], v21, s[8:11], s24 offen
    s_add_u32 s24, s24, 131072
    buffer_load_dwordx4 v[252:255], v21, s[8:11], s24 offen
    s_add_u32 s24, s24, 131072
    s_load_dwordx2 s[8:9], s[0:1], 8
    s_mov_b32 s10, 16384
    v_bfe_u32 v57, v20, 4, 1
    v_lshrrev_b32 v58, 5, v20
    v_and_b32 v59, 1, v20
    v_bfe_u32 v60, v20, 1, 3
    v_lshlrev_b32 v60, 11, v60
    v_lshl_add_u32 v60, v57, 6, v60
    v_lshl_add_u32 v60, v58, 4, v60
    v_lshl_add_u32 v15, v59, 2, v60
    s_lshl_b32 s24, s3, 9
    s_waitcnt lgkmcnt(0)
    buffer_load_dword v32, v15, s[8:11], s24 offen offset:0
    buffer_load_dword v33, v15, s[8:11], s24 offen offset:8
    buffer_load_dword v34, v15, s[8:11], s24 offen offset:32
    buffer_load_dword v35, v15, s[8:11], s24 offen offset:40
    buffer_load_dword v36, v15, s[8:11], s24 offen offset:128
    buffer_load_dword v37, v15, s[8:11], s24 offen offset:136
    buffer_load_dword v38, v15, s[8:11], s24 offen offset:160
    buffer_load_dword v39, v15, s[8:11], s24 offen offset:168
    buffer_load_dword v40, v15, s[8:11], s24 offen offset:256
    buffer_load_dword v41, v15, s[8:11], s24 offen offset:264
    buffer_load_dword v42, v15, s[8:11], s24 offen offset:288
    buffer_load_dword v43, v15, s[8:11], s24 offen offset:296
    buffer_load_dword v44, v15, s[8:11], s24 offen offset:384
    buffer_load_dword v45, v15, s[8:11], s24 offen offset:392
    buffer_load_dword v46, v15, s[8:11], s24 offen offset:416
    buffer_load_dword v47, v15, s[8:11], s24 offen offset:424
    s_barrier
    v_add_u32 v56, s70, v1
    s_add_u32 s71, s71, 8192
    v_add_u32 v26, s71, v1
    s_waitcnt vmcnt(48)
    ds_read_b64_tr_b16 v[64:65], v24 offset:0
    ds_read_b64_tr_b16 v[66:67], v24 offset:256
    ds_read_b64_tr_b16 v[68:69], v24 offset:512
    ds_read_b64_tr_b16 v[70:71], v24 offset:768
    ds_read_b64_tr_b16 v[72:73], v24 offset:32
    ds_read_b64_tr_b16 v[74:75], v24 offset:288
    ds_read_b64_tr_b16 v[76:77], v24 offset:544
    ds_read_b64_tr_b16 v[78:79], v24 offset:800
    s_waitcnt lgkmcnt(0)
    ds_read_b64_tr_b16 v[112:113], v24 offset:4096
    ds_read_b64_tr_b16 v[114:115], v24 offset:4352
    ds_read_b64_tr_b16 v[116:117], v24 offset:4608
    ds_read_b64_tr_b16 v[118:119], v24 offset:4864
    ds_read_b64_tr_b16 v[120:121], v24 offset:4128
    ds_read_b64_tr_b16 v[122:123], v24 offset:4384
    ds_read_b64_tr_b16 v[124:125], v24 offset:4640
    ds_read_b64_tr_b16 v[126:127], v24 offset:4896
    s_waitcnt lgkmcnt(0)
    ds_read_b64_tr_b16 v[160:161], v24 offset:8192
    ds_read_b64_tr_b16 v[162:163], v24 offset:8448
    ds_read_b64_tr_b16 v[164:165], v24 offset:8704
    ds_read_b64_tr_b16 v[166:167], v24 offset:8960
    ds_read_b64_tr_b16 v[168:169], v24 offset:8224
    ds_read_b64_tr_b16 v[170:171], v24 offset:8480
    ds_read_b64_tr_b16 v[172:173], v24 offset:8736
    ds_read_b64_tr_b16 v[174:175], v24 offset:8992
    s_waitcnt lgkmcnt(0)
    ds_read_b64_tr_b16 v[208:209], v24 offset:12288
    ds_read_b64_tr_b16 v[210:211], v24 offset:12544
    ds_read_b64_tr_b16 v[212:213], v24 offset:12800
    ds_read_b64_tr_b16 v[214:215], v24 offset:13056
    ds_read_b64_tr_b16 v[216:217], v24 offset:12320
    ds_read_b64_tr_b16 v[218:219], v24 offset:12576
    ds_read_b64_tr_b16 v[220:221], v24 offset:12832
    ds_read_b64_tr_b16 v[222:223], v24 offset:13088
    s_waitcnt lgkmcnt(0)
    s_waitcnt vmcnt(32)
    ds_read_b64_tr_b16 v[80:81], v24 offset:16384
    ds_read_b64_tr_b16 v[82:83], v24 offset:16640
    ds_read_b64_tr_b16 v[84:85], v24 offset:16896
    ds_read_b64_tr_b16 v[86:87], v24 offset:17152
    ds_read_b64_tr_b16 v[88:89], v24 offset:16416
    ds_read_b64_tr_b16 v[90:91], v24 offset:16672
    ds_read_b64_tr_b16 v[92:93], v24 offset:16928
    ds_read_b64_tr_b16 v[94:95], v24 offset:17184
    s_waitcnt lgkmcnt(0)
    ds_read_b64_tr_b16 v[128:129], v24 offset:20480
    ds_read_b64_tr_b16 v[130:131], v24 offset:20736
    ds_read_b64_tr_b16 v[132:133], v24 offset:20992
    ds_read_b64_tr_b16 v[134:135], v24 offset:21248
    ds_read_b64_tr_b16 v[136:137], v24 offset:20512
    ds_read_b64_tr_b16 v[138:139], v24 offset:20768
    ds_read_b64_tr_b16 v[140:141], v24 offset:21024
    ds_read_b64_tr_b16 v[142:143], v24 offset:21280
    s_waitcnt lgkmcnt(0)
    ds_read_b64_tr_b16 v[176:177], v24 offset:24576
    ds_read_b64_tr_b16 v[178:179], v24 offset:24832
    ds_read_b64_tr_b16 v[180:181], v24 offset:25088
    ds_read_b64_tr_b16 v[182:183], v24 offset:25344
    ds_read_b64_tr_b16 v[184:185], v24 offset:24608
    ds_read_b64_tr_b16 v[186:187], v24 offset:24864
    ds_read_b64_tr_b16 v[188:189], v24 offset:25120
    ds_read_b64_tr_b16 v[190:191], v24 offset:25376
    s_waitcnt lgkmcnt(0)
    ds_read_b64_tr_b16 v[224:225], v24 offset:28672
    ds_read_b64_tr_b16 v[226:227], v24 offset:28928
    ds_read_b64_tr_b16 v[228:229], v24 offset:29184
    ds_read_b64_tr_b16 v[230:231], v24 offset:29440
    ds_read_b64_tr_b16 v[232:233], v24 offset:28704
    ds_read_b64_tr_b16 v[234:235], v24 offset:28960
    ds_read_b64_tr_b16 v[236:237], v24 offset:29216
    ds_read_b64_tr_b16 v[238:239], v24 offset:29472
    s_waitcnt lgkmcnt(0)
    s_waitcnt vmcnt(16)
    ds_write_b128 v56, v[96:99] offset:0
    ds_write_b128 v56, v[100:103] offset:1024
    ds_write_b128 v56, v[104:107] offset:2048
    ds_write_b128 v56, v[108:111] offset:3072
    ds_write_b128 v56, v[144:147] offset:4096
    ds_write_b128 v56, v[148:151] offset:5120
    ds_write_b128 v56, v[152:155] offset:6144
    ds_write_b128 v56, v[156:159] offset:7168
    ds_write_b128 v26, v[192:195] offset:0
    ds_write_b128 v26, v[196:199] offset:1024
    ds_write_b128 v26, v[200:203] offset:2048
    ds_write_b128 v26, v[204:207] offset:3072
    ds_write_b128 v26, v[240:243] offset:4096
    ds_write_b128 v26, v[244:247] offset:5120
    ds_write_b128 v26, v[248:251] offset:6144
    ds_write_b128 v26, v[252:255] offset:7168
    s_waitcnt lgkmcnt(0)
    ds_read_b64_tr_b16 v[96:97], v24 offset:0
    ds_read_b64_tr_b16 v[98:99], v24 offset:256
    ds_read_b64_tr_b16 v[100:101], v24 offset:512
    ds_read_b64_tr_b16 v[102:103], v24 offset:768
    ds_read_b64_tr_b16 v[104:105], v24 offset:32
    ds_read_b64_tr_b16 v[106:107], v24 offset:288
    ds_read_b64_tr_b16 v[108:109], v24 offset:544
    ds_read_b64_tr_b16 v[110:111], v24 offset:800
    s_waitcnt lgkmcnt(0)
    ds_read_b64_tr_b16 v[144:145], v24 offset:4096
    ds_read_b64_tr_b16 v[146:147], v24 offset:4352
    ds_read_b64_tr_b16 v[148:149], v24 offset:4608
    ds_read_b64_tr_b16 v[150:151], v24 offset:4864
    ds_read_b64_tr_b16 v[152:153], v24 offset:4128
    ds_read_b64_tr_b16 v[154:155], v24 offset:4384
    ds_read_b64_tr_b16 v[156:157], v24 offset:4640
    ds_read_b64_tr_b16 v[158:159], v24 offset:4896
    s_waitcnt lgkmcnt(0)
    ds_read_b64_tr_b16 v[192:193], v24 offset:8192
    ds_read_b64_tr_b16 v[194:195], v24 offset:8448
    ds_read_b64_tr_b16 v[196:197], v24 offset:8704
    ds_read_b64_tr_b16 v[198:199], v24 offset:8960
    ds_read_b64_tr_b16 v[200:201], v24 offset:8224
    ds_read_b64_tr_b16 v[202:203], v24 offset:8480
    ds_read_b64_tr_b16 v[204:205], v24 offset:8736
    ds_read_b64_tr_b16 v[206:207], v24 offset:8992
    s_waitcnt lgkmcnt(0)
    ds_read_b64_tr_b16 v[240:241], v24 offset:12288
    ds_read_b64_tr_b16 v[242:243], v24 offset:12544
    ds_read_b64_tr_b16 v[244:245], v24 offset:12800
    ds_read_b64_tr_b16 v[246:247], v24 offset:13056
    ds_read_b64_tr_b16 v[248:249], v24 offset:12320
    ds_read_b64_tr_b16 v[250:251], v24 offset:12576
    ds_read_b64_tr_b16 v[252:253], v24 offset:12832
    ds_read_b64_tr_b16 v[254:255], v24 offset:13088
    s_waitcnt lgkmcnt(0)
    v_mov_b32 v21, 0x44444444
    v_mov_b32 v22, 0xeeeeeeee
    v_and_b32 v23, 1, v20
    v_cmp_eq_u32 vcc, 0, v23
    v_and_b32 v27, 255, v0
    v_lshlrev_b32 v2, 2, v27
    v_cndmask_b32 v62, v22, v21, vcc
    s_lshr_b32 s21, s15, 1
    s_sub_u32 s21, s21, s15
    s_add_u32 s21, s21, 4
    s_lshl_b32 s21, s21, 10
    s_and_b32 s22, s15, 1
    s_lshl_b32 s22, s22, 9
    s_add_u32 s21, s21, s22
    s_lshl_b32 s22, s3, 7
    s_add_u32 s21, s21, s22
    v_and_b32 v21, 31, v20
    v_lshlrev_b32 v21, 2, v21
    v_add_u32 v3, s21, v21
    v_lshrrev_b32 v21, 4, v20
    v_and_b32 v22, 15, v20
    v_mul_u32_u24 v21, 208, v21
    v_add_lshl_u32 v21, v21, v22, 2
    s_mul_i32 s21, s3, 3328
    v_add_u32 v4, s21, v21
    v_lshrrev_b32 v21, 4, v20
    v_bfe_u32 v22, v20, 2, 1
    v_lshl_add_u32 v21, v21, 1, v22
    v_mul_u32_u24 v21, 104, v21
    v_bfe_u32 v22, v20, 3, 1
    v_xor_b32 v22, 1, v22
    v_lshl_add_u32 v21, v22, 5, v21
    v_and_b32 v22, 3, v20
    v_lshlrev_b32 v22, 1, v22
    s_and_b32 s21, s3, 1
    s_lshl_b32 s21, s21, 2
    v_xor_b32 v22, s21, v22
    v_add_u32 v21, v21, v22
    s_lshl_b32 s21, s3, 3
    v_add_u32 v21, s21, v21
    v_lshlrev_b32 v5, 2, v21
    s_and_b32 s21, s3, 1
    s_lshl_b32 s21, s21, 2
    v_bfe_u32 v21, v20, 3, 2
    v_add_u32 v21, s21, v21
    v_mul_u32_u24 v21, 104, v21
    v_bfe_u32 v22, v20, 1, 1
    v_lshl_add_u32 v21, v22, 3, v21
    v_and_b32 v23, 1, v20
    v_xor_b32 v22, v22, v23
    v_lshl_add_u32 v21, v22, 2, v21
    v_bfe_u32 v22, v20, 2, 1
    v_lshl_add_u32 v21, v22, 1, v21
    s_lshr_b32 s21, s3, 1
    s_lshl_b32 s21, s21, 4
    s_add_u32 s21, s21, 64
    v_add_u32 v21, s21, v21
    v_lshlrev_b32 v6, 2, v21
    v_lshrrev_b32 v21, 6, v27
    v_bfe_u32 v22, v27, 1, 1
    v_lshrrev_b32 v23, 1, v21
    v_lshl_add_u32 v22, v22, 1, v23
    v_xor_b32 v23, v27, v22
    v_and_b32 v23, 1, v23
    v_and_b32 v21, 1, v21
    v_lshl_add_u32 v21, v21, 1, v23
    v_mul_u32_u24 v21, 544, v21
    v_lshl_add_u32 v21, v22, 5, v21
    v_bfe_u32 v23, v27, 4, 2
    v_mul_u32_u24 v23, 136, v23
    v_add_u32 v21, v21, v23
    v_bfe_u32 v24, v27, 3, 1
    v_lshl_add_u32 v21, v24, 2, v21
    v_bfe_u32 v24, v27, 2, 1
    v_lshl_add_u32 v21, v24, 4, v21
    v_add_u32 v7, 16384, v21
    v_lshlrev_b32 v8, 2, v20
    s_and_b32 s21, s12, 1
    s_lshl_b32 s21, s21, 9
    s_lshl_b32 s22, s3, 7
    s_add_u32 s21, s21, s22
    v_and_b32 v21, 7, v20
    v_lshlrev_b32 v21, 4, v21
    v_add_u32 v21, s21, v21
    v_lshrrev_b32 v22, 3, v20
    v_lshl_add_u32 v12, v22, 10, v21
    v_bfe_u32 v22, v20, 4, 1
    v_lshl_add_u32 v13, v22, 3, v21
    s_and_b32 s21, s3, 1
    s_lshl_b32 s21, s21, 12
    s_lshr_b32 s22, s3, 1
    s_lshl_b32 s22, s22, 11
    s_add_u32 s21, s21, s22
    s_add_u32 s21, s21, 18560
    v_add_u32 v61, s21, v1
    s_lshl_b32 s21, s3, 2
    s_add_u32 s21, s21, 13312
    v_mov_b32 v14, s21
    v_and_b32 v21, 15, v20
    v_and_b32 v22, 1, v20
    v_lshlrev_b32 v22, 4, v22
    v_mov_b32 v23, 0x3f80
    v_lshlrev_b32 v22, v22, v23
    v_lshrrev_b32 v21, 1, v21
    v_cmp_eq_u32 vcc, 0, v21
    s_nop 1
    v_cndmask_b32 v56, 0, v22, vcc
    v_cmp_eq_u32 vcc, 1, v21
    s_nop 1
    v_cndmask_b32 v57, 0, v22, vcc
    v_cmp_eq_u32 vcc, 2, v21
    s_nop 1
    v_cndmask_b32 v58, 0, v22, vcc
    v_cmp_eq_u32 vcc, 3, v21
    s_nop 1
    v_cndmask_b32 v59, 0, v22, vcc
    v_and_b32 v21, 7, v20
    v_lshlrev_b32 v21, 7, v21
    v_bfe_u32 v22, v20, 3, 1
    v_lshl_add_u32 v21, v22, 17, v21
    s_lshl_b32 s21, s12, 14
    s_lshl_b32 s22, s13, 10
    s_add_u32 s21, s21, s22
    s_add_u32 s21, s21, 4980736
    v_lshrrev_b32 v22, 4, v20
    v_lshl_add_u32 v21, v22, 24, v21
    v_add_u32 v63, s21, v21
    s_mov_b32 s47, 0x3e0293ee
    s_lshl_b32 s14, s12, 2
    s_add_u32 s14, s14, s3
    s_lshl_b32 s61, s14, 13
    s_add_u32 s61, s61, 2097152
    s_lshl_b32 s14, s14, 12
    s_and_b32 s22, s13, 1
    s_lshl_b32 s69, s22, 17
    s_add_u32 s69, s69, s14
    s_add_u32 s69, s69, 4194304
    s_add_u32 s52, s14, 20971520
    s_lshl_b32 s21, s22, 11
    s_add_u32 s14, s14, s21
    s_add_u32 s14, s14, 1179648
    s_lshr_b32 s21, s13, 1
    s_sub_u32 s21, s21, 0
    s_cmp_eq_u32 s21, s3
    s_cselect_b32 s15, 1, 0
    v_lshrrev_b32 v21, 4, v20
    v_and_b32 v23, 15, v20
    v_lshlrev_b32 v21, 2, v21
    v_add_u32 v24, 0, v21
    v_cmp_gt_u32 vcc, v24, v23
    s_cmp_eq_u32 s22, 0
    s_cselect_b64 s[38:39], vcc, 0
    s_cselect_b64 s[48:49], -1, vcc
    v_add_u32 v24, 1, v21
    v_cmp_gt_u32 vcc, v24, v23
    s_cmp_eq_u32 s22, 0
    s_cselect_b64 s[40:41], vcc, 0
    s_cselect_b64 s[50:51], -1, vcc
    v_add_u32 v24, 2, v21
    v_cmp_gt_u32 vcc, v24, v23
    s_cmp_eq_u32 s22, 0
    s_cselect_b64 s[42:43], vcc, 0
    s_cselect_b64 s[54:55], -1, vcc
    v_add_u32 v24, 3, v21
    v_cmp_gt_u32 vcc, v24, v23
    s_cmp_eq_u32 s22, 0
    s_cselect_b64 s[44:45], vcc, 0
    s_cselect_b64 s[56:57], -1, vcc
    s_waitcnt vmcnt(0)
    v_mov_b32 v16, v32
    v_mov_b32 v17, v33
    v_mov_b32 v18, v34
    v_mov_b32 v19, v35
    v_mov_b32 v20, v36
    v_mov_b32 v21, v37
    v_mov_b32 v22, v38
    v_mov_b32 v23, v39
    v_mov_b32 v24, v40
    v_mov_b32 v25, v41
    v_mov_b32 v26, v42
    v_mov_b32 v27, v43
    v_mov_b32 v28, v44
    v_mov_b32 v29, v45
    v_mov_b32 v30, v46
    v_mov_b32 v31, v47
    v_mov_b32 v32, -1
    v_mov_b32 v33, -1
    v_mov_b32 v34, -1
    v_mov_b32 v35, -1
    s_add_u32 s21, s37, 3997696
    buffer_store_dwordx4 v[32:35], v1, s[4:7], s21 offen sc1
    s_add_u32 s21, s37, 4063232
    buffer_store_dwordx4 v[32:35], v1, s[4:7], s21 offen sc1
    s_add_u32 s21, s37, 4128768
    buffer_store_dwordx4 v[32:35], v1, s[4:7], s21 offen sc1
    s_lshl_b32 s29, s29, 5
    s_barrier
    ds_write_b32 v14, v10
    ds_write_b32 v14, v10 offset:16
    s_lshl_b32 s53, s3, 13
    s_add_u32 s53, s53, 92160
    v_add_u32 v32, 14336, v1
    ds_write_b128 v32, v[56:59]
    s_lshl_b32 s60, s12, 4
    s_add_u32 s60, s60, 218104320
    v_mov_b32 v15, 0
    s_add_u32 s25, s16, 0
    s_min_u32 s25, s25, 63
    s_cmp_lt_u32 s25, 8
    s_cselect_b32 s59, 12, 24
    s_cselect_b32 s58, -4, -8
    s_and_b32 s25, s25, s58
    s_lshl_b32 s25, s25, 5
    s_add_u32 s58, s25, s60
    v_mov_b32 v32, 131072
    s_waitcnt vmcnt(0) lgkmcnt(0)
    s_barrier
    ds_read_b64 v[32:33], v32
    s_waitcnt lgkmcnt(0)
    v_cmp_ne_u32 vcc, s29, v32
    s_setprio 3
    v_readfirstlane_b32 s63, v33
    s_add_u32 s34, s34, s63
    s_add_u32 s35, s35, s63
gate_6:
    v_readfirstlane_b32 s25, v15
    s_cmp_ge_u32 s25, s59
    s_cbranch_scc1 gate_6_ok
    s_sleep 8
    buffer_load_dword v15, off, s[4:7], s58 sc1
    s_waitcnt vmcnt(0)
    s_sub_u32 s26, s26, 1
    s_cbranch_scc0 gate_6
    s_mov_b32 s26, 0
gate_6_ok:
    s_add_u32 m0, s53, 0
    s_add_u32 s22, s52, 0
    buffer_load_dwordx4 v1, s[4:7], s22 offen offset:0 sc1 lds
    buffer_load_dwordx4 v1, s[4:7], s22 offen offset:1024 sc1 lds
    buffer_load_dwordx4 v1, s[4:7], s22 offen offset:2048 sc1 lds
    buffer_load_dwordx4 v1, s[4:7], s22 offen offset:3072 sc1 lds
    s_add_u32 m0, s53, 4096
    s_add_u32 s22, s52, 131072
    buffer_load_dwordx4 v1, s[4:7], s22 offen offset:0 sc1 lds
    buffer_load_dwordx4 v1, s[4:7], s22 offen offset:1024 sc1 lds
    buffer_load_dwordx4 v1, s[4:7], s22 offen offset:2048 sc1 lds
    buffer_load_dwordx4 v1, s[4:7], s22 offen offset:3072 sc1 lds
    s_add_u32 s52, s52, 262144
    s_cmp_eq_u32 s15, 0
    s_cbranch_scc1 ch_p_nd
    s_mov_b32 m0, 124928
    s_nop 0
    buffer_load_dwordx4 v1, s[4:7], s69 offen offset:0 sc1 lds
    buffer_load_dwordx4 v1, s[4:7], s69 offen offset:1024 sc1 lds
    buffer_load_dwordx4 v1, s[4:7], s69 offen offset:2048 sc1 lds
    buffer_load_dwordx4 v1, s[4:7], s69 offen offset:3072 sc1 lds
    s_add_u32 s69, s69, 262144
ch_p_nd:
    s_cbranch_vccnz ch_p_slow
    v_mov_b32 v32, 0
    v_mov_b32 v33, 0
    v_mov_b32 v34, 0
    v_mov_b32 v35, 0
    v_mov_b32 v36, 0
    v_mov_b32 v37, 0
    v_mov_b32 v38, 0
    v_mov_b32 v39, 0
    v_mov_b32 v40, 0
    v_mov_b32 v41, 0
    v_mov_b32 v42, 0
    v_mov_b32 v43, 0
    v_mov_b32 v44, 0
    v_mov_b32 v45, 0
    v_mov_b32 v46, 0
    v_mov_b32 v47, 0
    v_mov_b32 v48, 0
    v_mov_b32 v49, 0
    v_mov_b32 v50, 0
    v_mov_b32 v51, 0
    v_mov_b32 v52, 0
    v_mov_b32 v53, 0
    v_mov_b32 v54, 0
    v_mov_b32 v55, 0
    s_mov_b32 s31, 0
    v_mov_b32 v60, s16
    s_branch pnc_8
.p2align 6
ploop_7:
    s_add_u32 s21, s17, s33
    v_mov_b32 v32, 0
    v_mov_b32 v33, 0
    v_mov_b32 v34, 0
    v_mov_b32 v35, 0
    v_mov_b32 v36, 0
    v_mov_b32 v37, 0
    v_mov_b32 v38, 0
    v_mov_b32 v39, 0
    v_mov_b32 v40, 0
    v_mov_b32 v41, 0
    v_mov_b32 v42, 0
    v_mov_b32 v43, 0
    v_mov_b32 v44, 0
    v_mov_b32 v45, 0
    v_mov_b32 v46, 0
    v_mov_b32 v47, 0
    v_mov_b32 v48, 0
    v_mov_b32 v49, 0
    v_mov_b32 v50, 0
    v_mov_b32 v51, 0
    v_mov_b32 v52, 0
    v_mov_b32 v53, 0
    v_mov_b32 v54, 0
    v_mov_b32 v55, 0
    s_nop 15
    s_nop 8
    buffer_load_dwordx4 v[16:19], v1, s[4:7], s21 offen offset:0 sc1
    s_nop 7
    buffer_load_dwordx4 v[20:23], v1, s[4:7], s21 offen offset:1024 sc1
    s_nop 7
    buffer_load_dwordx4 v[24:27], v1, s[4:7], s21 offen offset:2048 sc1
    s_nop 7
    buffer_load_dwordx4 v[28:31], v1, s[4:7], s21 offen offset:3072 sc1
    s_waitcnt vmcnt(3)
    v_max3_u32 v9, v16, v17, v18
    v_max_u32 v9, v9, v19
    v_cmp_eq_u32 vcc, -1, v9
    s_cbranch_vccnz prm_10_0
prm_10_0ok:
    v_smfmac_f32_16x16x64_bf16 v[32:35], v[16:19], v[64:71], v62
    v_smfmac_f32_16x16x64_bf16 v[36:39], v[16:19], v[72:79], v62
    v_smfmac_f32_16x16x64_bf16 v[40:43], v[16:19], v[80:87], v62
    s_waitcnt vmcnt(2)
    v_max3_u32 v9, v20, v21, v22
    v_max_u32 v9, v9, v23
    v_cmp_eq_u32 vcc, -1, v9
    v_smfmac_f32_16x16x64_bf16 v[44:47], v[16:19], v[88:95], v62
    v_smfmac_f32_16x16x64_bf16 v[48:51], v[16:19], v[96:103], v62
    v_smfmac_f32_16x16x64_bf16 v[52:55], v[16:19], v[104:111], v62
    s_cbranch_vccnz prm_10_1
prm_10_1ok:
    v_smfmac_f32_16x16x64_bf16 v[32:35], v[20:23], v[112:119], v62
    v_readfirstlane_b32 s23, v15
    v_smfmac_f32_16x16x64_bf16 v[36:39], v[20:23], v[120:127], v62
    v_smfmac_f32_16x16x64_bf16 v[40:43], v[20:23], v[128:135], v62
    s_waitcnt vmcnt(1)
    v_max3_u32 v9, v24, v25, v26
    v_max_u32 v9, v9, v27
    v_cmp_eq_u32 vcc, -1, v9
    v_smfmac_f32_16x16x64_bf16 v[44:47], v[20:23], v[136:143], v62
    v_smfmac_f32_16x16x64_bf16 v[48:51], v[20:23], v[144:151], v62
    v_smfmac_f32_16x16x64_bf16 v[52:55], v[20:23], v[152:159], v62
    s_cbranch_vccnz prm_10_2
prm_10_2ok:
    v_smfmac_f32_16x16x64_bf16 v[32:35], v[24:27], v[160:167], v62
    v_smfmac_f32_16x16x64_bf16 v[36:39], v[24:27], v[168:175], v62
    v_smfmac_f32_16x16x64_bf16 v[40:43], v[24:27], v[176:183], v62
    s_waitcnt vmcnt(0)
    v_max3_u32 v9, v28, v29, v30
    v_max_u32 v9, v9, v31
    v_cmp_eq_u32 vcc, -1, v9
    v_smfmac_f32_16x16x64_bf16 v[44:47], v[24:27], v[184:191], v62
    v_smfmac_f32_16x16x64_bf16 v[48:51], v[24:27], v[192:199], v62
    v_smfmac_f32_16x16x64_bf16 v[52:55], v[24:27], v[200:207], v62
    s_cbranch_vccnz prm_10_3
prm_10_3ok:
    v_smfmac_f32_16x16x64_bf16 v[32:35], v[28:31], v[208:215], v62
    s_cmp_lt_u32 s23, s59
    s_cbranch_scc1 prm_10_gt
prm_10_gtb:
    ds_write_b32 v14, v60
    v_smfmac_f32_16x16x64_bf16 v[36:39], v[28:31], v[216:223], v62
    v_smfmac_f32_16x16x64_bf16 v[40:43], v[28:31], v[224:231], v62
    v_smfmac_f32_16x16x64_bf16 v[44:47], v[28:31], v[232:239], v62
    v_add_f32 v32, v32, v33
    v_add_f32 v34, v34, v35
    v_smfmac_f32_16x16x64_bf16 v[48:51], v[28:31], v[240:247], v62
    v_add_f32 v36, v36, v37
    v_add_f32 v38, v38, v39
    ds_write2_b32 v4, v32, v34 offset0:0 offset1:104
    v_smfmac_f32_16x16x64_bf16 v[52:55], v[28:31], v[248:255], v62
    v_add_f32 v40, v40, v41
    v_add_f32 v42, v42, v43
    ds_write2_b32 v4, v36, v38 offset0:16 offset1:120
    v_add_f32 v44, v44, v45
    v_add_f32 v46, v46, v47
    ds_write2_b32 v4, v40, v42 offset0:32 offset1:136
    v_add_f32 v48, v48, v49
    v_add_f32 v50, v50, v51
    ds_write2_b32 v4, v44, v46 offset0:48 offset1:152
    v_add_f32 v52, v52, v53
    v_add_f32 v54, v54, v55
    ds_write2_b32 v4, v48, v50 offset0:64 offset1:168
    ds_write2_b32 v4, v52, v54 offset0:80 offset1:184
    s_branch pnc_8_done
pnc_8:
    v_smfmac_f32_16x16x64_bf16 v[32:35], v[16:19], v[64:71], v62
    v_smfmac_f32_16x16x64_bf16 v[36:39], v[16:19], v[72:79], v62
    v_smfmac_f32_16x16x64_bf16 v[40:43], v[16:19], v[80:87], v62
    v_smfmac_f32_16x16x64_bf16 v[44:47], v[16:19], v[88:95], v62
    v_smfmac_f32_16x16x64_bf16 v[48:51], v[16:19], v[96:103], v62
    v_smfmac_f32_16x16x64_bf16 v[52:55], v[16:19], v[104:111], v62
    v_smfmac_f32_16x16x64_bf16 v[32:35], v[20:23], v[112:119], v62
    v_smfmac_f32_16x16x64_bf16 v[36:39], v[20:23], v[120:127], v62
    v_smfmac_f32_16x16x64_bf16 v[40:43], v[20:23], v[128:135], v62
    v_smfmac_f32_16x16x64_bf16 v[44:47], v[20:23], v[136:143], v62
    v_smfmac_f32_16x16x64_bf16 v[48:51], v[20:23], v[144:151], v62
    v_smfmac_f32_16x16x64_bf16 v[52:55], v[20:23], v[152:159], v62
    v_smfmac_f32_16x16x64_bf16 v[32:35], v[24:27], v[160:167], v62
    v_smfmac_f32_16x16x64_bf16 v[36:39], v[24:27], v[168:175], v62
    v_smfmac_f32_16x16x64_bf16 v[40:43], v[24:27], v[176:183], v62
    v_smfmac_f32_16x16x64_bf16 v[44:47], v[24:27], v[184:191], v62
    v_smfmac_f32_16x16x64_bf16 v[48:51], v[24:27], v[192:199], v62
    v_smfmac_f32_16x16x64_bf16 v[52:55], v[24:27], v[200:207], v62
    v_smfmac_f32_16x16x64_bf16 v[32:35], v[28:31], v[208:215], v62
    ds_write_b32 v14, v60
    v_smfmac_f32_16x16x64_bf16 v[36:39], v[28:31], v[216:223], v62
    v_smfmac_f32_16x16x64_bf16 v[40:43], v[28:31], v[224:231], v62
    v_smfmac_f32_16x16x64_bf16 v[44:47], v[28:31], v[232:239], v62
    v_add_f32 v32, v32, v33
    v_add_f32 v34, v34, v35
    v_smfmac_f32_16x16x64_bf16 v[48:51], v[28:31], v[240:247], v62
    v_add_f32 v36, v36, v37
    v_add_f32 v38, v38, v39
    ds_write2_b32 v4, v32, v34 offset0:0 offset1:104
    v_smfmac_f32_16x16x64_bf16 v[52:55], v[28:31], v[248:255], v62
    v_add_f32 v40, v40, v41
    v_add_f32 v42, v42, v43
    ds_write2_b32 v4, v36, v38 offset0:16 offset1:120
    v_add_f32 v44, v44, v45
    v_add_f32 v46, v46, v47
    ds_write2_b32 v4, v40, v42 offset0:32 offset1:136
    v_add_f32 v48, v48, v49
    v_add_f32 v50, v50, v51
    ds_write2_b32 v4, v44, v46 offset0:48 offset1:152
    v_add_f32 v52, v52, v53
    v_add_f32 v54, v54, v55
    ds_write2_b32 v4, v48, v50 offset0:64 offset1:168
    ds_write2_b32 v4, v52, v54 offset0:80 offset1:184
    s_waitcnt vmcnt(0)
pnc_8_done:
    s_add_u32 s21, s17, s32
    s_add_u32 s22, s19, s32
    s_add_u32 s24, s19, s35
    s_waitcnt lgkmcnt(0)
    s_barrier
    ds_read_b64 v[32:33], v5 offset:0
    ds_read_b64 v[34:35], v5 offset:3328
    ds_read_b64 v[36:37], v5 offset:6656
    ds_read_b64 v[38:39], v5 offset:9984
    ds_read_b64 v[40:41], v6 offset:0
    ds_read_b64 v[42:43], v6 offset:3328
    ds_read_b64 v[44:45], v6 offset:6656
    ds_read_b64 v[46:47], v6 offset:9984
    s_waitcnt lgkmcnt(6)
    v_add_f32 v32, v32, v34
    v_add_f32 v33, v33, v35
    s_waitcnt lgkmcnt(4)
    v_add_f32 v36, v36, v38
    v_add_f32 v37, v37, v39
    v_add_f32 v32, v32, v36
    v_add_f32 v33, v33, v37
    v_cvt_pk_bf16_f32 v32, v32, v33
    v_min_u32 v32, -2, v32
    buffer_store_dword v32, v2, s[4:7], s21 offen
    s_waitcnt lgkmcnt(2)
    v_add_f32 v40, v40, v42
    v_add_f32 v41, v41, v43
    s_waitcnt lgkmcnt(0)
    v_add_f32 v44, v44, v46
    v_add_f32 v45, v45, v47
    v_add_f32 v40, v40, v44
    v_add_f32 v41, v41, v45
    v_cvt_pk_bf16_f32 v40, v40, v41
    v_min_u32 v40, -2, v40
    s_mov_b32 exec_hi, 0
    buffer_store_dword v40, v3, s[4:7], s21 offen
    s_setprio 0
    s_add_u32 s23, s20, s36
    buffer_store_dword v10, v3, s[4:7], s22 offen
    s_mov_b32 exec_lo, 0x00ff00ff
    buffer_store_dwordx2 v[10:11], v13, s[4:7], s23 offen
    s_mov_b64 exec, -1
    buffer_store_dword v10, v2, s[4:7], s22 offen
    s_add_u32 s21, s17, s35
    s_add_u32 s30, s17, s34
    s_add_u32 s23, s18, s36
    s_add_u32 s25, s16, 2
    s_min_u32 s25, s25, 63
    s_cmp_lt_u32 s25, 8
    s_cselect_b32 s59, 12, 24
    s_cselect_b32 s58, -4, -8
    s_and_b32 s25, s25, s58
    s_lshl_b32 s25, s25, 5
    s_add_u32 s58, s25, s60
    s_cmp_eq_u32 s15, 0
    s_cbranch_scc1 ploop_7_nd
    v_add_u32 v9, s53, v1
    v_add_u32 v0, 124928, v1
    ds_read_b128 v[16:19], v0 offset:0
    ds_read_b128 v[32:35], v9 offset:0
    ds_read_b128 v[20:23], v0 offset:1024
    ds_read_b128 v[36:39], v9 offset:1024
    ds_read_b128 v[24:27], v0 offset:2048
    ds_read_b128 v[40:43], v9 offset:2048
    ds_read_b128 v[28:31], v0 offset:3072
    ds_read_b128 v[44:47], v9 offset:3072
    s_add_u32 s22, s17, s61
    s_waitcnt lgkmcnt(6)
    v_mfma_f32_16x16x32_bf16 v[48:51], v[32:35], v[16:19], 0
    ds_read_b128 v[32:35], v9 offset:4096
    s_waitcnt lgkmcnt(5)
    v_mfma_f32_16x16x32_bf16 v[48:51], v[36:39], v[20:23], v[48:51]
    ds_read_b128 v[36:39], v9 offset:5120
    s_waitcnt lgkmcnt(4)
    v_mfma_f32_16x16x32_bf16 v[48:51], v[40:43], v[24:27], v[48:51]
    ds_read_b128 v[40:43], v9 offset:6144
    s_waitcnt lgkmcnt(3)
    v_mfma_f32_16x16x32_bf16 v[48:51], v[44:47], v[28:31], v[48:51]
    ds_read_b128 v[44:47], v9 offset:7168
    s_waitcnt lgkmcnt(3)
    v_mfma_f32_16x16x32_bf16 v[52:55], v[32:35], v[16:19], 0
    s_waitcnt lgkmcnt(2)
    v_mfma_f32_16x16x32_bf16 v[52:55], v[36:39], v[20:23], v[52:55]
    s_waitcnt lgkmcnt(1)
    v_mfma_f32_16x16x32_bf16 v[52:55], v[40:43], v[24:27], v[52:55]
    s_waitcnt lgkmcnt(0)
    v_mfma_f32_16x16x32_bf16 v[52:55], v[44:47], v[28:31], v[52:55]
    buffer_load_dwordx4 v[32:35], v1, s[4:7], s22 offen offset:0 sc1
    buffer_load_dwordx4 v[36:39], v1, s[4:7], s22 offen offset:1024 sc1
    buffer_load_dwordx4 v[40:43], v1, s[4:7], s22 offen offset:2048 sc1
    buffer_load_dwordx4 v[44:47], v1, s[4:7], s22 offen offset:3072 sc1
    v_mov_b32 v60, 0xff61b1e6
    s_nop 2
    v_cndmask_b32 v48, v48, v60, s[38:39]
    v_cndmask_b32 v49, v49, v60, s[40:41]
    v_cndmask_b32 v50, v50, v60, s[42:43]
    v_cndmask_b32 v51, v51, v60, s[44:45]
    v_cndmask_b32 v52, v52, v60, s[48:49]
    v_cndmask_b32 v53, v53, v60, s[50:51]
    v_cndmask_b32 v54, v54, v60, s[54:55]
    v_cndmask_b32 v55, v55, v60, s[56:57]
    v_max3_f32 v0, v48, v49, v50
    v_max3_f32 v9, v51, v52, v53
    v_max3_f32 v0, v0, v54, v55
    v_max_f32 v0, v0, v9
    v_mov_b32 v9, v0
    s_nop 1
    v_permlane16_swap_b32 v9, v0
    v_max_f32 v0, v0, v9
    v_mov_b32 v9, v0
    s_nop 1
    v_permlane32_swap_b32 v9, v0
    v_max_f32 v0, v0, v9
    v_mul_f32 v0, s47, v0
    v_fma_f32 v48, v48, s47, -v0
    v_fma_f32 v49, v49, s47, -v0
    v_fma_f32 v50, v50, s47, -v0
    v_fma_f32 v51, v51, s47, -v0
    v_fma_f32 v52, v52, s47, -v0
    v_fma_f32 v53, v53, s47, -v0
    v_fma_f32 v54, v54, s47, -v0
    v_fma_f32 v55, v55, s47, -v0
    v_exp_f32 v48, v48
    v_exp_f32 v49, v49
    v_exp_f32 v50, v50
    v_exp_f32 v51, v51
    v_exp_f32 v52, v52
    v_exp_f32 v53, v53
    v_exp_f32 v54, v54
    v_exp_f32 v55, v55
    v_add_f32 v15, v48, v49
    v_add_f32 v15, v15, v50
    v_add_f32 v15, v15, v51
    v_add_f32 v15, v15, v52
    v_add_f32 v15, v15, v53
    v_add_f32 v15, v15, v54
    v_add_f32 v15, v15, v55
ploop_7_za:
    s_waitcnt vmcnt(0)
    v_max3_u32 v9, v32, v33, v34
    v_max3_u32 v9, v9, v35, v36
    v_max3_u32 v9, v9, v37, v38
    v_max3_u32 v9, v9, v39, v40
    v_max3_u32 v9, v9, v41, v42
    v_max3_u32 v9, v9, v43, v44
    v_max3_u32 v9, v9, v45, v46
    v_max_u32 v9, v9, v47
    v_cmp_eq_u32 vcc, -1, v9
    s_cbranch_vccnz ploop_7_zr
ploop_7_zok:
    v_mfma_f32_16x16x32_bf16 v[56:59], v[32:35], v[16:19], 0
    v_mfma_f32_16x16x32_bf16 v[56:59], v[36:39], v[20:23], v[56:59]
    v_mfma_f32_16x16x32_bf16 v[56:59], v[40:43], v[24:27], v[56:59]
    v_mfma_f32_16x16x32_bf16 v[56:59], v[44:47], v[28:31], v[56:59]
    s_nop 7
    v_max_f32 v60, v56, v57
    v_mov_b32 v9, v60
    s_nop 1
    v_permlane16_swap_b32 v9, v60
    v_max_f32 v60, v60, v9
    v_mov_b32 v9, v60
    s_nop 1
    v_permlane32_swap_b32 v9, v60
    v_max_f32 v60, v60, v9
    v_mul_f32 v60, s47, v60
    v_max_f32 v58, v60, v0
    v_sub_f32 v60, v0, v58
    v_fma_f32 v56, v56, s47, -v58
    v_fma_f32 v57, v57, s47, -v58
    v_exp_f32 v60, v60
    v_exp_f32 v56, v56
    v_exp_f32 v57, v57
    v_fma_f32 v15, v15, v60, v56
    v_add_f32 v15, v15, v57
    v_mov_b32 v9, v15
    s_nop 1
    v_permlane16_swap_b32 v9, v15
    v_add_f32 v15, v15, v9
    v_mov_b32 v9, v15
    s_nop 1
    v_permlane32_swap_b32 v9, v15
    v_add_f32 v15, v15, v9
    v_rcp_f32 v15, v15
    s_add_u32 s22, s17, s14
    s_add_u32 s25, s19, s14
    v_add_u32 v9, 14336, v1
    v_mul_f32 v60, v60, v15
    v_mul_f32 v56, v56, v15
    v_mul_f32 v57, v57, v15
    v_mul_f32 v48, v48, v60
    v_mul_f32 v49, v49, v60
    v_mul_f32 v50, v50, v60
    v_mul_f32 v51, v51, v60
    v_mul_f32 v52, v52, v60
    v_mul_f32 v53, v53, v60
    v_mul_f32 v54, v54, v60
    v_mul_f32 v55, v55, v60
    v_cvt_pk_bf16_f32 v48, v48, v49
    v_cvt_pk_bf16_f32 v49, v50, v51
    v_cvt_pk_bf16_f32 v50, v52, v53
    v_cvt_pk_bf16_f32 v51, v54, v55
    v_cvt_pk_bf16_f32 v52, v56, v57
    v_min_u32 v48, -2, v48
    v_min_u32 v49, -2, v49
    v_min_u32 v50, -2, v50
    v_min_u32 v51, -2, v51
    v_min_u32 v52, -2, v52
    buffer_store_dwordx4 v[48:51], v1, s[4:7], s22 offen
    buffer_store_dword v52, v8, s[4:7], s22 offen offset:1024
    ds_read_b128 v[56:59], v9
    s_branch ploop_7_nd2
ploop_7_nd:
ploop_7_flag:
    ds_read_b32 v9, v14 offset:16
    s_waitcnt lgkmcnt(0)
    v_readfirstlane_b32 s25, v9
    s_cmp_eq_u32 s25, s16
    s_cbranch_scc0 ploop_7_flag
    s_add_u32 m0, s53, 0
    s_add_u32 s22, s52, 0
    buffer_load_dwordx4 v1, s[4:7], s22 offen offset:0 sc1 lds
    buffer_load_dwordx4 v1, s[4:7], s22 offen offset:1024 sc1 lds
    buffer_load_dwordx4 v1, s[4:7], s22 offen offset:2048 sc1 lds
    buffer_load_dwordx4 v1, s[4:7], s22 offen offset:3072 sc1 lds
    s_add_u32 m0, s53, 4096
    s_add_u32 s22, s52, 131072
    buffer_load_dwordx4 v1, s[4:7], s22 offen offset:0 sc1 lds
    buffer_load_dwordx4 v1, s[4:7], s22 offen offset:1024 sc1 lds
    buffer_load_dwordx4 v1, s[4:7], s22 offen offset:2048 sc1 lds
    buffer_load_dwordx4 v1, s[4:7], s22 offen offset:3072 sc1 lds
    s_add_u32 s52, s52, 262144
ploop_7_nd2:
    s_cmp_lg_u32 s3, 2
    s_cbranch_scc1 ppf_12
    s_lshl_b32 s22, s16, 18
    s_mov_b32 exec_hi, 0xffff
    buffer_load_dword v0, v63, s[4:7], s22 offen sc1
    buffer_load_dword v0, v63, s[4:7], s22 offen offset:64 sc1
    s_mov_b32 exec_hi, -1
ppf_12:
    v_add_u32 v24, 18560, v7
    v_add_u32 v25, 37120, v7
    v_add_u32 v26, 55680, v7
    s_cmp_eq_u32 s16, 63
    s_setprio 3
    s_barrier
    s_cbranch_scc1 ptail_9
    ds_read2_b32 v[16:17], v7 offset0:0 offset1:2
    ds_read2_b32 v[18:19], v24 offset0:0 offset1:2
    ds_read2_b32 v[20:21], v25 offset0:0 offset1:2
    ds_read2_b32 v[22:23], v26 offset0:0 offset1:2
    s_waitcnt lgkmcnt(2)
    v_add_f32 v16, v16, v18
    v_add_f32 v17, v17, v19
    s_waitcnt lgkmcnt(0)
    v_add_f32 v20, v20, v22
    v_add_f32 v21, v21, v23
    v_add_f32 v16, v16, v20
    v_add_f32 v17, v17, v21
    v_cvt_pk_bf16_f32 v16, v16, v17
    v_min_u32 v16, -2, v16
    buffer_store_dword v16, v2, s[4:7], s21 offen sc1
    buffer_store_dword v10, v2, s[4:7], s24 offen sc1
    s_cmp_eq_u32 s15, 0
    s_cbranch_scc1 ploop_7_pnd
    s_sleep 6
    s_nop 8
    buffer_load_dwordx4 v[16:19], v12, s[4:7], s30 offen sc1
    buffer_load_dword v15, off, s[4:7], s58 sc1
    v_mov_b32 v20, -1
    v_mov_b32 v21, -1
    v_mov_b32 v22, -1
    v_mov_b32 v23, -1
    buffer_store_dwordx4 v[20:23], v1, s[4:7], s25 offen
    buffer_store_dword v20, v8, s[4:7], s25 offen offset:1024
    s_mov_b32 m0, 124928
    s_nop 0
    buffer_load_dwordx4 v1, s[4:7], s69 offen offset:0 sc1 lds
    buffer_load_dwordx4 v1, s[4:7], s69 offen offset:1024 sc1 lds
    buffer_load_dwordx4 v1, s[4:7], s69 offen offset:2048 sc1 lds
    buffer_load_dwordx4 v1, s[4:7], s69 offen offset:3072 sc1 lds
    s_add_u32 s69, s69, 262144
    s_add_u32 m0, s53, 0
    s_add_u32 s22, s52, 0
    buffer_load_dwordx4 v1, s[4:7], s22 offen offset:0 sc1 lds
    buffer_load_dwordx4 v1, s[4:7], s22 offen offset:1024 sc1 lds
    buffer_load_dwordx4 v1, s[4:7], s22 offen offset:2048 sc1 lds
    buffer_load_dwordx4 v1, s[4:7], s22 offen offset:3072 sc1 lds
    s_add_u32 m0, s53, 4096
    s_add_u32 s22, s52, 131072
    buffer_load_dwordx4 v1, s[4:7], s22 offen offset:0 sc1 lds
    buffer_load_dwordx4 v1, s[4:7], s22 offen offset:1024 sc1 lds
    buffer_load_dwordx4 v1, s[4:7], s22 offen offset:2048 sc1 lds
    buffer_load_dwordx4 v1, s[4:7], s22 offen offset:3072 sc1 lds
    s_add_u32 s52, s52, 262144
    s_add_u32 s22, s16, 1
    v_mov_b32 v60, s22
    s_cmp_eq_u32 s16, 0
    s_cbranch_scc1 ploop_7_pagain
    v_add_u32 v55, s68, v61
    s_xor_b32 s68, s68, 8192
    ds_read_b128 v[24:27], v55 offset:0
    ds_read_b128 v[28:31], v55 offset:1024
    ds_read_b128 v[32:35], v55 offset:18560
    ds_read_b128 v[36:39], v55 offset:19584
    ds_read_b128 v[40:43], v55 offset:37120
    ds_read_b128 v[44:47], v55 offset:38144
    ds_read_b128 v[48:51], v55 offset:55680
    ds_read_b128 v[52:55], v55 offset:56704
    s_waitcnt lgkmcnt(4)
    v_add_f32 v24, v24, v32
    v_add_f32 v25, v25, v33
    v_add_f32 v26, v26, v34
    v_add_f32 v27, v27, v35
    v_add_f32 v28, v28, v36
    v_add_f32 v29, v29, v37
    v_add_f32 v30, v30, v38
    v_add_f32 v31, v31, v39
    s_waitcnt lgkmcnt(0)
    v_add_f32 v40, v40, v48
    v_add_f32 v41, v41, v49
    v_add_f32 v42, v42, v50
    v_add_f32 v43, v43, v51
    v_add_f32 v44, v44, v52
    v_add_f32 v45, v45, v53
    v_add_f32 v46, v46, v54
    v_add_f32 v47, v47, v55
    v_add_f32 v24, v24, v40
    v_add_f32 v25, v25, v41
    v_add_f32 v26, v26, v42
    v_add_f32 v27, v27, v43
    v_add_f32 v28, v28, v44
    v_add_f32 v29, v29, v45
    v_add_f32 v30, v30, v46
    v_add_f32 v31, v31, v47
    v_cvt_pk_bf16_f32 v24, v24, v25
    v_cvt_pk_bf16_f32 v25, v26, v27
    v_cvt_pk_bf16_f32 v26, v28, v29
    v_cvt_pk_bf16_f32 v27, v30, v31
    v_min_u32 v24, -2, v24
    v_min_u32 v25, -2, v25
    v_min_u32 v26, -2, v26
    v_min_u32 v27, -2, v27
    buffer_store_dwordx4 v[24:27], v1, s[4:7], s37 offen sc1
    s_add_u32 s37, s37, 65536
    s_waitcnt vmcnt(16) lgkmcnt(0)
    s_branch ploop_7_pchk
ploop_7_pnd:
    s_sleep 6
    s_nop 8
    buffer_load_dwordx4 v[16:19], v12, s[4:7], s30 offen sc1
    buffer_load_dword v15, off, s[4:7], s58 sc1
    s_add_u32 s22, s16, 1
    v_mov_b32 v60, s22
    s_cmp_eq_u32 s16, 0
    s_cbranch_scc1 ploop_7_pagain
    v_add_u32 v55, s68, v61
    s_xor_b32 s68, s68, 8192
    ds_read_b128 v[24:27], v55 offset:0
    ds_read_b128 v[28:31], v55 offset:1024
    ds_read_b128 v[32:35], v55 offset:18560
    ds_read_b128 v[36:39], v55 offset:19584
    ds_read_b128 v[40:43], v55 offset:37120
    ds_read_b128 v[44:47], v55 offset:38144
    ds_read_b128 v[48:51], v55 offset:55680
    ds_read_b128 v[52:55], v55 offset:56704
    s_waitcnt lgkmcnt(4)
    v_add_f32 v24, v24, v32
    v_add_f32 v25, v25, v33
    v_add_f32 v26, v26, v34
    v_add_f32 v27, v27, v35
    v_add_f32 v28, v28, v36
    v_add_f32 v29, v29, v37
    v_add_f32 v30, v30, v38
    v_add_f32 v31, v31, v39
    s_waitcnt lgkmcnt(0)
    v_add_f32 v40, v40, v48
    v_add_f32 v41, v41, v49
    v_add_f32 v42, v42, v50
    v_add_f32 v43, v43, v51
    v_add_f32 v44, v44, v52
    v_add_f32 v45, v45, v53
    v_add_f32 v46, v46, v54
    v_add_f32 v47, v47, v55
    v_add_f32 v24, v24, v40
    v_add_f32 v25, v25, v41
    v_add_f32 v26, v26, v42
    v_add_f32 v27, v27, v43
    v_add_f32 v28, v28, v44
    v_add_f32 v29, v29, v45
    v_add_f32 v30, v30, v46
    v_add_f32 v31, v31, v47
    v_cvt_pk_bf16_f32 v24, v24, v25
    v_cvt_pk_bf16_f32 v25, v26, v27
    v_cvt_pk_bf16_f32 v26, v28, v29
    v_cvt_pk_bf16_f32 v27, v30, v31
    v_min_u32 v24, -2, v24
    v_min_u32 v25, -2, v25
    v_min_u32 v26, -2, v26
    v_min_u32 v27, -2, v27
    buffer_store_dwordx4 v[24:27], v1, s[4:7], s37 offen sc1
    s_add_u32 s37, s37, 65536
    s_waitcnt vmcnt(2) lgkmcnt(0)
    s_branch ploop_7_pchk
ploop_7_pagain:
    s_waitcnt vmcnt(1) lgkmcnt(0)
ploop_7_pchk:
    v_mfma_f32_16x16x32_bf16 v[20:23], v[56:59], v[16:19], 0
    v_max3_u32 v9, v16, v17, v18
    v_max_u32 v9, v9, v19
    v_cmp_eq_u32 vcc, -1, v9
    s_cbranch_vccnz prp_11
ploop_7_pgo:
    s_nop 3
    v_add_f32_dpp v20, v20, v20 row_ror:8 row_mask:0xf bank_mask:0xf
    v_add_f32_dpp v21, v21, v21 row_ror:8 row_mask:0xf bank_mask:0xf
    v_add_f32_dpp v22, v22, v22 row_ror:8 row_mask:0xf bank_mask:0xf
    v_add_f32_dpp v23, v23, v23 row_ror:8 row_mask:0xf bank_mask:0xf
    v_cvt_pk_bf16_f32 v20, v20, v21
    v_cvt_pk_bf16_f32 v21, v22, v23
    s_mov_b32 exec_hi, 0
    v_min_u32 v20, -2, v20
    v_min_u32 v21, -2, v21
    s_mov_b32 exec_lo, 0x00ff00ff
    buffer_store_dwordx2 v[20:21], v13, s[4:7], s23 offen
    s_mov_b64 exec, -1
    s_add_u32 s16, s16, 1
    s_mov_b32 s17, s18
    s_mov_b32 s18, s19
    s_mov_b32 s19, s20
    s_add_u32 s20, s20, 262144
    s_cmp_eq_u32 s20, 210763776
    s_cselect_b32 s20, 209715200, s20
    s_branch ploop_7
prm_10_gt:
gate_13:
    v_readfirstlane_b32 s25, v15
    s_cmp_ge_u32 s25, s59
    s_cbranch_scc1 gate_13_ok
    s_sleep 8
    buffer_load_dword v15, off, s[4:7], s58 sc1
    s_waitcnt vmcnt(0)
    s_sub_u32 s26, s26, 1
    s_cbranch_scc0 gate_13
    s_mov_b32 s26, 0
gate_13_ok:
    s_branch prm_10_gtb
prm_10_0:
    s_sub_u32 s26, s26, 1
    s_cbranch_scc1 prm_10_0_g
    buffer_load_dwordx4 v[16:19], v1, s[4:7], s21 offen offset:0 sc1
    buffer_load_dwordx4 v[20:23], v1, s[4:7], s21 offen offset:1024 sc1
    buffer_load_dwordx4 v[24:27], v1, s[4:7], s21 offen offset:2048 sc1
    buffer_load_dwordx4 v[28:31], v1, s[4:7], s21 offen offset:3072 sc1
    s_waitcnt vmcnt(3)
    v_max3_u32 v9, v16, v17, v18
    v_max_u32 v9, v9, v19
    v_cmp_eq_u32 vcc, -1, v9
    s_cbranch_vccnz prm_10_0
    s_branch prm_10_0ok
prm_10_0_g:
    s_mov_b32 s26, 0
    s_waitcnt vmcnt(0)
    s_branch prm_10_0ok
prm_10_1:
    s_sub_u32 s26, s26, 1
    s_cbranch_scc1 prm_10_1_g
    buffer_load_dwordx4 v[20:23], v1, s[4:7], s21 offen offset:1024 sc1
    buffer_load_dwordx4 v[24:27], v1, s[4:7], s21 offen offset:2048 sc1
    buffer_load_dwordx4 v[28:31], v1, s[4:7], s21 offen offset:3072 sc1
    s_waitcnt vmcnt(2)
    v_max3_u32 v9, v20, v21, v22
    v_max_u32 v9, v9, v23
    v_cmp_eq_u32 vcc, -1, v9
    s_cbranch_vccnz prm_10_1
    s_branch prm_10_1ok
prm_10_1_g:
    s_mov_b32 s26, 0
    s_waitcnt vmcnt(0)
    s_branch prm_10_1ok
prm_10_2:
    s_sub_u32 s26, s26, 1
    s_cbranch_scc1 prm_10_2_g
    buffer_load_dwordx4 v[24:27], v1, s[4:7], s21 offen offset:2048 sc1
    buffer_load_dwordx4 v[28:31], v1, s[4:7], s21 offen offset:3072 sc1
    s_waitcnt vmcnt(1)
    v_max3_u32 v9, v24, v25, v26
    v_max_u32 v9, v9, v27
    v_cmp_eq_u32 vcc, -1, v9
    s_cbranch_vccnz prm_10_2
    s_branch prm_10_2ok
prm_10_2_g:
    s_mov_b32 s26, 0
    s_waitcnt vmcnt(0)
    s_branch prm_10_2ok
prm_10_3:
    s_sub_u32 s26, s26, 1
    s_cbranch_scc1 prm_10_3_g
    buffer_load_dwordx4 v[28:31], v1, s[4:7], s21 offen offset:3072 sc1
    s_waitcnt vmcnt(0)
    v_max3_u32 v9, v28, v29, v30
    v_max_u32 v9, v9, v31
    v_cmp_eq_u32 vcc, -1, v9
    s_cbranch_vccnz prm_10_3
    s_branch prm_10_3ok
prm_10_3_g:
    s_mov_b32 s26, 0
    s_waitcnt vmcnt(0)
    s_branch prm_10_3ok
prm_10_d:
gate_14:
    v_readfirstlane_b32 s25, v15
    s_cmp_ge_u32 s25, s59
    s_cbranch_scc1 gate_14_ok
    s_sleep 8
    buffer_load_dword v15, off, s[4:7], s58 sc1
    s_waitcnt vmcnt(0)
    s_sub_u32 s26, s26, 1
    s_cbranch_scc0 gate_14
    s_mov_b32 s26, 0
gate_14_ok:
    ds_write_b32 v14, v60
    v_add_f32 v32, v32, v33
    v_add_f32 v34, v34, v35
    ds_write2_b32 v4, v32, v34 offset0:0 offset1:104
    v_add_f32 v36, v36, v37
    v_add_f32 v38, v38, v39
    ds_write2_b32 v4, v36, v38 offset0:16 offset1:120
    v_add_f32 v40, v40, v41
    v_add_f32 v42, v42, v43
    ds_write2_b32 v4, v40, v42 offset0:32 offset1:136
    v_add_f32 v44, v44, v45
    v_add_f32 v46, v46, v47
    ds_write2_b32 v4, v44, v46 offset0:48 offset1:152
    v_add_f32 v48, v48, v49
    v_add_f32 v50, v50, v51
    ds_write2_b32 v4, v48, v50 offset0:64 offset1:168
    v_add_f32 v52, v52, v53
    v_add_f32 v54, v54, v55
    ds_write2_b32 v4, v52, v54 offset0:80 offset1:184
    s_branch pnc_8_done
prp_11:
    s_sub_u32 s26, s26, 1
    s_nop 3
    s_cbranch_scc1 prp_11_g
    buffer_load_dwordx4 v[16:19], v12, s[4:7], s30 offen sc1
    buffer_load_dword v15, off, s[4:7], s58 sc1
    s_branch ploop_7_pagain
prp_11_g:
    s_mov_b32 s26, 0
    s_branch ploop_7_pgo
ploop_7_zr:
    s_sub_u32 s26, s26, 1
    s_cbranch_scc1 ploop_7_zg
    buffer_load_dwordx4 v[32:35], v1, s[4:7], s22 offen offset:0 sc1
    buffer_load_dwordx4 v[36:39], v1, s[4:7], s22 offen offset:1024 sc1
    buffer_load_dwordx4 v[40:43], v1, s[4:7], s22 offen offset:2048 sc1
    buffer_load_dwordx4 v[44:47], v1, s[4:7], s22 offen offset:3072 sc1
    s_branch ploop_7_za
ploop_7_zg:
    s_mov_b32 s26, 0
    s_branch ploop_7_zok
ptail_9:
    s_cmp_eq_u32 s15, 0
    s_cbranch_scc1 ptail_9_nd
    s_nop 0
ptail_9_nd:
    v_add_u32 v55, s68, v61
    s_xor_b32 s68, s68, 8192
    ds_read_b128 v[24:27], v55 offset:0
    ds_read_b128 v[28:31], v55 offset:1024
    ds_read_b128 v[32:35], v55 offset:18560
    ds_read_b128 v[36:39], v55 offset:19584
    ds_read_b128 v[40:43], v55 offset:37120
    ds_read_b128 v[44:47], v55 offset:38144
    ds_read_b128 v[48:51], v55 offset:55680
    ds_read_b128 v[52:55], v55 offset:56704
    s_waitcnt lgkmcnt(4)
    v_add_f32 v24, v24, v32
    v_add_f32 v25, v25, v33
    v_add_f32 v26, v26, v34
    v_add_f32 v27, v27, v35
    v_add_f32 v28, v28, v36
    v_add_f32 v29, v29, v37
    v_add_f32 v30, v30, v38
    v_add_f32 v31, v31, v39
    s_waitcnt lgkmcnt(0)
    v_add_f32 v40, v40, v48
    v_add_f32 v41, v41, v49
    v_add_f32 v42, v42, v50
    v_add_f32 v43, v43, v51
    v_add_f32 v44, v44, v52
    v_add_f32 v45, v45, v53
    v_add_f32 v46, v46, v54
    v_add_f32 v47, v47, v55
    v_add_f32 v24, v24, v40
    v_add_f32 v25, v25, v41
    v_add_f32 v26, v26, v42
    v_add_f32 v27, v27, v43
    v_add_f32 v28, v28, v44
    v_add_f32 v29, v29, v45
    v_add_f32 v30, v30, v46
    v_add_f32 v31, v31, v47
    v_cvt_pk_bf16_f32 v24, v24, v25
    v_cvt_pk_bf16_f32 v25, v26, v27
    v_cvt_pk_bf16_f32 v26, v28, v29
    v_cvt_pk_bf16_f32 v27, v30, v31
    v_min_u32 v24, -2, v24
    v_min_u32 v25, -2, v25
    v_min_u32 v26, -2, v26
    v_min_u32 v27, -2, v27
    buffer_store_dwordx4 v[24:27], v1, s[4:7], s37 offen sc1
    s_add_u32 s37, s37, 65536
    s_barrier
    s_nop 0
    v_add_u32 v55, s68, v61
    s_xor_b32 s68, s68, 8192
    ds_read_b128 v[24:27], v55 offset:0
    ds_read_b128 v[28:31], v55 offset:1024
    ds_read_b128 v[32:35], v55 offset:18560
    ds_read_b128 v[36:39], v55 offset:19584
    ds_read_b128 v[40:43], v55 offset:37120
    ds_read_b128 v[44:47], v55 offset:38144
    ds_read_b128 v[48:51], v55 offset:55680
    ds_read_b128 v[52:55], v55 offset:56704
    s_waitcnt lgkmcnt(4)
    v_add_f32 v24, v24, v32
    v_add_f32 v25, v25, v33
    v_add_f32 v26, v26, v34
    v_add_f32 v27, v27, v35
    v_add_f32 v28, v28, v36
    v_add_f32 v29, v29, v37
    v_add_f32 v30, v30, v38
    v_add_f32 v31, v31, v39
    s_waitcnt lgkmcnt(0)
    v_add_f32 v40, v40, v48
    v_add_f32 v41, v41, v49
    v_add_f32 v42, v42, v50
    v_add_f32 v43, v43, v51
    v_add_f32 v44, v44, v52
    v_add_f32 v45, v45, v53
    v_add_f32 v46, v46, v54
    v_add_f32 v47, v47, v55
    v_add_f32 v24, v24, v40
    v_add_f32 v25, v25, v41
    v_add_f32 v26, v26, v42
    v_add_f32 v27, v27, v43
    v_add_f32 v28, v28, v44
    v_add_f32 v29, v29, v45
    v_add_f32 v30, v30, v46
    v_add_f32 v31, v31, v47
    v_cvt_pk_bf16_f32 v24, v24, v25
    v_cvt_pk_bf16_f32 v25, v26, v27
    v_cvt_pk_bf16_f32 v26, v28, v29
    v_cvt_pk_bf16_f32 v27, v30, v31
    v_min_u32 v24, -2, v24
    v_min_u32 v25, -2, v25
    v_min_u32 v26, -2, v26
    v_min_u32 v27, -2, v27
    buffer_store_dwordx4 v[24:27], v1, s[4:7], s37 offen sc1
    s_add_u32 s37, s37, 65536
    s_branch k_end
ch_p_slow:
    v_mov_b32 v32, 0
    v_mov_b32 v33, 0
    v_mov_b32 v34, 0
    v_mov_b32 v35, 0
    v_mov_b32 v36, 0
    v_mov_b32 v37, 0
    v_mov_b32 v38, 0
    v_mov_b32 v39, 0
    v_mov_b32 v40, 0
    v_mov_b32 v41, 0
    v_mov_b32 v42, 0
    v_mov_b32 v43, 0
    v_mov_b32 v44, 0
    v_mov_b32 v45, 0
    v_mov_b32 v46, 0
    v_mov_b32 v47, 0
    v_mov_b32 v48, 0
    v_mov_b32 v49, 0
    v_mov_b32 v50, 0
    v_mov_b32 v51, 0
    v_mov_b32 v52, 0
    v_mov_b32 v53, 0
    v_mov_b32 v54, 0
    v_mov_b32 v55, 0
    s_mov_b32 s31, 0
    v_mov_b32 v60, s16
    s_branch pnc_16
.p2align 6
ploop_15:
    s_add_u32 s21, s17, s33
    v_mov_b32 v32, 0
    v_mov_b32 v33, 0
    v_mov_b32 v34, 0
    v_mov_b32 v35, 0
    v_mov_b32 v36, 0
    v_mov_b32 v37, 0
    v_mov_b32 v38, 0
    v_mov_b32 v39, 0
    v_mov_b32 v40, 0
    v_mov_b32 v41, 0
    v_mov_b32 v42, 0
    v_mov_b32 v43, 0
    v_mov_b32 v44, 0
    v_mov_b32 v45, 0
    v_mov_b32 v46, 0
    v_mov_b32 v47, 0
    v_mov_b32 v48, 0
    v_mov_b32 v49, 0
    v_mov_b32 v50, 0
    v_mov_b32 v51, 0
    v_mov_b32 v52, 0
    v_mov_b32 v53, 0
    v_mov_b32 v54, 0
    v_mov_b32 v55, 0
    s_nop 15
    s_nop 8
    buffer_load_dwordx4 v[16:19], v1, s[4:7], s21 offen offset:0 sc1
    s_nop 7
    buffer_load_dwordx4 v[20:23], v1, s[4:7], s21 offen offset:1024 sc1
    s_nop 7
    buffer_load_dwordx4 v[24:27], v1, s[4:7], s21 offen offset:2048 sc1
    s_nop 7
    buffer_load_dwordx4 v[28:31], v1, s[4:7], s21 offen offset:3072 sc1
    s_waitcnt vmcnt(3)
    v_max3_u32 v9, v16, v17, v18
    v_max_u32 v9, v9, v19
    v_cmp_eq_u32 vcc, -1, v9
    s_cbranch_vccnz prm_18_0
prm_18_0ok:
    v_smfmac_f32_16x16x64_bf16 v[32:35], v[16:19], v[64:71], v62
    v_smfmac_f32_16x16x64_bf16 v[36:39], v[16:19], v[72:79], v62
    v_smfmac_f32_16x16x64_bf16 v[40:43], v[16:19], v[80:87], v62
    s_waitcnt vmcnt(2)
    v_max3_u32 v9, v20, v21, v22
    v_max_u32 v9, v9, v23
    v_cmp_eq_u32 vcc, -1, v9
    v_smfmac_f32_16x16x64_bf16 v[44:47], v[16:19], v[88:95], v62
    v_smfmac_f32_16x16x64_bf16 v[48:51], v[16:19], v[96:103], v62
    v_smfmac_f32_16x16x64_bf16 v[52:55], v[16:19], v[104:111], v62
    s_cbranch_vccnz prm_18_1
prm_18_1ok:
    v_smfmac_f32_16x16x64_bf16 v[32:35], v[20:23], v[112:119], v62
    v_readfirstlane_b32 s23, v15
    v_smfmac_f32_16x16x64_bf16 v[36:39], v[20:23], v[120:127], v62
    v_smfmac_f32_16x16x64_bf16 v[40:43], v[20:23], v[128:135], v62
    s_waitcnt vmcnt(1)
    v_max3_u32 v9, v24, v25, v26
    v_max_u32 v9, v9, v27
    v_cmp_eq_u32 vcc, -1, v9
    v_smfmac_f32_16x16x64_bf16 v[44:47], v[20:23], v[136:143], v62
    v_smfmac_f32_16x16x64_bf16 v[48:51], v[20:23], v[144:151], v62
    v_smfmac_f32_16x16x64_bf16 v[52:55], v[20:23], v[152:159], v62
    s_cbranch_vccnz prm_18_2
prm_18_2ok:
    v_smfmac_f32_16x16x64_bf16 v[32:35], v[24:27], v[160:167], v62
    v_smfmac_f32_16x16x64_bf16 v[36:39], v[24:27], v[168:175], v62
    v_smfmac_f32_16x16x64_bf16 v[40:43], v[24:27], v[176:183], v62
    s_waitcnt vmcnt(0)
    v_max3_u32 v9, v28, v29, v30
    v_max_u32 v9, v9, v31
    v_cmp_eq_u32 vcc, -1, v9
    v_smfmac_f32_16x16x64_bf16 v[44:47], v[24:27], v[184:191], v62
    v_smfmac_f32_16x16x64_bf16 v[48:51], v[24:27], v[192:199], v62
    v_smfmac_f32_16x16x64_bf16 v[52:55], v[24:27], v[200:207], v62
    s_cbranch_vccnz prm_18_3
prm_18_3ok:
    v_smfmac_f32_16x16x64_bf16 v[32:35], v[28:31], v[208:215], v62
    s_cmp_lt_u32 s23, s59
    s_cbranch_scc1 prm_18_gt
prm_18_gtb:
    ds_write_b32 v14, v60
    v_smfmac_f32_16x16x64_bf16 v[36:39], v[28:31], v[216:223], v62
    v_smfmac_f32_16x16x64_bf16 v[40:43], v[28:31], v[224:231], v62
    v_smfmac_f32_16x16x64_bf16 v[44:47], v[28:31], v[232:239], v62
    v_add_f32 v32, v32, v33
    v_add_f32 v34, v34, v35
    v_smfmac_f32_16x16x64_bf16 v[48:51], v[28:31], v[240:247], v62
    v_add_f32 v36, v36, v37
    v_add_f32 v38, v38, v39
    ds_write2_b32 v4, v32, v34 offset0:0 offset1:104
    v_smfmac_f32_16x16x64_bf16 v[52:55], v[28:31], v[248:255], v62
    v_add_f32 v40, v40, v41
    v_add_f32 v42, v42, v43
    ds_write2_b32 v4, v36, v38 offset0:16 offset1:120
    v_add_f32 v44, v44, v45
    v_add_f32 v46, v46, v47
    ds_write2_b32 v4, v40, v42 offset0:32 offset1:136
    v_add_f32 v48, v48, v49
    v_add_f32 v50, v50, v51
    ds_write2_b32 v4, v44, v46 offset0:48 offset1:152
    v_add_f32 v52, v52, v53
    v_add_f32 v54, v54, v55
    ds_write2_b32 v4, v48, v50 offset0:64 offset1:168
    ds_write2_b32 v4, v52, v54 offset0:80 offset1:184
    s_branch pnc_16_done
pnc_16:
    v_smfmac_f32_16x16x64_bf16 v[32:35], v[16:19], v[64:71], v62
    v_smfmac_f32_16x16x64_bf16 v[36:39], v[16:19], v[72:79], v62
    v_smfmac_f32_16x16x64_bf16 v[40:43], v[16:19], v[80:87], v62
    v_smfmac_f32_16x16x64_bf16 v[44:47], v[16:19], v[88:95], v62
    v_smfmac_f32_16x16x64_bf16 v[48:51], v[16:19], v[96:103], v62
    v_smfmac_f32_16x16x64_bf16 v[52:55], v[16:19], v[104:111], v62
    v_smfmac_f32_16x16x64_bf16 v[32:35], v[20:23], v[112:119], v62
    v_smfmac_f32_16x16x64_bf16 v[36:39], v[20:23], v[120:127], v62
    v_smfmac_f32_16x16x64_bf16 v[40:43], v[20:23], v[128:135], v62
    v_smfmac_f32_16x16x64_bf16 v[44:47], v[20:23], v[136:143], v62
    v_smfmac_f32_16x16x64_bf16 v[48:51], v[20:23], v[144:151], v62
    v_smfmac_f32_16x16x64_bf16 v[52:55], v[20:23], v[152:159], v62
    v_smfmac_f32_16x16x64_bf16 v[32:35], v[24:27], v[160:167], v62
    v_smfmac_f32_16x16x64_bf16 v[36:39], v[24:27], v[168:175], v62
    v_smfmac_f32_16x16x64_bf16 v[40:43], v[24:27], v[176:183], v62
    v_smfmac_f32_16x16x64_bf16 v[44:47], v[24:27], v[184:191], v62
    v_smfmac_f32_16x16x64_bf16 v[48:51], v[24:27], v[192:199], v62
    v_smfmac_f32_16x16x64_bf16 v[52:55], v[24:27], v[200:207], v62
    v_smfmac_f32_16x16x64_bf16 v[32:35], v[28:31], v[208:215], v62
    ds_write_b32 v14, v60
    v_smfmac_f32_16x16x64_bf16 v[36:39], v[28:31], v[216:223], v62
    v_smfmac_f32_16x16x64_bf16 v[40:43], v[28:31], v[224:231], v62
    v_smfmac_f32_16x16x64_bf16 v[44:47], v[28:31], v[232:239], v62
    v_add_f32 v32, v32, v33
    v_add_f32 v34, v34, v35
    v_smfmac_f32_16x16x64_bf16 v[48:51], v[28:31], v[240:247], v62
    v_add_f32 v36, v36, v37
    v_add_f32 v38, v38, v39
    ds_write2_b32 v4, v32, v34 offset0:0 offset1:104
    v_smfmac_f32_16x16x64_bf16 v[52:55], v[28:31], v[248:255], v62
    v_add_f32 v40, v40, v41
    v_add_f32 v42, v42, v43
    ds_write2_b32 v4, v36, v38 offset0:16 offset1:120
    v_add_f32 v44, v44, v45
    v_add_f32 v46, v46, v47
    ds_write2_b32 v4, v40, v42 offset0:32 offset1:136
    v_add_f32 v48, v48, v49
    v_add_f32 v50, v50, v51
    ds_write2_b32 v4, v44, v46 offset0:48 offset1:152
    v_add_f32 v52, v52, v53
    v_add_f32 v54, v54, v55
    ds_write2_b32 v4, v48, v50 offset0:64 offset1:168
    ds_write2_b32 v4, v52, v54 offset0:80 offset1:184
    s_waitcnt vmcnt(0)
pnc_16_done:
    s_add_u32 s21, s17, s32
    s_add_u32 s22, s19, s32
    s_add_u32 s24, s19, s35
    s_waitcnt lgkmcnt(0)
    s_barrier
    ds_read_b64 v[32:33], v5 offset:0
    ds_read_b64 v[34:35], v5 offset:3328
    ds_read_b64 v[36:37], v5 offset:6656
    ds_read_b64 v[38:39], v5 offset:9984
    ds_read_b64 v[40:41], v6 offset:0
    ds_read_b64 v[42:43], v6 offset:3328
    ds_read_b64 v[44:45], v6 offset:6656
    ds_read_b64 v[46:47], v6 offset:9984
    s_waitcnt lgkmcnt(6)
    v_add_f32 v32, v32, v34
    v_add_f32 v33, v33, v35
    s_waitcnt lgkmcnt(4)
    v_add_f32 v36, v36, v38
    v_add_f32 v37, v37, v39
    v_add_f32 v32, v32, v36
    v_add_f32 v33, v33, v37
    v_cvt_pk_bf16_f32 v32, v32, v33
    v_min_u32 v32, -2, v32
    buffer_store_dword v32, v2, s[4:7], s21 offen sc1
    s_waitcnt lgkmcnt(2)
    v_add_f32 v40, v40, v42
    v_add_f32 v41, v41, v43
    s_waitcnt lgkmcnt(0)
    v_add_f32 v44, v44, v46
    v_add_f32 v45, v45, v47
    v_add_f32 v40, v40, v44
    v_add_f32 v41, v41, v45
    v_cvt_pk_bf16_f32 v40, v40, v41
    v_min_u32 v40, -2, v40
    s_mov_b32 exec_hi, 0
    buffer_store_dword v40, v3, s[4:7], s21 offen sc1
    s_setprio 0
    s_add_u32 s23, s20, s36
    buffer_store_dword v10, v3, s[4:7], s22 offen sc1
    s_mov_b32 exec_lo, 0x00ff00ff
    buffer_store_dwordx2 v[10:11], v13, s[4:7], s23 offen sc1
    s_mov_b64 exec, -1
    buffer_store_dword v10, v2, s[4:7], s22 offen sc1
    s_add_u32 s21, s17, s35
    s_add_u32 s30, s17, s34
    s_add_u32 s23, s18, s36
    s_add_u32 s25, s16, 2
    s_min_u32 s25, s25, 63
    s_cmp_lt_u32 s25, 8
    s_cselect_b32 s59, 12, 24
    s_cselect_b32 s58, -4, -8
    s_and_b32 s25, s25, s58
    s_lshl_b32 s25, s25, 5
    s_add_u32 s58, s25, s60
    s_cmp_eq_u32 s15, 0
    s_cbranch_scc1 ploop_15_nd
    v_add_u32 v9, s53, v1
    v_add_u32 v0, 124928, v1
    ds_read_b128 v[16:19], v0 offset:0
    ds_read_b128 v[32:35], v9 offset:0
    ds_read_b128 v[20:23], v0 offset:1024
    ds_read_b128 v[36:39], v9 offset:1024
    ds_read_b128 v[24:27], v0 offset:2048
    ds_read_b128 v[40:43], v9 offset:2048
    ds_read_b128 v[28:31], v0 offset:3072
    ds_read_b128 v[44:47], v9 offset:3072
    s_add_u32 s22, s17, s61
    s_waitcnt lgkmcnt(6)
    v_mfma_f32_16x16x32_bf16 v[48:51], v[32:35], v[16:19], 0
    ds_read_b128 v[32:35], v9 offset:4096
    s_waitcnt lgkmcnt(5)
    v_mfma_f32_16x16x32_bf16 v[48:51], v[36:39], v[20:23], v[48:51]
    ds_read_b128 v[36:39], v9 offset:5120
    s_waitcnt lgkmcnt(4)
    v_mfma_f32_16x16x32_bf16 v[48:51], v[40:43], v[24:27], v[48:51]
    ds_read_b128 v[40:43], v9 offset:6144
    s_waitcnt lgkmcnt(3)
    v_mfma_f32_16x16x32_bf16 v[48:51], v[44:47], v[28:31], v[48:51]
    ds_read_b128 v[44:47], v9 offset:7168
    s_waitcnt lgkmcnt(3)
    v_mfma_f32_16x16x32_bf16 v[52:55], v[32:35], v[16:19], 0
    s_waitcnt lgkmcnt(2)
    v_mfma_f32_16x16x32_bf16 v[52:55], v[36:39], v[20:23], v[52:55]
    s_waitcnt lgkmcnt(1)
    v_mfma_f32_16x16x32_bf16 v[52:55], v[40:43], v[24:27], v[52:55]
    s_waitcnt lgkmcnt(0)
    v_mfma_f32_16x16x32_bf16 v[52:55], v[44:47], v[28:31], v[52:55]
    buffer_load_dwordx4 v[32:35], v1, s[4:7], s22 offen offset:0 sc1
    buffer_load_dwordx4 v[36:39], v1, s[4:7], s22 offen offset:1024 sc1
    buffer_load_dwordx4 v[40:43], v1, s[4:7], s22 offen offset:2048 sc1
    buffer_load_dwordx4 v[44:47], v1, s[4:7], s22 offen offset:3072 sc1
    v_mov_b32 v60, 0xff61b1e6
    s_nop 2
    v_cndmask_b32 v48, v48, v60, s[38:39]
    v_cndmask_b32 v49, v49, v60, s[40:41]
    v_cndmask_b32 v50, v50, v60, s[42:43]
    v_cndmask_b32 v51, v51, v60, s[44:45]
    v_cndmask_b32 v52, v52, v60, s[48:49]
    v_cndmask_b32 v53, v53, v60, s[50:51]
    v_cndmask_b32 v54, v54, v60, s[54:55]
    v_cndmask_b32 v55, v55, v60, s[56:57]
    v_max3_f32 v0, v48, v49, v50
    v_max3_f32 v9, v51, v52, v53
    v_max3_f32 v0, v0, v54, v55
    v_max_f32 v0, v0, v9
    v_mov_b32 v9, v0
    s_nop 1
    v_permlane16_swap_b32 v9, v0
    v_max_f32 v0, v0, v9
    v_mov_b32 v9, v0
    s_nop 1
    v_permlane32_swap_b32 v9, v0
    v_max_f32 v0, v0, v9
    v_mul_f32 v0, s47, v0
    v_fma_f32 v48, v48, s47, -v0
    v_fma_f32 v49, v49, s47, -v0
    v_fma_f32 v50, v50, s47, -v0
    v_fma_f32 v51, v51, s47, -v0
    v_fma_f32 v52, v52, s47, -v0
    v_fma_f32 v53, v53, s47, -v0
    v_fma_f32 v54, v54, s47, -v0
    v_fma_f32 v55, v55, s47, -v0
    v_exp_f32 v48, v48
    v_exp_f32 v49, v49
    v_exp_f32 v50, v50
    v_exp_f32 v51, v51
    v_exp_f32 v52, v52
    v_exp_f32 v53, v53
    v_exp_f32 v54, v54
    v_exp_f32 v55, v55
    v_add_f32 v15, v48, v49
    v_add_f32 v15, v15, v50
    v_add_f32 v15, v15, v51
    v_add_f32 v15, v15, v52
    v_add_f32 v15, v15, v53
    v_add_f32 v15, v15, v54
    v_add_f32 v15, v15, v55
ploop_15_za:
    s_waitcnt vmcnt(0)
    v_max3_u32 v9, v32, v33, v34
    v_max3_u32 v9, v9, v35, v36
    v_max3_u32 v9, v9, v37, v38
    v_max3_u32 v9, v9, v39, v40
    v_max3_u32 v9, v9, v41, v42
    v_max3_u32 v9, v9, v43, v44
    v_max3_u32 v9, v9, v45, v46
    v_max_u32 v9, v9, v47
    v_cmp_eq_u32 vcc, -1, v9
    s_cbranch_vccnz ploop_15_zr
ploop_15_zok:
    v_mfma_f32_16x16x32_bf16 v[56:59], v[32:35], v[16:19], 0
    v_mfma_f32_16x16x32_bf16 v[56:59], v[36:39], v[20:23], v[56:59]
    v_mfma_f32_16x16x32_bf16 v[56:59], v[40:43], v[24:27], v[56:59]
    v_mfma_f32_16x16x32_bf16 v[56:59], v[44:47], v[28:31], v[56:59]
    s_nop 7
    v_max_f32 v60, v56, v57
    v_mov_b32 v9, v60
    s_nop 1
    v_permlane16_swap_b32 v9, v60
    v_max_f32 v60, v60, v9
    v_mov_b32 v9, v60
    s_nop 1
    v_permlane32_swap_b32 v9, v60
    v_max_f32 v60, v60, v9
    v_mul_f32 v60, s47, v60
    v_max_f32 v58, v60, v0
    v_sub_f32 v60, v0, v58
    v_fma_f32 v56, v56, s47, -v58
    v_fma_f32 v57, v57, s47, -v58
    v_exp_f32 v60, v60
    v_exp_f32 v56, v56
    v_exp_f32 v57, v57
    v_fma_f32 v15, v15, v60, v56
    v_add_f32 v15, v15, v57
    v_mov_b32 v9, v15
    s_nop 1
    v_permlane16_swap_b32 v9, v15
    v_add_f32 v15, v15, v9
    v_mov_b32 v9, v15
    s_nop 1
    v_permlane32_swap_b32 v9, v15
    v_add_f32 v15, v15, v9
    v_rcp_f32 v15, v15
    s_add_u32 s22, s17, s14
    s_add_u32 s25, s19, s14
    v_add_u32 v9, 14336, v1
    v_mul_f32 v60, v60, v15
    v_mul_f32 v56, v56, v15
    v_mul_f32 v57, v57, v15
    v_mul_f32 v48, v48, v60
    v_mul_f32 v49, v49, v60
    v_mul_f32 v50, v50, v60
    v_mul_f32 v51, v51, v60
    v_mul_f32 v52, v52, v60
    v_mul_f32 v53, v53, v60
    v_mul_f32 v54, v54, v60
    v_mul_f32 v55, v55, v60
    v_cvt_pk_bf16_f32 v48, v48, v49
    v_cvt_pk_bf16_f32 v49, v50, v51
    v_cvt_pk_bf16_f32 v50, v52, v53
    v_cvt_pk_bf16_f32 v51, v54, v55
    v_cvt_pk_bf16_f32 v52, v56, v57
    v_min_u32 v48, -2, v48
    v_min_u32 v49, -2, v49
    v_min_u32 v50, -2, v50
    v_min_u32 v51, -2, v51
    v_min_u32 v52, -2, v52
    buffer_store_dwordx4 v[48:51], v1, s[4:7], s22 offen sc1
    buffer_store_dword v52, v8, s[4:7], s22 offen offset:1024 sc1
    ds_read_b128 v[56:59], v9
    s_branch ploop_15_nd2
ploop_15_nd:
ploop_15_flag:
    ds_read_b32 v9, v14 offset:16
    s_waitcnt lgkmcnt(0)
    v_readfirstlane_b32 s25, v9
    s_cmp_eq_u32 s25, s16
    s_cbranch_scc0 ploop_15_flag
    s_add_u32 m0, s53, 0
    s_add_u32 s22, s52, 0
    buffer_load_dwordx4 v1, s[4:7], s22 offen offset:0 sc1 lds
    buffer_load_dwordx4 v1, s[4:7], s22 offen offset:1024 sc1 lds
    buffer_load_dwordx4 v1, s[4:7], s22 offen offset:2048 sc1 lds
    buffer_load_dwordx4 v1, s[4:7], s22 offen offset:3072 sc1 lds
    s_add_u32 m0, s53, 4096
    s_add_u32 s22, s52, 131072
    buffer_load_dwordx4 v1, s[4:7], s22 offen offset:0 sc1 lds
    buffer_load_dwordx4 v1, s[4:7], s22 offen offset:1024 sc1 lds
    buffer_load_dwordx4 v1, s[4:7], s22 offen offset:2048 sc1 lds
    buffer_load_dwordx4 v1, s[4:7], s22 offen offset:3072 sc1 lds
    s_add_u32 s52, s52, 262144
ploop_15_nd2:
    s_cmp_lg_u32 s3, 2
    s_cbranch_scc1 ppf_20
    s_lshl_b32 s22, s16, 18
    s_mov_b32 exec_hi, 0xffff
    buffer_load_dword v0, v63, s[4:7], s22 offen sc1
    buffer_load_dword v0, v63, s[4:7], s22 offen offset:64 sc1
    s_mov_b32 exec_hi, -1
ppf_20:
    v_add_u32 v24, 18560, v7
    v_add_u32 v25, 37120, v7
    v_add_u32 v26, 55680, v7
    s_cmp_eq_u32 s16, 63
    s_setprio 3
    s_barrier
    s_cbranch_scc1 ptail_17
    ds_read2_b32 v[16:17], v7 offset0:0 offset1:2
    ds_read2_b32 v[18:19], v24 offset0:0 offset1:2
    ds_read2_b32 v[20:21], v25 offset0:0 offset1:2
    ds_read2_b32 v[22:23], v26 offset0:0 offset1:2
    s_waitcnt lgkmcnt(2)
    v_add_f32 v16, v16, v18
    v_add_f32 v17, v17, v19
    s_waitcnt lgkmcnt(0)
    v_add_f32 v20, v20, v22
    v_add_f32 v21, v21, v23
    v_add_f32 v16, v16, v20
    v_add_f32 v17, v17, v21
    v_cvt_pk_bf16_f32 v16, v16, v17
    v_min_u32 v16, -2, v16
    buffer_store_dword v16, v2, s[4:7], s21 offen sc1
    buffer_store_dword v10, v2, s[4:7], s24 offen sc1
    s_cmp_eq_u32 s15, 0
    s_cbranch_scc1 ploop_15_pnd
    s_sleep 6
    s_nop 8
    buffer_load_dwordx4 v[16:19], v12, s[4:7], s30 offen sc1
    buffer_load_dword v15, off, s[4:7], s58 sc1
    v_mov_b32 v20, -1
    v_mov_b32 v21, -1
    v_mov_b32 v22, -1
    v_mov_b32 v23, -1
    buffer_store_dwordx4 v[20:23], v1, s[4:7], s25 offen sc1
    buffer_store_dword v20, v8, s[4:7], s25 offen offset:1024 sc1
    s_mov_b32 m0, 124928
    s_nop 0
    buffer_load_dwordx4 v1, s[4:7], s69 offen offset:0 sc1 lds
    buffer_load_dwordx4 v1, s[4:7], s69 offen offset:1024 sc1 lds
    buffer_load_dwordx4 v1, s[4:7], s69 offen offset:2048 sc1 lds
    buffer_load_dwordx4 v1, s[4:7], s69 offen offset:3072 sc1 lds
    s_add_u32 s69, s69, 262144
    s_add_u32 m0, s53, 0
    s_add_u32 s22, s52, 0
    buffer_load_dwordx4 v1, s[4:7], s22 offen offset:0 sc1 lds
    buffer_load_dwordx4 v1, s[4:7], s22 offen offset:1024 sc1 lds
    buffer_load_dwordx4 v1, s[4:7], s22 offen offset:2048 sc1 lds
    buffer_load_dwordx4 v1, s[4:7], s22 offen offset:3072 sc1 lds
    s_add_u32 m0, s53, 4096
    s_add_u32 s22, s52, 131072
    buffer_load_dwordx4 v1, s[4:7], s22 offen offset:0 sc1 lds
    buffer_load_dwordx4 v1, s[4:7], s22 offen offset:1024 sc1 lds
    buffer_load_dwordx4 v1, s[4:7], s22 offen offset:2048 sc1 lds
    buffer_load_dwordx4 v1, s[4:7], s22 offen offset:3072 sc1 lds
    s_add_u32 s52, s52, 262144
    s_add_u32 s22, s16, 1
    v_mov_b32 v60, s22
    s_cmp_eq_u32 s16, 0
    s_cbranch_scc1 ploop_15_pagain
    v_add_u32 v55, s68, v61
    s_xor_b32 s68, s68, 8192
    ds_read_b128 v[24:27], v55 offset:0
    ds_read_b128 v[28:31], v55 offset:1024
    ds_read_b128 v[32:35], v55 offset:18560
    ds_read_b128 v[36:39], v55 offset:19584
    ds_read_b128 v[40:43], v55 offset:37120
    ds_read_b128 v[44:47], v55 offset:38144
    ds_read_b128 v[48:51], v55 offset:55680
    ds_read_b128 v[52:55], v55 offset:56704
    s_waitcnt lgkmcnt(4)
    v_add_f32 v24, v24, v32
    v_add_f32 v25, v25, v33
    v_add_f32 v26, v26, v34
    v_add_f32 v27, v27, v35
    v_add_f32 v28, v28, v36
    v_add_f32 v29, v29, v37
    v_add_f32 v30, v30, v38
    v_add_f32 v31, v31, v39
    s_waitcnt lgkmcnt(0)
    v_add_f32 v40, v40, v48
    v_add_f32 v41, v41, v49
    v_add_f32 v42, v42, v50
    v_add_f32 v43, v43, v51
    v_add_f32 v44, v44, v52
    v_add_f32 v45, v45, v53
    v_add_f32 v46, v46, v54
    v_add_f32 v47, v47, v55
    v_add_f32 v24, v24, v40
    v_add_f32 v25, v25, v41
    v_add_f32 v26, v26, v42
    v_add_f32 v27, v27, v43
    v_add_f32 v28, v28, v44
    v_add_f32 v29, v29, v45
    v_add_f32 v30, v30, v46
    v_add_f32 v31, v31, v47
    v_cvt_pk_bf16_f32 v24, v24, v25
    v_cvt_pk_bf16_f32 v25, v26, v27
    v_cvt_pk_bf16_f32 v26, v28, v29
    v_cvt_pk_bf16_f32 v27, v30, v31
    v_min_u32 v24, -2, v24
    v_min_u32 v25, -2, v25
    v_min_u32 v26, -2, v26
    v_min_u32 v27, -2, v27
    buffer_store_dwordx4 v[24:27], v1, s[4:7], s37 offen sc1
    s_add_u32 s37, s37, 65536
    s_waitcnt vmcnt(16) lgkmcnt(0)
    s_branch ploop_15_pchk
ploop_15_pnd:
    s_sleep 6
    s_nop 8
    buffer_load_dwordx4 v[16:19], v12, s[4:7], s30 offen sc1
    buffer_load_dword v15, off, s[4:7], s58 sc1
    s_add_u32 s22, s16, 1
    v_mov_b32 v60, s22
    s_cmp_eq_u32 s16, 0
    s_cbranch_scc1 ploop_15_pagain
    v_add_u32 v55, s68, v61
    s_xor_b32 s68, s68, 8192
    ds_read_b128 v[24:27], v55 offset:0
    ds_read_b128 v[28:31], v55 offset:1024
    ds_read_b128 v[32:35], v55 offset:18560
    ds_read_b128 v[36:39], v55 offset:19584
    ds_read_b128 v[40:43], v55 offset:37120
    ds_read_b128 v[44:47], v55 offset:38144
    ds_read_b128 v[48:51], v55 offset:55680
    ds_read_b128 v[52:55], v55 offset:56704
    s_waitcnt lgkmcnt(4)
    v_add_f32 v24, v24, v32
    v_add_f32 v25, v25, v33
    v_add_f32 v26, v26, v34
    v_add_f32 v27, v27, v35
    v_add_f32 v28, v28, v36
    v_add_f32 v29, v29, v37
    v_add_f32 v30, v30, v38
    v_add_f32 v31, v31, v39
    s_waitcnt lgkmcnt(0)
    v_add_f32 v40, v40, v48
    v_add_f32 v41, v41, v49
    v_add_f32 v42, v42, v50
    v_add_f32 v43, v43, v51
    v_add_f32 v44, v44, v52
    v_add_f32 v45, v45, v53
    v_add_f32 v46, v46, v54
    v_add_f32 v47, v47, v55
    v_add_f32 v24, v24, v40
    v_add_f32 v25, v25, v41
    v_add_f32 v26, v26, v42
    v_add_f32 v27, v27, v43
    v_add_f32 v28, v28, v44
    v_add_f32 v29, v29, v45
    v_add_f32 v30, v30, v46
    v_add_f32 v31, v31, v47
    v_cvt_pk_bf16_f32 v24, v24, v25
    v_cvt_pk_bf16_f32 v25, v26, v27
    v_cvt_pk_bf16_f32 v26, v28, v29
    v_cvt_pk_bf16_f32 v27, v30, v31
    v_min_u32 v24, -2, v24
    v_min_u32 v25, -2, v25
    v_min_u32 v26, -2, v26
    v_min_u32 v27, -2, v27
    buffer_store_dwordx4 v[24:27], v1, s[4:7], s37 offen sc1
    s_add_u32 s37, s37, 65536
    s_waitcnt vmcnt(2) lgkmcnt(0)
    s_branch ploop_15_pchk
ploop_15_pagain:
    s_waitcnt vmcnt(1) lgkmcnt(0)
ploop_15_pchk:
    v_mfma_f32_16x16x32_bf16 v[20:23], v[56:59], v[16:19], 0
    v_max3_u32 v9, v16, v17, v18
    v_max_u32 v9, v9, v19
    v_cmp_eq_u32 vcc, -1, v9
    s_cbranch_vccnz prp_19
ploop_15_pgo:
    s_nop 3
    v_add_f32_dpp v20, v20, v20 row_ror:8 row_mask:0xf bank_mask:0xf
    v_add_f32_dpp v21, v21, v21 row_ror:8 row_mask:0xf bank_mask:0xf
    v_add_f32_dpp v22, v22, v22 row_ror:8 row_mask:0xf bank_mask:0xf
    v_add_f32_dpp v23, v23, v23 row_ror:8 row_mask:0xf bank_mask:0xf
    v_cvt_pk_bf16_f32 v20, v20, v21
    v_cvt_pk_bf16_f32 v21, v22, v23
    s_mov_b32 exec_hi, 0
    v_min_u32 v20, -2, v20
    v_min_u32 v21, -2, v21
    s_mov_b32 exec_lo, 0x00ff00ff
    buffer_store_dwordx2 v[20:21], v13, s[4:7], s23 offen sc1
    s_mov_b64 exec, -1
    s_add_u32 s16, s16, 1
    s_mov_b32 s17, s18
    s_mov_b32 s18, s19
    s_mov_b32 s19, s20
    s_add_u32 s20, s20, 262144
    s_cmp_eq_u32 s20, 210763776
    s_cselect_b32 s20, 209715200, s20
    s_branch ploop_15
prm_18_gt:
gate_21:
    v_readfirstlane_b32 s25, v15
    s_cmp_ge_u32 s25, s59
    s_cbranch_scc1 gate_21_ok
    s_sleep 8
    buffer_load_dword v15, off, s[4:7], s58 sc1
    s_waitcnt vmcnt(0)
    s_sub_u32 s26, s26, 1
    s_cbranch_scc0 gate_21
    s_mov_b32 s26, 0
gate_21_ok:
    s_branch prm_18_gtb
prm_18_0:
    s_sub_u32 s26, s26, 1
    s_cbranch_scc1 prm_18_0_g
    buffer_load_dwordx4 v[16:19], v1, s[4:7], s21 offen offset:0 sc1
    buffer_load_dwordx4 v[20:23], v1, s[4:7], s21 offen offset:1024 sc1
    buffer_load_dwordx4 v[24:27], v1, s[4:7], s21 offen offset:2048 sc1
    buffer_load_dwordx4 v[28:31], v1, s[4:7], s21 offen offset:3072 sc1
    s_waitcnt vmcnt(3)
    v_max3_u32 v9, v16, v17, v18
    v_max_u32 v9, v9, v19
    v_cmp_eq_u32 vcc, -1, v9
    s_cbranch_vccnz prm_18_0
    s_branch prm_18_0ok
prm_18_0_g:
    s_mov_b32 s26, 0
    s_waitcnt vmcnt(0)
    s_branch prm_18_0ok
prm_18_1:
    s_sub_u32 s26, s26, 1
    s_cbranch_scc1 prm_18_1_g
    buffer_load_dwordx4 v[20:23], v1, s[4:7], s21 offen offset:1024 sc1
    buffer_load_dwordx4 v[24:27], v1, s[4:7], s21 offen offset:2048 sc1
    buffer_load_dwordx4 v[28:31], v1, s[4:7], s21 offen offset:3072 sc1
    s_waitcnt vmcnt(2)
    v_max3_u32 v9, v20, v21, v22
    v_max_u32 v9, v9, v23
    v_cmp_eq_u32 vcc, -1, v9
    s_cbranch_vccnz prm_18_1
    s_branch prm_18_1ok
prm_18_1_g:
    s_mov_b32 s26, 0
    s_waitcnt vmcnt(0)
    s_branch prm_18_1ok
prm_18_2:
    s_sub_u32 s26, s26, 1
    s_cbranch_scc1 prm_18_2_g
    buffer_load_dwordx4 v[24:27], v1, s[4:7], s21 offen offset:2048 sc1
    buffer_load_dwordx4 v[28:31], v1, s[4:7], s21 offen offset:3072 sc1
    s_waitcnt vmcnt(1)
    v_max3_u32 v9, v24, v25, v26
    v_max_u32 v9, v9, v27
    v_cmp_eq_u32 vcc, -1, v9
    s_cbranch_vccnz prm_18_2
    s_branch prm_18_2ok
prm_18_2_g:
    s_mov_b32 s26, 0
    s_waitcnt vmcnt(0)
    s_branch prm_18_2ok
prm_18_3:
    s_sub_u32 s26, s26, 1
    s_cbranch_scc1 prm_18_3_g
    buffer_load_dwordx4 v[28:31], v1, s[4:7], s21 offen offset:3072 sc1
    s_waitcnt vmcnt(0)
    v_max3_u32 v9, v28, v29, v30
    v_max_u32 v9, v9, v31
    v_cmp_eq_u32 vcc, -1, v9
    s_cbranch_vccnz prm_18_3
    s_branch prm_18_3ok
prm_18_3_g:
    s_mov_b32 s26, 0
    s_waitcnt vmcnt(0)
    s_branch prm_18_3ok
prm_18_d:
gate_22:
    v_readfirstlane_b32 s25, v15
    s_cmp_ge_u32 s25, s59
    s_cbranch_scc1 gate_22_ok
    s_sleep 8
    buffer_load_dword v15, off, s[4:7], s58 sc1
    s_waitcnt vmcnt(0)
    s_sub_u32 s26, s26, 1
    s_cbranch_scc0 gate_22
    s_mov_b32 s26, 0
gate_22_ok:
    ds_write_b32 v14, v60
    v_add_f32 v32, v32, v33
    v_add_f32 v34, v34, v35
    ds_write2_b32 v4, v32, v34 offset0:0 offset1:104
    v_add_f32 v36, v36, v37
    v_add_f32 v38, v38, v39
    ds_write2_b32 v4, v36, v38 offset0:16 offset1:120
    v_add_f32 v40, v40, v41
    v_add_f32 v42, v42, v43
    ds_write2_b32 v4, v40, v42 offset0:32 offset1:136
    v_add_f32 v44, v44, v45
    v_add_f32 v46, v46, v47
    ds_write2_b32 v4, v44, v46 offset0:48 offset1:152
    v_add_f32 v48, v48, v49
    v_add_f32 v50, v50, v51
    ds_write2_b32 v4, v48, v50 offset0:64 offset1:168
    v_add_f32 v52, v52, v53
    v_add_f32 v54, v54, v55
    ds_write2_b32 v4, v52, v54 offset0:80 offset1:184
    s_branch pnc_16_done
prp_19:
    s_sub_u32 s26, s26, 1
    s_nop 3
    s_cbranch_scc1 prp_19_g
    buffer_load_dwordx4 v[16:19], v12, s[4:7], s30 offen sc1
    buffer_load_dword v15, off, s[4:7], s58 sc1
    s_branch ploop_15_pagain
prp_19_g:
    s_mov_b32 s26, 0
    s_branch ploop_15_pgo
ploop_15_zr:
    s_sub_u32 s26, s26, 1
    s_cbranch_scc1 ploop_15_zg
    buffer_load_dwordx4 v[32:35], v1, s[4:7], s22 offen offset:0 sc1
    buffer_load_dwordx4 v[36:39], v1, s[4:7], s22 offen offset:1024 sc1
    buffer_load_dwordx4 v[40:43], v1, s[4:7], s22 offen offset:2048 sc1
    buffer_load_dwordx4 v[44:47], v1, s[4:7], s22 offen offset:3072 sc1
    s_branch ploop_15_za
ploop_15_zg:
    s_mov_b32 s26, 0
    s_branch ploop_15_zok
ptail_17:
    s_cmp_eq_u32 s15, 0
    s_cbranch_scc1 ptail_17_nd
    s_nop 0
ptail_17_nd:
    v_add_u32 v55, s68, v61
    s_xor_b32 s68, s68, 8192
    ds_read_b128 v[24:27], v55 offset:0
    ds_read_b128 v[28:31], v55 offset:1024
    ds_read_b128 v[32:35], v55 offset:18560
    ds_read_b128 v[36:39], v55 offset:19584
    ds_read_b128 v[40:43], v55 offset:37120
    ds_read_b128 v[44:47], v55 offset:38144
    ds_read_b128 v[48:51], v55 offset:55680
    ds_read_b128 v[52:55], v55 offset:56704
    s_waitcnt lgkmcnt(4)
    v_add_f32 v24, v24, v32
    v_add_f32 v25, v25, v33
    v_add_f32 v26, v26, v34
    v_add_f32 v27, v27, v35
    v_add_f32 v28, v28, v36
    v_add_f32 v29, v29, v37
    v_add_f32 v30, v30, v38
    v_add_f32 v31, v31, v39
    s_waitcnt lgkmcnt(0)
    v_add_f32 v40, v40, v48
    v_add_f32 v41, v41, v49
    v_add_f32 v42, v42, v50
    v_add_f32 v43, v43, v51
    v_add_f32 v44, v44, v52
    v_add_f32 v45, v45, v53
    v_add_f32 v46, v46, v54
    v_add_f32 v47, v47, v55
    v_add_f32 v24, v24, v40
    v_add_f32 v25, v25, v41
    v_add_f32 v26, v26, v42
    v_add_f32 v27, v27, v43
    v_add_f32 v28, v28, v44
    v_add_f32 v29, v29, v45
    v_add_f32 v30, v30, v46
    v_add_f32 v31, v31, v47
    v_cvt_pk_bf16_f32 v24, v24, v25
    v_cvt_pk_bf16_f32 v25, v26, v27
    v_cvt_pk_bf16_f32 v26, v28, v29
    v_cvt_pk_bf16_f32 v27, v30, v31
    v_min_u32 v24, -2, v24
    v_min_u32 v25, -2, v25
    v_min_u32 v26, -2, v26
    v_min_u32 v27, -2, v27
    buffer_store_dwordx4 v[24:27], v1, s[4:7], s37 offen sc1
    s_add_u32 s37, s37, 65536
    s_barrier
    s_nop 0
    v_add_u32 v55, s68, v61
    s_xor_b32 s68, s68, 8192
    ds_read_b128 v[24:27], v55 offset:0
    ds_read_b128 v[28:31], v55 offset:1024
    ds_read_b128 v[32:35], v55 offset:18560
    ds_read_b128 v[36:39], v55 offset:19584
    ds_read_b128 v[40:43], v55 offset:37120
    ds_read_b128 v[44:47], v55 offset:38144
    ds_read_b128 v[48:51], v55 offset:55680
    ds_read_b128 v[52:55], v55 offset:56704
    s_waitcnt lgkmcnt(4)
    v_add_f32 v24, v24, v32
    v_add_f32 v25, v25, v33
    v_add_f32 v26, v26, v34
    v_add_f32 v27, v27, v35
    v_add_f32 v28, v28, v36
    v_add_f32 v29, v29, v37
    v_add_f32 v30, v30, v38
    v_add_f32 v31, v31, v39
    s_waitcnt lgkmcnt(0)
    v_add_f32 v40, v40, v48
    v_add_f32 v41, v41, v49
    v_add_f32 v42, v42, v50
    v_add_f32 v43, v43, v51
    v_add_f32 v44, v44, v52
    v_add_f32 v45, v45, v53
    v_add_f32 v46, v46, v54
    v_add_f32 v47, v47, v55
    v_add_f32 v24, v24, v40
    v_add_f32 v25, v25, v41
    v_add_f32 v26, v26, v42
    v_add_f32 v27, v27, v43
    v_add_f32 v28, v28, v44
    v_add_f32 v29, v29, v45
    v_add_f32 v30, v30, v46
    v_add_f32 v31, v31, v47
    v_cvt_pk_bf16_f32 v24, v24, v25
    v_cvt_pk_bf16_f32 v25, v26, v27
    v_cvt_pk_bf16_f32 v26, v28, v29
    v_cvt_pk_bf16_f32 v27, v30, v31
    v_min_u32 v24, -2, v24
    v_min_u32 v25, -2, v25
    v_min_u32 v26, -2, v26
    v_min_u32 v27, -2, v27
    buffer_store_dwordx4 v[24:27], v1, s[4:7], s37 offen sc1
    s_add_u32 s37, s37, 65536
    s_branch k_end
ch_a_pro:
    s_mul_i32 s21, s2, 24576
    s_add_u32 s21, s21, 209711104
    v_lshlrev_b32 v1, 4, v0
    v_mov_b32 v4, -1
    v_mov_b32 v5, -1
    v_mov_b32 v6, -1
    v_mov_b32 v7, -1
    buffer_store_dwordx4 v[4:7], v1, s[4:7], s21 offen sc1
    s_add_u32 s21, s21, 4096
    buffer_store_dwordx4 v[4:7], v1, s[4:7], s21 offen sc1
    s_add_u32 s21, s21, 4096
    buffer_store_dwordx4 v[4:7], v1, s[4:7], s21 offen sc1
    s_add_u32 s21, s21, 4096
    buffer_store_dwordx4 v[4:7], v1, s[4:7], s21 offen sc1
    s_add_u32 s21, s21, 4096
    buffer_store_dwordx4 v[4:7], v1, s[4:7], s21 offen sc1
    s_add_u32 s21, s21, 4096
    buffer_store_dwordx4 v[4:7], v1, s[4:7], s21 offen sc1
    s_add_u32 s21, s21, 4096
    v_mov_b32 v2, s29
    s_waitcnt vmcnt(0)
    s_barrier
    s_cmp_lg_u32 s3, 4
    s_cbranch_scc1 ch_nox
    s_mov_b64 exec, 1
    buffer_atomic_add v2, off, s[64:67], s28 sc1
    s_mov_b64 exec, -1
ch_nox:
    v_and_b32 v20, 63, v0
    v_lshlrev_b32 v0, 4, v20
    s_sub_u32 s25, s3, 4
    s_lshl_b32 s46, s12, 2
    s_add_u32 s46, s46, s25
    s_lshl_b32 s21, s46, 18
    s_lshl_b32 s22, s13, 7
    s_add_u32 s21, s21, s22
    s_lshl_b32 s46, s46, 12
    s_lshl_b32 s23, s25, 13
    s_add_u32 s23, s23, 131072
    s_load_dwordx2 s[8:9], s[0:1], 40
    s_mov_b32 s10, 8388608
    s_mov_b32 s11, 131072
    v_lshrrev_b32 v21, 3, v20
    v_and_b32 v22, 7, v20
    v_lshlrev_b32 v21, 11, v21
    v_lshl_add_u32 v21, v22, 4, v21
    v_lshrrev_b32 v28, 4, v20
    v_and_b32 v29, 1, v28
    v_xor_b32 v29, 0, v29
    v_lshlrev_b32 v29, 2, v29
    v_lshl_add_u32 v29, v28, 3, v29
    v_bfe_u32 v28, v20, 2, 2
    v_add_u32 v29, v29, v28
    v_lshlrev_b32 v29, 7, v29
    v_and_b32 v28, 3, v20
    v_lshl_add_u32 v29, v28, 4, v29
    v_and_b32 v28, 1, v28
    v_xor_b32 v28, 0, v28
    v_lshl_add_u32 v24, v28, 3, v29
    v_add_u32 v24, s23, v24
    v_lshrrev_b32 v28, 4, v20
    v_and_b32 v29, 1, v28
    v_xor_b32 v29, 1, v29
    v_lshlrev_b32 v29, 2, v29
    v_lshl_add_u32 v29, v28, 3, v29
    v_bfe_u32 v28, v20, 2, 2
    v_add_u32 v29, v29, v28
    v_lshlrev_b32 v29, 7, v29
    v_and_b32 v28, 3, v20
    v_lshl_add_u32 v29, v28, 4, v29
    v_and_b32 v28, 1, v28
    v_xor_b32 v28, 0, v28
    v_lshl_add_u32 v25, v28, 3, v29
    v_add_u32 v25, s23, v25
    v_lshrrev_b32 v28, 4, v20
    v_and_b32 v29, 1, v28
    v_xor_b32 v29, 0, v29
    v_lshlrev_b32 v29, 2, v29
    v_lshl_add_u32 v29, v28, 3, v29
    v_bfe_u32 v28, v20, 2, 2
    v_add_u32 v29, v29, v28
    v_lshlrev_b32 v29, 7, v29
    v_and_b32 v28, 3, v20
    v_lshl_add_u32 v29, v28, 4, v29
    v_and_b32 v28, 1, v28
    v_xor_b32 v28, 1, v28
    v_lshl_add_u32 v26, v28, 3, v29
    v_add_u32 v26, s23, v26
    v_lshrrev_b32 v28, 4, v20
    v_and_b32 v29, 1, v28
    v_xor_b32 v29, 1, v29
    v_lshlrev_b32 v29, 2, v29
    v_lshl_add_u32 v29, v28, 3, v29
    v_bfe_u32 v28, v20, 2, 2
    v_add_u32 v29, v29, v28
    v_lshlrev_b32 v29, 7, v29
    v_and_b32 v28, 3, v20
    v_lshl_add_u32 v29, v28, 4, v29
    v_and_b32 v28, 1, v28
    v_xor_b32 v28, 1, v28
    v_lshl_add_u32 v27, v28, 3, v29
    v_add_u32 v27, s23, v27
    s_waitcnt lgkmcnt(0)
    s_add_u32 m0, s23, 0
    s_nop 0
    buffer_load_dwordx4 v21, s[8:11], s21 offen lds
    s_add_u32 s21, s21, 16384
    s_add_u32 m0, s23, 1024
    s_nop 0
    buffer_load_dwordx4 v21, s[8:11], s21 offen lds
    s_add_u32 s21, s21, 16384
    s_add_u32 m0, s23, 2048
    s_nop 0
    buffer_load_dwordx4 v21, s[8:11], s21 offen lds
    s_add_u32 s21, s21, 16384
    s_add_u32 m0, s23, 3072
    s_nop 0
    buffer_load_dwordx4 v21, s[8:11], s21 offen lds
    s_add_u32 s21, s21, 16384
    s_add_u32 m0, s23, 4096
    s_nop 0
    buffer_load_dwordx4 v21, s[8:11], s21 offen lds
    s_add_u32 s21, s21, 16384
    s_add_u32 m0, s23, 5120
    s_nop 0
    buffer_load_dwordx4 v21, s[8:11], s21 offen lds
    s_add_u32 s21, s21, 16384
    s_add_u32 m0, s23, 6144
    s_nop 0
    buffer_load_dwordx4 v21, s[8:11], s21 offen lds
    s_add_u32 s21, s21, 16384
    s_add_u32 m0, s23, 7168
    s_nop 0
    buffer_load_dwordx4 v21, s[8:11], s21 offen lds
    s_add_u32 s21, s21, 16384
    buffer_load_dwordx4 v[98:101], v21, s[8:11], s21 offen
    s_add_u32 s21, s21, 16384
    buffer_load_dwordx4 v[102:105], v21, s[8:11], s21 offen
    s_add_u32 s21, s21, 16384
    buffer_load_dwordx4 v[106:109], v21, s[8:11], s21 offen
    s_add_u32 s21, s21, 16384
    buffer_load_dwordx4 v[110:113], v21, s[8:11], s21 offen
    s_add_u32 s21, s21, 16384
    buffer_load_dwordx4 v[114:117], v21, s[8:11], s21 offen
    s_add_u32 s21, s21, 16384
    buffer_load_dwordx4 v[118:121], v21, s[8:11], s21 offen
    s_add_u32 s21, s21, 16384
    buffer_load_dwordx4 v[122:125], v21, s[8:11], s21 offen
    s_add_u32 s21, s21, 16384
    buffer_load_dwordx4 v[126:129], v21, s[8:11], s21 offen
    s_add_u32 s21, s21, 16384
    v_add_u32 v30, s23, v0
    s_waitcnt vmcnt(8)
    ds_read_b64_tr_b16 v[192:193], v24 offset:0
    ds_read_b64_tr_b16 v[194:195], v25 offset:0
    ds_read_b64_tr_b16 v[200:201], v26 offset:0
    ds_read_b64_tr_b16 v[202:203], v27 offset:0
    ds_read_b64_tr_b16 v[208:209], v24 offset:64
    ds_read_b64_tr_b16 v[210:211], v25 offset:64
    ds_read_b64_tr_b16 v[216:217], v26 offset:64
    ds_read_b64_tr_b16 v[218:219], v27 offset:64
    s_waitcnt lgkmcnt(0)
    ds_read_b64_tr_b16 v[196:197], v24 offset:4096
    ds_read_b64_tr_b16 v[198:199], v25 offset:4096
    ds_read_b64_tr_b16 v[204:205], v26 offset:4096
    ds_read_b64_tr_b16 v[206:207], v27 offset:4096
    ds_read_b64_tr_b16 v[212:213], v24 offset:4160
    ds_read_b64_tr_b16 v[214:215], v25 offset:4160
    ds_read_b64_tr_b16 v[220:221], v26 offset:4160
    ds_read_b64_tr_b16 v[222:223], v27 offset:4160
    s_waitcnt lgkmcnt(0)
    s_waitcnt vmcnt(0)
    ds_write_b128 v30, v[98:101] offset:0
    ds_write_b128 v30, v[102:105] offset:1024
    ds_write_b128 v30, v[106:109] offset:2048
    ds_write_b128 v30, v[110:113] offset:3072
    ds_write_b128 v30, v[114:117] offset:4096
    ds_write_b128 v30, v[118:121] offset:5120
    ds_write_b128 v30, v[122:125] offset:6144
    ds_write_b128 v30, v[126:129] offset:7168
    s_waitcnt lgkmcnt(0)
    ds_read_b64_tr_b16 v[224:225], v24 offset:0
    ds_read_b64_tr_b16 v[226:227], v25 offset:0
    ds_read_b64_tr_b16 v[232:233], v26 offset:0
    ds_read_b64_tr_b16 v[234:235], v27 offset:0
    ds_read_b64_tr_b16 v[240:241], v24 offset:64
    ds_read_b64_tr_b16 v[242:243], v25 offset:64
    ds_read_b64_tr_b16 v[248:249], v26 offset:64
    ds_read_b64_tr_b16 v[250:251], v27 offset:64
    s_waitcnt lgkmcnt(0)
    ds_read_b64_tr_b16 v[228:229], v24 offset:4096
    ds_read_b64_tr_b16 v[230:231], v25 offset:4096
    ds_read_b64_tr_b16 v[236:237], v26 offset:4096
    ds_read_b64_tr_b16 v[238:239], v27 offset:4096
    ds_read_b64_tr_b16 v[244:245], v24 offset:4160
    ds_read_b64_tr_b16 v[246:247], v25 offset:4160
    ds_read_b64_tr_b16 v[252:253], v26 offset:4160
    ds_read_b64_tr_b16 v[254:255], v27 offset:4160
    s_waitcnt lgkmcnt(0)
    v_lshrrev_b32 v21, 4, v20
    s_mul_i32 s21, s25, 18560
    s_add_u32 s21, s21, 16384
    v_add_u32 v1, s21, v0
    v_and_b32 v23, 15, v20
    v_mul_u32_u24 v21, 136, v21
    v_lshl_add_u32 v21, v23, 3, v21
    v_add_u32 v45, s21, v21
    s_lshl_b32 s53, s25, 13
    s_add_u32 s53, s53, 92160
    v_add_u32 v49, s53, v0
    v_mov_b32 v48, 0
    v_mov_b32 v4, 0x3f803f80
    v_mov_b32 v5, 0x3f803f80
    v_mov_b32 v6, 0x3f803f80
    v_mov_b32 v7, 0x3f803f80
    v_mov_b32 v8, 0
    v_mov_b32 v9, 0
    v_mov_b32 v10, 0
    v_mov_b32 v11, 0
    v_lshlrev_b32 v43, 2, v20
    v_mov_b32 v26, 0x44444444
    v_mov_b32 v27, 0xeeeeeeee
    v_and_b32 v28, 1, v20
    v_cmp_eq_u32 vcc, 0, v28
    s_mov_b32 s47, 0x3e0293ee
    s_lshl_b32 s32, s12, 15
    v_cndmask_b32 v41, v27, v26, vcc
    s_lshl_b32 s21, s25, 13
    s_add_u32 s32, s32, s21
    s_add_u32 s32, s32, 2097152
    s_lshl_b32 s21, s25, 2
    s_add_u32 s21, s21, 13312
    v_mov_b32 v47, s21
    s_lshl_b32 s27, s13, 2
    s_add_u32 s27, s27, s25
    s_lshl_b32 s62, s12, 7
    s_add_u32 s62, s62, 218112000
    s_lshl_b32 s33, s12, 14
    s_lshl_b32 s21, s25, 12
    s_add_u32 s33, s33, s21
    s_add_u32 s33, s33, 1179648
    v_mov_b32 v139, 0
    v_mov_b32 v140, 0
    v_mov_b32 v141, 0
    v_mov_b32 v143, 0
    v_mov_b32 v144, 0
    v_mov_b32 v145, 0
    v_mov_b32 v40, 0
    v_mov_b32 v42, 0
    v_mov_b32 v44, 0
    v_mov_b32 v46, 0
    s_cmp_lg_u32 s3, 4
    s_cbranch_scc1 ch_xcc_skip
    v_add_u32 v56, 128, v43
    v_writelane_b32 v56, 0, 4
    v_mov_b32 v59, 63
    v_writelane_b32 v59, -1, 4
    v_mov_b32 v60, 32
    s_movk_i32 s21, 128
    v_writelane_b32 v60, s21, 4
    s_mov_b64 exec, 0x1f
ch_xcc:
    buffer_load_dword v57, v56, s[64:67], 0 offen sc1
    s_waitcnt vmcnt(0)
    v_and_b32 v62, v59, v57
    v_cmp_ne_u32 vcc, v62, v60
    s_cbranch_vccz ch_xcc_ok
    s_sleep 16
    s_sub_u32 s26, s26, 1
    s_cbranch_scc0 ch_xcc
    s_mov_b32 s26, 0
ch_xcc_ok:
    s_lshr_b32 s22, s12, 1
    v_readlane_b32 s23, v57, 0
    s_nop 2
    v_readlane_b32 s21, v57, s22
    s_mov_b64 exec, -1
    v_mov_b32 v58, 131072
    v_mov_b32 v57, s21
    ds_write_b32 v58, v57
    s_bfe_u32 s23, s23, 0x1000f
    v_and_b32 v60, 0x70, v0
    v_lshlrev_b32 v60, 3, v60
    s_mov_b32 s22, 218112000
ch_pgv:
    buffer_load_dword v61, v60, s[4:7], s22 offen offset:8 sc1
    s_waitcnt vmcnt(0) lgkmcnt(0)
    v_and_b32 v62, 1, v61
    v_cmp_eq_u32 vcc, 0, v62
    s_cbranch_vccz ch_pgvok
    s_sleep 8
    s_sub_u32 s26, s26, 1
    s_cbranch_scc0 ch_pgv
    s_mov_b32 s26, 0
ch_pgvok:
    v_bfe_u32 v62, v61, 1, 1
    v_ashrrev_i32 v61, 8, v61
    v_sub_u32 v59, 0, v61
    v_cmp_eq_u32 vcc, s23, v62
    s_mov_b32 s21, 0
    s_nop 1
    v_cndmask_b32 v61, v59, v61, vcc
    s_nop 1
    v_readlane_b32 s22, v61, 0
    s_add_i32 s21, s21, s22
    v_readlane_b32 s22, v61, 1
    s_add_i32 s21, s21, s22
    v_readlane_b32 s22, v61, 2
    s_add_i32 s21, s21, s22
    v_readlane_b32 s22, v61, 3
    s_add_i32 s21, s21, s22
    v_readlane_b32 s22, v61, 4
    s_add_i32 s21, s21, s22
    v_readlane_b32 s22, v61, 5
    s_add_i32 s21, s21, s22
    v_readlane_b32 s22, v61, 6
    s_add_i32 s21, s21, s22
    v_readlane_b32 s22, v61, 7
    s_add_i32 s21, s21, s22
    s_cmp_gt_i32 s21, 0
    s_cselect_b32 s21, 0x2000, 0
    v_mov_b32 v59, s21
    ds_write_b32 v58, v59 offset:4
    s_waitcnt lgkmcnt(0)
ch_xcc_skip:
    s_barrier
    s_barrier
    s_lshl_b32 s60, s12, 4
    s_add_u32 s60, s60, 218104320
ch_g0:
    buffer_load_dword v57, off, s[4:7], s60 sc1
    s_waitcnt vmcnt(0)
    v_readfirstlane_b32 s21, v57
    s_cmp_ge_u32 s21, 12
    s_cbranch_scc1 ch_g0b
    s_sleep 12
    s_sub_u32 s26, s26, 1
    s_cbranch_scc0 ch_g0
    s_mov_b32 s26, 0
ch_g0b:
    s_add_u32 s21, s16, 0
    s_lshl_b32 s21, s21, 18
    s_add_u32 s21, s21, s46
    s_add_u32 s21, s21, 37748736
    s_add_u32 s22, s21, 131072
    buffer_load_dwordx4 v[160:163], v0, s[4:7], s21 offen offset:0 sc1
    buffer_load_dwordx4 v[164:167], v0, s[4:7], s21 offen offset:1024 sc1
    buffer_load_dwordx4 v[168:171], v0, s[4:7], s21 offen offset:2048 sc1
    buffer_load_dwordx4 v[172:175], v0, s[4:7], s21 offen offset:3072 sc1
    buffer_load_dwordx4 v[176:179], v0, s[4:7], s22 offen offset:0 sc1
    buffer_load_dwordx4 v[180:183], v0, s[4:7], s22 offen offset:1024 sc1
    buffer_load_dwordx4 v[184:187], v0, s[4:7], s22 offen offset:2048 sc1
    buffer_load_dwordx4 v[188:191], v0, s[4:7], s22 offen offset:3072 sc1
    s_waitcnt vmcnt(0)
    v_mfma_f32_16x16x32_bf16 v[50:53], v[160:163], v[192:195], 0
    v_mfma_f32_16x16x32_bf16 v[54:57], v[160:163], v[200:203], 0
    v_mfma_f32_16x16x32_bf16 v[58:61], v[160:163], v[208:211], 0
    v_mfma_f32_16x16x32_bf16 v[62:65], v[160:163], v[216:219], 0
    v_mfma_f32_16x16x32_bf16 v[66:69], v[176:179], v[192:195], 0
    v_mfma_f32_16x16x32_bf16 v[70:73], v[176:179], v[200:203], 0
    v_mfma_f32_16x16x32_bf16 v[74:77], v[176:179], v[208:211], 0
    v_mfma_f32_16x16x32_bf16 v[78:81], v[176:179], v[216:219], 0
    v_mfma_f32_16x16x32_bf16 v[50:53], v[164:167], v[196:199], v[50:53]
    v_mfma_f32_16x16x32_bf16 v[54:57], v[164:167], v[204:207], v[54:57]
    v_mfma_f32_16x16x32_bf16 v[58:61], v[164:167], v[212:215], v[58:61]
    v_mfma_f32_16x16x32_bf16 v[62:65], v[164:167], v[220:223], v[62:65]
    v_mfma_f32_16x16x32_bf16 v[66:69], v[180:183], v[196:199], v[66:69]
    v_mfma_f32_16x16x32_bf16 v[70:73], v[180:183], v[204:207], v[70:73]
    v_mfma_f32_16x16x32_bf16 v[74:77], v[180:183], v[212:215], v[74:77]
    v_mfma_f32_16x16x32_bf16 v[78:81], v[180:183], v[220:223], v[78:81]
    v_mfma_f32_16x16x32_bf16 v[50:53], v[168:171], v[224:227], v[50:53]
    v_mfma_f32_16x16x32_bf16 v[54:57], v[168:171], v[232:235], v[54:57]
    v_mfma_f32_16x16x32_bf16 v[58:61], v[168:171], v[240:243], v[58:61]
    v_mfma_f32_16x16x32_bf16 v[62:65], v[168:171], v[248:251], v[62:65]
    v_mfma_f32_16x16x32_bf16 v[66:69], v[184:187], v[224:227], v[66:69]
    v_mfma_f32_16x16x32_bf16 v[70:73], v[184:187], v[232:235], v[70:73]
    v_mfma_f32_16x16x32_bf16 v[74:77], v[184:187], v[240:243], v[74:77]
    v_mfma_f32_16x16x32_bf16 v[78:81], v[184:187], v[248:251], v[78:81]
    v_mfma_f32_16x16x32_bf16 v[50:53], v[172:175], v[228:231], v[50:53]
    v_mfma_f32_16x16x32_bf16 v[54:57], v[172:175], v[236:239], v[54:57]
    v_mfma_f32_16x16x32_bf16 v[58:61], v[172:175], v[244:247], v[58:61]
    v_mfma_f32_16x16x32_bf16 v[62:65], v[172:175], v[252:255], v[62:65]
    v_mfma_f32_16x16x32_bf16 v[66:69], v[188:191], v[228:231], v[66:69]
    v_mfma_f32_16x16x32_bf16 v[70:73], v[188:191], v[236:239], v[70:73]
    v_mfma_f32_16x16x32_bf16 v[74:77], v[188:191], v[244:247], v[74:77]
    v_mfma_f32_16x16x32_bf16 v[78:81], v[188:191], v[252:255], v[78:81]
    s_nop 7
    v_cvt_pk_bf16_f32 v82, v50, v51
    v_cvt_pk_bf16_f32 v83, v52, v53
    v_cvt_pk_bf16_f32 v84, v66, v67
    v_cvt_pk_bf16_f32 v85, v68, v69
    v_cvt_pk_bf16_f32 v86, v54, v55
    v_cvt_pk_bf16_f32 v87, v56, v57
    v_cvt_pk_bf16_f32 v88, v70, v71
    v_cvt_pk_bf16_f32 v89, v72, v73
    v_cvt_pk_bf16_f32 v90, v58, v59
    v_cvt_pk_bf16_f32 v91, v60, v61
    v_cvt_pk_bf16_f32 v92, v74, v75
    v_cvt_pk_bf16_f32 v93, v76, v77
    v_cvt_pk_bf16_f32 v94, v62, v63
    v_cvt_pk_bf16_f32 v95, v64, v65
    v_cvt_pk_bf16_f32 v96, v78, v79
    v_cvt_pk_bf16_f32 v97, v80, v81
.p2align 6
aloop_23:
    s_add_u32 s21, s17, s32
    s_add_u32 s22, s21, 4096
    v_mov_b32 v74, 0
    v_mov_b32 v75, 0
    v_mov_b32 v76, 0
    v_mov_b32 v77, 0
    v_mov_b32 v78, 0
    v_mov_b32 v79, 0
    v_mov_b32 v80, 0
    v_mov_b32 v81, 0
    v_mov_b32 v146, 0
    v_mov_b32 v147, 0
    v_mov_b32 v148, 0
    v_mov_b32 v149, 0
    v_mov_b32 v150, 0
    v_mov_b32 v151, 0
    v_mov_b32 v152, 0
    v_mov_b32 v153, 0
    s_add_u32 s30, s16, 1
    s_lshl_b32 s30, s30, 18
    s_add_u32 s30, s30, s46
    s_add_u32 s30, s30, 37748736
    s_add_u32 s31, s30, 131072
aloop_23_wm:
    ds_read_b32 v3, v47
    s_waitcnt lgkmcnt(0)
    v_readfirstlane_b32 s23, v3
    s_cmp_eq_u32 s23, s16
    s_cbranch_scc1 aloop_23_wmok
    s_sleep 1
    s_branch aloop_23_wm
aloop_23_wmok:
    buffer_load_dwordx4 v[160:163], v0, s[4:7], s30 offen offset:0 sc1
    buffer_load_dwordx4 v[164:167], v0, s[4:7], s30 offen offset:1024 sc1
    buffer_load_dwordx4 v[168:171], v0, s[4:7], s30 offen offset:2048 sc1
    buffer_load_dwordx4 v[172:175], v0, s[4:7], s30 offen offset:3072 sc1
    buffer_load_dwordx4 v[176:179], v0, s[4:7], s31 offen offset:0 sc1
    buffer_load_dwordx4 v[180:183], v0, s[4:7], s31 offen offset:1024 sc1
    buffer_load_dwordx4 v[184:187], v0, s[4:7], s31 offen offset:2048 sc1
    buffer_load_dwordx4 v[188:191], v0, s[4:7], s31 offen offset:3072 sc1
    s_setprio 2
    v_mov_b32 v2, s16
    s_barrier
    s_nop 15
    s_nop 13
    ds_read_b128 v[98:101], v49 offset:0
    ds_read_b128 v[102:105], v49 offset:1024
    ds_read_b128 v[106:109], v49 offset:2048
    ds_read_b128 v[110:113], v49 offset:3072
    ds_read_b128 v[114:117], v49 offset:4096
    ds_read_b128 v[118:121], v49 offset:5120
    ds_read_b128 v[122:125], v49 offset:6144
    ds_read_b128 v[126:129], v49 offset:7168
    v_mov_b32 v12, 0
    v_mov_b32 v13, 0
    v_mov_b32 v14, 0
    v_mov_b32 v15, 0
    v_mov_b32 v16, 0
    v_mov_b32 v17, 0
    v_mov_b32 v18, 0
    v_mov_b32 v19, 0
    v_mov_b32 v20, 0
    v_mov_b32 v21, 0
    v_mov_b32 v22, 0
    v_mov_b32 v23, 0
    s_sleep 4
    s_nop 2
    buffer_load_dwordx4 v[50:53], v0, s[4:7], s21 offen offset:0 sc1
    s_nop 7
    buffer_load_dwordx4 v[54:57], v0, s[4:7], s21 offen offset:1024 sc1
    s_nop 7
    buffer_load_dwordx4 v[58:61], v0, s[4:7], s21 offen offset:2048 sc1
    s_nop 7
    buffer_load_dwordx4 v[62:65], v0, s[4:7], s21 offen offset:3072 sc1
    s_nop 7
    buffer_load_dwordx4 v[66:69], v0, s[4:7], s22 offen offset:0 sc1
    s_nop 7
    buffer_load_dwordx4 v[70:73], v0, s[4:7], s22 offen offset:1024 sc1
    s_waitcnt lgkmcnt(0)
    s_waitcnt vmcnt(5)
    v_max3_u32 v3, v50, v51, v52
    v_max_u32 v3, v3, v53
    v_cmp_eq_u32 vcc, -1, v3
    s_cbranch_vccnz arq_24_0
arq_24_0ok:
    v_mfma_f32_16x16x32_bf16 v[12:15], v[98:101], v[50:53], v[12:15]
    v_mfma_f32_16x16x32_bf16 v[16:19], v[114:117], v[50:53], v[16:19]
    s_waitcnt vmcnt(4)
    v_max3_u32 v3, v54, v55, v56
    v_max_u32 v3, v3, v57
    v_cmp_eq_u32 vcc, -1, v3
    v_mfma_f32_16x16x32_bf16 v[20:23], v[50:53], v[50:53], v[20:23]
    s_cbranch_vccnz arq_24_1
arq_24_1ok:
    v_mfma_f32_16x16x32_bf16 v[12:15], v[102:105], v[54:57], v[12:15]
    v_mfma_f32_16x16x32_bf16 v[16:19], v[118:121], v[54:57], v[16:19]
    s_waitcnt vmcnt(3)
    v_max3_u32 v3, v58, v59, v60
    v_max_u32 v3, v3, v61
    v_cmp_eq_u32 vcc, -1, v3
    v_mfma_f32_16x16x32_bf16 v[20:23], v[54:57], v[54:57], v[20:23]
    s_cbranch_vccnz arq_24_2
arq_24_2ok:
    v_mfma_f32_16x16x32_bf16 v[12:15], v[106:109], v[58:61], v[12:15]
    v_mfma_f32_16x16x32_bf16 v[16:19], v[122:125], v[58:61], v[16:19]
    s_waitcnt vmcnt(2)
    v_max3_u32 v3, v62, v63, v64
    v_max_u32 v3, v3, v65
    v_cmp_eq_u32 vcc, -1, v3
    v_mfma_f32_16x16x32_bf16 v[20:23], v[58:61], v[58:61], v[20:23]
    s_cbranch_vccnz arq_24_3
arq_24_3ok:
    v_mfma_f32_16x16x32_bf16 v[12:15], v[110:113], v[62:65], v[12:15]
    v_mfma_f32_16x16x32_bf16 v[16:19], v[126:129], v[62:65], v[16:19]
    v_mfma_f32_16x16x32_bf16 v[20:23], v[62:65], v[62:65], v[20:23]
aloop_23_sdone:
    ds_write_b32 v47, v2 offset:16
    s_cmp_eq_u32 s16, 63
    s_cbranch_scc1 aloop_23_lsk
    s_nop 1
    v_max3_f32 v2, v12, v13, v14
    v_max3_f32 v3, v15, v16, v17
    v_max3_f32 v2, v2, v18, v19
    s_nop 0
    v_max3_f32 v3, v3, v20, v21
    v_max_f32 v2, v2, v3
    v_mov_b32 v3, v2
    s_nop 1
    v_permlane16_swap_b32 v3, v2
    v_max_f32 v2, v2, v3
    v_mov_b32 v3, v2
    s_waitcnt vmcnt(0)
    v_max3_u32 v24, v66, v67, v68
    v_permlane32_swap_b32 v3, v2
    v_max3_u32 v24, v24, v69, v70
    v_max_f32 v2, v2, v3
    v_max3_u32 v24, v24, v71, v72
    v_mul_f32 v2, s47, v2
    v_max_u32 v24, v24, v73
    v_fma_f32 v12, v12, s47, -v2
    v_cmp_eq_u32 vcc, -1, v24
    v_fma_f32 v13, v13, s47, -v2
    s_cbranch_vccnz arq_24_v
    v_fma_f32 v14, v14, s47, -v2
    v_smfmac_f32_16x16x64_bf16 v[74:77], v[66:69], v[192:199], v41
    v_exp_f32 v12, v12
    v_fma_f32 v15, v15, s47, -v2
    v_smfmac_f32_16x16x64_bf16 v[78:81], v[66:69], v[200:207], v41
    v_exp_f32 v13, v13
    v_fma_f32 v16, v16, s47, -v2
    v_smfmac_f32_16x16x64_bf16 v[146:149], v[66:69], v[208:215], v41
    v_exp_f32 v14, v14
    v_fma_f32 v17, v17, s47, -v2
    v_smfmac_f32_16x16x64_bf16 v[150:153], v[66:69], v[216:223], v41
    v_exp_f32 v15, v15
    v_fma_f32 v18, v18, s47, -v2
    v_smfmac_f32_16x16x64_bf16 v[74:77], v[70:73], v[224:231], v41
    v_exp_f32 v16, v16
    v_fma_f32 v19, v19, s47, -v2
    v_smfmac_f32_16x16x64_bf16 v[78:81], v[70:73], v[232:239], v41
    v_exp_f32 v17, v17
    v_fma_f32 v20, v20, s47, -v2
    v_smfmac_f32_16x16x64_bf16 v[146:149], v[70:73], v[240:247], v41
    v_exp_f32 v18, v18
    v_fma_f32 v21, v21, s47, -v2
    v_smfmac_f32_16x16x64_bf16 v[150:153], v[70:73], v[248:255], v41
    v_exp_f32 v19, v19
    v_exp_f32 v20, v20
    v_exp_f32 v21, v21
    v_cvt_pk_bf16_f32 v12, v12, v13
    v_cvt_pk_bf16_f32 v13, v14, v15
    v_cvt_pk_bf16_f32 v14, v16, v17
    v_cvt_pk_bf16_f32 v15, v18, v19
    v_cvt_pk_bf16_f32 v8, v20, v21
    v_add_f32 v74, v74, v75
    v_mfma_f32_16x16x32_bf16 v[16:19], v[12:15], v[4:7], 0
    v_add_f32 v76, v76, v77
    v_mfma_f32_16x16x32_bf16 v[16:19], v[8:11], v[4:7], v[16:19]
    v_cvt_pk_bf16_f32 v40, v74, v76
    v_mfma_f32_16x16x32_bf16 v[24:27], v[12:15], v[82:85], 0
    v_add_f32 v78, v78, v79
    v_add_f32 v80, v80, v81
    v_mfma_f32_16x16x32_bf16 v[24:27], v[8:11], v[40:43], v[24:27]
    v_cvt_pk_bf16_f32 v42, v78, v80
    v_add_f32 v146, v146, v147
    v_mfma_f32_16x16x32_bf16 v[28:31], v[12:15], v[86:89], 0
    v_add_f32 v148, v148, v149
    v_cvt_pk_bf16_f32 v44, v146, v148
    v_mfma_f32_16x16x32_bf16 v[28:31], v[8:11], v[42:45], v[28:31]
    v_add_f32 v150, v150, v151
    v_add_f32 v152, v152, v153
    v_mfma_f32_16x16x32_bf16 v[32:35], v[12:15], v[90:93], 0
    v_cvt_pk_bf16_f32 v46, v150, v152
    v_rcp_f32 v18, v18
    v_mfma_f32_16x16x32_bf16 v[32:35], v[8:11], v[44:47], v[32:35]
    v_rcp_f32 v19, v19
    v_mfma_f32_16x16x32_bf16 v[36:39], v[12:15], v[94:97], 0
    v_mul_f32 v26, v26, v18
    v_mul_f32 v27, v27, v19
    v_mfma_f32_16x16x32_bf16 v[36:39], v[8:11], v[46:49], v[36:39]
    v_mul_f32 v30, v30, v18
    v_mul_f32 v31, v31, v19
    ds_write_b64 v45, v[26:27] offset:0
    ds_write_b64 v45, v[30:31] offset:544
aloop_23_pvd:
    v_mul_f32 v34, v34, v18
    v_mul_f32 v35, v35, v19
    s_nop 1
    v_mul_f32 v38, v38, v18
    v_mul_f32 v39, v39, v19
    ds_write_b64 v45, v[34:35] offset:1088
    ds_write_b64 v45, v[38:39] offset:1632
aloop_23_lskb:
    s_waitcnt lgkmcnt(0)
    s_barrier
    s_setprio 0
    s_add_u32 s21, s17, s33
    s_cmp_eq_u32 s16, 63
    s_cbranch_scc1 aloop_23_nvw
    v_mfma_f32_16x16x32_bf16 v[50:53], v[160:163], v[192:195], 0
    v_mfma_f32_16x16x32_bf16 v[54:57], v[160:163], v[200:203], 0
    v_mfma_f32_16x16x32_bf16 v[58:61], v[160:163], v[208:211], 0
    v_mfma_f32_16x16x32_bf16 v[62:65], v[160:163], v[216:219], 0
    v_mfma_f32_16x16x32_bf16 v[66:69], v[176:179], v[192:195], 0
    v_mfma_f32_16x16x32_bf16 v[70:73], v[176:179], v[200:203], 0
    v_mfma_f32_16x16x32_bf16 v[74:77], v[176:179], v[208:211], 0
    v_mfma_f32_16x16x32_bf16 v[78:81], v[176:179], v[216:219], 0
    v_mfma_f32_16x16x32_bf16 v[50:53], v[164:167], v[196:199], v[50:53]
    v_mfma_f32_16x16x32_bf16 v[54:57], v[164:167], v[204:207], v[54:57]
    v_mfma_f32_16x16x32_bf16 v[58:61], v[164:167], v[212:215], v[58:61]
    v_mfma_f32_16x16x32_bf16 v[62:65], v[164:167], v[220:223], v[62:65]
    v_mfma_f32_16x16x32_bf16 v[66:69], v[180:183], v[196:199], v[66:69]
    v_mfma_f32_16x16x32_bf16 v[70:73], v[180:183], v[204:207], v[70:73]
    v_mfma_f32_16x16x32_bf16 v[74:77], v[180:183], v[212:215], v[74:77]
    v_mfma_f32_16x16x32_bf16 v[78:81], v[180:183], v[220:223], v[78:81]
    v_mfma_f32_16x16x32_bf16 v[50:53], v[168:171], v[224:227], v[50:53]
    v_mfma_f32_16x16x32_bf16 v[54:57], v[168:171], v[232:235], v[54:57]
    v_mfma_f32_16x16x32_bf16 v[58:61], v[168:171], v[240:243], v[58:61]
    v_mfma_f32_16x16x32_bf16 v[62:65], v[168:171], v[248:251], v[62:65]
    v_mfma_f32_16x16x32_bf16 v[66:69], v[184:187], v[224:227], v[66:69]
    v_mfma_f32_16x16x32_bf16 v[70:73], v[184:187], v[232:235], v[70:73]
    v_mfma_f32_16x16x32_bf16 v[74:77], v[184:187], v[240:243], v[74:77]
    v_mfma_f32_16x16x32_bf16 v[78:81], v[184:187], v[248:251], v[78:81]
    v_mfma_f32_16x16x32_bf16 v[50:53], v[172:175], v[228:231], v[50:53]
    v_mfma_f32_16x16x32_bf16 v[54:57], v[172:175], v[236:239], v[54:57]
    v_mfma_f32_16x16x32_bf16 v[58:61], v[172:175], v[244:247], v[58:61]
    v_mfma_f32_16x16x32_bf16 v[62:65], v[172:175], v[252:255], v[62:65]
    v_mfma_f32_16x16x32_bf16 v[66:69], v[188:191], v[228:231], v[66:69]
    v_mfma_f32_16x16x32_bf16 v[70:73], v[188:191], v[236:239], v[70:73]
    v_mfma_f32_16x16x32_bf16 v[74:77], v[188:191], v[244:247], v[74:77]
    v_mfma_f32_16x16x32_bf16 v[78:81], v[188:191], v[252:255], v[78:81]
aloop_23_nvw:
    buffer_load_dwordx4 v[130:133], v0, s[4:7], s21 offen sc1
    buffer_load_dword v138, v43, s[4:7], s21 offen offset:1024 sc1
    buffer_load_dwordx4 v[134:137], v0, s[4:7], s21 offen offset:2048 sc1
    buffer_load_dword v142, v43, s[4:7], s21 offen offset:3072 sc1
    s_cmp_lg_u32 s27, 0
    s_cbranch_scc1 pg_25
    s_sub_u32 s25, s16, 2
    s_cbranch_scc1 pg_25
    v_mov_b32 v3, s25
    s_mov_b64 exec, 1
    buffer_store_dword v3, off, s[4:7], s62 sc1
    s_mov_b64 exec, -1
pg_25:
    v_add_u32 v48, s68, v1
    s_xor_b32 s68, s68, 8192
aloop_23_psa:
    s_waitcnt vmcnt(0)
    v_max3_u32 v3, v130, v131, v132
    v_max3_u32 v3, v3, v133, v134
    v_max3_u32 v3, v3, v135, v136
    v_max3_u32 v3, v3, v137, v138
    v_max_u32 v3, v3, v142
    v_cmp_eq_u32 vcc, -1, v3
    s_cbranch_vccnz arq_24_ps
aloop_23_psok:
    v_mfma_f32_16x16x32_bf16 v[24:27], v[82:85], v[130:133], 0
    v_mfma_f32_16x16x32_bf16 v[24:27], v[40:43], v[138:141], v[24:27]
    v_mfma_f32_16x16x32_bf16 v[28:31], v[86:89], v[130:133], 0
    v_mfma_f32_16x16x32_bf16 v[28:31], v[42:45], v[138:141], v[28:31]
    v_mfma_f32_16x16x32_bf16 v[32:35], v[90:93], v[130:133], 0
    v_mfma_f32_16x16x32_bf16 v[32:35], v[44:47], v[138:141], v[32:35]
    v_mfma_f32_16x16x32_bf16 v[36:39], v[94:97], v[130:133], 0
    v_mfma_f32_16x16x32_bf16 v[36:39], v[46:49], v[138:141], v[36:39]
    v_mfma_f32_16x16x32_bf16 v[12:15], v[82:85], v[134:137], 0
    v_mfma_f32_16x16x32_bf16 v[12:15], v[40:43], v[142:145], v[12:15]
    v_mfma_f32_16x16x32_bf16 v[16:19], v[86:89], v[134:137], 0
    v_mfma_f32_16x16x32_bf16 v[16:19], v[42:45], v[142:145], v[16:19]
    v_mfma_f32_16x16x32_bf16 v[20:23], v[90:93], v[134:137], 0
    v_mfma_f32_16x16x32_bf16 v[20:23], v[44:47], v[142:145], v[20:23]
    v_mfma_f32_16x16x32_bf16 v[154:157], v[94:97], v[134:137], 0
    v_mfma_f32_16x16x32_bf16 v[154:157], v[46:49], v[142:145], v[154:157]
    ds_write_b128 v48, v[24:27] offset:2176
    v_cvt_pk_bf16_f32 v82, v50, v51
    v_cvt_pk_bf16_f32 v83, v52, v53
    ds_write_b128 v48, v[28:31] offset:3200
    v_cvt_pk_bf16_f32 v84, v66, v67
    v_cvt_pk_bf16_f32 v85, v68, v69
    ds_write_b128 v48, v[32:35] offset:4224
    v_cvt_pk_bf16_f32 v86, v54, v55
    v_cvt_pk_bf16_f32 v87, v56, v57
    ds_write_b128 v48, v[36:39] offset:5248
    v_cvt_pk_bf16_f32 v88, v70, v71
    v_cvt_pk_bf16_f32 v89, v72, v73
    ds_write_b128 v48, v[12:15] offset:6272
    v_cvt_pk_bf16_f32 v90, v58, v59
    v_cvt_pk_bf16_f32 v91, v60, v61
    ds_write_b128 v48, v[16:19] offset:7296
    v_cvt_pk_bf16_f32 v92, v74, v75
    v_cvt_pk_bf16_f32 v93, v76, v77
    ds_write_b128 v48, v[20:23] offset:8320
    v_cvt_pk_bf16_f32 v94, v62, v63
    v_cvt_pk_bf16_f32 v95, v64, v65
    ds_write_b128 v48, v[154:157] offset:9344
    v_cvt_pk_bf16_f32 v96, v78, v79
    v_cvt_pk_bf16_f32 v97, v80, v81
aloop_23_bgskip:
    s_waitcnt lgkmcnt(0)
    s_cmp_eq_u32 s16, 63
    s_cbranch_scc1 aloop_23_fin
    s_add_u32 s16, s16, 1
    s_mov_b32 s17, s18
    s_mov_b32 s18, s19
    s_mov_b32 s19, s20
    s_add_u32 s20, s20, 262144
    s_cmp_eq_u32 s20, 210763776
    s_cselect_b32 s20, 209715200, s20
    s_branch aloop_23
arq_24_0:
    s_sub_u32 s26, s26, 1
    s_cbranch_scc1 arq_24_0_g
    buffer_load_dwordx4 v[50:53], v0, s[4:7], s21 offen offset:0 sc1
    buffer_load_dwordx4 v[54:57], v0, s[4:7], s21 offen offset:1024 sc1
    buffer_load_dwordx4 v[58:61], v0, s[4:7], s21 offen offset:2048 sc1
    buffer_load_dwordx4 v[62:65], v0, s[4:7], s21 offen offset:3072 sc1
    buffer_load_dwordx4 v[66:69], v0, s[4:7], s22 offen offset:0 sc1
    buffer_load_dwordx4 v[70:73], v0, s[4:7], s22 offen offset:1024 sc1
    s_waitcnt vmcnt(5)
    v_max3_u32 v3, v50, v51, v52
    v_max_u32 v3, v3, v53
    v_cmp_eq_u32 vcc, -1, v3
    s_cbranch_vccnz arq_24_0
    s_branch arq_24_0ok
arq_24_0_g:
    s_mov_b32 s26, 0
    s_waitcnt vmcnt(0)
    s_branch arq_24_0ok
arq_24_1:
    s_sub_u32 s26, s26, 1
    s_cbranch_scc1 arq_24_1_g
    buffer_load_dwordx4 v[54:57], v0, s[4:7], s21 offen offset:1024 sc1
    buffer_load_dwordx4 v[58:61], v0, s[4:7], s21 offen offset:2048 sc1
    buffer_load_dwordx4 v[62:65], v0, s[4:7], s21 offen offset:3072 sc1
    buffer_load_dwordx4 v[66:69], v0, s[4:7], s22 offen offset:0 sc1
    buffer_load_dwordx4 v[70:73], v0, s[4:7], s22 offen offset:1024 sc1
    s_waitcnt vmcnt(4)
    v_max3_u32 v3, v54, v55, v56
    v_max_u32 v3, v3, v57
    v_cmp_eq_u32 vcc, -1, v3
    s_cbranch_vccnz arq_24_1
    s_branch arq_24_1ok
arq_24_1_g:
    s_mov_b32 s26, 0
    s_waitcnt vmcnt(0)
    s_branch arq_24_1ok
arq_24_2:
    s_sub_u32 s26, s26, 1
    s_cbranch_scc1 arq_24_2_g
    buffer_load_dwordx4 v[58:61], v0, s[4:7], s21 offen offset:2048 sc1
    buffer_load_dwordx4 v[62:65], v0, s[4:7], s21 offen offset:3072 sc1
    buffer_load_dwordx4 v[66:69], v0, s[4:7], s22 offen offset:0 sc1
    buffer_load_dwordx4 v[70:73], v0, s[4:7], s22 offen offset:1024 sc1
    s_waitcnt vmcnt(3)
    v_max3_u32 v3, v58, v59, v60
    v_max_u32 v3, v3, v61
    v_cmp_eq_u32 vcc, -1, v3
    s_cbranch_vccnz arq_24_2
    s_branch arq_24_2ok
arq_24_2_g:
    s_mov_b32 s26, 0
    s_waitcnt vmcnt(0)
    s_branch arq_24_2ok
arq_24_3:
    s_sub_u32 s26, s26, 1
    s_cbranch_scc1 arq_24_3_g
    buffer_load_dwordx4 v[62:65], v0, s[4:7], s21 offen offset:3072 sc1
    buffer_load_dwordx4 v[66:69], v0, s[4:7], s22 offen offset:0 sc1
    buffer_load_dwordx4 v[70:73], v0, s[4:7], s22 offen offset:1024 sc1
    s_waitcnt vmcnt(2)
    v_max3_u32 v3, v62, v63, v64
    v_max_u32 v3, v3, v65
    v_cmp_eq_u32 vcc, -1, v3
    s_cbranch_vccnz arq_24_3
    s_branch arq_24_3ok
arq_24_3_g:
    s_mov_b32 s26, 0
    s_waitcnt vmcnt(0)
    s_branch arq_24_3ok
arq_24_v:
    buffer_load_dwordx4 v[66:69], v0, s[4:7], s22 offen offset:0 sc1
    buffer_load_dwordx4 v[70:73], v0, s[4:7], s22 offen offset:1024 sc1
    v_fma_f32 v14, v14, s47, -v2
    v_exp_f32 v12, v12
    v_fma_f32 v15, v15, s47, -v2
    v_exp_f32 v13, v13
    v_fma_f32 v16, v16, s47, -v2
    v_exp_f32 v14, v14
    v_fma_f32 v17, v17, s47, -v2
    v_exp_f32 v15, v15
    v_fma_f32 v18, v18, s47, -v2
    v_exp_f32 v16, v16
    v_fma_f32 v19, v19, s47, -v2
    v_exp_f32 v17, v17
    v_fma_f32 v20, v20, s47, -v2
    v_exp_f32 v18, v18
    v_fma_f32 v21, v21, s47, -v2
    v_exp_f32 v19, v19
    v_exp_f32 v20, v20
    v_exp_f32 v21, v21
    v_cvt_pk_bf16_f32 v12, v12, v13
    v_cvt_pk_bf16_f32 v13, v14, v15
    v_cvt_pk_bf16_f32 v14, v16, v17
    v_cvt_pk_bf16_f32 v15, v18, v19
    v_cvt_pk_bf16_f32 v8, v20, v21
    s_nop 0
    v_mfma_f32_16x16x32_bf16 v[16:19], v[12:15], v[4:7], 0
    v_mfma_f32_16x16x32_bf16 v[16:19], v[8:11], v[4:7], v[16:19]
    v_mfma_f32_16x16x32_bf16 v[24:27], v[12:15], v[82:85], 0
    v_mfma_f32_16x16x32_bf16 v[28:31], v[12:15], v[86:89], 0
    v_mfma_f32_16x16x32_bf16 v[32:35], v[12:15], v[90:93], 0
    v_mfma_f32_16x16x32_bf16 v[36:39], v[12:15], v[94:97], 0
arq_24_vs:
    s_waitcnt vmcnt(0)
    v_max3_u32 v3, v66, v67, v68
    v_max3_u32 v3, v3, v69, v70
    v_max3_u32 v3, v3, v71, v72
    v_max_u32 v3, v3, v73
    v_cmp_eq_u32 vcc, -1, v3
    s_cbranch_vccnz arq_24_vsr
    s_branch arq_24_vsok
arq_24_vsr:
    s_sub_u32 s26, s26, 1
    s_cbranch_scc1 arq_24_vsg
    buffer_load_dwordx4 v[66:69], v0, s[4:7], s22 offen offset:0 sc1
    buffer_load_dwordx4 v[70:73], v0, s[4:7], s22 offen offset:1024 sc1
    s_branch arq_24_vs
arq_24_vsg:
    s_mov_b32 s26, 0
arq_24_vsok:
    v_smfmac_f32_16x16x64_bf16 v[74:77], v[66:69], v[192:199], v41
    v_smfmac_f32_16x16x64_bf16 v[78:81], v[66:69], v[200:207], v41
    v_smfmac_f32_16x16x64_bf16 v[146:149], v[66:69], v[208:215], v41
    v_smfmac_f32_16x16x64_bf16 v[150:153], v[66:69], v[216:223], v41
    v_smfmac_f32_16x16x64_bf16 v[74:77], v[70:73], v[224:231], v41
    v_smfmac_f32_16x16x64_bf16 v[78:81], v[70:73], v[232:239], v41
    v_smfmac_f32_16x16x64_bf16 v[146:149], v[70:73], v[240:247], v41
    v_smfmac_f32_16x16x64_bf16 v[150:153], v[70:73], v[248:255], v41
    v_rcp_f32 v18, v18
    v_rcp_f32 v19, v19
    s_nop 2
    v_add_f32 v74, v74, v75
    v_add_f32 v76, v76, v77
    v_cvt_pk_bf16_f32 v40, v74, v76
    v_add_f32 v78, v78, v79
    v_add_f32 v80, v80, v81
    v_cvt_pk_bf16_f32 v42, v78, v80
    v_add_f32 v146, v146, v147
    v_add_f32 v148, v148, v149
    v_cvt_pk_bf16_f32 v44, v146, v148
    v_add_f32 v150, v150, v151
    v_add_f32 v152, v152, v153
    v_cvt_pk_bf16_f32 v46, v150, v152
    s_nop 1
    v_mfma_f32_16x16x32_bf16 v[24:27], v[8:11], v[40:43], v[24:27]
    v_mfma_f32_16x16x32_bf16 v[28:31], v[8:11], v[42:45], v[28:31]
    v_mfma_f32_16x16x32_bf16 v[32:35], v[8:11], v[44:47], v[32:35]
    v_mfma_f32_16x16x32_bf16 v[36:39], v[8:11], v[46:49], v[36:39]
    s_nop 4
    v_mul_f32 v26, v26, v18
    v_mul_f32 v27, v27, v19
    ds_write_b64 v45, v[26:27] offset:0
    v_mul_f32 v30, v30, v18
    v_mul_f32 v31, v31, v19
    ds_write_b64 v45, v[30:31] offset:544
    s_branch aloop_23_pvd
aloop_23_lsk:
arq_24_vl:
    s_waitcnt vmcnt(0)
    v_max3_u32 v3, v66, v67, v68
    v_max3_u32 v3, v3, v69, v70
    v_max3_u32 v3, v3, v71, v72
    v_max_u32 v3, v3, v73
    v_cmp_eq_u32 vcc, -1, v3
    s_cbranch_vccnz arq_24_vlr
    s_branch arq_24_vlok
arq_24_vlr:
    s_sub_u32 s26, s26, 1
    s_cbranch_scc1 arq_24_vlg
    buffer_load_dwordx4 v[66:69], v0, s[4:7], s22 offen offset:0 sc1
    buffer_load_dwordx4 v[70:73], v0, s[4:7], s22 offen offset:1024 sc1
    s_branch arq_24_vl
arq_24_vlg:
    s_mov_b32 s26, 0
arq_24_vlok:
    v_smfmac_f32_16x16x64_bf16 v[74:77], v[66:69], v[192:199], v41
    v_smfmac_f32_16x16x64_bf16 v[78:81], v[66:69], v[200:207], v41
    v_smfmac_f32_16x16x64_bf16 v[146:149], v[66:69], v[208:215], v41
    v_smfmac_f32_16x16x64_bf16 v[150:153], v[66:69], v[216:223], v41
    v_smfmac_f32_16x16x64_bf16 v[74:77], v[70:73], v[224:231], v41
    v_smfmac_f32_16x16x64_bf16 v[78:81], v[70:73], v[232:239], v41
    v_smfmac_f32_16x16x64_bf16 v[146:149], v[70:73], v[240:247], v41
    v_smfmac_f32_16x16x64_bf16 v[150:153], v[70:73], v[248:255], v41
    s_nop 4
    v_add_f32 v74, v74, v75
    v_add_f32 v76, v76, v77
    v_cvt_pk_bf16_f32 v40, v74, v76
    v_add_f32 v78, v78, v79
    v_add_f32 v80, v80, v81
    v_cvt_pk_bf16_f32 v42, v78, v80
    v_add_f32 v146, v146, v147
    v_add_f32 v148, v148, v149
    v_cvt_pk_bf16_f32 v44, v146, v148
    v_add_f32 v150, v150, v151
    v_add_f32 v152, v152, v153
    v_cvt_pk_bf16_f32 v46, v150, v152
    s_branch aloop_23_lskb
arq_24_ps:
    s_sub_u32 s26, s26, 1
    s_cbranch_scc1 arq_24_psg
    s_sleep 2
    buffer_load_dwordx4 v[130:133], v0, s[4:7], s21 offen sc1
    buffer_load_dword v138, v43, s[4:7], s21 offen offset:1024 sc1
    buffer_load_dwordx4 v[134:137], v0, s[4:7], s21 offen offset:2048 sc1
    buffer_load_dword v142, v43, s[4:7], s21 offen offset:3072 sc1
    s_branch aloop_23_psa
arq_24_psg:
    s_mov_b32 s26, 0
    s_branch aloop_23_psok
aloop_23_fin:
    s_barrier
    s_branch k_end
k_end:
k_exit:
    s_endpgm
.section .rodata,"a"
.p2align 6
jobtab:
    .long 4, 24, 24, 8192, 0, 262144, 8388608, 0, 32768, 4, 20971520, 131072, 0, 0, 218104320, 1
    .long 4, 24, 24, 8192, 0, 262144, 8388608, 262144, 32768, 4, 22020096, 131072, 0, 0, 218104448, 1
    .long 1, 32, 32, 8192, 0, 256, 8388608, 1048576, 32768, 8, 41943040, 131072, 0, 0, 218104832, 4
    .long 1, 16, 16, 8192, 0, 256, 8388608, 2097152, 32768, 8, 12582912, 131072, 0, 0, 218105344, 4
    .long 1, 32, 32, 8192, 0, 256, 8388608, 3145728, 32768, 8, 50331648, 131072, 0, 0, 218105856, 4
    .long 1, 32, 32, 8192, 0, 256, 8388608, 3670016, 32768, 8, 52428800, 131072, 0, 0, 218106112, 4
    .long 1, 80, 80, 2048, 0, 256, 7340032, 54525952, 114688, 7, 167772160, 32768, 218103808, 7, 218106368, 1
    .long 0, 0, 0, 0, 0, 0, 0, 0, 0, 0, 0, 0, 0, 0, 0, 0
    .long 0, 0, 0, 0, 0, 0, 0, 0, 0, 0, 0, 0, 0, 0, 0, 0
    .long 0, 0, 0, 0, 0, 0, 0, 0, 0, 0, 0, 0, 0, 0, 0, 0
    .long 4, 24, 24, 8192, 2048, 264192, 8388608, 0, 32768, 4, 21004288, 131072, 0, 0, 218104352, 1
    .long 4, 24, 24, 8192, 2048, 264192, 8388608, 262144, 32768, 4, 22052864, 131072, 0, 0, 218104480, 1
    .long 1, 32, 32, 8192, 2048, 2304, 8388608, 1048576, 32768, 8, 41975808, 131072, 0, 0, 218104864, 4
    .long 1, 16, 16, 8192, 2048, 2304, 8388608, 2097152, 32768, 8, 12615680, 131072, 0, 0, 218105376, 4
    .long 1, 32, 32, 8192, 2048, 2304, 8388608, 3145728, 32768, 8, 50364416, 131072, 0, 0, 218105888, 4
    .long 1, 32, 32, 8192, 2048, 2304, 8388608, 3670016, 32768, 8, 52461568, 131072, 0, 0, 218106144, 4
    .long 1, 80, 80, 2048, 512, 768, 7340032, 54525952, 114688, 7, 167780352, 32768, 218103808, 7, 218106368, 1
    .long 0, 0, 0, 0, 0, 0, 0, 0, 0, 0, 0, 0, 0, 0, 0, 0
    .long 0, 0, 0, 0, 0, 0, 0, 0, 0, 0, 0, 0, 0, 0, 0, 0
    .long 0, 0, 0, 0, 0, 0, 0, 0, 0, 0, 0, 0, 0, 0, 0, 0
    .long 4, 24, 24, 8192, 4096, 266240, 8388608, 0, 32768, 4, 21037056, 131072, 0, 0, 218104384, 1
    .long 4, 24, 24, 8192, 4096, 266240, 8388608, 262144, 32768, 4, 22085632, 131072, 0, 0, 218104512, 1
    .long 1, 32, 32, 8192, 4096, 4352, 8388608, 1048576, 32768, 8, 42008576, 131072, 0, 0, 218104896, 4
    .long 1, 16, 16, 8192, 4096, 4352, 8388608, 2097152, 32768, 8, 12648448, 131072, 0, 0, 218105408, 4
    .long 1, 32, 32, 8192, 4096, 4352, 8388608, 3145728, 32768, 8, 50397184, 131072, 0, 0, 218105920, 4
    .long 1, 32, 32, 8192, 4096, 4352, 8388608, 3670016, 32768, 8, 52494336, 131072, 0, 0, 218106176, 4
    .long 1, 80, 80, 2048, 1024, 1280, 7340032, 54525952, 114688, 7, 167788544, 32768, 218103808, 7, 218106368, 1
    .long 0, 0, 0, 0, 0, 0, 0, 0, 0, 0, 0, 0, 0, 0, 0, 0
    .long 0, 0, 0, 0, 0, 0, 0, 0, 0, 0, 0, 0, 0, 0, 0, 0
    .long 0, 0, 0, 0, 0, 0, 0, 0, 0, 0, 0, 0, 0, 0, 0, 0
    .long 4, 24, 24, 8192, 6144, 268288, 8388608, 0, 32768, 4, 21069824, 131072, 0, 0, 218104416, 1
    .long 4, 24, 24, 8192, 6144, 268288, 8388608, 262144, 32768, 4, 22118400, 131072, 0, 0, 218104544, 1
    .long 1, 32, 32, 8192, 6144, 6400, 8388608, 1048576, 32768, 8, 42041344, 131072, 0, 0, 218104928, 4
    .long 1, 16, 16, 8192, 6144, 6400, 8388608, 2097152, 32768, 8, 12681216, 131072, 0, 0, 218105440, 4
    .long 1, 32, 32, 8192, 6144, 6400, 8388608, 3145728, 32768, 8, 50429952, 131072, 0, 0, 218105952, 4
    .long 1, 32, 32, 8192, 6144, 6400, 8388608, 3670016, 32768, 8, 52527104, 131072, 0, 0, 218106208, 4
    .long 1, 80, 80, 2048, 1536, 1792, 7340032, 54525952, 114688, 7, 167796736, 32768, 218103808, 7, 218106368, 1
    .long 0, 0, 0, 0, 0, 0, 0, 0, 0, 0, 0, 0, 0, 0, 0, 0
    .long 0, 0, 0, 0, 0, 0, 0, 0, 0, 0, 0, 0, 0, 0, 0, 0
    .long 0, 0, 0, 0, 0, 0, 0, 0, 0, 0, 0, 0, 0, 0, 0, 0
    .long 4, 24, 24, 8192, 256, 262400, 8388608, 0, 32768, 4, 20975616, 131072, 0, 0, 218104320, 1
    .long 4, 24, 24, 8192, 256, 262400, 8388608, 262144, 32768, 4, 22024192, 131072, 0, 0, 218104448, 1
    .long 1, 32, 32, 8192, 512, 768, 8388608, 1048576, 32768, 8, 41951232, 131072, 0, 0, 218104832, 4
    .long 1, 16, 16, 8192, 512, 768, 8388608, 2097152, 32768, 8, 12591104, 131072, 0, 0, 218105344, 4
    .long 1, 32, 32, 8192, 512, 768, 8388608, 3145728, 32768, 8, 50339840, 131072, 0, 0, 218105856, 4
    .long 1, 32, 32, 8192, 512, 768, 8388608, 3670016, 32768, 8, 52436992, 131072, 0, 0, 218106112, 4
    .long 1, 80, 80, 2048, 1835008, 1835264, 7340032, 54554624, 114688, 7, 171966464, 32768, 218103824, 7, 218106368, 1
    .long 0, 0, 0, 0, 0, 0, 0, 0, 0, 0, 0, 0, 0, 0, 0, 0
    .long 0, 0, 0, 0, 0, 0, 0, 0, 0, 0, 0, 0, 0, 0, 0, 0
    .long 0, 0, 0, 0, 0, 0, 0, 0, 0, 0, 0, 0, 0, 0, 0, 0
    .long 4, 24, 24, 8192, 2304, 264448, 8388608, 0, 32768, 4, 21008384, 131072, 0, 0, 218104352, 1
    .long 4, 24, 24, 8192, 2304, 264448, 8388608, 262144, 32768, 4, 22056960, 131072, 0, 0, 218104480, 1
    .long 1, 32, 32, 8192, 2560, 2816, 8388608, 1048576, 32768, 8, 41984000, 131072, 0, 0, 218104864, 4
    .long 1, 16, 16, 8192, 2560, 2816, 8388608, 2097152, 32768, 8, 12623872, 131072, 0, 0, 218105376, 4
    .long 1, 32, 32, 8192, 2560, 2816, 8388608, 3145728, 32768, 8, 50372608, 131072, 0, 0, 218105888, 4
    .long 1, 32, 32, 8192, 2560, 2816, 8388608, 3670016, 32768, 8, 52469760, 131072, 0, 0, 218106144, 4
    .long 1, 80, 80, 2048, 1835520, 1835776, 7340032, 54554624, 114688, 7, 171974656, 32768, 218103824, 7, 218106368, 1
    .long 0, 0, 0, 0, 0, 0, 0, 0, 0, 0, 0, 0, 0, 0, 0, 0
    .long 0, 0, 0, 0, 0, 0, 0, 0, 0, 0, 0, 0, 0, 0, 0, 0
    .long 0, 0, 0, 0, 0, 0, 0, 0, 0, 0, 0, 0, 0, 0, 0, 0
    .long 4, 24, 24, 8192, 4352, 266496, 8388608, 0, 32768, 4, 21041152, 131072, 0, 0, 218104384, 1
    .long 4, 24, 24, 8192, 4352, 266496, 8388608, 262144, 32768, 4, 22089728, 131072, 0, 0, 218104512, 1
    .long 1, 32, 32, 8192, 4608, 4864, 8388608, 1048576, 32768, 8, 42016768, 131072, 0, 0, 218104896, 4
    .long 1, 16, 16, 8192, 4608, 4864, 8388608, 2097152, 32768, 8, 12656640, 131072, 0, 0, 218105408, 4
    .long 1, 32, 32, 8192, 4608, 4864, 8388608, 3145728, 32768, 8, 50405376, 131072, 0, 0, 218105920, 4
    .long 1, 32, 32, 8192, 4608, 4864, 8388608, 3670016, 32768, 8, 52502528, 131072, 0, 0, 218106176, 4
    .long 1, 80, 80, 2048, 1836032, 1836288, 7340032, 54554624, 114688, 7, 171982848, 32768, 218103824, 7, 218106368, 1
    .long 0, 0, 0, 0, 0, 0, 0, 0, 0, 0, 0, 0, 0, 0, 0, 0
    .long 0, 0, 0, 0, 0, 0, 0, 0, 0, 0, 0, 0, 0, 0, 0, 0
    .long 0, 0, 0, 0, 0, 0, 0, 0, 0, 0, 0, 0, 0, 0, 0, 0
    .long 4, 24, 24, 8192, 6400, 268544, 8388608, 0, 32768, 4, 21073920, 131072, 0, 0, 218104416, 1
    .long 4, 24, 24, 8192, 6400, 268544, 8388608, 262144, 32768, 4, 22122496, 131072, 0, 0, 218104544, 1
    .long 1, 32, 32, 8192, 6656, 6912, 8388608, 1048576, 32768, 8, 42049536, 131072, 0, 0, 218104928, 4
    .long 1, 16, 16, 8192, 6656, 6912, 8388608, 2097152, 32768, 8, 12689408, 131072, 0, 0, 218105440, 4
    .long 1, 32, 32, 8192, 6656, 6912, 8388608, 3145728, 32768, 8, 50438144, 131072, 0, 0, 218105952, 4
    .long 1, 32, 32, 8192, 6656, 6912, 8388608, 3670016, 32768, 8, 52535296, 131072, 0, 0, 218106208, 4
    .long 1, 80, 80, 2048, 1836544, 1836800, 7340032, 54554624, 114688, 7, 171991040, 32768, 218103824, 7, 218106368, 1
    .long 0, 0, 0, 0, 0, 0, 0, 0, 0, 0, 0, 0, 0, 0, 0, 0
    .long 0, 0, 0, 0, 0, 0, 0, 0, 0, 0, 0, 0, 0, 0, 0, 0
    .long 0, 0, 0, 0, 0, 0, 0, 0, 0, 0, 0, 0, 0, 0, 0, 0
    .long 4, 24, 24, 8192, 512, 262656, 8388608, 0, 32768, 4, 20979712, 131072, 0, 0, 218104320, 1
    .long 4, 24, 24, 8192, 512, 262656, 8388608, 262144, 32768, 4, 22028288, 131072, 0, 0, 218104448, 1
    .long 1, 32, 32, 8192, 1024, 1280, 8388608, 1048576, 32768, 8, 41959424, 131072, 0, 0, 218104848, 4
    .long 1, 16, 16, 8192, 1024, 1280, 8388608, 2097152, 32768, 8, 12599296, 131072, 0, 0, 218105360, 4
    .long 1, 32, 32, 8192, 1024, 1280, 8388608, 3145728, 32768, 8, 50348032, 131072, 0, 0, 218105872, 4
    .long 1, 32, 32, 8192, 1024, 1280, 8388608, 3670016, 32768, 8, 52445184, 131072, 0, 0, 218106128, 4
    .long 1, 80, 80, 2048, 3670016, 3670272, 7340032, 54583296, 114688, 7, 176160768, 32768, 218103840, 7, 218106368, 1
    .long 0, 0, 0, 0, 0, 0, 0, 0, 0, 0, 0, 0, 0, 0, 0, 0
    .long 0, 0, 0, 0, 0, 0, 0, 0, 0, 0, 0, 0, 0, 0, 0, 0
    .long 0, 0, 0, 0, 0, 0, 0, 0, 0, 0, 0, 0, 0, 0, 0, 0
    .long 4, 24, 24, 8192, 2560, 264704, 8388608, 0, 32768, 4, 21012480, 131072, 0, 0, 218104352, 1
    .long 4, 24, 24, 8192, 2560, 264704, 8388608, 262144, 32768, 4, 22061056, 131072, 0, 0, 218104480, 1
    .long 1, 32, 32, 8192, 3072, 3328, 8388608, 1048576, 32768, 8, 41992192, 131072, 0, 0, 218104880, 4
    .long 1, 16, 16, 8192, 3072, 3328, 8388608, 2097152, 32768, 8, 12632064, 131072, 0, 0, 218105392, 4
    .long 1, 32, 32, 8192, 3072, 3328, 8388608, 3145728, 32768, 8, 50380800, 131072, 0, 0, 218105904, 4
    .long 1, 32, 32, 8192, 3072, 3328, 8388608, 3670016, 32768, 8, 52477952, 131072, 0, 0, 218106160, 4
    .long 1, 80, 80, 2048, 3670528, 3670784, 7340032, 54583296, 114688, 7, 176168960, 32768, 218103840, 7, 218106368, 1
    .long 0, 0, 0, 0, 0, 0, 0, 0, 0, 0, 0, 0, 0, 0, 0, 0
    .long 0, 0, 0, 0, 0, 0, 0, 0, 0, 0, 0, 0, 0, 0, 0, 0
    .long 0, 0, 0, 0, 0, 0, 0, 0, 0, 0, 0, 0, 0, 0, 0, 0
    .long 4, 24, 24, 8192, 4608, 266752, 8388608, 0, 32768, 4, 21045248, 131072, 0, 0, 218104384, 1
    .long 4, 24, 24, 8192, 4608, 266752, 8388608, 262144, 32768, 4, 22093824, 131072, 0, 0, 218104512, 1
    .long 1, 32, 32, 8192, 5120, 5376, 8388608, 1048576, 32768, 8, 42024960, 131072, 0, 0, 218104912, 4
    .long 1, 16, 16, 8192, 5120, 5376, 8388608, 2097152, 32768, 8, 12664832, 131072, 0, 0, 218105424, 4
    .long 1, 32, 32, 8192, 5120, 5376, 8388608, 3145728, 32768, 8, 50413568, 131072, 0, 0, 218105936, 4
    .long 1, 32, 32, 8192, 5120, 5376, 8388608, 3670016, 32768, 8, 52510720, 131072, 0, 0, 218106192, 4
    .long 1, 80, 80, 2048, 3671040, 3671296, 7340032, 54583296, 114688, 7, 176177152, 32768, 218103840, 7, 218106368, 1
    .long 0, 0, 0, 0, 0, 0, 0, 0, 0, 0, 0, 0, 0, 0, 0, 0
    .long 0, 0, 0, 0, 0, 0, 0, 0, 0, 0, 0, 0, 0, 0, 0, 0
    .long 0, 0, 0, 0, 0, 0, 0, 0, 0, 0, 0, 0, 0, 0, 0, 0
    .long 4, 24, 24, 8192, 6656, 268800, 8388608, 0, 32768, 4, 21078016, 131072, 0, 0, 218104416, 1
    .long 4, 24, 24, 8192, 6656, 268800, 8388608, 262144, 32768, 4, 22126592, 131072, 0, 0, 218104544, 1
    .long 1, 32, 32, 8192, 7168, 7424, 8388608, 1048576, 32768, 8, 42057728, 131072, 0, 0, 218104944, 4
    .long 1, 16, 16, 8192, 7168, 7424, 8388608, 2097152, 32768, 8, 12697600, 131072, 0, 0, 218105456, 4
    .long 1, 32, 32, 8192, 7168, 7424, 8388608, 3145728, 32768, 8, 50446336, 131072, 0, 0, 218105968, 4
    .long 1, 32, 32, 8192, 7168, 7424, 8388608, 3670016, 32768, 8, 52543488, 131072, 0, 0, 218106224, 4
    .long 1, 80, 80, 2048, 3671552, 3671808, 7340032, 54583296, 114688, 7, 176185344, 32768, 218103840, 7, 218106368, 1
    .long 0, 0, 0, 0, 0, 0, 0, 0, 0, 0, 0, 0, 0, 0, 0, 0
    .long 0, 0, 0, 0, 0, 0, 0, 0, 0, 0, 0, 0, 0, 0, 0, 0
    .long 0, 0, 0, 0, 0, 0, 0, 0, 0, 0, 0, 0, 0, 0, 0, 0
    .long 4, 24, 24, 8192, 768, 262912, 8388608, 0, 32768, 4, 20983808, 131072, 0, 0, 218104320, 1
    .long 4, 24, 24, 8192, 768, 262912, 8388608, 262144, 32768, 4, 22032384, 131072, 0, 0, 218104448, 1
    .long 1, 32, 32, 8192, 1536, 1792, 8388608, 1048576, 32768, 8, 41967616, 131072, 0, 0, 218104848, 4
    .long 1, 16, 16, 8192, 1536, 1792, 8388608, 2097152, 32768, 8, 12607488, 131072, 0, 0, 218105360, 4
    .long 1, 32, 32, 8192, 1536, 1792, 8388608, 3145728, 32768, 8, 50356224, 131072, 0, 0, 218105872, 4
    .long 1, 32, 32, 8192, 1536, 1792, 8388608, 3670016, 32768, 8, 52453376, 131072, 0, 0, 218106128, 4
    .long 1, 80, 80, 2048, 5505024, 5505280, 7340032, 54611968, 114688, 7, 180355072, 32768, 218103856, 7, 218106368, 1
    .long 0, 0, 0, 0, 0, 0, 0, 0, 0, 0, 0, 0, 0, 0, 0, 0
    .long 0, 0, 0, 0, 0, 0, 0, 0, 0, 0, 0, 0, 0, 0, 0, 0
    .long 0, 0, 0, 0, 0, 0, 0, 0, 0, 0, 0, 0, 0, 0, 0, 0
    .long 4, 24, 24, 8192, 2816, 264960, 8388608, 0, 32768, 4, 21016576, 131072, 0, 0, 218104352, 1
    .long 4, 24, 24, 8192, 2816, 264960, 8388608, 262144, 32768, 4, 22065152, 131072, 0, 0, 218104480, 1
    .long 1, 32, 32, 8192, 3584, 3840, 8388608, 1048576, 32768, 8, 42000384, 131072, 0, 0, 218104880, 4
    .long 1, 16, 16, 8192, 3584, 3840, 8388608, 2097152, 32768, 8, 12640256, 131072, 0, 0, 218105392, 4
    .long 1, 32, 32, 8192, 3584, 3840, 8388608, 3145728, 32768, 8, 50388992, 131072, 0, 0, 218105904, 4
    .long 1, 32, 32, 8192, 3584, 3840, 8388608, 3670016, 32768, 8, 52486144, 131072, 0, 0, 218106160, 4
    .long 1, 80, 80, 2048, 5505536, 5505792, 7340032, 54611968, 114688, 7, 180363264, 32768, 218103856, 7, 218106368, 1
    .long 0, 0, 0, 0, 0, 0, 0, 0, 0, 0, 0, 0, 0, 0, 0, 0
    .long 0, 0, 0, 0, 0, 0, 0, 0, 0, 0, 0, 0, 0, 0, 0, 0
    .long 0, 0, 0, 0, 0, 0, 0, 0, 0, 0, 0, 0, 0, 0, 0, 0
    .long 4, 24, 24, 8192, 4864, 267008, 8388608, 0, 32768, 4, 21049344, 131072, 0, 0, 218104384, 1
    .long 4, 24, 24, 8192, 4864, 267008, 8388608, 262144, 32768, 4, 22097920, 131072, 0, 0, 218104512, 1
    .long 1, 32, 32, 8192, 5632, 5888, 8388608, 1048576, 32768, 8, 42033152, 131072, 0, 0, 218104912, 4
    .long 1, 16, 16, 8192, 5632, 5888, 8388608, 2097152, 32768, 8, 12673024, 131072, 0, 0, 218105424, 4
    .long 1, 32, 32, 8192, 5632, 5888, 8388608, 3145728, 32768, 8, 50421760, 131072, 0, 0, 218105936, 4
    .long 1, 32, 32, 8192, 5632, 5888, 8388608, 3670016, 32768, 8, 52518912, 131072, 0, 0, 218106192, 4
    .long 1, 80, 80, 2048, 5506048, 5506304, 7340032, 54611968, 114688, 7, 180371456, 32768, 218103856, 7, 218106368, 1
    .long 0, 0, 0, 0, 0, 0, 0, 0, 0, 0, 0, 0, 0, 0, 0, 0
    .long 0, 0, 0, 0, 0, 0, 0, 0, 0, 0, 0, 0, 0, 0, 0, 0
    .long 0, 0, 0, 0, 0, 0, 0, 0, 0, 0, 0, 0, 0, 0, 0, 0
    .long 4, 24, 24, 8192, 6912, 269056, 8388608, 0, 32768, 4, 21082112, 131072, 0, 0, 218104416, 1
    .long 4, 24, 24, 8192, 6912, 269056, 8388608, 262144, 32768, 4, 22130688, 131072, 0, 0, 218104544, 1
    .long 1, 32, 32, 8192, 7680, 7936, 8388608, 1048576, 32768, 8, 42065920, 131072, 0, 0, 218104944, 4
    .long 1, 16, 16, 8192, 7680, 7936, 8388608, 2097152, 32768, 8, 12705792, 131072, 0, 0, 218105456, 4
    .long 1, 32, 32, 8192, 7680, 7936, 8388608, 3145728, 32768, 8, 50454528, 131072, 0, 0, 218105968, 4
    .long 1, 32, 32, 8192, 7680, 7936, 8388608, 3670016, 32768, 8, 52551680, 131072, 0, 0, 218106224, 4
    .long 1, 80, 80, 2048, 5506560, 5506816, 7340032, 54611968, 114688, 7, 180379648, 32768, 218103856, 7, 218106368, 1
    .long 0, 0, 0, 0, 0, 0, 0, 0, 0, 0, 0, 0, 0, 0, 0, 0
    .long 0, 0, 0, 0, 0, 0, 0, 0, 0, 0, 0, 0, 0, 0, 0, 0
    .long 0, 0, 0, 0, 0, 0, 0, 0, 0, 0, 0, 0, 0, 0, 0, 0
    .long 4, 24, 24, 8192, 1024, 263168, 8388608, 0, 32768, 4, 20987904, 131072, 0, 0, 218104336, 1
    .long 4, 24, 24, 8192, 1024, 263168, 8388608, 262144, 32768, 4, 22036480, 131072, 0, 0, 218104464, 1
    .long 1, 24, 24, 8192, 0, 256, 8388608, 1048576, 32768, 8, 25165824, 131072, 0, 0, 218104832, 4
    .long 1, 32, 32, 8192, 0, 256, 8388608, 2621440, 32768, 8, 48234496, 131072, 0, 0, 218105600, 4
    .long 1, 24, 24, 8192, 0, 256, 8388608, 3145728, 32768, 8, 33554432, 131072, 0, 0, 218105856, 4
    .long 1, 24, 24, 8192, 0, 256, 8388608, 3670016, 32768, 8, 35651584, 131072, 0, 0, 218106112, 4
    .long 1, 80, 80, 2048, 0, 256, 7340032, 56360960, 114688, 7, 168296448, 32768, 218103872, 7, 218106432, 1
    .long 0, 0, 0, 0, 0, 0, 0, 0, 0, 0, 0, 0, 0, 0, 0, 0
    .long 0, 0, 0, 0, 0, 0, 0, 0, 0, 0, 0, 0, 0, 0, 0, 0
    .long 0, 0, 0, 0, 0, 0, 0, 0, 0, 0, 0, 0, 0, 0, 0, 0
    .long 4, 24, 24, 8192, 3072, 265216, 8388608, 0, 32768, 4, 21020672, 131072, 0, 0, 218104368, 1
    .long 4, 24, 24, 8192, 3072, 265216, 8388608, 262144, 32768, 4, 22069248, 131072, 0, 0, 218104496, 1
    .long 1, 24, 24, 8192, 2048, 2304, 8388608, 1048576, 32768, 8, 25198592, 131072, 0, 0, 218104864, 4
    .long 1, 32, 32, 8192, 2048, 2304, 8388608, 2621440, 32768, 8, 48267264, 131072, 0, 0, 218105632, 4
    .long 1, 24, 24, 8192, 2048, 2304, 8388608, 3145728, 32768, 8, 33587200, 131072, 0, 0, 218105888, 4
    .long 1, 24, 24, 8192, 2048, 2304, 8388608, 3670016, 32768, 8, 35684352, 131072, 0, 0, 218106144, 4
    .long 1, 80, 80, 2048, 512, 768, 7340032, 56360960, 114688, 7, 168304640, 32768, 218103872, 7, 218106432, 1
    .long 0, 0, 0, 0, 0, 0, 0, 0, 0, 0, 0, 0, 0, 0, 0, 0
    .long 0, 0, 0, 0, 0, 0, 0, 0, 0, 0, 0, 0, 0, 0, 0, 0
    .long 0, 0, 0, 0, 0, 0, 0, 0, 0, 0, 0, 0, 0, 0, 0, 0
    .long 4, 24, 24, 8192, 5120, 267264, 8388608, 0, 32768, 4, 21053440, 131072, 0, 0, 218104400, 1
    .long 4, 24, 24, 8192, 5120, 267264, 8388608, 262144, 32768, 4, 22102016, 131072, 0, 0, 218104528, 1
    .long 1, 24, 24, 8192, 4096, 4352, 8388608, 1048576, 32768, 8, 25231360, 131072, 0, 0, 218104896, 4
    .long 1, 32, 32, 8192, 4096, 4352, 8388608, 2621440, 32768, 8, 48300032, 131072, 0, 0, 218105664, 4
    .long 1, 24, 24, 8192, 4096, 4352, 8388608, 3145728, 32768, 8, 33619968, 131072, 0, 0, 218105920, 4
    .long 1, 24, 24, 8192, 4096, 4352, 8388608, 3670016, 32768, 8, 35717120, 131072, 0, 0, 218106176, 4
    .long 1, 80, 80, 2048, 1024, 1280, 7340032, 56360960, 114688, 7, 168312832, 32768, 218103872, 7, 218106432, 1
    .long 0, 0, 0, 0, 0, 0, 0, 0, 0, 0, 0, 0, 0, 0, 0, 0
    .long 0, 0, 0, 0, 0, 0, 0, 0, 0, 0, 0, 0, 0, 0, 0, 0
    .long 0, 0, 0, 0, 0, 0, 0, 0, 0, 0, 0, 0, 0, 0, 0, 0
    .long 4, 24, 24, 8192, 7168, 269312, 8388608, 0, 32768, 4, 21086208, 131072, 0, 0, 218104432, 1
    .long 4, 24, 24, 8192, 7168, 269312, 8388608, 262144, 32768, 4, 22134784, 131072, 0, 0, 218104560, 1
    .long 1, 24, 24, 8192, 6144, 6400, 8388608, 1048576, 32768, 8, 25264128, 131072, 0, 0, 218104928, 4
    .long 1, 32, 32, 8192, 6144, 6400, 8388608, 2621440, 32768, 8, 48332800, 131072, 0, 0, 218105696, 4
    .long 1, 24, 24, 8192, 6144, 6400, 8388608, 3145728, 32768, 8, 33652736, 131072, 0, 0, 218105952, 4
    .long 1, 24, 24, 8192, 6144, 6400, 8388608, 3670016, 32768, 8, 35749888, 131072, 0, 0, 218106208, 4
    .long 1, 80, 80, 2048, 1536, 1792, 7340032, 56360960, 114688, 7, 168321024, 32768, 218103872, 7, 218106432, 1
    .long 0, 0, 0, 0, 0, 0, 0, 0, 0, 0, 0, 0, 0, 0, 0, 0
    .long 0, 0, 0, 0, 0, 0, 0, 0, 0, 0, 0, 0, 0, 0, 0, 0
    .long 0, 0, 0, 0, 0, 0, 0, 0, 0, 0, 0, 0, 0, 0, 0, 0
    .long 4, 24, 24, 8192, 1280, 263424, 8388608, 0, 32768, 4, 20992000, 131072, 0, 0, 218104336, 1
    .long 4, 24, 24, 8192, 1280, 263424, 8388608, 262144, 32768, 4, 22040576, 131072, 0, 0, 218104464, 1
    .long 1, 24, 24, 8192, 512, 768, 8388608, 1048576, 32768, 8, 25174016, 131072, 0, 0, 218104832, 4
    .long 1, 32, 32, 8192, 512, 768, 8388608, 2621440, 32768, 8, 48242688, 131072, 0, 0, 218105600, 4
    .long 1, 24, 24, 8192, 512, 768, 8388608, 3145728, 32768, 8, 33562624, 131072, 0, 0, 218105856, 4
    .long 1, 24, 24, 8192, 512, 768, 8388608, 3670016, 32768, 8, 35659776, 131072, 0, 0, 218106112, 4
    .long 1, 80, 80, 2048, 1835008, 1835264, 7340032, 56389632, 114688, 7, 172490752, 32768, 218103888, 7, 218106432, 1
    .long 0, 0, 0, 0, 0, 0, 0, 0, 0, 0, 0, 0, 0, 0, 0, 0
    .long 0, 0, 0, 0, 0, 0, 0, 0, 0, 0, 0, 0, 0, 0, 0, 0
    .long 0, 0, 0, 0, 0, 0, 0, 0, 0, 0, 0, 0, 0, 0, 0, 0
    .long 4, 24, 24, 8192, 3328, 265472, 8388608, 0, 32768, 4, 21024768, 131072, 0, 0, 218104368, 1
    .long 4, 24, 24, 8192, 3328, 265472, 8388608, 262144, 32768, 4, 22073344, 131072, 0, 0, 218104496, 1
    .long 1, 24, 24, 8192, 2560, 2816, 8388608, 1048576, 32768, 8, 25206784, 131072, 0, 0, 218104864, 4
    .long 1, 32, 32, 8192, 2560, 2816, 8388608, 2621440, 32768, 8, 48275456, 131072, 0, 0, 218105632, 4
    .long 1, 24, 24, 8192, 2560, 2816, 8388608, 3145728, 32768, 8, 33595392, 131072, 0, 0, 218105888, 4
    .long 1, 24, 24, 8192, 2560, 2816, 8388608, 3670016, 32768, 8, 35692544, 131072, 0, 0, 218106144, 4
    .long 1, 80, 80, 2048, 1835520, 1835776, 7340032, 56389632, 114688, 7, 172498944, 32768, 218103888, 7, 218106432, 1
    .long 0, 0, 0, 0, 0, 0, 0, 0, 0, 0, 0, 0, 0, 0, 0, 0
    .long 0, 0, 0, 0, 0, 0, 0, 0, 0, 0, 0, 0, 0, 0, 0, 0
    .long 0, 0, 0, 0, 0, 0, 0, 0, 0, 0, 0, 0, 0, 0, 0, 0
    .long 4, 24, 24, 8192, 5376, 267520, 8388608, 0, 32768, 4, 21057536, 131072, 0, 0, 218104400, 1
    .long 4, 24, 24, 8192, 5376, 267520, 8388608, 262144, 32768, 4, 22106112, 131072, 0, 0, 218104528, 1
    .long 1, 24, 24, 8192, 4608, 4864, 8388608, 1048576, 32768, 8, 25239552, 131072, 0, 0, 218104896, 4
    .long 1, 32, 32, 8192, 4608, 4864, 8388608, 2621440, 32768, 8, 48308224, 131072, 0, 0, 218105664, 4
    .long 1, 24, 24, 8192, 4608, 4864, 8388608, 3145728, 32768, 8, 33628160, 131072, 0, 0, 218105920, 4
    .long 1, 24, 24, 8192, 4608, 4864, 8388608, 3670016, 32768, 8, 35725312, 131072, 0, 0, 218106176, 4
    .long 1, 80, 80, 2048, 1836032, 1836288, 7340032, 56389632, 114688, 7, 172507136, 32768, 218103888, 7, 218106432, 1
    .long 0, 0, 0, 0, 0, 0, 0, 0, 0, 0, 0, 0, 0, 0, 0, 0
    .long 0, 0, 0, 0, 0, 0, 0, 0, 0, 0, 0, 0, 0, 0, 0, 0
    .long 0, 0, 0, 0, 0, 0, 0, 0, 0, 0, 0, 0, 0, 0, 0, 0
    .long 4, 24, 24, 8192, 7424, 269568, 8388608, 0, 32768, 4, 21090304, 131072, 0, 0, 218104432, 1
    .long 4, 24, 24, 8192, 7424, 269568, 8388608, 262144, 32768, 4, 22138880, 131072, 0, 0, 218104560, 1
    .long 1, 24, 24, 8192, 6656, 6912, 8388608, 1048576, 32768, 8, 25272320, 131072, 0, 0, 218104928, 4
    .long 1, 32, 32, 8192, 6656, 6912, 8388608, 2621440, 32768, 8, 48340992, 131072, 0, 0, 218105696, 4
    .long 1, 24, 24, 8192, 6656, 6912, 8388608, 3145728, 32768, 8, 33660928, 131072, 0, 0, 218105952, 4
    .long 1, 24, 24, 8192, 6656, 6912, 8388608, 3670016, 32768, 8, 35758080, 131072, 0, 0, 218106208, 4
    .long 1, 80, 80, 2048, 1836544, 1836800, 7340032, 56389632, 114688, 7, 172515328, 32768, 218103888, 7, 218106432, 1
    .long 0, 0, 0, 0, 0, 0, 0, 0, 0, 0, 0, 0, 0, 0, 0, 0
    .long 0, 0, 0, 0, 0, 0, 0, 0, 0, 0, 0, 0, 0, 0, 0, 0
    .long 0, 0, 0, 0, 0, 0, 0, 0, 0, 0, 0, 0, 0, 0, 0, 0
    .long 4, 24, 24, 8192, 1536, 263680, 8388608, 0, 32768, 4, 20996096, 131072, 0, 0, 218104336, 1
    .long 4, 24, 24, 8192, 1536, 263680, 8388608, 262144, 32768, 4, 22044672, 131072, 0, 0, 218104464, 1
    .long 1, 24, 24, 8192, 1024, 1280, 8388608, 1048576, 32768, 8, 25182208, 131072, 0, 0, 218104848, 4
    .long 1, 32, 32, 8192, 1024, 1280, 8388608, 2621440, 32768, 8, 48250880, 131072, 0, 0, 218105616, 4
    .long 1, 24, 24, 8192, 1024, 1280, 8388608, 3145728, 32768, 8, 33570816, 131072, 0, 0, 218105872, 4
    .long 1, 24, 24, 8192, 1024, 1280, 8388608, 3670016, 32768, 8, 35667968, 131072, 0, 0, 218106128, 4
    .long 1, 80, 80, 2048, 3670016, 3670272, 7340032, 56418304, 114688, 7, 176685056, 32768, 218103904, 7, 218106432, 1
    .long 0, 0, 0, 0, 0, 0, 0, 0, 0, 0, 0, 0, 0, 0, 0, 0
    .long 0, 0, 0, 0, 0, 0, 0, 0, 0, 0, 0, 0, 0, 0, 0, 0
    .long 0, 0, 0, 0, 0, 0, 0, 0, 0, 0, 0, 0, 0, 0, 0, 0
    .long 4, 24, 24, 8192, 3584, 265728, 8388608, 0, 32768, 4, 21028864, 131072, 0, 0, 218104368, 1
    .long 4, 24, 24, 8192, 3584, 265728, 8388608, 262144, 32768, 4, 22077440, 131072, 0, 0, 218104496, 1
    .long 1, 24, 24, 8192, 3072, 3328, 8388608, 1048576, 32768, 8, 25214976, 131072, 0, 0, 218104880, 4
    .long 1, 32, 32, 8192, 3072, 3328, 8388608, 2621440, 32768, 8, 48283648, 131072, 0, 0, 218105648, 4
    .long 1, 24, 24, 8192, 3072, 3328, 8388608, 3145728, 32768, 8, 33603584, 131072, 0, 0, 218105904, 4
    .long 1, 24, 24, 8192, 3072, 3328, 8388608, 3670016, 32768, 8, 35700736, 131072, 0, 0, 218106160, 4
    .long 1, 80, 80, 2048, 3670528, 3670784, 7340032, 56418304, 114688, 7, 176693248, 32768, 218103904, 7, 218106432, 1
    .long 0, 0, 0, 0, 0, 0, 0, 0, 0, 0, 0, 0, 0, 0, 0, 0
    .long 0, 0, 0, 0, 0, 0, 0, 0, 0, 0, 0, 0, 0, 0, 0, 0
    .long 0, 0, 0, 0, 0, 0, 0, 0, 0, 0, 0, 0, 0, 0, 0, 0
    .long 4, 24, 24, 8192, 5632, 267776, 8388608, 0, 32768, 4, 21061632, 131072, 0, 0, 218104400, 1
    .long 4, 24, 24, 8192, 5632, 267776, 8388608, 262144, 32768, 4, 22110208, 131072, 0, 0, 218104528, 1
    .long 1, 24, 24, 8192, 5120, 5376, 8388608, 1048576, 32768, 8, 25247744, 131072, 0, 0, 218104912, 4
    .long 1, 32, 32, 8192, 5120, 5376, 8388608, 2621440, 32768, 8, 48316416, 131072, 0, 0, 218105680, 4
    .long 1, 24, 24, 8192, 5120, 5376, 8388608, 3145728, 32768, 8, 33636352, 131072, 0, 0, 218105936, 4
    .long 1, 24, 24, 8192, 5120, 5376, 8388608, 3670016, 32768, 8, 35733504, 131072, 0, 0, 218106192, 4
    .long 1, 80, 80, 2048, 3671040, 3671296, 7340032, 56418304, 114688, 7, 176701440, 32768, 218103904, 7, 218106432, 1
    .long 0, 0, 0, 0, 0, 0, 0, 0, 0, 0, 0, 0, 0, 0, 0, 0
    .long 0, 0, 0, 0, 0, 0, 0, 0, 0, 0, 0, 0, 0, 0, 0, 0
    .long 0, 0, 0, 0, 0, 0, 0, 0, 0, 0, 0, 0, 0, 0, 0, 0
    .long 4, 24, 24, 8192, 7680, 269824, 8388608, 0, 32768, 4, 21094400, 131072, 0, 0, 218104432, 1
    .long 4, 24, 24, 8192, 7680, 269824, 8388608, 262144, 32768, 4, 22142976, 131072, 0, 0, 218104560, 1
    .long 1, 24, 24, 8192, 7168, 7424, 8388608, 1048576, 32768, 8, 25280512, 131072, 0, 0, 218104944, 4
    .long 1, 32, 32, 8192, 7168, 7424, 8388608, 2621440, 32768, 8, 48349184, 131072, 0, 0, 218105712, 4
    .long 1, 24, 24, 8192, 7168, 7424, 8388608, 3145728, 32768, 8, 33669120, 131072, 0, 0, 218105968, 4
    .long 1, 24, 24, 8192, 7168, 7424, 8388608, 3670016, 32768, 8, 35766272, 131072, 0, 0, 218106224, 4
    .long 1, 80, 80, 2048, 3671552, 3671808, 7340032, 56418304, 114688, 7, 176709632, 32768, 218103904, 7, 218106432, 1
    .long 0, 0, 0, 0, 0, 0, 0, 0, 0, 0, 0, 0, 0, 0, 0, 0
    .long 0, 0, 0, 0, 0, 0, 0, 0, 0, 0, 0, 0, 0, 0, 0, 0
    .long 0, 0, 0, 0, 0, 0, 0, 0, 0, 0, 0, 0, 0, 0, 0, 0
    .long 4, 24, 24, 8192, 1792, 263936, 8388608, 0, 32768, 4, 21000192, 131072, 0, 0, 218104336, 1
    .long 4, 24, 24, 8192, 1792, 263936, 8388608, 262144, 32768, 4, 22048768, 131072, 0, 0, 218104464, 1
    .long 1, 24, 24, 8192, 1536, 1792, 8388608, 1048576, 32768, 8, 25190400, 131072, 0, 0, 218104848, 4
    .long 1, 32, 32, 8192, 1536, 1792, 8388608, 2621440, 32768, 8, 48259072, 131072, 0, 0, 218105616, 4
    .long 1, 24, 24, 8192, 1536, 1792, 8388608, 3145728, 32768, 8, 33579008, 131072, 0, 0, 218105872, 4
    .long 1, 24, 24, 8192, 1536, 1792, 8388608, 3670016, 32768, 8, 35676160, 131072, 0, 0, 218106128, 4
    .long 1, 80, 80, 2048, 5505024, 5505280, 7340032, 56446976, 114688, 7, 180879360, 32768, 218103920, 7, 218106432, 1
    .long 0, 0, 0, 0, 0, 0, 0, 0, 0, 0, 0, 0, 0, 0, 0, 0
    .long 0, 0, 0, 0, 0, 0, 0, 0, 0, 0, 0, 0, 0, 0, 0, 0
    .long 0, 0, 0, 0, 0, 0, 0, 0, 0, 0, 0, 0, 0, 0, 0, 0
    .long 4, 24, 24, 8192, 3840, 265984, 8388608, 0, 32768, 4, 21032960, 131072, 0, 0, 218104368, 1
    .long 4, 24, 24, 8192, 3840, 265984, 8388608, 262144, 32768, 4, 22081536, 131072, 0, 0, 218104496, 1
    .long 1, 24, 24, 8192, 3584, 3840, 8388608, 1048576, 32768, 8, 25223168, 131072, 0, 0, 218104880, 4
    .long 1, 32, 32, 8192, 3584, 3840, 8388608, 2621440, 32768, 8, 48291840, 131072, 0, 0, 218105648, 4
    .long 1, 24, 24, 8192, 3584, 3840, 8388608, 3145728, 32768, 8, 33611776, 131072, 0, 0, 218105904, 4
    .long 1, 24, 24, 8192, 3584, 3840, 8388608, 3670016, 32768, 8, 35708928, 131072, 0, 0, 218106160, 4
    .long 1, 80, 80, 2048, 5505536, 5505792, 7340032, 56446976, 114688, 7, 180887552, 32768, 218103920, 7, 218106432, 1
    .long 0, 0, 0, 0, 0, 0, 0, 0, 0, 0, 0, 0, 0, 0, 0, 0
    .long 0, 0, 0, 0, 0, 0, 0, 0, 0, 0, 0, 0, 0, 0, 0, 0
    .long 0, 0, 0, 0, 0, 0, 0, 0, 0, 0, 0, 0, 0, 0, 0, 0
    .long 4, 24, 24, 8192, 5888, 268032, 8388608, 0, 32768, 4, 21065728, 131072, 0, 0, 218104400, 1
    .long 4, 24, 24, 8192, 5888, 268032, 8388608, 262144, 32768, 4, 22114304, 131072, 0, 0, 218104528, 1
    .long 1, 24, 24, 8192, 5632, 5888, 8388608, 1048576, 32768, 8, 25255936, 131072, 0, 0, 218104912, 4
    .long 1, 32, 32, 8192, 5632, 5888, 8388608, 2621440, 32768, 8, 48324608, 131072, 0, 0, 218105680, 4
    .long 1, 24, 24, 8192, 5632, 5888, 8388608, 3145728, 32768, 8, 33644544, 131072, 0, 0, 218105936, 4
    .long 1, 24, 24, 8192, 5632, 5888, 8388608, 3670016, 32768, 8, 35741696, 131072, 0, 0, 218106192, 4
    .long 1, 80, 80, 2048, 5506048, 5506304, 7340032, 56446976, 114688, 7, 180895744, 32768, 218103920, 7, 218106432, 1
    .long 0, 0, 0, 0, 0, 0, 0, 0, 0, 0, 0, 0, 0, 0, 0, 0
    .long 0, 0, 0, 0, 0, 0, 0, 0, 0, 0, 0, 0, 0, 0, 0, 0
    .long 0, 0, 0, 0, 0, 0, 0, 0, 0, 0, 0, 0, 0, 0, 0, 0
    .long 4, 24, 24, 8192, 7936, 270080, 8388608, 0, 32768, 4, 21098496, 131072, 0, 0, 218104432, 1
    .long 4, 24, 24, 8192, 7936, 270080, 8388608, 262144, 32768, 4, 22147072, 131072, 0, 0, 218104560, 1
    .long 1, 24, 24, 8192, 7680, 7936, 8388608, 1048576, 32768, 8, 25288704, 131072, 0, 0, 218104944, 4
    .long 1, 32, 32, 8192, 7680, 7936, 8388608, 2621440, 32768, 8, 48357376, 131072, 0, 0, 218105712, 4
    .long 1, 24, 24, 8192, 7680, 7936, 8388608, 3145728, 32768, 8, 33677312, 131072, 0, 0, 218105968, 4
    .long 1, 24, 24, 8192, 7680, 7936, 8388608, 3670016, 32768, 8, 35774464, 131072, 0, 0, 218106224, 4
    .long 1, 80, 80, 2048, 5506560, 5506816, 7340032, 56446976, 114688, 7, 180903936, 32768, 218103920, 7, 218106432, 1
    .long 0, 0, 0, 0, 0, 0, 0, 0, 0, 0, 0, 0, 0, 0, 0, 0
    .long 0, 0, 0, 0, 0, 0, 0, 0, 0, 0, 0, 0, 0, 0, 0, 0
    .long 0, 0, 0, 0, 0, 0, 0, 0, 0, 0, 0, 0, 0, 0, 0, 0
    .long 4, 32, 32, 8192, 0, 262144, 8388608, 0, 32768, 4, 37748736, 131072, 0, 0, 218104320, 1
    .long 4, 32, 32, 8192, 0, 262144, 8388608, 262144, 32768, 4, 38797312, 131072, 0, 0, 218104448, 1
    .long 4, 16, 16, 8192, 1792, 263936, 8388608, 786432, 32768, 4, 7368704, 131072, 0, 0, 218104592, 1
    .long 1, 32, 32, 8192, 1024, 1280, 8388608, 1572864, 32768, 8, 44056576, 131072, 0, 0, 218105104, 4
    .long 1, 16, 16, 8192, 1024, 1280, 8388608, 2621440, 32768, 8, 14696448, 131072, 0, 0, 218105616, 4
    .long 2, 64, 72, 7168, 4096, 4096, 7340032, 1048576, 32768, 8, 58261504, 114688, 0, 0, 218103968, 1
    .long 2, 64, 72, 7168, 3072, 3072, 7340032, 2621440, 32768, 8, 63750144, 114688, 0, 0, 218104144, 1
    .long 1, 80, 80, 2048, 3670016, 3670272, 7340032, 60088320, 114688, 7, 177733632, 32768, 218104032, 7, 218106560, 1
    .long 0, 0, 0, 0, 0, 0, 0, 0, 0, 0, 0, 0, 0, 0, 0, 0
    .long 0, 0, 0, 0, 0, 0, 0, 0, 0, 0, 0, 0, 0, 0, 0, 0
    .long 4, 32, 32, 8192, 2048, 264192, 8388608, 0, 32768, 4, 37781504, 131072, 0, 0, 218104352, 1
    .long 4, 32, 32, 8192, 2048, 264192, 8388608, 262144, 32768, 4, 38830080, 131072, 0, 0, 218104480, 1
    .long 4, 16, 16, 8192, 3840, 265984, 8388608, 786432, 32768, 4, 7401472, 131072, 0, 0, 218104624, 1
    .long 1, 32, 32, 8192, 3072, 3328, 8388608, 1572864, 32768, 8, 44089344, 131072, 0, 0, 218105136, 4
    .long 1, 16, 16, 8192, 3072, 3328, 8388608, 2621440, 32768, 8, 14729216, 131072, 0, 0, 218105648, 4
    .long 2, 64, 72, 7168, 4352, 4352, 7340032, 1048576, 32768, 8, 58265600, 114688, 0, 0, 218103968, 1
    .long 2, 64, 72, 7168, 3328, 3328, 7340032, 2621440, 32768, 8, 63754240, 114688, 0, 0, 218104144, 1
    .long 1, 80, 80, 2048, 3670528, 3670784, 7340032, 60088320, 114688, 7, 177741824, 32768, 218104032, 7, 218106560, 1
    .long 0, 0, 0, 0, 0, 0, 0, 0, 0, 0, 0, 0, 0, 0, 0, 0
    .long 0, 0, 0, 0, 0, 0, 0, 0, 0, 0, 0, 0, 0, 0, 0, 0
    .long 4, 32, 32, 8192, 4096, 266240, 8388608, 0, 32768, 4, 37814272, 131072, 0, 0, 218104384, 1
    .long 4, 32, 32, 8192, 4096, 266240, 8388608, 262144, 32768, 4, 38862848, 131072, 0, 0, 218104512, 1
    .long 4, 16, 16, 8192, 5888, 268032, 8388608, 786432, 32768, 4, 7434240, 131072, 0, 0, 218104656, 1
    .long 1, 32, 32, 8192, 5120, 5376, 8388608, 1572864, 32768, 8, 44122112, 131072, 0, 0, 218105168, 4
    .long 1, 16, 16, 8192, 5120, 5376, 8388608, 2621440, 32768, 8, 14761984, 131072, 0, 0, 218105680, 4
    .long 2, 64, 72, 7168, 4608, 4608, 7340032, 1048576, 32768, 8, 58269696, 114688, 0, 0, 218103968, 1
    .long 2, 64, 72, 7168, 3584, 3584, 7340032, 2621440, 32768, 8, 63758336, 114688, 0, 0, 218104160, 1
    .long 1, 80, 80, 2048, 3671040, 3671296, 7340032, 60088320, 114688, 7, 177750016, 32768, 218104032, 7, 218106560, 1
    .long 0, 0, 0, 0, 0, 0, 0, 0, 0, 0, 0, 0, 0, 0, 0, 0
    .long 0, 0, 0, 0, 0, 0, 0, 0, 0, 0, 0, 0, 0, 0, 0, 0
    .long 4, 32, 32, 8192, 6144, 268288, 8388608, 0, 32768, 4, 37847040, 131072, 0, 0, 218104416, 1
    .long 4, 32, 32, 8192, 6144, 268288, 8388608, 262144, 32768, 4, 38895616, 131072, 0, 0, 218104544, 1
    .long 4, 16, 16, 8192, 7936, 270080, 8388608, 786432, 32768, 4, 7467008, 131072, 0, 0, 218104688, 1
    .long 1, 32, 32, 8192, 7168, 7424, 8388608, 1572864, 32768, 8, 44154880, 131072, 0, 0, 218105200, 4
    .long 1, 16, 16, 8192, 7168, 7424, 8388608, 2621440, 32768, 8, 14794752, 131072, 0, 0, 218105712, 4
    .long 2, 64, 72, 7168, 4864, 4864, 7340032, 1048576, 32768, 8, 58273792, 114688, 0, 0, 218103968, 1
    .long 2, 64, 72, 7168, 3840, 3840, 7340032, 2621440, 32768, 8, 63762432, 114688, 0, 0, 218104160, 1
    .long 1, 80, 80, 2048, 3671552, 3671808, 7340032, 60088320, 114688, 7, 177758208, 32768, 218104032, 7, 218106560, 1
    .long 0, 0, 0, 0, 0, 0, 0, 0, 0, 0, 0, 0, 0, 0, 0, 0
    .long 0, 0, 0, 0, 0, 0, 0, 0, 0, 0, 0, 0, 0, 0, 0, 0
    .long 4, 32, 32, 8192, 256, 262400, 8388608, 0, 32768, 4, 37752832, 131072, 0, 0, 218104320, 1
    .long 4, 32, 32, 8192, 256, 262400, 8388608, 262144, 32768, 4, 38801408, 131072, 0, 0, 218104448, 1
    .long 4, 16, 16, 8192, 1792, 263936, 8388608, 524288, 32768, 4, 6320128, 131072, 0, 0, 218104592, 1
    .long 1, 32, 32, 8192, 1536, 1792, 8388608, 1572864, 32768, 8, 44064768, 131072, 0, 0, 218105104, 4
    .long 1, 16, 16, 8192, 1536, 1792, 8388608, 2621440, 32768, 8, 14704640, 131072, 0, 0, 218105616, 4
    .long 2, 64, 72, 7168, 5120, 5120, 7340032, 1048576, 32768, 8, 58277888, 114688, 0, 0, 218103968, 1
    .long 2, 64, 72, 7168, 4096, 4096, 7340032, 2621440, 32768, 8, 63766528, 114688, 0, 0, 218104160, 1
    .long 1, 80, 80, 2048, 5505024, 5505280, 7340032, 60116992, 114688, 7, 181927936, 32768, 218104048, 7, 218106560, 1
    .long 0, 0, 0, 0, 0, 0, 0, 0, 0, 0, 0, 0, 0, 0, 0, 0
    .long 0, 0, 0, 0, 0, 0, 0, 0, 0, 0, 0, 0, 0, 0, 0, 0
    .long 4, 32, 32, 8192, 2304, 264448, 8388608, 0, 32768, 4, 37785600, 131072, 0, 0, 218104352, 1
    .long 4, 32, 32, 8192, 2304, 264448, 8388608, 262144, 32768, 4, 38834176, 131072, 0, 0, 218104480, 1
    .long 4, 16, 16, 8192, 3840, 265984, 8388608, 524288, 32768, 4, 6352896, 131072, 0, 0, 218104624, 1
    .long 1, 32, 32, 8192, 3584, 3840, 8388608, 1572864, 32768, 8, 44097536, 131072, 0, 0, 218105136, 4
    .long 1, 16, 16, 8192, 3584, 3840, 8388608, 2621440, 32768, 8, 14737408, 131072, 0, 0, 218105648, 4
    .long 2, 64, 72, 7168, 5376, 5376, 7340032, 1048576, 32768, 8, 58281984, 114688, 0, 0, 218103984, 1
    .long 2, 64, 72, 7168, 4352, 4352, 7340032, 2621440, 32768, 8, 63770624, 114688, 0, 0, 218104160, 1
    .long 1, 80, 80, 2048, 5505536, 5505792, 7340032, 60116992, 114688, 7, 181936128, 32768, 218104048, 7, 218106560, 1
    .long 0, 0, 0, 0, 0, 0, 0, 0, 0, 0, 0, 0, 0, 0, 0, 0
    .long 0, 0, 0, 0, 0, 0, 0, 0, 0, 0, 0, 0, 0, 0, 0, 0
    .long 4, 32, 32, 8192, 4352, 266496, 8388608, 0, 32768, 4, 37818368, 131072, 0, 0, 218104384, 1
    .long 4, 32, 32, 8192, 4352, 266496, 8388608, 262144, 32768, 4, 38866944, 131072, 0, 0, 218104512, 1
    .long 4, 16, 16, 8192, 5888, 268032, 8388608, 524288, 32768, 4, 6385664, 131072, 0, 0, 218104656, 1
    .long 1, 32, 32, 8192, 5632, 5888, 8388608, 1572864, 32768, 8, 44130304, 131072, 0, 0, 218105168, 4
    .long 1, 16, 16, 8192, 5632, 5888, 8388608, 2621440, 32768, 8, 14770176, 131072, 0, 0, 218105680, 4
    .long 2, 64, 72, 7168, 5632, 5632, 7340032, 1048576, 32768, 8, 58286080, 114688, 0, 0, 218103984, 1
    .long 2, 64, 72, 7168, 4608, 4608, 7340032, 2621440, 32768, 8, 63774720, 114688, 0, 0, 218104160, 1
    .long 1, 80, 80, 2048, 5506048, 5506304, 7340032, 60116992, 114688, 7, 181944320, 32768, 218104048, 7, 218106560, 1
    .long 0, 0, 0, 0, 0, 0, 0, 0, 0, 0, 0, 0, 0, 0, 0, 0
    .long 0, 0, 0, 0, 0, 0, 0, 0, 0, 0, 0, 0, 0, 0, 0, 0
    .long 4, 32, 32, 8192, 6400, 268544, 8388608, 0, 32768, 4, 37851136, 131072, 0, 0, 218104416, 1
    .long 4, 32, 32, 8192, 6400, 268544, 8388608, 262144, 32768, 4, 38899712, 131072, 0, 0, 218104544, 1
    .long 4, 16, 16, 8192, 7936, 270080, 8388608, 524288, 32768, 4, 6418432, 131072, 0, 0, 218104688, 1
    .long 1, 32, 32, 8192, 7680, 7936, 8388608, 1572864, 32768, 8, 44163072, 131072, 0, 0, 218105200, 4
    .long 1, 16, 16, 8192, 7680, 7936, 8388608, 2621440, 32768, 8, 14802944, 131072, 0, 0, 218105712, 4
    .long 2, 64, 72, 7168, 5888, 5888, 7340032, 1048576, 32768, 8, 58290176, 114688, 0, 0, 218103984, 1
    .long 2, 64, 72, 7168, 4864, 4864, 7340032, 2621440, 32768, 8, 63778816, 114688, 0, 0, 218104160, 1
    .long 1, 80, 80, 2048, 5506560, 5506816, 7340032, 60116992, 114688, 7, 181952512, 32768, 218104048, 7, 218106560, 1
    .long 0, 0, 0, 0, 0, 0, 0, 0, 0, 0, 0, 0, 0, 0, 0, 0
    .long 0, 0, 0, 0, 0, 0, 0, 0, 0, 0, 0, 0, 0, 0, 0, 0
    .long 4, 32, 32, 8192, 512, 262656, 8388608, 0, 32768, 4, 37756928, 131072, 0, 0, 218104320, 1
    .long 4, 32, 32, 8192, 512, 262656, 8388608, 262144, 32768, 4, 38805504, 131072, 0, 0, 218104448, 1
    .long 4, 16, 16, 8192, 1536, 263680, 8388608, 786432, 32768, 4, 7364608, 131072, 0, 0, 218104592, 1
    .long 1, 24, 24, 8192, 0, 256, 8388608, 1572864, 32768, 8, 27262976, 131072, 0, 0, 218105088, 4
    .long 2, 64, 72, 7168, 0, 0, 7340032, 0, 32768, 8, 54525952, 114688, 0, 0, 218103808, 1
    .long 2, 64, 72, 7168, 6144, 6144, 7340032, 1048576, 32768, 8, 58294272, 114688, 0, 0, 218103984, 1
    .long 2, 64, 72, 7168, 5120, 5120, 7340032, 2621440, 32768, 8, 63782912, 114688, 0, 0, 218104160, 1
    .long 1, 80, 80, 2048, 0, 256, 7340032, 61865984, 114688, 7, 169869312, 32768, 218104064, 7, 218106624, 1
    .long 0, 0, 0, 0, 0, 0, 0, 0, 0, 0, 0, 0, 0, 0, 0, 0
    .long 0, 0, 0, 0, 0, 0, 0, 0, 0, 0, 0, 0, 0, 0, 0, 0
    .long 4, 32, 32, 8192, 2560, 264704, 8388608, 0, 32768, 4, 37789696, 131072, 0, 0, 218104352, 1
    .long 4, 32, 32, 8192, 2560, 264704, 8388608, 262144, 32768, 4, 38838272, 131072, 0, 0, 218104480, 1
    .long 4, 16, 16, 8192, 3584, 265728, 8388608, 786432, 32768, 4, 7397376, 131072, 0, 0, 218104624, 1
    .long 1, 24, 24, 8192, 2048, 2304, 8388608, 1572864, 32768, 8, 27295744, 131072, 0, 0, 218105120, 4
    .long 2, 64, 72, 7168, 256, 256, 7340032, 0, 32768, 8, 54530048, 114688, 0, 0, 218103808, 1
    .long 2, 64, 72, 7168, 6400, 6400, 7340032, 1048576, 32768, 8, 58298368, 114688, 0, 0, 218103984, 1
    .long 2, 64, 72, 7168, 5376, 5376, 7340032, 2621440, 32768, 8, 63787008, 114688, 0, 0, 218104176, 1
    .long 1, 80, 80, 2048, 512, 768, 7340032, 61865984, 114688, 7, 169877504, 32768, 218104064, 7, 218106624, 1
    .long 0, 0, 0, 0, 0, 0, 0, 0, 0, 0, 0, 0, 0, 0, 0, 0
    .long 0, 0, 0, 0, 0, 0, 0, 0, 0, 0, 0, 0, 0, 0, 0, 0
    .long 4, 32, 32, 8192, 4608, 266752, 8388608, 0, 32768, 4, 37822464, 131072, 0, 0, 218104384, 1
    .long 4, 32, 32, 8192, 4608, 266752, 8388608, 262144, 32768, 4, 38871040, 131072, 0, 0, 218104512, 1
    .long 4, 16, 16, 8192, 5632, 267776, 8388608, 786432, 32768, 4, 7430144, 131072, 0, 0, 218104656, 1
    .long 1, 24, 24, 8192, 4096, 4352, 8388608, 1572864, 32768, 8, 27328512, 131072, 0, 0, 218105152, 4
    .long 2, 64, 72, 7168, 512, 512, 7340032, 0, 32768, 8, 54534144, 114688, 0, 0, 218103808, 1
    .long 2, 64, 72, 7168, 6656, 6656, 7340032, 1048576, 32768, 8, 58302464, 114688, 0, 0, 218103984, 1
    .long 2, 64, 72, 7168, 5632, 5632, 7340032, 2621440, 32768, 8, 63791104, 114688, 0, 0, 218104176, 1
    .long 1, 80, 80, 2048, 1024, 1280, 7340032, 61865984, 114688, 7, 169885696, 32768, 218104064, 7, 218106624, 1
    .long 0, 0, 0, 0, 0, 0, 0, 0, 0, 0, 0, 0, 0, 0, 0, 0
    .long 0, 0, 0, 0, 0, 0, 0, 0, 0, 0, 0, 0, 0, 0, 0, 0
    .long 4, 32, 32, 8192, 6656, 268800, 8388608, 0, 32768, 4, 37855232, 131072, 0, 0, 218104416, 1
    .long 4, 32, 32, 8192, 6656, 268800, 8388608, 262144, 32768, 4, 38903808, 131072, 0, 0, 218104544, 1
    .long 4, 16, 16, 8192, 7680, 269824, 8388608, 786432, 32768, 4, 7462912, 131072, 0, 0, 218104688, 1
    .long 1, 24, 24, 8192, 6144, 6400, 8388608, 1572864, 32768, 8, 27361280, 131072, 0, 0, 218105184, 4
    .long 2, 64, 72, 7168, 768, 768, 7340032, 0, 32768, 8, 54538240, 114688, 0, 0, 218103808, 1
    .long 2, 64, 72, 7168, 6912, 6912, 7340032, 1048576, 32768, 8, 58306560, 114688, 0, 0, 218103984, 1
    .long 2, 64, 72, 7168, 5888, 5888, 7340032, 2621440, 32768, 8, 63795200, 114688, 0, 0, 218104176, 1
    .long 1, 80, 80, 2048, 1536, 1792, 7340032, 61865984, 114688, 7, 169893888, 32768, 218104064, 7, 218106624, 1
    .long 0, 0, 0, 0, 0, 0, 0, 0, 0, 0, 0, 0, 0, 0, 0, 0
    .long 0, 0, 0, 0, 0, 0, 0, 0, 0, 0, 0, 0, 0, 0, 0, 0
    .long 4, 32, 32, 8192, 768, 262912, 8388608, 0, 32768, 4, 37761024, 131072, 0, 0, 218104320, 1
    .long 4, 32, 32, 8192, 768, 262912, 8388608, 262144, 32768, 4, 38809600, 131072, 0, 0, 218104448, 1
    .long 4, 16, 16, 8192, 1536, 263680, 8388608, 524288, 32768, 4, 6316032, 131072, 0, 0, 218104592, 1
    .long 1, 24, 24, 8192, 512, 768, 8388608, 1572864, 32768, 8, 27271168, 131072, 0, 0, 218105088, 4
    .long 2, 64, 72, 7168, 1024, 1024, 7340032, 0, 32768, 8, 54542336, 114688, 0, 0, 218103808, 1
    .long 2, 64, 72, 7168, 0, 0, 7340032, 1572864, 32768, 8, 60030976, 114688, 0, 0, 218104000, 1
    .long 2, 64, 72, 7168, 6144, 6144, 7340032, 2621440, 32768, 8, 63799296, 114688, 0, 0, 218104176, 1
    .long 1, 80, 80, 2048, 1835008, 1835264, 7340032, 61894656, 114688, 7, 174063616, 32768, 218104080, 7, 218106624, 1
    .long 0, 0, 0, 0, 0, 0, 0, 0, 0, 0, 0, 0, 0, 0, 0, 0
    .long 0, 0, 0, 0, 0, 0, 0, 0, 0, 0, 0, 0, 0, 0, 0, 0
    .long 4, 32, 32, 8192, 2816, 264960, 8388608, 0, 32768, 4, 37793792, 131072, 0, 0, 218104352, 1
    .long 4, 32, 32, 8192, 2816, 264960, 8388608, 262144, 32768, 4, 38842368, 131072, 0, 0, 218104480, 1
    .long 4, 16, 16, 8192, 3584, 265728, 8388608, 524288, 32768, 4, 6348800, 131072, 0, 0, 218104624, 1
    .long 1, 24, 24, 8192, 2560, 2816, 8388608, 1572864, 32768, 8, 27303936, 131072, 0, 0, 218105120, 4
    .long 2, 64, 72, 7168, 1280, 1280, 7340032, 0, 32768, 8, 54546432, 114688, 0, 0, 218103808, 1
    .long 2, 64, 72, 7168, 256, 256, 7340032, 1572864, 32768, 8, 60035072, 114688, 0, 0, 218104000, 1
    .long 2, 64, 72, 7168, 6400, 6400, 7340032, 2621440, 32768, 8, 63803392, 114688, 0, 0, 218104176, 1
    .long 1, 80, 80, 2048, 1835520, 1835776, 7340032, 61894656, 114688, 7, 174071808, 32768, 218104080, 7, 218106624, 1
    .long 0, 0, 0, 0, 0, 0, 0, 0, 0, 0, 0, 0, 0, 0, 0, 0
    .long 0, 0, 0, 0, 0, 0, 0, 0, 0, 0, 0, 0, 0, 0, 0, 0
    .long 4, 32, 32, 8192, 4864, 267008, 8388608, 0, 32768, 4, 37826560, 131072, 0, 0, 218104384, 1
    .long 4, 32, 32, 8192, 4864, 267008, 8388608, 262144, 32768, 4, 38875136, 131072, 0, 0, 218104512, 1
    .long 4, 16, 16, 8192, 5632, 267776, 8388608, 524288, 32768, 4, 6381568, 131072, 0, 0, 218104656, 1
    .long 1, 24, 24, 8192, 4608, 4864, 8388608, 1572864, 32768, 8, 27336704, 131072, 0, 0, 218105152, 4
    .long 2, 64, 72, 7168, 1536, 1536, 7340032, 0, 32768, 8, 54550528, 114688, 0, 0, 218103808, 1
    .long 2, 64, 72, 7168, 512, 512, 7340032, 1572864, 32768, 8, 60039168, 114688, 0, 0, 218104000, 1
    .long 2, 64, 72, 7168, 6656, 6656, 7340032, 2621440, 32768, 8, 63807488, 114688, 0, 0, 218104176, 1
    .long 1, 80, 80, 2048, 1836032, 1836288, 7340032, 61894656, 114688, 7, 174080000, 32768, 218104080, 7, 218106624, 1
    .long 0, 0, 0, 0, 0, 0, 0, 0, 0, 0, 0, 0, 0, 0, 0, 0
    .long 0, 0, 0, 0, 0, 0, 0, 0, 0, 0, 0, 0, 0, 0, 0, 0
    .long 4, 32, 32, 8192, 6912, 269056, 8388608, 0, 32768, 4, 37859328, 131072, 0, 0, 218104416, 1
    .long 4, 32, 32, 8192, 6912, 269056, 8388608, 262144, 32768, 4, 38907904, 131072, 0, 0, 218104544, 1
    .long 4, 16, 16, 8192, 7680, 269824, 8388608, 524288, 32768, 4, 6414336, 131072, 0, 0, 218104688, 1
    .long 1, 24, 24, 8192, 6656, 6912, 8388608, 1572864, 32768, 8, 27369472, 131072, 0, 0, 218105184, 4
    .long 2, 64, 72, 7168, 1792, 1792, 7340032, 0, 32768, 8, 54554624, 114688, 0, 0, 218103824, 1
    .long 2, 64, 72, 7168, 768, 768, 7340032, 1572864, 32768, 8, 60043264, 114688, 0, 0, 218104000, 1
    .long 2, 64, 72, 7168, 6912, 6912, 7340032, 2621440, 32768, 8, 63811584, 114688, 0, 0, 218104176, 1
    .long 1, 80, 80, 2048, 1836544, 1836800, 7340032, 61894656, 114688, 7, 174088192, 32768, 218104080, 7, 218106624, 1
    .long 0, 0, 0, 0, 0, 0, 0, 0, 0, 0, 0, 0, 0, 0, 0, 0
    .long 0, 0, 0, 0, 0, 0, 0, 0, 0, 0, 0, 0, 0, 0, 0, 0
    .long 4, 32, 32, 8192, 1024, 263168, 8388608, 0, 32768, 4, 37765120, 131072, 0, 0, 218104336, 1
    .long 4, 32, 32, 8192, 1024, 263168, 8388608, 262144, 32768, 4, 38813696, 131072, 0, 0, 218104464, 1
    .long 4, 16, 16, 8192, 1280, 263424, 8388608, 786432, 32768, 4, 7360512, 131072, 0, 0, 218104592, 1
    .long 1, 24, 24, 8192, 1024, 1280, 8388608, 1572864, 32768, 8, 27279360, 131072, 0, 0, 218105104, 4
    .long 2, 64, 72, 7168, 2048, 2048, 7340032, 0, 32768, 8, 54558720, 114688, 0, 0, 218103824, 1
    .long 2, 64, 72, 7168, 1024, 1024, 7340032, 1572864, 32768, 8, 60047360, 114688, 0, 0, 218104000, 1
    .long 2, 64, 72, 7168, 0, 0, 7340032, 3145728, 32768, 8, 65536000, 114688, 0, 0, 218104192, 1
    .long 1, 80, 80, 2048, 3670016, 3670272, 7340032, 61923328, 114688, 7, 178257920, 32768, 218104096, 7, 218106624, 1
    .long 0, 0, 0, 0, 0, 0, 0, 0, 0, 0, 0, 0, 0, 0, 0, 0
    .long 0, 0, 0, 0, 0, 0, 0, 0, 0, 0, 0, 0, 0, 0, 0, 0
    .long 4, 32, 32, 8192, 3072, 265216, 8388608, 0, 32768, 4, 37797888, 131072, 0, 0, 218104368, 1
    .long 4, 32, 32, 8192, 3072, 265216, 8388608, 262144, 32768, 4, 38846464, 131072, 0, 0, 218104496, 1
    .long 4, 16, 16, 8192, 3328, 265472, 8388608, 786432, 32768, 4, 7393280, 131072, 0, 0, 218104624, 1
    .long 1, 24, 24, 8192, 3072, 3328, 8388608, 1572864, 32768, 8, 27312128, 131072, 0, 0, 218105136, 4
    .long 2, 64, 72, 7168, 2304, 2304, 7340032, 0, 32768, 8, 54562816, 114688, 0, 0, 218103824, 1
    .long 2, 64, 72, 7168, 1280, 1280, 7340032, 1572864, 32768, 8, 60051456, 114688, 0, 0, 218104000, 1
    .long 2, 64, 72, 7168, 256, 256, 7340032, 3145728, 32768, 8, 65540096, 114688, 0, 0, 218104192, 1
    .long 1, 80, 80, 2048, 3670528, 3670784, 7340032, 61923328, 114688, 7, 178266112, 32768, 218104096, 7, 218106624, 1
    .long 0, 0, 0, 0, 0, 0, 0, 0, 0, 0, 0, 0, 0, 0, 0, 0
    .long 0, 0, 0, 0, 0, 0, 0, 0, 0, 0, 0, 0, 0, 0, 0, 0
    .long 4, 32, 32, 8192, 5120, 267264, 8388608, 0, 32768, 4, 37830656, 131072, 0, 0, 218104400, 1
    .long 4, 32, 32, 8192, 5120, 267264, 8388608, 262144, 32768, 4, 38879232, 131072, 0, 0, 218104528, 1
    .long 4, 16, 16, 8192, 5376, 267520, 8388608, 786432, 32768, 4, 7426048, 131072, 0, 0, 218104656, 1
    .long 1, 24, 24, 8192, 5120, 5376, 8388608, 1572864, 32768, 8, 27344896, 131072, 0, 0, 218105168, 4
    .long 2, 64, 72, 7168, 2560, 2560, 7340032, 0, 32768, 8, 54566912, 114688, 0, 0, 218103824, 1
    .long 2, 64, 72, 7168, 1536, 1536, 7340032, 1572864, 32768, 8, 60055552, 114688, 0, 0, 218104000, 1
    .long 2, 64, 72, 7168, 512, 512, 7340032, 3145728, 32768, 8, 65544192, 114688, 0, 0, 218104192, 1
    .long 1, 80, 80, 2048, 3671040, 3671296, 7340032, 61923328, 114688, 7, 178274304, 32768, 218104096, 7, 218106624, 1
    .long 0, 0, 0, 0, 0, 0, 0, 0, 0, 0, 0, 0, 0, 0, 0, 0
    .long 0, 0, 0, 0, 0, 0, 0, 0, 0, 0, 0, 0, 0, 0, 0, 0
    .long 4, 32, 32, 8192, 7168, 269312, 8388608, 0, 32768, 4, 37863424, 131072, 0, 0, 218104432, 1
    .long 4, 32, 32, 8192, 7168, 269312, 8388608, 262144, 32768, 4, 38912000, 131072, 0, 0, 218104560, 1
    .long 4, 16, 16, 8192, 7424, 269568, 8388608, 786432, 32768, 4, 7458816, 131072, 0, 0, 218104688, 1
    .long 1, 24, 24, 8192, 7168, 7424, 8388608, 1572864, 32768, 8, 27377664, 131072, 0, 0, 218105200, 4
    .long 2, 64, 72, 7168, 2816, 2816, 7340032, 0, 32768, 8, 54571008, 114688, 0, 0, 218103824, 1
    .long 2, 64, 72, 7168, 1792, 1792, 7340032, 1572864, 32768, 8, 60059648, 114688, 0, 0, 218104016, 1
    .long 2, 64, 72, 7168, 768, 768, 7340032, 3145728, 32768, 8, 65548288, 114688, 0, 0, 218104192, 1
    .long 1, 80, 80, 2048, 3671552, 3671808, 7340032, 61923328, 114688, 7, 178282496, 32768, 218104096, 7, 218106624, 1
    .long 0, 0, 0, 0, 0, 0, 0, 0, 0, 0, 0, 0, 0, 0, 0, 0
    .long 0, 0, 0, 0, 0, 0, 0, 0, 0, 0, 0, 0, 0, 0, 0, 0
    .long 4, 32, 32, 8192, 1280, 263424, 8388608, 0, 32768, 4, 37769216, 131072, 0, 0, 218104336, 1
    .long 4, 32, 32, 8192, 1280, 263424, 8388608, 262144, 32768, 4, 38817792, 131072, 0, 0, 218104464, 1
    .long 4, 16, 16, 8192, 1280, 263424, 8388608, 524288, 32768, 4, 6311936, 131072, 0, 0, 218104592, 1
    .long 1, 24, 24, 8192, 1536, 1792, 8388608, 1572864, 32768, 8, 27287552, 131072, 0, 0, 218105104, 4
    .long 2, 64, 72, 7168, 3072, 3072, 7340032, 0, 32768, 8, 54575104, 114688, 0, 0, 218103824, 1
    .long 2, 64, 72, 7168, 2048, 2048, 7340032, 1572864, 32768, 8, 60063744, 114688, 0, 0, 218104016, 1
    .long 2, 64, 72, 7168, 1024, 1024, 7340032, 3145728, 32768, 8, 65552384, 114688, 0, 0, 218104192, 1
    .long 1, 80, 80, 2048, 5505024, 5505280, 7340032, 61952000, 114688, 7, 182452224, 32768, 218104112, 7, 218106624, 1
    .long 0, 0, 0, 0, 0, 0, 0, 0, 0, 0, 0, 0, 0, 0, 0, 0
    .long 0, 0, 0, 0, 0, 0, 0, 0, 0, 0, 0, 0, 0, 0, 0, 0
    .long 4, 32, 32, 8192, 3328, 265472, 8388608, 0, 32768, 4, 37801984, 131072, 0, 0, 218104368, 1
    .long 4, 32, 32, 8192, 3328, 265472, 8388608, 262144, 32768, 4, 38850560, 131072, 0, 0, 218104496, 1
    .long 4, 16, 16, 8192, 3328, 265472, 8388608, 524288, 32768, 4, 6344704, 131072, 0, 0, 218104624, 1
    .long 1, 24, 24, 8192, 3584, 3840, 8388608, 1572864, 32768, 8, 27320320, 131072, 0, 0, 218105136, 4
    .long 2, 64, 72, 7168, 3328, 3328, 7340032, 0, 32768, 8, 54579200, 114688, 0, 0, 218103824, 1
    .long 2, 64, 72, 7168, 2304, 2304, 7340032, 1572864, 32768, 8, 60067840, 114688, 0, 0, 218104016, 1
    .long 2, 64, 72, 7168, 1280, 1280, 7340032, 3145728, 32768, 8, 65556480, 114688, 0, 0, 218104192, 1
    .long 1, 80, 80, 2048, 5505536, 5505792, 7340032, 61952000, 114688, 7, 182460416, 32768, 218104112, 7, 218106624, 1
    .long 0, 0, 0, 0, 0, 0, 0, 0, 0, 0, 0, 0, 0, 0, 0, 0
    .long 0, 0, 0, 0, 0, 0, 0, 0, 0, 0, 0, 0, 0, 0, 0, 0
    .long 4, 32, 32, 8192, 5376, 267520, 8388608, 0, 32768, 4, 37834752, 131072, 0, 0, 218104400, 1
    .long 4, 32, 32, 8192, 5376, 267520, 8388608, 262144, 32768, 4, 38883328, 131072, 0, 0, 218104528, 1
    .long 4, 16, 16, 8192, 5376, 267520, 8388608, 524288, 32768, 4, 6377472, 131072, 0, 0, 218104656, 1
    .long 1, 24, 24, 8192, 5632, 5888, 8388608, 1572864, 32768, 8, 27353088, 131072, 0, 0, 218105168, 4
    .long 2, 64, 72, 7168, 3584, 3584, 7340032, 0, 32768, 8, 54583296, 114688, 0, 0, 218103840, 1
    .long 2, 64, 72, 7168, 2560, 2560, 7340032, 1572864, 32768, 8, 60071936, 114688, 0, 0, 218104016, 1
    .long 2, 64, 72, 7168, 1536, 1536, 7340032, 3145728, 32768, 8, 65560576, 114688, 0, 0, 218104192, 1
    .long 1, 80, 80, 2048, 5506048, 5506304, 7340032, 61952000, 114688, 7, 182468608, 32768, 218104112, 7, 218106624, 1
    .long 0, 0, 0, 0, 0, 0, 0, 0, 0, 0, 0, 0, 0, 0, 0, 0
    .long 0, 0, 0, 0, 0, 0, 0, 0, 0, 0, 0, 0, 0, 0, 0, 0
    .long 4, 32, 32, 8192, 7424, 269568, 8388608, 0, 32768, 4, 37867520, 131072, 0, 0, 218104432, 1
    .long 4, 32, 32, 8192, 7424, 269568, 8388608, 262144, 32768, 4, 38916096, 131072, 0, 0, 218104560, 1
    .long 4, 16, 16, 8192, 7424, 269568, 8388608, 524288, 32768, 4, 6410240, 131072, 0, 0, 218104688, 1
    .long 1, 24, 24, 8192, 7680, 7936, 8388608, 1572864, 32768, 8, 27385856, 131072, 0, 0, 218105200, 4
    .long 2, 64, 72, 7168, 3840, 3840, 7340032, 0, 32768, 8, 54587392, 114688, 0, 0, 218103840, 1
    .long 2, 64, 72, 7168, 2816, 2816, 7340032, 1572864, 32768, 8, 60076032, 114688, 0, 0, 218104016, 1
    .long 2, 64, 72, 7168, 1792, 1792, 7340032, 3145728, 32768, 8, 65564672, 114688, 0, 0, 218104208, 1
    .long 1, 80, 80, 2048, 5506560, 5506816, 7340032, 61952000, 114688, 7, 182476800, 32768, 218104112, 7, 218106624, 1
    .long 0, 0, 0, 0, 0, 0, 0, 0, 0, 0, 0, 0, 0, 0, 0, 0
    .long 0, 0, 0, 0, 0, 0, 0, 0, 0, 0, 0, 0, 0, 0, 0, 0
    .long 4, 32, 32, 8192, 1536, 263680, 8388608, 0, 32768, 4, 37773312, 131072, 0, 0, 218104336, 1
    .long 4, 32, 32, 8192, 1536, 263680, 8388608, 262144, 32768, 4, 38821888, 131072, 0, 0, 218104464, 1
    .long 4, 16, 16, 8192, 1024, 263168, 8388608, 786432, 32768, 4, 7356416, 131072, 0, 0, 218104592, 1
    .long 1, 16, 16, 8192, 0, 256, 8388608, 1572864, 32768, 8, 10485760, 131072, 0, 0, 218105088, 4
    .long 2, 64, 72, 7168, 4096, 4096, 7340032, 0, 32768, 8, 54591488, 114688, 0, 0, 218103840, 1
    .long 2, 64, 72, 7168, 3072, 3072, 7340032, 1572864, 32768, 8, 60080128, 114688, 0, 0, 218104016, 1
    .long 2, 64, 72, 7168, 2048, 2048, 7340032, 3145728, 32768, 8, 65568768, 114688, 0, 0, 218104208, 1
    .long 1, 80, 80, 2048, 0, 256, 7340032, 63700992, 114688, 7, 170393600, 32768, 218104128, 7, 218106688, 1
    .long 0, 0, 0, 0, 0, 0, 0, 0, 0, 0, 0, 0, 0, 0, 0, 0
    .long 0, 0, 0, 0, 0, 0, 0, 0, 0, 0, 0, 0, 0, 0, 0, 0
    .long 4, 32, 32, 8192, 3584, 265728, 8388608, 0, 32768, 4, 37806080, 131072, 0, 0, 218104368, 1
    .long 4, 32, 32, 8192, 3584, 265728, 8388608, 262144, 32768, 4, 38854656, 131072, 0, 0, 218104496, 1
    .long 4, 16, 16, 8192, 3072, 265216, 8388608, 786432, 32768, 4, 7389184, 131072, 0, 0, 218104624, 1
    .long 1, 16, 16, 8192, 2048, 2304, 8388608, 1572864, 32768, 8, 10518528, 131072, 0, 0, 218105120, 4
    .long 2, 64, 72, 7168, 4352, 4352, 7340032, 0, 32768, 8, 54595584, 114688, 0, 0, 218103840, 1
    .long 2, 64, 72, 7168, 3328, 3328, 7340032, 1572864, 32768, 8, 60084224, 114688, 0, 0, 218104016, 1
    .long 2, 64, 72, 7168, 2304, 2304, 7340032, 3145728, 32768, 8, 65572864, 114688, 0, 0, 218104208, 1
    .long 1, 80, 80, 2048, 512, 768, 7340032, 63700992, 114688, 7, 170401792, 32768, 218104128, 7, 218106688, 1
    .long 0, 0, 0, 0, 0, 0, 0, 0, 0, 0, 0, 0, 0, 0, 0, 0
    .long 0, 0, 0, 0, 0, 0, 0, 0, 0, 0, 0, 0, 0, 0, 0, 0
    .long 4, 32, 32, 8192, 5632, 267776, 8388608, 0, 32768, 4, 37838848, 131072, 0, 0, 218104400, 1
    .long 4, 32, 32, 8192, 5632, 267776, 8388608, 262144, 32768, 4, 38887424, 131072, 0, 0, 218104528, 1
    .long 4, 16, 16, 8192, 5120, 267264, 8388608, 786432, 32768, 4, 7421952, 131072, 0, 0, 218104656, 1
    .long 1, 16, 16, 8192, 4096, 4352, 8388608, 1572864, 32768, 8, 10551296, 131072, 0, 0, 218105152, 4
    .long 2, 64, 72, 7168, 4608, 4608, 7340032, 0, 32768, 8, 54599680, 114688, 0, 0, 218103840, 1
    .long 2, 64, 72, 7168, 3584, 3584, 7340032, 1572864, 32768, 8, 60088320, 114688, 0, 0, 218104032, 1
    .long 2, 64, 72, 7168, 2560, 2560, 7340032, 3145728, 32768, 8, 65576960, 114688, 0, 0, 218104208, 1
    .long 1, 80, 80, 2048, 1024, 1280, 7340032, 63700992, 114688, 7, 170409984, 32768, 218104128, 7, 218106688, 1
    .long 0, 0, 0, 0, 0, 0, 0, 0, 0, 0, 0, 0, 0, 0, 0, 0
    .long 0, 0, 0, 0, 0, 0, 0, 0, 0, 0, 0, 0, 0, 0, 0, 0
    .long 4, 32, 32, 8192, 7680, 269824, 8388608, 0, 32768, 4, 37871616, 131072, 0, 0, 218104432, 1
    .long 4, 32, 32, 8192, 7680, 269824, 8388608, 262144, 32768, 4, 38920192, 131072, 0, 0, 218104560, 1
    .long 4, 16, 16, 8192, 7168, 269312, 8388608, 786432, 32768, 4, 7454720, 131072, 0, 0, 218104688, 1
    .long 1, 16, 16, 8192, 6144, 6400, 8388608, 1572864, 32768, 8, 10584064, 131072, 0, 0, 218105184, 4
    .long 2, 64, 72, 7168, 4864, 4864, 7340032, 0, 32768, 8, 54603776, 114688, 0, 0, 218103840, 1
    .long 2, 64, 72, 7168, 3840, 3840, 7340032, 1572864, 32768, 8, 60092416, 114688, 0, 0, 218104032, 1
    .long 2, 64, 72, 7168, 2816, 2816, 7340032, 3145728, 32768, 8, 65581056, 114688, 0, 0, 218104208, 1
    .long 1, 80, 80, 2048, 1536, 1792, 7340032, 63700992, 114688, 7, 170418176, 32768, 218104128, 7, 218106688, 1
    .long 0, 0, 0, 0, 0, 0, 0, 0, 0, 0, 0, 0, 0, 0, 0, 0
    .long 0, 0, 0, 0, 0, 0, 0, 0, 0, 0, 0, 0, 0, 0, 0, 0
    .long 4, 32, 32, 8192, 1792, 263936, 8388608, 0, 32768, 4, 37777408, 131072, 0, 0, 218104336, 1
    .long 4, 32, 32, 8192, 1792, 263936, 8388608, 262144, 32768, 4, 38825984, 131072, 0, 0, 218104464, 1
    .long 4, 16, 16, 8192, 1024, 263168, 8388608, 524288, 32768, 4, 6307840, 131072, 0, 0, 218104592, 1
    .long 1, 16, 16, 8192, 512, 768, 8388608, 1572864, 32768, 8, 10493952, 131072, 0, 0, 218105088, 4
    .long 2, 64, 72, 7168, 5120, 5120, 7340032, 0, 32768, 8, 54607872, 114688, 0, 0, 218103840, 1
    .long 2, 64, 72, 7168, 4096, 4096, 7340032, 1572864, 32768, 8, 60096512, 114688, 0, 0, 218104032, 1
    .long 2, 64, 72, 7168, 3072, 3072, 7340032, 3145728, 32768, 8, 65585152, 114688, 0, 0, 218104208, 1
    .long 1, 80, 80, 2048, 1835008, 1835264, 7340032, 63729664, 114688, 7, 174587904, 32768, 218104144, 7, 218106688, 1
    .long 0, 0, 0, 0, 0, 0, 0, 0, 0, 0, 0, 0, 0, 0, 0, 0
    .long 0, 0, 0, 0, 0, 0, 0, 0, 0, 0, 0, 0, 0, 0, 0, 0
    .long 4, 32, 32, 8192, 3840, 265984, 8388608, 0, 32768, 4, 37810176, 131072, 0, 0, 218104368, 1
    .long 4, 32, 32, 8192, 3840, 265984, 8388608, 262144, 32768, 4, 38858752, 131072, 0, 0, 218104496, 1
    .long 4, 16, 16, 8192, 3072, 265216, 8388608, 524288, 32768, 4, 6340608, 131072, 0, 0, 218104624, 1
    .long 1, 16, 16, 8192, 2560, 2816, 8388608, 1572864, 32768, 8, 10526720, 131072, 0, 0, 218105120, 4
    .long 2, 64, 72, 7168, 5376, 5376, 7340032, 0, 32768, 8, 54611968, 114688, 0, 0, 218103856, 1
    .long 2, 64, 72, 7168, 4352, 4352, 7340032, 1572864, 32768, 8, 60100608, 114688, 0, 0, 218104032, 1
    .long 2, 64, 72, 7168, 3328, 3328, 7340032, 3145728, 32768, 8, 65589248, 114688, 0, 0, 218104208, 1
    .long 1, 80, 80, 2048, 1835520, 1835776, 7340032, 63729664, 114688, 7, 174596096, 32768, 218104144, 7, 218106688, 1
    .long 0, 0, 0, 0, 0, 0, 0, 0, 0, 0, 0, 0, 0, 0, 0, 0
    .long 0, 0, 0, 0, 0, 0, 0, 0, 0, 0, 0, 0, 0, 0, 0, 0
    .long 4, 32, 32, 8192, 5888, 268032, 8388608, 0, 32768, 4, 37842944, 131072, 0, 0, 218104400, 1
    .long 4, 32, 32, 8192, 5888, 268032, 8388608, 262144, 32768, 4, 38891520, 131072, 0, 0, 218104528, 1
    .long 4, 16, 16, 8192, 5120, 267264, 8388608, 524288, 32768, 4, 6373376, 131072, 0, 0, 218104656, 1
    .long 1, 16, 16, 8192, 4608, 4864, 8388608, 1572864, 32768, 8, 10559488, 131072, 0, 0, 218105152, 4
    .long 2, 64, 72, 7168, 5632, 5632, 7340032, 0, 32768, 8, 54616064, 114688, 0, 0, 218103856, 1
    .long 2, 64, 72, 7168, 4608, 4608, 7340032, 1572864, 32768, 8, 60104704, 114688, 0, 0, 218104032, 1
    .long 2, 64, 72, 7168, 3584, 3584, 7340032, 3145728, 32768, 8, 65593344, 114688, 0, 0, 218104224, 1
    .long 1, 80, 80, 2048, 1836032, 1836288, 7340032, 63729664, 114688, 7, 174604288, 32768, 218104144, 7, 218106688, 1
    .long 0, 0, 0, 0, 0, 0, 0, 0, 0, 0, 0, 0, 0, 0, 0, 0
    .long 0, 0, 0, 0, 0, 0, 0, 0, 0, 0, 0, 0, 0, 0, 0, 0
    .long 4, 32, 32, 8192, 7936, 270080, 8388608, 0, 32768, 4, 37875712, 131072, 0, 0, 218104432, 1
    .long 4, 32, 32, 8192, 7936, 270080, 8388608, 262144, 32768, 4, 38924288, 131072, 0, 0, 218104560, 1
    .long 4, 16, 16, 8192, 7168, 269312, 8388608, 524288, 32768, 4, 6406144, 131072, 0, 0, 218104688, 1
    .long 1, 16, 16, 8192, 6656, 6912, 8388608, 1572864, 32768, 8, 10592256, 131072, 0, 0, 218105184, 4
    .long 2, 64, 72, 7168, 5888, 5888, 7340032, 0, 32768, 8, 54620160, 114688, 0, 0, 218103856, 1
    .long 2, 64, 72, 7168, 4864, 4864, 7340032, 1572864, 32768, 8, 60108800, 114688, 0, 0, 218104032, 1
    .long 2, 64, 72, 7168, 3840, 3840, 7340032, 3145728, 32768, 8, 65597440, 114688, 0, 0, 218104224, 1
    .long 1, 80, 80, 2048, 1836544, 1836800, 7340032, 63729664, 114688, 7, 174612480, 32768, 218104144, 7, 218106688, 1
    .long 0, 0, 0, 0, 0, 0, 0, 0, 0, 0, 0, 0, 0, 0, 0, 0
    .long 0, 0, 0, 0, 0, 0, 0, 0, 0, 0, 0, 0, 0, 0, 0, 0
    .long 4, 16, 16, 8192, 0, 262144, 8388608, 0, 32768, 4, 4194304, 131072, 0, 0, 218104320, 1
    .long 4, 16, 16, 8192, 0, 262144, 8388608, 262144, 32768, 4, 5242880, 131072, 0, 0, 218104448, 1
    .long 4, 16, 16, 8192, 0, 262144, 8388608, 524288, 32768, 4, 6291456, 131072, 0, 0, 218104576, 1
    .long 1, 16, 16, 8192, 1024, 1280, 8388608, 1572864, 32768, 8, 10502144, 131072, 0, 0, 218105104, 4
    .long 2, 64, 72, 7168, 6144, 6144, 7340032, 0, 32768, 8, 54624256, 114688, 0, 0, 218103856, 1
    .long 2, 64, 72, 7168, 5120, 5120, 7340032, 1572864, 32768, 8, 60112896, 114688, 0, 0, 218104032, 1
    .long 2, 64, 72, 7168, 4096, 4096, 7340032, 3145728, 32768, 8, 65601536, 114688, 0, 0, 218104224, 1
    .long 1, 80, 80, 2048, 3670016, 3670272, 7340032, 63758336, 114688, 7, 178782208, 32768, 218104160, 7, 218106688, 1
    .long 0, 0, 0, 0, 0, 0, 0, 0, 0, 0, 0, 0, 0, 0, 0, 0
    .long 0, 0, 0, 0, 0, 0, 0, 0, 0, 0, 0, 0, 0, 0, 0, 0
    .long 4, 16, 16, 8192, 2048, 264192, 8388608, 0, 32768, 4, 4227072, 131072, 0, 0, 218104352, 1
    .long 4, 16, 16, 8192, 2048, 264192, 8388608, 262144, 32768, 4, 5275648, 131072, 0, 0, 218104480, 1
    .long 4, 16, 16, 8192, 2048, 264192, 8388608, 524288, 32768, 4, 6324224, 131072, 0, 0, 218104608, 1
    .long 1, 16, 16, 8192, 3072, 3328, 8388608, 1572864, 32768, 8, 10534912, 131072, 0, 0, 218105136, 4
    .long 2, 64, 72, 7168, 6400, 6400, 7340032, 0, 32768, 8, 54628352, 114688, 0, 0, 218103856, 1
    .long 2, 64, 72, 7168, 5376, 5376, 7340032, 1572864, 32768, 8, 60116992, 114688, 0, 0, 218104048, 1
    .long 2, 64, 72, 7168, 4352, 4352, 7340032, 3145728, 32768, 8, 65605632, 114688, 0, 0, 218104224, 1
    .long 1, 80, 80, 2048, 3670528, 3670784, 7340032, 63758336, 114688, 7, 178790400, 32768, 218104160, 7, 218106688, 1
    .long 0, 0, 0, 0, 0, 0, 0, 0, 0, 0, 0, 0, 0, 0, 0, 0
    .long 0, 0, 0, 0, 0, 0, 0, 0, 0, 0, 0, 0, 0, 0, 0, 0
    .long 4, 16, 16, 8192, 4096, 266240, 8388608, 0, 32768, 4, 4259840, 131072, 0, 0, 218104384, 1
    .long 4, 16, 16, 8192, 4096, 266240, 8388608, 262144, 32768, 4, 5308416, 131072, 0, 0, 218104512, 1
    .long 4, 16, 16, 8192, 4096, 266240, 8388608, 524288, 32768, 4, 6356992, 131072, 0, 0, 218104640, 1
    .long 1, 16, 16, 8192, 5120, 5376, 8388608, 1572864, 32768, 8, 10567680, 131072, 0, 0, 218105168, 4
    .long 2, 64, 72, 7168, 6656, 6656, 7340032, 0, 32768, 8, 54632448, 114688, 0, 0, 218103856, 1
    .long 2, 64, 72, 7168, 5632, 5632, 7340032, 1572864, 32768, 8, 60121088, 114688, 0, 0, 218104048, 1
    .long 2, 64, 72, 7168, 4608, 4608, 7340032, 3145728, 32768, 8, 65609728, 114688, 0, 0, 218104224, 1
    .long 1, 80, 80, 2048, 3671040, 3671296, 7340032, 63758336, 114688, 7, 178798592, 32768, 218104160, 7, 218106688, 1
    .long 0, 0, 0, 0, 0, 0, 0, 0, 0, 0, 0, 0, 0, 0, 0, 0
    .long 0, 0, 0, 0, 0, 0, 0, 0, 0, 0, 0, 0, 0, 0, 0, 0
    .long 4, 16, 16, 8192, 6144, 268288, 8388608, 0, 32768, 4, 4292608, 131072, 0, 0, 218104416, 1
    .long 4, 16, 16, 8192, 6144, 268288, 8388608, 262144, 32768, 4, 5341184, 131072, 0, 0, 218104544, 1
    .long 4, 16, 16, 8192, 6144, 268288, 8388608, 524288, 32768, 4, 6389760, 131072, 0, 0, 218104672, 1
    .long 1, 16, 16, 8192, 7168, 7424, 8388608, 1572864, 32768, 8, 10600448, 131072, 0, 0, 218105200, 4
    .long 2, 64, 72, 7168, 6912, 6912, 7340032, 0, 32768, 8, 54636544, 114688, 0, 0, 218103856, 1
    .long 2, 64, 72, 7168, 5888, 5888, 7340032, 1572864, 32768, 8, 60125184, 114688, 0, 0, 218104048, 1
    .long 2, 64, 72, 7168, 4864, 4864, 7340032, 3145728, 32768, 8, 65613824, 114688, 0, 0, 218104224, 1
    .long 1, 80, 80, 2048, 3671552, 3671808, 7340032, 63758336, 114688, 7, 178806784, 32768, 218104160, 7, 218106688, 1
    .long 0, 0, 0, 0, 0, 0, 0, 0, 0, 0, 0, 0, 0, 0, 0, 0
    .long 0, 0, 0, 0, 0, 0, 0, 0, 0, 0, 0, 0, 0, 0, 0, 0
    .long 4, 16, 16, 8192, 256, 262400, 8388608, 0, 32768, 4, 4198400, 131072, 0, 0, 218104320, 1
    .long 4, 16, 16, 8192, 256, 262400, 8388608, 262144, 32768, 4, 5246976, 131072, 0, 0, 218104448, 1
    .long 4, 16, 16, 8192, 256, 262400, 8388608, 524288, 32768, 4, 6295552, 131072, 0, 0, 218104576, 1
    .long 1, 16, 16, 8192, 1536, 1792, 8388608, 1572864, 32768, 8, 10510336, 131072, 0, 0, 218105104, 4
    .long 2, 64, 72, 7168, 0, 0, 7340032, 524288, 32768, 8, 56360960, 114688, 0, 0, 218103872, 1
    .long 2, 64, 72, 7168, 6144, 6144, 7340032, 1572864, 32768, 8, 60129280, 114688, 0, 0, 218104048, 1
    .long 2, 64, 72, 7168, 5120, 5120, 7340032, 3145728, 32768, 8, 65617920, 114688, 0, 0, 218104224, 1
    .long 1, 80, 80, 2048, 5505024, 5505280, 7340032, 63787008, 114688, 7, 182976512, 32768, 218104176, 7, 218106688, 1
    .long 0, 0, 0, 0, 0, 0, 0, 0, 0, 0, 0, 0, 0, 0, 0, 0
    .long 0, 0, 0, 0, 0, 0, 0, 0, 0, 0, 0, 0, 0, 0, 0, 0
    .long 4, 16, 16, 8192, 2304, 264448, 8388608, 0, 32768, 4, 4231168, 131072, 0, 0, 218104352, 1
    .long 4, 16, 16, 8192, 2304, 264448, 8388608, 262144, 32768, 4, 5279744, 131072, 0, 0, 218104480, 1
    .long 4, 16, 16, 8192, 2304, 264448, 8388608, 524288, 32768, 4, 6328320, 131072, 0, 0, 218104608, 1
    .long 1, 16, 16, 8192, 3584, 3840, 8388608, 1572864, 32768, 8, 10543104, 131072, 0, 0, 218105136, 4
    .long 2, 64, 72, 7168, 256, 256, 7340032, 524288, 32768, 8, 56365056, 114688, 0, 0, 218103872, 1
    .long 2, 64, 72, 7168, 6400, 6400, 7340032, 1572864, 32768, 8, 60133376, 114688, 0, 0, 218104048, 1
    .long 2, 64, 72, 7168, 5376, 5376, 7340032, 3145728, 32768, 8, 65622016, 114688, 0, 0, 218104240, 1
    .long 1, 80, 80, 2048, 5505536, 5505792, 7340032, 63787008, 114688, 7, 182984704, 32768, 218104176, 7, 218106688, 1
    .long 0, 0, 0, 0, 0, 0, 0, 0, 0, 0, 0, 0, 0, 0, 0, 0
    .long 0, 0, 0, 0, 0, 0, 0, 0, 0, 0, 0, 0, 0, 0, 0, 0
    .long 4, 16, 16, 8192, 4352, 266496, 8388608, 0, 32768, 4, 4263936, 131072, 0, 0, 218104384, 1
    .long 4, 16, 16, 8192, 4352, 266496, 8388608, 262144, 32768, 4, 5312512, 131072, 0, 0, 218104512, 1
    .long 4, 16, 16, 8192, 4352, 266496, 8388608, 524288, 32768, 4, 6361088, 131072, 0, 0, 218104640, 1
    .long 1, 16, 16, 8192, 5632, 5888, 8388608, 1572864, 32768, 8, 10575872, 131072, 0, 0, 218105168, 4
    .long 2, 64, 72, 7168, 512, 512, 7340032, 524288, 32768, 8, 56369152, 114688, 0, 0, 218103872, 1
    .long 2, 64, 72, 7168, 6656, 6656, 7340032, 1572864, 32768, 8, 60137472, 114688, 0, 0, 218104048, 1
    .long 2, 64, 72, 7168, 5632, 5632, 7340032, 3145728, 32768, 8, 65626112, 114688, 0, 0, 218104240, 1
    .long 1, 80, 80, 2048, 5506048, 5506304, 7340032, 63787008, 114688, 7, 182992896, 32768, 218104176, 7, 218106688, 1
    .long 0, 0, 0, 0, 0, 0, 0, 0, 0, 0, 0, 0, 0, 0, 0, 0
    .long 0, 0, 0, 0, 0, 0, 0, 0, 0, 0, 0, 0, 0, 0, 0, 0
    .long 4, 16, 16, 8192, 6400, 268544, 8388608, 0, 32768, 4, 4296704, 131072, 0, 0, 218104416, 1
    .long 4, 16, 16, 8192, 6400, 268544, 8388608, 262144, 32768, 4, 5345280, 131072, 0, 0, 218104544, 1
    .long 4, 16, 16, 8192, 6400, 268544, 8388608, 524288, 32768, 4, 6393856, 131072, 0, 0, 218104672, 1
    .long 1, 16, 16, 8192, 7680, 7936, 8388608, 1572864, 32768, 8, 10608640, 131072, 0, 0, 218105200, 4
    .long 2, 64, 72, 7168, 768, 768, 7340032, 524288, 32768, 8, 56373248, 114688, 0, 0, 218103872, 1
    .long 2, 64, 72, 7168, 6912, 6912, 7340032, 1572864, 32768, 8, 60141568, 114688, 0, 0, 218104048, 1
    .long 2, 64, 72, 7168, 5888, 5888, 7340032, 3145728, 32768, 8, 65630208, 114688, 0, 0, 218104240, 1
    .long 1, 80, 80, 2048, 5506560, 5506816, 7340032, 63787008, 114688, 7, 183001088, 32768, 218104176, 7, 218106688, 1
    .long 0, 0, 0, 0, 0, 0, 0, 0, 0, 0, 0, 0, 0, 0, 0, 0
    .long 0, 0, 0, 0, 0, 0, 0, 0, 0, 0, 0, 0, 0, 0, 0, 0
    .long 4, 16, 16, 8192, 512, 262656, 8388608, 0, 32768, 4, 4202496, 131072, 0, 0, 218104320, 1
    .long 4, 16, 16, 8192, 512, 262656, 8388608, 262144, 32768, 4, 5251072, 131072, 0, 0, 218104448, 1
    .long 4, 16, 16, 8192, 512, 262656, 8388608, 524288, 32768, 4, 6299648, 131072, 0, 0, 218104576, 1
    .long 1, 32, 32, 8192, 0, 256, 8388608, 2097152, 32768, 8, 46137344, 131072, 0, 0, 218105344, 4
    .long 2, 64, 72, 7168, 1024, 1024, 7340032, 524288, 32768, 8, 56377344, 114688, 0, 0, 218103872, 1
    .long 2, 64, 72, 7168, 0, 0, 7340032, 2097152, 32768, 8, 61865984, 114688, 0, 0, 218104064, 1
    .long 2, 64, 72, 7168, 6144, 6144, 7340032, 3145728, 32768, 8, 65634304, 114688, 0, 0, 218104240, 1
    .long 1, 80, 80, 2048, 0, 256, 7340032, 65536000, 114688, 7, 170917888, 32768, 218104192, 7, 218106752, 1
    .long 0, 0, 0, 0, 0, 0, 0, 0, 0, 0, 0, 0, 0, 0, 0, 0
    .long 0, 0, 0, 0, 0, 0, 0, 0, 0, 0, 0, 0, 0, 0, 0, 0
    .long 4, 16, 16, 8192, 2560, 264704, 8388608, 0, 32768, 4, 4235264, 131072, 0, 0, 218104352, 1
    .long 4, 16, 16, 8192, 2560, 264704, 8388608, 262144, 32768, 4, 5283840, 131072, 0, 0, 218104480, 1
    .long 4, 16, 16, 8192, 2560, 264704, 8388608, 524288, 32768, 4, 6332416, 131072, 0, 0, 218104608, 1
    .long 1, 32, 32, 8192, 2048, 2304, 8388608, 2097152, 32768, 8, 46170112, 131072, 0, 0, 218105376, 4
    .long 2, 64, 72, 7168, 1280, 1280, 7340032, 524288, 32768, 8, 56381440, 114688, 0, 0, 218103872, 1
    .long 2, 64, 72, 7168, 256, 256, 7340032, 2097152, 32768, 8, 61870080, 114688, 0, 0, 218104064, 1
    .long 2, 64, 72, 7168, 6400, 6400, 7340032, 3145728, 32768, 8, 65638400, 114688, 0, 0, 218104240, 1
    .long 1, 80, 80, 2048, 512, 768, 7340032, 65536000, 114688, 7, 170926080, 32768, 218104192, 7, 218106752, 1
    .long 0, 0, 0, 0, 0, 0, 0, 0, 0, 0, 0, 0, 0, 0, 0, 0
    .long 0, 0, 0, 0, 0, 0, 0, 0, 0, 0, 0, 0, 0, 0, 0, 0
    .long 4, 16, 16, 8192, 4608, 266752, 8388608, 0, 32768, 4, 4268032, 131072, 0, 0, 218104384, 1
    .long 4, 16, 16, 8192, 4608, 266752, 8388608, 262144, 32768, 4, 5316608, 131072, 0, 0, 218104512, 1
    .long 4, 16, 16, 8192, 4608, 266752, 8388608, 524288, 32768, 4, 6365184, 131072, 0, 0, 218104640, 1
    .long 1, 32, 32, 8192, 4096, 4352, 8388608, 2097152, 32768, 8, 46202880, 131072, 0, 0, 218105408, 4
    .long 2, 64, 72, 7168, 1536, 1536, 7340032, 524288, 32768, 8, 56385536, 114688, 0, 0, 218103872, 1
    .long 2, 64, 72, 7168, 512, 512, 7340032, 2097152, 32768, 8, 61874176, 114688, 0, 0, 218104064, 1
    .long 2, 64, 72, 7168, 6656, 6656, 7340032, 3145728, 32768, 8, 65642496, 114688, 0, 0, 218104240, 1
    .long 1, 80, 80, 2048, 1024, 1280, 7340032, 65536000, 114688, 7, 170934272, 32768, 218104192, 7, 218106752, 1
    .long 0, 0, 0, 0, 0, 0, 0, 0, 0, 0, 0, 0, 0, 0, 0, 0
    .long 0, 0, 0, 0, 0, 0, 0, 0, 0, 0, 0, 0, 0, 0, 0, 0
    .long 4, 16, 16, 8192, 6656, 268800, 8388608, 0, 32768, 4, 4300800, 131072, 0, 0, 218104416, 1
    .long 4, 16, 16, 8192, 6656, 268800, 8388608, 262144, 32768, 4, 5349376, 131072, 0, 0, 218104544, 1
    .long 4, 16, 16, 8192, 6656, 268800, 8388608, 524288, 32768, 4, 6397952, 131072, 0, 0, 218104672, 1
    .long 1, 32, 32, 8192, 6144, 6400, 8388608, 2097152, 32768, 8, 46235648, 131072, 0, 0, 218105440, 4
    .long 2, 64, 72, 7168, 1792, 1792, 7340032, 524288, 32768, 8, 56389632, 114688, 0, 0, 218103888, 1
    .long 2, 64, 72, 7168, 768, 768, 7340032, 2097152, 32768, 8, 61878272, 114688, 0, 0, 218104064, 1
    .long 2, 64, 72, 7168, 6912, 6912, 7340032, 3145728, 32768, 8, 65646592, 114688, 0, 0, 218104240, 1
    .long 1, 80, 80, 2048, 1536, 1792, 7340032, 65536000, 114688, 7, 170942464, 32768, 218104192, 7, 218106752, 1
    .long 0, 0, 0, 0, 0, 0, 0, 0, 0, 0, 0, 0, 0, 0, 0, 0
    .long 0, 0, 0, 0, 0, 0, 0, 0, 0, 0, 0, 0, 0, 0, 0, 0
    .long 4, 16, 16, 8192, 768, 262912, 8388608, 0, 32768, 4, 4206592, 131072, 0, 0, 218104320, 1
    .long 4, 16, 16, 8192, 768, 262912, 8388608, 262144, 32768, 4, 5255168, 131072, 0, 0, 218104448, 1
    .long 4, 16, 16, 8192, 768, 262912, 8388608, 524288, 32768, 4, 6303744, 131072, 0, 0, 218104576, 1
    .long 1, 32, 32, 8192, 512, 768, 8388608, 2097152, 32768, 8, 46145536, 131072, 0, 0, 218105344, 4
    .long 2, 64, 72, 7168, 2048, 2048, 7340032, 524288, 32768, 8, 56393728, 114688, 0, 0, 218103888, 1
    .long 2, 64, 72, 7168, 1024, 1024, 7340032, 2097152, 32768, 8, 61882368, 114688, 0, 0, 218104064, 1
    .long 2, 64, 72, 7168, 0, 0, 7340032, 3670016, 32768, 8, 67371008, 114688, 0, 0, 218104256, 1
    .long 1, 80, 80, 2048, 1835008, 1835264, 7340032, 65564672, 114688, 7, 175112192, 32768, 218104208, 7, 218106752, 1
    .long 0, 0, 0, 0, 0, 0, 0, 0, 0, 0, 0, 0, 0, 0, 0, 0
    .long 0, 0, 0, 0, 0, 0, 0, 0, 0, 0, 0, 0, 0, 0, 0, 0
    .long 4, 16, 16, 8192, 2816, 264960, 8388608, 0, 32768, 4, 4239360, 131072, 0, 0, 218104352, 1
    .long 4, 16, 16, 8192, 2816, 264960, 8388608, 262144, 32768, 4, 5287936, 131072, 0, 0, 218104480, 1
    .long 4, 16, 16, 8192, 2816, 264960, 8388608, 524288, 32768, 4, 6336512, 131072, 0, 0, 218104608, 1
    .long 1, 32, 32, 8192, 2560, 2816, 8388608, 2097152, 32768, 8, 46178304, 131072, 0, 0, 218105376, 4
    .long 2, 64, 72, 7168, 2304, 2304, 7340032, 524288, 32768, 8, 56397824, 114688, 0, 0, 218103888, 1
    .long 2, 64, 72, 7168, 1280, 1280, 7340032, 2097152, 32768, 8, 61886464, 114688, 0, 0, 218104064, 1
    .long 2, 64, 72, 7168, 256, 256, 7340032, 3670016, 32768, 8, 67375104, 114688, 0, 0, 218104256, 1
    .long 1, 80, 80, 2048, 1835520, 1835776, 7340032, 65564672, 114688, 7, 175120384, 32768, 218104208, 7, 218106752, 1
    .long 0, 0, 0, 0, 0, 0, 0, 0, 0, 0, 0, 0, 0, 0, 0, 0
    .long 0, 0, 0, 0, 0, 0, 0, 0, 0, 0, 0, 0, 0, 0, 0, 0
    .long 4, 16, 16, 8192, 4864, 267008, 8388608, 0, 32768, 4, 4272128, 131072, 0, 0, 218104384, 1
    .long 4, 16, 16, 8192, 4864, 267008, 8388608, 262144, 32768, 4, 5320704, 131072, 0, 0, 218104512, 1
    .long 4, 16, 16, 8192, 4864, 267008, 8388608, 524288, 32768, 4, 6369280, 131072, 0, 0, 218104640, 1
    .long 1, 32, 32, 8192, 4608, 4864, 8388608, 2097152, 32768, 8, 46211072, 131072, 0, 0, 218105408, 4
    .long 2, 64, 72, 7168, 2560, 2560, 7340032, 524288, 32768, 8, 56401920, 114688, 0, 0, 218103888, 1
    .long 2, 64, 72, 7168, 1536, 1536, 7340032, 2097152, 32768, 8, 61890560, 114688, 0, 0, 218104064, 1
    .long 2, 64, 72, 7168, 512, 512, 7340032, 3670016, 32768, 8, 67379200, 114688, 0, 0, 218104256, 1
    .long 1, 80, 80, 2048, 1836032, 1836288, 7340032, 65564672, 114688, 7, 175128576, 32768, 218104208, 7, 218106752, 1
    .long 0, 0, 0, 0, 0, 0, 0, 0, 0, 0, 0, 0, 0, 0, 0, 0
    .long 0, 0, 0, 0, 0, 0, 0, 0, 0, 0, 0, 0, 0, 0, 0, 0
    .long 4, 16, 16, 8192, 6912, 269056, 8388608, 0, 32768, 4, 4304896, 131072, 0, 0, 218104416, 1
    .long 4, 16, 16, 8192, 6912, 269056, 8388608, 262144, 32768, 4, 5353472, 131072, 0, 0, 218104544, 1
    .long 4, 16, 16, 8192, 6912, 269056, 8388608, 524288, 32768, 4, 6402048, 131072, 0, 0, 218104672, 1
    .long 1, 32, 32, 8192, 6656, 6912, 8388608, 2097152, 32768, 8, 46243840, 131072, 0, 0, 218105440, 4
    .long 2, 64, 72, 7168, 2816, 2816, 7340032, 524288, 32768, 8, 56406016, 114688, 0, 0, 218103888, 1
    .long 2, 64, 72, 7168, 1792, 1792, 7340032, 2097152, 32768, 8, 61894656, 114688, 0, 0, 218104080, 1
    .long 2, 64, 72, 7168, 768, 768, 7340032, 3670016, 32768, 8, 67383296, 114688, 0, 0, 218104256, 1
    .long 1, 80, 80, 2048, 1836544, 1836800, 7340032, 65564672, 114688, 7, 175136768, 32768, 218104208, 7, 218106752, 1
    .long 0, 0, 0, 0, 0, 0, 0, 0, 0, 0, 0, 0, 0, 0, 0, 0
    .long 0, 0, 0, 0, 0, 0, 0, 0, 0, 0, 0, 0, 0, 0, 0, 0
    .long 4, 16, 16, 8192, 1024, 263168, 8388608, 0, 32768, 4, 4210688, 131072, 0, 0, 218104336, 1
    .long 4, 16, 16, 8192, 1024, 263168, 8388608, 262144, 32768, 4, 5259264, 131072, 0, 0, 218104464, 1
    .long 4, 16, 16, 8192, 768, 262912, 8388608, 786432, 32768, 4, 7352320, 131072, 0, 0, 218104576, 1
    .long 1, 32, 32, 8192, 1024, 1280, 8388608, 2097152, 32768, 8, 46153728, 131072, 0, 0, 218105360, 4
    .long 2, 64, 72, 7168, 3072, 3072, 7340032, 524288, 32768, 8, 56410112, 114688, 0, 0, 218103888, 1
    .long 2, 64, 72, 7168, 2048, 2048, 7340032, 2097152, 32768, 8, 61898752, 114688, 0, 0, 218104080, 1
    .long 2, 64, 72, 7168, 1024, 1024, 7340032, 3670016, 32768, 8, 67387392, 114688, 0, 0, 218104256, 1
    .long 1, 80, 80, 2048, 3670016, 3670272, 7340032, 65593344, 114688, 7, 179306496, 32768, 218104224, 7, 218106752, 1
    .long 0, 0, 0, 0, 0, 0, 0, 0, 0, 0, 0, 0, 0, 0, 0, 0
    .long 0, 0, 0, 0, 0, 0, 0, 0, 0, 0, 0, 0, 0, 0, 0, 0
    .long 4, 16, 16, 8192, 3072, 265216, 8388608, 0, 32768, 4, 4243456, 131072, 0, 0, 218104368, 1
    .long 4, 16, 16, 8192, 3072, 265216, 8388608, 262144, 32768, 4, 5292032, 131072, 0, 0, 218104496, 1
    .long 4, 16, 16, 8192, 2816, 264960, 8388608, 786432, 32768, 4, 7385088, 131072, 0, 0, 218104608, 1
    .long 1, 32, 32, 8192, 3072, 3328, 8388608, 2097152, 32768, 8, 46186496, 131072, 0, 0, 218105392, 4
    .long 2, 64, 72, 7168, 3328, 3328, 7340032, 524288, 32768, 8, 56414208, 114688, 0, 0, 218103888, 1
    .long 2, 64, 72, 7168, 2304, 2304, 7340032, 2097152, 32768, 8, 61902848, 114688, 0, 0, 218104080, 1
    .long 2, 64, 72, 7168, 1280, 1280, 7340032, 3670016, 32768, 8, 67391488, 114688, 0, 0, 218104256, 1
    .long 1, 80, 80, 2048, 3670528, 3670784, 7340032, 65593344, 114688, 7, 179314688, 32768, 218104224, 7, 218106752, 1
    .long 0, 0, 0, 0, 0, 0, 0, 0, 0, 0, 0, 0, 0, 0, 0, 0
    .long 0, 0, 0, 0, 0, 0, 0, 0, 0, 0, 0, 0, 0, 0, 0, 0
    .long 4, 16, 16, 8192, 5120, 267264, 8388608, 0, 32768, 4, 4276224, 131072, 0, 0, 218104400, 1
    .long 4, 16, 16, 8192, 5120, 267264, 8388608, 262144, 32768, 4, 5324800, 131072, 0, 0, 218104528, 1
    .long 4, 16, 16, 8192, 4864, 267008, 8388608, 786432, 32768, 4, 7417856, 131072, 0, 0, 218104640, 1
    .long 1, 32, 32, 8192, 5120, 5376, 8388608, 2097152, 32768, 8, 46219264, 131072, 0, 0, 218105424, 4
    .long 2, 64, 72, 7168, 3584, 3584, 7340032, 524288, 32768, 8, 56418304, 114688, 0, 0, 218103904, 1
    .long 2, 64, 72, 7168, 2560, 2560, 7340032, 2097152, 32768, 8, 61906944, 114688, 0, 0, 218104080, 1
    .long 2, 64, 72, 7168, 1536, 1536, 7340032, 3670016, 32768, 8, 67395584, 114688, 0, 0, 218104256, 1
    .long 1, 80, 80, 2048, 3671040, 3671296, 7340032, 65593344, 114688, 7, 179322880, 32768, 218104224, 7, 218106752, 1
    .long 0, 0, 0, 0, 0, 0, 0, 0, 0, 0, 0, 0, 0, 0, 0, 0
    .long 0, 0, 0, 0, 0, 0, 0, 0, 0, 0, 0, 0, 0, 0, 0, 0
    .long 4, 16, 16, 8192, 7168, 269312, 8388608, 0, 32768, 4, 4308992, 131072, 0, 0, 218104432, 1
    .long 4, 16, 16, 8192, 7168, 269312, 8388608, 262144, 32768, 4, 5357568, 131072, 0, 0, 218104560, 1
    .long 4, 16, 16, 8192, 6912, 269056, 8388608, 786432, 32768, 4, 7450624, 131072, 0, 0, 218104672, 1
    .long 1, 32, 32, 8192, 7168, 7424, 8388608, 2097152, 32768, 8, 46252032, 131072, 0, 0, 218105456, 4
    .long 2, 64, 72, 7168, 3840, 3840, 7340032, 524288, 32768, 8, 56422400, 114688, 0, 0, 218103904, 1
    .long 2, 64, 72, 7168, 2816, 2816, 7340032, 2097152, 32768, 8, 61911040, 114688, 0, 0, 218104080, 1
    .long 2, 64, 72, 7168, 1792, 1792, 7340032, 3670016, 32768, 8, 67399680, 114688, 0, 0, 218104272, 1
    .long 1, 80, 80, 2048, 3671552, 3671808, 7340032, 65593344, 114688, 7, 179331072, 32768, 218104224, 7, 218106752, 1
    .long 0, 0, 0, 0, 0, 0, 0, 0, 0, 0, 0, 0, 0, 0, 0, 0
    .long 0, 0, 0, 0, 0, 0, 0, 0, 0, 0, 0, 0, 0, 0, 0, 0
    .long 4, 16, 16, 8192, 1280, 263424, 8388608, 0, 32768, 4, 4214784, 131072, 0, 0, 218104336, 1
    .long 4, 16, 16, 8192, 1280, 263424, 8388608, 262144, 32768, 4, 5263360, 131072, 0, 0, 218104464, 1
    .long 4, 16, 16, 8192, 512, 262656, 8388608, 786432, 32768, 4, 7348224, 131072, 0, 0, 218104576, 1
    .long 1, 32, 32, 8192, 1536, 1792, 8388608, 2097152, 32768, 8, 46161920, 131072, 0, 0, 218105360, 4
    .long 2, 64, 72, 7168, 4096, 4096, 7340032, 524288, 32768, 8, 56426496, 114688, 0, 0, 218103904, 1
    .long 2, 64, 72, 7168, 3072, 3072, 7340032, 2097152, 32768, 8, 61915136, 114688, 0, 0, 218104080, 1
    .long 2, 64, 72, 7168, 2048, 2048, 7340032, 3670016, 32768, 8, 67403776, 114688, 0, 0, 218104272, 1
    .long 1, 80, 80, 2048, 5505024, 5505280, 7340032, 65622016, 114688, 7, 183500800, 32768, 218104240, 7, 218106752, 1
    .long 0, 0, 0, 0, 0, 0, 0, 0, 0, 0, 0, 0, 0, 0, 0, 0
    .long 0, 0, 0, 0, 0, 0, 0, 0, 0, 0, 0, 0, 0, 0, 0, 0
    .long 4, 16, 16, 8192, 3328, 265472, 8388608, 0, 32768, 4, 4247552, 131072, 0, 0, 218104368, 1
    .long 4, 16, 16, 8192, 3328, 265472, 8388608, 262144, 32768, 4, 5296128, 131072, 0, 0, 218104496, 1
    .long 4, 16, 16, 8192, 2560, 264704, 8388608, 786432, 32768, 4, 7380992, 131072, 0, 0, 218104608, 1
    .long 1, 32, 32, 8192, 3584, 3840, 8388608, 2097152, 32768, 8, 46194688, 131072, 0, 0, 218105392, 4
    .long 2, 64, 72, 7168, 4352, 4352, 7340032, 524288, 32768, 8, 56430592, 114688, 0, 0, 218103904, 1
    .long 2, 64, 72, 7168, 3328, 3328, 7340032, 2097152, 32768, 8, 61919232, 114688, 0, 0, 218104080, 1
    .long 2, 64, 72, 7168, 2304, 2304, 7340032, 3670016, 32768, 8, 67407872, 114688, 0, 0, 218104272, 1
    .long 1, 80, 80, 2048, 5505536, 5505792, 7340032, 65622016, 114688, 7, 183508992, 32768, 218104240, 7, 218106752, 1
    .long 0, 0, 0, 0, 0, 0, 0, 0, 0, 0, 0, 0, 0, 0, 0, 0
    .long 0, 0, 0, 0, 0, 0, 0, 0, 0, 0, 0, 0, 0, 0, 0, 0
    .long 4, 16, 16, 8192, 5376, 267520, 8388608, 0, 32768, 4, 4280320, 131072, 0, 0, 218104400, 1
    .long 4, 16, 16, 8192, 5376, 267520, 8388608, 262144, 32768, 4, 5328896, 131072, 0, 0, 218104528, 1
    .long 4, 16, 16, 8192, 4608, 266752, 8388608, 786432, 32768, 4, 7413760, 131072, 0, 0, 218104640, 1
    .long 1, 32, 32, 8192, 5632, 5888, 8388608, 2097152, 32768, 8, 46227456, 131072, 0, 0, 218105424, 4
    .long 2, 64, 72, 7168, 4608, 4608, 7340032, 524288, 32768, 8, 56434688, 114688, 0, 0, 218103904, 1
    .long 2, 64, 72, 7168, 3584, 3584, 7340032, 2097152, 32768, 8, 61923328, 114688, 0, 0, 218104096, 1
    .long 2, 64, 72, 7168, 2560, 2560, 7340032, 3670016, 32768, 8, 67411968, 114688, 0, 0, 218104272, 1
    .long 1, 80, 80, 2048, 5506048, 5506304, 7340032, 65622016, 114688, 7, 183517184, 32768, 218104240, 7, 218106752, 1
    .long 0, 0, 0, 0, 0, 0, 0, 0, 0, 0, 0, 0, 0, 0, 0, 0
    .long 0, 0, 0, 0, 0, 0, 0, 0, 0, 0, 0, 0, 0, 0, 0, 0
    .long 4, 16, 16, 8192, 7424, 269568, 8388608, 0, 32768, 4, 4313088, 131072, 0, 0, 218104432, 1
    .long 4, 16, 16, 8192, 7424, 269568, 8388608, 262144, 32768, 4, 5361664, 131072, 0, 0, 218104560, 1
    .long 4, 16, 16, 8192, 6656, 268800, 8388608, 786432, 32768, 4, 7446528, 131072, 0, 0, 218104672, 1
    .long 1, 32, 32, 8192, 7680, 7936, 8388608, 2097152, 32768, 8, 46260224, 131072, 0, 0, 218105456, 4
    .long 2, 64, 72, 7168, 4864, 4864, 7340032, 524288, 32768, 8, 56438784, 114688, 0, 0, 218103904, 1
    .long 2, 64, 72, 7168, 3840, 3840, 7340032, 2097152, 32768, 8, 61927424, 114688, 0, 0, 218104096, 1
    .long 2, 64, 72, 7168, 2816, 2816, 7340032, 3670016, 32768, 8, 67416064, 114688, 0, 0, 218104272, 1
    .long 1, 80, 80, 2048, 5506560, 5506816, 7340032, 65622016, 114688, 7, 183525376, 32768, 218104240, 7, 218106752, 1
    .long 0, 0, 0, 0, 0, 0, 0, 0, 0, 0, 0, 0, 0, 0, 0, 0
    .long 0, 0, 0, 0, 0, 0, 0, 0, 0, 0, 0, 0, 0, 0, 0, 0
    .long 4, 16, 16, 8192, 1536, 263680, 8388608, 0, 32768, 4, 4218880, 131072, 0, 0, 218104336, 1
    .long 4, 16, 16, 8192, 1536, 263680, 8388608, 262144, 32768, 4, 5267456, 131072, 0, 0, 218104464, 1
    .long 4, 16, 16, 8192, 256, 262400, 8388608, 786432, 32768, 4, 7344128, 131072, 0, 0, 218104576, 1
    .long 1, 24, 24, 8192, 0, 256, 8388608, 2097152, 32768, 8, 29360128, 131072, 0, 0, 218105344, 4
    .long 2, 64, 72, 7168, 5120, 5120, 7340032, 524288, 32768, 8, 56442880, 114688, 0, 0, 218103904, 1
    .long 2, 64, 72, 7168, 4096, 4096, 7340032, 2097152, 32768, 8, 61931520, 114688, 0, 0, 218104096, 1
    .long 2, 64, 72, 7168, 3072, 3072, 7340032, 3670016, 32768, 8, 67420160, 114688, 0, 0, 218104272, 1
    .long 1, 80, 80, 2048, 0, 256, 7340032, 67371008, 114688, 7, 171442176, 32768, 218104256, 7, 218106816, 1
    .long 0, 0, 0, 0, 0, 0, 0, 0, 0, 0, 0, 0, 0, 0, 0, 0
    .long 0, 0, 0, 0, 0, 0, 0, 0, 0, 0, 0, 0, 0, 0, 0, 0
    .long 4, 16, 16, 8192, 3584, 265728, 8388608, 0, 32768, 4, 4251648, 131072, 0, 0, 218104368, 1
    .long 4, 16, 16, 8192, 3584, 265728, 8388608, 262144, 32768, 4, 5300224, 131072, 0, 0, 218104496, 1
    .long 4, 16, 16, 8192, 2304, 264448, 8388608, 786432, 32768, 4, 7376896, 131072, 0, 0, 218104608, 1
    .long 1, 24, 24, 8192, 2048, 2304, 8388608, 2097152, 32768, 8, 29392896, 131072, 0, 0, 218105376, 4
    .long 2, 64, 72, 7168, 5376, 5376, 7340032, 524288, 32768, 8, 56446976, 114688, 0, 0, 218103920, 1
    .long 2, 64, 72, 7168, 4352, 4352, 7340032, 2097152, 32768, 8, 61935616, 114688, 0, 0, 218104096, 1
    .long 2, 64, 72, 7168, 3328, 3328, 7340032, 3670016, 32768, 8, 67424256, 114688, 0, 0, 218104272, 1
    .long 1, 80, 80, 2048, 512, 768, 7340032, 67371008, 114688, 7, 171450368, 32768, 218104256, 7, 218106816, 1
    .long 0, 0, 0, 0, 0, 0, 0, 0, 0, 0, 0, 0, 0, 0, 0, 0
    .long 0, 0, 0, 0, 0, 0, 0, 0, 0, 0, 0, 0, 0, 0, 0, 0
    .long 4, 16, 16, 8192, 5632, 267776, 8388608, 0, 32768, 4, 4284416, 131072, 0, 0, 218104400, 1
    .long 4, 16, 16, 8192, 5632, 267776, 8388608, 262144, 32768, 4, 5332992, 131072, 0, 0, 218104528, 1
    .long 4, 16, 16, 8192, 4352, 266496, 8388608, 786432, 32768, 4, 7409664, 131072, 0, 0, 218104640, 1
    .long 1, 24, 24, 8192, 4096, 4352, 8388608, 2097152, 32768, 8, 29425664, 131072, 0, 0, 218105408, 4
    .long 2, 64, 72, 7168, 5632, 5632, 7340032, 524288, 32768, 8, 56451072, 114688, 0, 0, 218103920, 1
    .long 2, 64, 72, 7168, 4608, 4608, 7340032, 2097152, 32768, 8, 61939712, 114688, 0, 0, 218104096, 1
    .long 2, 64, 72, 7168, 3584, 3584, 7340032, 3670016, 32768, 8, 67428352, 114688, 0, 0, 218104288, 1
    .long 1, 80, 80, 2048, 1024, 1280, 7340032, 67371008, 114688, 7, 171458560, 32768, 218104256, 7, 218106816, 1
    .long 0, 0, 0, 0, 0, 0, 0, 0, 0, 0, 0, 0, 0, 0, 0, 0
    .long 0, 0, 0, 0, 0, 0, 0, 0, 0, 0, 0, 0, 0, 0, 0, 0
    .long 4, 16, 16, 8192, 7680, 269824, 8388608, 0, 32768, 4, 4317184, 131072, 0, 0, 218104432, 1
    .long 4, 16, 16, 8192, 7680, 269824, 8388608, 262144, 32768, 4, 5365760, 131072, 0, 0, 218104560, 1
    .long 4, 16, 16, 8192, 6400, 268544, 8388608, 786432, 32768, 4, 7442432, 131072, 0, 0, 218104672, 1
    .long 1, 24, 24, 8192, 6144, 6400, 8388608, 2097152, 32768, 8, 29458432, 131072, 0, 0, 218105440, 4
    .long 2, 64, 72, 7168, 5888, 5888, 7340032, 524288, 32768, 8, 56455168, 114688, 0, 0, 218103920, 1
    .long 2, 64, 72, 7168, 4864, 4864, 7340032, 2097152, 32768, 8, 61943808, 114688, 0, 0, 218104096, 1
    .long 2, 64, 72, 7168, 3840, 3840, 7340032, 3670016, 32768, 8, 67432448, 114688, 0, 0, 218104288, 1
    .long 1, 80, 80, 2048, 1536, 1792, 7340032, 67371008, 114688, 7, 171466752, 32768, 218104256, 7, 218106816, 1
    .long 0, 0, 0, 0, 0, 0, 0, 0, 0, 0, 0, 0, 0, 0, 0, 0
    .long 0, 0, 0, 0, 0, 0, 0, 0, 0, 0, 0, 0, 0, 0, 0, 0
    .long 4, 16, 16, 8192, 1792, 263936, 8388608, 0, 32768, 4, 4222976, 131072, 0, 0, 218104336, 1
    .long 4, 16, 16, 8192, 1792, 263936, 8388608, 262144, 32768, 4, 5271552, 131072, 0, 0, 218104464, 1
    .long 4, 16, 16, 8192, 0, 262144, 8388608, 786432, 32768, 4, 7340032, 131072, 0, 0, 218104576, 1
    .long 1, 24, 24, 8192, 512, 768, 8388608, 2097152, 32768, 8, 29368320, 131072, 0, 0, 218105344, 4
    .long 2, 64, 72, 7168, 6144, 6144, 7340032, 524288, 32768, 8, 56459264, 114688, 0, 0, 218103920, 1
    .long 2, 64, 72, 7168, 5120, 5120, 7340032, 2097152, 32768, 8, 61947904, 114688, 0, 0, 218104096, 1
    .long 2, 64, 72, 7168, 4096, 4096, 7340032, 3670016, 32768, 8, 67436544, 114688, 0, 0, 218104288, 1
    .long 1, 80, 80, 2048, 1835008, 1835264, 7340032, 67399680, 114688, 7, 175636480, 32768, 218104272, 7, 218106816, 1
    .long 0, 0, 0, 0, 0, 0, 0, 0, 0, 0, 0, 0, 0, 0, 0, 0
    .long 0, 0, 0, 0, 0, 0, 0, 0, 0, 0, 0, 0, 0, 0, 0, 0
    .long 4, 16, 16, 8192, 3840, 265984, 8388608, 0, 32768, 4, 4255744, 131072, 0, 0, 218104368, 1
    .long 4, 16, 16, 8192, 3840, 265984, 8388608, 262144, 32768, 4, 5304320, 131072, 0, 0, 218104496, 1
    .long 4, 16, 16, 8192, 2048, 264192, 8388608, 786432, 32768, 4, 7372800, 131072, 0, 0, 218104608, 1
    .long 1, 24, 24, 8192, 2560, 2816, 8388608, 2097152, 32768, 8, 29401088, 131072, 0, 0, 218105376, 4
    .long 2, 64, 72, 7168, 6400, 6400, 7340032, 524288, 32768, 8, 56463360, 114688, 0, 0, 218103920, 1
    .long 2, 64, 72, 7168, 5376, 5376, 7340032, 2097152, 32768, 8, 61952000, 114688, 0, 0, 218104112, 1
    .long 2, 64, 72, 7168, 4352, 4352, 7340032, 3670016, 32768, 8, 67440640, 114688, 0, 0, 218104288, 1
    .long 1, 80, 80, 2048, 1835520, 1835776, 7340032, 67399680, 114688, 7, 175644672, 32768, 218104272, 7, 218106816, 1
    .long 0, 0, 0, 0, 0, 0, 0, 0, 0, 0, 0, 0, 0, 0, 0, 0
    .long 0, 0, 0, 0, 0, 0, 0, 0, 0, 0, 0, 0, 0, 0, 0, 0
    .long 4, 16, 16, 8192, 5888, 268032, 8388608, 0, 32768, 4, 4288512, 131072, 0, 0, 218104400, 1
    .long 4, 16, 16, 8192, 5888, 268032, 8388608, 262144, 32768, 4, 5337088, 131072, 0, 0, 218104528, 1
    .long 4, 16, 16, 8192, 4096, 266240, 8388608, 786432, 32768, 4, 7405568, 131072, 0, 0, 218104640, 1
    .long 1, 24, 24, 8192, 4608, 4864, 8388608, 2097152, 32768, 8, 29433856, 131072, 0, 0, 218105408, 4
    .long 2, 64, 72, 7168, 6656, 6656, 7340032, 524288, 32768, 8, 56467456, 114688, 0, 0, 218103920, 1
    .long 2, 64, 72, 7168, 5632, 5632, 7340032, 2097152, 32768, 8, 61956096, 114688, 0, 0, 218104112, 1
    .long 2, 64, 72, 7168, 4608, 4608, 7340032, 3670016, 32768, 8, 67444736, 114688, 0, 0, 218104288, 1
    .long 1, 80, 80, 2048, 1836032, 1836288, 7340032, 67399680, 114688, 7, 175652864, 32768, 218104272, 7, 218106816, 1
    .long 0, 0, 0, 0, 0, 0, 0, 0, 0, 0, 0, 0, 0, 0, 0, 0
    .long 0, 0, 0, 0, 0, 0, 0, 0, 0, 0, 0, 0, 0, 0, 0, 0
    .long 4, 16, 16, 8192, 7936, 270080, 8388608, 0, 32768, 4, 4321280, 131072, 0, 0, 218104432, 1
    .long 4, 16, 16, 8192, 7936, 270080, 8388608, 262144, 32768, 4, 5369856, 131072, 0, 0, 218104560, 1
    .long 4, 16, 16, 8192, 6144, 268288, 8388608, 786432, 32768, 4, 7438336, 131072, 0, 0, 218104672, 1
    .long 1, 24, 24, 8192, 6656, 6912, 8388608, 2097152, 32768, 8, 29466624, 131072, 0, 0, 218105440, 4
    .long 2, 64, 72, 7168, 6912, 6912, 7340032, 524288, 32768, 8, 56471552, 114688, 0, 0, 218103920, 1
    .long 2, 64, 72, 7168, 5888, 5888, 7340032, 2097152, 32768, 8, 61960192, 114688, 0, 0, 218104112, 1
    .long 2, 64, 72, 7168, 4864, 4864, 7340032, 3670016, 32768, 8, 67448832, 114688, 0, 0, 218104288, 1
    .long 1, 80, 80, 2048, 1836544, 1836800, 7340032, 67399680, 114688, 7, 175661056, 32768, 218104272, 7, 218106816, 1
    .long 0, 0, 0, 0, 0, 0, 0, 0, 0, 0, 0, 0, 0, 0, 0, 0
    .long 0, 0, 0, 0, 0, 0, 0, 0, 0, 0, 0, 0, 0, 0, 0, 0
    .long 1, 32, 32, 8192, 0, 256, 8388608, 524288, 32768, 8, 39845888, 131072, 0, 0, 218104576, 4
    .long 1, 16, 16, 8192, 0, 256, 8388608, 1048576, 32768, 8, 8388608, 131072, 0, 0, 218104832, 4
    .long 1, 24, 24, 8192, 0, 256, 8388608, 2621440, 32768, 8, 31457280, 131072, 0, 0, 218105600, 4
    .long 1, 16, 16, 8192, 0, 256, 8388608, 3145728, 32768, 8, 16777216, 131072, 0, 0, 218105856, 4
    .long 1, 16, 16, 8192, 0, 256, 8388608, 3670016, 32768, 8, 18874368, 131072, 0, 0, 218106112, 4
    .long 1, 80, 80, 2048, 0, 256, 7340032, 58195968, 114688, 7, 168820736, 32768, 218103936, 7, 218106496, 1
    .long 0, 0, 0, 0, 0, 0, 0, 0, 0, 0, 0, 0, 0, 0, 0, 0
    .long 0, 0, 0, 0, 0, 0, 0, 0, 0, 0, 0, 0, 0, 0, 0, 0
    .long 0, 0, 0, 0, 0, 0, 0, 0, 0, 0, 0, 0, 0, 0, 0, 0
    .long 0, 0, 0, 0, 0, 0, 0, 0, 0, 0, 0, 0, 0, 0, 0, 0
    .long 1, 32, 32, 8192, 2048, 2304, 8388608, 524288, 32768, 8, 39878656, 131072, 0, 0, 218104608, 4
    .long 1, 16, 16, 8192, 2048, 2304, 8388608, 1048576, 32768, 8, 8421376, 131072, 0, 0, 218104864, 4
    .long 1, 24, 24, 8192, 2048, 2304, 8388608, 2621440, 32768, 8, 31490048, 131072, 0, 0, 218105632, 4
    .long 1, 16, 16, 8192, 2048, 2304, 8388608, 3145728, 32768, 8, 16809984, 131072, 0, 0, 218105888, 4
    .long 1, 16, 16, 8192, 2048, 2304, 8388608, 3670016, 32768, 8, 18907136, 131072, 0, 0, 218106144, 4
    .long 1, 80, 80, 2048, 512, 768, 7340032, 58195968, 114688, 7, 168828928, 32768, 218103936, 7, 218106496, 1
    .long 0, 0, 0, 0, 0, 0, 0, 0, 0, 0, 0, 0, 0, 0, 0, 0
    .long 0, 0, 0, 0, 0, 0, 0, 0, 0, 0, 0, 0, 0, 0, 0, 0
    .long 0, 0, 0, 0, 0, 0, 0, 0, 0, 0, 0, 0, 0, 0, 0, 0
    .long 0, 0, 0, 0, 0, 0, 0, 0, 0, 0, 0, 0, 0, 0, 0, 0
    .long 1, 32, 32, 8192, 4096, 4352, 8388608, 524288, 32768, 8, 39911424, 131072, 0, 0, 218104640, 4
    .long 1, 16, 16, 8192, 4096, 4352, 8388608, 1048576, 32768, 8, 8454144, 131072, 0, 0, 218104896, 4
    .long 1, 24, 24, 8192, 4096, 4352, 8388608, 2621440, 32768, 8, 31522816, 131072, 0, 0, 218105664, 4
    .long 1, 16, 16, 8192, 4096, 4352, 8388608, 3145728, 32768, 8, 16842752, 131072, 0, 0, 218105920, 4
    .long 1, 16, 16, 8192, 4096, 4352, 8388608, 3670016, 32768, 8, 18939904, 131072, 0, 0, 218106176, 4
    .long 1, 80, 80, 2048, 1024, 1280, 7340032, 58195968, 114688, 7, 168837120, 32768, 218103936, 7, 218106496, 1
    .long 0, 0, 0, 0, 0, 0, 0, 0, 0, 0, 0, 0, 0, 0, 0, 0
    .long 0, 0, 0, 0, 0, 0, 0, 0, 0, 0, 0, 0, 0, 0, 0, 0
    .long 0, 0, 0, 0, 0, 0, 0, 0, 0, 0, 0, 0, 0, 0, 0, 0
    .long 0, 0, 0, 0, 0, 0, 0, 0, 0, 0, 0, 0, 0, 0, 0, 0
    .long 1, 32, 32, 8192, 6144, 6400, 8388608, 524288, 32768, 8, 39944192, 131072, 0, 0, 218104672, 4
    .long 1, 16, 16, 8192, 6144, 6400, 8388608, 1048576, 32768, 8, 8486912, 131072, 0, 0, 218104928, 4
    .long 1, 24, 24, 8192, 6144, 6400, 8388608, 2621440, 32768, 8, 31555584, 131072, 0, 0, 218105696, 4
    .long 1, 16, 16, 8192, 6144, 6400, 8388608, 3145728, 32768, 8, 16875520, 131072, 0, 0, 218105952, 4
    .long 1, 16, 16, 8192, 6144, 6400, 8388608, 3670016, 32768, 8, 18972672, 131072, 0, 0, 218106208, 4
    .long 1, 80, 80, 2048, 1536, 1792, 7340032, 58195968, 114688, 7, 168845312, 32768, 218103936, 7, 218106496, 1
    .long 0, 0, 0, 0, 0, 0, 0, 0, 0, 0, 0, 0, 0, 0, 0, 0
    .long 0, 0, 0, 0, 0, 0, 0, 0, 0, 0, 0, 0, 0, 0, 0, 0
    .long 0, 0, 0, 0, 0, 0, 0, 0, 0, 0, 0, 0, 0, 0, 0, 0
    .long 0, 0, 0, 0, 0, 0, 0, 0, 0, 0, 0, 0, 0, 0, 0, 0
    .long 1, 32, 32, 8192, 512, 768, 8388608, 524288, 32768, 8, 39854080, 131072, 0, 0, 218104576, 4
    .long 1, 16, 16, 8192, 512, 768, 8388608, 1048576, 32768, 8, 8396800, 131072, 0, 0, 218104832, 4
    .long 1, 24, 24, 8192, 512, 768, 8388608, 2621440, 32768, 8, 31465472, 131072, 0, 0, 218105600, 4
    .long 1, 16, 16, 8192, 512, 768, 8388608, 3145728, 32768, 8, 16785408, 131072, 0, 0, 218105856, 4
    .long 1, 16, 16, 8192, 512, 768, 8388608, 3670016, 32768, 8, 18882560, 131072, 0, 0, 218106112, 4
    .long 1, 80, 80, 2048, 1835008, 1835264, 7340032, 58224640, 114688, 7, 173015040, 32768, 218103952, 7, 218106496, 1
    .long 0, 0, 0, 0, 0, 0, 0, 0, 0, 0, 0, 0, 0, 0, 0, 0
    .long 0, 0, 0, 0, 0, 0, 0, 0, 0, 0, 0, 0, 0, 0, 0, 0
    .long 0, 0, 0, 0, 0, 0, 0, 0, 0, 0, 0, 0, 0, 0, 0, 0
    .long 0, 0, 0, 0, 0, 0, 0, 0, 0, 0, 0, 0, 0, 0, 0, 0
    .long 1, 32, 32, 8192, 2560, 2816, 8388608, 524288, 32768, 8, 39886848, 131072, 0, 0, 218104608, 4
    .long 1, 16, 16, 8192, 2560, 2816, 8388608, 1048576, 32768, 8, 8429568, 131072, 0, 0, 218104864, 4
    .long 1, 24, 24, 8192, 2560, 2816, 8388608, 2621440, 32768, 8, 31498240, 131072, 0, 0, 218105632, 4
    .long 1, 16, 16, 8192, 2560, 2816, 8388608, 3145728, 32768, 8, 16818176, 131072, 0, 0, 218105888, 4
    .long 1, 16, 16, 8192, 2560, 2816, 8388608, 3670016, 32768, 8, 18915328, 131072, 0, 0, 218106144, 4
    .long 1, 80, 80, 2048, 1835520, 1835776, 7340032, 58224640, 114688, 7, 173023232, 32768, 218103952, 7, 218106496, 1
    .long 0, 0, 0, 0, 0, 0, 0, 0, 0, 0, 0, 0, 0, 0, 0, 0
    .long 0, 0, 0, 0, 0, 0, 0, 0, 0, 0, 0, 0, 0, 0, 0, 0
    .long 0, 0, 0, 0, 0, 0, 0, 0, 0, 0, 0, 0, 0, 0, 0, 0
    .long 0, 0, 0, 0, 0, 0, 0, 0, 0, 0, 0, 0, 0, 0, 0, 0
    .long 1, 32, 32, 8192, 4608, 4864, 8388608, 524288, 32768, 8, 39919616, 131072, 0, 0, 218104640, 4
    .long 1, 16, 16, 8192, 4608, 4864, 8388608, 1048576, 32768, 8, 8462336, 131072, 0, 0, 218104896, 4
    .long 1, 24, 24, 8192, 4608, 4864, 8388608, 2621440, 32768, 8, 31531008, 131072, 0, 0, 218105664, 4
    .long 1, 16, 16, 8192, 4608, 4864, 8388608, 3145728, 32768, 8, 16850944, 131072, 0, 0, 218105920, 4
    .long 1, 16, 16, 8192, 4608, 4864, 8388608, 3670016, 32768, 8, 18948096, 131072, 0, 0, 218106176, 4
    .long 1, 80, 80, 2048, 1836032, 1836288, 7340032, 58224640, 114688, 7, 173031424, 32768, 218103952, 7, 218106496, 1
    .long 0, 0, 0, 0, 0, 0, 0, 0, 0, 0, 0, 0, 0, 0, 0, 0
    .long 0, 0, 0, 0, 0, 0, 0, 0, 0, 0, 0, 0, 0, 0, 0, 0
    .long 0, 0, 0, 0, 0, 0, 0, 0, 0, 0, 0, 0, 0, 0, 0, 0
    .long 0, 0, 0, 0, 0, 0, 0, 0, 0, 0, 0, 0, 0, 0, 0, 0
    .long 1, 32, 32, 8192, 6656, 6912, 8388608, 524288, 32768, 8, 39952384, 131072, 0, 0, 218104672, 4
    .long 1, 16, 16, 8192, 6656, 6912, 8388608, 1048576, 32768, 8, 8495104, 131072, 0, 0, 218104928, 4
    .long 1, 24, 24, 8192, 6656, 6912, 8388608, 2621440, 32768, 8, 31563776, 131072, 0, 0, 218105696, 4
    .long 1, 16, 16, 8192, 6656, 6912, 8388608, 3145728, 32768, 8, 16883712, 131072, 0, 0, 218105952, 4
    .long 1, 16, 16, 8192, 6656, 6912, 8388608, 3670016, 32768, 8, 18980864, 131072, 0, 0, 218106208, 4
    .long 1, 80, 80, 2048, 1836544, 1836800, 7340032, 58224640, 114688, 7, 173039616, 32768, 218103952, 7, 218106496, 1
    .long 0, 0, 0, 0, 0, 0, 0, 0, 0, 0, 0, 0, 0, 0, 0, 0
    .long 0, 0, 0, 0, 0, 0, 0, 0, 0, 0, 0, 0, 0, 0, 0, 0
    .long 0, 0, 0, 0, 0, 0, 0, 0, 0, 0, 0, 0, 0, 0, 0, 0
    .long 0, 0, 0, 0, 0, 0, 0, 0, 0, 0, 0, 0, 0, 0, 0, 0
    .long 1, 32, 32, 8192, 1024, 1280, 8388608, 524288, 32768, 8, 39862272, 131072, 0, 0, 218104592, 4
    .long 1, 16, 16, 8192, 1024, 1280, 8388608, 1048576, 32768, 8, 8404992, 131072, 0, 0, 218104848, 4
    .long 1, 24, 24, 8192, 1024, 1280, 8388608, 2621440, 32768, 8, 31473664, 131072, 0, 0, 218105616, 4
    .long 1, 16, 16, 8192, 1024, 1280, 8388608, 3145728, 32768, 8, 16793600, 131072, 0, 0, 218105872, 4
    .long 1, 16, 16, 8192, 1024, 1280, 8388608, 3670016, 32768, 8, 18890752, 131072, 0, 0, 218106128, 4
    .long 1, 80, 80, 2048, 3670016, 3670272, 7340032, 58253312, 114688, 7, 177209344, 32768, 218103968, 7, 218106496, 1
    .long 0, 0, 0, 0, 0, 0, 0, 0, 0, 0, 0, 0, 0, 0, 0, 0
    .long 0, 0, 0, 0, 0, 0, 0, 0, 0, 0, 0, 0, 0, 0, 0, 0
    .long 0, 0, 0, 0, 0, 0, 0, 0, 0, 0, 0, 0, 0, 0, 0, 0
    .long 0, 0, 0, 0, 0, 0, 0, 0, 0, 0, 0, 0, 0, 0, 0, 0
    .long 1, 32, 32, 8192, 3072, 3328, 8388608, 524288, 32768, 8, 39895040, 131072, 0, 0, 218104624, 4
    .long 1, 16, 16, 8192, 3072, 3328, 8388608, 1048576, 32768, 8, 8437760, 131072, 0, 0, 218104880, 4
    .long 1, 24, 24, 8192, 3072, 3328, 8388608, 2621440, 32768, 8, 31506432, 131072, 0, 0, 218105648, 4
    .long 1, 16, 16, 8192, 3072, 3328, 8388608, 3145728, 32768, 8, 16826368, 131072, 0, 0, 218105904, 4
    .long 1, 16, 16, 8192, 3072, 3328, 8388608, 3670016, 32768, 8, 18923520, 131072, 0, 0, 218106160, 4
    .long 1, 80, 80, 2048, 3670528, 3670784, 7340032, 58253312, 114688, 7, 177217536, 32768, 218103968, 7, 218106496, 1
    .long 0, 0, 0, 0, 0, 0, 0, 0, 0, 0, 0, 0, 0, 0, 0, 0
    .long 0, 0, 0, 0, 0, 0, 0, 0, 0, 0, 0, 0, 0, 0, 0, 0
    .long 0, 0, 0, 0, 0, 0, 0, 0, 0, 0, 0, 0, 0, 0, 0, 0
    .long 0, 0, 0, 0, 0, 0, 0, 0, 0, 0, 0, 0, 0, 0, 0, 0
    .long 1, 32, 32, 8192, 5120, 5376, 8388608, 524288, 32768, 8, 39927808, 131072, 0, 0, 218104656, 4
    .long 1, 16, 16, 8192, 5120, 5376, 8388608, 1048576, 32768, 8, 8470528, 131072, 0, 0, 218104912, 4
    .long 1, 24, 24, 8192, 5120, 5376, 8388608, 2621440, 32768, 8, 31539200, 131072, 0, 0, 218105680, 4
    .long 1, 16, 16, 8192, 5120, 5376, 8388608, 3145728, 32768, 8, 16859136, 131072, 0, 0, 218105936, 4
    .long 1, 16, 16, 8192, 5120, 5376, 8388608, 3670016, 32768, 8, 18956288, 131072, 0, 0, 218106192, 4
    .long 1, 80, 80, 2048, 3671040, 3671296, 7340032, 58253312, 114688, 7, 177225728, 32768, 218103968, 7, 218106496, 1
    .long 0, 0, 0, 0, 0, 0, 0, 0, 0, 0, 0, 0, 0, 0, 0, 0
    .long 0, 0, 0, 0, 0, 0, 0, 0, 0, 0, 0, 0, 0, 0, 0, 0
    .long 0, 0, 0, 0, 0, 0, 0, 0, 0, 0, 0, 0, 0, 0, 0, 0
    .long 0, 0, 0, 0, 0, 0, 0, 0, 0, 0, 0, 0, 0, 0, 0, 0
    .long 1, 32, 32, 8192, 7168, 7424, 8388608, 524288, 32768, 8, 39960576, 131072, 0, 0, 218104688, 4
    .long 1, 16, 16, 8192, 7168, 7424, 8388608, 1048576, 32768, 8, 8503296, 131072, 0, 0, 218104944, 4
    .long 1, 24, 24, 8192, 7168, 7424, 8388608, 2621440, 32768, 8, 31571968, 131072, 0, 0, 218105712, 4
    .long 1, 16, 16, 8192, 7168, 7424, 8388608, 3145728, 32768, 8, 16891904, 131072, 0, 0, 218105968, 4
    .long 1, 16, 16, 8192, 7168, 7424, 8388608, 3670016, 32768, 8, 18989056, 131072, 0, 0, 218106224, 4
    .long 1, 80, 80, 2048, 3671552, 3671808, 7340032, 58253312, 114688, 7, 177233920, 32768, 218103968, 7, 218106496, 1
    .long 0, 0, 0, 0, 0, 0, 0, 0, 0, 0, 0, 0, 0, 0, 0, 0
    .long 0, 0, 0, 0, 0, 0, 0, 0, 0, 0, 0, 0, 0, 0, 0, 0
    .long 0, 0, 0, 0, 0, 0, 0, 0, 0, 0, 0, 0, 0, 0, 0, 0
    .long 0, 0, 0, 0, 0, 0, 0, 0, 0, 0, 0, 0, 0, 0, 0, 0
    .long 1, 32, 32, 8192, 1536, 1792, 8388608, 524288, 32768, 8, 39870464, 131072, 0, 0, 218104592, 4
    .long 1, 16, 16, 8192, 1536, 1792, 8388608, 1048576, 32768, 8, 8413184, 131072, 0, 0, 218104848, 4
    .long 1, 24, 24, 8192, 1536, 1792, 8388608, 2621440, 32768, 8, 31481856, 131072, 0, 0, 218105616, 4
    .long 1, 16, 16, 8192, 1536, 1792, 8388608, 3145728, 32768, 8, 16801792, 131072, 0, 0, 218105872, 4
    .long 1, 16, 16, 8192, 1536, 1792, 8388608, 3670016, 32768, 8, 18898944, 131072, 0, 0, 218106128, 4
    .long 1, 80, 80, 2048, 5505024, 5505280, 7340032, 58281984, 114688, 7, 181403648, 32768, 218103984, 7, 218106496, 1
    .long 0, 0, 0, 0, 0, 0, 0, 0, 0, 0, 0, 0, 0, 0, 0, 0
    .long 0, 0, 0, 0, 0, 0, 0, 0, 0, 0, 0, 0, 0, 0, 0, 0
    .long 0, 0, 0, 0, 0, 0, 0, 0, 0, 0, 0, 0, 0, 0, 0, 0
    .long 0, 0, 0, 0, 0, 0, 0, 0, 0, 0, 0, 0, 0, 0, 0, 0
    .long 1, 32, 32, 8192, 3584, 3840, 8388608, 524288, 32768, 8, 39903232, 131072, 0, 0, 218104624, 4
    .long 1, 16, 16, 8192, 3584, 3840, 8388608, 1048576, 32768, 8, 8445952, 131072, 0, 0, 218104880, 4
    .long 1, 24, 24, 8192, 3584, 3840, 8388608, 2621440, 32768, 8, 31514624, 131072, 0, 0, 218105648, 4
    .long 1, 16, 16, 8192, 3584, 3840, 8388608, 3145728, 32768, 8, 16834560, 131072, 0, 0, 218105904, 4
    .long 1, 16, 16, 8192, 3584, 3840, 8388608, 3670016, 32768, 8, 18931712, 131072, 0, 0, 218106160, 4
    .long 1, 80, 80, 2048, 5505536, 5505792, 7340032, 58281984, 114688, 7, 181411840, 32768, 218103984, 7, 218106496, 1
    .long 0, 0, 0, 0, 0, 0, 0, 0, 0, 0, 0, 0, 0, 0, 0, 0
    .long 0, 0, 0, 0, 0, 0, 0, 0, 0, 0, 0, 0, 0, 0, 0, 0
    .long 0, 0, 0, 0, 0, 0, 0, 0, 0, 0, 0, 0, 0, 0, 0, 0
    .long 0, 0, 0, 0, 0, 0, 0, 0, 0, 0, 0, 0, 0, 0, 0, 0
    .long 1, 32, 32, 8192, 5632, 5888, 8388608, 524288, 32768, 8, 39936000, 131072, 0, 0, 218104656, 4
    .long 1, 16, 16, 8192, 5632, 5888, 8388608, 1048576, 32768, 8, 8478720, 131072, 0, 0, 218104912, 4
    .long 1, 24, 24, 8192, 5632, 5888, 8388608, 2621440, 32768, 8, 31547392, 131072, 0, 0, 218105680, 4
    .long 1, 16, 16, 8192, 5632, 5888, 8388608, 3145728, 32768, 8, 16867328, 131072, 0, 0, 218105936, 4
    .long 1, 16, 16, 8192, 5632, 5888, 8388608, 3670016, 32768, 8, 18964480, 131072, 0, 0, 218106192, 4
    .long 1, 80, 80, 2048, 5506048, 5506304, 7340032, 58281984, 114688, 7, 181420032, 32768, 218103984, 7, 218106496, 1
    .long 0, 0, 0, 0, 0, 0, 0, 0, 0, 0, 0, 0, 0, 0, 0, 0
    .long 0, 0, 0, 0, 0, 0, 0, 0, 0, 0, 0, 0, 0, 0, 0, 0
    .long 0, 0, 0, 0, 0, 0, 0, 0, 0, 0, 0, 0, 0, 0, 0, 0
    .long 0, 0, 0, 0, 0, 0, 0, 0, 0, 0, 0, 0, 0, 0, 0, 0
    .long 1, 32, 32, 8192, 7680, 7936, 8388608, 524288, 32768, 8, 39968768, 131072, 0, 0, 218104688, 4
    .long 1, 16, 16, 8192, 7680, 7936, 8388608, 1048576, 32768, 8, 8511488, 131072, 0, 0, 218104944, 4
    .long 1, 24, 24, 8192, 7680, 7936, 8388608, 2621440, 32768, 8, 31580160, 131072, 0, 0, 218105712, 4
    .long 1, 16, 16, 8192, 7680, 7936, 8388608, 3145728, 32768, 8, 16900096, 131072, 0, 0, 218105968, 4
    .long 1, 16, 16, 8192, 7680, 7936, 8388608, 3670016, 32768, 8, 18997248, 131072, 0, 0, 218106224, 4
    .long 1, 80, 80, 2048, 5506560, 5506816, 7340032, 58281984, 114688, 7, 181428224, 32768, 218103984, 7, 218106496, 1
    .long 0, 0, 0, 0, 0, 0, 0, 0, 0, 0, 0, 0, 0, 0, 0, 0
    .long 0, 0, 0, 0, 0, 0, 0, 0, 0, 0, 0, 0, 0, 0, 0, 0
    .long 0, 0, 0, 0, 0, 0, 0, 0, 0, 0, 0, 0, 0, 0, 0, 0
    .long 0, 0, 0, 0, 0, 0, 0, 0, 0, 0, 0, 0, 0, 0, 0, 0
    .long 1, 24, 24, 8192, 0, 256, 8388608, 524288, 32768, 8, 23068672, 131072, 0, 0, 218104576, 4
    .long 1, 32, 32, 8192, 0, 256, 8388608, 1572864, 32768, 8, 44040192, 131072, 0, 0, 218105088, 4
    .long 1, 16, 16, 8192, 0, 256, 8388608, 2621440, 32768, 8, 14680064, 131072, 0, 0, 218105600, 4
    .long 2, 64, 72, 7168, 2048, 2048, 7340032, 1048576, 32768, 8, 58228736, 114688, 0, 0, 218103952, 1
    .long 2, 64, 72, 7168, 1024, 1024, 7340032, 2621440, 32768, 8, 63717376, 114688, 0, 0, 218104128, 1
    .long 1, 80, 80, 2048, 0, 256, 7340032, 60030976, 114688, 7, 169345024, 32768, 218104000, 7, 218106560, 1
    .long 0, 0, 0, 0, 0, 0, 0, 0, 0, 0, 0, 0, 0, 0, 0, 0
    .long 0, 0, 0, 0, 0, 0, 0, 0, 0, 0, 0, 0, 0, 0, 0, 0
    .long 0, 0, 0, 0, 0, 0, 0, 0, 0, 0, 0, 0, 0, 0, 0, 0
    .long 0, 0, 0, 0, 0, 0, 0, 0, 0, 0, 0, 0, 0, 0, 0, 0
    .long 1, 24, 24, 8192, 2048, 2304, 8388608, 524288, 32768, 8, 23101440, 131072, 0, 0, 218104608, 4
    .long 1, 32, 32, 8192, 2048, 2304, 8388608, 1572864, 32768, 8, 44072960, 131072, 0, 0, 218105120, 4
    .long 1, 16, 16, 8192, 2048, 2304, 8388608, 2621440, 32768, 8, 14712832, 131072, 0, 0, 218105632, 4
    .long 2, 64, 72, 7168, 2304, 2304, 7340032, 1048576, 32768, 8, 58232832, 114688, 0, 0, 218103952, 1
    .long 2, 64, 72, 7168, 1280, 1280, 7340032, 2621440, 32768, 8, 63721472, 114688, 0, 0, 218104128, 1
    .long 1, 80, 80, 2048, 512, 768, 7340032, 60030976, 114688, 7, 169353216, 32768, 218104000, 7, 218106560, 1
    .long 0, 0, 0, 0, 0, 0, 0, 0, 0, 0, 0, 0, 0, 0, 0, 0
    .long 0, 0, 0, 0, 0, 0, 0, 0, 0, 0, 0, 0, 0, 0, 0, 0
    .long 0, 0, 0, 0, 0, 0, 0, 0, 0, 0, 0, 0, 0, 0, 0, 0
    .long 0, 0, 0, 0, 0, 0, 0, 0, 0, 0, 0, 0, 0, 0, 0, 0
    .long 1, 24, 24, 8192, 4096, 4352, 8388608, 524288, 32768, 8, 23134208, 131072, 0, 0, 218104640, 4
    .long 1, 32, 32, 8192, 4096, 4352, 8388608, 1572864, 32768, 8, 44105728, 131072, 0, 0, 218105152, 4
    .long 1, 16, 16, 8192, 4096, 4352, 8388608, 2621440, 32768, 8, 14745600, 131072, 0, 0, 218105664, 4
    .long 2, 64, 72, 7168, 2560, 2560, 7340032, 1048576, 32768, 8, 58236928, 114688, 0, 0, 218103952, 1
    .long 2, 64, 72, 7168, 1536, 1536, 7340032, 2621440, 32768, 8, 63725568, 114688, 0, 0, 218104128, 1
    .long 1, 80, 80, 2048, 1024, 1280, 7340032, 60030976, 114688, 7, 169361408, 32768, 218104000, 7, 218106560, 1
    .long 0, 0, 0, 0, 0, 0, 0, 0, 0, 0, 0, 0, 0, 0, 0, 0
    .long 0, 0, 0, 0, 0, 0, 0, 0, 0, 0, 0, 0, 0, 0, 0, 0
    .long 0, 0, 0, 0, 0, 0, 0, 0, 0, 0, 0, 0, 0, 0, 0, 0
    .long 0, 0, 0, 0, 0, 0, 0, 0, 0, 0, 0, 0, 0, 0, 0, 0
    .long 1, 24, 24, 8192, 6144, 6400, 8388608, 524288, 32768, 8, 23166976, 131072, 0, 0, 218104672, 4
    .long 1, 32, 32, 8192, 6144, 6400, 8388608, 1572864, 32768, 8, 44138496, 131072, 0, 0, 218105184, 4
    .long 1, 16, 16, 8192, 6144, 6400, 8388608, 2621440, 32768, 8, 14778368, 131072, 0, 0, 218105696, 4
    .long 2, 64, 72, 7168, 2816, 2816, 7340032, 1048576, 32768, 8, 58241024, 114688, 0, 0, 218103952, 1
    .long 2, 64, 72, 7168, 1792, 1792, 7340032, 2621440, 32768, 8, 63729664, 114688, 0, 0, 218104144, 1
    .long 1, 80, 80, 2048, 1536, 1792, 7340032, 60030976, 114688, 7, 169369600, 32768, 218104000, 7, 218106560, 1
    .long 0, 0, 0, 0, 0, 0, 0, 0, 0, 0, 0, 0, 0, 0, 0, 0
    .long 0, 0, 0, 0, 0, 0, 0, 0, 0, 0, 0, 0, 0, 0, 0, 0
    .long 0, 0, 0, 0, 0, 0, 0, 0, 0, 0, 0, 0, 0, 0, 0, 0
    .long 0, 0, 0, 0, 0, 0, 0, 0, 0, 0, 0, 0, 0, 0, 0, 0
    .long 1, 24, 24, 8192, 512, 768, 8388608, 524288, 32768, 8, 23076864, 131072, 0, 0, 218104576, 4
    .long 1, 32, 32, 8192, 512, 768, 8388608, 1572864, 32768, 8, 44048384, 131072, 0, 0, 218105088, 4
    .long 1, 16, 16, 8192, 512, 768, 8388608, 2621440, 32768, 8, 14688256, 131072, 0, 0, 218105600, 4
    .long 2, 64, 72, 7168, 3072, 3072, 7340032, 1048576, 32768, 8, 58245120, 114688, 0, 0, 218103952, 1
    .long 2, 64, 72, 7168, 2048, 2048, 7340032, 2621440, 32768, 8, 63733760, 114688, 0, 0, 218104144, 1
    .long 1, 80, 80, 2048, 1835008, 1835264, 7340032, 60059648, 114688, 7, 173539328, 32768, 218104016, 7, 218106560, 1
    .long 0, 0, 0, 0, 0, 0, 0, 0, 0, 0, 0, 0, 0, 0, 0, 0
    .long 0, 0, 0, 0, 0, 0, 0, 0, 0, 0, 0, 0, 0, 0, 0, 0
    .long 0, 0, 0, 0, 0, 0, 0, 0, 0, 0, 0, 0, 0, 0, 0, 0
    .long 0, 0, 0, 0, 0, 0, 0, 0, 0, 0, 0, 0, 0, 0, 0, 0
    .long 1, 24, 24, 8192, 2560, 2816, 8388608, 524288, 32768, 8, 23109632, 131072, 0, 0, 218104608, 4
    .long 1, 32, 32, 8192, 2560, 2816, 8388608, 1572864, 32768, 8, 44081152, 131072, 0, 0, 218105120, 4
    .long 1, 16, 16, 8192, 2560, 2816, 8388608, 2621440, 32768, 8, 14721024, 131072, 0, 0, 218105632, 4
    .long 2, 64, 72, 7168, 3328, 3328, 7340032, 1048576, 32768, 8, 58249216, 114688, 0, 0, 218103952, 1
    .long 2, 64, 72, 7168, 2304, 2304, 7340032, 2621440, 32768, 8, 63737856, 114688, 0, 0, 218104144, 1
    .long 1, 80, 80, 2048, 1835520, 1835776, 7340032, 60059648, 114688, 7, 173547520, 32768, 218104016, 7, 218106560, 1
    .long 0, 0, 0, 0, 0, 0, 0, 0, 0, 0, 0, 0, 0, 0, 0, 0
    .long 0, 0, 0, 0, 0, 0, 0, 0, 0, 0, 0, 0, 0, 0, 0, 0
    .long 0, 0, 0, 0, 0, 0, 0, 0, 0, 0, 0, 0, 0, 0, 0, 0
    .long 0, 0, 0, 0, 0, 0, 0, 0, 0, 0, 0, 0, 0, 0, 0, 0
    .long 1, 24, 24, 8192, 4608, 4864, 8388608, 524288, 32768, 8, 23142400, 131072, 0, 0, 218104640, 4
    .long 1, 32, 32, 8192, 4608, 4864, 8388608, 1572864, 32768, 8, 44113920, 131072, 0, 0, 218105152, 4
    .long 1, 16, 16, 8192, 4608, 4864, 8388608, 2621440, 32768, 8, 14753792, 131072, 0, 0, 218105664, 4
    .long 2, 64, 72, 7168, 3584, 3584, 7340032, 1048576, 32768, 8, 58253312, 114688, 0, 0, 218103968, 1
    .long 2, 64, 72, 7168, 2560, 2560, 7340032, 2621440, 32768, 8, 63741952, 114688, 0, 0, 218104144, 1
    .long 1, 80, 80, 2048, 1836032, 1836288, 7340032, 60059648, 114688, 7, 173555712, 32768, 218104016, 7, 218106560, 1
    .long 0, 0, 0, 0, 0, 0, 0, 0, 0, 0, 0, 0, 0, 0, 0, 0
    .long 0, 0, 0, 0, 0, 0, 0, 0, 0, 0, 0, 0, 0, 0, 0, 0
    .long 0, 0, 0, 0, 0, 0, 0, 0, 0, 0, 0, 0, 0, 0, 0, 0
    .long 0, 0, 0, 0, 0, 0, 0, 0, 0, 0, 0, 0, 0, 0, 0, 0
    .long 1, 24, 24, 8192, 6656, 6912, 8388608, 524288, 32768, 8, 23175168, 131072, 0, 0, 218104672, 4
    .long 1, 32, 32, 8192, 6656, 6912, 8388608, 1572864, 32768, 8, 44146688, 131072, 0, 0, 218105184, 4
    .long 1, 16, 16, 8192, 6656, 6912, 8388608, 2621440, 32768, 8, 14786560, 131072, 0, 0, 218105696, 4
    .long 2, 64, 72, 7168, 3840, 3840, 7340032, 1048576, 32768, 8, 58257408, 114688, 0, 0, 218103968, 1
    .long 2, 64, 72, 7168, 2816, 2816, 7340032, 2621440, 32768, 8, 63746048, 114688, 0, 0, 218104144, 1
    .long 1, 80, 80, 2048, 1836544, 1836800, 7340032, 60059648, 114688, 7, 173563904, 32768, 218104016, 7, 218106560, 1
    .long 0, 0, 0, 0, 0, 0, 0, 0, 0, 0, 0, 0, 0, 0, 0, 0
    .long 0, 0, 0, 0, 0, 0, 0, 0, 0, 0, 0, 0, 0, 0, 0, 0
    .long 0, 0, 0, 0, 0, 0, 0, 0, 0, 0, 0, 0, 0, 0, 0, 0
    .long 0, 0, 0, 0, 0, 0, 0, 0, 0, 0, 0, 0, 0, 0, 0, 0
    .long 1, 24, 24, 8192, 1024, 1280, 8388608, 524288, 32768, 8, 23085056, 131072, 0, 0, 218104592, 4
    .long 1, 24, 24, 8192, 1024, 1280, 8388608, 2097152, 32768, 8, 29376512, 131072, 0, 0, 218105360, 4
    .long 2, 64, 72, 7168, 0, 0, 7340032, 1048576, 32768, 8, 58195968, 114688, 0, 0, 218103936, 1
    .long 2, 64, 72, 7168, 6144, 6144, 7340032, 2097152, 32768, 8, 61964288, 114688, 0, 0, 218104112, 1
    .long 2, 64, 72, 7168, 5120, 5120, 7340032, 3670016, 32768, 8, 67452928, 114688, 0, 0, 218104288, 1
    .long 1, 80, 80, 2048, 3670016, 3670272, 7340032, 67428352, 114688, 7, 179830784, 32768, 218104288, 7, 218106816, 1
    .long 0, 0, 0, 0, 0, 0, 0, 0, 0, 0, 0, 0, 0, 0, 0, 0
    .long 0, 0, 0, 0, 0, 0, 0, 0, 0, 0, 0, 0, 0, 0, 0, 0
    .long 0, 0, 0, 0, 0, 0, 0, 0, 0, 0, 0, 0, 0, 0, 0, 0
    .long 0, 0, 0, 0, 0, 0, 0, 0, 0, 0, 0, 0, 0, 0, 0, 0
    .long 1, 24, 24, 8192, 3072, 3328, 8388608, 524288, 32768, 8, 23117824, 131072, 0, 0, 218104624, 4
    .long 1, 24, 24, 8192, 3072, 3328, 8388608, 2097152, 32768, 8, 29409280, 131072, 0, 0, 218105392, 4
    .long 2, 64, 72, 7168, 256, 256, 7340032, 1048576, 32768, 8, 58200064, 114688, 0, 0, 218103936, 1
    .long 2, 64, 72, 7168, 6400, 6400, 7340032, 2097152, 32768, 8, 61968384, 114688, 0, 0, 218104112, 1
    .long 2, 64, 72, 7168, 5376, 5376, 7340032, 3670016, 32768, 8, 67457024, 114688, 0, 0, 218104304, 1
    .long 1, 80, 80, 2048, 3670528, 3670784, 7340032, 67428352, 114688, 7, 179838976, 32768, 218104288, 7, 218106816, 1
    .long 0, 0, 0, 0, 0, 0, 0, 0, 0, 0, 0, 0, 0, 0, 0, 0
    .long 0, 0, 0, 0, 0, 0, 0, 0, 0, 0, 0, 0, 0, 0, 0, 0
    .long 0, 0, 0, 0, 0, 0, 0, 0, 0, 0, 0, 0, 0, 0, 0, 0
    .long 0, 0, 0, 0, 0, 0, 0, 0, 0, 0, 0, 0, 0, 0, 0, 0
    .long 1, 24, 24, 8192, 5120, 5376, 8388608, 524288, 32768, 8, 23150592, 131072, 0, 0, 218104656, 4
    .long 1, 24, 24, 8192, 5120, 5376, 8388608, 2097152, 32768, 8, 29442048, 131072, 0, 0, 218105424, 4
    .long 2, 64, 72, 7168, 512, 512, 7340032, 1048576, 32768, 8, 58204160, 114688, 0, 0, 218103936, 1
    .long 2, 64, 72, 7168, 6656, 6656, 7340032, 2097152, 32768, 8, 61972480, 114688, 0, 0, 218104112, 1
    .long 2, 64, 72, 7168, 5632, 5632, 7340032, 3670016, 32768, 8, 67461120, 114688, 0, 0, 218104304, 1
    .long 1, 80, 80, 2048, 3671040, 3671296, 7340032, 67428352, 114688, 7, 179847168, 32768, 218104288, 7, 218106816, 1
    .long 0, 0, 0, 0, 0, 0, 0, 0, 0, 0, 0, 0, 0, 0, 0, 0
    .long 0, 0, 0, 0, 0, 0, 0, 0, 0, 0, 0, 0, 0, 0, 0, 0
    .long 0, 0, 0, 0, 0, 0, 0, 0, 0, 0, 0, 0, 0, 0, 0, 0
    .long 0, 0, 0, 0, 0, 0, 0, 0, 0, 0, 0, 0, 0, 0, 0, 0
    .long 1, 24, 24, 8192, 7168, 7424, 8388608, 524288, 32768, 8, 23183360, 131072, 0, 0, 218104688, 4
    .long 1, 24, 24, 8192, 7168, 7424, 8388608, 2097152, 32768, 8, 29474816, 131072, 0, 0, 218105456, 4
    .long 2, 64, 72, 7168, 768, 768, 7340032, 1048576, 32768, 8, 58208256, 114688, 0, 0, 218103936, 1
    .long 2, 64, 72, 7168, 6912, 6912, 7340032, 2097152, 32768, 8, 61976576, 114688, 0, 0, 218104112, 1
    .long 2, 64, 72, 7168, 5888, 5888, 7340032, 3670016, 32768, 8, 67465216, 114688, 0, 0, 218104304, 1
    .long 1, 80, 80, 2048, 3671552, 3671808, 7340032, 67428352, 114688, 7, 179855360, 32768, 218104288, 7, 218106816, 1
    .long 0, 0, 0, 0, 0, 0, 0, 0, 0, 0, 0, 0, 0, 0, 0, 0
    .long 0, 0, 0, 0, 0, 0, 0, 0, 0, 0, 0, 0, 0, 0, 0, 0
    .long 0, 0, 0, 0, 0, 0, 0, 0, 0, 0, 0, 0, 0, 0, 0, 0
    .long 0, 0, 0, 0, 0, 0, 0, 0, 0, 0, 0, 0, 0, 0, 0, 0
    .long 1, 24, 24, 8192, 1536, 1792, 8388608, 524288, 32768, 8, 23093248, 131072, 0, 0, 218104592, 4
    .long 1, 24, 24, 8192, 1536, 1792, 8388608, 2097152, 32768, 8, 29384704, 131072, 0, 0, 218105360, 4
    .long 2, 64, 72, 7168, 1024, 1024, 7340032, 1048576, 32768, 8, 58212352, 114688, 0, 0, 218103936, 1
    .long 2, 64, 72, 7168, 0, 0, 7340032, 2621440, 32768, 8, 63700992, 114688, 0, 0, 218104128, 1
    .long 2, 64, 72, 7168, 6144, 6144, 7340032, 3670016, 32768, 8, 67469312, 114688, 0, 0, 218104304, 1
    .long 1, 80, 80, 2048, 5505024, 5505280, 7340032, 67457024, 114688, 7, 184025088, 32768, 218104304, 7, 218106816, 1
    .long 0, 0, 0, 0, 0, 0, 0, 0, 0, 0, 0, 0, 0, 0, 0, 0
    .long 0, 0, 0, 0, 0, 0, 0, 0, 0, 0, 0, 0, 0, 0, 0, 0
    .long 0, 0, 0, 0, 0, 0, 0, 0, 0, 0, 0, 0, 0, 0, 0, 0
    .long 0, 0, 0, 0, 0, 0, 0, 0, 0, 0, 0, 0, 0, 0, 0, 0
    .long 1, 24, 24, 8192, 3584, 3840, 8388608, 524288, 32768, 8, 23126016, 131072, 0, 0, 218104624, 4
    .long 1, 24, 24, 8192, 3584, 3840, 8388608, 2097152, 32768, 8, 29417472, 131072, 0, 0, 218105392, 4
    .long 2, 64, 72, 7168, 1280, 1280, 7340032, 1048576, 32768, 8, 58216448, 114688, 0, 0, 218103936, 1
    .long 2, 64, 72, 7168, 256, 256, 7340032, 2621440, 32768, 8, 63705088, 114688, 0, 0, 218104128, 1
    .long 2, 64, 72, 7168, 6400, 6400, 7340032, 3670016, 32768, 8, 67473408, 114688, 0, 0, 218104304, 1
    .long 1, 80, 80, 2048, 5505536, 5505792, 7340032, 67457024, 114688, 7, 184033280, 32768, 218104304, 7, 218106816, 1
    .long 0, 0, 0, 0, 0, 0, 0, 0, 0, 0, 0, 0, 0, 0, 0, 0
    .long 0, 0, 0, 0, 0, 0, 0, 0, 0, 0, 0, 0, 0, 0, 0, 0
    .long 0, 0, 0, 0, 0, 0, 0, 0, 0, 0, 0, 0, 0, 0, 0, 0
    .long 0, 0, 0, 0, 0, 0, 0, 0, 0, 0, 0, 0, 0, 0, 0, 0
    .long 1, 24, 24, 8192, 5632, 5888, 8388608, 524288, 32768, 8, 23158784, 131072, 0, 0, 218104656, 4
    .long 1, 24, 24, 8192, 5632, 5888, 8388608, 2097152, 32768, 8, 29450240, 131072, 0, 0, 218105424, 4
    .long 2, 64, 72, 7168, 1536, 1536, 7340032, 1048576, 32768, 8, 58220544, 114688, 0, 0, 218103936, 1
    .long 2, 64, 72, 7168, 512, 512, 7340032, 2621440, 32768, 8, 63709184, 114688, 0, 0, 218104128, 1
    .long 2, 64, 72, 7168, 6656, 6656, 7340032, 3670016, 32768, 8, 67477504, 114688, 0, 0, 218104304, 1
    .long 1, 80, 80, 2048, 5506048, 5506304, 7340032, 67457024, 114688, 7, 184041472, 32768, 218104304, 7, 218106816, 1
    .long 0, 0, 0, 0, 0, 0, 0, 0, 0, 0, 0, 0, 0, 0, 0, 0
    .long 0, 0, 0, 0, 0, 0, 0, 0, 0, 0, 0, 0, 0, 0, 0, 0
    .long 0, 0, 0, 0, 0, 0, 0, 0, 0, 0, 0, 0, 0, 0, 0, 0
    .long 0, 0, 0, 0, 0, 0, 0, 0, 0, 0, 0, 0, 0, 0, 0, 0
    .long 1, 24, 24, 8192, 7680, 7936, 8388608, 524288, 32768, 8, 23191552, 131072, 0, 0, 218104688, 4
    .long 1, 24, 24, 8192, 7680, 7936, 8388608, 2097152, 32768, 8, 29483008, 131072, 0, 0, 218105456, 4
    .long 2, 64, 72, 7168, 1792, 1792, 7340032, 1048576, 32768, 8, 58224640, 114688, 0, 0, 218103952, 1
    .long 2, 64, 72, 7168, 768, 768, 7340032, 2621440, 32768, 8, 63713280, 114688, 0, 0, 218104128, 1
    .long 2, 64, 72, 7168, 6912, 6912, 7340032, 3670016, 32768, 8, 67481600, 114688, 0, 0, 218104304, 1
    .long 1, 80, 80, 2048, 5506560, 5506816, 7340032, 67457024, 114688, 7, 184049664, 32768, 218104304, 7, 218106816, 1
    .long 0, 0, 0, 0, 0, 0, 0, 0, 0, 0, 0, 0, 0, 0, 0, 0
    .long 0, 0, 0, 0, 0, 0, 0, 0, 0, 0, 0, 0, 0, 0, 0, 0
    .long 0, 0, 0, 0, 0, 0, 0, 0, 0, 0, 0, 0, 0, 0, 0, 0
    .long 0, 0, 0, 0, 0, 0, 0, 0, 0, 0, 0, 0, 0, 0, 0, 0
.p2align 6
.amdhsa_kernel recurrent_scan__memory_aug_recurrent_mem_tr__glu_gated_glu__prompt_kernel
  .amdhsa_next_free_vgpr 256
  .amdhsa_next_free_sgpr 102
  .amdhsa_accum_offset 256
  .amdhsa_group_segment_fixed_size 0
  .amdhsa_kernarg_size 112
  .amdhsa_user_sgpr_count 2
  .amdhsa_user_sgpr_kernarg_segment_ptr 1
  .amdhsa_system_sgpr_workgroup_id_x 1
  .amdhsa_float_denorm_mode_32 3
.end_amdhsa_kernel
```

```asm
; @launch grid=(256,1,1) block=(512,1,1) lds=163840
.amdgcn_target "amdgcn-amd-amdhsa--gfx950"
.text
.globl recurrent_scan__memory_aug_recurrent_mem_tr__glu_gated_glu__prompt_kernel
.p2align 8
.type recurrent_scan__memory_aug_recurrent_mem_tr__glu_gated_glu__prompt_kernel,@function
recurrent_scan__memory_aug_recurrent_mem_tr__glu_gated_glu__prompt_kernel:
    s_cmp_ge_u32 s2, 256
    s_cbranch_scc1 k_exit
    s_mov_b32 s99, s2
    s_load_dwordx2 s[4:5], s[0:1], 104
    s_load_dwordx2 s[64:65], s[0:1], 96
    v_lshrrev_b32 v2, 6, v0
    s_mov_b32 s6, 268435456
    s_mov_b32 s7, 131072
    s_mov_b32 s66, 256
    s_mov_b32 s67, 131072
    v_readfirstlane_b32 s3, v2
    s_lshr_b32 s12, s2, 3
    s_and_b32 s13, s2, 3
    s_waitcnt lgkmcnt(0)
    s_bitcmp0_b32 s2, 2
    s_cbranch_scc1 chain_map
    s_lshl_b32 s63, s12, 2
    s_add_u32 s63, s63, s13
    s_cmp_ge_u32 s3, 4
    s_cbranch_scc1 ln_touch
    s_load_dwordx2 s[8:9], s[0:1], 0
    v_and_b32 v1, 63, v0
    s_mov_b32 s10, 4194304
    s_mov_b32 s11, 131072
    v_and_b32 v3, 15, v1
    v_lshrrev_b32 v4, 4, v1
    v_lshlrev_b32 v5, 11, v3
    v_lshl_add_u32 v5, v4, 4, v5
    s_lshl_b32 s12, s63, 15
    s_lshl_b32 s13, s3, 9
    s_add_u32 s12, s12, s13
    s_waitcnt lgkmcnt(0)
    buffer_load_dwordx4 v[16:19], v5, s[8:11], s12 offen offset:0
    buffer_load_dwordx4 v[20:23], v5, s[8:11], s12 offen offset:64
    buffer_load_dwordx4 v[24:27], v5, s[8:11], s12 offen offset:128
    buffer_load_dwordx4 v[28:31], v5, s[8:11], s12 offen offset:192
    buffer_load_dwordx4 v[32:35], v5, s[8:11], s12 offen offset:256
    buffer_load_dwordx4 v[36:39], v5, s[8:11], s12 offen offset:320
    buffer_load_dwordx4 v[40:43], v5, s[8:11], s12 offen offset:384
    buffer_load_dwordx4 v[44:47], v5, s[8:11], s12 offen offset:448
    v_mov_b32 v14, 0
    s_lshl_b32 s13, s63, 7
    s_add_u32 s13, s13, 218103808
    v_lshlrev_b32 v13, 2, v0
    v_cmp_gt_u32 vcc, 32, v0
    s_and_saveexec_b64 s[22:23], vcc
    s_cbranch_execz ln_nz
    buffer_store_dword v14, v13, s[4:7], s13 offen sc1
ln_nz:
    s_mov_b64 exec, -1
    v_lshlrev_b32 v6, 4, v3
    s_lshl_b32 s14, s3, 2
    v_add_u32 v7, s14, v6
    v_lshlrev_b32 v8, 4, v1
    s_lshl_b32 s15, s63, 15
    s_lshl_b32 s16, s3, 13
    s_add_u32 s15, s15, s16
    s_add_u32 s16, s15, 4096
    v_and_b32 v9, 1, v4
    v_cmp_eq_u32 s[20:21], 1, v9
    s_waitcnt vmcnt(1)
    v_lshlrev_b32 v48, 16, v16
    v_and_b32 v49, 0xffff0000, v16
    v_lshlrev_b32 v50, 16, v17
    v_and_b32 v51, 0xffff0000, v17
    v_lshlrev_b32 v52, 16, v18
    v_and_b32 v53, 0xffff0000, v18
    v_lshlrev_b32 v54, 16, v19
    v_and_b32 v55, 0xffff0000, v19
    v_lshlrev_b32 v56, 16, v20
    v_and_b32 v57, 0xffff0000, v20
    v_lshlrev_b32 v58, 16, v21
    v_and_b32 v59, 0xffff0000, v21
    v_lshlrev_b32 v60, 16, v22
    v_and_b32 v61, 0xffff0000, v22
    v_lshlrev_b32 v62, 16, v23
    v_and_b32 v63, 0xffff0000, v23
    v_lshlrev_b32 v64, 16, v24
    v_and_b32 v65, 0xffff0000, v24
    v_lshlrev_b32 v66, 16, v25
    v_and_b32 v67, 0xffff0000, v25
    v_lshlrev_b32 v68, 16, v26
    v_and_b32 v69, 0xffff0000, v26
    v_lshlrev_b32 v70, 16, v27
    v_and_b32 v71, 0xffff0000, v27
    v_lshlrev_b32 v72, 16, v28
    v_and_b32 v73, 0xffff0000, v28
    v_lshlrev_b32 v74, 16, v29
    v_and_b32 v75, 0xffff0000, v29
    v_lshlrev_b32 v76, 16, v30
    v_and_b32 v77, 0xffff0000, v30
    v_lshlrev_b32 v78, 16, v31
    v_and_b32 v79, 0xffff0000, v31
    v_lshlrev_b32 v80, 16, v32
    v_and_b32 v81, 0xffff0000, v32
    v_lshlrev_b32 v82, 16, v33
    v_and_b32 v83, 0xffff0000, v33
    v_lshlrev_b32 v84, 16, v34
    v_and_b32 v85, 0xffff0000, v34
    v_lshlrev_b32 v86, 16, v35
    v_and_b32 v87, 0xffff0000, v35
    v_lshlrev_b32 v88, 16, v36
    v_and_b32 v89, 0xffff0000, v36
    v_lshlrev_b32 v90, 16, v37
    v_and_b32 v91, 0xffff0000, v37
    v_lshlrev_b32 v92, 16, v38
    v_and_b32 v93, 0xffff0000, v38
    v_lshlrev_b32 v94, 16, v39
    v_and_b32 v95, 0xffff0000, v39
    v_lshlrev_b32 v96, 16, v40
    v_and_b32 v97, 0xffff0000, v40
    v_lshlrev_b32 v98, 16, v41
    v_and_b32 v99, 0xffff0000, v41
    v_lshlrev_b32 v100, 16, v42
    v_and_b32 v101, 0xffff0000, v42
    v_lshlrev_b32 v102, 16, v43
    v_and_b32 v103, 0xffff0000, v43
    v_lshlrev_b32 v104, 16, v44
    v_and_b32 v105, 0xffff0000, v44
    v_lshlrev_b32 v106, 16, v45
    v_and_b32 v107, 0xffff0000, v45
    v_lshlrev_b32 v108, 16, v46
    v_and_b32 v109, 0xffff0000, v46
    v_lshlrev_b32 v110, 16, v47
    v_and_b32 v111, 0xffff0000, v47
    v_add_f32 v112, v48, v80
    v_add_f32 v113, v49, v81
    v_add_f32 v114, v50, v82
    v_add_f32 v115, v51, v83
    v_add_f32 v116, v52, v84
    v_add_f32 v117, v53, v85
    v_add_f32 v118, v54, v86
    v_add_f32 v119, v55, v87
    v_add_f32 v120, v56, v88
    v_add_f32 v121, v57, v89
    v_add_f32 v122, v58, v90
    v_add_f32 v123, v59, v91
    v_add_f32 v124, v60, v92
    v_add_f32 v125, v61, v93
    v_add_f32 v126, v62, v94
    v_add_f32 v127, v63, v95
    v_add_f32 v128, v64, v96
    v_add_f32 v129, v65, v97
    v_add_f32 v130, v66, v98
    v_add_f32 v131, v67, v99
    v_add_f32 v132, v68, v100
    v_add_f32 v133, v69, v101
    v_add_f32 v134, v70, v102
    v_add_f32 v135, v71, v103
    v_add_f32 v136, v72, v104
    v_add_f32 v137, v73, v105
    v_add_f32 v138, v74, v106
    v_add_f32 v139, v75, v107
    v_add_f32 v140, v76, v108
    v_add_f32 v141, v77, v109
    v_add_f32 v142, v78, v110
    v_add_f32 v143, v79, v111
    v_add_f32 v112, v112, v128
    v_add_f32 v113, v113, v129
    v_add_f32 v114, v114, v130
    v_add_f32 v115, v115, v131
    v_add_f32 v116, v116, v132
    v_add_f32 v117, v117, v133
    v_add_f32 v118, v118, v134
    v_add_f32 v119, v119, v135
    v_add_f32 v120, v120, v136
    v_add_f32 v121, v121, v137
    v_add_f32 v122, v122, v138
    v_add_f32 v123, v123, v139
    v_add_f32 v124, v124, v140
    v_add_f32 v125, v125, v141
    v_add_f32 v126, v126, v142
    v_add_f32 v127, v127, v143
    v_add_f32 v112, v112, v120
    v_add_f32 v113, v113, v121
    v_add_f32 v114, v114, v122
    v_add_f32 v115, v115, v123
    v_add_f32 v116, v116, v124
    v_add_f32 v117, v117, v125
    v_add_f32 v118, v118, v126
    v_add_f32 v119, v119, v127
    v_add_f32 v112, v112, v116
    v_add_f32 v113, v113, v117
    v_add_f32 v114, v114, v118
    v_add_f32 v115, v115, v119
    v_add_f32 v112, v112, v114
    v_add_f32 v113, v113, v115
    v_add_f32 v112, v112, v113
    v_mov_b32 v113, v112
    s_nop 1
    v_permlane16_swap_b32 v113, v112
    v_add_f32 v112, v112, v113
    v_mov_b32 v113, v112
    s_nop 1
    v_permlane32_swap_b32 v113, v112
    v_add_f32 v112, v112, v113
    ds_write_b32 v7, v112
    s_waitcnt lgkmcnt(0)
    s_barrier
    ds_read_b128 v[112:115], v6
    s_waitcnt lgkmcnt(0)
    v_add_f32 v112, v112, v114
    v_add_f32 v113, v113, v115
    v_add_f32 v112, v112, v113
    v_mul_f32 v10, 0x3a800000, v112
    v_sub_f32 v176, v48, v10
    v_sub_f32 v177, v49, v10
    v_sub_f32 v178, v50, v10
    v_sub_f32 v179, v51, v10
    v_sub_f32 v180, v52, v10
    v_sub_f32 v181, v53, v10
    v_sub_f32 v182, v54, v10
    v_sub_f32 v183, v55, v10
    v_sub_f32 v184, v56, v10
    v_sub_f32 v185, v57, v10
    v_sub_f32 v186, v58, v10
    v_sub_f32 v187, v59, v10
    v_sub_f32 v188, v60, v10
    v_sub_f32 v189, v61, v10
    v_sub_f32 v190, v62, v10
    v_sub_f32 v191, v63, v10
    v_sub_f32 v192, v64, v10
    v_sub_f32 v193, v65, v10
    v_sub_f32 v194, v66, v10
    v_sub_f32 v195, v67, v10
    v_sub_f32 v196, v68, v10
    v_sub_f32 v197, v69, v10
    v_sub_f32 v198, v70, v10
    v_sub_f32 v199, v71, v10
    v_sub_f32 v200, v72, v10
    v_sub_f32 v201, v73, v10
    v_sub_f32 v202, v74, v10
    v_sub_f32 v203, v75, v10
    v_sub_f32 v204, v76, v10
    v_sub_f32 v205, v77, v10
    v_sub_f32 v206, v78, v10
    v_sub_f32 v207, v79, v10
    v_sub_f32 v208, v80, v10
    v_sub_f32 v209, v81, v10
    v_sub_f32 v210, v82, v10
    v_sub_f32 v211, v83, v10
    v_sub_f32 v212, v84, v10
    v_sub_f32 v213, v85, v10
    v_sub_f32 v214, v86, v10
    v_sub_f32 v215, v87, v10
    v_sub_f32 v216, v88, v10
    v_sub_f32 v217, v89, v10
    v_sub_f32 v218, v90, v10
    v_sub_f32 v219, v91, v10
    v_sub_f32 v220, v92, v10
    v_sub_f32 v221, v93, v10
    v_sub_f32 v222, v94, v10
    v_sub_f32 v223, v95, v10
    v_sub_f32 v224, v96, v10
    v_sub_f32 v225, v97, v10
    v_sub_f32 v226, v98, v10
    v_sub_f32 v227, v99, v10
    v_sub_f32 v228, v100, v10
    v_sub_f32 v229, v101, v10
    v_sub_f32 v230, v102, v10
    v_sub_f32 v231, v103, v10
    v_sub_f32 v232, v104, v10
    v_sub_f32 v233, v105, v10
    v_sub_f32 v234, v106, v10
    v_sub_f32 v235, v107, v10
    v_sub_f32 v236, v108, v10
    v_sub_f32 v237, v109, v10
    v_sub_f32 v238, v110, v10
    v_sub_f32 v239, v111, v10
    v_mul_f32 v112, v176, v176
    v_fmac_f32 v112, v208, v208
    v_mul_f32 v113, v177, v177
    v_fmac_f32 v113, v209, v209
    v_mul_f32 v114, v178, v178
    v_fmac_f32 v114, v210, v210
    v_mul_f32 v115, v179, v179
    v_fmac_f32 v115, v211, v211
    v_mul_f32 v116, v180, v180
    v_fmac_f32 v116, v212, v212
    v_mul_f32 v117, v181, v181
    v_fmac_f32 v117, v213, v213
    v_mul_f32 v118, v182, v182
    v_fmac_f32 v118, v214, v214
    v_mul_f32 v119, v183, v183
    v_fmac_f32 v119, v215, v215
    v_mul_f32 v120, v184, v184
    v_fmac_f32 v120, v216, v216
    v_mul_f32 v121, v185, v185
    v_fmac_f32 v121, v217, v217
    v_mul_f32 v122, v186, v186
    v_fmac_f32 v122, v218, v218
    v_mul_f32 v123, v187, v187
    v_fmac_f32 v123, v219, v219
    v_mul_f32 v124, v188, v188
    v_fmac_f32 v124, v220, v220
    v_mul_f32 v125, v189, v189
    v_fmac_f32 v125, v221, v221
    v_mul_f32 v126, v190, v190
    v_fmac_f32 v126, v222, v222
    v_mul_f32 v127, v191, v191
    v_fmac_f32 v127, v223, v223
    v_mul_f32 v128, v192, v192
    v_fmac_f32 v128, v224, v224
    v_mul_f32 v129, v193, v193
    v_fmac_f32 v129, v225, v225
    v_mul_f32 v130, v194, v194
    v_fmac_f32 v130, v226, v226
    v_mul_f32 v131, v195, v195
    v_fmac_f32 v131, v227, v227
    v_mul_f32 v132, v196, v196
    v_fmac_f32 v132, v228, v228
    v_mul_f32 v133, v197, v197
    v_fmac_f32 v133, v229, v229
    v_mul_f32 v134, v198, v198
    v_fmac_f32 v134, v230, v230
    v_mul_f32 v135, v199, v199
    v_fmac_f32 v135, v231, v231
    v_mul_f32 v136, v200, v200
    v_fmac_f32 v136, v232, v232
    v_mul_f32 v137, v201, v201
    v_fmac_f32 v137, v233, v233
    v_mul_f32 v138, v202, v202
    v_fmac_f32 v138, v234, v234
    v_mul_f32 v139, v203, v203
    v_fmac_f32 v139, v235, v235
    v_mul_f32 v140, v204, v204
    v_fmac_f32 v140, v236, v236
    v_mul_f32 v141, v205, v205
    v_fmac_f32 v141, v237, v237
    v_mul_f32 v142, v206, v206
    v_fmac_f32 v142, v238, v238
    v_mul_f32 v143, v207, v207
    v_fmac_f32 v143, v239, v239
    v_add_f32 v112, v112, v128
    v_add_f32 v113, v113, v129
    v_add_f32 v114, v114, v130
    v_add_f32 v115, v115, v131
    v_add_f32 v116, v116, v132
    v_add_f32 v117, v117, v133
    v_add_f32 v118, v118, v134
    v_add_f32 v119, v119, v135
    v_add_f32 v120, v120, v136
    v_add_f32 v121, v121, v137
    v_add_f32 v122, v122, v138
    v_add_f32 v123, v123, v139
    v_add_f32 v124, v124, v140
    v_add_f32 v125, v125, v141
    v_add_f32 v126, v126, v142
    v_add_f32 v127, v127, v143
    v_add_f32 v112, v112, v120
    v_add_f32 v113, v113, v121
    v_add_f32 v114, v114, v122
    v_add_f32 v115, v115, v123
    v_add_f32 v116, v116, v124
    v_add_f32 v117, v117, v125
    v_add_f32 v118, v118, v126
    v_add_f32 v119, v119, v127
    v_add_f32 v112, v112, v116
    v_add_f32 v113, v113, v117
    v_add_f32 v114, v114, v118
    v_add_f32 v115, v115, v119
    v_add_f32 v112, v112, v114
    v_add_f32 v113, v113, v115
    v_add_f32 v112, v112, v113
    v_mov_b32 v113, v112
    s_nop 1
    v_permlane16_swap_b32 v113, v112
    v_add_f32 v112, v112, v113
    v_mov_b32 v113, v112
    s_nop 1
    v_permlane32_swap_b32 v113, v112
    v_add_f32 v112, v112, v113
    ds_write_b32 v7, v112 offset:512
    s_waitcnt lgkmcnt(0)
    s_barrier
    ds_read_b128 v[112:115], v6 offset:512
    s_waitcnt lgkmcnt(0)
    v_add_f32 v112, v112, v114
    v_add_f32 v113, v113, v115
    v_add_f32 v112, v112, v113
    v_mul_f32 v11, 0x3a800000, v112
    v_cvt_pk_bf16_f32 v10, v10, v10
    v_lshlrev_b32 v10, 16, v10
    v_cvt_pk_bf16_f32 v11, v11, v11
    v_lshlrev_b32 v11, 16, v11
    v_add_f32 v11, 0x3727c5ac, v11
    v_cvt_pk_bf16_f32 v11, v11, v11
    v_lshlrev_b32 v11, 16, v11
    v_sqrt_f32 v11, v11
    s_nop 0
    v_cvt_pk_bf16_f32 v11, v11, v11
    v_lshlrev_b32 v11, 16, v11
    v_rcp_f32 v11, v11
    s_nop 0
    v_sub_f32 v48, v48, v10
    v_sub_f32 v49, v49, v10
    v_cvt_pk_bf16_f32 v16, v48, v49
    v_lshlrev_b32 v48, 16, v16
    v_and_b32 v49, 0xffff0000, v16
    v_mul_f32 v48, v48, v11
    v_mul_f32 v49, v49, v11
    v_cvt_pk_bf16_f32 v16, v48, v49
    v_sub_f32 v50, v50, v10
    v_sub_f32 v51, v51, v10
    v_cvt_pk_bf16_f32 v17, v50, v51
    v_lshlrev_b32 v50, 16, v17
    v_and_b32 v51, 0xffff0000, v17
    v_mul_f32 v50, v50, v11
    v_mul_f32 v51, v51, v11
    v_cvt_pk_bf16_f32 v17, v50, v51
    v_sub_f32 v52, v52, v10
    v_sub_f32 v53, v53, v10
    v_cvt_pk_bf16_f32 v18, v52, v53
    v_lshlrev_b32 v52, 16, v18
    v_and_b32 v53, 0xffff0000, v18
    v_mul_f32 v52, v52, v11
    v_mul_f32 v53, v53, v11
    v_cvt_pk_bf16_f32 v18, v52, v53
    v_sub_f32 v54, v54, v10
    v_sub_f32 v55, v55, v10
    v_cvt_pk_bf16_f32 v19, v54, v55
    v_lshlrev_b32 v54, 16, v19
    v_and_b32 v55, 0xffff0000, v19
    v_mul_f32 v54, v54, v11
    v_mul_f32 v55, v55, v11
    v_cvt_pk_bf16_f32 v19, v54, v55
    v_cndmask_b32 v112, v16, v18, s[20:21]
    v_cndmask_b32 v113, v17, v19, s[20:21]
    v_cndmask_b32 v114, v18, v16, s[20:21]
    v_cndmask_b32 v115, v19, v17, s[20:21]
    buffer_store_dwordx4 v[112:115], v8, s[4:7], s15 offen offset:0 sc1
    v_sub_f32 v56, v56, v10
    v_sub_f32 v57, v57, v10
    v_cvt_pk_bf16_f32 v20, v56, v57
    v_lshlrev_b32 v56, 16, v20
    v_and_b32 v57, 0xffff0000, v20
    v_mul_f32 v56, v56, v11
    v_mul_f32 v57, v57, v11
    v_cvt_pk_bf16_f32 v20, v56, v57
    v_sub_f32 v58, v58, v10
    v_sub_f32 v59, v59, v10
    v_cvt_pk_bf16_f32 v21, v58, v59
    v_lshlrev_b32 v58, 16, v21
    v_and_b32 v59, 0xffff0000, v21
    v_mul_f32 v58, v58, v11
    v_mul_f32 v59, v59, v11
    v_cvt_pk_bf16_f32 v21, v58, v59
    v_sub_f32 v60, v60, v10
    v_sub_f32 v61, v61, v10
    v_cvt_pk_bf16_f32 v22, v60, v61
    v_lshlrev_b32 v60, 16, v22
    v_and_b32 v61, 0xffff0000, v22
    v_mul_f32 v60, v60, v11
    v_mul_f32 v61, v61, v11
    v_cvt_pk_bf16_f32 v22, v60, v61
    v_sub_f32 v62, v62, v10
    v_sub_f32 v63, v63, v10
    v_cvt_pk_bf16_f32 v23, v62, v63
    v_lshlrev_b32 v62, 16, v23
    v_and_b32 v63, 0xffff0000, v23
    v_mul_f32 v62, v62, v11
    v_mul_f32 v63, v63, v11
    v_cvt_pk_bf16_f32 v23, v62, v63
    v_cndmask_b32 v116, v20, v22, s[20:21]
    v_cndmask_b32 v117, v21, v23, s[20:21]
    v_cndmask_b32 v118, v22, v20, s[20:21]
    v_cndmask_b32 v119, v23, v21, s[20:21]
    buffer_store_dwordx4 v[116:119], v8, s[4:7], s15 offen offset:1024 sc1
    v_sub_f32 v64, v64, v10
    v_sub_f32 v65, v65, v10
    v_cvt_pk_bf16_f32 v24, v64, v65
    v_lshlrev_b32 v64, 16, v24
    v_and_b32 v65, 0xffff0000, v24
    v_mul_f32 v64, v64, v11
    v_mul_f32 v65, v65, v11
    v_cvt_pk_bf16_f32 v24, v64, v65
    v_sub_f32 v66, v66, v10
    v_sub_f32 v67, v67, v10
    v_cvt_pk_bf16_f32 v25, v66, v67
    v_lshlrev_b32 v66, 16, v25
    v_and_b32 v67, 0xffff0000, v25
    v_mul_f32 v66, v66, v11
    v_mul_f32 v67, v67, v11
    v_cvt_pk_bf16_f32 v25, v66, v67
    v_sub_f32 v68, v68, v10
    v_sub_f32 v69, v69, v10
    v_cvt_pk_bf16_f32 v26, v68, v69
    v_lshlrev_b32 v68, 16, v26
    v_and_b32 v69, 0xffff0000, v26
    v_mul_f32 v68, v68, v11
    v_mul_f32 v69, v69, v11
    v_cvt_pk_bf16_f32 v26, v68, v69
    v_sub_f32 v70, v70, v10
    v_sub_f32 v71, v71, v10
    v_cvt_pk_bf16_f32 v27, v70, v71
    v_lshlrev_b32 v70, 16, v27
    v_and_b32 v71, 0xffff0000, v27
    v_mul_f32 v70, v70, v11
    v_mul_f32 v71, v71, v11
    v_cvt_pk_bf16_f32 v27, v70, v71
    v_cndmask_b32 v120, v24, v26, s[20:21]
    v_cndmask_b32 v121, v25, v27, s[20:21]
    v_cndmask_b32 v122, v26, v24, s[20:21]
    v_cndmask_b32 v123, v27, v25, s[20:21]
    buffer_store_dwordx4 v[120:123], v8, s[4:7], s15 offen offset:2048 sc1
    v_sub_f32 v72, v72, v10
    v_sub_f32 v73, v73, v10
    v_cvt_pk_bf16_f32 v28, v72, v73
    v_lshlrev_b32 v72, 16, v28
    v_and_b32 v73, 0xffff0000, v28
    v_mul_f32 v72, v72, v11
    v_mul_f32 v73, v73, v11
    v_cvt_pk_bf16_f32 v28, v72, v73
    v_sub_f32 v74, v74, v10
    v_sub_f32 v75, v75, v10
    v_cvt_pk_bf16_f32 v29, v74, v75
    v_lshlrev_b32 v74, 16, v29
    v_and_b32 v75, 0xffff0000, v29
    v_mul_f32 v74, v74, v11
    v_mul_f32 v75, v75, v11
    v_cvt_pk_bf16_f32 v29, v74, v75
    v_sub_f32 v76, v76, v10
    v_sub_f32 v77, v77, v10
    v_cvt_pk_bf16_f32 v30, v76, v77
    v_lshlrev_b32 v76, 16, v30
    v_and_b32 v77, 0xffff0000, v30
    v_mul_f32 v76, v76, v11
    v_mul_f32 v77, v77, v11
    v_cvt_pk_bf16_f32 v30, v76, v77
    v_sub_f32 v78, v78, v10
    v_sub_f32 v79, v79, v10
    v_cvt_pk_bf16_f32 v31, v78, v79
    v_lshlrev_b32 v78, 16, v31
    v_and_b32 v79, 0xffff0000, v31
    v_mul_f32 v78, v78, v11
    v_mul_f32 v79, v79, v11
    v_cvt_pk_bf16_f32 v31, v78, v79
    v_cndmask_b32 v124, v28, v30, s[20:21]
    v_cndmask_b32 v125, v29, v31, s[20:21]
    v_cndmask_b32 v126, v30, v28, s[20:21]
    v_cndmask_b32 v127, v31, v29, s[20:21]
    buffer_store_dwordx4 v[124:127], v8, s[4:7], s15 offen offset:3072 sc1
    v_sub_f32 v80, v80, v10
    v_sub_f32 v81, v81, v10
    v_cvt_pk_bf16_f32 v32, v80, v81
    v_lshlrev_b32 v80, 16, v32
    v_and_b32 v81, 0xffff0000, v32
    v_mul_f32 v80, v80, v11
    v_mul_f32 v81, v81, v11
    v_cvt_pk_bf16_f32 v32, v80, v81
    v_sub_f32 v82, v82, v10
    v_sub_f32 v83, v83, v10
    v_cvt_pk_bf16_f32 v33, v82, v83
    v_lshlrev_b32 v82, 16, v33
    v_and_b32 v83, 0xffff0000, v33
    v_mul_f32 v82, v82, v11
    v_mul_f32 v83, v83, v11
    v_cvt_pk_bf16_f32 v33, v82, v83
    v_sub_f32 v84, v84, v10
    v_sub_f32 v85, v85, v10
    v_cvt_pk_bf16_f32 v34, v84, v85
    v_lshlrev_b32 v84, 16, v34
    v_and_b32 v85, 0xffff0000, v34
    v_mul_f32 v84, v84, v11
    v_mul_f32 v85, v85, v11
    v_cvt_pk_bf16_f32 v34, v84, v85
    v_sub_f32 v86, v86, v10
    v_sub_f32 v87, v87, v10
    v_cvt_pk_bf16_f32 v35, v86, v87
    v_lshlrev_b32 v86, 16, v35
    v_and_b32 v87, 0xffff0000, v35
    v_mul_f32 v86, v86, v11
    v_mul_f32 v87, v87, v11
    v_cvt_pk_bf16_f32 v35, v86, v87
    v_cndmask_b32 v128, v32, v34, s[20:21]
    v_cndmask_b32 v129, v33, v35, s[20:21]
    v_cndmask_b32 v130, v34, v32, s[20:21]
    v_cndmask_b32 v131, v35, v33, s[20:21]
    buffer_store_dwordx4 v[128:131], v8, s[4:7], s16 offen offset:0 sc1
    v_sub_f32 v88, v88, v10
    v_sub_f32 v89, v89, v10
    v_cvt_pk_bf16_f32 v36, v88, v89
    v_lshlrev_b32 v88, 16, v36
    v_and_b32 v89, 0xffff0000, v36
    v_mul_f32 v88, v88, v11
    v_mul_f32 v89, v89, v11
    v_cvt_pk_bf16_f32 v36, v88, v89
    v_sub_f32 v90, v90, v10
    v_sub_f32 v91, v91, v10
    v_cvt_pk_bf16_f32 v37, v90, v91
    v_lshlrev_b32 v90, 16, v37
    v_and_b32 v91, 0xffff0000, v37
    v_mul_f32 v90, v90, v11
    v_mul_f32 v91, v91, v11
    v_cvt_pk_bf16_f32 v37, v90, v91
    v_sub_f32 v92, v92, v10
    v_sub_f32 v93, v93, v10
    v_cvt_pk_bf16_f32 v38, v92, v93
    v_lshlrev_b32 v92, 16, v38
    v_and_b32 v93, 0xffff0000, v38
    v_mul_f32 v92, v92, v11
    v_mul_f32 v93, v93, v11
    v_cvt_pk_bf16_f32 v38, v92, v93
    v_sub_f32 v94, v94, v10
    v_sub_f32 v95, v95, v10
    v_cvt_pk_bf16_f32 v39, v94, v95
    v_lshlrev_b32 v94, 16, v39
    v_and_b32 v95, 0xffff0000, v39
    v_mul_f32 v94, v94, v11
    v_mul_f32 v95, v95, v11
    v_cvt_pk_bf16_f32 v39, v94, v95
    v_cndmask_b32 v132, v36, v38, s[20:21]
    v_cndmask_b32 v133, v37, v39, s[20:21]
    v_cndmask_b32 v134, v38, v36, s[20:21]
    v_cndmask_b32 v135, v39, v37, s[20:21]
    buffer_store_dwordx4 v[132:135], v8, s[4:7], s16 offen offset:1024 sc1
    v_sub_f32 v96, v96, v10
    v_sub_f32 v97, v97, v10
    v_cvt_pk_bf16_f32 v40, v96, v97
    v_lshlrev_b32 v96, 16, v40
    v_and_b32 v97, 0xffff0000, v40
    v_mul_f32 v96, v96, v11
    v_mul_f32 v97, v97, v11
    v_cvt_pk_bf16_f32 v40, v96, v97
    v_sub_f32 v98, v98, v10
    v_sub_f32 v99, v99, v10
    v_cvt_pk_bf16_f32 v41, v98, v99
    v_lshlrev_b32 v98, 16, v41
    v_and_b32 v99, 0xffff0000, v41
    v_mul_f32 v98, v98, v11
    v_mul_f32 v99, v99, v11
    v_cvt_pk_bf16_f32 v41, v98, v99
    v_sub_f32 v100, v100, v10
    v_sub_f32 v101, v101, v10
    v_cvt_pk_bf16_f32 v42, v100, v101
    v_lshlrev_b32 v100, 16, v42
    v_and_b32 v101, 0xffff0000, v42
    v_mul_f32 v100, v100, v11
    v_mul_f32 v101, v101, v11
    v_cvt_pk_bf16_f32 v42, v100, v101
    v_sub_f32 v102, v102, v10
    v_sub_f32 v103, v103, v10
    v_cvt_pk_bf16_f32 v43, v102, v103
    v_lshlrev_b32 v102, 16, v43
    v_and_b32 v103, 0xffff0000, v43
    v_mul_f32 v102, v102, v11
    v_mul_f32 v103, v103, v11
    v_cvt_pk_bf16_f32 v43, v102, v103
    v_cndmask_b32 v136, v40, v42, s[20:21]
    v_cndmask_b32 v137, v41, v43, s[20:21]
    v_cndmask_b32 v138, v42, v40, s[20:21]
    v_cndmask_b32 v139, v43, v41, s[20:21]
    buffer_store_dwordx4 v[136:139], v8, s[4:7], s16 offen offset:2048 sc1
    v_sub_f32 v104, v104, v10
    v_sub_f32 v105, v105, v10
    v_cvt_pk_bf16_f32 v44, v104, v105
    v_lshlrev_b32 v104, 16, v44
    v_and_b32 v105, 0xffff0000, v44
    v_mul_f32 v104, v104, v11
    v_mul_f32 v105, v105, v11
    v_cvt_pk_bf16_f32 v44, v104, v105
    v_sub_f32 v106, v106, v10
    v_sub_f32 v107, v107, v10
    v_cvt_pk_bf16_f32 v45, v106, v107
    v_lshlrev_b32 v106, 16, v45
    v_and_b32 v107, 0xffff0000, v45
    v_mul_f32 v106, v106, v11
    v_mul_f32 v107, v107, v11
    v_cvt_pk_bf16_f32 v45, v106, v107
    v_sub_f32 v108, v108, v10
    v_sub_f32 v109, v109, v10
    v_cvt_pk_bf16_f32 v46, v108, v109
    v_lshlrev_b32 v108, 16, v46
    v_and_b32 v109, 0xffff0000, v46
    v_mul_f32 v108, v108, v11
    v_mul_f32 v109, v109, v11
    v_cvt_pk_bf16_f32 v46, v108, v109
    v_sub_f32 v110, v110, v10
    v_sub_f32 v111, v111, v10
    v_cvt_pk_bf16_f32 v47, v110, v111
    v_lshlrev_b32 v110, 16, v47
    v_and_b32 v111, 0xffff0000, v47
    v_mul_f32 v110, v110, v11
    v_mul_f32 v111, v111, v11
    v_cvt_pk_bf16_f32 v47, v110, v111
    v_cndmask_b32 v140, v44, v46, s[20:21]
    v_cndmask_b32 v141, v45, v47, s[20:21]
    v_cndmask_b32 v142, v46, v44, s[20:21]
    v_cndmask_b32 v143, v47, v45, s[20:21]
    buffer_store_dwordx4 v[140:143], v8, s[4:7], s16 offen offset:3072 sc1
    s_waitcnt vmcnt(0)
    s_barrier
    s_cmp_lg_u32 s3, 0
    s_cbranch_scc1 ln_sig
    v_mov_b32 v2, 1
    s_mov_b64 exec, 1
    s_cmp_ge_u32 s63, 8
    s_cbranch_scc1 ln_sb
    buffer_atomic_add v2, off, s[64:67], 0 offset:192 sc1
ln_sb:
    buffer_atomic_add v2, off, s[64:67], 0 offset:0 sc1
    s_mov_b64 exec, -1
    s_branch ln_sig
ln_touch:
    s_getpc_b64 s[24:25]
    s_add_u32 s24, s24, jobtab@rel32@lo+4
    s_addc_u32 s25, s25, jobtab@rel32@hi+12
    s_mul_i32 s30, s63, 640
    s_add_u32 s24, s24, s30
    s_addc_u32 s25, s25, 0
    s_load_dwordx16 s[32:47], s[24:25], 0
    s_mov_b32 s11, 131072
    v_and_b32 v20, 63, v0
    s_waitcnt lgkmcnt(0)
    s_load_dwordx2 s[8:9], s[0:1], s33
    s_mov_b32 s10, s38
    s_lshl_b32 s30, s35, 4
    v_mul_lo_u32 v21, s30, v20
    v_and_b32 v22, 15, v20
    v_mul_lo_u32 v22, s43, v22
    s_waitcnt lgkmcnt(0)
    s_cmp_eq_u32 s3, 4
    s_cbranch_scc0 tlb_1_1
    buffer_load_dword v23, v21, s[8:11], s36 offen
    s_branch tlb_1
tlb_1_1:
    s_cmp_eq_u32 s3, 5
    s_cbranch_scc0 tlb_1
    buffer_load_dword v23, v22, s[4:7], s42 offen
    buffer_load_dword v23, off, s[4:7], s46
tlb_1:
    s_barrier
    s_barrier
    s_barrier
ln_sig:
    s_cmp_lt_u32 s63, 120
    s_cbranch_scc1 prb_done
    s_cmp_lg_u32 s3, 0
    s_cbranch_scc1 prb_bar
    s_sub_u32 s12, s63, 120
    s_lshl_b32 s62, s12, 7
    s_add_u32 s62, s62, 218112000
    s_lshl_b32 s21, s12, 10
    s_add_u32 s21, s21, 209715200
    s_mov_b32 s80, -1
    s_mov_b32 s81, -1
    s_mov_b64 exec, 1
    s_memtime s[74:75]
    s_add_u32 s24, s21, 0
    s_waitcnt lgkmcnt(0)
    buffer_load_dword v3, off, s[4:7], s24 sc1
    s_waitcnt vmcnt(0)
    s_memtime s[76:77]
    s_waitcnt lgkmcnt(0)
    s_sub_u32 s24, s76, s74
    s_min_u32 s80, s80, s24
    s_memtime s[74:75]
    s_add_u32 s24, s21, 8192
    s_waitcnt lgkmcnt(0)
    buffer_load_dword v3, off, s[4:7], s24 sc1
    s_waitcnt vmcnt(0)
    s_memtime s[76:77]
    s_waitcnt lgkmcnt(0)
    s_sub_u32 s24, s76, s74
    s_min_u32 s81, s81, s24
    s_memtime s[74:75]
    s_add_u32 s24, s21, 16384
    s_waitcnt lgkmcnt(0)
    buffer_load_dword v3, off, s[4:7], s24 sc1
    s_waitcnt vmcnt(0)
    s_memtime s[76:77]
    s_waitcnt lgkmcnt(0)
    s_sub_u32 s24, s76, s74
    s_min_u32 s80, s80, s24
    s_memtime s[74:75]
    s_add_u32 s24, s21, 24576
    s_waitcnt lgkmcnt(0)
    buffer_load_dword v3, off, s[4:7], s24 sc1
    s_waitcnt vmcnt(0)
    s_memtime s[76:77]
    s_waitcnt lgkmcnt(0)
    s_sub_u32 s24, s76, s74
    s_min_u32 s81, s81, s24
    s_memtime s[74:75]
    s_add_u32 s24, s21, 32768
    s_waitcnt lgkmcnt(0)
    buffer_load_dword v3, off, s[4:7], s24 sc1
    s_waitcnt vmcnt(0)
    s_memtime s[76:77]
    s_waitcnt lgkmcnt(0)
    s_sub_u32 s24, s76, s74
    s_min_u32 s80, s80, s24
    s_memtime s[74:75]
    s_add_u32 s24, s21, 40960
    s_waitcnt lgkmcnt(0)
    buffer_load_dword v3, off, s[4:7], s24 sc1
    s_waitcnt vmcnt(0)
    s_memtime s[76:77]
    s_waitcnt lgkmcnt(0)
    s_sub_u32 s24, s76, s74
    s_min_u32 s81, s81, s24
    s_memtime s[74:75]
    s_add_u32 s24, s21, 49152
    s_waitcnt lgkmcnt(0)
    buffer_load_dword v3, off, s[4:7], s24 sc1
    s_waitcnt vmcnt(0)
    s_memtime s[76:77]
    s_waitcnt lgkmcnt(0)
    s_sub_u32 s24, s76, s74
    s_min_u32 s80, s80, s24
    s_memtime s[74:75]
    s_add_u32 s24, s21, 57344
    s_waitcnt lgkmcnt(0)
    buffer_load_dword v3, off, s[4:7], s24 sc1
    s_waitcnt vmcnt(0)
    s_memtime s[76:77]
    s_waitcnt lgkmcnt(0)
    s_sub_u32 s24, s76, s74
    s_min_u32 s81, s81, s24
    s_memtime s[74:75]
    s_add_u32 s24, s21, 65536
    s_waitcnt lgkmcnt(0)
    buffer_load_dword v3, off, s[4:7], s24 sc1
    s_waitcnt vmcnt(0)
    s_memtime s[76:77]
    s_waitcnt lgkmcnt(0)
    s_sub_u32 s24, s76, s74
    s_min_u32 s80, s80, s24
    s_memtime s[74:75]
    s_add_u32 s24, s21, 73728
    s_waitcnt lgkmcnt(0)
    buffer_load_dword v3, off, s[4:7], s24 sc1
    s_waitcnt vmcnt(0)
    s_memtime s[76:77]
    s_waitcnt lgkmcnt(0)
    s_sub_u32 s24, s76, s74
    s_min_u32 s81, s81, s24
    s_memtime s[74:75]
    s_add_u32 s24, s21, 81920
    s_waitcnt lgkmcnt(0)
    buffer_load_dword v3, off, s[4:7], s24 sc1
    s_waitcnt vmcnt(0)
    s_memtime s[76:77]
    s_waitcnt lgkmcnt(0)
    s_sub_u32 s24, s76, s74
    s_min_u32 s80, s80, s24
    s_memtime s[74:75]
    s_add_u32 s24, s21, 90112
    s_waitcnt lgkmcnt(0)
    buffer_load_dword v3, off, s[4:7], s24 sc1
    s_waitcnt vmcnt(0)
    s_memtime s[76:77]
    s_waitcnt lgkmcnt(0)
    s_sub_u32 s24, s76, s74
    s_min_u32 s81, s81, s24
    s_sub_i32 s22, s80, s81
    s_min_i32 s22, s22, 400
    s_max_i32 s22, s22, -400
    s_lshl_b32 s22, s22, 8
    s_getreg_b32 s23, hwreg(HW_REG_XCC_ID)
    s_bfe_u32 s23, s23, 0x10002
    s_lshl_b32 s23, s23, 1
    s_or_b32 s22, s22, s23
    s_or_b32 s22, s22, 1
    s_mov_b32 s23, 65536
prb_i:
    buffer_load_dword v3, off, s[64:67], 0 offset:0 sc1
    s_waitcnt vmcnt(0)
    v_readfirstlane_b32 s21, v3
    s_cmp_ge_u32 s21, 128
    s_cbranch_scc1 prb_i_ok
    s_sleep 8
    s_sub_u32 s23, s23, 1
    s_cbranch_scc0 prb_i
prb_i_ok:
    v_mov_b32 v3, s22
    buffer_store_dword v3, off, s[4:7], s62 offset:8 sc1
    s_mov_b64 exec, -1
prb_bar:
    s_barrier
prb_done:
    s_mov_b32 s29, s63
    v_and_b32 v20, 63, v0
    v_lshlrev_b32 v1, 4, v20
    v_add_u32 v19, 0x1000, v1
    v_lshrrev_b32 v4, 4, v20
    v_mov_b32 v17, 0
    v_mov_b32 v18, 1
    s_lshr_b32 s26, s3, 2
    s_and_b32 s27, s3, 3
    s_lshl_b32 s21, s3, 11
    s_lshl_b32 s22, s3, 10
    s_add_u32 s22, s22, 16384
    s_mov_b32 s11, 131072
    s_mov_b32 s15, 131072
    s_mov_b32 s28, 0
    v_and_b32 v21, 15, v20
    v_lshlrev_b32 v22, 2, v4
    v_xor_b32 v21, v21, v22
    s_lshr_b32 s30, s3, 1
    s_and_b32 s30, s30, 1
    v_xor_b32 v21, s30, v21
    v_lshlrev_b32 v3, 4, v21
    s_lshl_b32 s30, s26, 13
    v_add_u32 v5, s30, v1
    v_add_u32 v6, 0x10000, v5
    v_bfe_u32 v21, v20, 2, 2
    v_and_b32 v22, 3, v20
    v_and_b32 v23, 1, v4
    v_xor_b32 v24, s27, v21
    v_xor_b32 v25, v22, v23
    v_lshl_add_u32 v24, v24, 2, v25
    v_lshlrev_b32 v24, 4, v24
    v_lshl_add_u32 v25, v4, 3, v21
    v_lshl_add_u32 v24, v25, 8, v24
    v_and_b32 v22, 1, v22
    v_xor_b32 v25, 0, v23
    v_lshl_add_u32 v8, v25, 10, v24
    v_xor_b32 v25, 0, v22
    v_lshl_add_u32 v8, v25, 3, v8
    v_add_u32 v12, 0x10000, v8
    v_xor_b32 v25, 1, v23
    v_lshl_add_u32 v9, v25, 10, v24
    v_xor_b32 v25, 0, v22
    v_lshl_add_u32 v9, v25, 3, v9
    v_add_u32 v13, 0x10000, v9
    v_xor_b32 v25, 0, v23
    v_lshl_add_u32 v10, v25, 10, v24
    v_xor_b32 v25, 1, v22
    v_lshl_add_u32 v10, v25, 3, v10
    v_add_u32 v14, 0x10000, v10
    v_xor_b32 v25, 1, v23
    v_lshl_add_u32 v11, v25, 10, v24
    v_xor_b32 v25, 1, v22
    v_lshl_add_u32 v11, v25, 3, v11
    v_add_u32 v15, 0x10000, v11
    s_lshl_b32 s30, s3, 2
    s_add_u32 s30, s30, 131072
    v_mov_b32 v7, s30
    s_getpc_b64 s[24:25]
    s_add_u32 s24, s24, jobtab@rel32@lo+4
    s_addc_u32 s25, s25, jobtab@rel32@hi+12
    s_mul_i32 s30, s29, 640
    s_add_u32 s24, s24, s30
    s_addc_u32 s25, s25, 0
    s_load_dwordx16 s[32:47], s[24:25], 0
    s_add_u32 s24, s24, 64
    s_addc_u32 s25, s25, 0
    s_waitcnt lgkmcnt(0)
    s_cmp_lt_u32 s32, 4
    s_cbranch_scc1 w_nopre
    s_load_dwordx2 s[8:9], s[0:1], s33
    s_load_dwordx2 s[12:13], s[0:1], s34
    s_mov_b32 s10, s38
    s_mov_b32 s14, s38
    s_cmp_ge_u32 s32, 4
    s_cselect_b32 s31, 0, 1
    s_lshl_b32 s30, s3, s31
    s_mul_i32 s30, s30, s40
    s_add_u32 s16, s39, s30
    s_cmp_eq_u32 s32, 4
    s_cselect_b32 s30, 1024, s40
    s_cselect_b32 s31, 6, 5
    s_lshl_b32 s62, 32, s31
    s_add_u32 s17, s16, s30
    s_lshl_b32 s30, s3, 2
    s_mul_i32 s30, s30, s35
    s_add_u32 s18, s36, s30
    s_add_u32 s19, s37, s30
    s_lshl_b32 s20, s35, s31
    v_mul_u32_u24 v2, s35, v4
    v_add_u32 v2, v2, v3
    s_waitcnt lgkmcnt(0)
    s_add_u32 m0, s22, 0
    s_nop 0
    buffer_load_dwordx4 v2, s[8:11], s18 offen lds
    s_add_u32 s18, s18, s20
    s_add_u32 m0, s22, 8192
    s_nop 0
    buffer_load_dwordx4 v2, s[12:15], s19 offen lds
    s_add_u32 s19, s19, s20
    s_add_u32 m0, s22, 32768
    s_nop 0
    buffer_load_dwordx4 v2, s[8:11], s18 offen lds
    s_add_u32 s18, s18, s20
    s_add_u32 m0, s22, 40960
    s_nop 0
    buffer_load_dwordx4 v2, s[12:15], s19 offen lds
    s_add_u32 s19, s19, s20
    s_add_u32 m0, s22, 65536
    s_nop 0
    buffer_load_dwordx4 v2, s[8:11], s18 offen lds
    s_add_u32 s18, s18, s20
    s_add_u32 m0, s22, 73728
    s_nop 0
    buffer_load_dwordx4 v2, s[12:15], s19 offen lds
    s_add_u32 s19, s19, s20
    s_add_u32 m0, s22, 98304
    s_nop 0
    buffer_load_dwordx4 v2, s[8:11], s18 offen lds
    s_add_u32 s18, s18, s20
    s_add_u32 m0, s22, 106496
    s_nop 0
    buffer_load_dwordx4 v2, s[12:15], s19 offen lds
    s_add_u32 s19, s19, s20
    s_cmp_ge_u32 s32, 4
    s_cselect_b32 s70, 1, 0
    s_cmp_lt_u32 s39, 262144
    s_cselect_b32 s70, s70, 0
    s_cmp_lg_u32 s3, 0
    s_cbranch_scc1 lnwp_ok
    s_cmp_eq_u32 s70, 0
    s_cbranch_scc1 lnwp_full
    s_mov_b32 s69, 65536
lnwap:
    buffer_load_dword v20, off, s[64:67], 0 offset:192 sc1
    s_waitcnt vmcnt(0)
    v_readfirstlane_b32 s68, v20
    s_cmp_ge_u32 s68, 8
    s_cbranch_scc1 lnwap_ok
    s_sleep 8
    s_sub_u32 s69, s69, 1
    s_cbranch_scc0 lnwap
lnwap_ok:
    s_branch lnwp_ok
lnwp_full:
    s_mov_b32 s69, 65536
lnwp:
    buffer_load_dword v20, off, s[64:67], 0 offset:0 sc1
    s_waitcnt vmcnt(0)
    v_readfirstlane_b32 s68, v20
    s_cmp_ge_u32 s68, 128
    s_cbranch_scc1 lnwp_ok
    s_sleep 8
    s_sub_u32 s69, s69, 1
    s_cbranch_scc0 lnwp
lnwp_ok:
    s_barrier
    s_add_u32 m0, s21, 0
    s_nop 0
    buffer_load_dwordx4 v1, s[4:7], s16 offen sc1 lds
    s_add_u32 s16, s16, s62
    s_add_u32 m0, s21, 1024
    s_nop 0
    buffer_load_dwordx4 v1, s[4:7], s17 offen sc1 lds
    s_add_u32 s17, s17, s62
    s_add_u32 m0, s21, 32768
    s_nop 0
    buffer_load_dwordx4 v1, s[4:7], s16 offen sc1 lds
    s_add_u32 s16, s16, s62
    s_add_u32 m0, s21, 33792
    s_nop 0
    buffer_load_dwordx4 v1, s[4:7], s17 offen sc1 lds
    s_add_u32 s17, s17, s62
    s_add_u32 m0, s21, 65536
    s_nop 0
    buffer_load_dwordx4 v1, s[4:7], s16 offen sc1 lds
    s_add_u32 s16, s16, s62
    s_add_u32 m0, s21, 66560
    s_nop 0
    buffer_load_dwordx4 v1, s[4:7], s17 offen sc1 lds
    s_add_u32 s17, s17, s62
    s_add_u32 m0, s21, 98304
    s_nop 0
    buffer_load_dwordx4 v1, s[4:7], s16 offen sc1 lds
    s_add_u32 s16, s16, s62
    s_add_u32 m0, s21, 99328
    s_nop 0
    buffer_load_dwordx4 v1, s[4:7], s17 offen sc1 lds
    s_add_u32 s17, s17, s62
    s_branch w_adopt
w_nopre:
    s_cmp_ge_u32 s32, 4
    s_cselect_b32 s70, 1, 0
    s_cmp_lt_u32 s39, 262144
    s_cselect_b32 s70, s70, 0
    s_cmp_lg_u32 s3, 0
    s_cbranch_scc1 lnw_ok
    s_cmp_eq_u32 s70, 0
    s_cbranch_scc1 lnw_full
    s_mov_b32 s69, 65536
lnwa:
    buffer_load_dword v20, off, s[64:67], 0 offset:192 sc1
    s_waitcnt vmcnt(0)
    v_readfirstlane_b32 s68, v20
    s_cmp_ge_u32 s68, 8
    s_cbranch_scc1 lnwa_ok
    s_sleep 8
    s_sub_u32 s69, s69, 1
    s_cbranch_scc0 lnwa
lnwa_ok:
    s_branch lnw_ok
lnw_full:
    s_mov_b32 s69, 65536
lnw:
    buffer_load_dword v20, off, s[64:67], 0 offset:0 sc1
    s_waitcnt vmcnt(0)
    v_readfirstlane_b32 s68, v20
    s_cmp_ge_u32 s68, 128
    s_cbranch_scc1 lnw_ok
    s_sleep 8
    s_sub_u32 s69, s69, 1
    s_cbranch_scc0 lnw
lnw_ok:
    s_barrier
w_cold:
    s_cmp_eq_u32 s32, 0
    s_cbranch_scc1 fin_entry
    s_cmp_lg_u32 s3, 0
    s_cbranch_scc1 w_depok
    s_cmp_eq_u32 s45, 0
    s_cbranch_scc1 w_depok
    s_mov_b32 s31, 0x40000
w_waitdep:
    buffer_load_dword v16, v17, s[4:7], s44 offen sc1
    s_waitcnt vmcnt(0)
    v_readfirstlane_b32 s30, v16
    s_cmp_ge_u32 s30, s45
    s_cbranch_scc1 w_depok
    s_sleep 16
    s_sub_u32 s31, s31, 1
    s_cbranch_scc0 w_waitdep
w_depok:
    s_load_dwordx2 s[8:9], s[0:1], s33
    s_load_dwordx2 s[12:13], s[0:1], s34
    s_mov_b32 s10, s38
    s_mov_b32 s14, s38
    s_cmp_ge_u32 s32, 4
    s_cselect_b32 s31, 0, 1
    s_lshl_b32 s30, s3, s31
    s_mul_i32 s30, s30, s40
    s_add_u32 s16, s39, s30
    s_cmp_eq_u32 s32, 4
    s_cselect_b32 s30, 1024, s40
    s_cselect_b32 s31, 6, 5
    s_lshl_b32 s62, 32, s31
    s_add_u32 s17, s16, s30
    s_lshl_b32 s30, s3, 2
    s_mul_i32 s30, s30, s35
    s_add_u32 s18, s36, s30
    s_add_u32 s19, s37, s30
    s_lshl_b32 s20, s35, s31
    v_mul_u32_u24 v2, s35, v4
    v_add_u32 v2, v2, v3
    s_waitcnt lgkmcnt(0)
    s_barrier
    s_add_u32 m0, s21, 0
    s_nop 0
    buffer_load_dwordx4 v1, s[4:7], s16 offen sc1 lds
    s_add_u32 s16, s16, s62
    s_add_u32 m0, s21, 1024
    s_nop 0
    buffer_load_dwordx4 v1, s[4:7], s17 offen sc1 lds
    s_add_u32 s17, s17, s62
    s_add_u32 m0, s22, 0
    s_nop 0
    buffer_load_dwordx4 v2, s[8:11], s18 offen lds
    s_add_u32 s18, s18, s20
    s_add_u32 m0, s22, 8192
    s_nop 0
    buffer_load_dwordx4 v2, s[12:15], s19 offen lds
    s_add_u32 s19, s19, s20
    s_add_u32 m0, s21, 32768
    s_nop 0
    buffer_load_dwordx4 v1, s[4:7], s16 offen sc1 lds
    s_add_u32 s16, s16, s62
    s_add_u32 m0, s21, 33792
    s_nop 0
    buffer_load_dwordx4 v1, s[4:7], s17 offen sc1 lds
    s_add_u32 s17, s17, s62
    s_add_u32 m0, s22, 32768
    s_nop 0
    buffer_load_dwordx4 v2, s[8:11], s18 offen lds
    s_add_u32 s18, s18, s20
    s_add_u32 m0, s22, 40960
    s_nop 0
    buffer_load_dwordx4 v2, s[12:15], s19 offen lds
    s_add_u32 s19, s19, s20
    s_add_u32 m0, s21, 65536
    s_nop 0
    buffer_load_dwordx4 v1, s[4:7], s16 offen sc1 lds
    s_add_u32 s16, s16, s62
    s_add_u32 m0, s21, 66560
    s_nop 0
    buffer_load_dwordx4 v1, s[4:7], s17 offen sc1 lds
    s_add_u32 s17, s17, s62
    s_add_u32 m0, s22, 65536
    s_nop 0
    buffer_load_dwordx4 v2, s[8:11], s18 offen lds
    s_add_u32 s18, s18, s20
    s_add_u32 m0, s22, 73728
    s_nop 0
    buffer_load_dwordx4 v2, s[12:15], s19 offen lds
    s_add_u32 s19, s19, s20
    s_add_u32 m0, s21, 98304
    s_nop 0
    buffer_load_dwordx4 v1, s[4:7], s16 offen sc1 lds
    s_add_u32 s16, s16, s62
    s_add_u32 m0, s21, 99328
    s_nop 0
    buffer_load_dwordx4 v1, s[4:7], s17 offen sc1 lds
    s_add_u32 s17, s17, s62
    s_add_u32 m0, s22, 98304
    s_nop 0
    buffer_load_dwordx4 v2, s[8:11], s18 offen lds
    s_add_u32 s18, s18, s20
    s_add_u32 m0, s22, 106496
    s_nop 0
    buffer_load_dwordx4 v2, s[12:15], s19 offen lds
    s_add_u32 s19, s19, s20
w_adopt:
    s_mov_b32 s48, s32
    s_cmp_ge_u32 s32, 4
    s_cselect_b32 s30, 2, 3
    s_lshl_b32 s30, s26, s30
    s_mul_i32 s30, s30, s43
    s_add_u32 s49, s42, s30
    s_mov_b32 s50, s43
    s_mov_b32 s51, s46
    s_mov_b32 s23, s41
    s_mov_b32 s53, s47
    s_nop 0
    s_load_dwordx16 s[32:47], s[24:25], 0
    s_add_u32 s24, s24, 64
    s_addc_u32 s25, s25, 0
    s_waitcnt vmcnt(0)
    s_barrier
    ds_read_b64_tr_b16 v[64:65], v8 offset:16384
    ds_read_b64_tr_b16 v[66:67], v9 offset:16384
    ds_read_b64_tr_b16 v[68:69], v10 offset:16384
    ds_read_b64_tr_b16 v[70:71], v11 offset:16384
    ds_read_b64_tr_b16 v[72:73], v8 offset:24576
    ds_read_b64_tr_b16 v[74:75], v9 offset:24576
    ds_read_b64_tr_b16 v[76:77], v10 offset:24576
    ds_read_b64_tr_b16 v[78:79], v11 offset:24576
    ds_read_b128 v[32:35], v5 offset:0
    ds_read_b128 v[36:39], v5 offset:1024
    ds_read_b128 v[40:43], v5 offset:2048
    ds_read_b128 v[44:47], v5 offset:3072
    ds_read_b128 v[48:51], v5 offset:4096
    ds_read_b128 v[52:55], v5 offset:5120
    ds_read_b128 v[56:59], v5 offset:6144
    ds_read_b128 v[60:63], v5 offset:7168
    s_waitcnt lgkmcnt(0)
    s_cmp_eq_u32 s48, 4
    s_cbranch_scc1 w_firstH
    s_cmp_eq_u32 s48, 5
    s_cbranch_scc1 w_firstM
    s_branch w_first16
w_first4:
    s_waitcnt vmcnt(12)
    s_barrier
    v_mfma_f32_16x16x32_bf16 v[128:131], v[64:67], v[32:35], 0
    ds_read_b64_tr_b16 v[112:113], v8 offset:49152
    v_mfma_f32_16x16x32_bf16 v[132:135], v[68:71], v[32:35], 0
    ds_read_b64_tr_b16 v[114:115], v9 offset:49152
    v_mfma_f32_16x16x32_bf16 v[136:139], v[72:75], v[32:35], 0
    ds_read_b64_tr_b16 v[116:117], v10 offset:49152
    v_mfma_f32_16x16x32_bf16 v[140:143], v[76:79], v[32:35], 0
    ds_read_b64_tr_b16 v[118:119], v11 offset:49152
    v_mfma_f32_16x16x32_bf16 v[144:147], v[64:67], v[36:39], 0
    ds_read_b64_tr_b16 v[120:121], v8 offset:57344
    v_mfma_f32_16x16x32_bf16 v[148:151], v[68:71], v[36:39], 0
    ds_read_b64_tr_b16 v[122:123], v9 offset:57344
    v_mfma_f32_16x16x32_bf16 v[152:155], v[72:75], v[36:39], 0
    ds_read_b64_tr_b16 v[124:125], v10 offset:57344
    v_mfma_f32_16x16x32_bf16 v[156:159], v[76:79], v[36:39], 0
    ds_read_b64_tr_b16 v[126:127], v11 offset:57344
    v_mfma_f32_16x16x32_bf16 v[160:163], v[64:67], v[40:43], 0
    ds_read_b128 v[80:83], v5 offset:32768
    v_mfma_f32_16x16x32_bf16 v[164:167], v[68:71], v[40:43], 0
    ds_read_b128 v[84:87], v5 offset:33792
    v_mfma_f32_16x16x32_bf16 v[168:171], v[72:75], v[40:43], 0
    ds_read_b128 v[88:91], v5 offset:34816
    v_mfma_f32_16x16x32_bf16 v[172:175], v[76:79], v[40:43], 0
    ds_read_b128 v[92:95], v5 offset:35840
    v_mfma_f32_16x16x32_bf16 v[176:179], v[64:67], v[44:47], 0
    ds_read_b128 v[96:99], v5 offset:36864
    v_mfma_f32_16x16x32_bf16 v[180:183], v[68:71], v[44:47], 0
    ds_read_b128 v[100:103], v5 offset:37888
    v_mfma_f32_16x16x32_bf16 v[184:187], v[72:75], v[44:47], 0
    ds_read_b128 v[104:107], v5 offset:38912
    v_mfma_f32_16x16x32_bf16 v[188:191], v[76:79], v[44:47], 0
    ds_read_b128 v[108:111], v5 offset:39936
    v_mfma_f32_16x16x32_bf16 v[192:195], v[64:67], v[48:51], 0
    v_mfma_f32_16x16x32_bf16 v[196:199], v[68:71], v[48:51], 0
    s_add_u32 m0, s21, 0
    s_nop 0
    buffer_load_dwordx4 v1, s[4:7], s16 offen sc1 lds
    s_add_u32 s16, s16, s62
    v_mfma_f32_16x16x32_bf16 v[200:203], v[72:75], v[48:51], 0
    v_mfma_f32_16x16x32_bf16 v[204:207], v[76:79], v[48:51], 0
    v_mfma_f32_16x16x32_bf16 v[208:211], v[64:67], v[52:55], 0
    s_add_u32 m0, s21, 1024
    s_nop 0
    buffer_load_dwordx4 v1, s[4:7], s17 offen sc1 lds
    s_add_u32 s17, s17, s62
    v_mfma_f32_16x16x32_bf16 v[212:215], v[68:71], v[52:55], 0
    v_mfma_f32_16x16x32_bf16 v[216:219], v[72:75], v[52:55], 0
    v_mfma_f32_16x16x32_bf16 v[220:223], v[76:79], v[52:55], 0
    s_add_u32 m0, s22, 0
    s_nop 0
    buffer_load_dwordx4 v2, s[8:11], s18 offen lds
    s_add_u32 s18, s18, s20
    v_mfma_f32_16x16x32_bf16 v[224:227], v[64:67], v[56:59], 0
    v_mfma_f32_16x16x32_bf16 v[228:231], v[68:71], v[56:59], 0
    v_mfma_f32_16x16x32_bf16 v[232:235], v[72:75], v[56:59], 0
    s_add_u32 m0, s22, 8192
    s_nop 0
    buffer_load_dwordx4 v2, s[12:15], s19 offen lds
    s_add_u32 s19, s19, s20
    v_mfma_f32_16x16x32_bf16 v[236:239], v[76:79], v[56:59], 0
    v_mfma_f32_16x16x32_bf16 v[240:243], v[64:67], v[60:63], 0
    v_mfma_f32_16x16x32_bf16 v[244:247], v[68:71], v[60:63], 0
    v_mfma_f32_16x16x32_bf16 v[248:251], v[72:75], v[60:63], 0
    v_mfma_f32_16x16x32_bf16 v[252:255], v[76:79], v[60:63], 0
    s_waitcnt lgkmcnt(0)
    s_waitcnt vmcnt(12)
    s_barrier
    v_mfma_f32_16x16x32_bf16 v[128:131], v[112:115], v[80:83], v[128:131]
    ds_read_b64_tr_b16 v[64:65], v12 offset:16384
    v_mfma_f32_16x16x32_bf16 v[132:135], v[116:119], v[80:83], v[132:135]
    ds_read_b64_tr_b16 v[66:67], v13 offset:16384
    v_mfma_f32_16x16x32_bf16 v[136:139], v[120:123], v[80:83], v[136:139]
    ds_read_b64_tr_b16 v[68:69], v14 offset:16384
    v_mfma_f32_16x16x32_bf16 v[140:143], v[124:127], v[80:83], v[140:143]
    ds_read_b64_tr_b16 v[70:71], v15 offset:16384
    v_mfma_f32_16x16x32_bf16 v[144:147], v[112:115], v[84:87], v[144:147]
    ds_read_b64_tr_b16 v[72:73], v12 offset:24576
    v_mfma_f32_16x16x32_bf16 v[148:151], v[116:119], v[84:87], v[148:151]
    ds_read_b64_tr_b16 v[74:75], v13 offset:24576
    v_mfma_f32_16x16x32_bf16 v[152:155], v[120:123], v[84:87], v[152:155]
    ds_read_b64_tr_b16 v[76:77], v14 offset:24576
    v_mfma_f32_16x16x32_bf16 v[156:159], v[124:127], v[84:87], v[156:159]
    ds_read_b64_tr_b16 v[78:79], v15 offset:24576
    v_mfma_f32_16x16x32_bf16 v[160:163], v[112:115], v[88:91], v[160:163]
    ds_read_b128 v[32:35], v6 offset:0
    v_mfma_f32_16x16x32_bf16 v[164:167], v[116:119], v[88:91], v[164:167]
    ds_read_b128 v[36:39], v6 offset:1024
    v_mfma_f32_16x16x32_bf16 v[168:171], v[120:123], v[88:91], v[168:171]
    ds_read_b128 v[40:43], v6 offset:2048
    v_mfma_f32_16x16x32_bf16 v[172:175], v[124:127], v[88:91], v[172:175]
    ds_read_b128 v[44:47], v6 offset:3072
    v_mfma_f32_16x16x32_bf16 v[176:179], v[112:115], v[92:95], v[176:179]
    ds_read_b128 v[48:51], v6 offset:4096
    v_mfma_f32_16x16x32_bf16 v[180:183], v[116:119], v[92:95], v[180:183]
    ds_read_b128 v[52:55], v6 offset:5120
    v_mfma_f32_16x16x32_bf16 v[184:187], v[120:123], v[92:95], v[184:187]
    ds_read_b128 v[56:59], v6 offset:6144
    v_mfma_f32_16x16x32_bf16 v[188:191], v[124:127], v[92:95], v[188:191]
    ds_read_b128 v[60:63], v6 offset:7168
    v_mfma_f32_16x16x32_bf16 v[192:195], v[112:115], v[96:99], v[192:195]
    v_mfma_f32_16x16x32_bf16 v[196:199], v[116:119], v[96:99], v[196:199]
    s_add_u32 m0, s21, 32768
    s_nop 0
    buffer_load_dwordx4 v1, s[4:7], s16 offen sc1 lds
    s_add_u32 s16, s16, s62
    v_mfma_f32_16x16x32_bf16 v[200:203], v[120:123], v[96:99], v[200:203]
    v_mfma_f32_16x16x32_bf16 v[204:207], v[124:127], v[96:99], v[204:207]
    v_mfma_f32_16x16x32_bf16 v[208:211], v[112:115], v[100:103], v[208:211]
    s_add_u32 m0, s21, 33792
    s_nop 0
    buffer_load_dwordx4 v1, s[4:7], s17 offen sc1 lds
    s_add_u32 s17, s17, s62
    v_mfma_f32_16x16x32_bf16 v[212:215], v[116:119], v[100:103], v[212:215]
    v_mfma_f32_16x16x32_bf16 v[216:219], v[120:123], v[100:103], v[216:219]
    v_mfma_f32_16x16x32_bf16 v[220:223], v[124:127], v[100:103], v[220:223]
    s_add_u32 m0, s22, 32768
    s_nop 0
    buffer_load_dwordx4 v2, s[8:11], s18 offen lds
    s_add_u32 s18, s18, s20
    v_mfma_f32_16x16x32_bf16 v[224:227], v[112:115], v[104:107], v[224:227]
    v_mfma_f32_16x16x32_bf16 v[228:231], v[116:119], v[104:107], v[228:231]
    v_mfma_f32_16x16x32_bf16 v[232:235], v[120:123], v[104:107], v[232:235]
    s_add_u32 m0, s22, 40960
    s_nop 0
    buffer_load_dwordx4 v2, s[12:15], s19 offen lds
    s_add_u32 s19, s19, s20
    v_mfma_f32_16x16x32_bf16 v[236:239], v[124:127], v[104:107], v[236:239]
    v_mfma_f32_16x16x32_bf16 v[240:243], v[112:115], v[108:111], v[240:243]
    v_mfma_f32_16x16x32_bf16 v[244:247], v[116:119], v[108:111], v[244:247]
    v_mfma_f32_16x16x32_bf16 v[248:251], v[120:123], v[108:111], v[248:251]
    v_mfma_f32_16x16x32_bf16 v[252:255], v[124:127], v[108:111], v[252:255]
    s_waitcnt lgkmcnt(0)
    s_waitcnt vmcnt(12)
    s_barrier
    v_mfma_f32_16x16x32_bf16 v[128:131], v[64:67], v[32:35], v[128:131]
    ds_read_b64_tr_b16 v[112:113], v12 offset:49152
    v_mfma_f32_16x16x32_bf16 v[132:135], v[68:71], v[32:35], v[132:135]
    ds_read_b64_tr_b16 v[114:115], v13 offset:49152
    v_mfma_f32_16x16x32_bf16 v[136:139], v[72:75], v[32:35], v[136:139]
    ds_read_b64_tr_b16 v[116:117], v14 offset:49152
    v_mfma_f32_16x16x32_bf16 v[140:143], v[76:79], v[32:35], v[140:143]
    ds_read_b64_tr_b16 v[118:119], v15 offset:49152
    v_mfma_f32_16x16x32_bf16 v[144:147], v[64:67], v[36:39], v[144:147]
    ds_read_b64_tr_b16 v[120:121], v12 offset:57344
    v_mfma_f32_16x16x32_bf16 v[148:151], v[68:71], v[36:39], v[148:151]
    ds_read_b64_tr_b16 v[122:123], v13 offset:57344
    v_mfma_f32_16x16x32_bf16 v[152:155], v[72:75], v[36:39], v[152:155]
    ds_read_b64_tr_b16 v[124:125], v14 offset:57344
    v_mfma_f32_16x16x32_bf16 v[156:159], v[76:79], v[36:39], v[156:159]
    ds_read_b64_tr_b16 v[126:127], v15 offset:57344
    v_mfma_f32_16x16x32_bf16 v[160:163], v[64:67], v[40:43], v[160:163]
    ds_read_b128 v[80:83], v6 offset:32768
    v_mfma_f32_16x16x32_bf16 v[164:167], v[68:71], v[40:43], v[164:167]
    ds_read_b128 v[84:87], v6 offset:33792
    v_mfma_f32_16x16x32_bf16 v[168:171], v[72:75], v[40:43], v[168:171]
    ds_read_b128 v[88:91], v6 offset:34816
    v_mfma_f32_16x16x32_bf16 v[172:175], v[76:79], v[40:43], v[172:175]
    ds_read_b128 v[92:95], v6 offset:35840
    v_mfma_f32_16x16x32_bf16 v[176:179], v[64:67], v[44:47], v[176:179]
    ds_read_b128 v[96:99], v6 offset:36864
    v_mfma_f32_16x16x32_bf16 v[180:183], v[68:71], v[44:47], v[180:183]
    ds_read_b128 v[100:103], v6 offset:37888
    v_mfma_f32_16x16x32_bf16 v[184:187], v[72:75], v[44:47], v[184:187]
    ds_read_b128 v[104:107], v6 offset:38912
    v_mfma_f32_16x16x32_bf16 v[188:191], v[76:79], v[44:47], v[188:191]
    ds_read_b128 v[108:111], v6 offset:39936
    v_mfma_f32_16x16x32_bf16 v[192:195], v[64:67], v[48:51], v[192:195]
    v_mfma_f32_16x16x32_bf16 v[196:199], v[68:71], v[48:51], v[196:199]
    s_add_u32 m0, s21, 65536
    s_nop 0
    buffer_load_dwordx4 v1, s[4:7], s16 offen sc1 lds
    s_add_u32 s16, s16, s62
    v_mfma_f32_16x16x32_bf16 v[200:203], v[72:75], v[48:51], v[200:203]
    v_mfma_f32_16x16x32_bf16 v[204:207], v[76:79], v[48:51], v[204:207]
    v_mfma_f32_16x16x32_bf16 v[208:211], v[64:67], v[52:55], v[208:211]
    s_add_u32 m0, s21, 66560
    s_nop 0
    buffer_load_dwordx4 v1, s[4:7], s17 offen sc1 lds
    s_add_u32 s17, s17, s62
    v_mfma_f32_16x16x32_bf16 v[212:215], v[68:71], v[52:55], v[212:215]
    v_mfma_f32_16x16x32_bf16 v[216:219], v[72:75], v[52:55], v[216:219]
    v_mfma_f32_16x16x32_bf16 v[220:223], v[76:79], v[52:55], v[220:223]
    s_add_u32 m0, s22, 65536
    s_nop 0
    buffer_load_dwordx4 v2, s[8:11], s18 offen lds
    s_add_u32 s18, s18, s20
    v_mfma_f32_16x16x32_bf16 v[224:227], v[64:67], v[56:59], v[224:227]
    v_mfma_f32_16x16x32_bf16 v[228:231], v[68:71], v[56:59], v[228:231]
    v_mfma_f32_16x16x32_bf16 v[232:235], v[72:75], v[56:59], v[232:235]
    s_add_u32 m0, s22, 73728
    s_nop 0
    buffer_load_dwordx4 v2, s[12:15], s19 offen lds
    s_add_u32 s19, s19, s20
    v_mfma_f32_16x16x32_bf16 v[236:239], v[76:79], v[56:59], v[236:239]
    v_mfma_f32_16x16x32_bf16 v[240:243], v[64:67], v[60:63], v[240:243]
    v_mfma_f32_16x16x32_bf16 v[244:247], v[68:71], v[60:63], v[244:247]
    v_mfma_f32_16x16x32_bf16 v[248:251], v[72:75], v[60:63], v[248:251]
    v_mfma_f32_16x16x32_bf16 v[252:255], v[76:79], v[60:63], v[252:255]
    s_waitcnt lgkmcnt(0)
    s_waitcnt vmcnt(8)
    s_barrier
    s_cmp_eq_u32 s28, 0
    s_cbranch_scc1 sig_2
    s_cmp_lg_u32 s3, 0
    s_cbranch_scc1 sig_2
    s_mov_b64 exec, 1
    v_mov_b32 v18, s57
    buffer_atomic_add v18, v17, s[4:7], s28 offen sc1
    s_mov_b64 exec, -1
sig_2:
    s_mov_b32 s28, 0
    v_mfma_f32_16x16x32_bf16 v[128:131], v[112:115], v[80:83], v[128:131]
    ds_read_b64_tr_b16 v[64:65], v8 offset:16384
    v_mfma_f32_16x16x32_bf16 v[132:135], v[116:119], v[80:83], v[132:135]
    ds_read_b64_tr_b16 v[66:67], v9 offset:16384
    v_mfma_f32_16x16x32_bf16 v[136:139], v[120:123], v[80:83], v[136:139]
    ds_read_b64_tr_b16 v[68:69], v10 offset:16384
    v_mfma_f32_16x16x32_bf16 v[140:143], v[124:127], v[80:83], v[140:143]
    ds_read_b64_tr_b16 v[70:71], v11 offset:16384
    v_mfma_f32_16x16x32_bf16 v[144:147], v[112:115], v[84:87], v[144:147]
    ds_read_b64_tr_b16 v[72:73], v8 offset:24576
    v_mfma_f32_16x16x32_bf16 v[148:151], v[116:119], v[84:87], v[148:151]
    ds_read_b64_tr_b16 v[74:75], v9 offset:24576
    v_mfma_f32_16x16x32_bf16 v[152:155], v[120:123], v[84:87], v[152:155]
    ds_read_b64_tr_b16 v[76:77], v10 offset:24576
    v_mfma_f32_16x16x32_bf16 v[156:159], v[124:127], v[84:87], v[156:159]
    ds_read_b64_tr_b16 v[78:79], v11 offset:24576
    v_mfma_f32_16x16x32_bf16 v[160:163], v[112:115], v[88:91], v[160:163]
    ds_read_b128 v[32:35], v5 offset:0
    v_mfma_f32_16x16x32_bf16 v[164:167], v[116:119], v[88:91], v[164:167]
    ds_read_b128 v[36:39], v5 offset:1024
    v_mfma_f32_16x16x32_bf16 v[168:171], v[120:123], v[88:91], v[168:171]
    ds_read_b128 v[40:43], v5 offset:2048
    v_mfma_f32_16x16x32_bf16 v[172:175], v[124:127], v[88:91], v[172:175]
    ds_read_b128 v[44:47], v5 offset:3072
    v_mfma_f32_16x16x32_bf16 v[176:179], v[112:115], v[92:95], v[176:179]
    ds_read_b128 v[48:51], v5 offset:4096
    v_mfma_f32_16x16x32_bf16 v[180:183], v[116:119], v[92:95], v[180:183]
    ds_read_b128 v[52:55], v5 offset:5120
    v_mfma_f32_16x16x32_bf16 v[184:187], v[120:123], v[92:95], v[184:187]
    ds_read_b128 v[56:59], v5 offset:6144
    v_mfma_f32_16x16x32_bf16 v[188:191], v[124:127], v[92:95], v[188:191]
    ds_read_b128 v[60:63], v5 offset:7168
    v_mfma_f32_16x16x32_bf16 v[192:195], v[112:115], v[96:99], v[192:195]
    v_mfma_f32_16x16x32_bf16 v[196:199], v[116:119], v[96:99], v[196:199]
    s_add_u32 m0, s21, 98304
    s_nop 0
    buffer_load_dwordx4 v1, s[4:7], s16 offen sc1 lds
    s_add_u32 s16, s16, s62
    v_mfma_f32_16x16x32_bf16 v[200:203], v[120:123], v[96:99], v[200:203]
    v_mfma_f32_16x16x32_bf16 v[204:207], v[124:127], v[96:99], v[204:207]
    v_mfma_f32_16x16x32_bf16 v[208:211], v[112:115], v[100:103], v[208:211]
    s_add_u32 m0, s21, 99328
    s_nop 0
    buffer_load_dwordx4 v1, s[4:7], s17 offen sc1 lds
    s_add_u32 s17, s17, s62
    v_mfma_f32_16x16x32_bf16 v[212:215], v[116:119], v[100:103], v[212:215]
    v_mfma_f32_16x16x32_bf16 v[216:219], v[120:123], v[100:103], v[216:219]
    v_mfma_f32_16x16x32_bf16 v[220:223], v[124:127], v[100:103], v[220:223]
    s_add_u32 m0, s22, 98304
    s_nop 0
    buffer_load_dwordx4 v2, s[8:11], s18 offen lds
    s_add_u32 s18, s18, s20
    v_mfma_f32_16x16x32_bf16 v[224:227], v[112:115], v[104:107], v[224:227]
    v_mfma_f32_16x16x32_bf16 v[228:231], v[116:119], v[104:107], v[228:231]
    v_mfma_f32_16x16x32_bf16 v[232:235], v[120:123], v[104:107], v[232:235]
    s_add_u32 m0, s22, 106496
    s_nop 0
    buffer_load_dwordx4 v2, s[12:15], s19 offen lds
    s_add_u32 s19, s19, s20
    v_mfma_f32_16x16x32_bf16 v[236:239], v[124:127], v[104:107], v[236:239]
    v_mfma_f32_16x16x32_bf16 v[240:243], v[112:115], v[108:111], v[240:243]
    v_mfma_f32_16x16x32_bf16 v[244:247], v[116:119], v[108:111], v[244:247]
    v_mfma_f32_16x16x32_bf16 v[248:251], v[120:123], v[108:111], v[248:251]
    v_mfma_f32_16x16x32_bf16 v[252:255], v[124:127], v[108:111], v[252:255]
    s_waitcnt lgkmcnt(0)
    s_branch w_loop_chk
w_first8:
    s_waitcnt vmcnt(16)
    s_barrier
    v_mfma_f32_16x16x32_bf16 v[128:131], v[64:67], v[32:35], 0
    ds_read_b64_tr_b16 v[112:113], v8 offset:49152
    v_mfma_f32_16x16x32_bf16 v[132:135], v[68:71], v[32:35], 0
    ds_read_b64_tr_b16 v[114:115], v9 offset:49152
    v_mfma_f32_16x16x32_bf16 v[136:139], v[72:75], v[32:35], 0
    ds_read_b64_tr_b16 v[116:117], v10 offset:49152
    v_mfma_f32_16x16x32_bf16 v[140:143], v[76:79], v[32:35], 0
    ds_read_b64_tr_b16 v[118:119], v11 offset:49152
    v_mfma_f32_16x16x32_bf16 v[144:147], v[64:67], v[36:39], 0
    ds_read_b64_tr_b16 v[120:121], v8 offset:57344
    v_mfma_f32_16x16x32_bf16 v[148:151], v[68:71], v[36:39], 0
    ds_read_b64_tr_b16 v[122:123], v9 offset:57344
    v_mfma_f32_16x16x32_bf16 v[152:155], v[72:75], v[36:39], 0
    ds_read_b64_tr_b16 v[124:125], v10 offset:57344
    v_mfma_f32_16x16x32_bf16 v[156:159], v[76:79], v[36:39], 0
    ds_read_b64_tr_b16 v[126:127], v11 offset:57344
    v_mfma_f32_16x16x32_bf16 v[160:163], v[64:67], v[40:43], 0
    ds_read_b128 v[80:83], v5 offset:32768
    v_mfma_f32_16x16x32_bf16 v[164:167], v[68:71], v[40:43], 0
    ds_read_b128 v[84:87], v5 offset:33792
    v_mfma_f32_16x16x32_bf16 v[168:171], v[72:75], v[40:43], 0
    ds_read_b128 v[88:91], v5 offset:34816
    v_mfma_f32_16x16x32_bf16 v[172:175], v[76:79], v[40:43], 0
    ds_read_b128 v[92:95], v5 offset:35840
    v_mfma_f32_16x16x32_bf16 v[176:179], v[64:67], v[44:47], 0
    ds_read_b128 v[96:99], v5 offset:36864
    v_mfma_f32_16x16x32_bf16 v[180:183], v[68:71], v[44:47], 0
    ds_read_b128 v[100:103], v5 offset:37888
    v_mfma_f32_16x16x32_bf16 v[184:187], v[72:75], v[44:47], 0
    ds_read_b128 v[104:107], v5 offset:38912
    v_mfma_f32_16x16x32_bf16 v[188:191], v[76:79], v[44:47], 0
    ds_read_b128 v[108:111], v5 offset:39936
    v_mfma_f32_16x16x32_bf16 v[192:195], v[64:67], v[48:51], 0
    v_mfma_f32_16x16x32_bf16 v[196:199], v[68:71], v[48:51], 0
    s_add_u32 m0, s21, 0
    s_nop 0
    buffer_load_dwordx4 v1, s[4:7], s16 offen sc1 lds
    s_add_u32 s16, s16, s62
    v_mfma_f32_16x16x32_bf16 v[200:203], v[72:75], v[48:51], 0
    v_mfma_f32_16x16x32_bf16 v[204:207], v[76:79], v[48:51], 0
    v_mfma_f32_16x16x32_bf16 v[208:211], v[64:67], v[52:55], 0
    s_add_u32 m0, s21, 1024
    s_nop 0
    buffer_load_dwordx4 v1, s[4:7], s17 offen sc1 lds
    s_add_u32 s17, s17, s62
    v_mfma_f32_16x16x32_bf16 v[212:215], v[68:71], v[52:55], 0
    v_mfma_f32_16x16x32_bf16 v[216:219], v[72:75], v[52:55], 0
    v_mfma_f32_16x16x32_bf16 v[220:223], v[76:79], v[52:55], 0
    s_add_u32 m0, s22, 0
    s_nop 0
    buffer_load_dwordx4 v2, s[8:11], s18 offen lds
    s_add_u32 s18, s18, s20
    v_mfma_f32_16x16x32_bf16 v[224:227], v[64:67], v[56:59], 0
    v_mfma_f32_16x16x32_bf16 v[228:231], v[68:71], v[56:59], 0
    v_mfma_f32_16x16x32_bf16 v[232:235], v[72:75], v[56:59], 0
    s_add_u32 m0, s22, 8192
    s_nop 0
    buffer_load_dwordx4 v2, s[12:15], s19 offen lds
    s_add_u32 s19, s19, s20
    v_mfma_f32_16x16x32_bf16 v[236:239], v[76:79], v[56:59], 0
    v_mfma_f32_16x16x32_bf16 v[240:243], v[64:67], v[60:63], 0
    v_mfma_f32_16x16x32_bf16 v[244:247], v[68:71], v[60:63], 0
    v_mfma_f32_16x16x32_bf16 v[248:251], v[72:75], v[60:63], 0
    v_mfma_f32_16x16x32_bf16 v[252:255], v[76:79], v[60:63], 0
    s_waitcnt lgkmcnt(0)
    s_waitcnt vmcnt(16)
    s_barrier
    v_mfma_f32_16x16x32_bf16 v[128:131], v[112:115], v[80:83], v[128:131]
    ds_read_b64_tr_b16 v[64:65], v12 offset:16384
    v_mfma_f32_16x16x32_bf16 v[132:135], v[116:119], v[80:83], v[132:135]
    ds_read_b64_tr_b16 v[66:67], v13 offset:16384
    v_mfma_f32_16x16x32_bf16 v[136:139], v[120:123], v[80:83], v[136:139]
    ds_read_b64_tr_b16 v[68:69], v14 offset:16384
    v_mfma_f32_16x16x32_bf16 v[140:143], v[124:127], v[80:83], v[140:143]
    ds_read_b64_tr_b16 v[70:71], v15 offset:16384
    v_mfma_f32_16x16x32_bf16 v[144:147], v[112:115], v[84:87], v[144:147]
    ds_read_b64_tr_b16 v[72:73], v12 offset:24576
    v_mfma_f32_16x16x32_bf16 v[148:151], v[116:119], v[84:87], v[148:151]
    ds_read_b64_tr_b16 v[74:75], v13 offset:24576
    v_mfma_f32_16x16x32_bf16 v[152:155], v[120:123], v[84:87], v[152:155]
    ds_read_b64_tr_b16 v[76:77], v14 offset:24576
    v_mfma_f32_16x16x32_bf16 v[156:159], v[124:127], v[84:87], v[156:159]
    ds_read_b64_tr_b16 v[78:79], v15 offset:24576
    v_mfma_f32_16x16x32_bf16 v[160:163], v[112:115], v[88:91], v[160:163]
    ds_read_b128 v[32:35], v6 offset:0
    v_mfma_f32_16x16x32_bf16 v[164:167], v[116:119], v[88:91], v[164:167]
    ds_read_b128 v[36:39], v6 offset:1024
    v_mfma_f32_16x16x32_bf16 v[168:171], v[120:123], v[88:91], v[168:171]
    ds_read_b128 v[40:43], v6 offset:2048
    v_mfma_f32_16x16x32_bf16 v[172:175], v[124:127], v[88:91], v[172:175]
    ds_read_b128 v[44:47], v6 offset:3072
    v_mfma_f32_16x16x32_bf16 v[176:179], v[112:115], v[92:95], v[176:179]
    ds_read_b128 v[48:51], v6 offset:4096
    v_mfma_f32_16x16x32_bf16 v[180:183], v[116:119], v[92:95], v[180:183]
    ds_read_b128 v[52:55], v6 offset:5120
    v_mfma_f32_16x16x32_bf16 v[184:187], v[120:123], v[92:95], v[184:187]
    ds_read_b128 v[56:59], v6 offset:6144
    v_mfma_f32_16x16x32_bf16 v[188:191], v[124:127], v[92:95], v[188:191]
    ds_read_b128 v[60:63], v6 offset:7168
    v_mfma_f32_16x16x32_bf16 v[192:195], v[112:115], v[96:99], v[192:195]
    v_mfma_f32_16x16x32_bf16 v[196:199], v[116:119], v[96:99], v[196:199]
    s_add_u32 m0, s21, 32768
    s_nop 0
    buffer_load_dwordx4 v1, s[4:7], s16 offen sc1 lds
    s_add_u32 s16, s16, s62
    v_mfma_f32_16x16x32_bf16 v[200:203], v[120:123], v[96:99], v[200:203]
    v_mfma_f32_16x16x32_bf16 v[204:207], v[124:127], v[96:99], v[204:207]
    v_mfma_f32_16x16x32_bf16 v[208:211], v[112:115], v[100:103], v[208:211]
    s_add_u32 m0, s21, 33792
    s_nop 0
    buffer_load_dwordx4 v1, s[4:7], s17 offen sc1 lds
    s_add_u32 s17, s17, s62
    v_mfma_f32_16x16x32_bf16 v[212:215], v[116:119], v[100:103], v[212:215]
    v_mfma_f32_16x16x32_bf16 v[216:219], v[120:123], v[100:103], v[216:219]
    v_mfma_f32_16x16x32_bf16 v[220:223], v[124:127], v[100:103], v[220:223]
    s_add_u32 m0, s22, 32768
    s_nop 0
    buffer_load_dwordx4 v2, s[8:11], s18 offen lds
    s_add_u32 s18, s18, s20
    v_mfma_f32_16x16x32_bf16 v[224:227], v[112:115], v[104:107], v[224:227]
    v_mfma_f32_16x16x32_bf16 v[228:231], v[116:119], v[104:107], v[228:231]
    v_mfma_f32_16x16x32_bf16 v[232:235], v[120:123], v[104:107], v[232:235]
    s_add_u32 m0, s22, 40960
    s_nop 0
    buffer_load_dwordx4 v2, s[12:15], s19 offen lds
    s_add_u32 s19, s19, s20
    v_mfma_f32_16x16x32_bf16 v[236:239], v[124:127], v[104:107], v[236:239]
    v_mfma_f32_16x16x32_bf16 v[240:243], v[112:115], v[108:111], v[240:243]
    v_mfma_f32_16x16x32_bf16 v[244:247], v[116:119], v[108:111], v[244:247]
    v_mfma_f32_16x16x32_bf16 v[248:251], v[120:123], v[108:111], v[248:251]
    v_mfma_f32_16x16x32_bf16 v[252:255], v[124:127], v[108:111], v[252:255]
    s_waitcnt lgkmcnt(0)
    s_waitcnt vmcnt(16)
    s_barrier
    v_mfma_f32_16x16x32_bf16 v[128:131], v[64:67], v[32:35], v[128:131]
    ds_read_b64_tr_b16 v[112:113], v12 offset:49152
    v_mfma_f32_16x16x32_bf16 v[132:135], v[68:71], v[32:35], v[132:135]
    ds_read_b64_tr_b16 v[114:115], v13 offset:49152
    v_mfma_f32_16x16x32_bf16 v[136:139], v[72:75], v[32:35], v[136:139]
    ds_read_b64_tr_b16 v[116:117], v14 offset:49152
    v_mfma_f32_16x16x32_bf16 v[140:143], v[76:79], v[32:35], v[140:143]
    ds_read_b64_tr_b16 v[118:119], v15 offset:49152
    v_mfma_f32_16x16x32_bf16 v[144:147], v[64:67], v[36:39], v[144:147]
    ds_read_b64_tr_b16 v[120:121], v12 offset:57344
    v_mfma_f32_16x16x32_bf16 v[148:151], v[68:71], v[36:39], v[148:151]
    ds_read_b64_tr_b16 v[122:123], v13 offset:57344
    v_mfma_f32_16x16x32_bf16 v[152:155], v[72:75], v[36:39], v[152:155]
    ds_read_b64_tr_b16 v[124:125], v14 offset:57344
    v_mfma_f32_16x16x32_bf16 v[156:159], v[76:79], v[36:39], v[156:159]
    ds_read_b64_tr_b16 v[126:127], v15 offset:57344
    v_mfma_f32_16x16x32_bf16 v[160:163], v[64:67], v[40:43], v[160:163]
    ds_read_b128 v[80:83], v6 offset:32768
    v_mfma_f32_16x16x32_bf16 v[164:167], v[68:71], v[40:43], v[164:167]
    ds_read_b128 v[84:87], v6 offset:33792
    v_mfma_f32_16x16x32_bf16 v[168:171], v[72:75], v[40:43], v[168:171]
    ds_read_b128 v[88:91], v6 offset:34816
    v_mfma_f32_16x16x32_bf16 v[172:175], v[76:79], v[40:43], v[172:175]
    ds_read_b128 v[92:95], v6 offset:35840
    v_mfma_f32_16x16x32_bf16 v[176:179], v[64:67], v[44:47], v[176:179]
    ds_read_b128 v[96:99], v6 offset:36864
    v_mfma_f32_16x16x32_bf16 v[180:183], v[68:71], v[44:47], v[180:183]
    ds_read_b128 v[100:103], v6 offset:37888
    v_mfma_f32_16x16x32_bf16 v[184:187], v[72:75], v[44:47], v[184:187]
    ds_read_b128 v[104:107], v6 offset:38912
    v_mfma_f32_16x16x32_bf16 v[188:191], v[76:79], v[44:47], v[188:191]
    ds_read_b128 v[108:111], v6 offset:39936
    v_mfma_f32_16x16x32_bf16 v[192:195], v[64:67], v[48:51], v[192:195]
    v_mfma_f32_16x16x32_bf16 v[196:199], v[68:71], v[48:51], v[196:199]
    s_add_u32 m0, s21, 65536
    s_nop 0
    buffer_load_dwordx4 v1, s[4:7], s16 offen sc1 lds
    s_add_u32 s16, s16, s62
    v_mfma_f32_16x16x32_bf16 v[200:203], v[72:75], v[48:51], v[200:203]
    v_mfma_f32_16x16x32_bf16 v[204:207], v[76:79], v[48:51], v[204:207]
    v_mfma_f32_16x16x32_bf16 v[208:211], v[64:67], v[52:55], v[208:211]
    s_add_u32 m0, s21, 66560
    s_nop 0
    buffer_load_dwordx4 v1, s[4:7], s17 offen sc1 lds
    s_add_u32 s17, s17, s62
    v_mfma_f32_16x16x32_bf16 v[212:215], v[68:71], v[52:55], v[212:215]
    v_mfma_f32_16x16x32_bf16 v[216:219], v[72:75], v[52:55], v[216:219]
    v_mfma_f32_16x16x32_bf16 v[220:223], v[76:79], v[52:55], v[220:223]
    s_add_u32 m0, s22, 65536
    s_nop 0
    buffer_load_dwordx4 v2, s[8:11], s18 offen lds
    s_add_u32 s18, s18, s20
    v_mfma_f32_16x16x32_bf16 v[224:227], v[64:67], v[56:59], v[224:227]
    v_mfma_f32_16x16x32_bf16 v[228:231], v[68:71], v[56:59], v[228:231]
    v_mfma_f32_16x16x32_bf16 v[232:235], v[72:75], v[56:59], v[232:235]
    s_add_u32 m0, s22, 73728
    s_nop 0
    buffer_load_dwordx4 v2, s[12:15], s19 offen lds
    s_add_u32 s19, s19, s20
    v_mfma_f32_16x16x32_bf16 v[236:239], v[76:79], v[56:59], v[236:239]
    v_mfma_f32_16x16x32_bf16 v[240:243], v[64:67], v[60:63], v[240:243]
    v_mfma_f32_16x16x32_bf16 v[244:247], v[68:71], v[60:63], v[244:247]
    v_mfma_f32_16x16x32_bf16 v[248:251], v[72:75], v[60:63], v[248:251]
    v_mfma_f32_16x16x32_bf16 v[252:255], v[76:79], v[60:63], v[252:255]
    s_waitcnt lgkmcnt(0)
    s_waitcnt vmcnt(8)
    s_barrier
    s_cmp_eq_u32 s28, 0
    s_cbranch_scc1 sig_3
    s_cmp_lg_u32 s3, 0
    s_cbranch_scc1 sig_3
    s_mov_b64 exec, 1
    v_mov_b32 v18, s57
    buffer_atomic_add v18, v17, s[4:7], s28 offen sc1
    s_mov_b64 exec, -1
sig_3:
    s_mov_b32 s28, 0
    v_mfma_f32_16x16x32_bf16 v[128:131], v[112:115], v[80:83], v[128:131]
    ds_read_b64_tr_b16 v[64:65], v8 offset:16384
    v_mfma_f32_16x16x32_bf16 v[132:135], v[116:119], v[80:83], v[132:135]
    ds_read_b64_tr_b16 v[66:67], v9 offset:16384
    v_mfma_f32_16x16x32_bf16 v[136:139], v[120:123], v[80:83], v[136:139]
    ds_read_b64_tr_b16 v[68:69], v10 offset:16384
    v_mfma_f32_16x16x32_bf16 v[140:143], v[124:127], v[80:83], v[140:143]
    ds_read_b64_tr_b16 v[70:71], v11 offset:16384
    v_mfma_f32_16x16x32_bf16 v[144:147], v[112:115], v[84:87], v[144:147]
    ds_read_b64_tr_b16 v[72:73], v8 offset:24576
    v_mfma_f32_16x16x32_bf16 v[148:151], v[116:119], v[84:87], v[148:151]
    ds_read_b64_tr_b16 v[74:75], v9 offset:24576
    v_mfma_f32_16x16x32_bf16 v[152:155], v[120:123], v[84:87], v[152:155]
    ds_read_b64_tr_b16 v[76:77], v10 offset:24576
    v_mfma_f32_16x16x32_bf16 v[156:159], v[124:127], v[84:87], v[156:159]
    ds_read_b64_tr_b16 v[78:79], v11 offset:24576
    v_mfma_f32_16x16x32_bf16 v[160:163], v[112:115], v[88:91], v[160:163]
    ds_read_b128 v[32:35], v5 offset:0
    v_mfma_f32_16x16x32_bf16 v[164:167], v[116:119], v[88:91], v[164:167]
    ds_read_b128 v[36:39], v5 offset:1024
    v_mfma_f32_16x16x32_bf16 v[168:171], v[120:123], v[88:91], v[168:171]
    ds_read_b128 v[40:43], v5 offset:2048
    v_mfma_f32_16x16x32_bf16 v[172:175], v[124:127], v[88:91], v[172:175]
    ds_read_b128 v[44:47], v5 offset:3072
    v_mfma_f32_16x16x32_bf16 v[176:179], v[112:115], v[92:95], v[176:179]
    ds_read_b128 v[48:51], v5 offset:4096
    v_mfma_f32_16x16x32_bf16 v[180:183], v[116:119], v[92:95], v[180:183]
    ds_read_b128 v[52:55], v5 offset:5120
    v_mfma_f32_16x16x32_bf16 v[184:187], v[120:123], v[92:95], v[184:187]
    ds_read_b128 v[56:59], v5 offset:6144
    v_mfma_f32_16x16x32_bf16 v[188:191], v[124:127], v[92:95], v[188:191]
    ds_read_b128 v[60:63], v5 offset:7168
    v_mfma_f32_16x16x32_bf16 v[192:195], v[112:115], v[96:99], v[192:195]
    v_mfma_f32_16x16x32_bf16 v[196:199], v[116:119], v[96:99], v[196:199]
    s_add_u32 m0, s21, 98304
    s_nop 0
    buffer_load_dwordx4 v1, s[4:7], s16 offen sc1 lds
    s_add_u32 s16, s16, s62
    v_mfma_f32_16x16x32_bf16 v[200:203], v[120:123], v[96:99], v[200:203]
    v_mfma_f32_16x16x32_bf16 v[204:207], v[124:127], v[96:99], v[204:207]
    v_mfma_f32_16x16x32_bf16 v[208:211], v[112:115], v[100:103], v[208:211]
    s_add_u32 m0, s21, 99328
    s_nop 0
    buffer_load_dwordx4 v1, s[4:7], s17 offen sc1 lds
    s_add_u32 s17, s17, s62
    v_mfma_f32_16x16x32_bf16 v[212:215], v[116:119], v[100:103], v[212:215]
    v_mfma_f32_16x16x32_bf16 v[216:219], v[120:123], v[100:103], v[216:219]
    v_mfma_f32_16x16x32_bf16 v[220:223], v[124:127], v[100:103], v[220:223]
    s_add_u32 m0, s22, 98304
    s_nop 0
    buffer_load_dwordx4 v2, s[8:11], s18 offen lds
    s_add_u32 s18, s18, s20
    v_mfma_f32_16x16x32_bf16 v[224:227], v[112:115], v[104:107], v[224:227]
    v_mfma_f32_16x16x32_bf16 v[228:231], v[116:119], v[104:107], v[228:231]
    v_mfma_f32_16x16x32_bf16 v[232:235], v[120:123], v[104:107], v[232:235]
    s_add_u32 m0, s22, 106496
    s_nop 0
    buffer_load_dwordx4 v2, s[12:15], s19 offen lds
    s_add_u32 s19, s19, s20
    v_mfma_f32_16x16x32_bf16 v[236:239], v[124:127], v[104:107], v[236:239]
    v_mfma_f32_16x16x32_bf16 v[240:243], v[112:115], v[108:111], v[240:243]
    v_mfma_f32_16x16x32_bf16 v[244:247], v[116:119], v[108:111], v[244:247]
    v_mfma_f32_16x16x32_bf16 v[248:251], v[120:123], v[108:111], v[248:251]
    v_mfma_f32_16x16x32_bf16 v[252:255], v[124:127], v[108:111], v[252:255]
    s_waitcnt lgkmcnt(0)
    s_branch w_loop_chk
w_first16:
    s_waitcnt vmcnt(24)
    s_barrier
    v_mfma_f32_16x16x32_bf16 v[128:131], v[64:67], v[32:35], 0
    ds_read_b64_tr_b16 v[112:113], v8 offset:49152
    v_mfma_f32_16x16x32_bf16 v[132:135], v[68:71], v[32:35], 0
    ds_read_b64_tr_b16 v[114:115], v9 offset:49152
    v_mfma_f32_16x16x32_bf16 v[136:139], v[72:75], v[32:35], 0
    ds_read_b64_tr_b16 v[116:117], v10 offset:49152
    v_mfma_f32_16x16x32_bf16 v[140:143], v[76:79], v[32:35], 0
    ds_read_b64_tr_b16 v[118:119], v11 offset:49152
    v_mfma_f32_16x16x32_bf16 v[144:147], v[64:67], v[36:39], 0
    ds_read_b64_tr_b16 v[120:121], v8 offset:57344
    v_mfma_f32_16x16x32_bf16 v[148:151], v[68:71], v[36:39], 0
    ds_read_b64_tr_b16 v[122:123], v9 offset:57344
    v_mfma_f32_16x16x32_bf16 v[152:155], v[72:75], v[36:39], 0
    ds_read_b64_tr_b16 v[124:125], v10 offset:57344
    v_mfma_f32_16x16x32_bf16 v[156:159], v[76:79], v[36:39], 0
    ds_read_b64_tr_b16 v[126:127], v11 offset:57344
    v_mfma_f32_16x16x32_bf16 v[160:163], v[64:67], v[40:43], 0
    ds_read_b128 v[80:83], v5 offset:32768
    v_mfma_f32_16x16x32_bf16 v[164:167], v[68:71], v[40:43], 0
    ds_read_b128 v[84:87], v5 offset:33792
    v_mfma_f32_16x16x32_bf16 v[168:171], v[72:75], v[40:43], 0
    ds_read_b128 v[88:91], v5 offset:34816
    v_mfma_f32_16x16x32_bf16 v[172:175], v[76:79], v[40:43], 0
    ds_read_b128 v[92:95], v5 offset:35840
    v_mfma_f32_16x16x32_bf16 v[176:179], v[64:67], v[44:47], 0
    ds_read_b128 v[96:99], v5 offset:36864
    v_mfma_f32_16x16x32_bf16 v[180:183], v[68:71], v[44:47], 0
    ds_read_b128 v[100:103], v5 offset:37888
    v_mfma_f32_16x16x32_bf16 v[184:187], v[72:75], v[44:47], 0
    ds_read_b128 v[104:107], v5 offset:38912
    v_mfma_f32_16x16x32_bf16 v[188:191], v[76:79], v[44:47], 0
    ds_read_b128 v[108:111], v5 offset:39936
    v_mfma_f32_16x16x32_bf16 v[192:195], v[64:67], v[48:51], 0
    v_mfma_f32_16x16x32_bf16 v[196:199], v[68:71], v[48:51], 0
    s_add_u32 m0, s21, 0
    s_nop 0
    buffer_load_dwordx4 v1, s[4:7], s16 offen sc1 lds
    s_add_u32 s16, s16, s62
    v_mfma_f32_16x16x32_bf16 v[200:203], v[72:75], v[48:51], 0
    v_mfma_f32_16x16x32_bf16 v[204:207], v[76:79], v[48:51], 0
    v_mfma_f32_16x16x32_bf16 v[208:211], v[64:67], v[52:55], 0
    s_add_u32 m0, s21, 1024
    s_nop 0
    buffer_load_dwordx4 v1, s[4:7], s17 offen sc1 lds
    s_add_u32 s17, s17, s62
    v_mfma_f32_16x16x32_bf16 v[212:215], v[68:71], v[52:55], 0
    v_mfma_f32_16x16x32_bf16 v[216:219], v[72:75], v[52:55], 0
    v_mfma_f32_16x16x32_bf16 v[220:223], v[76:79], v[52:55], 0
    s_add_u32 m0, s22, 0
    s_nop 0
    buffer_load_dwordx4 v2, s[8:11], s18 offen lds
    s_add_u32 s18, s18, s20
    v_mfma_f32_16x16x32_bf16 v[224:227], v[64:67], v[56:59], 0
    v_mfma_f32_16x16x32_bf16 v[228:231], v[68:71], v[56:59], 0
    v_mfma_f32_16x16x32_bf16 v[232:235], v[72:75], v[56:59], 0
    s_add_u32 m0, s22, 8192
    s_nop 0
    buffer_load_dwordx4 v2, s[12:15], s19 offen lds
    s_add_u32 s19, s19, s20
    v_mfma_f32_16x16x32_bf16 v[236:239], v[76:79], v[56:59], 0
    v_mfma_f32_16x16x32_bf16 v[240:243], v[64:67], v[60:63], 0
    v_mfma_f32_16x16x32_bf16 v[244:247], v[68:71], v[60:63], 0
    v_mfma_f32_16x16x32_bf16 v[248:251], v[72:75], v[60:63], 0
    v_mfma_f32_16x16x32_bf16 v[252:255], v[76:79], v[60:63], 0
    s_waitcnt lgkmcnt(0)
    s_waitcnt vmcnt(24)
    s_barrier
    v_mfma_f32_16x16x32_bf16 v[128:131], v[112:115], v[80:83], v[128:131]
    ds_read_b64_tr_b16 v[64:65], v12 offset:16384
    v_mfma_f32_16x16x32_bf16 v[132:135], v[116:119], v[80:83], v[132:135]
    ds_read_b64_tr_b16 v[66:67], v13 offset:16384
    v_mfma_f32_16x16x32_bf16 v[136:139], v[120:123], v[80:83], v[136:139]
    ds_read_b64_tr_b16 v[68:69], v14 offset:16384
    v_mfma_f32_16x16x32_bf16 v[140:143], v[124:127], v[80:83], v[140:143]
    ds_read_b64_tr_b16 v[70:71], v15 offset:16384
    v_mfma_f32_16x16x32_bf16 v[144:147], v[112:115], v[84:87], v[144:147]
    ds_read_b64_tr_b16 v[72:73], v12 offset:24576
    v_mfma_f32_16x16x32_bf16 v[148:151], v[116:119], v[84:87], v[148:151]
    ds_read_b64_tr_b16 v[74:75], v13 offset:24576
    v_mfma_f32_16x16x32_bf16 v[152:155], v[120:123], v[84:87], v[152:155]
    ds_read_b64_tr_b16 v[76:77], v14 offset:24576
    v_mfma_f32_16x16x32_bf16 v[156:159], v[124:127], v[84:87], v[156:159]
    ds_read_b64_tr_b16 v[78:79], v15 offset:24576
    v_mfma_f32_16x16x32_bf16 v[160:163], v[112:115], v[88:91], v[160:163]
    ds_read_b128 v[32:35], v6 offset:0
    v_mfma_f32_16x16x32_bf16 v[164:167], v[116:119], v[88:91], v[164:167]
    ds_read_b128 v[36:39], v6 offset:1024
    v_mfma_f32_16x16x32_bf16 v[168:171], v[120:123], v[88:91], v[168:171]
    ds_read_b128 v[40:43], v6 offset:2048
    v_mfma_f32_16x16x32_bf16 v[172:175], v[124:127], v[88:91], v[172:175]
    ds_read_b128 v[44:47], v6 offset:3072
    v_mfma_f32_16x16x32_bf16 v[176:179], v[112:115], v[92:95], v[176:179]
    ds_read_b128 v[48:51], v6 offset:4096
    v_mfma_f32_16x16x32_bf16 v[180:183], v[116:119], v[92:95], v[180:183]
    ds_read_b128 v[52:55], v6 offset:5120
    v_mfma_f32_16x16x32_bf16 v[184:187], v[120:123], v[92:95], v[184:187]
    ds_read_b128 v[56:59], v6 offset:6144
    v_mfma_f32_16x16x32_bf16 v[188:191], v[124:127], v[92:95], v[188:191]
    ds_read_b128 v[60:63], v6 offset:7168
    v_mfma_f32_16x16x32_bf16 v[192:195], v[112:115], v[96:99], v[192:195]
    v_mfma_f32_16x16x32_bf16 v[196:199], v[116:119], v[96:99], v[196:199]
    s_add_u32 m0, s21, 32768
    s_nop 0
    buffer_load_dwordx4 v1, s[4:7], s16 offen sc1 lds
    s_add_u32 s16, s16, s62
    v_mfma_f32_16x16x32_bf16 v[200:203], v[120:123], v[96:99], v[200:203]
    v_mfma_f32_16x16x32_bf16 v[204:207], v[124:127], v[96:99], v[204:207]
    v_mfma_f32_16x16x32_bf16 v[208:211], v[112:115], v[100:103], v[208:211]
    s_add_u32 m0, s21, 33792
    s_nop 0
    buffer_load_dwordx4 v1, s[4:7], s17 offen sc1 lds
    s_add_u32 s17, s17, s62
    v_mfma_f32_16x16x32_bf16 v[212:215], v[116:119], v[100:103], v[212:215]
    v_mfma_f32_16x16x32_bf16 v[216:219], v[120:123], v[100:103], v[216:219]
    v_mfma_f32_16x16x32_bf16 v[220:223], v[124:127], v[100:103], v[220:223]
    s_add_u32 m0, s22, 32768
    s_nop 0
    buffer_load_dwordx4 v2, s[8:11], s18 offen lds
    s_add_u32 s18, s18, s20
    v_mfma_f32_16x16x32_bf16 v[224:227], v[112:115], v[104:107], v[224:227]
    v_mfma_f32_16x16x32_bf16 v[228:231], v[116:119], v[104:107], v[228:231]
    v_mfma_f32_16x16x32_bf16 v[232:235], v[120:123], v[104:107], v[232:235]
    s_add_u32 m0, s22, 40960
    s_nop 0
    buffer_load_dwordx4 v2, s[12:15], s19 offen lds
    s_add_u32 s19, s19, s20
    v_mfma_f32_16x16x32_bf16 v[236:239], v[124:127], v[104:107], v[236:239]
    v_mfma_f32_16x16x32_bf16 v[240:243], v[112:115], v[108:111], v[240:243]
    v_mfma_f32_16x16x32_bf16 v[244:247], v[116:119], v[108:111], v[244:247]
    v_mfma_f32_16x16x32_bf16 v[248:251], v[120:123], v[108:111], v[248:251]
    v_mfma_f32_16x16x32_bf16 v[252:255], v[124:127], v[108:111], v[252:255]
    s_waitcnt lgkmcnt(0)
    s_waitcnt vmcnt(24)
    s_barrier
    v_mfma_f32_16x16x32_bf16 v[128:131], v[64:67], v[32:35], v[128:131]
    ds_read_b64_tr_b16 v[112:113], v12 offset:49152
    v_mfma_f32_16x16x32_bf16 v[132:135], v[68:71], v[32:35], v[132:135]
    ds_read_b64_tr_b16 v[114:115], v13 offset:49152
    v_mfma_f32_16x16x32_bf16 v[136:139], v[72:75], v[32:35], v[136:139]
    ds_read_b64_tr_b16 v[116:117], v14 offset:49152
    v_mfma_f32_16x16x32_bf16 v[140:143], v[76:79], v[32:35], v[140:143]
    ds_read_b64_tr_b16 v[118:119], v15 offset:49152
    v_mfma_f32_16x16x32_bf16 v[144:147], v[64:67], v[36:39], v[144:147]
    ds_read_b64_tr_b16 v[120:121], v12 offset:57344
    v_mfma_f32_16x16x32_bf16 v[148:151], v[68:71], v[36:39], v[148:151]
    ds_read_b64_tr_b16 v[122:123], v13 offset:57344
    v_mfma_f32_16x16x32_bf16 v[152:155], v[72:75], v[36:39], v[152:155]
    ds_read_b64_tr_b16 v[124:125], v14 offset:57344
    v_mfma_f32_16x16x32_bf16 v[156:159], v[76:79], v[36:39], v[156:159]
    ds_read_b64_tr_b16 v[126:127], v15 offset:57344
    v_mfma_f32_16x16x32_bf16 v[160:163], v[64:67], v[40:43], v[160:163]
    ds_read_b128 v[80:83], v6 offset:32768
    v_mfma_f32_16x16x32_bf16 v[164:167], v[68:71], v[40:43], v[164:167]
    ds_read_b128 v[84:87], v6 offset:33792
    v_mfma_f32_16x16x32_bf16 v[168:171], v[72:75], v[40:43], v[168:171]
    ds_read_b128 v[88:91], v6 offset:34816
    v_mfma_f32_16x16x32_bf16 v[172:175], v[76:79], v[40:43], v[172:175]
    ds_read_b128 v[92:95], v6 offset:35840
    v_mfma_f32_16x16x32_bf16 v[176:179], v[64:67], v[44:47], v[176:179]
    ds_read_b128 v[96:99], v6 offset:36864
    v_mfma_f32_16x16x32_bf16 v[180:183], v[68:71], v[44:47], v[180:183]
    ds_read_b128 v[100:103], v6 offset:37888
    v_mfma_f32_16x16x32_bf16 v[184:187], v[72:75], v[44:47], v[184:187]
    ds_read_b128 v[104:107], v6 offset:38912
    v_mfma_f32_16x16x32_bf16 v[188:191], v[76:79], v[44:47], v[188:191]
    ds_read_b128 v[108:111], v6 offset:39936
    v_mfma_f32_16x16x32_bf16 v[192:195], v[64:67], v[48:51], v[192:195]
    v_mfma_f32_16x16x32_bf16 v[196:199], v[68:71], v[48:51], v[196:199]
    s_add_u32 m0, s21, 65536
    s_nop 0
    buffer_load_dwordx4 v1, s[4:7], s16 offen sc1 lds
    s_add_u32 s16, s16, s62
    v_mfma_f32_16x16x32_bf16 v[200:203], v[72:75], v[48:51], v[200:203]
    v_mfma_f32_16x16x32_bf16 v[204:207], v[76:79], v[48:51], v[204:207]
    v_mfma_f32_16x16x32_bf16 v[208:211], v[64:67], v[52:55], v[208:211]
    s_add_u32 m0, s21, 66560
    s_nop 0
    buffer_load_dwordx4 v1, s[4:7], s17 offen sc1 lds
    s_add_u32 s17, s17, s62
    v_mfma_f32_16x16x32_bf16 v[212:215], v[68:71], v[52:55], v[212:215]
    v_mfma_f32_16x16x32_bf16 v[216:219], v[72:75], v[52:55], v[216:219]
    v_mfma_f32_16x16x32_bf16 v[220:223], v[76:79], v[52:55], v[220:223]
    s_add_u32 m0, s22, 65536
    s_nop 0
    buffer_load_dwordx4 v2, s[8:11], s18 offen lds
    s_add_u32 s18, s18, s20
    v_mfma_f32_16x16x32_bf16 v[224:227], v[64:67], v[56:59], v[224:227]
    v_mfma_f32_16x16x32_bf16 v[228:231], v[68:71], v[56:59], v[228:231]
    v_mfma_f32_16x16x32_bf16 v[232:235], v[72:75], v[56:59], v[232:235]
    s_add_u32 m0, s22, 73728
    s_nop 0
    buffer_load_dwordx4 v2, s[12:15], s19 offen lds
    s_add_u32 s19, s19, s20
    v_mfma_f32_16x16x32_bf16 v[236:239], v[76:79], v[56:59], v[236:239]
    v_mfma_f32_16x16x32_bf16 v[240:243], v[64:67], v[60:63], v[240:243]
    v_mfma_f32_16x16x32_bf16 v[244:247], v[68:71], v[60:63], v[244:247]
    v_mfma_f32_16x16x32_bf16 v[248:251], v[72:75], v[60:63], v[248:251]
    v_mfma_f32_16x16x32_bf16 v[252:255], v[76:79], v[60:63], v[252:255]
    s_waitcnt lgkmcnt(0)
    s_waitcnt vmcnt(8)
    s_barrier
    s_cmp_eq_u32 s28, 0
    s_cbranch_scc1 sig_4
    s_cmp_lg_u32 s3, 0
    s_cbranch_scc1 sig_4
    s_mov_b64 exec, 1
    v_mov_b32 v18, s57
    buffer_atomic_add v18, v17, s[4:7], s28 offen sc1
    s_mov_b64 exec, -1
sig_4:
    s_mov_b32 s28, 0
    v_mfma_f32_16x16x32_bf16 v[128:131], v[112:115], v[80:83], v[128:131]
    ds_read_b64_tr_b16 v[64:65], v8 offset:16384
    v_mfma_f32_16x16x32_bf16 v[132:135], v[116:119], v[80:83], v[132:135]
    ds_read_b64_tr_b16 v[66:67], v9 offset:16384
    v_mfma_f32_16x16x32_bf16 v[136:139], v[120:123], v[80:83], v[136:139]
    ds_read_b64_tr_b16 v[68:69], v10 offset:16384
    v_mfma_f32_16x16x32_bf16 v[140:143], v[124:127], v[80:83], v[140:143]
    ds_read_b64_tr_b16 v[70:71], v11 offset:16384
    v_mfma_f32_16x16x32_bf16 v[144:147], v[112:115], v[84:87], v[144:147]
    ds_read_b64_tr_b16 v[72:73], v8 offset:24576
    v_mfma_f32_16x16x32_bf16 v[148:151], v[116:119], v[84:87], v[148:151]
    ds_read_b64_tr_b16 v[74:75], v9 offset:24576
    v_mfma_f32_16x16x32_bf16 v[152:155], v[120:123], v[84:87], v[152:155]
    ds_read_b64_tr_b16 v[76:77], v10 offset:24576
    v_mfma_f32_16x16x32_bf16 v[156:159], v[124:127], v[84:87], v[156:159]
    ds_read_b64_tr_b16 v[78:79], v11 offset:24576
    v_mfma_f32_16x16x32_bf16 v[160:163], v[112:115], v[88:91], v[160:163]
    ds_read_b128 v[32:35], v5 offset:0
    v_mfma_f32_16x16x32_bf16 v[164:167], v[116:119], v[88:91], v[164:167]
    ds_read_b128 v[36:39], v5 offset:1024
    v_mfma_f32_16x16x32_bf16 v[168:171], v[120:123], v[88:91], v[168:171]
    ds_read_b128 v[40:43], v5 offset:2048
    v_mfma_f32_16x16x32_bf16 v[172:175], v[124:127], v[88:91], v[172:175]
    ds_read_b128 v[44:47], v5 offset:3072
    v_mfma_f32_16x16x32_bf16 v[176:179], v[112:115], v[92:95], v[176:179]
    ds_read_b128 v[48:51], v5 offset:4096
    v_mfma_f32_16x16x32_bf16 v[180:183], v[116:119], v[92:95], v[180:183]
    ds_read_b128 v[52:55], v5 offset:5120
    v_mfma_f32_16x16x32_bf16 v[184:187], v[120:123], v[92:95], v[184:187]
    ds_read_b128 v[56:59], v5 offset:6144
    v_mfma_f32_16x16x32_bf16 v[188:191], v[124:127], v[92:95], v[188:191]
    ds_read_b128 v[60:63], v5 offset:7168
    v_mfma_f32_16x16x32_bf16 v[192:195], v[112:115], v[96:99], v[192:195]
    v_mfma_f32_16x16x32_bf16 v[196:199], v[116:119], v[96:99], v[196:199]
    s_add_u32 m0, s21, 98304
    s_nop 0
    buffer_load_dwordx4 v1, s[4:7], s16 offen sc1 lds
    s_add_u32 s16, s16, s62
    v_mfma_f32_16x16x32_bf16 v[200:203], v[120:123], v[96:99], v[200:203]
    v_mfma_f32_16x16x32_bf16 v[204:207], v[124:127], v[96:99], v[204:207]
    v_mfma_f32_16x16x32_bf16 v[208:211], v[112:115], v[100:103], v[208:211]
    s_add_u32 m0, s21, 99328
    s_nop 0
    buffer_load_dwordx4 v1, s[4:7], s17 offen sc1 lds
    s_add_u32 s17, s17, s62
    v_mfma_f32_16x16x32_bf16 v[212:215], v[116:119], v[100:103], v[212:215]
    v_mfma_f32_16x16x32_bf16 v[216:219], v[120:123], v[100:103], v[216:219]
    v_mfma_f32_16x16x32_bf16 v[220:223], v[124:127], v[100:103], v[220:223]
    s_add_u32 m0, s22, 98304
    s_nop 0
    buffer_load_dwordx4 v2, s[8:11], s18 offen lds
    s_add_u32 s18, s18, s20
    v_mfma_f32_16x16x32_bf16 v[224:227], v[112:115], v[104:107], v[224:227]
    v_mfma_f32_16x16x32_bf16 v[228:231], v[116:119], v[104:107], v[228:231]
    v_mfma_f32_16x16x32_bf16 v[232:235], v[120:123], v[104:107], v[232:235]
    s_add_u32 m0, s22, 106496
    s_nop 0
    buffer_load_dwordx4 v2, s[12:15], s19 offen lds
    s_add_u32 s19, s19, s20
    v_mfma_f32_16x16x32_bf16 v[236:239], v[124:127], v[104:107], v[236:239]
    v_mfma_f32_16x16x32_bf16 v[240:243], v[112:115], v[108:111], v[240:243]
    v_mfma_f32_16x16x32_bf16 v[244:247], v[116:119], v[108:111], v[244:247]
    v_mfma_f32_16x16x32_bf16 v[248:251], v[120:123], v[108:111], v[248:251]
    v_mfma_f32_16x16x32_bf16 v[252:255], v[124:127], v[108:111], v[252:255]
    s_waitcnt lgkmcnt(0)
w_loop_chk:
    s_sub_u32 s23, s23, 1
w_loop:
    s_cmp_lg_u32 s23, 1
    s_cbranch_scc1 w_body
    v_readfirstlane_b32 s30, v16
    s_cmp_ge_u32 s30, s45
    s_cselect_b32 s30, 0, 1
    s_or_b32 s30, s30, s70
    s_cmp_ge_u32 s32, 4
    s_cselect_b32 s30, 1, s30
    s_cmp_eq_u32 s32, 0
    s_cselect_b32 s30, 1, s30
    v_mov_b32 v20, s30
    ds_write_b32 v7, v20
    s_cbranch_scc1 w_body
    s_load_dwordx2 s[8:9], s[0:1], s33
    s_load_dwordx2 s[12:13], s[0:1], s34
    s_mov_b32 s10, s38
    s_mov_b32 s14, s38
    s_cmp_ge_u32 s32, 4
    s_cselect_b32 s31, 0, 1
    s_lshl_b32 s30, s3, s31
    s_mul_i32 s30, s30, s40
    s_add_u32 s16, s39, s30
    s_cmp_eq_u32 s32, 4
    s_cselect_b32 s30, 1024, s40
    s_cselect_b32 s31, 6, 5
    s_lshl_b32 s62, 32, s31
    s_add_u32 s17, s16, s30
    s_lshl_b32 s30, s3, 2
    s_mul_i32 s30, s30, s35
    s_add_u32 s18, s36, s30
    s_add_u32 s19, s37, s30
    s_lshl_b32 s20, s35, s31
    v_mul_u32_u24 v2, s35, v4
    v_add_u32 v2, v2, v3
    s_waitcnt lgkmcnt(0)
w_body:
    s_waitcnt vmcnt(8)
    s_barrier
    v_mfma_f32_16x16x32_bf16 v[128:131], v[64:67], v[32:35], v[128:131]
    ds_read_b64_tr_b16 v[112:113], v8 offset:49152
    v_mfma_f32_16x16x32_bf16 v[132:135], v[68:71], v[32:35], v[132:135]
    ds_read_b64_tr_b16 v[114:115], v9 offset:49152
    v_mfma_f32_16x16x32_bf16 v[136:139], v[72:75], v[32:35], v[136:139]
    ds_read_b64_tr_b16 v[116:117], v10 offset:49152
    v_mfma_f32_16x16x32_bf16 v[140:143], v[76:79], v[32:35], v[140:143]
    ds_read_b64_tr_b16 v[118:119], v11 offset:49152
    v_mfma_f32_16x16x32_bf16 v[144:147], v[64:67], v[36:39], v[144:147]
    ds_read_b64_tr_b16 v[120:121], v8 offset:57344
    v_mfma_f32_16x16x32_bf16 v[148:151], v[68:71], v[36:39], v[148:151]
    ds_read_b64_tr_b16 v[122:123], v9 offset:57344
    v_mfma_f32_16x16x32_bf16 v[152:155], v[72:75], v[36:39], v[152:155]
    ds_read_b64_tr_b16 v[124:125], v10 offset:57344
    v_mfma_f32_16x16x32_bf16 v[156:159], v[76:79], v[36:39], v[156:159]
    ds_read_b64_tr_b16 v[126:127], v11 offset:57344
    v_mfma_f32_16x16x32_bf16 v[160:163], v[64:67], v[40:43], v[160:163]
    ds_read_b128 v[80:83], v5 offset:32768
    v_mfma_f32_16x16x32_bf16 v[164:167], v[68:71], v[40:43], v[164:167]
    ds_read_b128 v[84:87], v5 offset:33792
    v_mfma_f32_16x16x32_bf16 v[168:171], v[72:75], v[40:43], v[168:171]
    ds_read_b128 v[88:91], v5 offset:34816
    v_mfma_f32_16x16x32_bf16 v[172:175], v[76:79], v[40:43], v[172:175]
    ds_read_b128 v[92:95], v5 offset:35840
    v_mfma_f32_16x16x32_bf16 v[176:179], v[64:67], v[44:47], v[176:179]
    ds_read_b128 v[96:99], v5 offset:36864
    v_mfma_f32_16x16x32_bf16 v[180:183], v[68:71], v[44:47], v[180:183]
    ds_read_b128 v[100:103], v5 offset:37888
    v_mfma_f32_16x16x32_bf16 v[184:187], v[72:75], v[44:47], v[184:187]
    ds_read_b128 v[104:107], v5 offset:38912
    v_mfma_f32_16x16x32_bf16 v[188:191], v[76:79], v[44:47], v[188:191]
    ds_read_b128 v[108:111], v5 offset:39936
    v_mfma_f32_16x16x32_bf16 v[192:195], v[64:67], v[48:51], v[192:195]
    v_mfma_f32_16x16x32_bf16 v[196:199], v[68:71], v[48:51], v[196:199]
    s_add_u32 m0, s21, 0
    s_nop 0
    buffer_load_dwordx4 v1, s[4:7], s16 offen sc1 lds
    s_add_u32 s16, s16, s62
    v_mfma_f32_16x16x32_bf16 v[200:203], v[72:75], v[48:51], v[200:203]
    v_mfma_f32_16x16x32_bf16 v[204:207], v[76:79], v[48:51], v[204:207]
    v_mfma_f32_16x16x32_bf16 v[208:211], v[64:67], v[52:55], v[208:211]
    s_add_u32 m0, s21, 1024
    s_nop 0
    buffer_load_dwordx4 v1, s[4:7], s17 offen sc1 lds
    s_add_u32 s17, s17, s62
    v_mfma_f32_16x16x32_bf16 v[212:215], v[68:71], v[52:55], v[212:215]
    v_mfma_f32_16x16x32_bf16 v[216:219], v[72:75], v[52:55], v[216:219]
    v_mfma_f32_16x16x32_bf16 v[220:223], v[76:79], v[52:55], v[220:223]
    s_add_u32 m0, s22, 0
    s_nop 0
    buffer_load_dwordx4 v2, s[8:11], s18 offen lds
    s_add_u32 s18, s18, s20
    v_mfma_f32_16x16x32_bf16 v[224:227], v[64:67], v[56:59], v[224:227]
    v_mfma_f32_16x16x32_bf16 v[228:231], v[68:71], v[56:59], v[228:231]
    v_mfma_f32_16x16x32_bf16 v[232:235], v[72:75], v[56:59], v[232:235]
    s_add_u32 m0, s22, 8192
    s_nop 0
    buffer_load_dwordx4 v2, s[12:15], s19 offen lds
    s_add_u32 s19, s19, s20
    v_mfma_f32_16x16x32_bf16 v[236:239], v[76:79], v[56:59], v[236:239]
    v_mfma_f32_16x16x32_bf16 v[240:243], v[64:67], v[60:63], v[240:243]
    v_mfma_f32_16x16x32_bf16 v[244:247], v[68:71], v[60:63], v[244:247]
    buffer_load_dword v16, v17, s[4:7], s44 offen sc1
    v_mfma_f32_16x16x32_bf16 v[248:251], v[72:75], v[60:63], v[248:251]
    v_mfma_f32_16x16x32_bf16 v[252:255], v[76:79], v[60:63], v[252:255]
    s_waitcnt lgkmcnt(0)
    s_waitcnt vmcnt(8)
    s_barrier
    v_mfma_f32_16x16x32_bf16 v[128:131], v[112:115], v[80:83], v[128:131]
    ds_read_b64_tr_b16 v[64:65], v12 offset:16384
    v_mfma_f32_16x16x32_bf16 v[132:135], v[116:119], v[80:83], v[132:135]
    ds_read_b64_tr_b16 v[66:67], v13 offset:16384
    v_mfma_f32_16x16x32_bf16 v[136:139], v[120:123], v[80:83], v[136:139]
    ds_read_b64_tr_b16 v[68:69], v14 offset:16384
    v_mfma_f32_16x16x32_bf16 v[140:143], v[124:127], v[80:83], v[140:143]
    ds_read_b64_tr_b16 v[70:71], v15 offset:16384
    v_mfma_f32_16x16x32_bf16 v[144:147], v[112:115], v[84:87], v[144:147]
    ds_read_b64_tr_b16 v[72:73], v12 offset:24576
    v_mfma_f32_16x16x32_bf16 v[148:151], v[116:119], v[84:87], v[148:151]
    ds_read_b64_tr_b16 v[74:75], v13 offset:24576
    v_mfma_f32_16x16x32_bf16 v[152:155], v[120:123], v[84:87], v[152:155]
    ds_read_b64_tr_b16 v[76:77], v14 offset:24576
    v_mfma_f32_16x16x32_bf16 v[156:159], v[124:127], v[84:87], v[156:159]
    ds_read_b64_tr_b16 v[78:79], v15 offset:24576
    v_mfma_f32_16x16x32_bf16 v[160:163], v[112:115], v[88:91], v[160:163]
    ds_read_b128 v[32:35], v6 offset:0
    v_mfma_f32_16x16x32_bf16 v[164:167], v[116:119], v[88:91], v[164:167]
    ds_read_b128 v[36:39], v6 offset:1024
    v_mfma_f32_16x16x32_bf16 v[168:171], v[120:123], v[88:91], v[168:171]
    ds_read_b128 v[40:43], v6 offset:2048
    v_mfma_f32_16x16x32_bf16 v[172:175], v[124:127], v[88:91], v[172:175]
    ds_read_b128 v[44:47], v6 offset:3072
    v_mfma_f32_16x16x32_bf16 v[176:179], v[112:115], v[92:95], v[176:179]
    ds_read_b128 v[48:51], v6 offset:4096
    v_mfma_f32_16x16x32_bf16 v[180:183], v[116:119], v[92:95], v[180:183]
    ds_read_b128 v[52:55], v6 offset:5120
    v_mfma_f32_16x16x32_bf16 v[184:187], v[120:123], v[92:95], v[184:187]
    ds_read_b128 v[56:59], v6 offset:6144
    v_mfma_f32_16x16x32_bf16 v[188:191], v[124:127], v[92:95], v[188:191]
    ds_read_b128 v[60:63], v6 offset:7168
    v_mfma_f32_16x16x32_bf16 v[192:195], v[112:115], v[96:99], v[192:195]
    v_mfma_f32_16x16x32_bf16 v[196:199], v[116:119], v[96:99], v[196:199]
    s_add_u32 m0, s21, 32768
    s_nop 0
    buffer_load_dwordx4 v1, s[4:7], s16 offen sc1 lds
    s_add_u32 s16, s16, s62
    v_mfma_f32_16x16x32_bf16 v[200:203], v[120:123], v[96:99], v[200:203]
    v_mfma_f32_16x16x32_bf16 v[204:207], v[124:127], v[96:99], v[204:207]
    v_mfma_f32_16x16x32_bf16 v[208:211], v[112:115], v[100:103], v[208:211]
    s_add_u32 m0, s21, 33792
    s_nop 0
    buffer_load_dwordx4 v1, s[4:7], s17 offen sc1 lds
    s_add_u32 s17, s17, s62
    v_mfma_f32_16x16x32_bf16 v[212:215], v[116:119], v[100:103], v[212:215]
    v_mfma_f32_16x16x32_bf16 v[216:219], v[120:123], v[100:103], v[216:219]
    v_mfma_f32_16x16x32_bf16 v[220:223], v[124:127], v[100:103], v[220:223]
    s_add_u32 m0, s22, 32768
    s_nop 0
    buffer_load_dwordx4 v2, s[8:11], s18 offen lds
    s_add_u32 s18, s18, s20
    v_mfma_f32_16x16x32_bf16 v[224:227], v[112:115], v[104:107], v[224:227]
    v_mfma_f32_16x16x32_bf16 v[228:231], v[116:119], v[104:107], v[228:231]
    v_mfma_f32_16x16x32_bf16 v[232:235], v[120:123], v[104:107], v[232:235]
    s_add_u32 m0, s22, 40960
    s_nop 0
    buffer_load_dwordx4 v2, s[12:15], s19 offen lds
    s_add_u32 s19, s19, s20
    v_mfma_f32_16x16x32_bf16 v[236:239], v[124:127], v[104:107], v[236:239]
    v_mfma_f32_16x16x32_bf16 v[240:243], v[112:115], v[108:111], v[240:243]
    v_mfma_f32_16x16x32_bf16 v[244:247], v[116:119], v[108:111], v[244:247]
    v_mfma_f32_16x16x32_bf16 v[248:251], v[120:123], v[108:111], v[248:251]
    v_mfma_f32_16x16x32_bf16 v[252:255], v[124:127], v[108:111], v[252:255]
    s_waitcnt lgkmcnt(0)
    s_waitcnt vmcnt(8)
    s_barrier
    v_mfma_f32_16x16x32_bf16 v[128:131], v[64:67], v[32:35], v[128:131]
    ds_read_b64_tr_b16 v[112:113], v12 offset:49152
    v_mfma_f32_16x16x32_bf16 v[132:135], v[68:71], v[32:35], v[132:135]
    ds_read_b64_tr_b16 v[114:115], v13 offset:49152
    v_mfma_f32_16x16x32_bf16 v[136:139], v[72:75], v[32:35], v[136:139]
    ds_read_b64_tr_b16 v[116:117], v14 offset:49152
    v_mfma_f32_16x16x32_bf16 v[140:143], v[76:79], v[32:35], v[140:143]
    ds_read_b64_tr_b16 v[118:119], v15 offset:49152
    v_mfma_f32_16x16x32_bf16 v[144:147], v[64:67], v[36:39], v[144:147]
    ds_read_b64_tr_b16 v[120:121], v12 offset:57344
    v_mfma_f32_16x16x32_bf16 v[148:151], v[68:71], v[36:39], v[148:151]
    ds_read_b64_tr_b16 v[122:123], v13 offset:57344
    v_mfma_f32_16x16x32_bf16 v[152:155], v[72:75], v[36:39], v[152:155]
    ds_read_b64_tr_b16 v[124:125], v14 offset:57344
    v_mfma_f32_16x16x32_bf16 v[156:159], v[76:79], v[36:39], v[156:159]
    ds_read_b64_tr_b16 v[126:127], v15 offset:57344
    v_mfma_f32_16x16x32_bf16 v[160:163], v[64:67], v[40:43], v[160:163]
    ds_read_b128 v[80:83], v6 offset:32768
    v_mfma_f32_16x16x32_bf16 v[164:167], v[68:71], v[40:43], v[164:167]
    ds_read_b128 v[84:87], v6 offset:33792
    v_mfma_f32_16x16x32_bf16 v[168:171], v[72:75], v[40:43], v[168:171]
    ds_read_b128 v[88:91], v6 offset:34816
    v_mfma_f32_16x16x32_bf16 v[172:175], v[76:79], v[40:43], v[172:175]
    ds_read_b128 v[92:95], v6 offset:35840
    v_mfma_f32_16x16x32_bf16 v[176:179], v[64:67], v[44:47], v[176:179]
    ds_read_b128 v[96:99], v6 offset:36864
    v_mfma_f32_16x16x32_bf16 v[180:183], v[68:71], v[44:47], v[180:183]
    ds_read_b128 v[100:103], v6 offset:37888
    v_mfma_f32_16x16x32_bf16 v[184:187], v[72:75], v[44:47], v[184:187]
    ds_read_b128 v[104:107], v6 offset:38912
    v_mfma_f32_16x16x32_bf16 v[188:191], v[76:79], v[44:47], v[188:191]
    ds_read_b128 v[108:111], v6 offset:39936
    v_mfma_f32_16x16x32_bf16 v[192:195], v[64:67], v[48:51], v[192:195]
    v_mfma_f32_16x16x32_bf16 v[196:199], v[68:71], v[48:51], v[196:199]
    s_add_u32 m0, s21, 65536
    s_nop 0
    buffer_load_dwordx4 v1, s[4:7], s16 offen sc1 lds
    s_add_u32 s16, s16, s62
    v_mfma_f32_16x16x32_bf16 v[200:203], v[72:75], v[48:51], v[200:203]
    v_mfma_f32_16x16x32_bf16 v[204:207], v[76:79], v[48:51], v[204:207]
    v_mfma_f32_16x16x32_bf16 v[208:211], v[64:67], v[52:55], v[208:211]
    s_add_u32 m0, s21, 66560
    s_nop 0
    buffer_load_dwordx4 v1, s[4:7], s17 offen sc1 lds
    s_add_u32 s17, s17, s62
    v_mfma_f32_16x16x32_bf16 v[212:215], v[68:71], v[52:55], v[212:215]
    v_mfma_f32_16x16x32_bf16 v[216:219], v[72:75], v[52:55], v[216:219]
    v_mfma_f32_16x16x32_bf16 v[220:223], v[76:79], v[52:55], v[220:223]
    s_add_u32 m0, s22, 65536
    s_nop 0
    buffer_load_dwordx4 v2, s[8:11], s18 offen lds
    s_add_u32 s18, s18, s20
    v_mfma_f32_16x16x32_bf16 v[224:227], v[64:67], v[56:59], v[224:227]
    v_mfma_f32_16x16x32_bf16 v[228:231], v[68:71], v[56:59], v[228:231]
    v_mfma_f32_16x16x32_bf16 v[232:235], v[72:75], v[56:59], v[232:235]
    s_add_u32 m0, s22, 73728
    s_nop 0
    buffer_load_dwordx4 v2, s[12:15], s19 offen lds
    s_add_u32 s19, s19, s20
    v_mfma_f32_16x16x32_bf16 v[236:239], v[76:79], v[56:59], v[236:239]
    v_mfma_f32_16x16x32_bf16 v[240:243], v[64:67], v[60:63], v[240:243]
    v_mfma_f32_16x16x32_bf16 v[244:247], v[68:71], v[60:63], v[244:247]
    v_mfma_f32_16x16x32_bf16 v[248:251], v[72:75], v[60:63], v[248:251]
    v_mfma_f32_16x16x32_bf16 v[252:255], v[76:79], v[60:63], v[252:255]
    s_waitcnt lgkmcnt(0)
    s_waitcnt vmcnt(8)
    s_barrier
    v_mfma_f32_16x16x32_bf16 v[128:131], v[112:115], v[80:83], v[128:131]
    ds_read_b64_tr_b16 v[64:65], v8 offset:16384
    v_mfma_f32_16x16x32_bf16 v[132:135], v[116:119], v[80:83], v[132:135]
    ds_read_b64_tr_b16 v[66:67], v9 offset:16384
    v_mfma_f32_16x16x32_bf16 v[136:139], v[120:123], v[80:83], v[136:139]
    ds_read_b64_tr_b16 v[68:69], v10 offset:16384
    v_mfma_f32_16x16x32_bf16 v[140:143], v[124:127], v[80:83], v[140:143]
    ds_read_b64_tr_b16 v[70:71], v11 offset:16384
    v_mfma_f32_16x16x32_bf16 v[144:147], v[112:115], v[84:87], v[144:147]
    ds_read_b64_tr_b16 v[72:73], v8 offset:24576
    v_mfma_f32_16x16x32_bf16 v[148:151], v[116:119], v[84:87], v[148:151]
    ds_read_b64_tr_b16 v[74:75], v9 offset:24576
    v_mfma_f32_16x16x32_bf16 v[152:155], v[120:123], v[84:87], v[152:155]
    ds_read_b64_tr_b16 v[76:77], v10 offset:24576
    v_mfma_f32_16x16x32_bf16 v[156:159], v[124:127], v[84:87], v[156:159]
    ds_read_b64_tr_b16 v[78:79], v11 offset:24576
    v_mfma_f32_16x16x32_bf16 v[160:163], v[112:115], v[88:91], v[160:163]
    ds_read_b128 v[32:35], v5 offset:0
    v_mfma_f32_16x16x32_bf16 v[164:167], v[116:119], v[88:91], v[164:167]
    ds_read_b128 v[36:39], v5 offset:1024
    v_mfma_f32_16x16x32_bf16 v[168:171], v[120:123], v[88:91], v[168:171]
    ds_read_b128 v[40:43], v5 offset:2048
    v_mfma_f32_16x16x32_bf16 v[172:175], v[124:127], v[88:91], v[172:175]
    ds_read_b128 v[44:47], v5 offset:3072
    v_mfma_f32_16x16x32_bf16 v[176:179], v[112:115], v[92:95], v[176:179]
    ds_read_b128 v[48:51], v5 offset:4096
    v_mfma_f32_16x16x32_bf16 v[180:183], v[116:119], v[92:95], v[180:183]
    ds_read_b128 v[52:55], v5 offset:5120
    v_mfma_f32_16x16x32_bf16 v[184:187], v[120:123], v[92:95], v[184:187]
    ds_read_b128 v[56:59], v5 offset:6144
    v_mfma_f32_16x16x32_bf16 v[188:191], v[124:127], v[92:95], v[188:191]
    ds_read_b128 v[60:63], v5 offset:7168
    v_mfma_f32_16x16x32_bf16 v[192:195], v[112:115], v[96:99], v[192:195]
    v_mfma_f32_16x16x32_bf16 v[196:199], v[116:119], v[96:99], v[196:199]
    s_add_u32 m0, s21, 98304
    s_nop 0
    buffer_load_dwordx4 v1, s[4:7], s16 offen sc1 lds
    s_add_u32 s16, s16, s62
    v_mfma_f32_16x16x32_bf16 v[200:203], v[120:123], v[96:99], v[200:203]
    v_mfma_f32_16x16x32_bf16 v[204:207], v[124:127], v[96:99], v[204:207]
    v_mfma_f32_16x16x32_bf16 v[208:211], v[112:115], v[100:103], v[208:211]
    s_add_u32 m0, s21, 99328
    s_nop 0
    buffer_load_dwordx4 v1, s[4:7], s17 offen sc1 lds
    s_add_u32 s17, s17, s62
    v_mfma_f32_16x16x32_bf16 v[212:215], v[116:119], v[100:103], v[212:215]
    v_mfma_f32_16x16x32_bf16 v[216:219], v[120:123], v[100:103], v[216:219]
    v_mfma_f32_16x16x32_bf16 v[220:223], v[124:127], v[100:103], v[220:223]
    s_add_u32 m0, s22, 98304
    s_nop 0
    buffer_load_dwordx4 v2, s[8:11], s18 offen lds
    s_add_u32 s18, s18, s20
    v_mfma_f32_16x16x32_bf16 v[224:227], v[112:115], v[104:107], v[224:227]
    v_mfma_f32_16x16x32_bf16 v[228:231], v[116:119], v[104:107], v[228:231]
    v_mfma_f32_16x16x32_bf16 v[232:235], v[120:123], v[104:107], v[232:235]
    s_add_u32 m0, s22, 106496
    s_nop 0
    buffer_load_dwordx4 v2, s[12:15], s19 offen lds
    s_add_u32 s19, s19, s20
    v_mfma_f32_16x16x32_bf16 v[236:239], v[124:127], v[104:107], v[236:239]
    v_mfma_f32_16x16x32_bf16 v[240:243], v[112:115], v[108:111], v[240:243]
    v_mfma_f32_16x16x32_bf16 v[244:247], v[116:119], v[108:111], v[244:247]
    v_mfma_f32_16x16x32_bf16 v[248:251], v[120:123], v[108:111], v[248:251]
    v_mfma_f32_16x16x32_bf16 v[252:255], v[124:127], v[108:111], v[252:255]
    s_waitcnt lgkmcnt(0)
    s_sub_u32 s23, s23, 1
    s_cmp_lg_u32 s23, 0
    s_cbranch_scc1 w_loop
    v_mov_b32 v20, 131072
    ds_read_b128 v[24:27], v20
    ds_read_b128 v[28:31], v20 offset:16
    s_cmp_eq_u32 s48, 2
    s_cbranch_scc1 w_epi_glu
    s_cmp_eq_u32 s48, 3
    s_cbranch_scc1 w_epi_silu
    s_lshl_b32 s30, s27, 10
    s_add_u32 s30, s30, s49
    s_nop 7
    v_cvt_pk_bf16_f32 v80, v128, v129
    v_cvt_pk_bf16_f32 v81, v130, v131
    v_cvt_pk_bf16_f32 v82, v132, v133
    v_cvt_pk_bf16_f32 v83, v134, v135
    buffer_store_dwordx4 v[80:83], v1, s[4:7], s30 offen sc1
    v_cvt_pk_bf16_f32 v84, v136, v137
    v_cvt_pk_bf16_f32 v85, v138, v139
    v_cvt_pk_bf16_f32 v86, v140, v141
    v_cvt_pk_bf16_f32 v87, v142, v143
    buffer_store_dwordx4 v[84:87], v19, s[4:7], s30 offen sc1
    s_add_u32 s30, s30, s50
    v_cvt_pk_bf16_f32 v88, v144, v145
    v_cvt_pk_bf16_f32 v89, v146, v147
    v_cvt_pk_bf16_f32 v90, v148, v149
    v_cvt_pk_bf16_f32 v91, v150, v151
    buffer_store_dwordx4 v[88:91], v1, s[4:7], s30 offen sc1
    v_cvt_pk_bf16_f32 v92, v152, v153
    v_cvt_pk_bf16_f32 v93, v154, v155
    v_cvt_pk_bf16_f32 v94, v156, v157
    v_cvt_pk_bf16_f32 v95, v158, v159
    buffer_store_dwordx4 v[92:95], v19, s[4:7], s30 offen sc1
    s_add_u32 s30, s30, s50
    v_cvt_pk_bf16_f32 v80, v160, v161
    v_cvt_pk_bf16_f32 v81, v162, v163
    v_cvt_pk_bf16_f32 v82, v164, v165
    v_cvt_pk_bf16_f32 v83, v166, v167
    buffer_store_dwordx4 v[80:83], v1, s[4:7], s30 offen sc1
    v_cvt_pk_bf16_f32 v84, v168, v169
    v_cvt_pk_bf16_f32 v85, v170, v171
    v_cvt_pk_bf16_f32 v86, v172, v173
    v_cvt_pk_bf16_f32 v87, v174, v175
    buffer_store_dwordx4 v[84:87], v19, s[4:7], s30 offen sc1
    s_add_u32 s30, s30, s50
    v_cvt_pk_bf16_f32 v88, v176, v177
    v_cvt_pk_bf16_f32 v89, v178, v179
    v_cvt_pk_bf16_f32 v90, v180, v181
    v_cvt_pk_bf16_f32 v91, v182, v183
    buffer_store_dwordx4 v[88:91], v1, s[4:7], s30 offen sc1
    v_cvt_pk_bf16_f32 v92, v184, v185
    v_cvt_pk_bf16_f32 v93, v186, v187
    v_cvt_pk_bf16_f32 v94, v188, v189
    v_cvt_pk_bf16_f32 v95, v190, v191
    buffer_store_dwordx4 v[92:95], v19, s[4:7], s30 offen sc1
    s_add_u32 s30, s30, s50
    v_cvt_pk_bf16_f32 v80, v192, v193
    v_cvt_pk_bf16_f32 v81, v194, v195
    v_cvt_pk_bf16_f32 v82, v196, v197
    v_cvt_pk_bf16_f32 v83, v198, v199
    buffer_store_dwordx4 v[80:83], v1, s[4:7], s30 offen sc1
    v_cvt_pk_bf16_f32 v84, v200, v201
    v_cvt_pk_bf16_f32 v85, v202, v203
    v_cvt_pk_bf16_f32 v86, v204, v205
    v_cvt_pk_bf16_f32 v87, v206, v207
    buffer_store_dwordx4 v[84:87], v19, s[4:7], s30 offen sc1
    s_add_u32 s30, s30, s50
    v_cvt_pk_bf16_f32 v88, v208, v209
    v_cvt_pk_bf16_f32 v89, v210, v211
    v_cvt_pk_bf16_f32 v90, v212, v213
    v_cvt_pk_bf16_f32 v91, v214, v215
    buffer_store_dwordx4 v[88:91], v1, s[4:7], s30 offen sc1
    v_cvt_pk_bf16_f32 v92, v216, v217
    v_cvt_pk_bf16_f32 v93, v218, v219
    v_cvt_pk_bf16_f32 v94, v220, v221
    v_cvt_pk_bf16_f32 v95, v222, v223
    buffer_store_dwordx4 v[92:95], v19, s[4:7], s30 offen sc1
    s_add_u32 s30, s30, s50
    v_cvt_pk_bf16_f32 v80, v224, v225
    v_cvt_pk_bf16_f32 v81, v226, v227
    v_cvt_pk_bf16_f32 v82, v228, v229
    v_cvt_pk_bf16_f32 v83, v230, v231
    buffer_store_dwordx4 v[80:83], v1, s[4:7], s30 offen sc1
    v_cvt_pk_bf16_f32 v84, v232, v233
    v_cvt_pk_bf16_f32 v85, v234, v235
    v_cvt_pk_bf16_f32 v86, v236, v237
    v_cvt_pk_bf16_f32 v87, v238, v239
    buffer_store_dwordx4 v[84:87], v19, s[4:7], s30 offen sc1
    s_add_u32 s30, s30, s50
    v_cvt_pk_bf16_f32 v88, v240, v241
    v_cvt_pk_bf16_f32 v89, v242, v243
    v_cvt_pk_bf16_f32 v90, v244, v245
    v_cvt_pk_bf16_f32 v91, v246, v247
    buffer_store_dwordx4 v[88:91], v1, s[4:7], s30 offen sc1
    v_cvt_pk_bf16_f32 v92, v248, v249
    v_cvt_pk_bf16_f32 v93, v250, v251
    v_cvt_pk_bf16_f32 v94, v252, v253
    v_cvt_pk_bf16_f32 v95, v254, v255
    buffer_store_dwordx4 v[92:95], v19, s[4:7], s30 offen sc1
    s_waitcnt lgkmcnt(0)
    v_or3_b32 v24, v24, v25, v26
    v_or3_b32 v28, v28, v29, v30
    v_or3_b32 v24, v24, v27, v31
    v_or_b32 v24, v24, v28
    s_mov_b32 s28, s51
    s_mov_b32 s57, s53
    v_readfirstlane_b32 s30, v24
    s_cmp_lg_u32 s30, 0
    s_cbranch_scc1 w_drain
    s_mov_b32 s48, s32
    s_cmp_ge_u32 s32, 4
    s_cselect_b32 s30, 2, 3
    s_lshl_b32 s30, s26, s30
    s_mul_i32 s30, s30, s43
    s_add_u32 s49, s42, s30
    s_mov_b32 s50, s43
    s_mov_b32 s51, s46
    s_mov_b32 s23, s41
    s_mov_b32 s53, s47
    s_nop 0
    s_load_dwordx16 s[32:47], s[24:25], 0
    s_add_u32 s24, s24, 64
    s_addc_u32 s25, s25, 0
    s_branch w_first16
w_epi_glu:
    s_lshl_b32 s30, s27, 10
    s_add_u32 s30, s30, s49
    s_mov_b32 s54, 0xbfb8aa3b
    s_nop 7
    v_cvt_pk_bf16_f32 v80, v128, v129
    v_cvt_pk_bf16_f32 v81, v130, v131
    v_cvt_pk_bf16_f32 v82, v132, v133
    v_cvt_pk_bf16_f32 v83, v134, v135
    v_lshlrev_b32 v96, 16, v80
    v_and_b32 v97, 0xffff0000, v80
    v_lshlrev_b32 v98, 16, v81
    v_and_b32 v99, 0xffff0000, v81
    v_lshlrev_b32 v100, 16, v82
    v_and_b32 v101, 0xffff0000, v82
    v_lshlrev_b32 v102, 16, v83
    v_and_b32 v103, 0xffff0000, v83
    v_mul_f32 v96, s54, v96
    v_mul_f32 v97, s54, v97
    v_mul_f32 v98, s54, v98
    v_mul_f32 v99, s54, v99
    v_mul_f32 v100, s54, v100
    v_mul_f32 v101, s54, v101
    v_mul_f32 v102, s54, v102
    v_mul_f32 v103, s54, v103
    v_exp_f32 v96, v96
    v_exp_f32 v97, v97
    v_exp_f32 v98, v98
    v_exp_f32 v99, v99
    v_exp_f32 v100, v100
    v_exp_f32 v101, v101
    v_exp_f32 v102, v102
    v_exp_f32 v103, v103
    v_add_f32 v96, 1.0, v96
    v_add_f32 v97, 1.0, v97
    v_add_f32 v98, 1.0, v98
    v_add_f32 v99, 1.0, v99
    v_add_f32 v100, 1.0, v100
    v_add_f32 v101, 1.0, v101
    v_add_f32 v102, 1.0, v102
    v_add_f32 v103, 1.0, v103
    v_rcp_f32 v96, v96
    v_rcp_f32 v97, v97
    v_rcp_f32 v98, v98
    v_rcp_f32 v99, v99
    v_rcp_f32 v100, v100
    v_rcp_f32 v101, v101
    v_rcp_f32 v102, v102
    v_rcp_f32 v103, v103
    v_mul_f32 v96, v96, v136
    v_mul_f32 v97, v97, v137
    v_mul_f32 v98, v98, v138
    v_mul_f32 v99, v99, v139
    v_mul_f32 v100, v100, v140
    v_mul_f32 v101, v101, v141
    v_mul_f32 v102, v102, v142
    v_mul_f32 v103, v103, v143
    v_cvt_pk_bf16_f32 v80, v96, v97
    v_cvt_pk_bf16_f32 v81, v98, v99
    v_cvt_pk_bf16_f32 v82, v100, v101
    v_cvt_pk_bf16_f32 v83, v102, v103
    buffer_store_dwordx4 v[80:83], v1, s[4:7], s30 offen sc1
    s_add_u32 s30, s30, s50
    v_cvt_pk_bf16_f32 v84, v144, v145
    v_cvt_pk_bf16_f32 v85, v146, v147
    v_cvt_pk_bf16_f32 v86, v148, v149
    v_cvt_pk_bf16_f32 v87, v150, v151
    v_lshlrev_b32 v104, 16, v84
    v_and_b32 v105, 0xffff0000, v84
    v_lshlrev_b32 v106, 16, v85
    v_and_b32 v107, 0xffff0000, v85
    v_lshlrev_b32 v108, 16, v86
    v_and_b32 v109, 0xffff0000, v86
    v_lshlrev_b32 v110, 16, v87
    v_and_b32 v111, 0xffff0000, v87
    v_mul_f32 v104, s54, v104
    v_mul_f32 v105, s54, v105
    v_mul_f32 v106, s54, v106
    v_mul_f32 v107, s54, v107
    v_mul_f32 v108, s54, v108
    v_mul_f32 v109, s54, v109
    v_mul_f32 v110, s54, v110
    v_mul_f32 v111, s54, v111
    v_exp_f32 v104, v104
    v_exp_f32 v105, v105
    v_exp_f32 v106, v106
    v_exp_f32 v107, v107
    v_exp_f32 v108, v108
    v_exp_f32 v109, v109
    v_exp_f32 v110, v110
    v_exp_f32 v111, v111
    v_add_f32 v104, 1.0, v104
    v_add_f32 v105, 1.0, v105
    v_add_f32 v106, 1.0, v106
    v_add_f32 v107, 1.0, v107
    v_add_f32 v108, 1.0, v108
    v_add_f32 v109, 1.0, v109
    v_add_f32 v110, 1.0, v110
    v_add_f32 v111, 1.0, v111
    v_rcp_f32 v104, v104
    v_rcp_f32 v105, v105
    v_rcp_f32 v106, v106
    v_rcp_f32 v107, v107
    v_rcp_f32 v108, v108
    v_rcp_f32 v109, v109
    v_rcp_f32 v110, v110
    v_rcp_f32 v111, v111
    v_mul_f32 v104, v104, v152
    v_mul_f32 v105, v105, v153
    v_mul_f32 v106, v106, v154
    v_mul_f32 v107, v107, v155
    v_mul_f32 v108, v108, v156
    v_mul_f32 v109, v109, v157
    v_mul_f32 v110, v110, v158
    v_mul_f32 v111, v111, v159
    v_cvt_pk_bf16_f32 v84, v104, v105
    v_cvt_pk_bf16_f32 v85, v106, v107
    v_cvt_pk_bf16_f32 v86, v108, v109
    v_cvt_pk_bf16_f32 v87, v110, v111
    buffer_store_dwordx4 v[84:87], v1, s[4:7], s30 offen sc1
    s_add_u32 s30, s30, s50
    v_cvt_pk_bf16_f32 v88, v160, v161
    v_cvt_pk_bf16_f32 v89, v162, v163
    v_cvt_pk_bf16_f32 v90, v164, v165
    v_cvt_pk_bf16_f32 v91, v166, v167
    v_lshlrev_b32 v96, 16, v88
    v_and_b32 v97, 0xffff0000, v88
    v_lshlrev_b32 v98, 16, v89
    v_and_b32 v99, 0xffff0000, v89
    v_lshlrev_b32 v100, 16, v90
    v_and_b32 v101, 0xffff0000, v90
    v_lshlrev_b32 v102, 16, v91
    v_and_b32 v103, 0xffff0000, v91
    v_mul_f32 v96, s54, v96
    v_mul_f32 v97, s54, v97
    v_mul_f32 v98, s54, v98
    v_mul_f32 v99, s54, v99
    v_mul_f32 v100, s54, v100
    v_mul_f32 v101, s54, v101
    v_mul_f32 v102, s54, v102
    v_mul_f32 v103, s54, v103
    v_exp_f32 v96, v96
    v_exp_f32 v97, v97
    v_exp_f32 v98, v98
    v_exp_f32 v99, v99
    v_exp_f32 v100, v100
    v_exp_f32 v101, v101
    v_exp_f32 v102, v102
    v_exp_f32 v103, v103
    v_add_f32 v96, 1.0, v96
    v_add_f32 v97, 1.0, v97
    v_add_f32 v98, 1.0, v98
    v_add_f32 v99, 1.0, v99
    v_add_f32 v100, 1.0, v100
    v_add_f32 v101, 1.0, v101
    v_add_f32 v102, 1.0, v102
    v_add_f32 v103, 1.0, v103
    v_rcp_f32 v96, v96
    v_rcp_f32 v97, v97
    v_rcp_f32 v98, v98
    v_rcp_f32 v99, v99
    v_rcp_f32 v100, v100
    v_rcp_f32 v101, v101
    v_rcp_f32 v102, v102
    v_rcp_f32 v103, v103
    v_mul_f32 v96, v96, v168
    v_mul_f32 v97, v97, v169
    v_mul_f32 v98, v98, v170
    v_mul_f32 v99, v99, v171
    v_mul_f32 v100, v100, v172
    v_mul_f32 v101, v101, v173
    v_mul_f32 v102, v102, v174
    v_mul_f32 v103, v103, v175
    v_cvt_pk_bf16_f32 v88, v96, v97
    v_cvt_pk_bf16_f32 v89, v98, v99
    v_cvt_pk_bf16_f32 v90, v100, v101
    v_cvt_pk_bf16_f32 v91, v102, v103
    buffer_store_dwordx4 v[88:91], v1, s[4:7], s30 offen sc1
    s_add_u32 s30, s30, s50
    v_cvt_pk_bf16_f32 v92, v176, v177
    v_cvt_pk_bf16_f32 v93, v178, v179
    v_cvt_pk_bf16_f32 v94, v180, v181
    v_cvt_pk_bf16_f32 v95, v182, v183
    v_lshlrev_b32 v104, 16, v92
    v_and_b32 v105, 0xffff0000, v92
    v_lshlrev_b32 v106, 16, v93
    v_and_b32 v107, 0xffff0000, v93
    v_lshlrev_b32 v108, 16, v94
    v_and_b32 v109, 0xffff0000, v94
    v_lshlrev_b32 v110, 16, v95
    v_and_b32 v111, 0xffff0000, v95
    v_mul_f32 v104, s54, v104
    v_mul_f32 v105, s54, v105
    v_mul_f32 v106, s54, v106
    v_mul_f32 v107, s54, v107
    v_mul_f32 v108, s54, v108
    v_mul_f32 v109, s54, v109
    v_mul_f32 v110, s54, v110
    v_mul_f32 v111, s54, v111
    v_exp_f32 v104, v104
    v_exp_f32 v105, v105
    v_exp_f32 v106, v106
    v_exp_f32 v107, v107
    v_exp_f32 v108, v108
    v_exp_f32 v109, v109
    v_exp_f32 v110, v110
    v_exp_f32 v111, v111
    v_add_f32 v104, 1.0, v104
    v_add_f32 v105, 1.0, v105
    v_add_f32 v106, 1.0, v106
    v_add_f32 v107, 1.0, v107
    v_add_f32 v108, 1.0, v108
    v_add_f32 v109, 1.0, v109
    v_add_f32 v110, 1.0, v110
    v_add_f32 v111, 1.0, v111
    v_rcp_f32 v104, v104
    v_rcp_f32 v105, v105
    v_rcp_f32 v106, v106
    v_rcp_f32 v107, v107
    v_rcp_f32 v108, v108
    v_rcp_f32 v109, v109
    v_rcp_f32 v110, v110
    v_rcp_f32 v111, v111
    v_mul_f32 v104, v104, v184
    v_mul_f32 v105, v105, v185
    v_mul_f32 v106, v106, v186
    v_mul_f32 v107, v107, v187
    v_mul_f32 v108, v108, v188
    v_mul_f32 v109, v109, v189
    v_mul_f32 v110, v110, v190
    v_mul_f32 v111, v111, v191
    v_cvt_pk_bf16_f32 v92, v104, v105
    v_cvt_pk_bf16_f32 v93, v106, v107
    v_cvt_pk_bf16_f32 v94, v108, v109
    v_cvt_pk_bf16_f32 v95, v110, v111
    buffer_store_dwordx4 v[92:95], v1, s[4:7], s30 offen sc1
    s_add_u32 s30, s30, s50
    v_cvt_pk_bf16_f32 v80, v192, v193
    v_cvt_pk_bf16_f32 v81, v194, v195
    v_cvt_pk_bf16_f32 v82, v196, v197
    v_cvt_pk_bf16_f32 v83, v198, v199
    v_lshlrev_b32 v96, 16, v80
    v_and_b32 v97, 0xffff0000, v80
    v_lshlrev_b32 v98, 16, v81
    v_and_b32 v99, 0xffff0000, v81
    v_lshlrev_b32 v100, 16, v82
    v_and_b32 v101, 0xffff0000, v82
    v_lshlrev_b32 v102, 16, v83
    v_and_b32 v103, 0xffff0000, v83
    v_mul_f32 v96, s54, v96
    v_mul_f32 v97, s54, v97
    v_mul_f32 v98, s54, v98
    v_mul_f32 v99, s54, v99
    v_mul_f32 v100, s54, v100
    v_mul_f32 v101, s54, v101
    v_mul_f32 v102, s54, v102
    v_mul_f32 v103, s54, v103
    v_exp_f32 v96, v96
    v_exp_f32 v97, v97
    v_exp_f32 v98, v98
    v_exp_f32 v99, v99
    v_exp_f32 v100, v100
    v_exp_f32 v101, v101
    v_exp_f32 v102, v102
    v_exp_f32 v103, v103
    v_add_f32 v96, 1.0, v96
    v_add_f32 v97, 1.0, v97
    v_add_f32 v98, 1.0, v98
    v_add_f32 v99, 1.0, v99
    v_add_f32 v100, 1.0, v100
    v_add_f32 v101, 1.0, v101
    v_add_f32 v102, 1.0, v102
    v_add_f32 v103, 1.0, v103
    v_rcp_f32 v96, v96
    v_rcp_f32 v97, v97
    v_rcp_f32 v98, v98
    v_rcp_f32 v99, v99
    v_rcp_f32 v100, v100
    v_rcp_f32 v101, v101
    v_rcp_f32 v102, v102
    v_rcp_f32 v103, v103
    v_mul_f32 v96, v96, v200
    v_mul_f32 v97, v97, v201
    v_mul_f32 v98, v98, v202
    v_mul_f32 v99, v99, v203
    v_mul_f32 v100, v100, v204
    v_mul_f32 v101, v101, v205
    v_mul_f32 v102, v102, v206
    v_mul_f32 v103, v103, v207
    v_cvt_pk_bf16_f32 v80, v96, v97
    v_cvt_pk_bf16_f32 v81, v98, v99
    v_cvt_pk_bf16_f32 v82, v100, v101
    v_cvt_pk_bf16_f32 v83, v102, v103
    buffer_store_dwordx4 v[80:83], v1, s[4:7], s30 offen sc1
    s_add_u32 s30, s30, s50
    v_cvt_pk_bf16_f32 v84, v208, v209
    v_cvt_pk_bf16_f32 v85, v210, v211
    v_cvt_pk_bf16_f32 v86, v212, v213
    v_cvt_pk_bf16_f32 v87, v214, v215
    v_lshlrev_b32 v104, 16, v84
    v_and_b32 v105, 0xffff0000, v84
    v_lshlrev_b32 v106, 16, v85
    v_and_b32 v107, 0xffff0000, v85
    v_lshlrev_b32 v108, 16, v86
    v_and_b32 v109, 0xffff0000, v86
    v_lshlrev_b32 v110, 16, v87
    v_and_b32 v111, 0xffff0000, v87
    v_mul_f32 v104, s54, v104
    v_mul_f32 v105, s54, v105
    v_mul_f32 v106, s54, v106
    v_mul_f32 v107, s54, v107
    v_mul_f32 v108, s54, v108
    v_mul_f32 v109, s54, v109
    v_mul_f32 v110, s54, v110
    v_mul_f32 v111, s54, v111
    v_exp_f32 v104, v104
    v_exp_f32 v105, v105
    v_exp_f32 v106, v106
    v_exp_f32 v107, v107
    v_exp_f32 v108, v108
    v_exp_f32 v109, v109
    v_exp_f32 v110, v110
    v_exp_f32 v111, v111
    v_add_f32 v104, 1.0, v104
    v_add_f32 v105, 1.0, v105
    v_add_f32 v106, 1.0, v106
    v_add_f32 v107, 1.0, v107
    v_add_f32 v108, 1.0, v108
    v_add_f32 v109, 1.0, v109
    v_add_f32 v110, 1.0, v110
    v_add_f32 v111, 1.0, v111
    v_rcp_f32 v104, v104
    v_rcp_f32 v105, v105
    v_rcp_f32 v106, v106
    v_rcp_f32 v107, v107
    v_rcp_f32 v108, v108
    v_rcp_f32 v109, v109
    v_rcp_f32 v110, v110
    v_rcp_f32 v111, v111
    v_mul_f32 v104, v104, v216
    v_mul_f32 v105, v105, v217
    v_mul_f32 v106, v106, v218
    v_mul_f32 v107, v107, v219
    v_mul_f32 v108, v108, v220
    v_mul_f32 v109, v109, v221
    v_mul_f32 v110, v110, v222
    v_mul_f32 v111, v111, v223
    v_cvt_pk_bf16_f32 v84, v104, v105
    v_cvt_pk_bf16_f32 v85, v106, v107
    v_cvt_pk_bf16_f32 v86, v108, v109
    v_cvt_pk_bf16_f32 v87, v110, v111
    buffer_store_dwordx4 v[84:87], v1, s[4:7], s30 offen sc1
    s_add_u32 s30, s30, s50
    v_cvt_pk_bf16_f32 v88, v224, v225
    v_cvt_pk_bf16_f32 v89, v226, v227
    v_cvt_pk_bf16_f32 v90, v228, v229
    v_cvt_pk_bf16_f32 v91, v230, v231
    v_lshlrev_b32 v96, 16, v88
    v_and_b32 v97, 0xffff0000, v88
    v_lshlrev_b32 v98, 16, v89
    v_and_b32 v99, 0xffff0000, v89
    v_lshlrev_b32 v100, 16, v90
    v_and_b32 v101, 0xffff0000, v90
    v_lshlrev_b32 v102, 16, v91
    v_and_b32 v103, 0xffff0000, v91
    v_mul_f32 v96, s54, v96
    v_mul_f32 v97, s54, v97
    v_mul_f32 v98, s54, v98
    v_mul_f32 v99, s54, v99
    v_mul_f32 v100, s54, v100
    v_mul_f32 v101, s54, v101
    v_mul_f32 v102, s54, v102
    v_mul_f32 v103, s54, v103
    v_exp_f32 v96, v96
    v_exp_f32 v97, v97
    v_exp_f32 v98, v98
    v_exp_f32 v99, v99
    v_exp_f32 v100, v100
    v_exp_f32 v101, v101
    v_exp_f32 v102, v102
    v_exp_f32 v103, v103
    v_add_f32 v96, 1.0, v96
    v_add_f32 v97, 1.0, v97
    v_add_f32 v98, 1.0, v98
    v_add_f32 v99, 1.0, v99
    v_add_f32 v100, 1.0, v100
    v_add_f32 v101, 1.0, v101
    v_add_f32 v102, 1.0, v102
    v_add_f32 v103, 1.0, v103
    v_rcp_f32 v96, v96
    v_rcp_f32 v97, v97
    v_rcp_f32 v98, v98
    v_rcp_f32 v99, v99
    v_rcp_f32 v100, v100
    v_rcp_f32 v101, v101
    v_rcp_f32 v102, v102
    v_rcp_f32 v103, v103
    v_mul_f32 v96, v96, v232
    v_mul_f32 v97, v97, v233
    v_mul_f32 v98, v98, v234
    v_mul_f32 v99, v99, v235
    v_mul_f32 v100, v100, v236
    v_mul_f32 v101, v101, v237
    v_mul_f32 v102, v102, v238
    v_mul_f32 v103, v103, v239
    v_cvt_pk_bf16_f32 v88, v96, v97
    v_cvt_pk_bf16_f32 v89, v98, v99
    v_cvt_pk_bf16_f32 v90, v100, v101
    v_cvt_pk_bf16_f32 v91, v102, v103
    buffer_store_dwordx4 v[88:91], v1, s[4:7], s30 offen sc1
    s_add_u32 s30, s30, s50
    v_cvt_pk_bf16_f32 v92, v240, v241
    v_cvt_pk_bf16_f32 v93, v242, v243
    v_cvt_pk_bf16_f32 v94, v244, v245
    v_cvt_pk_bf16_f32 v95, v246, v247
    v_lshlrev_b32 v104, 16, v92
    v_and_b32 v105, 0xffff0000, v92
    v_lshlrev_b32 v106, 16, v93
    v_and_b32 v107, 0xffff0000, v93
    v_lshlrev_b32 v108, 16, v94
    v_and_b32 v109, 0xffff0000, v94
    v_lshlrev_b32 v110, 16, v95
    v_and_b32 v111, 0xffff0000, v95
    v_mul_f32 v104, s54, v104
    v_mul_f32 v105, s54, v105
    v_mul_f32 v106, s54, v106
    v_mul_f32 v107, s54, v107
    v_mul_f32 v108, s54, v108
    v_mul_f32 v109, s54, v109
    v_mul_f32 v110, s54, v110
    v_mul_f32 v111, s54, v111
    v_exp_f32 v104, v104
    v_exp_f32 v105, v105
    v_exp_f32 v106, v106
    v_exp_f32 v107, v107
    v_exp_f32 v108, v108
    v_exp_f32 v109, v109
    v_exp_f32 v110, v110
    v_exp_f32 v111, v111
    v_add_f32 v104, 1.0, v104
    v_add_f32 v105, 1.0, v105
    v_add_f32 v106, 1.0, v106
    v_add_f32 v107, 1.0, v107
    v_add_f32 v108, 1.0, v108
    v_add_f32 v109, 1.0, v109
    v_add_f32 v110, 1.0, v110
    v_add_f32 v111, 1.0, v111
    v_rcp_f32 v104, v104
    v_rcp_f32 v105, v105
    v_rcp_f32 v106, v106
    v_rcp_f32 v107, v107
    v_rcp_f32 v108, v108
    v_rcp_f32 v109, v109
    v_rcp_f32 v110, v110
    v_rcp_f32 v111, v111
    v_mul_f32 v104, v104, v248
    v_mul_f32 v105, v105, v249
    v_mul_f32 v106, v106, v250
    v_mul_f32 v107, v107, v251
    v_mul_f32 v108, v108, v252
    v_mul_f32 v109, v109, v253
    v_mul_f32 v110, v110, v254
    v_mul_f32 v111, v111, v255
    v_cvt_pk_bf16_f32 v92, v104, v105
    v_cvt_pk_bf16_f32 v93, v106, v107
    v_cvt_pk_bf16_f32 v94, v108, v109
    v_cvt_pk_bf16_f32 v95, v110, v111
    buffer_store_dwordx4 v[92:95], v1, s[4:7], s30 offen sc1
    s_waitcnt lgkmcnt(0)
    v_or3_b32 v24, v24, v25, v26
    v_or3_b32 v28, v28, v29, v30
    v_or3_b32 v24, v24, v27, v31
    v_or_b32 v24, v24, v28
    s_mov_b32 s28, s51
    s_mov_b32 s57, s53
    v_readfirstlane_b32 s30, v24
    s_cmp_lg_u32 s30, 0
    s_cbranch_scc1 w_drain
    s_mov_b32 s48, s32
    s_cmp_ge_u32 s32, 4
    s_cselect_b32 s30, 2, 3
    s_lshl_b32 s30, s26, s30
    s_mul_i32 s30, s30, s43
    s_add_u32 s49, s42, s30
    s_mov_b32 s50, s43
    s_mov_b32 s51, s46
    s_mov_b32 s23, s41
    s_mov_b32 s53, s47
    s_nop 0
    s_load_dwordx16 s[32:47], s[24:25], 0
    s_add_u32 s24, s24, 64
    s_addc_u32 s25, s25, 0
    s_branch w_first8
w_epi_silu:
    s_lshl_b32 s30, s27, 10
    s_add_u32 s30, s30, s49
    s_mov_b32 s54, 0xbfb8aa3b
    s_nop 7
    v_cvt_pk_bf16_f32 v80, v128, v129
    v_cvt_pk_bf16_f32 v81, v130, v131
    v_cvt_pk_bf16_f32 v82, v132, v133
    v_cvt_pk_bf16_f32 v83, v134, v135
    v_lshlrev_b32 v128, 16, v80
    v_and_b32 v129, 0xffff0000, v80
    v_lshlrev_b32 v130, 16, v81
    v_and_b32 v131, 0xffff0000, v81
    v_lshlrev_b32 v132, 16, v82
    v_and_b32 v133, 0xffff0000, v82
    v_lshlrev_b32 v134, 16, v83
    v_and_b32 v135, 0xffff0000, v83
    v_mul_f32 v104, s54, v128
    v_mul_f32 v105, s54, v129
    v_mul_f32 v106, s54, v130
    v_mul_f32 v107, s54, v131
    v_mul_f32 v108, s54, v132
    v_mul_f32 v109, s54, v133
    v_mul_f32 v110, s54, v134
    v_mul_f32 v111, s54, v135
    v_exp_f32 v104, v104
    v_exp_f32 v105, v105
    v_exp_f32 v106, v106
    v_exp_f32 v107, v107
    v_exp_f32 v108, v108
    v_exp_f32 v109, v109
    v_exp_f32 v110, v110
    v_exp_f32 v111, v111
    v_add_f32 v104, 1.0, v104
    v_add_f32 v105, 1.0, v105
    v_add_f32 v106, 1.0, v106
    v_add_f32 v107, 1.0, v107
    v_add_f32 v108, 1.0, v108
    v_add_f32 v109, 1.0, v109
    v_add_f32 v110, 1.0, v110
    v_add_f32 v111, 1.0, v111
    v_rcp_f32 v104, v104
    v_rcp_f32 v105, v105
    v_rcp_f32 v106, v106
    v_rcp_f32 v107, v107
    v_rcp_f32 v108, v108
    v_rcp_f32 v109, v109
    v_rcp_f32 v110, v110
    v_rcp_f32 v111, v111
    v_mul_f32 v128, v128, v104
    v_mul_f32 v129, v129, v105
    v_mul_f32 v130, v130, v106
    v_mul_f32 v131, v131, v107
    v_mul_f32 v132, v132, v108
    v_mul_f32 v133, v133, v109
    v_mul_f32 v134, v134, v110
    v_mul_f32 v135, v135, v111
    v_cvt_pk_bf16_f32 v80, v128, v129
    v_cvt_pk_bf16_f32 v81, v130, v131
    v_cvt_pk_bf16_f32 v82, v132, v133
    v_cvt_pk_bf16_f32 v83, v134, v135
    buffer_store_dwordx4 v[80:83], v1, s[4:7], s30 offen sc1
    v_cvt_pk_bf16_f32 v84, v136, v137
    v_cvt_pk_bf16_f32 v85, v138, v139
    v_cvt_pk_bf16_f32 v86, v140, v141
    v_cvt_pk_bf16_f32 v87, v142, v143
    v_lshlrev_b32 v136, 16, v84
    v_and_b32 v137, 0xffff0000, v84
    v_lshlrev_b32 v138, 16, v85
    v_and_b32 v139, 0xffff0000, v85
    v_lshlrev_b32 v140, 16, v86
    v_and_b32 v141, 0xffff0000, v86
    v_lshlrev_b32 v142, 16, v87
    v_and_b32 v143, 0xffff0000, v87
    v_mul_f32 v96, s54, v136
    v_mul_f32 v97, s54, v137
    v_mul_f32 v98, s54, v138
    v_mul_f32 v99, s54, v139
    v_mul_f32 v100, s54, v140
    v_mul_f32 v101, s54, v141
    v_mul_f32 v102, s54, v142
    v_mul_f32 v103, s54, v143
    v_exp_f32 v96, v96
    v_exp_f32 v97, v97
    v_exp_f32 v98, v98
    v_exp_f32 v99, v99
    v_exp_f32 v100, v100
    v_exp_f32 v101, v101
    v_exp_f32 v102, v102
    v_exp_f32 v103, v103
    v_add_f32 v96, 1.0, v96
    v_add_f32 v97, 1.0, v97
    v_add_f32 v98, 1.0, v98
    v_add_f32 v99, 1.0, v99
    v_add_f32 v100, 1.0, v100
    v_add_f32 v101, 1.0, v101
    v_add_f32 v102, 1.0, v102
    v_add_f32 v103, 1.0, v103
    v_rcp_f32 v96, v96
    v_rcp_f32 v97, v97
    v_rcp_f32 v98, v98
    v_rcp_f32 v99, v99
    v_rcp_f32 v100, v100
    v_rcp_f32 v101, v101
    v_rcp_f32 v102, v102
    v_rcp_f32 v103, v103
    v_mul_f32 v136, v136, v96
    v_mul_f32 v137, v137, v97
    v_mul_f32 v138, v138, v98
    v_mul_f32 v139, v139, v99
    v_mul_f32 v140, v140, v100
    v_mul_f32 v141, v141, v101
    v_mul_f32 v142, v142, v102
    v_mul_f32 v143, v143, v103
    v_cvt_pk_bf16_f32 v84, v136, v137
    v_cvt_pk_bf16_f32 v85, v138, v139
    v_cvt_pk_bf16_f32 v86, v140, v141
    v_cvt_pk_bf16_f32 v87, v142, v143
    buffer_store_dwordx4 v[84:87], v19, s[4:7], s30 offen sc1
    s_add_u32 s30, s30, s50
    v_cvt_pk_bf16_f32 v88, v144, v145
    v_cvt_pk_bf16_f32 v89, v146, v147
    v_cvt_pk_bf16_f32 v90, v148, v149
    v_cvt_pk_bf16_f32 v91, v150, v151
    v_lshlrev_b32 v144, 16, v88
    v_and_b32 v145, 0xffff0000, v88
    v_lshlrev_b32 v146, 16, v89
    v_and_b32 v147, 0xffff0000, v89
    v_lshlrev_b32 v148, 16, v90
    v_and_b32 v149, 0xffff0000, v90
    v_lshlrev_b32 v150, 16, v91
    v_and_b32 v151, 0xffff0000, v91
    v_mul_f32 v104, s54, v144
    v_mul_f32 v105, s54, v145
    v_mul_f32 v106, s54, v146
    v_mul_f32 v107, s54, v147
    v_mul_f32 v108, s54, v148
    v_mul_f32 v109, s54, v149
    v_mul_f32 v110, s54, v150
    v_mul_f32 v111, s54, v151
    v_exp_f32 v104, v104
    v_exp_f32 v105, v105
    v_exp_f32 v106, v106
    v_exp_f32 v107, v107
    v_exp_f32 v108, v108
    v_exp_f32 v109, v109
    v_exp_f32 v110, v110
    v_exp_f32 v111, v111
    v_add_f32 v104, 1.0, v104
    v_add_f32 v105, 1.0, v105
    v_add_f32 v106, 1.0, v106
    v_add_f32 v107, 1.0, v107
    v_add_f32 v108, 1.0, v108
    v_add_f32 v109, 1.0, v109
    v_add_f32 v110, 1.0, v110
    v_add_f32 v111, 1.0, v111
    v_rcp_f32 v104, v104
    v_rcp_f32 v105, v105
    v_rcp_f32 v106, v106
    v_rcp_f32 v107, v107
    v_rcp_f32 v108, v108
    v_rcp_f32 v109, v109
    v_rcp_f32 v110, v110
    v_rcp_f32 v111, v111
    v_mul_f32 v144, v144, v104
    v_mul_f32 v145, v145, v105
    v_mul_f32 v146, v146, v106
    v_mul_f32 v147, v147, v107
    v_mul_f32 v148, v148, v108
    v_mul_f32 v149, v149, v109
    v_mul_f32 v150, v150, v110
    v_mul_f32 v151, v151, v111
    v_cvt_pk_bf16_f32 v88, v144, v145
    v_cvt_pk_bf16_f32 v89, v146, v147
    v_cvt_pk_bf16_f32 v90, v148, v149
    v_cvt_pk_bf16_f32 v91, v150, v151
    buffer_store_dwordx4 v[88:91], v1, s[4:7], s30 offen sc1
    v_cvt_pk_bf16_f32 v92, v152, v153
    v_cvt_pk_bf16_f32 v93, v154, v155
    v_cvt_pk_bf16_f32 v94, v156, v157
    v_cvt_pk_bf16_f32 v95, v158, v159
    v_lshlrev_b32 v152, 16, v92
    v_and_b32 v153, 0xffff0000, v92
    v_lshlrev_b32 v154, 16, v93
    v_and_b32 v155, 0xffff0000, v93
    v_lshlrev_b32 v156, 16, v94
    v_and_b32 v157, 0xffff0000, v94
    v_lshlrev_b32 v158, 16, v95
    v_and_b32 v159, 0xffff0000, v95
    v_mul_f32 v96, s54, v152
    v_mul_f32 v97, s54, v153
    v_mul_f32 v98, s54, v154
    v_mul_f32 v99, s54, v155
    v_mul_f32 v100, s54, v156
    v_mul_f32 v101, s54, v157
    v_mul_f32 v102, s54, v158
    v_mul_f32 v103, s54, v159
    v_exp_f32 v96, v96
    v_exp_f32 v97, v97
    v_exp_f32 v98, v98
    v_exp_f32 v99, v99
    v_exp_f32 v100, v100
    v_exp_f32 v101, v101
    v_exp_f32 v102, v102
    v_exp_f32 v103, v103
    v_add_f32 v96, 1.0, v96
    v_add_f32 v97, 1.0, v97
    v_add_f32 v98, 1.0, v98
    v_add_f32 v99, 1.0, v99
    v_add_f32 v100, 1.0, v100
    v_add_f32 v101, 1.0, v101
    v_add_f32 v102, 1.0, v102
    v_add_f32 v103, 1.0, v103
    v_rcp_f32 v96, v96
    v_rcp_f32 v97, v97
    v_rcp_f32 v98, v98
    v_rcp_f32 v99, v99
    v_rcp_f32 v100, v100
    v_rcp_f32 v101, v101
    v_rcp_f32 v102, v102
    v_rcp_f32 v103, v103
    v_mul_f32 v152, v152, v96
    v_mul_f32 v153, v153, v97
    v_mul_f32 v154, v154, v98
    v_mul_f32 v155, v155, v99
    v_mul_f32 v156, v156, v100
    v_mul_f32 v157, v157, v101
    v_mul_f32 v158, v158, v102
    v_mul_f32 v159, v159, v103
    v_cvt_pk_bf16_f32 v92, v152, v153
    v_cvt_pk_bf16_f32 v93, v154, v155
    v_cvt_pk_bf16_f32 v94, v156, v157
    v_cvt_pk_bf16_f32 v95, v158, v159
    buffer_store_dwordx4 v[92:95], v19, s[4:7], s30 offen sc1
    s_add_u32 s30, s30, s50
    v_cvt_pk_bf16_f32 v80, v160, v161
    v_cvt_pk_bf16_f32 v81, v162, v163
    v_cvt_pk_bf16_f32 v82, v164, v165
    v_cvt_pk_bf16_f32 v83, v166, v167
    v_lshlrev_b32 v160, 16, v80
    v_and_b32 v161, 0xffff0000, v80
    v_lshlrev_b32 v162, 16, v81
    v_and_b32 v163, 0xffff0000, v81
    v_lshlrev_b32 v164, 16, v82
    v_and_b32 v165, 0xffff0000, v82
    v_lshlrev_b32 v166, 16, v83
    v_and_b32 v167, 0xffff0000, v83
    v_mul_f32 v104, s54, v160
    v_mul_f32 v105, s54, v161
    v_mul_f32 v106, s54, v162
    v_mul_f32 v107, s54, v163
    v_mul_f32 v108, s54, v164
    v_mul_f32 v109, s54, v165
    v_mul_f32 v110, s54, v166
    v_mul_f32 v111, s54, v167
    v_exp_f32 v104, v104
    v_exp_f32 v105, v105
    v_exp_f32 v106, v106
    v_exp_f32 v107, v107
    v_exp_f32 v108, v108
    v_exp_f32 v109, v109
    v_exp_f32 v110, v110
    v_exp_f32 v111, v111
    v_add_f32 v104, 1.0, v104
    v_add_f32 v105, 1.0, v105
    v_add_f32 v106, 1.0, v106
    v_add_f32 v107, 1.0, v107
    v_add_f32 v108, 1.0, v108
    v_add_f32 v109, 1.0, v109
    v_add_f32 v110, 1.0, v110
    v_add_f32 v111, 1.0, v111
    v_rcp_f32 v104, v104
    v_rcp_f32 v105, v105
    v_rcp_f32 v106, v106
    v_rcp_f32 v107, v107
    v_rcp_f32 v108, v108
    v_rcp_f32 v109, v109
    v_rcp_f32 v110, v110
    v_rcp_f32 v111, v111
    v_mul_f32 v160, v160, v104
    v_mul_f32 v161, v161, v105
    v_mul_f32 v162, v162, v106
    v_mul_f32 v163, v163, v107
    v_mul_f32 v164, v164, v108
    v_mul_f32 v165, v165, v109
    v_mul_f32 v166, v166, v110
    v_mul_f32 v167, v167, v111
    v_cvt_pk_bf16_f32 v80, v160, v161
    v_cvt_pk_bf16_f32 v81, v162, v163
    v_cvt_pk_bf16_f32 v82, v164, v165
    v_cvt_pk_bf16_f32 v83, v166, v167
    buffer_store_dwordx4 v[80:83], v1, s[4:7], s30 offen sc1
    v_cvt_pk_bf16_f32 v84, v168, v169
    v_cvt_pk_bf16_f32 v85, v170, v171
    v_cvt_pk_bf16_f32 v86, v172, v173
    v_cvt_pk_bf16_f32 v87, v174, v175
    v_lshlrev_b32 v168, 16, v84
    v_and_b32 v169, 0xffff0000, v84
    v_lshlrev_b32 v170, 16, v85
    v_and_b32 v171, 0xffff0000, v85
    v_lshlrev_b32 v172, 16, v86
    v_and_b32 v173, 0xffff0000, v86
    v_lshlrev_b32 v174, 16, v87
    v_and_b32 v175, 0xffff0000, v87
    v_mul_f32 v96, s54, v168
    v_mul_f32 v97, s54, v169
    v_mul_f32 v98, s54, v170
    v_mul_f32 v99, s54, v171
    v_mul_f32 v100, s54, v172
    v_mul_f32 v101, s54, v173
    v_mul_f32 v102, s54, v174
    v_mul_f32 v103, s54, v175
    v_exp_f32 v96, v96
    v_exp_f32 v97, v97
    v_exp_f32 v98, v98
    v_exp_f32 v99, v99
    v_exp_f32 v100, v100
    v_exp_f32 v101, v101
    v_exp_f32 v102, v102
    v_exp_f32 v103, v103
    v_add_f32 v96, 1.0, v96
    v_add_f32 v97, 1.0, v97
    v_add_f32 v98, 1.0, v98
    v_add_f32 v99, 1.0, v99
    v_add_f32 v100, 1.0, v100
    v_add_f32 v101, 1.0, v101
    v_add_f32 v102, 1.0, v102
    v_add_f32 v103, 1.0, v103
    v_rcp_f32 v96, v96
    v_rcp_f32 v97, v97
    v_rcp_f32 v98, v98
    v_rcp_f32 v99, v99
    v_rcp_f32 v100, v100
    v_rcp_f32 v101, v101
    v_rcp_f32 v102, v102
    v_rcp_f32 v103, v103
    v_mul_f32 v168, v168, v96
    v_mul_f32 v169, v169, v97
    v_mul_f32 v170, v170, v98
    v_mul_f32 v171, v171, v99
    v_mul_f32 v172, v172, v100
    v_mul_f32 v173, v173, v101
    v_mul_f32 v174, v174, v102
    v_mul_f32 v175, v175, v103
    v_cvt_pk_bf16_f32 v84, v168, v169
    v_cvt_pk_bf16_f32 v85, v170, v171
    v_cvt_pk_bf16_f32 v86, v172, v173
    v_cvt_pk_bf16_f32 v87, v174, v175
    buffer_store_dwordx4 v[84:87], v19, s[4:7], s30 offen sc1
    s_add_u32 s30, s30, s50
    v_cvt_pk_bf16_f32 v88, v176, v177
    v_cvt_pk_bf16_f32 v89, v178, v179
    v_cvt_pk_bf16_f32 v90, v180, v181
    v_cvt_pk_bf16_f32 v91, v182, v183
    v_lshlrev_b32 v176, 16, v88
    v_and_b32 v177, 0xffff0000, v88
    v_lshlrev_b32 v178, 16, v89
    v_and_b32 v179, 0xffff0000, v89
    v_lshlrev_b32 v180, 16, v90
    v_and_b32 v181, 0xffff0000, v90
    v_lshlrev_b32 v182, 16, v91
    v_and_b32 v183, 0xffff0000, v91
    v_mul_f32 v104, s54, v176
    v_mul_f32 v105, s54, v177
    v_mul_f32 v106, s54, v178
    v_mul_f32 v107, s54, v179
    v_mul_f32 v108, s54, v180
    v_mul_f32 v109, s54, v181
    v_mul_f32 v110, s54, v182
    v_mul_f32 v111, s54, v183
    v_exp_f32 v104, v104
    v_exp_f32 v105, v105
    v_exp_f32 v106, v106
    v_exp_f32 v107, v107
    v_exp_f32 v108, v108
    v_exp_f32 v109, v109
    v_exp_f32 v110, v110
    v_exp_f32 v111, v111
    v_add_f32 v104, 1.0, v104
    v_add_f32 v105, 1.0, v105
    v_add_f32 v106, 1.0, v106
    v_add_f32 v107, 1.0, v107
    v_add_f32 v108, 1.0, v108
    v_add_f32 v109, 1.0, v109
    v_add_f32 v110, 1.0, v110
    v_add_f32 v111, 1.0, v111
    v_rcp_f32 v104, v104
    v_rcp_f32 v105, v105
    v_rcp_f32 v106, v106
    v_rcp_f32 v107, v107
    v_rcp_f32 v108, v108
    v_rcp_f32 v109, v109
    v_rcp_f32 v110, v110
    v_rcp_f32 v111, v111
    v_mul_f32 v176, v176, v104
    v_mul_f32 v177, v177, v105
    v_mul_f32 v178, v178, v106
    v_mul_f32 v179, v179, v107
    v_mul_f32 v180, v180, v108
    v_mul_f32 v181, v181, v109
    v_mul_f32 v182, v182, v110
    v_mul_f32 v183, v183, v111
    v_cvt_pk_bf16_f32 v88, v176, v177
    v_cvt_pk_bf16_f32 v89, v178, v179
    v_cvt_pk_bf16_f32 v90, v180, v181
    v_cvt_pk_bf16_f32 v91, v182, v183
    buffer_store_dwordx4 v[88:91], v1, s[4:7], s30 offen sc1
    v_cvt_pk_bf16_f32 v92, v184, v185
    v_cvt_pk_bf16_f32 v93, v186, v187
    v_cvt_pk_bf16_f32 v94, v188, v189
    v_cvt_pk_bf16_f32 v95, v190, v191
    v_lshlrev_b32 v184, 16, v92
    v_and_b32 v185, 0xffff0000, v92
    v_lshlrev_b32 v186, 16, v93
    v_and_b32 v187, 0xffff0000, v93
    v_lshlrev_b32 v188, 16, v94
    v_and_b32 v189, 0xffff0000, v94
    v_lshlrev_b32 v190, 16, v95
    v_and_b32 v191, 0xffff0000, v95
    v_mul_f32 v96, s54, v184
    v_mul_f32 v97, s54, v185
    v_mul_f32 v98, s54, v186
    v_mul_f32 v99, s54, v187
    v_mul_f32 v100, s54, v188
    v_mul_f32 v101, s54, v189
    v_mul_f32 v102, s54, v190
    v_mul_f32 v103, s54, v191
    v_exp_f32 v96, v96
    v_exp_f32 v97, v97
    v_exp_f32 v98, v98
    v_exp_f32 v99, v99
    v_exp_f32 v100, v100
    v_exp_f32 v101, v101
    v_exp_f32 v102, v102
    v_exp_f32 v103, v103
    v_add_f32 v96, 1.0, v96
    v_add_f32 v97, 1.0, v97
    v_add_f32 v98, 1.0, v98
    v_add_f32 v99, 1.0, v99
    v_add_f32 v100, 1.0, v100
    v_add_f32 v101, 1.0, v101
    v_add_f32 v102, 1.0, v102
    v_add_f32 v103, 1.0, v103
    v_rcp_f32 v96, v96
    v_rcp_f32 v97, v97
    v_rcp_f32 v98, v98
    v_rcp_f32 v99, v99
    v_rcp_f32 v100, v100
    v_rcp_f32 v101, v101
    v_rcp_f32 v102, v102
    v_rcp_f32 v103, v103
    v_mul_f32 v184, v184, v96
    v_mul_f32 v185, v185, v97
    v_mul_f32 v186, v186, v98
    v_mul_f32 v187, v187, v99
    v_mul_f32 v188, v188, v100
    v_mul_f32 v189, v189, v101
    v_mul_f32 v190, v190, v102
    v_mul_f32 v191, v191, v103
    v_cvt_pk_bf16_f32 v92, v184, v185
    v_cvt_pk_bf16_f32 v93, v186, v187
    v_cvt_pk_bf16_f32 v94, v188, v189
    v_cvt_pk_bf16_f32 v95, v190, v191
    buffer_store_dwordx4 v[92:95], v19, s[4:7], s30 offen sc1
    s_add_u32 s30, s30, s50
    v_cvt_pk_bf16_f32 v80, v192, v193
    v_cvt_pk_bf16_f32 v81, v194, v195
    v_cvt_pk_bf16_f32 v82, v196, v197
    v_cvt_pk_bf16_f32 v83, v198, v199
    v_lshlrev_b32 v192, 16, v80
    v_and_b32 v193, 0xffff0000, v80
    v_lshlrev_b32 v194, 16, v81
    v_and_b32 v195, 0xffff0000, v81
    v_lshlrev_b32 v196, 16, v82
    v_and_b32 v197, 0xffff0000, v82
    v_lshlrev_b32 v198, 16, v83
    v_and_b32 v199, 0xffff0000, v83
    v_mul_f32 v104, s54, v192
    v_mul_f32 v105, s54, v193
    v_mul_f32 v106, s54, v194
    v_mul_f32 v107, s54, v195
    v_mul_f32 v108, s54, v196
    v_mul_f32 v109, s54, v197
    v_mul_f32 v110, s54, v198
    v_mul_f32 v111, s54, v199
    v_exp_f32 v104, v104
    v_exp_f32 v105, v105
    v_exp_f32 v106, v106
    v_exp_f32 v107, v107
    v_exp_f32 v108, v108
    v_exp_f32 v109, v109
    v_exp_f32 v110, v110
    v_exp_f32 v111, v111
    v_add_f32 v104, 1.0, v104
    v_add_f32 v105, 1.0, v105
    v_add_f32 v106, 1.0, v106
    v_add_f32 v107, 1.0, v107
    v_add_f32 v108, 1.0, v108
    v_add_f32 v109, 1.0, v109
    v_add_f32 v110, 1.0, v110
    v_add_f32 v111, 1.0, v111
    v_rcp_f32 v104, v104
    v_rcp_f32 v105, v105
    v_rcp_f32 v106, v106
    v_rcp_f32 v107, v107
    v_rcp_f32 v108, v108
    v_rcp_f32 v109, v109
    v_rcp_f32 v110, v110
    v_rcp_f32 v111, v111
    v_mul_f32 v192, v192, v104
    v_mul_f32 v193, v193, v105
    v_mul_f32 v194, v194, v106
    v_mul_f32 v195, v195, v107
    v_mul_f32 v196, v196, v108
    v_mul_f32 v197, v197, v109
    v_mul_f32 v198, v198, v110
    v_mul_f32 v199, v199, v111
    v_cvt_pk_bf16_f32 v80, v192, v193
    v_cvt_pk_bf16_f32 v81, v194, v195
    v_cvt_pk_bf16_f32 v82, v196, v197
    v_cvt_pk_bf16_f32 v83, v198, v199
    buffer_store_dwordx4 v[80:83], v1, s[4:7], s30 offen sc1
    v_cvt_pk_bf16_f32 v84, v200, v201
    v_cvt_pk_bf16_f32 v85, v202, v203
    v_cvt_pk_bf16_f32 v86, v204, v205
    v_cvt_pk_bf16_f32 v87, v206, v207
    v_lshlrev_b32 v200, 16, v84
    v_and_b32 v201, 0xffff0000, v84
    v_lshlrev_b32 v202, 16, v85
    v_and_b32 v203, 0xffff0000, v85
    v_lshlrev_b32 v204, 16, v86
    v_and_b32 v205, 0xffff0000, v86
    v_lshlrev_b32 v206, 16, v87
    v_and_b32 v207, 0xffff0000, v87
    v_mul_f32 v96, s54, v200
    v_mul_f32 v97, s54, v201
    v_mul_f32 v98, s54, v202
    v_mul_f32 v99, s54, v203
    v_mul_f32 v100, s54, v204
    v_mul_f32 v101, s54, v205
    v_mul_f32 v102, s54, v206
    v_mul_f32 v103, s54, v207
    v_exp_f32 v96, v96
    v_exp_f32 v97, v97
    v_exp_f32 v98, v98
    v_exp_f32 v99, v99
    v_exp_f32 v100, v100
    v_exp_f32 v101, v101
    v_exp_f32 v102, v102
    v_exp_f32 v103, v103
    v_add_f32 v96, 1.0, v96
    v_add_f32 v97, 1.0, v97
    v_add_f32 v98, 1.0, v98
    v_add_f32 v99, 1.0, v99
    v_add_f32 v100, 1.0, v100
    v_add_f32 v101, 1.0, v101
    v_add_f32 v102, 1.0, v102
    v_add_f32 v103, 1.0, v103
    v_rcp_f32 v96, v96
    v_rcp_f32 v97, v97
    v_rcp_f32 v98, v98
    v_rcp_f32 v99, v99
    v_rcp_f32 v100, v100
    v_rcp_f32 v101, v101
    v_rcp_f32 v102, v102
    v_rcp_f32 v103, v103
    v_mul_f32 v200, v200, v96
    v_mul_f32 v201, v201, v97
    v_mul_f32 v202, v202, v98
    v_mul_f32 v203, v203, v99
    v_mul_f32 v204, v204, v100
    v_mul_f32 v205, v205, v101
    v_mul_f32 v206, v206, v102
    v_mul_f32 v207, v207, v103
    v_cvt_pk_bf16_f32 v84, v200, v201
    v_cvt_pk_bf16_f32 v85, v202, v203
    v_cvt_pk_bf16_f32 v86, v204, v205
    v_cvt_pk_bf16_f32 v87, v206, v207
    buffer_store_dwordx4 v[84:87], v19, s[4:7], s30 offen sc1
    s_add_u32 s30, s30, s50
    v_cvt_pk_bf16_f32 v88, v208, v209
    v_cvt_pk_bf16_f32 v89, v210, v211
    v_cvt_pk_bf16_f32 v90, v212, v213
    v_cvt_pk_bf16_f32 v91, v214, v215
    v_lshlrev_b32 v208, 16, v88
    v_and_b32 v209, 0xffff0000, v88
    v_lshlrev_b32 v210, 16, v89
    v_and_b32 v211, 0xffff0000, v89
    v_lshlrev_b32 v212, 16, v90
    v_and_b32 v213, 0xffff0000, v90
    v_lshlrev_b32 v214, 16, v91
    v_and_b32 v215, 0xffff0000, v91
    v_mul_f32 v104, s54, v208
    v_mul_f32 v105, s54, v209
    v_mul_f32 v106, s54, v210
    v_mul_f32 v107, s54, v211
    v_mul_f32 v108, s54, v212
    v_mul_f32 v109, s54, v213
    v_mul_f32 v110, s54, v214
    v_mul_f32 v111, s54, v215
    v_exp_f32 v104, v104
    v_exp_f32 v105, v105
    v_exp_f32 v106, v106
    v_exp_f32 v107, v107
    v_exp_f32 v108, v108
    v_exp_f32 v109, v109
    v_exp_f32 v110, v110
    v_exp_f32 v111, v111
    v_add_f32 v104, 1.0, v104
    v_add_f32 v105, 1.0, v105
    v_add_f32 v106, 1.0, v106
    v_add_f32 v107, 1.0, v107
    v_add_f32 v108, 1.0, v108
    v_add_f32 v109, 1.0, v109
    v_add_f32 v110, 1.0, v110
    v_add_f32 v111, 1.0, v111
    v_rcp_f32 v104, v104
    v_rcp_f32 v105, v105
    v_rcp_f32 v106, v106
    v_rcp_f32 v107, v107
    v_rcp_f32 v108, v108
    v_rcp_f32 v109, v109
    v_rcp_f32 v110, v110
    v_rcp_f32 v111, v111
    v_mul_f32 v208, v208, v104
    v_mul_f32 v209, v209, v105
    v_mul_f32 v210, v210, v106
    v_mul_f32 v211, v211, v107
    v_mul_f32 v212, v212, v108
    v_mul_f32 v213, v213, v109
    v_mul_f32 v214, v214, v110
    v_mul_f32 v215, v215, v111
    v_cvt_pk_bf16_f32 v88, v208, v209
    v_cvt_pk_bf16_f32 v89, v210, v211
    v_cvt_pk_bf16_f32 v90, v212, v213
    v_cvt_pk_bf16_f32 v91, v214, v215
    buffer_store_dwordx4 v[88:91], v1, s[4:7], s30 offen sc1
    v_cvt_pk_bf16_f32 v92, v216, v217
    v_cvt_pk_bf16_f32 v93, v218, v219
    v_cvt_pk_bf16_f32 v94, v220, v221
    v_cvt_pk_bf16_f32 v95, v222, v223
    v_lshlrev_b32 v216, 16, v92
    v_and_b32 v217, 0xffff0000, v92
    v_lshlrev_b32 v218, 16, v93
    v_and_b32 v219, 0xffff0000, v93
    v_lshlrev_b32 v220, 16, v94
    v_and_b32 v221, 0xffff0000, v94
    v_lshlrev_b32 v222, 16, v95
    v_and_b32 v223, 0xffff0000, v95
    v_mul_f32 v96, s54, v216
    v_mul_f32 v97, s54, v217
    v_mul_f32 v98, s54, v218
    v_mul_f32 v99, s54, v219
    v_mul_f32 v100, s54, v220
    v_mul_f32 v101, s54, v221
    v_mul_f32 v102, s54, v222
    v_mul_f32 v103, s54, v223
    v_exp_f32 v96, v96
    v_exp_f32 v97, v97
    v_exp_f32 v98, v98
    v_exp_f32 v99, v99
    v_exp_f32 v100, v100
    v_exp_f32 v101, v101
    v_exp_f32 v102, v102
    v_exp_f32 v103, v103
    v_add_f32 v96, 1.0, v96
    v_add_f32 v97, 1.0, v97
    v_add_f32 v98, 1.0, v98
    v_add_f32 v99, 1.0, v99
    v_add_f32 v100, 1.0, v100
    v_add_f32 v101, 1.0, v101
    v_add_f32 v102, 1.0, v102
    v_add_f32 v103, 1.0, v103
    v_rcp_f32 v96, v96
    v_rcp_f32 v97, v97
    v_rcp_f32 v98, v98
    v_rcp_f32 v99, v99
    v_rcp_f32 v100, v100
    v_rcp_f32 v101, v101
    v_rcp_f32 v102, v102
    v_rcp_f32 v103, v103
    v_mul_f32 v216, v216, v96
    v_mul_f32 v217, v217, v97
    v_mul_f32 v218, v218, v98
    v_mul_f32 v219, v219, v99
    v_mul_f32 v220, v220, v100
    v_mul_f32 v221, v221, v101
    v_mul_f32 v222, v222, v102
    v_mul_f32 v223, v223, v103
    v_cvt_pk_bf16_f32 v92, v216, v217
    v_cvt_pk_bf16_f32 v93, v218, v219
    v_cvt_pk_bf16_f32 v94, v220, v221
    v_cvt_pk_bf16_f32 v95, v222, v223
    buffer_store_dwordx4 v[92:95], v19, s[4:7], s30 offen sc1
    s_add_u32 s30, s30, s50
    v_cvt_pk_bf16_f32 v80, v224, v225
    v_cvt_pk_bf16_f32 v81, v226, v227
    v_cvt_pk_bf16_f32 v82, v228, v229
    v_cvt_pk_bf16_f32 v83, v230, v231
    v_lshlrev_b32 v224, 16, v80
    v_and_b32 v225, 0xffff0000, v80
    v_lshlrev_b32 v226, 16, v81
    v_and_b32 v227, 0xffff0000, v81
    v_lshlrev_b32 v228, 16, v82
    v_and_b32 v229, 0xffff0000, v82
    v_lshlrev_b32 v230, 16, v83
    v_and_b32 v231, 0xffff0000, v83
    v_mul_f32 v104, s54, v224
    v_mul_f32 v105, s54, v225
    v_mul_f32 v106, s54, v226
    v_mul_f32 v107, s54, v227
    v_mul_f32 v108, s54, v228
    v_mul_f32 v109, s54, v229
    v_mul_f32 v110, s54, v230
    v_mul_f32 v111, s54, v231
    v_exp_f32 v104, v104
    v_exp_f32 v105, v105
    v_exp_f32 v106, v106
    v_exp_f32 v107, v107
    v_exp_f32 v108, v108
    v_exp_f32 v109, v109
    v_exp_f32 v110, v110
    v_exp_f32 v111, v111
    v_add_f32 v104, 1.0, v104
    v_add_f32 v105, 1.0, v105
    v_add_f32 v106, 1.0, v106
    v_add_f32 v107, 1.0, v107
    v_add_f32 v108, 1.0, v108
    v_add_f32 v109, 1.0, v109
    v_add_f32 v110, 1.0, v110
    v_add_f32 v111, 1.0, v111
    v_rcp_f32 v104, v104
    v_rcp_f32 v105, v105
    v_rcp_f32 v106, v106
    v_rcp_f32 v107, v107
    v_rcp_f32 v108, v108
    v_rcp_f32 v109, v109
    v_rcp_f32 v110, v110
    v_rcp_f32 v111, v111
    v_mul_f32 v224, v224, v104
    v_mul_f32 v225, v225, v105
    v_mul_f32 v226, v226, v106
    v_mul_f32 v227, v227, v107
    v_mul_f32 v228, v228, v108
    v_mul_f32 v229, v229, v109
    v_mul_f32 v230, v230, v110
    v_mul_f32 v231, v231, v111
    v_cvt_pk_bf16_f32 v80, v224, v225
    v_cvt_pk_bf16_f32 v81, v226, v227
    v_cvt_pk_bf16_f32 v82, v228, v229
    v_cvt_pk_bf16_f32 v83, v230, v231
    buffer_store_dwordx4 v[80:83], v1, s[4:7], s30 offen sc1
    v_cvt_pk_bf16_f32 v84, v232, v233
    v_cvt_pk_bf16_f32 v85, v234, v235
    v_cvt_pk_bf16_f32 v86, v236, v237
    v_cvt_pk_bf16_f32 v87, v238, v239
    v_lshlrev_b32 v232, 16, v84
    v_and_b32 v233, 0xffff0000, v84
    v_lshlrev_b32 v234, 16, v85
    v_and_b32 v235, 0xffff0000, v85
    v_lshlrev_b32 v236, 16, v86
    v_and_b32 v237, 0xffff0000, v86
    v_lshlrev_b32 v238, 16, v87
    v_and_b32 v239, 0xffff0000, v87
    v_mul_f32 v96, s54, v232
    v_mul_f32 v97, s54, v233
    v_mul_f32 v98, s54, v234
    v_mul_f32 v99, s54, v235
    v_mul_f32 v100, s54, v236
    v_mul_f32 v101, s54, v237
    v_mul_f32 v102, s54, v238
    v_mul_f32 v103, s54, v239
    v_exp_f32 v96, v96
    v_exp_f32 v97, v97
    v_exp_f32 v98, v98
    v_exp_f32 v99, v99
    v_exp_f32 v100, v100
    v_exp_f32 v101, v101
    v_exp_f32 v102, v102
    v_exp_f32 v103, v103
    v_add_f32 v96, 1.0, v96
    v_add_f32 v97, 1.0, v97
    v_add_f32 v98, 1.0, v98
    v_add_f32 v99, 1.0, v99
    v_add_f32 v100, 1.0, v100
    v_add_f32 v101, 1.0, v101
    v_add_f32 v102, 1.0, v102
    v_add_f32 v103, 1.0, v103
    v_rcp_f32 v96, v96
    v_rcp_f32 v97, v97
    v_rcp_f32 v98, v98
    v_rcp_f32 v99, v99
    v_rcp_f32 v100, v100
    v_rcp_f32 v101, v101
    v_rcp_f32 v102, v102
    v_rcp_f32 v103, v103
    v_mul_f32 v232, v232, v96
    v_mul_f32 v233, v233, v97
    v_mul_f32 v234, v234, v98
    v_mul_f32 v235, v235, v99
    v_mul_f32 v236, v236, v100
    v_mul_f32 v237, v237, v101
    v_mul_f32 v238, v238, v102
    v_mul_f32 v239, v239, v103
    v_cvt_pk_bf16_f32 v84, v232, v233
    v_cvt_pk_bf16_f32 v85, v234, v235
    v_cvt_pk_bf16_f32 v86, v236, v237
    v_cvt_pk_bf16_f32 v87, v238, v239
    buffer_store_dwordx4 v[84:87], v19, s[4:7], s30 offen sc1
    s_add_u32 s30, s30, s50
    v_cvt_pk_bf16_f32 v88, v240, v241
    v_cvt_pk_bf16_f32 v89, v242, v243
    v_cvt_pk_bf16_f32 v90, v244, v245
    v_cvt_pk_bf16_f32 v91, v246, v247
    v_lshlrev_b32 v240, 16, v88
    v_and_b32 v241, 0xffff0000, v88
    v_lshlrev_b32 v242, 16, v89
    v_and_b32 v243, 0xffff0000, v89
    v_lshlrev_b32 v244, 16, v90
    v_and_b32 v245, 0xffff0000, v90
    v_lshlrev_b32 v246, 16, v91
    v_and_b32 v247, 0xffff0000, v91
    v_mul_f32 v104, s54, v240
    v_mul_f32 v105, s54, v241
    v_mul_f32 v106, s54, v242
    v_mul_f32 v107, s54, v243
    v_mul_f32 v108, s54, v244
    v_mul_f32 v109, s54, v245
    v_mul_f32 v110, s54, v246
    v_mul_f32 v111, s54, v247
    v_exp_f32 v104, v104
    v_exp_f32 v105, v105
    v_exp_f32 v106, v106
    v_exp_f32 v107, v107
    v_exp_f32 v108, v108
    v_exp_f32 v109, v109
    v_exp_f32 v110, v110
    v_exp_f32 v111, v111
    v_add_f32 v104, 1.0, v104
    v_add_f32 v105, 1.0, v105
    v_add_f32 v106, 1.0, v106
    v_add_f32 v107, 1.0, v107
    v_add_f32 v108, 1.0, v108
    v_add_f32 v109, 1.0, v109
    v_add_f32 v110, 1.0, v110
    v_add_f32 v111, 1.0, v111
    v_rcp_f32 v104, v104
    v_rcp_f32 v105, v105
    v_rcp_f32 v106, v106
    v_rcp_f32 v107, v107
    v_rcp_f32 v108, v108
    v_rcp_f32 v109, v109
    v_rcp_f32 v110, v110
    v_rcp_f32 v111, v111
    v_mul_f32 v240, v240, v104
    v_mul_f32 v241, v241, v105
    v_mul_f32 v242, v242, v106
    v_mul_f32 v243, v243, v107
    v_mul_f32 v244, v244, v108
    v_mul_f32 v245, v245, v109
    v_mul_f32 v246, v246, v110
    v_mul_f32 v247, v247, v111
    v_cvt_pk_bf16_f32 v88, v240, v241
    v_cvt_pk_bf16_f32 v89, v242, v243
    v_cvt_pk_bf16_f32 v90, v244, v245
    v_cvt_pk_bf16_f32 v91, v246, v247
    buffer_store_dwordx4 v[88:91], v1, s[4:7], s30 offen sc1
    v_cvt_pk_bf16_f32 v92, v248, v249
    v_cvt_pk_bf16_f32 v93, v250, v251
    v_cvt_pk_bf16_f32 v94, v252, v253
    v_cvt_pk_bf16_f32 v95, v254, v255
    v_lshlrev_b32 v248, 16, v92
    v_and_b32 v249, 0xffff0000, v92
    v_lshlrev_b32 v250, 16, v93
    v_and_b32 v251, 0xffff0000, v93
    v_lshlrev_b32 v252, 16, v94
    v_and_b32 v253, 0xffff0000, v94
    v_lshlrev_b32 v254, 16, v95
    v_and_b32 v255, 0xffff0000, v95
    v_mul_f32 v96, s54, v248
    v_mul_f32 v97, s54, v249
    v_mul_f32 v98, s54, v250
    v_mul_f32 v99, s54, v251
    v_mul_f32 v100, s54, v252
    v_mul_f32 v101, s54, v253
    v_mul_f32 v102, s54, v254
    v_mul_f32 v103, s54, v255
    v_exp_f32 v96, v96
    v_exp_f32 v97, v97
    v_exp_f32 v98, v98
    v_exp_f32 v99, v99
    v_exp_f32 v100, v100
    v_exp_f32 v101, v101
    v_exp_f32 v102, v102
    v_exp_f32 v103, v103
    v_add_f32 v96, 1.0, v96
    v_add_f32 v97, 1.0, v97
    v_add_f32 v98, 1.0, v98
    v_add_f32 v99, 1.0, v99
    v_add_f32 v100, 1.0, v100
    v_add_f32 v101, 1.0, v101
    v_add_f32 v102, 1.0, v102
    v_add_f32 v103, 1.0, v103
    v_rcp_f32 v96, v96
    v_rcp_f32 v97, v97
    v_rcp_f32 v98, v98
    v_rcp_f32 v99, v99
    v_rcp_f32 v100, v100
    v_rcp_f32 v101, v101
    v_rcp_f32 v102, v102
    v_rcp_f32 v103, v103
    v_mul_f32 v248, v248, v96
    v_mul_f32 v249, v249, v97
    v_mul_f32 v250, v250, v98
    v_mul_f32 v251, v251, v99
    v_mul_f32 v252, v252, v100
    v_mul_f32 v253, v253, v101
    v_mul_f32 v254, v254, v102
    v_mul_f32 v255, v255, v103
    v_cvt_pk_bf16_f32 v92, v248, v249
    v_cvt_pk_bf16_f32 v93, v250, v251
    v_cvt_pk_bf16_f32 v94, v252, v253
    v_cvt_pk_bf16_f32 v95, v254, v255
    buffer_store_dwordx4 v[92:95], v19, s[4:7], s30 offen sc1
    s_waitcnt lgkmcnt(0)
    v_or3_b32 v24, v24, v25, v26
    v_or3_b32 v28, v28, v29, v30
    v_or3_b32 v24, v24, v27, v31
    v_or_b32 v24, v24, v28
    s_mov_b32 s28, s51
    s_mov_b32 s57, s53
    v_readfirstlane_b32 s30, v24
    s_cmp_lg_u32 s30, 0
    s_cbranch_scc1 w_drain
    s_mov_b32 s48, s32
    s_cmp_ge_u32 s32, 4
    s_cselect_b32 s30, 2, 3
    s_lshl_b32 s30, s26, s30
    s_mul_i32 s30, s30, s43
    s_add_u32 s49, s42, s30
    s_mov_b32 s50, s43
    s_mov_b32 s51, s46
    s_mov_b32 s23, s41
    s_mov_b32 s53, s47
    s_nop 0
    s_load_dwordx16 s[32:47], s[24:25], 0
    s_add_u32 s24, s24, 64
    s_addc_u32 s25, s25, 0
    s_branch w_first16
w_firstH:
    s_waitcnt vmcnt(8)
    s_barrier
    s_add_u32 m0, s21, 0
    s_nop 0
    buffer_load_dwordx4 v1, s[4:7], s16 offen sc1 lds
    s_add_u32 s16, s16, s62
    s_add_u32 m0, s21, 1024
    s_nop 0
    buffer_load_dwordx4 v1, s[4:7], s17 offen sc1 lds
    s_add_u32 s17, s17, s62
    s_add_u32 m0, s22, 0
    s_nop 0
    buffer_load_dwordx4 v2, s[8:11], s18 offen lds
    s_add_u32 s18, s18, s20
    s_add_u32 m0, s22, 8192
    s_nop 0
    buffer_load_dwordx4 v2, s[12:15], s19 offen lds
    s_add_u32 s19, s19, s20
    v_mfma_f32_16x16x32_bf16 v[128:131], v[64:67], v[32:35], 0
    ds_read_b64_tr_b16 v[112:113], v8 offset:49152
    v_mfma_f32_16x16x32_bf16 v[132:135], v[68:71], v[32:35], 0
    ds_read_b64_tr_b16 v[114:115], v9 offset:49152
    v_mfma_f32_16x16x32_bf16 v[144:147], v[64:67], v[40:43], 0
    ds_read_b64_tr_b16 v[116:117], v10 offset:49152
    v_mfma_f32_16x16x32_bf16 v[148:151], v[68:71], v[40:43], 0
    ds_read_b64_tr_b16 v[118:119], v11 offset:49152
    v_mfma_f32_16x16x32_bf16 v[160:163], v[64:67], v[48:51], 0
    ds_read_b64_tr_b16 v[120:121], v8 offset:57344
    v_mfma_f32_16x16x32_bf16 v[164:167], v[68:71], v[48:51], 0
    ds_read_b64_tr_b16 v[122:123], v9 offset:57344
    v_mfma_f32_16x16x32_bf16 v[176:179], v[64:67], v[56:59], 0
    ds_read_b64_tr_b16 v[124:125], v10 offset:57344
    v_mfma_f32_16x16x32_bf16 v[180:183], v[68:71], v[56:59], 0
    ds_read_b64_tr_b16 v[126:127], v11 offset:57344
    v_mfma_f32_16x16x32_bf16 v[128:131], v[72:75], v[36:39], v[128:131]
    ds_read_b128 v[80:83], v5 offset:32768
    v_mfma_f32_16x16x32_bf16 v[132:135], v[76:79], v[36:39], v[132:135]
    ds_read_b128 v[84:87], v5 offset:33792
    v_mfma_f32_16x16x32_bf16 v[144:147], v[72:75], v[44:47], v[144:147]
    ds_read_b128 v[88:91], v5 offset:34816
    v_mfma_f32_16x16x32_bf16 v[148:151], v[76:79], v[44:47], v[148:151]
    ds_read_b128 v[92:95], v5 offset:35840
    v_mfma_f32_16x16x32_bf16 v[160:163], v[72:75], v[52:55], v[160:163]
    ds_read_b128 v[96:99], v5 offset:36864
    v_mfma_f32_16x16x32_bf16 v[164:167], v[76:79], v[52:55], v[164:167]
    ds_read_b128 v[100:103], v5 offset:37888
    v_mfma_f32_16x16x32_bf16 v[176:179], v[72:75], v[60:63], v[176:179]
    ds_read_b128 v[104:107], v5 offset:38912
    v_mfma_f32_16x16x32_bf16 v[180:183], v[76:79], v[60:63], v[180:183]
    ds_read_b128 v[108:111], v5 offset:39936
    s_waitcnt lgkmcnt(0)
    s_waitcnt vmcnt(8)
    s_barrier
    s_add_u32 m0, s21, 32768
    s_nop 0
    buffer_load_dwordx4 v1, s[4:7], s16 offen sc1 lds
    s_add_u32 s16, s16, s62
    s_add_u32 m0, s21, 33792
    s_nop 0
    buffer_load_dwordx4 v1, s[4:7], s17 offen sc1 lds
    s_add_u32 s17, s17, s62
    s_add_u32 m0, s22, 32768
    s_nop 0
    buffer_load_dwordx4 v2, s[8:11], s18 offen lds
    s_add_u32 s18, s18, s20
    s_add_u32 m0, s22, 40960
    s_nop 0
    buffer_load_dwordx4 v2, s[12:15], s19 offen lds
    s_add_u32 s19, s19, s20
    v_mfma_f32_16x16x32_bf16 v[128:131], v[112:115], v[80:83], v[128:131]
    ds_read_b64_tr_b16 v[64:65], v12 offset:16384
    v_mfma_f32_16x16x32_bf16 v[132:135], v[116:119], v[80:83], v[132:135]
    ds_read_b64_tr_b16 v[66:67], v13 offset:16384
    v_mfma_f32_16x16x32_bf16 v[144:147], v[112:115], v[88:91], v[144:147]
    ds_read_b64_tr_b16 v[68:69], v14 offset:16384
    v_mfma_f32_16x16x32_bf16 v[148:151], v[116:119], v[88:91], v[148:151]
    ds_read_b64_tr_b16 v[70:71], v15 offset:16384
    v_mfma_f32_16x16x32_bf16 v[160:163], v[112:115], v[96:99], v[160:163]
    ds_read_b64_tr_b16 v[72:73], v12 offset:24576
    v_mfma_f32_16x16x32_bf16 v[164:167], v[116:119], v[96:99], v[164:167]
    ds_read_b64_tr_b16 v[74:75], v13 offset:24576
    v_mfma_f32_16x16x32_bf16 v[176:179], v[112:115], v[104:107], v[176:179]
    ds_read_b64_tr_b16 v[76:77], v14 offset:24576
    v_mfma_f32_16x16x32_bf16 v[180:183], v[116:119], v[104:107], v[180:183]
    ds_read_b64_tr_b16 v[78:79], v15 offset:24576
    v_mfma_f32_16x16x32_bf16 v[128:131], v[120:123], v[84:87], v[128:131]
    ds_read_b128 v[32:35], v6 offset:0
    v_mfma_f32_16x16x32_bf16 v[132:135], v[124:127], v[84:87], v[132:135]
    ds_read_b128 v[36:39], v6 offset:1024
    v_mfma_f32_16x16x32_bf16 v[144:147], v[120:123], v[92:95], v[144:147]
    ds_read_b128 v[40:43], v6 offset:2048
    v_mfma_f32_16x16x32_bf16 v[148:151], v[124:127], v[92:95], v[148:151]
    ds_read_b128 v[44:47], v6 offset:3072
    v_mfma_f32_16x16x32_bf16 v[160:163], v[120:123], v[100:103], v[160:163]
    ds_read_b128 v[48:51], v6 offset:4096
    v_mfma_f32_16x16x32_bf16 v[164:167], v[124:127], v[100:103], v[164:167]
    ds_read_b128 v[52:55], v6 offset:5120
    v_mfma_f32_16x16x32_bf16 v[176:179], v[120:123], v[108:111], v[176:179]
    ds_read_b128 v[56:59], v6 offset:6144
    v_mfma_f32_16x16x32_bf16 v[180:183], v[124:127], v[108:111], v[180:183]
    ds_read_b128 v[60:63], v6 offset:7168
    s_waitcnt lgkmcnt(0)
    s_waitcnt vmcnt(8)
    s_barrier
    s_add_u32 m0, s21, 65536
    s_nop 0
    buffer_load_dwordx4 v1, s[4:7], s16 offen sc1 lds
    s_add_u32 s16, s16, s62
    s_add_u32 m0, s21, 66560
    s_nop 0
    buffer_load_dwordx4 v1, s[4:7], s17 offen sc1 lds
    s_add_u32 s17, s17, s62
    s_add_u32 m0, s22, 65536
    s_nop 0
    buffer_load_dwordx4 v2, s[8:11], s18 offen lds
    s_add_u32 s18, s18, s20
    s_add_u32 m0, s22, 73728
    s_nop 0
    buffer_load_dwordx4 v2, s[12:15], s19 offen lds
    s_add_u32 s19, s19, s20
    v_mfma_f32_16x16x32_bf16 v[128:131], v[64:67], v[32:35], v[128:131]
    ds_read_b64_tr_b16 v[112:113], v12 offset:49152
    v_mfma_f32_16x16x32_bf16 v[132:135], v[68:71], v[32:35], v[132:135]
    ds_read_b64_tr_b16 v[114:115], v13 offset:49152
    v_mfma_f32_16x16x32_bf16 v[144:147], v[64:67], v[40:43], v[144:147]
    ds_read_b64_tr_b16 v[116:117], v14 offset:49152
    v_mfma_f32_16x16x32_bf16 v[148:151], v[68:71], v[40:43], v[148:151]
    ds_read_b64_tr_b16 v[118:119], v15 offset:49152
    v_mfma_f32_16x16x32_bf16 v[160:163], v[64:67], v[48:51], v[160:163]
    ds_read_b64_tr_b16 v[120:121], v12 offset:57344
    v_mfma_f32_16x16x32_bf16 v[164:167], v[68:71], v[48:51], v[164:167]
    ds_read_b64_tr_b16 v[122:123], v13 offset:57344
    v_mfma_f32_16x16x32_bf16 v[176:179], v[64:67], v[56:59], v[176:179]
    ds_read_b64_tr_b16 v[124:125], v14 offset:57344
    v_mfma_f32_16x16x32_bf16 v[180:183], v[68:71], v[56:59], v[180:183]
    ds_read_b64_tr_b16 v[126:127], v15 offset:57344
    v_mfma_f32_16x16x32_bf16 v[128:131], v[72:75], v[36:39], v[128:131]
    ds_read_b128 v[80:83], v6 offset:32768
    v_mfma_f32_16x16x32_bf16 v[132:135], v[76:79], v[36:39], v[132:135]
    ds_read_b128 v[84:87], v6 offset:33792
    v_mfma_f32_16x16x32_bf16 v[144:147], v[72:75], v[44:47], v[144:147]
    ds_read_b128 v[88:91], v6 offset:34816
    v_mfma_f32_16x16x32_bf16 v[148:151], v[76:79], v[44:47], v[148:151]
    ds_read_b128 v[92:95], v6 offset:35840
    v_mfma_f32_16x16x32_bf16 v[160:163], v[72:75], v[52:55], v[160:163]
    ds_read_b128 v[96:99], v6 offset:36864
    v_mfma_f32_16x16x32_bf16 v[164:167], v[76:79], v[52:55], v[164:167]
    ds_read_b128 v[100:103], v6 offset:37888
    v_mfma_f32_16x16x32_bf16 v[176:179], v[72:75], v[60:63], v[176:179]
    ds_read_b128 v[104:107], v6 offset:38912
    v_mfma_f32_16x16x32_bf16 v[180:183], v[76:79], v[60:63], v[180:183]
    ds_read_b128 v[108:111], v6 offset:39936
    s_waitcnt lgkmcnt(0)
    s_waitcnt vmcnt(8)
    s_barrier
    s_add_u32 m0, s21, 98304
    s_nop 0
    buffer_load_dwordx4 v1, s[4:7], s16 offen sc1 lds
    s_add_u32 s16, s16, s62
    s_add_u32 m0, s21, 99328
    s_nop 0
    buffer_load_dwordx4 v1, s[4:7], s17 offen sc1 lds
    s_add_u32 s17, s17, s62
    s_add_u32 m0, s22, 98304
    s_nop 0
    buffer_load_dwordx4 v2, s[8:11], s18 offen lds
    s_add_u32 s18, s18, s20
    s_add_u32 m0, s22, 106496
    s_nop 0
    buffer_load_dwordx4 v2, s[12:15], s19 offen lds
    s_add_u32 s19, s19, s20
    v_mfma_f32_16x16x32_bf16 v[128:131], v[112:115], v[80:83], v[128:131]
    ds_read_b64_tr_b16 v[64:65], v8 offset:16384
    v_mfma_f32_16x16x32_bf16 v[132:135], v[116:119], v[80:83], v[132:135]
    ds_read_b64_tr_b16 v[66:67], v9 offset:16384
    v_mfma_f32_16x16x32_bf16 v[144:147], v[112:115], v[88:91], v[144:147]
    ds_read_b64_tr_b16 v[68:69], v10 offset:16384
    v_mfma_f32_16x16x32_bf16 v[148:151], v[116:119], v[88:91], v[148:151]
    ds_read_b64_tr_b16 v[70:71], v11 offset:16384
    v_mfma_f32_16x16x32_bf16 v[160:163], v[112:115], v[96:99], v[160:163]
    ds_read_b64_tr_b16 v[72:73], v8 offset:24576
    v_mfma_f32_16x16x32_bf16 v[164:167], v[116:119], v[96:99], v[164:167]
    ds_read_b64_tr_b16 v[74:75], v9 offset:24576
    v_mfma_f32_16x16x32_bf16 v[176:179], v[112:115], v[104:107], v[176:179]
    ds_read_b64_tr_b16 v[76:77], v10 offset:24576
    v_mfma_f32_16x16x32_bf16 v[180:183], v[116:119], v[104:107], v[180:183]
    ds_read_b64_tr_b16 v[78:79], v11 offset:24576
    v_mfma_f32_16x16x32_bf16 v[128:131], v[120:123], v[84:87], v[128:131]
    ds_read_b128 v[32:35], v5 offset:0
    v_mfma_f32_16x16x32_bf16 v[132:135], v[124:127], v[84:87], v[132:135]
    ds_read_b128 v[36:39], v5 offset:1024
    v_mfma_f32_16x16x32_bf16 v[144:147], v[120:123], v[92:95], v[144:147]
    ds_read_b128 v[40:43], v5 offset:2048
    v_mfma_f32_16x16x32_bf16 v[148:151], v[124:127], v[92:95], v[148:151]
    ds_read_b128 v[44:47], v5 offset:3072
    v_mfma_f32_16x16x32_bf16 v[160:163], v[120:123], v[100:103], v[160:163]
    ds_read_b128 v[48:51], v5 offset:4096
    v_mfma_f32_16x16x32_bf16 v[164:167], v[124:127], v[100:103], v[164:167]
    ds_read_b128 v[52:55], v5 offset:5120
    v_mfma_f32_16x16x32_bf16 v[176:179], v[120:123], v[108:111], v[176:179]
    ds_read_b128 v[56:59], v5 offset:6144
    v_mfma_f32_16x16x32_bf16 v[180:183], v[124:127], v[108:111], v[180:183]
    ds_read_b128 v[60:63], v5 offset:7168
    s_waitcnt lgkmcnt(0)
w_loop_chkH:
    s_sub_u32 s23, s23, 1
w_loopH:
    s_cmp_lg_u32 s23, 1
    s_cbranch_scc1 w_bodyH
    buffer_load_dword v22, off, s[64:67], 0 sc1
    v_readfirstlane_b32 s30, v16
    s_cmp_ge_u32 s30, s45
    s_cselect_b32 s30, 0, 1
    s_or_b32 s30, s30, s70
    s_cmp_ge_u32 s32, 4
    s_cselect_b32 s30, 1, s30
    s_cmp_eq_u32 s32, 0
    s_cselect_b32 s30, 1, s30
    v_mov_b32 v20, s30
    ds_write_b32 v7, v20
    s_cbranch_scc1 w_bodyH
    s_load_dwordx2 s[8:9], s[0:1], s33
    s_load_dwordx2 s[12:13], s[0:1], s34
    s_mov_b32 s10, s38
    s_mov_b32 s14, s38
    s_cmp_ge_u32 s32, 4
    s_cselect_b32 s31, 0, 1
    s_lshl_b32 s30, s3, s31
    s_mul_i32 s30, s30, s40
    s_add_u32 s16, s39, s30
    s_cmp_eq_u32 s32, 4
    s_cselect_b32 s30, 1024, s40
    s_cselect_b32 s31, 6, 5
    s_lshl_b32 s62, 32, s31
    s_add_u32 s17, s16, s30
    s_lshl_b32 s30, s3, 2
    s_mul_i32 s30, s30, s35
    s_add_u32 s18, s36, s30
    s_add_u32 s19, s37, s30
    s_lshl_b32 s20, s35, s31
    v_mul_u32_u24 v2, s35, v4
    v_add_u32 v2, v2, v3
    s_waitcnt lgkmcnt(0)
w_bodyH:
    s_waitcnt vmcnt(8)
    s_barrier
    s_add_u32 m0, s21, 0
    s_nop 0
    buffer_load_dwordx4 v1, s[4:7], s16 offen sc1 lds
    s_add_u32 s16, s16, s62
    s_add_u32 m0, s21, 1024
    s_nop 0
    buffer_load_dwordx4 v1, s[4:7], s17 offen sc1 lds
    s_add_u32 s17, s17, s62
    s_add_u32 m0, s22, 0
    s_nop 0
    buffer_load_dwordx4 v2, s[8:11], s18 offen lds
    s_add_u32 s18, s18, s20
    s_add_u32 m0, s22, 8192
    s_nop 0
    buffer_load_dwordx4 v2, s[12:15], s19 offen lds
    s_add_u32 s19, s19, s20
    v_mfma_f32_16x16x32_bf16 v[128:131], v[64:67], v[32:35], v[128:131]
    ds_read_b64_tr_b16 v[112:113], v8 offset:49152
    v_mfma_f32_16x16x32_bf16 v[132:135], v[68:71], v[32:35], v[132:135]
    ds_read_b64_tr_b16 v[114:115], v9 offset:49152
    v_mfma_f32_16x16x32_bf16 v[144:147], v[64:67], v[40:43], v[144:147]
    ds_read_b64_tr_b16 v[116:117], v10 offset:49152
    v_mfma_f32_16x16x32_bf16 v[148:151], v[68:71], v[40:43], v[148:151]
    ds_read_b64_tr_b16 v[118:119], v11 offset:49152
    v_mfma_f32_16x16x32_bf16 v[160:163], v[64:67], v[48:51], v[160:163]
    ds_read_b64_tr_b16 v[120:121], v8 offset:57344
    v_mfma_f32_16x16x32_bf16 v[164:167], v[68:71], v[48:51], v[164:167]
    ds_read_b64_tr_b16 v[122:123], v9 offset:57344
    v_mfma_f32_16x16x32_bf16 v[176:179], v[64:67], v[56:59], v[176:179]
    ds_read_b64_tr_b16 v[124:125], v10 offset:57344
    v_mfma_f32_16x16x32_bf16 v[180:183], v[68:71], v[56:59], v[180:183]
    ds_read_b64_tr_b16 v[126:127], v11 offset:57344
    v_mfma_f32_16x16x32_bf16 v[128:131], v[72:75], v[36:39], v[128:131]
    ds_read_b128 v[80:83], v5 offset:32768
    v_mfma_f32_16x16x32_bf16 v[132:135], v[76:79], v[36:39], v[132:135]
    ds_read_b128 v[84:87], v5 offset:33792
    v_mfma_f32_16x16x32_bf16 v[144:147], v[72:75], v[44:47], v[144:147]
    ds_read_b128 v[88:91], v5 offset:34816
    v_mfma_f32_16x16x32_bf16 v[148:151], v[76:79], v[44:47], v[148:151]
    ds_read_b128 v[92:95], v5 offset:35840
    v_mfma_f32_16x16x32_bf16 v[160:163], v[72:75], v[52:55], v[160:163]
    ds_read_b128 v[96:99], v5 offset:36864
    v_mfma_f32_16x16x32_bf16 v[164:167], v[76:79], v[52:55], v[164:167]
    ds_read_b128 v[100:103], v5 offset:37888
    v_mfma_f32_16x16x32_bf16 v[176:179], v[72:75], v[60:63], v[176:179]
    ds_read_b128 v[104:107], v5 offset:38912
    v_mfma_f32_16x16x32_bf16 v[180:183], v[76:79], v[60:63], v[180:183]
    ds_read_b128 v[108:111], v5 offset:39936
    buffer_load_dword v16, v17, s[4:7], s44 offen sc1
    s_waitcnt lgkmcnt(0)
    s_waitcnt vmcnt(8)
    s_barrier
    s_add_u32 m0, s21, 32768
    s_nop 0
    buffer_load_dwordx4 v1, s[4:7], s16 offen sc1 lds
    s_add_u32 s16, s16, s62
    s_add_u32 m0, s21, 33792
    s_nop 0
    buffer_load_dwordx4 v1, s[4:7], s17 offen sc1 lds
    s_add_u32 s17, s17, s62
    s_add_u32 m0, s22, 32768
    s_nop 0
    buffer_load_dwordx4 v2, s[8:11], s18 offen lds
    s_add_u32 s18, s18, s20
    s_add_u32 m0, s22, 40960
    s_nop 0
    buffer_load_dwordx4 v2, s[12:15], s19 offen lds
    s_add_u32 s19, s19, s20
    v_mfma_f32_16x16x32_bf16 v[128:131], v[112:115], v[80:83], v[128:131]
    ds_read_b64_tr_b16 v[64:65], v12 offset:16384
    v_mfma_f32_16x16x32_bf16 v[132:135], v[116:119], v[80:83], v[132:135]
    ds_read_b64_tr_b16 v[66:67], v13 offset:16384
    v_mfma_f32_16x16x32_bf16 v[144:147], v[112:115], v[88:91], v[144:147]
    ds_read_b64_tr_b16 v[68:69], v14 offset:16384
    v_mfma_f32_16x16x32_bf16 v[148:151], v[116:119], v[88:91], v[148:151]
    ds_read_b64_tr_b16 v[70:71], v15 offset:16384
    v_mfma_f32_16x16x32_bf16 v[160:163], v[112:115], v[96:99], v[160:163]
    ds_read_b64_tr_b16 v[72:73], v12 offset:24576
    v_mfma_f32_16x16x32_bf16 v[164:167], v[116:119], v[96:99], v[164:167]
    ds_read_b64_tr_b16 v[74:75], v13 offset:24576
    v_mfma_f32_16x16x32_bf16 v[176:179], v[112:115], v[104:107], v[176:179]
    ds_read_b64_tr_b16 v[76:77], v14 offset:24576
    v_mfma_f32_16x16x32_bf16 v[180:183], v[116:119], v[104:107], v[180:183]
    ds_read_b64_tr_b16 v[78:79], v15 offset:24576
    v_mfma_f32_16x16x32_bf16 v[128:131], v[120:123], v[84:87], v[128:131]
    ds_read_b128 v[32:35], v6 offset:0
    v_mfma_f32_16x16x32_bf16 v[132:135], v[124:127], v[84:87], v[132:135]
    ds_read_b128 v[36:39], v6 offset:1024
    v_mfma_f32_16x16x32_bf16 v[144:147], v[120:123], v[92:95], v[144:147]
    ds_read_b128 v[40:43], v6 offset:2048
    v_mfma_f32_16x16x32_bf16 v[148:151], v[124:127], v[92:95], v[148:151]
    ds_read_b128 v[44:47], v6 offset:3072
    v_mfma_f32_16x16x32_bf16 v[160:163], v[120:123], v[100:103], v[160:163]
    ds_read_b128 v[48:51], v6 offset:4096
    v_mfma_f32_16x16x32_bf16 v[164:167], v[124:127], v[100:103], v[164:167]
    ds_read_b128 v[52:55], v6 offset:5120
    v_mfma_f32_16x16x32_bf16 v[176:179], v[120:123], v[108:111], v[176:179]
    ds_read_b128 v[56:59], v6 offset:6144
    v_mfma_f32_16x16x32_bf16 v[180:183], v[124:127], v[108:111], v[180:183]
    ds_read_b128 v[60:63], v6 offset:7168
    s_waitcnt lgkmcnt(0)
    s_waitcnt vmcnt(8)
    s_barrier
    s_add_u32 m0, s21, 65536
    s_nop 0
    buffer_load_dwordx4 v1, s[4:7], s16 offen sc1 lds
    s_add_u32 s16, s16, s62
    s_add_u32 m0, s21, 66560
    s_nop 0
    buffer_load_dwordx4 v1, s[4:7], s17 offen sc1 lds
    s_add_u32 s17, s17, s62
    s_add_u32 m0, s22, 65536
    s_nop 0
    buffer_load_dwordx4 v2, s[8:11], s18 offen lds
    s_add_u32 s18, s18, s20
    s_add_u32 m0, s22, 73728
    s_nop 0
    buffer_load_dwordx4 v2, s[12:15], s19 offen lds
    s_add_u32 s19, s19, s20
    v_mfma_f32_16x16x32_bf16 v[128:131], v[64:67], v[32:35], v[128:131]
    ds_read_b64_tr_b16 v[112:113], v12 offset:49152
    v_mfma_f32_16x16x32_bf16 v[132:135], v[68:71], v[32:35], v[132:135]
    ds_read_b64_tr_b16 v[114:115], v13 offset:49152
    v_mfma_f32_16x16x32_bf16 v[144:147], v[64:67], v[40:43], v[144:147]
    ds_read_b64_tr_b16 v[116:117], v14 offset:49152
    v_mfma_f32_16x16x32_bf16 v[148:151], v[68:71], v[40:43], v[148:151]
    ds_read_b64_tr_b16 v[118:119], v15 offset:49152
    v_mfma_f32_16x16x32_bf16 v[160:163], v[64:67], v[48:51], v[160:163]
    ds_read_b64_tr_b16 v[120:121], v12 offset:57344
    v_mfma_f32_16x16x32_bf16 v[164:167], v[68:71], v[48:51], v[164:167]
    ds_read_b64_tr_b16 v[122:123], v13 offset:57344
    v_mfma_f32_16x16x32_bf16 v[176:179], v[64:67], v[56:59], v[176:179]
    ds_read_b64_tr_b16 v[124:125], v14 offset:57344
    v_mfma_f32_16x16x32_bf16 v[180:183], v[68:71], v[56:59], v[180:183]
    ds_read_b64_tr_b16 v[126:127], v15 offset:57344
    v_mfma_f32_16x16x32_bf16 v[128:131], v[72:75], v[36:39], v[128:131]
    ds_read_b128 v[80:83], v6 offset:32768
    v_mfma_f32_16x16x32_bf16 v[132:135], v[76:79], v[36:39], v[132:135]
    ds_read_b128 v[84:87], v6 offset:33792
    v_mfma_f32_16x16x32_bf16 v[144:147], v[72:75], v[44:47], v[144:147]
    ds_read_b128 v[88:91], v6 offset:34816
    v_mfma_f32_16x16x32_bf16 v[148:151], v[76:79], v[44:47], v[148:151]
    ds_read_b128 v[92:95], v6 offset:35840
    v_mfma_f32_16x16x32_bf16 v[160:163], v[72:75], v[52:55], v[160:163]
    ds_read_b128 v[96:99], v6 offset:36864
    v_mfma_f32_16x16x32_bf16 v[164:167], v[76:79], v[52:55], v[164:167]
    ds_read_b128 v[100:103], v6 offset:37888
    v_mfma_f32_16x16x32_bf16 v[176:179], v[72:75], v[60:63], v[176:179]
    ds_read_b128 v[104:107], v6 offset:38912
    v_mfma_f32_16x16x32_bf16 v[180:183], v[76:79], v[60:63], v[180:183]
    ds_read_b128 v[108:111], v6 offset:39936
    s_waitcnt lgkmcnt(0)
    s_waitcnt vmcnt(8)
    s_barrier
    s_add_u32 m0, s21, 98304
    s_nop 0
    buffer_load_dwordx4 v1, s[4:7], s16 offen sc1 lds
    s_add_u32 s16, s16, s62
    s_add_u32 m0, s21, 99328
    s_nop 0
    buffer_load_dwordx4 v1, s[4:7], s17 offen sc1 lds
    s_add_u32 s17, s17, s62
    s_add_u32 m0, s22, 98304
    s_nop 0
    buffer_load_dwordx4 v2, s[8:11], s18 offen lds
    s_add_u32 s18, s18, s20
    s_add_u32 m0, s22, 106496
    s_nop 0
    buffer_load_dwordx4 v2, s[12:15], s19 offen lds
    s_add_u32 s19, s19, s20
    v_mfma_f32_16x16x32_bf16 v[128:131], v[112:115], v[80:83], v[128:131]
    ds_read_b64_tr_b16 v[64:65], v8 offset:16384
    v_mfma_f32_16x16x32_bf16 v[132:135], v[116:119], v[80:83], v[132:135]
    ds_read_b64_tr_b16 v[66:67], v9 offset:16384
    v_mfma_f32_16x16x32_bf16 v[144:147], v[112:115], v[88:91], v[144:147]
    ds_read_b64_tr_b16 v[68:69], v10 offset:16384
    v_mfma_f32_16x16x32_bf16 v[148:151], v[116:119], v[88:91], v[148:151]
    ds_read_b64_tr_b16 v[70:71], v11 offset:16384
    v_mfma_f32_16x16x32_bf16 v[160:163], v[112:115], v[96:99], v[160:163]
    ds_read_b64_tr_b16 v[72:73], v8 offset:24576
    v_mfma_f32_16x16x32_bf16 v[164:167], v[116:119], v[96:99], v[164:167]
    ds_read_b64_tr_b16 v[74:75], v9 offset:24576
    v_mfma_f32_16x16x32_bf16 v[176:179], v[112:115], v[104:107], v[176:179]
    ds_read_b64_tr_b16 v[76:77], v10 offset:24576
    v_mfma_f32_16x16x32_bf16 v[180:183], v[116:119], v[104:107], v[180:183]
    ds_read_b64_tr_b16 v[78:79], v11 offset:24576
    v_mfma_f32_16x16x32_bf16 v[128:131], v[120:123], v[84:87], v[128:131]
    ds_read_b128 v[32:35], v5 offset:0
    v_mfma_f32_16x16x32_bf16 v[132:135], v[124:127], v[84:87], v[132:135]
    ds_read_b128 v[36:39], v5 offset:1024
    v_mfma_f32_16x16x32_bf16 v[144:147], v[120:123], v[92:95], v[144:147]
    ds_read_b128 v[40:43], v5 offset:2048
    v_mfma_f32_16x16x32_bf16 v[148:151], v[124:127], v[92:95], v[148:151]
    ds_read_b128 v[44:47], v5 offset:3072
    v_mfma_f32_16x16x32_bf16 v[160:163], v[120:123], v[100:103], v[160:163]
    ds_read_b128 v[48:51], v5 offset:4096
    v_mfma_f32_16x16x32_bf16 v[164:167], v[124:127], v[100:103], v[164:167]
    ds_read_b128 v[52:55], v5 offset:5120
    v_mfma_f32_16x16x32_bf16 v[176:179], v[120:123], v[108:111], v[176:179]
    ds_read_b128 v[56:59], v5 offset:6144
    v_mfma_f32_16x16x32_bf16 v[180:183], v[124:127], v[108:111], v[180:183]
    ds_read_b128 v[60:63], v5 offset:7168
    s_waitcnt lgkmcnt(0)
    s_sub_u32 s23, s23, 1
    s_cmp_lg_u32 s23, 0
    s_cbranch_scc1 w_loopH
    v_mov_b32 v20, 131072
    ds_read_b128 v[24:27], v20
    ds_read_b128 v[28:31], v20 offset:16
    s_cmp_lg_u32 s53, s53
    s_cbranch_scc1 w_epi_siluH
    s_lshl_b32 s30, s27, 10
    s_add_u32 s30, s30, s49
    s_nop 7
    v_cvt_pk_bf16_f32 v80, v128, v129
    v_cvt_pk_bf16_f32 v81, v130, v131
    v_cvt_pk_bf16_f32 v82, v132, v133
    v_cvt_pk_bf16_f32 v83, v134, v135
    buffer_store_dwordx4 v[80:83], v1, s[4:7], s30 offen sc1
    s_add_u32 s30, s30, s50
    v_cvt_pk_bf16_f32 v84, v144, v145
    v_cvt_pk_bf16_f32 v85, v146, v147
    v_cvt_pk_bf16_f32 v86, v148, v149
    v_cvt_pk_bf16_f32 v87, v150, v151
    buffer_store_dwordx4 v[84:87], v1, s[4:7], s30 offen sc1
    s_add_u32 s30, s30, s50
    v_cvt_pk_bf16_f32 v88, v160, v161
    v_cvt_pk_bf16_f32 v89, v162, v163
    v_cvt_pk_bf16_f32 v90, v164, v165
    v_cvt_pk_bf16_f32 v91, v166, v167
    buffer_store_dwordx4 v[88:91], v1, s[4:7], s30 offen sc1
    s_add_u32 s30, s30, s50
    v_cvt_pk_bf16_f32 v92, v176, v177
    v_cvt_pk_bf16_f32 v93, v178, v179
    v_cvt_pk_bf16_f32 v94, v180, v181
    v_cvt_pk_bf16_f32 v95, v182, v183
    buffer_store_dwordx4 v[92:95], v1, s[4:7], s30 offen sc1
    s_add_u32 s30, s30, s50
    s_waitcnt lgkmcnt(0)
    v_or3_b32 v24, v24, v25, v26
    v_or3_b32 v28, v28, v29, v30
    v_or3_b32 v24, v24, v27, v31
    v_or_b32 v24, v24, v28
    s_mov_b32 s28, s51
    s_mov_b32 s57, s53
    v_readfirstlane_b32 s30, v24
    s_cmp_lg_u32 s30, 0
    s_cbranch_scc1 w_drain
    s_mov_b32 s48, s32
    s_cmp_ge_u32 s32, 4
    s_cselect_b32 s30, 2, 3
    s_lshl_b32 s30, s26, s30
    s_mul_i32 s30, s30, s43
    s_add_u32 s49, s42, s30
    s_mov_b32 s50, s43
    s_mov_b32 s51, s46
    s_mov_b32 s23, s41
    s_mov_b32 s53, s47
    s_nop 0
    s_load_dwordx16 s[32:47], s[24:25], 0
    s_add_u32 s24, s24, 64
    s_addc_u32 s25, s25, 0
    s_branch w_first4
w_epi_siluH:
    s_lshl_b32 s30, s27, 10
    s_add_u32 s30, s30, s49
    s_mov_b32 s54, 0xbfb8aa3b
    s_nop 7
    v_cvt_pk_bf16_f32 v80, v128, v129
    v_cvt_pk_bf16_f32 v81, v130, v131
    v_cvt_pk_bf16_f32 v82, v132, v133
    v_cvt_pk_bf16_f32 v83, v134, v135
    v_lshlrev_b32 v128, 16, v80
    v_and_b32 v129, 0xffff0000, v80
    v_lshlrev_b32 v130, 16, v81
    v_and_b32 v131, 0xffff0000, v81
    v_lshlrev_b32 v132, 16, v82
    v_and_b32 v133, 0xffff0000, v82
    v_lshlrev_b32 v134, 16, v83
    v_and_b32 v135, 0xffff0000, v83
    v_mul_f32 v104, s54, v128
    v_mul_f32 v105, s54, v129
    v_mul_f32 v106, s54, v130
    v_mul_f32 v107, s54, v131
    v_mul_f32 v108, s54, v132
    v_mul_f32 v109, s54, v133
    v_mul_f32 v110, s54, v134
    v_mul_f32 v111, s54, v135
    v_exp_f32 v104, v104
    v_exp_f32 v105, v105
    v_exp_f32 v106, v106
    v_exp_f32 v107, v107
    v_exp_f32 v108, v108
    v_exp_f32 v109, v109
    v_exp_f32 v110, v110
    v_exp_f32 v111, v111
    v_add_f32 v104, 1.0, v104
    v_add_f32 v105, 1.0, v105
    v_add_f32 v106, 1.0, v106
    v_add_f32 v107, 1.0, v107
    v_add_f32 v108, 1.0, v108
    v_add_f32 v109, 1.0, v109
    v_add_f32 v110, 1.0, v110
    v_add_f32 v111, 1.0, v111
    v_rcp_f32 v104, v104
    v_rcp_f32 v105, v105
    v_rcp_f32 v106, v106
    v_rcp_f32 v107, v107
    v_rcp_f32 v108, v108
    v_rcp_f32 v109, v109
    v_rcp_f32 v110, v110
    v_rcp_f32 v111, v111
    v_mul_f32 v128, v128, v104
    v_mul_f32 v129, v129, v105
    v_mul_f32 v130, v130, v106
    v_mul_f32 v131, v131, v107
    v_mul_f32 v132, v132, v108
    v_mul_f32 v133, v133, v109
    v_mul_f32 v134, v134, v110
    v_mul_f32 v135, v135, v111
    v_cvt_pk_bf16_f32 v80, v128, v129
    v_cvt_pk_bf16_f32 v81, v130, v131
    v_cvt_pk_bf16_f32 v82, v132, v133
    v_cvt_pk_bf16_f32 v83, v134, v135
    buffer_store_dwordx4 v[80:83], v1, s[4:7], s30 offen sc1
    s_add_u32 s30, s30, s50
    v_cvt_pk_bf16_f32 v84, v144, v145
    v_cvt_pk_bf16_f32 v85, v146, v147
    v_cvt_pk_bf16_f32 v86, v148, v149
    v_cvt_pk_bf16_f32 v87, v150, v151
    v_lshlrev_b32 v144, 16, v84
    v_and_b32 v145, 0xffff0000, v84
    v_lshlrev_b32 v146, 16, v85
    v_and_b32 v147, 0xffff0000, v85
    v_lshlrev_b32 v148, 16, v86
    v_and_b32 v149, 0xffff0000, v86
    v_lshlrev_b32 v150, 16, v87
    v_and_b32 v151, 0xffff0000, v87
    v_mul_f32 v96, s54, v144
    v_mul_f32 v97, s54, v145
    v_mul_f32 v98, s54, v146
    v_mul_f32 v99, s54, v147
    v_mul_f32 v100, s54, v148
    v_mul_f32 v101, s54, v149
    v_mul_f32 v102, s54, v150
    v_mul_f32 v103, s54, v151
    v_exp_f32 v96, v96
    v_exp_f32 v97, v97
    v_exp_f32 v98, v98
    v_exp_f32 v99, v99
    v_exp_f32 v100, v100
    v_exp_f32 v101, v101
    v_exp_f32 v102, v102
    v_exp_f32 v103, v103
    v_add_f32 v96, 1.0, v96
    v_add_f32 v97, 1.0, v97
    v_add_f32 v98, 1.0, v98
    v_add_f32 v99, 1.0, v99
    v_add_f32 v100, 1.0, v100
    v_add_f32 v101, 1.0, v101
    v_add_f32 v102, 1.0, v102
    v_add_f32 v103, 1.0, v103
    v_rcp_f32 v96, v96
    v_rcp_f32 v97, v97
    v_rcp_f32 v98, v98
    v_rcp_f32 v99, v99
    v_rcp_f32 v100, v100
    v_rcp_f32 v101, v101
    v_rcp_f32 v102, v102
    v_rcp_f32 v103, v103
    v_mul_f32 v144, v144, v96
    v_mul_f32 v145, v145, v97
    v_mul_f32 v146, v146, v98
    v_mul_f32 v147, v147, v99
    v_mul_f32 v148, v148, v100
    v_mul_f32 v149, v149, v101
    v_mul_f32 v150, v150, v102
    v_mul_f32 v151, v151, v103
    v_cvt_pk_bf16_f32 v84, v144, v145
    v_cvt_pk_bf16_f32 v85, v146, v147
    v_cvt_pk_bf16_f32 v86, v148, v149
    v_cvt_pk_bf16_f32 v87, v150, v151
    buffer_store_dwordx4 v[84:87], v1, s[4:7], s30 offen sc1
    s_add_u32 s30, s30, s50
    v_cvt_pk_bf16_f32 v88, v160, v161
    v_cvt_pk_bf16_f32 v89, v162, v163
    v_cvt_pk_bf16_f32 v90, v164, v165
    v_cvt_pk_bf16_f32 v91, v166, v167
    v_lshlrev_b32 v160, 16, v88
    v_and_b32 v161, 0xffff0000, v88
    v_lshlrev_b32 v162, 16, v89
    v_and_b32 v163, 0xffff0000, v89
    v_lshlrev_b32 v164, 16, v90
    v_and_b32 v165, 0xffff0000, v90
    v_lshlrev_b32 v166, 16, v91
    v_and_b32 v167, 0xffff0000, v91
    v_mul_f32 v104, s54, v160
    v_mul_f32 v105, s54, v161
    v_mul_f32 v106, s54, v162
    v_mul_f32 v107, s54, v163
    v_mul_f32 v108, s54, v164
    v_mul_f32 v109, s54, v165
    v_mul_f32 v110, s54, v166
    v_mul_f32 v111, s54, v167
    v_exp_f32 v104, v104
    v_exp_f32 v105, v105
    v_exp_f32 v106, v106
    v_exp_f32 v107, v107
    v_exp_f32 v108, v108
    v_exp_f32 v109, v109
    v_exp_f32 v110, v110
    v_exp_f32 v111, v111
    v_add_f32 v104, 1.0, v104
    v_add_f32 v105, 1.0, v105
    v_add_f32 v106, 1.0, v106
    v_add_f32 v107, 1.0, v107
    v_add_f32 v108, 1.0, v108
    v_add_f32 v109, 1.0, v109
    v_add_f32 v110, 1.0, v110
    v_add_f32 v111, 1.0, v111
    v_rcp_f32 v104, v104
    v_rcp_f32 v105, v105
    v_rcp_f32 v106, v106
    v_rcp_f32 v107, v107
    v_rcp_f32 v108, v108
    v_rcp_f32 v109, v109
    v_rcp_f32 v110, v110
    v_rcp_f32 v111, v111
    v_mul_f32 v160, v160, v104
    v_mul_f32 v161, v161, v105
    v_mul_f32 v162, v162, v106
    v_mul_f32 v163, v163, v107
    v_mul_f32 v164, v164, v108
    v_mul_f32 v165, v165, v109
    v_mul_f32 v166, v166, v110
    v_mul_f32 v167, v167, v111
    v_cvt_pk_bf16_f32 v88, v160, v161
    v_cvt_pk_bf16_f32 v89, v162, v163
    v_cvt_pk_bf16_f32 v90, v164, v165
    v_cvt_pk_bf16_f32 v91, v166, v167
    buffer_store_dwordx4 v[88:91], v1, s[4:7], s30 offen sc1
    s_add_u32 s30, s30, s50
    v_cvt_pk_bf16_f32 v92, v176, v177
    v_cvt_pk_bf16_f32 v93, v178, v179
    v_cvt_pk_bf16_f32 v94, v180, v181
    v_cvt_pk_bf16_f32 v95, v182, v183
    v_lshlrev_b32 v176, 16, v92
    v_and_b32 v177, 0xffff0000, v92
    v_lshlrev_b32 v178, 16, v93
    v_and_b32 v179, 0xffff0000, v93
    v_lshlrev_b32 v180, 16, v94
    v_and_b32 v181, 0xffff0000, v94
    v_lshlrev_b32 v182, 16, v95
    v_and_b32 v183, 0xffff0000, v95
    v_mul_f32 v96, s54, v176
    v_mul_f32 v97, s54, v177
    v_mul_f32 v98, s54, v178
    v_mul_f32 v99, s54, v179
    v_mul_f32 v100, s54, v180
    v_mul_f32 v101, s54, v181
    v_mul_f32 v102, s54, v182
    v_mul_f32 v103, s54, v183
    v_exp_f32 v96, v96
    v_exp_f32 v97, v97
    v_exp_f32 v98, v98
    v_exp_f32 v99, v99
    v_exp_f32 v100, v100
    v_exp_f32 v101, v101
    v_exp_f32 v102, v102
    v_exp_f32 v103, v103
    v_add_f32 v96, 1.0, v96
    v_add_f32 v97, 1.0, v97
    v_add_f32 v98, 1.0, v98
    v_add_f32 v99, 1.0, v99
    v_add_f32 v100, 1.0, v100
    v_add_f32 v101, 1.0, v101
    v_add_f32 v102, 1.0, v102
    v_add_f32 v103, 1.0, v103
    v_rcp_f32 v96, v96
    v_rcp_f32 v97, v97
    v_rcp_f32 v98, v98
    v_rcp_f32 v99, v99
    v_rcp_f32 v100, v100
    v_rcp_f32 v101, v101
    v_rcp_f32 v102, v102
    v_rcp_f32 v103, v103
    v_mul_f32 v176, v176, v96
    v_mul_f32 v177, v177, v97
    v_mul_f32 v178, v178, v98
    v_mul_f32 v179, v179, v99
    v_mul_f32 v180, v180, v100
    v_mul_f32 v181, v181, v101
    v_mul_f32 v182, v182, v102
    v_mul_f32 v183, v183, v103
    v_cvt_pk_bf16_f32 v92, v176, v177
    v_cvt_pk_bf16_f32 v93, v178, v179
    v_cvt_pk_bf16_f32 v94, v180, v181
    v_cvt_pk_bf16_f32 v95, v182, v183
    buffer_store_dwordx4 v[92:95], v1, s[4:7], s30 offen sc1
    s_add_u32 s30, s30, s50
    s_waitcnt lgkmcnt(0)
    v_or3_b32 v24, v24, v25, v26
    v_or3_b32 v28, v28, v29, v30
    v_or3_b32 v24, v24, v27, v31
    v_or_b32 v24, v24, v28
    s_mov_b32 s28, s51
    s_mov_b32 s57, s53
    v_readfirstlane_b32 s30, v24
    s_cmp_lg_u32 s30, 0
    s_cbranch_scc1 w_drain
    s_mov_b32 s48, s32
    s_cmp_ge_u32 s32, 4
    s_cselect_b32 s30, 2, 3
    s_lshl_b32 s30, s26, s30
    s_mul_i32 s30, s30, s43
    s_add_u32 s49, s42, s30
    s_mov_b32 s50, s43
    s_mov_b32 s51, s46
    s_mov_b32 s23, s41
    s_mov_b32 s53, s47
    s_nop 0
    s_load_dwordx16 s[32:47], s[24:25], 0
    s_add_u32 s24, s24, 64
    s_addc_u32 s25, s25, 0
    s_branch w_first4
w_firstM:
    s_waitcnt vmcnt(6)
    s_barrier
    s_add_u32 m0, s21, 0
    s_nop 0
    buffer_load_dwordx4 v1, s[4:7], s16 offen sc1 lds
    s_add_u32 s16, s16, s62
    s_add_u32 m0, s22, 0
    s_nop 0
    buffer_load_dwordx4 v2, s[8:11], s18 offen lds
    s_add_u32 s18, s18, s20
    s_add_u32 m0, s22, 8192
    s_nop 0
    buffer_load_dwordx4 v2, s[12:15], s19 offen lds
    s_add_u32 s19, s19, s20
    v_mfma_f32_16x16x32_bf16 v[128:131], v[64:67], v[32:35], 0
    ds_read_b64_tr_b16 v[112:113], v8 offset:49152
    v_mfma_f32_16x16x32_bf16 v[132:135], v[68:71], v[32:35], 0
    ds_read_b64_tr_b16 v[114:115], v9 offset:49152
    v_mfma_f32_16x16x32_bf16 v[136:139], v[72:75], v[32:35], 0
    ds_read_b64_tr_b16 v[116:117], v10 offset:49152
    v_mfma_f32_16x16x32_bf16 v[140:143], v[76:79], v[32:35], 0
    ds_read_b64_tr_b16 v[118:119], v11 offset:49152
    v_mfma_f32_16x16x32_bf16 v[144:147], v[64:67], v[40:43], 0
    ds_read_b64_tr_b16 v[120:121], v8 offset:57344
    v_mfma_f32_16x16x32_bf16 v[148:151], v[68:71], v[40:43], 0
    ds_read_b64_tr_b16 v[122:123], v9 offset:57344
    v_mfma_f32_16x16x32_bf16 v[152:155], v[72:75], v[40:43], 0
    ds_read_b64_tr_b16 v[124:125], v10 offset:57344
    v_mfma_f32_16x16x32_bf16 v[156:159], v[76:79], v[40:43], 0
    ds_read_b64_tr_b16 v[126:127], v11 offset:57344
    v_mfma_f32_16x16x32_bf16 v[160:163], v[64:67], v[48:51], 0
    ds_read_b128 v[80:83], v5 offset:32768
    v_mfma_f32_16x16x32_bf16 v[164:167], v[68:71], v[48:51], 0
    ds_read_b128 v[88:91], v5 offset:34816
    v_mfma_f32_16x16x32_bf16 v[168:171], v[72:75], v[48:51], 0
    ds_read_b128 v[96:99], v5 offset:36864
    v_mfma_f32_16x16x32_bf16 v[172:175], v[76:79], v[48:51], 0
    ds_read_b128 v[104:107], v5 offset:38912
    v_mfma_f32_16x16x32_bf16 v[176:179], v[64:67], v[56:59], 0
    v_mfma_f32_16x16x32_bf16 v[180:183], v[68:71], v[56:59], 0
    v_mfma_f32_16x16x32_bf16 v[184:187], v[72:75], v[56:59], 0
    v_mfma_f32_16x16x32_bf16 v[188:191], v[76:79], v[56:59], 0
    s_waitcnt lgkmcnt(0)
    s_waitcnt vmcnt(6)
    s_barrier
    s_add_u32 m0, s21, 32768
    s_nop 0
    buffer_load_dwordx4 v1, s[4:7], s16 offen sc1 lds
    s_add_u32 s16, s16, s62
    s_add_u32 m0, s22, 32768
    s_nop 0
    buffer_load_dwordx4 v2, s[8:11], s18 offen lds
    s_add_u32 s18, s18, s20
    s_add_u32 m0, s22, 40960
    s_nop 0
    buffer_load_dwordx4 v2, s[12:15], s19 offen lds
    s_add_u32 s19, s19, s20
    v_mfma_f32_16x16x32_bf16 v[128:131], v[112:115], v[80:83], v[128:131]
    ds_read_b64_tr_b16 v[64:65], v12 offset:16384
    v_mfma_f32_16x16x32_bf16 v[132:135], v[116:119], v[80:83], v[132:135]
    ds_read_b64_tr_b16 v[66:67], v13 offset:16384
    v_mfma_f32_16x16x32_bf16 v[136:139], v[120:123], v[80:83], v[136:139]
    ds_read_b64_tr_b16 v[68:69], v14 offset:16384
    v_mfma_f32_16x16x32_bf16 v[140:143], v[124:127], v[80:83], v[140:143]
    ds_read_b64_tr_b16 v[70:71], v15 offset:16384
    v_mfma_f32_16x16x32_bf16 v[144:147], v[112:115], v[88:91], v[144:147]
    ds_read_b64_tr_b16 v[72:73], v12 offset:24576
    v_mfma_f32_16x16x32_bf16 v[148:151], v[116:119], v[88:91], v[148:151]
    ds_read_b64_tr_b16 v[74:75], v13 offset:24576
    v_mfma_f32_16x16x32_bf16 v[152:155], v[120:123], v[88:91], v[152:155]
    ds_read_b64_tr_b16 v[76:77], v14 offset:24576
    v_mfma_f32_16x16x32_bf16 v[156:159], v[124:127], v[88:91], v[156:159]
    ds_read_b64_tr_b16 v[78:79], v15 offset:24576
    v_mfma_f32_16x16x32_bf16 v[160:163], v[112:115], v[96:99], v[160:163]
    ds_read_b128 v[32:35], v6 offset:0
    v_mfma_f32_16x16x32_bf16 v[164:167], v[116:119], v[96:99], v[164:167]
    ds_read_b128 v[40:43], v6 offset:2048
    v_mfma_f32_16x16x32_bf16 v[168:171], v[120:123], v[96:99], v[168:171]
    ds_read_b128 v[48:51], v6 offset:4096
    v_mfma_f32_16x16x32_bf16 v[172:175], v[124:127], v[96:99], v[172:175]
    ds_read_b128 v[56:59], v6 offset:6144
    v_mfma_f32_16x16x32_bf16 v[176:179], v[112:115], v[104:107], v[176:179]
    v_mfma_f32_16x16x32_bf16 v[180:183], v[116:119], v[104:107], v[180:183]
    v_mfma_f32_16x16x32_bf16 v[184:187], v[120:123], v[104:107], v[184:187]
    v_mfma_f32_16x16x32_bf16 v[188:191], v[124:127], v[104:107], v[188:191]
    s_waitcnt lgkmcnt(0)
    s_waitcnt vmcnt(6)
    s_barrier
    s_add_u32 m0, s21, 65536
    s_nop 0
    buffer_load_dwordx4 v1, s[4:7], s16 offen sc1 lds
    s_add_u32 s16, s16, s62
    s_add_u32 m0, s22, 65536
    s_nop 0
    buffer_load_dwordx4 v2, s[8:11], s18 offen lds
    s_add_u32 s18, s18, s20
    s_add_u32 m0, s22, 73728
    s_nop 0
    buffer_load_dwordx4 v2, s[12:15], s19 offen lds
    s_add_u32 s19, s19, s20
    v_mfma_f32_16x16x32_bf16 v[128:131], v[64:67], v[32:35], v[128:131]
    ds_read_b64_tr_b16 v[112:113], v12 offset:49152
    v_mfma_f32_16x16x32_bf16 v[132:135], v[68:71], v[32:35], v[132:135]
    ds_read_b64_tr_b16 v[114:115], v13 offset:49152
    v_mfma_f32_16x16x32_bf16 v[136:139], v[72:75], v[32:35], v[136:139]
    ds_read_b64_tr_b16 v[116:117], v14 offset:49152
    v_mfma_f32_16x16x32_bf16 v[140:143], v[76:79], v[32:35], v[140:143]
    ds_read_b64_tr_b16 v[118:119], v15 offset:49152
    v_mfma_f32_16x16x32_bf16 v[144:147], v[64:67], v[40:43], v[144:147]
    ds_read_b64_tr_b16 v[120:121], v12 offset:57344
    v_mfma_f32_16x16x32_bf16 v[148:151], v[68:71], v[40:43], v[148:151]
    ds_read_b64_tr_b16 v[122:123], v13 offset:57344
    v_mfma_f32_16x16x32_bf16 v[152:155], v[72:75], v[40:43], v[152:155]
    ds_read_b64_tr_b16 v[124:125], v14 offset:57344
    v_mfma_f32_16x16x32_bf16 v[156:159], v[76:79], v[40:43], v[156:159]
    ds_read_b64_tr_b16 v[126:127], v15 offset:57344
    v_mfma_f32_16x16x32_bf16 v[160:163], v[64:67], v[48:51], v[160:163]
    ds_read_b128 v[80:83], v6 offset:32768
    v_mfma_f32_16x16x32_bf16 v[164:167], v[68:71], v[48:51], v[164:167]
    ds_read_b128 v[88:91], v6 offset:34816
    v_mfma_f32_16x16x32_bf16 v[168:171], v[72:75], v[48:51], v[168:171]
    ds_read_b128 v[96:99], v6 offset:36864
    v_mfma_f32_16x16x32_bf16 v[172:175], v[76:79], v[48:51], v[172:175]
    ds_read_b128 v[104:107], v6 offset:38912
    v_mfma_f32_16x16x32_bf16 v[176:179], v[64:67], v[56:59], v[176:179]
    v_mfma_f32_16x16x32_bf16 v[180:183], v[68:71], v[56:59], v[180:183]
    v_mfma_f32_16x16x32_bf16 v[184:187], v[72:75], v[56:59], v[184:187]
    v_mfma_f32_16x16x32_bf16 v[188:191], v[76:79], v[56:59], v[188:191]
    s_waitcnt lgkmcnt(0)
    s_waitcnt vmcnt(6)
    s_barrier
    s_add_u32 m0, s21, 98304
    s_nop 0
    buffer_load_dwordx4 v1, s[4:7], s16 offen sc1 lds
    s_add_u32 s16, s16, s62
    s_add_u32 m0, s22, 98304
    s_nop 0
    buffer_load_dwordx4 v2, s[8:11], s18 offen lds
    s_add_u32 s18, s18, s20
    s_add_u32 m0, s22, 106496
    s_nop 0
    buffer_load_dwordx4 v2, s[12:15], s19 offen lds
    s_add_u32 s19, s19, s20
    v_mfma_f32_16x16x32_bf16 v[128:131], v[112:115], v[80:83], v[128:131]
    ds_read_b64_tr_b16 v[64:65], v8 offset:16384
    v_mfma_f32_16x16x32_bf16 v[132:135], v[116:119], v[80:83], v[132:135]
    ds_read_b64_tr_b16 v[66:67], v9 offset:16384
    v_mfma_f32_16x16x32_bf16 v[136:139], v[120:123], v[80:83], v[136:139]
    ds_read_b64_tr_b16 v[68:69], v10 offset:16384
    v_mfma_f32_16x16x32_bf16 v[140:143], v[124:127], v[80:83], v[140:143]
    ds_read_b64_tr_b16 v[70:71], v11 offset:16384
    v_mfma_f32_16x16x32_bf16 v[144:147], v[112:115], v[88:91], v[144:147]
    ds_read_b64_tr_b16 v[72:73], v8 offset:24576
    v_mfma_f32_16x16x32_bf16 v[148:151], v[116:119], v[88:91], v[148:151]
    ds_read_b64_tr_b16 v[74:75], v9 offset:24576
    v_mfma_f32_16x16x32_bf16 v[152:155], v[120:123], v[88:91], v[152:155]
    ds_read_b64_tr_b16 v[76:77], v10 offset:24576
    v_mfma_f32_16x16x32_bf16 v[156:159], v[124:127], v[88:91], v[156:159]
    ds_read_b64_tr_b16 v[78:79], v11 offset:24576
    v_mfma_f32_16x16x32_bf16 v[160:163], v[112:115], v[96:99], v[160:163]
    ds_read_b128 v[32:35], v5 offset:0
    v_mfma_f32_16x16x32_bf16 v[164:167], v[116:119], v[96:99], v[164:167]
    ds_read_b128 v[40:43], v5 offset:2048
    v_mfma_f32_16x16x32_bf16 v[168:171], v[120:123], v[96:99], v[168:171]
    ds_read_b128 v[48:51], v5 offset:4096
    v_mfma_f32_16x16x32_bf16 v[172:175], v[124:127], v[96:99], v[172:175]
    ds_read_b128 v[56:59], v5 offset:6144
    v_mfma_f32_16x16x32_bf16 v[176:179], v[112:115], v[104:107], v[176:179]
    v_mfma_f32_16x16x32_bf16 v[180:183], v[116:119], v[104:107], v[180:183]
    v_mfma_f32_16x16x32_bf16 v[184:187], v[120:123], v[104:107], v[184:187]
    v_mfma_f32_16x16x32_bf16 v[188:191], v[124:127], v[104:107], v[188:191]
    s_waitcnt lgkmcnt(0)
w_loop_chkM:
    s_sub_u32 s23, s23, 1
w_loopM:
    s_cmp_lg_u32 s23, 1
    s_cbranch_scc1 w_bodyM
    v_readfirstlane_b32 s68, v22
    s_cmp_ge_u32 s68, 128
    s_cselect_b32 s70, 0, s70
    v_readfirstlane_b32 s30, v16
    s_cmp_ge_u32 s30, s45
    s_cselect_b32 s30, 0, 1
    s_or_b32 s30, s30, s70
    s_cmp_ge_u32 s32, 4
    s_cselect_b32 s30, 1, s30
    s_cmp_eq_u32 s32, 0
    s_cselect_b32 s30, 1, s30
    v_mov_b32 v20, s30
    ds_write_b32 v7, v20
    s_cbranch_scc1 w_bodyM
    s_load_dwordx2 s[8:9], s[0:1], s33
    s_load_dwordx2 s[12:13], s[0:1], s34
    s_mov_b32 s10, s38
    s_mov_b32 s14, s38
    s_cmp_ge_u32 s32, 4
    s_cselect_b32 s31, 0, 1
    s_lshl_b32 s30, s3, s31
    s_mul_i32 s30, s30, s40
    s_add_u32 s16, s39, s30
    s_cmp_eq_u32 s32, 4
    s_cselect_b32 s30, 1024, s40
    s_cselect_b32 s31, 6, 5
    s_lshl_b32 s62, 32, s31
    s_add_u32 s17, s16, s30
    s_lshl_b32 s30, s3, 2
    s_mul_i32 s30, s30, s35
    s_add_u32 s18, s36, s30
    s_add_u32 s19, s37, s30
    s_lshl_b32 s20, s35, s31
    v_mul_u32_u24 v2, s35, v4
    v_add_u32 v2, v2, v3
    s_waitcnt lgkmcnt(0)
    s_waitcnt vmcnt(6)
    s_barrier
    s_add_u32 m0, s21, 0
    s_nop 0
    buffer_load_dwordx4 v1, s[4:7], s16 offen sc1 lds
    s_add_u32 s16, s16, s62
    s_add_u32 m0, s21, 1024
    s_nop 0
    buffer_load_dwordx4 v1, s[4:7], s17 offen sc1 lds
    s_add_u32 s17, s17, s62
    s_add_u32 m0, s22, 0
    s_nop 0
    buffer_load_dwordx4 v2, s[8:11], s18 offen lds
    s_add_u32 s18, s18, s20
    s_add_u32 m0, s22, 8192
    s_nop 0
    buffer_load_dwordx4 v2, s[12:15], s19 offen lds
    s_add_u32 s19, s19, s20
    v_mfma_f32_16x16x32_bf16 v[128:131], v[64:67], v[32:35], v[128:131]
    ds_read_b64_tr_b16 v[112:113], v8 offset:49152
    v_mfma_f32_16x16x32_bf16 v[132:135], v[68:71], v[32:35], v[132:135]
    ds_read_b64_tr_b16 v[114:115], v9 offset:49152
    v_mfma_f32_16x16x32_bf16 v[136:139], v[72:75], v[32:35], v[136:139]
    ds_read_b64_tr_b16 v[116:117], v10 offset:49152
    v_mfma_f32_16x16x32_bf16 v[140:143], v[76:79], v[32:35], v[140:143]
    ds_read_b64_tr_b16 v[118:119], v11 offset:49152
    v_mfma_f32_16x16x32_bf16 v[144:147], v[64:67], v[40:43], v[144:147]
    ds_read_b64_tr_b16 v[120:121], v8 offset:57344
    v_mfma_f32_16x16x32_bf16 v[148:151], v[68:71], v[40:43], v[148:151]
    ds_read_b64_tr_b16 v[122:123], v9 offset:57344
    v_mfma_f32_16x16x32_bf16 v[152:155], v[72:75], v[40:43], v[152:155]
    ds_read_b64_tr_b16 v[124:125], v10 offset:57344
    v_mfma_f32_16x16x32_bf16 v[156:159], v[76:79], v[40:43], v[156:159]
    ds_read_b64_tr_b16 v[126:127], v11 offset:57344
    v_mfma_f32_16x16x32_bf16 v[160:163], v[64:67], v[48:51], v[160:163]
    ds_read_b128 v[80:83], v5 offset:32768
    v_mfma_f32_16x16x32_bf16 v[164:167], v[68:71], v[48:51], v[164:167]
    ds_read_b128 v[88:91], v5 offset:34816
    v_mfma_f32_16x16x32_bf16 v[168:171], v[72:75], v[48:51], v[168:171]
    ds_read_b128 v[96:99], v5 offset:36864
    v_mfma_f32_16x16x32_bf16 v[172:175], v[76:79], v[48:51], v[172:175]
    ds_read_b128 v[104:107], v5 offset:38912
    v_mfma_f32_16x16x32_bf16 v[176:179], v[64:67], v[56:59], v[176:179]
    v_mfma_f32_16x16x32_bf16 v[180:183], v[68:71], v[56:59], v[180:183]
    v_mfma_f32_16x16x32_bf16 v[184:187], v[72:75], v[56:59], v[184:187]
    v_mfma_f32_16x16x32_bf16 v[188:191], v[76:79], v[56:59], v[188:191]
    s_waitcnt lgkmcnt(0)
    s_waitcnt vmcnt(7)
    s_barrier
    s_add_u32 m0, s21, 32768
    s_nop 0
    buffer_load_dwordx4 v1, s[4:7], s16 offen sc1 lds
    s_add_u32 s16, s16, s62
    s_add_u32 m0, s21, 33792
    s_nop 0
    buffer_load_dwordx4 v1, s[4:7], s17 offen sc1 lds
    s_add_u32 s17, s17, s62
    s_add_u32 m0, s22, 32768
    s_nop 0
    buffer_load_dwordx4 v2, s[8:11], s18 offen lds
    s_add_u32 s18, s18, s20
    s_add_u32 m0, s22, 40960
    s_nop 0
    buffer_load_dwordx4 v2, s[12:15], s19 offen lds
    s_add_u32 s19, s19, s20
    v_mfma_f32_16x16x32_bf16 v[128:131], v[112:115], v[80:83], v[128:131]
    ds_read_b64_tr_b16 v[64:65], v12 offset:16384
    v_mfma_f32_16x16x32_bf16 v[132:135], v[116:119], v[80:83], v[132:135]
    ds_read_b64_tr_b16 v[66:67], v13 offset:16384
    v_mfma_f32_16x16x32_bf16 v[136:139], v[120:123], v[80:83], v[136:139]
    ds_read_b64_tr_b16 v[68:69], v14 offset:16384
    v_mfma_f32_16x16x32_bf16 v[140:143], v[124:127], v[80:83], v[140:143]
    ds_read_b64_tr_b16 v[70:71], v15 offset:16384
    v_mfma_f32_16x16x32_bf16 v[144:147], v[112:115], v[88:91], v[144:147]
    ds_read_b64_tr_b16 v[72:73], v12 offset:24576
    v_mfma_f32_16x16x32_bf16 v[148:151], v[116:119], v[88:91], v[148:151]
    ds_read_b64_tr_b16 v[74:75], v13 offset:24576
    v_mfma_f32_16x16x32_bf16 v[152:155], v[120:123], v[88:91], v[152:155]
    ds_read_b64_tr_b16 v[76:77], v14 offset:24576
    v_mfma_f32_16x16x32_bf16 v[156:159], v[124:127], v[88:91], v[156:159]
    ds_read_b64_tr_b16 v[78:79], v15 offset:24576
    v_mfma_f32_16x16x32_bf16 v[160:163], v[112:115], v[96:99], v[160:163]
    ds_read_b128 v[32:35], v6 offset:0
    v_mfma_f32_16x16x32_bf16 v[164:167], v[116:119], v[96:99], v[164:167]
    ds_read_b128 v[40:43], v6 offset:2048
    v_mfma_f32_16x16x32_bf16 v[168:171], v[120:123], v[96:99], v[168:171]
    ds_read_b128 v[48:51], v6 offset:4096
    v_mfma_f32_16x16x32_bf16 v[172:175], v[124:127], v[96:99], v[172:175]
    ds_read_b128 v[56:59], v6 offset:6144
    v_mfma_f32_16x16x32_bf16 v[176:179], v[112:115], v[104:107], v[176:179]
    v_mfma_f32_16x16x32_bf16 v[180:183], v[116:119], v[104:107], v[180:183]
    v_mfma_f32_16x16x32_bf16 v[184:187], v[120:123], v[104:107], v[184:187]
    v_mfma_f32_16x16x32_bf16 v[188:191], v[124:127], v[104:107], v[188:191]
    s_waitcnt lgkmcnt(0)
    s_waitcnt vmcnt(8)
    s_barrier
    s_add_u32 m0, s21, 65536
    s_nop 0
    buffer_load_dwordx4 v1, s[4:7], s16 offen sc1 lds
    s_add_u32 s16, s16, s62
    s_add_u32 m0, s21, 66560
    s_nop 0
    buffer_load_dwordx4 v1, s[4:7], s17 offen sc1 lds
    s_add_u32 s17, s17, s62
    s_add_u32 m0, s22, 65536
    s_nop 0
    buffer_load_dwordx4 v2, s[8:11], s18 offen lds
    s_add_u32 s18, s18, s20
    s_add_u32 m0, s22, 73728
    s_nop 0
    buffer_load_dwordx4 v2, s[12:15], s19 offen lds
    s_add_u32 s19, s19, s20
    v_mfma_f32_16x16x32_bf16 v[128:131], v[64:67], v[32:35], v[128:131]
    ds_read_b64_tr_b16 v[112:113], v12 offset:49152
    v_mfma_f32_16x16x32_bf16 v[132:135], v[68:71], v[32:35], v[132:135]
    ds_read_b64_tr_b16 v[114:115], v13 offset:49152
    v_mfma_f32_16x16x32_bf16 v[136:139], v[72:75], v[32:35], v[136:139]
    ds_read_b64_tr_b16 v[116:117], v14 offset:49152
    v_mfma_f32_16x16x32_bf16 v[140:143], v[76:79], v[32:35], v[140:143]
    ds_read_b64_tr_b16 v[118:119], v15 offset:49152
    v_mfma_f32_16x16x32_bf16 v[144:147], v[64:67], v[40:43], v[144:147]
    ds_read_b64_tr_b16 v[120:121], v12 offset:57344
    v_mfma_f32_16x16x32_bf16 v[148:151], v[68:71], v[40:43], v[148:151]
    ds_read_b64_tr_b16 v[122:123], v13 offset:57344
    v_mfma_f32_16x16x32_bf16 v[152:155], v[72:75], v[40:43], v[152:155]
    ds_read_b64_tr_b16 v[124:125], v14 offset:57344
    v_mfma_f32_16x16x32_bf16 v[156:159], v[76:79], v[40:43], v[156:159]
    ds_read_b64_tr_b16 v[126:127], v15 offset:57344
    v_mfma_f32_16x16x32_bf16 v[160:163], v[64:67], v[48:51], v[160:163]
    ds_read_b128 v[80:83], v6 offset:32768
    v_mfma_f32_16x16x32_bf16 v[164:167], v[68:71], v[48:51], v[164:167]
    ds_read_b128 v[88:91], v6 offset:34816
    v_mfma_f32_16x16x32_bf16 v[168:171], v[72:75], v[48:51], v[168:171]
    ds_read_b128 v[96:99], v6 offset:36864
    v_mfma_f32_16x16x32_bf16 v[172:175], v[76:79], v[48:51], v[172:175]
    ds_read_b128 v[104:107], v6 offset:38912
    v_mfma_f32_16x16x32_bf16 v[176:179], v[64:67], v[56:59], v[176:179]
    v_mfma_f32_16x16x32_bf16 v[180:183], v[68:71], v[56:59], v[180:183]
    v_mfma_f32_16x16x32_bf16 v[184:187], v[72:75], v[56:59], v[184:187]
    v_mfma_f32_16x16x32_bf16 v[188:191], v[76:79], v[56:59], v[188:191]
    s_waitcnt lgkmcnt(0)
    s_waitcnt vmcnt(8)
    s_barrier
    s_add_u32 m0, s21, 98304
    s_nop 0
    buffer_load_dwordx4 v1, s[4:7], s16 offen sc1 lds
    s_add_u32 s16, s16, s62
    s_add_u32 m0, s21, 99328
    s_nop 0
    buffer_load_dwordx4 v1, s[4:7], s17 offen sc1 lds
    s_add_u32 s17, s17, s62
    s_add_u32 m0, s22, 98304
    s_nop 0
    buffer_load_dwordx4 v2, s[8:11], s18 offen lds
    s_add_u32 s18, s18, s20
    s_add_u32 m0, s22, 106496
    s_nop 0
    buffer_load_dwordx4 v2, s[12:15], s19 offen lds
    s_add_u32 s19, s19, s20
    v_mfma_f32_16x16x32_bf16 v[128:131], v[112:115], v[80:83], v[128:131]
    ds_read_b64_tr_b16 v[64:65], v8 offset:16384
    v_mfma_f32_16x16x32_bf16 v[132:135], v[116:119], v[80:83], v[132:135]
    ds_read_b64_tr_b16 v[66:67], v9 offset:16384
    v_mfma_f32_16x16x32_bf16 v[136:139], v[120:123], v[80:83], v[136:139]
    ds_read_b64_tr_b16 v[68:69], v10 offset:16384
    v_mfma_f32_16x16x32_bf16 v[140:143], v[124:127], v[80:83], v[140:143]
    ds_read_b64_tr_b16 v[70:71], v11 offset:16384
    v_mfma_f32_16x16x32_bf16 v[144:147], v[112:115], v[88:91], v[144:147]
    ds_read_b64_tr_b16 v[72:73], v8 offset:24576
    v_mfma_f32_16x16x32_bf16 v[148:151], v[116:119], v[88:91], v[148:151]
    ds_read_b64_tr_b16 v[74:75], v9 offset:24576
    v_mfma_f32_16x16x32_bf16 v[152:155], v[120:123], v[88:91], v[152:155]
    ds_read_b64_tr_b16 v[76:77], v10 offset:24576
    v_mfma_f32_16x16x32_bf16 v[156:159], v[124:127], v[88:91], v[156:159]
    ds_read_b64_tr_b16 v[78:79], v11 offset:24576
    v_mfma_f32_16x16x32_bf16 v[160:163], v[112:115], v[96:99], v[160:163]
    ds_read_b128 v[32:35], v5 offset:0
    v_mfma_f32_16x16x32_bf16 v[164:167], v[116:119], v[96:99], v[164:167]
    ds_read_b128 v[36:39], v5 offset:1024
    v_mfma_f32_16x16x32_bf16 v[168:171], v[120:123], v[96:99], v[168:171]
    ds_read_b128 v[40:43], v5 offset:2048
    v_mfma_f32_16x16x32_bf16 v[172:175], v[124:127], v[96:99], v[172:175]
    ds_read_b128 v[44:47], v5 offset:3072
    v_mfma_f32_16x16x32_bf16 v[176:179], v[112:115], v[104:107], v[176:179]
    ds_read_b128 v[48:51], v5 offset:4096
    v_mfma_f32_16x16x32_bf16 v[180:183], v[116:119], v[104:107], v[180:183]
    ds_read_b128 v[52:55], v5 offset:5120
    v_mfma_f32_16x16x32_bf16 v[184:187], v[120:123], v[104:107], v[184:187]
    ds_read_b128 v[56:59], v5 offset:6144
    v_mfma_f32_16x16x32_bf16 v[188:191], v[124:127], v[104:107], v[188:191]
    ds_read_b128 v[60:63], v5 offset:7168
    s_waitcnt lgkmcnt(0)
    s_branch w_doneM
w_bodyM:
    buffer_load_dword v22, off, s[64:67], 0 sc1
    s_waitcnt vmcnt(6)
    s_barrier
    s_add_u32 m0, s21, 0
    s_nop 0
    buffer_load_dwordx4 v1, s[4:7], s16 offen sc1 lds
    s_add_u32 s16, s16, s62
    s_add_u32 m0, s22, 0
    s_nop 0
    buffer_load_dwordx4 v2, s[8:11], s18 offen lds
    s_add_u32 s18, s18, s20
    s_add_u32 m0, s22, 8192
    s_nop 0
    buffer_load_dwordx4 v2, s[12:15], s19 offen lds
    s_add_u32 s19, s19, s20
    v_mfma_f32_16x16x32_bf16 v[128:131], v[64:67], v[32:35], v[128:131]
    ds_read_b64_tr_b16 v[112:113], v8 offset:49152
    v_mfma_f32_16x16x32_bf16 v[132:135], v[68:71], v[32:35], v[132:135]
    ds_read_b64_tr_b16 v[114:115], v9 offset:49152
    v_mfma_f32_16x16x32_bf16 v[136:139], v[72:75], v[32:35], v[136:139]
    ds_read_b64_tr_b16 v[116:117], v10 offset:49152
    v_mfma_f32_16x16x32_bf16 v[140:143], v[76:79], v[32:35], v[140:143]
    ds_read_b64_tr_b16 v[118:119], v11 offset:49152
    v_mfma_f32_16x16x32_bf16 v[144:147], v[64:67], v[40:43], v[144:147]
    ds_read_b64_tr_b16 v[120:121], v8 offset:57344
    v_mfma_f32_16x16x32_bf16 v[148:151], v[68:71], v[40:43], v[148:151]
    ds_read_b64_tr_b16 v[122:123], v9 offset:57344
    v_mfma_f32_16x16x32_bf16 v[152:155], v[72:75], v[40:43], v[152:155]
    ds_read_b64_tr_b16 v[124:125], v10 offset:57344
    v_mfma_f32_16x16x32_bf16 v[156:159], v[76:79], v[40:43], v[156:159]
    ds_read_b64_tr_b16 v[126:127], v11 offset:57344
    v_mfma_f32_16x16x32_bf16 v[160:163], v[64:67], v[48:51], v[160:163]
    ds_read_b128 v[80:83], v5 offset:32768
    v_mfma_f32_16x16x32_bf16 v[164:167], v[68:71], v[48:51], v[164:167]
    ds_read_b128 v[88:91], v5 offset:34816
    v_mfma_f32_16x16x32_bf16 v[168:171], v[72:75], v[48:51], v[168:171]
    ds_read_b128 v[96:99], v5 offset:36864
    v_mfma_f32_16x16x32_bf16 v[172:175], v[76:79], v[48:51], v[172:175]
    ds_read_b128 v[104:107], v5 offset:38912
    v_mfma_f32_16x16x32_bf16 v[176:179], v[64:67], v[56:59], v[176:179]
    v_mfma_f32_16x16x32_bf16 v[180:183], v[68:71], v[56:59], v[180:183]
    v_mfma_f32_16x16x32_bf16 v[184:187], v[72:75], v[56:59], v[184:187]
    v_mfma_f32_16x16x32_bf16 v[188:191], v[76:79], v[56:59], v[188:191]
    buffer_load_dword v16, v17, s[4:7], s44 offen sc1
    s_waitcnt lgkmcnt(0)
    s_waitcnt vmcnt(6)
    s_barrier
    s_add_u32 m0, s21, 32768
    s_nop 0
    buffer_load_dwordx4 v1, s[4:7], s16 offen sc1 lds
    s_add_u32 s16, s16, s62
    s_add_u32 m0, s22, 32768
    s_nop 0
    buffer_load_dwordx4 v2, s[8:11], s18 offen lds
    s_add_u32 s18, s18, s20
    s_add_u32 m0, s22, 40960
    s_nop 0
    buffer_load_dwordx4 v2, s[12:15], s19 offen lds
    s_add_u32 s19, s19, s20
    v_mfma_f32_16x16x32_bf16 v[128:131], v[112:115], v[80:83], v[128:131]
    ds_read_b64_tr_b16 v[64:65], v12 offset:16384
    v_mfma_f32_16x16x32_bf16 v[132:135], v[116:119], v[80:83], v[132:135]
    ds_read_b64_tr_b16 v[66:67], v13 offset:16384
    v_mfma_f32_16x16x32_bf16 v[136:139], v[120:123], v[80:83], v[136:139]
    ds_read_b64_tr_b16 v[68:69], v14 offset:16384
    v_mfma_f32_16x16x32_bf16 v[140:143], v[124:127], v[80:83], v[140:143]
    ds_read_b64_tr_b16 v[70:71], v15 offset:16384
    v_mfma_f32_16x16x32_bf16 v[144:147], v[112:115], v[88:91], v[144:147]
    ds_read_b64_tr_b16 v[72:73], v12 offset:24576
    v_mfma_f32_16x16x32_bf16 v[148:151], v[116:119], v[88:91], v[148:151]
    ds_read_b64_tr_b16 v[74:75], v13 offset:24576
    v_mfma_f32_16x16x32_bf16 v[152:155], v[120:123], v[88:91], v[152:155]
    ds_read_b64_tr_b16 v[76:77], v14 offset:24576
    v_mfma_f32_16x16x32_bf16 v[156:159], v[124:127], v[88:91], v[156:159]
    ds_read_b64_tr_b16 v[78:79], v15 offset:24576
    v_mfma_f32_16x16x32_bf16 v[160:163], v[112:115], v[96:99], v[160:163]
    ds_read_b128 v[32:35], v6 offset:0
    v_mfma_f32_16x16x32_bf16 v[164:167], v[116:119], v[96:99], v[164:167]
    ds_read_b128 v[40:43], v6 offset:2048
    v_mfma_f32_16x16x32_bf16 v[168:171], v[120:123], v[96:99], v[168:171]
    ds_read_b128 v[48:51], v6 offset:4096
    v_mfma_f32_16x16x32_bf16 v[172:175], v[124:127], v[96:99], v[172:175]
    ds_read_b128 v[56:59], v6 offset:6144
    v_mfma_f32_16x16x32_bf16 v[176:179], v[112:115], v[104:107], v[176:179]
    v_mfma_f32_16x16x32_bf16 v[180:183], v[116:119], v[104:107], v[180:183]
    v_mfma_f32_16x16x32_bf16 v[184:187], v[120:123], v[104:107], v[184:187]
    v_mfma_f32_16x16x32_bf16 v[188:191], v[124:127], v[104:107], v[188:191]
    s_waitcnt lgkmcnt(0)
    s_waitcnt vmcnt(6)
    s_barrier
    s_add_u32 m0, s21, 65536
    s_nop 0
    buffer_load_dwordx4 v1, s[4:7], s16 offen sc1 lds
    s_add_u32 s16, s16, s62
    s_add_u32 m0, s22, 65536
    s_nop 0
    buffer_load_dwordx4 v2, s[8:11], s18 offen lds
    s_add_u32 s18, s18, s20
    s_add_u32 m0, s22, 73728
    s_nop 0
    buffer_load_dwordx4 v2, s[12:15], s19 offen lds
    s_add_u32 s19, s19, s20
    v_mfma_f32_16x16x32_bf16 v[128:131], v[64:67], v[32:35], v[128:131]
    ds_read_b64_tr_b16 v[112:113], v12 offset:49152
    v_mfma_f32_16x16x32_bf16 v[132:135], v[68:71], v[32:35], v[132:135]
    ds_read_b64_tr_b16 v[114:115], v13 offset:49152
    v_mfma_f32_16x16x32_bf16 v[136:139], v[72:75], v[32:35], v[136:139]
    ds_read_b64_tr_b16 v[116:117], v14 offset:49152
    v_mfma_f32_16x16x32_bf16 v[140:143], v[76:79], v[32:35], v[140:143]
    ds_read_b64_tr_b16 v[118:119], v15 offset:49152
    v_mfma_f32_16x16x32_bf16 v[144:147], v[64:67], v[40:43], v[144:147]
    ds_read_b64_tr_b16 v[120:121], v12 offset:57344
    v_mfma_f32_16x16x32_bf16 v[148:151], v[68:71], v[40:43], v[148:151]
    ds_read_b64_tr_b16 v[122:123], v13 offset:57344
    v_mfma_f32_16x16x32_bf16 v[152:155], v[72:75], v[40:43], v[152:155]
    ds_read_b64_tr_b16 v[124:125], v14 offset:57344
    v_mfma_f32_16x16x32_bf16 v[156:159], v[76:79], v[40:43], v[156:159]
    ds_read_b64_tr_b16 v[126:127], v15 offset:57344
    v_mfma_f32_16x16x32_bf16 v[160:163], v[64:67], v[48:51], v[160:163]
    ds_read_b128 v[80:83], v6 offset:32768
    v_mfma_f32_16x16x32_bf16 v[164:167], v[68:71], v[48:51], v[164:167]
    ds_read_b128 v[88:91], v6 offset:34816
    v_mfma_f32_16x16x32_bf16 v[168:171], v[72:75], v[48:51], v[168:171]
    ds_read_b128 v[96:99], v6 offset:36864
    v_mfma_f32_16x16x32_bf16 v[172:175], v[76:79], v[48:51], v[172:175]
    ds_read_b128 v[104:107], v6 offset:38912
    v_mfma_f32_16x16x32_bf16 v[176:179], v[64:67], v[56:59], v[176:179]
    v_mfma_f32_16x16x32_bf16 v[180:183], v[68:71], v[56:59], v[180:183]
    v_mfma_f32_16x16x32_bf16 v[184:187], v[72:75], v[56:59], v[184:187]
    v_mfma_f32_16x16x32_bf16 v[188:191], v[76:79], v[56:59], v[188:191]
    s_waitcnt lgkmcnt(0)
    s_waitcnt vmcnt(6)
    s_barrier
    s_add_u32 m0, s21, 98304
    s_nop 0
    buffer_load_dwordx4 v1, s[4:7], s16 offen sc1 lds
    s_add_u32 s16, s16, s62
    s_add_u32 m0, s22, 98304
    s_nop 0
    buffer_load_dwordx4 v2, s[8:11], s18 offen lds
    s_add_u32 s18, s18, s20
    s_add_u32 m0, s22, 106496
    s_nop 0
    buffer_load_dwordx4 v2, s[12:15], s19 offen lds
    s_add_u32 s19, s19, s20
    v_mfma_f32_16x16x32_bf16 v[128:131], v[112:115], v[80:83], v[128:131]
    ds_read_b64_tr_b16 v[64:65], v8 offset:16384
    v_mfma_f32_16x16x32_bf16 v[132:135], v[116:119], v[80:83], v[132:135]
    ds_read_b64_tr_b16 v[66:67], v9 offset:16384
    v_mfma_f32_16x16x32_bf16 v[136:139], v[120:123], v[80:83], v[136:139]
    ds_read_b64_tr_b16 v[68:69], v10 offset:16384
    v_mfma_f32_16x16x32_bf16 v[140:143], v[124:127], v[80:83], v[140:143]
    ds_read_b64_tr_b16 v[70:71], v11 offset:16384
    v_mfma_f32_16x16x32_bf16 v[144:147], v[112:115], v[88:91], v[144:147]
    ds_read_b64_tr_b16 v[72:73], v8 offset:24576
    v_mfma_f32_16x16x32_bf16 v[148:151], v[116:119], v[88:91], v[148:151]
    ds_read_b64_tr_b16 v[74:75], v9 offset:24576
    v_mfma_f32_16x16x32_bf16 v[152:155], v[120:123], v[88:91], v[152:155]
    ds_read_b64_tr_b16 v[76:77], v10 offset:24576
    v_mfma_f32_16x16x32_bf16 v[156:159], v[124:127], v[88:91], v[156:159]
    ds_read_b64_tr_b16 v[78:79], v11 offset:24576
    v_mfma_f32_16x16x32_bf16 v[160:163], v[112:115], v[96:99], v[160:163]
    ds_read_b128 v[32:35], v5 offset:0
    v_mfma_f32_16x16x32_bf16 v[164:167], v[116:119], v[96:99], v[164:167]
    ds_read_b128 v[40:43], v5 offset:2048
    v_mfma_f32_16x16x32_bf16 v[168:171], v[120:123], v[96:99], v[168:171]
    ds_read_b128 v[48:51], v5 offset:4096
    v_mfma_f32_16x16x32_bf16 v[172:175], v[124:127], v[96:99], v[172:175]
    ds_read_b128 v[56:59], v5 offset:6144
    v_mfma_f32_16x16x32_bf16 v[176:179], v[112:115], v[104:107], v[176:179]
    v_mfma_f32_16x16x32_bf16 v[180:183], v[116:119], v[104:107], v[180:183]
    v_mfma_f32_16x16x32_bf16 v[184:187], v[120:123], v[104:107], v[184:187]
    v_mfma_f32_16x16x32_bf16 v[188:191], v[124:127], v[104:107], v[188:191]
    s_waitcnt lgkmcnt(0)
    s_sub_u32 s23, s23, 1
    s_cmp_lg_u32 s23, 0
    s_cbranch_scc1 w_loopM
w_doneM:
    v_mov_b32 v20, 131072
    ds_read_b128 v[24:27], v20
    ds_read_b128 v[28:31], v20 offset:16
    s_lshl_b32 s30, s27, 10
    s_add_u32 s30, s30, s49
    s_nop 7
    v_cvt_pk_bf16_f32 v80, v128, v129
    v_cvt_pk_bf16_f32 v81, v130, v131
    v_cvt_pk_bf16_f32 v82, v132, v133
    v_cvt_pk_bf16_f32 v83, v134, v135
    buffer_store_dwordx4 v[80:83], v1, s[4:7], s30 offen sc1
    v_cvt_pk_bf16_f32 v84, v136, v137
    v_cvt_pk_bf16_f32 v85, v138, v139
    v_cvt_pk_bf16_f32 v86, v140, v141
    v_cvt_pk_bf16_f32 v87, v142, v143
    buffer_store_dwordx4 v[84:87], v19, s[4:7], s30 offen sc1
    s_add_u32 s30, s30, s50
    v_cvt_pk_bf16_f32 v88, v144, v145
    v_cvt_pk_bf16_f32 v89, v146, v147
    v_cvt_pk_bf16_f32 v90, v148, v149
    v_cvt_pk_bf16_f32 v91, v150, v151
    buffer_store_dwordx4 v[88:91], v1, s[4:7], s30 offen sc1
    v_cvt_pk_bf16_f32 v92, v152, v153
    v_cvt_pk_bf16_f32 v93, v154, v155
    v_cvt_pk_bf16_f32 v94, v156, v157
    v_cvt_pk_bf16_f32 v95, v158, v159
    buffer_store_dwordx4 v[92:95], v19, s[4:7], s30 offen sc1
    s_add_u32 s30, s30, s50
    v_cvt_pk_bf16_f32 v80, v160, v161
    v_cvt_pk_bf16_f32 v81, v162, v163
    v_cvt_pk_bf16_f32 v82, v164, v165
    v_cvt_pk_bf16_f32 v83, v166, v167
    buffer_store_dwordx4 v[80:83], v1, s[4:7], s30 offen sc1
    v_cvt_pk_bf16_f32 v84, v168, v169
    v_cvt_pk_bf16_f32 v85, v170, v171
    v_cvt_pk_bf16_f32 v86, v172, v173
    v_cvt_pk_bf16_f32 v87, v174, v175
    buffer_store_dwordx4 v[84:87], v19, s[4:7], s30 offen sc1
    s_add_u32 s30, s30, s50
    v_cvt_pk_bf16_f32 v88, v176, v177
    v_cvt_pk_bf16_f32 v89, v178, v179
    v_cvt_pk_bf16_f32 v90, v180, v181
    v_cvt_pk_bf16_f32 v91, v182, v183
    buffer_store_dwordx4 v[88:91], v1, s[4:7], s30 offen sc1
    v_cvt_pk_bf16_f32 v92, v184, v185
    v_cvt_pk_bf16_f32 v93, v186, v187
    v_cvt_pk_bf16_f32 v94, v188, v189
    v_cvt_pk_bf16_f32 v95, v190, v191
    buffer_store_dwordx4 v[92:95], v19, s[4:7], s30 offen sc1
    s_add_u32 s30, s30, s50
    s_waitcnt lgkmcnt(0)
    v_or3_b32 v24, v24, v25, v26
    v_or3_b32 v28, v28, v29, v30
    v_or3_b32 v24, v24, v27, v31
    v_or_b32 v24, v24, v28
    s_mov_b32 s28, s51
    s_mov_b32 s57, s53
    v_readfirstlane_b32 s30, v24
    s_cmp_lg_u32 s30, 0
    s_cbranch_scc1 w_drain
    s_mov_b32 s48, s32
    s_cmp_ge_u32 s32, 4
    s_cselect_b32 s30, 2, 3
    s_lshl_b32 s30, s26, s30
    s_mul_i32 s30, s30, s43
    s_add_u32 s49, s42, s30
    s_mov_b32 s50, s43
    s_mov_b32 s51, s46
    s_mov_b32 s23, s41
    s_mov_b32 s53, s47
    s_nop 0
    s_load_dwordx16 s[32:47], s[24:25], 0
    s_add_u32 s24, s24, 64
    s_addc_u32 s25, s25, 0
    s_branch w_first8
w_drain:
    s_waitcnt vmcnt(0)
    s_barrier
    s_cmp_eq_u32 s70, 0
    s_cbranch_scc1 drw_ok
    s_mov_b32 s70, 0
    s_cmp_lg_u32 s3, 0
    s_cbranch_scc1 drw_ok
    v_readfirstlane_b32 s68, v22
    s_cmp_ge_u32 s68, 128
    s_cbranch_scc1 drw_ok
    s_mov_b32 s69, 65536
drw:
    buffer_load_dword v20, off, s[64:67], 0 offset:0 sc1
    s_waitcnt vmcnt(0)
    v_readfirstlane_b32 s68, v20
    s_cmp_ge_u32 s68, 128
    s_cbranch_scc1 drw_ok
    s_sleep 8
    s_sub_u32 s69, s69, 1
    s_cbranch_scc0 drw
drw_ok:
    s_cmp_eq_u32 s28, 0
    s_cbranch_scc1 sig_5
    s_cmp_lg_u32 s3, 0
    s_cbranch_scc1 sig_5
    s_mov_b64 exec, 1
    v_mov_b32 v18, s57
    buffer_atomic_add v18, v17, s[4:7], s28 offen sc1
    s_mov_b64 exec, -1
sig_5:
    s_mov_b32 s28, 0
    s_branch w_cold
fin_entry:
    s_load_dwordx2 s[8:9], s[0:1], 0
    s_load_dwordx2 s[12:13], s[0:1], 88
    v_mbcnt_lo_u32_b32 v1, -1, 0
    v_mbcnt_hi_u32_b32 v1, -1, v1
    s_mov_b32 s10, 4194304
    s_mov_b32 s11, 131072
    s_mov_b32 s14, 4194304
    s_mov_b32 s15, 131072
    v_lshlrev_b32 v3, 4, v1
    v_and_b32 v4, 15, v1
    v_lshrrev_b32 v5, 4, v1
    v_lshlrev_b32 v4, 11, v4
    v_lshl_add_u32 v4, v5, 4, v4
    v_and_b32 v5, 1, v5
    v_cmp_eq_u32 s[20:21], 1, v5
    v_and_b32 v6, 7, v1
    v_lshlrev_b32 v6, 7, v6
    s_lshr_b32 s24, s63, 2
    s_and_b32 s25, s63, 3
    s_lshl_b32 s25, s25, 2
    s_and_b32 s26, s3, 3
    s_add_u32 s25, s25, s26
    s_lshr_b32 s26, s3, 2
    s_mov_b32 s28, 65536
    s_waitcnt lgkmcnt(0)
fin_job:
    s_lshl_b32 s16, s24, 1
    s_add_u32 s16, s16, s26
    s_lshl_b32 s18, s16, 15
    s_lshl_b32 s17, s25, 11
    s_add_u32 s17, s17, s18
    s_lshl_b32 s19, s25, 7
    s_add_u32 s18, s18, s19
    s_add_u32 s22, s17, 167772160
    s_add_u32 s23, s17, 75497472
    s_lshr_b32 s27, s24, 3
    s_lshl_b32 s27, s27, 6
    s_add_u32 s27, s27, 218106368
    s_cmp_ge_u32 s24, 64
    s_cselect_b32 s29, 16, 16
    s_mov_b32 s30, 218112000
    s_add_u32 s32, s24, 1
    s_mov_b32 s33, 0
    s_mov_b32 s34, 255
    s_cmp_lt_u32 s24, 62
    s_cbranch_scc1 fin_tg
    s_mov_b32 s32, 16
    s_add_u32 s30, s30, 4
    s_sub_u32 s33, s24, 62
    s_lshl_b32 s33, s33, 3
fin_tg:
    s_mul_i32 s35, s24, 3
    s_lshr_b32 s35, s35, 4
    s_add_u32 s35, s35, 49
    s_min_u32 s35, s35, 61
    s_max_u32 s32, s32, s35
    buffer_load_dwordx4 v[88:91], v4, s[8:11], s18 offen offset:0
    buffer_load_dwordx4 v[92:95], v4, s[8:11], s18 offen offset:64
    s_cmp_lg_u32 s3, 0
    s_cbranch_scc1 fin_ws_ok
fin_wd:
    buffer_load_dword v7, off, s[4:7], s27 sc1
    s_waitcnt vmcnt(0)
    v_readfirstlane_b32 s31, v7
    s_cmp_ge_u32 s31, s29
    s_cbranch_scc1 fin_wd_ok
    s_sleep 127
    s_sub_u32 s28, s28, 1
    s_cbranch_scc0 fin_wd
    s_mov_b32 s28, 0
fin_wd_ok:
fin_ws:
    buffer_load_dword v7, v6, s[4:7], s30 offen sc1
    s_waitcnt vmcnt(0)
    v_lshrrev_b32 v7, s33, v7
    v_and_b32 v7, s34, v7
    v_cmp_gt_u32 vcc, s32, v7
    s_cbranch_vccz fin_ws_ok
    s_sleep 12
    v_add_u32 v7, 1, v7
    v_cmp_gt_u32 vcc, s32, v7
    s_cbranch_vccz fin_ws_f
    s_sleep 48
    v_add_u32 v7, 3, v7
    v_cmp_gt_u32 vcc, s32, v7
    s_cbranch_vccz fin_ws_f
    s_sleep 127
    s_sleep 127
fin_ws_f:
    s_sub_u32 s28, s28, 1
    s_cbranch_scc0 fin_ws
    s_mov_b32 s28, 0
fin_ws_ok:
    s_barrier
    buffer_load_dwordx4 v[144:147], v3, s[4:7], s22 offen offset:0 sc1
    buffer_load_dwordx4 v[160:163], v3, s[4:7], s22 offen offset:1024 sc1
    s_add_u32 s22, s22, 4194304
    buffer_load_dwordx4 v[148:151], v3, s[4:7], s22 offen offset:0 sc1
    buffer_load_dwordx4 v[164:167], v3, s[4:7], s22 offen offset:1024 sc1
    s_add_u32 s22, s22, 4194304
    buffer_load_dwordx4 v[152:155], v3, s[4:7], s22 offen offset:0 sc1
    buffer_load_dwordx4 v[168:171], v3, s[4:7], s22 offen offset:1024 sc1
    s_add_u32 s22, s22, 4194304
    buffer_load_dwordx4 v[156:159], v3, s[4:7], s22 offen offset:0 sc1
    buffer_load_dwordx4 v[172:175], v3, s[4:7], s22 offen offset:1024 sc1
    buffer_load_dwordx4 v[16:19], v3, s[4:7], s23 offen offset:0 sc1
    buffer_load_dwordx4 v[48:51], v3, s[4:7], s23 offen offset:1024 sc1
    s_add_u32 s23, s23, 4194304
    buffer_load_dwordx4 v[20:23], v3, s[4:7], s23 offen offset:0 sc1
    buffer_load_dwordx4 v[52:55], v3, s[4:7], s23 offen offset:1024 sc1
    s_add_u32 s23, s23, 4194304
    buffer_load_dwordx4 v[24:27], v3, s[4:7], s23 offen offset:0 sc1
    buffer_load_dwordx4 v[56:59], v3, s[4:7], s23 offen offset:1024 sc1
    s_add_u32 s23, s23, 4194304
    buffer_load_dwordx4 v[28:31], v3, s[4:7], s23 offen offset:0 sc1
    buffer_load_dwordx4 v[60:63], v3, s[4:7], s23 offen offset:1024 sc1
    s_add_u32 s23, s23, 4194304
    buffer_load_dwordx4 v[32:35], v3, s[4:7], s23 offen offset:0 sc1
    buffer_load_dwordx4 v[64:67], v3, s[4:7], s23 offen offset:1024 sc1
    s_add_u32 s23, s23, 4194304
    buffer_load_dwordx4 v[36:39], v3, s[4:7], s23 offen offset:0 sc1
    buffer_load_dwordx4 v[68:71], v3, s[4:7], s23 offen offset:1024 sc1
    s_add_u32 s23, s23, 4194304
    buffer_load_dwordx4 v[40:43], v3, s[4:7], s23 offen offset:0 sc1
    buffer_load_dwordx4 v[72:75], v3, s[4:7], s23 offen offset:1024 sc1
    s_add_u32 s23, s23, 4194304
    buffer_load_dwordx4 v[44:47], v3, s[4:7], s23 offen offset:0 sc1
    buffer_load_dwordx4 v[76:79], v3, s[4:7], s23 offen offset:1024 sc1
    s_add_u32 s23, s23, 4194304
    s_waitcnt vmcnt(16)
    v_lshlrev_b32 v96, 16, v144
    v_and_b32 v97, 0xffff0000, v144
    v_lshlrev_b32 v98, 16, v145
    v_and_b32 v99, 0xffff0000, v145
    v_lshlrev_b32 v100, 16, v146
    v_and_b32 v101, 0xffff0000, v146
    v_lshlrev_b32 v102, 16, v147
    v_and_b32 v103, 0xffff0000, v147
    v_lshlrev_b32 v120, 16, v148
    v_and_b32 v121, 0xffff0000, v148
    v_lshlrev_b32 v122, 16, v149
    v_and_b32 v123, 0xffff0000, v149
    v_lshlrev_b32 v124, 16, v150
    v_and_b32 v125, 0xffff0000, v150
    v_lshlrev_b32 v126, 16, v151
    v_and_b32 v127, 0xffff0000, v151
    v_add_f32 v96, v96, v120
    v_add_f32 v97, v97, v121
    v_add_f32 v98, v98, v122
    v_add_f32 v99, v99, v123
    v_add_f32 v100, v100, v124
    v_add_f32 v101, v101, v125
    v_add_f32 v102, v102, v126
    v_add_f32 v103, v103, v127
    v_lshlrev_b32 v120, 16, v152
    v_and_b32 v121, 0xffff0000, v152
    v_lshlrev_b32 v122, 16, v153
    v_and_b32 v123, 0xffff0000, v153
    v_lshlrev_b32 v124, 16, v154
    v_and_b32 v125, 0xffff0000, v154
    v_lshlrev_b32 v126, 16, v155
    v_and_b32 v127, 0xffff0000, v155
    v_add_f32 v96, v96, v120
    v_add_f32 v97, v97, v121
    v_add_f32 v98, v98, v122
    v_add_f32 v99, v99, v123
    v_add_f32 v100, v100, v124
    v_add_f32 v101, v101, v125
    v_add_f32 v102, v102, v126
    v_add_f32 v103, v103, v127
    v_lshlrev_b32 v120, 16, v156
    v_and_b32 v121, 0xffff0000, v156
    v_lshlrev_b32 v122, 16, v157
    v_and_b32 v123, 0xffff0000, v157
    v_lshlrev_b32 v124, 16, v158
    v_and_b32 v125, 0xffff0000, v158
    v_lshlrev_b32 v126, 16, v159
    v_and_b32 v127, 0xffff0000, v159
    v_add_f32 v96, v96, v120
    v_add_f32 v97, v97, v121
    v_add_f32 v98, v98, v122
    v_add_f32 v99, v99, v123
    v_add_f32 v100, v100, v124
    v_add_f32 v101, v101, v125
    v_add_f32 v102, v102, v126
    v_add_f32 v103, v103, v127
    v_cvt_pk_bf16_f32 v120, v96, v97
    v_cvt_pk_bf16_f32 v121, v98, v99
    v_cvt_pk_bf16_f32 v122, v100, v101
    v_cvt_pk_bf16_f32 v123, v102, v103
    v_lshlrev_b32 v96, 16, v120
    v_and_b32 v97, 0xffff0000, v120
    v_lshlrev_b32 v98, 16, v121
    v_and_b32 v99, 0xffff0000, v121
    v_lshlrev_b32 v100, 16, v122
    v_and_b32 v101, 0xffff0000, v122
    v_lshlrev_b32 v102, 16, v123
    v_and_b32 v103, 0xffff0000, v123
    v_mul_f32 v104, 0xbfb8aa3b, v96
    v_mul_f32 v105, 0xbfb8aa3b, v97
    v_mul_f32 v106, 0xbfb8aa3b, v98
    v_mul_f32 v107, 0xbfb8aa3b, v99
    v_mul_f32 v108, 0xbfb8aa3b, v100
    v_mul_f32 v109, 0xbfb8aa3b, v101
    v_mul_f32 v110, 0xbfb8aa3b, v102
    v_mul_f32 v111, 0xbfb8aa3b, v103
    v_exp_f32 v104, v104
    v_exp_f32 v105, v105
    v_exp_f32 v106, v106
    v_exp_f32 v107, v107
    v_exp_f32 v108, v108
    v_exp_f32 v109, v109
    v_exp_f32 v110, v110
    v_exp_f32 v111, v111
    v_add_f32 v104, 1.0, v104
    v_add_f32 v105, 1.0, v105
    v_add_f32 v106, 1.0, v106
    v_add_f32 v107, 1.0, v107
    v_add_f32 v108, 1.0, v108
    v_add_f32 v109, 1.0, v109
    v_add_f32 v110, 1.0, v110
    v_add_f32 v111, 1.0, v111
    v_rcp_f32 v104, v104
    v_rcp_f32 v105, v105
    v_rcp_f32 v106, v106
    v_rcp_f32 v107, v107
    v_rcp_f32 v108, v108
    v_rcp_f32 v109, v109
    v_rcp_f32 v110, v110
    v_rcp_f32 v111, v111
    v_mul_f32 v96, v96, v104
    v_mul_f32 v97, v97, v105
    v_mul_f32 v98, v98, v106
    v_mul_f32 v99, v99, v107
    v_mul_f32 v100, v100, v108
    v_mul_f32 v101, v101, v109
    v_mul_f32 v102, v102, v110
    v_mul_f32 v103, v103, v111
    v_cvt_pk_bf16_f32 v80, v96, v97
    v_cvt_pk_bf16_f32 v81, v98, v99
    v_cvt_pk_bf16_f32 v82, v100, v101
    v_cvt_pk_bf16_f32 v83, v102, v103
    v_lshlrev_b32 v96, 16, v160
    v_and_b32 v97, 0xffff0000, v160
    v_lshlrev_b32 v98, 16, v161
    v_and_b32 v99, 0xffff0000, v161
    v_lshlrev_b32 v100, 16, v162
    v_and_b32 v101, 0xffff0000, v162
    v_lshlrev_b32 v102, 16, v163
    v_and_b32 v103, 0xffff0000, v163
    v_lshlrev_b32 v120, 16, v164
    v_and_b32 v121, 0xffff0000, v164
    v_lshlrev_b32 v122, 16, v165
    v_and_b32 v123, 0xffff0000, v165
    v_lshlrev_b32 v124, 16, v166
    v_and_b32 v125, 0xffff0000, v166
    v_lshlrev_b32 v126, 16, v167
    v_and_b32 v127, 0xffff0000, v167
    v_add_f32 v96, v96, v120
    v_add_f32 v97, v97, v121
    v_add_f32 v98, v98, v122
    v_add_f32 v99, v99, v123
    v_add_f32 v100, v100, v124
    v_add_f32 v101, v101, v125
    v_add_f32 v102, v102, v126
    v_add_f32 v103, v103, v127
    v_lshlrev_b32 v120, 16, v168
    v_and_b32 v121, 0xffff0000, v168
    v_lshlrev_b32 v122, 16, v169
    v_and_b32 v123, 0xffff0000, v169
    v_lshlrev_b32 v124, 16, v170
    v_and_b32 v125, 0xffff0000, v170
    v_lshlrev_b32 v126, 16, v171
    v_and_b32 v127, 0xffff0000, v171
    v_add_f32 v96, v96, v120
    v_add_f32 v97, v97, v121
    v_add_f32 v98, v98, v122
    v_add_f32 v99, v99, v123
    v_add_f32 v100, v100, v124
    v_add_f32 v101, v101, v125
    v_add_f32 v102, v102, v126
    v_add_f32 v103, v103, v127
    v_lshlrev_b32 v120, 16, v172
    v_and_b32 v121, 0xffff0000, v172
    v_lshlrev_b32 v122, 16, v173
    v_and_b32 v123, 0xffff0000, v173
    v_lshlrev_b32 v124, 16, v174
    v_and_b32 v125, 0xffff0000, v174
    v_lshlrev_b32 v126, 16, v175
    v_and_b32 v127, 0xffff0000, v175
    v_add_f32 v96, v96, v120
    v_add_f32 v97, v97, v121
    v_add_f32 v98, v98, v122
    v_add_f32 v99, v99, v123
    v_add_f32 v100, v100, v124
    v_add_f32 v101, v101, v125
    v_add_f32 v102, v102, v126
    v_add_f32 v103, v103, v127
    v_cvt_pk_bf16_f32 v120, v96, v97
    v_cvt_pk_bf16_f32 v121, v98, v99
    v_cvt_pk_bf16_f32 v122, v100, v101
    v_cvt_pk_bf16_f32 v123, v102, v103
    v_lshlrev_b32 v96, 16, v120
    v_and_b32 v97, 0xffff0000, v120
    v_lshlrev_b32 v98, 16, v121
    v_and_b32 v99, 0xffff0000, v121
    v_lshlrev_b32 v100, 16, v122
    v_and_b32 v101, 0xffff0000, v122
    v_lshlrev_b32 v102, 16, v123
    v_and_b32 v103, 0xffff0000, v123
    v_mul_f32 v104, 0xbfb8aa3b, v96
    v_mul_f32 v105, 0xbfb8aa3b, v97
    v_mul_f32 v106, 0xbfb8aa3b, v98
    v_mul_f32 v107, 0xbfb8aa3b, v99
    v_mul_f32 v108, 0xbfb8aa3b, v100
    v_mul_f32 v109, 0xbfb8aa3b, v101
    v_mul_f32 v110, 0xbfb8aa3b, v102
    v_mul_f32 v111, 0xbfb8aa3b, v103
    v_exp_f32 v104, v104
    v_exp_f32 v105, v105
    v_exp_f32 v106, v106
    v_exp_f32 v107, v107
    v_exp_f32 v108, v108
    v_exp_f32 v109, v109
    v_exp_f32 v110, v110
    v_exp_f32 v111, v111
    v_add_f32 v104, 1.0, v104
    v_add_f32 v105, 1.0, v105
    v_add_f32 v106, 1.0, v106
    v_add_f32 v107, 1.0, v107
    v_add_f32 v108, 1.0, v108
    v_add_f32 v109, 1.0, v109
    v_add_f32 v110, 1.0, v110
    v_add_f32 v111, 1.0, v111
    v_rcp_f32 v104, v104
    v_rcp_f32 v105, v105
    v_rcp_f32 v106, v106
    v_rcp_f32 v107, v107
    v_rcp_f32 v108, v108
    v_rcp_f32 v109, v109
    v_rcp_f32 v110, v110
    v_rcp_f32 v111, v111
    v_mul_f32 v96, v96, v104
    v_mul_f32 v97, v97, v105
    v_mul_f32 v98, v98, v106
    v_mul_f32 v99, v99, v107
    v_mul_f32 v100, v100, v108
    v_mul_f32 v101, v101, v109
    v_mul_f32 v102, v102, v110
    v_mul_f32 v103, v103, v111
    v_cvt_pk_bf16_f32 v84, v96, v97
    v_cvt_pk_bf16_f32 v85, v98, v99
    v_cvt_pk_bf16_f32 v86, v100, v101
    v_cvt_pk_bf16_f32 v87, v102, v103
    s_waitcnt vmcnt(0)
    v_lshlrev_b32 v96, 16, v16
    v_and_b32 v97, 0xffff0000, v16
    v_lshlrev_b32 v98, 16, v17
    v_and_b32 v99, 0xffff0000, v17
    v_lshlrev_b32 v100, 16, v18
    v_and_b32 v101, 0xffff0000, v18
    v_lshlrev_b32 v102, 16, v19
    v_and_b32 v103, 0xffff0000, v19
    v_lshlrev_b32 v120, 16, v20
    v_and_b32 v121, 0xffff0000, v20
    v_lshlrev_b32 v122, 16, v21
    v_and_b32 v123, 0xffff0000, v21
    v_lshlrev_b32 v124, 16, v22
    v_and_b32 v125, 0xffff0000, v22
    v_lshlrev_b32 v126, 16, v23
    v_and_b32 v127, 0xffff0000, v23
    v_add_f32 v96, v96, v120
    v_add_f32 v97, v97, v121
    v_add_f32 v98, v98, v122
    v_add_f32 v99, v99, v123
    v_add_f32 v100, v100, v124
    v_add_f32 v101, v101, v125
    v_add_f32 v102, v102, v126
    v_add_f32 v103, v103, v127
    v_lshlrev_b32 v120, 16, v24
    v_and_b32 v121, 0xffff0000, v24
    v_lshlrev_b32 v122, 16, v25
    v_and_b32 v123, 0xffff0000, v25
    v_lshlrev_b32 v124, 16, v26
    v_and_b32 v125, 0xffff0000, v26
    v_lshlrev_b32 v126, 16, v27
    v_and_b32 v127, 0xffff0000, v27
    v_add_f32 v96, v96, v120
    v_add_f32 v97, v97, v121
    v_add_f32 v98, v98, v122
    v_add_f32 v99, v99, v123
    v_add_f32 v100, v100, v124
    v_add_f32 v101, v101, v125
    v_add_f32 v102, v102, v126
    v_add_f32 v103, v103, v127
    v_lshlrev_b32 v120, 16, v28
    v_and_b32 v121, 0xffff0000, v28
    v_lshlrev_b32 v122, 16, v29
    v_and_b32 v123, 0xffff0000, v29
    v_lshlrev_b32 v124, 16, v30
    v_and_b32 v125, 0xffff0000, v30
    v_lshlrev_b32 v126, 16, v31
    v_and_b32 v127, 0xffff0000, v31
    v_add_f32 v96, v96, v120
    v_add_f32 v97, v97, v121
    v_add_f32 v98, v98, v122
    v_add_f32 v99, v99, v123
    v_add_f32 v100, v100, v124
    v_add_f32 v101, v101, v125
    v_add_f32 v102, v102, v126
    v_add_f32 v103, v103, v127
    v_lshlrev_b32 v120, 16, v32
    v_and_b32 v121, 0xffff0000, v32
    v_lshlrev_b32 v122, 16, v33
    v_and_b32 v123, 0xffff0000, v33
    v_lshlrev_b32 v124, 16, v34
    v_and_b32 v125, 0xffff0000, v34
    v_lshlrev_b32 v126, 16, v35
    v_and_b32 v127, 0xffff0000, v35
    v_add_f32 v96, v96, v120
    v_add_f32 v97, v97, v121
    v_add_f32 v98, v98, v122
    v_add_f32 v99, v99, v123
    v_add_f32 v100, v100, v124
    v_add_f32 v101, v101, v125
    v_add_f32 v102, v102, v126
    v_add_f32 v103, v103, v127
    v_lshlrev_b32 v120, 16, v36
    v_and_b32 v121, 0xffff0000, v36
    v_lshlrev_b32 v122, 16, v37
    v_and_b32 v123, 0xffff0000, v37
    v_lshlrev_b32 v124, 16, v38
    v_and_b32 v125, 0xffff0000, v38
    v_lshlrev_b32 v126, 16, v39
    v_and_b32 v127, 0xffff0000, v39
    v_add_f32 v96, v96, v120
    v_add_f32 v97, v97, v121
    v_add_f32 v98, v98, v122
    v_add_f32 v99, v99, v123
    v_add_f32 v100, v100, v124
    v_add_f32 v101, v101, v125
    v_add_f32 v102, v102, v126
    v_add_f32 v103, v103, v127
    v_lshlrev_b32 v120, 16, v40
    v_and_b32 v121, 0xffff0000, v40
    v_lshlrev_b32 v122, 16, v41
    v_and_b32 v123, 0xffff0000, v41
    v_lshlrev_b32 v124, 16, v42
    v_and_b32 v125, 0xffff0000, v42
    v_lshlrev_b32 v126, 16, v43
    v_and_b32 v127, 0xffff0000, v43
    v_add_f32 v96, v96, v120
    v_add_f32 v97, v97, v121
    v_add_f32 v98, v98, v122
    v_add_f32 v99, v99, v123
    v_add_f32 v100, v100, v124
    v_add_f32 v101, v101, v125
    v_add_f32 v102, v102, v126
    v_add_f32 v103, v103, v127
    v_lshlrev_b32 v120, 16, v44
    v_and_b32 v121, 0xffff0000, v44
    v_lshlrev_b32 v122, 16, v45
    v_and_b32 v123, 0xffff0000, v45
    v_lshlrev_b32 v124, 16, v46
    v_and_b32 v125, 0xffff0000, v46
    v_lshlrev_b32 v126, 16, v47
    v_and_b32 v127, 0xffff0000, v47
    v_add_f32 v96, v96, v120
    v_add_f32 v97, v97, v121
    v_add_f32 v98, v98, v122
    v_add_f32 v99, v99, v123
    v_add_f32 v100, v100, v124
    v_add_f32 v101, v101, v125
    v_add_f32 v102, v102, v126
    v_add_f32 v103, v103, v127
    v_cndmask_b32 v108, v88, v90, s[20:21]
    v_cndmask_b32 v109, v89, v91, s[20:21]
    v_cndmask_b32 v110, v90, v88, s[20:21]
    v_cndmask_b32 v111, v91, v89, s[20:21]
    v_cvt_pk_bf16_f32 v104, v96, v97
    v_lshlrev_b32 v96, 16, v104
    v_and_b32 v97, 0xffff0000, v104
    v_lshlrev_b32 v104, 16, v80
    v_and_b32 v105, 0xffff0000, v80
    v_mul_f32 v96, v96, v104
    v_mul_f32 v97, v97, v105
    v_cvt_pk_bf16_f32 v104, v96, v97
    v_lshlrev_b32 v96, 16, v104
    v_and_b32 v97, 0xffff0000, v104
    v_lshlrev_b32 v104, 16, v108
    v_and_b32 v105, 0xffff0000, v108
    v_add_f32 v96, v96, v104
    v_add_f32 v97, v97, v105
    v_cvt_pk_bf16_f32 v112, v96, v97
    v_cvt_pk_bf16_f32 v104, v98, v99
    v_lshlrev_b32 v98, 16, v104
    v_and_b32 v99, 0xffff0000, v104
    v_lshlrev_b32 v104, 16, v81
    v_and_b32 v105, 0xffff0000, v81
    v_mul_f32 v98, v98, v104
    v_mul_f32 v99, v99, v105
    v_cvt_pk_bf16_f32 v104, v98, v99
    v_lshlrev_b32 v98, 16, v104
    v_and_b32 v99, 0xffff0000, v104
    v_lshlrev_b32 v104, 16, v109
    v_and_b32 v105, 0xffff0000, v109
    v_add_f32 v98, v98, v104
    v_add_f32 v99, v99, v105
    v_cvt_pk_bf16_f32 v113, v98, v99
    v_cvt_pk_bf16_f32 v104, v100, v101
    v_lshlrev_b32 v100, 16, v104
    v_and_b32 v101, 0xffff0000, v104
    v_lshlrev_b32 v104, 16, v82
    v_and_b32 v105, 0xffff0000, v82
    v_mul_f32 v100, v100, v104
    v_mul_f32 v101, v101, v105
    v_cvt_pk_bf16_f32 v104, v100, v101
    v_lshlrev_b32 v100, 16, v104
    v_and_b32 v101, 0xffff0000, v104
    v_lshlrev_b32 v104, 16, v110
    v_and_b32 v105, 0xffff0000, v110
    v_add_f32 v100, v100, v104
    v_add_f32 v101, v101, v105
    v_cvt_pk_bf16_f32 v114, v100, v101
    v_cvt_pk_bf16_f32 v104, v102, v103
    v_lshlrev_b32 v102, 16, v104
    v_and_b32 v103, 0xffff0000, v104
    v_lshlrev_b32 v104, 16, v83
    v_and_b32 v105, 0xffff0000, v83
    v_mul_f32 v102, v102, v104
    v_mul_f32 v103, v103, v105
    v_cvt_pk_bf16_f32 v104, v102, v103
    v_lshlrev_b32 v102, 16, v104
    v_and_b32 v103, 0xffff0000, v104
    v_lshlrev_b32 v104, 16, v111
    v_and_b32 v105, 0xffff0000, v111
    v_add_f32 v102, v102, v104
    v_add_f32 v103, v103, v105
    v_cvt_pk_bf16_f32 v115, v102, v103
    v_cndmask_b32 v128, v112, v114, s[20:21]
    v_cndmask_b32 v129, v113, v115, s[20:21]
    v_cndmask_b32 v130, v114, v112, s[20:21]
    v_cndmask_b32 v131, v115, v113, s[20:21]
    buffer_store_dwordx4 v[128:131], v4, s[12:15], s18 offen offset:0
    v_lshlrev_b32 v96, 16, v48
    v_and_b32 v97, 0xffff0000, v48
    v_lshlrev_b32 v98, 16, v49
    v_and_b32 v99, 0xffff0000, v49
    v_lshlrev_b32 v100, 16, v50
    v_and_b32 v101, 0xffff0000, v50
    v_lshlrev_b32 v102, 16, v51
    v_and_b32 v103, 0xffff0000, v51
    v_lshlrev_b32 v120, 16, v52
    v_and_b32 v121, 0xffff0000, v52
    v_lshlrev_b32 v122, 16, v53
    v_and_b32 v123, 0xffff0000, v53
    v_lshlrev_b32 v124, 16, v54
    v_and_b32 v125, 0xffff0000, v54
    v_lshlrev_b32 v126, 16, v55
    v_and_b32 v127, 0xffff0000, v55
    v_add_f32 v96, v96, v120
    v_add_f32 v97, v97, v121
    v_add_f32 v98, v98, v122
    v_add_f32 v99, v99, v123
    v_add_f32 v100, v100, v124
    v_add_f32 v101, v101, v125
    v_add_f32 v102, v102, v126
    v_add_f32 v103, v103, v127
    v_lshlrev_b32 v120, 16, v56
    v_and_b32 v121, 0xffff0000, v56
    v_lshlrev_b32 v122, 16, v57
    v_and_b32 v123, 0xffff0000, v57
    v_lshlrev_b32 v124, 16, v58
    v_and_b32 v125, 0xffff0000, v58
    v_lshlrev_b32 v126, 16, v59
    v_and_b32 v127, 0xffff0000, v59
    v_add_f32 v96, v96, v120
    v_add_f32 v97, v97, v121
    v_add_f32 v98, v98, v122
    v_add_f32 v99, v99, v123
    v_add_f32 v100, v100, v124
    v_add_f32 v101, v101, v125
    v_add_f32 v102, v102, v126
    v_add_f32 v103, v103, v127
    v_lshlrev_b32 v120, 16, v60
    v_and_b32 v121, 0xffff0000, v60
    v_lshlrev_b32 v122, 16, v61
    v_and_b32 v123, 0xffff0000, v61
    v_lshlrev_b32 v124, 16, v62
    v_and_b32 v125, 0xffff0000, v62
    v_lshlrev_b32 v126, 16, v63
    v_and_b32 v127, 0xffff0000, v63
    v_add_f32 v96, v96, v120
    v_add_f32 v97, v97, v121
    v_add_f32 v98, v98, v122
    v_add_f32 v99, v99, v123
    v_add_f32 v100, v100, v124
    v_add_f32 v101, v101, v125
    v_add_f32 v102, v102, v126
    v_add_f32 v103, v103, v127
    v_lshlrev_b32 v120, 16, v64
    v_and_b32 v121, 0xffff0000, v64
    v_lshlrev_b32 v122, 16, v65
    v_and_b32 v123, 0xffff0000, v65
    v_lshlrev_b32 v124, 16, v66
    v_and_b32 v125, 0xffff0000, v66
    v_lshlrev_b32 v126, 16, v67
    v_and_b32 v127, 0xffff0000, v67
    v_add_f32 v96, v96, v120
    v_add_f32 v97, v97, v121
    v_add_f32 v98, v98, v122
    v_add_f32 v99, v99, v123
    v_add_f32 v100, v100, v124
    v_add_f32 v101, v101, v125
    v_add_f32 v102, v102, v126
    v_add_f32 v103, v103, v127
    v_lshlrev_b32 v120, 16, v68
    v_and_b32 v121, 0xffff0000, v68
    v_lshlrev_b32 v122, 16, v69
    v_and_b32 v123, 0xffff0000, v69
    v_lshlrev_b32 v124, 16, v70
    v_and_b32 v125, 0xffff0000, v70
    v_lshlrev_b32 v126, 16, v71
    v_and_b32 v127, 0xffff0000, v71
    v_add_f32 v96, v96, v120
    v_add_f32 v97, v97, v121
    v_add_f32 v98, v98, v122
    v_add_f32 v99, v99, v123
    v_add_f32 v100, v100, v124
    v_add_f32 v101, v101, v125
    v_add_f32 v102, v102, v126
    v_add_f32 v103, v103, v127
    v_lshlrev_b32 v120, 16, v72
    v_and_b32 v121, 0xffff0000, v72
    v_lshlrev_b32 v122, 16, v73
    v_and_b32 v123, 0xffff0000, v73
    v_lshlrev_b32 v124, 16, v74
    v_and_b32 v125, 0xffff0000, v74
    v_lshlrev_b32 v126, 16, v75
    v_and_b32 v127, 0xffff0000, v75
    v_add_f32 v96, v96, v120
    v_add_f32 v97, v97, v121
    v_add_f32 v98, v98, v122
    v_add_f32 v99, v99, v123
    v_add_f32 v100, v100, v124
    v_add_f32 v101, v101, v125
    v_add_f32 v102, v102, v126
    v_add_f32 v103, v103, v127
    v_lshlrev_b32 v120, 16, v76
    v_and_b32 v121, 0xffff0000, v76
    v_lshlrev_b32 v122, 16, v77
    v_and_b32 v123, 0xffff0000, v77
    v_lshlrev_b32 v124, 16, v78
    v_and_b32 v125, 0xffff0000, v78
    v_lshlrev_b32 v126, 16, v79
    v_and_b32 v127, 0xffff0000, v79
    v_add_f32 v96, v96, v120
    v_add_f32 v97, v97, v121
    v_add_f32 v98, v98, v122
    v_add_f32 v99, v99, v123
    v_add_f32 v100, v100, v124
    v_add_f32 v101, v101, v125
    v_add_f32 v102, v102, v126
    v_add_f32 v103, v103, v127
    v_cndmask_b32 v108, v92, v94, s[20:21]
    v_cndmask_b32 v109, v93, v95, s[20:21]
    v_cndmask_b32 v110, v94, v92, s[20:21]
    v_cndmask_b32 v111, v95, v93, s[20:21]
    v_cvt_pk_bf16_f32 v104, v96, v97
    v_lshlrev_b32 v96, 16, v104
    v_and_b32 v97, 0xffff0000, v104
    v_lshlrev_b32 v104, 16, v84
    v_and_b32 v105, 0xffff0000, v84
    v_mul_f32 v96, v96, v104
    v_mul_f32 v97, v97, v105
    v_cvt_pk_bf16_f32 v104, v96, v97
    v_lshlrev_b32 v96, 16, v104
    v_and_b32 v97, 0xffff0000, v104
    v_lshlrev_b32 v104, 16, v108
    v_and_b32 v105, 0xffff0000, v108
    v_add_f32 v96, v96, v104
    v_add_f32 v97, v97, v105
    v_cvt_pk_bf16_f32 v112, v96, v97
    v_cvt_pk_bf16_f32 v104, v98, v99
    v_lshlrev_b32 v98, 16, v104
    v_and_b32 v99, 0xffff0000, v104
    v_lshlrev_b32 v104, 16, v85
    v_and_b32 v105, 0xffff0000, v85
    v_mul_f32 v98, v98, v104
    v_mul_f32 v99, v99, v105
    v_cvt_pk_bf16_f32 v104, v98, v99
    v_lshlrev_b32 v98, 16, v104
    v_and_b32 v99, 0xffff0000, v104
    v_lshlrev_b32 v104, 16, v109
    v_and_b32 v105, 0xffff0000, v109
    v_add_f32 v98, v98, v104
    v_add_f32 v99, v99, v105
    v_cvt_pk_bf16_f32 v113, v98, v99
    v_cvt_pk_bf16_f32 v104, v100, v101
    v_lshlrev_b32 v100, 16, v104
    v_and_b32 v101, 0xffff0000, v104
    v_lshlrev_b32 v104, 16, v86
    v_and_b32 v105, 0xffff0000, v86
    v_mul_f32 v100, v100, v104
    v_mul_f32 v101, v101, v105
    v_cvt_pk_bf16_f32 v104, v100, v101
    v_lshlrev_b32 v100, 16, v104
    v_and_b32 v101, 0xffff0000, v104
    v_lshlrev_b32 v104, 16, v110
    v_and_b32 v105, 0xffff0000, v110
    v_add_f32 v100, v100, v104
    v_add_f32 v101, v101, v105
    v_cvt_pk_bf16_f32 v114, v100, v101
    v_cvt_pk_bf16_f32 v104, v102, v103
    v_lshlrev_b32 v102, 16, v104
    v_and_b32 v103, 0xffff0000, v104
    v_lshlrev_b32 v104, 16, v87
    v_and_b32 v105, 0xffff0000, v87
    v_mul_f32 v102, v102, v104
    v_mul_f32 v103, v103, v105
    v_cvt_pk_bf16_f32 v104, v102, v103
    v_lshlrev_b32 v102, 16, v104
    v_and_b32 v103, 0xffff0000, v104
    v_lshlrev_b32 v104, 16, v111
    v_and_b32 v105, 0xffff0000, v111
    v_add_f32 v102, v102, v104
    v_add_f32 v103, v103, v105
    v_cvt_pk_bf16_f32 v115, v102, v103
    v_cndmask_b32 v132, v112, v114, s[20:21]
    v_cndmask_b32 v133, v113, v115, s[20:21]
    v_cndmask_b32 v134, v114, v112, s[20:21]
    v_cndmask_b32 v135, v115, v113, s[20:21]
    buffer_store_dwordx4 v[132:135], v4, s[12:15], s18 offen offset:64
    s_add_u32 s24, s24, 32
    s_cmp_lt_u32 s24, 61
    s_cbranch_scc1 fin_job
    s_cmp_ge_u32 s63, 48
    s_cbranch_scc1 k_end
    s_lshr_b32 s24, s63, 4
    s_sub_u32 s24, 63, s24
    s_and_b32 s25, s63, 15
    s_lshl_b32 s25, s25, 2
    s_and_b32 s26, s3, 3
    s_add_u32 s25, s25, s26
    s_lshr_b32 s26, s25, 5
    s_and_b32 s25, s25, 31
    s_lshl_b32 s16, s24, 1
    s_add_u32 s16, s16, s26
    s_lshl_b32 s18, s16, 15
    s_lshl_b32 s17, s25, 10
    s_add_u32 s17, s17, s18
    s_lshl_b32 s19, s25, 6
    s_add_u32 s18, s18, s19
    s_add_u32 s22, s17, 167772160
    s_add_u32 s23, s17, 75497472
    s_mov_b32 s27, 218106816
    s_mov_b32 s30, 218112000
    s_mov_b32 s28, 65536
    v_and_b32 v8, 7, v1
    v_lshlrev_b32 v8, 22, v8
    s_cmp_lg_u32 s3, 0
    s_cbranch_scc1 ft_ok
ft_wd:
    buffer_load_dword v7, off, s[4:7], s27 sc1
    s_waitcnt vmcnt(0)
    v_readfirstlane_b32 s31, v7
    s_cmp_ge_u32 s31, 16
    s_cbranch_scc1 ft_ws
    s_sleep 127
    s_sub_u32 s28, s28, 1
    s_cbranch_scc0 ft_wd
    s_mov_b32 s28, 0
ft_ws:
    buffer_load_dword v7, v6, s[4:7], s30 offen sc1
    s_waitcnt vmcnt(0)
    v_cmp_gt_u32 vcc, 61, v7
    s_cbranch_vccz ft_ok
    s_sleep 12
    v_cmp_gt_u32 vcc, 59, v7
    s_cbranch_vccz ft_wsf
    s_sleep 64
    v_cmp_gt_u32 vcc, 56, v7
    s_cbranch_vccz ft_wsf
    s_sleep 127
    s_sleep 127
ft_wsf:
    s_sub_u32 s28, s28, 1
    s_cbranch_scc0 ft_ws
    s_mov_b32 s28, 0
ft_ok:
    s_barrier
    s_cmp_ge_u32 s3, 4
    s_cbranch_scc1 k_end
    buffer_load_dwordx4 v[88:91], v4, s[8:11], s18 offen
    buffer_load_dwordx4 v[144:147], v3, s[4:7], s22 offen offset:0 sc1
    s_add_u32 s22, s22, 4194304
    buffer_load_dwordx4 v[148:151], v3, s[4:7], s22 offen offset:0 sc1
    s_add_u32 s22, s22, 4194304
    buffer_load_dwordx4 v[152:155], v3, s[4:7], s22 offen offset:0 sc1
    s_add_u32 s22, s22, 4194304
    buffer_load_dwordx4 v[156:159], v3, s[4:7], s22 offen offset:0 sc1
    s_waitcnt vmcnt(0)
    v_lshlrev_b32 v96, 16, v144
    v_and_b32 v97, 0xffff0000, v144
    v_lshlrev_b32 v98, 16, v145
    v_and_b32 v99, 0xffff0000, v145
    v_lshlrev_b32 v100, 16, v146
    v_and_b32 v101, 0xffff0000, v146
    v_lshlrev_b32 v102, 16, v147
    v_and_b32 v103, 0xffff0000, v147
    v_lshlrev_b32 v120, 16, v148
    v_and_b32 v121, 0xffff0000, v148
    v_lshlrev_b32 v122, 16, v149
    v_and_b32 v123, 0xffff0000, v149
    v_lshlrev_b32 v124, 16, v150
    v_and_b32 v125, 0xffff0000, v150
    v_lshlrev_b32 v126, 16, v151
    v_and_b32 v127, 0xffff0000, v151
    v_add_f32 v96, v96, v120
    v_add_f32 v97, v97, v121
    v_add_f32 v98, v98, v122
    v_add_f32 v99, v99, v123
    v_add_f32 v100, v100, v124
    v_add_f32 v101, v101, v125
    v_add_f32 v102, v102, v126
    v_add_f32 v103, v103, v127
    v_lshlrev_b32 v120, 16, v152
    v_and_b32 v121, 0xffff0000, v152
    v_lshlrev_b32 v122, 16, v153
    v_and_b32 v123, 0xffff0000, v153
    v_lshlrev_b32 v124, 16, v154
    v_and_b32 v125, 0xffff0000, v154
    v_lshlrev_b32 v126, 16, v155
    v_and_b32 v127, 0xffff0000, v155
    v_add_f32 v96, v96, v120
    v_add_f32 v97, v97, v121
    v_add_f32 v98, v98, v122
    v_add_f32 v99, v99, v123
    v_add_f32 v100, v100, v124
    v_add_f32 v101, v101, v125
    v_add_f32 v102, v102, v126
    v_add_f32 v103, v103, v127
    v_lshlrev_b32 v120, 16, v156
    v_and_b32 v121, 0xffff0000, v156
    v_lshlrev_b32 v122, 16, v157
    v_and_b32 v123, 0xffff0000, v157
    v_lshlrev_b32 v124, 16, v158
    v_and_b32 v125, 0xffff0000, v158
    v_lshlrev_b32 v126, 16, v159
    v_and_b32 v127, 0xffff0000, v159
    v_add_f32 v96, v96, v120
    v_add_f32 v97, v97, v121
    v_add_f32 v98, v98, v122
    v_add_f32 v99, v99, v123
    v_add_f32 v100, v100, v124
    v_add_f32 v101, v101, v125
    v_add_f32 v102, v102, v126
    v_add_f32 v103, v103, v127
    v_cvt_pk_bf16_f32 v120, v96, v97
    v_cvt_pk_bf16_f32 v121, v98, v99
    v_cvt_pk_bf16_f32 v122, v100, v101
    v_cvt_pk_bf16_f32 v123, v102, v103
    v_lshlrev_b32 v96, 16, v120
    v_and_b32 v97, 0xffff0000, v120
    v_lshlrev_b32 v98, 16, v121
    v_and_b32 v99, 0xffff0000, v121
    v_lshlrev_b32 v100, 16, v122
    v_and_b32 v101, 0xffff0000, v122
    v_lshlrev_b32 v102, 16, v123
    v_and_b32 v103, 0xffff0000, v123
    v_mul_f32 v104, 0xbfb8aa3b, v96
    v_mul_f32 v105, 0xbfb8aa3b, v97
    v_mul_f32 v106, 0xbfb8aa3b, v98
    v_mul_f32 v107, 0xbfb8aa3b, v99
    v_mul_f32 v108, 0xbfb8aa3b, v100
    v_mul_f32 v109, 0xbfb8aa3b, v101
    v_mul_f32 v110, 0xbfb8aa3b, v102
    v_mul_f32 v111, 0xbfb8aa3b, v103
    v_exp_f32 v104, v104
    v_exp_f32 v105, v105
    v_exp_f32 v106, v106
    v_exp_f32 v107, v107
    v_exp_f32 v108, v108
    v_exp_f32 v109, v109
    v_exp_f32 v110, v110
    v_exp_f32 v111, v111
    v_add_f32 v104, 1.0, v104
    v_add_f32 v105, 1.0, v105
    v_add_f32 v106, 1.0, v106
    v_add_f32 v107, 1.0, v107
    v_add_f32 v108, 1.0, v108
    v_add_f32 v109, 1.0, v109
    v_add_f32 v110, 1.0, v110
    v_add_f32 v111, 1.0, v111
    v_rcp_f32 v104, v104
    v_rcp_f32 v105, v105
    v_rcp_f32 v106, v106
    v_rcp_f32 v107, v107
    v_rcp_f32 v108, v108
    v_rcp_f32 v109, v109
    v_rcp_f32 v110, v110
    v_rcp_f32 v111, v111
    v_mul_f32 v96, v96, v104
    v_mul_f32 v97, v97, v105
    v_mul_f32 v98, v98, v106
    v_mul_f32 v99, v99, v107
    v_mul_f32 v100, v100, v108
    v_mul_f32 v101, v101, v109
    v_mul_f32 v102, v102, v110
    v_mul_f32 v103, v103, v111
    v_cvt_pk_bf16_f32 v80, v96, v97
    v_cvt_pk_bf16_f32 v81, v98, v99
    v_cvt_pk_bf16_f32 v82, v100, v101
    v_cvt_pk_bf16_f32 v83, v102, v103
ft_p:
    buffer_load_dword v7, v8, s[4:7], s23 offen offset:1020 sc1
    s_waitcnt vmcnt(0)
    v_cmp_eq_u32 vcc, -1, v7
    s_cbranch_vccz ft_l
    s_sleep 4
    s_sub_u32 s28, s28, 1
    s_cbranch_scc0 ft_p
    s_mov_b32 s28, 0
ft_l:
    s_mov_b32 s31, s23
    buffer_load_dwordx4 v[16:19], v3, s[4:7], s31 offen sc1
    s_add_u32 s31, s31, 4194304
    buffer_load_dwordx4 v[20:23], v3, s[4:7], s31 offen sc1
    s_add_u32 s31, s31, 4194304
    buffer_load_dwordx4 v[24:27], v3, s[4:7], s31 offen sc1
    s_add_u32 s31, s31, 4194304
    buffer_load_dwordx4 v[28:31], v3, s[4:7], s31 offen sc1
    s_add_u32 s31, s31, 4194304
    buffer_load_dwordx4 v[32:35], v3, s[4:7], s31 offen sc1
    s_add_u32 s31, s31, 4194304
    buffer_load_dwordx4 v[36:39], v3, s[4:7], s31 offen sc1
    s_add_u32 s31, s31, 4194304
    buffer_load_dwordx4 v[40:43], v3, s[4:7], s31 offen sc1
    s_add_u32 s31, s31, 4194304
    buffer_load_dwordx4 v[44:47], v3, s[4:7], s31 offen sc1
    s_waitcnt vmcnt(0)
    v_max3_u32 v7, v16, v17, v18
    v_max3_u32 v7, v7, v19, v20
    v_max3_u32 v7, v7, v21, v22
    v_max3_u32 v7, v7, v23, v24
    v_max3_u32 v7, v7, v25, v26
    v_max3_u32 v7, v7, v27, v28
    v_max3_u32 v7, v7, v29, v30
    v_max3_u32 v7, v7, v31, v32
    v_max3_u32 v7, v7, v33, v34
    v_max3_u32 v7, v7, v35, v36
    v_max3_u32 v7, v7, v37, v38
    v_max3_u32 v7, v7, v39, v40
    v_max3_u32 v7, v7, v41, v42
    v_max3_u32 v7, v7, v43, v44
    v_max3_u32 v7, v7, v45, v46
    v_max_u32 v7, v7, v47
    v_cmp_eq_u32 vcc, -1, v7
    s_cbranch_vccz ft_go
    s_sub_u32 s28, s28, 1
    s_cbranch_scc0 ft_l
ft_go:
    v_lshlrev_b32 v96, 16, v16
    v_and_b32 v97, 0xffff0000, v16
    v_lshlrev_b32 v98, 16, v17
    v_and_b32 v99, 0xffff0000, v17
    v_lshlrev_b32 v100, 16, v18
    v_and_b32 v101, 0xffff0000, v18
    v_lshlrev_b32 v102, 16, v19
    v_and_b32 v103, 0xffff0000, v19
    v_lshlrev_b32 v120, 16, v20
    v_and_b32 v121, 0xffff0000, v20
    v_lshlrev_b32 v122, 16, v21
    v_and_b32 v123, 0xffff0000, v21
    v_lshlrev_b32 v124, 16, v22
    v_and_b32 v125, 0xffff0000, v22
    v_lshlrev_b32 v126, 16, v23
    v_and_b32 v127, 0xffff0000, v23
    v_add_f32 v96, v96, v120
    v_add_f32 v97, v97, v121
    v_add_f32 v98, v98, v122
    v_add_f32 v99, v99, v123
    v_add_f32 v100, v100, v124
    v_add_f32 v101, v101, v125
    v_add_f32 v102, v102, v126
    v_add_f32 v103, v103, v127
    v_lshlrev_b32 v120, 16, v24
    v_and_b32 v121, 0xffff0000, v24
    v_lshlrev_b32 v122, 16, v25
    v_and_b32 v123, 0xffff0000, v25
    v_lshlrev_b32 v124, 16, v26
    v_and_b32 v125, 0xffff0000, v26
    v_lshlrev_b32 v126, 16, v27
    v_and_b32 v127, 0xffff0000, v27
    v_add_f32 v96, v96, v120
    v_add_f32 v97, v97, v121
    v_add_f32 v98, v98, v122
    v_add_f32 v99, v99, v123
    v_add_f32 v100, v100, v124
    v_add_f32 v101, v101, v125
    v_add_f32 v102, v102, v126
    v_add_f32 v103, v103, v127
    v_lshlrev_b32 v120, 16, v28
    v_and_b32 v121, 0xffff0000, v28
    v_lshlrev_b32 v122, 16, v29
    v_and_b32 v123, 0xffff0000, v29
    v_lshlrev_b32 v124, 16, v30
    v_and_b32 v125, 0xffff0000, v30
    v_lshlrev_b32 v126, 16, v31
    v_and_b32 v127, 0xffff0000, v31
    v_add_f32 v96, v96, v120
    v_add_f32 v97, v97, v121
    v_add_f32 v98, v98, v122
    v_add_f32 v99, v99, v123
    v_add_f32 v100, v100, v124
    v_add_f32 v101, v101, v125
    v_add_f32 v102, v102, v126
    v_add_f32 v103, v103, v127
    v_lshlrev_b32 v120, 16, v32
    v_and_b32 v121, 0xffff0000, v32
    v_lshlrev_b32 v122, 16, v33
    v_and_b32 v123, 0xffff0000, v33
    v_lshlrev_b32 v124, 16, v34
    v_and_b32 v125, 0xffff0000, v34
    v_lshlrev_b32 v126, 16, v35
    v_and_b32 v127, 0xffff0000, v35
    v_add_f32 v96, v96, v120
    v_add_f32 v97, v97, v121
    v_add_f32 v98, v98, v122
    v_add_f32 v99, v99, v123
    v_add_f32 v100, v100, v124
    v_add_f32 v101, v101, v125
    v_add_f32 v102, v102, v126
    v_add_f32 v103, v103, v127
    v_lshlrev_b32 v120, 16, v36
    v_and_b32 v121, 0xffff0000, v36
    v_lshlrev_b32 v122, 16, v37
    v_and_b32 v123, 0xffff0000, v37
    v_lshlrev_b32 v124, 16, v38
    v_and_b32 v125, 0xffff0000, v38
    v_lshlrev_b32 v126, 16, v39
    v_and_b32 v127, 0xffff0000, v39
    v_add_f32 v96, v96, v120
    v_add_f32 v97, v97, v121
    v_add_f32 v98, v98, v122
    v_add_f32 v99, v99, v123
    v_add_f32 v100, v100, v124
    v_add_f32 v101, v101, v125
    v_add_f32 v102, v102, v126
    v_add_f32 v103, v103, v127
    v_lshlrev_b32 v120, 16, v40
    v_and_b32 v121, 0xffff0000, v40
    v_lshlrev_b32 v122, 16, v41
    v_and_b32 v123, 0xffff0000, v41
    v_lshlrev_b32 v124, 16, v42
    v_and_b32 v125, 0xffff0000, v42
    v_lshlrev_b32 v126, 16, v43
    v_and_b32 v127, 0xffff0000, v43
    v_add_f32 v96, v96, v120
    v_add_f32 v97, v97, v121
    v_add_f32 v98, v98, v122
    v_add_f32 v99, v99, v123
    v_add_f32 v100, v100, v124
    v_add_f32 v101, v101, v125
    v_add_f32 v102, v102, v126
    v_add_f32 v103, v103, v127
    v_lshlrev_b32 v120, 16, v44
    v_and_b32 v121, 0xffff0000, v44
    v_lshlrev_b32 v122, 16, v45
    v_and_b32 v123, 0xffff0000, v45
    v_lshlrev_b32 v124, 16, v46
    v_and_b32 v125, 0xffff0000, v46
    v_lshlrev_b32 v126, 16, v47
    v_and_b32 v127, 0xffff0000, v47
    v_add_f32 v96, v96, v120
    v_add_f32 v97, v97, v121
    v_add_f32 v98, v98, v122
    v_add_f32 v99, v99, v123
    v_add_f32 v100, v100, v124
    v_add_f32 v101, v101, v125
    v_add_f32 v102, v102, v126
    v_add_f32 v103, v103, v127
    v_cndmask_b32 v108, v88, v90, s[20:21]
    v_cndmask_b32 v109, v89, v91, s[20:21]
    v_cndmask_b32 v110, v90, v88, s[20:21]
    v_cndmask_b32 v111, v91, v89, s[20:21]
    v_cvt_pk_bf16_f32 v104, v96, v97
    v_lshlrev_b32 v96, 16, v104
    v_and_b32 v97, 0xffff0000, v104
    v_lshlrev_b32 v104, 16, v80
    v_and_b32 v105, 0xffff0000, v80
    v_mul_f32 v96, v96, v104
    v_mul_f32 v97, v97, v105
    v_cvt_pk_bf16_f32 v104, v96, v97
    v_lshlrev_b32 v96, 16, v104
    v_and_b32 v97, 0xffff0000, v104
    v_lshlrev_b32 v104, 16, v108
    v_and_b32 v105, 0xffff0000, v108
    v_add_f32 v96, v96, v104
    v_add_f32 v97, v97, v105
    v_cvt_pk_bf16_f32 v112, v96, v97
    v_cvt_pk_bf16_f32 v104, v98, v99
    v_lshlrev_b32 v98, 16, v104
    v_and_b32 v99, 0xffff0000, v104
    v_lshlrev_b32 v104, 16, v81
    v_and_b32 v105, 0xffff0000, v81
    v_mul_f32 v98, v98, v104
    v_mul_f32 v99, v99, v105
    v_cvt_pk_bf16_f32 v104, v98, v99
    v_lshlrev_b32 v98, 16, v104
    v_and_b32 v99, 0xffff0000, v104
    v_lshlrev_b32 v104, 16, v109
    v_and_b32 v105, 0xffff0000, v109
    v_add_f32 v98, v98, v104
    v_add_f32 v99, v99, v105
    v_cvt_pk_bf16_f32 v113, v98, v99
    v_cvt_pk_bf16_f32 v104, v100, v101
    v_lshlrev_b32 v100, 16, v104
    v_and_b32 v101, 0xffff0000, v104
    v_lshlrev_b32 v104, 16, v82
    v_and_b32 v105, 0xffff0000, v82
    v_mul_f32 v100, v100, v104
    v_mul_f32 v101, v101, v105
    v_cvt_pk_bf16_f32 v104, v100, v101
    v_lshlrev_b32 v100, 16, v104
    v_and_b32 v101, 0xffff0000, v104
    v_lshlrev_b32 v104, 16, v110
    v_and_b32 v105, 0xffff0000, v110
    v_add_f32 v100, v100, v104
    v_add_f32 v101, v101, v105
    v_cvt_pk_bf16_f32 v114, v100, v101
    v_cvt_pk_bf16_f32 v104, v102, v103
    v_lshlrev_b32 v102, 16, v104
    v_and_b32 v103, 0xffff0000, v104
    v_lshlrev_b32 v104, 16, v83
    v_and_b32 v105, 0xffff0000, v83
    v_mul_f32 v102, v102, v104
    v_mul_f32 v103, v103, v105
    v_cvt_pk_bf16_f32 v104, v102, v103
    v_lshlrev_b32 v102, 16, v104
    v_and_b32 v103, 0xffff0000, v104
    v_lshlrev_b32 v104, 16, v111
    v_and_b32 v105, 0xffff0000, v111
    v_add_f32 v102, v102, v104
    v_add_f32 v103, v103, v105
    v_cvt_pk_bf16_f32 v115, v102, v103
    v_cndmask_b32 v128, v112, v114, s[20:21]
    v_cndmask_b32 v129, v113, v115, s[20:21]
    v_cndmask_b32 v130, v114, v112, s[20:21]
    v_cndmask_b32 v131, v115, v113, s[20:21]
    buffer_store_dwordx4 v[128:131], v4, s[12:15], s18 offen offset:0
    s_branch k_end
chain_map:
    s_and_b32 s14, s12, 1
    s_lshl_b32 s13, s13, 1
    s_lshr_b32 s15, s12, 1
    s_add_u32 s12, s13, s14
    s_mov_b32 s13, s15
    s_lshl_b32 s2, s13, 3
    s_add_u32 s2, s2, s12
    s_lshr_b32 s14, s13, 2
    s_and_b32 s15, s13, 3
    s_mov_b32 s16, 0
    s_mov_b32 s17, 209715200
    s_mov_b32 s18, 209977344
    s_mov_b32 s19, 210239488
    s_mov_b32 s20, 210501632
    s_mov_b32 s26, 131072
    s_mov_b32 s68, 0
    s_getreg_b32 s29, hwreg(HW_REG_XCC_ID)
    s_and_b32 s29, s29, 15
    s_mul_i32 s23, s29, s29
    s_lshl_b32 s23, s23, 18
    s_lshl_b32 s29, s29, 8
    s_add_u32 s29, s29, s23
    s_add_u32 s29, s29, 1
    s_lshr_b32 s28, s12, 1
    s_lshl_b32 s28, s28, 2
    s_add_u32 s28, s28, 128
    s_cmp_ge_u32 s3, 4
    s_cbranch_scc1 ch_a_pro
    s_lshl_b32 s32, s12, 15
    s_lshl_b32 s21, s14, 13
    s_add_u32 s32, s32, s21
    s_lshl_b32 s21, s15, 10
    s_add_u32 s32, s32, s21
    s_add_u32 s32, s32, 2097152
    s_lshr_b32 s33, s12, 1
    s_lshl_b32 s33, s33, 14
    s_add_u32 s33, s33, 1048576
    s_lshl_b32 s21, s13, 10
    s_add_u32 s36, s33, s21
    s_lshl_b32 s21, s3, 12
    s_add_u32 s33, s33, s21
    s_lshl_b32 s34, s13, 14
    s_lshl_b32 s21, s12, 10
    s_add_u32 s35, s34, s21
    s_lshl_b32 s37, s12, 22
    s_lshl_b32 s21, s13, 11
    s_add_u32 s37, s37, s21
    s_and_b32 s21, s3, 1
    s_lshl_b32 s21, s21, 15
    s_add_u32 s37, s37, s21
    s_lshr_b32 s21, s3, 1
    s_lshl_b32 s21, s21, 10
    s_add_u32 s37, s37, s21
    s_add_u32 s37, s37, 75497472
    v_and_b32 v20, 63, v0
    v_lshlrev_b32 v1, 4, v20
    v_mov_b32 v10, -1
    v_mov_b32 v11, -1
    v_lshrrev_b32 v21, 2, v20
    v_and_b32 v22, 3, v20
    v_lshlrev_b32 v21, 13, v21
    v_lshl_add_u32 v21, v22, 4, v21
    s_lshl_b32 s21, s3, 21
    s_lshl_b32 s22, s12, 10
    s_add_u32 s21, s21, s22
    s_lshl_b32 s23, s3, 15
    s_mov_b32 s10, 8388608
    s_mov_b32 s11, 131072
    v_lshrrev_b32 v24, 4, v20
    v_bfe_u32 v25, v20, 2, 2
    v_lshl_add_u32 v24, v24, 4, v25
    v_lshlrev_b32 v24, 6, v24
    v_lshl_add_u32 v24, v22, 3, v24
    v_add_u32 v24, s23, v24
    s_and_b32 s70, s13, 1
    s_lshl_b32 s71, s12, 4
    s_add_u32 s71, s71, s13
    s_cmp_eq_u32 s71, 127
    s_cselect_b32 s70, 1, 0
    s_cmp_eq_u32 s13, 7
    s_cselect_b32 s70, 1, s70
    s_lshl_b32 s72, s70, 20
    s_lshl_b32 s73, s70, 21
    s_lshl_b32 s70, s70, 13
    s_sub_u32 s71, s23, s70
    s_add_u32 s70, s23, s70
    s_load_dwordx2 s[8:9], s[0:1], 16
    s_lshl_b32 s25, s13, 6
    s_add_u32 s24, s21, s25
    s_add_u32 s24, s24, s72
    s_waitcnt lgkmcnt(0)
    s_add_u32 m0, s70, 0
    s_nop 0
    buffer_load_dwordx4 v21, s[8:11], s24 offen lds
    s_add_u32 s24, s24, 131072
    s_add_u32 m0, s70, 1024
    s_nop 0
    buffer_load_dwordx4 v21, s[8:11], s24 offen lds
    s_add_u32 s24, s24, 131072
    s_add_u32 m0, s70, 2048
    s_nop 0
    buffer_load_dwordx4 v21, s[8:11], s24 offen lds
    s_add_u32 s24, s24, 131072
    s_add_u32 m0, s70, 3072
    s_nop 0
    buffer_load_dwordx4 v21, s[8:11], s24 offen lds
    s_add_u32 s24, s24, 131072
    s_add_u32 m0, s70, 4096
    s_nop 0
    buffer_load_dwordx4 v21, s[8:11], s24 offen lds
    s_add_u32 s24, s24, 131072
    s_add_u32 m0, s70, 5120
    s_nop 0
    buffer_load_dwordx4 v21, s[8:11], s24 offen lds
    s_add_u32 s24, s24, 131072
    s_add_u32 m0, s70, 6144
    s_nop 0
    buffer_load_dwordx4 v21, s[8:11], s24 offen lds
    s_add_u32 s24, s24, 131072
    s_add_u32 m0, s70, 7168
    s_nop 0
    buffer_load_dwordx4 v21, s[8:11], s24 offen lds
    s_add_u32 s24, s24, 131072
    s_sub_u32 s24, s24, s73
    s_add_u32 m0, s71, 8192
    s_nop 0
    buffer_load_dwordx4 v21, s[8:11], s24 offen lds
    s_add_u32 s24, s24, 131072
    s_add_u32 m0, s71, 9216
    s_nop 0
    buffer_load_dwordx4 v21, s[8:11], s24 offen lds
    s_add_u32 s24, s24, 131072
    s_add_u32 m0, s71, 10240
    s_nop 0
    buffer_load_dwordx4 v21, s[8:11], s24 offen lds
    s_add_u32 s24, s24, 131072
    s_add_u32 m0, s71, 11264
    s_nop 0
    buffer_load_dwordx4 v21, s[8:11], s24 offen lds
    s_add_u32 s24, s24, 131072
    s_add_u32 m0, s71, 12288
    s_nop 0
    buffer_load_dwordx4 v21, s[8:11], s24 offen lds
    s_add_u32 s24, s24, 131072
    s_add_u32 m0, s71, 13312
    s_nop 0
    buffer_load_dwordx4 v21, s[8:11], s24 offen lds
    s_add_u32 s24, s24, 131072
    s_add_u32 m0, s71, 14336
    s_nop 0
    buffer_load_dwordx4 v21, s[8:11], s24 offen lds
    s_add_u32 s24, s24, 131072
    s_add_u32 m0, s71, 15360
    s_nop 0
    buffer_load_dwordx4 v21, s[8:11], s24 offen lds
    s_add_u32 s24, s24, 131072
    s_load_dwordx2 s[8:9], s[0:1], 24
    s_lshl_b32 s25, s13, 6
    s_add_u32 s24, s21, s25
    s_add_u32 s24, s24, s72
    s_waitcnt lgkmcnt(0)
    s_add_u32 m0, s70, 16384
    s_nop 0
    buffer_load_dwordx4 v21, s[8:11], s24 offen lds
    s_add_u32 s24, s24, 131072
    s_add_u32 m0, s70, 17408
    s_nop 0
    buffer_load_dwordx4 v21, s[8:11], s24 offen lds
    s_add_u32 s24, s24, 131072
    s_add_u32 m0, s70, 18432
    s_nop 0
    buffer_load_dwordx4 v21, s[8:11], s24 offen lds
    s_add_u32 s24, s24, 131072
    s_add_u32 m0, s70, 19456
    s_nop 0
    buffer_load_dwordx4 v21, s[8:11], s24 offen lds
    s_add_u32 s24, s24, 131072
    s_add_u32 m0, s70, 20480
    s_nop 0
    buffer_load_dwordx4 v21, s[8:11], s24 offen lds
    s_add_u32 s24, s24, 131072
    s_add_u32 m0, s70, 21504
    s_nop 0
    buffer_load_dwordx4 v21, s[8:11], s24 offen lds
    s_add_u32 s24, s24, 131072
    s_add_u32 m0, s70, 22528
    s_nop 0
    buffer_load_dwordx4 v21, s[8:11], s24 offen lds
    s_add_u32 s24, s24, 131072
    s_add_u32 m0, s70, 23552
    s_nop 0
    buffer_load_dwordx4 v21, s[8:11], s24 offen lds
    s_add_u32 s24, s24, 131072
    s_sub_u32 s24, s24, s73
    s_add_u32 m0, s71, 24576
    s_nop 0
    buffer_load_dwordx4 v21, s[8:11], s24 offen lds
    s_add_u32 s24, s24, 131072
    s_add_u32 m0, s71, 25600
    s_nop 0
    buffer_load_dwordx4 v21, s[8:11], s24 offen lds
    s_add_u32 s24, s24, 131072
    s_add_u32 m0, s71, 26624
    s_nop 0
    buffer_load_dwordx4 v21, s[8:11], s24 offen lds
    s_add_u32 s24, s24, 131072
    s_add_u32 m0, s71, 27648
    s_nop 0
    buffer_load_dwordx4 v21, s[8:11], s24 offen lds
    s_add_u32 s24, s24, 131072
    s_add_u32 m0, s71, 28672
    s_nop 0
    buffer_load_dwordx4 v21, s[8:11], s24 offen lds
    s_add_u32 s24, s24, 131072
    s_add_u32 m0, s71, 29696
    s_nop 0
    buffer_load_dwordx4 v21, s[8:11], s24 offen lds
    s_add_u32 s24, s24, 131072
    s_add_u32 m0, s71, 30720
    s_nop 0
    buffer_load_dwordx4 v21, s[8:11], s24 offen lds
    s_add_u32 s24, s24, 131072
    s_add_u32 m0, s71, 31744
    s_nop 0
    buffer_load_dwordx4 v21, s[8:11], s24 offen lds
    s_add_u32 s24, s24, 131072
    s_load_dwordx2 s[8:9], s[0:1], 32
    s_lshl_b32 s25, s13, 6
    s_add_u32 s24, s21, s25
    s_add_u32 s24, s24, s72
    s_waitcnt lgkmcnt(0)
    buffer_load_dwordx4 v[96:99], v21, s[8:11], s24 offen
    s_add_u32 s24, s24, 131072
    buffer_load_dwordx4 v[100:103], v21, s[8:11], s24 offen
    s_add_u32 s24, s24, 131072
    buffer_load_dwordx4 v[104:107], v21, s[8:11], s24 offen
    s_add_u32 s24, s24, 131072
    buffer_load_dwordx4 v[108:111], v21, s[8:11], s24 offen
    s_add_u32 s24, s24, 131072
    buffer_load_dwordx4 v[144:147], v21, s[8:11], s24 offen
    s_add_u32 s24, s24, 131072
    buffer_load_dwordx4 v[148:151], v21, s[8:11], s24 offen
    s_add_u32 s24, s24, 131072
    buffer_load_dwordx4 v[152:155], v21, s[8:11], s24 offen
    s_add_u32 s24, s24, 131072
    buffer_load_dwordx4 v[156:159], v21, s[8:11], s24 offen
    s_add_u32 s24, s24, 131072
    s_sub_u32 s24, s24, s73
    buffer_load_dwordx4 v[192:195], v21, s[8:11], s24 offen
    s_add_u32 s24, s24, 131072
    buffer_load_dwordx4 v[196:199], v21, s[8:11], s24 offen
    s_add_u32 s24, s24, 131072
    buffer_load_dwordx4 v[200:203], v21, s[8:11], s24 offen
    s_add_u32 s24, s24, 131072
    buffer_load_dwordx4 v[204:207], v21, s[8:11], s24 offen
    s_add_u32 s24, s24, 131072
    buffer_load_dwordx4 v[240:243], v21, s[8:11], s24 offen
    s_add_u32 s24, s24, 131072
    buffer_load_dwordx4 v[244:247], v21, s[8:11], s24 offen
    s_add_u32 s24, s24, 131072
    buffer_load_dwordx4 v[248:251], v21, s[8:11], s24 offen
    s_add_u32 s24, s24, 131072
    buffer_load_dwordx4 v[252:255], v21, s[8:11], s24 offen
    s_add_u32 s24, s24, 131072
    s_load_dwordx2 s[8:9], s[0:1], 8
    s_mov_b32 s10, 16384
    v_bfe_u32 v57, v20, 4, 1
    v_lshrrev_b32 v58, 5, v20
    v_and_b32 v59, 1, v20
    v_bfe_u32 v60, v20, 1, 3
    v_lshlrev_b32 v60, 11, v60
    v_lshl_add_u32 v60, v57, 6, v60
    v_lshl_add_u32 v60, v58, 4, v60
    v_lshl_add_u32 v15, v59, 2, v60
    s_lshl_b32 s24, s3, 9
    s_waitcnt lgkmcnt(0)
    buffer_load_dword v32, v15, s[8:11], s24 offen offset:0
    buffer_load_dword v33, v15, s[8:11], s24 offen offset:8
    buffer_load_dword v34, v15, s[8:11], s24 offen offset:32
    buffer_load_dword v35, v15, s[8:11], s24 offen offset:40
    buffer_load_dword v36, v15, s[8:11], s24 offen offset:128
    buffer_load_dword v37, v15, s[8:11], s24 offen offset:136
    buffer_load_dword v38, v15, s[8:11], s24 offen offset:160
    buffer_load_dword v39, v15, s[8:11], s24 offen offset:168
    buffer_load_dword v40, v15, s[8:11], s24 offen offset:256
    buffer_load_dword v41, v15, s[8:11], s24 offen offset:264
    buffer_load_dword v42, v15, s[8:11], s24 offen offset:288
    buffer_load_dword v43, v15, s[8:11], s24 offen offset:296
    buffer_load_dword v44, v15, s[8:11], s24 offen offset:384
    buffer_load_dword v45, v15, s[8:11], s24 offen offset:392
    buffer_load_dword v46, v15, s[8:11], s24 offen offset:416
    buffer_load_dword v47, v15, s[8:11], s24 offen offset:424
    s_barrier
    v_add_u32 v56, s70, v1
    s_add_u32 s71, s71, 8192
    v_add_u32 v26, s71, v1
    s_waitcnt vmcnt(48)
    ds_read_b64_tr_b16 v[64:65], v24 offset:0
    ds_read_b64_tr_b16 v[66:67], v24 offset:256
    ds_read_b64_tr_b16 v[68:69], v24 offset:512
    ds_read_b64_tr_b16 v[70:71], v24 offset:768
    ds_read_b64_tr_b16 v[72:73], v24 offset:32
    ds_read_b64_tr_b16 v[74:75], v24 offset:288
    ds_read_b64_tr_b16 v[76:77], v24 offset:544
    ds_read_b64_tr_b16 v[78:79], v24 offset:800
    s_waitcnt lgkmcnt(0)
    ds_read_b64_tr_b16 v[112:113], v24 offset:4096
    ds_read_b64_tr_b16 v[114:115], v24 offset:4352
    ds_read_b64_tr_b16 v[116:117], v24 offset:4608
    ds_read_b64_tr_b16 v[118:119], v24 offset:4864
    ds_read_b64_tr_b16 v[120:121], v24 offset:4128
    ds_read_b64_tr_b16 v[122:123], v24 offset:4384
    ds_read_b64_tr_b16 v[124:125], v24 offset:4640
    ds_read_b64_tr_b16 v[126:127], v24 offset:4896
    s_waitcnt lgkmcnt(0)
    ds_read_b64_tr_b16 v[160:161], v24 offset:8192
    ds_read_b64_tr_b16 v[162:163], v24 offset:8448
    ds_read_b64_tr_b16 v[164:165], v24 offset:8704
    ds_read_b64_tr_b16 v[166:167], v24 offset:8960
    ds_read_b64_tr_b16 v[168:169], v24 offset:8224
    ds_read_b64_tr_b16 v[170:171], v24 offset:8480
    ds_read_b64_tr_b16 v[172:173], v24 offset:8736
    ds_read_b64_tr_b16 v[174:175], v24 offset:8992
    s_waitcnt lgkmcnt(0)
    ds_read_b64_tr_b16 v[208:209], v24 offset:12288
    ds_read_b64_tr_b16 v[210:211], v24 offset:12544
    ds_read_b64_tr_b16 v[212:213], v24 offset:12800
    ds_read_b64_tr_b16 v[214:215], v24 offset:13056
    ds_read_b64_tr_b16 v[216:217], v24 offset:12320
    ds_read_b64_tr_b16 v[218:219], v24 offset:12576
    ds_read_b64_tr_b16 v[220:221], v24 offset:12832
    ds_read_b64_tr_b16 v[222:223], v24 offset:13088
    s_waitcnt lgkmcnt(0)
    s_waitcnt vmcnt(32)
    ds_read_b64_tr_b16 v[80:81], v24 offset:16384
    ds_read_b64_tr_b16 v[82:83], v24 offset:16640
    ds_read_b64_tr_b16 v[84:85], v24 offset:16896
    ds_read_b64_tr_b16 v[86:87], v24 offset:17152
    ds_read_b64_tr_b16 v[88:89], v24 offset:16416
    ds_read_b64_tr_b16 v[90:91], v24 offset:16672
    ds_read_b64_tr_b16 v[92:93], v24 offset:16928
    ds_read_b64_tr_b16 v[94:95], v24 offset:17184
    s_waitcnt lgkmcnt(0)
    ds_read_b64_tr_b16 v[128:129], v24 offset:20480
    ds_read_b64_tr_b16 v[130:131], v24 offset:20736
    ds_read_b64_tr_b16 v[132:133], v24 offset:20992
    ds_read_b64_tr_b16 v[134:135], v24 offset:21248
    ds_read_b64_tr_b16 v[136:137], v24 offset:20512
    ds_read_b64_tr_b16 v[138:139], v24 offset:20768
    ds_read_b64_tr_b16 v[140:141], v24 offset:21024
    ds_read_b64_tr_b16 v[142:143], v24 offset:21280
    s_waitcnt lgkmcnt(0)
    ds_read_b64_tr_b16 v[176:177], v24 offset:24576
    ds_read_b64_tr_b16 v[178:179], v24 offset:24832
    ds_read_b64_tr_b16 v[180:181], v24 offset:25088
    ds_read_b64_tr_b16 v[182:183], v24 offset:25344
    ds_read_b64_tr_b16 v[184:185], v24 offset:24608
    ds_read_b64_tr_b16 v[186:187], v24 offset:24864
    ds_read_b64_tr_b16 v[188:189], v24 offset:25120
    ds_read_b64_tr_b16 v[190:191], v24 offset:25376
    s_waitcnt lgkmcnt(0)
    ds_read_b64_tr_b16 v[224:225], v24 offset:28672
    ds_read_b64_tr_b16 v[226:227], v24 offset:28928
    ds_read_b64_tr_b16 v[228:229], v24 offset:29184
    ds_read_b64_tr_b16 v[230:231], v24 offset:29440
    ds_read_b64_tr_b16 v[232:233], v24 offset:28704
    ds_read_b64_tr_b16 v[234:235], v24 offset:28960
    ds_read_b64_tr_b16 v[236:237], v24 offset:29216
    ds_read_b64_tr_b16 v[238:239], v24 offset:29472
    s_waitcnt lgkmcnt(0)
    s_waitcnt vmcnt(16)
    ds_write_b128 v56, v[96:99] offset:0
    ds_write_b128 v56, v[100:103] offset:1024
    ds_write_b128 v56, v[104:107] offset:2048
    ds_write_b128 v56, v[108:111] offset:3072
    ds_write_b128 v56, v[144:147] offset:4096
    ds_write_b128 v56, v[148:151] offset:5120
    ds_write_b128 v56, v[152:155] offset:6144
    ds_write_b128 v56, v[156:159] offset:7168
    ds_write_b128 v26, v[192:195] offset:0
    ds_write_b128 v26, v[196:199] offset:1024
    ds_write_b128 v26, v[200:203] offset:2048
    ds_write_b128 v26, v[204:207] offset:3072
    ds_write_b128 v26, v[240:243] offset:4096
    ds_write_b128 v26, v[244:247] offset:5120
    ds_write_b128 v26, v[248:251] offset:6144
    ds_write_b128 v26, v[252:255] offset:7168
    s_waitcnt lgkmcnt(0)
    ds_read_b64_tr_b16 v[96:97], v24 offset:0
    ds_read_b64_tr_b16 v[98:99], v24 offset:256
    ds_read_b64_tr_b16 v[100:101], v24 offset:512
    ds_read_b64_tr_b16 v[102:103], v24 offset:768
    ds_read_b64_tr_b16 v[104:105], v24 offset:32
    ds_read_b64_tr_b16 v[106:107], v24 offset:288
    ds_read_b64_tr_b16 v[108:109], v24 offset:544
    ds_read_b64_tr_b16 v[110:111], v24 offset:800
    s_waitcnt lgkmcnt(0)
    ds_read_b64_tr_b16 v[144:145], v24 offset:4096
    ds_read_b64_tr_b16 v[146:147], v24 offset:4352
    ds_read_b64_tr_b16 v[148:149], v24 offset:4608
    ds_read_b64_tr_b16 v[150:151], v24 offset:4864
    ds_read_b64_tr_b16 v[152:153], v24 offset:4128
    ds_read_b64_tr_b16 v[154:155], v24 offset:4384
    ds_read_b64_tr_b16 v[156:157], v24 offset:4640
    ds_read_b64_tr_b16 v[158:159], v24 offset:4896
    s_waitcnt lgkmcnt(0)
    ds_read_b64_tr_b16 v[192:193], v24 offset:8192
    ds_read_b64_tr_b16 v[194:195], v24 offset:8448
    ds_read_b64_tr_b16 v[196:197], v24 offset:8704
    ds_read_b64_tr_b16 v[198:199], v24 offset:8960
    ds_read_b64_tr_b16 v[200:201], v24 offset:8224
    ds_read_b64_tr_b16 v[202:203], v24 offset:8480
    ds_read_b64_tr_b16 v[204:205], v24 offset:8736
    ds_read_b64_tr_b16 v[206:207], v24 offset:8992
    s_waitcnt lgkmcnt(0)
    ds_read_b64_tr_b16 v[240:241], v24 offset:12288
    ds_read_b64_tr_b16 v[242:243], v24 offset:12544
    ds_read_b64_tr_b16 v[244:245], v24 offset:12800
    ds_read_b64_tr_b16 v[246:247], v24 offset:13056
    ds_read_b64_tr_b16 v[248:249], v24 offset:12320
    ds_read_b64_tr_b16 v[250:251], v24 offset:12576
    ds_read_b64_tr_b16 v[252:253], v24 offset:12832
    ds_read_b64_tr_b16 v[254:255], v24 offset:13088
    s_waitcnt lgkmcnt(0)
    v_mov_b32 v21, 0x44444444
    v_mov_b32 v22, 0xeeeeeeee
    v_and_b32 v23, 1, v20
    v_cmp_eq_u32 vcc, 0, v23
    v_and_b32 v27, 255, v0
    v_lshlrev_b32 v2, 2, v27
    v_cndmask_b32 v62, v22, v21, vcc
    s_lshr_b32 s21, s15, 1
    s_sub_u32 s21, s21, s15
    s_add_u32 s21, s21, 4
    s_lshl_b32 s21, s21, 10
    s_and_b32 s22, s15, 1
    s_lshl_b32 s22, s22, 9
    s_add_u32 s21, s21, s22
    s_lshl_b32 s22, s3, 7
    s_add_u32 s21, s21, s22
    v_and_b32 v21, 31, v20
    v_lshlrev_b32 v21, 2, v21
    v_add_u32 v3, s21, v21
    v_lshrrev_b32 v21, 4, v20
    v_and_b32 v22, 15, v20
    v_mul_u32_u24 v21, 208, v21
    v_add_lshl_u32 v21, v21, v22, 2
    s_mul_i32 s21, s3, 3328
    v_add_u32 v4, s21, v21
    v_lshrrev_b32 v21, 4, v20
    v_bfe_u32 v22, v20, 2, 1
    v_lshl_add_u32 v21, v21, 1, v22
    v_mul_u32_u24 v21, 104, v21
    v_bfe_u32 v22, v20, 3, 1
    v_xor_b32 v22, 1, v22
    v_lshl_add_u32 v21, v22, 5, v21
    v_and_b32 v22, 3, v20
    v_lshlrev_b32 v22, 1, v22
    s_and_b32 s21, s3, 1
    s_lshl_b32 s21, s21, 2
    v_xor_b32 v22, s21, v22
    v_add_u32 v21, v21, v22
    s_lshl_b32 s21, s3, 3
    v_add_u32 v21, s21, v21
    v_lshlrev_b32 v5, 2, v21
    s_and_b32 s21, s3, 1
    s_lshl_b32 s21, s21, 2
    v_bfe_u32 v21, v20, 3, 2
    v_add_u32 v21, s21, v21
    v_mul_u32_u24 v21, 104, v21
    v_bfe_u32 v22, v20, 1, 1
    v_lshl_add_u32 v21, v22, 3, v21
    v_and_b32 v23, 1, v20
    v_xor_b32 v22, v22, v23
    v_lshl_add_u32 v21, v22, 2, v21
    v_bfe_u32 v22, v20, 2, 1
    v_lshl_add_u32 v21, v22, 1, v21
    s_lshr_b32 s21, s3, 1
    s_lshl_b32 s21, s21, 4
    s_add_u32 s21, s21, 64
    v_add_u32 v21, s21, v21
    v_lshlrev_b32 v6, 2, v21
    v_lshrrev_b32 v21, 6, v27
    v_bfe_u32 v22, v27, 1, 1
    v_lshrrev_b32 v23, 1, v21
    v_lshl_add_u32 v22, v22, 1, v23
    v_xor_b32 v23, v27, v22
    v_and_b32 v23, 1, v23
    v_and_b32 v21, 1, v21
    v_lshl_add_u32 v21, v21, 1, v23
    v_mul_u32_u24 v21, 544, v21
    v_lshl_add_u32 v21, v22, 5, v21
    v_bfe_u32 v23, v27, 4, 2
    v_mul_u32_u24 v23, 136, v23
    v_add_u32 v21, v21, v23
    v_bfe_u32 v24, v27, 3, 1
    v_lshl_add_u32 v21, v24, 2, v21
    v_bfe_u32 v24, v27, 2, 1
    v_lshl_add_u32 v21, v24, 4, v21
    v_add_u32 v7, 16384, v21
    v_lshlrev_b32 v8, 2, v20
    s_and_b32 s21, s12, 1
    s_lshl_b32 s21, s21, 9
    s_lshl_b32 s22, s3, 7
    s_add_u32 s21, s21, s22
    v_and_b32 v21, 7, v20
    v_lshlrev_b32 v21, 4, v21
    v_add_u32 v21, s21, v21
    v_lshrrev_b32 v22, 3, v20
    v_lshl_add_u32 v12, v22, 10, v21
    v_bfe_u32 v22, v20, 4, 1
    v_lshl_add_u32 v13, v22, 3, v21
    s_and_b32 s21, s3, 1
    s_lshl_b32 s21, s21, 12
    s_lshr_b32 s22, s3, 1
    s_lshl_b32 s22, s22, 11
    s_add_u32 s21, s21, s22
    s_add_u32 s21, s21, 18560
    v_add_u32 v61, s21, v1
    s_lshl_b32 s21, s3, 2
    s_add_u32 s21, s21, 13312
    v_mov_b32 v14, s21
    v_and_b32 v21, 15, v20
    v_and_b32 v22, 1, v20
    v_lshlrev_b32 v22, 4, v22
    v_mov_b32 v23, 0x3f80
    v_lshlrev_b32 v22, v22, v23
    v_lshrrev_b32 v21, 1, v21
    v_cmp_eq_u32 vcc, 0, v21
    s_nop 1
    v_cndmask_b32 v56, 0, v22, vcc
    v_cmp_eq_u32 vcc, 1, v21
    s_nop 1
    v_cndmask_b32 v57, 0, v22, vcc
    v_cmp_eq_u32 vcc, 2, v21
    s_nop 1
    v_cndmask_b32 v58, 0, v22, vcc
    v_cmp_eq_u32 vcc, 3, v21
    s_nop 1
    v_cndmask_b32 v59, 0, v22, vcc
    v_and_b32 v21, 7, v20
    v_lshlrev_b32 v21, 7, v21
    v_bfe_u32 v22, v20, 3, 1
    v_lshl_add_u32 v21, v22, 17, v21
    s_lshl_b32 s21, s12, 14
    s_lshl_b32 s22, s13, 10
    s_add_u32 s21, s21, s22
    s_add_u32 s21, s21, 4980736
    v_lshrrev_b32 v22, 4, v20
    v_lshl_add_u32 v21, v22, 24, v21
    v_add_u32 v63, s21, v21
    s_mov_b32 s47, 0x3e0293ee
    s_lshl_b32 s14, s12, 2
    s_add_u32 s14, s14, s3
    s_lshl_b32 s61, s14, 13
    s_add_u32 s61, s61, 2097152
    s_lshl_b32 s14, s14, 12
    s_and_b32 s22, s13, 1
    s_lshl_b32 s69, s22, 17
    s_add_u32 s69, s69, s14
    s_add_u32 s69, s69, 4194304
    s_add_u32 s52, s14, 20971520
    s_lshl_b32 s21, s22, 11
    s_add_u32 s14, s14, s21
    s_add_u32 s14, s14, 1179648
    s_lshr_b32 s21, s13, 1
    s_sub_u32 s21, s21, 0
    s_cmp_eq_u32 s21, s3
    s_cselect_b32 s15, 1, 0
    s_add_u32 s23, s3, 3
    s_and_b32 s23, s23, 3
    s_cmp_eq_u32 s21, s23
    s_cselect_b32 s31, 1, 0
    s_and_b32 s24, s23, 1
    s_and_b32 s25, s3, 1
    s_sub_i32 s24, s24, s25
    s_lshr_b32 s23, s23, 1
    s_lshr_b32 s25, s3, 1
    s_sub_i32 s23, s23, s25
    s_mul_i32 s46, s24, 4096
    s_mul_i32 s25, s23, 2048
    s_add_i32 s46, s46, s25
    s_mul_i32 s27, s24, 32768
    s_mul_i32 s25, s23, 1024
    s_add_i32 s27, s27, s25
    v_lshrrev_b32 v21, 4, v20
    v_and_b32 v23, 15, v20
    v_lshlrev_b32 v21, 2, v21
    v_add_u32 v24, 0, v21
    v_cmp_gt_u32 vcc, v24, v23
    s_cmp_eq_u32 s22, 0
    s_cselect_b64 s[38:39], vcc, 0
    s_cselect_b64 s[48:49], -1, vcc
    v_add_u32 v24, 1, v21
    v_cmp_gt_u32 vcc, v24, v23
    s_cmp_eq_u32 s22, 0
    s_cselect_b64 s[40:41], vcc, 0
    s_cselect_b64 s[50:51], -1, vcc
    v_add_u32 v24, 2, v21
    v_cmp_gt_u32 vcc, v24, v23
    s_cmp_eq_u32 s22, 0
    s_cselect_b64 s[42:43], vcc, 0
    s_cselect_b64 s[54:55], -1, vcc
    v_add_u32 v24, 3, v21
    v_cmp_gt_u32 vcc, v24, v23
    s_cmp_eq_u32 s22, 0
    s_cselect_b64 s[44:45], vcc, 0
    s_cselect_b64 s[56:57], -1, vcc
    s_waitcnt vmcnt(0)
    v_mov_b32 v16, v32
    v_mov_b32 v17, v33
    v_mov_b32 v18, v34
    v_mov_b32 v19, v35
    v_mov_b32 v20, v36
    v_mov_b32 v21, v37
    v_mov_b32 v22, v38
    v_mov_b32 v23, v39
    v_mov_b32 v24, v40
    v_mov_b32 v25, v41
    v_mov_b32 v26, v42
    v_mov_b32 v27, v43
    v_mov_b32 v28, v44
    v_mov_b32 v29, v45
    v_mov_b32 v30, v46
    v_mov_b32 v31, v47
    v_mov_b32 v32, -1
    v_mov_b32 v33, -1
    v_mov_b32 v34, -1
    v_mov_b32 v35, -1
    s_add_u32 s21, s37, 3997696
    buffer_store_dwordx4 v[32:35], v1, s[4:7], s21 offen sc1
    s_add_u32 s21, s37, 4063232
    buffer_store_dwordx4 v[32:35], v1, s[4:7], s21 offen sc1
    s_add_u32 s21, s37, 4128768
    buffer_store_dwordx4 v[32:35], v1, s[4:7], s21 offen sc1
    s_lshl_b32 s29, s29, 5
    s_barrier
    ds_write_b32 v14, v10
    ds_write_b32 v14, v10 offset:16
    s_lshl_b32 s53, s3, 13
    s_add_u32 s53, s53, 92160
    v_add_u32 v32, 14336, v1
    ds_write_b128 v32, v[56:59]
    s_lshl_b32 s60, s12, 4
    s_add_u32 s60, s60, 218104320
    v_mov_b32 v15, 0
    s_add_u32 s25, s16, 0
    s_min_u32 s25, s25, 63
    s_cmp_lt_u32 s25, 8
    s_cselect_b32 s59, 12, 24
    s_cselect_b32 s58, -4, -8
    s_and_b32 s25, s25, s58
    s_lshl_b32 s25, s25, 5
    s_add_u32 s58, s25, s60
    v_mov_b32 v32, 131072
    s_waitcnt vmcnt(0) lgkmcnt(0)
    s_barrier
    ds_read_b64 v[32:33], v32
    s_waitcnt lgkmcnt(0)
    v_cmp_ne_u32 vcc, s29, v32
    s_setprio 3
    v_readfirstlane_b32 s63, v33
    s_add_u32 s34, s34, s63
    s_add_u32 s35, s35, s63
gate_6:
    v_readfirstlane_b32 s25, v15
    s_cmp_ge_u32 s25, s59
    s_cbranch_scc1 gate_6_ok
    s_sleep 8
    buffer_load_dword v15, off, s[4:7], s58 sc1
    s_waitcnt vmcnt(0)
    s_sub_u32 s26, s26, 1
    s_cbranch_scc0 gate_6
    s_mov_b32 s26, 0
gate_6_ok:
    s_add_u32 m0, s53, 0
    s_add_u32 s22, s52, 0
    buffer_load_dwordx4 v1, s[4:7], s22 offen offset:0 sc1 lds
    buffer_load_dwordx4 v1, s[4:7], s22 offen offset:1024 sc1 lds
    buffer_load_dwordx4 v1, s[4:7], s22 offen offset:2048 sc1 lds
    buffer_load_dwordx4 v1, s[4:7], s22 offen offset:3072 sc1 lds
    s_add_u32 m0, s53, 4096
    s_add_u32 s22, s52, 131072
    buffer_load_dwordx4 v1, s[4:7], s22 offen offset:0 sc1 lds
    buffer_load_dwordx4 v1, s[4:7], s22 offen offset:1024 sc1 lds
    buffer_load_dwordx4 v1, s[4:7], s22 offen offset:2048 sc1 lds
    buffer_load_dwordx4 v1, s[4:7], s22 offen offset:3072 sc1 lds
    s_add_u32 s52, s52, 262144
    s_cmp_eq_u32 s15, 0
    s_cbranch_scc1 ch_p_nd
    s_mov_b32 m0, 124928
    s_nop 0
    buffer_load_dwordx4 v1, s[4:7], s69 offen offset:0 sc1 lds
    buffer_load_dwordx4 v1, s[4:7], s69 offen offset:1024 sc1 lds
    buffer_load_dwordx4 v1, s[4:7], s69 offen offset:2048 sc1 lds
    buffer_load_dwordx4 v1, s[4:7], s69 offen offset:3072 sc1 lds
    s_add_u32 s69, s69, 262144
ch_p_nd:
    s_cbranch_vccnz ch_p_slow
    v_mov_b32 v32, 0
    v_mov_b32 v33, 0
    v_mov_b32 v34, 0
    v_mov_b32 v35, 0
    v_mov_b32 v36, 0
    v_mov_b32 v37, 0
    v_mov_b32 v38, 0
    v_mov_b32 v39, 0
    v_mov_b32 v40, 0
    v_mov_b32 v41, 0
    v_mov_b32 v42, 0
    v_mov_b32 v43, 0
    v_mov_b32 v44, 0
    v_mov_b32 v45, 0
    v_mov_b32 v46, 0
    v_mov_b32 v47, 0
    v_mov_b32 v48, 0
    v_mov_b32 v49, 0
    v_mov_b32 v50, 0
    v_mov_b32 v51, 0
    v_mov_b32 v52, 0
    v_mov_b32 v53, 0
    v_mov_b32 v54, 0
    v_mov_b32 v55, 0
    v_mov_b32 v0, 1.0
    s_mov_b32 exec_lo, 0xff00ff00
    s_mov_b32 exec_hi, 0xff00ff00
    v_mov_b32 v0, s47
    s_mov_b64 exec, -1
    v_mov_b32 v60, s16
    s_branch pnc_8
.p2align 6
ploop_7:
    s_add_u32 s21, s17, s33
    v_mov_b32 v32, 0
    v_mov_b32 v33, 0
    v_mov_b32 v34, 0
    v_mov_b32 v35, 0
    v_mov_b32 v36, 0
    v_mov_b32 v37, 0
    v_mov_b32 v38, 0
    v_mov_b32 v39, 0
    v_mov_b32 v40, 0
    v_mov_b32 v41, 0
    v_mov_b32 v42, 0
    v_mov_b32 v43, 0
    v_mov_b32 v44, 0
    v_mov_b32 v45, 0
    v_mov_b32 v46, 0
    v_mov_b32 v47, 0
    v_mov_b32 v48, 0
    v_mov_b32 v49, 0
    v_mov_b32 v50, 0
    v_mov_b32 v51, 0
    v_mov_b32 v52, 0
    v_mov_b32 v53, 0
    v_mov_b32 v54, 0
    v_mov_b32 v55, 0
    v_mov_b32 v0, 1.0
    s_mov_b32 exec_lo, 0xff00ff00
    s_mov_b32 exec_hi, 0xff00ff00
    v_mov_b32 v0, s47
    s_mov_b64 exec, -1
    s_nop 15
    s_nop 8
    buffer_load_dwordx4 v[16:19], v1, s[4:7], s21 offen offset:0 sc1
    s_nop 7
    buffer_load_dwordx4 v[20:23], v1, s[4:7], s21 offen offset:1024 sc1
    s_nop 7
    buffer_load_dwordx4 v[24:27], v1, s[4:7], s21 offen offset:2048 sc1
    s_nop 7
    buffer_load_dwordx4 v[28:31], v1, s[4:7], s21 offen offset:3072 sc1
    s_waitcnt vmcnt(3)
    v_max3_u32 v9, v16, v17, v18
    v_max_u32 v9, v9, v19
    v_cmp_eq_u32 vcc, -1, v9
    s_cbranch_vccnz prm_10_0
prm_10_0ok:
    v_smfmac_f32_16x16x64_bf16 v[32:35], v[16:19], v[64:71], v62
    v_smfmac_f32_16x16x64_bf16 v[36:39], v[16:19], v[72:79], v62
    v_smfmac_f32_16x16x64_bf16 v[40:43], v[16:19], v[80:87], v62
    s_waitcnt vmcnt(2)
    v_max3_u32 v9, v20, v21, v22
    v_max_u32 v9, v9, v23
    v_cmp_eq_u32 vcc, -1, v9
    v_smfmac_f32_16x16x64_bf16 v[44:47], v[16:19], v[88:95], v62
    v_smfmac_f32_16x16x64_bf16 v[48:51], v[16:19], v[96:103], v62
    v_smfmac_f32_16x16x64_bf16 v[52:55], v[16:19], v[104:111], v62
    s_cbranch_vccnz prm_10_1
prm_10_1ok:
    v_smfmac_f32_16x16x64_bf16 v[32:35], v[20:23], v[112:119], v62
    v_readfirstlane_b32 s23, v15
    v_smfmac_f32_16x16x64_bf16 v[36:39], v[20:23], v[120:127], v62
    v_smfmac_f32_16x16x64_bf16 v[40:43], v[20:23], v[128:135], v62
    s_waitcnt vmcnt(1)
    v_max3_u32 v9, v24, v25, v26
    v_max_u32 v9, v9, v27
    v_cmp_eq_u32 vcc, -1, v9
    v_smfmac_f32_16x16x64_bf16 v[44:47], v[20:23], v[136:143], v62
    v_smfmac_f32_16x16x64_bf16 v[48:51], v[20:23], v[144:151], v62
    v_smfmac_f32_16x16x64_bf16 v[52:55], v[20:23], v[152:159], v62
    s_cbranch_vccnz prm_10_2
prm_10_2ok:
    v_smfmac_f32_16x16x64_bf16 v[32:35], v[24:27], v[160:167], v62
    v_smfmac_f32_16x16x64_bf16 v[36:39], v[24:27], v[168:175], v62
    v_smfmac_f32_16x16x64_bf16 v[40:43], v[24:27], v[176:183], v62
    s_waitcnt vmcnt(0)
    v_max3_u32 v9, v28, v29, v30
    v_max_u32 v9, v9, v31
    v_cmp_eq_u32 vcc, -1, v9
    v_smfmac_f32_16x16x64_bf16 v[44:47], v[24:27], v[184:191], v62
    v_smfmac_f32_16x16x64_bf16 v[48:51], v[24:27], v[192:199], v62
    v_smfmac_f32_16x16x64_bf16 v[52:55], v[24:27], v[200:207], v62
    s_cbranch_vccnz prm_10_3
prm_10_3ok:
    v_smfmac_f32_16x16x64_bf16 v[32:35], v[28:31], v[208:215], v62
    s_cmp_lt_u32 s23, s59
    s_cbranch_scc1 prm_10_gt
prm_10_gtb:
    ds_write_b32 v14, v60
    v_smfmac_f32_16x16x64_bf16 v[36:39], v[28:31], v[216:223], v62
    v_smfmac_f32_16x16x64_bf16 v[40:43], v[28:31], v[224:231], v62
    v_smfmac_f32_16x16x64_bf16 v[44:47], v[28:31], v[232:239], v62
    v_add_f32 v32, v32, v33
    v_add_f32 v34, v34, v35
    v_smfmac_f32_16x16x64_bf16 v[48:51], v[28:31], v[240:247], v62
    v_add_f32 v36, v36, v37
    v_add_f32 v38, v38, v39
    ds_write2_b32 v4, v32, v34 offset0:0 offset1:104
    v_smfmac_f32_16x16x64_bf16 v[52:55], v[28:31], v[248:255], v62
    v_add_f32 v40, v40, v41
    v_add_f32 v42, v42, v43
    ds_write2_b32 v4, v36, v38 offset0:16 offset1:120
    v_add_f32 v44, v44, v45
    v_add_f32 v46, v46, v47
    ds_write2_b32 v4, v40, v42 offset0:32 offset1:136
    v_add_f32 v48, v48, v49
    v_add_f32 v50, v50, v51
    ds_write2_b32 v4, v44, v46 offset0:48 offset1:152
    v_add_f32 v52, v52, v53
    v_add_f32 v54, v54, v55
    ds_write2_b32 v4, v48, v50 offset0:64 offset1:168
    ds_write2_b32 v4, v52, v54 offset0:80 offset1:184
    s_branch pnc_8_done
pnc_8:
    v_smfmac_f32_16x16x64_bf16 v[32:35], v[16:19], v[64:71], v62
    v_smfmac_f32_16x16x64_bf16 v[36:39], v[16:19], v[72:79], v62
    v_smfmac_f32_16x16x64_bf16 v[40:43], v[16:19], v[80:87], v62
    v_smfmac_f32_16x16x64_bf16 v[44:47], v[16:19], v[88:95], v62
    v_smfmac_f32_16x16x64_bf16 v[48:51], v[16:19], v[96:103], v62
    v_smfmac_f32_16x16x64_bf16 v[52:55], v[16:19], v[104:111], v62
    v_smfmac_f32_16x16x64_bf16 v[32:35], v[20:23], v[112:119], v62
    v_smfmac_f32_16x16x64_bf16 v[36:39], v[20:23], v[120:127], v62
    v_smfmac_f32_16x16x64_bf16 v[40:43], v[20:23], v[128:135], v62
    v_smfmac_f32_16x16x64_bf16 v[44:47], v[20:23], v[136:143], v62
    v_smfmac_f32_16x16x64_bf16 v[48:51], v[20:23], v[144:151], v62
    v_smfmac_f32_16x16x64_bf16 v[52:55], v[20:23], v[152:159], v62
    v_smfmac_f32_16x16x64_bf16 v[32:35], v[24:27], v[160:167], v62
    v_smfmac_f32_16x16x64_bf16 v[36:39], v[24:27], v[168:175], v62
    v_smfmac_f32_16x16x64_bf16 v[40:43], v[24:27], v[176:183], v62
    v_smfmac_f32_16x16x64_bf16 v[44:47], v[24:27], v[184:191], v62
    v_smfmac_f32_16x16x64_bf16 v[48:51], v[24:27], v[192:199], v62
    v_smfmac_f32_16x16x64_bf16 v[52:55], v[24:27], v[200:207], v62
    v_smfmac_f32_16x16x64_bf16 v[32:35], v[28:31], v[208:215], v62
    ds_write_b32 v14, v60
    v_smfmac_f32_16x16x64_bf16 v[36:39], v[28:31], v[216:223], v62
    v_smfmac_f32_16x16x64_bf16 v[40:43], v[28:31], v[224:231], v62
    v_smfmac_f32_16x16x64_bf16 v[44:47], v[28:31], v[232:239], v62
    v_add_f32 v32, v32, v33
    v_add_f32 v34, v34, v35
    v_smfmac_f32_16x16x64_bf16 v[48:51], v[28:31], v[240:247], v62
    v_add_f32 v36, v36, v37
    v_add_f32 v38, v38, v39
    ds_write2_b32 v4, v32, v34 offset0:0 offset1:104
    v_smfmac_f32_16x16x64_bf16 v[52:55], v[28:31], v[248:255], v62
    v_add_f32 v40, v40, v41
    v_add_f32 v42, v42, v43
    ds_write2_b32 v4, v36, v38 offset0:16 offset1:120
    v_add_f32 v44, v44, v45
    v_add_f32 v46, v46, v47
    ds_write2_b32 v4, v40, v42 offset0:32 offset1:136
    v_add_f32 v48, v48, v49
    v_add_f32 v50, v50, v51
    ds_write2_b32 v4, v44, v46 offset0:48 offset1:152
    v_add_f32 v52, v52, v53
    v_add_f32 v54, v54, v55
    ds_write2_b32 v4, v48, v50 offset0:64 offset1:168
    ds_write2_b32 v4, v52, v54 offset0:80 offset1:184
    s_waitcnt vmcnt(0)
pnc_8_done:
    s_add_u32 s21, s17, s32
    s_add_u32 s22, s19, s32
    s_add_u32 s24, s19, s35
    s_waitcnt lgkmcnt(0)
    s_barrier
    ds_read_b64 v[32:33], v5 offset:0
    ds_read_b64 v[34:35], v5 offset:3328
    ds_read_b64 v[36:37], v5 offset:6656
    ds_read_b64 v[38:39], v5 offset:9984
    ds_read_b64 v[40:41], v6 offset:0
    ds_read_b64 v[42:43], v6 offset:3328
    ds_read_b64 v[44:45], v6 offset:6656
    ds_read_b64 v[46:47], v6 offset:9984
    s_waitcnt lgkmcnt(6)
    v_add_f32 v32, v32, v34
    v_add_f32 v33, v33, v35
    s_waitcnt lgkmcnt(4)
    v_add_f32 v36, v36, v38
    v_add_f32 v37, v37, v39
    v_add_f32 v32, v32, v36
    v_add_f32 v33, v33, v37
    v_mul_f32 v32, v32, v0
    v_mul_f32 v33, v33, v0
    v_cvt_pk_bf16_f32 v32, v32, v33
    v_min_u32 v32, -2, v32
    buffer_store_dword v32, v2, s[4:7], s21 offen
    s_waitcnt lgkmcnt(2)
    v_add_f32 v40, v40, v42
    v_add_f32 v41, v41, v43
    s_waitcnt lgkmcnt(0)
    v_add_f32 v44, v44, v46
    v_add_f32 v45, v45, v47
    v_add_f32 v40, v40, v44
    v_add_f32 v41, v41, v45
    v_cvt_pk_bf16_f32 v40, v40, v41
    v_min_u32 v40, -2, v40
    s_mov_b32 exec_hi, 0
    buffer_store_dword v40, v3, s[4:7], s21 offen
    s_setprio 0
    s_mov_b64 exec, -1
    s_add_u32 s21, s17, s35
    s_add_u32 s30, s17, s34
    s_add_u32 s23, s18, s36
    s_add_u32 s25, s16, 2
    s_min_u32 s25, s25, 63
    s_cmp_lt_u32 s25, 8
    s_cselect_b32 s59, 12, 24
    s_cselect_b32 s58, -4, -8
    s_and_b32 s25, s25, s58
    s_lshl_b32 s25, s25, 5
    s_add_u32 s58, s25, s60
    s_cmp_eq_u32 s15, 0
    s_cbranch_scc1 ploop_7_nd
    v_add_u32 v9, s53, v1
    v_add_u32 v0, 124928, v1
    ds_read_b128 v[16:19], v0 offset:0
    ds_read_b128 v[32:35], v9 offset:0
    ds_read_b128 v[20:23], v0 offset:1024
    ds_read_b128 v[36:39], v9 offset:1024
    ds_read_b128 v[24:27], v0 offset:2048
    ds_read_b128 v[40:43], v9 offset:2048
    ds_read_b128 v[28:31], v0 offset:3072
    ds_read_b128 v[44:47], v9 offset:3072
    s_add_u32 s22, s17, s61
    s_waitcnt lgkmcnt(6)
    v_mfma_f32_16x16x32_bf16 v[48:51], v[32:35], v[16:19], 0
    ds_read_b128 v[32:35], v9 offset:4096
    s_waitcnt lgkmcnt(5)
    v_mfma_f32_16x16x32_bf16 v[48:51], v[36:39], v[20:23], v[48:51]
    ds_read_b128 v[36:39], v9 offset:5120
    s_waitcnt lgkmcnt(4)
    v_mfma_f32_16x16x32_bf16 v[48:51], v[40:43], v[24:27], v[48:51]
    ds_read_b128 v[40:43], v9 offset:6144
    s_waitcnt lgkmcnt(3)
    v_mfma_f32_16x16x32_bf16 v[48:51], v[44:47], v[28:31], v[48:51]
    ds_read_b128 v[44:47], v9 offset:7168
    s_waitcnt lgkmcnt(3)
    v_mfma_f32_16x16x32_bf16 v[52:55], v[32:35], v[16:19], 0
    s_waitcnt lgkmcnt(2)
    v_mfma_f32_16x16x32_bf16 v[52:55], v[36:39], v[20:23], v[52:55]
    s_waitcnt lgkmcnt(1)
    v_mfma_f32_16x16x32_bf16 v[52:55], v[40:43], v[24:27], v[52:55]
    s_waitcnt lgkmcnt(0)
    v_mfma_f32_16x16x32_bf16 v[52:55], v[44:47], v[28:31], v[52:55]
    buffer_load_dwordx4 v[32:35], v1, s[4:7], s22 offen offset:0 sc1
    buffer_load_dwordx4 v[36:39], v1, s[4:7], s22 offen offset:1024 sc1
    buffer_load_dwordx4 v[40:43], v1, s[4:7], s22 offen offset:2048 sc1
    buffer_load_dwordx4 v[44:47], v1, s[4:7], s22 offen offset:3072 sc1
    v_mov_b32 v60, 0xff61b1e6
    s_nop 2
    v_cndmask_b32 v48, v48, v60, s[38:39]
    v_cndmask_b32 v49, v49, v60, s[40:41]
    v_cndmask_b32 v50, v50, v60, s[42:43]
    v_cndmask_b32 v51, v51, v60, s[44:45]
    v_cndmask_b32 v52, v52, v60, s[48:49]
    v_cndmask_b32 v53, v53, v60, s[50:51]
    v_cndmask_b32 v54, v54, v60, s[54:55]
    v_cndmask_b32 v55, v55, v60, s[56:57]
    v_max3_f32 v0, v48, v49, v50
    v_max3_f32 v9, v51, v52, v53
    v_max3_f32 v0, v0, v54, v55
    v_max_f32 v0, v0, v9
    v_mov_b32 v9, v0
    s_nop 1
    v_permlane16_swap_b32 v9, v0
    v_max_f32 v0, v0, v9
    v_mov_b32 v9, v0
    s_nop 1
    v_permlane32_swap_b32 v9, v0
    v_max_f32 v0, v0, v9
    v_mul_f32 v0, s47, v0
    v_fma_f32 v48, v48, s47, -v0
    v_fma_f32 v49, v49, s47, -v0
    v_fma_f32 v50, v50, s47, -v0
    v_fma_f32 v51, v51, s47, -v0
    v_fma_f32 v52, v52, s47, -v0
    v_fma_f32 v53, v53, s47, -v0
    v_fma_f32 v54, v54, s47, -v0
    v_fma_f32 v55, v55, s47, -v0
    v_exp_f32 v48, v48
    v_exp_f32 v49, v49
    v_exp_f32 v50, v50
    v_exp_f32 v51, v51
    v_exp_f32 v52, v52
    v_exp_f32 v53, v53
    v_exp_f32 v54, v54
    v_exp_f32 v55, v55
    v_add_f32 v15, v48, v49
    v_add_f32 v15, v15, v50
    v_add_f32 v15, v15, v51
    v_add_f32 v15, v15, v52
    v_add_f32 v15, v15, v53
    v_add_f32 v15, v15, v54
    v_add_f32 v15, v15, v55
ploop_7_za:
    s_waitcnt vmcnt(0)
    v_max3_u32 v9, v32, v33, v34
    v_max3_u32 v9, v9, v35, v36
    v_max3_u32 v9, v9, v37, v38
    v_max3_u32 v9, v9, v39, v40
    v_max3_u32 v9, v9, v41, v42
    v_max3_u32 v9, v9, v43, v44
    v_max3_u32 v9, v9, v45, v46
    v_max_u32 v9, v9, v47
    v_cmp_eq_u32 vcc, -1, v9
    s_cbranch_vccnz ploop_7_zr
ploop_7_zok:
    v_mfma_f32_16x16x32_bf16 v[56:59], v[32:35], v[16:19], 0
    v_mfma_f32_16x16x32_bf16 v[56:59], v[36:39], v[20:23], v[56:59]
    v_mfma_f32_16x16x32_bf16 v[56:59], v[40:43], v[24:27], v[56:59]
    v_mfma_f32_16x16x32_bf16 v[56:59], v[44:47], v[28:31], v[56:59]
    s_add_u32 s22, s17, s14
    s_nop 6
    v_max_f32 v60, v56, v57
    v_mov_b32 v9, v60
    s_nop 1
    v_permlane16_swap_b32 v9, v60
    v_max_f32 v60, v60, v9
    v_mov_b32 v9, v60
    s_nop 1
    v_permlane32_swap_b32 v9, v60
    v_max_f32 v60, v60, v9
    v_mul_f32 v60, s47, v60
    v_max_f32 v58, v60, v0
    v_sub_f32 v60, v0, v58
    v_fma_f32 v56, v56, s47, -v58
    v_fma_f32 v57, v57, s47, -v58
    v_exp_f32 v60, v60
    v_exp_f32 v56, v56
    v_exp_f32 v57, v57
    v_fma_f32 v15, v15, v60, v56
    v_add_f32 v15, v15, v57
    v_mov_b32 v9, v15
    s_nop 1
    v_permlane16_swap_b32 v9, v15
    v_add_f32 v15, v15, v9
    v_mov_b32 v9, v15
    s_nop 1
    v_permlane32_swap_b32 v9, v15
    v_add_f32 v15, v15, v9
    v_rcp_f32 v15, v15
    s_add_u32 s25, s19, s14
    v_mul_f32 v56, v56, v15
    v_mul_f32 v57, v57, v15
    v_mul_f32 v60, v60, v15
    v_mul_f32 v48, v48, v60
    v_mul_f32 v49, v49, v60
    v_mul_f32 v50, v50, v60
    v_mul_f32 v51, v51, v60
    v_mul_f32 v52, v52, v60
    v_mul_f32 v53, v53, v60
    v_mul_f32 v54, v54, v60
    v_mul_f32 v55, v55, v60
    v_cvt_pk_bf16_f32 v48, v48, v49
    v_cvt_pk_bf16_f32 v49, v50, v51
    v_cvt_pk_bf16_f32 v50, v52, v53
    v_cvt_pk_bf16_f32 v51, v54, v55
    v_min_u32 v48, -2, v48
    v_min_u32 v49, -2, v49
    v_min_u32 v50, -2, v50
    v_min_u32 v51, -2, v51
    v_lshlrev_b32 v54, 1, v8
    v_add_u32 v55, 14336, v1
    v_mov_b32 v53, 1.0
    v_cvt_pk_bf16_f32 v52, v56, v57
    v_min_u32 v53, -2, v53
    v_min_u32 v52, -2, v52
    buffer_store_dwordx4 v[48:51], v1, s[4:7], s22 offen
    buffer_store_dwordx2 v[52:53], v54, s[4:7], s22 offen offset:1024
    ds_read_b128 v[56:59], v55
    s_branch ploop_7_nd2
ploop_7_nd:
    s_cmp_eq_u32 s16, 0
    s_cbranch_scc1 ploop_7_ns
    s_cmp_eq_u32 s31, 0
    s_cbranch_scc1 ploop_7_n2
    s_add_u32 s25, s68, s46
    v_add_u32 v55, s25, v61
    ds_read_b128 v[24:27], v55 offset:0
    ds_read_b128 v[28:31], v55 offset:1024
    ds_read_b128 v[32:35], v55 offset:18560
    ds_read_b128 v[36:39], v55 offset:19584
    ds_read_b128 v[40:43], v55 offset:37120
    ds_read_b128 v[44:47], v55 offset:38144
    ds_read_b128 v[48:51], v55 offset:55680
    ds_read_b128 v[52:55], v55 offset:56704
    s_waitcnt lgkmcnt(4)
    v_add_f32 v24, v24, v32
    v_add_f32 v25, v25, v33
    v_add_f32 v26, v26, v34
    v_add_f32 v27, v27, v35
    v_add_f32 v28, v28, v36
    v_add_f32 v29, v29, v37
    v_add_f32 v30, v30, v38
    v_add_f32 v31, v31, v39
    s_waitcnt lgkmcnt(0)
    v_add_f32 v40, v40, v48
    v_add_f32 v41, v41, v49
    v_add_f32 v42, v42, v50
    v_add_f32 v43, v43, v51
    v_add_f32 v44, v44, v52
    v_add_f32 v45, v45, v53
    v_add_f32 v46, v46, v54
    v_add_f32 v47, v47, v55
    v_add_f32 v24, v24, v40
    v_add_f32 v25, v25, v41
    v_add_f32 v26, v26, v42
    v_add_f32 v27, v27, v43
    v_add_f32 v28, v28, v44
    v_add_f32 v29, v29, v45
    v_add_f32 v30, v30, v46
    v_add_f32 v31, v31, v47
    v_cvt_pk_bf16_f32 v24, v24, v25
    v_cvt_pk_bf16_f32 v25, v26, v27
    v_cvt_pk_bf16_f32 v26, v28, v29
    v_cvt_pk_bf16_f32 v27, v30, v31
    v_min_u32 v24, -2, v24
    v_min_u32 v25, -2, v25
    v_min_u32 v26, -2, v26
    v_min_u32 v27, -2, v27
    v_mov_b32 v16, v24
    v_mov_b32 v17, v25
    v_mov_b32 v18, v26
    v_mov_b32 v19, v27
ploop_7_n2:
    v_add_u32 v55, s68, v61
    ds_read_b128 v[24:27], v55 offset:0
    ds_read_b128 v[28:31], v55 offset:1024
    ds_read_b128 v[32:35], v55 offset:18560
    ds_read_b128 v[36:39], v55 offset:19584
    ds_read_b128 v[40:43], v55 offset:37120
    ds_read_b128 v[44:47], v55 offset:38144
    ds_read_b128 v[48:51], v55 offset:55680
    ds_read_b128 v[52:55], v55 offset:56704
    s_waitcnt lgkmcnt(4)
    v_add_f32 v24, v24, v32
    v_add_f32 v25, v25, v33
    v_add_f32 v26, v26, v34
    v_add_f32 v27, v27, v35
    v_add_f32 v28, v28, v36
    v_add_f32 v29, v29, v37
    v_add_f32 v30, v30, v38
    v_add_f32 v31, v31, v39
    s_waitcnt lgkmcnt(0)
    v_add_f32 v40, v40, v48
    v_add_f32 v41, v41, v49
    v_add_f32 v42, v42, v50
    v_add_f32 v43, v43, v51
    v_add_f32 v44, v44, v52
    v_add_f32 v45, v45, v53
    v_add_f32 v46, v46, v54
    v_add_f32 v47, v47, v55
    v_add_f32 v24, v24, v40
    v_add_f32 v25, v25, v41
    v_add_f32 v26, v26, v42
    v_add_f32 v27, v27, v43
    v_add_f32 v28, v28, v44
    v_add_f32 v29, v29, v45
    v_add_f32 v30, v30, v46
    v_add_f32 v31, v31, v47
    v_cvt_pk_bf16_f32 v24, v24, v25
    v_cvt_pk_bf16_f32 v25, v26, v27
    v_cvt_pk_bf16_f32 v26, v28, v29
    v_cvt_pk_bf16_f32 v27, v30, v31
    v_min_u32 v24, -2, v24
    v_min_u32 v25, -2, v25
    v_min_u32 v26, -2, v26
    v_min_u32 v27, -2, v27
ploop_7_ns:
ploop_7_flag:
    ds_read_b32 v9, v14 offset:16
    s_waitcnt lgkmcnt(0)
    v_readfirstlane_b32 s25, v9
    s_cmp_eq_u32 s25, s16
    s_cbranch_scc0 ploop_7_flag
    s_add_u32 m0, s53, 0
    s_add_u32 s22, s52, 0
    buffer_load_dwordx4 v1, s[4:7], s22 offen offset:0 sc1 lds
    buffer_load_dwordx4 v1, s[4:7], s22 offen offset:1024 sc1 lds
    buffer_load_dwordx4 v1, s[4:7], s22 offen offset:2048 sc1 lds
    buffer_load_dwordx4 v1, s[4:7], s22 offen offset:3072 sc1 lds
    s_add_u32 m0, s53, 4096
    s_add_u32 s22, s52, 131072
    buffer_load_dwordx4 v1, s[4:7], s22 offen offset:0 sc1 lds
    buffer_load_dwordx4 v1, s[4:7], s22 offen offset:1024 sc1 lds
    buffer_load_dwordx4 v1, s[4:7], s22 offen offset:2048 sc1 lds
    buffer_load_dwordx4 v1, s[4:7], s22 offen offset:3072 sc1 lds
    s_add_u32 s52, s52, 262144
    s_cmp_eq_u32 s16, 0
    s_cbranch_scc1 ploop_7_nd2
    buffer_store_dwordx4 v[24:27], v1, s[4:7], s37 offen sc1
    s_cmp_eq_u32 s31, 0
    s_cbranch_scc1 ploop_7_nd2
    s_add_u32 s25, s37, s27
    buffer_store_dwordx4 v[16:19], v1, s[4:7], s25 offen sc1
ploop_7_nd2:
    s_cmp_eq_u32 s16, 0
    s_cbranch_scc1 ploop_7_nn
    s_add_u32 s37, s37, 65536
    s_xor_b32 s68, s68, 8192
ploop_7_nn:
    s_cmp_lg_u32 s3, 2
    s_cbranch_scc1 ppf_12
    s_lshl_b32 s22, s16, 18
    s_mov_b32 exec_hi, 0xffff
    buffer_load_dword v0, v63, s[4:7], s22 offen sc1
    buffer_load_dword v0, v63, s[4:7], s22 offen offset:64 sc1
    s_mov_b32 exec_hi, -1
ppf_12:
    v_add_u32 v24, 18560, v7
    v_add_u32 v25, 37120, v7
    v_add_u32 v26, 55680, v7
    s_cmp_eq_u32 s16, 63
    s_setprio 3
    s_barrier
    s_cbranch_scc1 ptail_9
    ds_read2_b32 v[16:17], v7 offset0:0 offset1:2
    ds_read2_b32 v[18:19], v24 offset0:0 offset1:2
    ds_read2_b32 v[20:21], v25 offset0:0 offset1:2
    ds_read2_b32 v[22:23], v26 offset0:0 offset1:2
    s_waitcnt lgkmcnt(2)
    v_add_f32 v16, v16, v18
    v_add_f32 v17, v17, v19
    s_waitcnt lgkmcnt(0)
    v_add_f32 v20, v20, v22
    v_add_f32 v21, v21, v23
    v_add_f32 v16, v16, v20
    v_add_f32 v17, v17, v21
    v_cvt_pk_bf16_f32 v16, v16, v17
    v_min_u32 v16, -2, v16
    buffer_store_dword v16, v2, s[4:7], s21 offen sc1
    buffer_store_dword v10, v2, s[4:7], s24 offen sc1
    s_cmp_eq_u32 s15, 0
    s_cbranch_scc1 ploop_7_pnd
    s_sleep 6
    s_nop 8
    buffer_load_dwordx4 v[16:19], v12, s[4:7], s30 offen sc1
    buffer_load_dword v15, off, s[4:7], s58 sc1
    s_add_u32 s25, s19, s14
    v_mov_b32 v20, -1
    v_mov_b32 v21, -1
    v_mov_b32 v22, -1
    v_mov_b32 v23, -1
    buffer_store_dwordx4 v[20:23], v1, s[4:7], s25 offen
    buffer_store_dwordx2 v[20:21], v54, s[4:7], s25 offen offset:1024
    s_mov_b32 m0, 124928
    s_nop 0
    buffer_load_dwordx4 v1, s[4:7], s69 offen offset:0 sc1 lds
    buffer_load_dwordx4 v1, s[4:7], s69 offen offset:1024 sc1 lds
    buffer_load_dwordx4 v1, s[4:7], s69 offen offset:2048 sc1 lds
    buffer_load_dwordx4 v1, s[4:7], s69 offen offset:3072 sc1 lds
    s_add_u32 s69, s69, 262144
    s_add_u32 m0, s53, 0
    s_add_u32 s22, s52, 0
    buffer_load_dwordx4 v1, s[4:7], s22 offen offset:0 sc1 lds
    buffer_load_dwordx4 v1, s[4:7], s22 offen offset:1024 sc1 lds
    buffer_load_dwordx4 v1, s[4:7], s22 offen offset:2048 sc1 lds
    buffer_load_dwordx4 v1, s[4:7], s22 offen offset:3072 sc1 lds
    s_add_u32 m0, s53, 4096
    s_add_u32 s22, s52, 131072
    buffer_load_dwordx4 v1, s[4:7], s22 offen offset:0 sc1 lds
    buffer_load_dwordx4 v1, s[4:7], s22 offen offset:1024 sc1 lds
    buffer_load_dwordx4 v1, s[4:7], s22 offen offset:2048 sc1 lds
    buffer_load_dwordx4 v1, s[4:7], s22 offen offset:3072 sc1 lds
    s_add_u32 s52, s52, 262144
    s_add_u32 s22, s16, 1
    v_mov_b32 v60, s22
    s_waitcnt vmcnt(15) lgkmcnt(0)
    s_branch ploop_7_pchk
ploop_7_pnd:
    s_sleep 6
    s_nop 8
    buffer_load_dwordx4 v[16:19], v12, s[4:7], s30 offen sc1
    buffer_load_dword v15, off, s[4:7], s58 sc1
    s_add_u32 s22, s16, 1
    v_mov_b32 v60, s22
    s_waitcnt vmcnt(1) lgkmcnt(0)
    s_branch ploop_7_pchk
ploop_7_pagain:
    s_waitcnt vmcnt(1) lgkmcnt(0)
ploop_7_pchk:
    v_mfma_f32_16x16x32_bf16 v[20:23], v[56:59], v[16:19], 0
    v_max3_u32 v9, v16, v17, v18
    v_max_u32 v9, v9, v19
    v_cmp_eq_u32 vcc, -1, v9
    s_cbranch_vccnz prp_11
ploop_7_pgo:
    s_nop 3
    v_add_f32_dpp v20, v20, v20 row_ror:8 row_mask:0xf bank_mask:0xf
    v_add_f32_dpp v21, v21, v21 row_ror:8 row_mask:0xf bank_mask:0xf
    v_add_f32_dpp v22, v22, v22 row_ror:8 row_mask:0xf bank_mask:0xf
    v_add_f32_dpp v23, v23, v23 row_ror:8 row_mask:0xf bank_mask:0xf
    v_cvt_pk_bf16_f32 v20, v20, v21
    v_cvt_pk_bf16_f32 v21, v22, v23
    s_mov_b32 exec_hi, 0
    v_min_u32 v20, -2, v20
    v_min_u32 v21, -2, v21
    s_mov_b32 exec_lo, 0x00ff00ff
    buffer_store_dwordx2 v[20:21], v13, s[4:7], s23 offen
    s_mov_b64 exec, -1
    s_add_u32 s22, s19, s32
    s_add_u32 s25, s20, s36
    buffer_store_dword v10, v2, s[4:7], s22 offen
    s_mov_b32 exec_hi, 0
    buffer_store_dword v10, v3, s[4:7], s22 offen
    s_mov_b32 exec_lo, 0x00ff00ff
    buffer_store_dwordx2 v[10:11], v13, s[4:7], s25 offen
    s_mov_b64 exec, -1
    s_add_u32 s16, s16, 1
    s_mov_b32 s17, s18
    s_mov_b32 s18, s19
    s_mov_b32 s19, s20
    s_add_u32 s20, s20, 262144
    s_cmp_eq_u32 s20, 210763776
    s_cselect_b32 s20, 209715200, s20
    s_branch ploop_7
prm_10_gt:
gate_13:
    v_readfirstlane_b32 s25, v15
    s_cmp_ge_u32 s25, s59
    s_cbranch_scc1 gate_13_ok
    s_sleep 8
    buffer_load_dword v15, off, s[4:7], s58 sc1
    s_waitcnt vmcnt(0)
    s_sub_u32 s26, s26, 1
    s_cbranch_scc0 gate_13
    s_mov_b32 s26, 0
gate_13_ok:
    s_branch prm_10_gtb
prm_10_0:
    s_sub_u32 s26, s26, 1
    s_cbranch_scc1 prm_10_0_g
    buffer_load_dwordx4 v[16:19], v1, s[4:7], s21 offen offset:0 sc1
    buffer_load_dwordx4 v[20:23], v1, s[4:7], s21 offen offset:1024 sc1
    buffer_load_dwordx4 v[24:27], v1, s[4:7], s21 offen offset:2048 sc1
    buffer_load_dwordx4 v[28:31], v1, s[4:7], s21 offen offset:3072 sc1
    s_waitcnt vmcnt(3)
    v_max3_u32 v9, v16, v17, v18
    v_max_u32 v9, v9, v19
    v_cmp_eq_u32 vcc, -1, v9
    s_cbranch_vccnz prm_10_0
    s_branch prm_10_0ok
prm_10_0_g:
    s_mov_b32 s26, 0
    s_waitcnt vmcnt(0)
    s_branch prm_10_0ok
prm_10_1:
    s_sub_u32 s26, s26, 1
    s_cbranch_scc1 prm_10_1_g
    buffer_load_dwordx4 v[20:23], v1, s[4:7], s21 offen offset:1024 sc1
    buffer_load_dwordx4 v[24:27], v1, s[4:7], s21 offen offset:2048 sc1
    buffer_load_dwordx4 v[28:31], v1, s[4:7], s21 offen offset:3072 sc1
    s_waitcnt vmcnt(2)
    v_max3_u32 v9, v20, v21, v22
    v_max_u32 v9, v9, v23
    v_cmp_eq_u32 vcc, -1, v9
    s_cbranch_vccnz prm_10_1
    s_branch prm_10_1ok
prm_10_1_g:
    s_mov_b32 s26, 0
    s_waitcnt vmcnt(0)
    s_branch prm_10_1ok
prm_10_2:
    s_sub_u32 s26, s26, 1
    s_cbranch_scc1 prm_10_2_g
    buffer_load_dwordx4 v[24:27], v1, s[4:7], s21 offen offset:2048 sc1
    buffer_load_dwordx4 v[28:31], v1, s[4:7], s21 offen offset:3072 sc1
    s_waitcnt vmcnt(1)
    v_max3_u32 v9, v24, v25, v26
    v_max_u32 v9, v9, v27
    v_cmp_eq_u32 vcc, -1, v9
    s_cbranch_vccnz prm_10_2
    s_branch prm_10_2ok
prm_10_2_g:
    s_mov_b32 s26, 0
    s_waitcnt vmcnt(0)
    s_branch prm_10_2ok
prm_10_3:
    s_sub_u32 s26, s26, 1
    s_cbranch_scc1 prm_10_3_g
    buffer_load_dwordx4 v[28:31], v1, s[4:7], s21 offen offset:3072 sc1
    s_waitcnt vmcnt(0)
    v_max3_u32 v9, v28, v29, v30
    v_max_u32 v9, v9, v31
    v_cmp_eq_u32 vcc, -1, v9
    s_cbranch_vccnz prm_10_3
    s_branch prm_10_3ok
prm_10_3_g:
    s_mov_b32 s26, 0
    s_waitcnt vmcnt(0)
    s_branch prm_10_3ok
prm_10_d:
gate_14:
    v_readfirstlane_b32 s25, v15
    s_cmp_ge_u32 s25, s59
    s_cbranch_scc1 gate_14_ok
    s_sleep 8
    buffer_load_dword v15, off, s[4:7], s58 sc1
    s_waitcnt vmcnt(0)
    s_sub_u32 s26, s26, 1
    s_cbranch_scc0 gate_14
    s_mov_b32 s26, 0
gate_14_ok:
    ds_write_b32 v14, v60
    v_add_f32 v32, v32, v33
    v_add_f32 v34, v34, v35
    ds_write2_b32 v4, v32, v34 offset0:0 offset1:104
    v_add_f32 v36, v36, v37
    v_add_f32 v38, v38, v39
    ds_write2_b32 v4, v36, v38 offset0:16 offset1:120
    v_add_f32 v40, v40, v41
    v_add_f32 v42, v42, v43
    ds_write2_b32 v4, v40, v42 offset0:32 offset1:136
    v_add_f32 v44, v44, v45
    v_add_f32 v46, v46, v47
    ds_write2_b32 v4, v44, v46 offset0:48 offset1:152
    v_add_f32 v48, v48, v49
    v_add_f32 v50, v50, v51
    ds_write2_b32 v4, v48, v50 offset0:64 offset1:168
    v_add_f32 v52, v52, v53
    v_add_f32 v54, v54, v55
    ds_write2_b32 v4, v52, v54 offset0:80 offset1:184
    s_branch pnc_8_done
prp_11:
    s_sub_u32 s26, s26, 1
    s_nop 3
    s_cbranch_scc1 prp_11_g
    buffer_load_dwordx4 v[16:19], v12, s[4:7], s30 offen sc1
    buffer_load_dword v15, off, s[4:7], s58 sc1
    s_branch ploop_7_pagain
prp_11_g:
    s_mov_b32 s26, 0
    s_branch ploop_7_pgo
ploop_7_zr:
    s_sub_u32 s26, s26, 1
    s_cbranch_scc1 ploop_7_zg
    buffer_load_dwordx4 v[32:35], v1, s[4:7], s22 offen offset:0 sc1
    buffer_load_dwordx4 v[36:39], v1, s[4:7], s22 offen offset:1024 sc1
    buffer_load_dwordx4 v[40:43], v1, s[4:7], s22 offen offset:2048 sc1
    buffer_load_dwordx4 v[44:47], v1, s[4:7], s22 offen offset:3072 sc1
    s_branch ploop_7_za
ploop_7_zg:
    s_mov_b32 s26, 0
    s_branch ploop_7_zok
ptail_9:
    s_cmp_eq_u32 s15, 0
    s_cbranch_scc1 ptail_9_nd
    s_nop 0
ptail_9_nd:
    s_barrier
    v_add_u32 v55, s68, v61
    ds_read_b128 v[24:27], v55 offset:0
    ds_read_b128 v[28:31], v55 offset:1024
    ds_read_b128 v[32:35], v55 offset:18560
    ds_read_b128 v[36:39], v55 offset:19584
    ds_read_b128 v[40:43], v55 offset:37120
    ds_read_b128 v[44:47], v55 offset:38144
    ds_read_b128 v[48:51], v55 offset:55680
    ds_read_b128 v[52:55], v55 offset:56704
    s_waitcnt lgkmcnt(4)
    v_add_f32 v24, v24, v32
    v_add_f32 v25, v25, v33
    v_add_f32 v26, v26, v34
    v_add_f32 v27, v27, v35
    v_add_f32 v28, v28, v36
    v_add_f32 v29, v29, v37
    v_add_f32 v30, v30, v38
    v_add_f32 v31, v31, v39
    s_waitcnt lgkmcnt(0)
    v_add_f32 v40, v40, v48
    v_add_f32 v41, v41, v49
    v_add_f32 v42, v42, v50
    v_add_f32 v43, v43, v51
    v_add_f32 v44, v44, v52
    v_add_f32 v45, v45, v53
    v_add_f32 v46, v46, v54
    v_add_f32 v47, v47, v55
    v_add_f32 v24, v24, v40
    v_add_f32 v25, v25, v41
    v_add_f32 v26, v26, v42
    v_add_f32 v27, v27, v43
    v_add_f32 v28, v28, v44
    v_add_f32 v29, v29, v45
    v_add_f32 v30, v30, v46
    v_add_f32 v31, v31, v47
    v_cvt_pk_bf16_f32 v24, v24, v25
    v_cvt_pk_bf16_f32 v25, v26, v27
    v_cvt_pk_bf16_f32 v26, v28, v29
    v_cvt_pk_bf16_f32 v27, v30, v31
    v_min_u32 v24, -2, v24
    v_min_u32 v25, -2, v25
    v_min_u32 v26, -2, v26
    v_min_u32 v27, -2, v27
    buffer_store_dwordx4 v[24:27], v1, s[4:7], s37 offen sc1
    s_branch k_end
ch_p_slow:
    v_mov_b32 v32, 0
    v_mov_b32 v33, 0
    v_mov_b32 v34, 0
    v_mov_b32 v35, 0
    v_mov_b32 v36, 0
    v_mov_b32 v37, 0
    v_mov_b32 v38, 0
    v_mov_b32 v39, 0
    v_mov_b32 v40, 0
    v_mov_b32 v41, 0
    v_mov_b32 v42, 0
    v_mov_b32 v43, 0
    v_mov_b32 v44, 0
    v_mov_b32 v45, 0
    v_mov_b32 v46, 0
    v_mov_b32 v47, 0
    v_mov_b32 v48, 0
    v_mov_b32 v49, 0
    v_mov_b32 v50, 0
    v_mov_b32 v51, 0
    v_mov_b32 v52, 0
    v_mov_b32 v53, 0
    v_mov_b32 v54, 0
    v_mov_b32 v55, 0
    v_mov_b32 v0, 1.0
    s_mov_b32 exec_lo, 0xff00ff00
    s_mov_b32 exec_hi, 0xff00ff00
    v_mov_b32 v0, s47
    s_mov_b64 exec, -1
    v_mov_b32 v60, s16
    s_branch pnc_16
.p2align 6
ploop_15:
    s_add_u32 s21, s17, s33
    v_mov_b32 v32, 0
    v_mov_b32 v33, 0
    v_mov_b32 v34, 0
    v_mov_b32 v35, 0
    v_mov_b32 v36, 0
    v_mov_b32 v37, 0
    v_mov_b32 v38, 0
    v_mov_b32 v39, 0
    v_mov_b32 v40, 0
    v_mov_b32 v41, 0
    v_mov_b32 v42, 0
    v_mov_b32 v43, 0
    v_mov_b32 v44, 0
    v_mov_b32 v45, 0
    v_mov_b32 v46, 0
    v_mov_b32 v47, 0
    v_mov_b32 v48, 0
    v_mov_b32 v49, 0
    v_mov_b32 v50, 0
    v_mov_b32 v51, 0
    v_mov_b32 v52, 0
    v_mov_b32 v53, 0
    v_mov_b32 v54, 0
    v_mov_b32 v55, 0
    v_mov_b32 v0, 1.0
    s_mov_b32 exec_lo, 0xff00ff00
    s_mov_b32 exec_hi, 0xff00ff00
    v_mov_b32 v0, s47
    s_mov_b64 exec, -1
    s_nop 15
    s_nop 8
    buffer_load_dwordx4 v[16:19], v1, s[4:7], s21 offen offset:0 sc1
    s_nop 7
    buffer_load_dwordx4 v[20:23], v1, s[4:7], s21 offen offset:1024 sc1
    s_nop 7
    buffer_load_dwordx4 v[24:27], v1, s[4:7], s21 offen offset:2048 sc1
    s_nop 7
    buffer_load_dwordx4 v[28:31], v1, s[4:7], s21 offen offset:3072 sc1
    s_waitcnt vmcnt(3)
    v_max3_u32 v9, v16, v17, v18
    v_max_u32 v9, v9, v19
    v_cmp_eq_u32 vcc, -1, v9
    s_cbranch_vccnz prm_18_0
prm_18_0ok:
    v_smfmac_f32_16x16x64_bf16 v[32:35], v[16:19], v[64:71], v62
    v_smfmac_f32_16x16x64_bf16 v[36:39], v[16:19], v[72:79], v62
    v_smfmac_f32_16x16x64_bf16 v[40:43], v[16:19], v[80:87], v62
    s_waitcnt vmcnt(2)
    v_max3_u32 v9, v20, v21, v22
    v_max_u32 v9, v9, v23
    v_cmp_eq_u32 vcc, -1, v9
    v_smfmac_f32_16x16x64_bf16 v[44:47], v[16:19], v[88:95], v62
    v_smfmac_f32_16x16x64_bf16 v[48:51], v[16:19], v[96:103], v62
    v_smfmac_f32_16x16x64_bf16 v[52:55], v[16:19], v[104:111], v62
    s_cbranch_vccnz prm_18_1
prm_18_1ok:
    v_smfmac_f32_16x16x64_bf16 v[32:35], v[20:23], v[112:119], v62
    v_readfirstlane_b32 s23, v15
    v_smfmac_f32_16x16x64_bf16 v[36:39], v[20:23], v[120:127], v62
    v_smfmac_f32_16x16x64_bf16 v[40:43], v[20:23], v[128:135], v62
    s_waitcnt vmcnt(1)
    v_max3_u32 v9, v24, v25, v26
    v_max_u32 v9, v9, v27
    v_cmp_eq_u32 vcc, -1, v9
    v_smfmac_f32_16x16x64_bf16 v[44:47], v[20:23], v[136:143], v62
    v_smfmac_f32_16x16x64_bf16 v[48:51], v[20:23], v[144:151], v62
    v_smfmac_f32_16x16x64_bf16 v[52:55], v[20:23], v[152:159], v62
    s_cbranch_vccnz prm_18_2
prm_18_2ok:
    v_smfmac_f32_16x16x64_bf16 v[32:35], v[24:27], v[160:167], v62
    v_smfmac_f32_16x16x64_bf16 v[36:39], v[24:27], v[168:175], v62
    v_smfmac_f32_16x16x64_bf16 v[40:43], v[24:27], v[176:183], v62
    s_waitcnt vmcnt(0)
    v_max3_u32 v9, v28, v29, v30
    v_max_u32 v9, v9, v31
    v_cmp_eq_u32 vcc, -1, v9
    v_smfmac_f32_16x16x64_bf16 v[44:47], v[24:27], v[184:191], v62
    v_smfmac_f32_16x16x64_bf16 v[48:51], v[24:27], v[192:199], v62
    v_smfmac_f32_16x16x64_bf16 v[52:55], v[24:27], v[200:207], v62
    s_cbranch_vccnz prm_18_3
prm_18_3ok:
    v_smfmac_f32_16x16x64_bf16 v[32:35], v[28:31], v[208:215], v62
    s_cmp_lt_u32 s23, s59
    s_cbranch_scc1 prm_18_gt
prm_18_gtb:
    ds_write_b32 v14, v60
    v_smfmac_f32_16x16x64_bf16 v[36:39], v[28:31], v[216:223], v62
    v_smfmac_f32_16x16x64_bf16 v[40:43], v[28:31], v[224:231], v62
    v_smfmac_f32_16x16x64_bf16 v[44:47], v[28:31], v[232:239], v62
    v_add_f32 v32, v32, v33
    v_add_f32 v34, v34, v35
    v_smfmac_f32_16x16x64_bf16 v[48:51], v[28:31], v[240:247], v62
    v_add_f32 v36, v36, v37
    v_add_f32 v38, v38, v39
    ds_write2_b32 v4, v32, v34 offset0:0 offset1:104
    v_smfmac_f32_16x16x64_bf16 v[52:55], v[28:31], v[248:255], v62
    v_add_f32 v40, v40, v41
    v_add_f32 v42, v42, v43
    ds_write2_b32 v4, v36, v38 offset0:16 offset1:120
    v_add_f32 v44, v44, v45
    v_add_f32 v46, v46, v47
    ds_write2_b32 v4, v40, v42 offset0:32 offset1:136
    v_add_f32 v48, v48, v49
    v_add_f32 v50, v50, v51
    ds_write2_b32 v4, v44, v46 offset0:48 offset1:152
    v_add_f32 v52, v52, v53
    v_add_f32 v54, v54, v55
    ds_write2_b32 v4, v48, v50 offset0:64 offset1:168
    ds_write2_b32 v4, v52, v54 offset0:80 offset1:184
    s_branch pnc_16_done
pnc_16:
    v_smfmac_f32_16x16x64_bf16 v[32:35], v[16:19], v[64:71], v62
    v_smfmac_f32_16x16x64_bf16 v[36:39], v[16:19], v[72:79], v62
    v_smfmac_f32_16x16x64_bf16 v[40:43], v[16:19], v[80:87], v62
    v_smfmac_f32_16x16x64_bf16 v[44:47], v[16:19], v[88:95], v62
    v_smfmac_f32_16x16x64_bf16 v[48:51], v[16:19], v[96:103], v62
    v_smfmac_f32_16x16x64_bf16 v[52:55], v[16:19], v[104:111], v62
    v_smfmac_f32_16x16x64_bf16 v[32:35], v[20:23], v[112:119], v62
    v_smfmac_f32_16x16x64_bf16 v[36:39], v[20:23], v[120:127], v62
    v_smfmac_f32_16x16x64_bf16 v[40:43], v[20:23], v[128:135], v62
    v_smfmac_f32_16x16x64_bf16 v[44:47], v[20:23], v[136:143], v62
    v_smfmac_f32_16x16x64_bf16 v[48:51], v[20:23], v[144:151], v62
    v_smfmac_f32_16x16x64_bf16 v[52:55], v[20:23], v[152:159], v62
    v_smfmac_f32_16x16x64_bf16 v[32:35], v[24:27], v[160:167], v62
    v_smfmac_f32_16x16x64_bf16 v[36:39], v[24:27], v[168:175], v62
    v_smfmac_f32_16x16x64_bf16 v[40:43], v[24:27], v[176:183], v62
    v_smfmac_f32_16x16x64_bf16 v[44:47], v[24:27], v[184:191], v62
    v_smfmac_f32_16x16x64_bf16 v[48:51], v[24:27], v[192:199], v62
    v_smfmac_f32_16x16x64_bf16 v[52:55], v[24:27], v[200:207], v62
    v_smfmac_f32_16x16x64_bf16 v[32:35], v[28:31], v[208:215], v62
    ds_write_b32 v14, v60
    v_smfmac_f32_16x16x64_bf16 v[36:39], v[28:31], v[216:223], v62
    v_smfmac_f32_16x16x64_bf16 v[40:43], v[28:31], v[224:231], v62
    v_smfmac_f32_16x16x64_bf16 v[44:47], v[28:31], v[232:239], v62
    v_add_f32 v32, v32, v33
    v_add_f32 v34, v34, v35
    v_smfmac_f32_16x16x64_bf16 v[48:51], v[28:31], v[240:247], v62
    v_add_f32 v36, v36, v37
    v_add_f32 v38, v38, v39
    ds_write2_b32 v4, v32, v34 offset0:0 offset1:104
    v_smfmac_f32_16x16x64_bf16 v[52:55], v[28:31], v[248:255], v62
    v_add_f32 v40, v40, v41
    v_add_f32 v42, v42, v43
    ds_write2_b32 v4, v36, v38 offset0:16 offset1:120
    v_add_f32 v44, v44, v45
    v_add_f32 v46, v46, v47
    ds_write2_b32 v4, v40, v42 offset0:32 offset1:136
    v_add_f32 v48, v48, v49
    v_add_f32 v50, v50, v51
    ds_write2_b32 v4, v44, v46 offset0:48 offset1:152
    v_add_f32 v52, v52, v53
    v_add_f32 v54, v54, v55
    ds_write2_b32 v4, v48, v50 offset0:64 offset1:168
    ds_write2_b32 v4, v52, v54 offset0:80 offset1:184
    s_waitcnt vmcnt(0)
pnc_16_done:
    s_add_u32 s21, s17, s32
    s_add_u32 s22, s19, s32
    s_add_u32 s24, s19, s35
    s_waitcnt lgkmcnt(0)
    s_barrier
    ds_read_b64 v[32:33], v5 offset:0
    ds_read_b64 v[34:35], v5 offset:3328
    ds_read_b64 v[36:37], v5 offset:6656
    ds_read_b64 v[38:39], v5 offset:9984
    ds_read_b64 v[40:41], v6 offset:0
    ds_read_b64 v[42:43], v6 offset:3328
    ds_read_b64 v[44:45], v6 offset:6656
    ds_read_b64 v[46:47], v6 offset:9984
    s_waitcnt lgkmcnt(6)
    v_add_f32 v32, v32, v34
    v_add_f32 v33, v33, v35
    s_waitcnt lgkmcnt(4)
    v_add_f32 v36, v36, v38
    v_add_f32 v37, v37, v39
    v_add_f32 v32, v32, v36
    v_add_f32 v33, v33, v37
    v_mul_f32 v32, v32, v0
    v_mul_f32 v33, v33, v0
    v_cvt_pk_bf16_f32 v32, v32, v33
    v_min_u32 v32, -2, v32
    buffer_store_dword v32, v2, s[4:7], s21 offen sc1
    s_waitcnt lgkmcnt(2)
    v_add_f32 v40, v40, v42
    v_add_f32 v41, v41, v43
    s_waitcnt lgkmcnt(0)
    v_add_f32 v44, v44, v46
    v_add_f32 v45, v45, v47
    v_add_f32 v40, v40, v44
    v_add_f32 v41, v41, v45
    v_cvt_pk_bf16_f32 v40, v40, v41
    v_min_u32 v40, -2, v40
    s_mov_b32 exec_hi, 0
    buffer_store_dword v40, v3, s[4:7], s21 offen sc1
    s_setprio 0
    s_mov_b64 exec, -1
    s_add_u32 s21, s17, s35
    s_add_u32 s30, s17, s34
    s_add_u32 s23, s18, s36
    s_add_u32 s25, s16, 2
    s_min_u32 s25, s25, 63
    s_cmp_lt_u32 s25, 8
    s_cselect_b32 s59, 12, 24
    s_cselect_b32 s58, -4, -8
    s_and_b32 s25, s25, s58
    s_lshl_b32 s25, s25, 5
    s_add_u32 s58, s25, s60
    s_cmp_eq_u32 s15, 0
    s_cbranch_scc1 ploop_15_nd
    v_add_u32 v9, s53, v1
    v_add_u32 v0, 124928, v1
    ds_read_b128 v[16:19], v0 offset:0
    ds_read_b128 v[32:35], v9 offset:0
    ds_read_b128 v[20:23], v0 offset:1024
    ds_read_b128 v[36:39], v9 offset:1024
    ds_read_b128 v[24:27], v0 offset:2048
    ds_read_b128 v[40:43], v9 offset:2048
    ds_read_b128 v[28:31], v0 offset:3072
    ds_read_b128 v[44:47], v9 offset:3072
    s_add_u32 s22, s17, s61
    s_waitcnt lgkmcnt(6)
    v_mfma_f32_16x16x32_bf16 v[48:51], v[32:35], v[16:19], 0
    ds_read_b128 v[32:35], v9 offset:4096
    s_waitcnt lgkmcnt(5)
    v_mfma_f32_16x16x32_bf16 v[48:51], v[36:39], v[20:23], v[48:51]
    ds_read_b128 v[36:39], v9 offset:5120
    s_waitcnt lgkmcnt(4)
    v_mfma_f32_16x16x32_bf16 v[48:51], v[40:43], v[24:27], v[48:51]
    ds_read_b128 v[40:43], v9 offset:6144
    s_waitcnt lgkmcnt(3)
    v_mfma_f32_16x16x32_bf16 v[48:51], v[44:47], v[28:31], v[48:51]
    ds_read_b128 v[44:47], v9 offset:7168
    s_waitcnt lgkmcnt(3)
    v_mfma_f32_16x16x32_bf16 v[52:55], v[32:35], v[16:19], 0
    s_waitcnt lgkmcnt(2)
    v_mfma_f32_16x16x32_bf16 v[52:55], v[36:39], v[20:23], v[52:55]
    s_waitcnt lgkmcnt(1)
    v_mfma_f32_16x16x32_bf16 v[52:55], v[40:43], v[24:27], v[52:55]
    s_waitcnt lgkmcnt(0)
    v_mfma_f32_16x16x32_bf16 v[52:55], v[44:47], v[28:31], v[52:55]
    buffer_load_dwordx4 v[32:35], v1, s[4:7], s22 offen offset:0 sc1
    buffer_load_dwordx4 v[36:39], v1, s[4:7], s22 offen offset:1024 sc1
    buffer_load_dwordx4 v[40:43], v1, s[4:7], s22 offen offset:2048 sc1
    buffer_load_dwordx4 v[44:47], v1, s[4:7], s22 offen offset:3072 sc1
    v_mov_b32 v60, 0xff61b1e6
    s_nop 2
    v_cndmask_b32 v48, v48, v60, s[38:39]
    v_cndmask_b32 v49, v49, v60, s[40:41]
    v_cndmask_b32 v50, v50, v60, s[42:43]
    v_cndmask_b32 v51, v51, v60, s[44:45]
    v_cndmask_b32 v52, v52, v60, s[48:49]
    v_cndmask_b32 v53, v53, v60, s[50:51]
    v_cndmask_b32 v54, v54, v60, s[54:55]
    v_cndmask_b32 v55, v55, v60, s[56:57]
    v_max3_f32 v0, v48, v49, v50
    v_max3_f32 v9, v51, v52, v53
    v_max3_f32 v0, v0, v54, v55
    v_max_f32 v0, v0, v9
    v_mov_b32 v9, v0
    s_nop 1
    v_permlane16_swap_b32 v9, v0
    v_max_f32 v0, v0, v9
    v_mov_b32 v9, v0
    s_nop 1
    v_permlane32_swap_b32 v9, v0
    v_max_f32 v0, v0, v9
    v_mul_f32 v0, s47, v0
    v_fma_f32 v48, v48, s47, -v0
    v_fma_f32 v49, v49, s47, -v0
    v_fma_f32 v50, v50, s47, -v0
    v_fma_f32 v51, v51, s47, -v0
    v_fma_f32 v52, v52, s47, -v0
    v_fma_f32 v53, v53, s47, -v0
    v_fma_f32 v54, v54, s47, -v0
    v_fma_f32 v55, v55, s47, -v0
    v_exp_f32 v48, v48
    v_exp_f32 v49, v49
    v_exp_f32 v50, v50
    v_exp_f32 v51, v51
    v_exp_f32 v52, v52
    v_exp_f32 v53, v53
    v_exp_f32 v54, v54
    v_exp_f32 v55, v55
    v_add_f32 v15, v48, v49
    v_add_f32 v15, v15, v50
    v_add_f32 v15, v15, v51
    v_add_f32 v15, v15, v52
    v_add_f32 v15, v15, v53
    v_add_f32 v15, v15, v54
    v_add_f32 v15, v15, v55
ploop_15_za:
    s_waitcnt vmcnt(0)
    v_max3_u32 v9, v32, v33, v34
    v_max3_u32 v9, v9, v35, v36
    v_max3_u32 v9, v9, v37, v38
    v_max3_u32 v9, v9, v39, v40
    v_max3_u32 v9, v9, v41, v42
    v_max3_u32 v9, v9, v43, v44
    v_max3_u32 v9, v9, v45, v46
    v_max_u32 v9, v9, v47
    v_cmp_eq_u32 vcc, -1, v9
    s_cbranch_vccnz ploop_15_zr
ploop_15_zok:
    v_mfma_f32_16x16x32_bf16 v[56:59], v[32:35], v[16:19], 0
    v_mfma_f32_16x16x32_bf16 v[56:59], v[36:39], v[20:23], v[56:59]
    v_mfma_f32_16x16x32_bf16 v[56:59], v[40:43], v[24:27], v[56:59]
    v_mfma_f32_16x16x32_bf16 v[56:59], v[44:47], v[28:31], v[56:59]
    s_add_u32 s22, s17, s14
    s_nop 6
    v_max_f32 v60, v56, v57
    v_mov_b32 v9, v60
    s_nop 1
    v_permlane16_swap_b32 v9, v60
    v_max_f32 v60, v60, v9
    v_mov_b32 v9, v60
    s_nop 1
    v_permlane32_swap_b32 v9, v60
    v_max_f32 v60, v60, v9
    v_mul_f32 v60, s47, v60
    v_max_f32 v58, v60, v0
    v_sub_f32 v60, v0, v58
    v_fma_f32 v56, v56, s47, -v58
    v_fma_f32 v57, v57, s47, -v58
    v_exp_f32 v60, v60
    v_exp_f32 v56, v56
    v_exp_f32 v57, v57
    v_fma_f32 v15, v15, v60, v56
    v_add_f32 v15, v15, v57
    v_mov_b32 v9, v15
    s_nop 1
    v_permlane16_swap_b32 v9, v15
    v_add_f32 v15, v15, v9
    v_mov_b32 v9, v15
    s_nop 1
    v_permlane32_swap_b32 v9, v15
    v_add_f32 v15, v15, v9
    v_rcp_f32 v15, v15
    s_add_u32 s25, s19, s14
    v_mul_f32 v56, v56, v15
    v_mul_f32 v57, v57, v15
    v_mul_f32 v60, v60, v15
    v_mul_f32 v48, v48, v60
    v_mul_f32 v49, v49, v60
    v_mul_f32 v50, v50, v60
    v_mul_f32 v51, v51, v60
    v_mul_f32 v52, v52, v60
    v_mul_f32 v53, v53, v60
    v_mul_f32 v54, v54, v60
    v_mul_f32 v55, v55, v60
    v_cvt_pk_bf16_f32 v48, v48, v49
    v_cvt_pk_bf16_f32 v49, v50, v51
    v_cvt_pk_bf16_f32 v50, v52, v53
    v_cvt_pk_bf16_f32 v51, v54, v55
    v_min_u32 v48, -2, v48
    v_min_u32 v49, -2, v49
    v_min_u32 v50, -2, v50
    v_min_u32 v51, -2, v51
    v_lshlrev_b32 v54, 1, v8
    v_add_u32 v55, 14336, v1
    v_mov_b32 v53, 1.0
    v_cvt_pk_bf16_f32 v52, v56, v57
    v_min_u32 v53, -2, v53
    v_min_u32 v52, -2, v52
    buffer_store_dwordx4 v[48:51], v1, s[4:7], s22 offen sc1
    buffer_store_dwordx2 v[52:53], v54, s[4:7], s22 offen offset:1024 sc1
    ds_read_b128 v[56:59], v55
    s_branch ploop_15_nd2
ploop_15_nd:
    s_cmp_eq_u32 s16, 0
    s_cbranch_scc1 ploop_15_ns
    s_cmp_eq_u32 s31, 0
    s_cbranch_scc1 ploop_15_n2
    s_add_u32 s25, s68, s46
    v_add_u32 v55, s25, v61
    ds_read_b128 v[24:27], v55 offset:0
    ds_read_b128 v[28:31], v55 offset:1024
    ds_read_b128 v[32:35], v55 offset:18560
    ds_read_b128 v[36:39], v55 offset:19584
    ds_read_b128 v[40:43], v55 offset:37120
    ds_read_b128 v[44:47], v55 offset:38144
    ds_read_b128 v[48:51], v55 offset:55680
    ds_read_b128 v[52:55], v55 offset:56704
    s_waitcnt lgkmcnt(4)
    v_add_f32 v24, v24, v32
    v_add_f32 v25, v25, v33
    v_add_f32 v26, v26, v34
    v_add_f32 v27, v27, v35
    v_add_f32 v28, v28, v36
    v_add_f32 v29, v29, v37
    v_add_f32 v30, v30, v38
    v_add_f32 v31, v31, v39
    s_waitcnt lgkmcnt(0)
    v_add_f32 v40, v40, v48
    v_add_f32 v41, v41, v49
    v_add_f32 v42, v42, v50
    v_add_f32 v43, v43, v51
    v_add_f32 v44, v44, v52
    v_add_f32 v45, v45, v53
    v_add_f32 v46, v46, v54
    v_add_f32 v47, v47, v55
    v_add_f32 v24, v24, v40
    v_add_f32 v25, v25, v41
    v_add_f32 v26, v26, v42
    v_add_f32 v27, v27, v43
    v_add_f32 v28, v28, v44
    v_add_f32 v29, v29, v45
    v_add_f32 v30, v30, v46
    v_add_f32 v31, v31, v47
    v_cvt_pk_bf16_f32 v24, v24, v25
    v_cvt_pk_bf16_f32 v25, v26, v27
    v_cvt_pk_bf16_f32 v26, v28, v29
    v_cvt_pk_bf16_f32 v27, v30, v31
    v_min_u32 v24, -2, v24
    v_min_u32 v25, -2, v25
    v_min_u32 v26, -2, v26
    v_min_u32 v27, -2, v27
    v_mov_b32 v16, v24
    v_mov_b32 v17, v25
    v_mov_b32 v18, v26
    v_mov_b32 v19, v27
ploop_15_n2:
    v_add_u32 v55, s68, v61
    ds_read_b128 v[24:27], v55 offset:0
    ds_read_b128 v[28:31], v55 offset:1024
    ds_read_b128 v[32:35], v55 offset:18560
    ds_read_b128 v[36:39], v55 offset:19584
    ds_read_b128 v[40:43], v55 offset:37120
    ds_read_b128 v[44:47], v55 offset:38144
    ds_read_b128 v[48:51], v55 offset:55680
    ds_read_b128 v[52:55], v55 offset:56704
    s_waitcnt lgkmcnt(4)
    v_add_f32 v24, v24, v32
    v_add_f32 v25, v25, v33
    v_add_f32 v26, v26, v34
    v_add_f32 v27, v27, v35
    v_add_f32 v28, v28, v36
    v_add_f32 v29, v29, v37
    v_add_f32 v30, v30, v38
    v_add_f32 v31, v31, v39
    s_waitcnt lgkmcnt(0)
    v_add_f32 v40, v40, v48
    v_add_f32 v41, v41, v49
    v_add_f32 v42, v42, v50
    v_add_f32 v43, v43, v51
    v_add_f32 v44, v44, v52
    v_add_f32 v45, v45, v53
    v_add_f32 v46, v46, v54
    v_add_f32 v47, v47, v55
    v_add_f32 v24, v24, v40
    v_add_f32 v25, v25, v41
    v_add_f32 v26, v26, v42
    v_add_f32 v27, v27, v43
    v_add_f32 v28, v28, v44
    v_add_f32 v29, v29, v45
    v_add_f32 v30, v30, v46
    v_add_f32 v31, v31, v47
    v_cvt_pk_bf16_f32 v24, v24, v25
    v_cvt_pk_bf16_f32 v25, v26, v27
    v_cvt_pk_bf16_f32 v26, v28, v29
    v_cvt_pk_bf16_f32 v27, v30, v31
    v_min_u32 v24, -2, v24
    v_min_u32 v25, -2, v25
    v_min_u32 v26, -2, v26
    v_min_u32 v27, -2, v27
ploop_15_ns:
ploop_15_flag:
    ds_read_b32 v9, v14 offset:16
    s_waitcnt lgkmcnt(0)
    v_readfirstlane_b32 s25, v9
    s_cmp_eq_u32 s25, s16
    s_cbranch_scc0 ploop_15_flag
    s_add_u32 m0, s53, 0
    s_add_u32 s22, s52, 0
    buffer_load_dwordx4 v1, s[4:7], s22 offen offset:0 sc1 lds
    buffer_load_dwordx4 v1, s[4:7], s22 offen offset:1024 sc1 lds
    buffer_load_dwordx4 v1, s[4:7], s22 offen offset:2048 sc1 lds
    buffer_load_dwordx4 v1, s[4:7], s22 offen offset:3072 sc1 lds
    s_add_u32 m0, s53, 4096
    s_add_u32 s22, s52, 131072
    buffer_load_dwordx4 v1, s[4:7], s22 offen offset:0 sc1 lds
    buffer_load_dwordx4 v1, s[4:7], s22 offen offset:1024 sc1 lds
    buffer_load_dwordx4 v1, s[4:7], s22 offen offset:2048 sc1 lds
    buffer_load_dwordx4 v1, s[4:7], s22 offen offset:3072 sc1 lds
    s_add_u32 s52, s52, 262144
    s_cmp_eq_u32 s16, 0
    s_cbranch_scc1 ploop_15_nd2
    buffer_store_dwordx4 v[24:27], v1, s[4:7], s37 offen sc1
    s_cmp_eq_u32 s31, 0
    s_cbranch_scc1 ploop_15_nd2
    s_add_u32 s25, s37, s27
    buffer_store_dwordx4 v[16:19], v1, s[4:7], s25 offen sc1
ploop_15_nd2:
    s_cmp_eq_u32 s16, 0
    s_cbranch_scc1 ploop_15_nn
    s_add_u32 s37, s37, 65536
    s_xor_b32 s68, s68, 8192
ploop_15_nn:
    s_cmp_lg_u32 s3, 2
    s_cbranch_scc1 ppf_20
    s_lshl_b32 s22, s16, 18
    s_mov_b32 exec_hi, 0xffff
    buffer_load_dword v0, v63, s[4:7], s22 offen sc1
    buffer_load_dword v0, v63, s[4:7], s22 offen offset:64 sc1
    s_mov_b32 exec_hi, -1
ppf_20:
    v_add_u32 v24, 18560, v7
    v_add_u32 v25, 37120, v7
    v_add_u32 v26, 55680, v7
    s_cmp_eq_u32 s16, 63
    s_setprio 3
    s_barrier
    s_cbranch_scc1 ptail_17
    ds_read2_b32 v[16:17], v7 offset0:0 offset1:2
    ds_read2_b32 v[18:19], v24 offset0:0 offset1:2
    ds_read2_b32 v[20:21], v25 offset0:0 offset1:2
    ds_read2_b32 v[22:23], v26 offset0:0 offset1:2
    s_waitcnt lgkmcnt(2)
    v_add_f32 v16, v16, v18
    v_add_f32 v17, v17, v19
    s_waitcnt lgkmcnt(0)
    v_add_f32 v20, v20, v22
    v_add_f32 v21, v21, v23
    v_add_f32 v16, v16, v20
    v_add_f32 v17, v17, v21
    v_cvt_pk_bf16_f32 v16, v16, v17
    v_min_u32 v16, -2, v16
    buffer_store_dword v16, v2, s[4:7], s21 offen sc1
    buffer_store_dword v10, v2, s[4:7], s24 offen sc1
    s_cmp_eq_u32 s15, 0
    s_cbranch_scc1 ploop_15_pnd
    s_sleep 6
    s_nop 8
    buffer_load_dwordx4 v[16:19], v12, s[4:7], s30 offen sc1
    buffer_load_dword v15, off, s[4:7], s58 sc1
    s_add_u32 s25, s19, s14
    v_mov_b32 v20, -1
    v_mov_b32 v21, -1
    v_mov_b32 v22, -1
    v_mov_b32 v23, -1
    buffer_store_dwordx4 v[20:23], v1, s[4:7], s25 offen sc1
    buffer_store_dwordx2 v[20:21], v54, s[4:7], s25 offen offset:1024 sc1
    s_mov_b32 m0, 124928
    s_nop 0
    buffer_load_dwordx4 v1, s[4:7], s69 offen offset:0 sc1 lds
    buffer_load_dwordx4 v1, s[4:7], s69 offen offset:1024 sc1 lds
    buffer_load_dwordx4 v1, s[4:7], s69 offen offset:2048 sc1 lds
    buffer_load_dwordx4 v1, s[4:7], s69 offen offset:3072 sc1 lds
    s_add_u32 s69, s69, 262144
    s_add_u32 m0, s53, 0
    s_add_u32 s22, s52, 0
    buffer_load_dwordx4 v1, s[4:7], s22 offen offset:0 sc1 lds
    buffer_load_dwordx4 v1, s[4:7], s22 offen offset:1024 sc1 lds
    buffer_load_dwordx4 v1, s[4:7], s22 offen offset:2048 sc1 lds
    buffer_load_dwordx4 v1, s[4:7], s22 offen offset:3072 sc1 lds
    s_add_u32 m0, s53, 4096
    s_add_u32 s22, s52, 131072
    buffer_load_dwordx4 v1, s[4:7], s22 offen offset:0 sc1 lds
    buffer_load_dwordx4 v1, s[4:7], s22 offen offset:1024 sc1 lds
    buffer_load_dwordx4 v1, s[4:7], s22 offen offset:2048 sc1 lds
    buffer_load_dwordx4 v1, s[4:7], s22 offen offset:3072 sc1 lds
    s_add_u32 s52, s52, 262144
    s_add_u32 s22, s16, 1
    v_mov_b32 v60, s22
    s_waitcnt vmcnt(15) lgkmcnt(0)
    s_branch ploop_15_pchk
ploop_15_pnd:
    s_sleep 6
    s_nop 8
    buffer_load_dwordx4 v[16:19], v12, s[4:7], s30 offen sc1
    buffer_load_dword v15, off, s[4:7], s58 sc1
    s_add_u32 s22, s16, 1
    v_mov_b32 v60, s22
    s_waitcnt vmcnt(1) lgkmcnt(0)
    s_branch ploop_15_pchk
ploop_15_pagain:
    s_waitcnt vmcnt(1) lgkmcnt(0)
ploop_15_pchk:
    v_mfma_f32_16x16x32_bf16 v[20:23], v[56:59], v[16:19], 0
    v_max3_u32 v9, v16, v17, v18
    v_max_u32 v9, v9, v19
    v_cmp_eq_u32 vcc, -1, v9
    s_cbranch_vccnz prp_19
ploop_15_pgo:
    s_nop 3
    v_add_f32_dpp v20, v20, v20 row_ror:8 row_mask:0xf bank_mask:0xf
    v_add_f32_dpp v21, v21, v21 row_ror:8 row_mask:0xf bank_mask:0xf
    v_add_f32_dpp v22, v22, v22 row_ror:8 row_mask:0xf bank_mask:0xf
    v_add_f32_dpp v23, v23, v23 row_ror:8 row_mask:0xf bank_mask:0xf
    v_cvt_pk_bf16_f32 v20, v20, v21
    v_cvt_pk_bf16_f32 v21, v22, v23
    s_mov_b32 exec_hi, 0
    v_min_u32 v20, -2, v20
    v_min_u32 v21, -2, v21
    s_mov_b32 exec_lo, 0x00ff00ff
    buffer_store_dwordx2 v[20:21], v13, s[4:7], s23 offen sc1
    s_mov_b64 exec, -1
    s_add_u32 s22, s19, s32
    s_add_u32 s25, s20, s36
    buffer_store_dword v10, v2, s[4:7], s22 offen sc1
    s_mov_b32 exec_hi, 0
    buffer_store_dword v10, v3, s[4:7], s22 offen sc1
    s_mov_b32 exec_lo, 0x00ff00ff
    buffer_store_dwordx2 v[10:11], v13, s[4:7], s25 offen sc1
    s_mov_b64 exec, -1
    s_add_u32 s16, s16, 1
    s_mov_b32 s17, s18
    s_mov_b32 s18, s19
    s_mov_b32 s19, s20
    s_add_u32 s20, s20, 262144
    s_cmp_eq_u32 s20, 210763776
    s_cselect_b32 s20, 209715200, s20
    s_branch ploop_15
prm_18_gt:
gate_21:
    v_readfirstlane_b32 s25, v15
    s_cmp_ge_u32 s25, s59
    s_cbranch_scc1 gate_21_ok
    s_sleep 8
    buffer_load_dword v15, off, s[4:7], s58 sc1
    s_waitcnt vmcnt(0)
    s_sub_u32 s26, s26, 1
    s_cbranch_scc0 gate_21
    s_mov_b32 s26, 0
gate_21_ok:
    s_branch prm_18_gtb
prm_18_0:
    s_sub_u32 s26, s26, 1
    s_cbranch_scc1 prm_18_0_g
    buffer_load_dwordx4 v[16:19], v1, s[4:7], s21 offen offset:0 sc1
    buffer_load_dwordx4 v[20:23], v1, s[4:7], s21 offen offset:1024 sc1
    buffer_load_dwordx4 v[24:27], v1, s[4:7], s21 offen offset:2048 sc1
    buffer_load_dwordx4 v[28:31], v1, s[4:7], s21 offen offset:3072 sc1
    s_waitcnt vmcnt(3)
    v_max3_u32 v9, v16, v17, v18
    v_max_u32 v9, v9, v19
    v_cmp_eq_u32 vcc, -1, v9
    s_cbranch_vccnz prm_18_0
    s_branch prm_18_0ok
prm_18_0_g:
    s_mov_b32 s26, 0
    s_waitcnt vmcnt(0)
    s_branch prm_18_0ok
prm_18_1:
    s_sub_u32 s26, s26, 1
    s_cbranch_scc1 prm_18_1_g
    buffer_load_dwordx4 v[20:23], v1, s[4:7], s21 offen offset:1024 sc1
    buffer_load_dwordx4 v[24:27], v1, s[4:7], s21 offen offset:2048 sc1
    buffer_load_dwordx4 v[28:31], v1, s[4:7], s21 offen offset:3072 sc1
    s_waitcnt vmcnt(2)
    v_max3_u32 v9, v20, v21, v22
    v_max_u32 v9, v9, v23
    v_cmp_eq_u32 vcc, -1, v9
    s_cbranch_vccnz prm_18_1
    s_branch prm_18_1ok
prm_18_1_g:
    s_mov_b32 s26, 0
    s_waitcnt vmcnt(0)
    s_branch prm_18_1ok
prm_18_2:
    s_sub_u32 s26, s26, 1
    s_cbranch_scc1 prm_18_2_g
    buffer_load_dwordx4 v[24:27], v1, s[4:7], s21 offen offset:2048 sc1
    buffer_load_dwordx4 v[28:31], v1, s[4:7], s21 offen offset:3072 sc1
    s_waitcnt vmcnt(1)
    v_max3_u32 v9, v24, v25, v26
    v_max_u32 v9, v9, v27
    v_cmp_eq_u32 vcc, -1, v9
    s_cbranch_vccnz prm_18_2
    s_branch prm_18_2ok
prm_18_2_g:
    s_mov_b32 s26, 0
    s_waitcnt vmcnt(0)
    s_branch prm_18_2ok
prm_18_3:
    s_sub_u32 s26, s26, 1
    s_cbranch_scc1 prm_18_3_g
    buffer_load_dwordx4 v[28:31], v1, s[4:7], s21 offen offset:3072 sc1
    s_waitcnt vmcnt(0)
    v_max3_u32 v9, v28, v29, v30
    v_max_u32 v9, v9, v31
    v_cmp_eq_u32 vcc, -1, v9
    s_cbranch_vccnz prm_18_3
    s_branch prm_18_3ok
prm_18_3_g:
    s_mov_b32 s26, 0
    s_waitcnt vmcnt(0)
    s_branch prm_18_3ok
prm_18_d:
gate_22:
    v_readfirstlane_b32 s25, v15
    s_cmp_ge_u32 s25, s59
    s_cbranch_scc1 gate_22_ok
    s_sleep 8
    buffer_load_dword v15, off, s[4:7], s58 sc1
    s_waitcnt vmcnt(0)
    s_sub_u32 s26, s26, 1
    s_cbranch_scc0 gate_22
    s_mov_b32 s26, 0
gate_22_ok:
    ds_write_b32 v14, v60
    v_add_f32 v32, v32, v33
    v_add_f32 v34, v34, v35
    ds_write2_b32 v4, v32, v34 offset0:0 offset1:104
    v_add_f32 v36, v36, v37
    v_add_f32 v38, v38, v39
    ds_write2_b32 v4, v36, v38 offset0:16 offset1:120
    v_add_f32 v40, v40, v41
    v_add_f32 v42, v42, v43
    ds_write2_b32 v4, v40, v42 offset0:32 offset1:136
    v_add_f32 v44, v44, v45
    v_add_f32 v46, v46, v47
    ds_write2_b32 v4, v44, v46 offset0:48 offset1:152
    v_add_f32 v48, v48, v49
    v_add_f32 v50, v50, v51
    ds_write2_b32 v4, v48, v50 offset0:64 offset1:168
    v_add_f32 v52, v52, v53
    v_add_f32 v54, v54, v55
    ds_write2_b32 v4, v52, v54 offset0:80 offset1:184
    s_branch pnc_16_done
prp_19:
    s_sub_u32 s26, s26, 1
    s_nop 3
    s_cbranch_scc1 prp_19_g
    buffer_load_dwordx4 v[16:19], v12, s[4:7], s30 offen sc1
    buffer_load_dword v15, off, s[4:7], s58 sc1
    s_branch ploop_15_pagain
prp_19_g:
    s_mov_b32 s26, 0
    s_branch ploop_15_pgo
ploop_15_zr:
    s_sub_u32 s26, s26, 1
    s_cbranch_scc1 ploop_15_zg
    buffer_load_dwordx4 v[32:35], v1, s[4:7], s22 offen offset:0 sc1
    buffer_load_dwordx4 v[36:39], v1, s[4:7], s22 offen offset:1024 sc1
    buffer_load_dwordx4 v[40:43], v1, s[4:7], s22 offen offset:2048 sc1
    buffer_load_dwordx4 v[44:47], v1, s[4:7], s22 offen offset:3072 sc1
    s_branch ploop_15_za
ploop_15_zg:
    s_mov_b32 s26, 0
    s_branch ploop_15_zok
ptail_17:
    s_cmp_eq_u32 s15, 0
    s_cbranch_scc1 ptail_17_nd
    s_nop 0
ptail_17_nd:
    s_barrier
    v_add_u32 v55, s68, v61
    ds_read_b128 v[24:27], v55 offset:0
    ds_read_b128 v[28:31], v55 offset:1024
    ds_read_b128 v[32:35], v55 offset:18560
    ds_read_b128 v[36:39], v55 offset:19584
    ds_read_b128 v[40:43], v55 offset:37120
    ds_read_b128 v[44:47], v55 offset:38144
    ds_read_b128 v[48:51], v55 offset:55680
    ds_read_b128 v[52:55], v55 offset:56704
    s_waitcnt lgkmcnt(4)
    v_add_f32 v24, v24, v32
    v_add_f32 v25, v25, v33
    v_add_f32 v26, v26, v34
    v_add_f32 v27, v27, v35
    v_add_f32 v28, v28, v36
    v_add_f32 v29, v29, v37
    v_add_f32 v30, v30, v38
    v_add_f32 v31, v31, v39
    s_waitcnt lgkmcnt(0)
    v_add_f32 v40, v40, v48
    v_add_f32 v41, v41, v49
    v_add_f32 v42, v42, v50
    v_add_f32 v43, v43, v51
    v_add_f32 v44, v44, v52
    v_add_f32 v45, v45, v53
    v_add_f32 v46, v46, v54
    v_add_f32 v47, v47, v55
    v_add_f32 v24, v24, v40
    v_add_f32 v25, v25, v41
    v_add_f32 v26, v26, v42
    v_add_f32 v27, v27, v43
    v_add_f32 v28, v28, v44
    v_add_f32 v29, v29, v45
    v_add_f32 v30, v30, v46
    v_add_f32 v31, v31, v47
    v_cvt_pk_bf16_f32 v24, v24, v25
    v_cvt_pk_bf16_f32 v25, v26, v27
    v_cvt_pk_bf16_f32 v26, v28, v29
    v_cvt_pk_bf16_f32 v27, v30, v31
    v_min_u32 v24, -2, v24
    v_min_u32 v25, -2, v25
    v_min_u32 v26, -2, v26
    v_min_u32 v27, -2, v27
    buffer_store_dwordx4 v[24:27], v1, s[4:7], s37 offen sc1
    s_branch k_end
ch_a_pro:
    s_mul_i32 s21, s2, 24576
    s_add_u32 s21, s21, 209711104
    v_lshlrev_b32 v1, 4, v0
    v_mov_b32 v4, -1
    v_mov_b32 v5, -1
    v_mov_b32 v6, -1
    v_mov_b32 v7, -1
    buffer_store_dwordx4 v[4:7], v1, s[4:7], s21 offen sc1
    s_add_u32 s21, s21, 4096
    buffer_store_dwordx4 v[4:7], v1, s[4:7], s21 offen sc1
    s_add_u32 s21, s21, 4096
    buffer_store_dwordx4 v[4:7], v1, s[4:7], s21 offen sc1
    s_add_u32 s21, s21, 4096
    buffer_store_dwordx4 v[4:7], v1, s[4:7], s21 offen sc1
    s_add_u32 s21, s21, 4096
    buffer_store_dwordx4 v[4:7], v1, s[4:7], s21 offen sc1
    s_add_u32 s21, s21, 4096
    buffer_store_dwordx4 v[4:7], v1, s[4:7], s21 offen sc1
    s_add_u32 s21, s21, 4096
    v_mov_b32 v2, s29
    s_waitcnt vmcnt(0)
    s_barrier
    s_cmp_lg_u32 s3, 4
    s_cbranch_scc1 ch_nox
    s_mov_b64 exec, 1
    buffer_atomic_add v2, off, s[64:67], s28 sc1
    s_mov_b64 exec, -1
ch_nox:
    v_and_b32 v20, 63, v0
    v_lshlrev_b32 v0, 4, v20
    s_sub_u32 s25, s3, 4
    s_lshl_b32 s46, s12, 2
    s_add_u32 s46, s46, s25
    s_lshl_b32 s21, s46, 18
    s_lshl_b32 s22, s13, 7
    s_add_u32 s21, s21, s22
    s_lshl_b32 s46, s46, 12
    s_lshl_b32 s23, s25, 13
    s_add_u32 s23, s23, 131072
    s_load_dwordx2 s[8:9], s[0:1], 40
    s_mov_b32 s10, 8388608
    s_mov_b32 s11, 131072
    v_lshrrev_b32 v21, 3, v20
    v_and_b32 v22, 7, v20
    v_lshlrev_b32 v21, 11, v21
    v_lshl_add_u32 v21, v22, 4, v21
    v_lshrrev_b32 v28, 4, v20
    v_and_b32 v29, 1, v28
    v_xor_b32 v29, 0, v29
    v_lshlrev_b32 v29, 2, v29
    v_lshl_add_u32 v29, v28, 3, v29
    v_bfe_u32 v28, v20, 2, 2
    v_add_u32 v29, v29, v28
    v_lshlrev_b32 v29, 7, v29
    v_and_b32 v28, 3, v20
    v_lshl_add_u32 v29, v28, 4, v29
    v_and_b32 v28, 1, v28
    v_xor_b32 v28, 0, v28
    v_lshl_add_u32 v24, v28, 3, v29
    v_add_u32 v24, s23, v24
    v_lshrrev_b32 v28, 4, v20
    v_and_b32 v29, 1, v28
    v_xor_b32 v29, 1, v29
    v_lshlrev_b32 v29, 2, v29
    v_lshl_add_u32 v29, v28, 3, v29
    v_bfe_u32 v28, v20, 2, 2
    v_add_u32 v29, v29, v28
    v_lshlrev_b32 v29, 7, v29
    v_and_b32 v28, 3, v20
    v_lshl_add_u32 v29, v28, 4, v29
    v_and_b32 v28, 1, v28
    v_xor_b32 v28, 0, v28
    v_lshl_add_u32 v25, v28, 3, v29
    v_add_u32 v25, s23, v25
    v_lshrrev_b32 v28, 4, v20
    v_and_b32 v29, 1, v28
    v_xor_b32 v29, 0, v29
    v_lshlrev_b32 v29, 2, v29
    v_lshl_add_u32 v29, v28, 3, v29
    v_bfe_u32 v28, v20, 2, 2
    v_add_u32 v29, v29, v28
    v_lshlrev_b32 v29, 7, v29
    v_and_b32 v28, 3, v20
    v_lshl_add_u32 v29, v28, 4, v29
    v_and_b32 v28, 1, v28
    v_xor_b32 v28, 1, v28
    v_lshl_add_u32 v26, v28, 3, v29
    v_add_u32 v26, s23, v26
    v_lshrrev_b32 v28, 4, v20
    v_and_b32 v29, 1, v28
    v_xor_b32 v29, 1, v29
    v_lshlrev_b32 v29, 2, v29
    v_lshl_add_u32 v29, v28, 3, v29
    v_bfe_u32 v28, v20, 2, 2
    v_add_u32 v29, v29, v28
    v_lshlrev_b32 v29, 7, v29
    v_and_b32 v28, 3, v20
    v_lshl_add_u32 v29, v28, 4, v29
    v_and_b32 v28, 1, v28
    v_xor_b32 v28, 1, v28
    v_lshl_add_u32 v27, v28, 3, v29
    v_add_u32 v27, s23, v27
    s_waitcnt lgkmcnt(0)
    s_add_u32 m0, s23, 0
    s_nop 0
    buffer_load_dwordx4 v21, s[8:11], s21 offen lds
    s_add_u32 s21, s21, 16384
    s_add_u32 m0, s23, 1024
    s_nop 0
    buffer_load_dwordx4 v21, s[8:11], s21 offen lds
    s_add_u32 s21, s21, 16384
    s_add_u32 m0, s23, 2048
    s_nop 0
    buffer_load_dwordx4 v21, s[8:11], s21 offen lds
    s_add_u32 s21, s21, 16384
    s_add_u32 m0, s23, 3072
    s_nop 0
    buffer_load_dwordx4 v21, s[8:11], s21 offen lds
    s_add_u32 s21, s21, 16384
    s_add_u32 m0, s23, 4096
    s_nop 0
    buffer_load_dwordx4 v21, s[8:11], s21 offen lds
    s_add_u32 s21, s21, 16384
    s_add_u32 m0, s23, 5120
    s_nop 0
    buffer_load_dwordx4 v21, s[8:11], s21 offen lds
    s_add_u32 s21, s21, 16384
    s_add_u32 m0, s23, 6144
    s_nop 0
    buffer_load_dwordx4 v21, s[8:11], s21 offen lds
    s_add_u32 s21, s21, 16384
    s_add_u32 m0, s23, 7168
    s_nop 0
    buffer_load_dwordx4 v21, s[8:11], s21 offen lds
    s_add_u32 s21, s21, 16384
    buffer_load_dwordx4 v[98:101], v21, s[8:11], s21 offen
    s_add_u32 s21, s21, 16384
    buffer_load_dwordx4 v[102:105], v21, s[8:11], s21 offen
    s_add_u32 s21, s21, 16384
    buffer_load_dwordx4 v[106:109], v21, s[8:11], s21 offen
    s_add_u32 s21, s21, 16384
    buffer_load_dwordx4 v[110:113], v21, s[8:11], s21 offen
    s_add_u32 s21, s21, 16384
    buffer_load_dwordx4 v[114:117], v21, s[8:11], s21 offen
    s_add_u32 s21, s21, 16384
    buffer_load_dwordx4 v[118:121], v21, s[8:11], s21 offen
    s_add_u32 s21, s21, 16384
    buffer_load_dwordx4 v[122:125], v21, s[8:11], s21 offen
    s_add_u32 s21, s21, 16384
    buffer_load_dwordx4 v[126:129], v21, s[8:11], s21 offen
    s_add_u32 s21, s21, 16384
    v_add_u32 v30, s23, v0
    s_waitcnt vmcnt(8)
    ds_read_b64_tr_b16 v[192:193], v24 offset:0
    ds_read_b64_tr_b16 v[194:195], v25 offset:0
    ds_read_b64_tr_b16 v[200:201], v26 offset:0
    ds_read_b64_tr_b16 v[202:203], v27 offset:0
    ds_read_b64_tr_b16 v[208:209], v24 offset:64
    ds_read_b64_tr_b16 v[210:211], v25 offset:64
    ds_read_b64_tr_b16 v[216:217], v26 offset:64
    ds_read_b64_tr_b16 v[218:219], v27 offset:64
    s_waitcnt lgkmcnt(0)
    ds_read_b64_tr_b16 v[196:197], v24 offset:4096
    ds_read_b64_tr_b16 v[198:199], v25 offset:4096
    ds_read_b64_tr_b16 v[204:205], v26 offset:4096
    ds_read_b64_tr_b16 v[206:207], v27 offset:4096
    ds_read_b64_tr_b16 v[212:213], v24 offset:4160
    ds_read_b64_tr_b16 v[214:215], v25 offset:4160
    ds_read_b64_tr_b16 v[220:221], v26 offset:4160
    ds_read_b64_tr_b16 v[222:223], v27 offset:4160
    s_waitcnt lgkmcnt(0)
    s_waitcnt vmcnt(0)
    ds_write_b128 v30, v[98:101] offset:0
    ds_write_b128 v30, v[102:105] offset:1024
    ds_write_b128 v30, v[106:109] offset:2048
    ds_write_b128 v30, v[110:113] offset:3072
    ds_write_b128 v30, v[114:117] offset:4096
    ds_write_b128 v30, v[118:121] offset:5120
    ds_write_b128 v30, v[122:125] offset:6144
    ds_write_b128 v30, v[126:129] offset:7168
    s_waitcnt lgkmcnt(0)
    ds_read_b64_tr_b16 v[224:225], v24 offset:0
    ds_read_b64_tr_b16 v[226:227], v25 offset:0
    ds_read_b64_tr_b16 v[232:233], v26 offset:0
    ds_read_b64_tr_b16 v[234:235], v27 offset:0
    ds_read_b64_tr_b16 v[240:241], v24 offset:64
    ds_read_b64_tr_b16 v[242:243], v25 offset:64
    ds_read_b64_tr_b16 v[248:249], v26 offset:64
    ds_read_b64_tr_b16 v[250:251], v27 offset:64
    s_waitcnt lgkmcnt(0)
    ds_read_b64_tr_b16 v[228:229], v24 offset:4096
    ds_read_b64_tr_b16 v[230:231], v25 offset:4096
    ds_read_b64_tr_b16 v[236:237], v26 offset:4096
    ds_read_b64_tr_b16 v[238:239], v27 offset:4096
    ds_read_b64_tr_b16 v[244:245], v24 offset:4160
    ds_read_b64_tr_b16 v[246:247], v25 offset:4160
    ds_read_b64_tr_b16 v[252:253], v26 offset:4160
    ds_read_b64_tr_b16 v[254:255], v27 offset:4160
    s_waitcnt lgkmcnt(0)
    v_lshrrev_b32 v21, 4, v20
    s_mul_i32 s21, s25, 18560
    s_add_u32 s21, s21, 16384
    v_add_u32 v1, s21, v0
    v_and_b32 v23, 15, v20
    v_mul_u32_u24 v21, 136, v21
    v_lshl_add_u32 v21, v23, 3, v21
    v_add_u32 v45, s21, v21
    s_lshl_b32 s53, s25, 13
    s_add_u32 s53, s53, 92160
    v_add_u32 v49, s53, v0
    v_mov_b32 v48, 0
    v_mov_b32 v4, 0x3f803f80
    v_mov_b32 v5, 0x3f803f80
    v_mov_b32 v6, 0x3f803f80
    v_mov_b32 v7, 0x3f803f80
    v_mov_b32 v8, 0
    v_mov_b32 v9, 0
    v_mov_b32 v10, 0
    v_mov_b32 v11, 0
    v_lshlrev_b32 v43, 2, v20
    v_mov_b32 v26, 0x44444444
    v_mov_b32 v27, 0xeeeeeeee
    v_and_b32 v28, 1, v20
    v_cmp_eq_u32 vcc, 0, v28
    s_mov_b32 s47, 0x3e0293ee
    s_lshl_b32 s32, s12, 15
    v_cndmask_b32 v41, v27, v26, vcc
    s_lshl_b32 s21, s25, 13
    s_add_u32 s32, s32, s21
    s_add_u32 s32, s32, 2097152
    s_lshl_b32 s21, s25, 2
    s_add_u32 s21, s21, 13312
    v_mov_b32 v47, s21
    s_lshl_b32 s27, s13, 2
    s_add_u32 s27, s27, s25
    s_lshl_b32 s62, s12, 7
    s_add_u32 s62, s62, 218112000
    s_lshl_b32 s33, s12, 14
    s_lshl_b32 s21, s25, 12
    s_add_u32 s33, s33, s21
    s_add_u32 s33, s33, 1179648
    v_mov_b32 v139, 0
    v_mov_b32 v140, 0
    v_mov_b32 v141, 0
    v_mov_b32 v143, 0
    v_mov_b32 v144, 0
    v_mov_b32 v145, 0
    v_mov_b32 v40, 0
    v_mov_b32 v42, 0
    v_mov_b32 v44, 0
    v_mov_b32 v46, 0
    v_mov_b32 v158, 0x7f800000
    s_mov_b32 exec_lo, 0xcccccccc
    s_mov_b32 exec_hi, 0xcccccccc
    v_mov_b32 v158, 0x42700000
    s_mov_b64 exec, -1
    s_cmp_lg_u32 s3, 4
    s_cbranch_scc1 ch_xcc_skip
    v_add_u32 v56, 128, v43
    v_writelane_b32 v56, 0, 4
    v_mov_b32 v59, 63
    v_writelane_b32 v59, -1, 4
    v_mov_b32 v60, 32
    s_movk_i32 s21, 128
    v_writelane_b32 v60, s21, 4
    s_mov_b64 exec, 0x1f
ch_xcc:
    buffer_load_dword v57, v56, s[64:67], 0 offen sc1
    s_waitcnt vmcnt(0)
    v_and_b32 v62, v59, v57
    v_cmp_ne_u32 vcc, v62, v60
    s_cbranch_vccz ch_xcc_ok
    s_sleep 16
    s_sub_u32 s26, s26, 1
    s_cbranch_scc0 ch_xcc
    s_mov_b32 s26, 0
ch_xcc_ok:
    s_lshr_b32 s22, s12, 1
    v_readlane_b32 s23, v57, 0
    s_nop 2
    v_readlane_b32 s21, v57, s22
    s_mov_b64 exec, -1
    v_mov_b32 v58, 131072
    v_mov_b32 v57, s21
    ds_write_b32 v58, v57
    s_bfe_u32 s23, s23, 0x1000f
    v_and_b32 v60, 0x70, v0
    v_lshlrev_b32 v60, 3, v60
    s_mov_b32 s22, 218112000
ch_pgv:
    buffer_load_dword v61, v60, s[4:7], s22 offen offset:8 sc1
    s_waitcnt vmcnt(0) lgkmcnt(0)
    v_and_b32 v62, 1, v61
    v_cmp_eq_u32 vcc, 0, v62
    s_cbranch_vccz ch_pgvok
    s_sleep 8
    s_sub_u32 s26, s26, 1
    s_cbranch_scc0 ch_pgv
    s_mov_b32 s26, 0
ch_pgvok:
    v_bfe_u32 v62, v61, 1, 1
    v_ashrrev_i32 v61, 8, v61
    v_sub_u32 v59, 0, v61
    v_cmp_eq_u32 vcc, s23, v62
    s_mov_b32 s21, 0
    s_nop 1
    v_cndmask_b32 v61, v59, v61, vcc
    s_nop 1
    v_readlane_b32 s22, v61, 0
    s_add_i32 s21, s21, s22
    v_readlane_b32 s22, v61, 1
    s_add_i32 s21, s21, s22
    v_readlane_b32 s22, v61, 2
    s_add_i32 s21, s21, s22
    v_readlane_b32 s22, v61, 3
    s_add_i32 s21, s21, s22
    v_readlane_b32 s22, v61, 4
    s_add_i32 s21, s21, s22
    v_readlane_b32 s22, v61, 5
    s_add_i32 s21, s21, s22
    v_readlane_b32 s22, v61, 6
    s_add_i32 s21, s21, s22
    v_readlane_b32 s22, v61, 7
    s_add_i32 s21, s21, s22
    s_cmp_gt_i32 s21, 0
    s_cselect_b32 s21, 0x2000, 0
    v_mov_b32 v59, s21
    ds_write_b32 v58, v59 offset:4
    s_waitcnt lgkmcnt(0)
ch_xcc_skip:
    s_barrier
    s_barrier
    s_lshl_b32 s60, s12, 4
    s_add_u32 s60, s60, 218104320
ch_g0:
    buffer_load_dword v57, off, s[4:7], s60 sc1
    s_waitcnt vmcnt(0)
    v_readfirstlane_b32 s21, v57
    s_cmp_ge_u32 s21, 12
    s_cbranch_scc1 ch_g0b
    s_sleep 8
    s_sub_u32 s26, s26, 1
    s_cbranch_scc0 ch_g0
    s_mov_b32 s26, 0
ch_g0b:
    s_add_u32 s21, s16, 0
    s_lshl_b32 s21, s21, 18
    s_add_u32 s21, s21, s46
    s_add_u32 s21, s21, 37748736
    s_add_u32 s22, s21, 131072
    buffer_load_dwordx4 v[160:163], v0, s[4:7], s21 offen offset:0 sc1
    buffer_load_dwordx4 v[164:167], v0, s[4:7], s21 offen offset:1024 sc1
    buffer_load_dwordx4 v[168:171], v0, s[4:7], s21 offen offset:2048 sc1
    buffer_load_dwordx4 v[172:175], v0, s[4:7], s21 offen offset:3072 sc1
    buffer_load_dwordx4 v[176:179], v0, s[4:7], s22 offen offset:0 sc1
    buffer_load_dwordx4 v[180:183], v0, s[4:7], s22 offen offset:1024 sc1
    buffer_load_dwordx4 v[184:187], v0, s[4:7], s22 offen offset:2048 sc1
    buffer_load_dwordx4 v[188:191], v0, s[4:7], s22 offen offset:3072 sc1
    s_waitcnt vmcnt(0)
    v_mfma_f32_16x16x32_bf16 v[50:53], v[160:163], v[192:195], 0
    v_mfma_f32_16x16x32_bf16 v[54:57], v[160:163], v[200:203], 0
    v_mfma_f32_16x16x32_bf16 v[58:61], v[160:163], v[208:211], 0
    v_mfma_f32_16x16x32_bf16 v[62:65], v[160:163], v[216:219], 0
    v_mfma_f32_16x16x32_bf16 v[66:69], v[176:179], v[192:195], 0
    v_mfma_f32_16x16x32_bf16 v[70:73], v[176:179], v[200:203], 0
    v_mfma_f32_16x16x32_bf16 v[74:77], v[176:179], v[208:211], 0
    v_mfma_f32_16x16x32_bf16 v[78:81], v[176:179], v[216:219], 0
    v_mfma_f32_16x16x32_bf16 v[50:53], v[164:167], v[196:199], v[50:53]
    v_mfma_f32_16x16x32_bf16 v[54:57], v[164:167], v[204:207], v[54:57]
    v_mfma_f32_16x16x32_bf16 v[58:61], v[164:167], v[212:215], v[58:61]
    v_mfma_f32_16x16x32_bf16 v[62:65], v[164:167], v[220:223], v[62:65]
    v_mfma_f32_16x16x32_bf16 v[66:69], v[180:183], v[196:199], v[66:69]
    v_mfma_f32_16x16x32_bf16 v[70:73], v[180:183], v[204:207], v[70:73]
    v_mfma_f32_16x16x32_bf16 v[74:77], v[180:183], v[212:215], v[74:77]
    v_mfma_f32_16x16x32_bf16 v[78:81], v[180:183], v[220:223], v[78:81]
    v_mfma_f32_16x16x32_bf16 v[50:53], v[168:171], v[224:227], v[50:53]
    v_mfma_f32_16x16x32_bf16 v[54:57], v[168:171], v[232:235], v[54:57]
    v_mfma_f32_16x16x32_bf16 v[58:61], v[168:171], v[240:243], v[58:61]
    v_mfma_f32_16x16x32_bf16 v[62:65], v[168:171], v[248:251], v[62:65]
    v_mfma_f32_16x16x32_bf16 v[66:69], v[184:187], v[224:227], v[66:69]
    v_mfma_f32_16x16x32_bf16 v[70:73], v[184:187], v[232:235], v[70:73]
    v_mfma_f32_16x16x32_bf16 v[74:77], v[184:187], v[240:243], v[74:77]
    v_mfma_f32_16x16x32_bf16 v[78:81], v[184:187], v[248:251], v[78:81]
    v_mfma_f32_16x16x32_bf16 v[50:53], v[172:175], v[228:231], v[50:53]
    v_mfma_f32_16x16x32_bf16 v[54:57], v[172:175], v[236:239], v[54:57]
    v_mfma_f32_16x16x32_bf16 v[58:61], v[172:175], v[244:247], v[58:61]
    v_mfma_f32_16x16x32_bf16 v[62:65], v[172:175], v[252:255], v[62:65]
    v_mfma_f32_16x16x32_bf16 v[66:69], v[188:191], v[228:231], v[66:69]
    v_mfma_f32_16x16x32_bf16 v[70:73], v[188:191], v[236:239], v[70:73]
    v_mfma_f32_16x16x32_bf16 v[74:77], v[188:191], v[244:247], v[74:77]
    v_mfma_f32_16x16x32_bf16 v[78:81], v[188:191], v[252:255], v[78:81]
    s_nop 7
    v_cvt_pk_bf16_f32 v82, v50, v51
    v_cvt_pk_bf16_f32 v83, v52, v53
    v_cvt_pk_bf16_f32 v84, v66, v67
    v_cvt_pk_bf16_f32 v85, v68, v69
    v_cvt_pk_bf16_f32 v86, v54, v55
    v_cvt_pk_bf16_f32 v87, v56, v57
    v_cvt_pk_bf16_f32 v88, v70, v71
    v_cvt_pk_bf16_f32 v89, v72, v73
    v_cvt_pk_bf16_f32 v90, v58, v59
    v_cvt_pk_bf16_f32 v91, v60, v61
    v_cvt_pk_bf16_f32 v92, v74, v75
    v_cvt_pk_bf16_f32 v93, v76, v77
    v_cvt_pk_bf16_f32 v94, v62, v63
    v_cvt_pk_bf16_f32 v95, v64, v65
    v_cvt_pk_bf16_f32 v96, v78, v79
    v_cvt_pk_bf16_f32 v97, v80, v81
.p2align 6
aloop_23:
    s_add_u32 s21, s17, s32
    s_add_u32 s22, s21, 4096
    v_mov_b32 v74, 0
    v_mov_b32 v75, 0
    v_mov_b32 v76, 0
    v_mov_b32 v77, 0
    v_mov_b32 v78, 0
    v_mov_b32 v79, 0
    v_mov_b32 v80, 0
    v_mov_b32 v81, 0
    v_mov_b32 v146, 0
    v_mov_b32 v147, 0
    v_mov_b32 v148, 0
    v_mov_b32 v149, 0
    v_mov_b32 v150, 0
    v_mov_b32 v151, 0
    v_mov_b32 v152, 0
    v_mov_b32 v153, 0
    s_add_u32 s30, s16, 1
    s_lshl_b32 s30, s30, 18
    s_add_u32 s30, s30, s46
    s_add_u32 s30, s30, 37748736
    s_add_u32 s31, s30, 131072
aloop_23_wm:
    ds_read_b32 v3, v47
    s_waitcnt lgkmcnt(0)
    v_readfirstlane_b32 s23, v3
    s_cmp_eq_u32 s23, s16
    s_cbranch_scc1 aloop_23_wmok
    s_sleep 1
    s_branch aloop_23_wm
aloop_23_wmok:
    buffer_load_dwordx4 v[160:163], v0, s[4:7], s30 offen offset:0 sc1
    buffer_load_dwordx4 v[164:167], v0, s[4:7], s30 offen offset:1024 sc1
    buffer_load_dwordx4 v[168:171], v0, s[4:7], s30 offen offset:2048 sc1
    buffer_load_dwordx4 v[172:175], v0, s[4:7], s30 offen offset:3072 sc1
    buffer_load_dwordx4 v[176:179], v0, s[4:7], s31 offen offset:0 sc1
    buffer_load_dwordx4 v[180:183], v0, s[4:7], s31 offen offset:1024 sc1
    buffer_load_dwordx4 v[184:187], v0, s[4:7], s31 offen offset:2048 sc1
    buffer_load_dwordx4 v[188:191], v0, s[4:7], s31 offen offset:3072 sc1
    s_setprio 2
    v_mov_b32 v2, s16
    s_barrier
    s_nop 15
    s_nop 13
    ds_read_b128 v[98:101], v49 offset:0
    ds_read_b128 v[102:105], v49 offset:1024
    ds_read_b128 v[106:109], v49 offset:2048
    ds_read_b128 v[110:113], v49 offset:3072
    ds_read_b128 v[114:117], v49 offset:4096
    ds_read_b128 v[118:121], v49 offset:5120
    ds_read_b128 v[122:125], v49 offset:6144
    ds_read_b128 v[126:129], v49 offset:7168
    v_mov_b32 v12, 0
    v_mov_b32 v13, 0
    v_mov_b32 v14, 0
    v_mov_b32 v15, 0
    v_mov_b32 v16, 0
    v_mov_b32 v17, 0
    v_mov_b32 v18, 0
    v_mov_b32 v19, 0
    v_mov_b32 v20, 0
    v_mov_b32 v21, 0
    v_mov_b32 v22, 0
    v_mov_b32 v23, 0
    s_sleep 3
    s_nop 6
    buffer_load_dwordx4 v[50:53], v0, s[4:7], s21 offen offset:0 sc1
    s_nop 7
    buffer_load_dwordx4 v[54:57], v0, s[4:7], s21 offen offset:1024 sc1
    s_nop 7
    buffer_load_dwordx4 v[58:61], v0, s[4:7], s21 offen offset:2048 sc1
    s_nop 7
    buffer_load_dwordx4 v[62:65], v0, s[4:7], s21 offen offset:3072 sc1
    s_nop 7
    buffer_load_dwordx4 v[66:69], v0, s[4:7], s22 offen offset:0 sc1
    s_nop 7
    buffer_load_dwordx4 v[70:73], v0, s[4:7], s22 offen offset:1024 sc1
    s_waitcnt lgkmcnt(0)
    s_waitcnt vmcnt(5)
    v_max3_u32 v3, v50, v51, v52
    v_max_u32 v3, v3, v53
    v_cmp_eq_u32 vcc, -1, v3
    s_cbranch_vccnz arq_24_0
arq_24_0ok:
    v_mfma_f32_16x16x32_bf16 v[12:15], v[98:101], v[50:53], v[12:15]
    v_mfma_f32_16x16x32_bf16 v[16:19], v[114:117], v[50:53], v[16:19]
    s_waitcnt vmcnt(4)
    v_max3_u32 v3, v54, v55, v56
    v_max_u32 v3, v3, v57
    v_cmp_eq_u32 vcc, -1, v3
    v_mfma_f32_16x16x32_bf16 v[20:23], v[50:53], v[50:53], v[20:23]
    s_cbranch_vccnz arq_24_1
arq_24_1ok:
    v_mfma_f32_16x16x32_bf16 v[12:15], v[102:105], v[54:57], v[12:15]
    v_mfma_f32_16x16x32_bf16 v[16:19], v[118:121], v[54:57], v[16:19]
    s_waitcnt vmcnt(3)
    v_max3_u32 v3, v58, v59, v60
    v_max_u32 v3, v3, v61
    v_cmp_eq_u32 vcc, -1, v3
    v_mfma_f32_16x16x32_bf16 v[20:23], v[54:57], v[54:57], v[20:23]
    s_cbranch_vccnz arq_24_2
arq_24_2ok:
    v_mfma_f32_16x16x32_bf16 v[12:15], v[106:109], v[58:61], v[12:15]
    v_mfma_f32_16x16x32_bf16 v[16:19], v[122:125], v[58:61], v[16:19]
    s_waitcnt vmcnt(2)
    v_max3_u32 v3, v62, v63, v64
    v_max_u32 v3, v3, v65
    v_cmp_eq_u32 vcc, -1, v3
    v_mfma_f32_16x16x32_bf16 v[20:23], v[58:61], v[58:61], v[20:23]
    s_cbranch_vccnz arq_24_3
arq_24_3ok:
    v_mfma_f32_16x16x32_bf16 v[12:15], v[110:113], v[62:65], v[12:15]
    v_mfma_f32_16x16x32_bf16 v[16:19], v[126:129], v[62:65], v[16:19]
    v_mfma_f32_16x16x32_bf16 v[20:23], v[62:65], v[62:65], v[20:23]
aloop_23_sdone:
    ds_write_b32 v47, v2 offset:16
    s_cmp_eq_u32 s16, 63
    s_cbranch_scc1 aloop_23_lsk
    s_nop 1
    v_exp_f32 v54, v12
    v_exp_f32 v55, v13
    s_waitcnt vmcnt(0)
    v_max3_u32 v24, v66, v67, v68
    v_max3_u32 v24, v24, v69, v70
    v_max3_u32 v24, v24, v71, v72
    v_max_u32 v24, v24, v73
    v_cmp_eq_u32 vcc, -1, v24
    s_cbranch_vccnz arq_24_v
    v_smfmac_f32_16x16x64_bf16 v[74:77], v[66:69], v[192:199], v41
    v_exp_f32 v56, v14
    v_smfmac_f32_16x16x64_bf16 v[78:81], v[66:69], v[200:207], v41
    v_exp_f32 v57, v15
    v_smfmac_f32_16x16x64_bf16 v[146:149], v[66:69], v[208:215], v41
    v_exp_f32 v58, v16
    v_smfmac_f32_16x16x64_bf16 v[150:153], v[66:69], v[216:223], v41
    v_exp_f32 v59, v17
    v_smfmac_f32_16x16x64_bf16 v[74:77], v[70:73], v[224:231], v41
    v_exp_f32 v60, v18
    v_smfmac_f32_16x16x64_bf16 v[78:81], v[70:73], v[232:239], v41
    v_exp_f32 v61, v19
    v_smfmac_f32_16x16x64_bf16 v[146:149], v[70:73], v[240:247], v41
    v_exp_f32 v62, v20
    v_smfmac_f32_16x16x64_bf16 v[150:153], v[70:73], v[248:255], v41
    v_exp_f32 v63, v21
    v_cvt_pk_bf16_f32 v154, v54, v55
    v_cvt_pk_bf16_f32 v155, v56, v57
    v_cvt_pk_bf16_f32 v156, v58, v59
    v_cvt_pk_bf16_f32 v157, v60, v61
    v_cvt_pk_bf16_f32 v8, v62, v63
    v_max3_f32 v2, |v12|, |v13|, |v14|
    v_mfma_f32_16x16x32_bf16 v[50:53], v[154:157], v[4:7], 0
    v_max3_f32 v3, |v15|, |v16|, |v17|
    v_add_f32 v74, v74, v75
    v_mfma_f32_16x16x32_bf16 v[50:53], v[8:11], v[4:7], v[50:53]
    v_add_f32 v76, v76, v77
    v_cvt_pk_bf16_f32 v40, v74, v76
    v_mfma_f32_16x16x32_bf16 v[24:27], v[154:157], v[82:85], 0
    v_add_f32 v78, v78, v79
    v_add_f32 v80, v80, v81
    v_mfma_f32_16x16x32_bf16 v[24:27], v[8:11], v[40:43], v[24:27]
    v_cvt_pk_bf16_f32 v42, v78, v80
    v_add_f32 v146, v146, v147
    v_mfma_f32_16x16x32_bf16 v[28:31], v[154:157], v[86:89], 0
    v_add_f32 v148, v148, v149
    v_cvt_pk_bf16_f32 v44, v146, v148
    v_mfma_f32_16x16x32_bf16 v[28:31], v[8:11], v[42:45], v[28:31]
    v_add_f32 v150, v150, v151
    v_add_f32 v152, v152, v153
    v_mfma_f32_16x16x32_bf16 v[32:35], v[154:157], v[90:93], 0
    v_cvt_pk_bf16_f32 v46, v150, v152
    v_rcp_f32 v52, v52
    v_mfma_f32_16x16x32_bf16 v[32:35], v[8:11], v[44:47], v[32:35]
    v_rcp_f32 v53, v53
    v_max3_f32 v2, v2, |v18|, |v19|
    v_mfma_f32_16x16x32_bf16 v[36:39], v[154:157], v[94:97], 0
    v_max3_f32 v3, v3, |v20|, |v21|
    v_max_f32 v2, v2, v3
    v_mfma_f32_16x16x32_bf16 v[36:39], v[8:11], v[46:49], v[36:39]
    v_cmp_nle_f32 vcc, v2, v158
    v_mul_f32 v26, v26, v52
    v_mul_f32 v27, v27, v53
    s_cbranch_vccnz aloop_23_tm
    v_mul_f32 v30, v30, v52
    v_mul_f32 v31, v31, v53
aloop_23_pvd:
    ds_write_b64 v45, v[26:27] offset:0
    v_mul_f32 v34, v34, v52
    v_mul_f32 v35, v35, v53
    ds_write_b64 v45, v[30:31] offset:544
    v_mul_f32 v38, v38, v52
    v_mul_f32 v39, v39, v53
    ds_write_b64 v45, v[34:35] offset:1088
    ds_write_b64 v45, v[38:39] offset:1632
aloop_23_lskb:
    s_waitcnt lgkmcnt(0)
    s_barrier
    s_setprio 0
    s_cmp_lg_u32 s27, 0
    s_cbranch_scc1 pg_25
    s_sub_u32 s25, s16, 1
    s_cbranch_scc1 pg_25
    v_mov_b32 v3, s25
    s_mov_b64 exec, 1
    buffer_store_dword v3, off, s[4:7], s62 sc1
    s_mov_b64 exec, -1
pg_25:
    s_add_u32 s21, s17, s33
    v_lshlrev_b32 v2, 1, v43
    s_cmp_eq_u32 s16, 63
    s_cbranch_scc1 aloop_23_nvw
    v_mfma_f32_16x16x32_bf16 v[50:53], v[160:163], v[192:195], 0
    v_mfma_f32_16x16x32_bf16 v[54:57], v[160:163], v[200:203], 0
    v_mfma_f32_16x16x32_bf16 v[58:61], v[160:163], v[208:211], 0
    v_mfma_f32_16x16x32_bf16 v[62:65], v[160:163], v[216:219], 0
    v_mfma_f32_16x16x32_bf16 v[66:69], v[176:179], v[192:195], 0
    v_mfma_f32_16x16x32_bf16 v[70:73], v[176:179], v[200:203], 0
    v_mfma_f32_16x16x32_bf16 v[74:77], v[176:179], v[208:211], 0
    v_mfma_f32_16x16x32_bf16 v[78:81], v[176:179], v[216:219], 0
    v_mfma_f32_16x16x32_bf16 v[50:53], v[164:167], v[196:199], v[50:53]
    v_mfma_f32_16x16x32_bf16 v[54:57], v[164:167], v[204:207], v[54:57]
    v_mfma_f32_16x16x32_bf16 v[58:61], v[164:167], v[212:215], v[58:61]
    v_mfma_f32_16x16x32_bf16 v[62:65], v[164:167], v[220:223], v[62:65]
    v_mfma_f32_16x16x32_bf16 v[66:69], v[180:183], v[196:199], v[66:69]
    v_mfma_f32_16x16x32_bf16 v[70:73], v[180:183], v[204:207], v[70:73]
    v_mfma_f32_16x16x32_bf16 v[74:77], v[180:183], v[212:215], v[74:77]
    v_mfma_f32_16x16x32_bf16 v[78:81], v[180:183], v[220:223], v[78:81]
    v_mfma_f32_16x16x32_bf16 v[50:53], v[168:171], v[224:227], v[50:53]
    v_mfma_f32_16x16x32_bf16 v[54:57], v[168:171], v[232:235], v[54:57]
    v_mfma_f32_16x16x32_bf16 v[58:61], v[168:171], v[240:243], v[58:61]
    v_mfma_f32_16x16x32_bf16 v[62:65], v[168:171], v[248:251], v[62:65]
    v_mfma_f32_16x16x32_bf16 v[66:69], v[184:187], v[224:227], v[66:69]
    v_mfma_f32_16x16x32_bf16 v[70:73], v[184:187], v[232:235], v[70:73]
    v_mfma_f32_16x16x32_bf16 v[74:77], v[184:187], v[240:243], v[74:77]
    v_mfma_f32_16x16x32_bf16 v[78:81], v[184:187], v[248:251], v[78:81]
    v_mfma_f32_16x16x32_bf16 v[50:53], v[172:175], v[228:231], v[50:53]
    v_mfma_f32_16x16x32_bf16 v[54:57], v[172:175], v[236:239], v[54:57]
    v_mfma_f32_16x16x32_bf16 v[58:61], v[172:175], v[244:247], v[58:61]
    v_mfma_f32_16x16x32_bf16 v[62:65], v[172:175], v[252:255], v[62:65]
    v_mfma_f32_16x16x32_bf16 v[66:69], v[188:191], v[228:231], v[66:69]
    v_mfma_f32_16x16x32_bf16 v[70:73], v[188:191], v[236:239], v[70:73]
    v_mfma_f32_16x16x32_bf16 v[74:77], v[188:191], v[244:247], v[74:77]
    v_mfma_f32_16x16x32_bf16 v[78:81], v[188:191], v[252:255], v[78:81]
    buffer_load_dwordx4 v[130:133], v0, s[4:7], s21 offen sc1
    buffer_load_dwordx2 v[146:147], v2, s[4:7], s21 offen offset:1024 sc1
    buffer_load_dwordx4 v[134:137], v0, s[4:7], s21 offen offset:2048 sc1
    buffer_load_dwordx2 v[148:149], v2, s[4:7], s21 offen offset:3072 sc1
    s_branch aloop_23_vwd
aloop_23_nvw:
    buffer_load_dwordx4 v[130:133], v0, s[4:7], s21 offen sc1
    buffer_load_dwordx2 v[146:147], v2, s[4:7], s21 offen offset:1024 sc1
    buffer_load_dwordx4 v[134:137], v0, s[4:7], s21 offen offset:2048 sc1
    buffer_load_dwordx2 v[148:149], v2, s[4:7], s21 offen offset:3072 sc1
aloop_23_vwd:
    v_add_u32 v48, s68, v1
    s_xor_b32 s68, s68, 8192
aloop_23_psa:
    s_waitcnt vmcnt(0)
    v_max3_u32 v3, v130, v131, v132
    v_max3_u32 v3, v3, v133, v134
    v_max3_u32 v3, v3, v135, v136
    v_max3_u32 v3, v3, v137, v146
    v_max3_u32 v3, v3, v147, v148
    v_max_u32 v3, v3, v149
    v_cmp_eq_u32 vcc, -1, v3
    s_cbranch_vccnz arq_24_ps
aloop_23_psok:
    v_mfma_f32_16x16x32_bf16 v[24:27], v[82:85], v[130:133], 0
    v_mfma_f32_16x16x32_bf16 v[28:31], v[86:89], v[130:133], 0
    v_mfma_f32_16x16x32_bf16 v[32:35], v[90:93], v[130:133], 0
    v_mfma_f32_16x16x32_bf16 v[36:39], v[94:97], v[130:133], 0
    v_mov_b32 v138, v146
    v_mfma_f32_16x16x32_bf16 v[12:15], v[82:85], v[134:137], 0
    v_mfma_f32_16x16x32_bf16 v[16:19], v[86:89], v[134:137], 0
    v_mfma_f32_16x16x32_bf16 v[20:23], v[90:93], v[134:137], 0
    v_mfma_f32_16x16x32_bf16 v[154:157], v[94:97], v[134:137], 0
    v_mov_b32 v142, v148
    v_mfma_f32_16x16x32_bf16 v[24:27], v[40:43], v[138:141], v[24:27]
    v_mfma_f32_16x16x32_bf16 v[28:31], v[42:45], v[138:141], v[28:31]
    v_mfma_f32_16x16x32_bf16 v[32:35], v[44:47], v[138:141], v[32:35]
    v_mfma_f32_16x16x32_bf16 v[36:39], v[46:49], v[138:141], v[36:39]
    v_mfma_f32_16x16x32_bf16 v[12:15], v[40:43], v[142:145], v[12:15]
    v_mfma_f32_16x16x32_bf16 v[16:19], v[42:45], v[142:145], v[16:19]
    v_mfma_f32_16x16x32_bf16 v[20:23], v[44:47], v[142:145], v[20:23]
    s_nop 1
    v_mfma_f32_16x16x32_bf16 v[154:157], v[46:49], v[142:145], v[154:157]
    ds_write_b128 v48, v[24:27] offset:2176
    v_cvt_pk_bf16_f32 v82, v50, v51
    v_cvt_pk_bf16_f32 v83, v52, v53
    ds_write_b128 v48, v[28:31] offset:3200
    v_cvt_pk_bf16_f32 v84, v66, v67
    v_cvt_pk_bf16_f32 v85, v68, v69
    ds_write_b128 v48, v[32:35] offset:4224
    v_cvt_pk_bf16_f32 v86, v54, v55
    v_cvt_pk_bf16_f32 v87, v56, v57
    ds_write_b128 v48, v[36:39] offset:5248
    v_cvt_pk_bf16_f32 v88, v70, v71
    v_cvt_pk_bf16_f32 v89, v72, v73
    ds_write_b128 v48, v[12:15] offset:6272
    v_cvt_pk_bf16_f32 v90, v58, v59
    v_cvt_pk_bf16_f32 v91, v60, v61
    ds_write_b128 v48, v[16:19] offset:7296
    v_cvt_pk_bf16_f32 v92, v74, v75
    v_cvt_pk_bf16_f32 v93, v76, v77
    ds_write_b128 v48, v[20:23] offset:8320
    v_cvt_pk_bf16_f32 v94, v62, v63
    v_cvt_pk_bf16_f32 v95, v64, v65
    ds_write_b128 v48, v[154:157] offset:9344
    v_cvt_pk_bf16_f32 v96, v78, v79
    v_cvt_pk_bf16_f32 v97, v80, v81
aloop_23_bgskip:
    s_waitcnt lgkmcnt(0)
    s_cmp_eq_u32 s16, 63
    s_cbranch_scc1 aloop_23_fin
    s_add_u32 s16, s16, 1
    s_mov_b32 s17, s18
    s_mov_b32 s18, s19
    s_mov_b32 s19, s20
    s_add_u32 s20, s20, 262144
    s_cmp_eq_u32 s20, 210763776
    s_cselect_b32 s20, 209715200, s20
    s_branch aloop_23
arq_24_0:
    s_sub_u32 s26, s26, 1
    s_cbranch_scc1 arq_24_0_g
    buffer_load_dwordx4 v[50:53], v0, s[4:7], s21 offen offset:0 sc1
    buffer_load_dwordx4 v[54:57], v0, s[4:7], s21 offen offset:1024 sc1
    buffer_load_dwordx4 v[58:61], v0, s[4:7], s21 offen offset:2048 sc1
    buffer_load_dwordx4 v[62:65], v0, s[4:7], s21 offen offset:3072 sc1
    buffer_load_dwordx4 v[66:69], v0, s[4:7], s22 offen offset:0 sc1
    buffer_load_dwordx4 v[70:73], v0, s[4:7], s22 offen offset:1024 sc1
    s_waitcnt vmcnt(5)
    v_max3_u32 v3, v50, v51, v52
    v_max_u32 v3, v3, v53
    v_cmp_eq_u32 vcc, -1, v3
    s_cbranch_vccnz arq_24_0
    s_branch arq_24_0ok
arq_24_0_g:
    s_mov_b32 s26, 0
    s_waitcnt vmcnt(0)
    s_branch arq_24_0ok
arq_24_1:
    s_sub_u32 s26, s26, 1
    s_cbranch_scc1 arq_24_1_g
    buffer_load_dwordx4 v[54:57], v0, s[4:7], s21 offen offset:1024 sc1
    buffer_load_dwordx4 v[58:61], v0, s[4:7], s21 offen offset:2048 sc1
    buffer_load_dwordx4 v[62:65], v0, s[4:7], s21 offen offset:3072 sc1
    buffer_load_dwordx4 v[66:69], v0, s[4:7], s22 offen offset:0 sc1
    buffer_load_dwordx4 v[70:73], v0, s[4:7], s22 offen offset:1024 sc1
    s_waitcnt vmcnt(4)
    v_max3_u32 v3, v54, v55, v56
    v_max_u32 v3, v3, v57
    v_cmp_eq_u32 vcc, -1, v3
    s_cbranch_vccnz arq_24_1
    s_branch arq_24_1ok
arq_24_1_g:
    s_mov_b32 s26, 0
    s_waitcnt vmcnt(0)
    s_branch arq_24_1ok
arq_24_2:
    s_sub_u32 s26, s26, 1
    s_cbranch_scc1 arq_24_2_g
    buffer_load_dwordx4 v[58:61], v0, s[4:7], s21 offen offset:2048 sc1
    buffer_load_dwordx4 v[62:65], v0, s[4:7], s21 offen offset:3072 sc1
    buffer_load_dwordx4 v[66:69], v0, s[4:7], s22 offen offset:0 sc1
    buffer_load_dwordx4 v[70:73], v0, s[4:7], s22 offen offset:1024 sc1
    s_waitcnt vmcnt(3)
    v_max3_u32 v3, v58, v59, v60
    v_max_u32 v3, v3, v61
    v_cmp_eq_u32 vcc, -1, v3
    s_cbranch_vccnz arq_24_2
    s_branch arq_24_2ok
arq_24_2_g:
    s_mov_b32 s26, 0
    s_waitcnt vmcnt(0)
    s_branch arq_24_2ok
arq_24_3:
    s_sub_u32 s26, s26, 1
    s_cbranch_scc1 arq_24_3_g
    buffer_load_dwordx4 v[62:65], v0, s[4:7], s21 offen offset:3072 sc1
    buffer_load_dwordx4 v[66:69], v0, s[4:7], s22 offen offset:0 sc1
    buffer_load_dwordx4 v[70:73], v0, s[4:7], s22 offen offset:1024 sc1
    s_waitcnt vmcnt(2)
    v_max3_u32 v3, v62, v63, v64
    v_max_u32 v3, v3, v65
    v_cmp_eq_u32 vcc, -1, v3
    s_cbranch_vccnz arq_24_3
    s_branch arq_24_3ok
arq_24_3_g:
    s_mov_b32 s26, 0
    s_waitcnt vmcnt(0)
    s_branch arq_24_3ok
arq_24_v:
    buffer_load_dwordx4 v[66:69], v0, s[4:7], s22 offen offset:0 sc1
    buffer_load_dwordx4 v[70:73], v0, s[4:7], s22 offen offset:1024 sc1
    v_max3_f32 v2, v12, v13, v14
    v_max3_f32 v3, v15, v16, v17
    v_max3_f32 v2, v2, v18, v19
    v_max3_f32 v3, v3, v20, v21
    v_max_f32 v2, v2, v3
    v_mov_b32 v3, v2
    s_nop 1
    v_permlane16_swap_b32 v3, v2
    v_max_f32 v2, v2, v3
    v_mov_b32 v3, v2
    s_nop 1
    v_permlane32_swap_b32 v3, v2
    v_max_f32 v2, v2, v3
    v_sub_f32 v12, v12, v2
    v_sub_f32 v13, v13, v2
    v_sub_f32 v14, v14, v2
    v_sub_f32 v15, v15, v2
    v_sub_f32 v16, v16, v2
    v_sub_f32 v17, v17, v2
    v_sub_f32 v18, v18, v2
    v_sub_f32 v19, v19, v2
    v_sub_f32 v20, v20, v2
    v_sub_f32 v21, v21, v2
    v_exp_f32 v54, v12
    v_exp_f32 v55, v13
    v_exp_f32 v56, v14
    v_exp_f32 v57, v15
    v_exp_f32 v58, v16
    v_exp_f32 v59, v17
    v_exp_f32 v60, v18
    v_exp_f32 v61, v19
    v_exp_f32 v62, v20
    v_exp_f32 v63, v21
    s_nop 0
    v_cvt_pk_bf16_f32 v154, v54, v55
    v_cvt_pk_bf16_f32 v155, v56, v57
    v_cvt_pk_bf16_f32 v156, v58, v59
    v_cvt_pk_bf16_f32 v157, v60, v61
    v_cvt_pk_bf16_f32 v8, v62, v63
    s_nop 0
    v_mfma_f32_16x16x32_bf16 v[50:53], v[154:157], v[4:7], 0
    v_mfma_f32_16x16x32_bf16 v[50:53], v[8:11], v[4:7], v[50:53]
    v_mfma_f32_16x16x32_bf16 v[24:27], v[154:157], v[82:85], 0
    v_mfma_f32_16x16x32_bf16 v[28:31], v[154:157], v[86:89], 0
    v_mfma_f32_16x16x32_bf16 v[32:35], v[154:157], v[90:93], 0
    v_mfma_f32_16x16x32_bf16 v[36:39], v[154:157], v[94:97], 0
arq_24_vs:
    s_waitcnt vmcnt(0)
    v_max3_u32 v3, v66, v67, v68
    v_max3_u32 v3, v3, v69, v70
    v_max3_u32 v3, v3, v71, v72
    v_max_u32 v3, v3, v73
    v_cmp_eq_u32 vcc, -1, v3
    s_cbranch_vccnz arq_24_vsr
    s_branch arq_24_vsok
arq_24_vsr:
    s_sub_u32 s26, s26, 1
    s_cbranch_scc1 arq_24_vsg
    buffer_load_dwordx4 v[66:69], v0, s[4:7], s22 offen offset:0 sc1
    buffer_load_dwordx4 v[70:73], v0, s[4:7], s22 offen offset:1024 sc1
    s_branch arq_24_vs
arq_24_vsg:
    s_mov_b32 s26, 0
arq_24_vsok:
    v_smfmac_f32_16x16x64_bf16 v[74:77], v[66:69], v[192:199], v41
    v_smfmac_f32_16x16x64_bf16 v[78:81], v[66:69], v[200:207], v41
    v_smfmac_f32_16x16x64_bf16 v[146:149], v[66:69], v[208:215], v41
    v_smfmac_f32_16x16x64_bf16 v[150:153], v[66:69], v[216:223], v41
    v_smfmac_f32_16x16x64_bf16 v[74:77], v[70:73], v[224:231], v41
    v_smfmac_f32_16x16x64_bf16 v[78:81], v[70:73], v[232:239], v41
    v_smfmac_f32_16x16x64_bf16 v[146:149], v[70:73], v[240:247], v41
    v_smfmac_f32_16x16x64_bf16 v[150:153], v[70:73], v[248:255], v41
    v_rcp_f32 v52, v52
    v_rcp_f32 v53, v53
    s_nop 2
    v_add_f32 v74, v74, v75
    v_add_f32 v76, v76, v77
    v_cvt_pk_bf16_f32 v40, v74, v76
    v_add_f32 v78, v78, v79
    v_add_f32 v80, v80, v81
    v_cvt_pk_bf16_f32 v42, v78, v80
    v_add_f32 v146, v146, v147
    v_add_f32 v148, v148, v149
    v_cvt_pk_bf16_f32 v44, v146, v148
    v_add_f32 v150, v150, v151
    v_add_f32 v152, v152, v153
    v_cvt_pk_bf16_f32 v46, v150, v152
    s_nop 1
    v_mfma_f32_16x16x32_bf16 v[24:27], v[8:11], v[40:43], v[24:27]
    v_mfma_f32_16x16x32_bf16 v[28:31], v[8:11], v[42:45], v[28:31]
    v_mfma_f32_16x16x32_bf16 v[32:35], v[8:11], v[44:47], v[32:35]
    v_mfma_f32_16x16x32_bf16 v[36:39], v[8:11], v[46:49], v[36:39]
    s_nop 4
    v_mul_f32 v26, v26, v52
    v_mul_f32 v27, v27, v53
    v_mul_f32 v30, v30, v52
    v_mul_f32 v31, v31, v53
    s_branch aloop_23_pvd
aloop_23_tm:
    s_nop 7
    v_max3_f32 v2, v12, v13, v14
    v_max3_f32 v3, v15, v16, v17
    v_max3_f32 v2, v2, v18, v19
    v_max3_f32 v3, v3, v20, v21
    v_max_f32 v2, v2, v3
    v_mov_b32 v3, v2
    s_nop 1
    v_permlane16_swap_b32 v3, v2
    v_max_f32 v2, v2, v3
    v_mov_b32 v3, v2
    s_nop 1
    v_permlane32_swap_b32 v3, v2
    v_max_f32 v2, v2, v3
    v_sub_f32 v12, v12, v2
    v_sub_f32 v13, v13, v2
    v_sub_f32 v14, v14, v2
    v_sub_f32 v15, v15, v2
    v_sub_f32 v16, v16, v2
    v_sub_f32 v17, v17, v2
    v_sub_f32 v18, v18, v2
    v_sub_f32 v19, v19, v2
    v_sub_f32 v20, v20, v2
    v_sub_f32 v21, v21, v2
    v_exp_f32 v54, v12
    v_exp_f32 v55, v13
    v_exp_f32 v56, v14
    v_exp_f32 v57, v15
    v_exp_f32 v58, v16
    v_exp_f32 v59, v17
    v_exp_f32 v60, v18
    v_exp_f32 v61, v19
    v_exp_f32 v62, v20
    v_exp_f32 v63, v21
    s_nop 0
    v_cvt_pk_bf16_f32 v154, v54, v55
    v_cvt_pk_bf16_f32 v155, v56, v57
    v_cvt_pk_bf16_f32 v156, v58, v59
    v_cvt_pk_bf16_f32 v157, v60, v61
    v_cvt_pk_bf16_f32 v8, v62, v63
    s_nop 0
    v_mfma_f32_16x16x32_bf16 v[50:53], v[154:157], v[4:7], 0
    v_mfma_f32_16x16x32_bf16 v[50:53], v[8:11], v[4:7], v[50:53]
    v_mfma_f32_16x16x32_bf16 v[24:27], v[154:157], v[82:85], 0
    v_mfma_f32_16x16x32_bf16 v[28:31], v[154:157], v[86:89], 0
    v_mfma_f32_16x16x32_bf16 v[32:35], v[154:157], v[90:93], 0
    v_mfma_f32_16x16x32_bf16 v[36:39], v[154:157], v[94:97], 0
    v_mfma_f32_16x16x32_bf16 v[24:27], v[8:11], v[40:43], v[24:27]
    v_mfma_f32_16x16x32_bf16 v[28:31], v[8:11], v[42:45], v[28:31]
    v_mfma_f32_16x16x32_bf16 v[32:35], v[8:11], v[44:47], v[32:35]
    v_mfma_f32_16x16x32_bf16 v[36:39], v[8:11], v[46:49], v[36:39]
    v_rcp_f32 v52, v52
    v_rcp_f32 v53, v53
    s_nop 4
    v_mul_f32 v26, v26, v52
    v_mul_f32 v27, v27, v53
    v_mul_f32 v30, v30, v52
    v_mul_f32 v31, v31, v53
    s_branch aloop_23_pvd
aloop_23_lsk:
arq_24_vl:
    s_waitcnt vmcnt(0)
    v_max3_u32 v3, v66, v67, v68
    v_max3_u32 v3, v3, v69, v70
    v_max3_u32 v3, v3, v71, v72
    v_max_u32 v3, v3, v73
    v_cmp_eq_u32 vcc, -1, v3
    s_cbranch_vccnz arq_24_vlr
    s_branch arq_24_vlok
arq_24_vlr:
    s_sub_u32 s26, s26, 1
    s_cbranch_scc1 arq_24_vlg
    buffer_load_dwordx4 v[66:69], v0, s[4:7], s22 offen offset:0 sc1
    buffer_load_dwordx4 v[70:73], v0, s[4:7], s22 offen offset:1024 sc1
    s_branch arq_24_vl
arq_24_vlg:
    s_mov_b32 s26, 0
arq_24_vlok:
    v_smfmac_f32_16x16x64_bf16 v[74:77], v[66:69], v[192:199], v41
    v_smfmac_f32_16x16x64_bf16 v[78:81], v[66:69], v[200:207], v41
    v_smfmac_f32_16x16x64_bf16 v[146:149], v[66:69], v[208:215], v41
    v_smfmac_f32_16x16x64_bf16 v[150:153], v[66:69], v[216:223], v41
    v_smfmac_f32_16x16x64_bf16 v[74:77], v[70:73], v[224:231], v41
    v_smfmac_f32_16x16x64_bf16 v[78:81], v[70:73], v[232:239], v41
    v_smfmac_f32_16x16x64_bf16 v[146:149], v[70:73], v[240:247], v41
    v_smfmac_f32_16x16x64_bf16 v[150:153], v[70:73], v[248:255], v41
    s_nop 4
    v_add_f32 v74, v74, v75
    v_add_f32 v76, v76, v77
    v_cvt_pk_bf16_f32 v40, v74, v76
    v_add_f32 v78, v78, v79
    v_add_f32 v80, v80, v81
    v_cvt_pk_bf16_f32 v42, v78, v80
    v_add_f32 v146, v146, v147
    v_add_f32 v148, v148, v149
    v_cvt_pk_bf16_f32 v44, v146, v148
    v_add_f32 v150, v150, v151
    v_add_f32 v152, v152, v153
    v_cvt_pk_bf16_f32 v46, v150, v152
    s_branch aloop_23_lskb
arq_24_ps:
    s_sub_u32 s26, s26, 1
    s_cbranch_scc1 arq_24_psg
    s_sleep 2
    buffer_load_dwordx4 v[130:133], v0, s[4:7], s21 offen sc1
    buffer_load_dwordx2 v[146:147], v2, s[4:7], s21 offen offset:1024 sc1
    buffer_load_dwordx4 v[134:137], v0, s[4:7], s21 offen offset:2048 sc1
    buffer_load_dwordx2 v[148:149], v2, s[4:7], s21 offen offset:3072 sc1
    s_branch aloop_23_psa
arq_24_psg:
    s_mov_b32 s26, 0
    s_branch aloop_23_psok
aloop_23_fin:
    s_barrier
    s_branch k_end
k_end:
k_exit:
    s_endpgm
.section .rodata,"a"
.p2align 6
jobtab:
    .long 4, 24, 24, 8192, 0, 262144, 8388608, 0, 32768, 4, 20971520, 131072, 0, 0, 218104320, 1
    .long 4, 24, 24, 8192, 0, 262144, 8388608, 262144, 32768, 4, 22020096, 131072, 0, 0, 218104448, 1
    .long 1, 32, 32, 8192, 0, 256, 8388608, 1048576, 32768, 8, 41943040, 131072, 0, 0, 218104832, 4
    .long 1, 16, 16, 8192, 0, 256, 8388608, 2097152, 32768, 8, 12582912, 131072, 0, 0, 218105344, 4
    .long 1, 32, 32, 8192, 0, 256, 8388608, 3145728, 32768, 8, 50331648, 131072, 0, 0, 218105856, 4
    .long 1, 32, 32, 8192, 0, 256, 8388608, 3670016, 32768, 8, 52428800, 131072, 0, 0, 218106112, 4
    .long 1, 80, 80, 2048, 0, 256, 7340032, 54525952, 114688, 7, 167772160, 32768, 218103808, 7, 218106368, 1
    .long 0, 0, 0, 0, 0, 0, 0, 0, 0, 0, 0, 0, 0, 0, 0, 0
    .long 0, 0, 0, 0, 0, 0, 0, 0, 0, 0, 0, 0, 0, 0, 0, 0
    .long 0, 0, 0, 0, 0, 0, 0, 0, 0, 0, 0, 0, 0, 0, 0, 0
    .long 4, 24, 24, 8192, 2048, 264192, 8388608, 0, 32768, 4, 21004288, 131072, 0, 0, 218104352, 1
    .long 4, 24, 24, 8192, 2048, 264192, 8388608, 262144, 32768, 4, 22052864, 131072, 0, 0, 218104480, 1
    .long 1, 32, 32, 8192, 2048, 2304, 8388608, 1048576, 32768, 8, 41975808, 131072, 0, 0, 218104864, 4
    .long 1, 16, 16, 8192, 2048, 2304, 8388608, 2097152, 32768, 8, 12615680, 131072, 0, 0, 218105376, 4
    .long 1, 32, 32, 8192, 2048, 2304, 8388608, 3145728, 32768, 8, 50364416, 131072, 0, 0, 218105888, 4
    .long 1, 32, 32, 8192, 2048, 2304, 8388608, 3670016, 32768, 8, 52461568, 131072, 0, 0, 218106144, 4
    .long 1, 80, 80, 2048, 512, 768, 7340032, 54525952, 114688, 7, 167780352, 32768, 218103808, 7, 218106368, 1
    .long 0, 0, 0, 0, 0, 0, 0, 0, 0, 0, 0, 0, 0, 0, 0, 0
    .long 0, 0, 0, 0, 0, 0, 0, 0, 0, 0, 0, 0, 0, 0, 0, 0
    .long 0, 0, 0, 0, 0, 0, 0, 0, 0, 0, 0, 0, 0, 0, 0, 0
    .long 4, 24, 24, 8192, 4096, 266240, 8388608, 0, 32768, 4, 21037056, 131072, 0, 0, 218104384, 1
    .long 4, 24, 24, 8192, 4096, 266240, 8388608, 262144, 32768, 4, 22085632, 131072, 0, 0, 218104512, 1
    .long 1, 32, 32, 8192, 4096, 4352, 8388608, 1048576, 32768, 8, 42008576, 131072, 0, 0, 218104896, 4
    .long 1, 16, 16, 8192, 4096, 4352, 8388608, 2097152, 32768, 8, 12648448, 131072, 0, 0, 218105408, 4
    .long 1, 32, 32, 8192, 4096, 4352, 8388608, 3145728, 32768, 8, 50397184, 131072, 0, 0, 218105920, 4
    .long 1, 32, 32, 8192, 4096, 4352, 8388608, 3670016, 32768, 8, 52494336, 131072, 0, 0, 218106176, 4
    .long 1, 80, 80, 2048, 1024, 1280, 7340032, 54525952, 114688, 7, 167788544, 32768, 218103808, 7, 218106368, 1
    .long 0, 0, 0, 0, 0, 0, 0, 0, 0, 0, 0, 0, 0, 0, 0, 0
    .long 0, 0, 0, 0, 0, 0, 0, 0, 0, 0, 0, 0, 0, 0, 0, 0
    .long 0, 0, 0, 0, 0, 0, 0, 0, 0, 0, 0, 0, 0, 0, 0, 0
    .long 4, 24, 24, 8192, 6144, 268288, 8388608, 0, 32768, 4, 21069824, 131072, 0, 0, 218104416, 1
    .long 4, 24, 24, 8192, 6144, 268288, 8388608, 262144, 32768, 4, 22118400, 131072, 0, 0, 218104544, 1
    .long 1, 32, 32, 8192, 6144, 6400, 8388608, 1048576, 32768, 8, 42041344, 131072, 0, 0, 218104928, 4
    .long 1, 16, 16, 8192, 6144, 6400, 8388608, 2097152, 32768, 8, 12681216, 131072, 0, 0, 218105440, 4
    .long 1, 32, 32, 8192, 6144, 6400, 8388608, 3145728, 32768, 8, 50429952, 131072, 0, 0, 218105952, 4
    .long 1, 32, 32, 8192, 6144, 6400, 8388608, 3670016, 32768, 8, 52527104, 131072, 0, 0, 218106208, 4
    .long 1, 80, 80, 2048, 1536, 1792, 7340032, 54525952, 114688, 7, 167796736, 32768, 218103808, 7, 218106368, 1
    .long 0, 0, 0, 0, 0, 0, 0, 0, 0, 0, 0, 0, 0, 0, 0, 0
    .long 0, 0, 0, 0, 0, 0, 0, 0, 0, 0, 0, 0, 0, 0, 0, 0
    .long 0, 0, 0, 0, 0, 0, 0, 0, 0, 0, 0, 0, 0, 0, 0, 0
    .long 4, 24, 24, 8192, 256, 262400, 8388608, 0, 32768, 4, 20975616, 131072, 0, 0, 218104320, 1
    .long 4, 24, 24, 8192, 256, 262400, 8388608, 262144, 32768, 4, 22024192, 131072, 0, 0, 218104448, 1
    .long 1, 32, 32, 8192, 512, 768, 8388608, 1048576, 32768, 8, 41951232, 131072, 0, 0, 218104832, 4
    .long 1, 16, 16, 8192, 512, 768, 8388608, 2097152, 32768, 8, 12591104, 131072, 0, 0, 218105344, 4
    .long 1, 32, 32, 8192, 512, 768, 8388608, 3145728, 32768, 8, 50339840, 131072, 0, 0, 218105856, 4
    .long 1, 32, 32, 8192, 512, 768, 8388608, 3670016, 32768, 8, 52436992, 131072, 0, 0, 218106112, 4
    .long 1, 80, 80, 2048, 1835008, 1835264, 7340032, 54554624, 114688, 7, 171966464, 32768, 218103824, 7, 218106368, 1
    .long 0, 0, 0, 0, 0, 0, 0, 0, 0, 0, 0, 0, 0, 0, 0, 0
    .long 0, 0, 0, 0, 0, 0, 0, 0, 0, 0, 0, 0, 0, 0, 0, 0
    .long 0, 0, 0, 0, 0, 0, 0, 0, 0, 0, 0, 0, 0, 0, 0, 0
    .long 4, 24, 24, 8192, 2304, 264448, 8388608, 0, 32768, 4, 21008384, 131072, 0, 0, 218104352, 1
    .long 4, 24, 24, 8192, 2304, 264448, 8388608, 262144, 32768, 4, 22056960, 131072, 0, 0, 218104480, 1
    .long 1, 32, 32, 8192, 2560, 2816, 8388608, 1048576, 32768, 8, 41984000, 131072, 0, 0, 218104864, 4
    .long 1, 16, 16, 8192, 2560, 2816, 8388608, 2097152, 32768, 8, 12623872, 131072, 0, 0, 218105376, 4
    .long 1, 32, 32, 8192, 2560, 2816, 8388608, 3145728, 32768, 8, 50372608, 131072, 0, 0, 218105888, 4
    .long 1, 32, 32, 8192, 2560, 2816, 8388608, 3670016, 32768, 8, 52469760, 131072, 0, 0, 218106144, 4
    .long 1, 80, 80, 2048, 1835520, 1835776, 7340032, 54554624, 114688, 7, 171974656, 32768, 218103824, 7, 218106368, 1
    .long 0, 0, 0, 0, 0, 0, 0, 0, 0, 0, 0, 0, 0, 0, 0, 0
    .long 0, 0, 0, 0, 0, 0, 0, 0, 0, 0, 0, 0, 0, 0, 0, 0
    .long 0, 0, 0, 0, 0, 0, 0, 0, 0, 0, 0, 0, 0, 0, 0, 0
    .long 4, 24, 24, 8192, 4352, 266496, 8388608, 0, 32768, 4, 21041152, 131072, 0, 0, 218104384, 1
    .long 4, 24, 24, 8192, 4352, 266496, 8388608, 262144, 32768, 4, 22089728, 131072, 0, 0, 218104512, 1
    .long 1, 32, 32, 8192, 4608, 4864, 8388608, 1048576, 32768, 8, 42016768, 131072, 0, 0, 218104896, 4
    .long 1, 16, 16, 8192, 4608, 4864, 8388608, 2097152, 32768, 8, 12656640, 131072, 0, 0, 218105408, 4
    .long 1, 32, 32, 8192, 4608, 4864, 8388608, 3145728, 32768, 8, 50405376, 131072, 0, 0, 218105920, 4
    .long 1, 32, 32, 8192, 4608, 4864, 8388608, 3670016, 32768, 8, 52502528, 131072, 0, 0, 218106176, 4
    .long 1, 80, 80, 2048, 1836032, 1836288, 7340032, 54554624, 114688, 7, 171982848, 32768, 218103824, 7, 218106368, 1
    .long 0, 0, 0, 0, 0, 0, 0, 0, 0, 0, 0, 0, 0, 0, 0, 0
    .long 0, 0, 0, 0, 0, 0, 0, 0, 0, 0, 0, 0, 0, 0, 0, 0
    .long 0, 0, 0, 0, 0, 0, 0, 0, 0, 0, 0, 0, 0, 0, 0, 0
    .long 4, 24, 24, 8192, 6400, 268544, 8388608, 0, 32768, 4, 21073920, 131072, 0, 0, 218104416, 1
    .long 4, 24, 24, 8192, 6400, 268544, 8388608, 262144, 32768, 4, 22122496, 131072, 0, 0, 218104544, 1
    .long 1, 32, 32, 8192, 6656, 6912, 8388608, 1048576, 32768, 8, 42049536, 131072, 0, 0, 218104928, 4
    .long 1, 16, 16, 8192, 6656, 6912, 8388608, 2097152, 32768, 8, 12689408, 131072, 0, 0, 218105440, 4
    .long 1, 32, 32, 8192, 6656, 6912, 8388608, 3145728, 32768, 8, 50438144, 131072, 0, 0, 218105952, 4
    .long 1, 32, 32, 8192, 6656, 6912, 8388608, 3670016, 32768, 8, 52535296, 131072, 0, 0, 218106208, 4
    .long 1, 80, 80, 2048, 1836544, 1836800, 7340032, 54554624, 114688, 7, 171991040, 32768, 218103824, 7, 218106368, 1
    .long 0, 0, 0, 0, 0, 0, 0, 0, 0, 0, 0, 0, 0, 0, 0, 0
    .long 0, 0, 0, 0, 0, 0, 0, 0, 0, 0, 0, 0, 0, 0, 0, 0
    .long 0, 0, 0, 0, 0, 0, 0, 0, 0, 0, 0, 0, 0, 0, 0, 0
    .long 4, 24, 24, 8192, 512, 262656, 8388608, 0, 32768, 4, 20979712, 131072, 0, 0, 218104320, 1
    .long 4, 24, 24, 8192, 512, 262656, 8388608, 262144, 32768, 4, 22028288, 131072, 0, 0, 218104448, 1
    .long 1, 32, 32, 8192, 1024, 1280, 8388608, 1048576, 32768, 8, 41959424, 131072, 0, 0, 218104848, 4
    .long 1, 16, 16, 8192, 1024, 1280, 8388608, 2097152, 32768, 8, 12599296, 131072, 0, 0, 218105360, 4
    .long 1, 32, 32, 8192, 1024, 1280, 8388608, 3145728, 32768, 8, 50348032, 131072, 0, 0, 218105872, 4
    .long 1, 32, 32, 8192, 1024, 1280, 8388608, 3670016, 32768, 8, 52445184, 131072, 0, 0, 218106128, 4
    .long 1, 80, 80, 2048, 3670016, 3670272, 7340032, 54583296, 114688, 7, 176160768, 32768, 218103840, 7, 218106368, 1
    .long 0, 0, 0, 0, 0, 0, 0, 0, 0, 0, 0, 0, 0, 0, 0, 0
    .long 0, 0, 0, 0, 0, 0, 0, 0, 0, 0, 0, 0, 0, 0, 0, 0
    .long 0, 0, 0, 0, 0, 0, 0, 0, 0, 0, 0, 0, 0, 0, 0, 0
    .long 4, 24, 24, 8192, 2560, 264704, 8388608, 0, 32768, 4, 21012480, 131072, 0, 0, 218104352, 1
    .long 4, 24, 24, 8192, 2560, 264704, 8388608, 262144, 32768, 4, 22061056, 131072, 0, 0, 218104480, 1
    .long 1, 32, 32, 8192, 3072, 3328, 8388608, 1048576, 32768, 8, 41992192, 131072, 0, 0, 218104880, 4
    .long 1, 16, 16, 8192, 3072, 3328, 8388608, 2097152, 32768, 8, 12632064, 131072, 0, 0, 218105392, 4
    .long 1, 32, 32, 8192, 3072, 3328, 8388608, 3145728, 32768, 8, 50380800, 131072, 0, 0, 218105904, 4
    .long 1, 32, 32, 8192, 3072, 3328, 8388608, 3670016, 32768, 8, 52477952, 131072, 0, 0, 218106160, 4
    .long 1, 80, 80, 2048, 3670528, 3670784, 7340032, 54583296, 114688, 7, 176168960, 32768, 218103840, 7, 218106368, 1
    .long 0, 0, 0, 0, 0, 0, 0, 0, 0, 0, 0, 0, 0, 0, 0, 0
    .long 0, 0, 0, 0, 0, 0, 0, 0, 0, 0, 0, 0, 0, 0, 0, 0
    .long 0, 0, 0, 0, 0, 0, 0, 0, 0, 0, 0, 0, 0, 0, 0, 0
    .long 4, 24, 24, 8192, 4608, 266752, 8388608, 0, 32768, 4, 21045248, 131072, 0, 0, 218104384, 1
    .long 4, 24, 24, 8192, 4608, 266752, 8388608, 262144, 32768, 4, 22093824, 131072, 0, 0, 218104512, 1
    .long 1, 32, 32, 8192, 5120, 5376, 8388608, 1048576, 32768, 8, 42024960, 131072, 0, 0, 218104912, 4
    .long 1, 16, 16, 8192, 5120, 5376, 8388608, 2097152, 32768, 8, 12664832, 131072, 0, 0, 218105424, 4
    .long 1, 32, 32, 8192, 5120, 5376, 8388608, 3145728, 32768, 8, 50413568, 131072, 0, 0, 218105936, 4
    .long 1, 32, 32, 8192, 5120, 5376, 8388608, 3670016, 32768, 8, 52510720, 131072, 0, 0, 218106192, 4
    .long 1, 80, 80, 2048, 3671040, 3671296, 7340032, 54583296, 114688, 7, 176177152, 32768, 218103840, 7, 218106368, 1
    .long 0, 0, 0, 0, 0, 0, 0, 0, 0, 0, 0, 0, 0, 0, 0, 0
    .long 0, 0, 0, 0, 0, 0, 0, 0, 0, 0, 0, 0, 0, 0, 0, 0
    .long 0, 0, 0, 0, 0, 0, 0, 0, 0, 0, 0, 0, 0, 0, 0, 0
    .long 4, 24, 24, 8192, 6656, 268800, 8388608, 0, 32768, 4, 21078016, 131072, 0, 0, 218104416, 1
    .long 4, 24, 24, 8192, 6656, 268800, 8388608, 262144, 32768, 4, 22126592, 131072, 0, 0, 218104544, 1
    .long 1, 32, 32, 8192, 7168, 7424, 8388608, 1048576, 32768, 8, 42057728, 131072, 0, 0, 218104944, 4
    .long 1, 16, 16, 8192, 7168, 7424, 8388608, 2097152, 32768, 8, 12697600, 131072, 0, 0, 218105456, 4
    .long 1, 32, 32, 8192, 7168, 7424, 8388608, 3145728, 32768, 8, 50446336, 131072, 0, 0, 218105968, 4
    .long 1, 32, 32, 8192, 7168, 7424, 8388608, 3670016, 32768, 8, 52543488, 131072, 0, 0, 218106224, 4
    .long 1, 80, 80, 2048, 3671552, 3671808, 7340032, 54583296, 114688, 7, 176185344, 32768, 218103840, 7, 218106368, 1
    .long 0, 0, 0, 0, 0, 0, 0, 0, 0, 0, 0, 0, 0, 0, 0, 0
    .long 0, 0, 0, 0, 0, 0, 0, 0, 0, 0, 0, 0, 0, 0, 0, 0
    .long 0, 0, 0, 0, 0, 0, 0, 0, 0, 0, 0, 0, 0, 0, 0, 0
    .long 4, 24, 24, 8192, 768, 262912, 8388608, 0, 32768, 4, 20983808, 131072, 0, 0, 218104320, 1
    .long 4, 24, 24, 8192, 768, 262912, 8388608, 262144, 32768, 4, 22032384, 131072, 0, 0, 218104448, 1
    .long 1, 32, 32, 8192, 1536, 1792, 8388608, 1048576, 32768, 8, 41967616, 131072, 0, 0, 218104848, 4
    .long 1, 16, 16, 8192, 1536, 1792, 8388608, 2097152, 32768, 8, 12607488, 131072, 0, 0, 218105360, 4
    .long 1, 32, 32, 8192, 1536, 1792, 8388608, 3145728, 32768, 8, 50356224, 131072, 0, 0, 218105872, 4
    .long 1, 32, 32, 8192, 1536, 1792, 8388608, 3670016, 32768, 8, 52453376, 131072, 0, 0, 218106128, 4
    .long 1, 80, 80, 2048, 5505024, 5505280, 7340032, 54611968, 114688, 7, 180355072, 32768, 218103856, 7, 218106368, 1
    .long 0, 0, 0, 0, 0, 0, 0, 0, 0, 0, 0, 0, 0, 0, 0, 0
    .long 0, 0, 0, 0, 0, 0, 0, 0, 0, 0, 0, 0, 0, 0, 0, 0
    .long 0, 0, 0, 0, 0, 0, 0, 0, 0, 0, 0, 0, 0, 0, 0, 0
    .long 4, 24, 24, 8192, 2816, 264960, 8388608, 0, 32768, 4, 21016576, 131072, 0, 0, 218104352, 1
    .long 4, 24, 24, 8192, 2816, 264960, 8388608, 262144, 32768, 4, 22065152, 131072, 0, 0, 218104480, 1
    .long 1, 32, 32, 8192, 3584, 3840, 8388608, 1048576, 32768, 8, 42000384, 131072, 0, 0, 218104880, 4
    .long 1, 16, 16, 8192, 3584, 3840, 8388608, 2097152, 32768, 8, 12640256, 131072, 0, 0, 218105392, 4
    .long 1, 32, 32, 8192, 3584, 3840, 8388608, 3145728, 32768, 8, 50388992, 131072, 0, 0, 218105904, 4
    .long 1, 32, 32, 8192, 3584, 3840, 8388608, 3670016, 32768, 8, 52486144, 131072, 0, 0, 218106160, 4
    .long 1, 80, 80, 2048, 5505536, 5505792, 7340032, 54611968, 114688, 7, 180363264, 32768, 218103856, 7, 218106368, 1
    .long 0, 0, 0, 0, 0, 0, 0, 0, 0, 0, 0, 0, 0, 0, 0, 0
    .long 0, 0, 0, 0, 0, 0, 0, 0, 0, 0, 0, 0, 0, 0, 0, 0
    .long 0, 0, 0, 0, 0, 0, 0, 0, 0, 0, 0, 0, 0, 0, 0, 0
    .long 4, 24, 24, 8192, 4864, 267008, 8388608, 0, 32768, 4, 21049344, 131072, 0, 0, 218104384, 1
    .long 4, 24, 24, 8192, 4864, 267008, 8388608, 262144, 32768, 4, 22097920, 131072, 0, 0, 218104512, 1
    .long 1, 32, 32, 8192, 5632, 5888, 8388608, 1048576, 32768, 8, 42033152, 131072, 0, 0, 218104912, 4
    .long 1, 16, 16, 8192, 5632, 5888, 8388608, 2097152, 32768, 8, 12673024, 131072, 0, 0, 218105424, 4
    .long 1, 32, 32, 8192, 5632, 5888, 8388608, 3145728, 32768, 8, 50421760, 131072, 0, 0, 218105936, 4
    .long 1, 32, 32, 8192, 5632, 5888, 8388608, 3670016, 32768, 8, 52518912, 131072, 0, 0, 218106192, 4
    .long 1, 80, 80, 2048, 5506048, 5506304, 7340032, 54611968, 114688, 7, 180371456, 32768, 218103856, 7, 218106368, 1
    .long 0, 0, 0, 0, 0, 0, 0, 0, 0, 0, 0, 0, 0, 0, 0, 0
    .long 0, 0, 0, 0, 0, 0, 0, 0, 0, 0, 0, 0, 0, 0, 0, 0
    .long 0, 0, 0, 0, 0, 0, 0, 0, 0, 0, 0, 0, 0, 0, 0, 0
    .long 4, 24, 24, 8192, 6912, 269056, 8388608, 0, 32768, 4, 21082112, 131072, 0, 0, 218104416, 1
    .long 4, 24, 24, 8192, 6912, 269056, 8388608, 262144, 32768, 4, 22130688, 131072, 0, 0, 218104544, 1
    .long 1, 32, 32, 8192, 7680, 7936, 8388608, 1048576, 32768, 8, 42065920, 131072, 0, 0, 218104944, 4
    .long 1, 16, 16, 8192, 7680, 7936, 8388608, 2097152, 32768, 8, 12705792, 131072, 0, 0, 218105456, 4
    .long 1, 32, 32, 8192, 7680, 7936, 8388608, 3145728, 32768, 8, 50454528, 131072, 0, 0, 218105968, 4
    .long 1, 32, 32, 8192, 7680, 7936, 8388608, 3670016, 32768, 8, 52551680, 131072, 0, 0, 218106224, 4
    .long 1, 80, 80, 2048, 5506560, 5506816, 7340032, 54611968, 114688, 7, 180379648, 32768, 218103856, 7, 218106368, 1
    .long 0, 0, 0, 0, 0, 0, 0, 0, 0, 0, 0, 0, 0, 0, 0, 0
    .long 0, 0, 0, 0, 0, 0, 0, 0, 0, 0, 0, 0, 0, 0, 0, 0
    .long 0, 0, 0, 0, 0, 0, 0, 0, 0, 0, 0, 0, 0, 0, 0, 0
    .long 4, 24, 24, 8192, 1024, 263168, 8388608, 0, 32768, 4, 20987904, 131072, 0, 0, 218104336, 1
    .long 4, 24, 24, 8192, 1024, 263168, 8388608, 262144, 32768, 4, 22036480, 131072, 0, 0, 218104464, 1
    .long 1, 24, 24, 8192, 0, 256, 8388608, 1048576, 32768, 8, 25165824, 131072, 0, 0, 218104832, 4
    .long 1, 32, 32, 8192, 0, 256, 8388608, 2621440, 32768, 8, 48234496, 131072, 0, 0, 218105600, 4
    .long 1, 24, 24, 8192, 0, 256, 8388608, 3145728, 32768, 8, 33554432, 131072, 0, 0, 218105856, 4
    .long 1, 24, 24, 8192, 0, 256, 8388608, 3670016, 32768, 8, 35651584, 131072, 0, 0, 218106112, 4
    .long 1, 80, 80, 2048, 0, 256, 7340032, 56360960, 114688, 7, 168296448, 32768, 218103872, 7, 218106432, 1
    .long 0, 0, 0, 0, 0, 0, 0, 0, 0, 0, 0, 0, 0, 0, 0, 0
    .long 0, 0, 0, 0, 0, 0, 0, 0, 0, 0, 0, 0, 0, 0, 0, 0
    .long 0, 0, 0, 0, 0, 0, 0, 0, 0, 0, 0, 0, 0, 0, 0, 0
    .long 4, 24, 24, 8192, 3072, 265216, 8388608, 0, 32768, 4, 21020672, 131072, 0, 0, 218104368, 1
    .long 4, 24, 24, 8192, 3072, 265216, 8388608, 262144, 32768, 4, 22069248, 131072, 0, 0, 218104496, 1
    .long 1, 24, 24, 8192, 2048, 2304, 8388608, 1048576, 32768, 8, 25198592, 131072, 0, 0, 218104864, 4
    .long 1, 32, 32, 8192, 2048, 2304, 8388608, 2621440, 32768, 8, 48267264, 131072, 0, 0, 218105632, 4
    .long 1, 24, 24, 8192, 2048, 2304, 8388608, 3145728, 32768, 8, 33587200, 131072, 0, 0, 218105888, 4
    .long 1, 24, 24, 8192, 2048, 2304, 8388608, 3670016, 32768, 8, 35684352, 131072, 0, 0, 218106144, 4
    .long 1, 80, 80, 2048, 512, 768, 7340032, 56360960, 114688, 7, 168304640, 32768, 218103872, 7, 218106432, 1
    .long 0, 0, 0, 0, 0, 0, 0, 0, 0, 0, 0, 0, 0, 0, 0, 0
    .long 0, 0, 0, 0, 0, 0, 0, 0, 0, 0, 0, 0, 0, 0, 0, 0
    .long 0, 0, 0, 0, 0, 0, 0, 0, 0, 0, 0, 0, 0, 0, 0, 0
    .long 4, 24, 24, 8192, 5120, 267264, 8388608, 0, 32768, 4, 21053440, 131072, 0, 0, 218104400, 1
    .long 4, 24, 24, 8192, 5120, 267264, 8388608, 262144, 32768, 4, 22102016, 131072, 0, 0, 218104528, 1
    .long 1, 24, 24, 8192, 4096, 4352, 8388608, 1048576, 32768, 8, 25231360, 131072, 0, 0, 218104896, 4
    .long 1, 32, 32, 8192, 4096, 4352, 8388608, 2621440, 32768, 8, 48300032, 131072, 0, 0, 218105664, 4
    .long 1, 24, 24, 8192, 4096, 4352, 8388608, 3145728, 32768, 8, 33619968, 131072, 0, 0, 218105920, 4
    .long 1, 24, 24, 8192, 4096, 4352, 8388608, 3670016, 32768, 8, 35717120, 131072, 0, 0, 218106176, 4
    .long 1, 80, 80, 2048, 1024, 1280, 7340032, 56360960, 114688, 7, 168312832, 32768, 218103872, 7, 218106432, 1
    .long 0, 0, 0, 0, 0, 0, 0, 0, 0, 0, 0, 0, 0, 0, 0, 0
    .long 0, 0, 0, 0, 0, 0, 0, 0, 0, 0, 0, 0, 0, 0, 0, 0
    .long 0, 0, 0, 0, 0, 0, 0, 0, 0, 0, 0, 0, 0, 0, 0, 0
    .long 4, 24, 24, 8192, 7168, 269312, 8388608, 0, 32768, 4, 21086208, 131072, 0, 0, 218104432, 1
    .long 4, 24, 24, 8192, 7168, 269312, 8388608, 262144, 32768, 4, 22134784, 131072, 0, 0, 218104560, 1
    .long 1, 24, 24, 8192, 6144, 6400, 8388608, 1048576, 32768, 8, 25264128, 131072, 0, 0, 218104928, 4
    .long 1, 32, 32, 8192, 6144, 6400, 8388608, 2621440, 32768, 8, 48332800, 131072, 0, 0, 218105696, 4
    .long 1, 24, 24, 8192, 6144, 6400, 8388608, 3145728, 32768, 8, 33652736, 131072, 0, 0, 218105952, 4
    .long 1, 24, 24, 8192, 6144, 6400, 8388608, 3670016, 32768, 8, 35749888, 131072, 0, 0, 218106208, 4
    .long 1, 80, 80, 2048, 1536, 1792, 7340032, 56360960, 114688, 7, 168321024, 32768, 218103872, 7, 218106432, 1
    .long 0, 0, 0, 0, 0, 0, 0, 0, 0, 0, 0, 0, 0, 0, 0, 0
    .long 0, 0, 0, 0, 0, 0, 0, 0, 0, 0, 0, 0, 0, 0, 0, 0
    .long 0, 0, 0, 0, 0, 0, 0, 0, 0, 0, 0, 0, 0, 0, 0, 0
    .long 4, 24, 24, 8192, 1280, 263424, 8388608, 0, 32768, 4, 20992000, 131072, 0, 0, 218104336, 1
    .long 4, 24, 24, 8192, 1280, 263424, 8388608, 262144, 32768, 4, 22040576, 131072, 0, 0, 218104464, 1
    .long 1, 24, 24, 8192, 512, 768, 8388608, 1048576, 32768, 8, 25174016, 131072, 0, 0, 218104832, 4
    .long 1, 32, 32, 8192, 512, 768, 8388608, 2621440, 32768, 8, 48242688, 131072, 0, 0, 218105600, 4
    .long 1, 24, 24, 8192, 512, 768, 8388608, 3145728, 32768, 8, 33562624, 131072, 0, 0, 218105856, 4
    .long 1, 24, 24, 8192, 512, 768, 8388608, 3670016, 32768, 8, 35659776, 131072, 0, 0, 218106112, 4
    .long 1, 80, 80, 2048, 1835008, 1835264, 7340032, 56389632, 114688, 7, 172490752, 32768, 218103888, 7, 218106432, 1
    .long 0, 0, 0, 0, 0, 0, 0, 0, 0, 0, 0, 0, 0, 0, 0, 0
    .long 0, 0, 0, 0, 0, 0, 0, 0, 0, 0, 0, 0, 0, 0, 0, 0
    .long 0, 0, 0, 0, 0, 0, 0, 0, 0, 0, 0, 0, 0, 0, 0, 0
    .long 4, 24, 24, 8192, 3328, 265472, 8388608, 0, 32768, 4, 21024768, 131072, 0, 0, 218104368, 1
    .long 4, 24, 24, 8192, 3328, 265472, 8388608, 262144, 32768, 4, 22073344, 131072, 0, 0, 218104496, 1
    .long 1, 24, 24, 8192, 2560, 2816, 8388608, 1048576, 32768, 8, 25206784, 131072, 0, 0, 218104864, 4
    .long 1, 32, 32, 8192, 2560, 2816, 8388608, 2621440, 32768, 8, 48275456, 131072, 0, 0, 218105632, 4
    .long 1, 24, 24, 8192, 2560, 2816, 8388608, 3145728, 32768, 8, 33595392, 131072, 0, 0, 218105888, 4
    .long 1, 24, 24, 8192, 2560, 2816, 8388608, 3670016, 32768, 8, 35692544, 131072, 0, 0, 218106144, 4
    .long 1, 80, 80, 2048, 1835520, 1835776, 7340032, 56389632, 114688, 7, 172498944, 32768, 218103888, 7, 218106432, 1
    .long 0, 0, 0, 0, 0, 0, 0, 0, 0, 0, 0, 0, 0, 0, 0, 0
    .long 0, 0, 0, 0, 0, 0, 0, 0, 0, 0, 0, 0, 0, 0, 0, 0
    .long 0, 0, 0, 0, 0, 0, 0, 0, 0, 0, 0, 0, 0, 0, 0, 0
    .long 4, 24, 24, 8192, 5376, 267520, 8388608, 0, 32768, 4, 21057536, 131072, 0, 0, 218104400, 1
    .long 4, 24, 24, 8192, 5376, 267520, 8388608, 262144, 32768, 4, 22106112, 131072, 0, 0, 218104528, 1
    .long 1, 24, 24, 8192, 4608, 4864, 8388608, 1048576, 32768, 8, 25239552, 131072, 0, 0, 218104896, 4
    .long 1, 32, 32, 8192, 4608, 4864, 8388608, 2621440, 32768, 8, 48308224, 131072, 0, 0, 218105664, 4
    .long 1, 24, 24, 8192, 4608, 4864, 8388608, 3145728, 32768, 8, 33628160, 131072, 0, 0, 218105920, 4
    .long 1, 24, 24, 8192, 4608, 4864, 8388608, 3670016, 32768, 8, 35725312, 131072, 0, 0, 218106176, 4
    .long 1, 80, 80, 2048, 1836032, 1836288, 7340032, 56389632, 114688, 7, 172507136, 32768, 218103888, 7, 218106432, 1
    .long 0, 0, 0, 0, 0, 0, 0, 0, 0, 0, 0, 0, 0, 0, 0, 0
    .long 0, 0, 0, 0, 0, 0, 0, 0, 0, 0, 0, 0, 0, 0, 0, 0
    .long 0, 0, 0, 0, 0, 0, 0, 0, 0, 0, 0, 0, 0, 0, 0, 0
    .long 4, 24, 24, 8192, 7424, 269568, 8388608, 0, 32768, 4, 21090304, 131072, 0, 0, 218104432, 1
    .long 4, 24, 24, 8192, 7424, 269568, 8388608, 262144, 32768, 4, 22138880, 131072, 0, 0, 218104560, 1
    .long 1, 24, 24, 8192, 6656, 6912, 8388608, 1048576, 32768, 8, 25272320, 131072, 0, 0, 218104928, 4
    .long 1, 32, 32, 8192, 6656, 6912, 8388608, 2621440, 32768, 8, 48340992, 131072, 0, 0, 218105696, 4
    .long 1, 24, 24, 8192, 6656, 6912, 8388608, 3145728, 32768, 8, 33660928, 131072, 0, 0, 218105952, 4
    .long 1, 24, 24, 8192, 6656, 6912, 8388608, 3670016, 32768, 8, 35758080, 131072, 0, 0, 218106208, 4
    .long 1, 80, 80, 2048, 1836544, 1836800, 7340032, 56389632, 114688, 7, 172515328, 32768, 218103888, 7, 218106432, 1
    .long 0, 0, 0, 0, 0, 0, 0, 0, 0, 0, 0, 0, 0, 0, 0, 0
    .long 0, 0, 0, 0, 0, 0, 0, 0, 0, 0, 0, 0, 0, 0, 0, 0
    .long 0, 0, 0, 0, 0, 0, 0, 0, 0, 0, 0, 0, 0, 0, 0, 0
    .long 4, 24, 24, 8192, 1536, 263680, 8388608, 0, 32768, 4, 20996096, 131072, 0, 0, 218104336, 1
    .long 4, 24, 24, 8192, 1536, 263680, 8388608, 262144, 32768, 4, 22044672, 131072, 0, 0, 218104464, 1
    .long 1, 24, 24, 8192, 1024, 1280, 8388608, 1048576, 32768, 8, 25182208, 131072, 0, 0, 218104848, 4
    .long 1, 32, 32, 8192, 1024, 1280, 8388608, 2621440, 32768, 8, 48250880, 131072, 0, 0, 218105616, 4
    .long 1, 24, 24, 8192, 1024, 1280, 8388608, 3145728, 32768, 8, 33570816, 131072, 0, 0, 218105872, 4
    .long 1, 24, 24, 8192, 1024, 1280, 8388608, 3670016, 32768, 8, 35667968, 131072, 0, 0, 218106128, 4
    .long 1, 80, 80, 2048, 3670016, 3670272, 7340032, 56418304, 114688, 7, 176685056, 32768, 218103904, 7, 218106432, 1
    .long 0, 0, 0, 0, 0, 0, 0, 0, 0, 0, 0, 0, 0, 0, 0, 0
    .long 0, 0, 0, 0, 0, 0, 0, 0, 0, 0, 0, 0, 0, 0, 0, 0
    .long 0, 0, 0, 0, 0, 0, 0, 0, 0, 0, 0, 0, 0, 0, 0, 0
    .long 4, 24, 24, 8192, 3584, 265728, 8388608, 0, 32768, 4, 21028864, 131072, 0, 0, 218104368, 1
    .long 4, 24, 24, 8192, 3584, 265728, 8388608, 262144, 32768, 4, 22077440, 131072, 0, 0, 218104496, 1
    .long 1, 24, 24, 8192, 3072, 3328, 8388608, 1048576, 32768, 8, 25214976, 131072, 0, 0, 218104880, 4
    .long 1, 32, 32, 8192, 3072, 3328, 8388608, 2621440, 32768, 8, 48283648, 131072, 0, 0, 218105648, 4
    .long 1, 24, 24, 8192, 3072, 3328, 8388608, 3145728, 32768, 8, 33603584, 131072, 0, 0, 218105904, 4
    .long 1, 24, 24, 8192, 3072, 3328, 8388608, 3670016, 32768, 8, 35700736, 131072, 0, 0, 218106160, 4
    .long 1, 80, 80, 2048, 3670528, 3670784, 7340032, 56418304, 114688, 7, 176693248, 32768, 218103904, 7, 218106432, 1
    .long 0, 0, 0, 0, 0, 0, 0, 0, 0, 0, 0, 0, 0, 0, 0, 0
    .long 0, 0, 0, 0, 0, 0, 0, 0, 0, 0, 0, 0, 0, 0, 0, 0
    .long 0, 0, 0, 0, 0, 0, 0, 0, 0, 0, 0, 0, 0, 0, 0, 0
    .long 4, 24, 24, 8192, 5632, 267776, 8388608, 0, 32768, 4, 21061632, 131072, 0, 0, 218104400, 1
    .long 4, 24, 24, 8192, 5632, 267776, 8388608, 262144, 32768, 4, 22110208, 131072, 0, 0, 218104528, 1
    .long 1, 24, 24, 8192, 5120, 5376, 8388608, 1048576, 32768, 8, 25247744, 131072, 0, 0, 218104912, 4
    .long 1, 32, 32, 8192, 5120, 5376, 8388608, 2621440, 32768, 8, 48316416, 131072, 0, 0, 218105680, 4
    .long 1, 24, 24, 8192, 5120, 5376, 8388608, 3145728, 32768, 8, 33636352, 131072, 0, 0, 218105936, 4
    .long 1, 24, 24, 8192, 5120, 5376, 8388608, 3670016, 32768, 8, 35733504, 131072, 0, 0, 218106192, 4
    .long 1, 80, 80, 2048, 3671040, 3671296, 7340032, 56418304, 114688, 7, 176701440, 32768, 218103904, 7, 218106432, 1
    .long 0, 0, 0, 0, 0, 0, 0, 0, 0, 0, 0, 0, 0, 0, 0, 0
    .long 0, 0, 0, 0, 0, 0, 0, 0, 0, 0, 0, 0, 0, 0, 0, 0
    .long 0, 0, 0, 0, 0, 0, 0, 0, 0, 0, 0, 0, 0, 0, 0, 0
    .long 4, 24, 24, 8192, 7680, 269824, 8388608, 0, 32768, 4, 21094400, 131072, 0, 0, 218104432, 1
    .long 4, 24, 24, 8192, 7680, 269824, 8388608, 262144, 32768, 4, 22142976, 131072, 0, 0, 218104560, 1
    .long 1, 24, 24, 8192, 7168, 7424, 8388608, 1048576, 32768, 8, 25280512, 131072, 0, 0, 218104944, 4
    .long 1, 32, 32, 8192, 7168, 7424, 8388608, 2621440, 32768, 8, 48349184, 131072, 0, 0, 218105712, 4
    .long 1, 24, 24, 8192, 7168, 7424, 8388608, 3145728, 32768, 8, 33669120, 131072, 0, 0, 218105968, 4
    .long 1, 24, 24, 8192, 7168, 7424, 8388608, 3670016, 32768, 8, 35766272, 131072, 0, 0, 218106224, 4
    .long 1, 80, 80, 2048, 3671552, 3671808, 7340032, 56418304, 114688, 7, 176709632, 32768, 218103904, 7, 218106432, 1
    .long 0, 0, 0, 0, 0, 0, 0, 0, 0, 0, 0, 0, 0, 0, 0, 0
    .long 0, 0, 0, 0, 0, 0, 0, 0, 0, 0, 0, 0, 0, 0, 0, 0
    .long 0, 0, 0, 0, 0, 0, 0, 0, 0, 0, 0, 0, 0, 0, 0, 0
    .long 4, 24, 24, 8192, 1792, 263936, 8388608, 0, 32768, 4, 21000192, 131072, 0, 0, 218104336, 1
    .long 4, 24, 24, 8192, 1792, 263936, 8388608, 262144, 32768, 4, 22048768, 131072, 0, 0, 218104464, 1
    .long 1, 24, 24, 8192, 1536, 1792, 8388608, 1048576, 32768, 8, 25190400, 131072, 0, 0, 218104848, 4
    .long 1, 32, 32, 8192, 1536, 1792, 8388608, 2621440, 32768, 8, 48259072, 131072, 0, 0, 218105616, 4
    .long 1, 24, 24, 8192, 1536, 1792, 8388608, 3145728, 32768, 8, 33579008, 131072, 0, 0, 218105872, 4
    .long 1, 24, 24, 8192, 1536, 1792, 8388608, 3670016, 32768, 8, 35676160, 131072, 0, 0, 218106128, 4
    .long 1, 80, 80, 2048, 5505024, 5505280, 7340032, 56446976, 114688, 7, 180879360, 32768, 218103920, 7, 218106432, 1
    .long 0, 0, 0, 0, 0, 0, 0, 0, 0, 0, 0, 0, 0, 0, 0, 0
    .long 0, 0, 0, 0, 0, 0, 0, 0, 0, 0, 0, 0, 0, 0, 0, 0
    .long 0, 0, 0, 0, 0, 0, 0, 0, 0, 0, 0, 0, 0, 0, 0, 0
    .long 4, 24, 24, 8192, 3840, 265984, 8388608, 0, 32768, 4, 21032960, 131072, 0, 0, 218104368, 1
    .long 4, 24, 24, 8192, 3840, 265984, 8388608, 262144, 32768, 4, 22081536, 131072, 0, 0, 218104496, 1
    .long 1, 24, 24, 8192, 3584, 3840, 8388608, 1048576, 32768, 8, 25223168, 131072, 0, 0, 218104880, 4
    .long 1, 32, 32, 8192, 3584, 3840, 8388608, 2621440, 32768, 8, 48291840, 131072, 0, 0, 218105648, 4
    .long 1, 24, 24, 8192, 3584, 3840, 8388608, 3145728, 32768, 8, 33611776, 131072, 0, 0, 218105904, 4
    .long 1, 24, 24, 8192, 3584, 3840, 8388608, 3670016, 32768, 8, 35708928, 131072, 0, 0, 218106160, 4
    .long 1, 80, 80, 2048, 5505536, 5505792, 7340032, 56446976, 114688, 7, 180887552, 32768, 218103920, 7, 218106432, 1
    .long 0, 0, 0, 0, 0, 0, 0, 0, 0, 0, 0, 0, 0, 0, 0, 0
    .long 0, 0, 0, 0, 0, 0, 0, 0, 0, 0, 0, 0, 0, 0, 0, 0
    .long 0, 0, 0, 0, 0, 0, 0, 0, 0, 0, 0, 0, 0, 0, 0, 0
    .long 4, 24, 24, 8192, 5888, 268032, 8388608, 0, 32768, 4, 21065728, 131072, 0, 0, 218104400, 1
    .long 4, 24, 24, 8192, 5888, 268032, 8388608, 262144, 32768, 4, 22114304, 131072, 0, 0, 218104528, 1
    .long 1, 24, 24, 8192, 5632, 5888, 8388608, 1048576, 32768, 8, 25255936, 131072, 0, 0, 218104912, 4
    .long 1, 32, 32, 8192, 5632, 5888, 8388608, 2621440, 32768, 8, 48324608, 131072, 0, 0, 218105680, 4
    .long 1, 24, 24, 8192, 5632, 5888, 8388608, 3145728, 32768, 8, 33644544, 131072, 0, 0, 218105936, 4
    .long 1, 24, 24, 8192, 5632, 5888, 8388608, 3670016, 32768, 8, 35741696, 131072, 0, 0, 218106192, 4
    .long 1, 80, 80, 2048, 5506048, 5506304, 7340032, 56446976, 114688, 7, 180895744, 32768, 218103920, 7, 218106432, 1
    .long 0, 0, 0, 0, 0, 0, 0, 0, 0, 0, 0, 0, 0, 0, 0, 0
    .long 0, 0, 0, 0, 0, 0, 0, 0, 0, 0, 0, 0, 0, 0, 0, 0
    .long 0, 0, 0, 0, 0, 0, 0, 0, 0, 0, 0, 0, 0, 0, 0, 0
    .long 4, 24, 24, 8192, 7936, 270080, 8388608, 0, 32768, 4, 21098496, 131072, 0, 0, 218104432, 1
    .long 4, 24, 24, 8192, 7936, 270080, 8388608, 262144, 32768, 4, 22147072, 131072, 0, 0, 218104560, 1
    .long 1, 24, 24, 8192, 7680, 7936, 8388608, 1048576, 32768, 8, 25288704, 131072, 0, 0, 218104944, 4
    .long 1, 32, 32, 8192, 7680, 7936, 8388608, 2621440, 32768, 8, 48357376, 131072, 0, 0, 218105712, 4
    .long 1, 24, 24, 8192, 7680, 7936, 8388608, 3145728, 32768, 8, 33677312, 131072, 0, 0, 218105968, 4
    .long 1, 24, 24, 8192, 7680, 7936, 8388608, 3670016, 32768, 8, 35774464, 131072, 0, 0, 218106224, 4
    .long 1, 80, 80, 2048, 5506560, 5506816, 7340032, 56446976, 114688, 7, 180903936, 32768, 218103920, 7, 218106432, 1
    .long 0, 0, 0, 0, 0, 0, 0, 0, 0, 0, 0, 0, 0, 0, 0, 0
    .long 0, 0, 0, 0, 0, 0, 0, 0, 0, 0, 0, 0, 0, 0, 0, 0
    .long 0, 0, 0, 0, 0, 0, 0, 0, 0, 0, 0, 0, 0, 0, 0, 0
    .long 4, 32, 32, 8192, 0, 262144, 8388608, 0, 32768, 4, 37748736, 131072, 0, 0, 218104320, 1
    .long 4, 32, 32, 8192, 0, 262144, 8388608, 262144, 32768, 4, 38797312, 131072, 0, 0, 218104448, 1
    .long 4, 16, 16, 8192, 1792, 263936, 8388608, 786432, 32768, 4, 7368704, 131072, 0, 0, 218104592, 1
    .long 1, 32, 32, 8192, 1024, 1280, 8388608, 1572864, 32768, 8, 44056576, 131072, 0, 0, 218105104, 4
    .long 1, 16, 16, 8192, 1024, 1280, 8388608, 2621440, 32768, 8, 14696448, 131072, 0, 0, 218105616, 4
    .long 2, 64, 72, 7168, 4096, 4096, 7340032, 1048576, 32768, 8, 58261504, 114688, 0, 0, 218103968, 1
    .long 2, 64, 72, 7168, 3072, 3072, 7340032, 2621440, 32768, 8, 63750144, 114688, 0, 0, 218104144, 1
    .long 1, 80, 80, 2048, 3670016, 3670272, 7340032, 60088320, 114688, 7, 177733632, 32768, 218104032, 7, 218106560, 1
    .long 0, 0, 0, 0, 0, 0, 0, 0, 0, 0, 0, 0, 0, 0, 0, 0
    .long 0, 0, 0, 0, 0, 0, 0, 0, 0, 0, 0, 0, 0, 0, 0, 0
    .long 4, 32, 32, 8192, 2048, 264192, 8388608, 0, 32768, 4, 37781504, 131072, 0, 0, 218104352, 1
    .long 4, 32, 32, 8192, 2048, 264192, 8388608, 262144, 32768, 4, 38830080, 131072, 0, 0, 218104480, 1
    .long 4, 16, 16, 8192, 3840, 265984, 8388608, 786432, 32768, 4, 7401472, 131072, 0, 0, 218104624, 1
    .long 1, 32, 32, 8192, 3072, 3328, 8388608, 1572864, 32768, 8, 44089344, 131072, 0, 0, 218105136, 4
    .long 1, 16, 16, 8192, 3072, 3328, 8388608, 2621440, 32768, 8, 14729216, 131072, 0, 0, 218105648, 4
    .long 2, 64, 72, 7168, 4352, 4352, 7340032, 1048576, 32768, 8, 58265600, 114688, 0, 0, 218103968, 1
    .long 2, 64, 72, 7168, 3328, 3328, 7340032, 2621440, 32768, 8, 63754240, 114688, 0, 0, 218104144, 1
    .long 1, 80, 80, 2048, 3670528, 3670784, 7340032, 60088320, 114688, 7, 177741824, 32768, 218104032, 7, 218106560, 1
    .long 0, 0, 0, 0, 0, 0, 0, 0, 0, 0, 0, 0, 0, 0, 0, 0
    .long 0, 0, 0, 0, 0, 0, 0, 0, 0, 0, 0, 0, 0, 0, 0, 0
    .long 4, 32, 32, 8192, 4096, 266240, 8388608, 0, 32768, 4, 37814272, 131072, 0, 0, 218104384, 1
    .long 4, 32, 32, 8192, 4096, 266240, 8388608, 262144, 32768, 4, 38862848, 131072, 0, 0, 218104512, 1
    .long 4, 16, 16, 8192, 5888, 268032, 8388608, 786432, 32768, 4, 7434240, 131072, 0, 0, 218104656, 1
    .long 1, 32, 32, 8192, 5120, 5376, 8388608, 1572864, 32768, 8, 44122112, 131072, 0, 0, 218105168, 4
    .long 1, 16, 16, 8192, 5120, 5376, 8388608, 2621440, 32768, 8, 14761984, 131072, 0, 0, 218105680, 4
    .long 2, 64, 72, 7168, 4608, 4608, 7340032, 1048576, 32768, 8, 58269696, 114688, 0, 0, 218103968, 1
    .long 2, 64, 72, 7168, 3584, 3584, 7340032, 2621440, 32768, 8, 63758336, 114688, 0, 0, 218104160, 1
    .long 1, 80, 80, 2048, 3671040, 3671296, 7340032, 60088320, 114688, 7, 177750016, 32768, 218104032, 7, 218106560, 1
    .long 0, 0, 0, 0, 0, 0, 0, 0, 0, 0, 0, 0, 0, 0, 0, 0
    .long 0, 0, 0, 0, 0, 0, 0, 0, 0, 0, 0, 0, 0, 0, 0, 0
    .long 4, 32, 32, 8192, 6144, 268288, 8388608, 0, 32768, 4, 37847040, 131072, 0, 0, 218104416, 1
    .long 4, 32, 32, 8192, 6144, 268288, 8388608, 262144, 32768, 4, 38895616, 131072, 0, 0, 218104544, 1
    .long 4, 16, 16, 8192, 7936, 270080, 8388608, 786432, 32768, 4, 7467008, 131072, 0, 0, 218104688, 1
    .long 1, 32, 32, 8192, 7168, 7424, 8388608, 1572864, 32768, 8, 44154880, 131072, 0, 0, 218105200, 4
    .long 1, 16, 16, 8192, 7168, 7424, 8388608, 2621440, 32768, 8, 14794752, 131072, 0, 0, 218105712, 4
    .long 2, 64, 72, 7168, 4864, 4864, 7340032, 1048576, 32768, 8, 58273792, 114688, 0, 0, 218103968, 1
    .long 2, 64, 72, 7168, 3840, 3840, 7340032, 2621440, 32768, 8, 63762432, 114688, 0, 0, 218104160, 1
    .long 1, 80, 80, 2048, 3671552, 3671808, 7340032, 60088320, 114688, 7, 177758208, 32768, 218104032, 7, 218106560, 1
    .long 0, 0, 0, 0, 0, 0, 0, 0, 0, 0, 0, 0, 0, 0, 0, 0
    .long 0, 0, 0, 0, 0, 0, 0, 0, 0, 0, 0, 0, 0, 0, 0, 0
    .long 4, 32, 32, 8192, 256, 262400, 8388608, 0, 32768, 4, 37752832, 131072, 0, 0, 218104320, 1
    .long 4, 32, 32, 8192, 256, 262400, 8388608, 262144, 32768, 4, 38801408, 131072, 0, 0, 218104448, 1
    .long 4, 16, 16, 8192, 1792, 263936, 8388608, 524288, 32768, 4, 6320128, 131072, 0, 0, 218104592, 1
    .long 1, 32, 32, 8192, 1536, 1792, 8388608, 1572864, 32768, 8, 44064768, 131072, 0, 0, 218105104, 4
    .long 1, 16, 16, 8192, 1536, 1792, 8388608, 2621440, 32768, 8, 14704640, 131072, 0, 0, 218105616, 4
    .long 2, 64, 72, 7168, 5120, 5120, 7340032, 1048576, 32768, 8, 58277888, 114688, 0, 0, 218103968, 1
    .long 2, 64, 72, 7168, 4096, 4096, 7340032, 2621440, 32768, 8, 63766528, 114688, 0, 0, 218104160, 1
    .long 1, 80, 80, 2048, 5505024, 5505280, 7340032, 60116992, 114688, 7, 181927936, 32768, 218104048, 7, 218106560, 1
    .long 0, 0, 0, 0, 0, 0, 0, 0, 0, 0, 0, 0, 0, 0, 0, 0
    .long 0, 0, 0, 0, 0, 0, 0, 0, 0, 0, 0, 0, 0, 0, 0, 0
    .long 4, 32, 32, 8192, 2304, 264448, 8388608, 0, 32768, 4, 37785600, 131072, 0, 0, 218104352, 1
    .long 4, 32, 32, 8192, 2304, 264448, 8388608, 262144, 32768, 4, 38834176, 131072, 0, 0, 218104480, 1
    .long 4, 16, 16, 8192, 3840, 265984, 8388608, 524288, 32768, 4, 6352896, 131072, 0, 0, 218104624, 1
    .long 1, 32, 32, 8192, 3584, 3840, 8388608, 1572864, 32768, 8, 44097536, 131072, 0, 0, 218105136, 4
    .long 1, 16, 16, 8192, 3584, 3840, 8388608, 2621440, 32768, 8, 14737408, 131072, 0, 0, 218105648, 4
    .long 2, 64, 72, 7168, 5376, 5376, 7340032, 1048576, 32768, 8, 58281984, 114688, 0, 0, 218103984, 1
    .long 2, 64, 72, 7168, 4352, 4352, 7340032, 2621440, 32768, 8, 63770624, 114688, 0, 0, 218104160, 1
    .long 1, 80, 80, 2048, 5505536, 5505792, 7340032, 60116992, 114688, 7, 181936128, 32768, 218104048, 7, 218106560, 1
    .long 0, 0, 0, 0, 0, 0, 0, 0, 0, 0, 0, 0, 0, 0, 0, 0
    .long 0, 0, 0, 0, 0, 0, 0, 0, 0, 0, 0, 0, 0, 0, 0, 0
    .long 4, 32, 32, 8192, 4352, 266496, 8388608, 0, 32768, 4, 37818368, 131072, 0, 0, 218104384, 1
    .long 4, 32, 32, 8192, 4352, 266496, 8388608, 262144, 32768, 4, 38866944, 131072, 0, 0, 218104512, 1
    .long 4, 16, 16, 8192, 5888, 268032, 8388608, 524288, 32768, 4, 6385664, 131072, 0, 0, 218104656, 1
    .long 1, 32, 32, 8192, 5632, 5888, 8388608, 1572864, 32768, 8, 44130304, 131072, 0, 0, 218105168, 4
    .long 1, 16, 16, 8192, 5632, 5888, 8388608, 2621440, 32768, 8, 14770176, 131072, 0, 0, 218105680, 4
    .long 2, 64, 72, 7168, 5632, 5632, 7340032, 1048576, 32768, 8, 58286080, 114688, 0, 0, 218103984, 1
    .long 2, 64, 72, 7168, 4608, 4608, 7340032, 2621440, 32768, 8, 63774720, 114688, 0, 0, 218104160, 1
    .long 1, 80, 80, 2048, 5506048, 5506304, 7340032, 60116992, 114688, 7, 181944320, 32768, 218104048, 7, 218106560, 1
    .long 0, 0, 0, 0, 0, 0, 0, 0, 0, 0, 0, 0, 0, 0, 0, 0
    .long 0, 0, 0, 0, 0, 0, 0, 0, 0, 0, 0, 0, 0, 0, 0, 0
    .long 4, 32, 32, 8192, 6400, 268544, 8388608, 0, 32768, 4, 37851136, 131072, 0, 0, 218104416, 1
    .long 4, 32, 32, 8192, 6400, 268544, 8388608, 262144, 32768, 4, 38899712, 131072, 0, 0, 218104544, 1
    .long 4, 16, 16, 8192, 7936, 270080, 8388608, 524288, 32768, 4, 6418432, 131072, 0, 0, 218104688, 1
    .long 1, 32, 32, 8192, 7680, 7936, 8388608, 1572864, 32768, 8, 44163072, 131072, 0, 0, 218105200, 4
    .long 1, 16, 16, 8192, 7680, 7936, 8388608, 2621440, 32768, 8, 14802944, 131072, 0, 0, 218105712, 4
    .long 2, 64, 72, 7168, 5888, 5888, 7340032, 1048576, 32768, 8, 58290176, 114688, 0, 0, 218103984, 1
    .long 2, 64, 72, 7168, 4864, 4864, 7340032, 2621440, 32768, 8, 63778816, 114688, 0, 0, 218104160, 1
    .long 1, 80, 80, 2048, 5506560, 5506816, 7340032, 60116992, 114688, 7, 181952512, 32768, 218104048, 7, 218106560, 1
    .long 0, 0, 0, 0, 0, 0, 0, 0, 0, 0, 0, 0, 0, 0, 0, 0
    .long 0, 0, 0, 0, 0, 0, 0, 0, 0, 0, 0, 0, 0, 0, 0, 0
    .long 4, 32, 32, 8192, 512, 262656, 8388608, 0, 32768, 4, 37756928, 131072, 0, 0, 218104320, 1
    .long 4, 32, 32, 8192, 512, 262656, 8388608, 262144, 32768, 4, 38805504, 131072, 0, 0, 218104448, 1
    .long 4, 16, 16, 8192, 1536, 263680, 8388608, 786432, 32768, 4, 7364608, 131072, 0, 0, 218104592, 1
    .long 1, 24, 24, 8192, 0, 256, 8388608, 1572864, 32768, 8, 27262976, 131072, 0, 0, 218105088, 4
    .long 2, 64, 72, 7168, 0, 0, 7340032, 0, 32768, 8, 54525952, 114688, 0, 0, 218103808, 1
    .long 2, 64, 72, 7168, 6144, 6144, 7340032, 1048576, 32768, 8, 58294272, 114688, 0, 0, 218103984, 1
    .long 2, 64, 72, 7168, 5120, 5120, 7340032, 2621440, 32768, 8, 63782912, 114688, 0, 0, 218104160, 1
    .long 1, 80, 80, 2048, 0, 256, 7340032, 61865984, 114688, 7, 169869312, 32768, 218104064, 7, 218106624, 1
    .long 0, 0, 0, 0, 0, 0, 0, 0, 0, 0, 0, 0, 0, 0, 0, 0
    .long 0, 0, 0, 0, 0, 0, 0, 0, 0, 0, 0, 0, 0, 0, 0, 0
    .long 4, 32, 32, 8192, 2560, 264704, 8388608, 0, 32768, 4, 37789696, 131072, 0, 0, 218104352, 1
    .long 4, 32, 32, 8192, 2560, 264704, 8388608, 262144, 32768, 4, 38838272, 131072, 0, 0, 218104480, 1
    .long 4, 16, 16, 8192, 3584, 265728, 8388608, 786432, 32768, 4, 7397376, 131072, 0, 0, 218104624, 1
    .long 1, 24, 24, 8192, 2048, 2304, 8388608, 1572864, 32768, 8, 27295744, 131072, 0, 0, 218105120, 4
    .long 2, 64, 72, 7168, 256, 256, 7340032, 0, 32768, 8, 54530048, 114688, 0, 0, 218103808, 1
    .long 2, 64, 72, 7168, 6400, 6400, 7340032, 1048576, 32768, 8, 58298368, 114688, 0, 0, 218103984, 1
    .long 2, 64, 72, 7168, 5376, 5376, 7340032, 2621440, 32768, 8, 63787008, 114688, 0, 0, 218104176, 1
    .long 1, 80, 80, 2048, 512, 768, 7340032, 61865984, 114688, 7, 169877504, 32768, 218104064, 7, 218106624, 1
    .long 0, 0, 0, 0, 0, 0, 0, 0, 0, 0, 0, 0, 0, 0, 0, 0
    .long 0, 0, 0, 0, 0, 0, 0, 0, 0, 0, 0, 0, 0, 0, 0, 0
    .long 4, 32, 32, 8192, 4608, 266752, 8388608, 0, 32768, 4, 37822464, 131072, 0, 0, 218104384, 1
    .long 4, 32, 32, 8192, 4608, 266752, 8388608, 262144, 32768, 4, 38871040, 131072, 0, 0, 218104512, 1
    .long 4, 16, 16, 8192, 5632, 267776, 8388608, 786432, 32768, 4, 7430144, 131072, 0, 0, 218104656, 1
    .long 1, 24, 24, 8192, 4096, 4352, 8388608, 1572864, 32768, 8, 27328512, 131072, 0, 0, 218105152, 4
    .long 2, 64, 72, 7168, 512, 512, 7340032, 0, 32768, 8, 54534144, 114688, 0, 0, 218103808, 1
    .long 2, 64, 72, 7168, 6656, 6656, 7340032, 1048576, 32768, 8, 58302464, 114688, 0, 0, 218103984, 1
    .long 2, 64, 72, 7168, 5632, 5632, 7340032, 2621440, 32768, 8, 63791104, 114688, 0, 0, 218104176, 1
    .long 1, 80, 80, 2048, 1024, 1280, 7340032, 61865984, 114688, 7, 169885696, 32768, 218104064, 7, 218106624, 1
    .long 0, 0, 0, 0, 0, 0, 0, 0, 0, 0, 0, 0, 0, 0, 0, 0
    .long 0, 0, 0, 0, 0, 0, 0, 0, 0, 0, 0, 0, 0, 0, 0, 0
    .long 4, 32, 32, 8192, 6656, 268800, 8388608, 0, 32768, 4, 37855232, 131072, 0, 0, 218104416, 1
    .long 4, 32, 32, 8192, 6656, 268800, 8388608, 262144, 32768, 4, 38903808, 131072, 0, 0, 218104544, 1
    .long 4, 16, 16, 8192, 7680, 269824, 8388608, 786432, 32768, 4, 7462912, 131072, 0, 0, 218104688, 1
    .long 1, 24, 24, 8192, 6144, 6400, 8388608, 1572864, 32768, 8, 27361280, 131072, 0, 0, 218105184, 4
    .long 2, 64, 72, 7168, 768, 768, 7340032, 0, 32768, 8, 54538240, 114688, 0, 0, 218103808, 1
    .long 2, 64, 72, 7168, 6912, 6912, 7340032, 1048576, 32768, 8, 58306560, 114688, 0, 0, 218103984, 1
    .long 2, 64, 72, 7168, 5888, 5888, 7340032, 2621440, 32768, 8, 63795200, 114688, 0, 0, 218104176, 1
    .long 1, 80, 80, 2048, 1536, 1792, 7340032, 61865984, 114688, 7, 169893888, 32768, 218104064, 7, 218106624, 1
    .long 0, 0, 0, 0, 0, 0, 0, 0, 0, 0, 0, 0, 0, 0, 0, 0
    .long 0, 0, 0, 0, 0, 0, 0, 0, 0, 0, 0, 0, 0, 0, 0, 0
    .long 4, 32, 32, 8192, 768, 262912, 8388608, 0, 32768, 4, 37761024, 131072, 0, 0, 218104320, 1
    .long 4, 32, 32, 8192, 768, 262912, 8388608, 262144, 32768, 4, 38809600, 131072, 0, 0, 218104448, 1
    .long 4, 16, 16, 8192, 1536, 263680, 8388608, 524288, 32768, 4, 6316032, 131072, 0, 0, 218104592, 1
    .long 1, 24, 24, 8192, 512, 768, 8388608, 1572864, 32768, 8, 27271168, 131072, 0, 0, 218105088, 4
    .long 2, 64, 72, 7168, 1024, 1024, 7340032, 0, 32768, 8, 54542336, 114688, 0, 0, 218103808, 1
    .long 2, 64, 72, 7168, 0, 0, 7340032, 1572864, 32768, 8, 60030976, 114688, 0, 0, 218104000, 1
    .long 2, 64, 72, 7168, 6144, 6144, 7340032, 2621440, 32768, 8, 63799296, 114688, 0, 0, 218104176, 1
    .long 1, 80, 80, 2048, 1835008, 1835264, 7340032, 61894656, 114688, 7, 174063616, 32768, 218104080, 7, 218106624, 1
    .long 0, 0, 0, 0, 0, 0, 0, 0, 0, 0, 0, 0, 0, 0, 0, 0
    .long 0, 0, 0, 0, 0, 0, 0, 0, 0, 0, 0, 0, 0, 0, 0, 0
    .long 4, 32, 32, 8192, 2816, 264960, 8388608, 0, 32768, 4, 37793792, 131072, 0, 0, 218104352, 1
    .long 4, 32, 32, 8192, 2816, 264960, 8388608, 262144, 32768, 4, 38842368, 131072, 0, 0, 218104480, 1
    .long 4, 16, 16, 8192, 3584, 265728, 8388608, 524288, 32768, 4, 6348800, 131072, 0, 0, 218104624, 1
    .long 1, 24, 24, 8192, 2560, 2816, 8388608, 1572864, 32768, 8, 27303936, 131072, 0, 0, 218105120, 4
    .long 2, 64, 72, 7168, 1280, 1280, 7340032, 0, 32768, 8, 54546432, 114688, 0, 0, 218103808, 1
    .long 2, 64, 72, 7168, 256, 256, 7340032, 1572864, 32768, 8, 60035072, 114688, 0, 0, 218104000, 1
    .long 2, 64, 72, 7168, 6400, 6400, 7340032, 2621440, 32768, 8, 63803392, 114688, 0, 0, 218104176, 1
    .long 1, 80, 80, 2048, 1835520, 1835776, 7340032, 61894656, 114688, 7, 174071808, 32768, 218104080, 7, 218106624, 1
    .long 0, 0, 0, 0, 0, 0, 0, 0, 0, 0, 0, 0, 0, 0, 0, 0
    .long 0, 0, 0, 0, 0, 0, 0, 0, 0, 0, 0, 0, 0, 0, 0, 0
    .long 4, 32, 32, 8192, 4864, 267008, 8388608, 0, 32768, 4, 37826560, 131072, 0, 0, 218104384, 1
    .long 4, 32, 32, 8192, 4864, 267008, 8388608, 262144, 32768, 4, 38875136, 131072, 0, 0, 218104512, 1
    .long 4, 16, 16, 8192, 5632, 267776, 8388608, 524288, 32768, 4, 6381568, 131072, 0, 0, 218104656, 1
    .long 1, 24, 24, 8192, 4608, 4864, 8388608, 1572864, 32768, 8, 27336704, 131072, 0, 0, 218105152, 4
    .long 2, 64, 72, 7168, 1536, 1536, 7340032, 0, 32768, 8, 54550528, 114688, 0, 0, 218103808, 1
    .long 2, 64, 72, 7168, 512, 512, 7340032, 1572864, 32768, 8, 60039168, 114688, 0, 0, 218104000, 1
    .long 2, 64, 72, 7168, 6656, 6656, 7340032, 2621440, 32768, 8, 63807488, 114688, 0, 0, 218104176, 1
    .long 1, 80, 80, 2048, 1836032, 1836288, 7340032, 61894656, 114688, 7, 174080000, 32768, 218104080, 7, 218106624, 1
    .long 0, 0, 0, 0, 0, 0, 0, 0, 0, 0, 0, 0, 0, 0, 0, 0
    .long 0, 0, 0, 0, 0, 0, 0, 0, 0, 0, 0, 0, 0, 0, 0, 0
    .long 4, 32, 32, 8192, 6912, 269056, 8388608, 0, 32768, 4, 37859328, 131072, 0, 0, 218104416, 1
    .long 4, 32, 32, 8192, 6912, 269056, 8388608, 262144, 32768, 4, 38907904, 131072, 0, 0, 218104544, 1
    .long 4, 16, 16, 8192, 7680, 269824, 8388608, 524288, 32768, 4, 6414336, 131072, 0, 0, 218104688, 1
    .long 1, 24, 24, 8192, 6656, 6912, 8388608, 1572864, 32768, 8, 27369472, 131072, 0, 0, 218105184, 4
    .long 2, 64, 72, 7168, 1792, 1792, 7340032, 0, 32768, 8, 54554624, 114688, 0, 0, 218103824, 1
    .long 2, 64, 72, 7168, 768, 768, 7340032, 1572864, 32768, 8, 60043264, 114688, 0, 0, 218104000, 1
    .long 2, 64, 72, 7168, 6912, 6912, 7340032, 2621440, 32768, 8, 63811584, 114688, 0, 0, 218104176, 1
    .long 1, 80, 80, 2048, 1836544, 1836800, 7340032, 61894656, 114688, 7, 174088192, 32768, 218104080, 7, 218106624, 1
    .long 0, 0, 0, 0, 0, 0, 0, 0, 0, 0, 0, 0, 0, 0, 0, 0
    .long 0, 0, 0, 0, 0, 0, 0, 0, 0, 0, 0, 0, 0, 0, 0, 0
    .long 4, 32, 32, 8192, 1024, 263168, 8388608, 0, 32768, 4, 37765120, 131072, 0, 0, 218104336, 1
    .long 4, 32, 32, 8192, 1024, 263168, 8388608, 262144, 32768, 4, 38813696, 131072, 0, 0, 218104464, 1
    .long 4, 16, 16, 8192, 1280, 263424, 8388608, 786432, 32768, 4, 7360512, 131072, 0, 0, 218104592, 1
    .long 1, 24, 24, 8192, 1024, 1280, 8388608, 1572864, 32768, 8, 27279360, 131072, 0, 0, 218105104, 4
    .long 2, 64, 72, 7168, 2048, 2048, 7340032, 0, 32768, 8, 54558720, 114688, 0, 0, 218103824, 1
    .long 2, 64, 72, 7168, 1024, 1024, 7340032, 1572864, 32768, 8, 60047360, 114688, 0, 0, 218104000, 1
    .long 2, 64, 72, 7168, 0, 0, 7340032, 3145728, 32768, 8, 65536000, 114688, 0, 0, 218104192, 1
    .long 1, 80, 80, 2048, 3670016, 3670272, 7340032, 61923328, 114688, 7, 178257920, 32768, 218104096, 7, 218106624, 1
    .long 0, 0, 0, 0, 0, 0, 0, 0, 0, 0, 0, 0, 0, 0, 0, 0
    .long 0, 0, 0, 0, 0, 0, 0, 0, 0, 0, 0, 0, 0, 0, 0, 0
    .long 4, 32, 32, 8192, 3072, 265216, 8388608, 0, 32768, 4, 37797888, 131072, 0, 0, 218104368, 1
    .long 4, 32, 32, 8192, 3072, 265216, 8388608, 262144, 32768, 4, 38846464, 131072, 0, 0, 218104496, 1
    .long 4, 16, 16, 8192, 3328, 265472, 8388608, 786432, 32768, 4, 7393280, 131072, 0, 0, 218104624, 1
    .long 1, 24, 24, 8192, 3072, 3328, 8388608, 1572864, 32768, 8, 27312128, 131072, 0, 0, 218105136, 4
    .long 2, 64, 72, 7168, 2304, 2304, 7340032, 0, 32768, 8, 54562816, 114688, 0, 0, 218103824, 1
    .long 2, 64, 72, 7168, 1280, 1280, 7340032, 1572864, 32768, 8, 60051456, 114688, 0, 0, 218104000, 1
    .long 2, 64, 72, 7168, 256, 256, 7340032, 3145728, 32768, 8, 65540096, 114688, 0, 0, 218104192, 1
    .long 1, 80, 80, 2048, 3670528, 3670784, 7340032, 61923328, 114688, 7, 178266112, 32768, 218104096, 7, 218106624, 1
    .long 0, 0, 0, 0, 0, 0, 0, 0, 0, 0, 0, 0, 0, 0, 0, 0
    .long 0, 0, 0, 0, 0, 0, 0, 0, 0, 0, 0, 0, 0, 0, 0, 0
    .long 4, 32, 32, 8192, 5120, 267264, 8388608, 0, 32768, 4, 37830656, 131072, 0, 0, 218104400, 1
    .long 4, 32, 32, 8192, 5120, 267264, 8388608, 262144, 32768, 4, 38879232, 131072, 0, 0, 218104528, 1
    .long 4, 16, 16, 8192, 5376, 267520, 8388608, 786432, 32768, 4, 7426048, 131072, 0, 0, 218104656, 1
    .long 1, 24, 24, 8192, 5120, 5376, 8388608, 1572864, 32768, 8, 27344896, 131072, 0, 0, 218105168, 4
    .long 2, 64, 72, 7168, 2560, 2560, 7340032, 0, 32768, 8, 54566912, 114688, 0, 0, 218103824, 1
    .long 2, 64, 72, 7168, 1536, 1536, 7340032, 1572864, 32768, 8, 60055552, 114688, 0, 0, 218104000, 1
    .long 2, 64, 72, 7168, 512, 512, 7340032, 3145728, 32768, 8, 65544192, 114688, 0, 0, 218104192, 1
    .long 1, 80, 80, 2048, 3671040, 3671296, 7340032, 61923328, 114688, 7, 178274304, 32768, 218104096, 7, 218106624, 1
    .long 0, 0, 0, 0, 0, 0, 0, 0, 0, 0, 0, 0, 0, 0, 0, 0
    .long 0, 0, 0, 0, 0, 0, 0, 0, 0, 0, 0, 0, 0, 0, 0, 0
    .long 4, 32, 32, 8192, 7168, 269312, 8388608, 0, 32768, 4, 37863424, 131072, 0, 0, 218104432, 1
    .long 4, 32, 32, 8192, 7168, 269312, 8388608, 262144, 32768, 4, 38912000, 131072, 0, 0, 218104560, 1
    .long 4, 16, 16, 8192, 7424, 269568, 8388608, 786432, 32768, 4, 7458816, 131072, 0, 0, 218104688, 1
    .long 1, 24, 24, 8192, 7168, 7424, 8388608, 1572864, 32768, 8, 27377664, 131072, 0, 0, 218105200, 4
    .long 2, 64, 72, 7168, 2816, 2816, 7340032, 0, 32768, 8, 54571008, 114688, 0, 0, 218103824, 1
    .long 2, 64, 72, 7168, 1792, 1792, 7340032, 1572864, 32768, 8, 60059648, 114688, 0, 0, 218104016, 1
    .long 2, 64, 72, 7168, 768, 768, 7340032, 3145728, 32768, 8, 65548288, 114688, 0, 0, 218104192, 1
    .long 1, 80, 80, 2048, 3671552, 3671808, 7340032, 61923328, 114688, 7, 178282496, 32768, 218104096, 7, 218106624, 1
    .long 0, 0, 0, 0, 0, 0, 0, 0, 0, 0, 0, 0, 0, 0, 0, 0
    .long 0, 0, 0, 0, 0, 0, 0, 0, 0, 0, 0, 0, 0, 0, 0, 0
    .long 4, 32, 32, 8192, 1280, 263424, 8388608, 0, 32768, 4, 37769216, 131072, 0, 0, 218104336, 1
    .long 4, 32, 32, 8192, 1280, 263424, 8388608, 262144, 32768, 4, 38817792, 131072, 0, 0, 218104464, 1
    .long 4, 16, 16, 8192, 1280, 263424, 8388608, 524288, 32768, 4, 6311936, 131072, 0, 0, 218104592, 1
    .long 1, 24, 24, 8192, 1536, 1792, 8388608, 1572864, 32768, 8, 27287552, 131072, 0, 0, 218105104, 4
    .long 2, 64, 72, 7168, 3072, 3072, 7340032, 0, 32768, 8, 54575104, 114688, 0, 0, 218103824, 1
    .long 2, 64, 72, 7168, 2048, 2048, 7340032, 1572864, 32768, 8, 60063744, 114688, 0, 0, 218104016, 1
    .long 2, 64, 72, 7168, 1024, 1024, 7340032, 3145728, 32768, 8, 65552384, 114688, 0, 0, 218104192, 1
    .long 1, 80, 80, 2048, 5505024, 5505280, 7340032, 61952000, 114688, 7, 182452224, 32768, 218104112, 7, 218106624, 1
    .long 0, 0, 0, 0, 0, 0, 0, 0, 0, 0, 0, 0, 0, 0, 0, 0
    .long 0, 0, 0, 0, 0, 0, 0, 0, 0, 0, 0, 0, 0, 0, 0, 0
    .long 4, 32, 32, 8192, 3328, 265472, 8388608, 0, 32768, 4, 37801984, 131072, 0, 0, 218104368, 1
    .long 4, 32, 32, 8192, 3328, 265472, 8388608, 262144, 32768, 4, 38850560, 131072, 0, 0, 218104496, 1
    .long 4, 16, 16, 8192, 3328, 265472, 8388608, 524288, 32768, 4, 6344704, 131072, 0, 0, 218104624, 1
    .long 1, 24, 24, 8192, 3584, 3840, 8388608, 1572864, 32768, 8, 27320320, 131072, 0, 0, 218105136, 4
    .long 2, 64, 72, 7168, 3328, 3328, 7340032, 0, 32768, 8, 54579200, 114688, 0, 0, 218103824, 1
    .long 2, 64, 72, 7168, 2304, 2304, 7340032, 1572864, 32768, 8, 60067840, 114688, 0, 0, 218104016, 1
    .long 2, 64, 72, 7168, 1280, 1280, 7340032, 3145728, 32768, 8, 65556480, 114688, 0, 0, 218104192, 1
    .long 1, 80, 80, 2048, 5505536, 5505792, 7340032, 61952000, 114688, 7, 182460416, 32768, 218104112, 7, 218106624, 1
    .long 0, 0, 0, 0, 0, 0, 0, 0, 0, 0, 0, 0, 0, 0, 0, 0
    .long 0, 0, 0, 0, 0, 0, 0, 0, 0, 0, 0, 0, 0, 0, 0, 0
    .long 4, 32, 32, 8192, 5376, 267520, 8388608, 0, 32768, 4, 37834752, 131072, 0, 0, 218104400, 1
    .long 4, 32, 32, 8192, 5376, 267520, 8388608, 262144, 32768, 4, 38883328, 131072, 0, 0, 218104528, 1
    .long 4, 16, 16, 8192, 5376, 267520, 8388608, 524288, 32768, 4, 6377472, 131072, 0, 0, 218104656, 1
    .long 1, 24, 24, 8192, 5632, 5888, 8388608, 1572864, 32768, 8, 27353088, 131072, 0, 0, 218105168, 4
    .long 2, 64, 72, 7168, 3584, 3584, 7340032, 0, 32768, 8, 54583296, 114688, 0, 0, 218103840, 1
    .long 2, 64, 72, 7168, 2560, 2560, 7340032, 1572864, 32768, 8, 60071936, 114688, 0, 0, 218104016, 1
    .long 2, 64, 72, 7168, 1536, 1536, 7340032, 3145728, 32768, 8, 65560576, 114688, 0, 0, 218104192, 1
    .long 1, 80, 80, 2048, 5506048, 5506304, 7340032, 61952000, 114688, 7, 182468608, 32768, 218104112, 7, 218106624, 1
    .long 0, 0, 0, 0, 0, 0, 0, 0, 0, 0, 0, 0, 0, 0, 0, 0
    .long 0, 0, 0, 0, 0, 0, 0, 0, 0, 0, 0, 0, 0, 0, 0, 0
    .long 4, 32, 32, 8192, 7424, 269568, 8388608, 0, 32768, 4, 37867520, 131072, 0, 0, 218104432, 1
    .long 4, 32, 32, 8192, 7424, 269568, 8388608, 262144, 32768, 4, 38916096, 131072, 0, 0, 218104560, 1
    .long 4, 16, 16, 8192, 7424, 269568, 8388608, 524288, 32768, 4, 6410240, 131072, 0, 0, 218104688, 1
    .long 1, 24, 24, 8192, 7680, 7936, 8388608, 1572864, 32768, 8, 27385856, 131072, 0, 0, 218105200, 4
    .long 2, 64, 72, 7168, 3840, 3840, 7340032, 0, 32768, 8, 54587392, 114688, 0, 0, 218103840, 1
    .long 2, 64, 72, 7168, 2816, 2816, 7340032, 1572864, 32768, 8, 60076032, 114688, 0, 0, 218104016, 1
    .long 2, 64, 72, 7168, 1792, 1792, 7340032, 3145728, 32768, 8, 65564672, 114688, 0, 0, 218104208, 1
    .long 1, 80, 80, 2048, 5506560, 5506816, 7340032, 61952000, 114688, 7, 182476800, 32768, 218104112, 7, 218106624, 1
    .long 0, 0, 0, 0, 0, 0, 0, 0, 0, 0, 0, 0, 0, 0, 0, 0
    .long 0, 0, 0, 0, 0, 0, 0, 0, 0, 0, 0, 0, 0, 0, 0, 0
    .long 4, 32, 32, 8192, 1536, 263680, 8388608, 0, 32768, 4, 37773312, 131072, 0, 0, 218104336, 1
    .long 4, 32, 32, 8192, 1536, 263680, 8388608, 262144, 32768, 4, 38821888, 131072, 0, 0, 218104464, 1
    .long 4, 16, 16, 8192, 1024, 263168, 8388608, 786432, 32768, 4, 7356416, 131072, 0, 0, 218104592, 1
    .long 1, 16, 16, 8192, 0, 256, 8388608, 1572864, 32768, 8, 10485760, 131072, 0, 0, 218105088, 4
    .long 2, 64, 72, 7168, 4096, 4096, 7340032, 0, 32768, 8, 54591488, 114688, 0, 0, 218103840, 1
    .long 2, 64, 72, 7168, 3072, 3072, 7340032, 1572864, 32768, 8, 60080128, 114688, 0, 0, 218104016, 1
    .long 2, 64, 72, 7168, 2048, 2048, 7340032, 3145728, 32768, 8, 65568768, 114688, 0, 0, 218104208, 1
    .long 1, 80, 80, 2048, 0, 256, 7340032, 63700992, 114688, 7, 170393600, 32768, 218104128, 7, 218106688, 1
    .long 0, 0, 0, 0, 0, 0, 0, 0, 0, 0, 0, 0, 0, 0, 0, 0
    .long 0, 0, 0, 0, 0, 0, 0, 0, 0, 0, 0, 0, 0, 0, 0, 0
    .long 4, 32, 32, 8192, 3584, 265728, 8388608, 0, 32768, 4, 37806080, 131072, 0, 0, 218104368, 1
    .long 4, 32, 32, 8192, 3584, 265728, 8388608, 262144, 32768, 4, 38854656, 131072, 0, 0, 218104496, 1
    .long 4, 16, 16, 8192, 3072, 265216, 8388608, 786432, 32768, 4, 7389184, 131072, 0, 0, 218104624, 1
    .long 1, 16, 16, 8192, 2048, 2304, 8388608, 1572864, 32768, 8, 10518528, 131072, 0, 0, 218105120, 4
    .long 2, 64, 72, 7168, 4352, 4352, 7340032, 0, 32768, 8, 54595584, 114688, 0, 0, 218103840, 1
    .long 2, 64, 72, 7168, 3328, 3328, 7340032, 1572864, 32768, 8, 60084224, 114688, 0, 0, 218104016, 1
    .long 2, 64, 72, 7168, 2304, 2304, 7340032, 3145728, 32768, 8, 65572864, 114688, 0, 0, 218104208, 1
    .long 1, 80, 80, 2048, 512, 768, 7340032, 63700992, 114688, 7, 170401792, 32768, 218104128, 7, 218106688, 1
    .long 0, 0, 0, 0, 0, 0, 0, 0, 0, 0, 0, 0, 0, 0, 0, 0
    .long 0, 0, 0, 0, 0, 0, 0, 0, 0, 0, 0, 0, 0, 0, 0, 0
    .long 4, 32, 32, 8192, 5632, 267776, 8388608, 0, 32768, 4, 37838848, 131072, 0, 0, 218104400, 1
    .long 4, 32, 32, 8192, 5632, 267776, 8388608, 262144, 32768, 4, 38887424, 131072, 0, 0, 218104528, 1
    .long 4, 16, 16, 8192, 5120, 267264, 8388608, 786432, 32768, 4, 7421952, 131072, 0, 0, 218104656, 1
    .long 1, 16, 16, 8192, 4096, 4352, 8388608, 1572864, 32768, 8, 10551296, 131072, 0, 0, 218105152, 4
    .long 2, 64, 72, 7168, 4608, 4608, 7340032, 0, 32768, 8, 54599680, 114688, 0, 0, 218103840, 1
    .long 2, 64, 72, 7168, 3584, 3584, 7340032, 1572864, 32768, 8, 60088320, 114688, 0, 0, 218104032, 1
    .long 2, 64, 72, 7168, 2560, 2560, 7340032, 3145728, 32768, 8, 65576960, 114688, 0, 0, 218104208, 1
    .long 1, 80, 80, 2048, 1024, 1280, 7340032, 63700992, 114688, 7, 170409984, 32768, 218104128, 7, 218106688, 1
    .long 0, 0, 0, 0, 0, 0, 0, 0, 0, 0, 0, 0, 0, 0, 0, 0
    .long 0, 0, 0, 0, 0, 0, 0, 0, 0, 0, 0, 0, 0, 0, 0, 0
    .long 4, 32, 32, 8192, 7680, 269824, 8388608, 0, 32768, 4, 37871616, 131072, 0, 0, 218104432, 1
    .long 4, 32, 32, 8192, 7680, 269824, 8388608, 262144, 32768, 4, 38920192, 131072, 0, 0, 218104560, 1
    .long 4, 16, 16, 8192, 7168, 269312, 8388608, 786432, 32768, 4, 7454720, 131072, 0, 0, 218104688, 1
    .long 1, 16, 16, 8192, 6144, 6400, 8388608, 1572864, 32768, 8, 10584064, 131072, 0, 0, 218105184, 4
    .long 2, 64, 72, 7168, 4864, 4864, 7340032, 0, 32768, 8, 54603776, 114688, 0, 0, 218103840, 1
    .long 2, 64, 72, 7168, 3840, 3840, 7340032, 1572864, 32768, 8, 60092416, 114688, 0, 0, 218104032, 1
    .long 2, 64, 72, 7168, 2816, 2816, 7340032, 3145728, 32768, 8, 65581056, 114688, 0, 0, 218104208, 1
    .long 1, 80, 80, 2048, 1536, 1792, 7340032, 63700992, 114688, 7, 170418176, 32768, 218104128, 7, 218106688, 1
    .long 0, 0, 0, 0, 0, 0, 0, 0, 0, 0, 0, 0, 0, 0, 0, 0
    .long 0, 0, 0, 0, 0, 0, 0, 0, 0, 0, 0, 0, 0, 0, 0, 0
    .long 4, 32, 32, 8192, 1792, 263936, 8388608, 0, 32768, 4, 37777408, 131072, 0, 0, 218104336, 1
    .long 4, 32, 32, 8192, 1792, 263936, 8388608, 262144, 32768, 4, 38825984, 131072, 0, 0, 218104464, 1
    .long 4, 16, 16, 8192, 1024, 263168, 8388608, 524288, 32768, 4, 6307840, 131072, 0, 0, 218104592, 1
    .long 1, 16, 16, 8192, 512, 768, 8388608, 1572864, 32768, 8, 10493952, 131072, 0, 0, 218105088, 4
    .long 2, 64, 72, 7168, 5120, 5120, 7340032, 0, 32768, 8, 54607872, 114688, 0, 0, 218103840, 1
    .long 2, 64, 72, 7168, 4096, 4096, 7340032, 1572864, 32768, 8, 60096512, 114688, 0, 0, 218104032, 1
    .long 2, 64, 72, 7168, 3072, 3072, 7340032, 3145728, 32768, 8, 65585152, 114688, 0, 0, 218104208, 1
    .long 1, 80, 80, 2048, 1835008, 1835264, 7340032, 63729664, 114688, 7, 174587904, 32768, 218104144, 7, 218106688, 1
    .long 0, 0, 0, 0, 0, 0, 0, 0, 0, 0, 0, 0, 0, 0, 0, 0
    .long 0, 0, 0, 0, 0, 0, 0, 0, 0, 0, 0, 0, 0, 0, 0, 0
    .long 4, 32, 32, 8192, 3840, 265984, 8388608, 0, 32768, 4, 37810176, 131072, 0, 0, 218104368, 1
    .long 4, 32, 32, 8192, 3840, 265984, 8388608, 262144, 32768, 4, 38858752, 131072, 0, 0, 218104496, 1
    .long 4, 16, 16, 8192, 3072, 265216, 8388608, 524288, 32768, 4, 6340608, 131072, 0, 0, 218104624, 1
    .long 1, 16, 16, 8192, 2560, 2816, 8388608, 1572864, 32768, 8, 10526720, 131072, 0, 0, 218105120, 4
    .long 2, 64, 72, 7168, 5376, 5376, 7340032, 0, 32768, 8, 54611968, 114688, 0, 0, 218103856, 1
    .long 2, 64, 72, 7168, 4352, 4352, 7340032, 1572864, 32768, 8, 60100608, 114688, 0, 0, 218104032, 1
    .long 2, 64, 72, 7168, 3328, 3328, 7340032, 3145728, 32768, 8, 65589248, 114688, 0, 0, 218104208, 1
    .long 1, 80, 80, 2048, 1835520, 1835776, 7340032, 63729664, 114688, 7, 174596096, 32768, 218104144, 7, 218106688, 1
    .long 0, 0, 0, 0, 0, 0, 0, 0, 0, 0, 0, 0, 0, 0, 0, 0
    .long 0, 0, 0, 0, 0, 0, 0, 0, 0, 0, 0, 0, 0, 0, 0, 0
    .long 4, 32, 32, 8192, 5888, 268032, 8388608, 0, 32768, 4, 37842944, 131072, 0, 0, 218104400, 1
    .long 4, 32, 32, 8192, 5888, 268032, 8388608, 262144, 32768, 4, 38891520, 131072, 0, 0, 218104528, 1
    .long 4, 16, 16, 8192, 5120, 267264, 8388608, 524288, 32768, 4, 6373376, 131072, 0, 0, 218104656, 1
    .long 1, 16, 16, 8192, 4608, 4864, 8388608, 1572864, 32768, 8, 10559488, 131072, 0, 0, 218105152, 4
    .long 2, 64, 72, 7168, 5632, 5632, 7340032, 0, 32768, 8, 54616064, 114688, 0, 0, 218103856, 1
    .long 2, 64, 72, 7168, 4608, 4608, 7340032, 1572864, 32768, 8, 60104704, 114688, 0, 0, 218104032, 1
    .long 2, 64, 72, 7168, 3584, 3584, 7340032, 3145728, 32768, 8, 65593344, 114688, 0, 0, 218104224, 1
    .long 1, 80, 80, 2048, 1836032, 1836288, 7340032, 63729664, 114688, 7, 174604288, 32768, 218104144, 7, 218106688, 1
    .long 0, 0, 0, 0, 0, 0, 0, 0, 0, 0, 0, 0, 0, 0, 0, 0
    .long 0, 0, 0, 0, 0, 0, 0, 0, 0, 0, 0, 0, 0, 0, 0, 0
    .long 4, 32, 32, 8192, 7936, 270080, 8388608, 0, 32768, 4, 37875712, 131072, 0, 0, 218104432, 1
    .long 4, 32, 32, 8192, 7936, 270080, 8388608, 262144, 32768, 4, 38924288, 131072, 0, 0, 218104560, 1
    .long 4, 16, 16, 8192, 7168, 269312, 8388608, 524288, 32768, 4, 6406144, 131072, 0, 0, 218104688, 1
    .long 1, 16, 16, 8192, 6656, 6912, 8388608, 1572864, 32768, 8, 10592256, 131072, 0, 0, 218105184, 4
    .long 2, 64, 72, 7168, 5888, 5888, 7340032, 0, 32768, 8, 54620160, 114688, 0, 0, 218103856, 1
    .long 2, 64, 72, 7168, 4864, 4864, 7340032, 1572864, 32768, 8, 60108800, 114688, 0, 0, 218104032, 1
    .long 2, 64, 72, 7168, 3840, 3840, 7340032, 3145728, 32768, 8, 65597440, 114688, 0, 0, 218104224, 1
    .long 1, 80, 80, 2048, 1836544, 1836800, 7340032, 63729664, 114688, 7, 174612480, 32768, 218104144, 7, 218106688, 1
    .long 0, 0, 0, 0, 0, 0, 0, 0, 0, 0, 0, 0, 0, 0, 0, 0
    .long 0, 0, 0, 0, 0, 0, 0, 0, 0, 0, 0, 0, 0, 0, 0, 0
    .long 4, 16, 16, 8192, 0, 262144, 8388608, 0, 32768, 4, 4194304, 131072, 0, 0, 218104320, 1
    .long 4, 16, 16, 8192, 0, 262144, 8388608, 262144, 32768, 4, 5242880, 131072, 0, 0, 218104448, 1
    .long 4, 16, 16, 8192, 0, 262144, 8388608, 524288, 32768, 4, 6291456, 131072, 0, 0, 218104576, 1
    .long 1, 16, 16, 8192, 1024, 1280, 8388608, 1572864, 32768, 8, 10502144, 131072, 0, 0, 218105104, 4
    .long 2, 64, 72, 7168, 6144, 6144, 7340032, 0, 32768, 8, 54624256, 114688, 0, 0, 218103856, 1
    .long 2, 64, 72, 7168, 5120, 5120, 7340032, 1572864, 32768, 8, 60112896, 114688, 0, 0, 218104032, 1
    .long 2, 64, 72, 7168, 4096, 4096, 7340032, 3145728, 32768, 8, 65601536, 114688, 0, 0, 218104224, 1
    .long 1, 80, 80, 2048, 3670016, 3670272, 7340032, 63758336, 114688, 7, 178782208, 32768, 218104160, 7, 218106688, 1
    .long 0, 0, 0, 0, 0, 0, 0, 0, 0, 0, 0, 0, 0, 0, 0, 0
    .long 0, 0, 0, 0, 0, 0, 0, 0, 0, 0, 0, 0, 0, 0, 0, 0
    .long 4, 16, 16, 8192, 2048, 264192, 8388608, 0, 32768, 4, 4227072, 131072, 0, 0, 218104352, 1
    .long 4, 16, 16, 8192, 2048, 264192, 8388608, 262144, 32768, 4, 5275648, 131072, 0, 0, 218104480, 1
    .long 4, 16, 16, 8192, 2048, 264192, 8388608, 524288, 32768, 4, 6324224, 131072, 0, 0, 218104608, 1
    .long 1, 16, 16, 8192, 3072, 3328, 8388608, 1572864, 32768, 8, 10534912, 131072, 0, 0, 218105136, 4
    .long 2, 64, 72, 7168, 6400, 6400, 7340032, 0, 32768, 8, 54628352, 114688, 0, 0, 218103856, 1
    .long 2, 64, 72, 7168, 5376, 5376, 7340032, 1572864, 32768, 8, 60116992, 114688, 0, 0, 218104048, 1
    .long 2, 64, 72, 7168, 4352, 4352, 7340032, 3145728, 32768, 8, 65605632, 114688, 0, 0, 218104224, 1
    .long 1, 80, 80, 2048, 3670528, 3670784, 7340032, 63758336, 114688, 7, 178790400, 32768, 218104160, 7, 218106688, 1
    .long 0, 0, 0, 0, 0, 0, 0, 0, 0, 0, 0, 0, 0, 0, 0, 0
    .long 0, 0, 0, 0, 0, 0, 0, 0, 0, 0, 0, 0, 0, 0, 0, 0
    .long 4, 16, 16, 8192, 4096, 266240, 8388608, 0, 32768, 4, 4259840, 131072, 0, 0, 218104384, 1
    .long 4, 16, 16, 8192, 4096, 266240, 8388608, 262144, 32768, 4, 5308416, 131072, 0, 0, 218104512, 1
    .long 4, 16, 16, 8192, 4096, 266240, 8388608, 524288, 32768, 4, 6356992, 131072, 0, 0, 218104640, 1
    .long 1, 16, 16, 8192, 5120, 5376, 8388608, 1572864, 32768, 8, 10567680, 131072, 0, 0, 218105168, 4
    .long 2, 64, 72, 7168, 6656, 6656, 7340032, 0, 32768, 8, 54632448, 114688, 0, 0, 218103856, 1
    .long 2, 64, 72, 7168, 5632, 5632, 7340032, 1572864, 32768, 8, 60121088, 114688, 0, 0, 218104048, 1
    .long 2, 64, 72, 7168, 4608, 4608, 7340032, 3145728, 32768, 8, 65609728, 114688, 0, 0, 218104224, 1
    .long 1, 80, 80, 2048, 3671040, 3671296, 7340032, 63758336, 114688, 7, 178798592, 32768, 218104160, 7, 218106688, 1
    .long 0, 0, 0, 0, 0, 0, 0, 0, 0, 0, 0, 0, 0, 0, 0, 0
    .long 0, 0, 0, 0, 0, 0, 0, 0, 0, 0, 0, 0, 0, 0, 0, 0
    .long 4, 16, 16, 8192, 6144, 268288, 8388608, 0, 32768, 4, 4292608, 131072, 0, 0, 218104416, 1
    .long 4, 16, 16, 8192, 6144, 268288, 8388608, 262144, 32768, 4, 5341184, 131072, 0, 0, 218104544, 1
    .long 4, 16, 16, 8192, 6144, 268288, 8388608, 524288, 32768, 4, 6389760, 131072, 0, 0, 218104672, 1
    .long 1, 16, 16, 8192, 7168, 7424, 8388608, 1572864, 32768, 8, 10600448, 131072, 0, 0, 218105200, 4
    .long 2, 64, 72, 7168, 6912, 6912, 7340032, 0, 32768, 8, 54636544, 114688, 0, 0, 218103856, 1
    .long 2, 64, 72, 7168, 5888, 5888, 7340032, 1572864, 32768, 8, 60125184, 114688, 0, 0, 218104048, 1
    .long 2, 64, 72, 7168, 4864, 4864, 7340032, 3145728, 32768, 8, 65613824, 114688, 0, 0, 218104224, 1
    .long 1, 80, 80, 2048, 3671552, 3671808, 7340032, 63758336, 114688, 7, 178806784, 32768, 218104160, 7, 218106688, 1
    .long 0, 0, 0, 0, 0, 0, 0, 0, 0, 0, 0, 0, 0, 0, 0, 0
    .long 0, 0, 0, 0, 0, 0, 0, 0, 0, 0, 0, 0, 0, 0, 0, 0
    .long 4, 16, 16, 8192, 256, 262400, 8388608, 0, 32768, 4, 4198400, 131072, 0, 0, 218104320, 1
    .long 4, 16, 16, 8192, 256, 262400, 8388608, 262144, 32768, 4, 5246976, 131072, 0, 0, 218104448, 1
    .long 4, 16, 16, 8192, 256, 262400, 8388608, 524288, 32768, 4, 6295552, 131072, 0, 0, 218104576, 1
    .long 1, 16, 16, 8192, 1536, 1792, 8388608, 1572864, 32768, 8, 10510336, 131072, 0, 0, 218105104, 4
    .long 2, 64, 72, 7168, 0, 0, 7340032, 524288, 32768, 8, 56360960, 114688, 0, 0, 218103872, 1
    .long 2, 64, 72, 7168, 6144, 6144, 7340032, 1572864, 32768, 8, 60129280, 114688, 0, 0, 218104048, 1
    .long 2, 64, 72, 7168, 5120, 5120, 7340032, 3145728, 32768, 8, 65617920, 114688, 0, 0, 218104224, 1
    .long 1, 80, 80, 2048, 5505024, 5505280, 7340032, 63787008, 114688, 7, 182976512, 32768, 218104176, 7, 218106688, 1
    .long 0, 0, 0, 0, 0, 0, 0, 0, 0, 0, 0, 0, 0, 0, 0, 0
    .long 0, 0, 0, 0, 0, 0, 0, 0, 0, 0, 0, 0, 0, 0, 0, 0
    .long 4, 16, 16, 8192, 2304, 264448, 8388608, 0, 32768, 4, 4231168, 131072, 0, 0, 218104352, 1
    .long 4, 16, 16, 8192, 2304, 264448, 8388608, 262144, 32768, 4, 5279744, 131072, 0, 0, 218104480, 1
    .long 4, 16, 16, 8192, 2304, 264448, 8388608, 524288, 32768, 4, 6328320, 131072, 0, 0, 218104608, 1
    .long 1, 16, 16, 8192, 3584, 3840, 8388608, 1572864, 32768, 8, 10543104, 131072, 0, 0, 218105136, 4
    .long 2, 64, 72, 7168, 256, 256, 7340032, 524288, 32768, 8, 56365056, 114688, 0, 0, 218103872, 1
    .long 2, 64, 72, 7168, 6400, 6400, 7340032, 1572864, 32768, 8, 60133376, 114688, 0, 0, 218104048, 1
    .long 2, 64, 72, 7168, 5376, 5376, 7340032, 3145728, 32768, 8, 65622016, 114688, 0, 0, 218104240, 1
    .long 1, 80, 80, 2048, 5505536, 5505792, 7340032, 63787008, 114688, 7, 182984704, 32768, 218104176, 7, 218106688, 1
    .long 0, 0, 0, 0, 0, 0, 0, 0, 0, 0, 0, 0, 0, 0, 0, 0
    .long 0, 0, 0, 0, 0, 0, 0, 0, 0, 0, 0, 0, 0, 0, 0, 0
    .long 4, 16, 16, 8192, 4352, 266496, 8388608, 0, 32768, 4, 4263936, 131072, 0, 0, 218104384, 1
    .long 4, 16, 16, 8192, 4352, 266496, 8388608, 262144, 32768, 4, 5312512, 131072, 0, 0, 218104512, 1
    .long 4, 16, 16, 8192, 4352, 266496, 8388608, 524288, 32768, 4, 6361088, 131072, 0, 0, 218104640, 1
    .long 1, 16, 16, 8192, 5632, 5888, 8388608, 1572864, 32768, 8, 10575872, 131072, 0, 0, 218105168, 4
    .long 2, 64, 72, 7168, 512, 512, 7340032, 524288, 32768, 8, 56369152, 114688, 0, 0, 218103872, 1
    .long 2, 64, 72, 7168, 6656, 6656, 7340032, 1572864, 32768, 8, 60137472, 114688, 0, 0, 218104048, 1
    .long 2, 64, 72, 7168, 5632, 5632, 7340032, 3145728, 32768, 8, 65626112, 114688, 0, 0, 218104240, 1
    .long 1, 80, 80, 2048, 5506048, 5506304, 7340032, 63787008, 114688, 7, 182992896, 32768, 218104176, 7, 218106688, 1
    .long 0, 0, 0, 0, 0, 0, 0, 0, 0, 0, 0, 0, 0, 0, 0, 0
    .long 0, 0, 0, 0, 0, 0, 0, 0, 0, 0, 0, 0, 0, 0, 0, 0
    .long 4, 16, 16, 8192, 6400, 268544, 8388608, 0, 32768, 4, 4296704, 131072, 0, 0, 218104416, 1
    .long 4, 16, 16, 8192, 6400, 268544, 8388608, 262144, 32768, 4, 5345280, 131072, 0, 0, 218104544, 1
    .long 4, 16, 16, 8192, 6400, 268544, 8388608, 524288, 32768, 4, 6393856, 131072, 0, 0, 218104672, 1
    .long 1, 16, 16, 8192, 7680, 7936, 8388608, 1572864, 32768, 8, 10608640, 131072, 0, 0, 218105200, 4
    .long 2, 64, 72, 7168, 768, 768, 7340032, 524288, 32768, 8, 56373248, 114688, 0, 0, 218103872, 1
    .long 2, 64, 72, 7168, 6912, 6912, 7340032, 1572864, 32768, 8, 60141568, 114688, 0, 0, 218104048, 1
    .long 2, 64, 72, 7168, 5888, 5888, 7340032, 3145728, 32768, 8, 65630208, 114688, 0, 0, 218104240, 1
    .long 1, 80, 80, 2048, 5506560, 5506816, 7340032, 63787008, 114688, 7, 183001088, 32768, 218104176, 7, 218106688, 1
    .long 0, 0, 0, 0, 0, 0, 0, 0, 0, 0, 0, 0, 0, 0, 0, 0
    .long 0, 0, 0, 0, 0, 0, 0, 0, 0, 0, 0, 0, 0, 0, 0, 0
    .long 4, 16, 16, 8192, 512, 262656, 8388608, 0, 32768, 4, 4202496, 131072, 0, 0, 218104320, 1
    .long 4, 16, 16, 8192, 512, 262656, 8388608, 262144, 32768, 4, 5251072, 131072, 0, 0, 218104448, 1
    .long 4, 16, 16, 8192, 512, 262656, 8388608, 524288, 32768, 4, 6299648, 131072, 0, 0, 218104576, 1
    .long 1, 32, 32, 8192, 0, 256, 8388608, 2097152, 32768, 8, 46137344, 131072, 0, 0, 218105344, 4
    .long 2, 64, 72, 7168, 1024, 1024, 7340032, 524288, 32768, 8, 56377344, 114688, 0, 0, 218103872, 1
    .long 2, 64, 72, 7168, 0, 0, 7340032, 2097152, 32768, 8, 61865984, 114688, 0, 0, 218104064, 1
    .long 2, 64, 72, 7168, 6144, 6144, 7340032, 3145728, 32768, 8, 65634304, 114688, 0, 0, 218104240, 1
    .long 1, 80, 80, 2048, 0, 256, 7340032, 65536000, 114688, 7, 170917888, 32768, 218104192, 7, 218106752, 1
    .long 0, 0, 0, 0, 0, 0, 0, 0, 0, 0, 0, 0, 0, 0, 0, 0
    .long 0, 0, 0, 0, 0, 0, 0, 0, 0, 0, 0, 0, 0, 0, 0, 0
    .long 4, 16, 16, 8192, 2560, 264704, 8388608, 0, 32768, 4, 4235264, 131072, 0, 0, 218104352, 1
    .long 4, 16, 16, 8192, 2560, 264704, 8388608, 262144, 32768, 4, 5283840, 131072, 0, 0, 218104480, 1
    .long 4, 16, 16, 8192, 2560, 264704, 8388608, 524288, 32768, 4, 6332416, 131072, 0, 0, 218104608, 1
    .long 1, 32, 32, 8192, 2048, 2304, 8388608, 2097152, 32768, 8, 46170112, 131072, 0, 0, 218105376, 4
    .long 2, 64, 72, 7168, 1280, 1280, 7340032, 524288, 32768, 8, 56381440, 114688, 0, 0, 218103872, 1
    .long 2, 64, 72, 7168, 256, 256, 7340032, 2097152, 32768, 8, 61870080, 114688, 0, 0, 218104064, 1
    .long 2, 64, 72, 7168, 6400, 6400, 7340032, 3145728, 32768, 8, 65638400, 114688, 0, 0, 218104240, 1
    .long 1, 80, 80, 2048, 512, 768, 7340032, 65536000, 114688, 7, 170926080, 32768, 218104192, 7, 218106752, 1
    .long 0, 0, 0, 0, 0, 0, 0, 0, 0, 0, 0, 0, 0, 0, 0, 0
    .long 0, 0, 0, 0, 0, 0, 0, 0, 0, 0, 0, 0, 0, 0, 0, 0
    .long 4, 16, 16, 8192, 4608, 266752, 8388608, 0, 32768, 4, 4268032, 131072, 0, 0, 218104384, 1
    .long 4, 16, 16, 8192, 4608, 266752, 8388608, 262144, 32768, 4, 5316608, 131072, 0, 0, 218104512, 1
    .long 4, 16, 16, 8192, 4608, 266752, 8388608, 524288, 32768, 4, 6365184, 131072, 0, 0, 218104640, 1
    .long 1, 32, 32, 8192, 4096, 4352, 8388608, 2097152, 32768, 8, 46202880, 131072, 0, 0, 218105408, 4
    .long 2, 64, 72, 7168, 1536, 1536, 7340032, 524288, 32768, 8, 56385536, 114688, 0, 0, 218103872, 1
    .long 2, 64, 72, 7168, 512, 512, 7340032, 2097152, 32768, 8, 61874176, 114688, 0, 0, 218104064, 1
    .long 2, 64, 72, 7168, 6656, 6656, 7340032, 3145728, 32768, 8, 65642496, 114688, 0, 0, 218104240, 1
    .long 1, 80, 80, 2048, 1024, 1280, 7340032, 65536000, 114688, 7, 170934272, 32768, 218104192, 7, 218106752, 1
    .long 0, 0, 0, 0, 0, 0, 0, 0, 0, 0, 0, 0, 0, 0, 0, 0
    .long 0, 0, 0, 0, 0, 0, 0, 0, 0, 0, 0, 0, 0, 0, 0, 0
    .long 4, 16, 16, 8192, 6656, 268800, 8388608, 0, 32768, 4, 4300800, 131072, 0, 0, 218104416, 1
    .long 4, 16, 16, 8192, 6656, 268800, 8388608, 262144, 32768, 4, 5349376, 131072, 0, 0, 218104544, 1
    .long 4, 16, 16, 8192, 6656, 268800, 8388608, 524288, 32768, 4, 6397952, 131072, 0, 0, 218104672, 1
    .long 1, 32, 32, 8192, 6144, 6400, 8388608, 2097152, 32768, 8, 46235648, 131072, 0, 0, 218105440, 4
    .long 2, 64, 72, 7168, 1792, 1792, 7340032, 524288, 32768, 8, 56389632, 114688, 0, 0, 218103888, 1
    .long 2, 64, 72, 7168, 768, 768, 7340032, 2097152, 32768, 8, 61878272, 114688, 0, 0, 218104064, 1
    .long 2, 64, 72, 7168, 6912, 6912, 7340032, 3145728, 32768, 8, 65646592, 114688, 0, 0, 218104240, 1
    .long 1, 80, 80, 2048, 1536, 1792, 7340032, 65536000, 114688, 7, 170942464, 32768, 218104192, 7, 218106752, 1
    .long 0, 0, 0, 0, 0, 0, 0, 0, 0, 0, 0, 0, 0, 0, 0, 0
    .long 0, 0, 0, 0, 0, 0, 0, 0, 0, 0, 0, 0, 0, 0, 0, 0
    .long 4, 16, 16, 8192, 768, 262912, 8388608, 0, 32768, 4, 4206592, 131072, 0, 0, 218104320, 1
    .long 4, 16, 16, 8192, 768, 262912, 8388608, 262144, 32768, 4, 5255168, 131072, 0, 0, 218104448, 1
    .long 4, 16, 16, 8192, 768, 262912, 8388608, 524288, 32768, 4, 6303744, 131072, 0, 0, 218104576, 1
    .long 1, 32, 32, 8192, 512, 768, 8388608, 2097152, 32768, 8, 46145536, 131072, 0, 0, 218105344, 4
    .long 2, 64, 72, 7168, 2048, 2048, 7340032, 524288, 32768, 8, 56393728, 114688, 0, 0, 218103888, 1
    .long 2, 64, 72, 7168, 1024, 1024, 7340032, 2097152, 32768, 8, 61882368, 114688, 0, 0, 218104064, 1
    .long 2, 64, 72, 7168, 0, 0, 7340032, 3670016, 32768, 8, 67371008, 114688, 0, 0, 218104256, 1
    .long 1, 80, 80, 2048, 1835008, 1835264, 7340032, 65564672, 114688, 7, 175112192, 32768, 218104208, 7, 218106752, 1
    .long 0, 0, 0, 0, 0, 0, 0, 0, 0, 0, 0, 0, 0, 0, 0, 0
    .long 0, 0, 0, 0, 0, 0, 0, 0, 0, 0, 0, 0, 0, 0, 0, 0
    .long 4, 16, 16, 8192, 2816, 264960, 8388608, 0, 32768, 4, 4239360, 131072, 0, 0, 218104352, 1
    .long 4, 16, 16, 8192, 2816, 264960, 8388608, 262144, 32768, 4, 5287936, 131072, 0, 0, 218104480, 1
    .long 4, 16, 16, 8192, 2816, 264960, 8388608, 524288, 32768, 4, 6336512, 131072, 0, 0, 218104608, 1
    .long 1, 32, 32, 8192, 2560, 2816, 8388608, 2097152, 32768, 8, 46178304, 131072, 0, 0, 218105376, 4
    .long 2, 64, 72, 7168, 2304, 2304, 7340032, 524288, 32768, 8, 56397824, 114688, 0, 0, 218103888, 1
    .long 2, 64, 72, 7168, 1280, 1280, 7340032, 2097152, 32768, 8, 61886464, 114688, 0, 0, 218104064, 1
    .long 2, 64, 72, 7168, 256, 256, 7340032, 3670016, 32768, 8, 67375104, 114688, 0, 0, 218104256, 1
    .long 1, 80, 80, 2048, 1835520, 1835776, 7340032, 65564672, 114688, 7, 175120384, 32768, 218104208, 7, 218106752, 1
    .long 0, 0, 0, 0, 0, 0, 0, 0, 0, 0, 0, 0, 0, 0, 0, 0
    .long 0, 0, 0, 0, 0, 0, 0, 0, 0, 0, 0, 0, 0, 0, 0, 0
    .long 4, 16, 16, 8192, 4864, 267008, 8388608, 0, 32768, 4, 4272128, 131072, 0, 0, 218104384, 1
    .long 4, 16, 16, 8192, 4864, 267008, 8388608, 262144, 32768, 4, 5320704, 131072, 0, 0, 218104512, 1
    .long 4, 16, 16, 8192, 4864, 267008, 8388608, 524288, 32768, 4, 6369280, 131072, 0, 0, 218104640, 1
    .long 1, 32, 32, 8192, 4608, 4864, 8388608, 2097152, 32768, 8, 46211072, 131072, 0, 0, 218105408, 4
    .long 2, 64, 72, 7168, 2560, 2560, 7340032, 524288, 32768, 8, 56401920, 114688, 0, 0, 218103888, 1
    .long 2, 64, 72, 7168, 1536, 1536, 7340032, 2097152, 32768, 8, 61890560, 114688, 0, 0, 218104064, 1
    .long 2, 64, 72, 7168, 512, 512, 7340032, 3670016, 32768, 8, 67379200, 114688, 0, 0, 218104256, 1
    .long 1, 80, 80, 2048, 1836032, 1836288, 7340032, 65564672, 114688, 7, 175128576, 32768, 218104208, 7, 218106752, 1
    .long 0, 0, 0, 0, 0, 0, 0, 0, 0, 0, 0, 0, 0, 0, 0, 0
    .long 0, 0, 0, 0, 0, 0, 0, 0, 0, 0, 0, 0, 0, 0, 0, 0
    .long 4, 16, 16, 8192, 6912, 269056, 8388608, 0, 32768, 4, 4304896, 131072, 0, 0, 218104416, 1
    .long 4, 16, 16, 8192, 6912, 269056, 8388608, 262144, 32768, 4, 5353472, 131072, 0, 0, 218104544, 1
    .long 4, 16, 16, 8192, 6912, 269056, 8388608, 524288, 32768, 4, 6402048, 131072, 0, 0, 218104672, 1
    .long 1, 32, 32, 8192, 6656, 6912, 8388608, 2097152, 32768, 8, 46243840, 131072, 0, 0, 218105440, 4
    .long 2, 64, 72, 7168, 2816, 2816, 7340032, 524288, 32768, 8, 56406016, 114688, 0, 0, 218103888, 1
    .long 2, 64, 72, 7168, 1792, 1792, 7340032, 2097152, 32768, 8, 61894656, 114688, 0, 0, 218104080, 1
    .long 2, 64, 72, 7168, 768, 768, 7340032, 3670016, 32768, 8, 67383296, 114688, 0, 0, 218104256, 1
    .long 1, 80, 80, 2048, 1836544, 1836800, 7340032, 65564672, 114688, 7, 175136768, 32768, 218104208, 7, 218106752, 1
    .long 0, 0, 0, 0, 0, 0, 0, 0, 0, 0, 0, 0, 0, 0, 0, 0
    .long 0, 0, 0, 0, 0, 0, 0, 0, 0, 0, 0, 0, 0, 0, 0, 0
    .long 4, 16, 16, 8192, 1024, 263168, 8388608, 0, 32768, 4, 4210688, 131072, 0, 0, 218104336, 1
    .long 4, 16, 16, 8192, 1024, 263168, 8388608, 262144, 32768, 4, 5259264, 131072, 0, 0, 218104464, 1
    .long 4, 16, 16, 8192, 768, 262912, 8388608, 786432, 32768, 4, 7352320, 131072, 0, 0, 218104576, 1
    .long 1, 32, 32, 8192, 1024, 1280, 8388608, 2097152, 32768, 8, 46153728, 131072, 0, 0, 218105360, 4
    .long 2, 64, 72, 7168, 3072, 3072, 7340032, 524288, 32768, 8, 56410112, 114688, 0, 0, 218103888, 1
    .long 2, 64, 72, 7168, 2048, 2048, 7340032, 2097152, 32768, 8, 61898752, 114688, 0, 0, 218104080, 1
    .long 2, 64, 72, 7168, 1024, 1024, 7340032, 3670016, 32768, 8, 67387392, 114688, 0, 0, 218104256, 1
    .long 1, 80, 80, 2048, 3670016, 3670272, 7340032, 65593344, 114688, 7, 179306496, 32768, 218104224, 7, 218106752, 1
    .long 0, 0, 0, 0, 0, 0, 0, 0, 0, 0, 0, 0, 0, 0, 0, 0
    .long 0, 0, 0, 0, 0, 0, 0, 0, 0, 0, 0, 0, 0, 0, 0, 0
    .long 4, 16, 16, 8192, 3072, 265216, 8388608, 0, 32768, 4, 4243456, 131072, 0, 0, 218104368, 1
    .long 4, 16, 16, 8192, 3072, 265216, 8388608, 262144, 32768, 4, 5292032, 131072, 0, 0, 218104496, 1
    .long 4, 16, 16, 8192, 2816, 264960, 8388608, 786432, 32768, 4, 7385088, 131072, 0, 0, 218104608, 1
    .long 1, 32, 32, 8192, 3072, 3328, 8388608, 2097152, 32768, 8, 46186496, 131072, 0, 0, 218105392, 4
    .long 2, 64, 72, 7168, 3328, 3328, 7340032, 524288, 32768, 8, 56414208, 114688, 0, 0, 218103888, 1
    .long 2, 64, 72, 7168, 2304, 2304, 7340032, 2097152, 32768, 8, 61902848, 114688, 0, 0, 218104080, 1
    .long 2, 64, 72, 7168, 1280, 1280, 7340032, 3670016, 32768, 8, 67391488, 114688, 0, 0, 218104256, 1
    .long 1, 80, 80, 2048, 3670528, 3670784, 7340032, 65593344, 114688, 7, 179314688, 32768, 218104224, 7, 218106752, 1
    .long 0, 0, 0, 0, 0, 0, 0, 0, 0, 0, 0, 0, 0, 0, 0, 0
    .long 0, 0, 0, 0, 0, 0, 0, 0, 0, 0, 0, 0, 0, 0, 0, 0
    .long 4, 16, 16, 8192, 5120, 267264, 8388608, 0, 32768, 4, 4276224, 131072, 0, 0, 218104400, 1
    .long 4, 16, 16, 8192, 5120, 267264, 8388608, 262144, 32768, 4, 5324800, 131072, 0, 0, 218104528, 1
    .long 4, 16, 16, 8192, 4864, 267008, 8388608, 786432, 32768, 4, 7417856, 131072, 0, 0, 218104640, 1
    .long 1, 32, 32, 8192, 5120, 5376, 8388608, 2097152, 32768, 8, 46219264, 131072, 0, 0, 218105424, 4
    .long 2, 64, 72, 7168, 3584, 3584, 7340032, 524288, 32768, 8, 56418304, 114688, 0, 0, 218103904, 1
    .long 2, 64, 72, 7168, 2560, 2560, 7340032, 2097152, 32768, 8, 61906944, 114688, 0, 0, 218104080, 1
    .long 2, 64, 72, 7168, 1536, 1536, 7340032, 3670016, 32768, 8, 67395584, 114688, 0, 0, 218104256, 1
    .long 1, 80, 80, 2048, 3671040, 3671296, 7340032, 65593344, 114688, 7, 179322880, 32768, 218104224, 7, 218106752, 1
    .long 0, 0, 0, 0, 0, 0, 0, 0, 0, 0, 0, 0, 0, 0, 0, 0
    .long 0, 0, 0, 0, 0, 0, 0, 0, 0, 0, 0, 0, 0, 0, 0, 0
    .long 4, 16, 16, 8192, 7168, 269312, 8388608, 0, 32768, 4, 4308992, 131072, 0, 0, 218104432, 1
    .long 4, 16, 16, 8192, 7168, 269312, 8388608, 262144, 32768, 4, 5357568, 131072, 0, 0, 218104560, 1
    .long 4, 16, 16, 8192, 6912, 269056, 8388608, 786432, 32768, 4, 7450624, 131072, 0, 0, 218104672, 1
    .long 1, 32, 32, 8192, 7168, 7424, 8388608, 2097152, 32768, 8, 46252032, 131072, 0, 0, 218105456, 4
    .long 2, 64, 72, 7168, 3840, 3840, 7340032, 524288, 32768, 8, 56422400, 114688, 0, 0, 218103904, 1
    .long 2, 64, 72, 7168, 2816, 2816, 7340032, 2097152, 32768, 8, 61911040, 114688, 0, 0, 218104080, 1
    .long 2, 64, 72, 7168, 1792, 1792, 7340032, 3670016, 32768, 8, 67399680, 114688, 0, 0, 218104272, 1
    .long 1, 80, 80, 2048, 3671552, 3671808, 7340032, 65593344, 114688, 7, 179331072, 32768, 218104224, 7, 218106752, 1
    .long 0, 0, 0, 0, 0, 0, 0, 0, 0, 0, 0, 0, 0, 0, 0, 0
    .long 0, 0, 0, 0, 0, 0, 0, 0, 0, 0, 0, 0, 0, 0, 0, 0
    .long 4, 16, 16, 8192, 1280, 263424, 8388608, 0, 32768, 4, 4214784, 131072, 0, 0, 218104336, 1
    .long 4, 16, 16, 8192, 1280, 263424, 8388608, 262144, 32768, 4, 5263360, 131072, 0, 0, 218104464, 1
    .long 4, 16, 16, 8192, 512, 262656, 8388608, 786432, 32768, 4, 7348224, 131072, 0, 0, 218104576, 1
    .long 1, 32, 32, 8192, 1536, 1792, 8388608, 2097152, 32768, 8, 46161920, 131072, 0, 0, 218105360, 4
    .long 2, 64, 72, 7168, 4096, 4096, 7340032, 524288, 32768, 8, 56426496, 114688, 0, 0, 218103904, 1
    .long 2, 64, 72, 7168, 3072, 3072, 7340032, 2097152, 32768, 8, 61915136, 114688, 0, 0, 218104080, 1
    .long 2, 64, 72, 7168, 2048, 2048, 7340032, 3670016, 32768, 8, 67403776, 114688, 0, 0, 218104272, 1
    .long 1, 80, 80, 2048, 5505024, 5505280, 7340032, 65622016, 114688, 7, 183500800, 32768, 218104240, 7, 218106752, 1
    .long 0, 0, 0, 0, 0, 0, 0, 0, 0, 0, 0, 0, 0, 0, 0, 0
    .long 0, 0, 0, 0, 0, 0, 0, 0, 0, 0, 0, 0, 0, 0, 0, 0
    .long 4, 16, 16, 8192, 3328, 265472, 8388608, 0, 32768, 4, 4247552, 131072, 0, 0, 218104368, 1
    .long 4, 16, 16, 8192, 3328, 265472, 8388608, 262144, 32768, 4, 5296128, 131072, 0, 0, 218104496, 1
    .long 4, 16, 16, 8192, 2560, 264704, 8388608, 786432, 32768, 4, 7380992, 131072, 0, 0, 218104608, 1
    .long 1, 32, 32, 8192, 3584, 3840, 8388608, 2097152, 32768, 8, 46194688, 131072, 0, 0, 218105392, 4
    .long 2, 64, 72, 7168, 4352, 4352, 7340032, 524288, 32768, 8, 56430592, 114688, 0, 0, 218103904, 1
    .long 2, 64, 72, 7168, 3328, 3328, 7340032, 2097152, 32768, 8, 61919232, 114688, 0, 0, 218104080, 1
    .long 2, 64, 72, 7168, 2304, 2304, 7340032, 3670016, 32768, 8, 67407872, 114688, 0, 0, 218104272, 1
    .long 1, 80, 80, 2048, 5505536, 5505792, 7340032, 65622016, 114688, 7, 183508992, 32768, 218104240, 7, 218106752, 1
    .long 0, 0, 0, 0, 0, 0, 0, 0, 0, 0, 0, 0, 0, 0, 0, 0
    .long 0, 0, 0, 0, 0, 0, 0, 0, 0, 0, 0, 0, 0, 0, 0, 0
    .long 4, 16, 16, 8192, 5376, 267520, 8388608, 0, 32768, 4, 4280320, 131072, 0, 0, 218104400, 1
    .long 4, 16, 16, 8192, 5376, 267520, 8388608, 262144, 32768, 4, 5328896, 131072, 0, 0, 218104528, 1
    .long 4, 16, 16, 8192, 4608, 266752, 8388608, 786432, 32768, 4, 7413760, 131072, 0, 0, 218104640, 1
    .long 1, 32, 32, 8192, 5632, 5888, 8388608, 2097152, 32768, 8, 46227456, 131072, 0, 0, 218105424, 4
    .long 2, 64, 72, 7168, 4608, 4608, 7340032, 524288, 32768, 8, 56434688, 114688, 0, 0, 218103904, 1
    .long 2, 64, 72, 7168, 3584, 3584, 7340032, 2097152, 32768, 8, 61923328, 114688, 0, 0, 218104096, 1
    .long 2, 64, 72, 7168, 2560, 2560, 7340032, 3670016, 32768, 8, 67411968, 114688, 0, 0, 218104272, 1
    .long 1, 80, 80, 2048, 5506048, 5506304, 7340032, 65622016, 114688, 7, 183517184, 32768, 218104240, 7, 218106752, 1
    .long 0, 0, 0, 0, 0, 0, 0, 0, 0, 0, 0, 0, 0, 0, 0, 0
    .long 0, 0, 0, 0, 0, 0, 0, 0, 0, 0, 0, 0, 0, 0, 0, 0
    .long 4, 16, 16, 8192, 7424, 269568, 8388608, 0, 32768, 4, 4313088, 131072, 0, 0, 218104432, 1
    .long 4, 16, 16, 8192, 7424, 269568, 8388608, 262144, 32768, 4, 5361664, 131072, 0, 0, 218104560, 1
    .long 4, 16, 16, 8192, 6656, 268800, 8388608, 786432, 32768, 4, 7446528, 131072, 0, 0, 218104672, 1
    .long 1, 32, 32, 8192, 7680, 7936, 8388608, 2097152, 32768, 8, 46260224, 131072, 0, 0, 218105456, 4
    .long 2, 64, 72, 7168, 4864, 4864, 7340032, 524288, 32768, 8, 56438784, 114688, 0, 0, 218103904, 1
    .long 2, 64, 72, 7168, 3840, 3840, 7340032, 2097152, 32768, 8, 61927424, 114688, 0, 0, 218104096, 1
    .long 2, 64, 72, 7168, 2816, 2816, 7340032, 3670016, 32768, 8, 67416064, 114688, 0, 0, 218104272, 1
    .long 1, 80, 80, 2048, 5506560, 5506816, 7340032, 65622016, 114688, 7, 183525376, 32768, 218104240, 7, 218106752, 1
    .long 0, 0, 0, 0, 0, 0, 0, 0, 0, 0, 0, 0, 0, 0, 0, 0
    .long 0, 0, 0, 0, 0, 0, 0, 0, 0, 0, 0, 0, 0, 0, 0, 0
    .long 4, 16, 16, 8192, 1536, 263680, 8388608, 0, 32768, 4, 4218880, 131072, 0, 0, 218104336, 1
    .long 4, 16, 16, 8192, 1536, 263680, 8388608, 262144, 32768, 4, 5267456, 131072, 0, 0, 218104464, 1
    .long 4, 16, 16, 8192, 256, 262400, 8388608, 786432, 32768, 4, 7344128, 131072, 0, 0, 218104576, 1
    .long 1, 24, 24, 8192, 0, 256, 8388608, 2097152, 32768, 8, 29360128, 131072, 0, 0, 218105344, 4
    .long 2, 64, 72, 7168, 5120, 5120, 7340032, 524288, 32768, 8, 56442880, 114688, 0, 0, 218103904, 1
    .long 2, 64, 72, 7168, 4096, 4096, 7340032, 2097152, 32768, 8, 61931520, 114688, 0, 0, 218104096, 1
    .long 2, 64, 72, 7168, 3072, 3072, 7340032, 3670016, 32768, 8, 67420160, 114688, 0, 0, 218104272, 1
    .long 1, 80, 80, 2048, 0, 256, 7340032, 67371008, 114688, 7, 171442176, 32768, 218104256, 7, 218106816, 1
    .long 0, 0, 0, 0, 0, 0, 0, 0, 0, 0, 0, 0, 0, 0, 0, 0
    .long 0, 0, 0, 0, 0, 0, 0, 0, 0, 0, 0, 0, 0, 0, 0, 0
    .long 4, 16, 16, 8192, 3584, 265728, 8388608, 0, 32768, 4, 4251648, 131072, 0, 0, 218104368, 1
    .long 4, 16, 16, 8192, 3584, 265728, 8388608, 262144, 32768, 4, 5300224, 131072, 0, 0, 218104496, 1
    .long 4, 16, 16, 8192, 2304, 264448, 8388608, 786432, 32768, 4, 7376896, 131072, 0, 0, 218104608, 1
    .long 1, 24, 24, 8192, 2048, 2304, 8388608, 2097152, 32768, 8, 29392896, 131072, 0, 0, 218105376, 4
    .long 2, 64, 72, 7168, 5376, 5376, 7340032, 524288, 32768, 8, 56446976, 114688, 0, 0, 218103920, 1
    .long 2, 64, 72, 7168, 4352, 4352, 7340032, 2097152, 32768, 8, 61935616, 114688, 0, 0, 218104096, 1
    .long 2, 64, 72, 7168, 3328, 3328, 7340032, 3670016, 32768, 8, 67424256, 114688, 0, 0, 218104272, 1
    .long 1, 80, 80, 2048, 512, 768, 7340032, 67371008, 114688, 7, 171450368, 32768, 218104256, 7, 218106816, 1
    .long 0, 0, 0, 0, 0, 0, 0, 0, 0, 0, 0, 0, 0, 0, 0, 0
    .long 0, 0, 0, 0, 0, 0, 0, 0, 0, 0, 0, 0, 0, 0, 0, 0
    .long 4, 16, 16, 8192, 5632, 267776, 8388608, 0, 32768, 4, 4284416, 131072, 0, 0, 218104400, 1
    .long 4, 16, 16, 8192, 5632, 267776, 8388608, 262144, 32768, 4, 5332992, 131072, 0, 0, 218104528, 1
    .long 4, 16, 16, 8192, 4352, 266496, 8388608, 786432, 32768, 4, 7409664, 131072, 0, 0, 218104640, 1
    .long 1, 24, 24, 8192, 4096, 4352, 8388608, 2097152, 32768, 8, 29425664, 131072, 0, 0, 218105408, 4
    .long 2, 64, 72, 7168, 5632, 5632, 7340032, 524288, 32768, 8, 56451072, 114688, 0, 0, 218103920, 1
    .long 2, 64, 72, 7168, 4608, 4608, 7340032, 2097152, 32768, 8, 61939712, 114688, 0, 0, 218104096, 1
    .long 2, 64, 72, 7168, 3584, 3584, 7340032, 3670016, 32768, 8, 67428352, 114688, 0, 0, 218104288, 1
    .long 1, 80, 80, 2048, 1024, 1280, 7340032, 67371008, 114688, 7, 171458560, 32768, 218104256, 7, 218106816, 1
    .long 0, 0, 0, 0, 0, 0, 0, 0, 0, 0, 0, 0, 0, 0, 0, 0
    .long 0, 0, 0, 0, 0, 0, 0, 0, 0, 0, 0, 0, 0, 0, 0, 0
    .long 4, 16, 16, 8192, 7680, 269824, 8388608, 0, 32768, 4, 4317184, 131072, 0, 0, 218104432, 1
    .long 4, 16, 16, 8192, 7680, 269824, 8388608, 262144, 32768, 4, 5365760, 131072, 0, 0, 218104560, 1
    .long 4, 16, 16, 8192, 6400, 268544, 8388608, 786432, 32768, 4, 7442432, 131072, 0, 0, 218104672, 1
    .long 1, 24, 24, 8192, 6144, 6400, 8388608, 2097152, 32768, 8, 29458432, 131072, 0, 0, 218105440, 4
    .long 2, 64, 72, 7168, 5888, 5888, 7340032, 524288, 32768, 8, 56455168, 114688, 0, 0, 218103920, 1
    .long 2, 64, 72, 7168, 4864, 4864, 7340032, 2097152, 32768, 8, 61943808, 114688, 0, 0, 218104096, 1
    .long 2, 64, 72, 7168, 3840, 3840, 7340032, 3670016, 32768, 8, 67432448, 114688, 0, 0, 218104288, 1
    .long 1, 80, 80, 2048, 1536, 1792, 7340032, 67371008, 114688, 7, 171466752, 32768, 218104256, 7, 218106816, 1
    .long 0, 0, 0, 0, 0, 0, 0, 0, 0, 0, 0, 0, 0, 0, 0, 0
    .long 0, 0, 0, 0, 0, 0, 0, 0, 0, 0, 0, 0, 0, 0, 0, 0
    .long 4, 16, 16, 8192, 1792, 263936, 8388608, 0, 32768, 4, 4222976, 131072, 0, 0, 218104336, 1
    .long 4, 16, 16, 8192, 1792, 263936, 8388608, 262144, 32768, 4, 5271552, 131072, 0, 0, 218104464, 1
    .long 4, 16, 16, 8192, 0, 262144, 8388608, 786432, 32768, 4, 7340032, 131072, 0, 0, 218104576, 1
    .long 1, 24, 24, 8192, 512, 768, 8388608, 2097152, 32768, 8, 29368320, 131072, 0, 0, 218105344, 4
    .long 2, 64, 72, 7168, 6144, 6144, 7340032, 524288, 32768, 8, 56459264, 114688, 0, 0, 218103920, 1
    .long 2, 64, 72, 7168, 5120, 5120, 7340032, 2097152, 32768, 8, 61947904, 114688, 0, 0, 218104096, 1
    .long 2, 64, 72, 7168, 4096, 4096, 7340032, 3670016, 32768, 8, 67436544, 114688, 0, 0, 218104288, 1
    .long 1, 80, 80, 2048, 1835008, 1835264, 7340032, 67399680, 114688, 7, 175636480, 32768, 218104272, 7, 218106816, 1
    .long 0, 0, 0, 0, 0, 0, 0, 0, 0, 0, 0, 0, 0, 0, 0, 0
    .long 0, 0, 0, 0, 0, 0, 0, 0, 0, 0, 0, 0, 0, 0, 0, 0
    .long 4, 16, 16, 8192, 3840, 265984, 8388608, 0, 32768, 4, 4255744, 131072, 0, 0, 218104368, 1
    .long 4, 16, 16, 8192, 3840, 265984, 8388608, 262144, 32768, 4, 5304320, 131072, 0, 0, 218104496, 1
    .long 4, 16, 16, 8192, 2048, 264192, 8388608, 786432, 32768, 4, 7372800, 131072, 0, 0, 218104608, 1
    .long 1, 24, 24, 8192, 2560, 2816, 8388608, 2097152, 32768, 8, 29401088, 131072, 0, 0, 218105376, 4
    .long 2, 64, 72, 7168, 6400, 6400, 7340032, 524288, 32768, 8, 56463360, 114688, 0, 0, 218103920, 1
    .long 2, 64, 72, 7168, 5376, 5376, 7340032, 2097152, 32768, 8, 61952000, 114688, 0, 0, 218104112, 1
    .long 2, 64, 72, 7168, 4352, 4352, 7340032, 3670016, 32768, 8, 67440640, 114688, 0, 0, 218104288, 1
    .long 1, 80, 80, 2048, 1835520, 1835776, 7340032, 67399680, 114688, 7, 175644672, 32768, 218104272, 7, 218106816, 1
    .long 0, 0, 0, 0, 0, 0, 0, 0, 0, 0, 0, 0, 0, 0, 0, 0
    .long 0, 0, 0, 0, 0, 0, 0, 0, 0, 0, 0, 0, 0, 0, 0, 0
    .long 4, 16, 16, 8192, 5888, 268032, 8388608, 0, 32768, 4, 4288512, 131072, 0, 0, 218104400, 1
    .long 4, 16, 16, 8192, 5888, 268032, 8388608, 262144, 32768, 4, 5337088, 131072, 0, 0, 218104528, 1
    .long 4, 16, 16, 8192, 4096, 266240, 8388608, 786432, 32768, 4, 7405568, 131072, 0, 0, 218104640, 1
    .long 1, 24, 24, 8192, 4608, 4864, 8388608, 2097152, 32768, 8, 29433856, 131072, 0, 0, 218105408, 4
    .long 2, 64, 72, 7168, 6656, 6656, 7340032, 524288, 32768, 8, 56467456, 114688, 0, 0, 218103920, 1
    .long 2, 64, 72, 7168, 5632, 5632, 7340032, 2097152, 32768, 8, 61956096, 114688, 0, 0, 218104112, 1
    .long 2, 64, 72, 7168, 4608, 4608, 7340032, 3670016, 32768, 8, 67444736, 114688, 0, 0, 218104288, 1
    .long 1, 80, 80, 2048, 1836032, 1836288, 7340032, 67399680, 114688, 7, 175652864, 32768, 218104272, 7, 218106816, 1
    .long 0, 0, 0, 0, 0, 0, 0, 0, 0, 0, 0, 0, 0, 0, 0, 0
    .long 0, 0, 0, 0, 0, 0, 0, 0, 0, 0, 0, 0, 0, 0, 0, 0
    .long 4, 16, 16, 8192, 7936, 270080, 8388608, 0, 32768, 4, 4321280, 131072, 0, 0, 218104432, 1
    .long 4, 16, 16, 8192, 7936, 270080, 8388608, 262144, 32768, 4, 5369856, 131072, 0, 0, 218104560, 1
    .long 4, 16, 16, 8192, 6144, 268288, 8388608, 786432, 32768, 4, 7438336, 131072, 0, 0, 218104672, 1
    .long 1, 24, 24, 8192, 6656, 6912, 8388608, 2097152, 32768, 8, 29466624, 131072, 0, 0, 218105440, 4
    .long 2, 64, 72, 7168, 6912, 6912, 7340032, 524288, 32768, 8, 56471552, 114688, 0, 0, 218103920, 1
    .long 2, 64, 72, 7168, 5888, 5888, 7340032, 2097152, 32768, 8, 61960192, 114688, 0, 0, 218104112, 1
    .long 2, 64, 72, 7168, 4864, 4864, 7340032, 3670016, 32768, 8, 67448832, 114688, 0, 0, 218104288, 1
    .long 1, 80, 80, 2048, 1836544, 1836800, 7340032, 67399680, 114688, 7, 175661056, 32768, 218104272, 7, 218106816, 1
    .long 0, 0, 0, 0, 0, 0, 0, 0, 0, 0, 0, 0, 0, 0, 0, 0
    .long 0, 0, 0, 0, 0, 0, 0, 0, 0, 0, 0, 0, 0, 0, 0, 0
    .long 1, 32, 32, 8192, 0, 256, 8388608, 524288, 32768, 8, 39845888, 131072, 0, 0, 218104576, 4
    .long 1, 16, 16, 8192, 0, 256, 8388608, 1048576, 32768, 8, 8388608, 131072, 0, 0, 218104832, 4
    .long 1, 24, 24, 8192, 0, 256, 8388608, 2621440, 32768, 8, 31457280, 131072, 0, 0, 218105600, 4
    .long 1, 16, 16, 8192, 0, 256, 8388608, 3145728, 32768, 8, 16777216, 131072, 0, 0, 218105856, 4
    .long 1, 16, 16, 8192, 0, 256, 8388608, 3670016, 32768, 8, 18874368, 131072, 0, 0, 218106112, 4
    .long 1, 80, 80, 2048, 0, 256, 7340032, 58195968, 114688, 7, 168820736, 32768, 218103936, 7, 218106496, 1
    .long 0, 0, 0, 0, 0, 0, 0, 0, 0, 0, 0, 0, 0, 0, 0, 0
    .long 0, 0, 0, 0, 0, 0, 0, 0, 0, 0, 0, 0, 0, 0, 0, 0
    .long 0, 0, 0, 0, 0, 0, 0, 0, 0, 0, 0, 0, 0, 0, 0, 0
    .long 0, 0, 0, 0, 0, 0, 0, 0, 0, 0, 0, 0, 0, 0, 0, 0
    .long 1, 32, 32, 8192, 2048, 2304, 8388608, 524288, 32768, 8, 39878656, 131072, 0, 0, 218104608, 4
    .long 1, 16, 16, 8192, 2048, 2304, 8388608, 1048576, 32768, 8, 8421376, 131072, 0, 0, 218104864, 4
    .long 1, 24, 24, 8192, 2048, 2304, 8388608, 2621440, 32768, 8, 31490048, 131072, 0, 0, 218105632, 4
    .long 1, 16, 16, 8192, 2048, 2304, 8388608, 3145728, 32768, 8, 16809984, 131072, 0, 0, 218105888, 4
    .long 1, 16, 16, 8192, 2048, 2304, 8388608, 3670016, 32768, 8, 18907136, 131072, 0, 0, 218106144, 4
    .long 1, 80, 80, 2048, 512, 768, 7340032, 58195968, 114688, 7, 168828928, 32768, 218103936, 7, 218106496, 1
    .long 0, 0, 0, 0, 0, 0, 0, 0, 0, 0, 0, 0, 0, 0, 0, 0
    .long 0, 0, 0, 0, 0, 0, 0, 0, 0, 0, 0, 0, 0, 0, 0, 0
    .long 0, 0, 0, 0, 0, 0, 0, 0, 0, 0, 0, 0, 0, 0, 0, 0
    .long 0, 0, 0, 0, 0, 0, 0, 0, 0, 0, 0, 0, 0, 0, 0, 0
    .long 1, 32, 32, 8192, 4096, 4352, 8388608, 524288, 32768, 8, 39911424, 131072, 0, 0, 218104640, 4
    .long 1, 16, 16, 8192, 4096, 4352, 8388608, 1048576, 32768, 8, 8454144, 131072, 0, 0, 218104896, 4
    .long 1, 24, 24, 8192, 4096, 4352, 8388608, 2621440, 32768, 8, 31522816, 131072, 0, 0, 218105664, 4
    .long 1, 16, 16, 8192, 4096, 4352, 8388608, 3145728, 32768, 8, 16842752, 131072, 0, 0, 218105920, 4
    .long 1, 16, 16, 8192, 4096, 4352, 8388608, 3670016, 32768, 8, 18939904, 131072, 0, 0, 218106176, 4
    .long 1, 80, 80, 2048, 1024, 1280, 7340032, 58195968, 114688, 7, 168837120, 32768, 218103936, 7, 218106496, 1
    .long 0, 0, 0, 0, 0, 0, 0, 0, 0, 0, 0, 0, 0, 0, 0, 0
    .long 0, 0, 0, 0, 0, 0, 0, 0, 0, 0, 0, 0, 0, 0, 0, 0
    .long 0, 0, 0, 0, 0, 0, 0, 0, 0, 0, 0, 0, 0, 0, 0, 0
    .long 0, 0, 0, 0, 0, 0, 0, 0, 0, 0, 0, 0, 0, 0, 0, 0
    .long 1, 32, 32, 8192, 6144, 6400, 8388608, 524288, 32768, 8, 39944192, 131072, 0, 0, 218104672, 4
    .long 1, 16, 16, 8192, 6144, 6400, 8388608, 1048576, 32768, 8, 8486912, 131072, 0, 0, 218104928, 4
    .long 1, 24, 24, 8192, 6144, 6400, 8388608, 2621440, 32768, 8, 31555584, 131072, 0, 0, 218105696, 4
    .long 1, 16, 16, 8192, 6144, 6400, 8388608, 3145728, 32768, 8, 16875520, 131072, 0, 0, 218105952, 4
    .long 1, 16, 16, 8192, 6144, 6400, 8388608, 3670016, 32768, 8, 18972672, 131072, 0, 0, 218106208, 4
    .long 1, 80, 80, 2048, 1536, 1792, 7340032, 58195968, 114688, 7, 168845312, 32768, 218103936, 7, 218106496, 1
    .long 0, 0, 0, 0, 0, 0, 0, 0, 0, 0, 0, 0, 0, 0, 0, 0
    .long 0, 0, 0, 0, 0, 0, 0, 0, 0, 0, 0, 0, 0, 0, 0, 0
    .long 0, 0, 0, 0, 0, 0, 0, 0, 0, 0, 0, 0, 0, 0, 0, 0
    .long 0, 0, 0, 0, 0, 0, 0, 0, 0, 0, 0, 0, 0, 0, 0, 0
    .long 1, 32, 32, 8192, 512, 768, 8388608, 524288, 32768, 8, 39854080, 131072, 0, 0, 218104576, 4
    .long 1, 16, 16, 8192, 512, 768, 8388608, 1048576, 32768, 8, 8396800, 131072, 0, 0, 218104832, 4
    .long 1, 24, 24, 8192, 512, 768, 8388608, 2621440, 32768, 8, 31465472, 131072, 0, 0, 218105600, 4
    .long 1, 16, 16, 8192, 512, 768, 8388608, 3145728, 32768, 8, 16785408, 131072, 0, 0, 218105856, 4
    .long 1, 16, 16, 8192, 512, 768, 8388608, 3670016, 32768, 8, 18882560, 131072, 0, 0, 218106112, 4
    .long 1, 80, 80, 2048, 1835008, 1835264, 7340032, 58224640, 114688, 7, 173015040, 32768, 218103952, 7, 218106496, 1
    .long 0, 0, 0, 0, 0, 0, 0, 0, 0, 0, 0, 0, 0, 0, 0, 0
    .long 0, 0, 0, 0, 0, 0, 0, 0, 0, 0, 0, 0, 0, 0, 0, 0
    .long 0, 0, 0, 0, 0, 0, 0, 0, 0, 0, 0, 0, 0, 0, 0, 0
    .long 0, 0, 0, 0, 0, 0, 0, 0, 0, 0, 0, 0, 0, 0, 0, 0
    .long 1, 32, 32, 8192, 2560, 2816, 8388608, 524288, 32768, 8, 39886848, 131072, 0, 0, 218104608, 4
    .long 1, 16, 16, 8192, 2560, 2816, 8388608, 1048576, 32768, 8, 8429568, 131072, 0, 0, 218104864, 4
    .long 1, 24, 24, 8192, 2560, 2816, 8388608, 2621440, 32768, 8, 31498240, 131072, 0, 0, 218105632, 4
    .long 1, 16, 16, 8192, 2560, 2816, 8388608, 3145728, 32768, 8, 16818176, 131072, 0, 0, 218105888, 4
    .long 1, 16, 16, 8192, 2560, 2816, 8388608, 3670016, 32768, 8, 18915328, 131072, 0, 0, 218106144, 4
    .long 1, 80, 80, 2048, 1835520, 1835776, 7340032, 58224640, 114688, 7, 173023232, 32768, 218103952, 7, 218106496, 1
    .long 0, 0, 0, 0, 0, 0, 0, 0, 0, 0, 0, 0, 0, 0, 0, 0
    .long 0, 0, 0, 0, 0, 0, 0, 0, 0, 0, 0, 0, 0, 0, 0, 0
    .long 0, 0, 0, 0, 0, 0, 0, 0, 0, 0, 0, 0, 0, 0, 0, 0
    .long 0, 0, 0, 0, 0, 0, 0, 0, 0, 0, 0, 0, 0, 0, 0, 0
    .long 1, 32, 32, 8192, 4608, 4864, 8388608, 524288, 32768, 8, 39919616, 131072, 0, 0, 218104640, 4
    .long 1, 16, 16, 8192, 4608, 4864, 8388608, 1048576, 32768, 8, 8462336, 131072, 0, 0, 218104896, 4
    .long 1, 24, 24, 8192, 4608, 4864, 8388608, 2621440, 32768, 8, 31531008, 131072, 0, 0, 218105664, 4
    .long 1, 16, 16, 8192, 4608, 4864, 8388608, 3145728, 32768, 8, 16850944, 131072, 0, 0, 218105920, 4
    .long 1, 16, 16, 8192, 4608, 4864, 8388608, 3670016, 32768, 8, 18948096, 131072, 0, 0, 218106176, 4
    .long 1, 80, 80, 2048, 1836032, 1836288, 7340032, 58224640, 114688, 7, 173031424, 32768, 218103952, 7, 218106496, 1
    .long 0, 0, 0, 0, 0, 0, 0, 0, 0, 0, 0, 0, 0, 0, 0, 0
    .long 0, 0, 0, 0, 0, 0, 0, 0, 0, 0, 0, 0, 0, 0, 0, 0
    .long 0, 0, 0, 0, 0, 0, 0, 0, 0, 0, 0, 0, 0, 0, 0, 0
    .long 0, 0, 0, 0, 0, 0, 0, 0, 0, 0, 0, 0, 0, 0, 0, 0
    .long 1, 32, 32, 8192, 6656, 6912, 8388608, 524288, 32768, 8, 39952384, 131072, 0, 0, 218104672, 4
    .long 1, 16, 16, 8192, 6656, 6912, 8388608, 1048576, 32768, 8, 8495104, 131072, 0, 0, 218104928, 4
    .long 1, 24, 24, 8192, 6656, 6912, 8388608, 2621440, 32768, 8, 31563776, 131072, 0, 0, 218105696, 4
    .long 1, 16, 16, 8192, 6656, 6912, 8388608, 3145728, 32768, 8, 16883712, 131072, 0, 0, 218105952, 4
    .long 1, 16, 16, 8192, 6656, 6912, 8388608, 3670016, 32768, 8, 18980864, 131072, 0, 0, 218106208, 4
    .long 1, 80, 80, 2048, 1836544, 1836800, 7340032, 58224640, 114688, 7, 173039616, 32768, 218103952, 7, 218106496, 1
    .long 0, 0, 0, 0, 0, 0, 0, 0, 0, 0, 0, 0, 0, 0, 0, 0
    .long 0, 0, 0, 0, 0, 0, 0, 0, 0, 0, 0, 0, 0, 0, 0, 0
    .long 0, 0, 0, 0, 0, 0, 0, 0, 0, 0, 0, 0, 0, 0, 0, 0
    .long 0, 0, 0, 0, 0, 0, 0, 0, 0, 0, 0, 0, 0, 0, 0, 0
    .long 1, 32, 32, 8192, 1024, 1280, 8388608, 524288, 32768, 8, 39862272, 131072, 0, 0, 218104592, 4
    .long 1, 16, 16, 8192, 1024, 1280, 8388608, 1048576, 32768, 8, 8404992, 131072, 0, 0, 218104848, 4
    .long 1, 24, 24, 8192, 1024, 1280, 8388608, 2621440, 32768, 8, 31473664, 131072, 0, 0, 218105616, 4
    .long 1, 16, 16, 8192, 1024, 1280, 8388608, 3145728, 32768, 8, 16793600, 131072, 0, 0, 218105872, 4
    .long 1, 16, 16, 8192, 1024, 1280, 8388608, 3670016, 32768, 8, 18890752, 131072, 0, 0, 218106128, 4
    .long 1, 80, 80, 2048, 3670016, 3670272, 7340032, 58253312, 114688, 7, 177209344, 32768, 218103968, 7, 218106496, 1
    .long 0, 0, 0, 0, 0, 0, 0, 0, 0, 0, 0, 0, 0, 0, 0, 0
    .long 0, 0, 0, 0, 0, 0, 0, 0, 0, 0, 0, 0, 0, 0, 0, 0
    .long 0, 0, 0, 0, 0, 0, 0, 0, 0, 0, 0, 0, 0, 0, 0, 0
    .long 0, 0, 0, 0, 0, 0, 0, 0, 0, 0, 0, 0, 0, 0, 0, 0
    .long 1, 32, 32, 8192, 3072, 3328, 8388608, 524288, 32768, 8, 39895040, 131072, 0, 0, 218104624, 4
    .long 1, 16, 16, 8192, 3072, 3328, 8388608, 1048576, 32768, 8, 8437760, 131072, 0, 0, 218104880, 4
    .long 1, 24, 24, 8192, 3072, 3328, 8388608, 2621440, 32768, 8, 31506432, 131072, 0, 0, 218105648, 4
    .long 1, 16, 16, 8192, 3072, 3328, 8388608, 3145728, 32768, 8, 16826368, 131072, 0, 0, 218105904, 4
    .long 1, 16, 16, 8192, 3072, 3328, 8388608, 3670016, 32768, 8, 18923520, 131072, 0, 0, 218106160, 4
    .long 1, 80, 80, 2048, 3670528, 3670784, 7340032, 58253312, 114688, 7, 177217536, 32768, 218103968, 7, 218106496, 1
    .long 0, 0, 0, 0, 0, 0, 0, 0, 0, 0, 0, 0, 0, 0, 0, 0
    .long 0, 0, 0, 0, 0, 0, 0, 0, 0, 0, 0, 0, 0, 0, 0, 0
    .long 0, 0, 0, 0, 0, 0, 0, 0, 0, 0, 0, 0, 0, 0, 0, 0
    .long 0, 0, 0, 0, 0, 0, 0, 0, 0, 0, 0, 0, 0, 0, 0, 0
    .long 1, 32, 32, 8192, 5120, 5376, 8388608, 524288, 32768, 8, 39927808, 131072, 0, 0, 218104656, 4
    .long 1, 16, 16, 8192, 5120, 5376, 8388608, 1048576, 32768, 8, 8470528, 131072, 0, 0, 218104912, 4
    .long 1, 24, 24, 8192, 5120, 5376, 8388608, 2621440, 32768, 8, 31539200, 131072, 0, 0, 218105680, 4
    .long 1, 16, 16, 8192, 5120, 5376, 8388608, 3145728, 32768, 8, 16859136, 131072, 0, 0, 218105936, 4
    .long 1, 16, 16, 8192, 5120, 5376, 8388608, 3670016, 32768, 8, 18956288, 131072, 0, 0, 218106192, 4
    .long 1, 80, 80, 2048, 3671040, 3671296, 7340032, 58253312, 114688, 7, 177225728, 32768, 218103968, 7, 218106496, 1
    .long 0, 0, 0, 0, 0, 0, 0, 0, 0, 0, 0, 0, 0, 0, 0, 0
    .long 0, 0, 0, 0, 0, 0, 0, 0, 0, 0, 0, 0, 0, 0, 0, 0
    .long 0, 0, 0, 0, 0, 0, 0, 0, 0, 0, 0, 0, 0, 0, 0, 0
    .long 0, 0, 0, 0, 0, 0, 0, 0, 0, 0, 0, 0, 0, 0, 0, 0
    .long 1, 32, 32, 8192, 7168, 7424, 8388608, 524288, 32768, 8, 39960576, 131072, 0, 0, 218104688, 4
    .long 1, 16, 16, 8192, 7168, 7424, 8388608, 1048576, 32768, 8, 8503296, 131072, 0, 0, 218104944, 4
    .long 1, 24, 24, 8192, 7168, 7424, 8388608, 2621440, 32768, 8, 31571968, 131072, 0, 0, 218105712, 4
    .long 1, 16, 16, 8192, 7168, 7424, 8388608, 3145728, 32768, 8, 16891904, 131072, 0, 0, 218105968, 4
    .long 1, 16, 16, 8192, 7168, 7424, 8388608, 3670016, 32768, 8, 18989056, 131072, 0, 0, 218106224, 4
    .long 1, 80, 80, 2048, 3671552, 3671808, 7340032, 58253312, 114688, 7, 177233920, 32768, 218103968, 7, 218106496, 1
    .long 0, 0, 0, 0, 0, 0, 0, 0, 0, 0, 0, 0, 0, 0, 0, 0
    .long 0, 0, 0, 0, 0, 0, 0, 0, 0, 0, 0, 0, 0, 0, 0, 0
    .long 0, 0, 0, 0, 0, 0, 0, 0, 0, 0, 0, 0, 0, 0, 0, 0
    .long 0, 0, 0, 0, 0, 0, 0, 0, 0, 0, 0, 0, 0, 0, 0, 0
    .long 1, 32, 32, 8192, 1536, 1792, 8388608, 524288, 32768, 8, 39870464, 131072, 0, 0, 218104592, 4
    .long 1, 16, 16, 8192, 1536, 1792, 8388608, 1048576, 32768, 8, 8413184, 131072, 0, 0, 218104848, 4
    .long 1, 24, 24, 8192, 1536, 1792, 8388608, 2621440, 32768, 8, 31481856, 131072, 0, 0, 218105616, 4
    .long 1, 16, 16, 8192, 1536, 1792, 8388608, 3145728, 32768, 8, 16801792, 131072, 0, 0, 218105872, 4
    .long 1, 16, 16, 8192, 1536, 1792, 8388608, 3670016, 32768, 8, 18898944, 131072, 0, 0, 218106128, 4
    .long 1, 80, 80, 2048, 5505024, 5505280, 7340032, 58281984, 114688, 7, 181403648, 32768, 218103984, 7, 218106496, 1
    .long 0, 0, 0, 0, 0, 0, 0, 0, 0, 0, 0, 0, 0, 0, 0, 0
    .long 0, 0, 0, 0, 0, 0, 0, 0, 0, 0, 0, 0, 0, 0, 0, 0
    .long 0, 0, 0, 0, 0, 0, 0, 0, 0, 0, 0, 0, 0, 0, 0, 0
    .long 0, 0, 0, 0, 0, 0, 0, 0, 0, 0, 0, 0, 0, 0, 0, 0
    .long 1, 32, 32, 8192, 3584, 3840, 8388608, 524288, 32768, 8, 39903232, 131072, 0, 0, 218104624, 4
    .long 1, 16, 16, 8192, 3584, 3840, 8388608, 1048576, 32768, 8, 8445952, 131072, 0, 0, 218104880, 4
    .long 1, 24, 24, 8192, 3584, 3840, 8388608, 2621440, 32768, 8, 31514624, 131072, 0, 0, 218105648, 4
    .long 1, 16, 16, 8192, 3584, 3840, 8388608, 3145728, 32768, 8, 16834560, 131072, 0, 0, 218105904, 4
    .long 1, 16, 16, 8192, 3584, 3840, 8388608, 3670016, 32768, 8, 18931712, 131072, 0, 0, 218106160, 4
    .long 1, 80, 80, 2048, 5505536, 5505792, 7340032, 58281984, 114688, 7, 181411840, 32768, 218103984, 7, 218106496, 1
    .long 0, 0, 0, 0, 0, 0, 0, 0, 0, 0, 0, 0, 0, 0, 0, 0
    .long 0, 0, 0, 0, 0, 0, 0, 0, 0, 0, 0, 0, 0, 0, 0, 0
    .long 0, 0, 0, 0, 0, 0, 0, 0, 0, 0, 0, 0, 0, 0, 0, 0
    .long 0, 0, 0, 0, 0, 0, 0, 0, 0, 0, 0, 0, 0, 0, 0, 0
    .long 1, 32, 32, 8192, 5632, 5888, 8388608, 524288, 32768, 8, 39936000, 131072, 0, 0, 218104656, 4
    .long 1, 16, 16, 8192, 5632, 5888, 8388608, 1048576, 32768, 8, 8478720, 131072, 0, 0, 218104912, 4
    .long 1, 24, 24, 8192, 5632, 5888, 8388608, 2621440, 32768, 8, 31547392, 131072, 0, 0, 218105680, 4
    .long 1, 16, 16, 8192, 5632, 5888, 8388608, 3145728, 32768, 8, 16867328, 131072, 0, 0, 218105936, 4
    .long 1, 16, 16, 8192, 5632, 5888, 8388608, 3670016, 32768, 8, 18964480, 131072, 0, 0, 218106192, 4
    .long 1, 80, 80, 2048, 5506048, 5506304, 7340032, 58281984, 114688, 7, 181420032, 32768, 218103984, 7, 218106496, 1
    .long 0, 0, 0, 0, 0, 0, 0, 0, 0, 0, 0, 0, 0, 0, 0, 0
    .long 0, 0, 0, 0, 0, 0, 0, 0, 0, 0, 0, 0, 0, 0, 0, 0
    .long 0, 0, 0, 0, 0, 0, 0, 0, 0, 0, 0, 0, 0, 0, 0, 0
    .long 0, 0, 0, 0, 0, 0, 0, 0, 0, 0, 0, 0, 0, 0, 0, 0
    .long 1, 32, 32, 8192, 7680, 7936, 8388608, 524288, 32768, 8, 39968768, 131072, 0, 0, 218104688, 4
    .long 1, 16, 16, 8192, 7680, 7936, 8388608, 1048576, 32768, 8, 8511488, 131072, 0, 0, 218104944, 4
    .long 1, 24, 24, 8192, 7680, 7936, 8388608, 2621440, 32768, 8, 31580160, 131072, 0, 0, 218105712, 4
    .long 1, 16, 16, 8192, 7680, 7936, 8388608, 3145728, 32768, 8, 16900096, 131072, 0, 0, 218105968, 4
    .long 1, 16, 16, 8192, 7680, 7936, 8388608, 3670016, 32768, 8, 18997248, 131072, 0, 0, 218106224, 4
    .long 1, 80, 80, 2048, 5506560, 5506816, 7340032, 58281984, 114688, 7, 181428224, 32768, 218103984, 7, 218106496, 1
    .long 0, 0, 0, 0, 0, 0, 0, 0, 0, 0, 0, 0, 0, 0, 0, 0
    .long 0, 0, 0, 0, 0, 0, 0, 0, 0, 0, 0, 0, 0, 0, 0, 0
    .long 0, 0, 0, 0, 0, 0, 0, 0, 0, 0, 0, 0, 0, 0, 0, 0
    .long 0, 0, 0, 0, 0, 0, 0, 0, 0, 0, 0, 0, 0, 0, 0, 0
    .long 1, 24, 24, 8192, 0, 256, 8388608, 524288, 32768, 8, 23068672, 131072, 0, 0, 218104576, 4
    .long 1, 32, 32, 8192, 0, 256, 8388608, 1572864, 32768, 8, 44040192, 131072, 0, 0, 218105088, 4
    .long 1, 16, 16, 8192, 0, 256, 8388608, 2621440, 32768, 8, 14680064, 131072, 0, 0, 218105600, 4
    .long 2, 64, 72, 7168, 2048, 2048, 7340032, 1048576, 32768, 8, 58228736, 114688, 0, 0, 218103952, 1
    .long 2, 64, 72, 7168, 1024, 1024, 7340032, 2621440, 32768, 8, 63717376, 114688, 0, 0, 218104128, 1
    .long 1, 80, 80, 2048, 0, 256, 7340032, 60030976, 114688, 7, 169345024, 32768, 218104000, 7, 218106560, 1
    .long 0, 0, 0, 0, 0, 0, 0, 0, 0, 0, 0, 0, 0, 0, 0, 0
    .long 0, 0, 0, 0, 0, 0, 0, 0, 0, 0, 0, 0, 0, 0, 0, 0
    .long 0, 0, 0, 0, 0, 0, 0, 0, 0, 0, 0, 0, 0, 0, 0, 0
    .long 0, 0, 0, 0, 0, 0, 0, 0, 0, 0, 0, 0, 0, 0, 0, 0
    .long 1, 24, 24, 8192, 2048, 2304, 8388608, 524288, 32768, 8, 23101440, 131072, 0, 0, 218104608, 4
    .long 1, 32, 32, 8192, 2048, 2304, 8388608, 1572864, 32768, 8, 44072960, 131072, 0, 0, 218105120, 4
    .long 1, 16, 16, 8192, 2048, 2304, 8388608, 2621440, 32768, 8, 14712832, 131072, 0, 0, 218105632, 4
    .long 2, 64, 72, 7168, 2304, 2304, 7340032, 1048576, 32768, 8, 58232832, 114688, 0, 0, 218103952, 1
    .long 2, 64, 72, 7168, 1280, 1280, 7340032, 2621440, 32768, 8, 63721472, 114688, 0, 0, 218104128, 1
    .long 1, 80, 80, 2048, 512, 768, 7340032, 60030976, 114688, 7, 169353216, 32768, 218104000, 7, 218106560, 1
    .long 0, 0, 0, 0, 0, 0, 0, 0, 0, 0, 0, 0, 0, 0, 0, 0
    .long 0, 0, 0, 0, 0, 0, 0, 0, 0, 0, 0, 0, 0, 0, 0, 0
    .long 0, 0, 0, 0, 0, 0, 0, 0, 0, 0, 0, 0, 0, 0, 0, 0
    .long 0, 0, 0, 0, 0, 0, 0, 0, 0, 0, 0, 0, 0, 0, 0, 0
    .long 1, 24, 24, 8192, 4096, 4352, 8388608, 524288, 32768, 8, 23134208, 131072, 0, 0, 218104640, 4
    .long 1, 32, 32, 8192, 4096, 4352, 8388608, 1572864, 32768, 8, 44105728, 131072, 0, 0, 218105152, 4
    .long 1, 16, 16, 8192, 4096, 4352, 8388608, 2621440, 32768, 8, 14745600, 131072, 0, 0, 218105664, 4
    .long 2, 64, 72, 7168, 2560, 2560, 7340032, 1048576, 32768, 8, 58236928, 114688, 0, 0, 218103952, 1
    .long 2, 64, 72, 7168, 1536, 1536, 7340032, 2621440, 32768, 8, 63725568, 114688, 0, 0, 218104128, 1
    .long 1, 80, 80, 2048, 1024, 1280, 7340032, 60030976, 114688, 7, 169361408, 32768, 218104000, 7, 218106560, 1
    .long 0, 0, 0, 0, 0, 0, 0, 0, 0, 0, 0, 0, 0, 0, 0, 0
    .long 0, 0, 0, 0, 0, 0, 0, 0, 0, 0, 0, 0, 0, 0, 0, 0
    .long 0, 0, 0, 0, 0, 0, 0, 0, 0, 0, 0, 0, 0, 0, 0, 0
    .long 0, 0, 0, 0, 0, 0, 0, 0, 0, 0, 0, 0, 0, 0, 0, 0
    .long 1, 24, 24, 8192, 6144, 6400, 8388608, 524288, 32768, 8, 23166976, 131072, 0, 0, 218104672, 4
    .long 1, 32, 32, 8192, 6144, 6400, 8388608, 1572864, 32768, 8, 44138496, 131072, 0, 0, 218105184, 4
    .long 1, 16, 16, 8192, 6144, 6400, 8388608, 2621440, 32768, 8, 14778368, 131072, 0, 0, 218105696, 4
    .long 2, 64, 72, 7168, 2816, 2816, 7340032, 1048576, 32768, 8, 58241024, 114688, 0, 0, 218103952, 1
    .long 2, 64, 72, 7168, 1792, 1792, 7340032, 2621440, 32768, 8, 63729664, 114688, 0, 0, 218104144, 1
    .long 1, 80, 80, 2048, 1536, 1792, 7340032, 60030976, 114688, 7, 169369600, 32768, 218104000, 7, 218106560, 1
    .long 0, 0, 0, 0, 0, 0, 0, 0, 0, 0, 0, 0, 0, 0, 0, 0
    .long 0, 0, 0, 0, 0, 0, 0, 0, 0, 0, 0, 0, 0, 0, 0, 0
    .long 0, 0, 0, 0, 0, 0, 0, 0, 0, 0, 0, 0, 0, 0, 0, 0
    .long 0, 0, 0, 0, 0, 0, 0, 0, 0, 0, 0, 0, 0, 0, 0, 0
    .long 1, 24, 24, 8192, 512, 768, 8388608, 524288, 32768, 8, 23076864, 131072, 0, 0, 218104576, 4
    .long 1, 32, 32, 8192, 512, 768, 8388608, 1572864, 32768, 8, 44048384, 131072, 0, 0, 218105088, 4
    .long 1, 16, 16, 8192, 512, 768, 8388608, 2621440, 32768, 8, 14688256, 131072, 0, 0, 218105600, 4
    .long 2, 64, 72, 7168, 3072, 3072, 7340032, 1048576, 32768, 8, 58245120, 114688, 0, 0, 218103952, 1
    .long 2, 64, 72, 7168, 2048, 2048, 7340032, 2621440, 32768, 8, 63733760, 114688, 0, 0, 218104144, 1
    .long 1, 80, 80, 2048, 1835008, 1835264, 7340032, 60059648, 114688, 7, 173539328, 32768, 218104016, 7, 218106560, 1
    .long 0, 0, 0, 0, 0, 0, 0, 0, 0, 0, 0, 0, 0, 0, 0, 0
    .long 0, 0, 0, 0, 0, 0, 0, 0, 0, 0, 0, 0, 0, 0, 0, 0
    .long 0, 0, 0, 0, 0, 0, 0, 0, 0, 0, 0, 0, 0, 0, 0, 0
    .long 0, 0, 0, 0, 0, 0, 0, 0, 0, 0, 0, 0, 0, 0, 0, 0
    .long 1, 24, 24, 8192, 2560, 2816, 8388608, 524288, 32768, 8, 23109632, 131072, 0, 0, 218104608, 4
    .long 1, 32, 32, 8192, 2560, 2816, 8388608, 1572864, 32768, 8, 44081152, 131072, 0, 0, 218105120, 4
    .long 1, 16, 16, 8192, 2560, 2816, 8388608, 2621440, 32768, 8, 14721024, 131072, 0, 0, 218105632, 4
    .long 2, 64, 72, 7168, 3328, 3328, 7340032, 1048576, 32768, 8, 58249216, 114688, 0, 0, 218103952, 1
    .long 2, 64, 72, 7168, 2304, 2304, 7340032, 2621440, 32768, 8, 63737856, 114688, 0, 0, 218104144, 1
    .long 1, 80, 80, 2048, 1835520, 1835776, 7340032, 60059648, 114688, 7, 173547520, 32768, 218104016, 7, 218106560, 1
    .long 0, 0, 0, 0, 0, 0, 0, 0, 0, 0, 0, 0, 0, 0, 0, 0
    .long 0, 0, 0, 0, 0, 0, 0, 0, 0, 0, 0, 0, 0, 0, 0, 0
    .long 0, 0, 0, 0, 0, 0, 0, 0, 0, 0, 0, 0, 0, 0, 0, 0
    .long 0, 0, 0, 0, 0, 0, 0, 0, 0, 0, 0, 0, 0, 0, 0, 0
    .long 1, 24, 24, 8192, 4608, 4864, 8388608, 524288, 32768, 8, 23142400, 131072, 0, 0, 218104640, 4
    .long 1, 32, 32, 8192, 4608, 4864, 8388608, 1572864, 32768, 8, 44113920, 131072, 0, 0, 218105152, 4
    .long 1, 16, 16, 8192, 4608, 4864, 8388608, 2621440, 32768, 8, 14753792, 131072, 0, 0, 218105664, 4
    .long 2, 64, 72, 7168, 3584, 3584, 7340032, 1048576, 32768, 8, 58253312, 114688, 0, 0, 218103968, 1
    .long 2, 64, 72, 7168, 2560, 2560, 7340032, 2621440, 32768, 8, 63741952, 114688, 0, 0, 218104144, 1
    .long 1, 80, 80, 2048, 1836032, 1836288, 7340032, 60059648, 114688, 7, 173555712, 32768, 218104016, 7, 218106560, 1
    .long 0, 0, 0, 0, 0, 0, 0, 0, 0, 0, 0, 0, 0, 0, 0, 0
    .long 0, 0, 0, 0, 0, 0, 0, 0, 0, 0, 0, 0, 0, 0, 0, 0
    .long 0, 0, 0, 0, 0, 0, 0, 0, 0, 0, 0, 0, 0, 0, 0, 0
    .long 0, 0, 0, 0, 0, 0, 0, 0, 0, 0, 0, 0, 0, 0, 0, 0
    .long 1, 24, 24, 8192, 6656, 6912, 8388608, 524288, 32768, 8, 23175168, 131072, 0, 0, 218104672, 4
    .long 1, 32, 32, 8192, 6656, 6912, 8388608, 1572864, 32768, 8, 44146688, 131072, 0, 0, 218105184, 4
    .long 1, 16, 16, 8192, 6656, 6912, 8388608, 2621440, 32768, 8, 14786560, 131072, 0, 0, 218105696, 4
    .long 2, 64, 72, 7168, 3840, 3840, 7340032, 1048576, 32768, 8, 58257408, 114688, 0, 0, 218103968, 1
    .long 2, 64, 72, 7168, 2816, 2816, 7340032, 2621440, 32768, 8, 63746048, 114688, 0, 0, 218104144, 1
    .long 1, 80, 80, 2048, 1836544, 1836800, 7340032, 60059648, 114688, 7, 173563904, 32768, 218104016, 7, 218106560, 1
    .long 0, 0, 0, 0, 0, 0, 0, 0, 0, 0, 0, 0, 0, 0, 0, 0
    .long 0, 0, 0, 0, 0, 0, 0, 0, 0, 0, 0, 0, 0, 0, 0, 0
    .long 0, 0, 0, 0, 0, 0, 0, 0, 0, 0, 0, 0, 0, 0, 0, 0
    .long 0, 0, 0, 0, 0, 0, 0, 0, 0, 0, 0, 0, 0, 0, 0, 0
    .long 1, 24, 24, 8192, 1024, 1280, 8388608, 524288, 32768, 8, 23085056, 131072, 0, 0, 218104592, 4
    .long 1, 24, 24, 8192, 1024, 1280, 8388608, 2097152, 32768, 8, 29376512, 131072, 0, 0, 218105360, 4
    .long 2, 64, 72, 7168, 0, 0, 7340032, 1048576, 32768, 8, 58195968, 114688, 0, 0, 218103936, 1
    .long 2, 64, 72, 7168, 6144, 6144, 7340032, 2097152, 32768, 8, 61964288, 114688, 0, 0, 218104112, 1
    .long 2, 64, 72, 7168, 5120, 5120, 7340032, 3670016, 32768, 8, 67452928, 114688, 0, 0, 218104288, 1
    .long 1, 80, 80, 2048, 3670016, 3670272, 7340032, 67428352, 114688, 7, 179830784, 32768, 218104288, 7, 218106816, 1
    .long 0, 0, 0, 0, 0, 0, 0, 0, 0, 0, 0, 0, 0, 0, 0, 0
    .long 0, 0, 0, 0, 0, 0, 0, 0, 0, 0, 0, 0, 0, 0, 0, 0
    .long 0, 0, 0, 0, 0, 0, 0, 0, 0, 0, 0, 0, 0, 0, 0, 0
    .long 0, 0, 0, 0, 0, 0, 0, 0, 0, 0, 0, 0, 0, 0, 0, 0
    .long 1, 24, 24, 8192, 3072, 3328, 8388608, 524288, 32768, 8, 23117824, 131072, 0, 0, 218104624, 4
    .long 1, 24, 24, 8192, 3072, 3328, 8388608, 2097152, 32768, 8, 29409280, 131072, 0, 0, 218105392, 4
    .long 2, 64, 72, 7168, 256, 256, 7340032, 1048576, 32768, 8, 58200064, 114688, 0, 0, 218103936, 1
    .long 2, 64, 72, 7168, 6400, 6400, 7340032, 2097152, 32768, 8, 61968384, 114688, 0, 0, 218104112, 1
    .long 2, 64, 72, 7168, 5376, 5376, 7340032, 3670016, 32768, 8, 67457024, 114688, 0, 0, 218104304, 1
    .long 1, 80, 80, 2048, 3670528, 3670784, 7340032, 67428352, 114688, 7, 179838976, 32768, 218104288, 7, 218106816, 1
    .long 0, 0, 0, 0, 0, 0, 0, 0, 0, 0, 0, 0, 0, 0, 0, 0
    .long 0, 0, 0, 0, 0, 0, 0, 0, 0, 0, 0, 0, 0, 0, 0, 0
    .long 0, 0, 0, 0, 0, 0, 0, 0, 0, 0, 0, 0, 0, 0, 0, 0
    .long 0, 0, 0, 0, 0, 0, 0, 0, 0, 0, 0, 0, 0, 0, 0, 0
    .long 1, 24, 24, 8192, 5120, 5376, 8388608, 524288, 32768, 8, 23150592, 131072, 0, 0, 218104656, 4
    .long 1, 24, 24, 8192, 5120, 5376, 8388608, 2097152, 32768, 8, 29442048, 131072, 0, 0, 218105424, 4
    .long 2, 64, 72, 7168, 512, 512, 7340032, 1048576, 32768, 8, 58204160, 114688, 0, 0, 218103936, 1
    .long 2, 64, 72, 7168, 6656, 6656, 7340032, 2097152, 32768, 8, 61972480, 114688, 0, 0, 218104112, 1
    .long 2, 64, 72, 7168, 5632, 5632, 7340032, 3670016, 32768, 8, 67461120, 114688, 0, 0, 218104304, 1
    .long 1, 80, 80, 2048, 3671040, 3671296, 7340032, 67428352, 114688, 7, 179847168, 32768, 218104288, 7, 218106816, 1
    .long 0, 0, 0, 0, 0, 0, 0, 0, 0, 0, 0, 0, 0, 0, 0, 0
    .long 0, 0, 0, 0, 0, 0, 0, 0, 0, 0, 0, 0, 0, 0, 0, 0
    .long 0, 0, 0, 0, 0, 0, 0, 0, 0, 0, 0, 0, 0, 0, 0, 0
    .long 0, 0, 0, 0, 0, 0, 0, 0, 0, 0, 0, 0, 0, 0, 0, 0
    .long 1, 24, 24, 8192, 7168, 7424, 8388608, 524288, 32768, 8, 23183360, 131072, 0, 0, 218104688, 4
    .long 1, 24, 24, 8192, 7168, 7424, 8388608, 2097152, 32768, 8, 29474816, 131072, 0, 0, 218105456, 4
    .long 2, 64, 72, 7168, 768, 768, 7340032, 1048576, 32768, 8, 58208256, 114688, 0, 0, 218103936, 1
    .long 2, 64, 72, 7168, 6912, 6912, 7340032, 2097152, 32768, 8, 61976576, 114688, 0, 0, 218104112, 1
    .long 2, 64, 72, 7168, 5888, 5888, 7340032, 3670016, 32768, 8, 67465216, 114688, 0, 0, 218104304, 1
    .long 1, 80, 80, 2048, 3671552, 3671808, 7340032, 67428352, 114688, 7, 179855360, 32768, 218104288, 7, 218106816, 1
    .long 0, 0, 0, 0, 0, 0, 0, 0, 0, 0, 0, 0, 0, 0, 0, 0
    .long 0, 0, 0, 0, 0, 0, 0, 0, 0, 0, 0, 0, 0, 0, 0, 0
    .long 0, 0, 0, 0, 0, 0, 0, 0, 0, 0, 0, 0, 0, 0, 0, 0
    .long 0, 0, 0, 0, 0, 0, 0, 0, 0, 0, 0, 0, 0, 0, 0, 0
    .long 1, 24, 24, 8192, 1536, 1792, 8388608, 524288, 32768, 8, 23093248, 131072, 0, 0, 218104592, 4
    .long 1, 24, 24, 8192, 1536, 1792, 8388608, 2097152, 32768, 8, 29384704, 131072, 0, 0, 218105360, 4
    .long 2, 64, 72, 7168, 1024, 1024, 7340032, 1048576, 32768, 8, 58212352, 114688, 0, 0, 218103936, 1
    .long 2, 64, 72, 7168, 0, 0, 7340032, 2621440, 32768, 8, 63700992, 114688, 0, 0, 218104128, 1
    .long 2, 64, 72, 7168, 6144, 6144, 7340032, 3670016, 32768, 8, 67469312, 114688, 0, 0, 218104304, 1
    .long 1, 80, 80, 2048, 5505024, 5505280, 7340032, 67457024, 114688, 7, 184025088, 32768, 218104304, 7, 218106816, 1
    .long 0, 0, 0, 0, 0, 0, 0, 0, 0, 0, 0, 0, 0, 0, 0, 0
    .long 0, 0, 0, 0, 0, 0, 0, 0, 0, 0, 0, 0, 0, 0, 0, 0
    .long 0, 0, 0, 0, 0, 0, 0, 0, 0, 0, 0, 0, 0, 0, 0, 0
    .long 0, 0, 0, 0, 0, 0, 0, 0, 0, 0, 0, 0, 0, 0, 0, 0
    .long 1, 24, 24, 8192, 3584, 3840, 8388608, 524288, 32768, 8, 23126016, 131072, 0, 0, 218104624, 4
    .long 1, 24, 24, 8192, 3584, 3840, 8388608, 2097152, 32768, 8, 29417472, 131072, 0, 0, 218105392, 4
    .long 2, 64, 72, 7168, 1280, 1280, 7340032, 1048576, 32768, 8, 58216448, 114688, 0, 0, 218103936, 1
    .long 2, 64, 72, 7168, 256, 256, 7340032, 2621440, 32768, 8, 63705088, 114688, 0, 0, 218104128, 1
    .long 2, 64, 72, 7168, 6400, 6400, 7340032, 3670016, 32768, 8, 67473408, 114688, 0, 0, 218104304, 1
    .long 1, 80, 80, 2048, 5505536, 5505792, 7340032, 67457024, 114688, 7, 184033280, 32768, 218104304, 7, 218106816, 1
    .long 0, 0, 0, 0, 0, 0, 0, 0, 0, 0, 0, 0, 0, 0, 0, 0
    .long 0, 0, 0, 0, 0, 0, 0, 0, 0, 0, 0, 0, 0, 0, 0, 0
    .long 0, 0, 0, 0, 0, 0, 0, 0, 0, 0, 0, 0, 0, 0, 0, 0
    .long 0, 0, 0, 0, 0, 0, 0, 0, 0, 0, 0, 0, 0, 0, 0, 0
    .long 1, 24, 24, 8192, 5632, 5888, 8388608, 524288, 32768, 8, 23158784, 131072, 0, 0, 218104656, 4
    .long 1, 24, 24, 8192, 5632, 5888, 8388608, 2097152, 32768, 8, 29450240, 131072, 0, 0, 218105424, 4
    .long 2, 64, 72, 7168, 1536, 1536, 7340032, 1048576, 32768, 8, 58220544, 114688, 0, 0, 218103936, 1
    .long 2, 64, 72, 7168, 512, 512, 7340032, 2621440, 32768, 8, 63709184, 114688, 0, 0, 218104128, 1
    .long 2, 64, 72, 7168, 6656, 6656, 7340032, 3670016, 32768, 8, 67477504, 114688, 0, 0, 218104304, 1
    .long 1, 80, 80, 2048, 5506048, 5506304, 7340032, 67457024, 114688, 7, 184041472, 32768, 218104304, 7, 218106816, 1
    .long 0, 0, 0, 0, 0, 0, 0, 0, 0, 0, 0, 0, 0, 0, 0, 0
    .long 0, 0, 0, 0, 0, 0, 0, 0, 0, 0, 0, 0, 0, 0, 0, 0
    .long 0, 0, 0, 0, 0, 0, 0, 0, 0, 0, 0, 0, 0, 0, 0, 0
    .long 0, 0, 0, 0, 0, 0, 0, 0, 0, 0, 0, 0, 0, 0, 0, 0
    .long 1, 24, 24, 8192, 7680, 7936, 8388608, 524288, 32768, 8, 23191552, 131072, 0, 0, 218104688, 4
    .long 1, 24, 24, 8192, 7680, 7936, 8388608, 2097152, 32768, 8, 29483008, 131072, 0, 0, 218105456, 4
    .long 2, 64, 72, 7168, 1792, 1792, 7340032, 1048576, 32768, 8, 58224640, 114688, 0, 0, 218103952, 1
    .long 2, 64, 72, 7168, 768, 768, 7340032, 2621440, 32768, 8, 63713280, 114688, 0, 0, 218104128, 1
    .long 2, 64, 72, 7168, 6912, 6912, 7340032, 3670016, 32768, 8, 67481600, 114688, 0, 0, 218104304, 1
    .long 1, 80, 80, 2048, 5506560, 5506816, 7340032, 67457024, 114688, 7, 184049664, 32768, 218104304, 7, 218106816, 1
    .long 0, 0, 0, 0, 0, 0, 0, 0, 0, 0, 0, 0, 0, 0, 0, 0
    .long 0, 0, 0, 0, 0, 0, 0, 0, 0, 0, 0, 0, 0, 0, 0, 0
    .long 0, 0, 0, 0, 0, 0, 0, 0, 0, 0, 0, 0, 0, 0, 0, 0
    .long 0, 0, 0, 0, 0, 0, 0, 0, 0, 0, 0, 0, 0, 0, 0, 0
.p2align 6
.amdhsa_kernel recurrent_scan__memory_aug_recurrent_mem_tr__glu_gated_glu__prompt_kernel
  .amdhsa_next_free_vgpr 256
  .amdhsa_next_free_sgpr 102
  .amdhsa_accum_offset 256
  .amdhsa_group_segment_fixed_size 0
  .amdhsa_kernarg_size 112
  .amdhsa_user_sgpr_count 2
  .amdhsa_user_sgpr_kernarg_segment_ptr 1
  .amdhsa_system_sgpr_workgroup_id_x 1
  .amdhsa_float_denorm_mode_32 3
.end_amdhsa_kernel
```

```asm
; @launch grid=(256,1,1) block=(512,1,1) lds=163840
.amdgcn_target "amdgcn-amd-amdhsa--gfx950"
.text
.globl recurrent_scan__memory_aug_recurrent_mem_tr__glu_gated_glu__prompt_kernel
.p2align 8
.type recurrent_scan__memory_aug_recurrent_mem_tr__glu_gated_glu__prompt_kernel,@function
recurrent_scan__memory_aug_recurrent_mem_tr__glu_gated_glu__prompt_kernel:
    s_cmp_ge_u32 s2, 256
    s_cbranch_scc1 k_exit
    s_mov_b32 s99, s2
    s_load_dwordx2 s[4:5], s[0:1], 104
    s_load_dwordx2 s[64:65], s[0:1], 96
    v_lshrrev_b32 v2, 6, v0
    s_mov_b32 s6, 268435456
    s_mov_b32 s7, 131072
    s_mov_b32 s66, 256
    s_mov_b32 s67, 131072
    v_readfirstlane_b32 s3, v2
    s_lshr_b32 s12, s2, 3
    s_and_b32 s13, s2, 3
    s_waitcnt lgkmcnt(0)
    s_bitcmp0_b32 s2, 2
    s_cbranch_scc1 chain_map
    s_lshl_b32 s63, s12, 2
    s_add_u32 s63, s63, s13
    s_mov_b32 s29, s63
    v_and_b32 v20, 63, v0
    v_lshlrev_b32 v1, 4, v20
    v_add_u32 v19, 0x1000, v1
    v_lshrrev_b32 v4, 4, v20
    v_mov_b32 v17, 0
    v_mov_b32 v18, 1
    s_lshr_b32 s26, s3, 2
    s_and_b32 s27, s3, 3
    s_lshl_b32 s21, s3, 11
    s_lshl_b32 s22, s3, 10
    s_add_u32 s22, s22, 16384
    s_mov_b32 s11, 131072
    s_mov_b32 s15, 131072
    s_mov_b32 s28, 0
    v_and_b32 v21, 15, v20
    v_lshlrev_b32 v22, 2, v4
    v_xor_b32 v21, v21, v22
    s_lshr_b32 s30, s3, 1
    s_and_b32 s30, s30, 1
    v_xor_b32 v21, s30, v21
    v_lshlrev_b32 v3, 4, v21
    s_lshl_b32 s30, s26, 13
    v_add_u32 v5, s30, v1
    v_add_u32 v6, 0x10000, v5
    v_bfe_u32 v21, v20, 2, 2
    v_and_b32 v22, 3, v20
    v_and_b32 v23, 1, v4
    v_xor_b32 v24, s27, v21
    v_xor_b32 v25, v22, v23
    v_lshl_add_u32 v24, v24, 2, v25
    v_lshlrev_b32 v24, 4, v24
    v_lshl_add_u32 v25, v4, 3, v21
    v_lshl_add_u32 v24, v25, 8, v24
    v_and_b32 v22, 1, v22
    v_xor_b32 v25, 0, v23
    v_lshl_add_u32 v8, v25, 10, v24
    v_xor_b32 v25, 0, v22
    v_lshl_add_u32 v8, v25, 3, v8
    v_add_u32 v12, 0x10000, v8
    v_xor_b32 v25, 1, v23
    v_lshl_add_u32 v9, v25, 10, v24
    v_xor_b32 v25, 0, v22
    v_lshl_add_u32 v9, v25, 3, v9
    v_add_u32 v13, 0x10000, v9
    v_xor_b32 v25, 0, v23
    v_lshl_add_u32 v10, v25, 10, v24
    v_xor_b32 v25, 1, v22
    v_lshl_add_u32 v10, v25, 3, v10
    v_add_u32 v14, 0x10000, v10
    v_xor_b32 v25, 1, v23
    v_lshl_add_u32 v11, v25, 10, v24
    v_xor_b32 v25, 1, v22
    v_lshl_add_u32 v11, v25, 3, v11
    v_add_u32 v15, 0x10000, v11
    s_lshl_b32 s30, s3, 2
    s_add_u32 s30, s30, 131072
    v_mov_b32 v7, s30
    s_getpc_b64 s[24:25]
    s_add_u32 s24, s24, jobtab@rel32@lo+4
    s_addc_u32 s25, s25, jobtab@rel32@hi+12
    s_mul_i32 s30, s29, 640
    s_add_u32 s24, s24, s30
    s_addc_u32 s25, s25, 0
    s_load_dwordx16 s[32:47], s[24:25], 0
    s_add_u32 s24, s24, 64
    s_addc_u32 s25, s25, 0
    s_waitcnt lgkmcnt(0)
    s_mov_b32 s8, s4
    s_mov_b32 s9, s5
    s_mov_b32 s10, 0
    s_mov_b32 s12, s4
    s_mov_b32 s13, s5
    s_mov_b32 s14, 0
    s_load_dwordx2 s[88:89], s[0:1], 0
    s_mov_b32 s90, 4194304
    s_mov_b32 s91, 131072
    s_mov_b32 s98, 0
    v_mov_b32 v22, 0
    s_mov_b32 s70, 1
    v_and_b32 v245, 15, v0
    v_lshlrev_b32 v246, 11, v245
    v_lshl_add_u32 v246, v4, 4, v246
    s_add_u32 s71, s63, 32
    s_and_b32 s71, s71, 127
    s_lshl_b32 s72, s71, 15
    s_lshl_b32 s73, s3, 8
    s_add_u32 s72, s72, s73
    s_waitcnt lgkmcnt(0)
    buffer_load_dwordx4 v[228:231], v246, s[88:91], s72 offen offset:0
    buffer_load_dwordx4 v[232:235], v246, s[88:91], s72 offen offset:64
    buffer_load_dwordx4 v[236:239], v246, s[88:91], s72 offen offset:128
    buffer_load_dwordx4 v[240:243], v246, s[88:91], s72 offen offset:192
    s_cmp_lg_u32 s32, 6
    s_cbranch_scc1 ln_nx
    s_mov_b32 s98, 1
    s_cmp_lg_u32 s32, 6
    s_cbranch_scc1 xs_1
    s_load_dwordx2 s[8:9], s[0:1], s33
    s_load_dwordx2 s[12:13], s[0:1], s34
    s_mov_b32 s10, s38
    s_mov_b32 s14, s38
    s_cmp_ge_u32 s32, 4
    s_cselect_b32 s31, 0, 1
    s_lshl_b32 s30, s3, s31
    s_mul_i32 s30, s30, s40
    s_add_u32 s16, s39, s30
    s_cmp_eq_u32 s32, 4
    s_cselect_b32 s30, 1024, s40
    s_cselect_b32 s31, 6, 5
    s_lshl_b32 s62, 32, s31
    s_add_u32 s17, s16, s30
    s_lshl_b32 s30, s3, 2
    s_mul_i32 s30, s30, s35
    s_add_u32 s18, s36, s30
    s_add_u32 s19, s37, s30
    s_lshl_b32 s20, s35, s31
    v_mul_u32_u24 v2, s35, v4
    v_add_u32 v2, v2, v3
    s_waitcnt lgkmcnt(0)
    s_lshl_b32 s16, s3, 15
    s_add_u32 s16, s16, s39
    s_add_u32 s92, s16, 2048
    s_lshl_b32 s93, s35, 10
    s_lshr_b32 s94, s63, 2
    s_mul_i32 s94, s94, 1
    s_and_b32 s94, s94, 15
    s_lshl_b32 s95, s94, 7
    s_add_u32 s16, s16, s95
    s_lshl_b32 s95, s35, 6
    s_mul_i32 s95, s95, s94
    s_add_u32 s18, s18, s95
    s_add_u32 s19, s19, s95
    s_add_u32 s17, s16, 16384
    s_mov_b32 s62, 128
    s_lshl_b32 s20, s35, 6
    v_lshrrev_b32 v21, 7, v1
    v_bfe_u32 v23, v1, 4, 3
    v_xor_b32 v23, v21, v23
    v_lshlrev_b32 v23, 4, v23
    v_lshl_add_u32 v23, v21, 11, v23
    s_add_u32 m0, s21, 0
    s_nop 0
    buffer_load_dwordx4 v23, s[88:91], s16 offen lds
    s_add_u32 s16, s16, s62
    s_add_u32 m0, s21, 1024
    s_nop 0
    buffer_load_dwordx4 v23, s[88:91], s17 offen lds
    s_add_u32 s17, s17, s62
    s_add_u32 m0, s22, 0
    s_nop 0
    buffer_load_dwordx4 v2, s[8:11], s18 offen lds
    s_add_u32 s18, s18, s20
    s_add_u32 m0, s22, 8192
    s_nop 0
    buffer_load_dwordx4 v2, s[12:15], s19 offen lds
    s_add_u32 s19, s19, s20
    s_cmp_ge_u32 s16, s92
    s_cselect_b32 s94, 2048, 0
    s_cselect_b32 s95, s93, 0
    s_sub_u32 s16, s16, s94
    s_sub_u32 s17, s17, s94
    s_sub_u32 s18, s18, s95
    s_sub_u32 s19, s19, s95
    s_add_u32 m0, s21, 32768
    s_nop 0
    buffer_load_dwordx4 v23, s[88:91], s16 offen lds
    s_add_u32 s16, s16, s62
    s_add_u32 m0, s21, 33792
    s_nop 0
    buffer_load_dwordx4 v23, s[88:91], s17 offen lds
    s_add_u32 s17, s17, s62
    s_add_u32 m0, s22, 32768
    s_nop 0
    buffer_load_dwordx4 v2, s[8:11], s18 offen lds
    s_add_u32 s18, s18, s20
    s_add_u32 m0, s22, 40960
    s_nop 0
    buffer_load_dwordx4 v2, s[12:15], s19 offen lds
    s_add_u32 s19, s19, s20
    s_cmp_ge_u32 s16, s92
    s_cselect_b32 s94, 2048, 0
    s_cselect_b32 s95, s93, 0
    s_sub_u32 s16, s16, s94
    s_sub_u32 s17, s17, s94
    s_sub_u32 s18, s18, s95
    s_sub_u32 s19, s19, s95
    s_add_u32 m0, s21, 65536
    s_nop 0
    buffer_load_dwordx4 v23, s[88:91], s16 offen lds
    s_add_u32 s16, s16, s62
    s_add_u32 m0, s21, 66560
    s_nop 0
    buffer_load_dwordx4 v23, s[88:91], s17 offen lds
    s_add_u32 s17, s17, s62
    s_add_u32 m0, s22, 65536
    s_nop 0
    buffer_load_dwordx4 v2, s[8:11], s18 offen lds
    s_add_u32 s18, s18, s20
    s_add_u32 m0, s22, 73728
    s_nop 0
    buffer_load_dwordx4 v2, s[12:15], s19 offen lds
    s_add_u32 s19, s19, s20
    s_cmp_ge_u32 s16, s92
    s_cselect_b32 s94, 2048, 0
    s_cselect_b32 s95, s93, 0
    s_sub_u32 s16, s16, s94
    s_sub_u32 s17, s17, s94
    s_sub_u32 s18, s18, s95
    s_sub_u32 s19, s19, s95
    s_add_u32 m0, s21, 98304
    s_nop 0
    buffer_load_dwordx4 v23, s[88:91], s16 offen lds
    s_add_u32 s16, s16, s62
    s_add_u32 m0, s21, 99328
    s_nop 0
    buffer_load_dwordx4 v23, s[88:91], s17 offen lds
    s_add_u32 s17, s17, s62
    s_add_u32 m0, s22, 98304
    s_nop 0
    buffer_load_dwordx4 v2, s[8:11], s18 offen lds
    s_add_u32 s18, s18, s20
    s_add_u32 m0, s22, 106496
    s_nop 0
    buffer_load_dwordx4 v2, s[12:15], s19 offen lds
    s_add_u32 s19, s19, s20
    s_cmp_ge_u32 s16, s92
    s_cselect_b32 s94, 2048, 0
    s_cselect_b32 s95, s93, 0
    s_sub_u32 s16, s16, s94
    s_sub_u32 s17, s17, s94
    s_sub_u32 s18, s18, s95
    s_sub_u32 s19, s19, s95
    v_and_b32 v21, 1, v4
    v_lshlrev_b32 v21, 10, v21
    v_xor_b32 v8, v21, v8
    v_xor_b32 v9, v21, v9
    v_xor_b32 v10, v21, v10
    v_xor_b32 v11, v21, v11
    v_xor_b32 v12, v21, v12
    v_xor_b32 v13, v21, v13
    v_xor_b32 v14, v21, v14
    v_xor_b32 v15, v21, v15
xs_1:
    s_branch w_adopt
ln_nx:
    s_lshl_b32 s73, s71, 9
    s_add_u32 s73, s73, 218103808
    v_lshlrev_b32 v252, 2, v0
    s_cmp_ge_u32 s71, 32
    s_cbranch_scc1 ln_nz
    s_cmp_ge_u32 s3, 2
    s_cbranch_scc1 ln_nz
    buffer_store_dword v17, v252, s[4:7], s73 offen sc1
ln_nz:
    s_waitcnt vmcnt(0)
ln_entry:
    v_lshlrev_b32 v247, 5, v245
    v_add_u32 v247, 135168, v247
    s_lshl_b32 s74, s3, 2
    v_add_u32 v248, s74, v247
    s_lshl_b32 s75, s71, 15
    s_lshl_b32 s76, s3, 12
    s_add_u32 s75, s75, s76
    v_and_b32 v249, 1, v4
    v_cmp_eq_u32 s[80:81], 1, v249
    v_lshlrev_b32 v56, 16, v228
    v_and_b32 v57, 0xffff0000, v228
    v_lshlrev_b32 v58, 16, v229
    v_and_b32 v59, 0xffff0000, v229
    v_lshlrev_b32 v60, 16, v230
    v_and_b32 v61, 0xffff0000, v230
    v_lshlrev_b32 v62, 16, v231
    v_and_b32 v63, 0xffff0000, v231
    v_lshlrev_b32 v64, 16, v232
    v_and_b32 v65, 0xffff0000, v232
    v_lshlrev_b32 v66, 16, v233
    v_and_b32 v67, 0xffff0000, v233
    v_lshlrev_b32 v68, 16, v234
    v_and_b32 v69, 0xffff0000, v234
    v_lshlrev_b32 v70, 16, v235
    v_and_b32 v71, 0xffff0000, v235
    v_lshlrev_b32 v72, 16, v236
    v_and_b32 v73, 0xffff0000, v236
    v_lshlrev_b32 v74, 16, v237
    v_and_b32 v75, 0xffff0000, v237
    v_lshlrev_b32 v76, 16, v238
    v_and_b32 v77, 0xffff0000, v238
    v_lshlrev_b32 v78, 16, v239
    v_and_b32 v79, 0xffff0000, v239
    v_lshlrev_b32 v80, 16, v240
    v_and_b32 v81, 0xffff0000, v240
    v_lshlrev_b32 v82, 16, v241
    v_and_b32 v83, 0xffff0000, v241
    v_lshlrev_b32 v84, 16, v242
    v_and_b32 v85, 0xffff0000, v242
    v_lshlrev_b32 v86, 16, v243
    v_and_b32 v87, 0xffff0000, v243
    v_add_f32 v120, v56, v72
    v_add_f32 v121, v57, v73
    v_add_f32 v122, v58, v74
    v_add_f32 v123, v59, v75
    v_add_f32 v124, v60, v76
    v_add_f32 v125, v61, v77
    v_add_f32 v126, v62, v78
    v_add_f32 v127, v63, v79
    v_add_f32 v128, v64, v80
    v_add_f32 v129, v65, v81
    v_add_f32 v130, v66, v82
    v_add_f32 v131, v67, v83
    v_add_f32 v132, v68, v84
    v_add_f32 v133, v69, v85
    v_add_f32 v134, v70, v86
    v_add_f32 v135, v71, v87
    v_add_f32 v120, v120, v128
    v_add_f32 v121, v121, v129
    v_add_f32 v122, v122, v130
    v_add_f32 v123, v123, v131
    v_add_f32 v124, v124, v132
    v_add_f32 v125, v125, v133
    v_add_f32 v126, v126, v134
    v_add_f32 v127, v127, v135
    v_add_f32 v120, v120, v124
    v_add_f32 v121, v121, v125
    v_add_f32 v122, v122, v126
    v_add_f32 v123, v123, v127
    v_add_f32 v120, v120, v122
    v_add_f32 v121, v121, v123
    v_add_f32 v120, v120, v121
    v_mov_b32 v121, v120
    s_nop 1
    v_permlane16_swap_b32 v121, v120
    v_add_f32 v120, v120, v121
    v_mov_b32 v121, v120
    s_nop 1
    v_permlane32_swap_b32 v121, v120
    v_add_f32 v120, v120, v121
    ds_write_b32 v248, v120 offset:0
    s_waitcnt lgkmcnt(0)
    s_barrier
    ds_read_b128 v[120:123], v247 offset:0
    ds_read_b128 v[124:127], v247 offset:16
    s_waitcnt lgkmcnt(0)
    v_add_f32 v120, v120, v124
    v_add_f32 v121, v121, v125
    v_add_f32 v122, v122, v126
    v_add_f32 v123, v123, v127
    v_add_f32 v120, v120, v122
    v_add_f32 v121, v121, v123
    v_add_f32 v120, v120, v121
    v_mul_f32 v250, 0x3a800000, v120
    v_sub_f32 v152, v56, v250
    v_sub_f32 v153, v57, v250
    v_sub_f32 v154, v58, v250
    v_sub_f32 v155, v59, v250
    v_sub_f32 v156, v60, v250
    v_sub_f32 v157, v61, v250
    v_sub_f32 v158, v62, v250
    v_sub_f32 v159, v63, v250
    v_sub_f32 v160, v64, v250
    v_sub_f32 v161, v65, v250
    v_sub_f32 v162, v66, v250
    v_sub_f32 v163, v67, v250
    v_sub_f32 v164, v68, v250
    v_sub_f32 v165, v69, v250
    v_sub_f32 v166, v70, v250
    v_sub_f32 v167, v71, v250
    v_sub_f32 v168, v72, v250
    v_sub_f32 v169, v73, v250
    v_sub_f32 v170, v74, v250
    v_sub_f32 v171, v75, v250
    v_sub_f32 v172, v76, v250
    v_sub_f32 v173, v77, v250
    v_sub_f32 v174, v78, v250
    v_sub_f32 v175, v79, v250
    v_sub_f32 v176, v80, v250
    v_sub_f32 v177, v81, v250
    v_sub_f32 v178, v82, v250
    v_sub_f32 v179, v83, v250
    v_sub_f32 v180, v84, v250
    v_sub_f32 v181, v85, v250
    v_sub_f32 v182, v86, v250
    v_sub_f32 v183, v87, v250
    v_mul_f32 v120, v152, v152
    v_fmac_f32 v120, v168, v168
    v_mul_f32 v121, v153, v153
    v_fmac_f32 v121, v169, v169
    v_mul_f32 v122, v154, v154
    v_fmac_f32 v122, v170, v170
    v_mul_f32 v123, v155, v155
    v_fmac_f32 v123, v171, v171
    v_mul_f32 v124, v156, v156
    v_fmac_f32 v124, v172, v172
    v_mul_f32 v125, v157, v157
    v_fmac_f32 v125, v173, v173
    v_mul_f32 v126, v158, v158
    v_fmac_f32 v126, v174, v174
    v_mul_f32 v127, v159, v159
    v_fmac_f32 v127, v175, v175
    v_mul_f32 v128, v160, v160
    v_fmac_f32 v128, v176, v176
    v_mul_f32 v129, v161, v161
    v_fmac_f32 v129, v177, v177
    v_mul_f32 v130, v162, v162
    v_fmac_f32 v130, v178, v178
    v_mul_f32 v131, v163, v163
    v_fmac_f32 v131, v179, v179
    v_mul_f32 v132, v164, v164
    v_fmac_f32 v132, v180, v180
    v_mul_f32 v133, v165, v165
    v_fmac_f32 v133, v181, v181
    v_mul_f32 v134, v166, v166
    v_fmac_f32 v134, v182, v182
    v_mul_f32 v135, v167, v167
    v_fmac_f32 v135, v183, v183
    v_add_f32 v120, v120, v128
    v_add_f32 v121, v121, v129
    v_add_f32 v122, v122, v130
    v_add_f32 v123, v123, v131
    v_add_f32 v124, v124, v132
    v_add_f32 v125, v125, v133
    v_add_f32 v126, v126, v134
    v_add_f32 v127, v127, v135
    v_add_f32 v120, v120, v124
    v_add_f32 v121, v121, v125
    v_add_f32 v122, v122, v126
    v_add_f32 v123, v123, v127
    v_add_f32 v120, v120, v122
    v_add_f32 v121, v121, v123
    v_add_f32 v120, v120, v121
    v_mov_b32 v121, v120
    s_nop 1
    v_permlane16_swap_b32 v121, v120
    v_add_f32 v120, v120, v121
    v_mov_b32 v121, v120
    s_nop 1
    v_permlane32_swap_b32 v121, v120
    v_add_f32 v120, v120, v121
    ds_write_b32 v248, v120 offset:512
    s_waitcnt lgkmcnt(0)
    s_barrier
    ds_read_b128 v[120:123], v247 offset:512
    ds_read_b128 v[124:127], v247 offset:528
    s_waitcnt lgkmcnt(0)
    v_add_f32 v120, v120, v124
    v_add_f32 v121, v121, v125
    v_add_f32 v122, v122, v126
    v_add_f32 v123, v123, v127
    v_add_f32 v120, v120, v122
    v_add_f32 v121, v121, v123
    v_add_f32 v120, v120, v121
    v_mul_f32 v251, 0x3a800000, v120
    v_cvt_pk_bf16_f32 v250, v250, v250
    v_lshlrev_b32 v250, 16, v250
    v_cvt_pk_bf16_f32 v251, v251, v251
    v_lshlrev_b32 v251, 16, v251
    v_add_f32 v251, 0x3727c5ac, v251
    v_cvt_pk_bf16_f32 v251, v251, v251
    v_lshlrev_b32 v251, 16, v251
    v_sqrt_f32 v251, v251
    s_nop 0
    v_cvt_pk_bf16_f32 v251, v251, v251
    v_lshlrev_b32 v251, 16, v251
    v_rcp_f32 v251, v251
    s_nop 0
    s_cmp_lg_u32 s3, 0
    s_cbranch_scc1 ln_nst
    s_lshl_b32 s77, s71, 7
    s_add_u32 s77, s77, 188743680
    v_lshlrev_b32 v249, 3, v245
    s_mov_b64 exec, 0xffff
    buffer_store_dwordx2 v[250:251], v249, s[4:7], s77 offen sc1
    s_mov_b64 exec, -1
ln_nst:
    v_sub_f32 v56, v56, v250
    v_sub_f32 v57, v57, v250
    v_cvt_pk_bf16_f32 v228, v56, v57
    v_lshlrev_b32 v56, 16, v228
    v_and_b32 v57, 0xffff0000, v228
    v_mul_f32 v56, v56, v251
    v_mul_f32 v57, v57, v251
    v_cvt_pk_bf16_f32 v228, v56, v57
    v_sub_f32 v58, v58, v250
    v_sub_f32 v59, v59, v250
    v_cvt_pk_bf16_f32 v229, v58, v59
    v_lshlrev_b32 v58, 16, v229
    v_and_b32 v59, 0xffff0000, v229
    v_mul_f32 v58, v58, v251
    v_mul_f32 v59, v59, v251
    v_cvt_pk_bf16_f32 v229, v58, v59
    v_sub_f32 v60, v60, v250
    v_sub_f32 v61, v61, v250
    v_cvt_pk_bf16_f32 v230, v60, v61
    v_lshlrev_b32 v60, 16, v230
    v_and_b32 v61, 0xffff0000, v230
    v_mul_f32 v60, v60, v251
    v_mul_f32 v61, v61, v251
    v_cvt_pk_bf16_f32 v230, v60, v61
    v_sub_f32 v62, v62, v250
    v_sub_f32 v63, v63, v250
    v_cvt_pk_bf16_f32 v231, v62, v63
    v_lshlrev_b32 v62, 16, v231
    v_and_b32 v63, 0xffff0000, v231
    v_mul_f32 v62, v62, v251
    v_mul_f32 v63, v63, v251
    v_cvt_pk_bf16_f32 v231, v62, v63
    v_cndmask_b32 v120, v228, v230, s[80:81]
    v_cndmask_b32 v121, v229, v231, s[80:81]
    v_cndmask_b32 v122, v230, v228, s[80:81]
    v_cndmask_b32 v123, v231, v229, s[80:81]
    buffer_store_dwordx4 v[120:123], v1, s[4:7], s75 offen offset:0 sc1
    v_sub_f32 v64, v64, v250
    v_sub_f32 v65, v65, v250
    v_cvt_pk_bf16_f32 v232, v64, v65
    v_lshlrev_b32 v64, 16, v232
    v_and_b32 v65, 0xffff0000, v232
    v_mul_f32 v64, v64, v251
    v_mul_f32 v65, v65, v251
    v_cvt_pk_bf16_f32 v232, v64, v65
    v_sub_f32 v66, v66, v250
    v_sub_f32 v67, v67, v250
    v_cvt_pk_bf16_f32 v233, v66, v67
    v_lshlrev_b32 v66, 16, v233
    v_and_b32 v67, 0xffff0000, v233
    v_mul_f32 v66, v66, v251
    v_mul_f32 v67, v67, v251
    v_cvt_pk_bf16_f32 v233, v66, v67
    v_sub_f32 v68, v68, v250
    v_sub_f32 v69, v69, v250
    v_cvt_pk_bf16_f32 v234, v68, v69
    v_lshlrev_b32 v68, 16, v234
    v_and_b32 v69, 0xffff0000, v234
    v_mul_f32 v68, v68, v251
    v_mul_f32 v69, v69, v251
    v_cvt_pk_bf16_f32 v234, v68, v69
    v_sub_f32 v70, v70, v250
    v_sub_f32 v71, v71, v250
    v_cvt_pk_bf16_f32 v235, v70, v71
    v_lshlrev_b32 v70, 16, v235
    v_and_b32 v71, 0xffff0000, v235
    v_mul_f32 v70, v70, v251
    v_mul_f32 v71, v71, v251
    v_cvt_pk_bf16_f32 v235, v70, v71
    v_cndmask_b32 v124, v232, v234, s[80:81]
    v_cndmask_b32 v125, v233, v235, s[80:81]
    v_cndmask_b32 v126, v234, v232, s[80:81]
    v_cndmask_b32 v127, v235, v233, s[80:81]
    buffer_store_dwordx4 v[124:127], v1, s[4:7], s75 offen offset:1024 sc1
    v_sub_f32 v72, v72, v250
    v_sub_f32 v73, v73, v250
    v_cvt_pk_bf16_f32 v236, v72, v73
    v_lshlrev_b32 v72, 16, v236
    v_and_b32 v73, 0xffff0000, v236
    v_mul_f32 v72, v72, v251
    v_mul_f32 v73, v73, v251
    v_cvt_pk_bf16_f32 v236, v72, v73
    v_sub_f32 v74, v74, v250
    v_sub_f32 v75, v75, v250
    v_cvt_pk_bf16_f32 v237, v74, v75
    v_lshlrev_b32 v74, 16, v237
    v_and_b32 v75, 0xffff0000, v237
    v_mul_f32 v74, v74, v251
    v_mul_f32 v75, v75, v251
    v_cvt_pk_bf16_f32 v237, v74, v75
    v_sub_f32 v76, v76, v250
    v_sub_f32 v77, v77, v250
    v_cvt_pk_bf16_f32 v238, v76, v77
    v_lshlrev_b32 v76, 16, v238
    v_and_b32 v77, 0xffff0000, v238
    v_mul_f32 v76, v76, v251
    v_mul_f32 v77, v77, v251
    v_cvt_pk_bf16_f32 v238, v76, v77
    v_sub_f32 v78, v78, v250
    v_sub_f32 v79, v79, v250
    v_cvt_pk_bf16_f32 v239, v78, v79
    v_lshlrev_b32 v78, 16, v239
    v_and_b32 v79, 0xffff0000, v239
    v_mul_f32 v78, v78, v251
    v_mul_f32 v79, v79, v251
    v_cvt_pk_bf16_f32 v239, v78, v79
    v_cndmask_b32 v128, v236, v238, s[80:81]
    v_cndmask_b32 v129, v237, v239, s[80:81]
    v_cndmask_b32 v130, v238, v236, s[80:81]
    v_cndmask_b32 v131, v239, v237, s[80:81]
    buffer_store_dwordx4 v[128:131], v1, s[4:7], s75 offen offset:2048 sc1
    v_sub_f32 v80, v80, v250
    v_sub_f32 v81, v81, v250
    v_cvt_pk_bf16_f32 v240, v80, v81
    v_lshlrev_b32 v80, 16, v240
    v_and_b32 v81, 0xffff0000, v240
    v_mul_f32 v80, v80, v251
    v_mul_f32 v81, v81, v251
    v_cvt_pk_bf16_f32 v240, v80, v81
    v_sub_f32 v82, v82, v250
    v_sub_f32 v83, v83, v250
    v_cvt_pk_bf16_f32 v241, v82, v83
    v_lshlrev_b32 v82, 16, v241
    v_and_b32 v83, 0xffff0000, v241
    v_mul_f32 v82, v82, v251
    v_mul_f32 v83, v83, v251
    v_cvt_pk_bf16_f32 v241, v82, v83
    v_sub_f32 v84, v84, v250
    v_sub_f32 v85, v85, v250
    v_cvt_pk_bf16_f32 v242, v84, v85
    v_lshlrev_b32 v84, 16, v242
    v_and_b32 v85, 0xffff0000, v242
    v_mul_f32 v84, v84, v251
    v_mul_f32 v85, v85, v251
    v_cvt_pk_bf16_f32 v242, v84, v85
    v_sub_f32 v86, v86, v250
    v_sub_f32 v87, v87, v250
    v_cvt_pk_bf16_f32 v243, v86, v87
    v_lshlrev_b32 v86, 16, v243
    v_and_b32 v87, 0xffff0000, v243
    v_mul_f32 v86, v86, v251
    v_mul_f32 v87, v87, v251
    v_cvt_pk_bf16_f32 v243, v86, v87
    v_cndmask_b32 v132, v240, v242, s[80:81]
    v_cndmask_b32 v133, v241, v243, s[80:81]
    v_cndmask_b32 v134, v242, v240, s[80:81]
    v_cndmask_b32 v135, v243, v241, s[80:81]
    buffer_store_dwordx4 v[132:135], v1, s[4:7], s75 offen offset:3072 sc1
    s_cmp_eq_u32 s98, 1
    s_cselect_b32 s98, 2, 0
    s_cbranch_scc1 w_cold
    s_waitcnt vmcnt(0)
    s_barrier
    s_cmp_lg_u32 s3, 0
    s_cbranch_scc1 ln_sig
    s_mov_b64 exec, 1
    s_cmp_ge_u32 s71, 32
    s_cbranch_scc1 ln_sb
    buffer_atomic_add v18, off, s[64:67], 0 offset:192 sc1
ln_sb:
    buffer_atomic_add v18, off, s[64:67], 0 offset:0 sc1
    s_mov_b64 exec, -1
ln_sig:
    s_cmp_lt_u32 s63, 120
    s_cbranch_scc1 prb_done
    s_cmp_lg_u32 s3, 0
    s_cbranch_scc1 prb_bar
    s_sub_u32 s82, s63, 120
    s_lshl_b32 s83, s82, 7
    s_add_u32 s83, s83, 218112000
    s_lshl_b32 s84, s82, 10
    s_add_u32 s84, s84, 209715200
    s_mov_b32 s80, -1
    s_mov_b32 s81, -1
    s_mov_b64 exec, 1
    s_memtime s[74:75]
    s_add_u32 s87, s84, 0
    s_waitcnt lgkmcnt(0)
    buffer_load_dword v20, off, s[4:7], s87 sc1
    s_waitcnt vmcnt(0)
    s_memtime s[76:77]
    s_waitcnt lgkmcnt(0)
    s_sub_u32 s87, s76, s74
    s_min_u32 s80, s80, s87
    s_memtime s[74:75]
    s_add_u32 s87, s84, 8192
    s_waitcnt lgkmcnt(0)
    buffer_load_dword v20, off, s[4:7], s87 sc1
    s_waitcnt vmcnt(0)
    s_memtime s[76:77]
    s_waitcnt lgkmcnt(0)
    s_sub_u32 s87, s76, s74
    s_min_u32 s81, s81, s87
    s_memtime s[74:75]
    s_add_u32 s87, s84, 16384
    s_waitcnt lgkmcnt(0)
    buffer_load_dword v20, off, s[4:7], s87 sc1
    s_waitcnt vmcnt(0)
    s_memtime s[76:77]
    s_waitcnt lgkmcnt(0)
    s_sub_u32 s87, s76, s74
    s_min_u32 s80, s80, s87
    s_memtime s[74:75]
    s_add_u32 s87, s84, 24576
    s_waitcnt lgkmcnt(0)
    buffer_load_dword v20, off, s[4:7], s87 sc1
    s_waitcnt vmcnt(0)
    s_memtime s[76:77]
    s_waitcnt lgkmcnt(0)
    s_sub_u32 s87, s76, s74
    s_min_u32 s81, s81, s87
    s_memtime s[74:75]
    s_add_u32 s87, s84, 32768
    s_waitcnt lgkmcnt(0)
    buffer_load_dword v20, off, s[4:7], s87 sc1
    s_waitcnt vmcnt(0)
    s_memtime s[76:77]
    s_waitcnt lgkmcnt(0)
    s_sub_u32 s87, s76, s74
    s_min_u32 s80, s80, s87
    s_memtime s[74:75]
    s_add_u32 s87, s84, 40960
    s_waitcnt lgkmcnt(0)
    buffer_load_dword v20, off, s[4:7], s87 sc1
    s_waitcnt vmcnt(0)
    s_memtime s[76:77]
    s_waitcnt lgkmcnt(0)
    s_sub_u32 s87, s76, s74
    s_min_u32 s81, s81, s87
    s_memtime s[74:75]
    s_add_u32 s87, s84, 49152
    s_waitcnt lgkmcnt(0)
    buffer_load_dword v20, off, s[4:7], s87 sc1
    s_waitcnt vmcnt(0)
    s_memtime s[76:77]
    s_waitcnt lgkmcnt(0)
    s_sub_u32 s87, s76, s74
    s_min_u32 s80, s80, s87
    s_memtime s[74:75]
    s_add_u32 s87, s84, 57344
    s_waitcnt lgkmcnt(0)
    buffer_load_dword v20, off, s[4:7], s87 sc1
    s_waitcnt vmcnt(0)
    s_memtime s[76:77]
    s_waitcnt lgkmcnt(0)
    s_sub_u32 s87, s76, s74
    s_min_u32 s81, s81, s87
    s_memtime s[74:75]
    s_add_u32 s87, s84, 65536
    s_waitcnt lgkmcnt(0)
    buffer_load_dword v20, off, s[4:7], s87 sc1
    s_waitcnt vmcnt(0)
    s_memtime s[76:77]
    s_waitcnt lgkmcnt(0)
    s_sub_u32 s87, s76, s74
    s_min_u32 s80, s80, s87
    s_memtime s[74:75]
    s_add_u32 s87, s84, 73728
    s_waitcnt lgkmcnt(0)
    buffer_load_dword v20, off, s[4:7], s87 sc1
    s_waitcnt vmcnt(0)
    s_memtime s[76:77]
    s_waitcnt lgkmcnt(0)
    s_sub_u32 s87, s76, s74
    s_min_u32 s81, s81, s87
    s_memtime s[74:75]
    s_add_u32 s87, s84, 81920
    s_waitcnt lgkmcnt(0)
    buffer_load_dword v20, off, s[4:7], s87 sc1
    s_waitcnt vmcnt(0)
    s_memtime s[76:77]
    s_waitcnt lgkmcnt(0)
    s_sub_u32 s87, s76, s74
    s_min_u32 s80, s80, s87
    s_memtime s[74:75]
    s_add_u32 s87, s84, 90112
    s_waitcnt lgkmcnt(0)
    buffer_load_dword v20, off, s[4:7], s87 sc1
    s_waitcnt vmcnt(0)
    s_memtime s[76:77]
    s_waitcnt lgkmcnt(0)
    s_sub_u32 s87, s76, s74
    s_min_u32 s81, s81, s87
    s_sub_i32 s85, s80, s81
    s_min_i32 s85, s85, 400
    s_max_i32 s85, s85, -400
    s_lshl_b32 s85, s85, 8
    s_getreg_b32 s86, hwreg(HW_REG_XCC_ID)
    s_bfe_u32 s86, s86, 0x10002
    s_lshl_b32 s86, s86, 1
    s_or_b32 s85, s85, s86
    s_or_b32 s85, s85, 1
    s_mov_b32 s86, 65536
prb_i:
    buffer_load_dword v20, off, s[64:67], 0 offset:192 sc1
    s_waitcnt vmcnt(0)
    v_readfirstlane_b32 s84, v20
    s_cmp_ge_u32 s84, 32
    s_cbranch_scc1 prb_i_ok
    s_sleep 8
    s_sub_u32 s86, s86, 1
    s_cbranch_scc0 prb_i
prb_i_ok:
    v_mov_b32 v20, s85
    buffer_store_dword v20, off, s[4:7], s83 offset:8 sc1
    s_mov_b64 exec, -1
prb_bar:
    s_barrier
prb_done:
    s_cmp_lt_u32 s32, 4
    s_cbranch_scc1 w_nopre
    s_load_dwordx2 s[8:9], s[0:1], s33
    s_load_dwordx2 s[12:13], s[0:1], s34
    s_mov_b32 s10, s38
    s_mov_b32 s14, s38
    s_cmp_ge_u32 s32, 4
    s_cselect_b32 s31, 0, 1
    s_lshl_b32 s30, s3, s31
    s_mul_i32 s30, s30, s40
    s_add_u32 s16, s39, s30
    s_cmp_eq_u32 s32, 4
    s_cselect_b32 s30, 1024, s40
    s_cselect_b32 s31, 6, 5
    s_lshl_b32 s62, 32, s31
    s_add_u32 s17, s16, s30
    s_lshl_b32 s30, s3, 2
    s_mul_i32 s30, s30, s35
    s_add_u32 s18, s36, s30
    s_add_u32 s19, s37, s30
    s_lshl_b32 s20, s35, s31
    v_mul_u32_u24 v2, s35, v4
    v_add_u32 v2, v2, v3
    s_waitcnt lgkmcnt(0)
    s_add_u32 m0, s22, 0
    s_nop 0
    buffer_load_dwordx4 v2, s[8:11], s18 offen lds
    s_add_u32 s18, s18, s20
    s_add_u32 m0, s22, 8192
    s_nop 0
    buffer_load_dwordx4 v2, s[12:15], s19 offen lds
    s_add_u32 s19, s19, s20
    s_add_u32 m0, s22, 32768
    s_nop 0
    buffer_load_dwordx4 v2, s[8:11], s18 offen lds
    s_add_u32 s18, s18, s20
    s_add_u32 m0, s22, 40960
    s_nop 0
    buffer_load_dwordx4 v2, s[12:15], s19 offen lds
    s_add_u32 s19, s19, s20
    s_add_u32 m0, s22, 65536
    s_nop 0
    buffer_load_dwordx4 v2, s[8:11], s18 offen lds
    s_add_u32 s18, s18, s20
    s_add_u32 m0, s22, 73728
    s_nop 0
    buffer_load_dwordx4 v2, s[12:15], s19 offen lds
    s_add_u32 s19, s19, s20
    s_add_u32 m0, s22, 98304
    s_nop 0
    buffer_load_dwordx4 v2, s[8:11], s18 offen lds
    s_add_u32 s18, s18, s20
    s_add_u32 m0, s22, 106496
    s_nop 0
    buffer_load_dwordx4 v2, s[12:15], s19 offen lds
    s_add_u32 s19, s19, s20
    s_mov_b32 s70, 1
    s_cmp_lt_u32 s39, 1048576
    s_cselect_b32 s70, s70, 0
    s_cmp_lg_u32 s3, 0
    s_cbranch_scc1 lnwp_ok
    s_cmp_eq_u32 s70, 0
    s_cbranch_scc1 lnwp_full
    s_mov_b32 s69, 65536
lnwap:
    buffer_load_dword v20, off, s[64:67], 0 offset:192 sc1
    s_waitcnt vmcnt(0)
    v_readfirstlane_b32 s68, v20
    s_cmp_ge_u32 s68, 32
    s_cbranch_scc1 lnwap_ok
    s_sleep 8
    s_sub_u32 s69, s69, 1
    s_cbranch_scc0 lnwap
lnwap_ok:
    s_branch lnwp_ok
lnwp_full:
    s_mov_b32 s69, 65536
lnwp:
    buffer_load_dword v20, off, s[64:67], 0 offset:0 sc1
    s_waitcnt vmcnt(0)
    v_readfirstlane_b32 s68, v20
    s_cmp_ge_u32 s68, 128
    s_cbranch_scc1 lnwp_ok
    s_sleep 8
    s_sub_u32 s69, s69, 1
    s_cbranch_scc0 lnwp
lnwp_ok:
    s_barrier
    s_add_u32 m0, s21, 0
    s_nop 0
    buffer_load_dwordx4 v1, s[4:7], s16 offen sc1 lds
    s_add_u32 s16, s16, s62
    s_add_u32 m0, s21, 1024
    s_nop 0
    buffer_load_dwordx4 v1, s[4:7], s17 offen sc1 lds
    s_add_u32 s17, s17, s62
    s_add_u32 m0, s21, 32768
    s_nop 0
    buffer_load_dwordx4 v1, s[4:7], s16 offen sc1 lds
    s_add_u32 s16, s16, s62
    s_add_u32 m0, s21, 33792
    s_nop 0
    buffer_load_dwordx4 v1, s[4:7], s17 offen sc1 lds
    s_add_u32 s17, s17, s62
    s_add_u32 m0, s21, 65536
    s_nop 0
    buffer_load_dwordx4 v1, s[4:7], s16 offen sc1 lds
    s_add_u32 s16, s16, s62
    s_add_u32 m0, s21, 66560
    s_nop 0
    buffer_load_dwordx4 v1, s[4:7], s17 offen sc1 lds
    s_add_u32 s17, s17, s62
    s_add_u32 m0, s21, 98304
    s_nop 0
    buffer_load_dwordx4 v1, s[4:7], s16 offen sc1 lds
    s_add_u32 s16, s16, s62
    s_add_u32 m0, s21, 99328
    s_nop 0
    buffer_load_dwordx4 v1, s[4:7], s17 offen sc1 lds
    s_add_u32 s17, s17, s62
    s_branch w_adopt
w_nopre:
    s_mov_b32 s70, 1
    s_cmp_lt_u32 s39, 1048576
    s_cselect_b32 s70, s70, 0
    s_cmp_lg_u32 s3, 0
    s_cbranch_scc1 lnw_ok
    s_cmp_eq_u32 s70, 0
    s_cbranch_scc1 lnw_full
    s_mov_b32 s69, 65536
lnwa:
    buffer_load_dword v20, off, s[64:67], 0 offset:192 sc1
    s_waitcnt vmcnt(0)
    v_readfirstlane_b32 s68, v20
    s_cmp_ge_u32 s68, 32
    s_cbranch_scc1 lnwa_ok
    s_sleep 8
    s_sub_u32 s69, s69, 1
    s_cbranch_scc0 lnwa
lnwa_ok:
    s_branch lnw_ok
lnw_full:
    s_mov_b32 s69, 65536
lnw:
    buffer_load_dword v20, off, s[64:67], 0 offset:0 sc1
    s_waitcnt vmcnt(0)
    v_readfirstlane_b32 s68, v20
    s_cmp_ge_u32 s68, 128
    s_cbranch_scc1 lnw_ok
    s_sleep 8
    s_sub_u32 s69, s69, 1
    s_cbranch_scc0 lnw
lnw_ok:
    s_barrier
w_cold:
    s_cmp_eq_u32 s32, 0
    s_cbranch_scc1 fin_entry
    s_cmp_lg_u32 s3, 0
    s_cbranch_scc1 w_depok
    s_cmp_eq_u32 s45, 0
    s_cbranch_scc1 w_depok
    s_mov_b32 s31, 0x40000
w_waitdep:
    buffer_load_dword v16, v17, s[4:7], s44 offen sc1
    s_waitcnt vmcnt(0)
    v_readfirstlane_b32 s30, v16
    s_cmp_ge_u32 s30, s45
    s_cbranch_scc1 w_depok
    s_sleep 16
    s_sub_u32 s31, s31, 1
    s_cbranch_scc0 w_waitdep
w_depok:
    s_load_dwordx2 s[8:9], s[0:1], s33
    s_load_dwordx2 s[12:13], s[0:1], s34
    s_mov_b32 s10, s38
    s_mov_b32 s14, s38
    s_cmp_ge_u32 s32, 4
    s_cselect_b32 s31, 0, 1
    s_lshl_b32 s30, s3, s31
    s_mul_i32 s30, s30, s40
    s_add_u32 s16, s39, s30
    s_cmp_eq_u32 s32, 4
    s_cselect_b32 s30, 1024, s40
    s_cselect_b32 s31, 6, 5
    s_lshl_b32 s62, 32, s31
    s_add_u32 s17, s16, s30
    s_lshl_b32 s30, s3, 2
    s_mul_i32 s30, s30, s35
    s_add_u32 s18, s36, s30
    s_add_u32 s19, s37, s30
    s_lshl_b32 s20, s35, s31
    v_mul_u32_u24 v2, s35, v4
    v_add_u32 v2, v2, v3
    s_waitcnt lgkmcnt(0)
    s_barrier
    s_add_u32 m0, s21, 0
    s_nop 0
    buffer_load_dwordx4 v1, s[4:7], s16 offen sc1 lds
    s_add_u32 s16, s16, s62
    s_add_u32 m0, s21, 1024
    s_nop 0
    buffer_load_dwordx4 v1, s[4:7], s17 offen sc1 lds
    s_add_u32 s17, s17, s62
    s_add_u32 m0, s22, 0
    s_nop 0
    buffer_load_dwordx4 v2, s[8:11], s18 offen lds
    s_add_u32 s18, s18, s20
    s_add_u32 m0, s22, 8192
    s_nop 0
    buffer_load_dwordx4 v2, s[12:15], s19 offen lds
    s_add_u32 s19, s19, s20
    s_add_u32 m0, s21, 32768
    s_nop 0
    buffer_load_dwordx4 v1, s[4:7], s16 offen sc1 lds
    s_add_u32 s16, s16, s62
    s_add_u32 m0, s21, 33792
    s_nop 0
    buffer_load_dwordx4 v1, s[4:7], s17 offen sc1 lds
    s_add_u32 s17, s17, s62
    s_add_u32 m0, s22, 32768
    s_nop 0
    buffer_load_dwordx4 v2, s[8:11], s18 offen lds
    s_add_u32 s18, s18, s20
    s_add_u32 m0, s22, 40960
    s_nop 0
    buffer_load_dwordx4 v2, s[12:15], s19 offen lds
    s_add_u32 s19, s19, s20
    s_add_u32 m0, s21, 65536
    s_nop 0
    buffer_load_dwordx4 v1, s[4:7], s16 offen sc1 lds
    s_add_u32 s16, s16, s62
    s_add_u32 m0, s21, 66560
    s_nop 0
    buffer_load_dwordx4 v1, s[4:7], s17 offen sc1 lds
    s_add_u32 s17, s17, s62
    s_add_u32 m0, s22, 65536
    s_nop 0
    buffer_load_dwordx4 v2, s[8:11], s18 offen lds
    s_add_u32 s18, s18, s20
    s_add_u32 m0, s22, 73728
    s_nop 0
    buffer_load_dwordx4 v2, s[12:15], s19 offen lds
    s_add_u32 s19, s19, s20
    s_add_u32 m0, s21, 98304
    s_nop 0
    buffer_load_dwordx4 v1, s[4:7], s16 offen sc1 lds
    s_add_u32 s16, s16, s62
    s_add_u32 m0, s21, 99328
    s_nop 0
    buffer_load_dwordx4 v1, s[4:7], s17 offen sc1 lds
    s_add_u32 s17, s17, s62
    s_add_u32 m0, s22, 98304
    s_nop 0
    buffer_load_dwordx4 v2, s[8:11], s18 offen lds
    s_add_u32 s18, s18, s20
    s_add_u32 m0, s22, 106496
    s_nop 0
    buffer_load_dwordx4 v2, s[12:15], s19 offen lds
    s_add_u32 s19, s19, s20
w_adopt:
    s_mov_b32 s48, s32
    s_cmp_ge_u32 s32, 4
    s_cselect_b32 s30, 2, 3
    s_lshl_b32 s30, s26, s30
    s_mul_i32 s30, s30, s43
    s_add_u32 s49, s42, s30
    s_mov_b32 s50, s43
    s_mov_b32 s51, s46
    s_mov_b32 s23, s41
    s_mov_b32 s53, s47
    s_nop 0
    s_load_dwordx16 s[32:47], s[24:25], 0
    s_add_u32 s24, s24, 64
    s_addc_u32 s25, s25, 0
    s_waitcnt vmcnt(0)
    s_cmp_eq_u32 s48, 6
    s_barrier
    s_cbranch_scc1 w_firstX
    s_cmp_lg_u32 s98, 2
    s_cbranch_scc1 lls_done
    s_mov_b32 s98, 0
    s_cmp_lg_u32 s3, 0
    s_cbranch_scc1 lls_done
    v_mov_b32 v20, 1
    s_mov_b64 exec, 1
    buffer_atomic_add v20, off, s[64:67], 0 offset:0 sc1
    s_mov_b64 exec, -1
lls_done:
    ds_read_b64_tr_b16 v[64:65], v8 offset:16384
    ds_read_b64_tr_b16 v[66:67], v9 offset:16384
    ds_read_b64_tr_b16 v[68:69], v10 offset:16384
    ds_read_b64_tr_b16 v[70:71], v11 offset:16384
    ds_read_b64_tr_b16 v[72:73], v8 offset:24576
    ds_read_b64_tr_b16 v[74:75], v9 offset:24576
    ds_read_b64_tr_b16 v[76:77], v10 offset:24576
    ds_read_b64_tr_b16 v[78:79], v11 offset:24576
    ds_read_b128 v[32:35], v5 offset:0
    ds_read_b128 v[36:39], v5 offset:1024
    ds_read_b128 v[40:43], v5 offset:2048
    ds_read_b128 v[44:47], v5 offset:3072
    ds_read_b128 v[48:51], v5 offset:4096
    ds_read_b128 v[52:55], v5 offset:5120
    ds_read_b128 v[56:59], v5 offset:6144
    ds_read_b128 v[60:63], v5 offset:7168
    s_waitcnt lgkmcnt(0)
    s_cmp_eq_u32 s48, 4
    s_cbranch_scc1 w_firstH
    s_cmp_eq_u32 s48, 5
    s_cbranch_scc1 w_firstM
    s_branch w_first16
w_first4:
    s_waitcnt vmcnt(12)
    s_barrier
    v_mfma_f32_16x16x32_bf16 v[128:131], v[64:67], v[32:35], 0
    ds_read_b64_tr_b16 v[112:113], v8 offset:49152
    v_mfma_f32_16x16x32_bf16 v[132:135], v[68:71], v[32:35], 0
    ds_read_b64_tr_b16 v[114:115], v9 offset:49152
    v_mfma_f32_16x16x32_bf16 v[136:139], v[72:75], v[32:35], 0
    ds_read_b64_tr_b16 v[116:117], v10 offset:49152
    v_mfma_f32_16x16x32_bf16 v[140:143], v[76:79], v[32:35], 0
    ds_read_b64_tr_b16 v[118:119], v11 offset:49152
    v_mfma_f32_16x16x32_bf16 v[144:147], v[64:67], v[36:39], 0
    ds_read_b64_tr_b16 v[120:121], v8 offset:57344
    v_mfma_f32_16x16x32_bf16 v[148:151], v[68:71], v[36:39], 0
    ds_read_b64_tr_b16 v[122:123], v9 offset:57344
    v_mfma_f32_16x16x32_bf16 v[152:155], v[72:75], v[36:39], 0
    ds_read_b64_tr_b16 v[124:125], v10 offset:57344
    v_mfma_f32_16x16x32_bf16 v[156:159], v[76:79], v[36:39], 0
    ds_read_b64_tr_b16 v[126:127], v11 offset:57344
    v_mfma_f32_16x16x32_bf16 v[160:163], v[64:67], v[40:43], 0
    ds_read_b128 v[80:83], v5 offset:32768
    v_mfma_f32_16x16x32_bf16 v[164:167], v[68:71], v[40:43], 0
    ds_read_b128 v[84:87], v5 offset:33792
    v_mfma_f32_16x16x32_bf16 v[168:171], v[72:75], v[40:43], 0
    ds_read_b128 v[88:91], v5 offset:34816
    v_mfma_f32_16x16x32_bf16 v[172:175], v[76:79], v[40:43], 0
    ds_read_b128 v[92:95], v5 offset:35840
    v_mfma_f32_16x16x32_bf16 v[176:179], v[64:67], v[44:47], 0
    ds_read_b128 v[96:99], v5 offset:36864
    v_mfma_f32_16x16x32_bf16 v[180:183], v[68:71], v[44:47], 0
    ds_read_b128 v[100:103], v5 offset:37888
    v_mfma_f32_16x16x32_bf16 v[184:187], v[72:75], v[44:47], 0
    ds_read_b128 v[104:107], v5 offset:38912
    v_mfma_f32_16x16x32_bf16 v[188:191], v[76:79], v[44:47], 0
    ds_read_b128 v[108:111], v5 offset:39936
    v_mfma_f32_16x16x32_bf16 v[192:195], v[64:67], v[48:51], 0
    v_mfma_f32_16x16x32_bf16 v[196:199], v[68:71], v[48:51], 0
    s_add_u32 m0, s21, 0
    s_nop 0
    buffer_load_dwordx4 v1, s[4:7], s16 offen sc1 lds
    s_add_u32 s16, s16, s62
    v_mfma_f32_16x16x32_bf16 v[200:203], v[72:75], v[48:51], 0
    v_mfma_f32_16x16x32_bf16 v[204:207], v[76:79], v[48:51], 0
    v_mfma_f32_16x16x32_bf16 v[208:211], v[64:67], v[52:55], 0
    s_add_u32 m0, s21, 1024
    s_nop 0
    buffer_load_dwordx4 v1, s[4:7], s17 offen sc1 lds
    s_add_u32 s17, s17, s62
    v_mfma_f32_16x16x32_bf16 v[212:215], v[68:71], v[52:55], 0
    v_mfma_f32_16x16x32_bf16 v[216:219], v[72:75], v[52:55], 0
    v_mfma_f32_16x16x32_bf16 v[220:223], v[76:79], v[52:55], 0
    s_add_u32 m0, s22, 0
    s_nop 0
    buffer_load_dwordx4 v2, s[8:11], s18 offen lds
    s_add_u32 s18, s18, s20
    v_mfma_f32_16x16x32_bf16 v[224:227], v[64:67], v[56:59], 0
    v_mfma_f32_16x16x32_bf16 v[228:231], v[68:71], v[56:59], 0
    v_mfma_f32_16x16x32_bf16 v[232:235], v[72:75], v[56:59], 0
    s_add_u32 m0, s22, 8192
    s_nop 0
    buffer_load_dwordx4 v2, s[12:15], s19 offen lds
    s_add_u32 s19, s19, s20
    v_mfma_f32_16x16x32_bf16 v[236:239], v[76:79], v[56:59], 0
    v_mfma_f32_16x16x32_bf16 v[240:243], v[64:67], v[60:63], 0
    v_mfma_f32_16x16x32_bf16 v[244:247], v[68:71], v[60:63], 0
    v_mfma_f32_16x16x32_bf16 v[248:251], v[72:75], v[60:63], 0
    v_mfma_f32_16x16x32_bf16 v[252:255], v[76:79], v[60:63], 0
    s_waitcnt lgkmcnt(0)
    s_waitcnt vmcnt(12)
    s_barrier
    v_mfma_f32_16x16x32_bf16 v[128:131], v[112:115], v[80:83], v[128:131]
    ds_read_b64_tr_b16 v[64:65], v12 offset:16384
    v_mfma_f32_16x16x32_bf16 v[132:135], v[116:119], v[80:83], v[132:135]
    ds_read_b64_tr_b16 v[66:67], v13 offset:16384
    v_mfma_f32_16x16x32_bf16 v[136:139], v[120:123], v[80:83], v[136:139]
    ds_read_b64_tr_b16 v[68:69], v14 offset:16384
    v_mfma_f32_16x16x32_bf16 v[140:143], v[124:127], v[80:83], v[140:143]
    ds_read_b64_tr_b16 v[70:71], v15 offset:16384
    v_mfma_f32_16x16x32_bf16 v[144:147], v[112:115], v[84:87], v[144:147]
    ds_read_b64_tr_b16 v[72:73], v12 offset:24576
    v_mfma_f32_16x16x32_bf16 v[148:151], v[116:119], v[84:87], v[148:151]
    ds_read_b64_tr_b16 v[74:75], v13 offset:24576
    v_mfma_f32_16x16x32_bf16 v[152:155], v[120:123], v[84:87], v[152:155]
    ds_read_b64_tr_b16 v[76:77], v14 offset:24576
    v_mfma_f32_16x16x32_bf16 v[156:159], v[124:127], v[84:87], v[156:159]
    ds_read_b64_tr_b16 v[78:79], v15 offset:24576
    v_mfma_f32_16x16x32_bf16 v[160:163], v[112:115], v[88:91], v[160:163]
    ds_read_b128 v[32:35], v6 offset:0
    v_mfma_f32_16x16x32_bf16 v[164:167], v[116:119], v[88:91], v[164:167]
    ds_read_b128 v[36:39], v6 offset:1024
    v_mfma_f32_16x16x32_bf16 v[168:171], v[120:123], v[88:91], v[168:171]
    ds_read_b128 v[40:43], v6 offset:2048
    v_mfma_f32_16x16x32_bf16 v[172:175], v[124:127], v[88:91], v[172:175]
    ds_read_b128 v[44:47], v6 offset:3072
    v_mfma_f32_16x16x32_bf16 v[176:179], v[112:115], v[92:95], v[176:179]
    ds_read_b128 v[48:51], v6 offset:4096
    v_mfma_f32_16x16x32_bf16 v[180:183], v[116:119], v[92:95], v[180:183]
    ds_read_b128 v[52:55], v6 offset:5120
    v_mfma_f32_16x16x32_bf16 v[184:187], v[120:123], v[92:95], v[184:187]
    ds_read_b128 v[56:59], v6 offset:6144
    v_mfma_f32_16x16x32_bf16 v[188:191], v[124:127], v[92:95], v[188:191]
    ds_read_b128 v[60:63], v6 offset:7168
    v_mfma_f32_16x16x32_bf16 v[192:195], v[112:115], v[96:99], v[192:195]
    v_mfma_f32_16x16x32_bf16 v[196:199], v[116:119], v[96:99], v[196:199]
    s_add_u32 m0, s21, 32768
    s_nop 0
    buffer_load_dwordx4 v1, s[4:7], s16 offen sc1 lds
    s_add_u32 s16, s16, s62
    v_mfma_f32_16x16x32_bf16 v[200:203], v[120:123], v[96:99], v[200:203]
    v_mfma_f32_16x16x32_bf16 v[204:207], v[124:127], v[96:99], v[204:207]
    v_mfma_f32_16x16x32_bf16 v[208:211], v[112:115], v[100:103], v[208:211]
    s_add_u32 m0, s21, 33792
    s_nop 0
    buffer_load_dwordx4 v1, s[4:7], s17 offen sc1 lds
    s_add_u32 s17, s17, s62
    v_mfma_f32_16x16x32_bf16 v[212:215], v[116:119], v[100:103], v[212:215]
    v_mfma_f32_16x16x32_bf16 v[216:219], v[120:123], v[100:103], v[216:219]
    v_mfma_f32_16x16x32_bf16 v[220:223], v[124:127], v[100:103], v[220:223]
    s_add_u32 m0, s22, 32768
    s_nop 0
    buffer_load_dwordx4 v2, s[8:11], s18 offen lds
    s_add_u32 s18, s18, s20
    v_mfma_f32_16x16x32_bf16 v[224:227], v[112:115], v[104:107], v[224:227]
    v_mfma_f32_16x16x32_bf16 v[228:231], v[116:119], v[104:107], v[228:231]
    v_mfma_f32_16x16x32_bf16 v[232:235], v[120:123], v[104:107], v[232:235]
    s_add_u32 m0, s22, 40960
    s_nop 0
    buffer_load_dwordx4 v2, s[12:15], s19 offen lds
    s_add_u32 s19, s19, s20
    v_mfma_f32_16x16x32_bf16 v[236:239], v[124:127], v[104:107], v[236:239]
    v_mfma_f32_16x16x32_bf16 v[240:243], v[112:115], v[108:111], v[240:243]
    v_mfma_f32_16x16x32_bf16 v[244:247], v[116:119], v[108:111], v[244:247]
    v_mfma_f32_16x16x32_bf16 v[248:251], v[120:123], v[108:111], v[248:251]
    v_mfma_f32_16x16x32_bf16 v[252:255], v[124:127], v[108:111], v[252:255]
    s_waitcnt lgkmcnt(0)
    s_waitcnt vmcnt(12)
    s_barrier
    v_mfma_f32_16x16x32_bf16 v[128:131], v[64:67], v[32:35], v[128:131]
    ds_read_b64_tr_b16 v[112:113], v12 offset:49152
    v_mfma_f32_16x16x32_bf16 v[132:135], v[68:71], v[32:35], v[132:135]
    ds_read_b64_tr_b16 v[114:115], v13 offset:49152
    v_mfma_f32_16x16x32_bf16 v[136:139], v[72:75], v[32:35], v[136:139]
    ds_read_b64_tr_b16 v[116:117], v14 offset:49152
    v_mfma_f32_16x16x32_bf16 v[140:143], v[76:79], v[32:35], v[140:143]
    ds_read_b64_tr_b16 v[118:119], v15 offset:49152
    v_mfma_f32_16x16x32_bf16 v[144:147], v[64:67], v[36:39], v[144:147]
    ds_read_b64_tr_b16 v[120:121], v12 offset:57344
    v_mfma_f32_16x16x32_bf16 v[148:151], v[68:71], v[36:39], v[148:151]
    ds_read_b64_tr_b16 v[122:123], v13 offset:57344
    v_mfma_f32_16x16x32_bf16 v[152:155], v[72:75], v[36:39], v[152:155]
    ds_read_b64_tr_b16 v[124:125], v14 offset:57344
    v_mfma_f32_16x16x32_bf16 v[156:159], v[76:79], v[36:39], v[156:159]
    ds_read_b64_tr_b16 v[126:127], v15 offset:57344
    v_mfma_f32_16x16x32_bf16 v[160:163], v[64:67], v[40:43], v[160:163]
    ds_read_b128 v[80:83], v6 offset:32768
    v_mfma_f32_16x16x32_bf16 v[164:167], v[68:71], v[40:43], v[164:167]
    ds_read_b128 v[84:87], v6 offset:33792
    v_mfma_f32_16x16x32_bf16 v[168:171], v[72:75], v[40:43], v[168:171]
    ds_read_b128 v[88:91], v6 offset:34816
    v_mfma_f32_16x16x32_bf16 v[172:175], v[76:79], v[40:43], v[172:175]
    ds_read_b128 v[92:95], v6 offset:35840
    v_mfma_f32_16x16x32_bf16 v[176:179], v[64:67], v[44:47], v[176:179]
    ds_read_b128 v[96:99], v6 offset:36864
    v_mfma_f32_16x16x32_bf16 v[180:183], v[68:71], v[44:47], v[180:183]
    ds_read_b128 v[100:103], v6 offset:37888
    v_mfma_f32_16x16x32_bf16 v[184:187], v[72:75], v[44:47], v[184:187]
    ds_read_b128 v[104:107], v6 offset:38912
    v_mfma_f32_16x16x32_bf16 v[188:191], v[76:79], v[44:47], v[188:191]
    ds_read_b128 v[108:111], v6 offset:39936
    v_mfma_f32_16x16x32_bf16 v[192:195], v[64:67], v[48:51], v[192:195]
    v_mfma_f32_16x16x32_bf16 v[196:199], v[68:71], v[48:51], v[196:199]
    s_add_u32 m0, s21, 65536
    s_nop 0
    buffer_load_dwordx4 v1, s[4:7], s16 offen sc1 lds
    s_add_u32 s16, s16, s62
    v_mfma_f32_16x16x32_bf16 v[200:203], v[72:75], v[48:51], v[200:203]
    v_mfma_f32_16x16x32_bf16 v[204:207], v[76:79], v[48:51], v[204:207]
    v_mfma_f32_16x16x32_bf16 v[208:211], v[64:67], v[52:55], v[208:211]
    s_add_u32 m0, s21, 66560
    s_nop 0
    buffer_load_dwordx4 v1, s[4:7], s17 offen sc1 lds
    s_add_u32 s17, s17, s62
    v_mfma_f32_16x16x32_bf16 v[212:215], v[68:71], v[52:55], v[212:215]
    v_mfma_f32_16x16x32_bf16 v[216:219], v[72:75], v[52:55], v[216:219]
    v_mfma_f32_16x16x32_bf16 v[220:223], v[76:79], v[52:55], v[220:223]
    s_add_u32 m0, s22, 65536
    s_nop 0
    buffer_load_dwordx4 v2, s[8:11], s18 offen lds
    s_add_u32 s18, s18, s20
    v_mfma_f32_16x16x32_bf16 v[224:227], v[64:67], v[56:59], v[224:227]
    v_mfma_f32_16x16x32_bf16 v[228:231], v[68:71], v[56:59], v[228:231]
    v_mfma_f32_16x16x32_bf16 v[232:235], v[72:75], v[56:59], v[232:235]
    s_add_u32 m0, s22, 73728
    s_nop 0
    buffer_load_dwordx4 v2, s[12:15], s19 offen lds
    s_add_u32 s19, s19, s20
    v_mfma_f32_16x16x32_bf16 v[236:239], v[76:79], v[56:59], v[236:239]
    v_mfma_f32_16x16x32_bf16 v[240:243], v[64:67], v[60:63], v[240:243]
    v_mfma_f32_16x16x32_bf16 v[244:247], v[68:71], v[60:63], v[244:247]
    v_mfma_f32_16x16x32_bf16 v[248:251], v[72:75], v[60:63], v[248:251]
    v_mfma_f32_16x16x32_bf16 v[252:255], v[76:79], v[60:63], v[252:255]
    s_waitcnt lgkmcnt(0)
    s_waitcnt vmcnt(8)
    s_barrier
    s_cmp_eq_u32 s28, 0
    s_cbranch_scc1 sig_2
    s_cmp_lg_u32 s3, 0
    s_cbranch_scc1 sig_2
    s_mov_b64 exec, 1
    v_mov_b32 v18, s57
    buffer_atomic_add v18, v17, s[4:7], s28 offen sc1
    s_mov_b64 exec, -1
sig_2:
    s_mov_b32 s28, 0
    v_mfma_f32_16x16x32_bf16 v[128:131], v[112:115], v[80:83], v[128:131]
    ds_read_b64_tr_b16 v[64:65], v8 offset:16384
    v_mfma_f32_16x16x32_bf16 v[132:135], v[116:119], v[80:83], v[132:135]
    ds_read_b64_tr_b16 v[66:67], v9 offset:16384
    v_mfma_f32_16x16x32_bf16 v[136:139], v[120:123], v[80:83], v[136:139]
    ds_read_b64_tr_b16 v[68:69], v10 offset:16384
    v_mfma_f32_16x16x32_bf16 v[140:143], v[124:127], v[80:83], v[140:143]
    ds_read_b64_tr_b16 v[70:71], v11 offset:16384
    v_mfma_f32_16x16x32_bf16 v[144:147], v[112:115], v[84:87], v[144:147]
    ds_read_b64_tr_b16 v[72:73], v8 offset:24576
    v_mfma_f32_16x16x32_bf16 v[148:151], v[116:119], v[84:87], v[148:151]
    ds_read_b64_tr_b16 v[74:75], v9 offset:24576
    v_mfma_f32_16x16x32_bf16 v[152:155], v[120:123], v[84:87], v[152:155]
    ds_read_b64_tr_b16 v[76:77], v10 offset:24576
    v_mfma_f32_16x16x32_bf16 v[156:159], v[124:127], v[84:87], v[156:159]
    ds_read_b64_tr_b16 v[78:79], v11 offset:24576
    v_mfma_f32_16x16x32_bf16 v[160:163], v[112:115], v[88:91], v[160:163]
    ds_read_b128 v[32:35], v5 offset:0
    v_mfma_f32_16x16x32_bf16 v[164:167], v[116:119], v[88:91], v[164:167]
    ds_read_b128 v[36:39], v5 offset:1024
    v_mfma_f32_16x16x32_bf16 v[168:171], v[120:123], v[88:91], v[168:171]
    ds_read_b128 v[40:43], v5 offset:2048
    v_mfma_f32_16x16x32_bf16 v[172:175], v[124:127], v[88:91], v[172:175]
    ds_read_b128 v[44:47], v5 offset:3072
    v_mfma_f32_16x16x32_bf16 v[176:179], v[112:115], v[92:95], v[176:179]
    ds_read_b128 v[48:51], v5 offset:4096
    v_mfma_f32_16x16x32_bf16 v[180:183], v[116:119], v[92:95], v[180:183]
    ds_read_b128 v[52:55], v5 offset:5120
    v_mfma_f32_16x16x32_bf16 v[184:187], v[120:123], v[92:95], v[184:187]
    ds_read_b128 v[56:59], v5 offset:6144
    v_mfma_f32_16x16x32_bf16 v[188:191], v[124:127], v[92:95], v[188:191]
    ds_read_b128 v[60:63], v5 offset:7168
    v_mfma_f32_16x16x32_bf16 v[192:195], v[112:115], v[96:99], v[192:195]
    v_mfma_f32_16x16x32_bf16 v[196:199], v[116:119], v[96:99], v[196:199]
    s_add_u32 m0, s21, 98304
    s_nop 0
    buffer_load_dwordx4 v1, s[4:7], s16 offen sc1 lds
    s_add_u32 s16, s16, s62
    v_mfma_f32_16x16x32_bf16 v[200:203], v[120:123], v[96:99], v[200:203]
    v_mfma_f32_16x16x32_bf16 v[204:207], v[124:127], v[96:99], v[204:207]
    v_mfma_f32_16x16x32_bf16 v[208:211], v[112:115], v[100:103], v[208:211]
    s_add_u32 m0, s21, 99328
    s_nop 0
    buffer_load_dwordx4 v1, s[4:7], s17 offen sc1 lds
    s_add_u32 s17, s17, s62
    v_mfma_f32_16x16x32_bf16 v[212:215], v[116:119], v[100:103], v[212:215]
    v_mfma_f32_16x16x32_bf16 v[216:219], v[120:123], v[100:103], v[216:219]
    v_mfma_f32_16x16x32_bf16 v[220:223], v[124:127], v[100:103], v[220:223]
    s_add_u32 m0, s22, 98304
    s_nop 0
    buffer_load_dwordx4 v2, s[8:11], s18 offen lds
    s_add_u32 s18, s18, s20
    v_mfma_f32_16x16x32_bf16 v[224:227], v[112:115], v[104:107], v[224:227]
    v_mfma_f32_16x16x32_bf16 v[228:231], v[116:119], v[104:107], v[228:231]
    v_mfma_f32_16x16x32_bf16 v[232:235], v[120:123], v[104:107], v[232:235]
    s_add_u32 m0, s22, 106496
    s_nop 0
    buffer_load_dwordx4 v2, s[12:15], s19 offen lds
    s_add_u32 s19, s19, s20
    v_mfma_f32_16x16x32_bf16 v[236:239], v[124:127], v[104:107], v[236:239]
    v_mfma_f32_16x16x32_bf16 v[240:243], v[112:115], v[108:111], v[240:243]
    v_mfma_f32_16x16x32_bf16 v[244:247], v[116:119], v[108:111], v[244:247]
    v_mfma_f32_16x16x32_bf16 v[248:251], v[120:123], v[108:111], v[248:251]
    v_mfma_f32_16x16x32_bf16 v[252:255], v[124:127], v[108:111], v[252:255]
    s_waitcnt lgkmcnt(0)
    s_branch w_loop_chk
w_first8:
    s_waitcnt vmcnt(16)
    s_barrier
    v_mfma_f32_16x16x32_bf16 v[128:131], v[64:67], v[32:35], 0
    ds_read_b64_tr_b16 v[112:113], v8 offset:49152
    v_mfma_f32_16x16x32_bf16 v[132:135], v[68:71], v[32:35], 0
    ds_read_b64_tr_b16 v[114:115], v9 offset:49152
    v_mfma_f32_16x16x32_bf16 v[136:139], v[72:75], v[32:35], 0
    ds_read_b64_tr_b16 v[116:117], v10 offset:49152
    v_mfma_f32_16x16x32_bf16 v[140:143], v[76:79], v[32:35], 0
    ds_read_b64_tr_b16 v[118:119], v11 offset:49152
    v_mfma_f32_16x16x32_bf16 v[144:147], v[64:67], v[36:39], 0
    ds_read_b64_tr_b16 v[120:121], v8 offset:57344
    v_mfma_f32_16x16x32_bf16 v[148:151], v[68:71], v[36:39], 0
    ds_read_b64_tr_b16 v[122:123], v9 offset:57344
    v_mfma_f32_16x16x32_bf16 v[152:155], v[72:75], v[36:39], 0
    ds_read_b64_tr_b16 v[124:125], v10 offset:57344
    v_mfma_f32_16x16x32_bf16 v[156:159], v[76:79], v[36:39], 0
    ds_read_b64_tr_b16 v[126:127], v11 offset:57344
    v_mfma_f32_16x16x32_bf16 v[160:163], v[64:67], v[40:43], 0
    ds_read_b128 v[80:83], v5 offset:32768
    v_mfma_f32_16x16x32_bf16 v[164:167], v[68:71], v[40:43], 0
    ds_read_b128 v[84:87], v5 offset:33792
    v_mfma_f32_16x16x32_bf16 v[168:171], v[72:75], v[40:43], 0
    ds_read_b128 v[88:91], v5 offset:34816
    v_mfma_f32_16x16x32_bf16 v[172:175], v[76:79], v[40:43], 0
    ds_read_b128 v[92:95], v5 offset:35840
    v_mfma_f32_16x16x32_bf16 v[176:179], v[64:67], v[44:47], 0
    ds_read_b128 v[96:99], v5 offset:36864
    v_mfma_f32_16x16x32_bf16 v[180:183], v[68:71], v[44:47], 0
    ds_read_b128 v[100:103], v5 offset:37888
    v_mfma_f32_16x16x32_bf16 v[184:187], v[72:75], v[44:47], 0
    ds_read_b128 v[104:107], v5 offset:38912
    v_mfma_f32_16x16x32_bf16 v[188:191], v[76:79], v[44:47], 0
    ds_read_b128 v[108:111], v5 offset:39936
    v_mfma_f32_16x16x32_bf16 v[192:195], v[64:67], v[48:51], 0
    v_mfma_f32_16x16x32_bf16 v[196:199], v[68:71], v[48:51], 0
    s_add_u32 m0, s21, 0
    s_nop 0
    buffer_load_dwordx4 v1, s[4:7], s16 offen sc1 lds
    s_add_u32 s16, s16, s62
    v_mfma_f32_16x16x32_bf16 v[200:203], v[72:75], v[48:51], 0
    v_mfma_f32_16x16x32_bf16 v[204:207], v[76:79], v[48:51], 0
    v_mfma_f32_16x16x32_bf16 v[208:211], v[64:67], v[52:55], 0
    s_add_u32 m0, s21, 1024
    s_nop 0
    buffer_load_dwordx4 v1, s[4:7], s17 offen sc1 lds
    s_add_u32 s17, s17, s62
    v_mfma_f32_16x16x32_bf16 v[212:215], v[68:71], v[52:55], 0
    v_mfma_f32_16x16x32_bf16 v[216:219], v[72:75], v[52:55], 0
    v_mfma_f32_16x16x32_bf16 v[220:223], v[76:79], v[52:55], 0
    s_add_u32 m0, s22, 0
    s_nop 0
    buffer_load_dwordx4 v2, s[8:11], s18 offen lds
    s_add_u32 s18, s18, s20
    v_mfma_f32_16x16x32_bf16 v[224:227], v[64:67], v[56:59], 0
    v_mfma_f32_16x16x32_bf16 v[228:231], v[68:71], v[56:59], 0
    v_mfma_f32_16x16x32_bf16 v[232:235], v[72:75], v[56:59], 0
    s_add_u32 m0, s22, 8192
    s_nop 0
    buffer_load_dwordx4 v2, s[12:15], s19 offen lds
    s_add_u32 s19, s19, s20
    v_mfma_f32_16x16x32_bf16 v[236:239], v[76:79], v[56:59], 0
    v_mfma_f32_16x16x32_bf16 v[240:243], v[64:67], v[60:63], 0
    v_mfma_f32_16x16x32_bf16 v[244:247], v[68:71], v[60:63], 0
    v_mfma_f32_16x16x32_bf16 v[248:251], v[72:75], v[60:63], 0
    v_mfma_f32_16x16x32_bf16 v[252:255], v[76:79], v[60:63], 0
    s_waitcnt lgkmcnt(0)
    s_waitcnt vmcnt(16)
    s_barrier
    v_mfma_f32_16x16x32_bf16 v[128:131], v[112:115], v[80:83], v[128:131]
    ds_read_b64_tr_b16 v[64:65], v12 offset:16384
    v_mfma_f32_16x16x32_bf16 v[132:135], v[116:119], v[80:83], v[132:135]
    ds_read_b64_tr_b16 v[66:67], v13 offset:16384
    v_mfma_f32_16x16x32_bf16 v[136:139], v[120:123], v[80:83], v[136:139]
    ds_read_b64_tr_b16 v[68:69], v14 offset:16384
    v_mfma_f32_16x16x32_bf16 v[140:143], v[124:127], v[80:83], v[140:143]
    ds_read_b64_tr_b16 v[70:71], v15 offset:16384
    v_mfma_f32_16x16x32_bf16 v[144:147], v[112:115], v[84:87], v[144:147]
    ds_read_b64_tr_b16 v[72:73], v12 offset:24576
    v_mfma_f32_16x16x32_bf16 v[148:151], v[116:119], v[84:87], v[148:151]
    ds_read_b64_tr_b16 v[74:75], v13 offset:24576
    v_mfma_f32_16x16x32_bf16 v[152:155], v[120:123], v[84:87], v[152:155]
    ds_read_b64_tr_b16 v[76:77], v14 offset:24576
    v_mfma_f32_16x16x32_bf16 v[156:159], v[124:127], v[84:87], v[156:159]
    ds_read_b64_tr_b16 v[78:79], v15 offset:24576
    v_mfma_f32_16x16x32_bf16 v[160:163], v[112:115], v[88:91], v[160:163]
    ds_read_b128 v[32:35], v6 offset:0
    v_mfma_f32_16x16x32_bf16 v[164:167], v[116:119], v[88:91], v[164:167]
    ds_read_b128 v[36:39], v6 offset:1024
    v_mfma_f32_16x16x32_bf16 v[168:171], v[120:123], v[88:91], v[168:171]
    ds_read_b128 v[40:43], v6 offset:2048
    v_mfma_f32_16x16x32_bf16 v[172:175], v[124:127], v[88:91], v[172:175]
    ds_read_b128 v[44:47], v6 offset:3072
    v_mfma_f32_16x16x32_bf16 v[176:179], v[112:115], v[92:95], v[176:179]
    ds_read_b128 v[48:51], v6 offset:4096
    v_mfma_f32_16x16x32_bf16 v[180:183], v[116:119], v[92:95], v[180:183]
    ds_read_b128 v[52:55], v6 offset:5120
    v_mfma_f32_16x16x32_bf16 v[184:187], v[120:123], v[92:95], v[184:187]
    ds_read_b128 v[56:59], v6 offset:6144
    v_mfma_f32_16x16x32_bf16 v[188:191], v[124:127], v[92:95], v[188:191]
    ds_read_b128 v[60:63], v6 offset:7168
    v_mfma_f32_16x16x32_bf16 v[192:195], v[112:115], v[96:99], v[192:195]
    v_mfma_f32_16x16x32_bf16 v[196:199], v[116:119], v[96:99], v[196:199]
    s_add_u32 m0, s21, 32768
    s_nop 0
    buffer_load_dwordx4 v1, s[4:7], s16 offen sc1 lds
    s_add_u32 s16, s16, s62
    v_mfma_f32_16x16x32_bf16 v[200:203], v[120:123], v[96:99], v[200:203]
    v_mfma_f32_16x16x32_bf16 v[204:207], v[124:127], v[96:99], v[204:207]
    v_mfma_f32_16x16x32_bf16 v[208:211], v[112:115], v[100:103], v[208:211]
    s_add_u32 m0, s21, 33792
    s_nop 0
    buffer_load_dwordx4 v1, s[4:7], s17 offen sc1 lds
    s_add_u32 s17, s17, s62
    v_mfma_f32_16x16x32_bf16 v[212:215], v[116:119], v[100:103], v[212:215]
    v_mfma_f32_16x16x32_bf16 v[216:219], v[120:123], v[100:103], v[216:219]
    v_mfma_f32_16x16x32_bf16 v[220:223], v[124:127], v[100:103], v[220:223]
    s_add_u32 m0, s22, 32768
    s_nop 0
    buffer_load_dwordx4 v2, s[8:11], s18 offen lds
    s_add_u32 s18, s18, s20
    v_mfma_f32_16x16x32_bf16 v[224:227], v[112:115], v[104:107], v[224:227]
    v_mfma_f32_16x16x32_bf16 v[228:231], v[116:119], v[104:107], v[228:231]
    v_mfma_f32_16x16x32_bf16 v[232:235], v[120:123], v[104:107], v[232:235]
    s_add_u32 m0, s22, 40960
    s_nop 0
    buffer_load_dwordx4 v2, s[12:15], s19 offen lds
    s_add_u32 s19, s19, s20
    v_mfma_f32_16x16x32_bf16 v[236:239], v[124:127], v[104:107], v[236:239]
    v_mfma_f32_16x16x32_bf16 v[240:243], v[112:115], v[108:111], v[240:243]
    v_mfma_f32_16x16x32_bf16 v[244:247], v[116:119], v[108:111], v[244:247]
    v_mfma_f32_16x16x32_bf16 v[248:251], v[120:123], v[108:111], v[248:251]
    v_mfma_f32_16x16x32_bf16 v[252:255], v[124:127], v[108:111], v[252:255]
    s_waitcnt lgkmcnt(0)
    s_waitcnt vmcnt(16)
    s_barrier
    v_mfma_f32_16x16x32_bf16 v[128:131], v[64:67], v[32:35], v[128:131]
    ds_read_b64_tr_b16 v[112:113], v12 offset:49152
    v_mfma_f32_16x16x32_bf16 v[132:135], v[68:71], v[32:35], v[132:135]
    ds_read_b64_tr_b16 v[114:115], v13 offset:49152
    v_mfma_f32_16x16x32_bf16 v[136:139], v[72:75], v[32:35], v[136:139]
    ds_read_b64_tr_b16 v[116:117], v14 offset:49152
    v_mfma_f32_16x16x32_bf16 v[140:143], v[76:79], v[32:35], v[140:143]
    ds_read_b64_tr_b16 v[118:119], v15 offset:49152
    v_mfma_f32_16x16x32_bf16 v[144:147], v[64:67], v[36:39], v[144:147]
    ds_read_b64_tr_b16 v[120:121], v12 offset:57344
    v_mfma_f32_16x16x32_bf16 v[148:151], v[68:71], v[36:39], v[148:151]
    ds_read_b64_tr_b16 v[122:123], v13 offset:57344
    v_mfma_f32_16x16x32_bf16 v[152:155], v[72:75], v[36:39], v[152:155]
    ds_read_b64_tr_b16 v[124:125], v14 offset:57344
    v_mfma_f32_16x16x32_bf16 v[156:159], v[76:79], v[36:39], v[156:159]
    ds_read_b64_tr_b16 v[126:127], v15 offset:57344
    v_mfma_f32_16x16x32_bf16 v[160:163], v[64:67], v[40:43], v[160:163]
    ds_read_b128 v[80:83], v6 offset:32768
    v_mfma_f32_16x16x32_bf16 v[164:167], v[68:71], v[40:43], v[164:167]
    ds_read_b128 v[84:87], v6 offset:33792
    v_mfma_f32_16x16x32_bf16 v[168:171], v[72:75], v[40:43], v[168:171]
    ds_read_b128 v[88:91], v6 offset:34816
    v_mfma_f32_16x16x32_bf16 v[172:175], v[76:79], v[40:43], v[172:175]
    ds_read_b128 v[92:95], v6 offset:35840
    v_mfma_f32_16x16x32_bf16 v[176:179], v[64:67], v[44:47], v[176:179]
    ds_read_b128 v[96:99], v6 offset:36864
    v_mfma_f32_16x16x32_bf16 v[180:183], v[68:71], v[44:47], v[180:183]
    ds_read_b128 v[100:103], v6 offset:37888
    v_mfma_f32_16x16x32_bf16 v[184:187], v[72:75], v[44:47], v[184:187]
    ds_read_b128 v[104:107], v6 offset:38912
    v_mfma_f32_16x16x32_bf16 v[188:191], v[76:79], v[44:47], v[188:191]
    ds_read_b128 v[108:111], v6 offset:39936
    v_mfma_f32_16x16x32_bf16 v[192:195], v[64:67], v[48:51], v[192:195]
    v_mfma_f32_16x16x32_bf16 v[196:199], v[68:71], v[48:51], v[196:199]
    s_add_u32 m0, s21, 65536
    s_nop 0
    buffer_load_dwordx4 v1, s[4:7], s16 offen sc1 lds
    s_add_u32 s16, s16, s62
    v_mfma_f32_16x16x32_bf16 v[200:203], v[72:75], v[48:51], v[200:203]
    v_mfma_f32_16x16x32_bf16 v[204:207], v[76:79], v[48:51], v[204:207]
    v_mfma_f32_16x16x32_bf16 v[208:211], v[64:67], v[52:55], v[208:211]
    s_add_u32 m0, s21, 66560
    s_nop 0
    buffer_load_dwordx4 v1, s[4:7], s17 offen sc1 lds
    s_add_u32 s17, s17, s62
    v_mfma_f32_16x16x32_bf16 v[212:215], v[68:71], v[52:55], v[212:215]
    v_mfma_f32_16x16x32_bf16 v[216:219], v[72:75], v[52:55], v[216:219]
    v_mfma_f32_16x16x32_bf16 v[220:223], v[76:79], v[52:55], v[220:223]
    s_add_u32 m0, s22, 65536
    s_nop 0
    buffer_load_dwordx4 v2, s[8:11], s18 offen lds
    s_add_u32 s18, s18, s20
    v_mfma_f32_16x16x32_bf16 v[224:227], v[64:67], v[56:59], v[224:227]
    v_mfma_f32_16x16x32_bf16 v[228:231], v[68:71], v[56:59], v[228:231]
    v_mfma_f32_16x16x32_bf16 v[232:235], v[72:75], v[56:59], v[232:235]
    s_add_u32 m0, s22, 73728
    s_nop 0
    buffer_load_dwordx4 v2, s[12:15], s19 offen lds
    s_add_u32 s19, s19, s20
    v_mfma_f32_16x16x32_bf16 v[236:239], v[76:79], v[56:59], v[236:239]
    v_mfma_f32_16x16x32_bf16 v[240:243], v[64:67], v[60:63], v[240:243]
    v_mfma_f32_16x16x32_bf16 v[244:247], v[68:71], v[60:63], v[244:247]
    v_mfma_f32_16x16x32_bf16 v[248:251], v[72:75], v[60:63], v[248:251]
    v_mfma_f32_16x16x32_bf16 v[252:255], v[76:79], v[60:63], v[252:255]
    s_waitcnt lgkmcnt(0)
    s_waitcnt vmcnt(8)
    s_barrier
    s_cmp_eq_u32 s28, 0
    s_cbranch_scc1 sig_3
    s_cmp_lg_u32 s3, 0
    s_cbranch_scc1 sig_3
    s_mov_b64 exec, 1
    v_mov_b32 v18, s57
    buffer_atomic_add v18, v17, s[4:7], s28 offen sc1
    s_mov_b64 exec, -1
sig_3:
    s_mov_b32 s28, 0
    v_mfma_f32_16x16x32_bf16 v[128:131], v[112:115], v[80:83], v[128:131]
    ds_read_b64_tr_b16 v[64:65], v8 offset:16384
    v_mfma_f32_16x16x32_bf16 v[132:135], v[116:119], v[80:83], v[132:135]
    ds_read_b64_tr_b16 v[66:67], v9 offset:16384
    v_mfma_f32_16x16x32_bf16 v[136:139], v[120:123], v[80:83], v[136:139]
    ds_read_b64_tr_b16 v[68:69], v10 offset:16384
    v_mfma_f32_16x16x32_bf16 v[140:143], v[124:127], v[80:83], v[140:143]
    ds_read_b64_tr_b16 v[70:71], v11 offset:16384
    v_mfma_f32_16x16x32_bf16 v[144:147], v[112:115], v[84:87], v[144:147]
    ds_read_b64_tr_b16 v[72:73], v8 offset:24576
    v_mfma_f32_16x16x32_bf16 v[148:151], v[116:119], v[84:87], v[148:151]
    ds_read_b64_tr_b16 v[74:75], v9 offset:24576
    v_mfma_f32_16x16x32_bf16 v[152:155], v[120:123], v[84:87], v[152:155]
    ds_read_b64_tr_b16 v[76:77], v10 offset:24576
    v_mfma_f32_16x16x32_bf16 v[156:159], v[124:127], v[84:87], v[156:159]
    ds_read_b64_tr_b16 v[78:79], v11 offset:24576
    v_mfma_f32_16x16x32_bf16 v[160:163], v[112:115], v[88:91], v[160:163]
    ds_read_b128 v[32:35], v5 offset:0
    v_mfma_f32_16x16x32_bf16 v[164:167], v[116:119], v[88:91], v[164:167]
    ds_read_b128 v[36:39], v5 offset:1024
    v_mfma_f32_16x16x32_bf16 v[168:171], v[120:123], v[88:91], v[168:171]
    ds_read_b128 v[40:43], v5 offset:2048
    v_mfma_f32_16x16x32_bf16 v[172:175], v[124:127], v[88:91], v[172:175]
    ds_read_b128 v[44:47], v5 offset:3072
    v_mfma_f32_16x16x32_bf16 v[176:179], v[112:115], v[92:95], v[176:179]
    ds_read_b128 v[48:51], v5 offset:4096
    v_mfma_f32_16x16x32_bf16 v[180:183], v[116:119], v[92:95], v[180:183]
    ds_read_b128 v[52:55], v5 offset:5120
    v_mfma_f32_16x16x32_bf16 v[184:187], v[120:123], v[92:95], v[184:187]
    ds_read_b128 v[56:59], v5 offset:6144
    v_mfma_f32_16x16x32_bf16 v[188:191], v[124:127], v[92:95], v[188:191]
    ds_read_b128 v[60:63], v5 offset:7168
    v_mfma_f32_16x16x32_bf16 v[192:195], v[112:115], v[96:99], v[192:195]
    v_mfma_f32_16x16x32_bf16 v[196:199], v[116:119], v[96:99], v[196:199]
    s_add_u32 m0, s21, 98304
    s_nop 0
    buffer_load_dwordx4 v1, s[4:7], s16 offen sc1 lds
    s_add_u32 s16, s16, s62
    v_mfma_f32_16x16x32_bf16 v[200:203], v[120:123], v[96:99], v[200:203]
    v_mfma_f32_16x16x32_bf16 v[204:207], v[124:127], v[96:99], v[204:207]
    v_mfma_f32_16x16x32_bf16 v[208:211], v[112:115], v[100:103], v[208:211]
    s_add_u32 m0, s21, 99328
    s_nop 0
    buffer_load_dwordx4 v1, s[4:7], s17 offen sc1 lds
    s_add_u32 s17, s17, s62
    v_mfma_f32_16x16x32_bf16 v[212:215], v[116:119], v[100:103], v[212:215]
    v_mfma_f32_16x16x32_bf16 v[216:219], v[120:123], v[100:103], v[216:219]
    v_mfma_f32_16x16x32_bf16 v[220:223], v[124:127], v[100:103], v[220:223]
    s_add_u32 m0, s22, 98304
    s_nop 0
    buffer_load_dwordx4 v2, s[8:11], s18 offen lds
    s_add_u32 s18, s18, s20
    v_mfma_f32_16x16x32_bf16 v[224:227], v[112:115], v[104:107], v[224:227]
    v_mfma_f32_16x16x32_bf16 v[228:231], v[116:119], v[104:107], v[228:231]
    v_mfma_f32_16x16x32_bf16 v[232:235], v[120:123], v[104:107], v[232:235]
    s_add_u32 m0, s22, 106496
    s_nop 0
    buffer_load_dwordx4 v2, s[12:15], s19 offen lds
    s_add_u32 s19, s19, s20
    v_mfma_f32_16x16x32_bf16 v[236:239], v[124:127], v[104:107], v[236:239]
    v_mfma_f32_16x16x32_bf16 v[240:243], v[112:115], v[108:111], v[240:243]
    v_mfma_f32_16x16x32_bf16 v[244:247], v[116:119], v[108:111], v[244:247]
    v_mfma_f32_16x16x32_bf16 v[248:251], v[120:123], v[108:111], v[248:251]
    v_mfma_f32_16x16x32_bf16 v[252:255], v[124:127], v[108:111], v[252:255]
    s_waitcnt lgkmcnt(0)
    s_branch w_loop_chk
w_first16:
    s_waitcnt vmcnt(24)
    s_barrier
    v_mfma_f32_16x16x32_bf16 v[128:131], v[64:67], v[32:35], 0
    ds_read_b64_tr_b16 v[112:113], v8 offset:49152
    v_mfma_f32_16x16x32_bf16 v[132:135], v[68:71], v[32:35], 0
    ds_read_b64_tr_b16 v[114:115], v9 offset:49152
    v_mfma_f32_16x16x32_bf16 v[136:139], v[72:75], v[32:35], 0
    ds_read_b64_tr_b16 v[116:117], v10 offset:49152
    v_mfma_f32_16x16x32_bf16 v[140:143], v[76:79], v[32:35], 0
    ds_read_b64_tr_b16 v[118:119], v11 offset:49152
    v_mfma_f32_16x16x32_bf16 v[144:147], v[64:67], v[36:39], 0
    ds_read_b64_tr_b16 v[120:121], v8 offset:57344
    v_mfma_f32_16x16x32_bf16 v[148:151], v[68:71], v[36:39], 0
    ds_read_b64_tr_b16 v[122:123], v9 offset:57344
    v_mfma_f32_16x16x32_bf16 v[152:155], v[72:75], v[36:39], 0
    ds_read_b64_tr_b16 v[124:125], v10 offset:57344
    v_mfma_f32_16x16x32_bf16 v[156:159], v[76:79], v[36:39], 0
    ds_read_b64_tr_b16 v[126:127], v11 offset:57344
    v_mfma_f32_16x16x32_bf16 v[160:163], v[64:67], v[40:43], 0
    ds_read_b128 v[80:83], v5 offset:32768
    v_mfma_f32_16x16x32_bf16 v[164:167], v[68:71], v[40:43], 0
    ds_read_b128 v[84:87], v5 offset:33792
    v_mfma_f32_16x16x32_bf16 v[168:171], v[72:75], v[40:43], 0
    ds_read_b128 v[88:91], v5 offset:34816
    v_mfma_f32_16x16x32_bf16 v[172:175], v[76:79], v[40:43], 0
    ds_read_b128 v[92:95], v5 offset:35840
    v_mfma_f32_16x16x32_bf16 v[176:179], v[64:67], v[44:47], 0
    ds_read_b128 v[96:99], v5 offset:36864
    v_mfma_f32_16x16x32_bf16 v[180:183], v[68:71], v[44:47], 0
    ds_read_b128 v[100:103], v5 offset:37888
    v_mfma_f32_16x16x32_bf16 v[184:187], v[72:75], v[44:47], 0
    ds_read_b128 v[104:107], v5 offset:38912
    v_mfma_f32_16x16x32_bf16 v[188:191], v[76:79], v[44:47], 0
    ds_read_b128 v[108:111], v5 offset:39936
    v_mfma_f32_16x16x32_bf16 v[192:195], v[64:67], v[48:51], 0
    v_mfma_f32_16x16x32_bf16 v[196:199], v[68:71], v[48:51], 0
    s_add_u32 m0, s21, 0
    s_nop 0
    buffer_load_dwordx4 v1, s[4:7], s16 offen sc1 lds
    s_add_u32 s16, s16, s62
    v_mfma_f32_16x16x32_bf16 v[200:203], v[72:75], v[48:51], 0
    v_mfma_f32_16x16x32_bf16 v[204:207], v[76:79], v[48:51], 0
    v_mfma_f32_16x16x32_bf16 v[208:211], v[64:67], v[52:55], 0
    s_add_u32 m0, s21, 1024
    s_nop 0
    buffer_load_dwordx4 v1, s[4:7], s17 offen sc1 lds
    s_add_u32 s17, s17, s62
    v_mfma_f32_16x16x32_bf16 v[212:215], v[68:71], v[52:55], 0
    v_mfma_f32_16x16x32_bf16 v[216:219], v[72:75], v[52:55], 0
    v_mfma_f32_16x16x32_bf16 v[220:223], v[76:79], v[52:55], 0
    s_add_u32 m0, s22, 0
    s_nop 0
    buffer_load_dwordx4 v2, s[8:11], s18 offen lds
    s_add_u32 s18, s18, s20
    v_mfma_f32_16x16x32_bf16 v[224:227], v[64:67], v[56:59], 0
    v_mfma_f32_16x16x32_bf16 v[228:231], v[68:71], v[56:59], 0
    v_mfma_f32_16x16x32_bf16 v[232:235], v[72:75], v[56:59], 0
    s_add_u32 m0, s22, 8192
    s_nop 0
    buffer_load_dwordx4 v2, s[12:15], s19 offen lds
    s_add_u32 s19, s19, s20
    v_mfma_f32_16x16x32_bf16 v[236:239], v[76:79], v[56:59], 0
    v_mfma_f32_16x16x32_bf16 v[240:243], v[64:67], v[60:63], 0
    v_mfma_f32_16x16x32_bf16 v[244:247], v[68:71], v[60:63], 0
    v_mfma_f32_16x16x32_bf16 v[248:251], v[72:75], v[60:63], 0
    v_mfma_f32_16x16x32_bf16 v[252:255], v[76:79], v[60:63], 0
    s_waitcnt lgkmcnt(0)
    s_waitcnt vmcnt(24)
    s_barrier
    v_mfma_f32_16x16x32_bf16 v[128:131], v[112:115], v[80:83], v[128:131]
    ds_read_b64_tr_b16 v[64:65], v12 offset:16384
    v_mfma_f32_16x16x32_bf16 v[132:135], v[116:119], v[80:83], v[132:135]
    ds_read_b64_tr_b16 v[66:67], v13 offset:16384
    v_mfma_f32_16x16x32_bf16 v[136:139], v[120:123], v[80:83], v[136:139]
    ds_read_b64_tr_b16 v[68:69], v14 offset:16384
    v_mfma_f32_16x16x32_bf16 v[140:143], v[124:127], v[80:83], v[140:143]
    ds_read_b64_tr_b16 v[70:71], v15 offset:16384
    v_mfma_f32_16x16x32_bf16 v[144:147], v[112:115], v[84:87], v[144:147]
    ds_read_b64_tr_b16 v[72:73], v12 offset:24576
    v_mfma_f32_16x16x32_bf16 v[148:151], v[116:119], v[84:87], v[148:151]
    ds_read_b64_tr_b16 v[74:75], v13 offset:24576
    v_mfma_f32_16x16x32_bf16 v[152:155], v[120:123], v[84:87], v[152:155]
    ds_read_b64_tr_b16 v[76:77], v14 offset:24576
    v_mfma_f32_16x16x32_bf16 v[156:159], v[124:127], v[84:87], v[156:159]
    ds_read_b64_tr_b16 v[78:79], v15 offset:24576
    v_mfma_f32_16x16x32_bf16 v[160:163], v[112:115], v[88:91], v[160:163]
    ds_read_b128 v[32:35], v6 offset:0
    v_mfma_f32_16x16x32_bf16 v[164:167], v[116:119], v[88:91], v[164:167]
    ds_read_b128 v[36:39], v6 offset:1024
    v_mfma_f32_16x16x32_bf16 v[168:171], v[120:123], v[88:91], v[168:171]
    ds_read_b128 v[40:43], v6 offset:2048
    v_mfma_f32_16x16x32_bf16 v[172:175], v[124:127], v[88:91], v[172:175]
    ds_read_b128 v[44:47], v6 offset:3072
    v_mfma_f32_16x16x32_bf16 v[176:179], v[112:115], v[92:95], v[176:179]
    ds_read_b128 v[48:51], v6 offset:4096
    v_mfma_f32_16x16x32_bf16 v[180:183], v[116:119], v[92:95], v[180:183]
    ds_read_b128 v[52:55], v6 offset:5120
    v_mfma_f32_16x16x32_bf16 v[184:187], v[120:123], v[92:95], v[184:187]
    ds_read_b128 v[56:59], v6 offset:6144
    v_mfma_f32_16x16x32_bf16 v[188:191], v[124:127], v[92:95], v[188:191]
    ds_read_b128 v[60:63], v6 offset:7168
    v_mfma_f32_16x16x32_bf16 v[192:195], v[112:115], v[96:99], v[192:195]
    v_mfma_f32_16x16x32_bf16 v[196:199], v[116:119], v[96:99], v[196:199]
    s_add_u32 m0, s21, 32768
    s_nop 0
    buffer_load_dwordx4 v1, s[4:7], s16 offen sc1 lds
    s_add_u32 s16, s16, s62
    v_mfma_f32_16x16x32_bf16 v[200:203], v[120:123], v[96:99], v[200:203]
    v_mfma_f32_16x16x32_bf16 v[204:207], v[124:127], v[96:99], v[204:207]
    v_mfma_f32_16x16x32_bf16 v[208:211], v[112:115], v[100:103], v[208:211]
    s_add_u32 m0, s21, 33792
    s_nop 0
    buffer_load_dwordx4 v1, s[4:7], s17 offen sc1 lds
    s_add_u32 s17, s17, s62
    v_mfma_f32_16x16x32_bf16 v[212:215], v[116:119], v[100:103], v[212:215]
    v_mfma_f32_16x16x32_bf16 v[216:219], v[120:123], v[100:103], v[216:219]
    v_mfma_f32_16x16x32_bf16 v[220:223], v[124:127], v[100:103], v[220:223]
    s_add_u32 m0, s22, 32768
    s_nop 0
    buffer_load_dwordx4 v2, s[8:11], s18 offen lds
    s_add_u32 s18, s18, s20
    v_mfma_f32_16x16x32_bf16 v[224:227], v[112:115], v[104:107], v[224:227]
    v_mfma_f32_16x16x32_bf16 v[228:231], v[116:119], v[104:107], v[228:231]
    v_mfma_f32_16x16x32_bf16 v[232:235], v[120:123], v[104:107], v[232:235]
    s_add_u32 m0, s22, 40960
    s_nop 0
    buffer_load_dwordx4 v2, s[12:15], s19 offen lds
    s_add_u32 s19, s19, s20
    v_mfma_f32_16x16x32_bf16 v[236:239], v[124:127], v[104:107], v[236:239]
    v_mfma_f32_16x16x32_bf16 v[240:243], v[112:115], v[108:111], v[240:243]
    v_mfma_f32_16x16x32_bf16 v[244:247], v[116:119], v[108:111], v[244:247]
    v_mfma_f32_16x16x32_bf16 v[248:251], v[120:123], v[108:111], v[248:251]
    v_mfma_f32_16x16x32_bf16 v[252:255], v[124:127], v[108:111], v[252:255]
    s_waitcnt lgkmcnt(0)
    s_waitcnt vmcnt(24)
    s_barrier
    v_mfma_f32_16x16x32_bf16 v[128:131], v[64:67], v[32:35], v[128:131]
    ds_read_b64_tr_b16 v[112:113], v12 offset:49152
    v_mfma_f32_16x16x32_bf16 v[132:135], v[68:71], v[32:35], v[132:135]
    ds_read_b64_tr_b16 v[114:115], v13 offset:49152
    v_mfma_f32_16x16x32_bf16 v[136:139], v[72:75], v[32:35], v[136:139]
    ds_read_b64_tr_b16 v[116:117], v14 offset:49152
    v_mfma_f32_16x16x32_bf16 v[140:143], v[76:79], v[32:35], v[140:143]
    ds_read_b64_tr_b16 v[118:119], v15 offset:49152
    v_mfma_f32_16x16x32_bf16 v[144:147], v[64:67], v[36:39], v[144:147]
    ds_read_b64_tr_b16 v[120:121], v12 offset:57344
    v_mfma_f32_16x16x32_bf16 v[148:151], v[68:71], v[36:39], v[148:151]
    ds_read_b64_tr_b16 v[122:123], v13 offset:57344
    v_mfma_f32_16x16x32_bf16 v[152:155], v[72:75], v[36:39], v[152:155]
    ds_read_b64_tr_b16 v[124:125], v14 offset:57344
    v_mfma_f32_16x16x32_bf16 v[156:159], v[76:79], v[36:39], v[156:159]
    ds_read_b64_tr_b16 v[126:127], v15 offset:57344
    v_mfma_f32_16x16x32_bf16 v[160:163], v[64:67], v[40:43], v[160:163]
    ds_read_b128 v[80:83], v6 offset:32768
    v_mfma_f32_16x16x32_bf16 v[164:167], v[68:71], v[40:43], v[164:167]
    ds_read_b128 v[84:87], v6 offset:33792
    v_mfma_f32_16x16x32_bf16 v[168:171], v[72:75], v[40:43], v[168:171]
    ds_read_b128 v[88:91], v6 offset:34816
    v_mfma_f32_16x16x32_bf16 v[172:175], v[76:79], v[40:43], v[172:175]
    ds_read_b128 v[92:95], v6 offset:35840
    v_mfma_f32_16x16x32_bf16 v[176:179], v[64:67], v[44:47], v[176:179]
    ds_read_b128 v[96:99], v6 offset:36864
    v_mfma_f32_16x16x32_bf16 v[180:183], v[68:71], v[44:47], v[180:183]
    ds_read_b128 v[100:103], v6 offset:37888
    v_mfma_f32_16x16x32_bf16 v[184:187], v[72:75], v[44:47], v[184:187]
    ds_read_b128 v[104:107], v6 offset:38912
    v_mfma_f32_16x16x32_bf16 v[188:191], v[76:79], v[44:47], v[188:191]
    ds_read_b128 v[108:111], v6 offset:39936
    v_mfma_f32_16x16x32_bf16 v[192:195], v[64:67], v[48:51], v[192:195]
    v_mfma_f32_16x16x32_bf16 v[196:199], v[68:71], v[48:51], v[196:199]
    s_add_u32 m0, s21, 65536
    s_nop 0
    buffer_load_dwordx4 v1, s[4:7], s16 offen sc1 lds
    s_add_u32 s16, s16, s62
    v_mfma_f32_16x16x32_bf16 v[200:203], v[72:75], v[48:51], v[200:203]
    v_mfma_f32_16x16x32_bf16 v[204:207], v[76:79], v[48:51], v[204:207]
    v_mfma_f32_16x16x32_bf16 v[208:211], v[64:67], v[52:55], v[208:211]
    s_add_u32 m0, s21, 66560
    s_nop 0
    buffer_load_dwordx4 v1, s[4:7], s17 offen sc1 lds
    s_add_u32 s17, s17, s62
    v_mfma_f32_16x16x32_bf16 v[212:215], v[68:71], v[52:55], v[212:215]
    v_mfma_f32_16x16x32_bf16 v[216:219], v[72:75], v[52:55], v[216:219]
    v_mfma_f32_16x16x32_bf16 v[220:223], v[76:79], v[52:55], v[220:223]
    s_add_u32 m0, s22, 65536
    s_nop 0
    buffer_load_dwordx4 v2, s[8:11], s18 offen lds
    s_add_u32 s18, s18, s20
    v_mfma_f32_16x16x32_bf16 v[224:227], v[64:67], v[56:59], v[224:227]
    v_mfma_f32_16x16x32_bf16 v[228:231], v[68:71], v[56:59], v[228:231]
    v_mfma_f32_16x16x32_bf16 v[232:235], v[72:75], v[56:59], v[232:235]
    s_add_u32 m0, s22, 73728
    s_nop 0
    buffer_load_dwordx4 v2, s[12:15], s19 offen lds
    s_add_u32 s19, s19, s20
    v_mfma_f32_16x16x32_bf16 v[236:239], v[76:79], v[56:59], v[236:239]
    v_mfma_f32_16x16x32_bf16 v[240:243], v[64:67], v[60:63], v[240:243]
    v_mfma_f32_16x16x32_bf16 v[244:247], v[68:71], v[60:63], v[244:247]
    v_mfma_f32_16x16x32_bf16 v[248:251], v[72:75], v[60:63], v[248:251]
    v_mfma_f32_16x16x32_bf16 v[252:255], v[76:79], v[60:63], v[252:255]
    s_waitcnt lgkmcnt(0)
    s_waitcnt vmcnt(8)
    s_barrier
    s_cmp_eq_u32 s28, 0
    s_cbranch_scc1 sig_4
    s_cmp_lg_u32 s3, 0
    s_cbranch_scc1 sig_4
    s_mov_b64 exec, 1
    v_mov_b32 v18, s57
    buffer_atomic_add v18, v17, s[4:7], s28 offen sc1
    s_mov_b64 exec, -1
sig_4:
    s_mov_b32 s28, 0
    v_mfma_f32_16x16x32_bf16 v[128:131], v[112:115], v[80:83], v[128:131]
    ds_read_b64_tr_b16 v[64:65], v8 offset:16384
    v_mfma_f32_16x16x32_bf16 v[132:135], v[116:119], v[80:83], v[132:135]
    ds_read_b64_tr_b16 v[66:67], v9 offset:16384
    v_mfma_f32_16x16x32_bf16 v[136:139], v[120:123], v[80:83], v[136:139]
    ds_read_b64_tr_b16 v[68:69], v10 offset:16384
    v_mfma_f32_16x16x32_bf16 v[140:143], v[124:127], v[80:83], v[140:143]
    ds_read_b64_tr_b16 v[70:71], v11 offset:16384
    v_mfma_f32_16x16x32_bf16 v[144:147], v[112:115], v[84:87], v[144:147]
    ds_read_b64_tr_b16 v[72:73], v8 offset:24576
    v_mfma_f32_16x16x32_bf16 v[148:151], v[116:119], v[84:87], v[148:151]
    ds_read_b64_tr_b16 v[74:75], v9 offset:24576
    v_mfma_f32_16x16x32_bf16 v[152:155], v[120:123], v[84:87], v[152:155]
    ds_read_b64_tr_b16 v[76:77], v10 offset:24576
    v_mfma_f32_16x16x32_bf16 v[156:159], v[124:127], v[84:87], v[156:159]
    ds_read_b64_tr_b16 v[78:79], v11 offset:24576
    v_mfma_f32_16x16x32_bf16 v[160:163], v[112:115], v[88:91], v[160:163]
    ds_read_b128 v[32:35], v5 offset:0
    v_mfma_f32_16x16x32_bf16 v[164:167], v[116:119], v[88:91], v[164:167]
    ds_read_b128 v[36:39], v5 offset:1024
    v_mfma_f32_16x16x32_bf16 v[168:171], v[120:123], v[88:91], v[168:171]
    ds_read_b128 v[40:43], v5 offset:2048
    v_mfma_f32_16x16x32_bf16 v[172:175], v[124:127], v[88:91], v[172:175]
    ds_read_b128 v[44:47], v5 offset:3072
    v_mfma_f32_16x16x32_bf16 v[176:179], v[112:115], v[92:95], v[176:179]
    ds_read_b128 v[48:51], v5 offset:4096
    v_mfma_f32_16x16x32_bf16 v[180:183], v[116:119], v[92:95], v[180:183]
    ds_read_b128 v[52:55], v5 offset:5120
    v_mfma_f32_16x16x32_bf16 v[184:187], v[120:123], v[92:95], v[184:187]
    ds_read_b128 v[56:59], v5 offset:6144
    v_mfma_f32_16x16x32_bf16 v[188:191], v[124:127], v[92:95], v[188:191]
    ds_read_b128 v[60:63], v5 offset:7168
    v_mfma_f32_16x16x32_bf16 v[192:195], v[112:115], v[96:99], v[192:195]
    v_mfma_f32_16x16x32_bf16 v[196:199], v[116:119], v[96:99], v[196:199]
    s_add_u32 m0, s21, 98304
    s_nop 0
    buffer_load_dwordx4 v1, s[4:7], s16 offen sc1 lds
    s_add_u32 s16, s16, s62
    v_mfma_f32_16x16x32_bf16 v[200:203], v[120:123], v[96:99], v[200:203]
    v_mfma_f32_16x16x32_bf16 v[204:207], v[124:127], v[96:99], v[204:207]
    v_mfma_f32_16x16x32_bf16 v[208:211], v[112:115], v[100:103], v[208:211]
    s_add_u32 m0, s21, 99328
    s_nop 0
    buffer_load_dwordx4 v1, s[4:7], s17 offen sc1 lds
    s_add_u32 s17, s17, s62
    v_mfma_f32_16x16x32_bf16 v[212:215], v[116:119], v[100:103], v[212:215]
    v_mfma_f32_16x16x32_bf16 v[216:219], v[120:123], v[100:103], v[216:219]
    v_mfma_f32_16x16x32_bf16 v[220:223], v[124:127], v[100:103], v[220:223]
    s_add_u32 m0, s22, 98304
    s_nop 0
    buffer_load_dwordx4 v2, s[8:11], s18 offen lds
    s_add_u32 s18, s18, s20
    v_mfma_f32_16x16x32_bf16 v[224:227], v[112:115], v[104:107], v[224:227]
    v_mfma_f32_16x16x32_bf16 v[228:231], v[116:119], v[104:107], v[228:231]
    v_mfma_f32_16x16x32_bf16 v[232:235], v[120:123], v[104:107], v[232:235]
    s_add_u32 m0, s22, 106496
    s_nop 0
    buffer_load_dwordx4 v2, s[12:15], s19 offen lds
    s_add_u32 s19, s19, s20
    v_mfma_f32_16x16x32_bf16 v[236:239], v[124:127], v[104:107], v[236:239]
    v_mfma_f32_16x16x32_bf16 v[240:243], v[112:115], v[108:111], v[240:243]
    v_mfma_f32_16x16x32_bf16 v[244:247], v[116:119], v[108:111], v[244:247]
    v_mfma_f32_16x16x32_bf16 v[248:251], v[120:123], v[108:111], v[248:251]
    v_mfma_f32_16x16x32_bf16 v[252:255], v[124:127], v[108:111], v[252:255]
    s_waitcnt lgkmcnt(0)
w_loop_chk:
    s_sub_u32 s23, s23, 1
w_loop:
    s_cmp_lg_u32 s23, 1
    s_cbranch_scc1 w_body
    v_readfirstlane_b32 s30, v16
    s_cmp_ge_u32 s30, s45
    s_cselect_b32 s30, 0, 1
    s_or_b32 s30, s30, s70
    s_cmp_ge_u32 s32, 4
    s_cselect_b32 s30, 1, s30
    s_cmp_eq_u32 s32, 0
    s_cselect_b32 s30, 1, s30
    v_mov_b32 v20, s30
    ds_write_b32 v7, v20
    s_cbranch_scc1 w_nd
    s_cmp_ge_u32 s32, 4
    s_cbranch_scc1 w_nd
    s_cmp_lg_u32 s70, 0
    s_cbranch_scc1 w_nd
    s_load_dwordx2 s[8:9], s[0:1], s33
    s_load_dwordx2 s[12:13], s[0:1], s34
    s_mov_b32 s10, s38
    s_mov_b32 s14, s38
    s_cmp_ge_u32 s32, 4
    s_cselect_b32 s31, 0, 1
    s_lshl_b32 s30, s3, s31
    s_mul_i32 s30, s30, s40
    s_add_u32 s16, s39, s30
    s_cmp_eq_u32 s32, 4
    s_cselect_b32 s30, 1024, s40
    s_cselect_b32 s31, 6, 5
    s_lshl_b32 s62, 32, s31
    s_add_u32 s17, s16, s30
    s_lshl_b32 s30, s3, 2
    s_mul_i32 s30, s30, s35
    s_add_u32 s18, s36, s30
    s_add_u32 s19, s37, s30
    s_lshl_b32 s20, s35, s31
    v_mul_u32_u24 v2, s35, v4
    v_add_u32 v2, v2, v3
    s_waitcnt lgkmcnt(0)
w_body:
    s_waitcnt vmcnt(8)
    s_barrier
    v_mfma_f32_16x16x32_bf16 v[128:131], v[64:67], v[32:35], v[128:131]
    ds_read_b64_tr_b16 v[112:113], v8 offset:49152
    v_mfma_f32_16x16x32_bf16 v[132:135], v[68:71], v[32:35], v[132:135]
    ds_read_b64_tr_b16 v[114:115], v9 offset:49152
    v_mfma_f32_16x16x32_bf16 v[136:139], v[72:75], v[32:35], v[136:139]
    ds_read_b64_tr_b16 v[116:117], v10 offset:49152
    v_mfma_f32_16x16x32_bf16 v[140:143], v[76:79], v[32:35], v[140:143]
    ds_read_b64_tr_b16 v[118:119], v11 offset:49152
    v_mfma_f32_16x16x32_bf16 v[144:147], v[64:67], v[36:39], v[144:147]
    ds_read_b64_tr_b16 v[120:121], v8 offset:57344
    v_mfma_f32_16x16x32_bf16 v[148:151], v[68:71], v[36:39], v[148:151]
    ds_read_b64_tr_b16 v[122:123], v9 offset:57344
    v_mfma_f32_16x16x32_bf16 v[152:155], v[72:75], v[36:39], v[152:155]
    ds_read_b64_tr_b16 v[124:125], v10 offset:57344
    v_mfma_f32_16x16x32_bf16 v[156:159], v[76:79], v[36:39], v[156:159]
    ds_read_b64_tr_b16 v[126:127], v11 offset:57344
    v_mfma_f32_16x16x32_bf16 v[160:163], v[64:67], v[40:43], v[160:163]
    ds_read_b128 v[80:83], v5 offset:32768
    v_mfma_f32_16x16x32_bf16 v[164:167], v[68:71], v[40:43], v[164:167]
    ds_read_b128 v[84:87], v5 offset:33792
    v_mfma_f32_16x16x32_bf16 v[168:171], v[72:75], v[40:43], v[168:171]
    ds_read_b128 v[88:91], v5 offset:34816
    v_mfma_f32_16x16x32_bf16 v[172:175], v[76:79], v[40:43], v[172:175]
    ds_read_b128 v[92:95], v5 offset:35840
    v_mfma_f32_16x16x32_bf16 v[176:179], v[64:67], v[44:47], v[176:179]
    ds_read_b128 v[96:99], v5 offset:36864
    v_mfma_f32_16x16x32_bf16 v[180:183], v[68:71], v[44:47], v[180:183]
    ds_read_b128 v[100:103], v5 offset:37888
    v_mfma_f32_16x16x32_bf16 v[184:187], v[72:75], v[44:47], v[184:187]
    ds_read_b128 v[104:107], v5 offset:38912
    v_mfma_f32_16x16x32_bf16 v[188:191], v[76:79], v[44:47], v[188:191]
    ds_read_b128 v[108:111], v5 offset:39936
    v_mfma_f32_16x16x32_bf16 v[192:195], v[64:67], v[48:51], v[192:195]
    v_mfma_f32_16x16x32_bf16 v[196:199], v[68:71], v[48:51], v[196:199]
    s_add_u32 m0, s21, 0
    s_nop 0
    buffer_load_dwordx4 v1, s[4:7], s16 offen sc1 lds
    s_add_u32 s16, s16, s62
    v_mfma_f32_16x16x32_bf16 v[200:203], v[72:75], v[48:51], v[200:203]
    v_mfma_f32_16x16x32_bf16 v[204:207], v[76:79], v[48:51], v[204:207]
    v_mfma_f32_16x16x32_bf16 v[208:211], v[64:67], v[52:55], v[208:211]
    s_add_u32 m0, s21, 1024
    s_nop 0
    buffer_load_dwordx4 v1, s[4:7], s17 offen sc1 lds
    s_add_u32 s17, s17, s62
    v_mfma_f32_16x16x32_bf16 v[212:215], v[68:71], v[52:55], v[212:215]
    v_mfma_f32_16x16x32_bf16 v[216:219], v[72:75], v[52:55], v[216:219]
    v_mfma_f32_16x16x32_bf16 v[220:223], v[76:79], v[52:55], v[220:223]
    s_add_u32 m0, s22, 0
    s_nop 0
    buffer_load_dwordx4 v2, s[8:11], s18 offen lds
    s_add_u32 s18, s18, s20
    v_mfma_f32_16x16x32_bf16 v[224:227], v[64:67], v[56:59], v[224:227]
    v_mfma_f32_16x16x32_bf16 v[228:231], v[68:71], v[56:59], v[228:231]
    v_mfma_f32_16x16x32_bf16 v[232:235], v[72:75], v[56:59], v[232:235]
    s_add_u32 m0, s22, 8192
    s_nop 0
    buffer_load_dwordx4 v2, s[12:15], s19 offen lds
    s_add_u32 s19, s19, s20
    v_mfma_f32_16x16x32_bf16 v[236:239], v[76:79], v[56:59], v[236:239]
    v_mfma_f32_16x16x32_bf16 v[240:243], v[64:67], v[60:63], v[240:243]
    v_mfma_f32_16x16x32_bf16 v[244:247], v[68:71], v[60:63], v[244:247]
    buffer_load_dword v16, v17, s[4:7], s44 offen sc1
    v_mfma_f32_16x16x32_bf16 v[248:251], v[72:75], v[60:63], v[248:251]
    v_mfma_f32_16x16x32_bf16 v[252:255], v[76:79], v[60:63], v[252:255]
    s_waitcnt lgkmcnt(0)
    s_waitcnt vmcnt(8)
    s_barrier
    v_mfma_f32_16x16x32_bf16 v[128:131], v[112:115], v[80:83], v[128:131]
    ds_read_b64_tr_b16 v[64:65], v12 offset:16384
    v_mfma_f32_16x16x32_bf16 v[132:135], v[116:119], v[80:83], v[132:135]
    ds_read_b64_tr_b16 v[66:67], v13 offset:16384
    v_mfma_f32_16x16x32_bf16 v[136:139], v[120:123], v[80:83], v[136:139]
    ds_read_b64_tr_b16 v[68:69], v14 offset:16384
    v_mfma_f32_16x16x32_bf16 v[140:143], v[124:127], v[80:83], v[140:143]
    ds_read_b64_tr_b16 v[70:71], v15 offset:16384
    v_mfma_f32_16x16x32_bf16 v[144:147], v[112:115], v[84:87], v[144:147]
    ds_read_b64_tr_b16 v[72:73], v12 offset:24576
    v_mfma_f32_16x16x32_bf16 v[148:151], v[116:119], v[84:87], v[148:151]
    ds_read_b64_tr_b16 v[74:75], v13 offset:24576
    v_mfma_f32_16x16x32_bf16 v[152:155], v[120:123], v[84:87], v[152:155]
    ds_read_b64_tr_b16 v[76:77], v14 offset:24576
    v_mfma_f32_16x16x32_bf16 v[156:159], v[124:127], v[84:87], v[156:159]
    ds_read_b64_tr_b16 v[78:79], v15 offset:24576
    v_mfma_f32_16x16x32_bf16 v[160:163], v[112:115], v[88:91], v[160:163]
    ds_read_b128 v[32:35], v6 offset:0
    v_mfma_f32_16x16x32_bf16 v[164:167], v[116:119], v[88:91], v[164:167]
    ds_read_b128 v[36:39], v6 offset:1024
    v_mfma_f32_16x16x32_bf16 v[168:171], v[120:123], v[88:91], v[168:171]
    ds_read_b128 v[40:43], v6 offset:2048
    v_mfma_f32_16x16x32_bf16 v[172:175], v[124:127], v[88:91], v[172:175]
    ds_read_b128 v[44:47], v6 offset:3072
    v_mfma_f32_16x16x32_bf16 v[176:179], v[112:115], v[92:95], v[176:179]
    ds_read_b128 v[48:51], v6 offset:4096
    v_mfma_f32_16x16x32_bf16 v[180:183], v[116:119], v[92:95], v[180:183]
    ds_read_b128 v[52:55], v6 offset:5120
    v_mfma_f32_16x16x32_bf16 v[184:187], v[120:123], v[92:95], v[184:187]
    ds_read_b128 v[56:59], v6 offset:6144
    v_mfma_f32_16x16x32_bf16 v[188:191], v[124:127], v[92:95], v[188:191]
    ds_read_b128 v[60:63], v6 offset:7168
    v_mfma_f32_16x16x32_bf16 v[192:195], v[112:115], v[96:99], v[192:195]
    v_mfma_f32_16x16x32_bf16 v[196:199], v[116:119], v[96:99], v[196:199]
    s_add_u32 m0, s21, 32768
    s_nop 0
    buffer_load_dwordx4 v1, s[4:7], s16 offen sc1 lds
    s_add_u32 s16, s16, s62
    v_mfma_f32_16x16x32_bf16 v[200:203], v[120:123], v[96:99], v[200:203]
    v_mfma_f32_16x16x32_bf16 v[204:207], v[124:127], v[96:99], v[204:207]
    v_mfma_f32_16x16x32_bf16 v[208:211], v[112:115], v[100:103], v[208:211]
    s_add_u32 m0, s21, 33792
    s_nop 0
    buffer_load_dwordx4 v1, s[4:7], s17 offen sc1 lds
    s_add_u32 s17, s17, s62
    v_mfma_f32_16x16x32_bf16 v[212:215], v[116:119], v[100:103], v[212:215]
    v_mfma_f32_16x16x32_bf16 v[216:219], v[120:123], v[100:103], v[216:219]
    v_mfma_f32_16x16x32_bf16 v[220:223], v[124:127], v[100:103], v[220:223]
    s_add_u32 m0, s22, 32768
    s_nop 0
    buffer_load_dwordx4 v2, s[8:11], s18 offen lds
    s_add_u32 s18, s18, s20
    v_mfma_f32_16x16x32_bf16 v[224:227], v[112:115], v[104:107], v[224:227]
    v_mfma_f32_16x16x32_bf16 v[228:231], v[116:119], v[104:107], v[228:231]
    v_mfma_f32_16x16x32_bf16 v[232:235], v[120:123], v[104:107], v[232:235]
    s_add_u32 m0, s22, 40960
    s_nop 0
    buffer_load_dwordx4 v2, s[12:15], s19 offen lds
    s_add_u32 s19, s19, s20
    v_mfma_f32_16x16x32_bf16 v[236:239], v[124:127], v[104:107], v[236:239]
    v_mfma_f32_16x16x32_bf16 v[240:243], v[112:115], v[108:111], v[240:243]
    v_mfma_f32_16x16x32_bf16 v[244:247], v[116:119], v[108:111], v[244:247]
    v_mfma_f32_16x16x32_bf16 v[248:251], v[120:123], v[108:111], v[248:251]
    v_mfma_f32_16x16x32_bf16 v[252:255], v[124:127], v[108:111], v[252:255]
    s_waitcnt lgkmcnt(0)
    s_waitcnt vmcnt(8)
    s_barrier
    v_mfma_f32_16x16x32_bf16 v[128:131], v[64:67], v[32:35], v[128:131]
    ds_read_b64_tr_b16 v[112:113], v12 offset:49152
    v_mfma_f32_16x16x32_bf16 v[132:135], v[68:71], v[32:35], v[132:135]
    ds_read_b64_tr_b16 v[114:115], v13 offset:49152
    v_mfma_f32_16x16x32_bf16 v[136:139], v[72:75], v[32:35], v[136:139]
    ds_read_b64_tr_b16 v[116:117], v14 offset:49152
    v_mfma_f32_16x16x32_bf16 v[140:143], v[76:79], v[32:35], v[140:143]
    ds_read_b64_tr_b16 v[118:119], v15 offset:49152
    v_mfma_f32_16x16x32_bf16 v[144:147], v[64:67], v[36:39], v[144:147]
    ds_read_b64_tr_b16 v[120:121], v12 offset:57344
    v_mfma_f32_16x16x32_bf16 v[148:151], v[68:71], v[36:39], v[148:151]
    ds_read_b64_tr_b16 v[122:123], v13 offset:57344
    v_mfma_f32_16x16x32_bf16 v[152:155], v[72:75], v[36:39], v[152:155]
    ds_read_b64_tr_b16 v[124:125], v14 offset:57344
    v_mfma_f32_16x16x32_bf16 v[156:159], v[76:79], v[36:39], v[156:159]
    ds_read_b64_tr_b16 v[126:127], v15 offset:57344
    v_mfma_f32_16x16x32_bf16 v[160:163], v[64:67], v[40:43], v[160:163]
    ds_read_b128 v[80:83], v6 offset:32768
    v_mfma_f32_16x16x32_bf16 v[164:167], v[68:71], v[40:43], v[164:167]
    ds_read_b128 v[84:87], v6 offset:33792
    v_mfma_f32_16x16x32_bf16 v[168:171], v[72:75], v[40:43], v[168:171]
    ds_read_b128 v[88:91], v6 offset:34816
    v_mfma_f32_16x16x32_bf16 v[172:175], v[76:79], v[40:43], v[172:175]
    ds_read_b128 v[92:95], v6 offset:35840
    v_mfma_f32_16x16x32_bf16 v[176:179], v[64:67], v[44:47], v[176:179]
    ds_read_b128 v[96:99], v6 offset:36864
    v_mfma_f32_16x16x32_bf16 v[180:183], v[68:71], v[44:47], v[180:183]
    ds_read_b128 v[100:103], v6 offset:37888
    v_mfma_f32_16x16x32_bf16 v[184:187], v[72:75], v[44:47], v[184:187]
    ds_read_b128 v[104:107], v6 offset:38912
    v_mfma_f32_16x16x32_bf16 v[188:191], v[76:79], v[44:47], v[188:191]
    ds_read_b128 v[108:111], v6 offset:39936
    v_mfma_f32_16x16x32_bf16 v[192:195], v[64:67], v[48:51], v[192:195]
    v_mfma_f32_16x16x32_bf16 v[196:199], v[68:71], v[48:51], v[196:199]
    s_add_u32 m0, s21, 65536
    s_nop 0
    buffer_load_dwordx4 v1, s[4:7], s16 offen sc1 lds
    s_add_u32 s16, s16, s62
    v_mfma_f32_16x16x32_bf16 v[200:203], v[72:75], v[48:51], v[200:203]
    v_mfma_f32_16x16x32_bf16 v[204:207], v[76:79], v[48:51], v[204:207]
    v_mfma_f32_16x16x32_bf16 v[208:211], v[64:67], v[52:55], v[208:211]
    s_add_u32 m0, s21, 66560
    s_nop 0
    buffer_load_dwordx4 v1, s[4:7], s17 offen sc1 lds
    s_add_u32 s17, s17, s62
    v_mfma_f32_16x16x32_bf16 v[212:215], v[68:71], v[52:55], v[212:215]
    v_mfma_f32_16x16x32_bf16 v[216:219], v[72:75], v[52:55], v[216:219]
    v_mfma_f32_16x16x32_bf16 v[220:223], v[76:79], v[52:55], v[220:223]
    s_add_u32 m0, s22, 65536
    s_nop 0
    buffer_load_dwordx4 v2, s[8:11], s18 offen lds
    s_add_u32 s18, s18, s20
    v_mfma_f32_16x16x32_bf16 v[224:227], v[64:67], v[56:59], v[224:227]
    v_mfma_f32_16x16x32_bf16 v[228:231], v[68:71], v[56:59], v[228:231]
    v_mfma_f32_16x16x32_bf16 v[232:235], v[72:75], v[56:59], v[232:235]
    s_add_u32 m0, s22, 73728
    s_nop 0
    buffer_load_dwordx4 v2, s[12:15], s19 offen lds
    s_add_u32 s19, s19, s20
    v_mfma_f32_16x16x32_bf16 v[236:239], v[76:79], v[56:59], v[236:239]
    v_mfma_f32_16x16x32_bf16 v[240:243], v[64:67], v[60:63], v[240:243]
    v_mfma_f32_16x16x32_bf16 v[244:247], v[68:71], v[60:63], v[244:247]
    v_mfma_f32_16x16x32_bf16 v[248:251], v[72:75], v[60:63], v[248:251]
    v_mfma_f32_16x16x32_bf16 v[252:255], v[76:79], v[60:63], v[252:255]
    s_waitcnt lgkmcnt(0)
    s_waitcnt vmcnt(8)
    s_barrier
    v_mfma_f32_16x16x32_bf16 v[128:131], v[112:115], v[80:83], v[128:131]
    ds_read_b64_tr_b16 v[64:65], v8 offset:16384
    v_mfma_f32_16x16x32_bf16 v[132:135], v[116:119], v[80:83], v[132:135]
    ds_read_b64_tr_b16 v[66:67], v9 offset:16384
    v_mfma_f32_16x16x32_bf16 v[136:139], v[120:123], v[80:83], v[136:139]
    ds_read_b64_tr_b16 v[68:69], v10 offset:16384
    v_mfma_f32_16x16x32_bf16 v[140:143], v[124:127], v[80:83], v[140:143]
    ds_read_b64_tr_b16 v[70:71], v11 offset:16384
    v_mfma_f32_16x16x32_bf16 v[144:147], v[112:115], v[84:87], v[144:147]
    ds_read_b64_tr_b16 v[72:73], v8 offset:24576
    v_mfma_f32_16x16x32_bf16 v[148:151], v[116:119], v[84:87], v[148:151]
    ds_read_b64_tr_b16 v[74:75], v9 offset:24576
    v_mfma_f32_16x16x32_bf16 v[152:155], v[120:123], v[84:87], v[152:155]
    ds_read_b64_tr_b16 v[76:77], v10 offset:24576
    v_mfma_f32_16x16x32_bf16 v[156:159], v[124:127], v[84:87], v[156:159]
    ds_read_b64_tr_b16 v[78:79], v11 offset:24576
    v_mfma_f32_16x16x32_bf16 v[160:163], v[112:115], v[88:91], v[160:163]
    ds_read_b128 v[32:35], v5 offset:0
    v_mfma_f32_16x16x32_bf16 v[164:167], v[116:119], v[88:91], v[164:167]
    ds_read_b128 v[36:39], v5 offset:1024
    v_mfma_f32_16x16x32_bf16 v[168:171], v[120:123], v[88:91], v[168:171]
    ds_read_b128 v[40:43], v5 offset:2048
    v_mfma_f32_16x16x32_bf16 v[172:175], v[124:127], v[88:91], v[172:175]
    ds_read_b128 v[44:47], v5 offset:3072
    v_mfma_f32_16x16x32_bf16 v[176:179], v[112:115], v[92:95], v[176:179]
    ds_read_b128 v[48:51], v5 offset:4096
    v_mfma_f32_16x16x32_bf16 v[180:183], v[116:119], v[92:95], v[180:183]
    ds_read_b128 v[52:55], v5 offset:5120
    v_mfma_f32_16x16x32_bf16 v[184:187], v[120:123], v[92:95], v[184:187]
    ds_read_b128 v[56:59], v5 offset:6144
    v_mfma_f32_16x16x32_bf16 v[188:191], v[124:127], v[92:95], v[188:191]
    ds_read_b128 v[60:63], v5 offset:7168
    v_mfma_f32_16x16x32_bf16 v[192:195], v[112:115], v[96:99], v[192:195]
    v_mfma_f32_16x16x32_bf16 v[196:199], v[116:119], v[96:99], v[196:199]
    s_add_u32 m0, s21, 98304
    s_nop 0
    buffer_load_dwordx4 v1, s[4:7], s16 offen sc1 lds
    s_add_u32 s16, s16, s62
    v_mfma_f32_16x16x32_bf16 v[200:203], v[120:123], v[96:99], v[200:203]
    v_mfma_f32_16x16x32_bf16 v[204:207], v[124:127], v[96:99], v[204:207]
    v_mfma_f32_16x16x32_bf16 v[208:211], v[112:115], v[100:103], v[208:211]
    s_add_u32 m0, s21, 99328
    s_nop 0
    buffer_load_dwordx4 v1, s[4:7], s17 offen sc1 lds
    s_add_u32 s17, s17, s62
    v_mfma_f32_16x16x32_bf16 v[212:215], v[116:119], v[100:103], v[212:215]
    v_mfma_f32_16x16x32_bf16 v[216:219], v[120:123], v[100:103], v[216:219]
    v_mfma_f32_16x16x32_bf16 v[220:223], v[124:127], v[100:103], v[220:223]
    s_add_u32 m0, s22, 98304
    s_nop 0
    buffer_load_dwordx4 v2, s[8:11], s18 offen lds
    s_add_u32 s18, s18, s20
    v_mfma_f32_16x16x32_bf16 v[224:227], v[112:115], v[104:107], v[224:227]
    v_mfma_f32_16x16x32_bf16 v[228:231], v[116:119], v[104:107], v[228:231]
    v_mfma_f32_16x16x32_bf16 v[232:235], v[120:123], v[104:107], v[232:235]
    s_add_u32 m0, s22, 106496
    s_nop 0
    buffer_load_dwordx4 v2, s[12:15], s19 offen lds
    s_add_u32 s19, s19, s20
    v_mfma_f32_16x16x32_bf16 v[236:239], v[124:127], v[104:107], v[236:239]
    v_mfma_f32_16x16x32_bf16 v[240:243], v[112:115], v[108:111], v[240:243]
    v_mfma_f32_16x16x32_bf16 v[244:247], v[116:119], v[108:111], v[244:247]
    v_mfma_f32_16x16x32_bf16 v[248:251], v[120:123], v[108:111], v[248:251]
    v_mfma_f32_16x16x32_bf16 v[252:255], v[124:127], v[108:111], v[252:255]
    s_waitcnt lgkmcnt(0)
    s_sub_u32 s23, s23, 1
    s_cmp_lg_u32 s23, 0
    s_cbranch_scc1 w_loop
    s_branch w_end
w_nd:
    s_waitcnt vmcnt(8)
    s_barrier
    v_mfma_f32_16x16x32_bf16 v[128:131], v[64:67], v[32:35], v[128:131]
    ds_read_b64_tr_b16 v[112:113], v8 offset:49152
    v_mfma_f32_16x16x32_bf16 v[132:135], v[68:71], v[32:35], v[132:135]
    ds_read_b64_tr_b16 v[114:115], v9 offset:49152
    v_mfma_f32_16x16x32_bf16 v[136:139], v[72:75], v[32:35], v[136:139]
    ds_read_b64_tr_b16 v[116:117], v10 offset:49152
    v_mfma_f32_16x16x32_bf16 v[140:143], v[76:79], v[32:35], v[140:143]
    ds_read_b64_tr_b16 v[118:119], v11 offset:49152
    v_mfma_f32_16x16x32_bf16 v[144:147], v[64:67], v[36:39], v[144:147]
    ds_read_b64_tr_b16 v[120:121], v8 offset:57344
    v_mfma_f32_16x16x32_bf16 v[148:151], v[68:71], v[36:39], v[148:151]
    ds_read_b64_tr_b16 v[122:123], v9 offset:57344
    v_mfma_f32_16x16x32_bf16 v[152:155], v[72:75], v[36:39], v[152:155]
    ds_read_b64_tr_b16 v[124:125], v10 offset:57344
    v_mfma_f32_16x16x32_bf16 v[156:159], v[76:79], v[36:39], v[156:159]
    ds_read_b64_tr_b16 v[126:127], v11 offset:57344
    v_mfma_f32_16x16x32_bf16 v[160:163], v[64:67], v[40:43], v[160:163]
    ds_read_b128 v[80:83], v5 offset:32768
    v_mfma_f32_16x16x32_bf16 v[164:167], v[68:71], v[40:43], v[164:167]
    ds_read_b128 v[84:87], v5 offset:33792
    v_mfma_f32_16x16x32_bf16 v[168:171], v[72:75], v[40:43], v[168:171]
    ds_read_b128 v[88:91], v5 offset:34816
    v_mfma_f32_16x16x32_bf16 v[172:175], v[76:79], v[40:43], v[172:175]
    ds_read_b128 v[92:95], v5 offset:35840
    v_mfma_f32_16x16x32_bf16 v[176:179], v[64:67], v[44:47], v[176:179]
    ds_read_b128 v[96:99], v5 offset:36864
    v_mfma_f32_16x16x32_bf16 v[180:183], v[68:71], v[44:47], v[180:183]
    ds_read_b128 v[100:103], v5 offset:37888
    v_mfma_f32_16x16x32_bf16 v[184:187], v[72:75], v[44:47], v[184:187]
    ds_read_b128 v[104:107], v5 offset:38912
    v_mfma_f32_16x16x32_bf16 v[188:191], v[76:79], v[44:47], v[188:191]
    ds_read_b128 v[108:111], v5 offset:39936
    v_mfma_f32_16x16x32_bf16 v[192:195], v[64:67], v[48:51], v[192:195]
    v_mfma_f32_16x16x32_bf16 v[196:199], v[68:71], v[48:51], v[196:199]
    v_mfma_f32_16x16x32_bf16 v[200:203], v[72:75], v[48:51], v[200:203]
    v_mfma_f32_16x16x32_bf16 v[204:207], v[76:79], v[48:51], v[204:207]
    v_mfma_f32_16x16x32_bf16 v[208:211], v[64:67], v[52:55], v[208:211]
    v_mfma_f32_16x16x32_bf16 v[212:215], v[68:71], v[52:55], v[212:215]
    v_mfma_f32_16x16x32_bf16 v[216:219], v[72:75], v[52:55], v[216:219]
    v_mfma_f32_16x16x32_bf16 v[220:223], v[76:79], v[52:55], v[220:223]
    v_mfma_f32_16x16x32_bf16 v[224:227], v[64:67], v[56:59], v[224:227]
    v_mfma_f32_16x16x32_bf16 v[228:231], v[68:71], v[56:59], v[228:231]
    v_mfma_f32_16x16x32_bf16 v[232:235], v[72:75], v[56:59], v[232:235]
    v_mfma_f32_16x16x32_bf16 v[236:239], v[76:79], v[56:59], v[236:239]
    v_mfma_f32_16x16x32_bf16 v[240:243], v[64:67], v[60:63], v[240:243]
    v_mfma_f32_16x16x32_bf16 v[244:247], v[68:71], v[60:63], v[244:247]
    v_mfma_f32_16x16x32_bf16 v[248:251], v[72:75], v[60:63], v[248:251]
    v_mfma_f32_16x16x32_bf16 v[252:255], v[76:79], v[60:63], v[252:255]
    s_waitcnt lgkmcnt(0)
    s_waitcnt vmcnt(4)
    s_barrier
    v_mfma_f32_16x16x32_bf16 v[128:131], v[112:115], v[80:83], v[128:131]
    ds_read_b64_tr_b16 v[64:65], v12 offset:16384
    v_mfma_f32_16x16x32_bf16 v[132:135], v[116:119], v[80:83], v[132:135]
    ds_read_b64_tr_b16 v[66:67], v13 offset:16384
    v_mfma_f32_16x16x32_bf16 v[136:139], v[120:123], v[80:83], v[136:139]
    ds_read_b64_tr_b16 v[68:69], v14 offset:16384
    v_mfma_f32_16x16x32_bf16 v[140:143], v[124:127], v[80:83], v[140:143]
    ds_read_b64_tr_b16 v[70:71], v15 offset:16384
    v_mfma_f32_16x16x32_bf16 v[144:147], v[112:115], v[84:87], v[144:147]
    ds_read_b64_tr_b16 v[72:73], v12 offset:24576
    v_mfma_f32_16x16x32_bf16 v[148:151], v[116:119], v[84:87], v[148:151]
    ds_read_b64_tr_b16 v[74:75], v13 offset:24576
    v_mfma_f32_16x16x32_bf16 v[152:155], v[120:123], v[84:87], v[152:155]
    ds_read_b64_tr_b16 v[76:77], v14 offset:24576
    v_mfma_f32_16x16x32_bf16 v[156:159], v[124:127], v[84:87], v[156:159]
    ds_read_b64_tr_b16 v[78:79], v15 offset:24576
    v_mfma_f32_16x16x32_bf16 v[160:163], v[112:115], v[88:91], v[160:163]
    ds_read_b128 v[32:35], v6 offset:0
    v_mfma_f32_16x16x32_bf16 v[164:167], v[116:119], v[88:91], v[164:167]
    ds_read_b128 v[36:39], v6 offset:1024
    v_mfma_f32_16x16x32_bf16 v[168:171], v[120:123], v[88:91], v[168:171]
    ds_read_b128 v[40:43], v6 offset:2048
    v_mfma_f32_16x16x32_bf16 v[172:175], v[124:127], v[88:91], v[172:175]
    ds_read_b128 v[44:47], v6 offset:3072
    v_mfma_f32_16x16x32_bf16 v[176:179], v[112:115], v[92:95], v[176:179]
    ds_read_b128 v[48:51], v6 offset:4096
    v_mfma_f32_16x16x32_bf16 v[180:183], v[116:119], v[92:95], v[180:183]
    ds_read_b128 v[52:55], v6 offset:5120
    v_mfma_f32_16x16x32_bf16 v[184:187], v[120:123], v[92:95], v[184:187]
    ds_read_b128 v[56:59], v6 offset:6144
    v_mfma_f32_16x16x32_bf16 v[188:191], v[124:127], v[92:95], v[188:191]
    ds_read_b128 v[60:63], v6 offset:7168
    v_mfma_f32_16x16x32_bf16 v[192:195], v[112:115], v[96:99], v[192:195]
    v_mfma_f32_16x16x32_bf16 v[196:199], v[116:119], v[96:99], v[196:199]
    v_mfma_f32_16x16x32_bf16 v[200:203], v[120:123], v[96:99], v[200:203]
    v_mfma_f32_16x16x32_bf16 v[204:207], v[124:127], v[96:99], v[204:207]
    v_mfma_f32_16x16x32_bf16 v[208:211], v[112:115], v[100:103], v[208:211]
    v_mfma_f32_16x16x32_bf16 v[212:215], v[116:119], v[100:103], v[212:215]
    v_mfma_f32_16x16x32_bf16 v[216:219], v[120:123], v[100:103], v[216:219]
    v_mfma_f32_16x16x32_bf16 v[220:223], v[124:127], v[100:103], v[220:223]
    v_mfma_f32_16x16x32_bf16 v[224:227], v[112:115], v[104:107], v[224:227]
    v_mfma_f32_16x16x32_bf16 v[228:231], v[116:119], v[104:107], v[228:231]
    v_mfma_f32_16x16x32_bf16 v[232:235], v[120:123], v[104:107], v[232:235]
    v_mfma_f32_16x16x32_bf16 v[236:239], v[124:127], v[104:107], v[236:239]
    v_mfma_f32_16x16x32_bf16 v[240:243], v[112:115], v[108:111], v[240:243]
    v_mfma_f32_16x16x32_bf16 v[244:247], v[116:119], v[108:111], v[244:247]
    v_mfma_f32_16x16x32_bf16 v[248:251], v[120:123], v[108:111], v[248:251]
    v_mfma_f32_16x16x32_bf16 v[252:255], v[124:127], v[108:111], v[252:255]
    s_waitcnt lgkmcnt(0)
    s_waitcnt vmcnt(0)
    s_barrier
    v_mfma_f32_16x16x32_bf16 v[128:131], v[64:67], v[32:35], v[128:131]
    ds_read_b64_tr_b16 v[112:113], v12 offset:49152
    v_mfma_f32_16x16x32_bf16 v[132:135], v[68:71], v[32:35], v[132:135]
    ds_read_b64_tr_b16 v[114:115], v13 offset:49152
    v_mfma_f32_16x16x32_bf16 v[136:139], v[72:75], v[32:35], v[136:139]
    ds_read_b64_tr_b16 v[116:117], v14 offset:49152
    v_mfma_f32_16x16x32_bf16 v[140:143], v[76:79], v[32:35], v[140:143]
    ds_read_b64_tr_b16 v[118:119], v15 offset:49152
    v_mfma_f32_16x16x32_bf16 v[144:147], v[64:67], v[36:39], v[144:147]
    ds_read_b64_tr_b16 v[120:121], v12 offset:57344
    v_mfma_f32_16x16x32_bf16 v[148:151], v[68:71], v[36:39], v[148:151]
    ds_read_b64_tr_b16 v[122:123], v13 offset:57344
    v_mfma_f32_16x16x32_bf16 v[152:155], v[72:75], v[36:39], v[152:155]
    ds_read_b64_tr_b16 v[124:125], v14 offset:57344
    v_mfma_f32_16x16x32_bf16 v[156:159], v[76:79], v[36:39], v[156:159]
    ds_read_b64_tr_b16 v[126:127], v15 offset:57344
    v_mfma_f32_16x16x32_bf16 v[160:163], v[64:67], v[40:43], v[160:163]
    ds_read_b128 v[80:83], v6 offset:32768
    v_mfma_f32_16x16x32_bf16 v[164:167], v[68:71], v[40:43], v[164:167]
    ds_read_b128 v[84:87], v6 offset:33792
    v_mfma_f32_16x16x32_bf16 v[168:171], v[72:75], v[40:43], v[168:171]
    ds_read_b128 v[88:91], v6 offset:34816
    v_mfma_f32_16x16x32_bf16 v[172:175], v[76:79], v[40:43], v[172:175]
    ds_read_b128 v[92:95], v6 offset:35840
    v_mfma_f32_16x16x32_bf16 v[176:179], v[64:67], v[44:47], v[176:179]
    ds_read_b128 v[96:99], v6 offset:36864
    v_mfma_f32_16x16x32_bf16 v[180:183], v[68:71], v[44:47], v[180:183]
    ds_read_b128 v[100:103], v6 offset:37888
    v_mfma_f32_16x16x32_bf16 v[184:187], v[72:75], v[44:47], v[184:187]
    ds_read_b128 v[104:107], v6 offset:38912
    v_mfma_f32_16x16x32_bf16 v[188:191], v[76:79], v[44:47], v[188:191]
    ds_read_b128 v[108:111], v6 offset:39936
    v_mfma_f32_16x16x32_bf16 v[192:195], v[64:67], v[48:51], v[192:195]
    v_mfma_f32_16x16x32_bf16 v[196:199], v[68:71], v[48:51], v[196:199]
    v_mfma_f32_16x16x32_bf16 v[200:203], v[72:75], v[48:51], v[200:203]
    v_mfma_f32_16x16x32_bf16 v[204:207], v[76:79], v[48:51], v[204:207]
    v_mfma_f32_16x16x32_bf16 v[208:211], v[64:67], v[52:55], v[208:211]
    v_mfma_f32_16x16x32_bf16 v[212:215], v[68:71], v[52:55], v[212:215]
    v_mfma_f32_16x16x32_bf16 v[216:219], v[72:75], v[52:55], v[216:219]
    v_mfma_f32_16x16x32_bf16 v[220:223], v[76:79], v[52:55], v[220:223]
    v_mfma_f32_16x16x32_bf16 v[224:227], v[64:67], v[56:59], v[224:227]
    v_mfma_f32_16x16x32_bf16 v[228:231], v[68:71], v[56:59], v[228:231]
    v_mfma_f32_16x16x32_bf16 v[232:235], v[72:75], v[56:59], v[232:235]
    v_mfma_f32_16x16x32_bf16 v[236:239], v[76:79], v[56:59], v[236:239]
    v_mfma_f32_16x16x32_bf16 v[240:243], v[64:67], v[60:63], v[240:243]
    v_mfma_f32_16x16x32_bf16 v[244:247], v[68:71], v[60:63], v[244:247]
    v_mfma_f32_16x16x32_bf16 v[248:251], v[72:75], v[60:63], v[248:251]
    v_mfma_f32_16x16x32_bf16 v[252:255], v[76:79], v[60:63], v[252:255]
    s_waitcnt lgkmcnt(0)
    s_waitcnt vmcnt(0)
    s_barrier
    v_mfma_f32_16x16x32_bf16 v[128:131], v[112:115], v[80:83], v[128:131]
    ds_read_b64_tr_b16 v[64:65], v8 offset:16384
    v_mfma_f32_16x16x32_bf16 v[132:135], v[116:119], v[80:83], v[132:135]
    ds_read_b64_tr_b16 v[66:67], v9 offset:16384
    v_mfma_f32_16x16x32_bf16 v[136:139], v[120:123], v[80:83], v[136:139]
    ds_read_b64_tr_b16 v[68:69], v10 offset:16384
    v_mfma_f32_16x16x32_bf16 v[140:143], v[124:127], v[80:83], v[140:143]
    ds_read_b64_tr_b16 v[70:71], v11 offset:16384
    v_mfma_f32_16x16x32_bf16 v[144:147], v[112:115], v[84:87], v[144:147]
    ds_read_b64_tr_b16 v[72:73], v8 offset:24576
    v_mfma_f32_16x16x32_bf16 v[148:151], v[116:119], v[84:87], v[148:151]
    ds_read_b64_tr_b16 v[74:75], v9 offset:24576
    v_mfma_f32_16x16x32_bf16 v[152:155], v[120:123], v[84:87], v[152:155]
    ds_read_b64_tr_b16 v[76:77], v10 offset:24576
    v_mfma_f32_16x16x32_bf16 v[156:159], v[124:127], v[84:87], v[156:159]
    ds_read_b64_tr_b16 v[78:79], v11 offset:24576
    v_mfma_f32_16x16x32_bf16 v[160:163], v[112:115], v[88:91], v[160:163]
    ds_read_b128 v[32:35], v5 offset:0
    v_mfma_f32_16x16x32_bf16 v[164:167], v[116:119], v[88:91], v[164:167]
    ds_read_b128 v[36:39], v5 offset:1024
    v_mfma_f32_16x16x32_bf16 v[168:171], v[120:123], v[88:91], v[168:171]
    ds_read_b128 v[40:43], v5 offset:2048
    v_mfma_f32_16x16x32_bf16 v[172:175], v[124:127], v[88:91], v[172:175]
    ds_read_b128 v[44:47], v5 offset:3072
    v_mfma_f32_16x16x32_bf16 v[176:179], v[112:115], v[92:95], v[176:179]
    ds_read_b128 v[48:51], v5 offset:4096
    v_mfma_f32_16x16x32_bf16 v[180:183], v[116:119], v[92:95], v[180:183]
    ds_read_b128 v[52:55], v5 offset:5120
    v_mfma_f32_16x16x32_bf16 v[184:187], v[120:123], v[92:95], v[184:187]
    ds_read_b128 v[56:59], v5 offset:6144
    v_mfma_f32_16x16x32_bf16 v[188:191], v[124:127], v[92:95], v[188:191]
    ds_read_b128 v[60:63], v5 offset:7168
    v_mfma_f32_16x16x32_bf16 v[192:195], v[112:115], v[96:99], v[192:195]
    v_mfma_f32_16x16x32_bf16 v[196:199], v[116:119], v[96:99], v[196:199]
    v_mfma_f32_16x16x32_bf16 v[200:203], v[120:123], v[96:99], v[200:203]
    v_mfma_f32_16x16x32_bf16 v[204:207], v[124:127], v[96:99], v[204:207]
    v_mfma_f32_16x16x32_bf16 v[208:211], v[112:115], v[100:103], v[208:211]
    v_mfma_f32_16x16x32_bf16 v[212:215], v[116:119], v[100:103], v[212:215]
    v_mfma_f32_16x16x32_bf16 v[216:219], v[120:123], v[100:103], v[216:219]
    v_mfma_f32_16x16x32_bf16 v[220:223], v[124:127], v[100:103], v[220:223]
    v_mfma_f32_16x16x32_bf16 v[224:227], v[112:115], v[104:107], v[224:227]
    v_mfma_f32_16x16x32_bf16 v[228:231], v[116:119], v[104:107], v[228:231]
    v_mfma_f32_16x16x32_bf16 v[232:235], v[120:123], v[104:107], v[232:235]
    v_mfma_f32_16x16x32_bf16 v[236:239], v[124:127], v[104:107], v[236:239]
    v_mfma_f32_16x16x32_bf16 v[240:243], v[112:115], v[108:111], v[240:243]
    v_mfma_f32_16x16x32_bf16 v[244:247], v[116:119], v[108:111], v[244:247]
    v_mfma_f32_16x16x32_bf16 v[248:251], v[120:123], v[108:111], v[248:251]
    v_mfma_f32_16x16x32_bf16 v[252:255], v[124:127], v[108:111], v[252:255]
    s_waitcnt lgkmcnt(0)
w_end:
    v_mov_b32 v20, 131072
    ds_read_b128 v[24:27], v20
    ds_read_b128 v[28:31], v20 offset:16
    s_cmp_eq_u32 s48, 2
    s_cbranch_scc1 w_epi_glu
    s_cmp_eq_u32 s48, 3
    s_cbranch_scc1 w_epi_silu
    s_lshl_b32 s30, s27, 10
    s_add_u32 s30, s30, s49
    s_nop 7
    v_cvt_pk_bf16_f32 v80, v128, v129
    v_cvt_pk_bf16_f32 v81, v130, v131
    v_cvt_pk_bf16_f32 v82, v132, v133
    v_cvt_pk_bf16_f32 v83, v134, v135
    buffer_store_dwordx4 v[80:83], v1, s[4:7], s30 offen sc1
    v_cvt_pk_bf16_f32 v84, v136, v137
    v_cvt_pk_bf16_f32 v85, v138, v139
    v_cvt_pk_bf16_f32 v86, v140, v141
    v_cvt_pk_bf16_f32 v87, v142, v143
    buffer_store_dwordx4 v[84:87], v19, s[4:7], s30 offen sc1
    s_add_u32 s30, s30, s50
    v_cvt_pk_bf16_f32 v88, v144, v145
    v_cvt_pk_bf16_f32 v89, v146, v147
    v_cvt_pk_bf16_f32 v90, v148, v149
    v_cvt_pk_bf16_f32 v91, v150, v151
    buffer_store_dwordx4 v[88:91], v1, s[4:7], s30 offen sc1
    v_cvt_pk_bf16_f32 v92, v152, v153
    v_cvt_pk_bf16_f32 v93, v154, v155
    v_cvt_pk_bf16_f32 v94, v156, v157
    v_cvt_pk_bf16_f32 v95, v158, v159
    buffer_store_dwordx4 v[92:95], v19, s[4:7], s30 offen sc1
    s_add_u32 s30, s30, s50
    v_cvt_pk_bf16_f32 v80, v160, v161
    v_cvt_pk_bf16_f32 v81, v162, v163
    v_cvt_pk_bf16_f32 v82, v164, v165
    v_cvt_pk_bf16_f32 v83, v166, v167
    buffer_store_dwordx4 v[80:83], v1, s[4:7], s30 offen sc1
    v_cvt_pk_bf16_f32 v84, v168, v169
    v_cvt_pk_bf16_f32 v85, v170, v171
    v_cvt_pk_bf16_f32 v86, v172, v173
    v_cvt_pk_bf16_f32 v87, v174, v175
    buffer_store_dwordx4 v[84:87], v19, s[4:7], s30 offen sc1
    s_add_u32 s30, s30, s50
    v_cvt_pk_bf16_f32 v88, v176, v177
    v_cvt_pk_bf16_f32 v89, v178, v179
    v_cvt_pk_bf16_f32 v90, v180, v181
    v_cvt_pk_bf16_f32 v91, v182, v183
    buffer_store_dwordx4 v[88:91], v1, s[4:7], s30 offen sc1
    v_cvt_pk_bf16_f32 v92, v184, v185
    v_cvt_pk_bf16_f32 v93, v186, v187
    v_cvt_pk_bf16_f32 v94, v188, v189
    v_cvt_pk_bf16_f32 v95, v190, v191
    buffer_store_dwordx4 v[92:95], v19, s[4:7], s30 offen sc1
    s_add_u32 s30, s30, s50
    v_cvt_pk_bf16_f32 v80, v192, v193
    v_cvt_pk_bf16_f32 v81, v194, v195
    v_cvt_pk_bf16_f32 v82, v196, v197
    v_cvt_pk_bf16_f32 v83, v198, v199
    buffer_store_dwordx4 v[80:83], v1, s[4:7], s30 offen sc1
    v_cvt_pk_bf16_f32 v84, v200, v201
    v_cvt_pk_bf16_f32 v85, v202, v203
    v_cvt_pk_bf16_f32 v86, v204, v205
    v_cvt_pk_bf16_f32 v87, v206, v207
    buffer_store_dwordx4 v[84:87], v19, s[4:7], s30 offen sc1
    s_add_u32 s30, s30, s50
    v_cvt_pk_bf16_f32 v88, v208, v209
    v_cvt_pk_bf16_f32 v89, v210, v211
    v_cvt_pk_bf16_f32 v90, v212, v213
    v_cvt_pk_bf16_f32 v91, v214, v215
    buffer_store_dwordx4 v[88:91], v1, s[4:7], s30 offen sc1
    v_cvt_pk_bf16_f32 v92, v216, v217
    v_cvt_pk_bf16_f32 v93, v218, v219
    v_cvt_pk_bf16_f32 v94, v220, v221
    v_cvt_pk_bf16_f32 v95, v222, v223
    buffer_store_dwordx4 v[92:95], v19, s[4:7], s30 offen sc1
    s_add_u32 s30, s30, s50
    v_cvt_pk_bf16_f32 v80, v224, v225
    v_cvt_pk_bf16_f32 v81, v226, v227
    v_cvt_pk_bf16_f32 v82, v228, v229
    v_cvt_pk_bf16_f32 v83, v230, v231
    buffer_store_dwordx4 v[80:83], v1, s[4:7], s30 offen sc1
    v_cvt_pk_bf16_f32 v84, v232, v233
    v_cvt_pk_bf16_f32 v85, v234, v235
    v_cvt_pk_bf16_f32 v86, v236, v237
    v_cvt_pk_bf16_f32 v87, v238, v239
    buffer_store_dwordx4 v[84:87], v19, s[4:7], s30 offen sc1
    s_add_u32 s30, s30, s50
    v_cvt_pk_bf16_f32 v88, v240, v241
    v_cvt_pk_bf16_f32 v89, v242, v243
    v_cvt_pk_bf16_f32 v90, v244, v245
    v_cvt_pk_bf16_f32 v91, v246, v247
    buffer_store_dwordx4 v[88:91], v1, s[4:7], s30 offen sc1
    v_cvt_pk_bf16_f32 v92, v248, v249
    v_cvt_pk_bf16_f32 v93, v250, v251
    v_cvt_pk_bf16_f32 v94, v252, v253
    v_cvt_pk_bf16_f32 v95, v254, v255
    buffer_store_dwordx4 v[92:95], v19, s[4:7], s30 offen sc1
    s_waitcnt lgkmcnt(0)
    v_or3_b32 v24, v24, v25, v26
    v_or3_b32 v28, v28, v29, v30
    v_or3_b32 v24, v24, v27, v31
    v_or_b32 v24, v24, v28
    s_mov_b32 s28, s51
    s_mov_b32 s57, s53
    v_readfirstlane_b32 s30, v24
    s_cmp_lg_u32 s30, 0
    s_cbranch_scc1 w_drain
    s_mov_b32 s48, s32
    s_cmp_ge_u32 s32, 4
    s_cselect_b32 s30, 2, 3
    s_lshl_b32 s30, s26, s30
    s_mul_i32 s30, s30, s43
    s_add_u32 s49, s42, s30
    s_mov_b32 s50, s43
    s_mov_b32 s51, s46
    s_mov_b32 s23, s41
    s_mov_b32 s53, s47
    s_nop 0
    s_load_dwordx16 s[32:47], s[24:25], 0
    s_add_u32 s24, s24, 64
    s_addc_u32 s25, s25, 0
    s_branch w_first16
w_epi_glu:
    s_lshl_b32 s30, s27, 10
    s_add_u32 s30, s30, s49
    s_mov_b32 s54, 0xbfb8aa3b
    s_nop 7
    v_cvt_pk_bf16_f32 v80, v128, v129
    v_cvt_pk_bf16_f32 v81, v130, v131
    v_cvt_pk_bf16_f32 v82, v132, v133
    v_cvt_pk_bf16_f32 v83, v134, v135
    v_lshlrev_b32 v96, 16, v80
    v_and_b32 v97, 0xffff0000, v80
    v_lshlrev_b32 v98, 16, v81
    v_and_b32 v99, 0xffff0000, v81
    v_lshlrev_b32 v100, 16, v82
    v_and_b32 v101, 0xffff0000, v82
    v_lshlrev_b32 v102, 16, v83
    v_and_b32 v103, 0xffff0000, v83
    v_mul_f32 v96, s54, v96
    v_mul_f32 v97, s54, v97
    v_mul_f32 v98, s54, v98
    v_mul_f32 v99, s54, v99
    v_mul_f32 v100, s54, v100
    v_mul_f32 v101, s54, v101
    v_mul_f32 v102, s54, v102
    v_mul_f32 v103, s54, v103
    v_exp_f32 v96, v96
    v_exp_f32 v97, v97
    v_exp_f32 v98, v98
    v_exp_f32 v99, v99
    v_exp_f32 v100, v100
    v_exp_f32 v101, v101
    v_exp_f32 v102, v102
    v_exp_f32 v103, v103
    v_add_f32 v96, 1.0, v96
    v_add_f32 v97, 1.0, v97
    v_add_f32 v98, 1.0, v98
    v_add_f32 v99, 1.0, v99
    v_add_f32 v100, 1.0, v100
    v_add_f32 v101, 1.0, v101
    v_add_f32 v102, 1.0, v102
    v_add_f32 v103, 1.0, v103
    v_rcp_f32 v96, v96
    v_rcp_f32 v97, v97
    v_rcp_f32 v98, v98
    v_rcp_f32 v99, v99
    v_rcp_f32 v100, v100
    v_rcp_f32 v101, v101
    v_rcp_f32 v102, v102
    v_rcp_f32 v103, v103
    v_mul_f32 v96, v96, v136
    v_mul_f32 v97, v97, v137
    v_mul_f32 v98, v98, v138
    v_mul_f32 v99, v99, v139
    v_mul_f32 v100, v100, v140
    v_mul_f32 v101, v101, v141
    v_mul_f32 v102, v102, v142
    v_mul_f32 v103, v103, v143
    v_cvt_pk_bf16_f32 v80, v96, v97
    v_cvt_pk_bf16_f32 v81, v98, v99
    v_cvt_pk_bf16_f32 v82, v100, v101
    v_cvt_pk_bf16_f32 v83, v102, v103
    buffer_store_dwordx4 v[80:83], v1, s[4:7], s30 offen sc1
    s_add_u32 s30, s30, s50
    v_cvt_pk_bf16_f32 v84, v144, v145
    v_cvt_pk_bf16_f32 v85, v146, v147
    v_cvt_pk_bf16_f32 v86, v148, v149
    v_cvt_pk_bf16_f32 v87, v150, v151
    v_lshlrev_b32 v104, 16, v84
    v_and_b32 v105, 0xffff0000, v84
    v_lshlrev_b32 v106, 16, v85
    v_and_b32 v107, 0xffff0000, v85
    v_lshlrev_b32 v108, 16, v86
    v_and_b32 v109, 0xffff0000, v86
    v_lshlrev_b32 v110, 16, v87
    v_and_b32 v111, 0xffff0000, v87
    v_mul_f32 v104, s54, v104
    v_mul_f32 v105, s54, v105
    v_mul_f32 v106, s54, v106
    v_mul_f32 v107, s54, v107
    v_mul_f32 v108, s54, v108
    v_mul_f32 v109, s54, v109
    v_mul_f32 v110, s54, v110
    v_mul_f32 v111, s54, v111
    v_exp_f32 v104, v104
    v_exp_f32 v105, v105
    v_exp_f32 v106, v106
    v_exp_f32 v107, v107
    v_exp_f32 v108, v108
    v_exp_f32 v109, v109
    v_exp_f32 v110, v110
    v_exp_f32 v111, v111
    v_add_f32 v104, 1.0, v104
    v_add_f32 v105, 1.0, v105
    v_add_f32 v106, 1.0, v106
    v_add_f32 v107, 1.0, v107
    v_add_f32 v108, 1.0, v108
    v_add_f32 v109, 1.0, v109
    v_add_f32 v110, 1.0, v110
    v_add_f32 v111, 1.0, v111
    v_rcp_f32 v104, v104
    v_rcp_f32 v105, v105
    v_rcp_f32 v106, v106
    v_rcp_f32 v107, v107
    v_rcp_f32 v108, v108
    v_rcp_f32 v109, v109
    v_rcp_f32 v110, v110
    v_rcp_f32 v111, v111
    v_mul_f32 v104, v104, v152
    v_mul_f32 v105, v105, v153
    v_mul_f32 v106, v106, v154
    v_mul_f32 v107, v107, v155
    v_mul_f32 v108, v108, v156
    v_mul_f32 v109, v109, v157
    v_mul_f32 v110, v110, v158
    v_mul_f32 v111, v111, v159
    v_cvt_pk_bf16_f32 v84, v104, v105
    v_cvt_pk_bf16_f32 v85, v106, v107
    v_cvt_pk_bf16_f32 v86, v108, v109
    v_cvt_pk_bf16_f32 v87, v110, v111
    buffer_store_dwordx4 v[84:87], v1, s[4:7], s30 offen sc1
    s_add_u32 s30, s30, s50
    v_cvt_pk_bf16_f32 v88, v160, v161
    v_cvt_pk_bf16_f32 v89, v162, v163
    v_cvt_pk_bf16_f32 v90, v164, v165
    v_cvt_pk_bf16_f32 v91, v166, v167
    v_lshlrev_b32 v96, 16, v88
    v_and_b32 v97, 0xffff0000, v88
    v_lshlrev_b32 v98, 16, v89
    v_and_b32 v99, 0xffff0000, v89
    v_lshlrev_b32 v100, 16, v90
    v_and_b32 v101, 0xffff0000, v90
    v_lshlrev_b32 v102, 16, v91
    v_and_b32 v103, 0xffff0000, v91
    v_mul_f32 v96, s54, v96
    v_mul_f32 v97, s54, v97
    v_mul_f32 v98, s54, v98
    v_mul_f32 v99, s54, v99
    v_mul_f32 v100, s54, v100
    v_mul_f32 v101, s54, v101
    v_mul_f32 v102, s54, v102
    v_mul_f32 v103, s54, v103
    v_exp_f32 v96, v96
    v_exp_f32 v97, v97
    v_exp_f32 v98, v98
    v_exp_f32 v99, v99
    v_exp_f32 v100, v100
    v_exp_f32 v101, v101
    v_exp_f32 v102, v102
    v_exp_f32 v103, v103
    v_add_f32 v96, 1.0, v96
    v_add_f32 v97, 1.0, v97
    v_add_f32 v98, 1.0, v98
    v_add_f32 v99, 1.0, v99
    v_add_f32 v100, 1.0, v100
    v_add_f32 v101, 1.0, v101
    v_add_f32 v102, 1.0, v102
    v_add_f32 v103, 1.0, v103
    v_rcp_f32 v96, v96
    v_rcp_f32 v97, v97
    v_rcp_f32 v98, v98
    v_rcp_f32 v99, v99
    v_rcp_f32 v100, v100
    v_rcp_f32 v101, v101
    v_rcp_f32 v102, v102
    v_rcp_f32 v103, v103
    v_mul_f32 v96, v96, v168
    v_mul_f32 v97, v97, v169
    v_mul_f32 v98, v98, v170
    v_mul_f32 v99, v99, v171
    v_mul_f32 v100, v100, v172
    v_mul_f32 v101, v101, v173
    v_mul_f32 v102, v102, v174
    v_mul_f32 v103, v103, v175
    v_cvt_pk_bf16_f32 v88, v96, v97
    v_cvt_pk_bf16_f32 v89, v98, v99
    v_cvt_pk_bf16_f32 v90, v100, v101
    v_cvt_pk_bf16_f32 v91, v102, v103
    buffer_store_dwordx4 v[88:91], v1, s[4:7], s30 offen sc1
    s_add_u32 s30, s30, s50
    v_cvt_pk_bf16_f32 v92, v176, v177
    v_cvt_pk_bf16_f32 v93, v178, v179
    v_cvt_pk_bf16_f32 v94, v180, v181
    v_cvt_pk_bf16_f32 v95, v182, v183
    v_lshlrev_b32 v104, 16, v92
    v_and_b32 v105, 0xffff0000, v92
    v_lshlrev_b32 v106, 16, v93
    v_and_b32 v107, 0xffff0000, v93
    v_lshlrev_b32 v108, 16, v94
    v_and_b32 v109, 0xffff0000, v94
    v_lshlrev_b32 v110, 16, v95
    v_and_b32 v111, 0xffff0000, v95
    v_mul_f32 v104, s54, v104
    v_mul_f32 v105, s54, v105
    v_mul_f32 v106, s54, v106
    v_mul_f32 v107, s54, v107
    v_mul_f32 v108, s54, v108
    v_mul_f32 v109, s54, v109
    v_mul_f32 v110, s54, v110
    v_mul_f32 v111, s54, v111
    v_exp_f32 v104, v104
    v_exp_f32 v105, v105
    v_exp_f32 v106, v106
    v_exp_f32 v107, v107
    v_exp_f32 v108, v108
    v_exp_f32 v109, v109
    v_exp_f32 v110, v110
    v_exp_f32 v111, v111
    v_add_f32 v104, 1.0, v104
    v_add_f32 v105, 1.0, v105
    v_add_f32 v106, 1.0, v106
    v_add_f32 v107, 1.0, v107
    v_add_f32 v108, 1.0, v108
    v_add_f32 v109, 1.0, v109
    v_add_f32 v110, 1.0, v110
    v_add_f32 v111, 1.0, v111
    v_rcp_f32 v104, v104
    v_rcp_f32 v105, v105
    v_rcp_f32 v106, v106
    v_rcp_f32 v107, v107
    v_rcp_f32 v108, v108
    v_rcp_f32 v109, v109
    v_rcp_f32 v110, v110
    v_rcp_f32 v111, v111
    v_mul_f32 v104, v104, v184
    v_mul_f32 v105, v105, v185
    v_mul_f32 v106, v106, v186
    v_mul_f32 v107, v107, v187
    v_mul_f32 v108, v108, v188
    v_mul_f32 v109, v109, v189
    v_mul_f32 v110, v110, v190
    v_mul_f32 v111, v111, v191
    v_cvt_pk_bf16_f32 v92, v104, v105
    v_cvt_pk_bf16_f32 v93, v106, v107
    v_cvt_pk_bf16_f32 v94, v108, v109
    v_cvt_pk_bf16_f32 v95, v110, v111
    buffer_store_dwordx4 v[92:95], v1, s[4:7], s30 offen sc1
    s_add_u32 s30, s30, s50
    v_cvt_pk_bf16_f32 v80, v192, v193
    v_cvt_pk_bf16_f32 v81, v194, v195
    v_cvt_pk_bf16_f32 v82, v196, v197
    v_cvt_pk_bf16_f32 v83, v198, v199
    v_lshlrev_b32 v96, 16, v80
    v_and_b32 v97, 0xffff0000, v80
    v_lshlrev_b32 v98, 16, v81
    v_and_b32 v99, 0xffff0000, v81
    v_lshlrev_b32 v100, 16, v82
    v_and_b32 v101, 0xffff0000, v82
    v_lshlrev_b32 v102, 16, v83
    v_and_b32 v103, 0xffff0000, v83
    v_mul_f32 v96, s54, v96
    v_mul_f32 v97, s54, v97
    v_mul_f32 v98, s54, v98
    v_mul_f32 v99, s54, v99
    v_mul_f32 v100, s54, v100
    v_mul_f32 v101, s54, v101
    v_mul_f32 v102, s54, v102
    v_mul_f32 v103, s54, v103
    v_exp_f32 v96, v96
    v_exp_f32 v97, v97
    v_exp_f32 v98, v98
    v_exp_f32 v99, v99
    v_exp_f32 v100, v100
    v_exp_f32 v101, v101
    v_exp_f32 v102, v102
    v_exp_f32 v103, v103
    v_add_f32 v96, 1.0, v96
    v_add_f32 v97, 1.0, v97
    v_add_f32 v98, 1.0, v98
    v_add_f32 v99, 1.0, v99
    v_add_f32 v100, 1.0, v100
    v_add_f32 v101, 1.0, v101
    v_add_f32 v102, 1.0, v102
    v_add_f32 v103, 1.0, v103
    v_rcp_f32 v96, v96
    v_rcp_f32 v97, v97
    v_rcp_f32 v98, v98
    v_rcp_f32 v99, v99
    v_rcp_f32 v100, v100
    v_rcp_f32 v101, v101
    v_rcp_f32 v102, v102
    v_rcp_f32 v103, v103
    v_mul_f32 v96, v96, v200
    v_mul_f32 v97, v97, v201
    v_mul_f32 v98, v98, v202
    v_mul_f32 v99, v99, v203
    v_mul_f32 v100, v100, v204
    v_mul_f32 v101, v101, v205
    v_mul_f32 v102, v102, v206
    v_mul_f32 v103, v103, v207
    v_cvt_pk_bf16_f32 v80, v96, v97
    v_cvt_pk_bf16_f32 v81, v98, v99
    v_cvt_pk_bf16_f32 v82, v100, v101
    v_cvt_pk_bf16_f32 v83, v102, v103
    buffer_store_dwordx4 v[80:83], v1, s[4:7], s30 offen sc1
    s_add_u32 s30, s30, s50
    v_cvt_pk_bf16_f32 v84, v208, v209
    v_cvt_pk_bf16_f32 v85, v210, v211
    v_cvt_pk_bf16_f32 v86, v212, v213
    v_cvt_pk_bf16_f32 v87, v214, v215
    v_lshlrev_b32 v104, 16, v84
    v_and_b32 v105, 0xffff0000, v84
    v_lshlrev_b32 v106, 16, v85
    v_and_b32 v107, 0xffff0000, v85
    v_lshlrev_b32 v108, 16, v86
    v_and_b32 v109, 0xffff0000, v86
    v_lshlrev_b32 v110, 16, v87
    v_and_b32 v111, 0xffff0000, v87
    v_mul_f32 v104, s54, v104
    v_mul_f32 v105, s54, v105
    v_mul_f32 v106, s54, v106
    v_mul_f32 v107, s54, v107
    v_mul_f32 v108, s54, v108
    v_mul_f32 v109, s54, v109
    v_mul_f32 v110, s54, v110
    v_mul_f32 v111, s54, v111
    v_exp_f32 v104, v104
    v_exp_f32 v105, v105
    v_exp_f32 v106, v106
    v_exp_f32 v107, v107
    v_exp_f32 v108, v108
    v_exp_f32 v109, v109
    v_exp_f32 v110, v110
    v_exp_f32 v111, v111
    v_add_f32 v104, 1.0, v104
    v_add_f32 v105, 1.0, v105
    v_add_f32 v106, 1.0, v106
    v_add_f32 v107, 1.0, v107
    v_add_f32 v108, 1.0, v108
    v_add_f32 v109, 1.0, v109
    v_add_f32 v110, 1.0, v110
    v_add_f32 v111, 1.0, v111
    v_rcp_f32 v104, v104
    v_rcp_f32 v105, v105
    v_rcp_f32 v106, v106
    v_rcp_f32 v107, v107
    v_rcp_f32 v108, v108
    v_rcp_f32 v109, v109
    v_rcp_f32 v110, v110
    v_rcp_f32 v111, v111
    v_mul_f32 v104, v104, v216
    v_mul_f32 v105, v105, v217
    v_mul_f32 v106, v106, v218
    v_mul_f32 v107, v107, v219
    v_mul_f32 v108, v108, v220
    v_mul_f32 v109, v109, v221
    v_mul_f32 v110, v110, v222
    v_mul_f32 v111, v111, v223
    v_cvt_pk_bf16_f32 v84, v104, v105
    v_cvt_pk_bf16_f32 v85, v106, v107
    v_cvt_pk_bf16_f32 v86, v108, v109
    v_cvt_pk_bf16_f32 v87, v110, v111
    buffer_store_dwordx4 v[84:87], v1, s[4:7], s30 offen sc1
    s_add_u32 s30, s30, s50
    v_cvt_pk_bf16_f32 v88, v224, v225
    v_cvt_pk_bf16_f32 v89, v226, v227
    v_cvt_pk_bf16_f32 v90, v228, v229
    v_cvt_pk_bf16_f32 v91, v230, v231
    v_lshlrev_b32 v96, 16, v88
    v_and_b32 v97, 0xffff0000, v88
    v_lshlrev_b32 v98, 16, v89
    v_and_b32 v99, 0xffff0000, v89
    v_lshlrev_b32 v100, 16, v90
    v_and_b32 v101, 0xffff0000, v90
    v_lshlrev_b32 v102, 16, v91
    v_and_b32 v103, 0xffff0000, v91
    v_mul_f32 v96, s54, v96
    v_mul_f32 v97, s54, v97
    v_mul_f32 v98, s54, v98
    v_mul_f32 v99, s54, v99
    v_mul_f32 v100, s54, v100
    v_mul_f32 v101, s54, v101
    v_mul_f32 v102, s54, v102
    v_mul_f32 v103, s54, v103
    v_exp_f32 v96, v96
    v_exp_f32 v97, v97
    v_exp_f32 v98, v98
    v_exp_f32 v99, v99
    v_exp_f32 v100, v100
    v_exp_f32 v101, v101
    v_exp_f32 v102, v102
    v_exp_f32 v103, v103
    v_add_f32 v96, 1.0, v96
    v_add_f32 v97, 1.0, v97
    v_add_f32 v98, 1.0, v98
    v_add_f32 v99, 1.0, v99
    v_add_f32 v100, 1.0, v100
    v_add_f32 v101, 1.0, v101
    v_add_f32 v102, 1.0, v102
    v_add_f32 v103, 1.0, v103
    v_rcp_f32 v96, v96
    v_rcp_f32 v97, v97
    v_rcp_f32 v98, v98
    v_rcp_f32 v99, v99
    v_rcp_f32 v100, v100
    v_rcp_f32 v101, v101
    v_rcp_f32 v102, v102
    v_rcp_f32 v103, v103
    v_mul_f32 v96, v96, v232
    v_mul_f32 v97, v97, v233
    v_mul_f32 v98, v98, v234
    v_mul_f32 v99, v99, v235
    v_mul_f32 v100, v100, v236
    v_mul_f32 v101, v101, v237
    v_mul_f32 v102, v102, v238
    v_mul_f32 v103, v103, v239
    v_cvt_pk_bf16_f32 v88, v96, v97
    v_cvt_pk_bf16_f32 v89, v98, v99
    v_cvt_pk_bf16_f32 v90, v100, v101
    v_cvt_pk_bf16_f32 v91, v102, v103
    buffer_store_dwordx4 v[88:91], v1, s[4:7], s30 offen sc1
    s_add_u32 s30, s30, s50
    v_cvt_pk_bf16_f32 v92, v240, v241
    v_cvt_pk_bf16_f32 v93, v242, v243
    v_cvt_pk_bf16_f32 v94, v244, v245
    v_cvt_pk_bf16_f32 v95, v246, v247
    v_lshlrev_b32 v104, 16, v92
    v_and_b32 v105, 0xffff0000, v92
    v_lshlrev_b32 v106, 16, v93
    v_and_b32 v107, 0xffff0000, v93
    v_lshlrev_b32 v108, 16, v94
    v_and_b32 v109, 0xffff0000, v94
    v_lshlrev_b32 v110, 16, v95
    v_and_b32 v111, 0xffff0000, v95
    v_mul_f32 v104, s54, v104
    v_mul_f32 v105, s54, v105
    v_mul_f32 v106, s54, v106
    v_mul_f32 v107, s54, v107
    v_mul_f32 v108, s54, v108
    v_mul_f32 v109, s54, v109
    v_mul_f32 v110, s54, v110
    v_mul_f32 v111, s54, v111
    v_exp_f32 v104, v104
    v_exp_f32 v105, v105
    v_exp_f32 v106, v106
    v_exp_f32 v107, v107
    v_exp_f32 v108, v108
    v_exp_f32 v109, v109
    v_exp_f32 v110, v110
    v_exp_f32 v111, v111
    v_add_f32 v104, 1.0, v104
    v_add_f32 v105, 1.0, v105
    v_add_f32 v106, 1.0, v106
    v_add_f32 v107, 1.0, v107
    v_add_f32 v108, 1.0, v108
    v_add_f32 v109, 1.0, v109
    v_add_f32 v110, 1.0, v110
    v_add_f32 v111, 1.0, v111
    v_rcp_f32 v104, v104
    v_rcp_f32 v105, v105
    v_rcp_f32 v106, v106
    v_rcp_f32 v107, v107
    v_rcp_f32 v108, v108
    v_rcp_f32 v109, v109
    v_rcp_f32 v110, v110
    v_rcp_f32 v111, v111
    v_mul_f32 v104, v104, v248
    v_mul_f32 v105, v105, v249
    v_mul_f32 v106, v106, v250
    v_mul_f32 v107, v107, v251
    v_mul_f32 v108, v108, v252
    v_mul_f32 v109, v109, v253
    v_mul_f32 v110, v110, v254
    v_mul_f32 v111, v111, v255
    v_cvt_pk_bf16_f32 v92, v104, v105
    v_cvt_pk_bf16_f32 v93, v106, v107
    v_cvt_pk_bf16_f32 v94, v108, v109
    v_cvt_pk_bf16_f32 v95, v110, v111
    buffer_store_dwordx4 v[92:95], v1, s[4:7], s30 offen sc1
    s_waitcnt lgkmcnt(0)
    v_or3_b32 v24, v24, v25, v26
    v_or3_b32 v28, v28, v29, v30
    v_or3_b32 v24, v24, v27, v31
    v_or_b32 v24, v24, v28
    s_mov_b32 s28, s51
    s_mov_b32 s57, s53
    v_readfirstlane_b32 s30, v24
    s_cmp_lg_u32 s30, 0
    s_cbranch_scc1 w_drain
    s_mov_b32 s48, s32
    s_cmp_ge_u32 s32, 4
    s_cselect_b32 s30, 2, 3
    s_lshl_b32 s30, s26, s30
    s_mul_i32 s30, s30, s43
    s_add_u32 s49, s42, s30
    s_mov_b32 s50, s43
    s_mov_b32 s51, s46
    s_mov_b32 s23, s41
    s_mov_b32 s53, s47
    s_nop 0
    s_load_dwordx16 s[32:47], s[24:25], 0
    s_add_u32 s24, s24, 64
    s_addc_u32 s25, s25, 0
    s_branch w_first8
w_epi_silu:
    s_lshl_b32 s30, s27, 10
    s_add_u32 s30, s30, s49
    s_mov_b32 s54, 0xbfb8aa3b
    s_nop 7
    v_cvt_pk_bf16_f32 v80, v128, v129
    v_cvt_pk_bf16_f32 v81, v130, v131
    v_cvt_pk_bf16_f32 v82, v132, v133
    v_cvt_pk_bf16_f32 v83, v134, v135
    v_lshlrev_b32 v128, 16, v80
    v_and_b32 v129, 0xffff0000, v80
    v_lshlrev_b32 v130, 16, v81
    v_and_b32 v131, 0xffff0000, v81
    v_lshlrev_b32 v132, 16, v82
    v_and_b32 v133, 0xffff0000, v82
    v_lshlrev_b32 v134, 16, v83
    v_and_b32 v135, 0xffff0000, v83
    v_mul_f32 v104, s54, v128
    v_mul_f32 v105, s54, v129
    v_mul_f32 v106, s54, v130
    v_mul_f32 v107, s54, v131
    v_mul_f32 v108, s54, v132
    v_mul_f32 v109, s54, v133
    v_mul_f32 v110, s54, v134
    v_mul_f32 v111, s54, v135
    v_exp_f32 v104, v104
    v_exp_f32 v105, v105
    v_exp_f32 v106, v106
    v_exp_f32 v107, v107
    v_exp_f32 v108, v108
    v_exp_f32 v109, v109
    v_exp_f32 v110, v110
    v_exp_f32 v111, v111
    v_add_f32 v104, 1.0, v104
    v_add_f32 v105, 1.0, v105
    v_add_f32 v106, 1.0, v106
    v_add_f32 v107, 1.0, v107
    v_add_f32 v108, 1.0, v108
    v_add_f32 v109, 1.0, v109
    v_add_f32 v110, 1.0, v110
    v_add_f32 v111, 1.0, v111
    v_rcp_f32 v104, v104
    v_rcp_f32 v105, v105
    v_rcp_f32 v106, v106
    v_rcp_f32 v107, v107
    v_rcp_f32 v108, v108
    v_rcp_f32 v109, v109
    v_rcp_f32 v110, v110
    v_rcp_f32 v111, v111
    v_mul_f32 v128, v128, v104
    v_mul_f32 v129, v129, v105
    v_mul_f32 v130, v130, v106
    v_mul_f32 v131, v131, v107
    v_mul_f32 v132, v132, v108
    v_mul_f32 v133, v133, v109
    v_mul_f32 v134, v134, v110
    v_mul_f32 v135, v135, v111
    v_cvt_pk_bf16_f32 v80, v128, v129
    v_cvt_pk_bf16_f32 v81, v130, v131
    v_cvt_pk_bf16_f32 v82, v132, v133
    v_cvt_pk_bf16_f32 v83, v134, v135
    buffer_store_dwordx4 v[80:83], v1, s[4:7], s30 offen sc1
    v_cvt_pk_bf16_f32 v84, v136, v137
    v_cvt_pk_bf16_f32 v85, v138, v139
    v_cvt_pk_bf16_f32 v86, v140, v141
    v_cvt_pk_bf16_f32 v87, v142, v143
    v_lshlrev_b32 v136, 16, v84
    v_and_b32 v137, 0xffff0000, v84
    v_lshlrev_b32 v138, 16, v85
    v_and_b32 v139, 0xffff0000, v85
    v_lshlrev_b32 v140, 16, v86
    v_and_b32 v141, 0xffff0000, v86
    v_lshlrev_b32 v142, 16, v87
    v_and_b32 v143, 0xffff0000, v87
    v_mul_f32 v96, s54, v136
    v_mul_f32 v97, s54, v137
    v_mul_f32 v98, s54, v138
    v_mul_f32 v99, s54, v139
    v_mul_f32 v100, s54, v140
    v_mul_f32 v101, s54, v141
    v_mul_f32 v102, s54, v142
    v_mul_f32 v103, s54, v143
    v_exp_f32 v96, v96
    v_exp_f32 v97, v97
    v_exp_f32 v98, v98
    v_exp_f32 v99, v99
    v_exp_f32 v100, v100
    v_exp_f32 v101, v101
    v_exp_f32 v102, v102
    v_exp_f32 v103, v103
    v_add_f32 v96, 1.0, v96
    v_add_f32 v97, 1.0, v97
    v_add_f32 v98, 1.0, v98
    v_add_f32 v99, 1.0, v99
    v_add_f32 v100, 1.0, v100
    v_add_f32 v101, 1.0, v101
    v_add_f32 v102, 1.0, v102
    v_add_f32 v103, 1.0, v103
    v_rcp_f32 v96, v96
    v_rcp_f32 v97, v97
    v_rcp_f32 v98, v98
    v_rcp_f32 v99, v99
    v_rcp_f32 v100, v100
    v_rcp_f32 v101, v101
    v_rcp_f32 v102, v102
    v_rcp_f32 v103, v103
    v_mul_f32 v136, v136, v96
    v_mul_f32 v137, v137, v97
    v_mul_f32 v138, v138, v98
    v_mul_f32 v139, v139, v99
    v_mul_f32 v140, v140, v100
    v_mul_f32 v141, v141, v101
    v_mul_f32 v142, v142, v102
    v_mul_f32 v143, v143, v103
    v_cvt_pk_bf16_f32 v84, v136, v137
    v_cvt_pk_bf16_f32 v85, v138, v139
    v_cvt_pk_bf16_f32 v86, v140, v141
    v_cvt_pk_bf16_f32 v87, v142, v143
    buffer_store_dwordx4 v[84:87], v19, s[4:7], s30 offen sc1
    s_add_u32 s30, s30, s50
    v_cvt_pk_bf16_f32 v88, v144, v145
    v_cvt_pk_bf16_f32 v89, v146, v147
    v_cvt_pk_bf16_f32 v90, v148, v149
    v_cvt_pk_bf16_f32 v91, v150, v151
    v_lshlrev_b32 v144, 16, v88
    v_and_b32 v145, 0xffff0000, v88
    v_lshlrev_b32 v146, 16, v89
    v_and_b32 v147, 0xffff0000, v89
    v_lshlrev_b32 v148, 16, v90
    v_and_b32 v149, 0xffff0000, v90
    v_lshlrev_b32 v150, 16, v91
    v_and_b32 v151, 0xffff0000, v91
    v_mul_f32 v104, s54, v144
    v_mul_f32 v105, s54, v145
    v_mul_f32 v106, s54, v146
    v_mul_f32 v107, s54, v147
    v_mul_f32 v108, s54, v148
    v_mul_f32 v109, s54, v149
    v_mul_f32 v110, s54, v150
    v_mul_f32 v111, s54, v151
    v_exp_f32 v104, v104
    v_exp_f32 v105, v105
    v_exp_f32 v106, v106
    v_exp_f32 v107, v107
    v_exp_f32 v108, v108
    v_exp_f32 v109, v109
    v_exp_f32 v110, v110
    v_exp_f32 v111, v111
    v_add_f32 v104, 1.0, v104
    v_add_f32 v105, 1.0, v105
    v_add_f32 v106, 1.0, v106
    v_add_f32 v107, 1.0, v107
    v_add_f32 v108, 1.0, v108
    v_add_f32 v109, 1.0, v109
    v_add_f32 v110, 1.0, v110
    v_add_f32 v111, 1.0, v111
    v_rcp_f32 v104, v104
    v_rcp_f32 v105, v105
    v_rcp_f32 v106, v106
    v_rcp_f32 v107, v107
    v_rcp_f32 v108, v108
    v_rcp_f32 v109, v109
    v_rcp_f32 v110, v110
    v_rcp_f32 v111, v111
    v_mul_f32 v144, v144, v104
    v_mul_f32 v145, v145, v105
    v_mul_f32 v146, v146, v106
    v_mul_f32 v147, v147, v107
    v_mul_f32 v148, v148, v108
    v_mul_f32 v149, v149, v109
    v_mul_f32 v150, v150, v110
    v_mul_f32 v151, v151, v111
    v_cvt_pk_bf16_f32 v88, v144, v145
    v_cvt_pk_bf16_f32 v89, v146, v147
    v_cvt_pk_bf16_f32 v90, v148, v149
    v_cvt_pk_bf16_f32 v91, v150, v151
    buffer_store_dwordx4 v[88:91], v1, s[4:7], s30 offen sc1
    v_cvt_pk_bf16_f32 v92, v152, v153
    v_cvt_pk_bf16_f32 v93, v154, v155
    v_cvt_pk_bf16_f32 v94, v156, v157
    v_cvt_pk_bf16_f32 v95, v158, v159
    v_lshlrev_b32 v152, 16, v92
    v_and_b32 v153, 0xffff0000, v92
    v_lshlrev_b32 v154, 16, v93
    v_and_b32 v155, 0xffff0000, v93
    v_lshlrev_b32 v156, 16, v94
    v_and_b32 v157, 0xffff0000, v94
    v_lshlrev_b32 v158, 16, v95
    v_and_b32 v159, 0xffff0000, v95
    v_mul_f32 v96, s54, v152
    v_mul_f32 v97, s54, v153
    v_mul_f32 v98, s54, v154
    v_mul_f32 v99, s54, v155
    v_mul_f32 v100, s54, v156
    v_mul_f32 v101, s54, v157
    v_mul_f32 v102, s54, v158
    v_mul_f32 v103, s54, v159
    v_exp_f32 v96, v96
    v_exp_f32 v97, v97
    v_exp_f32 v98, v98
    v_exp_f32 v99, v99
    v_exp_f32 v100, v100
    v_exp_f32 v101, v101
    v_exp_f32 v102, v102
    v_exp_f32 v103, v103
    v_add_f32 v96, 1.0, v96
    v_add_f32 v97, 1.0, v97
    v_add_f32 v98, 1.0, v98
    v_add_f32 v99, 1.0, v99
    v_add_f32 v100, 1.0, v100
    v_add_f32 v101, 1.0, v101
    v_add_f32 v102, 1.0, v102
    v_add_f32 v103, 1.0, v103
    v_rcp_f32 v96, v96
    v_rcp_f32 v97, v97
    v_rcp_f32 v98, v98
    v_rcp_f32 v99, v99
    v_rcp_f32 v100, v100
    v_rcp_f32 v101, v101
    v_rcp_f32 v102, v102
    v_rcp_f32 v103, v103
    v_mul_f32 v152, v152, v96
    v_mul_f32 v153, v153, v97
    v_mul_f32 v154, v154, v98
    v_mul_f32 v155, v155, v99
    v_mul_f32 v156, v156, v100
    v_mul_f32 v157, v157, v101
    v_mul_f32 v158, v158, v102
    v_mul_f32 v159, v159, v103
    v_cvt_pk_bf16_f32 v92, v152, v153
    v_cvt_pk_bf16_f32 v93, v154, v155
    v_cvt_pk_bf16_f32 v94, v156, v157
    v_cvt_pk_bf16_f32 v95, v158, v159
    buffer_store_dwordx4 v[92:95], v19, s[4:7], s30 offen sc1
    s_add_u32 s30, s30, s50
    v_cvt_pk_bf16_f32 v80, v160, v161
    v_cvt_pk_bf16_f32 v81, v162, v163
    v_cvt_pk_bf16_f32 v82, v164, v165
    v_cvt_pk_bf16_f32 v83, v166, v167
    v_lshlrev_b32 v160, 16, v80
    v_and_b32 v161, 0xffff0000, v80
    v_lshlrev_b32 v162, 16, v81
    v_and_b32 v163, 0xffff0000, v81
    v_lshlrev_b32 v164, 16, v82
    v_and_b32 v165, 0xffff0000, v82
    v_lshlrev_b32 v166, 16, v83
    v_and_b32 v167, 0xffff0000, v83
    v_mul_f32 v104, s54, v160
    v_mul_f32 v105, s54, v161
    v_mul_f32 v106, s54, v162
    v_mul_f32 v107, s54, v163
    v_mul_f32 v108, s54, v164
    v_mul_f32 v109, s54, v165
    v_mul_f32 v110, s54, v166
    v_mul_f32 v111, s54, v167
    v_exp_f32 v104, v104
    v_exp_f32 v105, v105
    v_exp_f32 v106, v106
    v_exp_f32 v107, v107
    v_exp_f32 v108, v108
    v_exp_f32 v109, v109
    v_exp_f32 v110, v110
    v_exp_f32 v111, v111
    v_add_f32 v104, 1.0, v104
    v_add_f32 v105, 1.0, v105
    v_add_f32 v106, 1.0, v106
    v_add_f32 v107, 1.0, v107
    v_add_f32 v108, 1.0, v108
    v_add_f32 v109, 1.0, v109
    v_add_f32 v110, 1.0, v110
    v_add_f32 v111, 1.0, v111
    v_rcp_f32 v104, v104
    v_rcp_f32 v105, v105
    v_rcp_f32 v106, v106
    v_rcp_f32 v107, v107
    v_rcp_f32 v108, v108
    v_rcp_f32 v109, v109
    v_rcp_f32 v110, v110
    v_rcp_f32 v111, v111
    v_mul_f32 v160, v160, v104
    v_mul_f32 v161, v161, v105
    v_mul_f32 v162, v162, v106
    v_mul_f32 v163, v163, v107
    v_mul_f32 v164, v164, v108
    v_mul_f32 v165, v165, v109
    v_mul_f32 v166, v166, v110
    v_mul_f32 v167, v167, v111
    v_cvt_pk_bf16_f32 v80, v160, v161
    v_cvt_pk_bf16_f32 v81, v162, v163
    v_cvt_pk_bf16_f32 v82, v164, v165
    v_cvt_pk_bf16_f32 v83, v166, v167
    buffer_store_dwordx4 v[80:83], v1, s[4:7], s30 offen sc1
    v_cvt_pk_bf16_f32 v84, v168, v169
    v_cvt_pk_bf16_f32 v85, v170, v171
    v_cvt_pk_bf16_f32 v86, v172, v173
    v_cvt_pk_bf16_f32 v87, v174, v175
    v_lshlrev_b32 v168, 16, v84
    v_and_b32 v169, 0xffff0000, v84
    v_lshlrev_b32 v170, 16, v85
    v_and_b32 v171, 0xffff0000, v85
    v_lshlrev_b32 v172, 16, v86
    v_and_b32 v173, 0xffff0000, v86
    v_lshlrev_b32 v174, 16, v87
    v_and_b32 v175, 0xffff0000, v87
    v_mul_f32 v96, s54, v168
    v_mul_f32 v97, s54, v169
    v_mul_f32 v98, s54, v170
    v_mul_f32 v99, s54, v171
    v_mul_f32 v100, s54, v172
    v_mul_f32 v101, s54, v173
    v_mul_f32 v102, s54, v174
    v_mul_f32 v103, s54, v175
    v_exp_f32 v96, v96
    v_exp_f32 v97, v97
    v_exp_f32 v98, v98
    v_exp_f32 v99, v99
    v_exp_f32 v100, v100
    v_exp_f32 v101, v101
    v_exp_f32 v102, v102
    v_exp_f32 v103, v103
    v_add_f32 v96, 1.0, v96
    v_add_f32 v97, 1.0, v97
    v_add_f32 v98, 1.0, v98
    v_add_f32 v99, 1.0, v99
    v_add_f32 v100, 1.0, v100
    v_add_f32 v101, 1.0, v101
    v_add_f32 v102, 1.0, v102
    v_add_f32 v103, 1.0, v103
    v_rcp_f32 v96, v96
    v_rcp_f32 v97, v97
    v_rcp_f32 v98, v98
    v_rcp_f32 v99, v99
    v_rcp_f32 v100, v100
    v_rcp_f32 v101, v101
    v_rcp_f32 v102, v102
    v_rcp_f32 v103, v103
    v_mul_f32 v168, v168, v96
    v_mul_f32 v169, v169, v97
    v_mul_f32 v170, v170, v98
    v_mul_f32 v171, v171, v99
    v_mul_f32 v172, v172, v100
    v_mul_f32 v173, v173, v101
    v_mul_f32 v174, v174, v102
    v_mul_f32 v175, v175, v103
    v_cvt_pk_bf16_f32 v84, v168, v169
    v_cvt_pk_bf16_f32 v85, v170, v171
    v_cvt_pk_bf16_f32 v86, v172, v173
    v_cvt_pk_bf16_f32 v87, v174, v175
    buffer_store_dwordx4 v[84:87], v19, s[4:7], s30 offen sc1
    s_add_u32 s30, s30, s50
    v_cvt_pk_bf16_f32 v88, v176, v177
    v_cvt_pk_bf16_f32 v89, v178, v179
    v_cvt_pk_bf16_f32 v90, v180, v181
    v_cvt_pk_bf16_f32 v91, v182, v183
    v_lshlrev_b32 v176, 16, v88
    v_and_b32 v177, 0xffff0000, v88
    v_lshlrev_b32 v178, 16, v89
    v_and_b32 v179, 0xffff0000, v89
    v_lshlrev_b32 v180, 16, v90
    v_and_b32 v181, 0xffff0000, v90
    v_lshlrev_b32 v182, 16, v91
    v_and_b32 v183, 0xffff0000, v91
    v_mul_f32 v104, s54, v176
    v_mul_f32 v105, s54, v177
    v_mul_f32 v106, s54, v178
    v_mul_f32 v107, s54, v179
    v_mul_f32 v108, s54, v180
    v_mul_f32 v109, s54, v181
    v_mul_f32 v110, s54, v182
    v_mul_f32 v111, s54, v183
    v_exp_f32 v104, v104
    v_exp_f32 v105, v105
    v_exp_f32 v106, v106
    v_exp_f32 v107, v107
    v_exp_f32 v108, v108
    v_exp_f32 v109, v109
    v_exp_f32 v110, v110
    v_exp_f32 v111, v111
    v_add_f32 v104, 1.0, v104
    v_add_f32 v105, 1.0, v105
    v_add_f32 v106, 1.0, v106
    v_add_f32 v107, 1.0, v107
    v_add_f32 v108, 1.0, v108
    v_add_f32 v109, 1.0, v109
    v_add_f32 v110, 1.0, v110
    v_add_f32 v111, 1.0, v111
    v_rcp_f32 v104, v104
    v_rcp_f32 v105, v105
    v_rcp_f32 v106, v106
    v_rcp_f32 v107, v107
    v_rcp_f32 v108, v108
    v_rcp_f32 v109, v109
    v_rcp_f32 v110, v110
    v_rcp_f32 v111, v111
    v_mul_f32 v176, v176, v104
    v_mul_f32 v177, v177, v105
    v_mul_f32 v178, v178, v106
    v_mul_f32 v179, v179, v107
    v_mul_f32 v180, v180, v108
    v_mul_f32 v181, v181, v109
    v_mul_f32 v182, v182, v110
    v_mul_f32 v183, v183, v111
    v_cvt_pk_bf16_f32 v88, v176, v177
    v_cvt_pk_bf16_f32 v89, v178, v179
    v_cvt_pk_bf16_f32 v90, v180, v181
    v_cvt_pk_bf16_f32 v91, v182, v183
    buffer_store_dwordx4 v[88:91], v1, s[4:7], s30 offen sc1
    v_cvt_pk_bf16_f32 v92, v184, v185
    v_cvt_pk_bf16_f32 v93, v186, v187
    v_cvt_pk_bf16_f32 v94, v188, v189
    v_cvt_pk_bf16_f32 v95, v190, v191
    v_lshlrev_b32 v184, 16, v92
    v_and_b32 v185, 0xffff0000, v92
    v_lshlrev_b32 v186, 16, v93
    v_and_b32 v187, 0xffff0000, v93
    v_lshlrev_b32 v188, 16, v94
    v_and_b32 v189, 0xffff0000, v94
    v_lshlrev_b32 v190, 16, v95
    v_and_b32 v191, 0xffff0000, v95
    v_mul_f32 v96, s54, v184
    v_mul_f32 v97, s54, v185
    v_mul_f32 v98, s54, v186
    v_mul_f32 v99, s54, v187
    v_mul_f32 v100, s54, v188
    v_mul_f32 v101, s54, v189
    v_mul_f32 v102, s54, v190
    v_mul_f32 v103, s54, v191
    v_exp_f32 v96, v96
    v_exp_f32 v97, v97
    v_exp_f32 v98, v98
    v_exp_f32 v99, v99
    v_exp_f32 v100, v100
    v_exp_f32 v101, v101
    v_exp_f32 v102, v102
    v_exp_f32 v103, v103
    v_add_f32 v96, 1.0, v96
    v_add_f32 v97, 1.0, v97
    v_add_f32 v98, 1.0, v98
    v_add_f32 v99, 1.0, v99
    v_add_f32 v100, 1.0, v100
    v_add_f32 v101, 1.0, v101
    v_add_f32 v102, 1.0, v102
    v_add_f32 v103, 1.0, v103
    v_rcp_f32 v96, v96
    v_rcp_f32 v97, v97
    v_rcp_f32 v98, v98
    v_rcp_f32 v99, v99
    v_rcp_f32 v100, v100
    v_rcp_f32 v101, v101
    v_rcp_f32 v102, v102
    v_rcp_f32 v103, v103
    v_mul_f32 v184, v184, v96
    v_mul_f32 v185, v185, v97
    v_mul_f32 v186, v186, v98
    v_mul_f32 v187, v187, v99
    v_mul_f32 v188, v188, v100
    v_mul_f32 v189, v189, v101
    v_mul_f32 v190, v190, v102
    v_mul_f32 v191, v191, v103
    v_cvt_pk_bf16_f32 v92, v184, v185
    v_cvt_pk_bf16_f32 v93, v186, v187
    v_cvt_pk_bf16_f32 v94, v188, v189
    v_cvt_pk_bf16_f32 v95, v190, v191
    buffer_store_dwordx4 v[92:95], v19, s[4:7], s30 offen sc1
    s_add_u32 s30, s30, s50
    v_cvt_pk_bf16_f32 v80, v192, v193
    v_cvt_pk_bf16_f32 v81, v194, v195
    v_cvt_pk_bf16_f32 v82, v196, v197
    v_cvt_pk_bf16_f32 v83, v198, v199
    v_lshlrev_b32 v192, 16, v80
    v_and_b32 v193, 0xffff0000, v80
    v_lshlrev_b32 v194, 16, v81
    v_and_b32 v195, 0xffff0000, v81
    v_lshlrev_b32 v196, 16, v82
    v_and_b32 v197, 0xffff0000, v82
    v_lshlrev_b32 v198, 16, v83
    v_and_b32 v199, 0xffff0000, v83
    v_mul_f32 v104, s54, v192
    v_mul_f32 v105, s54, v193
    v_mul_f32 v106, s54, v194
    v_mul_f32 v107, s54, v195
    v_mul_f32 v108, s54, v196
    v_mul_f32 v109, s54, v197
    v_mul_f32 v110, s54, v198
    v_mul_f32 v111, s54, v199
    v_exp_f32 v104, v104
    v_exp_f32 v105, v105
    v_exp_f32 v106, v106
    v_exp_f32 v107, v107
    v_exp_f32 v108, v108
    v_exp_f32 v109, v109
    v_exp_f32 v110, v110
    v_exp_f32 v111, v111
    v_add_f32 v104, 1.0, v104
    v_add_f32 v105, 1.0, v105
    v_add_f32 v106, 1.0, v106
    v_add_f32 v107, 1.0, v107
    v_add_f32 v108, 1.0, v108
    v_add_f32 v109, 1.0, v109
    v_add_f32 v110, 1.0, v110
    v_add_f32 v111, 1.0, v111
    v_rcp_f32 v104, v104
    v_rcp_f32 v105, v105
    v_rcp_f32 v106, v106
    v_rcp_f32 v107, v107
    v_rcp_f32 v108, v108
    v_rcp_f32 v109, v109
    v_rcp_f32 v110, v110
    v_rcp_f32 v111, v111
    v_mul_f32 v192, v192, v104
    v_mul_f32 v193, v193, v105
    v_mul_f32 v194, v194, v106
    v_mul_f32 v195, v195, v107
    v_mul_f32 v196, v196, v108
    v_mul_f32 v197, v197, v109
    v_mul_f32 v198, v198, v110
    v_mul_f32 v199, v199, v111
    v_cvt_pk_bf16_f32 v80, v192, v193
    v_cvt_pk_bf16_f32 v81, v194, v195
    v_cvt_pk_bf16_f32 v82, v196, v197
    v_cvt_pk_bf16_f32 v83, v198, v199
    buffer_store_dwordx4 v[80:83], v1, s[4:7], s30 offen sc1
    v_cvt_pk_bf16_f32 v84, v200, v201
    v_cvt_pk_bf16_f32 v85, v202, v203
    v_cvt_pk_bf16_f32 v86, v204, v205
    v_cvt_pk_bf16_f32 v87, v206, v207
    v_lshlrev_b32 v200, 16, v84
    v_and_b32 v201, 0xffff0000, v84
    v_lshlrev_b32 v202, 16, v85
    v_and_b32 v203, 0xffff0000, v85
    v_lshlrev_b32 v204, 16, v86
    v_and_b32 v205, 0xffff0000, v86
    v_lshlrev_b32 v206, 16, v87
    v_and_b32 v207, 0xffff0000, v87
    v_mul_f32 v96, s54, v200
    v_mul_f32 v97, s54, v201
    v_mul_f32 v98, s54, v202
    v_mul_f32 v99, s54, v203
    v_mul_f32 v100, s54, v204
    v_mul_f32 v101, s54, v205
    v_mul_f32 v102, s54, v206
    v_mul_f32 v103, s54, v207
    v_exp_f32 v96, v96
    v_exp_f32 v97, v97
    v_exp_f32 v98, v98
    v_exp_f32 v99, v99
    v_exp_f32 v100, v100
    v_exp_f32 v101, v101
    v_exp_f32 v102, v102
    v_exp_f32 v103, v103
    v_add_f32 v96, 1.0, v96
    v_add_f32 v97, 1.0, v97
    v_add_f32 v98, 1.0, v98
    v_add_f32 v99, 1.0, v99
    v_add_f32 v100, 1.0, v100
    v_add_f32 v101, 1.0, v101
    v_add_f32 v102, 1.0, v102
    v_add_f32 v103, 1.0, v103
    v_rcp_f32 v96, v96
    v_rcp_f32 v97, v97
    v_rcp_f32 v98, v98
    v_rcp_f32 v99, v99
    v_rcp_f32 v100, v100
    v_rcp_f32 v101, v101
    v_rcp_f32 v102, v102
    v_rcp_f32 v103, v103
    v_mul_f32 v200, v200, v96
    v_mul_f32 v201, v201, v97
    v_mul_f32 v202, v202, v98
    v_mul_f32 v203, v203, v99
    v_mul_f32 v204, v204, v100
    v_mul_f32 v205, v205, v101
    v_mul_f32 v206, v206, v102
    v_mul_f32 v207, v207, v103
    v_cvt_pk_bf16_f32 v84, v200, v201
    v_cvt_pk_bf16_f32 v85, v202, v203
    v_cvt_pk_bf16_f32 v86, v204, v205
    v_cvt_pk_bf16_f32 v87, v206, v207
    buffer_store_dwordx4 v[84:87], v19, s[4:7], s30 offen sc1
    s_add_u32 s30, s30, s50
    v_cvt_pk_bf16_f32 v88, v208, v209
    v_cvt_pk_bf16_f32 v89, v210, v211
    v_cvt_pk_bf16_f32 v90, v212, v213
    v_cvt_pk_bf16_f32 v91, v214, v215
    v_lshlrev_b32 v208, 16, v88
    v_and_b32 v209, 0xffff0000, v88
    v_lshlrev_b32 v210, 16, v89
    v_and_b32 v211, 0xffff0000, v89
    v_lshlrev_b32 v212, 16, v90
    v_and_b32 v213, 0xffff0000, v90
    v_lshlrev_b32 v214, 16, v91
    v_and_b32 v215, 0xffff0000, v91
    v_mul_f32 v104, s54, v208
    v_mul_f32 v105, s54, v209
    v_mul_f32 v106, s54, v210
    v_mul_f32 v107, s54, v211
    v_mul_f32 v108, s54, v212
    v_mul_f32 v109, s54, v213
    v_mul_f32 v110, s54, v214
    v_mul_f32 v111, s54, v215
    v_exp_f32 v104, v104
    v_exp_f32 v105, v105
    v_exp_f32 v106, v106
    v_exp_f32 v107, v107
    v_exp_f32 v108, v108
    v_exp_f32 v109, v109
    v_exp_f32 v110, v110
    v_exp_f32 v111, v111
    v_add_f32 v104, 1.0, v104
    v_add_f32 v105, 1.0, v105
    v_add_f32 v106, 1.0, v106
    v_add_f32 v107, 1.0, v107
    v_add_f32 v108, 1.0, v108
    v_add_f32 v109, 1.0, v109
    v_add_f32 v110, 1.0, v110
    v_add_f32 v111, 1.0, v111
    v_rcp_f32 v104, v104
    v_rcp_f32 v105, v105
    v_rcp_f32 v106, v106
    v_rcp_f32 v107, v107
    v_rcp_f32 v108, v108
    v_rcp_f32 v109, v109
    v_rcp_f32 v110, v110
    v_rcp_f32 v111, v111
    v_mul_f32 v208, v208, v104
    v_mul_f32 v209, v209, v105
    v_mul_f32 v210, v210, v106
    v_mul_f32 v211, v211, v107
    v_mul_f32 v212, v212, v108
    v_mul_f32 v213, v213, v109
    v_mul_f32 v214, v214, v110
    v_mul_f32 v215, v215, v111
    v_cvt_pk_bf16_f32 v88, v208, v209
    v_cvt_pk_bf16_f32 v89, v210, v211
    v_cvt_pk_bf16_f32 v90, v212, v213
    v_cvt_pk_bf16_f32 v91, v214, v215
    buffer_store_dwordx4 v[88:91], v1, s[4:7], s30 offen sc1
    v_cvt_pk_bf16_f32 v92, v216, v217
    v_cvt_pk_bf16_f32 v93, v218, v219
    v_cvt_pk_bf16_f32 v94, v220, v221
    v_cvt_pk_bf16_f32 v95, v222, v223
    v_lshlrev_b32 v216, 16, v92
    v_and_b32 v217, 0xffff0000, v92
    v_lshlrev_b32 v218, 16, v93
    v_and_b32 v219, 0xffff0000, v93
    v_lshlrev_b32 v220, 16, v94
    v_and_b32 v221, 0xffff0000, v94
    v_lshlrev_b32 v222, 16, v95
    v_and_b32 v223, 0xffff0000, v95
    v_mul_f32 v96, s54, v216
    v_mul_f32 v97, s54, v217
    v_mul_f32 v98, s54, v218
    v_mul_f32 v99, s54, v219
    v_mul_f32 v100, s54, v220
    v_mul_f32 v101, s54, v221
    v_mul_f32 v102, s54, v222
    v_mul_f32 v103, s54, v223
    v_exp_f32 v96, v96
    v_exp_f32 v97, v97
    v_exp_f32 v98, v98
    v_exp_f32 v99, v99
    v_exp_f32 v100, v100
    v_exp_f32 v101, v101
    v_exp_f32 v102, v102
    v_exp_f32 v103, v103
    v_add_f32 v96, 1.0, v96
    v_add_f32 v97, 1.0, v97
    v_add_f32 v98, 1.0, v98
    v_add_f32 v99, 1.0, v99
    v_add_f32 v100, 1.0, v100
    v_add_f32 v101, 1.0, v101
    v_add_f32 v102, 1.0, v102
    v_add_f32 v103, 1.0, v103
    v_rcp_f32 v96, v96
    v_rcp_f32 v97, v97
    v_rcp_f32 v98, v98
    v_rcp_f32 v99, v99
    v_rcp_f32 v100, v100
    v_rcp_f32 v101, v101
    v_rcp_f32 v102, v102
    v_rcp_f32 v103, v103
    v_mul_f32 v216, v216, v96
    v_mul_f32 v217, v217, v97
    v_mul_f32 v218, v218, v98
    v_mul_f32 v219, v219, v99
    v_mul_f32 v220, v220, v100
    v_mul_f32 v221, v221, v101
    v_mul_f32 v222, v222, v102
    v_mul_f32 v223, v223, v103
    v_cvt_pk_bf16_f32 v92, v216, v217
    v_cvt_pk_bf16_f32 v93, v218, v219
    v_cvt_pk_bf16_f32 v94, v220, v221
    v_cvt_pk_bf16_f32 v95, v222, v223
    buffer_store_dwordx4 v[92:95], v19, s[4:7], s30 offen sc1
    s_add_u32 s30, s30, s50
    v_cvt_pk_bf16_f32 v80, v224, v225
    v_cvt_pk_bf16_f32 v81, v226, v227
    v_cvt_pk_bf16_f32 v82, v228, v229
    v_cvt_pk_bf16_f32 v83, v230, v231
    v_lshlrev_b32 v224, 16, v80
    v_and_b32 v225, 0xffff0000, v80
    v_lshlrev_b32 v226, 16, v81
    v_and_b32 v227, 0xffff0000, v81
    v_lshlrev_b32 v228, 16, v82
    v_and_b32 v229, 0xffff0000, v82
    v_lshlrev_b32 v230, 16, v83
    v_and_b32 v231, 0xffff0000, v83
    v_mul_f32 v104, s54, v224
    v_mul_f32 v105, s54, v225
    v_mul_f32 v106, s54, v226
    v_mul_f32 v107, s54, v227
    v_mul_f32 v108, s54, v228
    v_mul_f32 v109, s54, v229
    v_mul_f32 v110, s54, v230
    v_mul_f32 v111, s54, v231
    v_exp_f32 v104, v104
    v_exp_f32 v105, v105
    v_exp_f32 v106, v106
    v_exp_f32 v107, v107
    v_exp_f32 v108, v108
    v_exp_f32 v109, v109
    v_exp_f32 v110, v110
    v_exp_f32 v111, v111
    v_add_f32 v104, 1.0, v104
    v_add_f32 v105, 1.0, v105
    v_add_f32 v106, 1.0, v106
    v_add_f32 v107, 1.0, v107
    v_add_f32 v108, 1.0, v108
    v_add_f32 v109, 1.0, v109
    v_add_f32 v110, 1.0, v110
    v_add_f32 v111, 1.0, v111
    v_rcp_f32 v104, v104
    v_rcp_f32 v105, v105
    v_rcp_f32 v106, v106
    v_rcp_f32 v107, v107
    v_rcp_f32 v108, v108
    v_rcp_f32 v109, v109
    v_rcp_f32 v110, v110
    v_rcp_f32 v111, v111
    v_mul_f32 v224, v224, v104
    v_mul_f32 v225, v225, v105
    v_mul_f32 v226, v226, v106
    v_mul_f32 v227, v227, v107
    v_mul_f32 v228, v228, v108
    v_mul_f32 v229, v229, v109
    v_mul_f32 v230, v230, v110
    v_mul_f32 v231, v231, v111
    v_cvt_pk_bf16_f32 v80, v224, v225
    v_cvt_pk_bf16_f32 v81, v226, v227
    v_cvt_pk_bf16_f32 v82, v228, v229
    v_cvt_pk_bf16_f32 v83, v230, v231
    buffer_store_dwordx4 v[80:83], v1, s[4:7], s30 offen sc1
    v_cvt_pk_bf16_f32 v84, v232, v233
    v_cvt_pk_bf16_f32 v85, v234, v235
    v_cvt_pk_bf16_f32 v86, v236, v237
    v_cvt_pk_bf16_f32 v87, v238, v239
    v_lshlrev_b32 v232, 16, v84
    v_and_b32 v233, 0xffff0000, v84
    v_lshlrev_b32 v234, 16, v85
    v_and_b32 v235, 0xffff0000, v85
    v_lshlrev_b32 v236, 16, v86
    v_and_b32 v237, 0xffff0000, v86
    v_lshlrev_b32 v238, 16, v87
    v_and_b32 v239, 0xffff0000, v87
    v_mul_f32 v96, s54, v232
    v_mul_f32 v97, s54, v233
    v_mul_f32 v98, s54, v234
    v_mul_f32 v99, s54, v235
    v_mul_f32 v100, s54, v236
    v_mul_f32 v101, s54, v237
    v_mul_f32 v102, s54, v238
    v_mul_f32 v103, s54, v239
    v_exp_f32 v96, v96
    v_exp_f32 v97, v97
    v_exp_f32 v98, v98
    v_exp_f32 v99, v99
    v_exp_f32 v100, v100
    v_exp_f32 v101, v101
    v_exp_f32 v102, v102
    v_exp_f32 v103, v103
    v_add_f32 v96, 1.0, v96
    v_add_f32 v97, 1.0, v97
    v_add_f32 v98, 1.0, v98
    v_add_f32 v99, 1.0, v99
    v_add_f32 v100, 1.0, v100
    v_add_f32 v101, 1.0, v101
    v_add_f32 v102, 1.0, v102
    v_add_f32 v103, 1.0, v103
    v_rcp_f32 v96, v96
    v_rcp_f32 v97, v97
    v_rcp_f32 v98, v98
    v_rcp_f32 v99, v99
    v_rcp_f32 v100, v100
    v_rcp_f32 v101, v101
    v_rcp_f32 v102, v102
    v_rcp_f32 v103, v103
    v_mul_f32 v232, v232, v96
    v_mul_f32 v233, v233, v97
    v_mul_f32 v234, v234, v98
    v_mul_f32 v235, v235, v99
    v_mul_f32 v236, v236, v100
    v_mul_f32 v237, v237, v101
    v_mul_f32 v238, v238, v102
    v_mul_f32 v239, v239, v103
    v_cvt_pk_bf16_f32 v84, v232, v233
    v_cvt_pk_bf16_f32 v85, v234, v235
    v_cvt_pk_bf16_f32 v86, v236, v237
    v_cvt_pk_bf16_f32 v87, v238, v239
    buffer_store_dwordx4 v[84:87], v19, s[4:7], s30 offen sc1
    s_add_u32 s30, s30, s50
    v_cvt_pk_bf16_f32 v88, v240, v241
    v_cvt_pk_bf16_f32 v89, v242, v243
    v_cvt_pk_bf16_f32 v90, v244, v245
    v_cvt_pk_bf16_f32 v91, v246, v247
    v_lshlrev_b32 v240, 16, v88
    v_and_b32 v241, 0xffff0000, v88
    v_lshlrev_b32 v242, 16, v89
    v_and_b32 v243, 0xffff0000, v89
    v_lshlrev_b32 v244, 16, v90
    v_and_b32 v245, 0xffff0000, v90
    v_lshlrev_b32 v246, 16, v91
    v_and_b32 v247, 0xffff0000, v91
    v_mul_f32 v104, s54, v240
    v_mul_f32 v105, s54, v241
    v_mul_f32 v106, s54, v242
    v_mul_f32 v107, s54, v243
    v_mul_f32 v108, s54, v244
    v_mul_f32 v109, s54, v245
    v_mul_f32 v110, s54, v246
    v_mul_f32 v111, s54, v247
    v_exp_f32 v104, v104
    v_exp_f32 v105, v105
    v_exp_f32 v106, v106
    v_exp_f32 v107, v107
    v_exp_f32 v108, v108
    v_exp_f32 v109, v109
    v_exp_f32 v110, v110
    v_exp_f32 v111, v111
    v_add_f32 v104, 1.0, v104
    v_add_f32 v105, 1.0, v105
    v_add_f32 v106, 1.0, v106
    v_add_f32 v107, 1.0, v107
    v_add_f32 v108, 1.0, v108
    v_add_f32 v109, 1.0, v109
    v_add_f32 v110, 1.0, v110
    v_add_f32 v111, 1.0, v111
    v_rcp_f32 v104, v104
    v_rcp_f32 v105, v105
    v_rcp_f32 v106, v106
    v_rcp_f32 v107, v107
    v_rcp_f32 v108, v108
    v_rcp_f32 v109, v109
    v_rcp_f32 v110, v110
    v_rcp_f32 v111, v111
    v_mul_f32 v240, v240, v104
    v_mul_f32 v241, v241, v105
    v_mul_f32 v242, v242, v106
    v_mul_f32 v243, v243, v107
    v_mul_f32 v244, v244, v108
    v_mul_f32 v245, v245, v109
    v_mul_f32 v246, v246, v110
    v_mul_f32 v247, v247, v111
    v_cvt_pk_bf16_f32 v88, v240, v241
    v_cvt_pk_bf16_f32 v89, v242, v243
    v_cvt_pk_bf16_f32 v90, v244, v245
    v_cvt_pk_bf16_f32 v91, v246, v247
    buffer_store_dwordx4 v[88:91], v1, s[4:7], s30 offen sc1
    v_cvt_pk_bf16_f32 v92, v248, v249
    v_cvt_pk_bf16_f32 v93, v250, v251
    v_cvt_pk_bf16_f32 v94, v252, v253
    v_cvt_pk_bf16_f32 v95, v254, v255
    v_lshlrev_b32 v248, 16, v92
    v_and_b32 v249, 0xffff0000, v92
    v_lshlrev_b32 v250, 16, v93
    v_and_b32 v251, 0xffff0000, v93
    v_lshlrev_b32 v252, 16, v94
    v_and_b32 v253, 0xffff0000, v94
    v_lshlrev_b32 v254, 16, v95
    v_and_b32 v255, 0xffff0000, v95
    v_mul_f32 v96, s54, v248
    v_mul_f32 v97, s54, v249
    v_mul_f32 v98, s54, v250
    v_mul_f32 v99, s54, v251
    v_mul_f32 v100, s54, v252
    v_mul_f32 v101, s54, v253
    v_mul_f32 v102, s54, v254
    v_mul_f32 v103, s54, v255
    v_exp_f32 v96, v96
    v_exp_f32 v97, v97
    v_exp_f32 v98, v98
    v_exp_f32 v99, v99
    v_exp_f32 v100, v100
    v_exp_f32 v101, v101
    v_exp_f32 v102, v102
    v_exp_f32 v103, v103
    v_add_f32 v96, 1.0, v96
    v_add_f32 v97, 1.0, v97
    v_add_f32 v98, 1.0, v98
    v_add_f32 v99, 1.0, v99
    v_add_f32 v100, 1.0, v100
    v_add_f32 v101, 1.0, v101
    v_add_f32 v102, 1.0, v102
    v_add_f32 v103, 1.0, v103
    v_rcp_f32 v96, v96
    v_rcp_f32 v97, v97
    v_rcp_f32 v98, v98
    v_rcp_f32 v99, v99
    v_rcp_f32 v100, v100
    v_rcp_f32 v101, v101
    v_rcp_f32 v102, v102
    v_rcp_f32 v103, v103
    v_mul_f32 v248, v248, v96
    v_mul_f32 v249, v249, v97
    v_mul_f32 v250, v250, v98
    v_mul_f32 v251, v251, v99
    v_mul_f32 v252, v252, v100
    v_mul_f32 v253, v253, v101
    v_mul_f32 v254, v254, v102
    v_mul_f32 v255, v255, v103
    v_cvt_pk_bf16_f32 v92, v248, v249
    v_cvt_pk_bf16_f32 v93, v250, v251
    v_cvt_pk_bf16_f32 v94, v252, v253
    v_cvt_pk_bf16_f32 v95, v254, v255
    buffer_store_dwordx4 v[92:95], v19, s[4:7], s30 offen sc1
    s_waitcnt lgkmcnt(0)
    v_or3_b32 v24, v24, v25, v26
    v_or3_b32 v28, v28, v29, v30
    v_or3_b32 v24, v24, v27, v31
    v_or_b32 v24, v24, v28
    s_mov_b32 s28, s51
    s_mov_b32 s57, s53
    v_readfirstlane_b32 s30, v24
    s_cmp_lg_u32 s30, 0
    s_cbranch_scc1 w_drain
    s_mov_b32 s48, s32
    s_cmp_ge_u32 s32, 4
    s_cselect_b32 s30, 2, 3
    s_lshl_b32 s30, s26, s30
    s_mul_i32 s30, s30, s43
    s_add_u32 s49, s42, s30
    s_mov_b32 s50, s43
    s_mov_b32 s51, s46
    s_mov_b32 s23, s41
    s_mov_b32 s53, s47
    s_nop 0
    s_load_dwordx16 s[32:47], s[24:25], 0
    s_add_u32 s24, s24, 64
    s_addc_u32 s25, s25, 0
    s_branch w_first16
w_firstH:
    s_waitcnt vmcnt(8)
    s_barrier
    s_add_u32 m0, s21, 0
    s_nop 0
    buffer_load_dwordx4 v1, s[4:7], s16 offen sc1 lds
    s_add_u32 s16, s16, s62
    s_add_u32 m0, s21, 1024
    s_nop 0
    buffer_load_dwordx4 v1, s[4:7], s17 offen sc1 lds
    s_add_u32 s17, s17, s62
    s_add_u32 m0, s22, 0
    s_nop 0
    buffer_load_dwordx4 v2, s[8:11], s18 offen lds
    s_add_u32 s18, s18, s20
    s_add_u32 m0, s22, 8192
    s_nop 0
    buffer_load_dwordx4 v2, s[12:15], s19 offen lds
    s_add_u32 s19, s19, s20
    v_mfma_f32_16x16x32_bf16 v[128:131], v[64:67], v[32:35], 0
    ds_read_b64_tr_b16 v[112:113], v8 offset:49152
    v_mfma_f32_16x16x32_bf16 v[132:135], v[68:71], v[32:35], 0
    ds_read_b64_tr_b16 v[114:115], v9 offset:49152
    v_mfma_f32_16x16x32_bf16 v[144:147], v[64:67], v[40:43], 0
    ds_read_b64_tr_b16 v[116:117], v10 offset:49152
    v_mfma_f32_16x16x32_bf16 v[148:151], v[68:71], v[40:43], 0
    ds_read_b64_tr_b16 v[118:119], v11 offset:49152
    v_mfma_f32_16x16x32_bf16 v[160:163], v[64:67], v[48:51], 0
    ds_read_b64_tr_b16 v[120:121], v8 offset:57344
    v_mfma_f32_16x16x32_bf16 v[164:167], v[68:71], v[48:51], 0
    ds_read_b64_tr_b16 v[122:123], v9 offset:57344
    v_mfma_f32_16x16x32_bf16 v[176:179], v[64:67], v[56:59], 0
    ds_read_b64_tr_b16 v[124:125], v10 offset:57344
    v_mfma_f32_16x16x32_bf16 v[180:183], v[68:71], v[56:59], 0
    ds_read_b64_tr_b16 v[126:127], v11 offset:57344
    v_mfma_f32_16x16x32_bf16 v[128:131], v[72:75], v[36:39], v[128:131]
    ds_read_b128 v[80:83], v5 offset:32768
    v_mfma_f32_16x16x32_bf16 v[132:135], v[76:79], v[36:39], v[132:135]
    ds_read_b128 v[84:87], v5 offset:33792
    v_mfma_f32_16x16x32_bf16 v[144:147], v[72:75], v[44:47], v[144:147]
    ds_read_b128 v[88:91], v5 offset:34816
    v_mfma_f32_16x16x32_bf16 v[148:151], v[76:79], v[44:47], v[148:151]
    ds_read_b128 v[92:95], v5 offset:35840
    v_mfma_f32_16x16x32_bf16 v[160:163], v[72:75], v[52:55], v[160:163]
    ds_read_b128 v[96:99], v5 offset:36864
    v_mfma_f32_16x16x32_bf16 v[164:167], v[76:79], v[52:55], v[164:167]
    ds_read_b128 v[100:103], v5 offset:37888
    v_mfma_f32_16x16x32_bf16 v[176:179], v[72:75], v[60:63], v[176:179]
    ds_read_b128 v[104:107], v5 offset:38912
    v_mfma_f32_16x16x32_bf16 v[180:183], v[76:79], v[60:63], v[180:183]
    ds_read_b128 v[108:111], v5 offset:39936
    s_waitcnt lgkmcnt(0)
    s_waitcnt vmcnt(8)
    s_barrier
    s_add_u32 m0, s21, 32768
    s_nop 0
    buffer_load_dwordx4 v1, s[4:7], s16 offen sc1 lds
    s_add_u32 s16, s16, s62
    s_add_u32 m0, s21, 33792
    s_nop 0
    buffer_load_dwordx4 v1, s[4:7], s17 offen sc1 lds
    s_add_u32 s17, s17, s62
    s_add_u32 m0, s22, 32768
    s_nop 0
    buffer_load_dwordx4 v2, s[8:11], s18 offen lds
    s_add_u32 s18, s18, s20
    s_add_u32 m0, s22, 40960
    s_nop 0
    buffer_load_dwordx4 v2, s[12:15], s19 offen lds
    s_add_u32 s19, s19, s20
    v_mfma_f32_16x16x32_bf16 v[128:131], v[112:115], v[80:83], v[128:131]
    ds_read_b64_tr_b16 v[64:65], v12 offset:16384
    v_mfma_f32_16x16x32_bf16 v[132:135], v[116:119], v[80:83], v[132:135]
    ds_read_b64_tr_b16 v[66:67], v13 offset:16384
    v_mfma_f32_16x16x32_bf16 v[144:147], v[112:115], v[88:91], v[144:147]
    ds_read_b64_tr_b16 v[68:69], v14 offset:16384
    v_mfma_f32_16x16x32_bf16 v[148:151], v[116:119], v[88:91], v[148:151]
    ds_read_b64_tr_b16 v[70:71], v15 offset:16384
    v_mfma_f32_16x16x32_bf16 v[160:163], v[112:115], v[96:99], v[160:163]
    ds_read_b64_tr_b16 v[72:73], v12 offset:24576
    v_mfma_f32_16x16x32_bf16 v[164:167], v[116:119], v[96:99], v[164:167]
    ds_read_b64_tr_b16 v[74:75], v13 offset:24576
    v_mfma_f32_16x16x32_bf16 v[176:179], v[112:115], v[104:107], v[176:179]
    ds_read_b64_tr_b16 v[76:77], v14 offset:24576
    v_mfma_f32_16x16x32_bf16 v[180:183], v[116:119], v[104:107], v[180:183]
    ds_read_b64_tr_b16 v[78:79], v15 offset:24576
    v_mfma_f32_16x16x32_bf16 v[128:131], v[120:123], v[84:87], v[128:131]
    ds_read_b128 v[32:35], v6 offset:0
    v_mfma_f32_16x16x32_bf16 v[132:135], v[124:127], v[84:87], v[132:135]
    ds_read_b128 v[36:39], v6 offset:1024
    v_mfma_f32_16x16x32_bf16 v[144:147], v[120:123], v[92:95], v[144:147]
    ds_read_b128 v[40:43], v6 offset:2048
    v_mfma_f32_16x16x32_bf16 v[148:151], v[124:127], v[92:95], v[148:151]
    ds_read_b128 v[44:47], v6 offset:3072
    v_mfma_f32_16x16x32_bf16 v[160:163], v[120:123], v[100:103], v[160:163]
    ds_read_b128 v[48:51], v6 offset:4096
    v_mfma_f32_16x16x32_bf16 v[164:167], v[124:127], v[100:103], v[164:167]
    ds_read_b128 v[52:55], v6 offset:5120
    v_mfma_f32_16x16x32_bf16 v[176:179], v[120:123], v[108:111], v[176:179]
    ds_read_b128 v[56:59], v6 offset:6144
    v_mfma_f32_16x16x32_bf16 v[180:183], v[124:127], v[108:111], v[180:183]
    ds_read_b128 v[60:63], v6 offset:7168
    s_waitcnt lgkmcnt(0)
    s_waitcnt vmcnt(8)
    s_barrier
    s_add_u32 m0, s21, 65536
    s_nop 0
    buffer_load_dwordx4 v1, s[4:7], s16 offen sc1 lds
    s_add_u32 s16, s16, s62
    s_add_u32 m0, s21, 66560
    s_nop 0
    buffer_load_dwordx4 v1, s[4:7], s17 offen sc1 lds
    s_add_u32 s17, s17, s62
    s_add_u32 m0, s22, 65536
    s_nop 0
    buffer_load_dwordx4 v2, s[8:11], s18 offen lds
    s_add_u32 s18, s18, s20
    s_add_u32 m0, s22, 73728
    s_nop 0
    buffer_load_dwordx4 v2, s[12:15], s19 offen lds
    s_add_u32 s19, s19, s20
    v_mfma_f32_16x16x32_bf16 v[128:131], v[64:67], v[32:35], v[128:131]
    ds_read_b64_tr_b16 v[112:113], v12 offset:49152
    v_mfma_f32_16x16x32_bf16 v[132:135], v[68:71], v[32:35], v[132:135]
    ds_read_b64_tr_b16 v[114:115], v13 offset:49152
    v_mfma_f32_16x16x32_bf16 v[144:147], v[64:67], v[40:43], v[144:147]
    ds_read_b64_tr_b16 v[116:117], v14 offset:49152
    v_mfma_f32_16x16x32_bf16 v[148:151], v[68:71], v[40:43], v[148:151]
    ds_read_b64_tr_b16 v[118:119], v15 offset:49152
    v_mfma_f32_16x16x32_bf16 v[160:163], v[64:67], v[48:51], v[160:163]
    ds_read_b64_tr_b16 v[120:121], v12 offset:57344
    v_mfma_f32_16x16x32_bf16 v[164:167], v[68:71], v[48:51], v[164:167]
    ds_read_b64_tr_b16 v[122:123], v13 offset:57344
    v_mfma_f32_16x16x32_bf16 v[176:179], v[64:67], v[56:59], v[176:179]
    ds_read_b64_tr_b16 v[124:125], v14 offset:57344
    v_mfma_f32_16x16x32_bf16 v[180:183], v[68:71], v[56:59], v[180:183]
    ds_read_b64_tr_b16 v[126:127], v15 offset:57344
    v_mfma_f32_16x16x32_bf16 v[128:131], v[72:75], v[36:39], v[128:131]
    ds_read_b128 v[80:83], v6 offset:32768
    v_mfma_f32_16x16x32_bf16 v[132:135], v[76:79], v[36:39], v[132:135]
    ds_read_b128 v[84:87], v6 offset:33792
    v_mfma_f32_16x16x32_bf16 v[144:147], v[72:75], v[44:47], v[144:147]
    ds_read_b128 v[88:91], v6 offset:34816
    v_mfma_f32_16x16x32_bf16 v[148:151], v[76:79], v[44:47], v[148:151]
    ds_read_b128 v[92:95], v6 offset:35840
    v_mfma_f32_16x16x32_bf16 v[160:163], v[72:75], v[52:55], v[160:163]
    ds_read_b128 v[96:99], v6 offset:36864
    v_mfma_f32_16x16x32_bf16 v[164:167], v[76:79], v[52:55], v[164:167]
    ds_read_b128 v[100:103], v6 offset:37888
    v_mfma_f32_16x16x32_bf16 v[176:179], v[72:75], v[60:63], v[176:179]
    ds_read_b128 v[104:107], v6 offset:38912
    v_mfma_f32_16x16x32_bf16 v[180:183], v[76:79], v[60:63], v[180:183]
    ds_read_b128 v[108:111], v6 offset:39936
    s_waitcnt lgkmcnt(0)
    s_waitcnt vmcnt(8)
    s_barrier
    s_add_u32 m0, s21, 98304
    s_nop 0
    buffer_load_dwordx4 v1, s[4:7], s16 offen sc1 lds
    s_add_u32 s16, s16, s62
    s_add_u32 m0, s21, 99328
    s_nop 0
    buffer_load_dwordx4 v1, s[4:7], s17 offen sc1 lds
    s_add_u32 s17, s17, s62
    s_add_u32 m0, s22, 98304
    s_nop 0
    buffer_load_dwordx4 v2, s[8:11], s18 offen lds
    s_add_u32 s18, s18, s20
    s_add_u32 m0, s22, 106496
    s_nop 0
    buffer_load_dwordx4 v2, s[12:15], s19 offen lds
    s_add_u32 s19, s19, s20
    v_mfma_f32_16x16x32_bf16 v[128:131], v[112:115], v[80:83], v[128:131]
    ds_read_b64_tr_b16 v[64:65], v8 offset:16384
    v_mfma_f32_16x16x32_bf16 v[132:135], v[116:119], v[80:83], v[132:135]
    ds_read_b64_tr_b16 v[66:67], v9 offset:16384
    v_mfma_f32_16x16x32_bf16 v[144:147], v[112:115], v[88:91], v[144:147]
    ds_read_b64_tr_b16 v[68:69], v10 offset:16384
    v_mfma_f32_16x16x32_bf16 v[148:151], v[116:119], v[88:91], v[148:151]
    ds_read_b64_tr_b16 v[70:71], v11 offset:16384
    v_mfma_f32_16x16x32_bf16 v[160:163], v[112:115], v[96:99], v[160:163]
    ds_read_b64_tr_b16 v[72:73], v8 offset:24576
    v_mfma_f32_16x16x32_bf16 v[164:167], v[116:119], v[96:99], v[164:167]
    ds_read_b64_tr_b16 v[74:75], v9 offset:24576
    v_mfma_f32_16x16x32_bf16 v[176:179], v[112:115], v[104:107], v[176:179]
    ds_read_b64_tr_b16 v[76:77], v10 offset:24576
    v_mfma_f32_16x16x32_bf16 v[180:183], v[116:119], v[104:107], v[180:183]
    ds_read_b64_tr_b16 v[78:79], v11 offset:24576
    v_mfma_f32_16x16x32_bf16 v[128:131], v[120:123], v[84:87], v[128:131]
    ds_read_b128 v[32:35], v5 offset:0
    v_mfma_f32_16x16x32_bf16 v[132:135], v[124:127], v[84:87], v[132:135]
    ds_read_b128 v[36:39], v5 offset:1024
    v_mfma_f32_16x16x32_bf16 v[144:147], v[120:123], v[92:95], v[144:147]
    ds_read_b128 v[40:43], v5 offset:2048
    v_mfma_f32_16x16x32_bf16 v[148:151], v[124:127], v[92:95], v[148:151]
    ds_read_b128 v[44:47], v5 offset:3072
    v_mfma_f32_16x16x32_bf16 v[160:163], v[120:123], v[100:103], v[160:163]
    ds_read_b128 v[48:51], v5 offset:4096
    v_mfma_f32_16x16x32_bf16 v[164:167], v[124:127], v[100:103], v[164:167]
    ds_read_b128 v[52:55], v5 offset:5120
    v_mfma_f32_16x16x32_bf16 v[176:179], v[120:123], v[108:111], v[176:179]
    ds_read_b128 v[56:59], v5 offset:6144
    v_mfma_f32_16x16x32_bf16 v[180:183], v[124:127], v[108:111], v[180:183]
    ds_read_b128 v[60:63], v5 offset:7168
    s_waitcnt lgkmcnt(0)
w_loop_chkH:
    s_sub_u32 s23, s23, 1
w_loopH:
    s_cmp_lg_u32 s23, 1
    s_cbranch_scc1 w_bodyH
    buffer_load_dword v22, off, s[64:67], 0 sc1
    v_readfirstlane_b32 s30, v16
    s_cmp_ge_u32 s30, s45
    s_cselect_b32 s30, 0, 1
    s_or_b32 s30, s30, s70
    s_cmp_ge_u32 s32, 4
    s_cselect_b32 s30, 1, s30
    s_cmp_eq_u32 s32, 0
    s_cselect_b32 s30, 1, s30
    v_mov_b32 v20, s30
    ds_write_b32 v7, v20
    s_cbranch_scc1 w_ndH
    s_cmp_ge_u32 s32, 4
    s_cbranch_scc1 w_ndH
    s_cmp_lg_u32 s70, 0
    s_cbranch_scc1 w_ndH
    s_load_dwordx2 s[8:9], s[0:1], s33
    s_load_dwordx2 s[12:13], s[0:1], s34
    s_mov_b32 s10, s38
    s_mov_b32 s14, s38
    s_cmp_ge_u32 s32, 4
    s_cselect_b32 s31, 0, 1
    s_lshl_b32 s30, s3, s31
    s_mul_i32 s30, s30, s40
    s_add_u32 s16, s39, s30
    s_cmp_eq_u32 s32, 4
    s_cselect_b32 s30, 1024, s40
    s_cselect_b32 s31, 6, 5
    s_lshl_b32 s62, 32, s31
    s_add_u32 s17, s16, s30
    s_lshl_b32 s30, s3, 2
    s_mul_i32 s30, s30, s35
    s_add_u32 s18, s36, s30
    s_add_u32 s19, s37, s30
    s_lshl_b32 s20, s35, s31
    v_mul_u32_u24 v2, s35, v4
    v_add_u32 v2, v2, v3
    s_waitcnt lgkmcnt(0)
w_bodyH:
    s_waitcnt vmcnt(8)
    s_barrier
    s_add_u32 m0, s21, 0
    s_nop 0
    buffer_load_dwordx4 v1, s[4:7], s16 offen sc1 lds
    s_add_u32 s16, s16, s62
    s_add_u32 m0, s21, 1024
    s_nop 0
    buffer_load_dwordx4 v1, s[4:7], s17 offen sc1 lds
    s_add_u32 s17, s17, s62
    s_add_u32 m0, s22, 0
    s_nop 0
    buffer_load_dwordx4 v2, s[8:11], s18 offen lds
    s_add_u32 s18, s18, s20
    s_add_u32 m0, s22, 8192
    s_nop 0
    buffer_load_dwordx4 v2, s[12:15], s19 offen lds
    s_add_u32 s19, s19, s20
    v_mfma_f32_16x16x32_bf16 v[128:131], v[64:67], v[32:35], v[128:131]
    ds_read_b64_tr_b16 v[112:113], v8 offset:49152
    v_mfma_f32_16x16x32_bf16 v[132:135], v[68:71], v[32:35], v[132:135]
    ds_read_b64_tr_b16 v[114:115], v9 offset:49152
    v_mfma_f32_16x16x32_bf16 v[144:147], v[64:67], v[40:43], v[144:147]
    ds_read_b64_tr_b16 v[116:117], v10 offset:49152
    v_mfma_f32_16x16x32_bf16 v[148:151], v[68:71], v[40:43], v[148:151]
    ds_read_b64_tr_b16 v[118:119], v11 offset:49152
    v_mfma_f32_16x16x32_bf16 v[160:163], v[64:67], v[48:51], v[160:163]
    ds_read_b64_tr_b16 v[120:121], v8 offset:57344
    v_mfma_f32_16x16x32_bf16 v[164:167], v[68:71], v[48:51], v[164:167]
    ds_read_b64_tr_b16 v[122:123], v9 offset:57344
    v_mfma_f32_16x16x32_bf16 v[176:179], v[64:67], v[56:59], v[176:179]
    ds_read_b64_tr_b16 v[124:125], v10 offset:57344
    v_mfma_f32_16x16x32_bf16 v[180:183], v[68:71], v[56:59], v[180:183]
    ds_read_b64_tr_b16 v[126:127], v11 offset:57344
    v_mfma_f32_16x16x32_bf16 v[128:131], v[72:75], v[36:39], v[128:131]
    ds_read_b128 v[80:83], v5 offset:32768
    v_mfma_f32_16x16x32_bf16 v[132:135], v[76:79], v[36:39], v[132:135]
    ds_read_b128 v[84:87], v5 offset:33792
    v_mfma_f32_16x16x32_bf16 v[144:147], v[72:75], v[44:47], v[144:147]
    ds_read_b128 v[88:91], v5 offset:34816
    v_mfma_f32_16x16x32_bf16 v[148:151], v[76:79], v[44:47], v[148:151]
    ds_read_b128 v[92:95], v5 offset:35840
    v_mfma_f32_16x16x32_bf16 v[160:163], v[72:75], v[52:55], v[160:163]
    ds_read_b128 v[96:99], v5 offset:36864
    v_mfma_f32_16x16x32_bf16 v[164:167], v[76:79], v[52:55], v[164:167]
    ds_read_b128 v[100:103], v5 offset:37888
    v_mfma_f32_16x16x32_bf16 v[176:179], v[72:75], v[60:63], v[176:179]
    ds_read_b128 v[104:107], v5 offset:38912
    v_mfma_f32_16x16x32_bf16 v[180:183], v[76:79], v[60:63], v[180:183]
    ds_read_b128 v[108:111], v5 offset:39936
    buffer_load_dword v16, v17, s[4:7], s44 offen sc1
    s_waitcnt lgkmcnt(0)
    s_waitcnt vmcnt(8)
    s_barrier
    s_add_u32 m0, s21, 32768
    s_nop 0
    buffer_load_dwordx4 v1, s[4:7], s16 offen sc1 lds
    s_add_u32 s16, s16, s62
    s_add_u32 m0, s21, 33792
    s_nop 0
    buffer_load_dwordx4 v1, s[4:7], s17 offen sc1 lds
    s_add_u32 s17, s17, s62
    s_add_u32 m0, s22, 32768
    s_nop 0
    buffer_load_dwordx4 v2, s[8:11], s18 offen lds
    s_add_u32 s18, s18, s20
    s_add_u32 m0, s22, 40960
    s_nop 0
    buffer_load_dwordx4 v2, s[12:15], s19 offen lds
    s_add_u32 s19, s19, s20
    v_mfma_f32_16x16x32_bf16 v[128:131], v[112:115], v[80:83], v[128:131]
    ds_read_b64_tr_b16 v[64:65], v12 offset:16384
    v_mfma_f32_16x16x32_bf16 v[132:135], v[116:119], v[80:83], v[132:135]
    ds_read_b64_tr_b16 v[66:67], v13 offset:16384
    v_mfma_f32_16x16x32_bf16 v[144:147], v[112:115], v[88:91], v[144:147]
    ds_read_b64_tr_b16 v[68:69], v14 offset:16384
    v_mfma_f32_16x16x32_bf16 v[148:151], v[116:119], v[88:91], v[148:151]
    ds_read_b64_tr_b16 v[70:71], v15 offset:16384
    v_mfma_f32_16x16x32_bf16 v[160:163], v[112:115], v[96:99], v[160:163]
    ds_read_b64_tr_b16 v[72:73], v12 offset:24576
    v_mfma_f32_16x16x32_bf16 v[164:167], v[116:119], v[96:99], v[164:167]
    ds_read_b64_tr_b16 v[74:75], v13 offset:24576
    v_mfma_f32_16x16x32_bf16 v[176:179], v[112:115], v[104:107], v[176:179]
    ds_read_b64_tr_b16 v[76:77], v14 offset:24576
    v_mfma_f32_16x16x32_bf16 v[180:183], v[116:119], v[104:107], v[180:183]
    ds_read_b64_tr_b16 v[78:79], v15 offset:24576
    v_mfma_f32_16x16x32_bf16 v[128:131], v[120:123], v[84:87], v[128:131]
    ds_read_b128 v[32:35], v6 offset:0
    v_mfma_f32_16x16x32_bf16 v[132:135], v[124:127], v[84:87], v[132:135]
    ds_read_b128 v[36:39], v6 offset:1024
    v_mfma_f32_16x16x32_bf16 v[144:147], v[120:123], v[92:95], v[144:147]
    ds_read_b128 v[40:43], v6 offset:2048
    v_mfma_f32_16x16x32_bf16 v[148:151], v[124:127], v[92:95], v[148:151]
    ds_read_b128 v[44:47], v6 offset:3072
    v_mfma_f32_16x16x32_bf16 v[160:163], v[120:123], v[100:103], v[160:163]
    ds_read_b128 v[48:51], v6 offset:4096
    v_mfma_f32_16x16x32_bf16 v[164:167], v[124:127], v[100:103], v[164:167]
    ds_read_b128 v[52:55], v6 offset:5120
    v_mfma_f32_16x16x32_bf16 v[176:179], v[120:123], v[108:111], v[176:179]
    ds_read_b128 v[56:59], v6 offset:6144
    v_mfma_f32_16x16x32_bf16 v[180:183], v[124:127], v[108:111], v[180:183]
    ds_read_b128 v[60:63], v6 offset:7168
    s_waitcnt lgkmcnt(0)
    s_waitcnt vmcnt(8)
    s_barrier
    s_add_u32 m0, s21, 65536
    s_nop 0
    buffer_load_dwordx4 v1, s[4:7], s16 offen sc1 lds
    s_add_u32 s16, s16, s62
    s_add_u32 m0, s21, 66560
    s_nop 0
    buffer_load_dwordx4 v1, s[4:7], s17 offen sc1 lds
    s_add_u32 s17, s17, s62
    s_add_u32 m0, s22, 65536
    s_nop 0
    buffer_load_dwordx4 v2, s[8:11], s18 offen lds
    s_add_u32 s18, s18, s20
    s_add_u32 m0, s22, 73728
    s_nop 0
    buffer_load_dwordx4 v2, s[12:15], s19 offen lds
    s_add_u32 s19, s19, s20
    v_mfma_f32_16x16x32_bf16 v[128:131], v[64:67], v[32:35], v[128:131]
    ds_read_b64_tr_b16 v[112:113], v12 offset:49152
    v_mfma_f32_16x16x32_bf16 v[132:135], v[68:71], v[32:35], v[132:135]
    ds_read_b64_tr_b16 v[114:115], v13 offset:49152
    v_mfma_f32_16x16x32_bf16 v[144:147], v[64:67], v[40:43], v[144:147]
    ds_read_b64_tr_b16 v[116:117], v14 offset:49152
    v_mfma_f32_16x16x32_bf16 v[148:151], v[68:71], v[40:43], v[148:151]
    ds_read_b64_tr_b16 v[118:119], v15 offset:49152
    v_mfma_f32_16x16x32_bf16 v[160:163], v[64:67], v[48:51], v[160:163]
    ds_read_b64_tr_b16 v[120:121], v12 offset:57344
    v_mfma_f32_16x16x32_bf16 v[164:167], v[68:71], v[48:51], v[164:167]
    ds_read_b64_tr_b16 v[122:123], v13 offset:57344
    v_mfma_f32_16x16x32_bf16 v[176:179], v[64:67], v[56:59], v[176:179]
    ds_read_b64_tr_b16 v[124:125], v14 offset:57344
    v_mfma_f32_16x16x32_bf16 v[180:183], v[68:71], v[56:59], v[180:183]
    ds_read_b64_tr_b16 v[126:127], v15 offset:57344
    v_mfma_f32_16x16x32_bf16 v[128:131], v[72:75], v[36:39], v[128:131]
    ds_read_b128 v[80:83], v6 offset:32768
    v_mfma_f32_16x16x32_bf16 v[132:135], v[76:79], v[36:39], v[132:135]
    ds_read_b128 v[84:87], v6 offset:33792
    v_mfma_f32_16x16x32_bf16 v[144:147], v[72:75], v[44:47], v[144:147]
    ds_read_b128 v[88:91], v6 offset:34816
    v_mfma_f32_16x16x32_bf16 v[148:151], v[76:79], v[44:47], v[148:151]
    ds_read_b128 v[92:95], v6 offset:35840
    v_mfma_f32_16x16x32_bf16 v[160:163], v[72:75], v[52:55], v[160:163]
    ds_read_b128 v[96:99], v6 offset:36864
    v_mfma_f32_16x16x32_bf16 v[164:167], v[76:79], v[52:55], v[164:167]
    ds_read_b128 v[100:103], v6 offset:37888
    v_mfma_f32_16x16x32_bf16 v[176:179], v[72:75], v[60:63], v[176:179]
    ds_read_b128 v[104:107], v6 offset:38912
    v_mfma_f32_16x16x32_bf16 v[180:183], v[76:79], v[60:63], v[180:183]
    ds_read_b128 v[108:111], v6 offset:39936
    s_waitcnt lgkmcnt(0)
    s_waitcnt vmcnt(8)
    s_barrier
    s_add_u32 m0, s21, 98304
    s_nop 0
    buffer_load_dwordx4 v1, s[4:7], s16 offen sc1 lds
    s_add_u32 s16, s16, s62
    s_add_u32 m0, s21, 99328
    s_nop 0
    buffer_load_dwordx4 v1, s[4:7], s17 offen sc1 lds
    s_add_u32 s17, s17, s62
    s_add_u32 m0, s22, 98304
    s_nop 0
    buffer_load_dwordx4 v2, s[8:11], s18 offen lds
    s_add_u32 s18, s18, s20
    s_add_u32 m0, s22, 106496
    s_nop 0
    buffer_load_dwordx4 v2, s[12:15], s19 offen lds
    s_add_u32 s19, s19, s20
    v_mfma_f32_16x16x32_bf16 v[128:131], v[112:115], v[80:83], v[128:131]
    ds_read_b64_tr_b16 v[64:65], v8 offset:16384
    v_mfma_f32_16x16x32_bf16 v[132:135], v[116:119], v[80:83], v[132:135]
    ds_read_b64_tr_b16 v[66:67], v9 offset:16384
    v_mfma_f32_16x16x32_bf16 v[144:147], v[112:115], v[88:91], v[144:147]
    ds_read_b64_tr_b16 v[68:69], v10 offset:16384
    v_mfma_f32_16x16x32_bf16 v[148:151], v[116:119], v[88:91], v[148:151]
    ds_read_b64_tr_b16 v[70:71], v11 offset:16384
    v_mfma_f32_16x16x32_bf16 v[160:163], v[112:115], v[96:99], v[160:163]
    ds_read_b64_tr_b16 v[72:73], v8 offset:24576
    v_mfma_f32_16x16x32_bf16 v[164:167], v[116:119], v[96:99], v[164:167]
    ds_read_b64_tr_b16 v[74:75], v9 offset:24576
    v_mfma_f32_16x16x32_bf16 v[176:179], v[112:115], v[104:107], v[176:179]
    ds_read_b64_tr_b16 v[76:77], v10 offset:24576
    v_mfma_f32_16x16x32_bf16 v[180:183], v[116:119], v[104:107], v[180:183]
    ds_read_b64_tr_b16 v[78:79], v11 offset:24576
    v_mfma_f32_16x16x32_bf16 v[128:131], v[120:123], v[84:87], v[128:131]
    ds_read_b128 v[32:35], v5 offset:0
    v_mfma_f32_16x16x32_bf16 v[132:135], v[124:127], v[84:87], v[132:135]
    ds_read_b128 v[36:39], v5 offset:1024
    v_mfma_f32_16x16x32_bf16 v[144:147], v[120:123], v[92:95], v[144:147]
    ds_read_b128 v[40:43], v5 offset:2048
    v_mfma_f32_16x16x32_bf16 v[148:151], v[124:127], v[92:95], v[148:151]
    ds_read_b128 v[44:47], v5 offset:3072
    v_mfma_f32_16x16x32_bf16 v[160:163], v[120:123], v[100:103], v[160:163]
    ds_read_b128 v[48:51], v5 offset:4096
    v_mfma_f32_16x16x32_bf16 v[164:167], v[124:127], v[100:103], v[164:167]
    ds_read_b128 v[52:55], v5 offset:5120
    v_mfma_f32_16x16x32_bf16 v[176:179], v[120:123], v[108:111], v[176:179]
    ds_read_b128 v[56:59], v5 offset:6144
    v_mfma_f32_16x16x32_bf16 v[180:183], v[124:127], v[108:111], v[180:183]
    ds_read_b128 v[60:63], v5 offset:7168
    s_waitcnt lgkmcnt(0)
    s_sub_u32 s23, s23, 1
    s_cmp_lg_u32 s23, 0
    s_cbranch_scc1 w_loopH
    s_branch w_endH
w_ndH:
    s_waitcnt vmcnt(8)
    s_barrier
    v_mfma_f32_16x16x32_bf16 v[128:131], v[64:67], v[32:35], v[128:131]
    ds_read_b64_tr_b16 v[112:113], v8 offset:49152
    v_mfma_f32_16x16x32_bf16 v[132:135], v[68:71], v[32:35], v[132:135]
    ds_read_b64_tr_b16 v[114:115], v9 offset:49152
    v_mfma_f32_16x16x32_bf16 v[144:147], v[64:67], v[40:43], v[144:147]
    ds_read_b64_tr_b16 v[116:117], v10 offset:49152
    v_mfma_f32_16x16x32_bf16 v[148:151], v[68:71], v[40:43], v[148:151]
    ds_read_b64_tr_b16 v[118:119], v11 offset:49152
    v_mfma_f32_16x16x32_bf16 v[160:163], v[64:67], v[48:51], v[160:163]
    ds_read_b64_tr_b16 v[120:121], v8 offset:57344
    v_mfma_f32_16x16x32_bf16 v[164:167], v[68:71], v[48:51], v[164:167]
    ds_read_b64_tr_b16 v[122:123], v9 offset:57344
    v_mfma_f32_16x16x32_bf16 v[176:179], v[64:67], v[56:59], v[176:179]
    ds_read_b64_tr_b16 v[124:125], v10 offset:57344
    v_mfma_f32_16x16x32_bf16 v[180:183], v[68:71], v[56:59], v[180:183]
    ds_read_b64_tr_b16 v[126:127], v11 offset:57344
    v_mfma_f32_16x16x32_bf16 v[128:131], v[72:75], v[36:39], v[128:131]
    ds_read_b128 v[80:83], v5 offset:32768
    v_mfma_f32_16x16x32_bf16 v[132:135], v[76:79], v[36:39], v[132:135]
    ds_read_b128 v[84:87], v5 offset:33792
    v_mfma_f32_16x16x32_bf16 v[144:147], v[72:75], v[44:47], v[144:147]
    ds_read_b128 v[88:91], v5 offset:34816
    v_mfma_f32_16x16x32_bf16 v[148:151], v[76:79], v[44:47], v[148:151]
    ds_read_b128 v[92:95], v5 offset:35840
    v_mfma_f32_16x16x32_bf16 v[160:163], v[72:75], v[52:55], v[160:163]
    ds_read_b128 v[96:99], v5 offset:36864
    v_mfma_f32_16x16x32_bf16 v[164:167], v[76:79], v[52:55], v[164:167]
    ds_read_b128 v[100:103], v5 offset:37888
    v_mfma_f32_16x16x32_bf16 v[176:179], v[72:75], v[60:63], v[176:179]
    ds_read_b128 v[104:107], v5 offset:38912
    v_mfma_f32_16x16x32_bf16 v[180:183], v[76:79], v[60:63], v[180:183]
    ds_read_b128 v[108:111], v5 offset:39936
    s_waitcnt lgkmcnt(0)
    s_waitcnt vmcnt(4)
    s_barrier
    v_mfma_f32_16x16x32_bf16 v[128:131], v[112:115], v[80:83], v[128:131]
    ds_read_b64_tr_b16 v[64:65], v12 offset:16384
    v_mfma_f32_16x16x32_bf16 v[132:135], v[116:119], v[80:83], v[132:135]
    ds_read_b64_tr_b16 v[66:67], v13 offset:16384
    v_mfma_f32_16x16x32_bf16 v[144:147], v[112:115], v[88:91], v[144:147]
    ds_read_b64_tr_b16 v[68:69], v14 offset:16384
    v_mfma_f32_16x16x32_bf16 v[148:151], v[116:119], v[88:91], v[148:151]
    ds_read_b64_tr_b16 v[70:71], v15 offset:16384
    v_mfma_f32_16x16x32_bf16 v[160:163], v[112:115], v[96:99], v[160:163]
    ds_read_b64_tr_b16 v[72:73], v12 offset:24576
    v_mfma_f32_16x16x32_bf16 v[164:167], v[116:119], v[96:99], v[164:167]
    ds_read_b64_tr_b16 v[74:75], v13 offset:24576
    v_mfma_f32_16x16x32_bf16 v[176:179], v[112:115], v[104:107], v[176:179]
    ds_read_b64_tr_b16 v[76:77], v14 offset:24576
    v_mfma_f32_16x16x32_bf16 v[180:183], v[116:119], v[104:107], v[180:183]
    ds_read_b64_tr_b16 v[78:79], v15 offset:24576
    v_mfma_f32_16x16x32_bf16 v[128:131], v[120:123], v[84:87], v[128:131]
    ds_read_b128 v[32:35], v6 offset:0
    v_mfma_f32_16x16x32_bf16 v[132:135], v[124:127], v[84:87], v[132:135]
    ds_read_b128 v[36:39], v6 offset:1024
    v_mfma_f32_16x16x32_bf16 v[144:147], v[120:123], v[92:95], v[144:147]
    ds_read_b128 v[40:43], v6 offset:2048
    v_mfma_f32_16x16x32_bf16 v[148:151], v[124:127], v[92:95], v[148:151]
    ds_read_b128 v[44:47], v6 offset:3072
    v_mfma_f32_16x16x32_bf16 v[160:163], v[120:123], v[100:103], v[160:163]
    ds_read_b128 v[48:51], v6 offset:4096
    v_mfma_f32_16x16x32_bf16 v[164:167], v[124:127], v[100:103], v[164:167]
    ds_read_b128 v[52:55], v6 offset:5120
    v_mfma_f32_16x16x32_bf16 v[176:179], v[120:123], v[108:111], v[176:179]
    ds_read_b128 v[56:59], v6 offset:6144
    v_mfma_f32_16x16x32_bf16 v[180:183], v[124:127], v[108:111], v[180:183]
    ds_read_b128 v[60:63], v6 offset:7168
    s_waitcnt lgkmcnt(0)
    s_waitcnt vmcnt(0)
    s_barrier
    v_mfma_f32_16x16x32_bf16 v[128:131], v[64:67], v[32:35], v[128:131]
    ds_read_b64_tr_b16 v[112:113], v12 offset:49152
    v_mfma_f32_16x16x32_bf16 v[132:135], v[68:71], v[32:35], v[132:135]
    ds_read_b64_tr_b16 v[114:115], v13 offset:49152
    v_mfma_f32_16x16x32_bf16 v[144:147], v[64:67], v[40:43], v[144:147]
    ds_read_b64_tr_b16 v[116:117], v14 offset:49152
    v_mfma_f32_16x16x32_bf16 v[148:151], v[68:71], v[40:43], v[148:151]
    ds_read_b64_tr_b16 v[118:119], v15 offset:49152
    v_mfma_f32_16x16x32_bf16 v[160:163], v[64:67], v[48:51], v[160:163]
    ds_read_b64_tr_b16 v[120:121], v12 offset:57344
    v_mfma_f32_16x16x32_bf16 v[164:167], v[68:71], v[48:51], v[164:167]
    ds_read_b64_tr_b16 v[122:123], v13 offset:57344
    v_mfma_f32_16x16x32_bf16 v[176:179], v[64:67], v[56:59], v[176:179]
    ds_read_b64_tr_b16 v[124:125], v14 offset:57344
    v_mfma_f32_16x16x32_bf16 v[180:183], v[68:71], v[56:59], v[180:183]
    ds_read_b64_tr_b16 v[126:127], v15 offset:57344
    v_mfma_f32_16x16x32_bf16 v[128:131], v[72:75], v[36:39], v[128:131]
    ds_read_b128 v[80:83], v6 offset:32768
    v_mfma_f32_16x16x32_bf16 v[132:135], v[76:79], v[36:39], v[132:135]
    ds_read_b128 v[84:87], v6 offset:33792
    v_mfma_f32_16x16x32_bf16 v[144:147], v[72:75], v[44:47], v[144:147]
    ds_read_b128 v[88:91], v6 offset:34816
    v_mfma_f32_16x16x32_bf16 v[148:151], v[76:79], v[44:47], v[148:151]
    ds_read_b128 v[92:95], v6 offset:35840
    v_mfma_f32_16x16x32_bf16 v[160:163], v[72:75], v[52:55], v[160:163]
    ds_read_b128 v[96:99], v6 offset:36864
    v_mfma_f32_16x16x32_bf16 v[164:167], v[76:79], v[52:55], v[164:167]
    ds_read_b128 v[100:103], v6 offset:37888
    v_mfma_f32_16x16x32_bf16 v[176:179], v[72:75], v[60:63], v[176:179]
    ds_read_b128 v[104:107], v6 offset:38912
    v_mfma_f32_16x16x32_bf16 v[180:183], v[76:79], v[60:63], v[180:183]
    ds_read_b128 v[108:111], v6 offset:39936
    s_waitcnt lgkmcnt(0)
    s_waitcnt vmcnt(0)
    s_barrier
    v_mfma_f32_16x16x32_bf16 v[128:131], v[112:115], v[80:83], v[128:131]
    ds_read_b64_tr_b16 v[64:65], v8 offset:16384
    v_mfma_f32_16x16x32_bf16 v[132:135], v[116:119], v[80:83], v[132:135]
    ds_read_b64_tr_b16 v[66:67], v9 offset:16384
    v_mfma_f32_16x16x32_bf16 v[144:147], v[112:115], v[88:91], v[144:147]
    ds_read_b64_tr_b16 v[68:69], v10 offset:16384
    v_mfma_f32_16x16x32_bf16 v[148:151], v[116:119], v[88:91], v[148:151]
    ds_read_b64_tr_b16 v[70:71], v11 offset:16384
    v_mfma_f32_16x16x32_bf16 v[160:163], v[112:115], v[96:99], v[160:163]
    ds_read_b64_tr_b16 v[72:73], v8 offset:24576
    v_mfma_f32_16x16x32_bf16 v[164:167], v[116:119], v[96:99], v[164:167]
    ds_read_b64_tr_b16 v[74:75], v9 offset:24576
    v_mfma_f32_16x16x32_bf16 v[176:179], v[112:115], v[104:107], v[176:179]
    ds_read_b64_tr_b16 v[76:77], v10 offset:24576
    v_mfma_f32_16x16x32_bf16 v[180:183], v[116:119], v[104:107], v[180:183]
    ds_read_b64_tr_b16 v[78:79], v11 offset:24576
    v_mfma_f32_16x16x32_bf16 v[128:131], v[120:123], v[84:87], v[128:131]
    ds_read_b128 v[32:35], v5 offset:0
    v_mfma_f32_16x16x32_bf16 v[132:135], v[124:127], v[84:87], v[132:135]
    ds_read_b128 v[36:39], v5 offset:1024
    v_mfma_f32_16x16x32_bf16 v[144:147], v[120:123], v[92:95], v[144:147]
    ds_read_b128 v[40:43], v5 offset:2048
    v_mfma_f32_16x16x32_bf16 v[148:151], v[124:127], v[92:95], v[148:151]
    ds_read_b128 v[44:47], v5 offset:3072
    v_mfma_f32_16x16x32_bf16 v[160:163], v[120:123], v[100:103], v[160:163]
    ds_read_b128 v[48:51], v5 offset:4096
    v_mfma_f32_16x16x32_bf16 v[164:167], v[124:127], v[100:103], v[164:167]
    ds_read_b128 v[52:55], v5 offset:5120
    v_mfma_f32_16x16x32_bf16 v[176:179], v[120:123], v[108:111], v[176:179]
    ds_read_b128 v[56:59], v5 offset:6144
    v_mfma_f32_16x16x32_bf16 v[180:183], v[124:127], v[108:111], v[180:183]
    ds_read_b128 v[60:63], v5 offset:7168
    s_waitcnt lgkmcnt(0)
w_endH:
    v_mov_b32 v20, 131072
    ds_read_b128 v[24:27], v20
    ds_read_b128 v[28:31], v20 offset:16
    s_cmp_lg_u32 s53, s53
    s_cbranch_scc1 w_epi_siluH
    s_lshl_b32 s30, s27, 10
    s_add_u32 s30, s30, s49
    s_nop 7
    v_cvt_pk_bf16_f32 v80, v128, v129
    v_cvt_pk_bf16_f32 v81, v130, v131
    v_cvt_pk_bf16_f32 v82, v132, v133
    v_cvt_pk_bf16_f32 v83, v134, v135
    buffer_store_dwordx4 v[80:83], v1, s[4:7], s30 offen sc1
    s_add_u32 s30, s30, s50
    v_cvt_pk_bf16_f32 v84, v144, v145
    v_cvt_pk_bf16_f32 v85, v146, v147
    v_cvt_pk_bf16_f32 v86, v148, v149
    v_cvt_pk_bf16_f32 v87, v150, v151
    buffer_store_dwordx4 v[84:87], v1, s[4:7], s30 offen sc1
    s_add_u32 s30, s30, s50
    v_cvt_pk_bf16_f32 v88, v160, v161
    v_cvt_pk_bf16_f32 v89, v162, v163
    v_cvt_pk_bf16_f32 v90, v164, v165
    v_cvt_pk_bf16_f32 v91, v166, v167
    buffer_store_dwordx4 v[88:91], v1, s[4:7], s30 offen sc1
    s_add_u32 s30, s30, s50
    v_cvt_pk_bf16_f32 v92, v176, v177
    v_cvt_pk_bf16_f32 v93, v178, v179
    v_cvt_pk_bf16_f32 v94, v180, v181
    v_cvt_pk_bf16_f32 v95, v182, v183
    buffer_store_dwordx4 v[92:95], v1, s[4:7], s30 offen sc1
    s_add_u32 s30, s30, s50
    s_waitcnt lgkmcnt(0)
    v_or3_b32 v24, v24, v25, v26
    v_or3_b32 v28, v28, v29, v30
    v_or3_b32 v24, v24, v27, v31
    v_or_b32 v24, v24, v28
    s_mov_b32 s28, s51
    s_mov_b32 s57, s53
    v_readfirstlane_b32 s30, v24
    s_cmp_lg_u32 s30, 0
    s_cbranch_scc1 w_drain
    s_mov_b32 s48, s32
    s_cmp_ge_u32 s32, 4
    s_cselect_b32 s30, 2, 3
    s_lshl_b32 s30, s26, s30
    s_mul_i32 s30, s30, s43
    s_add_u32 s49, s42, s30
    s_mov_b32 s50, s43
    s_mov_b32 s51, s46
    s_mov_b32 s23, s41
    s_mov_b32 s53, s47
    s_nop 0
    s_load_dwordx16 s[32:47], s[24:25], 0
    s_add_u32 s24, s24, 64
    s_addc_u32 s25, s25, 0
    s_branch w_first4
w_epi_siluH:
    s_lshl_b32 s30, s27, 10
    s_add_u32 s30, s30, s49
    s_mov_b32 s54, 0xbfb8aa3b
    s_nop 7
    v_cvt_pk_bf16_f32 v80, v128, v129
    v_cvt_pk_bf16_f32 v81, v130, v131
    v_cvt_pk_bf16_f32 v82, v132, v133
    v_cvt_pk_bf16_f32 v83, v134, v135
    v_lshlrev_b32 v128, 16, v80
    v_and_b32 v129, 0xffff0000, v80
    v_lshlrev_b32 v130, 16, v81
    v_and_b32 v131, 0xffff0000, v81
    v_lshlrev_b32 v132, 16, v82
    v_and_b32 v133, 0xffff0000, v82
    v_lshlrev_b32 v134, 16, v83
    v_and_b32 v135, 0xffff0000, v83
    v_mul_f32 v104, s54, v128
    v_mul_f32 v105, s54, v129
    v_mul_f32 v106, s54, v130
    v_mul_f32 v107, s54, v131
    v_mul_f32 v108, s54, v132
    v_mul_f32 v109, s54, v133
    v_mul_f32 v110, s54, v134
    v_mul_f32 v111, s54, v135
    v_exp_f32 v104, v104
    v_exp_f32 v105, v105
    v_exp_f32 v106, v106
    v_exp_f32 v107, v107
    v_exp_f32 v108, v108
    v_exp_f32 v109, v109
    v_exp_f32 v110, v110
    v_exp_f32 v111, v111
    v_add_f32 v104, 1.0, v104
    v_add_f32 v105, 1.0, v105
    v_add_f32 v106, 1.0, v106
    v_add_f32 v107, 1.0, v107
    v_add_f32 v108, 1.0, v108
    v_add_f32 v109, 1.0, v109
    v_add_f32 v110, 1.0, v110
    v_add_f32 v111, 1.0, v111
    v_rcp_f32 v104, v104
    v_rcp_f32 v105, v105
    v_rcp_f32 v106, v106
    v_rcp_f32 v107, v107
    v_rcp_f32 v108, v108
    v_rcp_f32 v109, v109
    v_rcp_f32 v110, v110
    v_rcp_f32 v111, v111
    v_mul_f32 v128, v128, v104
    v_mul_f32 v129, v129, v105
    v_mul_f32 v130, v130, v106
    v_mul_f32 v131, v131, v107
    v_mul_f32 v132, v132, v108
    v_mul_f32 v133, v133, v109
    v_mul_f32 v134, v134, v110
    v_mul_f32 v135, v135, v111
    v_cvt_pk_bf16_f32 v80, v128, v129
    v_cvt_pk_bf16_f32 v81, v130, v131
    v_cvt_pk_bf16_f32 v82, v132, v133
    v_cvt_pk_bf16_f32 v83, v134, v135
    buffer_store_dwordx4 v[80:83], v1, s[4:7], s30 offen sc1
    s_add_u32 s30, s30, s50
    v_cvt_pk_bf16_f32 v84, v144, v145
    v_cvt_pk_bf16_f32 v85, v146, v147
    v_cvt_pk_bf16_f32 v86, v148, v149
    v_cvt_pk_bf16_f32 v87, v150, v151
    v_lshlrev_b32 v144, 16, v84
    v_and_b32 v145, 0xffff0000, v84
    v_lshlrev_b32 v146, 16, v85
    v_and_b32 v147, 0xffff0000, v85
    v_lshlrev_b32 v148, 16, v86
    v_and_b32 v149, 0xffff0000, v86
    v_lshlrev_b32 v150, 16, v87
    v_and_b32 v151, 0xffff0000, v87
    v_mul_f32 v96, s54, v144
    v_mul_f32 v97, s54, v145
    v_mul_f32 v98, s54, v146
    v_mul_f32 v99, s54, v147
    v_mul_f32 v100, s54, v148
    v_mul_f32 v101, s54, v149
    v_mul_f32 v102, s54, v150
    v_mul_f32 v103, s54, v151
    v_exp_f32 v96, v96
    v_exp_f32 v97, v97
    v_exp_f32 v98, v98
    v_exp_f32 v99, v99
    v_exp_f32 v100, v100
    v_exp_f32 v101, v101
    v_exp_f32 v102, v102
    v_exp_f32 v103, v103
    v_add_f32 v96, 1.0, v96
    v_add_f32 v97, 1.0, v97
    v_add_f32 v98, 1.0, v98
    v_add_f32 v99, 1.0, v99
    v_add_f32 v100, 1.0, v100
    v_add_f32 v101, 1.0, v101
    v_add_f32 v102, 1.0, v102
    v_add_f32 v103, 1.0, v103
    v_rcp_f32 v96, v96
    v_rcp_f32 v97, v97
    v_rcp_f32 v98, v98
    v_rcp_f32 v99, v99
    v_rcp_f32 v100, v100
    v_rcp_f32 v101, v101
    v_rcp_f32 v102, v102
    v_rcp_f32 v103, v103
    v_mul_f32 v144, v144, v96
    v_mul_f32 v145, v145, v97
    v_mul_f32 v146, v146, v98
    v_mul_f32 v147, v147, v99
    v_mul_f32 v148, v148, v100
    v_mul_f32 v149, v149, v101
    v_mul_f32 v150, v150, v102
    v_mul_f32 v151, v151, v103
    v_cvt_pk_bf16_f32 v84, v144, v145
    v_cvt_pk_bf16_f32 v85, v146, v147
    v_cvt_pk_bf16_f32 v86, v148, v149
    v_cvt_pk_bf16_f32 v87, v150, v151
    buffer_store_dwordx4 v[84:87], v1, s[4:7], s30 offen sc1
    s_add_u32 s30, s30, s50
    v_cvt_pk_bf16_f32 v88, v160, v161
    v_cvt_pk_bf16_f32 v89, v162, v163
    v_cvt_pk_bf16_f32 v90, v164, v165
    v_cvt_pk_bf16_f32 v91, v166, v167
    v_lshlrev_b32 v160, 16, v88
    v_and_b32 v161, 0xffff0000, v88
    v_lshlrev_b32 v162, 16, v89
    v_and_b32 v163, 0xffff0000, v89
    v_lshlrev_b32 v164, 16, v90
    v_and_b32 v165, 0xffff0000, v90
    v_lshlrev_b32 v166, 16, v91
    v_and_b32 v167, 0xffff0000, v91
    v_mul_f32 v104, s54, v160
    v_mul_f32 v105, s54, v161
    v_mul_f32 v106, s54, v162
    v_mul_f32 v107, s54, v163
    v_mul_f32 v108, s54, v164
    v_mul_f32 v109, s54, v165
    v_mul_f32 v110, s54, v166
    v_mul_f32 v111, s54, v167
    v_exp_f32 v104, v104
    v_exp_f32 v105, v105
    v_exp_f32 v106, v106
    v_exp_f32 v107, v107
    v_exp_f32 v108, v108
    v_exp_f32 v109, v109
    v_exp_f32 v110, v110
    v_exp_f32 v111, v111
    v_add_f32 v104, 1.0, v104
    v_add_f32 v105, 1.0, v105
    v_add_f32 v106, 1.0, v106
    v_add_f32 v107, 1.0, v107
    v_add_f32 v108, 1.0, v108
    v_add_f32 v109, 1.0, v109
    v_add_f32 v110, 1.0, v110
    v_add_f32 v111, 1.0, v111
    v_rcp_f32 v104, v104
    v_rcp_f32 v105, v105
    v_rcp_f32 v106, v106
    v_rcp_f32 v107, v107
    v_rcp_f32 v108, v108
    v_rcp_f32 v109, v109
    v_rcp_f32 v110, v110
    v_rcp_f32 v111, v111
    v_mul_f32 v160, v160, v104
    v_mul_f32 v161, v161, v105
    v_mul_f32 v162, v162, v106
    v_mul_f32 v163, v163, v107
    v_mul_f32 v164, v164, v108
    v_mul_f32 v165, v165, v109
    v_mul_f32 v166, v166, v110
    v_mul_f32 v167, v167, v111
    v_cvt_pk_bf16_f32 v88, v160, v161
    v_cvt_pk_bf16_f32 v89, v162, v163
    v_cvt_pk_bf16_f32 v90, v164, v165
    v_cvt_pk_bf16_f32 v91, v166, v167
    buffer_store_dwordx4 v[88:91], v1, s[4:7], s30 offen sc1
    s_add_u32 s30, s30, s50
    v_cvt_pk_bf16_f32 v92, v176, v177
    v_cvt_pk_bf16_f32 v93, v178, v179
    v_cvt_pk_bf16_f32 v94, v180, v181
    v_cvt_pk_bf16_f32 v95, v182, v183
    v_lshlrev_b32 v176, 16, v92
    v_and_b32 v177, 0xffff0000, v92
    v_lshlrev_b32 v178, 16, v93
    v_and_b32 v179, 0xffff0000, v93
    v_lshlrev_b32 v180, 16, v94
    v_and_b32 v181, 0xffff0000, v94
    v_lshlrev_b32 v182, 16, v95
    v_and_b32 v183, 0xffff0000, v95
    v_mul_f32 v96, s54, v176
    v_mul_f32 v97, s54, v177
    v_mul_f32 v98, s54, v178
    v_mul_f32 v99, s54, v179
    v_mul_f32 v100, s54, v180
    v_mul_f32 v101, s54, v181
    v_mul_f32 v102, s54, v182
    v_mul_f32 v103, s54, v183
    v_exp_f32 v96, v96
    v_exp_f32 v97, v97
    v_exp_f32 v98, v98
    v_exp_f32 v99, v99
    v_exp_f32 v100, v100
    v_exp_f32 v101, v101
    v_exp_f32 v102, v102
    v_exp_f32 v103, v103
    v_add_f32 v96, 1.0, v96
    v_add_f32 v97, 1.0, v97
    v_add_f32 v98, 1.0, v98
    v_add_f32 v99, 1.0, v99
    v_add_f32 v100, 1.0, v100
    v_add_f32 v101, 1.0, v101
    v_add_f32 v102, 1.0, v102
    v_add_f32 v103, 1.0, v103
    v_rcp_f32 v96, v96
    v_rcp_f32 v97, v97
    v_rcp_f32 v98, v98
    v_rcp_f32 v99, v99
    v_rcp_f32 v100, v100
    v_rcp_f32 v101, v101
    v_rcp_f32 v102, v102
    v_rcp_f32 v103, v103
    v_mul_f32 v176, v176, v96
    v_mul_f32 v177, v177, v97
    v_mul_f32 v178, v178, v98
    v_mul_f32 v179, v179, v99
    v_mul_f32 v180, v180, v100
    v_mul_f32 v181, v181, v101
    v_mul_f32 v182, v182, v102
    v_mul_f32 v183, v183, v103
    v_cvt_pk_bf16_f32 v92, v176, v177
    v_cvt_pk_bf16_f32 v93, v178, v179
    v_cvt_pk_bf16_f32 v94, v180, v181
    v_cvt_pk_bf16_f32 v95, v182, v183
    buffer_store_dwordx4 v[92:95], v1, s[4:7], s30 offen sc1
    s_add_u32 s30, s30, s50
    s_waitcnt lgkmcnt(0)
    v_or3_b32 v24, v24, v25, v26
    v_or3_b32 v28, v28, v29, v30
    v_or3_b32 v24, v24, v27, v31
    v_or_b32 v24, v24, v28
    s_mov_b32 s28, s51
    s_mov_b32 s57, s53
    v_readfirstlane_b32 s30, v24
    s_cmp_lg_u32 s30, 0
    s_cbranch_scc1 w_drain
    s_mov_b32 s48, s32
    s_cmp_ge_u32 s32, 4
    s_cselect_b32 s30, 2, 3
    s_lshl_b32 s30, s26, s30
    s_mul_i32 s30, s30, s43
    s_add_u32 s49, s42, s30
    s_mov_b32 s50, s43
    s_mov_b32 s51, s46
    s_mov_b32 s23, s41
    s_mov_b32 s53, s47
    s_nop 0
    s_load_dwordx16 s[32:47], s[24:25], 0
    s_add_u32 s24, s24, 64
    s_addc_u32 s25, s25, 0
    s_branch w_first4
w_firstX:
    v_bfe_u32 v20, v1, 4, 3
    v_xor_b32 v21, v4, v20
    v_lshlrev_b32 v21, 4, v21
    v_lshl_add_u32 v21, v20, 7, v21
    v_bfe_u32 v20, v1, 7, 1
    v_lshl_add_u32 v21, v20, 10, v21
    s_lshl_b32 s30, s26, 13
    v_add_u32 v24, s30, v21
    v_xor_b32 v25, 64, v24
    v_add_u32 v26, 0x10000, v24
    v_add_u32 v27, 0x10000, v25
    ds_read_b64_tr_b16 v[64:65], v8 offset:16384
    ds_read_b64_tr_b16 v[66:67], v9 offset:16384
    ds_read_b64_tr_b16 v[68:69], v10 offset:16384
    ds_read_b64_tr_b16 v[70:71], v11 offset:16384
    ds_read_b64_tr_b16 v[72:73], v8 offset:24576
    ds_read_b64_tr_b16 v[74:75], v9 offset:24576
    ds_read_b64_tr_b16 v[76:77], v10 offset:24576
    ds_read_b64_tr_b16 v[78:79], v11 offset:24576
    ds_read_b128 v[32:35], v24 offset:0
    ds_read_b128 v[36:39], v25 offset:0
    ds_read_b128 v[40:43], v24 offset:2048
    ds_read_b128 v[44:47], v25 offset:2048
    ds_read_b128 v[48:51], v24 offset:4096
    ds_read_b128 v[52:55], v25 offset:4096
    ds_read_b128 v[56:59], v24 offset:6144
    ds_read_b128 v[60:63], v25 offset:6144
    v_mov_b32 v208, 0x3f803f80
    v_mov_b32 v209, 0x3f803f80
    v_mov_b32 v210, 0x3f803f80
    v_mov_b32 v211, 0x3f803f80
    s_waitcnt lgkmcnt(0)
    s_waitcnt vmcnt(8)
    s_barrier
    s_add_u32 m0, s21, 0
    s_nop 0
    buffer_load_dwordx4 v23, s[88:91], s16 offen lds
    s_add_u32 s16, s16, s62
    s_add_u32 m0, s21, 1024
    s_nop 0
    buffer_load_dwordx4 v23, s[88:91], s17 offen lds
    s_add_u32 s17, s17, s62
    s_add_u32 m0, s22, 0
    s_nop 0
    buffer_load_dwordx4 v2, s[8:11], s18 offen lds
    s_add_u32 s18, s18, s20
    s_add_u32 m0, s22, 8192
    s_nop 0
    buffer_load_dwordx4 v2, s[12:15], s19 offen lds
    s_add_u32 s19, s19, s20
    s_cmp_ge_u32 s16, s92
    s_cselect_b32 s94, 2048, 0
    s_cselect_b32 s95, s93, 0
    s_sub_u32 s16, s16, s94
    s_sub_u32 s17, s17, s94
    s_sub_u32 s18, s18, s95
    s_sub_u32 s19, s19, s95
    v_mfma_f32_16x16x32_bf16 v[128:131], v[64:67], v[32:35], 0
    ds_read_b64_tr_b16 v[112:113], v8 offset:49152
    v_mfma_f32_16x16x32_bf16 v[132:135], v[68:71], v[32:35], 0
    ds_read_b64_tr_b16 v[114:115], v9 offset:49152
    v_mfma_f32_16x16x32_bf16 v[144:147], v[64:67], v[40:43], 0
    ds_read_b64_tr_b16 v[116:117], v10 offset:49152
    v_mfma_f32_16x16x32_bf16 v[148:151], v[68:71], v[40:43], 0
    ds_read_b64_tr_b16 v[118:119], v11 offset:49152
    v_mfma_f32_16x16x32_bf16 v[160:163], v[64:67], v[48:51], 0
    ds_read_b64_tr_b16 v[120:121], v8 offset:57344
    v_mfma_f32_16x16x32_bf16 v[164:167], v[68:71], v[48:51], 0
    ds_read_b64_tr_b16 v[122:123], v9 offset:57344
    v_mfma_f32_16x16x32_bf16 v[176:179], v[64:67], v[56:59], 0
    ds_read_b64_tr_b16 v[124:125], v10 offset:57344
    v_mfma_f32_16x16x32_bf16 v[180:183], v[68:71], v[56:59], 0
    ds_read_b64_tr_b16 v[126:127], v11 offset:57344
    v_mfma_f32_16x16x32_bf16 v[192:195], v[64:67], v[208:211], 0
    ds_read_b128 v[80:83], v24 offset:32768
    v_mfma_f32_16x16x32_bf16 v[196:199], v[68:71], v[208:211], 0
    ds_read_b128 v[84:87], v25 offset:32768
    v_mfma_f32_16x16x32_bf16 v[128:131], v[72:75], v[36:39], v[128:131]
    ds_read_b128 v[88:91], v24 offset:34816
    v_mfma_f32_16x16x32_bf16 v[132:135], v[76:79], v[36:39], v[132:135]
    ds_read_b128 v[92:95], v25 offset:34816
    v_mfma_f32_16x16x32_bf16 v[144:147], v[72:75], v[44:47], v[144:147]
    ds_read_b128 v[96:99], v24 offset:36864
    v_mfma_f32_16x16x32_bf16 v[148:151], v[76:79], v[44:47], v[148:151]
    ds_read_b128 v[100:103], v25 offset:36864
    v_mfma_f32_16x16x32_bf16 v[160:163], v[72:75], v[52:55], v[160:163]
    ds_read_b128 v[104:107], v24 offset:38912
    v_mfma_f32_16x16x32_bf16 v[164:167], v[76:79], v[52:55], v[164:167]
    ds_read_b128 v[108:111], v25 offset:38912
    v_mfma_f32_16x16x32_bf16 v[176:179], v[72:75], v[60:63], v[176:179]
    v_mfma_f32_16x16x32_bf16 v[180:183], v[76:79], v[60:63], v[180:183]
    v_mfma_f32_16x16x32_bf16 v[192:195], v[72:75], v[208:211], v[192:195]
    v_mfma_f32_16x16x32_bf16 v[196:199], v[76:79], v[208:211], v[196:199]
    s_waitcnt lgkmcnt(0)
    s_waitcnt vmcnt(8)
    s_barrier
    s_add_u32 m0, s21, 32768
    s_nop 0
    buffer_load_dwordx4 v23, s[88:91], s16 offen lds
    s_add_u32 s16, s16, s62
    s_add_u32 m0, s21, 33792
    s_nop 0
    buffer_load_dwordx4 v23, s[88:91], s17 offen lds
    s_add_u32 s17, s17, s62
    s_add_u32 m0, s22, 32768
    s_nop 0
    buffer_load_dwordx4 v2, s[8:11], s18 offen lds
    s_add_u32 s18, s18, s20
    s_add_u32 m0, s22, 40960
    s_nop 0
    buffer_load_dwordx4 v2, s[12:15], s19 offen lds
    s_add_u32 s19, s19, s20
    s_cmp_ge_u32 s16, s92
    s_cselect_b32 s94, 2048, 0
    s_cselect_b32 s95, s93, 0
    s_sub_u32 s16, s16, s94
    s_sub_u32 s17, s17, s94
    s_sub_u32 s18, s18, s95
    s_sub_u32 s19, s19, s95
    v_mfma_f32_16x16x32_bf16 v[128:131], v[112:115], v[80:83], v[128:131]
    ds_read_b64_tr_b16 v[64:65], v12 offset:16384
    v_mfma_f32_16x16x32_bf16 v[132:135], v[116:119], v[80:83], v[132:135]
    ds_read_b64_tr_b16 v[66:67], v13 offset:16384
    v_mfma_f32_16x16x32_bf16 v[144:147], v[112:115], v[88:91], v[144:147]
    ds_read_b64_tr_b16 v[68:69], v14 offset:16384
    v_mfma_f32_16x16x32_bf16 v[148:151], v[116:119], v[88:91], v[148:151]
    ds_read_b64_tr_b16 v[70:71], v15 offset:16384
    v_mfma_f32_16x16x32_bf16 v[160:163], v[112:115], v[96:99], v[160:163]
    ds_read_b64_tr_b16 v[72:73], v12 offset:24576
    v_mfma_f32_16x16x32_bf16 v[164:167], v[116:119], v[96:99], v[164:167]
    ds_read_b64_tr_b16 v[74:75], v13 offset:24576
    v_mfma_f32_16x16x32_bf16 v[176:179], v[112:115], v[104:107], v[176:179]
    ds_read_b64_tr_b16 v[76:77], v14 offset:24576
    v_mfma_f32_16x16x32_bf16 v[180:183], v[116:119], v[104:107], v[180:183]
    ds_read_b64_tr_b16 v[78:79], v15 offset:24576
    v_mfma_f32_16x16x32_bf16 v[192:195], v[112:115], v[208:211], v[192:195]
    ds_read_b128 v[32:35], v26 offset:0
    v_mfma_f32_16x16x32_bf16 v[196:199], v[116:119], v[208:211], v[196:199]
    ds_read_b128 v[36:39], v27 offset:0
    v_mfma_f32_16x16x32_bf16 v[128:131], v[120:123], v[84:87], v[128:131]
    ds_read_b128 v[40:43], v26 offset:2048
    v_mfma_f32_16x16x32_bf16 v[132:135], v[124:127], v[84:87], v[132:135]
    ds_read_b128 v[44:47], v27 offset:2048
    v_mfma_f32_16x16x32_bf16 v[144:147], v[120:123], v[92:95], v[144:147]
    ds_read_b128 v[48:51], v26 offset:4096
    v_mfma_f32_16x16x32_bf16 v[148:151], v[124:127], v[92:95], v[148:151]
    ds_read_b128 v[52:55], v27 offset:4096
    v_mfma_f32_16x16x32_bf16 v[160:163], v[120:123], v[100:103], v[160:163]
    ds_read_b128 v[56:59], v26 offset:6144
    v_mfma_f32_16x16x32_bf16 v[164:167], v[124:127], v[100:103], v[164:167]
    ds_read_b128 v[60:63], v27 offset:6144
    v_mfma_f32_16x16x32_bf16 v[176:179], v[120:123], v[108:111], v[176:179]
    v_mfma_f32_16x16x32_bf16 v[180:183], v[124:127], v[108:111], v[180:183]
    v_mfma_f32_16x16x32_bf16 v[192:195], v[120:123], v[208:211], v[192:195]
    v_mfma_f32_16x16x32_bf16 v[196:199], v[124:127], v[208:211], v[196:199]
    s_waitcnt lgkmcnt(0)
    s_waitcnt vmcnt(8)
    s_barrier
    s_add_u32 m0, s21, 65536
    s_nop 0
    buffer_load_dwordx4 v23, s[88:91], s16 offen lds
    s_add_u32 s16, s16, s62
    s_add_u32 m0, s21, 66560
    s_nop 0
    buffer_load_dwordx4 v23, s[88:91], s17 offen lds
    s_add_u32 s17, s17, s62
    s_add_u32 m0, s22, 65536
    s_nop 0
    buffer_load_dwordx4 v2, s[8:11], s18 offen lds
    s_add_u32 s18, s18, s20
    s_add_u32 m0, s22, 73728
    s_nop 0
    buffer_load_dwordx4 v2, s[12:15], s19 offen lds
    s_add_u32 s19, s19, s20
    s_cmp_ge_u32 s16, s92
    s_cselect_b32 s94, 2048, 0
    s_cselect_b32 s95, s93, 0
    s_sub_u32 s16, s16, s94
    s_sub_u32 s17, s17, s94
    s_sub_u32 s18, s18, s95
    s_sub_u32 s19, s19, s95
    v_mfma_f32_16x16x32_bf16 v[128:131], v[64:67], v[32:35], v[128:131]
    ds_read_b64_tr_b16 v[112:113], v12 offset:49152
    v_mfma_f32_16x16x32_bf16 v[132:135], v[68:71], v[32:35], v[132:135]
    ds_read_b64_tr_b16 v[114:115], v13 offset:49152
    v_mfma_f32_16x16x32_bf16 v[144:147], v[64:67], v[40:43], v[144:147]
    ds_read_b64_tr_b16 v[116:117], v14 offset:49152
    v_mfma_f32_16x16x32_bf16 v[148:151], v[68:71], v[40:43], v[148:151]
    ds_read_b64_tr_b16 v[118:119], v15 offset:49152
    v_mfma_f32_16x16x32_bf16 v[160:163], v[64:67], v[48:51], v[160:163]
    ds_read_b64_tr_b16 v[120:121], v12 offset:57344
    v_mfma_f32_16x16x32_bf16 v[164:167], v[68:71], v[48:51], v[164:167]
    ds_read_b64_tr_b16 v[122:123], v13 offset:57344
    v_mfma_f32_16x16x32_bf16 v[176:179], v[64:67], v[56:59], v[176:179]
    ds_read_b64_tr_b16 v[124:125], v14 offset:57344
    v_mfma_f32_16x16x32_bf16 v[180:183], v[68:71], v[56:59], v[180:183]
    ds_read_b64_tr_b16 v[126:127], v15 offset:57344
    v_mfma_f32_16x16x32_bf16 v[192:195], v[64:67], v[208:211], v[192:195]
    ds_read_b128 v[80:83], v26 offset:32768
    v_mfma_f32_16x16x32_bf16 v[196:199], v[68:71], v[208:211], v[196:199]
    ds_read_b128 v[84:87], v27 offset:32768
    v_mfma_f32_16x16x32_bf16 v[128:131], v[72:75], v[36:39], v[128:131]
    ds_read_b128 v[88:91], v26 offset:34816
    v_mfma_f32_16x16x32_bf16 v[132:135], v[76:79], v[36:39], v[132:135]
    ds_read_b128 v[92:95], v27 offset:34816
    v_mfma_f32_16x16x32_bf16 v[144:147], v[72:75], v[44:47], v[144:147]
    ds_read_b128 v[96:99], v26 offset:36864
    v_mfma_f32_16x16x32_bf16 v[148:151], v[76:79], v[44:47], v[148:151]
    ds_read_b128 v[100:103], v27 offset:36864
    v_mfma_f32_16x16x32_bf16 v[160:163], v[72:75], v[52:55], v[160:163]
    ds_read_b128 v[104:107], v26 offset:38912
    v_mfma_f32_16x16x32_bf16 v[164:167], v[76:79], v[52:55], v[164:167]
    ds_read_b128 v[108:111], v27 offset:38912
    v_mfma_f32_16x16x32_bf16 v[176:179], v[72:75], v[60:63], v[176:179]
    v_mfma_f32_16x16x32_bf16 v[180:183], v[76:79], v[60:63], v[180:183]
    v_mfma_f32_16x16x32_bf16 v[192:195], v[72:75], v[208:211], v[192:195]
    v_mfma_f32_16x16x32_bf16 v[196:199], v[76:79], v[208:211], v[196:199]
    s_waitcnt lgkmcnt(0)
    s_waitcnt vmcnt(8)
    s_barrier
    s_add_u32 m0, s21, 98304
    s_nop 0
    buffer_load_dwordx4 v23, s[88:91], s16 offen lds
    s_add_u32 s16, s16, s62
    s_add_u32 m0, s21, 99328
    s_nop 0
    buffer_load_dwordx4 v23, s[88:91], s17 offen lds
    s_add_u32 s17, s17, s62
    s_add_u32 m0, s22, 98304
    s_nop 0
    buffer_load_dwordx4 v2, s[8:11], s18 offen lds
    s_add_u32 s18, s18, s20
    s_add_u32 m0, s22, 106496
    s_nop 0
    buffer_load_dwordx4 v2, s[12:15], s19 offen lds
    s_add_u32 s19, s19, s20
    s_cmp_ge_u32 s16, s92
    s_cselect_b32 s94, 2048, 0
    s_cselect_b32 s95, s93, 0
    s_sub_u32 s16, s16, s94
    s_sub_u32 s17, s17, s94
    s_sub_u32 s18, s18, s95
    s_sub_u32 s19, s19, s95
    v_mfma_f32_16x16x32_bf16 v[128:131], v[112:115], v[80:83], v[128:131]
    ds_read_b64_tr_b16 v[64:65], v8 offset:16384
    v_mfma_f32_16x16x32_bf16 v[132:135], v[116:119], v[80:83], v[132:135]
    ds_read_b64_tr_b16 v[66:67], v9 offset:16384
    v_mfma_f32_16x16x32_bf16 v[144:147], v[112:115], v[88:91], v[144:147]
    ds_read_b64_tr_b16 v[68:69], v10 offset:16384
    v_mfma_f32_16x16x32_bf16 v[148:151], v[116:119], v[88:91], v[148:151]
    ds_read_b64_tr_b16 v[70:71], v11 offset:16384
    v_mfma_f32_16x16x32_bf16 v[160:163], v[112:115], v[96:99], v[160:163]
    ds_read_b64_tr_b16 v[72:73], v8 offset:24576
    v_mfma_f32_16x16x32_bf16 v[164:167], v[116:119], v[96:99], v[164:167]
    ds_read_b64_tr_b16 v[74:75], v9 offset:24576
    v_mfma_f32_16x16x32_bf16 v[176:179], v[112:115], v[104:107], v[176:179]
    ds_read_b64_tr_b16 v[76:77], v10 offset:24576
    v_mfma_f32_16x16x32_bf16 v[180:183], v[116:119], v[104:107], v[180:183]
    ds_read_b64_tr_b16 v[78:79], v11 offset:24576
    v_mfma_f32_16x16x32_bf16 v[192:195], v[112:115], v[208:211], v[192:195]
    ds_read_b128 v[32:35], v24 offset:0
    v_mfma_f32_16x16x32_bf16 v[196:199], v[116:119], v[208:211], v[196:199]
    ds_read_b128 v[36:39], v25 offset:0
    v_mfma_f32_16x16x32_bf16 v[128:131], v[120:123], v[84:87], v[128:131]
    ds_read_b128 v[40:43], v24 offset:2048
    v_mfma_f32_16x16x32_bf16 v[132:135], v[124:127], v[84:87], v[132:135]
    ds_read_b128 v[44:47], v25 offset:2048
    v_mfma_f32_16x16x32_bf16 v[144:147], v[120:123], v[92:95], v[144:147]
    ds_read_b128 v[48:51], v24 offset:4096
    v_mfma_f32_16x16x32_bf16 v[148:151], v[124:127], v[92:95], v[148:151]
    ds_read_b128 v[52:55], v25 offset:4096
    v_mfma_f32_16x16x32_bf16 v[160:163], v[120:123], v[100:103], v[160:163]
    ds_read_b128 v[56:59], v24 offset:6144
    v_mfma_f32_16x16x32_bf16 v[164:167], v[124:127], v[100:103], v[164:167]
    ds_read_b128 v[60:63], v25 offset:6144
    v_mfma_f32_16x16x32_bf16 v[176:179], v[120:123], v[108:111], v[176:179]
    v_mfma_f32_16x16x32_bf16 v[180:183], v[124:127], v[108:111], v[180:183]
    v_mfma_f32_16x16x32_bf16 v[192:195], v[120:123], v[208:211], v[192:195]
    v_mfma_f32_16x16x32_bf16 v[196:199], v[124:127], v[208:211], v[196:199]
    s_waitcnt lgkmcnt(0)
    s_mov_b32 s23, 2
w_loopX:
    s_waitcnt vmcnt(8)
    s_barrier
    s_add_u32 m0, s21, 0
    s_nop 0
    buffer_load_dwordx4 v23, s[88:91], s16 offen lds
    s_add_u32 s16, s16, s62
    s_add_u32 m0, s21, 1024
    s_nop 0
    buffer_load_dwordx4 v23, s[88:91], s17 offen lds
    s_add_u32 s17, s17, s62
    s_add_u32 m0, s22, 0
    s_nop 0
    buffer_load_dwordx4 v2, s[8:11], s18 offen lds
    s_add_u32 s18, s18, s20
    s_add_u32 m0, s22, 8192
    s_nop 0
    buffer_load_dwordx4 v2, s[12:15], s19 offen lds
    s_add_u32 s19, s19, s20
    s_cmp_ge_u32 s16, s92
    s_cselect_b32 s94, 2048, 0
    s_cselect_b32 s95, s93, 0
    s_sub_u32 s16, s16, s94
    s_sub_u32 s17, s17, s94
    s_sub_u32 s18, s18, s95
    s_sub_u32 s19, s19, s95
    v_mfma_f32_16x16x32_bf16 v[128:131], v[64:67], v[32:35], v[128:131]
    ds_read_b64_tr_b16 v[112:113], v8 offset:49152
    v_mfma_f32_16x16x32_bf16 v[132:135], v[68:71], v[32:35], v[132:135]
    ds_read_b64_tr_b16 v[114:115], v9 offset:49152
    v_mfma_f32_16x16x32_bf16 v[144:147], v[64:67], v[40:43], v[144:147]
    ds_read_b64_tr_b16 v[116:117], v10 offset:49152
    v_mfma_f32_16x16x32_bf16 v[148:151], v[68:71], v[40:43], v[148:151]
    ds_read_b64_tr_b16 v[118:119], v11 offset:49152
    v_mfma_f32_16x16x32_bf16 v[160:163], v[64:67], v[48:51], v[160:163]
    ds_read_b64_tr_b16 v[120:121], v8 offset:57344
    v_mfma_f32_16x16x32_bf16 v[164:167], v[68:71], v[48:51], v[164:167]
    ds_read_b64_tr_b16 v[122:123], v9 offset:57344
    v_mfma_f32_16x16x32_bf16 v[176:179], v[64:67], v[56:59], v[176:179]
    ds_read_b64_tr_b16 v[124:125], v10 offset:57344
    v_mfma_f32_16x16x32_bf16 v[180:183], v[68:71], v[56:59], v[180:183]
    ds_read_b64_tr_b16 v[126:127], v11 offset:57344
    v_mfma_f32_16x16x32_bf16 v[192:195], v[64:67], v[208:211], v[192:195]
    ds_read_b128 v[80:83], v24 offset:32768
    v_mfma_f32_16x16x32_bf16 v[196:199], v[68:71], v[208:211], v[196:199]
    ds_read_b128 v[84:87], v25 offset:32768
    v_mfma_f32_16x16x32_bf16 v[128:131], v[72:75], v[36:39], v[128:131]
    ds_read_b128 v[88:91], v24 offset:34816
    v_mfma_f32_16x16x32_bf16 v[132:135], v[76:79], v[36:39], v[132:135]
    ds_read_b128 v[92:95], v25 offset:34816
    v_mfma_f32_16x16x32_bf16 v[144:147], v[72:75], v[44:47], v[144:147]
    ds_read_b128 v[96:99], v24 offset:36864
    v_mfma_f32_16x16x32_bf16 v[148:151], v[76:79], v[44:47], v[148:151]
    ds_read_b128 v[100:103], v25 offset:36864
    v_mfma_f32_16x16x32_bf16 v[160:163], v[72:75], v[52:55], v[160:163]
    ds_read_b128 v[104:107], v24 offset:38912
    v_mfma_f32_16x16x32_bf16 v[164:167], v[76:79], v[52:55], v[164:167]
    ds_read_b128 v[108:111], v25 offset:38912
    v_mfma_f32_16x16x32_bf16 v[176:179], v[72:75], v[60:63], v[176:179]
    v_mfma_f32_16x16x32_bf16 v[180:183], v[76:79], v[60:63], v[180:183]
    v_mfma_f32_16x16x32_bf16 v[192:195], v[72:75], v[208:211], v[192:195]
    v_mfma_f32_16x16x32_bf16 v[196:199], v[76:79], v[208:211], v[196:199]
    s_waitcnt lgkmcnt(0)
    s_waitcnt vmcnt(8)
    s_barrier
    s_add_u32 m0, s21, 32768
    s_nop 0
    buffer_load_dwordx4 v23, s[88:91], s16 offen lds
    s_add_u32 s16, s16, s62
    s_add_u32 m0, s21, 33792
    s_nop 0
    buffer_load_dwordx4 v23, s[88:91], s17 offen lds
    s_add_u32 s17, s17, s62
    s_add_u32 m0, s22, 32768
    s_nop 0
    buffer_load_dwordx4 v2, s[8:11], s18 offen lds
    s_add_u32 s18, s18, s20
    s_add_u32 m0, s22, 40960
    s_nop 0
    buffer_load_dwordx4 v2, s[12:15], s19 offen lds
    s_add_u32 s19, s19, s20
    s_cmp_ge_u32 s16, s92
    s_cselect_b32 s94, 2048, 0
    s_cselect_b32 s95, s93, 0
    s_sub_u32 s16, s16, s94
    s_sub_u32 s17, s17, s94
    s_sub_u32 s18, s18, s95
    s_sub_u32 s19, s19, s95
    v_mfma_f32_16x16x32_bf16 v[128:131], v[112:115], v[80:83], v[128:131]
    ds_read_b64_tr_b16 v[64:65], v12 offset:16384
    v_mfma_f32_16x16x32_bf16 v[132:135], v[116:119], v[80:83], v[132:135]
    ds_read_b64_tr_b16 v[66:67], v13 offset:16384
    v_mfma_f32_16x16x32_bf16 v[144:147], v[112:115], v[88:91], v[144:147]
    ds_read_b64_tr_b16 v[68:69], v14 offset:16384
    v_mfma_f32_16x16x32_bf16 v[148:151], v[116:119], v[88:91], v[148:151]
    ds_read_b64_tr_b16 v[70:71], v15 offset:16384
    v_mfma_f32_16x16x32_bf16 v[160:163], v[112:115], v[96:99], v[160:163]
    ds_read_b64_tr_b16 v[72:73], v12 offset:24576
    v_mfma_f32_16x16x32_bf16 v[164:167], v[116:119], v[96:99], v[164:167]
    ds_read_b64_tr_b16 v[74:75], v13 offset:24576
    v_mfma_f32_16x16x32_bf16 v[176:179], v[112:115], v[104:107], v[176:179]
    ds_read_b64_tr_b16 v[76:77], v14 offset:24576
    v_mfma_f32_16x16x32_bf16 v[180:183], v[116:119], v[104:107], v[180:183]
    ds_read_b64_tr_b16 v[78:79], v15 offset:24576
    v_mfma_f32_16x16x32_bf16 v[192:195], v[112:115], v[208:211], v[192:195]
    ds_read_b128 v[32:35], v26 offset:0
    v_mfma_f32_16x16x32_bf16 v[196:199], v[116:119], v[208:211], v[196:199]
    ds_read_b128 v[36:39], v27 offset:0
    v_mfma_f32_16x16x32_bf16 v[128:131], v[120:123], v[84:87], v[128:131]
    ds_read_b128 v[40:43], v26 offset:2048
    v_mfma_f32_16x16x32_bf16 v[132:135], v[124:127], v[84:87], v[132:135]
    ds_read_b128 v[44:47], v27 offset:2048
    v_mfma_f32_16x16x32_bf16 v[144:147], v[120:123], v[92:95], v[144:147]
    ds_read_b128 v[48:51], v26 offset:4096
    v_mfma_f32_16x16x32_bf16 v[148:151], v[124:127], v[92:95], v[148:151]
    ds_read_b128 v[52:55], v27 offset:4096
    v_mfma_f32_16x16x32_bf16 v[160:163], v[120:123], v[100:103], v[160:163]
    ds_read_b128 v[56:59], v26 offset:6144
    v_mfma_f32_16x16x32_bf16 v[164:167], v[124:127], v[100:103], v[164:167]
    ds_read_b128 v[60:63], v27 offset:6144
    v_mfma_f32_16x16x32_bf16 v[176:179], v[120:123], v[108:111], v[176:179]
    v_mfma_f32_16x16x32_bf16 v[180:183], v[124:127], v[108:111], v[180:183]
    v_mfma_f32_16x16x32_bf16 v[192:195], v[120:123], v[208:211], v[192:195]
    v_mfma_f32_16x16x32_bf16 v[196:199], v[124:127], v[208:211], v[196:199]
    s_waitcnt lgkmcnt(0)
    s_waitcnt vmcnt(8)
    s_barrier
    s_add_u32 m0, s21, 65536
    s_nop 0
    buffer_load_dwordx4 v23, s[88:91], s16 offen lds
    s_add_u32 s16, s16, s62
    s_add_u32 m0, s21, 66560
    s_nop 0
    buffer_load_dwordx4 v23, s[88:91], s17 offen lds
    s_add_u32 s17, s17, s62
    s_add_u32 m0, s22, 65536
    s_nop 0
    buffer_load_dwordx4 v2, s[8:11], s18 offen lds
    s_add_u32 s18, s18, s20
    s_add_u32 m0, s22, 73728
    s_nop 0
    buffer_load_dwordx4 v2, s[12:15], s19 offen lds
    s_add_u32 s19, s19, s20
    s_cmp_ge_u32 s16, s92
    s_cselect_b32 s94, 2048, 0
    s_cselect_b32 s95, s93, 0
    s_sub_u32 s16, s16, s94
    s_sub_u32 s17, s17, s94
    s_sub_u32 s18, s18, s95
    s_sub_u32 s19, s19, s95
    v_mfma_f32_16x16x32_bf16 v[128:131], v[64:67], v[32:35], v[128:131]
    ds_read_b64_tr_b16 v[112:113], v12 offset:49152
    v_mfma_f32_16x16x32_bf16 v[132:135], v[68:71], v[32:35], v[132:135]
    ds_read_b64_tr_b16 v[114:115], v13 offset:49152
    v_mfma_f32_16x16x32_bf16 v[144:147], v[64:67], v[40:43], v[144:147]
    ds_read_b64_tr_b16 v[116:117], v14 offset:49152
    v_mfma_f32_16x16x32_bf16 v[148:151], v[68:71], v[40:43], v[148:151]
    ds_read_b64_tr_b16 v[118:119], v15 offset:49152
    v_mfma_f32_16x16x32_bf16 v[160:163], v[64:67], v[48:51], v[160:163]
    ds_read_b64_tr_b16 v[120:121], v12 offset:57344
    v_mfma_f32_16x16x32_bf16 v[164:167], v[68:71], v[48:51], v[164:167]
    ds_read_b64_tr_b16 v[122:123], v13 offset:57344
    v_mfma_f32_16x16x32_bf16 v[176:179], v[64:67], v[56:59], v[176:179]
    ds_read_b64_tr_b16 v[124:125], v14 offset:57344
    v_mfma_f32_16x16x32_bf16 v[180:183], v[68:71], v[56:59], v[180:183]
    ds_read_b64_tr_b16 v[126:127], v15 offset:57344
    v_mfma_f32_16x16x32_bf16 v[192:195], v[64:67], v[208:211], v[192:195]
    ds_read_b128 v[80:83], v26 offset:32768
    v_mfma_f32_16x16x32_bf16 v[196:199], v[68:71], v[208:211], v[196:199]
    ds_read_b128 v[84:87], v27 offset:32768
    v_mfma_f32_16x16x32_bf16 v[128:131], v[72:75], v[36:39], v[128:131]
    ds_read_b128 v[88:91], v26 offset:34816
    v_mfma_f32_16x16x32_bf16 v[132:135], v[76:79], v[36:39], v[132:135]
    ds_read_b128 v[92:95], v27 offset:34816
    v_mfma_f32_16x16x32_bf16 v[144:147], v[72:75], v[44:47], v[144:147]
    ds_read_b128 v[96:99], v26 offset:36864
    v_mfma_f32_16x16x32_bf16 v[148:151], v[76:79], v[44:47], v[148:151]
    ds_read_b128 v[100:103], v27 offset:36864
    v_mfma_f32_16x16x32_bf16 v[160:163], v[72:75], v[52:55], v[160:163]
    ds_read_b128 v[104:107], v26 offset:38912
    v_mfma_f32_16x16x32_bf16 v[164:167], v[76:79], v[52:55], v[164:167]
    ds_read_b128 v[108:111], v27 offset:38912
    v_mfma_f32_16x16x32_bf16 v[176:179], v[72:75], v[60:63], v[176:179]
    v_mfma_f32_16x16x32_bf16 v[180:183], v[76:79], v[60:63], v[180:183]
    v_mfma_f32_16x16x32_bf16 v[192:195], v[72:75], v[208:211], v[192:195]
    v_mfma_f32_16x16x32_bf16 v[196:199], v[76:79], v[208:211], v[196:199]
    s_waitcnt lgkmcnt(0)
    s_waitcnt vmcnt(8)
    s_barrier
    s_add_u32 m0, s21, 98304
    s_nop 0
    buffer_load_dwordx4 v23, s[88:91], s16 offen lds
    s_add_u32 s16, s16, s62
    s_add_u32 m0, s21, 99328
    s_nop 0
    buffer_load_dwordx4 v23, s[88:91], s17 offen lds
    s_add_u32 s17, s17, s62
    s_add_u32 m0, s22, 98304
    s_nop 0
    buffer_load_dwordx4 v2, s[8:11], s18 offen lds
    s_add_u32 s18, s18, s20
    s_add_u32 m0, s22, 106496
    s_nop 0
    buffer_load_dwordx4 v2, s[12:15], s19 offen lds
    s_add_u32 s19, s19, s20
    s_cmp_ge_u32 s16, s92
    s_cselect_b32 s94, 2048, 0
    s_cselect_b32 s95, s93, 0
    s_sub_u32 s16, s16, s94
    s_sub_u32 s17, s17, s94
    s_sub_u32 s18, s18, s95
    s_sub_u32 s19, s19, s95
    v_mfma_f32_16x16x32_bf16 v[128:131], v[112:115], v[80:83], v[128:131]
    ds_read_b64_tr_b16 v[64:65], v8 offset:16384
    v_mfma_f32_16x16x32_bf16 v[132:135], v[116:119], v[80:83], v[132:135]
    ds_read_b64_tr_b16 v[66:67], v9 offset:16384
    v_mfma_f32_16x16x32_bf16 v[144:147], v[112:115], v[88:91], v[144:147]
    ds_read_b64_tr_b16 v[68:69], v10 offset:16384
    v_mfma_f32_16x16x32_bf16 v[148:151], v[116:119], v[88:91], v[148:151]
    ds_read_b64_tr_b16 v[70:71], v11 offset:16384
    v_mfma_f32_16x16x32_bf16 v[160:163], v[112:115], v[96:99], v[160:163]
    ds_read_b64_tr_b16 v[72:73], v8 offset:24576
    v_mfma_f32_16x16x32_bf16 v[164:167], v[116:119], v[96:99], v[164:167]
    ds_read_b64_tr_b16 v[74:75], v9 offset:24576
    v_mfma_f32_16x16x32_bf16 v[176:179], v[112:115], v[104:107], v[176:179]
    ds_read_b64_tr_b16 v[76:77], v10 offset:24576
    v_mfma_f32_16x16x32_bf16 v[180:183], v[116:119], v[104:107], v[180:183]
    ds_read_b64_tr_b16 v[78:79], v11 offset:24576
    v_mfma_f32_16x16x32_bf16 v[192:195], v[112:115], v[208:211], v[192:195]
    ds_read_b128 v[32:35], v24 offset:0
    v_mfma_f32_16x16x32_bf16 v[196:199], v[116:119], v[208:211], v[196:199]
    ds_read_b128 v[36:39], v25 offset:0
    v_mfma_f32_16x16x32_bf16 v[128:131], v[120:123], v[84:87], v[128:131]
    ds_read_b128 v[40:43], v24 offset:2048
    v_mfma_f32_16x16x32_bf16 v[132:135], v[124:127], v[84:87], v[132:135]
    ds_read_b128 v[44:47], v25 offset:2048
    v_mfma_f32_16x16x32_bf16 v[144:147], v[120:123], v[92:95], v[144:147]
    ds_read_b128 v[48:51], v24 offset:4096
    v_mfma_f32_16x16x32_bf16 v[148:151], v[124:127], v[92:95], v[148:151]
    ds_read_b128 v[52:55], v25 offset:4096
    v_mfma_f32_16x16x32_bf16 v[160:163], v[120:123], v[100:103], v[160:163]
    ds_read_b128 v[56:59], v24 offset:6144
    v_mfma_f32_16x16x32_bf16 v[164:167], v[124:127], v[100:103], v[164:167]
    ds_read_b128 v[60:63], v25 offset:6144
    v_mfma_f32_16x16x32_bf16 v[176:179], v[120:123], v[108:111], v[176:179]
    v_mfma_f32_16x16x32_bf16 v[180:183], v[124:127], v[108:111], v[180:183]
    v_mfma_f32_16x16x32_bf16 v[192:195], v[120:123], v[208:211], v[192:195]
    v_mfma_f32_16x16x32_bf16 v[196:199], v[124:127], v[208:211], v[196:199]
    s_waitcnt lgkmcnt(0)
    s_sub_u32 s23, s23, 1
    s_cmp_lg_u32 s23, 0
    s_cbranch_scc1 w_loopX
    s_waitcnt vmcnt(8)
    s_barrier
    v_mfma_f32_16x16x32_bf16 v[128:131], v[64:67], v[32:35], v[128:131]
    ds_read_b64_tr_b16 v[112:113], v8 offset:49152
    v_mfma_f32_16x16x32_bf16 v[132:135], v[68:71], v[32:35], v[132:135]
    ds_read_b64_tr_b16 v[114:115], v9 offset:49152
    v_mfma_f32_16x16x32_bf16 v[144:147], v[64:67], v[40:43], v[144:147]
    ds_read_b64_tr_b16 v[116:117], v10 offset:49152
    v_mfma_f32_16x16x32_bf16 v[148:151], v[68:71], v[40:43], v[148:151]
    ds_read_b64_tr_b16 v[118:119], v11 offset:49152
    v_mfma_f32_16x16x32_bf16 v[160:163], v[64:67], v[48:51], v[160:163]
    ds_read_b64_tr_b16 v[120:121], v8 offset:57344
    v_mfma_f32_16x16x32_bf16 v[164:167], v[68:71], v[48:51], v[164:167]
    ds_read_b64_tr_b16 v[122:123], v9 offset:57344
    v_mfma_f32_16x16x32_bf16 v[176:179], v[64:67], v[56:59], v[176:179]
    ds_read_b64_tr_b16 v[124:125], v10 offset:57344
    v_mfma_f32_16x16x32_bf16 v[180:183], v[68:71], v[56:59], v[180:183]
    ds_read_b64_tr_b16 v[126:127], v11 offset:57344
    v_mfma_f32_16x16x32_bf16 v[192:195], v[64:67], v[208:211], v[192:195]
    ds_read_b128 v[80:83], v24 offset:32768
    v_mfma_f32_16x16x32_bf16 v[196:199], v[68:71], v[208:211], v[196:199]
    ds_read_b128 v[84:87], v25 offset:32768
    v_mfma_f32_16x16x32_bf16 v[128:131], v[72:75], v[36:39], v[128:131]
    ds_read_b128 v[88:91], v24 offset:34816
    v_mfma_f32_16x16x32_bf16 v[132:135], v[76:79], v[36:39], v[132:135]
    ds_read_b128 v[92:95], v25 offset:34816
    v_mfma_f32_16x16x32_bf16 v[144:147], v[72:75], v[44:47], v[144:147]
    ds_read_b128 v[96:99], v24 offset:36864
    v_mfma_f32_16x16x32_bf16 v[148:151], v[76:79], v[44:47], v[148:151]
    ds_read_b128 v[100:103], v25 offset:36864
    v_mfma_f32_16x16x32_bf16 v[160:163], v[72:75], v[52:55], v[160:163]
    ds_read_b128 v[104:107], v24 offset:38912
    v_mfma_f32_16x16x32_bf16 v[164:167], v[76:79], v[52:55], v[164:167]
    ds_read_b128 v[108:111], v25 offset:38912
    v_mfma_f32_16x16x32_bf16 v[176:179], v[72:75], v[60:63], v[176:179]
    v_mfma_f32_16x16x32_bf16 v[180:183], v[76:79], v[60:63], v[180:183]
    v_mfma_f32_16x16x32_bf16 v[192:195], v[72:75], v[208:211], v[192:195]
    v_mfma_f32_16x16x32_bf16 v[196:199], v[76:79], v[208:211], v[196:199]
    s_waitcnt lgkmcnt(0)
    s_waitcnt vmcnt(4)
    s_barrier
    v_mfma_f32_16x16x32_bf16 v[128:131], v[112:115], v[80:83], v[128:131]
    ds_read_b64_tr_b16 v[64:65], v12 offset:16384
    v_mfma_f32_16x16x32_bf16 v[132:135], v[116:119], v[80:83], v[132:135]
    ds_read_b64_tr_b16 v[66:67], v13 offset:16384
    v_mfma_f32_16x16x32_bf16 v[144:147], v[112:115], v[88:91], v[144:147]
    ds_read_b64_tr_b16 v[68:69], v14 offset:16384
    v_mfma_f32_16x16x32_bf16 v[148:151], v[116:119], v[88:91], v[148:151]
    ds_read_b64_tr_b16 v[70:71], v15 offset:16384
    v_mfma_f32_16x16x32_bf16 v[160:163], v[112:115], v[96:99], v[160:163]
    ds_read_b64_tr_b16 v[72:73], v12 offset:24576
    v_mfma_f32_16x16x32_bf16 v[164:167], v[116:119], v[96:99], v[164:167]
    ds_read_b64_tr_b16 v[74:75], v13 offset:24576
    v_mfma_f32_16x16x32_bf16 v[176:179], v[112:115], v[104:107], v[176:179]
    ds_read_b64_tr_b16 v[76:77], v14 offset:24576
    v_mfma_f32_16x16x32_bf16 v[180:183], v[116:119], v[104:107], v[180:183]
    ds_read_b64_tr_b16 v[78:79], v15 offset:24576
    v_mfma_f32_16x16x32_bf16 v[192:195], v[112:115], v[208:211], v[192:195]
    ds_read_b128 v[32:35], v26 offset:0
    v_mfma_f32_16x16x32_bf16 v[196:199], v[116:119], v[208:211], v[196:199]
    ds_read_b128 v[36:39], v27 offset:0
    v_mfma_f32_16x16x32_bf16 v[128:131], v[120:123], v[84:87], v[128:131]
    ds_read_b128 v[40:43], v26 offset:2048
    v_mfma_f32_16x16x32_bf16 v[132:135], v[124:127], v[84:87], v[132:135]
    ds_read_b128 v[44:47], v27 offset:2048
    v_mfma_f32_16x16x32_bf16 v[144:147], v[120:123], v[92:95], v[144:147]
    ds_read_b128 v[48:51], v26 offset:4096
    v_mfma_f32_16x16x32_bf16 v[148:151], v[124:127], v[92:95], v[148:151]
    ds_read_b128 v[52:55], v27 offset:4096
    v_mfma_f32_16x16x32_bf16 v[160:163], v[120:123], v[100:103], v[160:163]
    ds_read_b128 v[56:59], v26 offset:6144
    v_mfma_f32_16x16x32_bf16 v[164:167], v[124:127], v[100:103], v[164:167]
    ds_read_b128 v[60:63], v27 offset:6144
    v_mfma_f32_16x16x32_bf16 v[176:179], v[120:123], v[108:111], v[176:179]
    v_mfma_f32_16x16x32_bf16 v[180:183], v[124:127], v[108:111], v[180:183]
    v_mfma_f32_16x16x32_bf16 v[192:195], v[120:123], v[208:211], v[192:195]
    v_mfma_f32_16x16x32_bf16 v[196:199], v[124:127], v[208:211], v[196:199]
    s_waitcnt lgkmcnt(0)
    s_waitcnt vmcnt(0)
    s_barrier
    v_mfma_f32_16x16x32_bf16 v[128:131], v[64:67], v[32:35], v[128:131]
    ds_read_b64_tr_b16 v[112:113], v12 offset:49152
    v_mfma_f32_16x16x32_bf16 v[132:135], v[68:71], v[32:35], v[132:135]
    ds_read_b64_tr_b16 v[114:115], v13 offset:49152
    v_mfma_f32_16x16x32_bf16 v[144:147], v[64:67], v[40:43], v[144:147]
    ds_read_b64_tr_b16 v[116:117], v14 offset:49152
    v_mfma_f32_16x16x32_bf16 v[148:151], v[68:71], v[40:43], v[148:151]
    ds_read_b64_tr_b16 v[118:119], v15 offset:49152
    v_mfma_f32_16x16x32_bf16 v[160:163], v[64:67], v[48:51], v[160:163]
    ds_read_b64_tr_b16 v[120:121], v12 offset:57344
    v_mfma_f32_16x16x32_bf16 v[164:167], v[68:71], v[48:51], v[164:167]
    ds_read_b64_tr_b16 v[122:123], v13 offset:57344
    v_mfma_f32_16x16x32_bf16 v[176:179], v[64:67], v[56:59], v[176:179]
    ds_read_b64_tr_b16 v[124:125], v14 offset:57344
    v_mfma_f32_16x16x32_bf16 v[180:183], v[68:71], v[56:59], v[180:183]
    ds_read_b64_tr_b16 v[126:127], v15 offset:57344
    v_mfma_f32_16x16x32_bf16 v[192:195], v[64:67], v[208:211], v[192:195]
    ds_read_b128 v[80:83], v26 offset:32768
    v_mfma_f32_16x16x32_bf16 v[196:199], v[68:71], v[208:211], v[196:199]
    ds_read_b128 v[84:87], v27 offset:32768
    v_mfma_f32_16x16x32_bf16 v[128:131], v[72:75], v[36:39], v[128:131]
    ds_read_b128 v[88:91], v26 offset:34816
    v_mfma_f32_16x16x32_bf16 v[132:135], v[76:79], v[36:39], v[132:135]
    ds_read_b128 v[92:95], v27 offset:34816
    v_mfma_f32_16x16x32_bf16 v[144:147], v[72:75], v[44:47], v[144:147]
    ds_read_b128 v[96:99], v26 offset:36864
    v_mfma_f32_16x16x32_bf16 v[148:151], v[76:79], v[44:47], v[148:151]
    ds_read_b128 v[100:103], v27 offset:36864
    v_mfma_f32_16x16x32_bf16 v[160:163], v[72:75], v[52:55], v[160:163]
    ds_read_b128 v[104:107], v26 offset:38912
    v_mfma_f32_16x16x32_bf16 v[164:167], v[76:79], v[52:55], v[164:167]
    ds_read_b128 v[108:111], v27 offset:38912
    v_mfma_f32_16x16x32_bf16 v[176:179], v[72:75], v[60:63], v[176:179]
    v_mfma_f32_16x16x32_bf16 v[180:183], v[76:79], v[60:63], v[180:183]
    v_mfma_f32_16x16x32_bf16 v[192:195], v[72:75], v[208:211], v[192:195]
    v_mfma_f32_16x16x32_bf16 v[196:199], v[76:79], v[208:211], v[196:199]
    s_waitcnt lgkmcnt(0)
    s_waitcnt vmcnt(0)
    s_barrier
    v_mfma_f32_16x16x32_bf16 v[128:131], v[112:115], v[80:83], v[128:131]
    ds_read_b64_tr_b16 v[64:65], v8 offset:16384
    v_mfma_f32_16x16x32_bf16 v[132:135], v[116:119], v[80:83], v[132:135]
    ds_read_b64_tr_b16 v[66:67], v9 offset:16384
    v_mfma_f32_16x16x32_bf16 v[144:147], v[112:115], v[88:91], v[144:147]
    ds_read_b64_tr_b16 v[68:69], v10 offset:16384
    v_mfma_f32_16x16x32_bf16 v[148:151], v[116:119], v[88:91], v[148:151]
    ds_read_b64_tr_b16 v[70:71], v11 offset:16384
    v_mfma_f32_16x16x32_bf16 v[160:163], v[112:115], v[96:99], v[160:163]
    ds_read_b64_tr_b16 v[72:73], v8 offset:24576
    v_mfma_f32_16x16x32_bf16 v[164:167], v[116:119], v[96:99], v[164:167]
    ds_read_b64_tr_b16 v[74:75], v9 offset:24576
    v_mfma_f32_16x16x32_bf16 v[176:179], v[112:115], v[104:107], v[176:179]
    ds_read_b64_tr_b16 v[76:77], v10 offset:24576
    v_mfma_f32_16x16x32_bf16 v[180:183], v[116:119], v[104:107], v[180:183]
    ds_read_b64_tr_b16 v[78:79], v11 offset:24576
    v_mfma_f32_16x16x32_bf16 v[192:195], v[112:115], v[208:211], v[192:195]
    ds_read_b128 v[32:35], v24 offset:0
    v_mfma_f32_16x16x32_bf16 v[196:199], v[116:119], v[208:211], v[196:199]
    ds_read_b128 v[36:39], v25 offset:0
    v_mfma_f32_16x16x32_bf16 v[128:131], v[120:123], v[84:87], v[128:131]
    ds_read_b128 v[40:43], v24 offset:2048
    v_mfma_f32_16x16x32_bf16 v[132:135], v[124:127], v[84:87], v[132:135]
    ds_read_b128 v[44:47], v25 offset:2048
    v_mfma_f32_16x16x32_bf16 v[144:147], v[120:123], v[92:95], v[144:147]
    ds_read_b128 v[48:51], v24 offset:4096
    v_mfma_f32_16x16x32_bf16 v[148:151], v[124:127], v[92:95], v[148:151]
    ds_read_b128 v[52:55], v25 offset:4096
    v_mfma_f32_16x16x32_bf16 v[160:163], v[120:123], v[100:103], v[160:163]
    ds_read_b128 v[56:59], v24 offset:6144
    v_mfma_f32_16x16x32_bf16 v[164:167], v[124:127], v[100:103], v[164:167]
    ds_read_b128 v[60:63], v25 offset:6144
    v_mfma_f32_16x16x32_bf16 v[176:179], v[120:123], v[108:111], v[176:179]
    v_mfma_f32_16x16x32_bf16 v[180:183], v[124:127], v[108:111], v[180:183]
    v_mfma_f32_16x16x32_bf16 v[192:195], v[120:123], v[208:211], v[192:195]
    v_mfma_f32_16x16x32_bf16 v[196:199], v[124:127], v[208:211], v[196:199]
    s_waitcnt lgkmcnt(0)
    v_and_b32 v20, 0xf0, v1
    v_lshrrev_b32 v20, 1, v20
    s_lshl_b32 s30, s26, 9
    s_add_u32 s30, s30, 188743680
    s_mov_b32 s31, 0x40000
    v_and_b32 v21, 1, v4
    v_lshlrev_b32 v21, 10, v21
    v_xor_b32 v8, v21, v8
    v_xor_b32 v9, v21, v9
    v_xor_b32 v10, v21, v10
    v_xor_b32 v11, v21, v11
    v_xor_b32 v12, v21, v12
    v_xor_b32 v13, v21, v13
    v_xor_b32 v14, v21, v14
    v_xor_b32 v15, v21, v15
w_stX:
    buffer_load_dword v22, off, s[64:67], 0 offset:192 sc1
    buffer_load_dwordx2 v[24:25], v20, s[4:7], s30 offen offset:0 sc1
    buffer_load_dwordx2 v[26:27], v20, s[4:7], s30 offen offset:128 sc1
    buffer_load_dwordx2 v[28:29], v20, s[4:7], s30 offen offset:256 sc1
    buffer_load_dwordx2 v[30:31], v20, s[4:7], s30 offen offset:384 sc1
    s_waitcnt vmcnt(0)
    v_readfirstlane_b32 s29, v22
    s_cmp_ge_u32 s29, 32
    s_cbranch_scc1 w_stXok
    s_sleep 4
    s_sub_u32 s31, s31, 1
    s_cbranch_scc0 w_stX
w_stXok:
    buffer_load_dword v22, off, s[64:67], 0 sc1
    v_fma_f32 v128, -v24, v192, v128
    v_fma_f32 v129, -v24, v193, v129
    v_fma_f32 v130, -v24, v194, v130
    v_fma_f32 v131, -v24, v195, v131
    v_fma_f32 v132, -v24, v196, v132
    v_fma_f32 v133, -v24, v197, v133
    v_fma_f32 v134, -v24, v198, v134
    v_fma_f32 v135, -v24, v199, v135
    v_mul_f32 v128, v128, v25
    v_mul_f32 v129, v129, v25
    v_mul_f32 v130, v130, v25
    v_mul_f32 v131, v131, v25
    v_mul_f32 v132, v132, v25
    v_mul_f32 v133, v133, v25
    v_mul_f32 v134, v134, v25
    v_mul_f32 v135, v135, v25
    v_fma_f32 v144, -v26, v192, v144
    v_fma_f32 v145, -v26, v193, v145
    v_fma_f32 v146, -v26, v194, v146
    v_fma_f32 v147, -v26, v195, v147
    v_fma_f32 v148, -v26, v196, v148
    v_fma_f32 v149, -v26, v197, v149
    v_fma_f32 v150, -v26, v198, v150
    v_fma_f32 v151, -v26, v199, v151
    v_mul_f32 v144, v144, v27
    v_mul_f32 v145, v145, v27
    v_mul_f32 v146, v146, v27
    v_mul_f32 v147, v147, v27
    v_mul_f32 v148, v148, v27
    v_mul_f32 v149, v149, v27
    v_mul_f32 v150, v150, v27
    v_mul_f32 v151, v151, v27
    v_fma_f32 v160, -v28, v192, v160
    v_fma_f32 v161, -v28, v193, v161
    v_fma_f32 v162, -v28, v194, v162
    v_fma_f32 v163, -v28, v195, v163
    v_fma_f32 v164, -v28, v196, v164
    v_fma_f32 v165, -v28, v197, v165
    v_fma_f32 v166, -v28, v198, v166
    v_fma_f32 v167, -v28, v199, v167
    v_mul_f32 v160, v160, v29
    v_mul_f32 v161, v161, v29
    v_mul_f32 v162, v162, v29
    v_mul_f32 v163, v163, v29
    v_mul_f32 v164, v164, v29
    v_mul_f32 v165, v165, v29
    v_mul_f32 v166, v166, v29
    v_mul_f32 v167, v167, v29
    v_fma_f32 v176, -v30, v192, v176
    v_fma_f32 v177, -v30, v193, v177
    v_fma_f32 v178, -v30, v194, v178
    v_fma_f32 v179, -v30, v195, v179
    v_fma_f32 v180, -v30, v196, v180
    v_fma_f32 v181, -v30, v197, v181
    v_fma_f32 v182, -v30, v198, v182
    v_fma_f32 v183, -v30, v199, v183
    v_mul_f32 v176, v176, v31
    v_mul_f32 v177, v177, v31
    v_mul_f32 v178, v178, v31
    v_mul_f32 v179, v179, v31
    v_mul_f32 v180, v180, v31
    v_mul_f32 v181, v181, v31
    v_mul_f32 v182, v182, v31
    v_mul_f32 v183, v183, v31
    s_lshl_b32 s30, s27, 10
    s_add_u32 s30, s30, s49
    s_nop 7
    v_cvt_pk_bf16_f32 v80, v128, v129
    v_cvt_pk_bf16_f32 v81, v130, v131
    v_cvt_pk_bf16_f32 v82, v132, v133
    v_cvt_pk_bf16_f32 v83, v134, v135
    buffer_store_dwordx4 v[80:83], v1, s[4:7], s30 offen sc1
    s_add_u32 s30, s30, s50
    v_cvt_pk_bf16_f32 v84, v144, v145
    v_cvt_pk_bf16_f32 v85, v146, v147
    v_cvt_pk_bf16_f32 v86, v148, v149
    v_cvt_pk_bf16_f32 v87, v150, v151
    buffer_store_dwordx4 v[84:87], v1, s[4:7], s30 offen sc1
    s_add_u32 s30, s30, s50
    v_cvt_pk_bf16_f32 v88, v160, v161
    v_cvt_pk_bf16_f32 v89, v162, v163
    v_cvt_pk_bf16_f32 v90, v164, v165
    v_cvt_pk_bf16_f32 v91, v166, v167
    buffer_store_dwordx4 v[88:91], v1, s[4:7], s30 offen sc1
    s_add_u32 s30, s30, s50
    v_cvt_pk_bf16_f32 v92, v176, v177
    v_cvt_pk_bf16_f32 v93, v178, v179
    v_cvt_pk_bf16_f32 v94, v180, v181
    v_cvt_pk_bf16_f32 v95, v182, v183
    buffer_store_dwordx4 v[92:95], v1, s[4:7], s30 offen sc1
    s_add_u32 s30, s30, s50
    s_mov_b32 s28, s51
    s_mov_b32 s57, s53
    s_branch w_drain
w_firstM:
    s_waitcnt vmcnt(6)
    s_barrier
    s_add_u32 m0, s21, 0
    s_nop 0
    buffer_load_dwordx4 v1, s[4:7], s16 offen sc1 lds
    s_add_u32 s16, s16, s62
    s_add_u32 m0, s22, 0
    s_nop 0
    buffer_load_dwordx4 v2, s[8:11], s18 offen lds
    s_add_u32 s18, s18, s20
    s_add_u32 m0, s22, 8192
    s_nop 0
    buffer_load_dwordx4 v2, s[12:15], s19 offen lds
    s_add_u32 s19, s19, s20
    v_mfma_f32_16x16x32_bf16 v[128:131], v[64:67], v[32:35], 0
    ds_read_b64_tr_b16 v[112:113], v8 offset:49152
    v_mfma_f32_16x16x32_bf16 v[132:135], v[68:71], v[32:35], 0
    ds_read_b64_tr_b16 v[114:115], v9 offset:49152
    v_mfma_f32_16x16x32_bf16 v[136:139], v[72:75], v[32:35], 0
    ds_read_b64_tr_b16 v[116:117], v10 offset:49152
    v_mfma_f32_16x16x32_bf16 v[140:143], v[76:79], v[32:35], 0
    ds_read_b64_tr_b16 v[118:119], v11 offset:49152
    v_mfma_f32_16x16x32_bf16 v[144:147], v[64:67], v[40:43], 0
    ds_read_b64_tr_b16 v[120:121], v8 offset:57344
    v_mfma_f32_16x16x32_bf16 v[148:151], v[68:71], v[40:43], 0
    ds_read_b64_tr_b16 v[122:123], v9 offset:57344
    v_mfma_f32_16x16x32_bf16 v[152:155], v[72:75], v[40:43], 0
    ds_read_b64_tr_b16 v[124:125], v10 offset:57344
    v_mfma_f32_16x16x32_bf16 v[156:159], v[76:79], v[40:43], 0
    ds_read_b64_tr_b16 v[126:127], v11 offset:57344
    v_mfma_f32_16x16x32_bf16 v[160:163], v[64:67], v[48:51], 0
    ds_read_b128 v[80:83], v5 offset:32768
    v_mfma_f32_16x16x32_bf16 v[164:167], v[68:71], v[48:51], 0
    ds_read_b128 v[88:91], v5 offset:34816
    v_mfma_f32_16x16x32_bf16 v[168:171], v[72:75], v[48:51], 0
    ds_read_b128 v[96:99], v5 offset:36864
    v_mfma_f32_16x16x32_bf16 v[172:175], v[76:79], v[48:51], 0
    ds_read_b128 v[104:107], v5 offset:38912
    v_mfma_f32_16x16x32_bf16 v[176:179], v[64:67], v[56:59], 0
    v_mfma_f32_16x16x32_bf16 v[180:183], v[68:71], v[56:59], 0
    v_mfma_f32_16x16x32_bf16 v[184:187], v[72:75], v[56:59], 0
    v_mfma_f32_16x16x32_bf16 v[188:191], v[76:79], v[56:59], 0
    s_waitcnt lgkmcnt(0)
    s_waitcnt vmcnt(6)
    s_barrier
    s_add_u32 m0, s21, 32768
    s_nop 0
    buffer_load_dwordx4 v1, s[4:7], s16 offen sc1 lds
    s_add_u32 s16, s16, s62
    s_add_u32 m0, s22, 32768
    s_nop 0
    buffer_load_dwordx4 v2, s[8:11], s18 offen lds
    s_add_u32 s18, s18, s20
    s_add_u32 m0, s22, 40960
    s_nop 0
    buffer_load_dwordx4 v2, s[12:15], s19 offen lds
    s_add_u32 s19, s19, s20
    v_mfma_f32_16x16x32_bf16 v[128:131], v[112:115], v[80:83], v[128:131]
    ds_read_b64_tr_b16 v[64:65], v12 offset:16384
    v_mfma_f32_16x16x32_bf16 v[132:135], v[116:119], v[80:83], v[132:135]
    ds_read_b64_tr_b16 v[66:67], v13 offset:16384
    v_mfma_f32_16x16x32_bf16 v[136:139], v[120:123], v[80:83], v[136:139]
    ds_read_b64_tr_b16 v[68:69], v14 offset:16384
    v_mfma_f32_16x16x32_bf16 v[140:143], v[124:127], v[80:83], v[140:143]
    ds_read_b64_tr_b16 v[70:71], v15 offset:16384
    v_mfma_f32_16x16x32_bf16 v[144:147], v[112:115], v[88:91], v[144:147]
    ds_read_b64_tr_b16 v[72:73], v12 offset:24576
    v_mfma_f32_16x16x32_bf16 v[148:151], v[116:119], v[88:91], v[148:151]
    ds_read_b64_tr_b16 v[74:75], v13 offset:24576
    v_mfma_f32_16x16x32_bf16 v[152:155], v[120:123], v[88:91], v[152:155]
    ds_read_b64_tr_b16 v[76:77], v14 offset:24576
    v_mfma_f32_16x16x32_bf16 v[156:159], v[124:127], v[88:91], v[156:159]
    ds_read_b64_tr_b16 v[78:79], v15 offset:24576
    v_mfma_f32_16x16x32_bf16 v[160:163], v[112:115], v[96:99], v[160:163]
    ds_read_b128 v[32:35], v6 offset:0
    v_mfma_f32_16x16x32_bf16 v[164:167], v[116:119], v[96:99], v[164:167]
    ds_read_b128 v[40:43], v6 offset:2048
    v_mfma_f32_16x16x32_bf16 v[168:171], v[120:123], v[96:99], v[168:171]
    ds_read_b128 v[48:51], v6 offset:4096
    v_mfma_f32_16x16x32_bf16 v[172:175], v[124:127], v[96:99], v[172:175]
    ds_read_b128 v[56:59], v6 offset:6144
    v_mfma_f32_16x16x32_bf16 v[176:179], v[112:115], v[104:107], v[176:179]
    v_mfma_f32_16x16x32_bf16 v[180:183], v[116:119], v[104:107], v[180:183]
    v_mfma_f32_16x16x32_bf16 v[184:187], v[120:123], v[104:107], v[184:187]
    v_mfma_f32_16x16x32_bf16 v[188:191], v[124:127], v[104:107], v[188:191]
    s_waitcnt lgkmcnt(0)
    s_waitcnt vmcnt(6)
    s_barrier
    s_add_u32 m0, s21, 65536
    s_nop 0
    buffer_load_dwordx4 v1, s[4:7], s16 offen sc1 lds
    s_add_u32 s16, s16, s62
    s_add_u32 m0, s22, 65536
    s_nop 0
    buffer_load_dwordx4 v2, s[8:11], s18 offen lds
    s_add_u32 s18, s18, s20
    s_add_u32 m0, s22, 73728
    s_nop 0
    buffer_load_dwordx4 v2, s[12:15], s19 offen lds
    s_add_u32 s19, s19, s20
    v_mfma_f32_16x16x32_bf16 v[128:131], v[64:67], v[32:35], v[128:131]
    ds_read_b64_tr_b16 v[112:113], v12 offset:49152
    v_mfma_f32_16x16x32_bf16 v[132:135], v[68:71], v[32:35], v[132:135]
    ds_read_b64_tr_b16 v[114:115], v13 offset:49152
    v_mfma_f32_16x16x32_bf16 v[136:139], v[72:75], v[32:35], v[136:139]
    ds_read_b64_tr_b16 v[116:117], v14 offset:49152
    v_mfma_f32_16x16x32_bf16 v[140:143], v[76:79], v[32:35], v[140:143]
    ds_read_b64_tr_b16 v[118:119], v15 offset:49152
    v_mfma_f32_16x16x32_bf16 v[144:147], v[64:67], v[40:43], v[144:147]
    ds_read_b64_tr_b16 v[120:121], v12 offset:57344
    v_mfma_f32_16x16x32_bf16 v[148:151], v[68:71], v[40:43], v[148:151]
    ds_read_b64_tr_b16 v[122:123], v13 offset:57344
    v_mfma_f32_16x16x32_bf16 v[152:155], v[72:75], v[40:43], v[152:155]
    ds_read_b64_tr_b16 v[124:125], v14 offset:57344
    v_mfma_f32_16x16x32_bf16 v[156:159], v[76:79], v[40:43], v[156:159]
    ds_read_b64_tr_b16 v[126:127], v15 offset:57344
    v_mfma_f32_16x16x32_bf16 v[160:163], v[64:67], v[48:51], v[160:163]
    ds_read_b128 v[80:83], v6 offset:32768
    v_mfma_f32_16x16x32_bf16 v[164:167], v[68:71], v[48:51], v[164:167]
    ds_read_b128 v[88:91], v6 offset:34816
    v_mfma_f32_16x16x32_bf16 v[168:171], v[72:75], v[48:51], v[168:171]
    ds_read_b128 v[96:99], v6 offset:36864
    v_mfma_f32_16x16x32_bf16 v[172:175], v[76:79], v[48:51], v[172:175]
    ds_read_b128 v[104:107], v6 offset:38912
    v_mfma_f32_16x16x32_bf16 v[176:179], v[64:67], v[56:59], v[176:179]
    v_mfma_f32_16x16x32_bf16 v[180:183], v[68:71], v[56:59], v[180:183]
    v_mfma_f32_16x16x32_bf16 v[184:187], v[72:75], v[56:59], v[184:187]
    v_mfma_f32_16x16x32_bf16 v[188:191], v[76:79], v[56:59], v[188:191]
    s_waitcnt lgkmcnt(0)
    s_waitcnt vmcnt(6)
    s_barrier
    s_add_u32 m0, s21, 98304
    s_nop 0
    buffer_load_dwordx4 v1, s[4:7], s16 offen sc1 lds
    s_add_u32 s16, s16, s62
    s_add_u32 m0, s22, 98304
    s_nop 0
    buffer_load_dwordx4 v2, s[8:11], s18 offen lds
    s_add_u32 s18, s18, s20
    s_add_u32 m0, s22, 106496
    s_nop 0
    buffer_load_dwordx4 v2, s[12:15], s19 offen lds
    s_add_u32 s19, s19, s20
    v_mfma_f32_16x16x32_bf16 v[128:131], v[112:115], v[80:83], v[128:131]
    ds_read_b64_tr_b16 v[64:65], v8 offset:16384
    v_mfma_f32_16x16x32_bf16 v[132:135], v[116:119], v[80:83], v[132:135]
    ds_read_b64_tr_b16 v[66:67], v9 offset:16384
    v_mfma_f32_16x16x32_bf16 v[136:139], v[120:123], v[80:83], v[136:139]
    ds_read_b64_tr_b16 v[68:69], v10 offset:16384
    v_mfma_f32_16x16x32_bf16 v[140:143], v[124:127], v[80:83], v[140:143]
    ds_read_b64_tr_b16 v[70:71], v11 offset:16384
    v_mfma_f32_16x16x32_bf16 v[144:147], v[112:115], v[88:91], v[144:147]
    ds_read_b64_tr_b16 v[72:73], v8 offset:24576
    v_mfma_f32_16x16x32_bf16 v[148:151], v[116:119], v[88:91], v[148:151]
    ds_read_b64_tr_b16 v[74:75], v9 offset:24576
    v_mfma_f32_16x16x32_bf16 v[152:155], v[120:123], v[88:91], v[152:155]
    ds_read_b64_tr_b16 v[76:77], v10 offset:24576
    v_mfma_f32_16x16x32_bf16 v[156:159], v[124:127], v[88:91], v[156:159]
    ds_read_b64_tr_b16 v[78:79], v11 offset:24576
    v_mfma_f32_16x16x32_bf16 v[160:163], v[112:115], v[96:99], v[160:163]
    ds_read_b128 v[32:35], v5 offset:0
    v_mfma_f32_16x16x32_bf16 v[164:167], v[116:119], v[96:99], v[164:167]
    ds_read_b128 v[40:43], v5 offset:2048
    v_mfma_f32_16x16x32_bf16 v[168:171], v[120:123], v[96:99], v[168:171]
    ds_read_b128 v[48:51], v5 offset:4096
    v_mfma_f32_16x16x32_bf16 v[172:175], v[124:127], v[96:99], v[172:175]
    ds_read_b128 v[56:59], v5 offset:6144
    v_mfma_f32_16x16x32_bf16 v[176:179], v[112:115], v[104:107], v[176:179]
    v_mfma_f32_16x16x32_bf16 v[180:183], v[116:119], v[104:107], v[180:183]
    v_mfma_f32_16x16x32_bf16 v[184:187], v[120:123], v[104:107], v[184:187]
    v_mfma_f32_16x16x32_bf16 v[188:191], v[124:127], v[104:107], v[188:191]
    s_waitcnt lgkmcnt(0)
w_loop_chkM:
    s_sub_u32 s23, s23, 1
w_loopM:
    s_cmp_lg_u32 s23, 1
    s_cbranch_scc1 w_bodyM
    v_readfirstlane_b32 s68, v22
    s_cmp_ge_u32 s68, 128
    s_cselect_b32 s70, 0, s70
    v_readfirstlane_b32 s30, v16
    s_cmp_ge_u32 s30, s45
    s_cselect_b32 s30, 0, 1
    s_or_b32 s30, s30, s70
    s_cmp_ge_u32 s32, 4
    s_cselect_b32 s30, 1, s30
    s_cmp_eq_u32 s32, 0
    s_cselect_b32 s30, 1, s30
    v_mov_b32 v20, s30
    ds_write_b32 v7, v20
    s_cbranch_scc1 w_bodyM
    s_load_dwordx2 s[8:9], s[0:1], s33
    s_load_dwordx2 s[12:13], s[0:1], s34
    s_mov_b32 s10, s38
    s_mov_b32 s14, s38
    s_cmp_ge_u32 s32, 4
    s_cselect_b32 s31, 0, 1
    s_lshl_b32 s30, s3, s31
    s_mul_i32 s30, s30, s40
    s_add_u32 s16, s39, s30
    s_cmp_eq_u32 s32, 4
    s_cselect_b32 s30, 1024, s40
    s_cselect_b32 s31, 6, 5
    s_lshl_b32 s62, 32, s31
    s_add_u32 s17, s16, s30
    s_lshl_b32 s30, s3, 2
    s_mul_i32 s30, s30, s35
    s_add_u32 s18, s36, s30
    s_add_u32 s19, s37, s30
    s_lshl_b32 s20, s35, s31
    v_mul_u32_u24 v2, s35, v4
    v_add_u32 v2, v2, v3
    s_waitcnt lgkmcnt(0)
    s_waitcnt vmcnt(6)
    s_barrier
    s_add_u32 m0, s21, 0
    s_nop 0
    buffer_load_dwordx4 v1, s[4:7], s16 offen sc1 lds
    s_add_u32 s16, s16, s62
    s_add_u32 m0, s21, 1024
    s_nop 0
    buffer_load_dwordx4 v1, s[4:7], s17 offen sc1 lds
    s_add_u32 s17, s17, s62
    s_add_u32 m0, s22, 0
    s_nop 0
    buffer_load_dwordx4 v2, s[8:11], s18 offen lds
    s_add_u32 s18, s18, s20
    s_add_u32 m0, s22, 8192
    s_nop 0
    buffer_load_dwordx4 v2, s[12:15], s19 offen lds
    s_add_u32 s19, s19, s20
    v_mfma_f32_16x16x32_bf16 v[128:131], v[64:67], v[32:35], v[128:131]
    ds_read_b64_tr_b16 v[112:113], v8 offset:49152
    v_mfma_f32_16x16x32_bf16 v[132:135], v[68:71], v[32:35], v[132:135]
    ds_read_b64_tr_b16 v[114:115], v9 offset:49152
    v_mfma_f32_16x16x32_bf16 v[136:139], v[72:75], v[32:35], v[136:139]
    ds_read_b64_tr_b16 v[116:117], v10 offset:49152
    v_mfma_f32_16x16x32_bf16 v[140:143], v[76:79], v[32:35], v[140:143]
    ds_read_b64_tr_b16 v[118:119], v11 offset:49152
    v_mfma_f32_16x16x32_bf16 v[144:147], v[64:67], v[40:43], v[144:147]
    ds_read_b64_tr_b16 v[120:121], v8 offset:57344
    v_mfma_f32_16x16x32_bf16 v[148:151], v[68:71], v[40:43], v[148:151]
    ds_read_b64_tr_b16 v[122:123], v9 offset:57344
    v_mfma_f32_16x16x32_bf16 v[152:155], v[72:75], v[40:43], v[152:155]
    ds_read_b64_tr_b16 v[124:125], v10 offset:57344
    v_mfma_f32_16x16x32_bf16 v[156:159], v[76:79], v[40:43], v[156:159]
    ds_read_b64_tr_b16 v[126:127], v11 offset:57344
    v_mfma_f32_16x16x32_bf16 v[160:163], v[64:67], v[48:51], v[160:163]
    ds_read_b128 v[80:83], v5 offset:32768
    v_mfma_f32_16x16x32_bf16 v[164:167], v[68:71], v[48:51], v[164:167]
    ds_read_b128 v[88:91], v5 offset:34816
    v_mfma_f32_16x16x32_bf16 v[168:171], v[72:75], v[48:51], v[168:171]
    ds_read_b128 v[96:99], v5 offset:36864
    v_mfma_f32_16x16x32_bf16 v[172:175], v[76:79], v[48:51], v[172:175]
    ds_read_b128 v[104:107], v5 offset:38912
    v_mfma_f32_16x16x32_bf16 v[176:179], v[64:67], v[56:59], v[176:179]
    v_mfma_f32_16x16x32_bf16 v[180:183], v[68:71], v[56:59], v[180:183]
    v_mfma_f32_16x16x32_bf16 v[184:187], v[72:75], v[56:59], v[184:187]
    v_mfma_f32_16x16x32_bf16 v[188:191], v[76:79], v[56:59], v[188:191]
    s_waitcnt lgkmcnt(0)
    s_waitcnt vmcnt(7)
    s_barrier
    s_add_u32 m0, s21, 32768
    s_nop 0
    buffer_load_dwordx4 v1, s[4:7], s16 offen sc1 lds
    s_add_u32 s16, s16, s62
    s_add_u32 m0, s21, 33792
    s_nop 0
    buffer_load_dwordx4 v1, s[4:7], s17 offen sc1 lds
    s_add_u32 s17, s17, s62
    s_add_u32 m0, s22, 32768
    s_nop 0
    buffer_load_dwordx4 v2, s[8:11], s18 offen lds
    s_add_u32 s18, s18, s20
    s_add_u32 m0, s22, 40960
    s_nop 0
    buffer_load_dwordx4 v2, s[12:15], s19 offen lds
    s_add_u32 s19, s19, s20
    v_mfma_f32_16x16x32_bf16 v[128:131], v[112:115], v[80:83], v[128:131]
    ds_read_b64_tr_b16 v[64:65], v12 offset:16384
    v_mfma_f32_16x16x32_bf16 v[132:135], v[116:119], v[80:83], v[132:135]
    ds_read_b64_tr_b16 v[66:67], v13 offset:16384
    v_mfma_f32_16x16x32_bf16 v[136:139], v[120:123], v[80:83], v[136:139]
    ds_read_b64_tr_b16 v[68:69], v14 offset:16384
    v_mfma_f32_16x16x32_bf16 v[140:143], v[124:127], v[80:83], v[140:143]
    ds_read_b64_tr_b16 v[70:71], v15 offset:16384
    v_mfma_f32_16x16x32_bf16 v[144:147], v[112:115], v[88:91], v[144:147]
    ds_read_b64_tr_b16 v[72:73], v12 offset:24576
    v_mfma_f32_16x16x32_bf16 v[148:151], v[116:119], v[88:91], v[148:151]
    ds_read_b64_tr_b16 v[74:75], v13 offset:24576
    v_mfma_f32_16x16x32_bf16 v[152:155], v[120:123], v[88:91], v[152:155]
    ds_read_b64_tr_b16 v[76:77], v14 offset:24576
    v_mfma_f32_16x16x32_bf16 v[156:159], v[124:127], v[88:91], v[156:159]
    ds_read_b64_tr_b16 v[78:79], v15 offset:24576
    v_mfma_f32_16x16x32_bf16 v[160:163], v[112:115], v[96:99], v[160:163]
    ds_read_b128 v[32:35], v6 offset:0
    v_mfma_f32_16x16x32_bf16 v[164:167], v[116:119], v[96:99], v[164:167]
    ds_read_b128 v[40:43], v6 offset:2048
    v_mfma_f32_16x16x32_bf16 v[168:171], v[120:123], v[96:99], v[168:171]
    ds_read_b128 v[48:51], v6 offset:4096
    v_mfma_f32_16x16x32_bf16 v[172:175], v[124:127], v[96:99], v[172:175]
    ds_read_b128 v[56:59], v6 offset:6144
    v_mfma_f32_16x16x32_bf16 v[176:179], v[112:115], v[104:107], v[176:179]
    v_mfma_f32_16x16x32_bf16 v[180:183], v[116:119], v[104:107], v[180:183]
    v_mfma_f32_16x16x32_bf16 v[184:187], v[120:123], v[104:107], v[184:187]
    v_mfma_f32_16x16x32_bf16 v[188:191], v[124:127], v[104:107], v[188:191]
    s_waitcnt lgkmcnt(0)
    s_waitcnt vmcnt(8)
    s_barrier
    s_add_u32 m0, s21, 65536
    s_nop 0
    buffer_load_dwordx4 v1, s[4:7], s16 offen sc1 lds
    s_add_u32 s16, s16, s62
    s_add_u32 m0, s21, 66560
    s_nop 0
    buffer_load_dwordx4 v1, s[4:7], s17 offen sc1 lds
    s_add_u32 s17, s17, s62
    s_add_u32 m0, s22, 65536
    s_nop 0
    buffer_load_dwordx4 v2, s[8:11], s18 offen lds
    s_add_u32 s18, s18, s20
    s_add_u32 m0, s22, 73728
    s_nop 0
    buffer_load_dwordx4 v2, s[12:15], s19 offen lds
    s_add_u32 s19, s19, s20
    v_mfma_f32_16x16x32_bf16 v[128:131], v[64:67], v[32:35], v[128:131]
    ds_read_b64_tr_b16 v[112:113], v12 offset:49152
    v_mfma_f32_16x16x32_bf16 v[132:135], v[68:71], v[32:35], v[132:135]
    ds_read_b64_tr_b16 v[114:115], v13 offset:49152
    v_mfma_f32_16x16x32_bf16 v[136:139], v[72:75], v[32:35], v[136:139]
    ds_read_b64_tr_b16 v[116:117], v14 offset:49152
    v_mfma_f32_16x16x32_bf16 v[140:143], v[76:79], v[32:35], v[140:143]
    ds_read_b64_tr_b16 v[118:119], v15 offset:49152
    v_mfma_f32_16x16x32_bf16 v[144:147], v[64:67], v[40:43], v[144:147]
    ds_read_b64_tr_b16 v[120:121], v12 offset:57344
    v_mfma_f32_16x16x32_bf16 v[148:151], v[68:71], v[40:43], v[148:151]
    ds_read_b64_tr_b16 v[122:123], v13 offset:57344
    v_mfma_f32_16x16x32_bf16 v[152:155], v[72:75], v[40:43], v[152:155]
    ds_read_b64_tr_b16 v[124:125], v14 offset:57344
    v_mfma_f32_16x16x32_bf16 v[156:159], v[76:79], v[40:43], v[156:159]
    ds_read_b64_tr_b16 v[126:127], v15 offset:57344
    v_mfma_f32_16x16x32_bf16 v[160:163], v[64:67], v[48:51], v[160:163]
    ds_read_b128 v[80:83], v6 offset:32768
    v_mfma_f32_16x16x32_bf16 v[164:167], v[68:71], v[48:51], v[164:167]
    ds_read_b128 v[88:91], v6 offset:34816
    v_mfma_f32_16x16x32_bf16 v[168:171], v[72:75], v[48:51], v[168:171]
    ds_read_b128 v[96:99], v6 offset:36864
    v_mfma_f32_16x16x32_bf16 v[172:175], v[76:79], v[48:51], v[172:175]
    ds_read_b128 v[104:107], v6 offset:38912
    v_mfma_f32_16x16x32_bf16 v[176:179], v[64:67], v[56:59], v[176:179]
    v_mfma_f32_16x16x32_bf16 v[180:183], v[68:71], v[56:59], v[180:183]
    v_mfma_f32_16x16x32_bf16 v[184:187], v[72:75], v[56:59], v[184:187]
    v_mfma_f32_16x16x32_bf16 v[188:191], v[76:79], v[56:59], v[188:191]
    s_waitcnt lgkmcnt(0)
    s_waitcnt vmcnt(8)
    s_barrier
    s_add_u32 m0, s21, 98304
    s_nop 0
    buffer_load_dwordx4 v1, s[4:7], s16 offen sc1 lds
    s_add_u32 s16, s16, s62
    s_add_u32 m0, s21, 99328
    s_nop 0
    buffer_load_dwordx4 v1, s[4:7], s17 offen sc1 lds
    s_add_u32 s17, s17, s62
    s_add_u32 m0, s22, 98304
    s_nop 0
    buffer_load_dwordx4 v2, s[8:11], s18 offen lds
    s_add_u32 s18, s18, s20
    s_add_u32 m0, s22, 106496
    s_nop 0
    buffer_load_dwordx4 v2, s[12:15], s19 offen lds
    s_add_u32 s19, s19, s20
    v_mfma_f32_16x16x32_bf16 v[128:131], v[112:115], v[80:83], v[128:131]
    ds_read_b64_tr_b16 v[64:65], v8 offset:16384
    v_mfma_f32_16x16x32_bf16 v[132:135], v[116:119], v[80:83], v[132:135]
    ds_read_b64_tr_b16 v[66:67], v9 offset:16384
    v_mfma_f32_16x16x32_bf16 v[136:139], v[120:123], v[80:83], v[136:139]
    ds_read_b64_tr_b16 v[68:69], v10 offset:16384
    v_mfma_f32_16x16x32_bf16 v[140:143], v[124:127], v[80:83], v[140:143]
    ds_read_b64_tr_b16 v[70:71], v11 offset:16384
    v_mfma_f32_16x16x32_bf16 v[144:147], v[112:115], v[88:91], v[144:147]
    ds_read_b64_tr_b16 v[72:73], v8 offset:24576
    v_mfma_f32_16x16x32_bf16 v[148:151], v[116:119], v[88:91], v[148:151]
    ds_read_b64_tr_b16 v[74:75], v9 offset:24576
    v_mfma_f32_16x16x32_bf16 v[152:155], v[120:123], v[88:91], v[152:155]
    ds_read_b64_tr_b16 v[76:77], v10 offset:24576
    v_mfma_f32_16x16x32_bf16 v[156:159], v[124:127], v[88:91], v[156:159]
    ds_read_b64_tr_b16 v[78:79], v11 offset:24576
    v_mfma_f32_16x16x32_bf16 v[160:163], v[112:115], v[96:99], v[160:163]
    ds_read_b128 v[32:35], v5 offset:0
    v_mfma_f32_16x16x32_bf16 v[164:167], v[116:119], v[96:99], v[164:167]
    ds_read_b128 v[36:39], v5 offset:1024
    v_mfma_f32_16x16x32_bf16 v[168:171], v[120:123], v[96:99], v[168:171]
    ds_read_b128 v[40:43], v5 offset:2048
    v_mfma_f32_16x16x32_bf16 v[172:175], v[124:127], v[96:99], v[172:175]
    ds_read_b128 v[44:47], v5 offset:3072
    v_mfma_f32_16x16x32_bf16 v[176:179], v[112:115], v[104:107], v[176:179]
    ds_read_b128 v[48:51], v5 offset:4096
    v_mfma_f32_16x16x32_bf16 v[180:183], v[116:119], v[104:107], v[180:183]
    ds_read_b128 v[52:55], v5 offset:5120
    v_mfma_f32_16x16x32_bf16 v[184:187], v[120:123], v[104:107], v[184:187]
    ds_read_b128 v[56:59], v5 offset:6144
    v_mfma_f32_16x16x32_bf16 v[188:191], v[124:127], v[104:107], v[188:191]
    ds_read_b128 v[60:63], v5 offset:7168
    s_waitcnt lgkmcnt(0)
    s_branch w_doneM
w_bodyM:
    buffer_load_dword v22, off, s[64:67], 0 sc1
    s_waitcnt vmcnt(6)
    s_barrier
    s_add_u32 m0, s21, 0
    s_nop 0
    buffer_load_dwordx4 v1, s[4:7], s16 offen sc1 lds
    s_add_u32 s16, s16, s62
    s_add_u32 m0, s22, 0
    s_nop 0
    buffer_load_dwordx4 v2, s[8:11], s18 offen lds
    s_add_u32 s18, s18, s20
    s_add_u32 m0, s22, 8192
    s_nop 0
    buffer_load_dwordx4 v2, s[12:15], s19 offen lds
    s_add_u32 s19, s19, s20
    v_mfma_f32_16x16x32_bf16 v[128:131], v[64:67], v[32:35], v[128:131]
    ds_read_b64_tr_b16 v[112:113], v8 offset:49152
    v_mfma_f32_16x16x32_bf16 v[132:135], v[68:71], v[32:35], v[132:135]
    ds_read_b64_tr_b16 v[114:115], v9 offset:49152
    v_mfma_f32_16x16x32_bf16 v[136:139], v[72:75], v[32:35], v[136:139]
    ds_read_b64_tr_b16 v[116:117], v10 offset:49152
    v_mfma_f32_16x16x32_bf16 v[140:143], v[76:79], v[32:35], v[140:143]
    ds_read_b64_tr_b16 v[118:119], v11 offset:49152
    v_mfma_f32_16x16x32_bf16 v[144:147], v[64:67], v[40:43], v[144:147]
    ds_read_b64_tr_b16 v[120:121], v8 offset:57344
    v_mfma_f32_16x16x32_bf16 v[148:151], v[68:71], v[40:43], v[148:151]
    ds_read_b64_tr_b16 v[122:123], v9 offset:57344
    v_mfma_f32_16x16x32_bf16 v[152:155], v[72:75], v[40:43], v[152:155]
    ds_read_b64_tr_b16 v[124:125], v10 offset:57344
    v_mfma_f32_16x16x32_bf16 v[156:159], v[76:79], v[40:43], v[156:159]
    ds_read_b64_tr_b16 v[126:127], v11 offset:57344
    v_mfma_f32_16x16x32_bf16 v[160:163], v[64:67], v[48:51], v[160:163]
    ds_read_b128 v[80:83], v5 offset:32768
    v_mfma_f32_16x16x32_bf16 v[164:167], v[68:71], v[48:51], v[164:167]
    ds_read_b128 v[88:91], v5 offset:34816
    v_mfma_f32_16x16x32_bf16 v[168:171], v[72:75], v[48:51], v[168:171]
    ds_read_b128 v[96:99], v5 offset:36864
    v_mfma_f32_16x16x32_bf16 v[172:175], v[76:79], v[48:51], v[172:175]
    ds_read_b128 v[104:107], v5 offset:38912
    v_mfma_f32_16x16x32_bf16 v[176:179], v[64:67], v[56:59], v[176:179]
    v_mfma_f32_16x16x32_bf16 v[180:183], v[68:71], v[56:59], v[180:183]
    v_mfma_f32_16x16x32_bf16 v[184:187], v[72:75], v[56:59], v[184:187]
    v_mfma_f32_16x16x32_bf16 v[188:191], v[76:79], v[56:59], v[188:191]
    buffer_load_dword v16, v17, s[4:7], s44 offen sc1
    s_waitcnt lgkmcnt(0)
    s_waitcnt vmcnt(6)
    s_barrier
    s_add_u32 m0, s21, 32768
    s_nop 0
    buffer_load_dwordx4 v1, s[4:7], s16 offen sc1 lds
    s_add_u32 s16, s16, s62
    s_add_u32 m0, s22, 32768
    s_nop 0
    buffer_load_dwordx4 v2, s[8:11], s18 offen lds
    s_add_u32 s18, s18, s20
    s_add_u32 m0, s22, 40960
    s_nop 0
    buffer_load_dwordx4 v2, s[12:15], s19 offen lds
    s_add_u32 s19, s19, s20
    v_mfma_f32_16x16x32_bf16 v[128:131], v[112:115], v[80:83], v[128:131]
    ds_read_b64_tr_b16 v[64:65], v12 offset:16384
    v_mfma_f32_16x16x32_bf16 v[132:135], v[116:119], v[80:83], v[132:135]
    ds_read_b64_tr_b16 v[66:67], v13 offset:16384
    v_mfma_f32_16x16x32_bf16 v[136:139], v[120:123], v[80:83], v[136:139]
    ds_read_b64_tr_b16 v[68:69], v14 offset:16384
    v_mfma_f32_16x16x32_bf16 v[140:143], v[124:127], v[80:83], v[140:143]
    ds_read_b64_tr_b16 v[70:71], v15 offset:16384
    v_mfma_f32_16x16x32_bf16 v[144:147], v[112:115], v[88:91], v[144:147]
    ds_read_b64_tr_b16 v[72:73], v12 offset:24576
    v_mfma_f32_16x16x32_bf16 v[148:151], v[116:119], v[88:91], v[148:151]
    ds_read_b64_tr_b16 v[74:75], v13 offset:24576
    v_mfma_f32_16x16x32_bf16 v[152:155], v[120:123], v[88:91], v[152:155]
    ds_read_b64_tr_b16 v[76:77], v14 offset:24576
    v_mfma_f32_16x16x32_bf16 v[156:159], v[124:127], v[88:91], v[156:159]
    ds_read_b64_tr_b16 v[78:79], v15 offset:24576
    v_mfma_f32_16x16x32_bf16 v[160:163], v[112:115], v[96:99], v[160:163]
    ds_read_b128 v[32:35], v6 offset:0
    v_mfma_f32_16x16x32_bf16 v[164:167], v[116:119], v[96:99], v[164:167]
    ds_read_b128 v[40:43], v6 offset:2048
    v_mfma_f32_16x16x32_bf16 v[168:171], v[120:123], v[96:99], v[168:171]
    ds_read_b128 v[48:51], v6 offset:4096
    v_mfma_f32_16x16x32_bf16 v[172:175], v[124:127], v[96:99], v[172:175]
    ds_read_b128 v[56:59], v6 offset:6144
    v_mfma_f32_16x16x32_bf16 v[176:179], v[112:115], v[104:107], v[176:179]
    v_mfma_f32_16x16x32_bf16 v[180:183], v[116:119], v[104:107], v[180:183]
    v_mfma_f32_16x16x32_bf16 v[184:187], v[120:123], v[104:107], v[184:187]
    v_mfma_f32_16x16x32_bf16 v[188:191], v[124:127], v[104:107], v[188:191]
    s_waitcnt lgkmcnt(0)
    s_waitcnt vmcnt(6)
    s_barrier
    s_add_u32 m0, s21, 65536
    s_nop 0
    buffer_load_dwordx4 v1, s[4:7], s16 offen sc1 lds
    s_add_u32 s16, s16, s62
    s_add_u32 m0, s22, 65536
    s_nop 0
    buffer_load_dwordx4 v2, s[8:11], s18 offen lds
    s_add_u32 s18, s18, s20
    s_add_u32 m0, s22, 73728
    s_nop 0
    buffer_load_dwordx4 v2, s[12:15], s19 offen lds
    s_add_u32 s19, s19, s20
    v_mfma_f32_16x16x32_bf16 v[128:131], v[64:67], v[32:35], v[128:131]
    ds_read_b64_tr_b16 v[112:113], v12 offset:49152
    v_mfma_f32_16x16x32_bf16 v[132:135], v[68:71], v[32:35], v[132:135]
    ds_read_b64_tr_b16 v[114:115], v13 offset:49152
    v_mfma_f32_16x16x32_bf16 v[136:139], v[72:75], v[32:35], v[136:139]
    ds_read_b64_tr_b16 v[116:117], v14 offset:49152
    v_mfma_f32_16x16x32_bf16 v[140:143], v[76:79], v[32:35], v[140:143]
    ds_read_b64_tr_b16 v[118:119], v15 offset:49152
    v_mfma_f32_16x16x32_bf16 v[144:147], v[64:67], v[40:43], v[144:147]
    ds_read_b64_tr_b16 v[120:121], v12 offset:57344
    v_mfma_f32_16x16x32_bf16 v[148:151], v[68:71], v[40:43], v[148:151]
    ds_read_b64_tr_b16 v[122:123], v13 offset:57344
    v_mfma_f32_16x16x32_bf16 v[152:155], v[72:75], v[40:43], v[152:155]
    ds_read_b64_tr_b16 v[124:125], v14 offset:57344
    v_mfma_f32_16x16x32_bf16 v[156:159], v[76:79], v[40:43], v[156:159]
    ds_read_b64_tr_b16 v[126:127], v15 offset:57344
    v_mfma_f32_16x16x32_bf16 v[160:163], v[64:67], v[48:51], v[160:163]
    ds_read_b128 v[80:83], v6 offset:32768
    v_mfma_f32_16x16x32_bf16 v[164:167], v[68:71], v[48:51], v[164:167]
    ds_read_b128 v[88:91], v6 offset:34816
    v_mfma_f32_16x16x32_bf16 v[168:171], v[72:75], v[48:51], v[168:171]
    ds_read_b128 v[96:99], v6 offset:36864
    v_mfma_f32_16x16x32_bf16 v[172:175], v[76:79], v[48:51], v[172:175]
    ds_read_b128 v[104:107], v6 offset:38912
    v_mfma_f32_16x16x32_bf16 v[176:179], v[64:67], v[56:59], v[176:179]
    v_mfma_f32_16x16x32_bf16 v[180:183], v[68:71], v[56:59], v[180:183]
    v_mfma_f32_16x16x32_bf16 v[184:187], v[72:75], v[56:59], v[184:187]
    v_mfma_f32_16x16x32_bf16 v[188:191], v[76:79], v[56:59], v[188:191]
    s_waitcnt lgkmcnt(0)
    s_waitcnt vmcnt(6)
    s_barrier
    s_add_u32 m0, s21, 98304
    s_nop 0
    buffer_load_dwordx4 v1, s[4:7], s16 offen sc1 lds
    s_add_u32 s16, s16, s62
    s_add_u32 m0, s22, 98304
    s_nop 0
    buffer_load_dwordx4 v2, s[8:11], s18 offen lds
    s_add_u32 s18, s18, s20
    s_add_u32 m0, s22, 106496
    s_nop 0
    buffer_load_dwordx4 v2, s[12:15], s19 offen lds
    s_add_u32 s19, s19, s20
    v_mfma_f32_16x16x32_bf16 v[128:131], v[112:115], v[80:83], v[128:131]
    ds_read_b64_tr_b16 v[64:65], v8 offset:16384
    v_mfma_f32_16x16x32_bf16 v[132:135], v[116:119], v[80:83], v[132:135]
    ds_read_b64_tr_b16 v[66:67], v9 offset:16384
    v_mfma_f32_16x16x32_bf16 v[136:139], v[120:123], v[80:83], v[136:139]
    ds_read_b64_tr_b16 v[68:69], v10 offset:16384
    v_mfma_f32_16x16x32_bf16 v[140:143], v[124:127], v[80:83], v[140:143]
    ds_read_b64_tr_b16 v[70:71], v11 offset:16384
    v_mfma_f32_16x16x32_bf16 v[144:147], v[112:115], v[88:91], v[144:147]
    ds_read_b64_tr_b16 v[72:73], v8 offset:24576
    v_mfma_f32_16x16x32_bf16 v[148:151], v[116:119], v[88:91], v[148:151]
    ds_read_b64_tr_b16 v[74:75], v9 offset:24576
    v_mfma_f32_16x16x32_bf16 v[152:155], v[120:123], v[88:91], v[152:155]
    ds_read_b64_tr_b16 v[76:77], v10 offset:24576
    v_mfma_f32_16x16x32_bf16 v[156:159], v[124:127], v[88:91], v[156:159]
    ds_read_b64_tr_b16 v[78:79], v11 offset:24576
    v_mfma_f32_16x16x32_bf16 v[160:163], v[112:115], v[96:99], v[160:163]
    ds_read_b128 v[32:35], v5 offset:0
    v_mfma_f32_16x16x32_bf16 v[164:167], v[116:119], v[96:99], v[164:167]
    ds_read_b128 v[40:43], v5 offset:2048
    v_mfma_f32_16x16x32_bf16 v[168:171], v[120:123], v[96:99], v[168:171]
    ds_read_b128 v[48:51], v5 offset:4096
    v_mfma_f32_16x16x32_bf16 v[172:175], v[124:127], v[96:99], v[172:175]
    ds_read_b128 v[56:59], v5 offset:6144
    v_mfma_f32_16x16x32_bf16 v[176:179], v[112:115], v[104:107], v[176:179]
    v_mfma_f32_16x16x32_bf16 v[180:183], v[116:119], v[104:107], v[180:183]
    v_mfma_f32_16x16x32_bf16 v[184:187], v[120:123], v[104:107], v[184:187]
    v_mfma_f32_16x16x32_bf16 v[188:191], v[124:127], v[104:107], v[188:191]
    s_waitcnt lgkmcnt(0)
    s_sub_u32 s23, s23, 1
    s_cmp_lg_u32 s23, 0
    s_cbranch_scc1 w_loopM
w_doneM:
    v_mov_b32 v20, 131072
    ds_read_b128 v[24:27], v20
    ds_read_b128 v[28:31], v20 offset:16
    s_lshl_b32 s30, s27, 10
    s_add_u32 s30, s30, s49
    s_nop 7
    v_cvt_pk_bf16_f32 v80, v128, v129
    v_cvt_pk_bf16_f32 v81, v130, v131
    v_cvt_pk_bf16_f32 v82, v132, v133
    v_cvt_pk_bf16_f32 v83, v134, v135
    buffer_store_dwordx4 v[80:83], v1, s[4:7], s30 offen sc1
    v_cvt_pk_bf16_f32 v84, v136, v137
    v_cvt_pk_bf16_f32 v85, v138, v139
    v_cvt_pk_bf16_f32 v86, v140, v141
    v_cvt_pk_bf16_f32 v87, v142, v143
    buffer_store_dwordx4 v[84:87], v19, s[4:7], s30 offen sc1
    s_add_u32 s30, s30, s50
    v_cvt_pk_bf16_f32 v88, v144, v145
    v_cvt_pk_bf16_f32 v89, v146, v147
    v_cvt_pk_bf16_f32 v90, v148, v149
    v_cvt_pk_bf16_f32 v91, v150, v151
    buffer_store_dwordx4 v[88:91], v1, s[4:7], s30 offen sc1
    v_cvt_pk_bf16_f32 v92, v152, v153
    v_cvt_pk_bf16_f32 v93, v154, v155
    v_cvt_pk_bf16_f32 v94, v156, v157
    v_cvt_pk_bf16_f32 v95, v158, v159
    buffer_store_dwordx4 v[92:95], v19, s[4:7], s30 offen sc1
    s_add_u32 s30, s30, s50
    v_cvt_pk_bf16_f32 v80, v160, v161
    v_cvt_pk_bf16_f32 v81, v162, v163
    v_cvt_pk_bf16_f32 v82, v164, v165
    v_cvt_pk_bf16_f32 v83, v166, v167
    buffer_store_dwordx4 v[80:83], v1, s[4:7], s30 offen sc1
    v_cvt_pk_bf16_f32 v84, v168, v169
    v_cvt_pk_bf16_f32 v85, v170, v171
    v_cvt_pk_bf16_f32 v86, v172, v173
    v_cvt_pk_bf16_f32 v87, v174, v175
    buffer_store_dwordx4 v[84:87], v19, s[4:7], s30 offen sc1
    s_add_u32 s30, s30, s50
    v_cvt_pk_bf16_f32 v88, v176, v177
    v_cvt_pk_bf16_f32 v89, v178, v179
    v_cvt_pk_bf16_f32 v90, v180, v181
    v_cvt_pk_bf16_f32 v91, v182, v183
    buffer_store_dwordx4 v[88:91], v1, s[4:7], s30 offen sc1
    v_cvt_pk_bf16_f32 v92, v184, v185
    v_cvt_pk_bf16_f32 v93, v186, v187
    v_cvt_pk_bf16_f32 v94, v188, v189
    v_cvt_pk_bf16_f32 v95, v190, v191
    buffer_store_dwordx4 v[92:95], v19, s[4:7], s30 offen sc1
    s_add_u32 s30, s30, s50
    s_waitcnt lgkmcnt(0)
    v_or3_b32 v24, v24, v25, v26
    v_or3_b32 v28, v28, v29, v30
    v_or3_b32 v24, v24, v27, v31
    v_or_b32 v24, v24, v28
    s_mov_b32 s28, s51
    s_mov_b32 s57, s53
    v_readfirstlane_b32 s30, v24
    s_cmp_lg_u32 s30, 0
    s_cbranch_scc1 w_drain
    s_mov_b32 s48, s32
    s_cmp_ge_u32 s32, 4
    s_cselect_b32 s30, 2, 3
    s_lshl_b32 s30, s26, s30
    s_mul_i32 s30, s30, s43
    s_add_u32 s49, s42, s30
    s_mov_b32 s50, s43
    s_mov_b32 s51, s46
    s_mov_b32 s23, s41
    s_mov_b32 s53, s47
    s_nop 0
    s_load_dwordx16 s[32:47], s[24:25], 0
    s_add_u32 s24, s24, 64
    s_addc_u32 s25, s25, 0
    s_branch w_first8
w_drain:
    s_waitcnt vmcnt(0)
    s_barrier
    s_cmp_eq_u32 s28, 0
    s_cbranch_scc1 sig_5
    s_cmp_lg_u32 s3, 0
    s_cbranch_scc1 sig_5
    s_mov_b64 exec, 1
    v_mov_b32 v18, s57
    buffer_atomic_add v18, v17, s[4:7], s28 offen sc1
    s_mov_b64 exec, -1
sig_5:
    s_mov_b32 s28, 0
    s_cmp_eq_u32 s98, 1
    s_cbranch_scc1 ln_entry
    s_cmp_eq_u32 s70, 0
    s_cbranch_scc1 drw_ok
    s_cmp_lt_u32 s39, 1048576
    s_cbranch_scc1 drw_ok
    s_mov_b32 s70, 0
    s_cmp_lg_u32 s3, 0
    s_cbranch_scc1 drw_ok
    v_readfirstlane_b32 s68, v22
    s_cmp_ge_u32 s68, 128
    s_cbranch_scc1 drw_ok
    s_mov_b32 s69, 65536
drw:
    buffer_load_dword v20, off, s[64:67], 0 offset:0 sc1
    s_waitcnt vmcnt(0)
    v_readfirstlane_b32 s68, v20
    s_cmp_ge_u32 s68, 128
    s_cbranch_scc1 drw_ok
    s_sleep 8
    s_sub_u32 s69, s69, 1
    s_cbranch_scc0 drw
drw_ok:
    s_branch w_cold
fin_entry:
    s_load_dwordx2 s[8:9], s[0:1], 0
    s_load_dwordx2 s[12:13], s[0:1], 88
    v_mbcnt_lo_u32_b32 v1, -1, 0
    v_mbcnt_hi_u32_b32 v1, -1, v1
    s_mov_b32 s10, 4194304
    s_mov_b32 s11, 131072
    s_mov_b32 s14, 4194304
    s_mov_b32 s15, 131072
    v_lshlrev_b32 v3, 4, v1
    v_and_b32 v4, 15, v1
    v_lshrrev_b32 v5, 4, v1
    v_lshlrev_b32 v4, 11, v4
    v_lshl_add_u32 v4, v5, 4, v4
    v_and_b32 v5, 1, v5
    v_cmp_eq_u32 s[20:21], 1, v5
    v_and_b32 v6, 7, v1
    v_lshlrev_b32 v6, 7, v6
    s_lshr_b32 s24, s63, 2
    s_and_b32 s25, s63, 3
    s_lshl_b32 s25, s25, 2
    s_and_b32 s26, s3, 3
    s_add_u32 s25, s25, s26
    s_lshr_b32 s26, s3, 2
    s_mov_b32 s28, 65536
    s_waitcnt lgkmcnt(0)
fin_job:
    s_lshl_b32 s16, s24, 1
    s_add_u32 s16, s16, s26
    s_lshl_b32 s18, s16, 15
    s_lshl_b32 s17, s25, 11
    s_add_u32 s17, s17, s18
    s_lshl_b32 s19, s25, 7
    s_add_u32 s18, s18, s19
    s_add_u32 s22, s17, 167772160
    s_add_u32 s23, s17, 75497472
    s_lshr_b32 s27, s24, 3
    s_lshl_b32 s27, s27, 6
    s_add_u32 s27, s27, 218106368
    s_cmp_ge_u32 s24, 64
    s_cselect_b32 s29, 16, 16
    s_mov_b32 s30, 218112000
    s_add_u32 s32, s24, 1
    s_mov_b32 s33, 0
    s_mov_b32 s34, 255
    s_cmp_lt_u32 s24, 62
    s_cbranch_scc1 fin_tg
    s_mov_b32 s32, 16
    s_add_u32 s30, s30, 4
    s_sub_u32 s33, s24, 62
    s_lshl_b32 s33, s33, 3
fin_tg:
    s_mul_i32 s35, s24, 3
    s_lshr_b32 s35, s35, 4
    s_add_u32 s35, s35, 49
    s_min_u32 s35, s35, 61
    s_max_u32 s32, s32, s35
    buffer_load_dwordx4 v[88:91], v4, s[8:11], s18 offen offset:0
    buffer_load_dwordx4 v[92:95], v4, s[8:11], s18 offen offset:64
    s_cmp_lg_u32 s3, 0
    s_cbranch_scc1 fin_ws_ok
fin_wd:
    buffer_load_dword v7, off, s[4:7], s27 sc1
    s_waitcnt vmcnt(0)
    v_readfirstlane_b32 s31, v7
    s_cmp_ge_u32 s31, s29
    s_cbranch_scc1 fin_wd_ok
    s_sleep 127
    s_sub_u32 s28, s28, 1
    s_cbranch_scc0 fin_wd
    s_mov_b32 s28, 0
fin_wd_ok:
fin_ws:
    buffer_load_dword v7, v6, s[4:7], s30 offen sc1
    s_waitcnt vmcnt(0)
    v_lshrrev_b32 v7, s33, v7
    v_and_b32 v7, s34, v7
    v_cmp_gt_u32 vcc, s32, v7
    s_cbranch_vccz fin_ws_ok
    s_sleep 12
    v_add_u32 v7, 1, v7
    v_cmp_gt_u32 vcc, s32, v7
    s_cbranch_vccz fin_ws_f
    s_sleep 48
    v_add_u32 v7, 3, v7
    v_cmp_gt_u32 vcc, s32, v7
    s_cbranch_vccz fin_ws_f
    s_sleep 127
    s_sleep 127
fin_ws_f:
    s_sub_u32 s28, s28, 1
    s_cbranch_scc0 fin_ws
    s_mov_b32 s28, 0
fin_ws_ok:
    s_barrier
    buffer_load_dwordx4 v[144:147], v3, s[4:7], s22 offen offset:0 sc1
    buffer_load_dwordx4 v[160:163], v3, s[4:7], s22 offen offset:1024 sc1
    s_add_u32 s22, s22, 4194304
    buffer_load_dwordx4 v[148:151], v3, s[4:7], s22 offen offset:0 sc1
    buffer_load_dwordx4 v[164:167], v3, s[4:7], s22 offen offset:1024 sc1
    s_add_u32 s22, s22, 4194304
    buffer_load_dwordx4 v[152:155], v3, s[4:7], s22 offen offset:0 sc1
    buffer_load_dwordx4 v[168:171], v3, s[4:7], s22 offen offset:1024 sc1
    s_add_u32 s22, s22, 4194304
    buffer_load_dwordx4 v[156:159], v3, s[4:7], s22 offen offset:0 sc1
    buffer_load_dwordx4 v[172:175], v3, s[4:7], s22 offen offset:1024 sc1
    buffer_load_dwordx4 v[16:19], v3, s[4:7], s23 offen offset:0 sc1
    buffer_load_dwordx4 v[48:51], v3, s[4:7], s23 offen offset:1024 sc1
    s_add_u32 s23, s23, 4194304
    buffer_load_dwordx4 v[20:23], v3, s[4:7], s23 offen offset:0 sc1
    buffer_load_dwordx4 v[52:55], v3, s[4:7], s23 offen offset:1024 sc1
    s_add_u32 s23, s23, 4194304
    buffer_load_dwordx4 v[24:27], v3, s[4:7], s23 offen offset:0 sc1
    buffer_load_dwordx4 v[56:59], v3, s[4:7], s23 offen offset:1024 sc1
    s_add_u32 s23, s23, 4194304
    buffer_load_dwordx4 v[28:31], v3, s[4:7], s23 offen offset:0 sc1
    buffer_load_dwordx4 v[60:63], v3, s[4:7], s23 offen offset:1024 sc1
    s_add_u32 s23, s23, 4194304
    buffer_load_dwordx4 v[32:35], v3, s[4:7], s23 offen offset:0 sc1
    buffer_load_dwordx4 v[64:67], v3, s[4:7], s23 offen offset:1024 sc1
    s_add_u32 s23, s23, 4194304
    buffer_load_dwordx4 v[36:39], v3, s[4:7], s23 offen offset:0 sc1
    buffer_load_dwordx4 v[68:71], v3, s[4:7], s23 offen offset:1024 sc1
    s_add_u32 s23, s23, 4194304
    buffer_load_dwordx4 v[40:43], v3, s[4:7], s23 offen offset:0 sc1
    buffer_load_dwordx4 v[72:75], v3, s[4:7], s23 offen offset:1024 sc1
    s_add_u32 s23, s23, 4194304
    buffer_load_dwordx4 v[44:47], v3, s[4:7], s23 offen offset:0 sc1
    buffer_load_dwordx4 v[76:79], v3, s[4:7], s23 offen offset:1024 sc1
    s_add_u32 s23, s23, 4194304
    s_waitcnt vmcnt(16)
    v_lshlrev_b32 v96, 16, v144
    v_and_b32 v97, 0xffff0000, v144
    v_lshlrev_b32 v98, 16, v145
    v_and_b32 v99, 0xffff0000, v145
    v_lshlrev_b32 v100, 16, v146
    v_and_b32 v101, 0xffff0000, v146
    v_lshlrev_b32 v102, 16, v147
    v_and_b32 v103, 0xffff0000, v147
    v_lshlrev_b32 v120, 16, v148
    v_and_b32 v121, 0xffff0000, v148
    v_lshlrev_b32 v122, 16, v149
    v_and_b32 v123, 0xffff0000, v149
    v_lshlrev_b32 v124, 16, v150
    v_and_b32 v125, 0xffff0000, v150
    v_lshlrev_b32 v126, 16, v151
    v_and_b32 v127, 0xffff0000, v151
    v_add_f32 v96, v96, v120
    v_add_f32 v97, v97, v121
    v_add_f32 v98, v98, v122
    v_add_f32 v99, v99, v123
    v_add_f32 v100, v100, v124
    v_add_f32 v101, v101, v125
    v_add_f32 v102, v102, v126
    v_add_f32 v103, v103, v127
    v_lshlrev_b32 v120, 16, v152
    v_and_b32 v121, 0xffff0000, v152
    v_lshlrev_b32 v122, 16, v153
    v_and_b32 v123, 0xffff0000, v153
    v_lshlrev_b32 v124, 16, v154
    v_and_b32 v125, 0xffff0000, v154
    v_lshlrev_b32 v126, 16, v155
    v_and_b32 v127, 0xffff0000, v155
    v_add_f32 v96, v96, v120
    v_add_f32 v97, v97, v121
    v_add_f32 v98, v98, v122
    v_add_f32 v99, v99, v123
    v_add_f32 v100, v100, v124
    v_add_f32 v101, v101, v125
    v_add_f32 v102, v102, v126
    v_add_f32 v103, v103, v127
    v_lshlrev_b32 v120, 16, v156
    v_and_b32 v121, 0xffff0000, v156
    v_lshlrev_b32 v122, 16, v157
    v_and_b32 v123, 0xffff0000, v157
    v_lshlrev_b32 v124, 16, v158
    v_and_b32 v125, 0xffff0000, v158
    v_lshlrev_b32 v126, 16, v159
    v_and_b32 v127, 0xffff0000, v159
    v_add_f32 v96, v96, v120
    v_add_f32 v97, v97, v121
    v_add_f32 v98, v98, v122
    v_add_f32 v99, v99, v123
    v_add_f32 v100, v100, v124
    v_add_f32 v101, v101, v125
    v_add_f32 v102, v102, v126
    v_add_f32 v103, v103, v127
    v_cvt_pk_bf16_f32 v120, v96, v97
    v_cvt_pk_bf16_f32 v121, v98, v99
    v_cvt_pk_bf16_f32 v122, v100, v101
    v_cvt_pk_bf16_f32 v123, v102, v103
    v_lshlrev_b32 v96, 16, v120
    v_and_b32 v97, 0xffff0000, v120
    v_lshlrev_b32 v98, 16, v121
    v_and_b32 v99, 0xffff0000, v121
    v_lshlrev_b32 v100, 16, v122
    v_and_b32 v101, 0xffff0000, v122
    v_lshlrev_b32 v102, 16, v123
    v_and_b32 v103, 0xffff0000, v123
    v_mul_f32 v104, 0xbfb8aa3b, v96
    v_mul_f32 v105, 0xbfb8aa3b, v97
    v_mul_f32 v106, 0xbfb8aa3b, v98
    v_mul_f32 v107, 0xbfb8aa3b, v99
    v_mul_f32 v108, 0xbfb8aa3b, v100
    v_mul_f32 v109, 0xbfb8aa3b, v101
    v_mul_f32 v110, 0xbfb8aa3b, v102
    v_mul_f32 v111, 0xbfb8aa3b, v103
    v_exp_f32 v104, v104
    v_exp_f32 v105, v105
    v_exp_f32 v106, v106
    v_exp_f32 v107, v107
    v_exp_f32 v108, v108
    v_exp_f32 v109, v109
    v_exp_f32 v110, v110
    v_exp_f32 v111, v111
    v_add_f32 v104, 1.0, v104
    v_add_f32 v105, 1.0, v105
    v_add_f32 v106, 1.0, v106
    v_add_f32 v107, 1.0, v107
    v_add_f32 v108, 1.0, v108
    v_add_f32 v109, 1.0, v109
    v_add_f32 v110, 1.0, v110
    v_add_f32 v111, 1.0, v111
    v_rcp_f32 v104, v104
    v_rcp_f32 v105, v105
    v_rcp_f32 v106, v106
    v_rcp_f32 v107, v107
    v_rcp_f32 v108, v108
    v_rcp_f32 v109, v109
    v_rcp_f32 v110, v110
    v_rcp_f32 v111, v111
    v_mul_f32 v96, v96, v104
    v_mul_f32 v97, v97, v105
    v_mul_f32 v98, v98, v106
    v_mul_f32 v99, v99, v107
    v_mul_f32 v100, v100, v108
    v_mul_f32 v101, v101, v109
    v_mul_f32 v102, v102, v110
    v_mul_f32 v103, v103, v111
    v_cvt_pk_bf16_f32 v80, v96, v97
    v_cvt_pk_bf16_f32 v81, v98, v99
    v_cvt_pk_bf16_f32 v82, v100, v101
    v_cvt_pk_bf16_f32 v83, v102, v103
    v_lshlrev_b32 v96, 16, v160
    v_and_b32 v97, 0xffff0000, v160
    v_lshlrev_b32 v98, 16, v161
    v_and_b32 v99, 0xffff0000, v161
    v_lshlrev_b32 v100, 16, v162
    v_and_b32 v101, 0xffff0000, v162
    v_lshlrev_b32 v102, 16, v163
    v_and_b32 v103, 0xffff0000, v163
    v_lshlrev_b32 v120, 16, v164
    v_and_b32 v121, 0xffff0000, v164
    v_lshlrev_b32 v122, 16, v165
    v_and_b32 v123, 0xffff0000, v165
    v_lshlrev_b32 v124, 16, v166
    v_and_b32 v125, 0xffff0000, v166
    v_lshlrev_b32 v126, 16, v167
    v_and_b32 v127, 0xffff0000, v167
    v_add_f32 v96, v96, v120
    v_add_f32 v97, v97, v121
    v_add_f32 v98, v98, v122
    v_add_f32 v99, v99, v123
    v_add_f32 v100, v100, v124
    v_add_f32 v101, v101, v125
    v_add_f32 v102, v102, v126
    v_add_f32 v103, v103, v127
    v_lshlrev_b32 v120, 16, v168
    v_and_b32 v121, 0xffff0000, v168
    v_lshlrev_b32 v122, 16, v169
    v_and_b32 v123, 0xffff0000, v169
    v_lshlrev_b32 v124, 16, v170
    v_and_b32 v125, 0xffff0000, v170
    v_lshlrev_b32 v126, 16, v171
    v_and_b32 v127, 0xffff0000, v171
    v_add_f32 v96, v96, v120
    v_add_f32 v97, v97, v121
    v_add_f32 v98, v98, v122
    v_add_f32 v99, v99, v123
    v_add_f32 v100, v100, v124
    v_add_f32 v101, v101, v125
    v_add_f32 v102, v102, v126
    v_add_f32 v103, v103, v127
    v_lshlrev_b32 v120, 16, v172
    v_and_b32 v121, 0xffff0000, v172
    v_lshlrev_b32 v122, 16, v173
    v_and_b32 v123, 0xffff0000, v173
    v_lshlrev_b32 v124, 16, v174
    v_and_b32 v125, 0xffff0000, v174
    v_lshlrev_b32 v126, 16, v175
    v_and_b32 v127, 0xffff0000, v175
    v_add_f32 v96, v96, v120
    v_add_f32 v97, v97, v121
    v_add_f32 v98, v98, v122
    v_add_f32 v99, v99, v123
    v_add_f32 v100, v100, v124
    v_add_f32 v101, v101, v125
    v_add_f32 v102, v102, v126
    v_add_f32 v103, v103, v127
    v_cvt_pk_bf16_f32 v120, v96, v97
    v_cvt_pk_bf16_f32 v121, v98, v99
    v_cvt_pk_bf16_f32 v122, v100, v101
    v_cvt_pk_bf16_f32 v123, v102, v103
    v_lshlrev_b32 v96, 16, v120
    v_and_b32 v97, 0xffff0000, v120
    v_lshlrev_b32 v98, 16, v121
    v_and_b32 v99, 0xffff0000, v121
    v_lshlrev_b32 v100, 16, v122
    v_and_b32 v101, 0xffff0000, v122
    v_lshlrev_b32 v102, 16, v123
    v_and_b32 v103, 0xffff0000, v123
    v_mul_f32 v104, 0xbfb8aa3b, v96
    v_mul_f32 v105, 0xbfb8aa3b, v97
    v_mul_f32 v106, 0xbfb8aa3b, v98
    v_mul_f32 v107, 0xbfb8aa3b, v99
    v_mul_f32 v108, 0xbfb8aa3b, v100
    v_mul_f32 v109, 0xbfb8aa3b, v101
    v_mul_f32 v110, 0xbfb8aa3b, v102
    v_mul_f32 v111, 0xbfb8aa3b, v103
    v_exp_f32 v104, v104
    v_exp_f32 v105, v105
    v_exp_f32 v106, v106
    v_exp_f32 v107, v107
    v_exp_f32 v108, v108
    v_exp_f32 v109, v109
    v_exp_f32 v110, v110
    v_exp_f32 v111, v111
    v_add_f32 v104, 1.0, v104
    v_add_f32 v105, 1.0, v105
    v_add_f32 v106, 1.0, v106
    v_add_f32 v107, 1.0, v107
    v_add_f32 v108, 1.0, v108
    v_add_f32 v109, 1.0, v109
    v_add_f32 v110, 1.0, v110
    v_add_f32 v111, 1.0, v111
    v_rcp_f32 v104, v104
    v_rcp_f32 v105, v105
    v_rcp_f32 v106, v106
    v_rcp_f32 v107, v107
    v_rcp_f32 v108, v108
    v_rcp_f32 v109, v109
    v_rcp_f32 v110, v110
    v_rcp_f32 v111, v111
    v_mul_f32 v96, v96, v104
    v_mul_f32 v97, v97, v105
    v_mul_f32 v98, v98, v106
    v_mul_f32 v99, v99, v107
    v_mul_f32 v100, v100, v108
    v_mul_f32 v101, v101, v109
    v_mul_f32 v102, v102, v110
    v_mul_f32 v103, v103, v111
    v_cvt_pk_bf16_f32 v84, v96, v97
    v_cvt_pk_bf16_f32 v85, v98, v99
    v_cvt_pk_bf16_f32 v86, v100, v101
    v_cvt_pk_bf16_f32 v87, v102, v103
    s_waitcnt vmcnt(0)
    v_lshlrev_b32 v96, 16, v16
    v_and_b32 v97, 0xffff0000, v16
    v_lshlrev_b32 v98, 16, v17
    v_and_b32 v99, 0xffff0000, v17
    v_lshlrev_b32 v100, 16, v18
    v_and_b32 v101, 0xffff0000, v18
    v_lshlrev_b32 v102, 16, v19
    v_and_b32 v103, 0xffff0000, v19
    v_lshlrev_b32 v120, 16, v20
    v_and_b32 v121, 0xffff0000, v20
    v_lshlrev_b32 v122, 16, v21
    v_and_b32 v123, 0xffff0000, v21
    v_lshlrev_b32 v124, 16, v22
    v_and_b32 v125, 0xffff0000, v22
    v_lshlrev_b32 v126, 16, v23
    v_and_b32 v127, 0xffff0000, v23
    v_add_f32 v96, v96, v120
    v_add_f32 v97, v97, v121
    v_add_f32 v98, v98, v122
    v_add_f32 v99, v99, v123
    v_add_f32 v100, v100, v124
    v_add_f32 v101, v101, v125
    v_add_f32 v102, v102, v126
    v_add_f32 v103, v103, v127
    v_lshlrev_b32 v120, 16, v24
    v_and_b32 v121, 0xffff0000, v24
    v_lshlrev_b32 v122, 16, v25
    v_and_b32 v123, 0xffff0000, v25
    v_lshlrev_b32 v124, 16, v26
    v_and_b32 v125, 0xffff0000, v26
    v_lshlrev_b32 v126, 16, v27
    v_and_b32 v127, 0xffff0000, v27
    v_add_f32 v96, v96, v120
    v_add_f32 v97, v97, v121
    v_add_f32 v98, v98, v122
    v_add_f32 v99, v99, v123
    v_add_f32 v100, v100, v124
    v_add_f32 v101, v101, v125
    v_add_f32 v102, v102, v126
    v_add_f32 v103, v103, v127
    v_lshlrev_b32 v120, 16, v28
    v_and_b32 v121, 0xffff0000, v28
    v_lshlrev_b32 v122, 16, v29
    v_and_b32 v123, 0xffff0000, v29
    v_lshlrev_b32 v124, 16, v30
    v_and_b32 v125, 0xffff0000, v30
    v_lshlrev_b32 v126, 16, v31
    v_and_b32 v127, 0xffff0000, v31
    v_add_f32 v96, v96, v120
    v_add_f32 v97, v97, v121
    v_add_f32 v98, v98, v122
    v_add_f32 v99, v99, v123
    v_add_f32 v100, v100, v124
    v_add_f32 v101, v101, v125
    v_add_f32 v102, v102, v126
    v_add_f32 v103, v103, v127
    v_lshlrev_b32 v120, 16, v32
    v_and_b32 v121, 0xffff0000, v32
    v_lshlrev_b32 v122, 16, v33
    v_and_b32 v123, 0xffff0000, v33
    v_lshlrev_b32 v124, 16, v34
    v_and_b32 v125, 0xffff0000, v34
    v_lshlrev_b32 v126, 16, v35
    v_and_b32 v127, 0xffff0000, v35
    v_add_f32 v96, v96, v120
    v_add_f32 v97, v97, v121
    v_add_f32 v98, v98, v122
    v_add_f32 v99, v99, v123
    v_add_f32 v100, v100, v124
    v_add_f32 v101, v101, v125
    v_add_f32 v102, v102, v126
    v_add_f32 v103, v103, v127
    v_lshlrev_b32 v120, 16, v36
    v_and_b32 v121, 0xffff0000, v36
    v_lshlrev_b32 v122, 16, v37
    v_and_b32 v123, 0xffff0000, v37
    v_lshlrev_b32 v124, 16, v38
    v_and_b32 v125, 0xffff0000, v38
    v_lshlrev_b32 v126, 16, v39
    v_and_b32 v127, 0xffff0000, v39
    v_add_f32 v96, v96, v120
    v_add_f32 v97, v97, v121
    v_add_f32 v98, v98, v122
    v_add_f32 v99, v99, v123
    v_add_f32 v100, v100, v124
    v_add_f32 v101, v101, v125
    v_add_f32 v102, v102, v126
    v_add_f32 v103, v103, v127
    v_lshlrev_b32 v120, 16, v40
    v_and_b32 v121, 0xffff0000, v40
    v_lshlrev_b32 v122, 16, v41
    v_and_b32 v123, 0xffff0000, v41
    v_lshlrev_b32 v124, 16, v42
    v_and_b32 v125, 0xffff0000, v42
    v_lshlrev_b32 v126, 16, v43
    v_and_b32 v127, 0xffff0000, v43
    v_add_f32 v96, v96, v120
    v_add_f32 v97, v97, v121
    v_add_f32 v98, v98, v122
    v_add_f32 v99, v99, v123
    v_add_f32 v100, v100, v124
    v_add_f32 v101, v101, v125
    v_add_f32 v102, v102, v126
    v_add_f32 v103, v103, v127
    v_lshlrev_b32 v120, 16, v44
    v_and_b32 v121, 0xffff0000, v44
    v_lshlrev_b32 v122, 16, v45
    v_and_b32 v123, 0xffff0000, v45
    v_lshlrev_b32 v124, 16, v46
    v_and_b32 v125, 0xffff0000, v46
    v_lshlrev_b32 v126, 16, v47
    v_and_b32 v127, 0xffff0000, v47
    v_add_f32 v96, v96, v120
    v_add_f32 v97, v97, v121
    v_add_f32 v98, v98, v122
    v_add_f32 v99, v99, v123
    v_add_f32 v100, v100, v124
    v_add_f32 v101, v101, v125
    v_add_f32 v102, v102, v126
    v_add_f32 v103, v103, v127
    v_cndmask_b32 v108, v88, v90, s[20:21]
    v_cndmask_b32 v109, v89, v91, s[20:21]
    v_cndmask_b32 v110, v90, v88, s[20:21]
    v_cndmask_b32 v111, v91, v89, s[20:21]
    v_cvt_pk_bf16_f32 v104, v96, v97
    v_lshlrev_b32 v96, 16, v104
    v_and_b32 v97, 0xffff0000, v104
    v_lshlrev_b32 v104, 16, v80
    v_and_b32 v105, 0xffff0000, v80
    v_mul_f32 v96, v96, v104
    v_mul_f32 v97, v97, v105
    v_cvt_pk_bf16_f32 v104, v96, v97
    v_lshlrev_b32 v96, 16, v104
    v_and_b32 v97, 0xffff0000, v104
    v_lshlrev_b32 v104, 16, v108
    v_and_b32 v105, 0xffff0000, v108
    v_add_f32 v96, v96, v104
    v_add_f32 v97, v97, v105
    v_cvt_pk_bf16_f32 v112, v96, v97
    v_cvt_pk_bf16_f32 v104, v98, v99
    v_lshlrev_b32 v98, 16, v104
    v_and_b32 v99, 0xffff0000, v104
    v_lshlrev_b32 v104, 16, v81
    v_and_b32 v105, 0xffff0000, v81
    v_mul_f32 v98, v98, v104
    v_mul_f32 v99, v99, v105
    v_cvt_pk_bf16_f32 v104, v98, v99
    v_lshlrev_b32 v98, 16, v104
    v_and_b32 v99, 0xffff0000, v104
    v_lshlrev_b32 v104, 16, v109
    v_and_b32 v105, 0xffff0000, v109
    v_add_f32 v98, v98, v104
    v_add_f32 v99, v99, v105
    v_cvt_pk_bf16_f32 v113, v98, v99
    v_cvt_pk_bf16_f32 v104, v100, v101
    v_lshlrev_b32 v100, 16, v104
    v_and_b32 v101, 0xffff0000, v104
    v_lshlrev_b32 v104, 16, v82
    v_and_b32 v105, 0xffff0000, v82
    v_mul_f32 v100, v100, v104
    v_mul_f32 v101, v101, v105
    v_cvt_pk_bf16_f32 v104, v100, v101
    v_lshlrev_b32 v100, 16, v104
    v_and_b32 v101, 0xffff0000, v104
    v_lshlrev_b32 v104, 16, v110
    v_and_b32 v105, 0xffff0000, v110
    v_add_f32 v100, v100, v104
    v_add_f32 v101, v101, v105
    v_cvt_pk_bf16_f32 v114, v100, v101
    v_cvt_pk_bf16_f32 v104, v102, v103
    v_lshlrev_b32 v102, 16, v104
    v_and_b32 v103, 0xffff0000, v104
    v_lshlrev_b32 v104, 16, v83
    v_and_b32 v105, 0xffff0000, v83
    v_mul_f32 v102, v102, v104
    v_mul_f32 v103, v103, v105
    v_cvt_pk_bf16_f32 v104, v102, v103
    v_lshlrev_b32 v102, 16, v104
    v_and_b32 v103, 0xffff0000, v104
    v_lshlrev_b32 v104, 16, v111
    v_and_b32 v105, 0xffff0000, v111
    v_add_f32 v102, v102, v104
    v_add_f32 v103, v103, v105
    v_cvt_pk_bf16_f32 v115, v102, v103
    v_cndmask_b32 v128, v112, v114, s[20:21]
    v_cndmask_b32 v129, v113, v115, s[20:21]
    v_cndmask_b32 v130, v114, v112, s[20:21]
    v_cndmask_b32 v131, v115, v113, s[20:21]
    buffer_store_dwordx4 v[128:131], v4, s[12:15], s18 offen offset:0
    v_lshlrev_b32 v96, 16, v48
    v_and_b32 v97, 0xffff0000, v48
    v_lshlrev_b32 v98, 16, v49
    v_and_b32 v99, 0xffff0000, v49
    v_lshlrev_b32 v100, 16, v50
    v_and_b32 v101, 0xffff0000, v50
    v_lshlrev_b32 v102, 16, v51
    v_and_b32 v103, 0xffff0000, v51
    v_lshlrev_b32 v120, 16, v52
    v_and_b32 v121, 0xffff0000, v52
    v_lshlrev_b32 v122, 16, v53
    v_and_b32 v123, 0xffff0000, v53
    v_lshlrev_b32 v124, 16, v54
    v_and_b32 v125, 0xffff0000, v54
    v_lshlrev_b32 v126, 16, v55
    v_and_b32 v127, 0xffff0000, v55
    v_add_f32 v96, v96, v120
    v_add_f32 v97, v97, v121
    v_add_f32 v98, v98, v122
    v_add_f32 v99, v99, v123
    v_add_f32 v100, v100, v124
    v_add_f32 v101, v101, v125
    v_add_f32 v102, v102, v126
    v_add_f32 v103, v103, v127
    v_lshlrev_b32 v120, 16, v56
    v_and_b32 v121, 0xffff0000, v56
    v_lshlrev_b32 v122, 16, v57
    v_and_b32 v123, 0xffff0000, v57
    v_lshlrev_b32 v124, 16, v58
    v_and_b32 v125, 0xffff0000, v58
    v_lshlrev_b32 v126, 16, v59
    v_and_b32 v127, 0xffff0000, v59
    v_add_f32 v96, v96, v120
    v_add_f32 v97, v97, v121
    v_add_f32 v98, v98, v122
    v_add_f32 v99, v99, v123
    v_add_f32 v100, v100, v124
    v_add_f32 v101, v101, v125
    v_add_f32 v102, v102, v126
    v_add_f32 v103, v103, v127
    v_lshlrev_b32 v120, 16, v60
    v_and_b32 v121, 0xffff0000, v60
    v_lshlrev_b32 v122, 16, v61
    v_and_b32 v123, 0xffff0000, v61
    v_lshlrev_b32 v124, 16, v62
    v_and_b32 v125, 0xffff0000, v62
    v_lshlrev_b32 v126, 16, v63
    v_and_b32 v127, 0xffff0000, v63
    v_add_f32 v96, v96, v120
    v_add_f32 v97, v97, v121
    v_add_f32 v98, v98, v122
    v_add_f32 v99, v99, v123
    v_add_f32 v100, v100, v124
    v_add_f32 v101, v101, v125
    v_add_f32 v102, v102, v126
    v_add_f32 v103, v103, v127
    v_lshlrev_b32 v120, 16, v64
    v_and_b32 v121, 0xffff0000, v64
    v_lshlrev_b32 v122, 16, v65
    v_and_b32 v123, 0xffff0000, v65
    v_lshlrev_b32 v124, 16, v66
    v_and_b32 v125, 0xffff0000, v66
    v_lshlrev_b32 v126, 16, v67
    v_and_b32 v127, 0xffff0000, v67
    v_add_f32 v96, v96, v120
    v_add_f32 v97, v97, v121
    v_add_f32 v98, v98, v122
    v_add_f32 v99, v99, v123
    v_add_f32 v100, v100, v124
    v_add_f32 v101, v101, v125
    v_add_f32 v102, v102, v126
    v_add_f32 v103, v103, v127
    v_lshlrev_b32 v120, 16, v68
    v_and_b32 v121, 0xffff0000, v68
    v_lshlrev_b32 v122, 16, v69
    v_and_b32 v123, 0xffff0000, v69
    v_lshlrev_b32 v124, 16, v70
    v_and_b32 v125, 0xffff0000, v70
    v_lshlrev_b32 v126, 16, v71
    v_and_b32 v127, 0xffff0000, v71
    v_add_f32 v96, v96, v120
    v_add_f32 v97, v97, v121
    v_add_f32 v98, v98, v122
    v_add_f32 v99, v99, v123
    v_add_f32 v100, v100, v124
    v_add_f32 v101, v101, v125
    v_add_f32 v102, v102, v126
    v_add_f32 v103, v103, v127
    v_lshlrev_b32 v120, 16, v72
    v_and_b32 v121, 0xffff0000, v72
    v_lshlrev_b32 v122, 16, v73
    v_and_b32 v123, 0xffff0000, v73
    v_lshlrev_b32 v124, 16, v74
    v_and_b32 v125, 0xffff0000, v74
    v_lshlrev_b32 v126, 16, v75
    v_and_b32 v127, 0xffff0000, v75
    v_add_f32 v96, v96, v120
    v_add_f32 v97, v97, v121
    v_add_f32 v98, v98, v122
    v_add_f32 v99, v99, v123
    v_add_f32 v100, v100, v124
    v_add_f32 v101, v101, v125
    v_add_f32 v102, v102, v126
    v_add_f32 v103, v103, v127
    v_lshlrev_b32 v120, 16, v76
    v_and_b32 v121, 0xffff0000, v76
    v_lshlrev_b32 v122, 16, v77
    v_and_b32 v123, 0xffff0000, v77
    v_lshlrev_b32 v124, 16, v78
    v_and_b32 v125, 0xffff0000, v78
    v_lshlrev_b32 v126, 16, v79
    v_and_b32 v127, 0xffff0000, v79
    v_add_f32 v96, v96, v120
    v_add_f32 v97, v97, v121
    v_add_f32 v98, v98, v122
    v_add_f32 v99, v99, v123
    v_add_f32 v100, v100, v124
    v_add_f32 v101, v101, v125
    v_add_f32 v102, v102, v126
    v_add_f32 v103, v103, v127
    v_cndmask_b32 v108, v92, v94, s[20:21]
    v_cndmask_b32 v109, v93, v95, s[20:21]
    v_cndmask_b32 v110, v94, v92, s[20:21]
    v_cndmask_b32 v111, v95, v93, s[20:21]
    v_cvt_pk_bf16_f32 v104, v96, v97
    v_lshlrev_b32 v96, 16, v104
    v_and_b32 v97, 0xffff0000, v104
    v_lshlrev_b32 v104, 16, v84
    v_and_b32 v105, 0xffff0000, v84
    v_mul_f32 v96, v96, v104
    v_mul_f32 v97, v97, v105
    v_cvt_pk_bf16_f32 v104, v96, v97
    v_lshlrev_b32 v96, 16, v104
    v_and_b32 v97, 0xffff0000, v104
    v_lshlrev_b32 v104, 16, v108
    v_and_b32 v105, 0xffff0000, v108
    v_add_f32 v96, v96, v104
    v_add_f32 v97, v97, v105
    v_cvt_pk_bf16_f32 v112, v96, v97
    v_cvt_pk_bf16_f32 v104, v98, v99
    v_lshlrev_b32 v98, 16, v104
    v_and_b32 v99, 0xffff0000, v104
    v_lshlrev_b32 v104, 16, v85
    v_and_b32 v105, 0xffff0000, v85
    v_mul_f32 v98, v98, v104
    v_mul_f32 v99, v99, v105
    v_cvt_pk_bf16_f32 v104, v98, v99
    v_lshlrev_b32 v98, 16, v104
    v_and_b32 v99, 0xffff0000, v104
    v_lshlrev_b32 v104, 16, v109
    v_and_b32 v105, 0xffff0000, v109
    v_add_f32 v98, v98, v104
    v_add_f32 v99, v99, v105
    v_cvt_pk_bf16_f32 v113, v98, v99
    v_cvt_pk_bf16_f32 v104, v100, v101
    v_lshlrev_b32 v100, 16, v104
    v_and_b32 v101, 0xffff0000, v104
    v_lshlrev_b32 v104, 16, v86
    v_and_b32 v105, 0xffff0000, v86
    v_mul_f32 v100, v100, v104
    v_mul_f32 v101, v101, v105
    v_cvt_pk_bf16_f32 v104, v100, v101
    v_lshlrev_b32 v100, 16, v104
    v_and_b32 v101, 0xffff0000, v104
    v_lshlrev_b32 v104, 16, v110
    v_and_b32 v105, 0xffff0000, v110
    v_add_f32 v100, v100, v104
    v_add_f32 v101, v101, v105
    v_cvt_pk_bf16_f32 v114, v100, v101
    v_cvt_pk_bf16_f32 v104, v102, v103
    v_lshlrev_b32 v102, 16, v104
    v_and_b32 v103, 0xffff0000, v104
    v_lshlrev_b32 v104, 16, v87
    v_and_b32 v105, 0xffff0000, v87
    v_mul_f32 v102, v102, v104
    v_mul_f32 v103, v103, v105
    v_cvt_pk_bf16_f32 v104, v102, v103
    v_lshlrev_b32 v102, 16, v104
    v_and_b32 v103, 0xffff0000, v104
    v_lshlrev_b32 v104, 16, v111
    v_and_b32 v105, 0xffff0000, v111
    v_add_f32 v102, v102, v104
    v_add_f32 v103, v103, v105
    v_cvt_pk_bf16_f32 v115, v102, v103
    v_cndmask_b32 v132, v112, v114, s[20:21]
    v_cndmask_b32 v133, v113, v115, s[20:21]
    v_cndmask_b32 v134, v114, v112, s[20:21]
    v_cndmask_b32 v135, v115, v113, s[20:21]
    buffer_store_dwordx4 v[132:135], v4, s[12:15], s18 offen offset:64
    s_add_u32 s24, s24, 32
    s_cmp_lt_u32 s24, 61
    s_cbranch_scc1 fin_job
    s_cmp_ge_u32 s63, 48
    s_cbranch_scc1 k_end
    s_lshr_b32 s24, s63, 4
    s_sub_u32 s24, 63, s24
    s_and_b32 s25, s63, 15
    s_lshl_b32 s25, s25, 2
    s_and_b32 s26, s3, 3
    s_add_u32 s25, s25, s26
    s_lshr_b32 s26, s25, 5
    s_and_b32 s25, s25, 31
    s_lshl_b32 s16, s24, 1
    s_add_u32 s16, s16, s26
    s_lshl_b32 s18, s16, 15
    s_lshl_b32 s17, s25, 10
    s_add_u32 s17, s17, s18
    s_lshl_b32 s19, s25, 6
    s_add_u32 s18, s18, s19
    s_add_u32 s22, s17, 167772160
    s_add_u32 s23, s17, 75497472
    s_mov_b32 s27, 218106816
    s_mov_b32 s30, 218112000
    s_mov_b32 s28, 65536
    v_and_b32 v8, 7, v1
    v_lshlrev_b32 v8, 22, v8
    s_cmp_lg_u32 s3, 0
    s_cbranch_scc1 ft_ok
ft_wd:
    buffer_load_dword v7, off, s[4:7], s27 sc1
    s_waitcnt vmcnt(0)
    v_readfirstlane_b32 s31, v7
    s_cmp_ge_u32 s31, 16
    s_cbranch_scc1 ft_ws
    s_sleep 127
    s_sub_u32 s28, s28, 1
    s_cbranch_scc0 ft_wd
    s_mov_b32 s28, 0
ft_ws:
    buffer_load_dword v7, v6, s[4:7], s30 offen sc1
    s_waitcnt vmcnt(0)
    v_cmp_gt_u32 vcc, 61, v7
    s_cbranch_vccz ft_ok
    s_sleep 12
    v_cmp_gt_u32 vcc, 59, v7
    s_cbranch_vccz ft_wsf
    s_sleep 64
    v_cmp_gt_u32 vcc, 56, v7
    s_cbranch_vccz ft_wsf
    s_sleep 127
    s_sleep 127
ft_wsf:
    s_sub_u32 s28, s28, 1
    s_cbranch_scc0 ft_ws
    s_mov_b32 s28, 0
ft_ok:
    s_barrier
    s_cmp_ge_u32 s3, 4
    s_cbranch_scc1 k_end
    buffer_load_dwordx4 v[88:91], v4, s[8:11], s18 offen
    buffer_load_dwordx4 v[144:147], v3, s[4:7], s22 offen offset:0 sc1
    s_add_u32 s22, s22, 4194304
    buffer_load_dwordx4 v[148:151], v3, s[4:7], s22 offen offset:0 sc1
    s_add_u32 s22, s22, 4194304
    buffer_load_dwordx4 v[152:155], v3, s[4:7], s22 offen offset:0 sc1
    s_add_u32 s22, s22, 4194304
    buffer_load_dwordx4 v[156:159], v3, s[4:7], s22 offen offset:0 sc1
    s_waitcnt vmcnt(0)
    v_lshlrev_b32 v96, 16, v144
    v_and_b32 v97, 0xffff0000, v144
    v_lshlrev_b32 v98, 16, v145
    v_and_b32 v99, 0xffff0000, v145
    v_lshlrev_b32 v100, 16, v146
    v_and_b32 v101, 0xffff0000, v146
    v_lshlrev_b32 v102, 16, v147
    v_and_b32 v103, 0xffff0000, v147
    v_lshlrev_b32 v120, 16, v148
    v_and_b32 v121, 0xffff0000, v148
    v_lshlrev_b32 v122, 16, v149
    v_and_b32 v123, 0xffff0000, v149
    v_lshlrev_b32 v124, 16, v150
    v_and_b32 v125, 0xffff0000, v150
    v_lshlrev_b32 v126, 16, v151
    v_and_b32 v127, 0xffff0000, v151
    v_add_f32 v96, v96, v120
    v_add_f32 v97, v97, v121
    v_add_f32 v98, v98, v122
    v_add_f32 v99, v99, v123
    v_add_f32 v100, v100, v124
    v_add_f32 v101, v101, v125
    v_add_f32 v102, v102, v126
    v_add_f32 v103, v103, v127
    v_lshlrev_b32 v120, 16, v152
    v_and_b32 v121, 0xffff0000, v152
    v_lshlrev_b32 v122, 16, v153
    v_and_b32 v123, 0xffff0000, v153
    v_lshlrev_b32 v124, 16, v154
    v_and_b32 v125, 0xffff0000, v154
    v_lshlrev_b32 v126, 16, v155
    v_and_b32 v127, 0xffff0000, v155
    v_add_f32 v96, v96, v120
    v_add_f32 v97, v97, v121
    v_add_f32 v98, v98, v122
    v_add_f32 v99, v99, v123
    v_add_f32 v100, v100, v124
    v_add_f32 v101, v101, v125
    v_add_f32 v102, v102, v126
    v_add_f32 v103, v103, v127
    v_lshlrev_b32 v120, 16, v156
    v_and_b32 v121, 0xffff0000, v156
    v_lshlrev_b32 v122, 16, v157
    v_and_b32 v123, 0xffff0000, v157
    v_lshlrev_b32 v124, 16, v158
    v_and_b32 v125, 0xffff0000, v158
    v_lshlrev_b32 v126, 16, v159
    v_and_b32 v127, 0xffff0000, v159
    v_add_f32 v96, v96, v120
    v_add_f32 v97, v97, v121
    v_add_f32 v98, v98, v122
    v_add_f32 v99, v99, v123
    v_add_f32 v100, v100, v124
    v_add_f32 v101, v101, v125
    v_add_f32 v102, v102, v126
    v_add_f32 v103, v103, v127
    v_cvt_pk_bf16_f32 v120, v96, v97
    v_cvt_pk_bf16_f32 v121, v98, v99
    v_cvt_pk_bf16_f32 v122, v100, v101
    v_cvt_pk_bf16_f32 v123, v102, v103
    v_lshlrev_b32 v96, 16, v120
    v_and_b32 v97, 0xffff0000, v120
    v_lshlrev_b32 v98, 16, v121
    v_and_b32 v99, 0xffff0000, v121
    v_lshlrev_b32 v100, 16, v122
    v_and_b32 v101, 0xffff0000, v122
    v_lshlrev_b32 v102, 16, v123
    v_and_b32 v103, 0xffff0000, v123
    v_mul_f32 v104, 0xbfb8aa3b, v96
    v_mul_f32 v105, 0xbfb8aa3b, v97
    v_mul_f32 v106, 0xbfb8aa3b, v98
    v_mul_f32 v107, 0xbfb8aa3b, v99
    v_mul_f32 v108, 0xbfb8aa3b, v100
    v_mul_f32 v109, 0xbfb8aa3b, v101
    v_mul_f32 v110, 0xbfb8aa3b, v102
    v_mul_f32 v111, 0xbfb8aa3b, v103
    v_exp_f32 v104, v104
    v_exp_f32 v105, v105
    v_exp_f32 v106, v106
    v_exp_f32 v107, v107
    v_exp_f32 v108, v108
    v_exp_f32 v109, v109
    v_exp_f32 v110, v110
    v_exp_f32 v111, v111
    v_add_f32 v104, 1.0, v104
    v_add_f32 v105, 1.0, v105
    v_add_f32 v106, 1.0, v106
    v_add_f32 v107, 1.0, v107
    v_add_f32 v108, 1.0, v108
    v_add_f32 v109, 1.0, v109
    v_add_f32 v110, 1.0, v110
    v_add_f32 v111, 1.0, v111
    v_rcp_f32 v104, v104
    v_rcp_f32 v105, v105
    v_rcp_f32 v106, v106
    v_rcp_f32 v107, v107
    v_rcp_f32 v108, v108
    v_rcp_f32 v109, v109
    v_rcp_f32 v110, v110
    v_rcp_f32 v111, v111
    v_mul_f32 v96, v96, v104
    v_mul_f32 v97, v97, v105
    v_mul_f32 v98, v98, v106
    v_mul_f32 v99, v99, v107
    v_mul_f32 v100, v100, v108
    v_mul_f32 v101, v101, v109
    v_mul_f32 v102, v102, v110
    v_mul_f32 v103, v103, v111
    v_cvt_pk_bf16_f32 v80, v96, v97
    v_cvt_pk_bf16_f32 v81, v98, v99
    v_cvt_pk_bf16_f32 v82, v100, v101
    v_cvt_pk_bf16_f32 v83, v102, v103
ft_p:
    buffer_load_dword v7, v8, s[4:7], s23 offen offset:1020 sc1
    s_waitcnt vmcnt(0)
    v_cmp_eq_u32 vcc, -1, v7
    s_cbranch_vccz ft_l
    s_sleep 4
    s_sub_u32 s28, s28, 1
    s_cbranch_scc0 ft_p
    s_mov_b32 s28, 0
ft_l:
    s_mov_b32 s31, s23
    buffer_load_dwordx4 v[16:19], v3, s[4:7], s31 offen sc1
    s_add_u32 s31, s31, 4194304
    buffer_load_dwordx4 v[20:23], v3, s[4:7], s31 offen sc1
    s_add_u32 s31, s31, 4194304
    buffer_load_dwordx4 v[24:27], v3, s[4:7], s31 offen sc1
    s_add_u32 s31, s31, 4194304
    buffer_load_dwordx4 v[28:31], v3, s[4:7], s31 offen sc1
    s_add_u32 s31, s31, 4194304
    buffer_load_dwordx4 v[32:35], v3, s[4:7], s31 offen sc1
    s_add_u32 s31, s31, 4194304
    buffer_load_dwordx4 v[36:39], v3, s[4:7], s31 offen sc1
    s_add_u32 s31, s31, 4194304
    buffer_load_dwordx4 v[40:43], v3, s[4:7], s31 offen sc1
    s_add_u32 s31, s31, 4194304
    buffer_load_dwordx4 v[44:47], v3, s[4:7], s31 offen sc1
    s_waitcnt vmcnt(0)
    v_max3_u32 v7, v16, v17, v18
    v_max3_u32 v7, v7, v19, v20
    v_max3_u32 v7, v7, v21, v22
    v_max3_u32 v7, v7, v23, v24
    v_max3_u32 v7, v7, v25, v26
    v_max3_u32 v7, v7, v27, v28
    v_max3_u32 v7, v7, v29, v30
    v_max3_u32 v7, v7, v31, v32
    v_max3_u32 v7, v7, v33, v34
    v_max3_u32 v7, v7, v35, v36
    v_max3_u32 v7, v7, v37, v38
    v_max3_u32 v7, v7, v39, v40
    v_max3_u32 v7, v7, v41, v42
    v_max3_u32 v7, v7, v43, v44
    v_max3_u32 v7, v7, v45, v46
    v_max_u32 v7, v7, v47
    v_cmp_eq_u32 vcc, -1, v7
    s_cbranch_vccz ft_go
    s_sub_u32 s28, s28, 1
    s_cbranch_scc0 ft_l
ft_go:
    v_lshlrev_b32 v96, 16, v16
    v_and_b32 v97, 0xffff0000, v16
    v_lshlrev_b32 v98, 16, v17
    v_and_b32 v99, 0xffff0000, v17
    v_lshlrev_b32 v100, 16, v18
    v_and_b32 v101, 0xffff0000, v18
    v_lshlrev_b32 v102, 16, v19
    v_and_b32 v103, 0xffff0000, v19
    v_lshlrev_b32 v120, 16, v20
    v_and_b32 v121, 0xffff0000, v20
    v_lshlrev_b32 v122, 16, v21
    v_and_b32 v123, 0xffff0000, v21
    v_lshlrev_b32 v124, 16, v22
    v_and_b32 v125, 0xffff0000, v22
    v_lshlrev_b32 v126, 16, v23
    v_and_b32 v127, 0xffff0000, v23
    v_add_f32 v96, v96, v120
    v_add_f32 v97, v97, v121
    v_add_f32 v98, v98, v122
    v_add_f32 v99, v99, v123
    v_add_f32 v100, v100, v124
    v_add_f32 v101, v101, v125
    v_add_f32 v102, v102, v126
    v_add_f32 v103, v103, v127
    v_lshlrev_b32 v120, 16, v24
    v_and_b32 v121, 0xffff0000, v24
    v_lshlrev_b32 v122, 16, v25
    v_and_b32 v123, 0xffff0000, v25
    v_lshlrev_b32 v124, 16, v26
    v_and_b32 v125, 0xffff0000, v26
    v_lshlrev_b32 v126, 16, v27
    v_and_b32 v127, 0xffff0000, v27
    v_add_f32 v96, v96, v120
    v_add_f32 v97, v97, v121
    v_add_f32 v98, v98, v122
    v_add_f32 v99, v99, v123
    v_add_f32 v100, v100, v124
    v_add_f32 v101, v101, v125
    v_add_f32 v102, v102, v126
    v_add_f32 v103, v103, v127
    v_lshlrev_b32 v120, 16, v28
    v_and_b32 v121, 0xffff0000, v28
    v_lshlrev_b32 v122, 16, v29
    v_and_b32 v123, 0xffff0000, v29
    v_lshlrev_b32 v124, 16, v30
    v_and_b32 v125, 0xffff0000, v30
    v_lshlrev_b32 v126, 16, v31
    v_and_b32 v127, 0xffff0000, v31
    v_add_f32 v96, v96, v120
    v_add_f32 v97, v97, v121
    v_add_f32 v98, v98, v122
    v_add_f32 v99, v99, v123
    v_add_f32 v100, v100, v124
    v_add_f32 v101, v101, v125
    v_add_f32 v102, v102, v126
    v_add_f32 v103, v103, v127
    v_lshlrev_b32 v120, 16, v32
    v_and_b32 v121, 0xffff0000, v32
    v_lshlrev_b32 v122, 16, v33
    v_and_b32 v123, 0xffff0000, v33
    v_lshlrev_b32 v124, 16, v34
    v_and_b32 v125, 0xffff0000, v34
    v_lshlrev_b32 v126, 16, v35
    v_and_b32 v127, 0xffff0000, v35
    v_add_f32 v96, v96, v120
    v_add_f32 v97, v97, v121
    v_add_f32 v98, v98, v122
    v_add_f32 v99, v99, v123
    v_add_f32 v100, v100, v124
    v_add_f32 v101, v101, v125
    v_add_f32 v102, v102, v126
    v_add_f32 v103, v103, v127
    v_lshlrev_b32 v120, 16, v36
    v_and_b32 v121, 0xffff0000, v36
    v_lshlrev_b32 v122, 16, v37
    v_and_b32 v123, 0xffff0000, v37
    v_lshlrev_b32 v124, 16, v38
    v_and_b32 v125, 0xffff0000, v38
    v_lshlrev_b32 v126, 16, v39
    v_and_b32 v127, 0xffff0000, v39
    v_add_f32 v96, v96, v120
    v_add_f32 v97, v97, v121
    v_add_f32 v98, v98, v122
    v_add_f32 v99, v99, v123
    v_add_f32 v100, v100, v124
    v_add_f32 v101, v101, v125
    v_add_f32 v102, v102, v126
    v_add_f32 v103, v103, v127
    v_lshlrev_b32 v120, 16, v40
    v_and_b32 v121, 0xffff0000, v40
    v_lshlrev_b32 v122, 16, v41
    v_and_b32 v123, 0xffff0000, v41
    v_lshlrev_b32 v124, 16, v42
    v_and_b32 v125, 0xffff0000, v42
    v_lshlrev_b32 v126, 16, v43
    v_and_b32 v127, 0xffff0000, v43
    v_add_f32 v96, v96, v120
    v_add_f32 v97, v97, v121
    v_add_f32 v98, v98, v122
    v_add_f32 v99, v99, v123
    v_add_f32 v100, v100, v124
    v_add_f32 v101, v101, v125
    v_add_f32 v102, v102, v126
    v_add_f32 v103, v103, v127
    v_lshlrev_b32 v120, 16, v44
    v_and_b32 v121, 0xffff0000, v44
    v_lshlrev_b32 v122, 16, v45
    v_and_b32 v123, 0xffff0000, v45
    v_lshlrev_b32 v124, 16, v46
    v_and_b32 v125, 0xffff0000, v46
    v_lshlrev_b32 v126, 16, v47
    v_and_b32 v127, 0xffff0000, v47
    v_add_f32 v96, v96, v120
    v_add_f32 v97, v97, v121
    v_add_f32 v98, v98, v122
    v_add_f32 v99, v99, v123
    v_add_f32 v100, v100, v124
    v_add_f32 v101, v101, v125
    v_add_f32 v102, v102, v126
    v_add_f32 v103, v103, v127
    v_cndmask_b32 v108, v88, v90, s[20:21]
    v_cndmask_b32 v109, v89, v91, s[20:21]
    v_cndmask_b32 v110, v90, v88, s[20:21]
    v_cndmask_b32 v111, v91, v89, s[20:21]
    v_cvt_pk_bf16_f32 v104, v96, v97
    v_lshlrev_b32 v96, 16, v104
    v_and_b32 v97, 0xffff0000, v104
    v_lshlrev_b32 v104, 16, v80
    v_and_b32 v105, 0xffff0000, v80
    v_mul_f32 v96, v96, v104
    v_mul_f32 v97, v97, v105
    v_cvt_pk_bf16_f32 v104, v96, v97
    v_lshlrev_b32 v96, 16, v104
    v_and_b32 v97, 0xffff0000, v104
    v_lshlrev_b32 v104, 16, v108
    v_and_b32 v105, 0xffff0000, v108
    v_add_f32 v96, v96, v104
    v_add_f32 v97, v97, v105
    v_cvt_pk_bf16_f32 v112, v96, v97
    v_cvt_pk_bf16_f32 v104, v98, v99
    v_lshlrev_b32 v98, 16, v104
    v_and_b32 v99, 0xffff0000, v104
    v_lshlrev_b32 v104, 16, v81
    v_and_b32 v105, 0xffff0000, v81
    v_mul_f32 v98, v98, v104
    v_mul_f32 v99, v99, v105
    v_cvt_pk_bf16_f32 v104, v98, v99
    v_lshlrev_b32 v98, 16, v104
    v_and_b32 v99, 0xffff0000, v104
    v_lshlrev_b32 v104, 16, v109
    v_and_b32 v105, 0xffff0000, v109
    v_add_f32 v98, v98, v104
    v_add_f32 v99, v99, v105
    v_cvt_pk_bf16_f32 v113, v98, v99
    v_cvt_pk_bf16_f32 v104, v100, v101
    v_lshlrev_b32 v100, 16, v104
    v_and_b32 v101, 0xffff0000, v104
    v_lshlrev_b32 v104, 16, v82
    v_and_b32 v105, 0xffff0000, v82
    v_mul_f32 v100, v100, v104
    v_mul_f32 v101, v101, v105
    v_cvt_pk_bf16_f32 v104, v100, v101
    v_lshlrev_b32 v100, 16, v104
    v_and_b32 v101, 0xffff0000, v104
    v_lshlrev_b32 v104, 16, v110
    v_and_b32 v105, 0xffff0000, v110
    v_add_f32 v100, v100, v104
    v_add_f32 v101, v101, v105
    v_cvt_pk_bf16_f32 v114, v100, v101
    v_cvt_pk_bf16_f32 v104, v102, v103
    v_lshlrev_b32 v102, 16, v104
    v_and_b32 v103, 0xffff0000, v104
    v_lshlrev_b32 v104, 16, v83
    v_and_b32 v105, 0xffff0000, v83
    v_mul_f32 v102, v102, v104
    v_mul_f32 v103, v103, v105
    v_cvt_pk_bf16_f32 v104, v102, v103
    v_lshlrev_b32 v102, 16, v104
    v_and_b32 v103, 0xffff0000, v104
    v_lshlrev_b32 v104, 16, v111
    v_and_b32 v105, 0xffff0000, v111
    v_add_f32 v102, v102, v104
    v_add_f32 v103, v103, v105
    v_cvt_pk_bf16_f32 v115, v102, v103
    v_cndmask_b32 v128, v112, v114, s[20:21]
    v_cndmask_b32 v129, v113, v115, s[20:21]
    v_cndmask_b32 v130, v114, v112, s[20:21]
    v_cndmask_b32 v131, v115, v113, s[20:21]
    buffer_store_dwordx4 v[128:131], v4, s[12:15], s18 offen offset:0
    s_branch k_end
chain_map:
    s_and_b32 s14, s12, 1
    s_lshl_b32 s13, s13, 1
    s_lshr_b32 s15, s12, 1
    s_add_u32 s12, s13, s14
    s_mov_b32 s13, s15
    s_lshl_b32 s2, s13, 3
    s_add_u32 s2, s2, s12
    s_lshr_b32 s14, s13, 2
    s_and_b32 s15, s13, 3
    s_mov_b32 s16, 0
    s_mov_b32 s17, 209715200
    s_mov_b32 s18, 209977344
    s_mov_b32 s19, 210239488
    s_mov_b32 s20, 210501632
    s_mov_b32 s26, 131072
    s_mov_b32 s68, 0
    s_getreg_b32 s29, hwreg(HW_REG_XCC_ID)
    s_and_b32 s29, s29, 15
    s_mul_i32 s23, s29, s29
    s_lshl_b32 s23, s23, 18
    s_lshl_b32 s29, s29, 8
    s_add_u32 s29, s29, s23
    s_add_u32 s29, s29, 1
    s_lshr_b32 s28, s12, 1
    s_lshl_b32 s28, s28, 2
    s_add_u32 s28, s28, 128
    s_cmp_ge_u32 s3, 4
    s_cbranch_scc1 ch_a_pro
    s_lshl_b32 s32, s12, 15
    s_lshl_b32 s21, s14, 13
    s_add_u32 s32, s32, s21
    s_lshl_b32 s21, s15, 10
    s_add_u32 s32, s32, s21
    s_add_u32 s32, s32, 2097152
    s_lshr_b32 s33, s12, 1
    s_lshl_b32 s33, s33, 14
    s_add_u32 s33, s33, 1048576
    s_lshl_b32 s21, s13, 10
    s_add_u32 s36, s33, s21
    s_lshl_b32 s21, s3, 12
    s_add_u32 s33, s33, s21
    s_lshl_b32 s34, s13, 14
    s_lshl_b32 s21, s12, 10
    s_add_u32 s35, s34, s21
    s_lshl_b32 s37, s12, 22
    s_lshl_b32 s21, s13, 11
    s_add_u32 s37, s37, s21
    s_and_b32 s21, s3, 1
    s_lshl_b32 s21, s21, 15
    s_add_u32 s37, s37, s21
    s_lshr_b32 s21, s3, 1
    s_lshl_b32 s21, s21, 10
    s_add_u32 s37, s37, s21
    s_add_u32 s37, s37, 75497472
    v_and_b32 v20, 63, v0
    v_lshlrev_b32 v1, 4, v20
    v_mov_b32 v10, -1
    v_mov_b32 v11, -1
    v_lshrrev_b32 v21, 2, v20
    v_and_b32 v22, 3, v20
    v_lshlrev_b32 v21, 13, v21
    v_lshl_add_u32 v21, v22, 4, v21
    s_lshl_b32 s21, s3, 21
    s_lshl_b32 s22, s12, 10
    s_add_u32 s21, s21, s22
    s_lshl_b32 s23, s3, 15
    s_mov_b32 s10, 8388608
    s_mov_b32 s11, 131072
    v_lshrrev_b32 v24, 4, v20
    v_bfe_u32 v25, v20, 2, 2
    v_lshl_add_u32 v24, v24, 4, v25
    v_lshlrev_b32 v24, 6, v24
    v_lshl_add_u32 v24, v22, 3, v24
    v_add_u32 v24, s23, v24
    s_and_b32 s70, s13, 1
    s_lshl_b32 s71, s12, 4
    s_add_u32 s71, s71, s13
    s_cmp_eq_u32 s71, 127
    s_cselect_b32 s70, 1, 0
    s_cmp_eq_u32 s13, 7
    s_cselect_b32 s70, 1, s70
    s_lshl_b32 s72, s70, 20
    s_lshl_b32 s73, s70, 21
    s_lshl_b32 s70, s70, 13
    s_sub_u32 s71, s23, s70
    s_add_u32 s70, s23, s70
    s_load_dwordx2 s[8:9], s[0:1], 16
    s_lshl_b32 s25, s13, 6
    s_add_u32 s24, s21, s25
    s_add_u32 s24, s24, s72
    s_waitcnt lgkmcnt(0)
    s_add_u32 m0, s70, 0
    s_nop 0
    buffer_load_dwordx4 v21, s[8:11], s24 offen lds
    s_add_u32 s24, s24, 131072
    s_add_u32 m0, s70, 1024
    s_nop 0
    buffer_load_dwordx4 v21, s[8:11], s24 offen lds
    s_add_u32 s24, s24, 131072
    s_add_u32 m0, s70, 2048
    s_nop 0
    buffer_load_dwordx4 v21, s[8:11], s24 offen lds
    s_add_u32 s24, s24, 131072
    s_add_u32 m0, s70, 3072
    s_nop 0
    buffer_load_dwordx4 v21, s[8:11], s24 offen lds
    s_add_u32 s24, s24, 131072
    s_add_u32 m0, s70, 4096
    s_nop 0
    buffer_load_dwordx4 v21, s[8:11], s24 offen lds
    s_add_u32 s24, s24, 131072
    s_add_u32 m0, s70, 5120
    s_nop 0
    buffer_load_dwordx4 v21, s[8:11], s24 offen lds
    s_add_u32 s24, s24, 131072
    s_add_u32 m0, s70, 6144
    s_nop 0
    buffer_load_dwordx4 v21, s[8:11], s24 offen lds
    s_add_u32 s24, s24, 131072
    s_add_u32 m0, s70, 7168
    s_nop 0
    buffer_load_dwordx4 v21, s[8:11], s24 offen lds
    s_add_u32 s24, s24, 131072
    s_sub_u32 s24, s24, s73
    s_add_u32 m0, s71, 8192
    s_nop 0
    buffer_load_dwordx4 v21, s[8:11], s24 offen lds
    s_add_u32 s24, s24, 131072
    s_add_u32 m0, s71, 9216
    s_nop 0
    buffer_load_dwordx4 v21, s[8:11], s24 offen lds
    s_add_u32 s24, s24, 131072
    s_add_u32 m0, s71, 10240
    s_nop 0
    buffer_load_dwordx4 v21, s[8:11], s24 offen lds
    s_add_u32 s24, s24, 131072
    s_add_u32 m0, s71, 11264
    s_nop 0
    buffer_load_dwordx4 v21, s[8:11], s24 offen lds
    s_add_u32 s24, s24, 131072
    s_add_u32 m0, s71, 12288
    s_nop 0
    buffer_load_dwordx4 v21, s[8:11], s24 offen lds
    s_add_u32 s24, s24, 131072
    s_add_u32 m0, s71, 13312
    s_nop 0
    buffer_load_dwordx4 v21, s[8:11], s24 offen lds
    s_add_u32 s24, s24, 131072
    s_add_u32 m0, s71, 14336
    s_nop 0
    buffer_load_dwordx4 v21, s[8:11], s24 offen lds
    s_add_u32 s24, s24, 131072
    s_add_u32 m0, s71, 15360
    s_nop 0
    buffer_load_dwordx4 v21, s[8:11], s24 offen lds
    s_add_u32 s24, s24, 131072
    s_load_dwordx2 s[8:9], s[0:1], 24
    s_lshl_b32 s25, s13, 6
    s_add_u32 s24, s21, s25
    s_add_u32 s24, s24, s72
    s_waitcnt lgkmcnt(0)
    s_add_u32 m0, s70, 16384
    s_nop 0
    buffer_load_dwordx4 v21, s[8:11], s24 offen lds
    s_add_u32 s24, s24, 131072
    s_add_u32 m0, s70, 17408
    s_nop 0
    buffer_load_dwordx4 v21, s[8:11], s24 offen lds
    s_add_u32 s24, s24, 131072
    s_add_u32 m0, s70, 18432
    s_nop 0
    buffer_load_dwordx4 v21, s[8:11], s24 offen lds
    s_add_u32 s24, s24, 131072
    s_add_u32 m0, s70, 19456
    s_nop 0
    buffer_load_dwordx4 v21, s[8:11], s24 offen lds
    s_add_u32 s24, s24, 131072
    s_add_u32 m0, s70, 20480
    s_nop 0
    buffer_load_dwordx4 v21, s[8:11], s24 offen lds
    s_add_u32 s24, s24, 131072
    s_add_u32 m0, s70, 21504
    s_nop 0
    buffer_load_dwordx4 v21, s[8:11], s24 offen lds
    s_add_u32 s24, s24, 131072
    s_add_u32 m0, s70, 22528
    s_nop 0
    buffer_load_dwordx4 v21, s[8:11], s24 offen lds
    s_add_u32 s24, s24, 131072
    s_add_u32 m0, s70, 23552
    s_nop 0
    buffer_load_dwordx4 v21, s[8:11], s24 offen lds
    s_add_u32 s24, s24, 131072
    s_sub_u32 s24, s24, s73
    s_add_u32 m0, s71, 24576
    s_nop 0
    buffer_load_dwordx4 v21, s[8:11], s24 offen lds
    s_add_u32 s24, s24, 131072
    s_add_u32 m0, s71, 25600
    s_nop 0
    buffer_load_dwordx4 v21, s[8:11], s24 offen lds
    s_add_u32 s24, s24, 131072
    s_add_u32 m0, s71, 26624
    s_nop 0
    buffer_load_dwordx4 v21, s[8:11], s24 offen lds
    s_add_u32 s24, s24, 131072
    s_add_u32 m0, s71, 27648
    s_nop 0
    buffer_load_dwordx4 v21, s[8:11], s24 offen lds
    s_add_u32 s24, s24, 131072
    s_add_u32 m0, s71, 28672
    s_nop 0
    buffer_load_dwordx4 v21, s[8:11], s24 offen lds
    s_add_u32 s24, s24, 131072
    s_add_u32 m0, s71, 29696
    s_nop 0
    buffer_load_dwordx4 v21, s[8:11], s24 offen lds
    s_add_u32 s24, s24, 131072
    s_add_u32 m0, s71, 30720
    s_nop 0
    buffer_load_dwordx4 v21, s[8:11], s24 offen lds
    s_add_u32 s24, s24, 131072
    s_add_u32 m0, s71, 31744
    s_nop 0
    buffer_load_dwordx4 v21, s[8:11], s24 offen lds
    s_add_u32 s24, s24, 131072
    s_load_dwordx2 s[8:9], s[0:1], 32
    s_lshl_b32 s25, s13, 6
    s_add_u32 s24, s21, s25
    s_add_u32 s24, s24, s72
    s_waitcnt lgkmcnt(0)
    buffer_load_dwordx4 v[96:99], v21, s[8:11], s24 offen
    s_add_u32 s24, s24, 131072
    buffer_load_dwordx4 v[100:103], v21, s[8:11], s24 offen
    s_add_u32 s24, s24, 131072
    buffer_load_dwordx4 v[104:107], v21, s[8:11], s24 offen
    s_add_u32 s24, s24, 131072
    buffer_load_dwordx4 v[108:111], v21, s[8:11], s24 offen
    s_add_u32 s24, s24, 131072
    buffer_load_dwordx4 v[144:147], v21, s[8:11], s24 offen
    s_add_u32 s24, s24, 131072
    buffer_load_dwordx4 v[148:151], v21, s[8:11], s24 offen
    s_add_u32 s24, s24, 131072
    buffer_load_dwordx4 v[152:155], v21, s[8:11], s24 offen
    s_add_u32 s24, s24, 131072
    buffer_load_dwordx4 v[156:159], v21, s[8:11], s24 offen
    s_add_u32 s24, s24, 131072
    s_sub_u32 s24, s24, s73
    buffer_load_dwordx4 v[192:195], v21, s[8:11], s24 offen
    s_add_u32 s24, s24, 131072
    buffer_load_dwordx4 v[196:199], v21, s[8:11], s24 offen
    s_add_u32 s24, s24, 131072
    buffer_load_dwordx4 v[200:203], v21, s[8:11], s24 offen
    s_add_u32 s24, s24, 131072
    buffer_load_dwordx4 v[204:207], v21, s[8:11], s24 offen
    s_add_u32 s24, s24, 131072
    buffer_load_dwordx4 v[240:243], v21, s[8:11], s24 offen
    s_add_u32 s24, s24, 131072
    buffer_load_dwordx4 v[244:247], v21, s[8:11], s24 offen
    s_add_u32 s24, s24, 131072
    buffer_load_dwordx4 v[248:251], v21, s[8:11], s24 offen
    s_add_u32 s24, s24, 131072
    buffer_load_dwordx4 v[252:255], v21, s[8:11], s24 offen
    s_add_u32 s24, s24, 131072
    s_load_dwordx2 s[8:9], s[0:1], 8
    s_mov_b32 s10, 16384
    v_bfe_u32 v57, v20, 4, 1
    v_lshrrev_b32 v58, 5, v20
    v_and_b32 v59, 1, v20
    v_bfe_u32 v60, v20, 1, 3
    v_lshlrev_b32 v60, 11, v60
    v_lshl_add_u32 v60, v57, 6, v60
    v_lshl_add_u32 v60, v58, 4, v60
    v_lshl_add_u32 v15, v59, 2, v60
    s_lshl_b32 s24, s3, 9
    s_waitcnt lgkmcnt(0)
    buffer_load_dword v32, v15, s[8:11], s24 offen offset:0
    buffer_load_dword v33, v15, s[8:11], s24 offen offset:8
    buffer_load_dword v34, v15, s[8:11], s24 offen offset:32
    buffer_load_dword v35, v15, s[8:11], s24 offen offset:40
    buffer_load_dword v36, v15, s[8:11], s24 offen offset:128
    buffer_load_dword v37, v15, s[8:11], s24 offen offset:136
    buffer_load_dword v38, v15, s[8:11], s24 offen offset:160
    buffer_load_dword v39, v15, s[8:11], s24 offen offset:168
    buffer_load_dword v40, v15, s[8:11], s24 offen offset:256
    buffer_load_dword v41, v15, s[8:11], s24 offen offset:264
    buffer_load_dword v42, v15, s[8:11], s24 offen offset:288
    buffer_load_dword v43, v15, s[8:11], s24 offen offset:296
    buffer_load_dword v44, v15, s[8:11], s24 offen offset:384
    buffer_load_dword v45, v15, s[8:11], s24 offen offset:392
    buffer_load_dword v46, v15, s[8:11], s24 offen offset:416
    buffer_load_dword v47, v15, s[8:11], s24 offen offset:424
    s_barrier
    v_add_u32 v56, s70, v1
    s_add_u32 s71, s71, 8192
    v_add_u32 v26, s71, v1
    s_waitcnt vmcnt(48)
    ds_read_b64_tr_b16 v[64:65], v24 offset:0
    ds_read_b64_tr_b16 v[66:67], v24 offset:256
    ds_read_b64_tr_b16 v[68:69], v24 offset:512
    ds_read_b64_tr_b16 v[70:71], v24 offset:768
    ds_read_b64_tr_b16 v[72:73], v24 offset:32
    ds_read_b64_tr_b16 v[74:75], v24 offset:288
    ds_read_b64_tr_b16 v[76:77], v24 offset:544
    ds_read_b64_tr_b16 v[78:79], v24 offset:800
    s_waitcnt lgkmcnt(0)
    ds_read_b64_tr_b16 v[112:113], v24 offset:4096
    ds_read_b64_tr_b16 v[114:115], v24 offset:4352
    ds_read_b64_tr_b16 v[116:117], v24 offset:4608
    ds_read_b64_tr_b16 v[118:119], v24 offset:4864
    ds_read_b64_tr_b16 v[120:121], v24 offset:4128
    ds_read_b64_tr_b16 v[122:123], v24 offset:4384
    ds_read_b64_tr_b16 v[124:125], v24 offset:4640
    ds_read_b64_tr_b16 v[126:127], v24 offset:4896
    s_waitcnt lgkmcnt(0)
    ds_read_b64_tr_b16 v[160:161], v24 offset:8192
    ds_read_b64_tr_b16 v[162:163], v24 offset:8448
    ds_read_b64_tr_b16 v[164:165], v24 offset:8704
    ds_read_b64_tr_b16 v[166:167], v24 offset:8960
    ds_read_b64_tr_b16 v[168:169], v24 offset:8224
    ds_read_b64_tr_b16 v[170:171], v24 offset:8480
    ds_read_b64_tr_b16 v[172:173], v24 offset:8736
    ds_read_b64_tr_b16 v[174:175], v24 offset:8992
    s_waitcnt lgkmcnt(0)
    ds_read_b64_tr_b16 v[208:209], v24 offset:12288
    ds_read_b64_tr_b16 v[210:211], v24 offset:12544
    ds_read_b64_tr_b16 v[212:213], v24 offset:12800
    ds_read_b64_tr_b16 v[214:215], v24 offset:13056
    ds_read_b64_tr_b16 v[216:217], v24 offset:12320
    ds_read_b64_tr_b16 v[218:219], v24 offset:12576
    ds_read_b64_tr_b16 v[220:221], v24 offset:12832
    ds_read_b64_tr_b16 v[222:223], v24 offset:13088
    s_waitcnt lgkmcnt(0)
    s_waitcnt vmcnt(32)
    ds_read_b64_tr_b16 v[80:81], v24 offset:16384
    ds_read_b64_tr_b16 v[82:83], v24 offset:16640
    ds_read_b64_tr_b16 v[84:85], v24 offset:16896
    ds_read_b64_tr_b16 v[86:87], v24 offset:17152
    ds_read_b64_tr_b16 v[88:89], v24 offset:16416
    ds_read_b64_tr_b16 v[90:91], v24 offset:16672
    ds_read_b64_tr_b16 v[92:93], v24 offset:16928
    ds_read_b64_tr_b16 v[94:95], v24 offset:17184
    s_waitcnt lgkmcnt(0)
    ds_read_b64_tr_b16 v[128:129], v24 offset:20480
    ds_read_b64_tr_b16 v[130:131], v24 offset:20736
    ds_read_b64_tr_b16 v[132:133], v24 offset:20992
    ds_read_b64_tr_b16 v[134:135], v24 offset:21248
    ds_read_b64_tr_b16 v[136:137], v24 offset:20512
    ds_read_b64_tr_b16 v[138:139], v24 offset:20768
    ds_read_b64_tr_b16 v[140:141], v24 offset:21024
    ds_read_b64_tr_b16 v[142:143], v24 offset:21280
    s_waitcnt lgkmcnt(0)
    ds_read_b64_tr_b16 v[176:177], v24 offset:24576
    ds_read_b64_tr_b16 v[178:179], v24 offset:24832
    ds_read_b64_tr_b16 v[180:181], v24 offset:25088
    ds_read_b64_tr_b16 v[182:183], v24 offset:25344
    ds_read_b64_tr_b16 v[184:185], v24 offset:24608
    ds_read_b64_tr_b16 v[186:187], v24 offset:24864
    ds_read_b64_tr_b16 v[188:189], v24 offset:25120
    ds_read_b64_tr_b16 v[190:191], v24 offset:25376
    s_waitcnt lgkmcnt(0)
    ds_read_b64_tr_b16 v[224:225], v24 offset:28672
    ds_read_b64_tr_b16 v[226:227], v24 offset:28928
    ds_read_b64_tr_b16 v[228:229], v24 offset:29184
    ds_read_b64_tr_b16 v[230:231], v24 offset:29440
    ds_read_b64_tr_b16 v[232:233], v24 offset:28704
    ds_read_b64_tr_b16 v[234:235], v24 offset:28960
    ds_read_b64_tr_b16 v[236:237], v24 offset:29216
    ds_read_b64_tr_b16 v[238:239], v24 offset:29472
    s_waitcnt lgkmcnt(0)
    s_waitcnt vmcnt(16)
    ds_write_b128 v56, v[96:99] offset:0
    ds_write_b128 v56, v[100:103] offset:1024
    ds_write_b128 v56, v[104:107] offset:2048
    ds_write_b128 v56, v[108:111] offset:3072
    ds_write_b128 v56, v[144:147] offset:4096
    ds_write_b128 v56, v[148:151] offset:5120
    ds_write_b128 v56, v[152:155] offset:6144
    ds_write_b128 v56, v[156:159] offset:7168
    ds_write_b128 v26, v[192:195] offset:0
    ds_write_b128 v26, v[196:199] offset:1024
    ds_write_b128 v26, v[200:203] offset:2048
    ds_write_b128 v26, v[204:207] offset:3072
    ds_write_b128 v26, v[240:243] offset:4096
    ds_write_b128 v26, v[244:247] offset:5120
    ds_write_b128 v26, v[248:251] offset:6144
    ds_write_b128 v26, v[252:255] offset:7168
    s_waitcnt lgkmcnt(0)
    ds_read_b64_tr_b16 v[96:97], v24 offset:0
    ds_read_b64_tr_b16 v[98:99], v24 offset:256
    ds_read_b64_tr_b16 v[100:101], v24 offset:512
    ds_read_b64_tr_b16 v[102:103], v24 offset:768
    ds_read_b64_tr_b16 v[104:105], v24 offset:32
    ds_read_b64_tr_b16 v[106:107], v24 offset:288
    ds_read_b64_tr_b16 v[108:109], v24 offset:544
    ds_read_b64_tr_b16 v[110:111], v24 offset:800
    s_waitcnt lgkmcnt(0)
    ds_read_b64_tr_b16 v[144:145], v24 offset:4096
    ds_read_b64_tr_b16 v[146:147], v24 offset:4352
    ds_read_b64_tr_b16 v[148:149], v24 offset:4608
    ds_read_b64_tr_b16 v[150:151], v24 offset:4864
    ds_read_b64_tr_b16 v[152:153], v24 offset:4128
    ds_read_b64_tr_b16 v[154:155], v24 offset:4384
    ds_read_b64_tr_b16 v[156:157], v24 offset:4640
    ds_read_b64_tr_b16 v[158:159], v24 offset:4896
    s_waitcnt lgkmcnt(0)
    ds_read_b64_tr_b16 v[192:193], v24 offset:8192
    ds_read_b64_tr_b16 v[194:195], v24 offset:8448
    ds_read_b64_tr_b16 v[196:197], v24 offset:8704
    ds_read_b64_tr_b16 v[198:199], v24 offset:8960
    ds_read_b64_tr_b16 v[200:201], v24 offset:8224
    ds_read_b64_tr_b16 v[202:203], v24 offset:8480
    ds_read_b64_tr_b16 v[204:205], v24 offset:8736
    ds_read_b64_tr_b16 v[206:207], v24 offset:8992
    s_waitcnt lgkmcnt(0)
    ds_read_b64_tr_b16 v[240:241], v24 offset:12288
    ds_read_b64_tr_b16 v[242:243], v24 offset:12544
    ds_read_b64_tr_b16 v[244:245], v24 offset:12800
    ds_read_b64_tr_b16 v[246:247], v24 offset:13056
    ds_read_b64_tr_b16 v[248:249], v24 offset:12320
    ds_read_b64_tr_b16 v[250:251], v24 offset:12576
    ds_read_b64_tr_b16 v[252:253], v24 offset:12832
    ds_read_b64_tr_b16 v[254:255], v24 offset:13088
    s_waitcnt lgkmcnt(0)
    v_mov_b32 v21, 0x44444444
    v_mov_b32 v22, 0xeeeeeeee
    v_and_b32 v23, 1, v20
    v_cmp_eq_u32 vcc, 0, v23
    v_and_b32 v27, 255, v0
    v_lshlrev_b32 v2, 2, v27
    v_cndmask_b32 v62, v22, v21, vcc
    s_lshr_b32 s21, s15, 1
    s_sub_u32 s21, s21, s15
    s_add_u32 s21, s21, 4
    s_lshl_b32 s21, s21, 10
    s_and_b32 s22, s15, 1
    s_lshl_b32 s22, s22, 9
    s_add_u32 s21, s21, s22
    s_lshl_b32 s22, s3, 7
    s_add_u32 s21, s21, s22
    v_and_b32 v21, 31, v20
    v_lshlrev_b32 v21, 2, v21
    v_add_u32 v3, s21, v21
    v_lshrrev_b32 v21, 4, v20
    v_and_b32 v22, 15, v20
    v_mul_u32_u24 v21, 208, v21
    v_add_lshl_u32 v21, v21, v22, 2
    s_mul_i32 s21, s3, 3328
    v_add_u32 v4, s21, v21
    v_lshrrev_b32 v21, 4, v20
    v_bfe_u32 v22, v20, 2, 1
    v_lshl_add_u32 v21, v21, 1, v22
    v_mul_u32_u24 v21, 104, v21
    v_bfe_u32 v22, v20, 3, 1
    v_xor_b32 v22, 1, v22
    v_lshl_add_u32 v21, v22, 5, v21
    v_and_b32 v22, 3, v20
    v_lshlrev_b32 v22, 1, v22
    s_and_b32 s21, s3, 1
    s_lshl_b32 s21, s21, 2
    v_xor_b32 v22, s21, v22
    v_add_u32 v21, v21, v22
    s_lshl_b32 s21, s3, 3
    v_add_u32 v21, s21, v21
    v_lshlrev_b32 v5, 2, v21
    s_and_b32 s21, s3, 1
    s_lshl_b32 s21, s21, 2
    v_bfe_u32 v21, v20, 3, 2
    v_add_u32 v21, s21, v21
    v_mul_u32_u24 v21, 104, v21
    v_bfe_u32 v22, v20, 1, 1
    v_lshl_add_u32 v21, v22, 3, v21
    v_and_b32 v23, 1, v20
    v_xor_b32 v22, v22, v23
    v_lshl_add_u32 v21, v22, 2, v21
    v_bfe_u32 v22, v20, 2, 1
    v_lshl_add_u32 v21, v22, 1, v21
    s_lshr_b32 s21, s3, 1
    s_lshl_b32 s21, s21, 4
    s_add_u32 s21, s21, 64
    v_add_u32 v21, s21, v21
    v_lshlrev_b32 v6, 2, v21
    v_lshrrev_b32 v21, 6, v27
    v_bfe_u32 v22, v27, 1, 1
    v_lshrrev_b32 v23, 1, v21
    v_lshl_add_u32 v22, v22, 1, v23
    v_xor_b32 v23, v27, v22
    v_and_b32 v23, 1, v23
    v_and_b32 v21, 1, v21
    v_lshl_add_u32 v21, v21, 1, v23
    v_mul_u32_u24 v21, 544, v21
    v_lshl_add_u32 v21, v22, 5, v21
    v_bfe_u32 v23, v27, 4, 2
    v_mul_u32_u24 v23, 136, v23
    v_add_u32 v21, v21, v23
    v_bfe_u32 v24, v27, 3, 1
    v_lshl_add_u32 v21, v24, 2, v21
    v_bfe_u32 v24, v27, 2, 1
    v_lshl_add_u32 v21, v24, 4, v21
    v_add_u32 v7, 16384, v21
    v_lshlrev_b32 v8, 2, v20
    s_and_b32 s21, s12, 1
    s_lshl_b32 s21, s21, 9
    s_lshl_b32 s22, s3, 7
    s_add_u32 s21, s21, s22
    v_and_b32 v21, 7, v20
    v_lshlrev_b32 v21, 4, v21
    v_add_u32 v21, s21, v21
    v_lshrrev_b32 v22, 3, v20
    v_lshl_add_u32 v12, v22, 10, v21
    v_bfe_u32 v22, v20, 4, 1
    v_lshl_add_u32 v13, v22, 3, v21
    s_and_b32 s21, s3, 1
    s_lshl_b32 s21, s21, 12
    s_lshr_b32 s22, s3, 1
    s_lshl_b32 s22, s22, 11
    s_add_u32 s21, s21, s22
    s_add_u32 s21, s21, 18560
    v_add_u32 v61, s21, v1
    s_lshl_b32 s21, s3, 2
    s_add_u32 s21, s21, 13312
    v_mov_b32 v14, s21
    v_and_b32 v21, 15, v20
    v_and_b32 v22, 1, v20
    v_lshlrev_b32 v22, 4, v22
    v_mov_b32 v23, 0x3f80
    v_lshlrev_b32 v22, v22, v23
    v_lshrrev_b32 v21, 1, v21
    v_cmp_eq_u32 vcc, 0, v21
    s_nop 1
    v_cndmask_b32 v56, 0, v22, vcc
    v_cmp_eq_u32 vcc, 1, v21
    s_nop 1
    v_cndmask_b32 v57, 0, v22, vcc
    v_cmp_eq_u32 vcc, 2, v21
    s_nop 1
    v_cndmask_b32 v58, 0, v22, vcc
    v_cmp_eq_u32 vcc, 3, v21
    s_nop 1
    v_cndmask_b32 v59, 0, v22, vcc
    v_and_b32 v21, 7, v20
    v_lshlrev_b32 v21, 7, v21
    v_bfe_u32 v22, v20, 3, 1
    v_lshl_add_u32 v21, v22, 17, v21
    s_lshl_b32 s21, s12, 14
    s_lshl_b32 s22, s13, 10
    s_add_u32 s21, s21, s22
    s_add_u32 s21, s21, 4980736
    v_lshrrev_b32 v22, 4, v20
    v_lshl_add_u32 v21, v22, 24, v21
    v_add_u32 v63, s21, v21
    s_mov_b32 s47, 0x3e0293ee
    s_lshl_b32 s14, s12, 2
    s_add_u32 s14, s14, s3
    s_lshl_b32 s61, s14, 13
    s_add_u32 s61, s61, 2097152
    s_lshl_b32 s14, s14, 12
    s_and_b32 s22, s13, 1
    s_lshl_b32 s69, s22, 17
    s_add_u32 s69, s69, s14
    s_add_u32 s69, s69, 4194304
    s_add_u32 s52, s14, 20971520
    s_lshl_b32 s21, s22, 11
    s_add_u32 s14, s14, s21
    s_add_u32 s14, s14, 1179648
    s_lshr_b32 s21, s13, 1
    s_sub_u32 s21, s21, 0
    s_cmp_eq_u32 s21, s3
    s_cselect_b32 s15, 1, 0
    s_add_u32 s23, s3, 3
    s_and_b32 s23, s23, 3
    s_cmp_eq_u32 s21, s23
    s_cselect_b32 s31, 1, 0
    s_and_b32 s24, s23, 1
    s_and_b32 s25, s3, 1
    s_sub_i32 s24, s24, s25
    s_lshr_b32 s23, s23, 1
    s_lshr_b32 s25, s3, 1
    s_sub_i32 s23, s23, s25
    s_mul_i32 s46, s24, 4096
    s_mul_i32 s25, s23, 2048
    s_add_i32 s46, s46, s25
    s_mul_i32 s27, s24, 32768
    s_mul_i32 s25, s23, 1024
    s_add_i32 s27, s27, s25
    v_lshrrev_b32 v21, 4, v20
    v_and_b32 v23, 15, v20
    v_lshlrev_b32 v21, 2, v21
    v_add_u32 v24, 0, v21
    v_cmp_gt_u32 vcc, v24, v23
    s_cmp_eq_u32 s22, 0
    s_cselect_b64 s[38:39], vcc, 0
    s_cselect_b64 s[48:49], -1, vcc
    v_add_u32 v24, 1, v21
    v_cmp_gt_u32 vcc, v24, v23
    s_cmp_eq_u32 s22, 0
    s_cselect_b64 s[40:41], vcc, 0
    s_cselect_b64 s[50:51], -1, vcc
    v_add_u32 v24, 2, v21
    v_cmp_gt_u32 vcc, v24, v23
    s_cmp_eq_u32 s22, 0
    s_cselect_b64 s[42:43], vcc, 0
    s_cselect_b64 s[54:55], -1, vcc
    v_add_u32 v24, 3, v21
    v_cmp_gt_u32 vcc, v24, v23
    s_cmp_eq_u32 s22, 0
    s_cselect_b64 s[44:45], vcc, 0
    s_cselect_b64 s[56:57], -1, vcc
    s_waitcnt vmcnt(0)
    v_mov_b32 v16, v32
    v_mov_b32 v17, v33
    v_mov_b32 v18, v34
    v_mov_b32 v19, v35
    v_mov_b32 v20, v36
    v_mov_b32 v21, v37
    v_mov_b32 v22, v38
    v_mov_b32 v23, v39
    v_mov_b32 v24, v40
    v_mov_b32 v25, v41
    v_mov_b32 v26, v42
    v_mov_b32 v27, v43
    v_mov_b32 v28, v44
    v_mov_b32 v29, v45
    v_mov_b32 v30, v46
    v_mov_b32 v31, v47
    v_mov_b32 v32, -1
    v_mov_b32 v33, -1
    v_mov_b32 v34, -1
    v_mov_b32 v35, -1
    s_add_u32 s21, s37, 3997696
    buffer_store_dwordx4 v[32:35], v1, s[4:7], s21 offen sc1
    s_add_u32 s21, s37, 4063232
    buffer_store_dwordx4 v[32:35], v1, s[4:7], s21 offen sc1
    s_add_u32 s21, s37, 4128768
    buffer_store_dwordx4 v[32:35], v1, s[4:7], s21 offen sc1
    s_lshl_b32 s29, s29, 5
    s_barrier
    ds_write_b32 v14, v10
    ds_write_b32 v14, v10 offset:16
    s_lshl_b32 s53, s3, 13
    s_add_u32 s53, s53, 92160
    v_add_u32 v32, 14336, v1
    ds_write_b128 v32, v[56:59]
    s_lshl_b32 s60, s12, 4
    s_add_u32 s60, s60, 218104320
    v_mov_b32 v15, 0
    s_add_u32 s25, s16, 0
    s_min_u32 s25, s25, 63
    s_cmp_lt_u32 s25, 8
    s_cselect_b32 s59, 12, 24
    s_cselect_b32 s58, -4, -8
    s_and_b32 s25, s25, s58
    s_lshl_b32 s25, s25, 5
    s_add_u32 s58, s25, s60
    v_mov_b32 v32, 131072
    s_waitcnt vmcnt(0) lgkmcnt(0)
    s_barrier
    ds_read_b64 v[32:33], v32
    s_waitcnt lgkmcnt(0)
    v_cmp_ne_u32 vcc, s29, v32
    s_setprio 3
    v_readfirstlane_b32 s63, v33
    s_add_u32 s34, s34, s63
    s_add_u32 s35, s35, s63
gate_6:
    v_readfirstlane_b32 s25, v15
    s_cmp_ge_u32 s25, s59
    s_cbranch_scc1 gate_6_ok
    s_sleep 8
    buffer_load_dword v15, off, s[4:7], s58 sc1
    s_waitcnt vmcnt(0)
    s_sub_u32 s26, s26, 1
    s_cbranch_scc0 gate_6
    s_mov_b32 s26, 0
gate_6_ok:
    s_add_u32 m0, s53, 0
    s_add_u32 s22, s52, 0
    buffer_load_dwordx4 v1, s[4:7], s22 offen offset:0 sc1 lds
    buffer_load_dwordx4 v1, s[4:7], s22 offen offset:1024 sc1 lds
    buffer_load_dwordx4 v1, s[4:7], s22 offen offset:2048 sc1 lds
    buffer_load_dwordx4 v1, s[4:7], s22 offen offset:3072 sc1 lds
    s_add_u32 m0, s53, 4096
    s_add_u32 s22, s52, 131072
    buffer_load_dwordx4 v1, s[4:7], s22 offen offset:0 sc1 lds
    buffer_load_dwordx4 v1, s[4:7], s22 offen offset:1024 sc1 lds
    buffer_load_dwordx4 v1, s[4:7], s22 offen offset:2048 sc1 lds
    buffer_load_dwordx4 v1, s[4:7], s22 offen offset:3072 sc1 lds
    s_add_u32 s52, s52, 262144
    s_cmp_eq_u32 s15, 0
    s_cbranch_scc1 ch_p_nd
    s_mov_b32 m0, 124928
    s_nop 0
    buffer_load_dwordx4 v1, s[4:7], s69 offen offset:0 sc1 lds
    buffer_load_dwordx4 v1, s[4:7], s69 offen offset:1024 sc1 lds
    buffer_load_dwordx4 v1, s[4:7], s69 offen offset:2048 sc1 lds
    buffer_load_dwordx4 v1, s[4:7], s69 offen offset:3072 sc1 lds
    s_add_u32 s69, s69, 262144
ch_p_nd:
    s_cbranch_vccnz ch_p_slow
    v_mov_b32 v32, 0
    v_mov_b32 v33, 0
    v_mov_b32 v34, 0
    v_mov_b32 v35, 0
    v_mov_b32 v36, 0
    v_mov_b32 v37, 0
    v_mov_b32 v38, 0
    v_mov_b32 v39, 0
    v_mov_b32 v40, 0
    v_mov_b32 v41, 0
    v_mov_b32 v42, 0
    v_mov_b32 v43, 0
    v_mov_b32 v44, 0
    v_mov_b32 v45, 0
    v_mov_b32 v46, 0
    v_mov_b32 v47, 0
    v_mov_b32 v48, 0
    v_mov_b32 v49, 0
    v_mov_b32 v50, 0
    v_mov_b32 v51, 0
    v_mov_b32 v52, 0
    v_mov_b32 v53, 0
    v_mov_b32 v54, 0
    v_mov_b32 v55, 0
    v_mov_b32 v0, 1.0
    s_mov_b32 exec_lo, 0xff00ff00
    s_mov_b32 exec_hi, 0xff00ff00
    v_mov_b32 v0, s47
    s_mov_b64 exec, -1
    v_mov_b32 v60, s16
    s_branch pnc_8
.p2align 6
ploop_7:
    s_add_u32 s21, s17, s33
    v_mov_b32 v32, 0
    v_mov_b32 v33, 0
    v_mov_b32 v34, 0
    v_mov_b32 v35, 0
    v_mov_b32 v36, 0
    v_mov_b32 v37, 0
    v_mov_b32 v38, 0
    v_mov_b32 v39, 0
    v_mov_b32 v40, 0
    v_mov_b32 v41, 0
    v_mov_b32 v42, 0
    v_mov_b32 v43, 0
    v_mov_b32 v44, 0
    v_mov_b32 v45, 0
    v_mov_b32 v46, 0
    v_mov_b32 v47, 0
    v_mov_b32 v48, 0
    v_mov_b32 v49, 0
    v_mov_b32 v50, 0
    v_mov_b32 v51, 0
    v_mov_b32 v52, 0
    v_mov_b32 v53, 0
    v_mov_b32 v54, 0
    v_mov_b32 v55, 0
    v_mov_b32 v0, 1.0
    s_mov_b32 exec_lo, 0xff00ff00
    s_mov_b32 exec_hi, 0xff00ff00
    v_mov_b32 v0, s47
    s_mov_b64 exec, -1
    s_nop 15
    s_nop 8
    buffer_load_dwordx4 v[16:19], v1, s[4:7], s21 offen offset:0 sc1
    s_nop 7
    buffer_load_dwordx4 v[20:23], v1, s[4:7], s21 offen offset:1024 sc1
    s_nop 7
    buffer_load_dwordx4 v[24:27], v1, s[4:7], s21 offen offset:2048 sc1
    s_nop 7
    buffer_load_dwordx4 v[28:31], v1, s[4:7], s21 offen offset:3072 sc1
    s_waitcnt vmcnt(3)
    v_max3_u32 v9, v16, v17, v18
    v_max_u32 v9, v9, v19
    v_cmp_eq_u32 vcc, -1, v9
    s_cbranch_vccnz prm_10_0
prm_10_0ok:
    v_smfmac_f32_16x16x64_bf16 v[32:35], v[16:19], v[64:71], v62
    v_smfmac_f32_16x16x64_bf16 v[36:39], v[16:19], v[72:79], v62
    v_smfmac_f32_16x16x64_bf16 v[40:43], v[16:19], v[80:87], v62
    s_waitcnt vmcnt(2)
    v_max3_u32 v9, v20, v21, v22
    v_max_u32 v9, v9, v23
    v_cmp_eq_u32 vcc, -1, v9
    v_smfmac_f32_16x16x64_bf16 v[44:47], v[16:19], v[88:95], v62
    v_smfmac_f32_16x16x64_bf16 v[48:51], v[16:19], v[96:103], v62
    v_smfmac_f32_16x16x64_bf16 v[52:55], v[16:19], v[104:111], v62
    s_cbranch_vccnz prm_10_1
prm_10_1ok:
    v_smfmac_f32_16x16x64_bf16 v[32:35], v[20:23], v[112:119], v62
    v_readfirstlane_b32 s23, v15
    v_smfmac_f32_16x16x64_bf16 v[36:39], v[20:23], v[120:127], v62
    v_smfmac_f32_16x16x64_bf16 v[40:43], v[20:23], v[128:135], v62
    s_waitcnt vmcnt(1)
    v_max3_u32 v9, v24, v25, v26
    v_max_u32 v9, v9, v27
    v_cmp_eq_u32 vcc, -1, v9
    v_smfmac_f32_16x16x64_bf16 v[44:47], v[20:23], v[136:143], v62
    v_smfmac_f32_16x16x64_bf16 v[48:51], v[20:23], v[144:151], v62
    v_smfmac_f32_16x16x64_bf16 v[52:55], v[20:23], v[152:159], v62
    s_cbranch_vccnz prm_10_2
prm_10_2ok:
    v_smfmac_f32_16x16x64_bf16 v[32:35], v[24:27], v[160:167], v62
    v_smfmac_f32_16x16x64_bf16 v[36:39], v[24:27], v[168:175], v62
    v_smfmac_f32_16x16x64_bf16 v[40:43], v[24:27], v[176:183], v62
    s_waitcnt vmcnt(0)
    v_max3_u32 v9, v28, v29, v30
    v_max_u32 v9, v9, v31
    v_cmp_eq_u32 vcc, -1, v9
    v_smfmac_f32_16x16x64_bf16 v[44:47], v[24:27], v[184:191], v62
    v_smfmac_f32_16x16x64_bf16 v[48:51], v[24:27], v[192:199], v62
    v_smfmac_f32_16x16x64_bf16 v[52:55], v[24:27], v[200:207], v62
    s_cbranch_vccnz prm_10_3
prm_10_3ok:
    v_smfmac_f32_16x16x64_bf16 v[32:35], v[28:31], v[208:215], v62
    s_cmp_lt_u32 s23, s59
    s_cbranch_scc1 prm_10_gt
prm_10_gtb:
    ds_write_b32 v14, v60
    v_smfmac_f32_16x16x64_bf16 v[36:39], v[28:31], v[216:223], v62
    v_smfmac_f32_16x16x64_bf16 v[40:43], v[28:31], v[224:231], v62
    v_smfmac_f32_16x16x64_bf16 v[44:47], v[28:31], v[232:239], v62
    v_add_f32 v32, v32, v33
    v_add_f32 v34, v34, v35
    v_smfmac_f32_16x16x64_bf16 v[48:51], v[28:31], v[240:247], v62
    v_add_f32 v36, v36, v37
    v_add_f32 v38, v38, v39
    ds_write2_b32 v4, v32, v34 offset0:0 offset1:104
    v_smfmac_f32_16x16x64_bf16 v[52:55], v[28:31], v[248:255], v62
    v_add_f32 v40, v40, v41
    v_add_f32 v42, v42, v43
    ds_write2_b32 v4, v36, v38 offset0:16 offset1:120
    v_add_f32 v44, v44, v45
    v_add_f32 v46, v46, v47
    ds_write2_b32 v4, v40, v42 offset0:32 offset1:136
    v_add_f32 v48, v48, v49
    v_add_f32 v50, v50, v51
    ds_write2_b32 v4, v44, v46 offset0:48 offset1:152
    v_add_f32 v52, v52, v53
    v_add_f32 v54, v54, v55
    ds_write2_b32 v4, v48, v50 offset0:64 offset1:168
    ds_write2_b32 v4, v52, v54 offset0:80 offset1:184
    s_branch pnc_8_done
pnc_8:
    v_smfmac_f32_16x16x64_bf16 v[32:35], v[16:19], v[64:71], v62
    v_smfmac_f32_16x16x64_bf16 v[36:39], v[16:19], v[72:79], v62
    v_smfmac_f32_16x16x64_bf16 v[40:43], v[16:19], v[80:87], v62
    v_smfmac_f32_16x16x64_bf16 v[44:47], v[16:19], v[88:95], v62
    v_smfmac_f32_16x16x64_bf16 v[48:51], v[16:19], v[96:103], v62
    v_smfmac_f32_16x16x64_bf16 v[52:55], v[16:19], v[104:111], v62
    v_smfmac_f32_16x16x64_bf16 v[32:35], v[20:23], v[112:119], v62
    v_smfmac_f32_16x16x64_bf16 v[36:39], v[20:23], v[120:127], v62
    v_smfmac_f32_16x16x64_bf16 v[40:43], v[20:23], v[128:135], v62
    v_smfmac_f32_16x16x64_bf16 v[44:47], v[20:23], v[136:143], v62
    v_smfmac_f32_16x16x64_bf16 v[48:51], v[20:23], v[144:151], v62
    v_smfmac_f32_16x16x64_bf16 v[52:55], v[20:23], v[152:159], v62
    v_smfmac_f32_16x16x64_bf16 v[32:35], v[24:27], v[160:167], v62
    v_smfmac_f32_16x16x64_bf16 v[36:39], v[24:27], v[168:175], v62
    v_smfmac_f32_16x16x64_bf16 v[40:43], v[24:27], v[176:183], v62
    v_smfmac_f32_16x16x64_bf16 v[44:47], v[24:27], v[184:191], v62
    v_smfmac_f32_16x16x64_bf16 v[48:51], v[24:27], v[192:199], v62
    v_smfmac_f32_16x16x64_bf16 v[52:55], v[24:27], v[200:207], v62
    v_smfmac_f32_16x16x64_bf16 v[32:35], v[28:31], v[208:215], v62
    ds_write_b32 v14, v60
    v_smfmac_f32_16x16x64_bf16 v[36:39], v[28:31], v[216:223], v62
    v_smfmac_f32_16x16x64_bf16 v[40:43], v[28:31], v[224:231], v62
    v_smfmac_f32_16x16x64_bf16 v[44:47], v[28:31], v[232:239], v62
    v_add_f32 v32, v32, v33
    v_add_f32 v34, v34, v35
    v_smfmac_f32_16x16x64_bf16 v[48:51], v[28:31], v[240:247], v62
    v_add_f32 v36, v36, v37
    v_add_f32 v38, v38, v39
    ds_write2_b32 v4, v32, v34 offset0:0 offset1:104
    v_smfmac_f32_16x16x64_bf16 v[52:55], v[28:31], v[248:255], v62
    v_add_f32 v40, v40, v41
    v_add_f32 v42, v42, v43
    ds_write2_b32 v4, v36, v38 offset0:16 offset1:120
    v_add_f32 v44, v44, v45
    v_add_f32 v46, v46, v47
    ds_write2_b32 v4, v40, v42 offset0:32 offset1:136
    v_add_f32 v48, v48, v49
    v_add_f32 v50, v50, v51
    ds_write2_b32 v4, v44, v46 offset0:48 offset1:152
    v_add_f32 v52, v52, v53
    v_add_f32 v54, v54, v55
    ds_write2_b32 v4, v48, v50 offset0:64 offset1:168
    ds_write2_b32 v4, v52, v54 offset0:80 offset1:184
    s_waitcnt vmcnt(0)
pnc_8_done:
    s_add_u32 s21, s17, s32
    s_add_u32 s22, s19, s32
    s_add_u32 s24, s19, s35
    s_waitcnt lgkmcnt(0)
    s_barrier
    ds_read_b64 v[32:33], v5 offset:0
    ds_read_b64 v[34:35], v5 offset:3328
    ds_read_b64 v[36:37], v5 offset:6656
    ds_read_b64 v[38:39], v5 offset:9984
    ds_read_b64 v[40:41], v6 offset:0
    ds_read_b64 v[42:43], v6 offset:3328
    ds_read_b64 v[44:45], v6 offset:6656
    ds_read_b64 v[46:47], v6 offset:9984
    s_waitcnt lgkmcnt(6)
    v_add_f32 v32, v32, v34
    v_add_f32 v33, v33, v35
    s_waitcnt lgkmcnt(4)
    v_add_f32 v36, v36, v38
    v_add_f32 v37, v37, v39
    v_add_f32 v32, v32, v36
    v_add_f32 v33, v33, v37
    v_mul_f32 v32, v32, v0
    v_mul_f32 v33, v33, v0
    v_cvt_pk_bf16_f32 v32, v32, v33
    v_min_u32 v32, -2, v32
    buffer_store_dword v32, v2, s[4:7], s21 offen
    s_waitcnt lgkmcnt(2)
    v_add_f32 v40, v40, v42
    v_add_f32 v41, v41, v43
    s_waitcnt lgkmcnt(0)
    v_add_f32 v44, v44, v46
    v_add_f32 v45, v45, v47
    v_add_f32 v40, v40, v44
    v_add_f32 v41, v41, v45
    v_cvt_pk_bf16_f32 v40, v40, v41
    v_min_u32 v40, -2, v40
    s_mov_b32 exec_hi, 0
    buffer_store_dword v40, v3, s[4:7], s21 offen
    s_setprio 0
    s_mov_b64 exec, -1
    s_add_u32 s21, s17, s35
    s_add_u32 s30, s17, s34
    s_add_u32 s23, s18, s36
    s_add_u32 s25, s16, 2
    s_min_u32 s25, s25, 63
    s_cmp_lt_u32 s25, 8
    s_cselect_b32 s59, 12, 24
    s_cselect_b32 s58, -4, -8
    s_and_b32 s25, s25, s58
    s_lshl_b32 s25, s25, 5
    s_add_u32 s58, s25, s60
    s_cmp_eq_u32 s15, 0
    s_cbranch_scc1 ploop_7_nd
    v_add_u32 v9, s53, v1
    v_add_u32 v0, 124928, v1
    ds_read_b128 v[16:19], v0 offset:0
    ds_read_b128 v[32:35], v9 offset:0
    ds_read_b128 v[20:23], v0 offset:1024
    ds_read_b128 v[36:39], v9 offset:1024
    ds_read_b128 v[24:27], v0 offset:2048
    ds_read_b128 v[40:43], v9 offset:2048
    ds_read_b128 v[28:31], v0 offset:3072
    ds_read_b128 v[44:47], v9 offset:3072
    s_add_u32 s22, s17, s61
    s_waitcnt lgkmcnt(6)
    v_mfma_f32_16x16x32_bf16 v[48:51], v[32:35], v[16:19], 0
    ds_read_b128 v[32:35], v9 offset:4096
    s_waitcnt lgkmcnt(5)
    v_mfma_f32_16x16x32_bf16 v[48:51], v[36:39], v[20:23], v[48:51]
    ds_read_b128 v[36:39], v9 offset:5120
    s_waitcnt lgkmcnt(4)
    v_mfma_f32_16x16x32_bf16 v[48:51], v[40:43], v[24:27], v[48:51]
    ds_read_b128 v[40:43], v9 offset:6144
    s_waitcnt lgkmcnt(3)
    v_mfma_f32_16x16x32_bf16 v[48:51], v[44:47], v[28:31], v[48:51]
    ds_read_b128 v[44:47], v9 offset:7168
    s_waitcnt lgkmcnt(3)
    v_mfma_f32_16x16x32_bf16 v[52:55], v[32:35], v[16:19], 0
    s_waitcnt lgkmcnt(2)
    v_mfma_f32_16x16x32_bf16 v[52:55], v[36:39], v[20:23], v[52:55]
    s_waitcnt lgkmcnt(1)
    v_mfma_f32_16x16x32_bf16 v[52:55], v[40:43], v[24:27], v[52:55]
    s_waitcnt lgkmcnt(0)
    v_mfma_f32_16x16x32_bf16 v[52:55], v[44:47], v[28:31], v[52:55]
    buffer_load_dwordx4 v[32:35], v1, s[4:7], s22 offen offset:0 sc1
    buffer_load_dwordx4 v[36:39], v1, s[4:7], s22 offen offset:1024 sc1
    buffer_load_dwordx4 v[40:43], v1, s[4:7], s22 offen offset:2048 sc1
    buffer_load_dwordx4 v[44:47], v1, s[4:7], s22 offen offset:3072 sc1
    v_mov_b32 v60, 0xff61b1e6
    s_nop 2
    v_cndmask_b32 v48, v48, v60, s[38:39]
    v_cndmask_b32 v49, v49, v60, s[40:41]
    v_cndmask_b32 v50, v50, v60, s[42:43]
    v_cndmask_b32 v51, v51, v60, s[44:45]
    v_cndmask_b32 v52, v52, v60, s[48:49]
    v_cndmask_b32 v53, v53, v60, s[50:51]
    v_cndmask_b32 v54, v54, v60, s[54:55]
    v_cndmask_b32 v55, v55, v60, s[56:57]
    v_max3_f32 v0, v48, v49, v50
    v_max3_f32 v9, v51, v52, v53
    v_max3_f32 v0, v0, v54, v55
    v_max_f32 v0, v0, v9
    v_mov_b32 v9, v0
    s_nop 1
    v_permlane16_swap_b32 v9, v0
    v_max_f32 v0, v0, v9
    v_mov_b32 v9, v0
    s_nop 1
    v_permlane32_swap_b32 v9, v0
    v_max_f32 v0, v0, v9
    v_mul_f32 v0, s47, v0
    v_fma_f32 v48, v48, s47, -v0
    v_fma_f32 v49, v49, s47, -v0
    v_fma_f32 v50, v50, s47, -v0
    v_fma_f32 v51, v51, s47, -v0
    v_fma_f32 v52, v52, s47, -v0
    v_fma_f32 v53, v53, s47, -v0
    v_fma_f32 v54, v54, s47, -v0
    v_fma_f32 v55, v55, s47, -v0
    v_exp_f32 v48, v48
    v_exp_f32 v49, v49
    v_exp_f32 v50, v50
    v_exp_f32 v51, v51
    v_exp_f32 v52, v52
    v_exp_f32 v53, v53
    v_exp_f32 v54, v54
    v_exp_f32 v55, v55
    v_add_f32 v15, v48, v49
    v_add_f32 v15, v15, v50
    v_add_f32 v15, v15, v51
    v_add_f32 v15, v15, v52
    v_add_f32 v15, v15, v53
    v_add_f32 v15, v15, v54
    v_add_f32 v15, v15, v55
ploop_7_za:
    s_waitcnt vmcnt(0)
    v_max3_u32 v9, v32, v33, v34
    v_max3_u32 v9, v9, v35, v36
    v_max3_u32 v9, v9, v37, v38
    v_max3_u32 v9, v9, v39, v40
    v_max3_u32 v9, v9, v41, v42
    v_max3_u32 v9, v9, v43, v44
    v_max3_u32 v9, v9, v45, v46
    v_max_u32 v9, v9, v47
    v_cmp_eq_u32 vcc, -1, v9
    s_cbranch_vccnz ploop_7_zr
ploop_7_zok:
    v_mfma_f32_16x16x32_bf16 v[56:59], v[32:35], v[16:19], 0
    v_mfma_f32_16x16x32_bf16 v[56:59], v[36:39], v[20:23], v[56:59]
    v_mfma_f32_16x16x32_bf16 v[56:59], v[40:43], v[24:27], v[56:59]
    v_mfma_f32_16x16x32_bf16 v[56:59], v[44:47], v[28:31], v[56:59]
    s_add_u32 s22, s17, s14
    s_nop 6
    v_max_f32 v60, v56, v57
    v_mov_b32 v9, v60
    s_nop 1
    v_permlane16_swap_b32 v9, v60
    v_max_f32 v60, v60, v9
    v_mov_b32 v9, v60
    s_nop 1
    v_permlane32_swap_b32 v9, v60
    v_max_f32 v60, v60, v9
    v_mul_f32 v60, s47, v60
    v_max_f32 v58, v60, v0
    v_sub_f32 v60, v0, v58
    v_fma_f32 v56, v56, s47, -v58
    v_fma_f32 v57, v57, s47, -v58
    v_exp_f32 v60, v60
    v_exp_f32 v56, v56
    v_exp_f32 v57, v57
    v_fma_f32 v15, v15, v60, v56
    v_add_f32 v15, v15, v57
    v_mov_b32 v9, v15
    s_nop 1
    v_permlane16_swap_b32 v9, v15
    v_add_f32 v15, v15, v9
    v_mov_b32 v9, v15
    s_nop 1
    v_permlane32_swap_b32 v9, v15
    v_add_f32 v15, v15, v9
    v_rcp_f32 v15, v15
    s_add_u32 s25, s19, s14
    v_mul_f32 v56, v56, v15
    v_mul_f32 v57, v57, v15
    v_mul_f32 v60, v60, v15
    v_mul_f32 v48, v48, v60
    v_mul_f32 v49, v49, v60
    v_mul_f32 v50, v50, v60
    v_mul_f32 v51, v51, v60
    v_mul_f32 v52, v52, v60
    v_mul_f32 v53, v53, v60
    v_mul_f32 v54, v54, v60
    v_mul_f32 v55, v55, v60
    v_cvt_pk_bf16_f32 v48, v48, v49
    v_cvt_pk_bf16_f32 v49, v50, v51
    v_cvt_pk_bf16_f32 v50, v52, v53
    v_cvt_pk_bf16_f32 v51, v54, v55
    v_min_u32 v48, -2, v48
    v_min_u32 v49, -2, v49
    v_min_u32 v50, -2, v50
    v_min_u32 v51, -2, v51
    v_lshlrev_b32 v54, 1, v8
    v_add_u32 v55, 14336, v1
    v_mov_b32 v53, 1.0
    v_cvt_pk_bf16_f32 v52, v56, v57
    v_min_u32 v53, -2, v53
    v_min_u32 v52, -2, v52
    buffer_store_dwordx4 v[48:51], v1, s[4:7], s22 offen
    buffer_store_dwordx2 v[52:53], v54, s[4:7], s22 offen offset:1024
    ds_read_b128 v[56:59], v55
    s_branch ploop_7_nd2
ploop_7_nd:
    s_cmp_eq_u32 s16, 0
    s_cbranch_scc1 ploop_7_ns
    s_cmp_eq_u32 s31, 0
    s_cbranch_scc1 ploop_7_n2
    s_add_u32 s25, s68, s46
    v_add_u32 v55, s25, v61
    ds_read_b128 v[24:27], v55 offset:0
    ds_read_b128 v[28:31], v55 offset:1024
    ds_read_b128 v[32:35], v55 offset:18560
    ds_read_b128 v[36:39], v55 offset:19584
    ds_read_b128 v[40:43], v55 offset:37120
    ds_read_b128 v[44:47], v55 offset:38144
    ds_read_b128 v[48:51], v55 offset:55680
    ds_read_b128 v[52:55], v55 offset:56704
    s_waitcnt lgkmcnt(4)
    v_add_f32 v24, v24, v32
    v_add_f32 v25, v25, v33
    v_add_f32 v26, v26, v34
    v_add_f32 v27, v27, v35
    v_add_f32 v28, v28, v36
    v_add_f32 v29, v29, v37
    v_add_f32 v30, v30, v38
    v_add_f32 v31, v31, v39
    s_waitcnt lgkmcnt(0)
    v_add_f32 v40, v40, v48
    v_add_f32 v41, v41, v49
    v_add_f32 v42, v42, v50
    v_add_f32 v43, v43, v51
    v_add_f32 v44, v44, v52
    v_add_f32 v45, v45, v53
    v_add_f32 v46, v46, v54
    v_add_f32 v47, v47, v55
    v_add_f32 v24, v24, v40
    v_add_f32 v25, v25, v41
    v_add_f32 v26, v26, v42
    v_add_f32 v27, v27, v43
    v_add_f32 v28, v28, v44
    v_add_f32 v29, v29, v45
    v_add_f32 v30, v30, v46
    v_add_f32 v31, v31, v47
    v_cvt_pk_bf16_f32 v24, v24, v25
    v_cvt_pk_bf16_f32 v25, v26, v27
    v_cvt_pk_bf16_f32 v26, v28, v29
    v_cvt_pk_bf16_f32 v27, v30, v31
    v_min_u32 v24, -2, v24
    v_min_u32 v25, -2, v25
    v_min_u32 v26, -2, v26
    v_min_u32 v27, -2, v27
    v_mov_b32 v16, v24
    v_mov_b32 v17, v25
    v_mov_b32 v18, v26
    v_mov_b32 v19, v27
ploop_7_n2:
    v_add_u32 v55, s68, v61
    ds_read_b128 v[24:27], v55 offset:0
    ds_read_b128 v[28:31], v55 offset:1024
    ds_read_b128 v[32:35], v55 offset:18560
    ds_read_b128 v[36:39], v55 offset:19584
    ds_read_b128 v[40:43], v55 offset:37120
    ds_read_b128 v[44:47], v55 offset:38144
    ds_read_b128 v[48:51], v55 offset:55680
    ds_read_b128 v[52:55], v55 offset:56704
    s_waitcnt lgkmcnt(4)
    v_add_f32 v24, v24, v32
    v_add_f32 v25, v25, v33
    v_add_f32 v26, v26, v34
    v_add_f32 v27, v27, v35
    v_add_f32 v28, v28, v36
    v_add_f32 v29, v29, v37
    v_add_f32 v30, v30, v38
    v_add_f32 v31, v31, v39
    s_waitcnt lgkmcnt(0)
    v_add_f32 v40, v40, v48
    v_add_f32 v41, v41, v49
    v_add_f32 v42, v42, v50
    v_add_f32 v43, v43, v51
    v_add_f32 v44, v44, v52
    v_add_f32 v45, v45, v53
    v_add_f32 v46, v46, v54
    v_add_f32 v47, v47, v55
    v_add_f32 v24, v24, v40
    v_add_f32 v25, v25, v41
    v_add_f32 v26, v26, v42
    v_add_f32 v27, v27, v43
    v_add_f32 v28, v28, v44
    v_add_f32 v29, v29, v45
    v_add_f32 v30, v30, v46
    v_add_f32 v31, v31, v47
    v_cvt_pk_bf16_f32 v24, v24, v25
    v_cvt_pk_bf16_f32 v25, v26, v27
    v_cvt_pk_bf16_f32 v26, v28, v29
    v_cvt_pk_bf16_f32 v27, v30, v31
    v_min_u32 v24, -2, v24
    v_min_u32 v25, -2, v25
    v_min_u32 v26, -2, v26
    v_min_u32 v27, -2, v27
ploop_7_ns:
ploop_7_flag:
    ds_read_b32 v9, v14 offset:16
    s_waitcnt lgkmcnt(0)
    v_readfirstlane_b32 s25, v9
    s_cmp_eq_u32 s25, s16
    s_cbranch_scc0 ploop_7_flag
    s_add_u32 m0, s53, 0
    s_add_u32 s22, s52, 0
    buffer_load_dwordx4 v1, s[4:7], s22 offen offset:0 sc1 lds
    buffer_load_dwordx4 v1, s[4:7], s22 offen offset:1024 sc1 lds
    buffer_load_dwordx4 v1, s[4:7], s22 offen offset:2048 sc1 lds
    buffer_load_dwordx4 v1, s[4:7], s22 offen offset:3072 sc1 lds
    s_add_u32 m0, s53, 4096
    s_add_u32 s22, s52, 131072
    buffer_load_dwordx4 v1, s[4:7], s22 offen offset:0 sc1 lds
    buffer_load_dwordx4 v1, s[4:7], s22 offen offset:1024 sc1 lds
    buffer_load_dwordx4 v1, s[4:7], s22 offen offset:2048 sc1 lds
    buffer_load_dwordx4 v1, s[4:7], s22 offen offset:3072 sc1 lds
    s_add_u32 s52, s52, 262144
    s_cmp_eq_u32 s16, 0
    s_cbranch_scc1 ploop_7_nd2
    buffer_store_dwordx4 v[24:27], v1, s[4:7], s37 offen sc1
    s_cmp_eq_u32 s31, 0
    s_cbranch_scc1 ploop_7_nd2
    s_add_u32 s25, s37, s27
    buffer_store_dwordx4 v[16:19], v1, s[4:7], s25 offen sc1
ploop_7_nd2:
    s_cmp_eq_u32 s16, 0
    s_cbranch_scc1 ploop_7_nn
    s_add_u32 s37, s37, 65536
    s_xor_b32 s68, s68, 8192
ploop_7_nn:
    s_cmp_lg_u32 s3, 2
    s_cbranch_scc1 ppf_12
    s_lshl_b32 s22, s16, 18
    s_mov_b32 exec_hi, 0xffff
    buffer_load_dword v0, v63, s[4:7], s22 offen sc1
    buffer_load_dword v0, v63, s[4:7], s22 offen offset:64 sc1
    s_mov_b32 exec_hi, -1
ppf_12:
    v_add_u32 v24, 18560, v7
    v_add_u32 v25, 37120, v7
    v_add_u32 v26, 55680, v7
    s_cmp_eq_u32 s16, 63
    s_setprio 3
    s_barrier
    s_cbranch_scc1 ptail_9
    ds_read2_b32 v[16:17], v7 offset0:0 offset1:2
    ds_read2_b32 v[18:19], v24 offset0:0 offset1:2
    ds_read2_b32 v[20:21], v25 offset0:0 offset1:2
    ds_read2_b32 v[22:23], v26 offset0:0 offset1:2
    s_waitcnt lgkmcnt(2)
    v_add_f32 v16, v16, v18
    v_add_f32 v17, v17, v19
    s_waitcnt lgkmcnt(0)
    v_add_f32 v20, v20, v22
    v_add_f32 v21, v21, v23
    v_add_f32 v16, v16, v20
    v_add_f32 v17, v17, v21
    v_cvt_pk_bf16_f32 v16, v16, v17
    v_min_u32 v16, -2, v16
    buffer_store_dword v16, v2, s[4:7], s21 offen sc1
    buffer_store_dword v10, v2, s[4:7], s24 offen sc1
    s_cmp_eq_u32 s15, 0
    s_cbranch_scc1 ploop_7_pnd
    s_sleep 6
    s_nop 8
    buffer_load_dwordx4 v[16:19], v12, s[4:7], s30 offen sc1
    buffer_load_dword v15, off, s[4:7], s58 sc1
    s_add_u32 s25, s19, s14
    v_mov_b32 v20, -1
    v_mov_b32 v21, -1
    v_mov_b32 v22, -1
    v_mov_b32 v23, -1
    buffer_store_dwordx4 v[20:23], v1, s[4:7], s25 offen
    buffer_store_dwordx2 v[20:21], v54, s[4:7], s25 offen offset:1024
    s_mov_b32 m0, 124928
    s_nop 0
    buffer_load_dwordx4 v1, s[4:7], s69 offen offset:0 sc1 lds
    buffer_load_dwordx4 v1, s[4:7], s69 offen offset:1024 sc1 lds
    buffer_load_dwordx4 v1, s[4:7], s69 offen offset:2048 sc1 lds
    buffer_load_dwordx4 v1, s[4:7], s69 offen offset:3072 sc1 lds
    s_add_u32 s69, s69, 262144
    s_add_u32 m0, s53, 0
    s_add_u32 s22, s52, 0
    buffer_load_dwordx4 v1, s[4:7], s22 offen offset:0 sc1 lds
    buffer_load_dwordx4 v1, s[4:7], s22 offen offset:1024 sc1 lds
    buffer_load_dwordx4 v1, s[4:7], s22 offen offset:2048 sc1 lds
    buffer_load_dwordx4 v1, s[4:7], s22 offen offset:3072 sc1 lds
    s_add_u32 m0, s53, 4096
    s_add_u32 s22, s52, 131072
    buffer_load_dwordx4 v1, s[4:7], s22 offen offset:0 sc1 lds
    buffer_load_dwordx4 v1, s[4:7], s22 offen offset:1024 sc1 lds
    buffer_load_dwordx4 v1, s[4:7], s22 offen offset:2048 sc1 lds
    buffer_load_dwordx4 v1, s[4:7], s22 offen offset:3072 sc1 lds
    s_add_u32 s52, s52, 262144
    s_add_u32 s22, s16, 1
    v_mov_b32 v60, s22
    s_waitcnt vmcnt(15) lgkmcnt(0)
    s_branch ploop_7_pchk
ploop_7_pnd:
    s_sleep 6
    s_nop 8
    buffer_load_dwordx4 v[16:19], v12, s[4:7], s30 offen sc1
    buffer_load_dword v15, off, s[4:7], s58 sc1
    s_add_u32 s22, s16, 1
    v_mov_b32 v60, s22
    s_waitcnt vmcnt(1) lgkmcnt(0)
    s_branch ploop_7_pchk
ploop_7_pagain:
    s_waitcnt vmcnt(1) lgkmcnt(0)
ploop_7_pchk:
    v_mfma_f32_16x16x32_bf16 v[20:23], v[56:59], v[16:19], 0
    v_max3_u32 v9, v16, v17, v18
    v_max_u32 v9, v9, v19
    v_cmp_eq_u32 vcc, -1, v9
    s_cbranch_vccnz prp_11
ploop_7_pgo:
    s_nop 3
    v_add_f32_dpp v20, v20, v20 row_ror:8 row_mask:0xf bank_mask:0xf
    v_add_f32_dpp v21, v21, v21 row_ror:8 row_mask:0xf bank_mask:0xf
    v_add_f32_dpp v22, v22, v22 row_ror:8 row_mask:0xf bank_mask:0xf
    v_add_f32_dpp v23, v23, v23 row_ror:8 row_mask:0xf bank_mask:0xf
    v_cvt_pk_bf16_f32 v20, v20, v21
    v_cvt_pk_bf16_f32 v21, v22, v23
    s_mov_b32 exec_hi, 0
    v_min_u32 v20, -2, v20
    v_min_u32 v21, -2, v21
    s_mov_b32 exec_lo, 0x00ff00ff
    buffer_store_dwordx2 v[20:21], v13, s[4:7], s23 offen
    s_mov_b64 exec, -1
    s_add_u32 s22, s19, s32
    s_add_u32 s25, s20, s36
    buffer_store_dword v10, v2, s[4:7], s22 offen
    s_mov_b32 exec_hi, 0
    buffer_store_dword v10, v3, s[4:7], s22 offen
    s_mov_b32 exec_lo, 0x00ff00ff
    buffer_store_dwordx2 v[10:11], v13, s[4:7], s25 offen
    s_mov_b64 exec, -1
    s_add_u32 s16, s16, 1
    s_mov_b32 s17, s18
    s_mov_b32 s18, s19
    s_mov_b32 s19, s20
    s_add_u32 s20, s20, 262144
    s_cmp_eq_u32 s20, 210763776
    s_cselect_b32 s20, 209715200, s20
    s_branch ploop_7
prm_10_gt:
gate_13:
    v_readfirstlane_b32 s25, v15
    s_cmp_ge_u32 s25, s59
    s_cbranch_scc1 gate_13_ok
    s_sleep 8
    buffer_load_dword v15, off, s[4:7], s58 sc1
    s_waitcnt vmcnt(0)
    s_sub_u32 s26, s26, 1
    s_cbranch_scc0 gate_13
    s_mov_b32 s26, 0
gate_13_ok:
    s_branch prm_10_gtb
prm_10_0:
    s_sub_u32 s26, s26, 1
    s_cbranch_scc1 prm_10_0_g
    buffer_load_dwordx4 v[16:19], v1, s[4:7], s21 offen offset:0 sc1
    buffer_load_dwordx4 v[20:23], v1, s[4:7], s21 offen offset:1024 sc1
    buffer_load_dwordx4 v[24:27], v1, s[4:7], s21 offen offset:2048 sc1
    buffer_load_dwordx4 v[28:31], v1, s[4:7], s21 offen offset:3072 sc1
    s_waitcnt vmcnt(3)
    v_max3_u32 v9, v16, v17, v18
    v_max_u32 v9, v9, v19
    v_cmp_eq_u32 vcc, -1, v9
    s_cbranch_vccnz prm_10_0
    s_branch prm_10_0ok
prm_10_0_g:
    s_mov_b32 s26, 0
    s_waitcnt vmcnt(0)
    s_branch prm_10_0ok
prm_10_1:
    s_sub_u32 s26, s26, 1
    s_cbranch_scc1 prm_10_1_g
    buffer_load_dwordx4 v[20:23], v1, s[4:7], s21 offen offset:1024 sc1
    buffer_load_dwordx4 v[24:27], v1, s[4:7], s21 offen offset:2048 sc1
    buffer_load_dwordx4 v[28:31], v1, s[4:7], s21 offen offset:3072 sc1
    s_waitcnt vmcnt(2)
    v_max3_u32 v9, v20, v21, v22
    v_max_u32 v9, v9, v23
    v_cmp_eq_u32 vcc, -1, v9
    s_cbranch_vccnz prm_10_1
    s_branch prm_10_1ok
prm_10_1_g:
    s_mov_b32 s26, 0
    s_waitcnt vmcnt(0)
    s_branch prm_10_1ok
prm_10_2:
    s_sub_u32 s26, s26, 1
    s_cbranch_scc1 prm_10_2_g
    buffer_load_dwordx4 v[24:27], v1, s[4:7], s21 offen offset:2048 sc1
    buffer_load_dwordx4 v[28:31], v1, s[4:7], s21 offen offset:3072 sc1
    s_waitcnt vmcnt(1)
    v_max3_u32 v9, v24, v25, v26
    v_max_u32 v9, v9, v27
    v_cmp_eq_u32 vcc, -1, v9
    s_cbranch_vccnz prm_10_2
    s_branch prm_10_2ok
prm_10_2_g:
    s_mov_b32 s26, 0
    s_waitcnt vmcnt(0)
    s_branch prm_10_2ok
prm_10_3:
    s_sub_u32 s26, s26, 1
    s_cbranch_scc1 prm_10_3_g
    buffer_load_dwordx4 v[28:31], v1, s[4:7], s21 offen offset:3072 sc1
    s_waitcnt vmcnt(0)
    v_max3_u32 v9, v28, v29, v30
    v_max_u32 v9, v9, v31
    v_cmp_eq_u32 vcc, -1, v9
    s_cbranch_vccnz prm_10_3
    s_branch prm_10_3ok
prm_10_3_g:
    s_mov_b32 s26, 0
    s_waitcnt vmcnt(0)
    s_branch prm_10_3ok
prm_10_d:
gate_14:
    v_readfirstlane_b32 s25, v15
    s_cmp_ge_u32 s25, s59
    s_cbranch_scc1 gate_14_ok
    s_sleep 8
    buffer_load_dword v15, off, s[4:7], s58 sc1
    s_waitcnt vmcnt(0)
    s_sub_u32 s26, s26, 1
    s_cbranch_scc0 gate_14
    s_mov_b32 s26, 0
gate_14_ok:
    ds_write_b32 v14, v60
    v_add_f32 v32, v32, v33
    v_add_f32 v34, v34, v35
    ds_write2_b32 v4, v32, v34 offset0:0 offset1:104
    v_add_f32 v36, v36, v37
    v_add_f32 v38, v38, v39
    ds_write2_b32 v4, v36, v38 offset0:16 offset1:120
    v_add_f32 v40, v40, v41
    v_add_f32 v42, v42, v43
    ds_write2_b32 v4, v40, v42 offset0:32 offset1:136
    v_add_f32 v44, v44, v45
    v_add_f32 v46, v46, v47
    ds_write2_b32 v4, v44, v46 offset0:48 offset1:152
    v_add_f32 v48, v48, v49
    v_add_f32 v50, v50, v51
    ds_write2_b32 v4, v48, v50 offset0:64 offset1:168
    v_add_f32 v52, v52, v53
    v_add_f32 v54, v54, v55
    ds_write2_b32 v4, v52, v54 offset0:80 offset1:184
    s_branch pnc_8_done
prp_11:
    s_sub_u32 s26, s26, 1
    s_nop 3
    s_cbranch_scc1 prp_11_g
    buffer_load_dwordx4 v[16:19], v12, s[4:7], s30 offen sc1
    buffer_load_dword v15, off, s[4:7], s58 sc1
    s_branch ploop_7_pagain
prp_11_g:
    s_mov_b32 s26, 0
    s_branch ploop_7_pgo
ploop_7_zr:
    s_sub_u32 s26, s26, 1
    s_cbranch_scc1 ploop_7_zg
    buffer_load_dwordx4 v[32:35], v1, s[4:7], s22 offen offset:0 sc1
    buffer_load_dwordx4 v[36:39], v1, s[4:7], s22 offen offset:1024 sc1
    buffer_load_dwordx4 v[40:43], v1, s[4:7], s22 offen offset:2048 sc1
    buffer_load_dwordx4 v[44:47], v1, s[4:7], s22 offen offset:3072 sc1
    s_branch ploop_7_za
ploop_7_zg:
    s_mov_b32 s26, 0
    s_branch ploop_7_zok
ptail_9:
    s_cmp_eq_u32 s15, 0
    s_cbranch_scc1 ptail_9_nd
    s_nop 0
ptail_9_nd:
    s_barrier
    v_add_u32 v55, s68, v61
    ds_read_b128 v[24:27], v55 offset:0
    ds_read_b128 v[28:31], v55 offset:1024
    ds_read_b128 v[32:35], v55 offset:18560
    ds_read_b128 v[36:39], v55 offset:19584
    ds_read_b128 v[40:43], v55 offset:37120
    ds_read_b128 v[44:47], v55 offset:38144
    ds_read_b128 v[48:51], v55 offset:55680
    ds_read_b128 v[52:55], v55 offset:56704
    s_waitcnt lgkmcnt(4)
    v_add_f32 v24, v24, v32
    v_add_f32 v25, v25, v33
    v_add_f32 v26, v26, v34
    v_add_f32 v27, v27, v35
    v_add_f32 v28, v28, v36
    v_add_f32 v29, v29, v37
    v_add_f32 v30, v30, v38
    v_add_f32 v31, v31, v39
    s_waitcnt lgkmcnt(0)
    v_add_f32 v40, v40, v48
    v_add_f32 v41, v41, v49
    v_add_f32 v42, v42, v50
    v_add_f32 v43, v43, v51
    v_add_f32 v44, v44, v52
    v_add_f32 v45, v45, v53
    v_add_f32 v46, v46, v54
    v_add_f32 v47, v47, v55
    v_add_f32 v24, v24, v40
    v_add_f32 v25, v25, v41
    v_add_f32 v26, v26, v42
    v_add_f32 v27, v27, v43
    v_add_f32 v28, v28, v44
    v_add_f32 v29, v29, v45
    v_add_f32 v30, v30, v46
    v_add_f32 v31, v31, v47
    v_cvt_pk_bf16_f32 v24, v24, v25
    v_cvt_pk_bf16_f32 v25, v26, v27
    v_cvt_pk_bf16_f32 v26, v28, v29
    v_cvt_pk_bf16_f32 v27, v30, v31
    v_min_u32 v24, -2, v24
    v_min_u32 v25, -2, v25
    v_min_u32 v26, -2, v26
    v_min_u32 v27, -2, v27
    buffer_store_dwordx4 v[24:27], v1, s[4:7], s37 offen sc1
    s_branch k_end
ch_p_slow:
    v_mov_b32 v32, 0
    v_mov_b32 v33, 0
    v_mov_b32 v34, 0
    v_mov_b32 v35, 0
    v_mov_b32 v36, 0
    v_mov_b32 v37, 0
    v_mov_b32 v38, 0
    v_mov_b32 v39, 0
    v_mov_b32 v40, 0
    v_mov_b32 v41, 0
    v_mov_b32 v42, 0
    v_mov_b32 v43, 0
    v_mov_b32 v44, 0
    v_mov_b32 v45, 0
    v_mov_b32 v46, 0
    v_mov_b32 v47, 0
    v_mov_b32 v48, 0
    v_mov_b32 v49, 0
    v_mov_b32 v50, 0
    v_mov_b32 v51, 0
    v_mov_b32 v52, 0
    v_mov_b32 v53, 0
    v_mov_b32 v54, 0
    v_mov_b32 v55, 0
    v_mov_b32 v0, 1.0
    s_mov_b32 exec_lo, 0xff00ff00
    s_mov_b32 exec_hi, 0xff00ff00
    v_mov_b32 v0, s47
    s_mov_b64 exec, -1
    v_mov_b32 v60, s16
    s_branch pnc_16
.p2align 6
ploop_15:
    s_add_u32 s21, s17, s33
    v_mov_b32 v32, 0
    v_mov_b32 v33, 0
    v_mov_b32 v34, 0
    v_mov_b32 v35, 0
    v_mov_b32 v36, 0
    v_mov_b32 v37, 0
    v_mov_b32 v38, 0
    v_mov_b32 v39, 0
    v_mov_b32 v40, 0
    v_mov_b32 v41, 0
    v_mov_b32 v42, 0
    v_mov_b32 v43, 0
    v_mov_b32 v44, 0
    v_mov_b32 v45, 0
    v_mov_b32 v46, 0
    v_mov_b32 v47, 0
    v_mov_b32 v48, 0
    v_mov_b32 v49, 0
    v_mov_b32 v50, 0
    v_mov_b32 v51, 0
    v_mov_b32 v52, 0
    v_mov_b32 v53, 0
    v_mov_b32 v54, 0
    v_mov_b32 v55, 0
    v_mov_b32 v0, 1.0
    s_mov_b32 exec_lo, 0xff00ff00
    s_mov_b32 exec_hi, 0xff00ff00
    v_mov_b32 v0, s47
    s_mov_b64 exec, -1
    s_nop 15
    s_nop 8
    buffer_load_dwordx4 v[16:19], v1, s[4:7], s21 offen offset:0 sc1
    s_nop 7
    buffer_load_dwordx4 v[20:23], v1, s[4:7], s21 offen offset:1024 sc1
    s_nop 7
    buffer_load_dwordx4 v[24:27], v1, s[4:7], s21 offen offset:2048 sc1
    s_nop 7
    buffer_load_dwordx4 v[28:31], v1, s[4:7], s21 offen offset:3072 sc1
    s_waitcnt vmcnt(3)
    v_max3_u32 v9, v16, v17, v18
    v_max_u32 v9, v9, v19
    v_cmp_eq_u32 vcc, -1, v9
    s_cbranch_vccnz prm_18_0
prm_18_0ok:
    v_smfmac_f32_16x16x64_bf16 v[32:35], v[16:19], v[64:71], v62
    v_smfmac_f32_16x16x64_bf16 v[36:39], v[16:19], v[72:79], v62
    v_smfmac_f32_16x16x64_bf16 v[40:43], v[16:19], v[80:87], v62
    s_waitcnt vmcnt(2)
    v_max3_u32 v9, v20, v21, v22
    v_max_u32 v9, v9, v23
    v_cmp_eq_u32 vcc, -1, v9
    v_smfmac_f32_16x16x64_bf16 v[44:47], v[16:19], v[88:95], v62
    v_smfmac_f32_16x16x64_bf16 v[48:51], v[16:19], v[96:103], v62
    v_smfmac_f32_16x16x64_bf16 v[52:55], v[16:19], v[104:111], v62
    s_cbranch_vccnz prm_18_1
prm_18_1ok:
    v_smfmac_f32_16x16x64_bf16 v[32:35], v[20:23], v[112:119], v62
    v_readfirstlane_b32 s23, v15
    v_smfmac_f32_16x16x64_bf16 v[36:39], v[20:23], v[120:127], v62
    v_smfmac_f32_16x16x64_bf16 v[40:43], v[20:23], v[128:135], v62
    s_waitcnt vmcnt(1)
    v_max3_u32 v9, v24, v25, v26
    v_max_u32 v9, v9, v27
    v_cmp_eq_u32 vcc, -1, v9
    v_smfmac_f32_16x16x64_bf16 v[44:47], v[20:23], v[136:143], v62
    v_smfmac_f32_16x16x64_bf16 v[48:51], v[20:23], v[144:151], v62
    v_smfmac_f32_16x16x64_bf16 v[52:55], v[20:23], v[152:159], v62
    s_cbranch_vccnz prm_18_2
prm_18_2ok:
    v_smfmac_f32_16x16x64_bf16 v[32:35], v[24:27], v[160:167], v62
    v_smfmac_f32_16x16x64_bf16 v[36:39], v[24:27], v[168:175], v62
    v_smfmac_f32_16x16x64_bf16 v[40:43], v[24:27], v[176:183], v62
    s_waitcnt vmcnt(0)
    v_max3_u32 v9, v28, v29, v30
    v_max_u32 v9, v9, v31
    v_cmp_eq_u32 vcc, -1, v9
    v_smfmac_f32_16x16x64_bf16 v[44:47], v[24:27], v[184:191], v62
    v_smfmac_f32_16x16x64_bf16 v[48:51], v[24:27], v[192:199], v62
    v_smfmac_f32_16x16x64_bf16 v[52:55], v[24:27], v[200:207], v62
    s_cbranch_vccnz prm_18_3
prm_18_3ok:
    v_smfmac_f32_16x16x64_bf16 v[32:35], v[28:31], v[208:215], v62
    s_cmp_lt_u32 s23, s59
    s_cbranch_scc1 prm_18_gt
prm_18_gtb:
    ds_write_b32 v14, v60
    v_smfmac_f32_16x16x64_bf16 v[36:39], v[28:31], v[216:223], v62
    v_smfmac_f32_16x16x64_bf16 v[40:43], v[28:31], v[224:231], v62
    v_smfmac_f32_16x16x64_bf16 v[44:47], v[28:31], v[232:239], v62
    v_add_f32 v32, v32, v33
    v_add_f32 v34, v34, v35
    v_smfmac_f32_16x16x64_bf16 v[48:51], v[28:31], v[240:247], v62
    v_add_f32 v36, v36, v37
    v_add_f32 v38, v38, v39
    ds_write2_b32 v4, v32, v34 offset0:0 offset1:104
    v_smfmac_f32_16x16x64_bf16 v[52:55], v[28:31], v[248:255], v62
    v_add_f32 v40, v40, v41
    v_add_f32 v42, v42, v43
    ds_write2_b32 v4, v36, v38 offset0:16 offset1:120
    v_add_f32 v44, v44, v45
    v_add_f32 v46, v46, v47
    ds_write2_b32 v4, v40, v42 offset0:32 offset1:136
    v_add_f32 v48, v48, v49
    v_add_f32 v50, v50, v51
    ds_write2_b32 v4, v44, v46 offset0:48 offset1:152
    v_add_f32 v52, v52, v53
    v_add_f32 v54, v54, v55
    ds_write2_b32 v4, v48, v50 offset0:64 offset1:168
    ds_write2_b32 v4, v52, v54 offset0:80 offset1:184
    s_branch pnc_16_done
pnc_16:
    v_smfmac_f32_16x16x64_bf16 v[32:35], v[16:19], v[64:71], v62
    v_smfmac_f32_16x16x64_bf16 v[36:39], v[16:19], v[72:79], v62
    v_smfmac_f32_16x16x64_bf16 v[40:43], v[16:19], v[80:87], v62
    v_smfmac_f32_16x16x64_bf16 v[44:47], v[16:19], v[88:95], v62
    v_smfmac_f32_16x16x64_bf16 v[48:51], v[16:19], v[96:103], v62
    v_smfmac_f32_16x16x64_bf16 v[52:55], v[16:19], v[104:111], v62
    v_smfmac_f32_16x16x64_bf16 v[32:35], v[20:23], v[112:119], v62
    v_smfmac_f32_16x16x64_bf16 v[36:39], v[20:23], v[120:127], v62
    v_smfmac_f32_16x16x64_bf16 v[40:43], v[20:23], v[128:135], v62
    v_smfmac_f32_16x16x64_bf16 v[44:47], v[20:23], v[136:143], v62
    v_smfmac_f32_16x16x64_bf16 v[48:51], v[20:23], v[144:151], v62
    v_smfmac_f32_16x16x64_bf16 v[52:55], v[20:23], v[152:159], v62
    v_smfmac_f32_16x16x64_bf16 v[32:35], v[24:27], v[160:167], v62
    v_smfmac_f32_16x16x64_bf16 v[36:39], v[24:27], v[168:175], v62
    v_smfmac_f32_16x16x64_bf16 v[40:43], v[24:27], v[176:183], v62
    v_smfmac_f32_16x16x64_bf16 v[44:47], v[24:27], v[184:191], v62
    v_smfmac_f32_16x16x64_bf16 v[48:51], v[24:27], v[192:199], v62
    v_smfmac_f32_16x16x64_bf16 v[52:55], v[24:27], v[200:207], v62
    v_smfmac_f32_16x16x64_bf16 v[32:35], v[28:31], v[208:215], v62
    ds_write_b32 v14, v60
    v_smfmac_f32_16x16x64_bf16 v[36:39], v[28:31], v[216:223], v62
    v_smfmac_f32_16x16x64_bf16 v[40:43], v[28:31], v[224:231], v62
    v_smfmac_f32_16x16x64_bf16 v[44:47], v[28:31], v[232:239], v62
    v_add_f32 v32, v32, v33
    v_add_f32 v34, v34, v35
    v_smfmac_f32_16x16x64_bf16 v[48:51], v[28:31], v[240:247], v62
    v_add_f32 v36, v36, v37
    v_add_f32 v38, v38, v39
    ds_write2_b32 v4, v32, v34 offset0:0 offset1:104
    v_smfmac_f32_16x16x64_bf16 v[52:55], v[28:31], v[248:255], v62
    v_add_f32 v40, v40, v41
    v_add_f32 v42, v42, v43
    ds_write2_b32 v4, v36, v38 offset0:16 offset1:120
    v_add_f32 v44, v44, v45
    v_add_f32 v46, v46, v47
    ds_write2_b32 v4, v40, v42 offset0:32 offset1:136
    v_add_f32 v48, v48, v49
    v_add_f32 v50, v50, v51
    ds_write2_b32 v4, v44, v46 offset0:48 offset1:152
    v_add_f32 v52, v52, v53
    v_add_f32 v54, v54, v55
    ds_write2_b32 v4, v48, v50 offset0:64 offset1:168
    ds_write2_b32 v4, v52, v54 offset0:80 offset1:184
    s_waitcnt vmcnt(0)
pnc_16_done:
    s_add_u32 s21, s17, s32
    s_add_u32 s22, s19, s32
    s_add_u32 s24, s19, s35
    s_waitcnt lgkmcnt(0)
    s_barrier
    ds_read_b64 v[32:33], v5 offset:0
    ds_read_b64 v[34:35], v5 offset:3328
    ds_read_b64 v[36:37], v5 offset:6656
    ds_read_b64 v[38:39], v5 offset:9984
    ds_read_b64 v[40:41], v6 offset:0
    ds_read_b64 v[42:43], v6 offset:3328
    ds_read_b64 v[44:45], v6 offset:6656
    ds_read_b64 v[46:47], v6 offset:9984
    s_waitcnt lgkmcnt(6)
    v_add_f32 v32, v32, v34
    v_add_f32 v33, v33, v35
    s_waitcnt lgkmcnt(4)
    v_add_f32 v36, v36, v38
    v_add_f32 v37, v37, v39
    v_add_f32 v32, v32, v36
    v_add_f32 v33, v33, v37
    v_mul_f32 v32, v32, v0
    v_mul_f32 v33, v33, v0
    v_cvt_pk_bf16_f32 v32, v32, v33
    v_min_u32 v32, -2, v32
    buffer_store_dword v32, v2, s[4:7], s21 offen sc1
    s_waitcnt lgkmcnt(2)
    v_add_f32 v40, v40, v42
    v_add_f32 v41, v41, v43
    s_waitcnt lgkmcnt(0)
    v_add_f32 v44, v44, v46
    v_add_f32 v45, v45, v47
    v_add_f32 v40, v40, v44
    v_add_f32 v41, v41, v45
    v_cvt_pk_bf16_f32 v40, v40, v41
    v_min_u32 v40, -2, v40
    s_mov_b32 exec_hi, 0
    buffer_store_dword v40, v3, s[4:7], s21 offen sc1
    s_setprio 0
    s_mov_b64 exec, -1
    s_add_u32 s21, s17, s35
    s_add_u32 s30, s17, s34
    s_add_u32 s23, s18, s36
    s_add_u32 s25, s16, 2
    s_min_u32 s25, s25, 63
    s_cmp_lt_u32 s25, 8
    s_cselect_b32 s59, 12, 24
    s_cselect_b32 s58, -4, -8
    s_and_b32 s25, s25, s58
    s_lshl_b32 s25, s25, 5
    s_add_u32 s58, s25, s60
    s_cmp_eq_u32 s15, 0
    s_cbranch_scc1 ploop_15_nd
    v_add_u32 v9, s53, v1
    v_add_u32 v0, 124928, v1
    ds_read_b128 v[16:19], v0 offset:0
    ds_read_b128 v[32:35], v9 offset:0
    ds_read_b128 v[20:23], v0 offset:1024
    ds_read_b128 v[36:39], v9 offset:1024
    ds_read_b128 v[24:27], v0 offset:2048
    ds_read_b128 v[40:43], v9 offset:2048
    ds_read_b128 v[28:31], v0 offset:3072
    ds_read_b128 v[44:47], v9 offset:3072
    s_add_u32 s22, s17, s61
    s_waitcnt lgkmcnt(6)
    v_mfma_f32_16x16x32_bf16 v[48:51], v[32:35], v[16:19], 0
    ds_read_b128 v[32:35], v9 offset:4096
    s_waitcnt lgkmcnt(5)
    v_mfma_f32_16x16x32_bf16 v[48:51], v[36:39], v[20:23], v[48:51]
    ds_read_b128 v[36:39], v9 offset:5120
    s_waitcnt lgkmcnt(4)
    v_mfma_f32_16x16x32_bf16 v[48:51], v[40:43], v[24:27], v[48:51]
    ds_read_b128 v[40:43], v9 offset:6144
    s_waitcnt lgkmcnt(3)
    v_mfma_f32_16x16x32_bf16 v[48:51], v[44:47], v[28:31], v[48:51]
    ds_read_b128 v[44:47], v9 offset:7168
    s_waitcnt lgkmcnt(3)
    v_mfma_f32_16x16x32_bf16 v[52:55], v[32:35], v[16:19], 0
    s_waitcnt lgkmcnt(2)
    v_mfma_f32_16x16x32_bf16 v[52:55], v[36:39], v[20:23], v[52:55]
    s_waitcnt lgkmcnt(1)
    v_mfma_f32_16x16x32_bf16 v[52:55], v[40:43], v[24:27], v[52:55]
    s_waitcnt lgkmcnt(0)
    v_mfma_f32_16x16x32_bf16 v[52:55], v[44:47], v[28:31], v[52:55]
    buffer_load_dwordx4 v[32:35], v1, s[4:7], s22 offen offset:0 sc1
    buffer_load_dwordx4 v[36:39], v1, s[4:7], s22 offen offset:1024 sc1
    buffer_load_dwordx4 v[40:43], v1, s[4:7], s22 offen offset:2048 sc1
    buffer_load_dwordx4 v[44:47], v1, s[4:7], s22 offen offset:3072 sc1
    v_mov_b32 v60, 0xff61b1e6
    s_nop 2
    v_cndmask_b32 v48, v48, v60, s[38:39]
    v_cndmask_b32 v49, v49, v60, s[40:41]
    v_cndmask_b32 v50, v50, v60, s[42:43]
    v_cndmask_b32 v51, v51, v60, s[44:45]
    v_cndmask_b32 v52, v52, v60, s[48:49]
    v_cndmask_b32 v53, v53, v60, s[50:51]
    v_cndmask_b32 v54, v54, v60, s[54:55]
    v_cndmask_b32 v55, v55, v60, s[56:57]
    v_max3_f32 v0, v48, v49, v50
    v_max3_f32 v9, v51, v52, v53
    v_max3_f32 v0, v0, v54, v55
    v_max_f32 v0, v0, v9
    v_mov_b32 v9, v0
    s_nop 1
    v_permlane16_swap_b32 v9, v0
    v_max_f32 v0, v0, v9
    v_mov_b32 v9, v0
    s_nop 1
    v_permlane32_swap_b32 v9, v0
    v_max_f32 v0, v0, v9
    v_mul_f32 v0, s47, v0
    v_fma_f32 v48, v48, s47, -v0
    v_fma_f32 v49, v49, s47, -v0
    v_fma_f32 v50, v50, s47, -v0
    v_fma_f32 v51, v51, s47, -v0
    v_fma_f32 v52, v52, s47, -v0
    v_fma_f32 v53, v53, s47, -v0
    v_fma_f32 v54, v54, s47, -v0
    v_fma_f32 v55, v55, s47, -v0
    v_exp_f32 v48, v48
    v_exp_f32 v49, v49
    v_exp_f32 v50, v50
    v_exp_f32 v51, v51
    v_exp_f32 v52, v52
    v_exp_f32 v53, v53
    v_exp_f32 v54, v54
    v_exp_f32 v55, v55
    v_add_f32 v15, v48, v49
    v_add_f32 v15, v15, v50
    v_add_f32 v15, v15, v51
    v_add_f32 v15, v15, v52
    v_add_f32 v15, v15, v53
    v_add_f32 v15, v15, v54
    v_add_f32 v15, v15, v55
ploop_15_za:
    s_waitcnt vmcnt(0)
    v_max3_u32 v9, v32, v33, v34
    v_max3_u32 v9, v9, v35, v36
    v_max3_u32 v9, v9, v37, v38
    v_max3_u32 v9, v9, v39, v40
    v_max3_u32 v9, v9, v41, v42
    v_max3_u32 v9, v9, v43, v44
    v_max3_u32 v9, v9, v45, v46
    v_max_u32 v9, v9, v47
    v_cmp_eq_u32 vcc, -1, v9
    s_cbranch_vccnz ploop_15_zr
ploop_15_zok:
    v_mfma_f32_16x16x32_bf16 v[56:59], v[32:35], v[16:19], 0
    v_mfma_f32_16x16x32_bf16 v[56:59], v[36:39], v[20:23], v[56:59]
    v_mfma_f32_16x16x32_bf16 v[56:59], v[40:43], v[24:27], v[56:59]
    v_mfma_f32_16x16x32_bf16 v[56:59], v[44:47], v[28:31], v[56:59]
    s_add_u32 s22, s17, s14
    s_nop 6
    v_max_f32 v60, v56, v57
    v_mov_b32 v9, v60
    s_nop 1
    v_permlane16_swap_b32 v9, v60
    v_max_f32 v60, v60, v9
    v_mov_b32 v9, v60
    s_nop 1
    v_permlane32_swap_b32 v9, v60
    v_max_f32 v60, v60, v9
    v_mul_f32 v60, s47, v60
    v_max_f32 v58, v60, v0
    v_sub_f32 v60, v0, v58
    v_fma_f32 v56, v56, s47, -v58
    v_fma_f32 v57, v57, s47, -v58
    v_exp_f32 v60, v60
    v_exp_f32 v56, v56
    v_exp_f32 v57, v57
    v_fma_f32 v15, v15, v60, v56
    v_add_f32 v15, v15, v57
    v_mov_b32 v9, v15
    s_nop 1
    v_permlane16_swap_b32 v9, v15
    v_add_f32 v15, v15, v9
    v_mov_b32 v9, v15
    s_nop 1
    v_permlane32_swap_b32 v9, v15
    v_add_f32 v15, v15, v9
    v_rcp_f32 v15, v15
    s_add_u32 s25, s19, s14
    v_mul_f32 v56, v56, v15
    v_mul_f32 v57, v57, v15
    v_mul_f32 v60, v60, v15
    v_mul_f32 v48, v48, v60
    v_mul_f32 v49, v49, v60
    v_mul_f32 v50, v50, v60
    v_mul_f32 v51, v51, v60
    v_mul_f32 v52, v52, v60
    v_mul_f32 v53, v53, v60
    v_mul_f32 v54, v54, v60
    v_mul_f32 v55, v55, v60
    v_cvt_pk_bf16_f32 v48, v48, v49
    v_cvt_pk_bf16_f32 v49, v50, v51
    v_cvt_pk_bf16_f32 v50, v52, v53
    v_cvt_pk_bf16_f32 v51, v54, v55
    v_min_u32 v48, -2, v48
    v_min_u32 v49, -2, v49
    v_min_u32 v50, -2, v50
    v_min_u32 v51, -2, v51
    v_lshlrev_b32 v54, 1, v8
    v_add_u32 v55, 14336, v1
    v_mov_b32 v53, 1.0
    v_cvt_pk_bf16_f32 v52, v56, v57
    v_min_u32 v53, -2, v53
    v_min_u32 v52, -2, v52
    buffer_store_dwordx4 v[48:51], v1, s[4:7], s22 offen sc1
    buffer_store_dwordx2 v[52:53], v54, s[4:7], s22 offen offset:1024 sc1
    ds_read_b128 v[56:59], v55
    s_branch ploop_15_nd2
ploop_15_nd:
    s_cmp_eq_u32 s16, 0
    s_cbranch_scc1 ploop_15_ns
    s_cmp_eq_u32 s31, 0
    s_cbranch_scc1 ploop_15_n2
    s_add_u32 s25, s68, s46
    v_add_u32 v55, s25, v61
    ds_read_b128 v[24:27], v55 offset:0
    ds_read_b128 v[28:31], v55 offset:1024
    ds_read_b128 v[32:35], v55 offset:18560
    ds_read_b128 v[36:39], v55 offset:19584
    ds_read_b128 v[40:43], v55 offset:37120
    ds_read_b128 v[44:47], v55 offset:38144
    ds_read_b128 v[48:51], v55 offset:55680
    ds_read_b128 v[52:55], v55 offset:56704
    s_waitcnt lgkmcnt(4)
    v_add_f32 v24, v24, v32
    v_add_f32 v25, v25, v33
    v_add_f32 v26, v26, v34
    v_add_f32 v27, v27, v35
    v_add_f32 v28, v28, v36
    v_add_f32 v29, v29, v37
    v_add_f32 v30, v30, v38
    v_add_f32 v31, v31, v39
    s_waitcnt lgkmcnt(0)
    v_add_f32 v40, v40, v48
    v_add_f32 v41, v41, v49
    v_add_f32 v42, v42, v50
    v_add_f32 v43, v43, v51
    v_add_f32 v44, v44, v52
    v_add_f32 v45, v45, v53
    v_add_f32 v46, v46, v54
    v_add_f32 v47, v47, v55
    v_add_f32 v24, v24, v40
    v_add_f32 v25, v25, v41
    v_add_f32 v26, v26, v42
    v_add_f32 v27, v27, v43
    v_add_f32 v28, v28, v44
    v_add_f32 v29, v29, v45
    v_add_f32 v30, v30, v46
    v_add_f32 v31, v31, v47
    v_cvt_pk_bf16_f32 v24, v24, v25
    v_cvt_pk_bf16_f32 v25, v26, v27
    v_cvt_pk_bf16_f32 v26, v28, v29
    v_cvt_pk_bf16_f32 v27, v30, v31
    v_min_u32 v24, -2, v24
    v_min_u32 v25, -2, v25
    v_min_u32 v26, -2, v26
    v_min_u32 v27, -2, v27
    v_mov_b32 v16, v24
    v_mov_b32 v17, v25
    v_mov_b32 v18, v26
    v_mov_b32 v19, v27
ploop_15_n2:
    v_add_u32 v55, s68, v61
    ds_read_b128 v[24:27], v55 offset:0
    ds_read_b128 v[28:31], v55 offset:1024
    ds_read_b128 v[32:35], v55 offset:18560
    ds_read_b128 v[36:39], v55 offset:19584
    ds_read_b128 v[40:43], v55 offset:37120
    ds_read_b128 v[44:47], v55 offset:38144
    ds_read_b128 v[48:51], v55 offset:55680
    ds_read_b128 v[52:55], v55 offset:56704
    s_waitcnt lgkmcnt(4)
    v_add_f32 v24, v24, v32
    v_add_f32 v25, v25, v33
    v_add_f32 v26, v26, v34
    v_add_f32 v27, v27, v35
    v_add_f32 v28, v28, v36
    v_add_f32 v29, v29, v37
    v_add_f32 v30, v30, v38
    v_add_f32 v31, v31, v39
    s_waitcnt lgkmcnt(0)
    v_add_f32 v40, v40, v48
    v_add_f32 v41, v41, v49
    v_add_f32 v42, v42, v50
    v_add_f32 v43, v43, v51
    v_add_f32 v44, v44, v52
    v_add_f32 v45, v45, v53
    v_add_f32 v46, v46, v54
    v_add_f32 v47, v47, v55
    v_add_f32 v24, v24, v40
    v_add_f32 v25, v25, v41
    v_add_f32 v26, v26, v42
    v_add_f32 v27, v27, v43
    v_add_f32 v28, v28, v44
    v_add_f32 v29, v29, v45
    v_add_f32 v30, v30, v46
    v_add_f32 v31, v31, v47
    v_cvt_pk_bf16_f32 v24, v24, v25
    v_cvt_pk_bf16_f32 v25, v26, v27
    v_cvt_pk_bf16_f32 v26, v28, v29
    v_cvt_pk_bf16_f32 v27, v30, v31
    v_min_u32 v24, -2, v24
    v_min_u32 v25, -2, v25
    v_min_u32 v26, -2, v26
    v_min_u32 v27, -2, v27
ploop_15_ns:
ploop_15_flag:
    ds_read_b32 v9, v14 offset:16
    s_waitcnt lgkmcnt(0)
    v_readfirstlane_b32 s25, v9
    s_cmp_eq_u32 s25, s16
    s_cbranch_scc0 ploop_15_flag
    s_add_u32 m0, s53, 0
    s_add_u32 s22, s52, 0
    buffer_load_dwordx4 v1, s[4:7], s22 offen offset:0 sc1 lds
    buffer_load_dwordx4 v1, s[4:7], s22 offen offset:1024 sc1 lds
    buffer_load_dwordx4 v1, s[4:7], s22 offen offset:2048 sc1 lds
    buffer_load_dwordx4 v1, s[4:7], s22 offen offset:3072 sc1 lds
    s_add_u32 m0, s53, 4096
    s_add_u32 s22, s52, 131072
    buffer_load_dwordx4 v1, s[4:7], s22 offen offset:0 sc1 lds
    buffer_load_dwordx4 v1, s[4:7], s22 offen offset:1024 sc1 lds
    buffer_load_dwordx4 v1, s[4:7], s22 offen offset:2048 sc1 lds
    buffer_load_dwordx4 v1, s[4:7], s22 offen offset:3072 sc1 lds
    s_add_u32 s52, s52, 262144
    s_cmp_eq_u32 s16, 0
    s_cbranch_scc1 ploop_15_nd2
    buffer_store_dwordx4 v[24:27], v1, s[4:7], s37 offen sc1
    s_cmp_eq_u32 s31, 0
    s_cbranch_scc1 ploop_15_nd2
    s_add_u32 s25, s37, s27
    buffer_store_dwordx4 v[16:19], v1, s[4:7], s25 offen sc1
ploop_15_nd2:
    s_cmp_eq_u32 s16, 0
    s_cbranch_scc1 ploop_15_nn
    s_add_u32 s37, s37, 65536
    s_xor_b32 s68, s68, 8192
ploop_15_nn:
    s_cmp_lg_u32 s3, 2
    s_cbranch_scc1 ppf_20
    s_lshl_b32 s22, s16, 18
    s_mov_b32 exec_hi, 0xffff
    buffer_load_dword v0, v63, s[4:7], s22 offen sc1
    buffer_load_dword v0, v63, s[4:7], s22 offen offset:64 sc1
    s_mov_b32 exec_hi, -1
ppf_20:
    v_add_u32 v24, 18560, v7
    v_add_u32 v25, 37120, v7
    v_add_u32 v26, 55680, v7
    s_cmp_eq_u32 s16, 63
    s_setprio 3
    s_barrier
    s_cbranch_scc1 ptail_17
    ds_read2_b32 v[16:17], v7 offset0:0 offset1:2
    ds_read2_b32 v[18:19], v24 offset0:0 offset1:2
    ds_read2_b32 v[20:21], v25 offset0:0 offset1:2
    ds_read2_b32 v[22:23], v26 offset0:0 offset1:2
    s_waitcnt lgkmcnt(2)
    v_add_f32 v16, v16, v18
    v_add_f32 v17, v17, v19
    s_waitcnt lgkmcnt(0)
    v_add_f32 v20, v20, v22
    v_add_f32 v21, v21, v23
    v_add_f32 v16, v16, v20
    v_add_f32 v17, v17, v21
    v_cvt_pk_bf16_f32 v16, v16, v17
    v_min_u32 v16, -2, v16
    buffer_store_dword v16, v2, s[4:7], s21 offen sc1
    buffer_store_dword v10, v2, s[4:7], s24 offen sc1
    s_cmp_eq_u32 s15, 0
    s_cbranch_scc1 ploop_15_pnd
    s_sleep 6
    s_nop 8
    buffer_load_dwordx4 v[16:19], v12, s[4:7], s30 offen sc1
    buffer_load_dword v15, off, s[4:7], s58 sc1
    s_add_u32 s25, s19, s14
    v_mov_b32 v20, -1
    v_mov_b32 v21, -1
    v_mov_b32 v22, -1
    v_mov_b32 v23, -1
    buffer_store_dwordx4 v[20:23], v1, s[4:7], s25 offen sc1
    buffer_store_dwordx2 v[20:21], v54, s[4:7], s25 offen offset:1024 sc1
    s_mov_b32 m0, 124928
    s_nop 0
    buffer_load_dwordx4 v1, s[4:7], s69 offen offset:0 sc1 lds
    buffer_load_dwordx4 v1, s[4:7], s69 offen offset:1024 sc1 lds
    buffer_load_dwordx4 v1, s[4:7], s69 offen offset:2048 sc1 lds
    buffer_load_dwordx4 v1, s[4:7], s69 offen offset:3072 sc1 lds
    s_add_u32 s69, s69, 262144
    s_add_u32 m0, s53, 0
    s_add_u32 s22, s52, 0
    buffer_load_dwordx4 v1, s[4:7], s22 offen offset:0 sc1 lds
    buffer_load_dwordx4 v1, s[4:7], s22 offen offset:1024 sc1 lds
    buffer_load_dwordx4 v1, s[4:7], s22 offen offset:2048 sc1 lds
    buffer_load_dwordx4 v1, s[4:7], s22 offen offset:3072 sc1 lds
    s_add_u32 m0, s53, 4096
    s_add_u32 s22, s52, 131072
    buffer_load_dwordx4 v1, s[4:7], s22 offen offset:0 sc1 lds
    buffer_load_dwordx4 v1, s[4:7], s22 offen offset:1024 sc1 lds
    buffer_load_dwordx4 v1, s[4:7], s22 offen offset:2048 sc1 lds
    buffer_load_dwordx4 v1, s[4:7], s22 offen offset:3072 sc1 lds
    s_add_u32 s52, s52, 262144
    s_add_u32 s22, s16, 1
    v_mov_b32 v60, s22
    s_waitcnt vmcnt(15) lgkmcnt(0)
    s_branch ploop_15_pchk
ploop_15_pnd:
    s_sleep 6
    s_nop 8
    buffer_load_dwordx4 v[16:19], v12, s[4:7], s30 offen sc1
    buffer_load_dword v15, off, s[4:7], s58 sc1
    s_add_u32 s22, s16, 1
    v_mov_b32 v60, s22
    s_waitcnt vmcnt(1) lgkmcnt(0)
    s_branch ploop_15_pchk
ploop_15_pagain:
    s_waitcnt vmcnt(1) lgkmcnt(0)
ploop_15_pchk:
    v_mfma_f32_16x16x32_bf16 v[20:23], v[56:59], v[16:19], 0
    v_max3_u32 v9, v16, v17, v18
    v_max_u32 v9, v9, v19
    v_cmp_eq_u32 vcc, -1, v9
    s_cbranch_vccnz prp_19
ploop_15_pgo:
    s_nop 3
    v_add_f32_dpp v20, v20, v20 row_ror:8 row_mask:0xf bank_mask:0xf
    v_add_f32_dpp v21, v21, v21 row_ror:8 row_mask:0xf bank_mask:0xf
    v_add_f32_dpp v22, v22, v22 row_ror:8 row_mask:0xf bank_mask:0xf
    v_add_f32_dpp v23, v23, v23 row_ror:8 row_mask:0xf bank_mask:0xf
    v_cvt_pk_bf16_f32 v20, v20, v21
    v_cvt_pk_bf16_f32 v21, v22, v23
    s_mov_b32 exec_hi, 0
    v_min_u32 v20, -2, v20
    v_min_u32 v21, -2, v21
    s_mov_b32 exec_lo, 0x00ff00ff
    buffer_store_dwordx2 v[20:21], v13, s[4:7], s23 offen sc1
    s_mov_b64 exec, -1
    s_add_u32 s22, s19, s32
    s_add_u32 s25, s20, s36
    buffer_store_dword v10, v2, s[4:7], s22 offen sc1
    s_mov_b32 exec_hi, 0
    buffer_store_dword v10, v3, s[4:7], s22 offen sc1
    s_mov_b32 exec_lo, 0x00ff00ff
    buffer_store_dwordx2 v[10:11], v13, s[4:7], s25 offen sc1
    s_mov_b64 exec, -1
    s_add_u32 s16, s16, 1
    s_mov_b32 s17, s18
    s_mov_b32 s18, s19
    s_mov_b32 s19, s20
    s_add_u32 s20, s20, 262144
    s_cmp_eq_u32 s20, 210763776
    s_cselect_b32 s20, 209715200, s20
    s_branch ploop_15
prm_18_gt:
gate_21:
    v_readfirstlane_b32 s25, v15
    s_cmp_ge_u32 s25, s59
    s_cbranch_scc1 gate_21_ok
    s_sleep 8
    buffer_load_dword v15, off, s[4:7], s58 sc1
    s_waitcnt vmcnt(0)
    s_sub_u32 s26, s26, 1
    s_cbranch_scc0 gate_21
    s_mov_b32 s26, 0
gate_21_ok:
    s_branch prm_18_gtb
prm_18_0:
    s_sub_u32 s26, s26, 1
    s_cbranch_scc1 prm_18_0_g
    buffer_load_dwordx4 v[16:19], v1, s[4:7], s21 offen offset:0 sc1
    buffer_load_dwordx4 v[20:23], v1, s[4:7], s21 offen offset:1024 sc1
    buffer_load_dwordx4 v[24:27], v1, s[4:7], s21 offen offset:2048 sc1
    buffer_load_dwordx4 v[28:31], v1, s[4:7], s21 offen offset:3072 sc1
    s_waitcnt vmcnt(3)
    v_max3_u32 v9, v16, v17, v18
    v_max_u32 v9, v9, v19
    v_cmp_eq_u32 vcc, -1, v9
    s_cbranch_vccnz prm_18_0
    s_branch prm_18_0ok
prm_18_0_g:
    s_mov_b32 s26, 0
    s_waitcnt vmcnt(0)
    s_branch prm_18_0ok
prm_18_1:
    s_sub_u32 s26, s26, 1
    s_cbranch_scc1 prm_18_1_g
    buffer_load_dwordx4 v[20:23], v1, s[4:7], s21 offen offset:1024 sc1
    buffer_load_dwordx4 v[24:27], v1, s[4:7], s21 offen offset:2048 sc1
    buffer_load_dwordx4 v[28:31], v1, s[4:7], s21 offen offset:3072 sc1
    s_waitcnt vmcnt(2)
    v_max3_u32 v9, v20, v21, v22
    v_max_u32 v9, v9, v23
    v_cmp_eq_u32 vcc, -1, v9
    s_cbranch_vccnz prm_18_1
    s_branch prm_18_1ok
prm_18_1_g:
    s_mov_b32 s26, 0
    s_waitcnt vmcnt(0)
    s_branch prm_18_1ok
prm_18_2:
    s_sub_u32 s26, s26, 1
    s_cbranch_scc1 prm_18_2_g
    buffer_load_dwordx4 v[24:27], v1, s[4:7], s21 offen offset:2048 sc1
    buffer_load_dwordx4 v[28:31], v1, s[4:7], s21 offen offset:3072 sc1
    s_waitcnt vmcnt(1)
    v_max3_u32 v9, v24, v25, v26
    v_max_u32 v9, v9, v27
    v_cmp_eq_u32 vcc, -1, v9
    s_cbranch_vccnz prm_18_2
    s_branch prm_18_2ok
prm_18_2_g:
    s_mov_b32 s26, 0
    s_waitcnt vmcnt(0)
    s_branch prm_18_2ok
prm_18_3:
    s_sub_u32 s26, s26, 1
    s_cbranch_scc1 prm_18_3_g
    buffer_load_dwordx4 v[28:31], v1, s[4:7], s21 offen offset:3072 sc1
    s_waitcnt vmcnt(0)
    v_max3_u32 v9, v28, v29, v30
    v_max_u32 v9, v9, v31
    v_cmp_eq_u32 vcc, -1, v9
    s_cbranch_vccnz prm_18_3
    s_branch prm_18_3ok
prm_18_3_g:
    s_mov_b32 s26, 0
    s_waitcnt vmcnt(0)
    s_branch prm_18_3ok
prm_18_d:
gate_22:
    v_readfirstlane_b32 s25, v15
    s_cmp_ge_u32 s25, s59
    s_cbranch_scc1 gate_22_ok
    s_sleep 8
    buffer_load_dword v15, off, s[4:7], s58 sc1
    s_waitcnt vmcnt(0)
    s_sub_u32 s26, s26, 1
    s_cbranch_scc0 gate_22
    s_mov_b32 s26, 0
gate_22_ok:
    ds_write_b32 v14, v60
    v_add_f32 v32, v32, v33
    v_add_f32 v34, v34, v35
    ds_write2_b32 v4, v32, v34 offset0:0 offset1:104
    v_add_f32 v36, v36, v37
    v_add_f32 v38, v38, v39
    ds_write2_b32 v4, v36, v38 offset0:16 offset1:120
    v_add_f32 v40, v40, v41
    v_add_f32 v42, v42, v43
    ds_write2_b32 v4, v40, v42 offset0:32 offset1:136
    v_add_f32 v44, v44, v45
    v_add_f32 v46, v46, v47
    ds_write2_b32 v4, v44, v46 offset0:48 offset1:152
    v_add_f32 v48, v48, v49
    v_add_f32 v50, v50, v51
    ds_write2_b32 v4, v48, v50 offset0:64 offset1:168
    v_add_f32 v52, v52, v53
    v_add_f32 v54, v54, v55
    ds_write2_b32 v4, v52, v54 offset0:80 offset1:184
    s_branch pnc_16_done
prp_19:
    s_sub_u32 s26, s26, 1
    s_nop 3
    s_cbranch_scc1 prp_19_g
    buffer_load_dwordx4 v[16:19], v12, s[4:7], s30 offen sc1
    buffer_load_dword v15, off, s[4:7], s58 sc1
    s_branch ploop_15_pagain
prp_19_g:
    s_mov_b32 s26, 0
    s_branch ploop_15_pgo
ploop_15_zr:
    s_sub_u32 s26, s26, 1
    s_cbranch_scc1 ploop_15_zg
    buffer_load_dwordx4 v[32:35], v1, s[4:7], s22 offen offset:0 sc1
    buffer_load_dwordx4 v[36:39], v1, s[4:7], s22 offen offset:1024 sc1
    buffer_load_dwordx4 v[40:43], v1, s[4:7], s22 offen offset:2048 sc1
    buffer_load_dwordx4 v[44:47], v1, s[4:7], s22 offen offset:3072 sc1
    s_branch ploop_15_za
ploop_15_zg:
    s_mov_b32 s26, 0
    s_branch ploop_15_zok
ptail_17:
    s_cmp_eq_u32 s15, 0
    s_cbranch_scc1 ptail_17_nd
    s_nop 0
ptail_17_nd:
    s_barrier
    v_add_u32 v55, s68, v61
    ds_read_b128 v[24:27], v55 offset:0
    ds_read_b128 v[28:31], v55 offset:1024
    ds_read_b128 v[32:35], v55 offset:18560
    ds_read_b128 v[36:39], v55 offset:19584
    ds_read_b128 v[40:43], v55 offset:37120
    ds_read_b128 v[44:47], v55 offset:38144
    ds_read_b128 v[48:51], v55 offset:55680
    ds_read_b128 v[52:55], v55 offset:56704
    s_waitcnt lgkmcnt(4)
    v_add_f32 v24, v24, v32
    v_add_f32 v25, v25, v33
    v_add_f32 v26, v26, v34
    v_add_f32 v27, v27, v35
    v_add_f32 v28, v28, v36
    v_add_f32 v29, v29, v37
    v_add_f32 v30, v30, v38
    v_add_f32 v31, v31, v39
    s_waitcnt lgkmcnt(0)
    v_add_f32 v40, v40, v48
    v_add_f32 v41, v41, v49
    v_add_f32 v42, v42, v50
    v_add_f32 v43, v43, v51
    v_add_f32 v44, v44, v52
    v_add_f32 v45, v45, v53
    v_add_f32 v46, v46, v54
    v_add_f32 v47, v47, v55
    v_add_f32 v24, v24, v40
    v_add_f32 v25, v25, v41
    v_add_f32 v26, v26, v42
    v_add_f32 v27, v27, v43
    v_add_f32 v28, v28, v44
    v_add_f32 v29, v29, v45
    v_add_f32 v30, v30, v46
    v_add_f32 v31, v31, v47
    v_cvt_pk_bf16_f32 v24, v24, v25
    v_cvt_pk_bf16_f32 v25, v26, v27
    v_cvt_pk_bf16_f32 v26, v28, v29
    v_cvt_pk_bf16_f32 v27, v30, v31
    v_min_u32 v24, -2, v24
    v_min_u32 v25, -2, v25
    v_min_u32 v26, -2, v26
    v_min_u32 v27, -2, v27
    buffer_store_dwordx4 v[24:27], v1, s[4:7], s37 offen sc1
    s_branch k_end
ch_a_pro:
    s_mul_i32 s21, s2, 24576
    s_add_u32 s21, s21, 209711104
    v_lshlrev_b32 v1, 4, v0
    v_mov_b32 v4, -1
    v_mov_b32 v5, -1
    v_mov_b32 v6, -1
    v_mov_b32 v7, -1
    buffer_store_dwordx4 v[4:7], v1, s[4:7], s21 offen sc1
    s_add_u32 s21, s21, 4096
    buffer_store_dwordx4 v[4:7], v1, s[4:7], s21 offen sc1
    s_add_u32 s21, s21, 4096
    buffer_store_dwordx4 v[4:7], v1, s[4:7], s21 offen sc1
    s_add_u32 s21, s21, 4096
    buffer_store_dwordx4 v[4:7], v1, s[4:7], s21 offen sc1
    s_add_u32 s21, s21, 4096
    buffer_store_dwordx4 v[4:7], v1, s[4:7], s21 offen sc1
    s_add_u32 s21, s21, 4096
    buffer_store_dwordx4 v[4:7], v1, s[4:7], s21 offen sc1
    s_add_u32 s21, s21, 4096
    v_mov_b32 v2, s29
    s_waitcnt vmcnt(0)
    s_barrier
    s_cmp_lg_u32 s3, 4
    s_cbranch_scc1 ch_nox
    s_mov_b64 exec, 1
    buffer_atomic_add v2, off, s[64:67], s28 sc1
    s_mov_b64 exec, -1
ch_nox:
    v_and_b32 v20, 63, v0
    v_lshlrev_b32 v0, 4, v20
    s_sub_u32 s25, s3, 4
    s_lshl_b32 s46, s12, 2
    s_add_u32 s46, s46, s25
    s_lshl_b32 s21, s46, 18
    s_lshl_b32 s22, s13, 7
    s_add_u32 s21, s21, s22
    s_lshl_b32 s46, s46, 12
    s_lshl_b32 s23, s25, 13
    s_add_u32 s23, s23, 131072
    s_load_dwordx2 s[8:9], s[0:1], 40
    s_mov_b32 s10, 8388608
    s_mov_b32 s11, 131072
    v_lshrrev_b32 v21, 3, v20
    v_and_b32 v22, 7, v20
    v_lshlrev_b32 v21, 11, v21
    v_lshl_add_u32 v21, v22, 4, v21
    v_lshrrev_b32 v28, 4, v20
    v_and_b32 v29, 1, v28
    v_xor_b32 v29, 0, v29
    v_lshlrev_b32 v29, 2, v29
    v_lshl_add_u32 v29, v28, 3, v29
    v_bfe_u32 v28, v20, 2, 2
    v_add_u32 v29, v29, v28
    v_lshlrev_b32 v29, 7, v29
    v_and_b32 v28, 3, v20
    v_lshl_add_u32 v29, v28, 4, v29
    v_and_b32 v28, 1, v28
    v_xor_b32 v28, 0, v28
    v_lshl_add_u32 v24, v28, 3, v29
    v_add_u32 v24, s23, v24
    v_lshrrev_b32 v28, 4, v20
    v_and_b32 v29, 1, v28
    v_xor_b32 v29, 1, v29
    v_lshlrev_b32 v29, 2, v29
    v_lshl_add_u32 v29, v28, 3, v29
    v_bfe_u32 v28, v20, 2, 2
    v_add_u32 v29, v29, v28
    v_lshlrev_b32 v29, 7, v29
    v_and_b32 v28, 3, v20
    v_lshl_add_u32 v29, v28, 4, v29
    v_and_b32 v28, 1, v28
    v_xor_b32 v28, 0, v28
    v_lshl_add_u32 v25, v28, 3, v29
    v_add_u32 v25, s23, v25
    v_lshrrev_b32 v28, 4, v20
    v_and_b32 v29, 1, v28
    v_xor_b32 v29, 0, v29
    v_lshlrev_b32 v29, 2, v29
    v_lshl_add_u32 v29, v28, 3, v29
    v_bfe_u32 v28, v20, 2, 2
    v_add_u32 v29, v29, v28
    v_lshlrev_b32 v29, 7, v29
    v_and_b32 v28, 3, v20
    v_lshl_add_u32 v29, v28, 4, v29
    v_and_b32 v28, 1, v28
    v_xor_b32 v28, 1, v28
    v_lshl_add_u32 v26, v28, 3, v29
    v_add_u32 v26, s23, v26
    v_lshrrev_b32 v28, 4, v20
    v_and_b32 v29, 1, v28
    v_xor_b32 v29, 1, v29
    v_lshlrev_b32 v29, 2, v29
    v_lshl_add_u32 v29, v28, 3, v29
    v_bfe_u32 v28, v20, 2, 2
    v_add_u32 v29, v29, v28
    v_lshlrev_b32 v29, 7, v29
    v_and_b32 v28, 3, v20
    v_lshl_add_u32 v29, v28, 4, v29
    v_and_b32 v28, 1, v28
    v_xor_b32 v28, 1, v28
    v_lshl_add_u32 v27, v28, 3, v29
    v_add_u32 v27, s23, v27
    s_waitcnt lgkmcnt(0)
    s_add_u32 m0, s23, 0
    s_nop 0
    buffer_load_dwordx4 v21, s[8:11], s21 offen lds
    s_add_u32 s21, s21, 16384
    s_add_u32 m0, s23, 1024
    s_nop 0
    buffer_load_dwordx4 v21, s[8:11], s21 offen lds
    s_add_u32 s21, s21, 16384
    s_add_u32 m0, s23, 2048
    s_nop 0
    buffer_load_dwordx4 v21, s[8:11], s21 offen lds
    s_add_u32 s21, s21, 16384
    s_add_u32 m0, s23, 3072
    s_nop 0
    buffer_load_dwordx4 v21, s[8:11], s21 offen lds
    s_add_u32 s21, s21, 16384
    s_add_u32 m0, s23, 4096
    s_nop 0
    buffer_load_dwordx4 v21, s[8:11], s21 offen lds
    s_add_u32 s21, s21, 16384
    s_add_u32 m0, s23, 5120
    s_nop 0
    buffer_load_dwordx4 v21, s[8:11], s21 offen lds
    s_add_u32 s21, s21, 16384
    s_add_u32 m0, s23, 6144
    s_nop 0
    buffer_load_dwordx4 v21, s[8:11], s21 offen lds
    s_add_u32 s21, s21, 16384
    s_add_u32 m0, s23, 7168
    s_nop 0
    buffer_load_dwordx4 v21, s[8:11], s21 offen lds
    s_add_u32 s21, s21, 16384
    buffer_load_dwordx4 v[98:101], v21, s[8:11], s21 offen
    s_add_u32 s21, s21, 16384
    buffer_load_dwordx4 v[102:105], v21, s[8:11], s21 offen
    s_add_u32 s21, s21, 16384
    buffer_load_dwordx4 v[106:109], v21, s[8:11], s21 offen
    s_add_u32 s21, s21, 16384
    buffer_load_dwordx4 v[110:113], v21, s[8:11], s21 offen
    s_add_u32 s21, s21, 16384
    buffer_load_dwordx4 v[114:117], v21, s[8:11], s21 offen
    s_add_u32 s21, s21, 16384
    buffer_load_dwordx4 v[118:121], v21, s[8:11], s21 offen
    s_add_u32 s21, s21, 16384
    buffer_load_dwordx4 v[122:125], v21, s[8:11], s21 offen
    s_add_u32 s21, s21, 16384
    buffer_load_dwordx4 v[126:129], v21, s[8:11], s21 offen
    s_add_u32 s21, s21, 16384
    v_add_u32 v30, s23, v0
    s_waitcnt vmcnt(8)
    ds_read_b64_tr_b16 v[192:193], v24 offset:0
    ds_read_b64_tr_b16 v[194:195], v25 offset:0
    ds_read_b64_tr_b16 v[200:201], v26 offset:0
    ds_read_b64_tr_b16 v[202:203], v27 offset:0
    ds_read_b64_tr_b16 v[208:209], v24 offset:64
    ds_read_b64_tr_b16 v[210:211], v25 offset:64
    ds_read_b64_tr_b16 v[216:217], v26 offset:64
    ds_read_b64_tr_b16 v[218:219], v27 offset:64
    s_waitcnt lgkmcnt(0)
    ds_read_b64_tr_b16 v[196:197], v24 offset:4096
    ds_read_b64_tr_b16 v[198:199], v25 offset:4096
    ds_read_b64_tr_b16 v[204:205], v26 offset:4096
    ds_read_b64_tr_b16 v[206:207], v27 offset:4096
    ds_read_b64_tr_b16 v[212:213], v24 offset:4160
    ds_read_b64_tr_b16 v[214:215], v25 offset:4160
    ds_read_b64_tr_b16 v[220:221], v26 offset:4160
    ds_read_b64_tr_b16 v[222:223], v27 offset:4160
    s_waitcnt lgkmcnt(0)
    s_waitcnt vmcnt(0)
    ds_write_b128 v30, v[98:101] offset:0
    ds_write_b128 v30, v[102:105] offset:1024
    ds_write_b128 v30, v[106:109] offset:2048
    ds_write_b128 v30, v[110:113] offset:3072
    ds_write_b128 v30, v[114:117] offset:4096
    ds_write_b128 v30, v[118:121] offset:5120
    ds_write_b128 v30, v[122:125] offset:6144
    ds_write_b128 v30, v[126:129] offset:7168
    s_waitcnt lgkmcnt(0)
    ds_read_b64_tr_b16 v[224:225], v24 offset:0
    ds_read_b64_tr_b16 v[226:227], v25 offset:0
    ds_read_b64_tr_b16 v[232:233], v26 offset:0
    ds_read_b64_tr_b16 v[234:235], v27 offset:0
    ds_read_b64_tr_b16 v[240:241], v24 offset:64
    ds_read_b64_tr_b16 v[242:243], v25 offset:64
    ds_read_b64_tr_b16 v[248:249], v26 offset:64
    ds_read_b64_tr_b16 v[250:251], v27 offset:64
    s_waitcnt lgkmcnt(0)
    ds_read_b64_tr_b16 v[228:229], v24 offset:4096
    ds_read_b64_tr_b16 v[230:231], v25 offset:4096
    ds_read_b64_tr_b16 v[236:237], v26 offset:4096
    ds_read_b64_tr_b16 v[238:239], v27 offset:4096
    ds_read_b64_tr_b16 v[244:245], v24 offset:4160
    ds_read_b64_tr_b16 v[246:247], v25 offset:4160
    ds_read_b64_tr_b16 v[252:253], v26 offset:4160
    ds_read_b64_tr_b16 v[254:255], v27 offset:4160
    s_waitcnt lgkmcnt(0)
    v_lshrrev_b32 v21, 4, v20
    s_mul_i32 s21, s25, 18560
    s_add_u32 s21, s21, 16384
    v_add_u32 v1, s21, v0
    v_and_b32 v23, 15, v20
    v_mul_u32_u24 v21, 136, v21
    v_lshl_add_u32 v21, v23, 3, v21
    v_add_u32 v45, s21, v21
    s_lshl_b32 s53, s25, 13
    s_add_u32 s53, s53, 92160
    v_add_u32 v49, s53, v0
    v_mov_b32 v48, 0
    v_mov_b32 v4, 0x3f803f80
    v_mov_b32 v5, 0x3f803f80
    v_mov_b32 v6, 0x3f803f80
    v_mov_b32 v7, 0x3f803f80
    v_mov_b32 v8, 0
    v_mov_b32 v9, 0
    v_mov_b32 v10, 0
    v_mov_b32 v11, 0
    v_lshlrev_b32 v43, 2, v20
    v_mov_b32 v26, 0x44444444
    v_mov_b32 v27, 0xeeeeeeee
    v_and_b32 v28, 1, v20
    v_cmp_eq_u32 vcc, 0, v28
    s_mov_b32 s47, 0x3e0293ee
    s_lshl_b32 s32, s12, 15
    v_cndmask_b32 v41, v27, v26, vcc
    s_lshl_b32 s21, s25, 13
    s_add_u32 s32, s32, s21
    s_add_u32 s32, s32, 2097152
    s_lshl_b32 s21, s25, 2
    s_add_u32 s21, s21, 13312
    v_mov_b32 v47, s21
    s_lshl_b32 s27, s13, 2
    s_add_u32 s27, s27, s25
    s_lshl_b32 s62, s12, 7
    s_add_u32 s62, s62, 218112000
    s_lshl_b32 s33, s12, 14
    s_lshl_b32 s21, s25, 12
    s_add_u32 s33, s33, s21
    s_add_u32 s33, s33, 1179648
    v_mov_b32 v139, 0
    v_mov_b32 v140, 0
    v_mov_b32 v141, 0
    v_mov_b32 v143, 0
    v_mov_b32 v144, 0
    v_mov_b32 v145, 0
    v_mov_b32 v40, 0
    v_mov_b32 v42, 0
    v_mov_b32 v44, 0
    v_mov_b32 v46, 0
    v_mov_b32 v158, 0x7f800000
    s_mov_b32 exec_lo, 0xcccccccc
    s_mov_b32 exec_hi, 0xcccccccc
    v_mov_b32 v158, 0x42700000
    s_mov_b64 exec, -1
    s_cmp_lg_u32 s3, 4
    s_cbranch_scc1 ch_xcc_skip
    v_add_u32 v56, 128, v43
    s_movk_i32 s21, 192
    v_writelane_b32 v56, s21, 4
    v_mov_b32 v59, 63
    v_writelane_b32 v59, -1, 4
    v_mov_b32 v60, 32
    s_mov_b64 exec, 0x1f
ch_xcc:
    buffer_load_dword v57, v56, s[64:67], 0 offen sc1
    s_waitcnt vmcnt(0)
    v_and_b32 v62, v59, v57
    v_cmp_ne_u32 vcc, v62, v60
    s_cbranch_vccz ch_xcc_ok
    s_sleep 16
    s_sub_u32 s26, s26, 1
    s_cbranch_scc0 ch_xcc
    s_mov_b32 s26, 0
ch_xcc_ok:
    s_lshr_b32 s22, s12, 1
    v_readlane_b32 s23, v57, 0
    s_nop 2
    v_readlane_b32 s21, v57, s22
    s_mov_b64 exec, -1
    v_mov_b32 v58, 131072
    v_mov_b32 v57, s21
    ds_write_b32 v58, v57
    s_bfe_u32 s23, s23, 0x1000f
    v_and_b32 v60, 0x70, v0
    v_lshlrev_b32 v60, 3, v60
    s_mov_b32 s22, 218112000
ch_pgv:
    buffer_load_dword v61, v60, s[4:7], s22 offen offset:8 sc1
    s_waitcnt vmcnt(0) lgkmcnt(0)
    v_and_b32 v62, 1, v61
    v_cmp_eq_u32 vcc, 0, v62
    s_cbranch_vccz ch_pgvok
    s_sleep 8
    s_sub_u32 s26, s26, 1
    s_cbranch_scc0 ch_pgv
    s_mov_b32 s26, 0
ch_pgvok:
    v_bfe_u32 v62, v61, 1, 1
    v_ashrrev_i32 v61, 8, v61
    v_sub_u32 v59, 0, v61
    v_cmp_eq_u32 vcc, s23, v62
    s_mov_b32 s21, 0
    s_nop 1
    v_cndmask_b32 v61, v59, v61, vcc
    s_nop 1
    v_readlane_b32 s22, v61, 0
    s_add_i32 s21, s21, s22
    v_readlane_b32 s22, v61, 1
    s_add_i32 s21, s21, s22
    v_readlane_b32 s22, v61, 2
    s_add_i32 s21, s21, s22
    v_readlane_b32 s22, v61, 3
    s_add_i32 s21, s21, s22
    v_readlane_b32 s22, v61, 4
    s_add_i32 s21, s21, s22
    v_readlane_b32 s22, v61, 5
    s_add_i32 s21, s21, s22
    v_readlane_b32 s22, v61, 6
    s_add_i32 s21, s21, s22
    v_readlane_b32 s22, v61, 7
    s_add_i32 s21, s21, s22
    s_cmp_gt_i32 s21, 0
    s_cselect_b32 s21, 0x2000, 0
    v_mov_b32 v59, s21
    ds_write_b32 v58, v59 offset:4
    s_waitcnt lgkmcnt(0)
ch_xcc_skip:
    s_barrier
    s_barrier
    s_lshl_b32 s60, s12, 4
    s_add_u32 s60, s60, 218104320
ch_g0:
    buffer_load_dword v57, off, s[4:7], s60 sc1
    s_waitcnt vmcnt(0)
    v_readfirstlane_b32 s21, v57
    s_cmp_ge_u32 s21, 12
    s_cbranch_scc1 ch_g0b
    s_sleep 8
    s_sub_u32 s26, s26, 1
    s_cbranch_scc0 ch_g0
    s_mov_b32 s26, 0
ch_g0b:
    s_add_u32 s21, s16, 0
    s_lshl_b32 s21, s21, 18
    s_add_u32 s21, s21, s46
    s_add_u32 s21, s21, 37748736
    s_add_u32 s22, s21, 131072
    buffer_load_dwordx4 v[160:163], v0, s[4:7], s21 offen offset:0 sc1
    buffer_load_dwordx4 v[164:167], v0, s[4:7], s21 offen offset:1024 sc1
    buffer_load_dwordx4 v[168:171], v0, s[4:7], s21 offen offset:2048 sc1
    buffer_load_dwordx4 v[172:175], v0, s[4:7], s21 offen offset:3072 sc1
    buffer_load_dwordx4 v[176:179], v0, s[4:7], s22 offen offset:0 sc1
    buffer_load_dwordx4 v[180:183], v0, s[4:7], s22 offen offset:1024 sc1
    buffer_load_dwordx4 v[184:187], v0, s[4:7], s22 offen offset:2048 sc1
    buffer_load_dwordx4 v[188:191], v0, s[4:7], s22 offen offset:3072 sc1
    s_waitcnt vmcnt(0)
    v_mfma_f32_16x16x32_bf16 v[50:53], v[160:163], v[192:195], 0
    v_mfma_f32_16x16x32_bf16 v[54:57], v[160:163], v[200:203], 0
    v_mfma_f32_16x16x32_bf16 v[58:61], v[160:163], v[208:211], 0
    v_mfma_f32_16x16x32_bf16 v[62:65], v[160:163], v[216:219], 0
    v_mfma_f32_16x16x32_bf16 v[66:69], v[176:179], v[192:195], 0
    v_mfma_f32_16x16x32_bf16 v[70:73], v[176:179], v[200:203], 0
    v_mfma_f32_16x16x32_bf16 v[74:77], v[176:179], v[208:211], 0
    v_mfma_f32_16x16x32_bf16 v[78:81], v[176:179], v[216:219], 0
    v_mfma_f32_16x16x32_bf16 v[50:53], v[164:167], v[196:199], v[50:53]
    v_mfma_f32_16x16x32_bf16 v[54:57], v[164:167], v[204:207], v[54:57]
    v_mfma_f32_16x16x32_bf16 v[58:61], v[164:167], v[212:215], v[58:61]
    v_mfma_f32_16x16x32_bf16 v[62:65], v[164:167], v[220:223], v[62:65]
    v_mfma_f32_16x16x32_bf16 v[66:69], v[180:183], v[196:199], v[66:69]
    v_mfma_f32_16x16x32_bf16 v[70:73], v[180:183], v[204:207], v[70:73]
    v_mfma_f32_16x16x32_bf16 v[74:77], v[180:183], v[212:215], v[74:77]
    v_mfma_f32_16x16x32_bf16 v[78:81], v[180:183], v[220:223], v[78:81]
    v_mfma_f32_16x16x32_bf16 v[50:53], v[168:171], v[224:227], v[50:53]
    v_mfma_f32_16x16x32_bf16 v[54:57], v[168:171], v[232:235], v[54:57]
    v_mfma_f32_16x16x32_bf16 v[58:61], v[168:171], v[240:243], v[58:61]
    v_mfma_f32_16x16x32_bf16 v[62:65], v[168:171], v[248:251], v[62:65]
    v_mfma_f32_16x16x32_bf16 v[66:69], v[184:187], v[224:227], v[66:69]
    v_mfma_f32_16x16x32_bf16 v[70:73], v[184:187], v[232:235], v[70:73]
    v_mfma_f32_16x16x32_bf16 v[74:77], v[184:187], v[240:243], v[74:77]
    v_mfma_f32_16x16x32_bf16 v[78:81], v[184:187], v[248:251], v[78:81]
    v_mfma_f32_16x16x32_bf16 v[50:53], v[172:175], v[228:231], v[50:53]
    v_mfma_f32_16x16x32_bf16 v[54:57], v[172:175], v[236:239], v[54:57]
    v_mfma_f32_16x16x32_bf16 v[58:61], v[172:175], v[244:247], v[58:61]
    v_mfma_f32_16x16x32_bf16 v[62:65], v[172:175], v[252:255], v[62:65]
    v_mfma_f32_16x16x32_bf16 v[66:69], v[188:191], v[228:231], v[66:69]
    v_mfma_f32_16x16x32_bf16 v[70:73], v[188:191], v[236:239], v[70:73]
    v_mfma_f32_16x16x32_bf16 v[74:77], v[188:191], v[244:247], v[74:77]
    v_mfma_f32_16x16x32_bf16 v[78:81], v[188:191], v[252:255], v[78:81]
    s_nop 7
    v_cvt_pk_bf16_f32 v82, v50, v51
    v_cvt_pk_bf16_f32 v83, v52, v53
    v_cvt_pk_bf16_f32 v84, v66, v67
    v_cvt_pk_bf16_f32 v85, v68, v69
    v_cvt_pk_bf16_f32 v86, v54, v55
    v_cvt_pk_bf16_f32 v87, v56, v57
    v_cvt_pk_bf16_f32 v88, v70, v71
    v_cvt_pk_bf16_f32 v89, v72, v73
    v_cvt_pk_bf16_f32 v90, v58, v59
    v_cvt_pk_bf16_f32 v91, v60, v61
    v_cvt_pk_bf16_f32 v92, v74, v75
    v_cvt_pk_bf16_f32 v93, v76, v77
    v_cvt_pk_bf16_f32 v94, v62, v63
    v_cvt_pk_bf16_f32 v95, v64, v65
    v_cvt_pk_bf16_f32 v96, v78, v79
    v_cvt_pk_bf16_f32 v97, v80, v81
.p2align 6
aloop_23:
    s_add_u32 s21, s17, s32
    s_add_u32 s22, s21, 4096
    v_mov_b32 v74, 0
    v_mov_b32 v75, 0
    v_mov_b32 v76, 0
    v_mov_b32 v77, 0
    v_mov_b32 v78, 0
    v_mov_b32 v79, 0
    v_mov_b32 v80, 0
    v_mov_b32 v81, 0
    v_mov_b32 v146, 0
    v_mov_b32 v147, 0
    v_mov_b32 v148, 0
    v_mov_b32 v149, 0
    v_mov_b32 v150, 0
    v_mov_b32 v151, 0
    v_mov_b32 v152, 0
    v_mov_b32 v153, 0
    s_add_u32 s30, s16, 1
    s_lshl_b32 s30, s30, 18
    s_add_u32 s30, s30, s46
    s_add_u32 s30, s30, 37748736
    s_add_u32 s31, s30, 131072
aloop_23_wm:
    ds_read_b32 v3, v47
    s_waitcnt lgkmcnt(0)
    v_readfirstlane_b32 s23, v3
    s_cmp_eq_u32 s23, s16
    s_cbranch_scc1 aloop_23_wmok
    s_sleep 1
    s_branch aloop_23_wm
aloop_23_wmok:
    buffer_load_dwordx4 v[160:163], v0, s[4:7], s30 offen offset:0 sc1
    buffer_load_dwordx4 v[164:167], v0, s[4:7], s30 offen offset:1024 sc1
    buffer_load_dwordx4 v[168:171], v0, s[4:7], s30 offen offset:2048 sc1
    buffer_load_dwordx4 v[172:175], v0, s[4:7], s30 offen offset:3072 sc1
    buffer_load_dwordx4 v[176:179], v0, s[4:7], s31 offen offset:0 sc1
    buffer_load_dwordx4 v[180:183], v0, s[4:7], s31 offen offset:1024 sc1
    buffer_load_dwordx4 v[184:187], v0, s[4:7], s31 offen offset:2048 sc1
    buffer_load_dwordx4 v[188:191], v0, s[4:7], s31 offen offset:3072 sc1
    s_setprio 2
    v_mov_b32 v2, s16
    s_barrier
    s_nop 15
    s_nop 13
    ds_read_b128 v[98:101], v49 offset:0
    ds_read_b128 v[102:105], v49 offset:1024
    ds_read_b128 v[106:109], v49 offset:2048
    ds_read_b128 v[110:113], v49 offset:3072
    ds_read_b128 v[114:117], v49 offset:4096
    ds_read_b128 v[118:121], v49 offset:5120
    ds_read_b128 v[122:125], v49 offset:6144
    ds_read_b128 v[126:129], v49 offset:7168
    v_mov_b32 v12, 0
    v_mov_b32 v13, 0
    v_mov_b32 v14, 0
    v_mov_b32 v15, 0
    v_mov_b32 v16, 0
    v_mov_b32 v17, 0
    v_mov_b32 v18, 0
    v_mov_b32 v19, 0
    v_mov_b32 v20, 0
    v_mov_b32 v21, 0
    v_mov_b32 v22, 0
    v_mov_b32 v23, 0
    s_sleep 3
    s_nop 6
    buffer_load_dwordx4 v[50:53], v0, s[4:7], s21 offen offset:0 sc1
    s_nop 7
    buffer_load_dwordx4 v[54:57], v0, s[4:7], s21 offen offset:1024 sc1
    s_nop 7
    buffer_load_dwordx4 v[58:61], v0, s[4:7], s21 offen offset:2048 sc1
    s_nop 7
    buffer_load_dwordx4 v[62:65], v0, s[4:7], s21 offen offset:3072 sc1
    s_nop 7
    buffer_load_dwordx4 v[66:69], v0, s[4:7], s22 offen offset:0 sc1
    s_nop 7
    buffer_load_dwordx4 v[70:73], v0, s[4:7], s22 offen offset:1024 sc1
    s_waitcnt lgkmcnt(0)
    s_waitcnt vmcnt(5)
    v_max3_u32 v3, v50, v51, v52
    v_max_u32 v3, v3, v53
    v_cmp_eq_u32 vcc, -1, v3
    s_cbranch_vccnz arq_24_0
arq_24_0ok:
    v_mfma_f32_16x16x32_bf16 v[12:15], v[98:101], v[50:53], v[12:15]
    v_mfma_f32_16x16x32_bf16 v[16:19], v[114:117], v[50:53], v[16:19]
    s_waitcnt vmcnt(4)
    v_max3_u32 v3, v54, v55, v56
    v_max_u32 v3, v3, v57
    v_cmp_eq_u32 vcc, -1, v3
    v_mfma_f32_16x16x32_bf16 v[20:23], v[50:53], v[50:53], v[20:23]
    s_cbranch_vccnz arq_24_1
arq_24_1ok:
    v_mfma_f32_16x16x32_bf16 v[12:15], v[102:105], v[54:57], v[12:15]
    v_mfma_f32_16x16x32_bf16 v[16:19], v[118:121], v[54:57], v[16:19]
    s_waitcnt vmcnt(3)
    v_max3_u32 v3, v58, v59, v60
    v_max_u32 v3, v3, v61
    v_cmp_eq_u32 vcc, -1, v3
    v_mfma_f32_16x16x32_bf16 v[20:23], v[54:57], v[54:57], v[20:23]
    s_cbranch_vccnz arq_24_2
arq_24_2ok:
    v_mfma_f32_16x16x32_bf16 v[12:15], v[106:109], v[58:61], v[12:15]
    v_mfma_f32_16x16x32_bf16 v[16:19], v[122:125], v[58:61], v[16:19]
    s_waitcnt vmcnt(2)
    v_max3_u32 v3, v62, v63, v64
    v_max_u32 v3, v3, v65
    v_cmp_eq_u32 vcc, -1, v3
    v_mfma_f32_16x16x32_bf16 v[20:23], v[58:61], v[58:61], v[20:23]
    s_cbranch_vccnz arq_24_3
arq_24_3ok:
    v_mfma_f32_16x16x32_bf16 v[12:15], v[110:113], v[62:65], v[12:15]
    v_mfma_f32_16x16x32_bf16 v[16:19], v[126:129], v[62:65], v[16:19]
    v_mfma_f32_16x16x32_bf16 v[20:23], v[62:65], v[62:65], v[20:23]
aloop_23_sdone:
    ds_write_b32 v47, v2 offset:16
    s_cmp_eq_u32 s16, 63
    s_cbranch_scc1 aloop_23_lsk
    s_nop 1
    v_exp_f32 v54, v12
    v_exp_f32 v55, v13
    s_waitcnt vmcnt(0)
    v_max3_u32 v24, v66, v67, v68
    v_max3_u32 v24, v24, v69, v70
    v_max3_u32 v24, v24, v71, v72
    v_max_u32 v24, v24, v73
    v_cmp_eq_u32 vcc, -1, v24
    s_cbranch_vccnz arq_24_v
    v_smfmac_f32_16x16x64_bf16 v[74:77], v[66:69], v[192:199], v41
    v_exp_f32 v56, v14
    v_smfmac_f32_16x16x64_bf16 v[78:81], v[66:69], v[200:207], v41
    v_exp_f32 v57, v15
    v_smfmac_f32_16x16x64_bf16 v[146:149], v[66:69], v[208:215], v41
    v_exp_f32 v58, v16
    v_smfmac_f32_16x16x64_bf16 v[150:153], v[66:69], v[216:223], v41
    v_exp_f32 v59, v17
    v_smfmac_f32_16x16x64_bf16 v[74:77], v[70:73], v[224:231], v41
    v_exp_f32 v60, v18
    v_smfmac_f32_16x16x64_bf16 v[78:81], v[70:73], v[232:239], v41
    v_exp_f32 v61, v19
    v_smfmac_f32_16x16x64_bf16 v[146:149], v[70:73], v[240:247], v41
    v_exp_f32 v62, v20
    v_smfmac_f32_16x16x64_bf16 v[150:153], v[70:73], v[248:255], v41
    v_exp_f32 v63, v21
    v_cvt_pk_bf16_f32 v154, v54, v55
    v_cvt_pk_bf16_f32 v155, v56, v57
    v_cvt_pk_bf16_f32 v156, v58, v59
    v_cvt_pk_bf16_f32 v157, v60, v61
    v_cvt_pk_bf16_f32 v8, v62, v63
    v_max3_f32 v2, |v12|, |v13|, |v14|
    v_mfma_f32_16x16x32_bf16 v[50:53], v[154:157], v[4:7], 0
    v_max3_f32 v3, |v15|, |v16|, |v17|
    v_add_f32 v74, v74, v75
    v_mfma_f32_16x16x32_bf16 v[50:53], v[8:11], v[4:7], v[50:53]
    v_add_f32 v76, v76, v77
    v_cvt_pk_bf16_f32 v40, v74, v76
    v_mfma_f32_16x16x32_bf16 v[24:27], v[154:157], v[82:85], 0
    v_add_f32 v78, v78, v79
    v_add_f32 v80, v80, v81
    v_mfma_f32_16x16x32_bf16 v[24:27], v[8:11], v[40:43], v[24:27]
    v_cvt_pk_bf16_f32 v42, v78, v80
    v_add_f32 v146, v146, v147
    v_mfma_f32_16x16x32_bf16 v[28:31], v[154:157], v[86:89], 0
    v_add_f32 v148, v148, v149
    v_cvt_pk_bf16_f32 v44, v146, v148
    v_mfma_f32_16x16x32_bf16 v[28:31], v[8:11], v[42:45], v[28:31]
    v_add_f32 v150, v150, v151
    v_add_f32 v152, v152, v153
    v_mfma_f32_16x16x32_bf16 v[32:35], v[154:157], v[90:93], 0
    v_cvt_pk_bf16_f32 v46, v150, v152
    v_rcp_f32 v52, v52
    v_mfma_f32_16x16x32_bf16 v[32:35], v[8:11], v[44:47], v[32:35]
    v_rcp_f32 v53, v53
    v_max3_f32 v2, v2, |v18|, |v19|
    v_mfma_f32_16x16x32_bf16 v[36:39], v[154:157], v[94:97], 0
    v_max3_f32 v3, v3, |v20|, |v21|
    v_max_f32 v2, v2, v3
    v_mfma_f32_16x16x32_bf16 v[36:39], v[8:11], v[46:49], v[36:39]
    v_cmp_nle_f32 vcc, v2, v158
    v_mul_f32 v26, v26, v52
    v_mul_f32 v27, v27, v53
    s_cbranch_vccnz aloop_23_tm
    v_mul_f32 v30, v30, v52
    v_mul_f32 v31, v31, v53
aloop_23_pvd:
    ds_write_b64 v45, v[26:27] offset:0
    v_mul_f32 v34, v34, v52
    v_mul_f32 v35, v35, v53
    ds_write_b64 v45, v[30:31] offset:544
    v_mul_f32 v38, v38, v52
    v_mul_f32 v39, v39, v53
    ds_write_b64 v45, v[34:35] offset:1088
    ds_write_b64 v45, v[38:39] offset:1632
aloop_23_lskb:
    s_waitcnt lgkmcnt(0)
    s_barrier
    s_setprio 0
    s_cmp_lg_u32 s27, 0
    s_cbranch_scc1 pg_25
    s_sub_u32 s25, s16, 1
    s_cbranch_scc1 pg_25
    v_mov_b32 v3, s25
    s_mov_b64 exec, 1
    buffer_store_dword v3, off, s[4:7], s62 sc1
    s_mov_b64 exec, -1
pg_25:
    s_add_u32 s21, s17, s33
    v_lshlrev_b32 v2, 1, v43
    s_cmp_eq_u32 s16, 63
    s_cbranch_scc1 aloop_23_nvw
    v_mfma_f32_16x16x32_bf16 v[50:53], v[160:163], v[192:195], 0
    v_mfma_f32_16x16x32_bf16 v[54:57], v[160:163], v[200:203], 0
    v_mfma_f32_16x16x32_bf16 v[58:61], v[160:163], v[208:211], 0
    v_mfma_f32_16x16x32_bf16 v[62:65], v[160:163], v[216:219], 0
    v_mfma_f32_16x16x32_bf16 v[66:69], v[176:179], v[192:195], 0
    v_mfma_f32_16x16x32_bf16 v[70:73], v[176:179], v[200:203], 0
    v_mfma_f32_16x16x32_bf16 v[74:77], v[176:179], v[208:211], 0
    v_mfma_f32_16x16x32_bf16 v[78:81], v[176:179], v[216:219], 0
    v_mfma_f32_16x16x32_bf16 v[50:53], v[164:167], v[196:199], v[50:53]
    v_mfma_f32_16x16x32_bf16 v[54:57], v[164:167], v[204:207], v[54:57]
    v_mfma_f32_16x16x32_bf16 v[58:61], v[164:167], v[212:215], v[58:61]
    v_mfma_f32_16x16x32_bf16 v[62:65], v[164:167], v[220:223], v[62:65]
    v_mfma_f32_16x16x32_bf16 v[66:69], v[180:183], v[196:199], v[66:69]
    v_mfma_f32_16x16x32_bf16 v[70:73], v[180:183], v[204:207], v[70:73]
    v_mfma_f32_16x16x32_bf16 v[74:77], v[180:183], v[212:215], v[74:77]
    v_mfma_f32_16x16x32_bf16 v[78:81], v[180:183], v[220:223], v[78:81]
    v_mfma_f32_16x16x32_bf16 v[50:53], v[168:171], v[224:227], v[50:53]
    v_mfma_f32_16x16x32_bf16 v[54:57], v[168:171], v[232:235], v[54:57]
    v_mfma_f32_16x16x32_bf16 v[58:61], v[168:171], v[240:243], v[58:61]
    v_mfma_f32_16x16x32_bf16 v[62:65], v[168:171], v[248:251], v[62:65]
    v_mfma_f32_16x16x32_bf16 v[66:69], v[184:187], v[224:227], v[66:69]
    v_mfma_f32_16x16x32_bf16 v[70:73], v[184:187], v[232:235], v[70:73]
    v_mfma_f32_16x16x32_bf16 v[74:77], v[184:187], v[240:243], v[74:77]
    v_mfma_f32_16x16x32_bf16 v[78:81], v[184:187], v[248:251], v[78:81]
    v_mfma_f32_16x16x32_bf16 v[50:53], v[172:175], v[228:231], v[50:53]
    v_mfma_f32_16x16x32_bf16 v[54:57], v[172:175], v[236:239], v[54:57]
    v_mfma_f32_16x16x32_bf16 v[58:61], v[172:175], v[244:247], v[58:61]
    v_mfma_f32_16x16x32_bf16 v[62:65], v[172:175], v[252:255], v[62:65]
    v_mfma_f32_16x16x32_bf16 v[66:69], v[188:191], v[228:231], v[66:69]
    v_mfma_f32_16x16x32_bf16 v[70:73], v[188:191], v[236:239], v[70:73]
    v_mfma_f32_16x16x32_bf16 v[74:77], v[188:191], v[244:247], v[74:77]
    v_mfma_f32_16x16x32_bf16 v[78:81], v[188:191], v[252:255], v[78:81]
    buffer_load_dwordx4 v[130:133], v0, s[4:7], s21 offen sc1
    buffer_load_dwordx2 v[146:147], v2, s[4:7], s21 offen offset:1024 sc1
    buffer_load_dwordx4 v[134:137], v0, s[4:7], s21 offen offset:2048 sc1
    buffer_load_dwordx2 v[148:149], v2, s[4:7], s21 offen offset:3072 sc1
    s_branch aloop_23_vwd
aloop_23_nvw:
    buffer_load_dwordx4 v[130:133], v0, s[4:7], s21 offen sc1
    buffer_load_dwordx2 v[146:147], v2, s[4:7], s21 offen offset:1024 sc1
    buffer_load_dwordx4 v[134:137], v0, s[4:7], s21 offen offset:2048 sc1
    buffer_load_dwordx2 v[148:149], v2, s[4:7], s21 offen offset:3072 sc1
aloop_23_vwd:
    v_add_u32 v48, s68, v1
    s_xor_b32 s68, s68, 8192
aloop_23_psa:
    s_waitcnt vmcnt(0)
    v_max3_u32 v3, v130, v131, v132
    v_max3_u32 v3, v3, v133, v134
    v_max3_u32 v3, v3, v135, v136
    v_max3_u32 v3, v3, v137, v146
    v_max3_u32 v3, v3, v147, v148
    v_max_u32 v3, v3, v149
    v_cmp_eq_u32 vcc, -1, v3
    s_cbranch_vccnz arq_24_ps
aloop_23_psok:
    v_mfma_f32_16x16x32_bf16 v[24:27], v[82:85], v[130:133], 0
    v_mfma_f32_16x16x32_bf16 v[28:31], v[86:89], v[130:133], 0
    v_mfma_f32_16x16x32_bf16 v[32:35], v[90:93], v[130:133], 0
    v_mfma_f32_16x16x32_bf16 v[36:39], v[94:97], v[130:133], 0
    v_mov_b32 v138, v146
    v_mfma_f32_16x16x32_bf16 v[12:15], v[82:85], v[134:137], 0
    v_mfma_f32_16x16x32_bf16 v[16:19], v[86:89], v[134:137], 0
    v_mfma_f32_16x16x32_bf16 v[20:23], v[90:93], v[134:137], 0
    v_mfma_f32_16x16x32_bf16 v[154:157], v[94:97], v[134:137], 0
    v_mov_b32 v142, v148
    v_mfma_f32_16x16x32_bf16 v[24:27], v[40:43], v[138:141], v[24:27]
    v_mfma_f32_16x16x32_bf16 v[28:31], v[42:45], v[138:141], v[28:31]
    v_mfma_f32_16x16x32_bf16 v[32:35], v[44:47], v[138:141], v[32:35]
    v_mfma_f32_16x16x32_bf16 v[36:39], v[46:49], v[138:141], v[36:39]
    v_mfma_f32_16x16x32_bf16 v[12:15], v[40:43], v[142:145], v[12:15]
    v_mfma_f32_16x16x32_bf16 v[16:19], v[42:45], v[142:145], v[16:19]
    v_mfma_f32_16x16x32_bf16 v[20:23], v[44:47], v[142:145], v[20:23]
    s_nop 1
    v_mfma_f32_16x16x32_bf16 v[154:157], v[46:49], v[142:145], v[154:157]
    ds_write_b128 v48, v[24:27] offset:2176
    v_cvt_pk_bf16_f32 v82, v50, v51
    v_cvt_pk_bf16_f32 v83, v52, v53
    ds_write_b128 v48, v[28:31] offset:3200
    v_cvt_pk_bf16_f32 v84, v66, v67
    v_cvt_pk_bf16_f32 v85, v68, v69
    ds_write_b128 v48, v[32:35] offset:4224
    v_cvt_pk_bf16_f32 v86, v54, v55
    v_cvt_pk_bf16_f32 v87, v56, v57
    ds_write_b128 v48, v[36:39] offset:5248
    v_cvt_pk_bf16_f32 v88, v70, v71
    v_cvt_pk_bf16_f32 v89, v72, v73
    ds_write_b128 v48, v[12:15] offset:6272
    v_cvt_pk_bf16_f32 v90, v58, v59
    v_cvt_pk_bf16_f32 v91, v60, v61
    ds_write_b128 v48, v[16:19] offset:7296
    v_cvt_pk_bf16_f32 v92, v74, v75
    v_cvt_pk_bf16_f32 v93, v76, v77
    ds_write_b128 v48, v[20:23] offset:8320
    v_cvt_pk_bf16_f32 v94, v62, v63
    v_cvt_pk_bf16_f32 v95, v64, v65
    ds_write_b128 v48, v[154:157] offset:9344
    v_cvt_pk_bf16_f32 v96, v78, v79
    v_cvt_pk_bf16_f32 v97, v80, v81
aloop_23_bgskip:
    s_waitcnt lgkmcnt(0)
    s_cmp_eq_u32 s16, 63
    s_cbranch_scc1 aloop_23_fin
    s_add_u32 s16, s16, 1
    s_mov_b32 s17, s18
    s_mov_b32 s18, s19
    s_mov_b32 s19, s20
    s_add_u32 s20, s20, 262144
    s_cmp_eq_u32 s20, 210763776
    s_cselect_b32 s20, 209715200, s20
    s_branch aloop_23
arq_24_0:
    s_sub_u32 s26, s26, 1
    s_cbranch_scc1 arq_24_0_g
    buffer_load_dwordx4 v[50:53], v0, s[4:7], s21 offen offset:0 sc1
    buffer_load_dwordx4 v[54:57], v0, s[4:7], s21 offen offset:1024 sc1
    buffer_load_dwordx4 v[58:61], v0, s[4:7], s21 offen offset:2048 sc1
    buffer_load_dwordx4 v[62:65], v0, s[4:7], s21 offen offset:3072 sc1
    buffer_load_dwordx4 v[66:69], v0, s[4:7], s22 offen offset:0 sc1
    buffer_load_dwordx4 v[70:73], v0, s[4:7], s22 offen offset:1024 sc1
    s_waitcnt vmcnt(5)
    v_max3_u32 v3, v50, v51, v52
    v_max_u32 v3, v3, v53
    v_cmp_eq_u32 vcc, -1, v3
    s_cbranch_vccnz arq_24_0
    s_branch arq_24_0ok
arq_24_0_g:
    s_mov_b32 s26, 0
    s_waitcnt vmcnt(0)
    s_branch arq_24_0ok
arq_24_1:
    s_sub_u32 s26, s26, 1
    s_cbranch_scc1 arq_24_1_g
    buffer_load_dwordx4 v[54:57], v0, s[4:7], s21 offen offset:1024 sc1
    buffer_load_dwordx4 v[58:61], v0, s[4:7], s21 offen offset:2048 sc1
    buffer_load_dwordx4 v[62:65], v0, s[4:7], s21 offen offset:3072 sc1
    buffer_load_dwordx4 v[66:69], v0, s[4:7], s22 offen offset:0 sc1
    buffer_load_dwordx4 v[70:73], v0, s[4:7], s22 offen offset:1024 sc1
    s_waitcnt vmcnt(4)
    v_max3_u32 v3, v54, v55, v56
    v_max_u32 v3, v3, v57
    v_cmp_eq_u32 vcc, -1, v3
    s_cbranch_vccnz arq_24_1
    s_branch arq_24_1ok
arq_24_1_g:
    s_mov_b32 s26, 0
    s_waitcnt vmcnt(0)
    s_branch arq_24_1ok
arq_24_2:
    s_sub_u32 s26, s26, 1
    s_cbranch_scc1 arq_24_2_g
    buffer_load_dwordx4 v[58:61], v0, s[4:7], s21 offen offset:2048 sc1
    buffer_load_dwordx4 v[62:65], v0, s[4:7], s21 offen offset:3072 sc1
    buffer_load_dwordx4 v[66:69], v0, s[4:7], s22 offen offset:0 sc1
    buffer_load_dwordx4 v[70:73], v0, s[4:7], s22 offen offset:1024 sc1
    s_waitcnt vmcnt(3)
    v_max3_u32 v3, v58, v59, v60
    v_max_u32 v3, v3, v61
    v_cmp_eq_u32 vcc, -1, v3
    s_cbranch_vccnz arq_24_2
    s_branch arq_24_2ok
arq_24_2_g:
    s_mov_b32 s26, 0
    s_waitcnt vmcnt(0)
    s_branch arq_24_2ok
arq_24_3:
    s_sub_u32 s26, s26, 1
    s_cbranch_scc1 arq_24_3_g
    buffer_load_dwordx4 v[62:65], v0, s[4:7], s21 offen offset:3072 sc1
    buffer_load_dwordx4 v[66:69], v0, s[4:7], s22 offen offset:0 sc1
    buffer_load_dwordx4 v[70:73], v0, s[4:7], s22 offen offset:1024 sc1
    s_waitcnt vmcnt(2)
    v_max3_u32 v3, v62, v63, v64
    v_max_u32 v3, v3, v65
    v_cmp_eq_u32 vcc, -1, v3
    s_cbranch_vccnz arq_24_3
    s_branch arq_24_3ok
arq_24_3_g:
    s_mov_b32 s26, 0
    s_waitcnt vmcnt(0)
    s_branch arq_24_3ok
arq_24_v:
    buffer_load_dwordx4 v[66:69], v0, s[4:7], s22 offen offset:0 sc1
    buffer_load_dwordx4 v[70:73], v0, s[4:7], s22 offen offset:1024 sc1
    v_max3_f32 v2, v12, v13, v14
    v_max3_f32 v3, v15, v16, v17
    v_max3_f32 v2, v2, v18, v19
    v_max3_f32 v3, v3, v20, v21
    v_max_f32 v2, v2, v3
    v_mov_b32 v3, v2
    s_nop 1
    v_permlane16_swap_b32 v3, v2
    v_max_f32 v2, v2, v3
    v_mov_b32 v3, v2
    s_nop 1
    v_permlane32_swap_b32 v3, v2
    v_max_f32 v2, v2, v3
    v_sub_f32 v12, v12, v2
    v_sub_f32 v13, v13, v2
    v_sub_f32 v14, v14, v2
    v_sub_f32 v15, v15, v2
    v_sub_f32 v16, v16, v2
    v_sub_f32 v17, v17, v2
    v_sub_f32 v18, v18, v2
    v_sub_f32 v19, v19, v2
    v_sub_f32 v20, v20, v2
    v_sub_f32 v21, v21, v2
    v_exp_f32 v54, v12
    v_exp_f32 v55, v13
    v_exp_f32 v56, v14
    v_exp_f32 v57, v15
    v_exp_f32 v58, v16
    v_exp_f32 v59, v17
    v_exp_f32 v60, v18
    v_exp_f32 v61, v19
    v_exp_f32 v62, v20
    v_exp_f32 v63, v21
    s_nop 0
    v_cvt_pk_bf16_f32 v154, v54, v55
    v_cvt_pk_bf16_f32 v155, v56, v57
    v_cvt_pk_bf16_f32 v156, v58, v59
    v_cvt_pk_bf16_f32 v157, v60, v61
    v_cvt_pk_bf16_f32 v8, v62, v63
    s_nop 0
    v_mfma_f32_16x16x32_bf16 v[50:53], v[154:157], v[4:7], 0
    v_mfma_f32_16x16x32_bf16 v[50:53], v[8:11], v[4:7], v[50:53]
    v_mfma_f32_16x16x32_bf16 v[24:27], v[154:157], v[82:85], 0
    v_mfma_f32_16x16x32_bf16 v[28:31], v[154:157], v[86:89], 0
    v_mfma_f32_16x16x32_bf16 v[32:35], v[154:157], v[90:93], 0
    v_mfma_f32_16x16x32_bf16 v[36:39], v[154:157], v[94:97], 0
arq_24_vs:
    s_waitcnt vmcnt(0)
    v_max3_u32 v3, v66, v67, v68
    v_max3_u32 v3, v3, v69, v70
    v_max3_u32 v3, v3, v71, v72
    v_max_u32 v3, v3, v73
    v_cmp_eq_u32 vcc, -1, v3
    s_cbranch_vccnz arq_24_vsr
    s_branch arq_24_vsok
arq_24_vsr:
    s_sub_u32 s26, s26, 1
    s_cbranch_scc1 arq_24_vsg
    buffer_load_dwordx4 v[66:69], v0, s[4:7], s22 offen offset:0 sc1
    buffer_load_dwordx4 v[70:73], v0, s[4:7], s22 offen offset:1024 sc1
    s_branch arq_24_vs
arq_24_vsg:
    s_mov_b32 s26, 0
arq_24_vsok:
    v_smfmac_f32_16x16x64_bf16 v[74:77], v[66:69], v[192:199], v41
    v_smfmac_f32_16x16x64_bf16 v[78:81], v[66:69], v[200:207], v41
    v_smfmac_f32_16x16x64_bf16 v[146:149], v[66:69], v[208:215], v41
    v_smfmac_f32_16x16x64_bf16 v[150:153], v[66:69], v[216:223], v41
    v_smfmac_f32_16x16x64_bf16 v[74:77], v[70:73], v[224:231], v41
    v_smfmac_f32_16x16x64_bf16 v[78:81], v[70:73], v[232:239], v41
    v_smfmac_f32_16x16x64_bf16 v[146:149], v[70:73], v[240:247], v41
    v_smfmac_f32_16x16x64_bf16 v[150:153], v[70:73], v[248:255], v41
    v_rcp_f32 v52, v52
    v_rcp_f32 v53, v53
    s_nop 2
    v_add_f32 v74, v74, v75
    v_add_f32 v76, v76, v77
    v_cvt_pk_bf16_f32 v40, v74, v76
    v_add_f32 v78, v78, v79
    v_add_f32 v80, v80, v81
    v_cvt_pk_bf16_f32 v42, v78, v80
    v_add_f32 v146, v146, v147
    v_add_f32 v148, v148, v149
    v_cvt_pk_bf16_f32 v44, v146, v148
    v_add_f32 v150, v150, v151
    v_add_f32 v152, v152, v153
    v_cvt_pk_bf16_f32 v46, v150, v152
    s_nop 1
    v_mfma_f32_16x16x32_bf16 v[24:27], v[8:11], v[40:43], v[24:27]
    v_mfma_f32_16x16x32_bf16 v[28:31], v[8:11], v[42:45], v[28:31]
    v_mfma_f32_16x16x32_bf16 v[32:35], v[8:11], v[44:47], v[32:35]
    v_mfma_f32_16x16x32_bf16 v[36:39], v[8:11], v[46:49], v[36:39]
    s_nop 4
    v_mul_f32 v26, v26, v52
    v_mul_f32 v27, v27, v53
    v_mul_f32 v30, v30, v52
    v_mul_f32 v31, v31, v53
    s_branch aloop_23_pvd
aloop_23_tm:
    s_nop 7
    v_max3_f32 v2, v12, v13, v14
    v_max3_f32 v3, v15, v16, v17
    v_max3_f32 v2, v2, v18, v19
    v_max3_f32 v3, v3, v20, v21
    v_max_f32 v2, v2, v3
    v_mov_b32 v3, v2
    s_nop 1
    v_permlane16_swap_b32 v3, v2
    v_max_f32 v2, v2, v3
    v_mov_b32 v3, v2
    s_nop 1
    v_permlane32_swap_b32 v3, v2
    v_max_f32 v2, v2, v3
    v_sub_f32 v12, v12, v2
    v_sub_f32 v13, v13, v2
    v_sub_f32 v14, v14, v2
    v_sub_f32 v15, v15, v2
    v_sub_f32 v16, v16, v2
    v_sub_f32 v17, v17, v2
    v_sub_f32 v18, v18, v2
    v_sub_f32 v19, v19, v2
    v_sub_f32 v20, v20, v2
    v_sub_f32 v21, v21, v2
    v_exp_f32 v54, v12
    v_exp_f32 v55, v13
    v_exp_f32 v56, v14
    v_exp_f32 v57, v15
    v_exp_f32 v58, v16
    v_exp_f32 v59, v17
    v_exp_f32 v60, v18
    v_exp_f32 v61, v19
    v_exp_f32 v62, v20
    v_exp_f32 v63, v21
    s_nop 0
    v_cvt_pk_bf16_f32 v154, v54, v55
    v_cvt_pk_bf16_f32 v155, v56, v57
    v_cvt_pk_bf16_f32 v156, v58, v59
    v_cvt_pk_bf16_f32 v157, v60, v61
    v_cvt_pk_bf16_f32 v8, v62, v63
    s_nop 0
    v_mfma_f32_16x16x32_bf16 v[50:53], v[154:157], v[4:7], 0
    v_mfma_f32_16x16x32_bf16 v[50:53], v[8:11], v[4:7], v[50:53]
    v_mfma_f32_16x16x32_bf16 v[24:27], v[154:157], v[82:85], 0
    v_mfma_f32_16x16x32_bf16 v[28:31], v[154:157], v[86:89], 0
    v_mfma_f32_16x16x32_bf16 v[32:35], v[154:157], v[90:93], 0
    v_mfma_f32_16x16x32_bf16 v[36:39], v[154:157], v[94:97], 0
    v_mfma_f32_16x16x32_bf16 v[24:27], v[8:11], v[40:43], v[24:27]
    v_mfma_f32_16x16x32_bf16 v[28:31], v[8:11], v[42:45], v[28:31]
    v_mfma_f32_16x16x32_bf16 v[32:35], v[8:11], v[44:47], v[32:35]
    v_mfma_f32_16x16x32_bf16 v[36:39], v[8:11], v[46:49], v[36:39]
    v_rcp_f32 v52, v52
    v_rcp_f32 v53, v53
    s_nop 4
    v_mul_f32 v26, v26, v52
    v_mul_f32 v27, v27, v53
    v_mul_f32 v30, v30, v52
    v_mul_f32 v31, v31, v53
    s_branch aloop_23_pvd
aloop_23_lsk:
arq_24_vl:
    s_waitcnt vmcnt(0)
    v_max3_u32 v3, v66, v67, v68
    v_max3_u32 v3, v3, v69, v70
    v_max3_u32 v3, v3, v71, v72
    v_max_u32 v3, v3, v73
    v_cmp_eq_u32 vcc, -1, v3
    s_cbranch_vccnz arq_24_vlr
    s_branch arq_24_vlok
arq_24_vlr:
    s_sub_u32 s26, s26, 1
    s_cbranch_scc1 arq_24_vlg
    buffer_load_dwordx4 v[66:69], v0, s[4:7], s22 offen offset:0 sc1
    buffer_load_dwordx4 v[70:73], v0, s[4:7], s22 offen offset:1024 sc1
    s_branch arq_24_vl
arq_24_vlg:
    s_mov_b32 s26, 0
arq_24_vlok:
    v_smfmac_f32_16x16x64_bf16 v[74:77], v[66:69], v[192:199], v41
    v_smfmac_f32_16x16x64_bf16 v[78:81], v[66:69], v[200:207], v41
    v_smfmac_f32_16x16x64_bf16 v[146:149], v[66:69], v[208:215], v41
    v_smfmac_f32_16x16x64_bf16 v[150:153], v[66:69], v[216:223], v41
    v_smfmac_f32_16x16x64_bf16 v[74:77], v[70:73], v[224:231], v41
    v_smfmac_f32_16x16x64_bf16 v[78:81], v[70:73], v[232:239], v41
    v_smfmac_f32_16x16x64_bf16 v[146:149], v[70:73], v[240:247], v41
    v_smfmac_f32_16x16x64_bf16 v[150:153], v[70:73], v[248:255], v41
    s_nop 4
    v_add_f32 v74, v74, v75
    v_add_f32 v76, v76, v77
    v_cvt_pk_bf16_f32 v40, v74, v76
    v_add_f32 v78, v78, v79
    v_add_f32 v80, v80, v81
    v_cvt_pk_bf16_f32 v42, v78, v80
    v_add_f32 v146, v146, v147
    v_add_f32 v148, v148, v149
    v_cvt_pk_bf16_f32 v44, v146, v148
    v_add_f32 v150, v150, v151
    v_add_f32 v152, v152, v153
    v_cvt_pk_bf16_f32 v46, v150, v152
    s_branch aloop_23_lskb
arq_24_ps:
    s_sub_u32 s26, s26, 1
    s_cbranch_scc1 arq_24_psg
    s_sleep 2
    buffer_load_dwordx4 v[130:133], v0, s[4:7], s21 offen sc1
    buffer_load_dwordx2 v[146:147], v2, s[4:7], s21 offen offset:1024 sc1
    buffer_load_dwordx4 v[134:137], v0, s[4:7], s21 offen offset:2048 sc1
    buffer_load_dwordx2 v[148:149], v2, s[4:7], s21 offen offset:3072 sc1
    s_branch aloop_23_psa
arq_24_psg:
    s_mov_b32 s26, 0
    s_branch aloop_23_psok
aloop_23_fin:
    s_barrier
    s_branch k_end
k_end:
k_exit:
    s_endpgm
.section .rodata,"a"
.p2align 6
jobtab:
    .long 6, 24, 24, 8192, 0, 262144, 8388608, 0, 32768, 4, 20971520, 131072, 0, 0, 218104320, 1
    .long 4, 24, 24, 8192, 0, 262144, 8388608, 262144, 32768, 4, 22020096, 131072, 0, 0, 218104448, 1
    .long 1, 32, 32, 8192, 0, 256, 8388608, 1048576, 32768, 8, 41943040, 131072, 0, 0, 218104832, 4
    .long 1, 16, 16, 8192, 0, 256, 8388608, 2097152, 32768, 8, 12582912, 131072, 0, 0, 218105344, 4
    .long 1, 32, 32, 8192, 0, 256, 8388608, 3145728, 32768, 8, 50331648, 131072, 0, 0, 218105856, 4
    .long 1, 32, 32, 8192, 0, 256, 8388608, 3670016, 32768, 8, 52428800, 131072, 0, 0, 218106112, 4
    .long 1, 80, 80, 2048, 0, 256, 7340032, 54525952, 114688, 7, 167772160, 32768, 218103808, 7, 218106368, 1
    .long 0, 0, 0, 0, 0, 0, 0, 0, 0, 0, 0, 0, 0, 0, 0, 0
    .long 0, 0, 0, 0, 0, 0, 0, 0, 0, 0, 0, 0, 0, 0, 0, 0
    .long 0, 0, 0, 0, 0, 0, 0, 0, 0, 0, 0, 0, 0, 0, 0, 0
    .long 6, 24, 24, 8192, 2048, 264192, 8388608, 0, 32768, 4, 21004288, 131072, 0, 0, 218104352, 1
    .long 4, 24, 24, 8192, 2048, 264192, 8388608, 262144, 32768, 4, 22052864, 131072, 0, 0, 218104480, 1
    .long 1, 32, 32, 8192, 2048, 2304, 8388608, 1048576, 32768, 8, 41975808, 131072, 0, 0, 218104864, 4
    .long 1, 16, 16, 8192, 2048, 2304, 8388608, 2097152, 32768, 8, 12615680, 131072, 0, 0, 218105376, 4
    .long 1, 32, 32, 8192, 2048, 2304, 8388608, 3145728, 32768, 8, 50364416, 131072, 0, 0, 218105888, 4
    .long 1, 32, 32, 8192, 2048, 2304, 8388608, 3670016, 32768, 8, 52461568, 131072, 0, 0, 218106144, 4
    .long 1, 80, 80, 2048, 512, 768, 7340032, 54525952, 114688, 7, 167780352, 32768, 218103808, 7, 218106368, 1
    .long 0, 0, 0, 0, 0, 0, 0, 0, 0, 0, 0, 0, 0, 0, 0, 0
    .long 0, 0, 0, 0, 0, 0, 0, 0, 0, 0, 0, 0, 0, 0, 0, 0
    .long 0, 0, 0, 0, 0, 0, 0, 0, 0, 0, 0, 0, 0, 0, 0, 0
    .long 6, 24, 24, 8192, 4096, 266240, 8388608, 0, 32768, 4, 21037056, 131072, 0, 0, 218104384, 1
    .long 4, 24, 24, 8192, 4096, 266240, 8388608, 262144, 32768, 4, 22085632, 131072, 0, 0, 218104512, 1
    .long 1, 32, 32, 8192, 4096, 4352, 8388608, 1048576, 32768, 8, 42008576, 131072, 0, 0, 218104896, 4
    .long 1, 16, 16, 8192, 4096, 4352, 8388608, 2097152, 32768, 8, 12648448, 131072, 0, 0, 218105408, 4
    .long 1, 32, 32, 8192, 4096, 4352, 8388608, 3145728, 32768, 8, 50397184, 131072, 0, 0, 218105920, 4
    .long 1, 32, 32, 8192, 4096, 4352, 8388608, 3670016, 32768, 8, 52494336, 131072, 0, 0, 218106176, 4
    .long 1, 80, 80, 2048, 1024, 1280, 7340032, 54525952, 114688, 7, 167788544, 32768, 218103808, 7, 218106368, 1
    .long 0, 0, 0, 0, 0, 0, 0, 0, 0, 0, 0, 0, 0, 0, 0, 0
    .long 0, 0, 0, 0, 0, 0, 0, 0, 0, 0, 0, 0, 0, 0, 0, 0
    .long 0, 0, 0, 0, 0, 0, 0, 0, 0, 0, 0, 0, 0, 0, 0, 0
    .long 6, 24, 24, 8192, 6144, 268288, 8388608, 0, 32768, 4, 21069824, 131072, 0, 0, 218104416, 1
    .long 4, 24, 24, 8192, 6144, 268288, 8388608, 262144, 32768, 4, 22118400, 131072, 0, 0, 218104544, 1
    .long 1, 32, 32, 8192, 6144, 6400, 8388608, 1048576, 32768, 8, 42041344, 131072, 0, 0, 218104928, 4
    .long 1, 16, 16, 8192, 6144, 6400, 8388608, 2097152, 32768, 8, 12681216, 131072, 0, 0, 218105440, 4
    .long 1, 32, 32, 8192, 6144, 6400, 8388608, 3145728, 32768, 8, 50429952, 131072, 0, 0, 218105952, 4
    .long 1, 32, 32, 8192, 6144, 6400, 8388608, 3670016, 32768, 8, 52527104, 131072, 0, 0, 218106208, 4
    .long 1, 80, 80, 2048, 1536, 1792, 7340032, 54525952, 114688, 7, 167796736, 32768, 218103808, 7, 218106368, 1
    .long 0, 0, 0, 0, 0, 0, 0, 0, 0, 0, 0, 0, 0, 0, 0, 0
    .long 0, 0, 0, 0, 0, 0, 0, 0, 0, 0, 0, 0, 0, 0, 0, 0
    .long 0, 0, 0, 0, 0, 0, 0, 0, 0, 0, 0, 0, 0, 0, 0, 0
    .long 6, 24, 24, 8192, 256, 262400, 8388608, 0, 32768, 4, 20975616, 131072, 0, 0, 218104320, 1
    .long 4, 24, 24, 8192, 256, 262400, 8388608, 262144, 32768, 4, 22024192, 131072, 0, 0, 218104448, 1
    .long 1, 32, 32, 8192, 512, 768, 8388608, 1048576, 32768, 8, 41951232, 131072, 0, 0, 218104832, 4
    .long 1, 16, 16, 8192, 512, 768, 8388608, 2097152, 32768, 8, 12591104, 131072, 0, 0, 218105344, 4
    .long 1, 32, 32, 8192, 512, 768, 8388608, 3145728, 32768, 8, 50339840, 131072, 0, 0, 218105856, 4
    .long 1, 32, 32, 8192, 512, 768, 8388608, 3670016, 32768, 8, 52436992, 131072, 0, 0, 218106112, 4
    .long 1, 80, 80, 2048, 1835008, 1835264, 7340032, 54554624, 114688, 7, 171966464, 32768, 218103824, 7, 218106368, 1
    .long 0, 0, 0, 0, 0, 0, 0, 0, 0, 0, 0, 0, 0, 0, 0, 0
    .long 0, 0, 0, 0, 0, 0, 0, 0, 0, 0, 0, 0, 0, 0, 0, 0
    .long 0, 0, 0, 0, 0, 0, 0, 0, 0, 0, 0, 0, 0, 0, 0, 0
    .long 6, 24, 24, 8192, 2304, 264448, 8388608, 0, 32768, 4, 21008384, 131072, 0, 0, 218104352, 1
    .long 4, 24, 24, 8192, 2304, 264448, 8388608, 262144, 32768, 4, 22056960, 131072, 0, 0, 218104480, 1
    .long 1, 32, 32, 8192, 2560, 2816, 8388608, 1048576, 32768, 8, 41984000, 131072, 0, 0, 218104864, 4
    .long 1, 16, 16, 8192, 2560, 2816, 8388608, 2097152, 32768, 8, 12623872, 131072, 0, 0, 218105376, 4
    .long 1, 32, 32, 8192, 2560, 2816, 8388608, 3145728, 32768, 8, 50372608, 131072, 0, 0, 218105888, 4
    .long 1, 32, 32, 8192, 2560, 2816, 8388608, 3670016, 32768, 8, 52469760, 131072, 0, 0, 218106144, 4
    .long 1, 80, 80, 2048, 1835520, 1835776, 7340032, 54554624, 114688, 7, 171974656, 32768, 218103824, 7, 218106368, 1
    .long 0, 0, 0, 0, 0, 0, 0, 0, 0, 0, 0, 0, 0, 0, 0, 0
    .long 0, 0, 0, 0, 0, 0, 0, 0, 0, 0, 0, 0, 0, 0, 0, 0
    .long 0, 0, 0, 0, 0, 0, 0, 0, 0, 0, 0, 0, 0, 0, 0, 0
    .long 6, 24, 24, 8192, 4352, 266496, 8388608, 0, 32768, 4, 21041152, 131072, 0, 0, 218104384, 1
    .long 4, 24, 24, 8192, 4352, 266496, 8388608, 262144, 32768, 4, 22089728, 131072, 0, 0, 218104512, 1
    .long 1, 32, 32, 8192, 4608, 4864, 8388608, 1048576, 32768, 8, 42016768, 131072, 0, 0, 218104896, 4
    .long 1, 16, 16, 8192, 4608, 4864, 8388608, 2097152, 32768, 8, 12656640, 131072, 0, 0, 218105408, 4
    .long 1, 32, 32, 8192, 4608, 4864, 8388608, 3145728, 32768, 8, 50405376, 131072, 0, 0, 218105920, 4
    .long 1, 32, 32, 8192, 4608, 4864, 8388608, 3670016, 32768, 8, 52502528, 131072, 0, 0, 218106176, 4
    .long 1, 80, 80, 2048, 1836032, 1836288, 7340032, 54554624, 114688, 7, 171982848, 32768, 218103824, 7, 218106368, 1
    .long 0, 0, 0, 0, 0, 0, 0, 0, 0, 0, 0, 0, 0, 0, 0, 0
    .long 0, 0, 0, 0, 0, 0, 0, 0, 0, 0, 0, 0, 0, 0, 0, 0
    .long 0, 0, 0, 0, 0, 0, 0, 0, 0, 0, 0, 0, 0, 0, 0, 0
    .long 6, 24, 24, 8192, 6400, 268544, 8388608, 0, 32768, 4, 21073920, 131072, 0, 0, 218104416, 1
    .long 4, 24, 24, 8192, 6400, 268544, 8388608, 262144, 32768, 4, 22122496, 131072, 0, 0, 218104544, 1
    .long 1, 32, 32, 8192, 6656, 6912, 8388608, 1048576, 32768, 8, 42049536, 131072, 0, 0, 218104928, 4
    .long 1, 16, 16, 8192, 6656, 6912, 8388608, 2097152, 32768, 8, 12689408, 131072, 0, 0, 218105440, 4
    .long 1, 32, 32, 8192, 6656, 6912, 8388608, 3145728, 32768, 8, 50438144, 131072, 0, 0, 218105952, 4
    .long 1, 32, 32, 8192, 6656, 6912, 8388608, 3670016, 32768, 8, 52535296, 131072, 0, 0, 218106208, 4
    .long 1, 80, 80, 2048, 1836544, 1836800, 7340032, 54554624, 114688, 7, 171991040, 32768, 218103824, 7, 218106368, 1
    .long 0, 0, 0, 0, 0, 0, 0, 0, 0, 0, 0, 0, 0, 0, 0, 0
    .long 0, 0, 0, 0, 0, 0, 0, 0, 0, 0, 0, 0, 0, 0, 0, 0
    .long 0, 0, 0, 0, 0, 0, 0, 0, 0, 0, 0, 0, 0, 0, 0, 0
    .long 6, 24, 24, 8192, 512, 262656, 8388608, 0, 32768, 4, 20979712, 131072, 0, 0, 218104320, 1
    .long 4, 24, 24, 8192, 512, 262656, 8388608, 262144, 32768, 4, 22028288, 131072, 0, 0, 218104448, 1
    .long 1, 32, 32, 8192, 1024, 1280, 8388608, 1048576, 32768, 8, 41959424, 131072, 0, 0, 218104848, 4
    .long 1, 16, 16, 8192, 1024, 1280, 8388608, 2097152, 32768, 8, 12599296, 131072, 0, 0, 218105360, 4
    .long 1, 32, 32, 8192, 1024, 1280, 8388608, 3145728, 32768, 8, 50348032, 131072, 0, 0, 218105872, 4
    .long 1, 32, 32, 8192, 1024, 1280, 8388608, 3670016, 32768, 8, 52445184, 131072, 0, 0, 218106128, 4
    .long 1, 80, 80, 2048, 3670016, 3670272, 7340032, 54583296, 114688, 7, 176160768, 32768, 218103840, 7, 218106368, 1
    .long 0, 0, 0, 0, 0, 0, 0, 0, 0, 0, 0, 0, 0, 0, 0, 0
    .long 0, 0, 0, 0, 0, 0, 0, 0, 0, 0, 0, 0, 0, 0, 0, 0
    .long 0, 0, 0, 0, 0, 0, 0, 0, 0, 0, 0, 0, 0, 0, 0, 0
    .long 6, 24, 24, 8192, 2560, 264704, 8388608, 0, 32768, 4, 21012480, 131072, 0, 0, 218104352, 1
    .long 4, 24, 24, 8192, 2560, 264704, 8388608, 262144, 32768, 4, 22061056, 131072, 0, 0, 218104480, 1
    .long 1, 32, 32, 8192, 3072, 3328, 8388608, 1048576, 32768, 8, 41992192, 131072, 0, 0, 218104880, 4
    .long 1, 16, 16, 8192, 3072, 3328, 8388608, 2097152, 32768, 8, 12632064, 131072, 0, 0, 218105392, 4
    .long 1, 32, 32, 8192, 3072, 3328, 8388608, 3145728, 32768, 8, 50380800, 131072, 0, 0, 218105904, 4
    .long 1, 32, 32, 8192, 3072, 3328, 8388608, 3670016, 32768, 8, 52477952, 131072, 0, 0, 218106160, 4
    .long 1, 80, 80, 2048, 3670528, 3670784, 7340032, 54583296, 114688, 7, 176168960, 32768, 218103840, 7, 218106368, 1
    .long 0, 0, 0, 0, 0, 0, 0, 0, 0, 0, 0, 0, 0, 0, 0, 0
    .long 0, 0, 0, 0, 0, 0, 0, 0, 0, 0, 0, 0, 0, 0, 0, 0
    .long 0, 0, 0, 0, 0, 0, 0, 0, 0, 0, 0, 0, 0, 0, 0, 0
    .long 6, 24, 24, 8192, 4608, 266752, 8388608, 0, 32768, 4, 21045248, 131072, 0, 0, 218104384, 1
    .long 4, 24, 24, 8192, 4608, 266752, 8388608, 262144, 32768, 4, 22093824, 131072, 0, 0, 218104512, 1
    .long 1, 32, 32, 8192, 5120, 5376, 8388608, 1048576, 32768, 8, 42024960, 131072, 0, 0, 218104912, 4
    .long 1, 16, 16, 8192, 5120, 5376, 8388608, 2097152, 32768, 8, 12664832, 131072, 0, 0, 218105424, 4
    .long 1, 32, 32, 8192, 5120, 5376, 8388608, 3145728, 32768, 8, 50413568, 131072, 0, 0, 218105936, 4
    .long 1, 32, 32, 8192, 5120, 5376, 8388608, 3670016, 32768, 8, 52510720, 131072, 0, 0, 218106192, 4
    .long 1, 80, 80, 2048, 3671040, 3671296, 7340032, 54583296, 114688, 7, 176177152, 32768, 218103840, 7, 218106368, 1
    .long 0, 0, 0, 0, 0, 0, 0, 0, 0, 0, 0, 0, 0, 0, 0, 0
    .long 0, 0, 0, 0, 0, 0, 0, 0, 0, 0, 0, 0, 0, 0, 0, 0
    .long 0, 0, 0, 0, 0, 0, 0, 0, 0, 0, 0, 0, 0, 0, 0, 0
    .long 6, 24, 24, 8192, 6656, 268800, 8388608, 0, 32768, 4, 21078016, 131072, 0, 0, 218104416, 1
    .long 4, 24, 24, 8192, 6656, 268800, 8388608, 262144, 32768, 4, 22126592, 131072, 0, 0, 218104544, 1
    .long 1, 32, 32, 8192, 7168, 7424, 8388608, 1048576, 32768, 8, 42057728, 131072, 0, 0, 218104944, 4
    .long 1, 16, 16, 8192, 7168, 7424, 8388608, 2097152, 32768, 8, 12697600, 131072, 0, 0, 218105456, 4
    .long 1, 32, 32, 8192, 7168, 7424, 8388608, 3145728, 32768, 8, 50446336, 131072, 0, 0, 218105968, 4
    .long 1, 32, 32, 8192, 7168, 7424, 8388608, 3670016, 32768, 8, 52543488, 131072, 0, 0, 218106224, 4
    .long 1, 80, 80, 2048, 3671552, 3671808, 7340032, 54583296, 114688, 7, 176185344, 32768, 218103840, 7, 218106368, 1
    .long 0, 0, 0, 0, 0, 0, 0, 0, 0, 0, 0, 0, 0, 0, 0, 0
    .long 0, 0, 0, 0, 0, 0, 0, 0, 0, 0, 0, 0, 0, 0, 0, 0
    .long 0, 0, 0, 0, 0, 0, 0, 0, 0, 0, 0, 0, 0, 0, 0, 0
    .long 6, 24, 24, 8192, 768, 262912, 8388608, 0, 32768, 4, 20983808, 131072, 0, 0, 218104320, 1
    .long 4, 24, 24, 8192, 768, 262912, 8388608, 262144, 32768, 4, 22032384, 131072, 0, 0, 218104448, 1
    .long 1, 32, 32, 8192, 1536, 1792, 8388608, 1048576, 32768, 8, 41967616, 131072, 0, 0, 218104848, 4
    .long 1, 16, 16, 8192, 1536, 1792, 8388608, 2097152, 32768, 8, 12607488, 131072, 0, 0, 218105360, 4
    .long 1, 32, 32, 8192, 1536, 1792, 8388608, 3145728, 32768, 8, 50356224, 131072, 0, 0, 218105872, 4
    .long 1, 32, 32, 8192, 1536, 1792, 8388608, 3670016, 32768, 8, 52453376, 131072, 0, 0, 218106128, 4
    .long 1, 80, 80, 2048, 5505024, 5505280, 7340032, 54611968, 114688, 7, 180355072, 32768, 218103856, 7, 218106368, 1
    .long 0, 0, 0, 0, 0, 0, 0, 0, 0, 0, 0, 0, 0, 0, 0, 0
    .long 0, 0, 0, 0, 0, 0, 0, 0, 0, 0, 0, 0, 0, 0, 0, 0
    .long 0, 0, 0, 0, 0, 0, 0, 0, 0, 0, 0, 0, 0, 0, 0, 0
    .long 6, 24, 24, 8192, 2816, 264960, 8388608, 0, 32768, 4, 21016576, 131072, 0, 0, 218104352, 1
    .long 4, 24, 24, 8192, 2816, 264960, 8388608, 262144, 32768, 4, 22065152, 131072, 0, 0, 218104480, 1
    .long 1, 32, 32, 8192, 3584, 3840, 8388608, 1048576, 32768, 8, 42000384, 131072, 0, 0, 218104880, 4
    .long 1, 16, 16, 8192, 3584, 3840, 8388608, 2097152, 32768, 8, 12640256, 131072, 0, 0, 218105392, 4
    .long 1, 32, 32, 8192, 3584, 3840, 8388608, 3145728, 32768, 8, 50388992, 131072, 0, 0, 218105904, 4
    .long 1, 32, 32, 8192, 3584, 3840, 8388608, 3670016, 32768, 8, 52486144, 131072, 0, 0, 218106160, 4
    .long 1, 80, 80, 2048, 5505536, 5505792, 7340032, 54611968, 114688, 7, 180363264, 32768, 218103856, 7, 218106368, 1
    .long 0, 0, 0, 0, 0, 0, 0, 0, 0, 0, 0, 0, 0, 0, 0, 0
    .long 0, 0, 0, 0, 0, 0, 0, 0, 0, 0, 0, 0, 0, 0, 0, 0
    .long 0, 0, 0, 0, 0, 0, 0, 0, 0, 0, 0, 0, 0, 0, 0, 0
    .long 6, 24, 24, 8192, 4864, 267008, 8388608, 0, 32768, 4, 21049344, 131072, 0, 0, 218104384, 1
    .long 4, 24, 24, 8192, 4864, 267008, 8388608, 262144, 32768, 4, 22097920, 131072, 0, 0, 218104512, 1
    .long 1, 32, 32, 8192, 5632, 5888, 8388608, 1048576, 32768, 8, 42033152, 131072, 0, 0, 218104912, 4
    .long 1, 16, 16, 8192, 5632, 5888, 8388608, 2097152, 32768, 8, 12673024, 131072, 0, 0, 218105424, 4
    .long 1, 32, 32, 8192, 5632, 5888, 8388608, 3145728, 32768, 8, 50421760, 131072, 0, 0, 218105936, 4
    .long 1, 32, 32, 8192, 5632, 5888, 8388608, 3670016, 32768, 8, 52518912, 131072, 0, 0, 218106192, 4
    .long 1, 80, 80, 2048, 5506048, 5506304, 7340032, 54611968, 114688, 7, 180371456, 32768, 218103856, 7, 218106368, 1
    .long 0, 0, 0, 0, 0, 0, 0, 0, 0, 0, 0, 0, 0, 0, 0, 0
    .long 0, 0, 0, 0, 0, 0, 0, 0, 0, 0, 0, 0, 0, 0, 0, 0
    .long 0, 0, 0, 0, 0, 0, 0, 0, 0, 0, 0, 0, 0, 0, 0, 0
    .long 6, 24, 24, 8192, 6912, 269056, 8388608, 0, 32768, 4, 21082112, 131072, 0, 0, 218104416, 1
    .long 4, 24, 24, 8192, 6912, 269056, 8388608, 262144, 32768, 4, 22130688, 131072, 0, 0, 218104544, 1
    .long 1, 32, 32, 8192, 7680, 7936, 8388608, 1048576, 32768, 8, 42065920, 131072, 0, 0, 218104944, 4
    .long 1, 16, 16, 8192, 7680, 7936, 8388608, 2097152, 32768, 8, 12705792, 131072, 0, 0, 218105456, 4
    .long 1, 32, 32, 8192, 7680, 7936, 8388608, 3145728, 32768, 8, 50454528, 131072, 0, 0, 218105968, 4
    .long 1, 32, 32, 8192, 7680, 7936, 8388608, 3670016, 32768, 8, 52551680, 131072, 0, 0, 218106224, 4
    .long 1, 80, 80, 2048, 5506560, 5506816, 7340032, 54611968, 114688, 7, 180379648, 32768, 218103856, 7, 218106368, 1
    .long 0, 0, 0, 0, 0, 0, 0, 0, 0, 0, 0, 0, 0, 0, 0, 0
    .long 0, 0, 0, 0, 0, 0, 0, 0, 0, 0, 0, 0, 0, 0, 0, 0
    .long 0, 0, 0, 0, 0, 0, 0, 0, 0, 0, 0, 0, 0, 0, 0, 0
    .long 6, 24, 24, 8192, 1024, 263168, 8388608, 0, 32768, 4, 20987904, 131072, 0, 0, 218104336, 1
    .long 4, 24, 24, 8192, 1024, 263168, 8388608, 262144, 32768, 4, 22036480, 131072, 0, 0, 218104464, 1
    .long 1, 24, 24, 8192, 0, 256, 8388608, 1048576, 32768, 8, 25165824, 131072, 0, 0, 218104832, 4
    .long 1, 32, 32, 8192, 0, 256, 8388608, 2621440, 32768, 8, 48234496, 131072, 0, 0, 218105600, 4
    .long 1, 24, 24, 8192, 0, 256, 8388608, 3145728, 32768, 8, 33554432, 131072, 0, 0, 218105856, 4
    .long 1, 24, 24, 8192, 0, 256, 8388608, 3670016, 32768, 8, 35651584, 131072, 0, 0, 218106112, 4
    .long 1, 80, 80, 2048, 0, 256, 7340032, 56360960, 114688, 7, 168296448, 32768, 218103872, 7, 218106432, 1
    .long 0, 0, 0, 0, 0, 0, 0, 0, 0, 0, 0, 0, 0, 0, 0, 0
    .long 0, 0, 0, 0, 0, 0, 0, 0, 0, 0, 0, 0, 0, 0, 0, 0
    .long 0, 0, 0, 0, 0, 0, 0, 0, 0, 0, 0, 0, 0, 0, 0, 0
    .long 6, 24, 24, 8192, 3072, 265216, 8388608, 0, 32768, 4, 21020672, 131072, 0, 0, 218104368, 1
    .long 4, 24, 24, 8192, 3072, 265216, 8388608, 262144, 32768, 4, 22069248, 131072, 0, 0, 218104496, 1
    .long 1, 24, 24, 8192, 2048, 2304, 8388608, 1048576, 32768, 8, 25198592, 131072, 0, 0, 218104864, 4
    .long 1, 32, 32, 8192, 2048, 2304, 8388608, 2621440, 32768, 8, 48267264, 131072, 0, 0, 218105632, 4
    .long 1, 24, 24, 8192, 2048, 2304, 8388608, 3145728, 32768, 8, 33587200, 131072, 0, 0, 218105888, 4
    .long 1, 24, 24, 8192, 2048, 2304, 8388608, 3670016, 32768, 8, 35684352, 131072, 0, 0, 218106144, 4
    .long 1, 80, 80, 2048, 512, 768, 7340032, 56360960, 114688, 7, 168304640, 32768, 218103872, 7, 218106432, 1
    .long 0, 0, 0, 0, 0, 0, 0, 0, 0, 0, 0, 0, 0, 0, 0, 0
    .long 0, 0, 0, 0, 0, 0, 0, 0, 0, 0, 0, 0, 0, 0, 0, 0
    .long 0, 0, 0, 0, 0, 0, 0, 0, 0, 0, 0, 0, 0, 0, 0, 0
    .long 6, 24, 24, 8192, 5120, 267264, 8388608, 0, 32768, 4, 21053440, 131072, 0, 0, 218104400, 1
    .long 4, 24, 24, 8192, 5120, 267264, 8388608, 262144, 32768, 4, 22102016, 131072, 0, 0, 218104528, 1
    .long 1, 24, 24, 8192, 4096, 4352, 8388608, 1048576, 32768, 8, 25231360, 131072, 0, 0, 218104896, 4
    .long 1, 32, 32, 8192, 4096, 4352, 8388608, 2621440, 32768, 8, 48300032, 131072, 0, 0, 218105664, 4
    .long 1, 24, 24, 8192, 4096, 4352, 8388608, 3145728, 32768, 8, 33619968, 131072, 0, 0, 218105920, 4
    .long 1, 24, 24, 8192, 4096, 4352, 8388608, 3670016, 32768, 8, 35717120, 131072, 0, 0, 218106176, 4
    .long 1, 80, 80, 2048, 1024, 1280, 7340032, 56360960, 114688, 7, 168312832, 32768, 218103872, 7, 218106432, 1
    .long 0, 0, 0, 0, 0, 0, 0, 0, 0, 0, 0, 0, 0, 0, 0, 0
    .long 0, 0, 0, 0, 0, 0, 0, 0, 0, 0, 0, 0, 0, 0, 0, 0
    .long 0, 0, 0, 0, 0, 0, 0, 0, 0, 0, 0, 0, 0, 0, 0, 0
    .long 6, 24, 24, 8192, 7168, 269312, 8388608, 0, 32768, 4, 21086208, 131072, 0, 0, 218104432, 1
    .long 4, 24, 24, 8192, 7168, 269312, 8388608, 262144, 32768, 4, 22134784, 131072, 0, 0, 218104560, 1
    .long 1, 24, 24, 8192, 6144, 6400, 8388608, 1048576, 32768, 8, 25264128, 131072, 0, 0, 218104928, 4
    .long 1, 32, 32, 8192, 6144, 6400, 8388608, 2621440, 32768, 8, 48332800, 131072, 0, 0, 218105696, 4
    .long 1, 24, 24, 8192, 6144, 6400, 8388608, 3145728, 32768, 8, 33652736, 131072, 0, 0, 218105952, 4
    .long 1, 24, 24, 8192, 6144, 6400, 8388608, 3670016, 32768, 8, 35749888, 131072, 0, 0, 218106208, 4
    .long 1, 80, 80, 2048, 1536, 1792, 7340032, 56360960, 114688, 7, 168321024, 32768, 218103872, 7, 218106432, 1
    .long 0, 0, 0, 0, 0, 0, 0, 0, 0, 0, 0, 0, 0, 0, 0, 0
    .long 0, 0, 0, 0, 0, 0, 0, 0, 0, 0, 0, 0, 0, 0, 0, 0
    .long 0, 0, 0, 0, 0, 0, 0, 0, 0, 0, 0, 0, 0, 0, 0, 0
    .long 6, 24, 24, 8192, 1280, 263424, 8388608, 0, 32768, 4, 20992000, 131072, 0, 0, 218104336, 1
    .long 4, 24, 24, 8192, 1280, 263424, 8388608, 262144, 32768, 4, 22040576, 131072, 0, 0, 218104464, 1
    .long 1, 24, 24, 8192, 512, 768, 8388608, 1048576, 32768, 8, 25174016, 131072, 0, 0, 218104832, 4
    .long 1, 32, 32, 8192, 512, 768, 8388608, 2621440, 32768, 8, 48242688, 131072, 0, 0, 218105600, 4
    .long 1, 24, 24, 8192, 512, 768, 8388608, 3145728, 32768, 8, 33562624, 131072, 0, 0, 218105856, 4
    .long 1, 24, 24, 8192, 512, 768, 8388608, 3670016, 32768, 8, 35659776, 131072, 0, 0, 218106112, 4
    .long 1, 80, 80, 2048, 1835008, 1835264, 7340032, 56389632, 114688, 7, 172490752, 32768, 218103888, 7, 218106432, 1
    .long 0, 0, 0, 0, 0, 0, 0, 0, 0, 0, 0, 0, 0, 0, 0, 0
    .long 0, 0, 0, 0, 0, 0, 0, 0, 0, 0, 0, 0, 0, 0, 0, 0
    .long 0, 0, 0, 0, 0, 0, 0, 0, 0, 0, 0, 0, 0, 0, 0, 0
    .long 6, 24, 24, 8192, 3328, 265472, 8388608, 0, 32768, 4, 21024768, 131072, 0, 0, 218104368, 1
    .long 4, 24, 24, 8192, 3328, 265472, 8388608, 262144, 32768, 4, 22073344, 131072, 0, 0, 218104496, 1
    .long 1, 24, 24, 8192, 2560, 2816, 8388608, 1048576, 32768, 8, 25206784, 131072, 0, 0, 218104864, 4
    .long 1, 32, 32, 8192, 2560, 2816, 8388608, 2621440, 32768, 8, 48275456, 131072, 0, 0, 218105632, 4
    .long 1, 24, 24, 8192, 2560, 2816, 8388608, 3145728, 32768, 8, 33595392, 131072, 0, 0, 218105888, 4
    .long 1, 24, 24, 8192, 2560, 2816, 8388608, 3670016, 32768, 8, 35692544, 131072, 0, 0, 218106144, 4
    .long 1, 80, 80, 2048, 1835520, 1835776, 7340032, 56389632, 114688, 7, 172498944, 32768, 218103888, 7, 218106432, 1
    .long 0, 0, 0, 0, 0, 0, 0, 0, 0, 0, 0, 0, 0, 0, 0, 0
    .long 0, 0, 0, 0, 0, 0, 0, 0, 0, 0, 0, 0, 0, 0, 0, 0
    .long 0, 0, 0, 0, 0, 0, 0, 0, 0, 0, 0, 0, 0, 0, 0, 0
    .long 6, 24, 24, 8192, 5376, 267520, 8388608, 0, 32768, 4, 21057536, 131072, 0, 0, 218104400, 1
    .long 4, 24, 24, 8192, 5376, 267520, 8388608, 262144, 32768, 4, 22106112, 131072, 0, 0, 218104528, 1
    .long 1, 24, 24, 8192, 4608, 4864, 8388608, 1048576, 32768, 8, 25239552, 131072, 0, 0, 218104896, 4
    .long 1, 32, 32, 8192, 4608, 4864, 8388608, 2621440, 32768, 8, 48308224, 131072, 0, 0, 218105664, 4
    .long 1, 24, 24, 8192, 4608, 4864, 8388608, 3145728, 32768, 8, 33628160, 131072, 0, 0, 218105920, 4
    .long 1, 24, 24, 8192, 4608, 4864, 8388608, 3670016, 32768, 8, 35725312, 131072, 0, 0, 218106176, 4
    .long 1, 80, 80, 2048, 1836032, 1836288, 7340032, 56389632, 114688, 7, 172507136, 32768, 218103888, 7, 218106432, 1
    .long 0, 0, 0, 0, 0, 0, 0, 0, 0, 0, 0, 0, 0, 0, 0, 0
    .long 0, 0, 0, 0, 0, 0, 0, 0, 0, 0, 0, 0, 0, 0, 0, 0
    .long 0, 0, 0, 0, 0, 0, 0, 0, 0, 0, 0, 0, 0, 0, 0, 0
    .long 6, 24, 24, 8192, 7424, 269568, 8388608, 0, 32768, 4, 21090304, 131072, 0, 0, 218104432, 1
    .long 4, 24, 24, 8192, 7424, 269568, 8388608, 262144, 32768, 4, 22138880, 131072, 0, 0, 218104560, 1
    .long 1, 24, 24, 8192, 6656, 6912, 8388608, 1048576, 32768, 8, 25272320, 131072, 0, 0, 218104928, 4
    .long 1, 32, 32, 8192, 6656, 6912, 8388608, 2621440, 32768, 8, 48340992, 131072, 0, 0, 218105696, 4
    .long 1, 24, 24, 8192, 6656, 6912, 8388608, 3145728, 32768, 8, 33660928, 131072, 0, 0, 218105952, 4
    .long 1, 24, 24, 8192, 6656, 6912, 8388608, 3670016, 32768, 8, 35758080, 131072, 0, 0, 218106208, 4
    .long 1, 80, 80, 2048, 1836544, 1836800, 7340032, 56389632, 114688, 7, 172515328, 32768, 218103888, 7, 218106432, 1
    .long 0, 0, 0, 0, 0, 0, 0, 0, 0, 0, 0, 0, 0, 0, 0, 0
    .long 0, 0, 0, 0, 0, 0, 0, 0, 0, 0, 0, 0, 0, 0, 0, 0
    .long 0, 0, 0, 0, 0, 0, 0, 0, 0, 0, 0, 0, 0, 0, 0, 0
    .long 6, 24, 24, 8192, 1536, 263680, 8388608, 0, 32768, 4, 20996096, 131072, 0, 0, 218104336, 1
    .long 4, 24, 24, 8192, 1536, 263680, 8388608, 262144, 32768, 4, 22044672, 131072, 0, 0, 218104464, 1
    .long 1, 24, 24, 8192, 1024, 1280, 8388608, 1048576, 32768, 8, 25182208, 131072, 0, 0, 218104848, 4
    .long 1, 32, 32, 8192, 1024, 1280, 8388608, 2621440, 32768, 8, 48250880, 131072, 0, 0, 218105616, 4
    .long 1, 24, 24, 8192, 1024, 1280, 8388608, 3145728, 32768, 8, 33570816, 131072, 0, 0, 218105872, 4
    .long 1, 24, 24, 8192, 1024, 1280, 8388608, 3670016, 32768, 8, 35667968, 131072, 0, 0, 218106128, 4
    .long 1, 80, 80, 2048, 3670016, 3670272, 7340032, 56418304, 114688, 7, 176685056, 32768, 218103904, 7, 218106432, 1
    .long 0, 0, 0, 0, 0, 0, 0, 0, 0, 0, 0, 0, 0, 0, 0, 0
    .long 0, 0, 0, 0, 0, 0, 0, 0, 0, 0, 0, 0, 0, 0, 0, 0
    .long 0, 0, 0, 0, 0, 0, 0, 0, 0, 0, 0, 0, 0, 0, 0, 0
    .long 6, 24, 24, 8192, 3584, 265728, 8388608, 0, 32768, 4, 21028864, 131072, 0, 0, 218104368, 1
    .long 4, 24, 24, 8192, 3584, 265728, 8388608, 262144, 32768, 4, 22077440, 131072, 0, 0, 218104496, 1
    .long 1, 24, 24, 8192, 3072, 3328, 8388608, 1048576, 32768, 8, 25214976, 131072, 0, 0, 218104880, 4
    .long 1, 32, 32, 8192, 3072, 3328, 8388608, 2621440, 32768, 8, 48283648, 131072, 0, 0, 218105648, 4
    .long 1, 24, 24, 8192, 3072, 3328, 8388608, 3145728, 32768, 8, 33603584, 131072, 0, 0, 218105904, 4
    .long 1, 24, 24, 8192, 3072, 3328, 8388608, 3670016, 32768, 8, 35700736, 131072, 0, 0, 218106160, 4
    .long 1, 80, 80, 2048, 3670528, 3670784, 7340032, 56418304, 114688, 7, 176693248, 32768, 218103904, 7, 218106432, 1
    .long 0, 0, 0, 0, 0, 0, 0, 0, 0, 0, 0, 0, 0, 0, 0, 0
    .long 0, 0, 0, 0, 0, 0, 0, 0, 0, 0, 0, 0, 0, 0, 0, 0
    .long 0, 0, 0, 0, 0, 0, 0, 0, 0, 0, 0, 0, 0, 0, 0, 0
    .long 6, 24, 24, 8192, 5632, 267776, 8388608, 0, 32768, 4, 21061632, 131072, 0, 0, 218104400, 1
    .long 4, 24, 24, 8192, 5632, 267776, 8388608, 262144, 32768, 4, 22110208, 131072, 0, 0, 218104528, 1
    .long 1, 24, 24, 8192, 5120, 5376, 8388608, 1048576, 32768, 8, 25247744, 131072, 0, 0, 218104912, 4
    .long 1, 32, 32, 8192, 5120, 5376, 8388608, 2621440, 32768, 8, 48316416, 131072, 0, 0, 218105680, 4
    .long 1, 24, 24, 8192, 5120, 5376, 8388608, 3145728, 32768, 8, 33636352, 131072, 0, 0, 218105936, 4
    .long 1, 24, 24, 8192, 5120, 5376, 8388608, 3670016, 32768, 8, 35733504, 131072, 0, 0, 218106192, 4
    .long 1, 80, 80, 2048, 3671040, 3671296, 7340032, 56418304, 114688, 7, 176701440, 32768, 218103904, 7, 218106432, 1
    .long 0, 0, 0, 0, 0, 0, 0, 0, 0, 0, 0, 0, 0, 0, 0, 0
    .long 0, 0, 0, 0, 0, 0, 0, 0, 0, 0, 0, 0, 0, 0, 0, 0
    .long 0, 0, 0, 0, 0, 0, 0, 0, 0, 0, 0, 0, 0, 0, 0, 0
    .long 6, 24, 24, 8192, 7680, 269824, 8388608, 0, 32768, 4, 21094400, 131072, 0, 0, 218104432, 1
    .long 4, 24, 24, 8192, 7680, 269824, 8388608, 262144, 32768, 4, 22142976, 131072, 0, 0, 218104560, 1
    .long 1, 24, 24, 8192, 7168, 7424, 8388608, 1048576, 32768, 8, 25280512, 131072, 0, 0, 218104944, 4
    .long 1, 32, 32, 8192, 7168, 7424, 8388608, 2621440, 32768, 8, 48349184, 131072, 0, 0, 218105712, 4
    .long 1, 24, 24, 8192, 7168, 7424, 8388608, 3145728, 32768, 8, 33669120, 131072, 0, 0, 218105968, 4
    .long 1, 24, 24, 8192, 7168, 7424, 8388608, 3670016, 32768, 8, 35766272, 131072, 0, 0, 218106224, 4
    .long 1, 80, 80, 2048, 3671552, 3671808, 7340032, 56418304, 114688, 7, 176709632, 32768, 218103904, 7, 218106432, 1
    .long 0, 0, 0, 0, 0, 0, 0, 0, 0, 0, 0, 0, 0, 0, 0, 0
    .long 0, 0, 0, 0, 0, 0, 0, 0, 0, 0, 0, 0, 0, 0, 0, 0
    .long 0, 0, 0, 0, 0, 0, 0, 0, 0, 0, 0, 0, 0, 0, 0, 0
    .long 6, 24, 24, 8192, 1792, 263936, 8388608, 0, 32768, 4, 21000192, 131072, 0, 0, 218104336, 1
    .long 4, 24, 24, 8192, 1792, 263936, 8388608, 262144, 32768, 4, 22048768, 131072, 0, 0, 218104464, 1
    .long 1, 24, 24, 8192, 1536, 1792, 8388608, 1048576, 32768, 8, 25190400, 131072, 0, 0, 218104848, 4
    .long 1, 32, 32, 8192, 1536, 1792, 8388608, 2621440, 32768, 8, 48259072, 131072, 0, 0, 218105616, 4
    .long 1, 24, 24, 8192, 1536, 1792, 8388608, 3145728, 32768, 8, 33579008, 131072, 0, 0, 218105872, 4
    .long 1, 24, 24, 8192, 1536, 1792, 8388608, 3670016, 32768, 8, 35676160, 131072, 0, 0, 218106128, 4
    .long 1, 80, 80, 2048, 5505024, 5505280, 7340032, 56446976, 114688, 7, 180879360, 32768, 218103920, 7, 218106432, 1
    .long 0, 0, 0, 0, 0, 0, 0, 0, 0, 0, 0, 0, 0, 0, 0, 0
    .long 0, 0, 0, 0, 0, 0, 0, 0, 0, 0, 0, 0, 0, 0, 0, 0
    .long 0, 0, 0, 0, 0, 0, 0, 0, 0, 0, 0, 0, 0, 0, 0, 0
    .long 6, 24, 24, 8192, 3840, 265984, 8388608, 0, 32768, 4, 21032960, 131072, 0, 0, 218104368, 1
    .long 4, 24, 24, 8192, 3840, 265984, 8388608, 262144, 32768, 4, 22081536, 131072, 0, 0, 218104496, 1
    .long 1, 24, 24, 8192, 3584, 3840, 8388608, 1048576, 32768, 8, 25223168, 131072, 0, 0, 218104880, 4
    .long 1, 32, 32, 8192, 3584, 3840, 8388608, 2621440, 32768, 8, 48291840, 131072, 0, 0, 218105648, 4
    .long 1, 24, 24, 8192, 3584, 3840, 8388608, 3145728, 32768, 8, 33611776, 131072, 0, 0, 218105904, 4
    .long 1, 24, 24, 8192, 3584, 3840, 8388608, 3670016, 32768, 8, 35708928, 131072, 0, 0, 218106160, 4
    .long 1, 80, 80, 2048, 5505536, 5505792, 7340032, 56446976, 114688, 7, 180887552, 32768, 218103920, 7, 218106432, 1
    .long 0, 0, 0, 0, 0, 0, 0, 0, 0, 0, 0, 0, 0, 0, 0, 0
    .long 0, 0, 0, 0, 0, 0, 0, 0, 0, 0, 0, 0, 0, 0, 0, 0
    .long 0, 0, 0, 0, 0, 0, 0, 0, 0, 0, 0, 0, 0, 0, 0, 0
    .long 6, 24, 24, 8192, 5888, 268032, 8388608, 0, 32768, 4, 21065728, 131072, 0, 0, 218104400, 1
    .long 4, 24, 24, 8192, 5888, 268032, 8388608, 262144, 32768, 4, 22114304, 131072, 0, 0, 218104528, 1
    .long 1, 24, 24, 8192, 5632, 5888, 8388608, 1048576, 32768, 8, 25255936, 131072, 0, 0, 218104912, 4
    .long 1, 32, 32, 8192, 5632, 5888, 8388608, 2621440, 32768, 8, 48324608, 131072, 0, 0, 218105680, 4
    .long 1, 24, 24, 8192, 5632, 5888, 8388608, 3145728, 32768, 8, 33644544, 131072, 0, 0, 218105936, 4
    .long 1, 24, 24, 8192, 5632, 5888, 8388608, 3670016, 32768, 8, 35741696, 131072, 0, 0, 218106192, 4
    .long 1, 80, 80, 2048, 5506048, 5506304, 7340032, 56446976, 114688, 7, 180895744, 32768, 218103920, 7, 218106432, 1
    .long 0, 0, 0, 0, 0, 0, 0, 0, 0, 0, 0, 0, 0, 0, 0, 0
    .long 0, 0, 0, 0, 0, 0, 0, 0, 0, 0, 0, 0, 0, 0, 0, 0
    .long 0, 0, 0, 0, 0, 0, 0, 0, 0, 0, 0, 0, 0, 0, 0, 0
    .long 6, 24, 24, 8192, 7936, 270080, 8388608, 0, 32768, 4, 21098496, 131072, 0, 0, 218104432, 1
    .long 4, 24, 24, 8192, 7936, 270080, 8388608, 262144, 32768, 4, 22147072, 131072, 0, 0, 218104560, 1
    .long 1, 24, 24, 8192, 7680, 7936, 8388608, 1048576, 32768, 8, 25288704, 131072, 0, 0, 218104944, 4
    .long 1, 32, 32, 8192, 7680, 7936, 8388608, 2621440, 32768, 8, 48357376, 131072, 0, 0, 218105712, 4
    .long 1, 24, 24, 8192, 7680, 7936, 8388608, 3145728, 32768, 8, 33677312, 131072, 0, 0, 218105968, 4
    .long 1, 24, 24, 8192, 7680, 7936, 8388608, 3670016, 32768, 8, 35774464, 131072, 0, 0, 218106224, 4
    .long 1, 80, 80, 2048, 5506560, 5506816, 7340032, 56446976, 114688, 7, 180903936, 32768, 218103920, 7, 218106432, 1
    .long 0, 0, 0, 0, 0, 0, 0, 0, 0, 0, 0, 0, 0, 0, 0, 0
    .long 0, 0, 0, 0, 0, 0, 0, 0, 0, 0, 0, 0, 0, 0, 0, 0
    .long 0, 0, 0, 0, 0, 0, 0, 0, 0, 0, 0, 0, 0, 0, 0, 0
    .long 6, 32, 32, 8192, 0, 262144, 8388608, 0, 32768, 4, 37748736, 131072, 0, 0, 218104320, 1
    .long 4, 32, 32, 8192, 0, 262144, 8388608, 262144, 32768, 4, 38797312, 131072, 0, 0, 218104448, 1
    .long 4, 16, 16, 8192, 1792, 263936, 8388608, 786432, 32768, 4, 7368704, 131072, 0, 0, 218104592, 1
    .long 1, 32, 32, 8192, 1024, 1280, 8388608, 1572864, 32768, 8, 44056576, 131072, 0, 0, 218105104, 4
    .long 1, 16, 16, 8192, 1024, 1280, 8388608, 2621440, 32768, 8, 14696448, 131072, 0, 0, 218105616, 4
    .long 2, 64, 72, 7168, 4096, 4096, 7340032, 1048576, 32768, 8, 58261504, 114688, 0, 0, 218103968, 1
    .long 2, 64, 72, 7168, 3072, 3072, 7340032, 2621440, 32768, 8, 63750144, 114688, 0, 0, 218104144, 1
    .long 1, 80, 80, 2048, 3670016, 3670272, 7340032, 60088320, 114688, 7, 177733632, 32768, 218104032, 7, 218106560, 1
    .long 0, 0, 0, 0, 0, 0, 0, 0, 0, 0, 0, 0, 0, 0, 0, 0
    .long 0, 0, 0, 0, 0, 0, 0, 0, 0, 0, 0, 0, 0, 0, 0, 0
    .long 6, 32, 32, 8192, 2048, 264192, 8388608, 0, 32768, 4, 37781504, 131072, 0, 0, 218104352, 1
    .long 4, 32, 32, 8192, 2048, 264192, 8388608, 262144, 32768, 4, 38830080, 131072, 0, 0, 218104480, 1
    .long 4, 16, 16, 8192, 3840, 265984, 8388608, 786432, 32768, 4, 7401472, 131072, 0, 0, 218104624, 1
    .long 1, 32, 32, 8192, 3072, 3328, 8388608, 1572864, 32768, 8, 44089344, 131072, 0, 0, 218105136, 4
    .long 1, 16, 16, 8192, 3072, 3328, 8388608, 2621440, 32768, 8, 14729216, 131072, 0, 0, 218105648, 4
    .long 2, 64, 72, 7168, 4352, 4352, 7340032, 1048576, 32768, 8, 58265600, 114688, 0, 0, 218103968, 1
    .long 2, 64, 72, 7168, 3328, 3328, 7340032, 2621440, 32768, 8, 63754240, 114688, 0, 0, 218104144, 1
    .long 1, 80, 80, 2048, 3670528, 3670784, 7340032, 60088320, 114688, 7, 177741824, 32768, 218104032, 7, 218106560, 1
    .long 0, 0, 0, 0, 0, 0, 0, 0, 0, 0, 0, 0, 0, 0, 0, 0
    .long 0, 0, 0, 0, 0, 0, 0, 0, 0, 0, 0, 0, 0, 0, 0, 0
    .long 6, 32, 32, 8192, 4096, 266240, 8388608, 0, 32768, 4, 37814272, 131072, 0, 0, 218104384, 1
    .long 4, 32, 32, 8192, 4096, 266240, 8388608, 262144, 32768, 4, 38862848, 131072, 0, 0, 218104512, 1
    .long 4, 16, 16, 8192, 5888, 268032, 8388608, 786432, 32768, 4, 7434240, 131072, 0, 0, 218104656, 1
    .long 1, 32, 32, 8192, 5120, 5376, 8388608, 1572864, 32768, 8, 44122112, 131072, 0, 0, 218105168, 4
    .long 1, 16, 16, 8192, 5120, 5376, 8388608, 2621440, 32768, 8, 14761984, 131072, 0, 0, 218105680, 4
    .long 2, 64, 72, 7168, 4608, 4608, 7340032, 1048576, 32768, 8, 58269696, 114688, 0, 0, 218103968, 1
    .long 2, 64, 72, 7168, 3584, 3584, 7340032, 2621440, 32768, 8, 63758336, 114688, 0, 0, 218104160, 1
    .long 1, 80, 80, 2048, 3671040, 3671296, 7340032, 60088320, 114688, 7, 177750016, 32768, 218104032, 7, 218106560, 1
    .long 0, 0, 0, 0, 0, 0, 0, 0, 0, 0, 0, 0, 0, 0, 0, 0
    .long 0, 0, 0, 0, 0, 0, 0, 0, 0, 0, 0, 0, 0, 0, 0, 0
    .long 6, 32, 32, 8192, 6144, 268288, 8388608, 0, 32768, 4, 37847040, 131072, 0, 0, 218104416, 1
    .long 4, 32, 32, 8192, 6144, 268288, 8388608, 262144, 32768, 4, 38895616, 131072, 0, 0, 218104544, 1
    .long 4, 16, 16, 8192, 7936, 270080, 8388608, 786432, 32768, 4, 7467008, 131072, 0, 0, 218104688, 1
    .long 1, 32, 32, 8192, 7168, 7424, 8388608, 1572864, 32768, 8, 44154880, 131072, 0, 0, 218105200, 4
    .long 1, 16, 16, 8192, 7168, 7424, 8388608, 2621440, 32768, 8, 14794752, 131072, 0, 0, 218105712, 4
    .long 2, 64, 72, 7168, 4864, 4864, 7340032, 1048576, 32768, 8, 58273792, 114688, 0, 0, 218103968, 1
    .long 2, 64, 72, 7168, 3840, 3840, 7340032, 2621440, 32768, 8, 63762432, 114688, 0, 0, 218104160, 1
    .long 1, 80, 80, 2048, 3671552, 3671808, 7340032, 60088320, 114688, 7, 177758208, 32768, 218104032, 7, 218106560, 1
    .long 0, 0, 0, 0, 0, 0, 0, 0, 0, 0, 0, 0, 0, 0, 0, 0
    .long 0, 0, 0, 0, 0, 0, 0, 0, 0, 0, 0, 0, 0, 0, 0, 0
    .long 6, 32, 32, 8192, 256, 262400, 8388608, 0, 32768, 4, 37752832, 131072, 0, 0, 218104320, 1
    .long 4, 32, 32, 8192, 256, 262400, 8388608, 262144, 32768, 4, 38801408, 131072, 0, 0, 218104448, 1
    .long 4, 16, 16, 8192, 1792, 263936, 8388608, 524288, 32768, 4, 6320128, 131072, 0, 0, 218104592, 1
    .long 1, 32, 32, 8192, 1536, 1792, 8388608, 1572864, 32768, 8, 44064768, 131072, 0, 0, 218105104, 4
    .long 1, 16, 16, 8192, 1536, 1792, 8388608, 2621440, 32768, 8, 14704640, 131072, 0, 0, 218105616, 4
    .long 2, 64, 72, 7168, 5120, 5120, 7340032, 1048576, 32768, 8, 58277888, 114688, 0, 0, 218103968, 1
    .long 2, 64, 72, 7168, 4096, 4096, 7340032, 2621440, 32768, 8, 63766528, 114688, 0, 0, 218104160, 1
    .long 1, 80, 80, 2048, 5505024, 5505280, 7340032, 60116992, 114688, 7, 181927936, 32768, 218104048, 7, 218106560, 1
    .long 0, 0, 0, 0, 0, 0, 0, 0, 0, 0, 0, 0, 0, 0, 0, 0
    .long 0, 0, 0, 0, 0, 0, 0, 0, 0, 0, 0, 0, 0, 0, 0, 0
    .long 6, 32, 32, 8192, 2304, 264448, 8388608, 0, 32768, 4, 37785600, 131072, 0, 0, 218104352, 1
    .long 4, 32, 32, 8192, 2304, 264448, 8388608, 262144, 32768, 4, 38834176, 131072, 0, 0, 218104480, 1
    .long 4, 16, 16, 8192, 3840, 265984, 8388608, 524288, 32768, 4, 6352896, 131072, 0, 0, 218104624, 1
    .long 1, 32, 32, 8192, 3584, 3840, 8388608, 1572864, 32768, 8, 44097536, 131072, 0, 0, 218105136, 4
    .long 1, 16, 16, 8192, 3584, 3840, 8388608, 2621440, 32768, 8, 14737408, 131072, 0, 0, 218105648, 4
    .long 2, 64, 72, 7168, 5376, 5376, 7340032, 1048576, 32768, 8, 58281984, 114688, 0, 0, 218103984, 1
    .long 2, 64, 72, 7168, 4352, 4352, 7340032, 2621440, 32768, 8, 63770624, 114688, 0, 0, 218104160, 1
    .long 1, 80, 80, 2048, 5505536, 5505792, 7340032, 60116992, 114688, 7, 181936128, 32768, 218104048, 7, 218106560, 1
    .long 0, 0, 0, 0, 0, 0, 0, 0, 0, 0, 0, 0, 0, 0, 0, 0
    .long 0, 0, 0, 0, 0, 0, 0, 0, 0, 0, 0, 0, 0, 0, 0, 0
    .long 6, 32, 32, 8192, 4352, 266496, 8388608, 0, 32768, 4, 37818368, 131072, 0, 0, 218104384, 1
    .long 4, 32, 32, 8192, 4352, 266496, 8388608, 262144, 32768, 4, 38866944, 131072, 0, 0, 218104512, 1
    .long 4, 16, 16, 8192, 5888, 268032, 8388608, 524288, 32768, 4, 6385664, 131072, 0, 0, 218104656, 1
    .long 1, 32, 32, 8192, 5632, 5888, 8388608, 1572864, 32768, 8, 44130304, 131072, 0, 0, 218105168, 4
    .long 1, 16, 16, 8192, 5632, 5888, 8388608, 2621440, 32768, 8, 14770176, 131072, 0, 0, 218105680, 4
    .long 2, 64, 72, 7168, 5632, 5632, 7340032, 1048576, 32768, 8, 58286080, 114688, 0, 0, 218103984, 1
    .long 2, 64, 72, 7168, 4608, 4608, 7340032, 2621440, 32768, 8, 63774720, 114688, 0, 0, 218104160, 1
    .long 1, 80, 80, 2048, 5506048, 5506304, 7340032, 60116992, 114688, 7, 181944320, 32768, 218104048, 7, 218106560, 1
    .long 0, 0, 0, 0, 0, 0, 0, 0, 0, 0, 0, 0, 0, 0, 0, 0
    .long 0, 0, 0, 0, 0, 0, 0, 0, 0, 0, 0, 0, 0, 0, 0, 0
    .long 6, 32, 32, 8192, 6400, 268544, 8388608, 0, 32768, 4, 37851136, 131072, 0, 0, 218104416, 1
    .long 4, 32, 32, 8192, 6400, 268544, 8388608, 262144, 32768, 4, 38899712, 131072, 0, 0, 218104544, 1
    .long 4, 16, 16, 8192, 7936, 270080, 8388608, 524288, 32768, 4, 6418432, 131072, 0, 0, 218104688, 1
    .long 1, 32, 32, 8192, 7680, 7936, 8388608, 1572864, 32768, 8, 44163072, 131072, 0, 0, 218105200, 4
    .long 1, 16, 16, 8192, 7680, 7936, 8388608, 2621440, 32768, 8, 14802944, 131072, 0, 0, 218105712, 4
    .long 2, 64, 72, 7168, 5888, 5888, 7340032, 1048576, 32768, 8, 58290176, 114688, 0, 0, 218103984, 1
    .long 2, 64, 72, 7168, 4864, 4864, 7340032, 2621440, 32768, 8, 63778816, 114688, 0, 0, 218104160, 1
    .long 1, 80, 80, 2048, 5506560, 5506816, 7340032, 60116992, 114688, 7, 181952512, 32768, 218104048, 7, 218106560, 1
    .long 0, 0, 0, 0, 0, 0, 0, 0, 0, 0, 0, 0, 0, 0, 0, 0
    .long 0, 0, 0, 0, 0, 0, 0, 0, 0, 0, 0, 0, 0, 0, 0, 0
    .long 6, 32, 32, 8192, 512, 262656, 8388608, 0, 32768, 4, 37756928, 131072, 0, 0, 218104320, 1
    .long 4, 32, 32, 8192, 512, 262656, 8388608, 262144, 32768, 4, 38805504, 131072, 0, 0, 218104448, 1
    .long 4, 16, 16, 8192, 1536, 263680, 8388608, 786432, 32768, 4, 7364608, 131072, 0, 0, 218104592, 1
    .long 1, 24, 24, 8192, 0, 256, 8388608, 1572864, 32768, 8, 27262976, 131072, 0, 0, 218105088, 4
    .long 2, 64, 72, 7168, 0, 0, 7340032, 0, 32768, 8, 54525952, 114688, 0, 0, 218103808, 1
    .long 2, 64, 72, 7168, 6144, 6144, 7340032, 1048576, 32768, 8, 58294272, 114688, 0, 0, 218103984, 1
    .long 2, 64, 72, 7168, 5120, 5120, 7340032, 2621440, 32768, 8, 63782912, 114688, 0, 0, 218104160, 1
    .long 1, 80, 80, 2048, 0, 256, 7340032, 61865984, 114688, 7, 169869312, 32768, 218104064, 7, 218106624, 1
    .long 0, 0, 0, 0, 0, 0, 0, 0, 0, 0, 0, 0, 0, 0, 0, 0
    .long 0, 0, 0, 0, 0, 0, 0, 0, 0, 0, 0, 0, 0, 0, 0, 0
    .long 6, 32, 32, 8192, 2560, 264704, 8388608, 0, 32768, 4, 37789696, 131072, 0, 0, 218104352, 1
    .long 4, 32, 32, 8192, 2560, 264704, 8388608, 262144, 32768, 4, 38838272, 131072, 0, 0, 218104480, 1
    .long 4, 16, 16, 8192, 3584, 265728, 8388608, 786432, 32768, 4, 7397376, 131072, 0, 0, 218104624, 1
    .long 1, 24, 24, 8192, 2048, 2304, 8388608, 1572864, 32768, 8, 27295744, 131072, 0, 0, 218105120, 4
    .long 2, 64, 72, 7168, 256, 256, 7340032, 0, 32768, 8, 54530048, 114688, 0, 0, 218103808, 1
    .long 2, 64, 72, 7168, 6400, 6400, 7340032, 1048576, 32768, 8, 58298368, 114688, 0, 0, 218103984, 1
    .long 2, 64, 72, 7168, 5376, 5376, 7340032, 2621440, 32768, 8, 63787008, 114688, 0, 0, 218104176, 1
    .long 1, 80, 80, 2048, 512, 768, 7340032, 61865984, 114688, 7, 169877504, 32768, 218104064, 7, 218106624, 1
    .long 0, 0, 0, 0, 0, 0, 0, 0, 0, 0, 0, 0, 0, 0, 0, 0
    .long 0, 0, 0, 0, 0, 0, 0, 0, 0, 0, 0, 0, 0, 0, 0, 0
    .long 6, 32, 32, 8192, 4608, 266752, 8388608, 0, 32768, 4, 37822464, 131072, 0, 0, 218104384, 1
    .long 4, 32, 32, 8192, 4608, 266752, 8388608, 262144, 32768, 4, 38871040, 131072, 0, 0, 218104512, 1
    .long 4, 16, 16, 8192, 5632, 267776, 8388608, 786432, 32768, 4, 7430144, 131072, 0, 0, 218104656, 1
    .long 1, 24, 24, 8192, 4096, 4352, 8388608, 1572864, 32768, 8, 27328512, 131072, 0, 0, 218105152, 4
    .long 2, 64, 72, 7168, 512, 512, 7340032, 0, 32768, 8, 54534144, 114688, 0, 0, 218103808, 1
    .long 2, 64, 72, 7168, 6656, 6656, 7340032, 1048576, 32768, 8, 58302464, 114688, 0, 0, 218103984, 1
    .long 2, 64, 72, 7168, 5632, 5632, 7340032, 2621440, 32768, 8, 63791104, 114688, 0, 0, 218104176, 1
    .long 1, 80, 80, 2048, 1024, 1280, 7340032, 61865984, 114688, 7, 169885696, 32768, 218104064, 7, 218106624, 1
    .long 0, 0, 0, 0, 0, 0, 0, 0, 0, 0, 0, 0, 0, 0, 0, 0
    .long 0, 0, 0, 0, 0, 0, 0, 0, 0, 0, 0, 0, 0, 0, 0, 0
    .long 6, 32, 32, 8192, 6656, 268800, 8388608, 0, 32768, 4, 37855232, 131072, 0, 0, 218104416, 1
    .long 4, 32, 32, 8192, 6656, 268800, 8388608, 262144, 32768, 4, 38903808, 131072, 0, 0, 218104544, 1
    .long 4, 16, 16, 8192, 7680, 269824, 8388608, 786432, 32768, 4, 7462912, 131072, 0, 0, 218104688, 1
    .long 1, 24, 24, 8192, 6144, 6400, 8388608, 1572864, 32768, 8, 27361280, 131072, 0, 0, 218105184, 4
    .long 2, 64, 72, 7168, 768, 768, 7340032, 0, 32768, 8, 54538240, 114688, 0, 0, 218103808, 1
    .long 2, 64, 72, 7168, 6912, 6912, 7340032, 1048576, 32768, 8, 58306560, 114688, 0, 0, 218103984, 1
    .long 2, 64, 72, 7168, 5888, 5888, 7340032, 2621440, 32768, 8, 63795200, 114688, 0, 0, 218104176, 1
    .long 1, 80, 80, 2048, 1536, 1792, 7340032, 61865984, 114688, 7, 169893888, 32768, 218104064, 7, 218106624, 1
    .long 0, 0, 0, 0, 0, 0, 0, 0, 0, 0, 0, 0, 0, 0, 0, 0
    .long 0, 0, 0, 0, 0, 0, 0, 0, 0, 0, 0, 0, 0, 0, 0, 0
    .long 6, 32, 32, 8192, 768, 262912, 8388608, 0, 32768, 4, 37761024, 131072, 0, 0, 218104320, 1
    .long 4, 32, 32, 8192, 768, 262912, 8388608, 262144, 32768, 4, 38809600, 131072, 0, 0, 218104448, 1
    .long 4, 16, 16, 8192, 1536, 263680, 8388608, 524288, 32768, 4, 6316032, 131072, 0, 0, 218104592, 1
    .long 1, 24, 24, 8192, 512, 768, 8388608, 1572864, 32768, 8, 27271168, 131072, 0, 0, 218105088, 4
    .long 2, 64, 72, 7168, 1024, 1024, 7340032, 0, 32768, 8, 54542336, 114688, 0, 0, 218103808, 1
    .long 2, 64, 72, 7168, 0, 0, 7340032, 1572864, 32768, 8, 60030976, 114688, 0, 0, 218104000, 1
    .long 2, 64, 72, 7168, 6144, 6144, 7340032, 2621440, 32768, 8, 63799296, 114688, 0, 0, 218104176, 1
    .long 1, 80, 80, 2048, 1835008, 1835264, 7340032, 61894656, 114688, 7, 174063616, 32768, 218104080, 7, 218106624, 1
    .long 0, 0, 0, 0, 0, 0, 0, 0, 0, 0, 0, 0, 0, 0, 0, 0
    .long 0, 0, 0, 0, 0, 0, 0, 0, 0, 0, 0, 0, 0, 0, 0, 0
    .long 6, 32, 32, 8192, 2816, 264960, 8388608, 0, 32768, 4, 37793792, 131072, 0, 0, 218104352, 1
    .long 4, 32, 32, 8192, 2816, 264960, 8388608, 262144, 32768, 4, 38842368, 131072, 0, 0, 218104480, 1
    .long 4, 16, 16, 8192, 3584, 265728, 8388608, 524288, 32768, 4, 6348800, 131072, 0, 0, 218104624, 1
    .long 1, 24, 24, 8192, 2560, 2816, 8388608, 1572864, 32768, 8, 27303936, 131072, 0, 0, 218105120, 4
    .long 2, 64, 72, 7168, 1280, 1280, 7340032, 0, 32768, 8, 54546432, 114688, 0, 0, 218103808, 1
    .long 2, 64, 72, 7168, 256, 256, 7340032, 1572864, 32768, 8, 60035072, 114688, 0, 0, 218104000, 1
    .long 2, 64, 72, 7168, 6400, 6400, 7340032, 2621440, 32768, 8, 63803392, 114688, 0, 0, 218104176, 1
    .long 1, 80, 80, 2048, 1835520, 1835776, 7340032, 61894656, 114688, 7, 174071808, 32768, 218104080, 7, 218106624, 1
    .long 0, 0, 0, 0, 0, 0, 0, 0, 0, 0, 0, 0, 0, 0, 0, 0
    .long 0, 0, 0, 0, 0, 0, 0, 0, 0, 0, 0, 0, 0, 0, 0, 0
    .long 6, 32, 32, 8192, 4864, 267008, 8388608, 0, 32768, 4, 37826560, 131072, 0, 0, 218104384, 1
    .long 4, 32, 32, 8192, 4864, 267008, 8388608, 262144, 32768, 4, 38875136, 131072, 0, 0, 218104512, 1
    .long 4, 16, 16, 8192, 5632, 267776, 8388608, 524288, 32768, 4, 6381568, 131072, 0, 0, 218104656, 1
    .long 1, 24, 24, 8192, 4608, 4864, 8388608, 1572864, 32768, 8, 27336704, 131072, 0, 0, 218105152, 4
    .long 2, 64, 72, 7168, 1536, 1536, 7340032, 0, 32768, 8, 54550528, 114688, 0, 0, 218103808, 1
    .long 2, 64, 72, 7168, 512, 512, 7340032, 1572864, 32768, 8, 60039168, 114688, 0, 0, 218104000, 1
    .long 2, 64, 72, 7168, 6656, 6656, 7340032, 2621440, 32768, 8, 63807488, 114688, 0, 0, 218104176, 1
    .long 1, 80, 80, 2048, 1836032, 1836288, 7340032, 61894656, 114688, 7, 174080000, 32768, 218104080, 7, 218106624, 1
    .long 0, 0, 0, 0, 0, 0, 0, 0, 0, 0, 0, 0, 0, 0, 0, 0
    .long 0, 0, 0, 0, 0, 0, 0, 0, 0, 0, 0, 0, 0, 0, 0, 0
    .long 6, 32, 32, 8192, 6912, 269056, 8388608, 0, 32768, 4, 37859328, 131072, 0, 0, 218104416, 1
    .long 4, 32, 32, 8192, 6912, 269056, 8388608, 262144, 32768, 4, 38907904, 131072, 0, 0, 218104544, 1
    .long 4, 16, 16, 8192, 7680, 269824, 8388608, 524288, 32768, 4, 6414336, 131072, 0, 0, 218104688, 1
    .long 1, 24, 24, 8192, 6656, 6912, 8388608, 1572864, 32768, 8, 27369472, 131072, 0, 0, 218105184, 4
    .long 2, 64, 72, 7168, 1792, 1792, 7340032, 0, 32768, 8, 54554624, 114688, 0, 0, 218103824, 1
    .long 2, 64, 72, 7168, 768, 768, 7340032, 1572864, 32768, 8, 60043264, 114688, 0, 0, 218104000, 1
    .long 2, 64, 72, 7168, 6912, 6912, 7340032, 2621440, 32768, 8, 63811584, 114688, 0, 0, 218104176, 1
    .long 1, 80, 80, 2048, 1836544, 1836800, 7340032, 61894656, 114688, 7, 174088192, 32768, 218104080, 7, 218106624, 1
    .long 0, 0, 0, 0, 0, 0, 0, 0, 0, 0, 0, 0, 0, 0, 0, 0
    .long 0, 0, 0, 0, 0, 0, 0, 0, 0, 0, 0, 0, 0, 0, 0, 0
    .long 6, 32, 32, 8192, 1024, 263168, 8388608, 0, 32768, 4, 37765120, 131072, 0, 0, 218104336, 1
    .long 4, 32, 32, 8192, 1024, 263168, 8388608, 262144, 32768, 4, 38813696, 131072, 0, 0, 218104464, 1
    .long 4, 16, 16, 8192, 1280, 263424, 8388608, 786432, 32768, 4, 7360512, 131072, 0, 0, 218104592, 1
    .long 1, 24, 24, 8192, 1024, 1280, 8388608, 1572864, 32768, 8, 27279360, 131072, 0, 0, 218105104, 4
    .long 2, 64, 72, 7168, 2048, 2048, 7340032, 0, 32768, 8, 54558720, 114688, 0, 0, 218103824, 1
    .long 2, 64, 72, 7168, 1024, 1024, 7340032, 1572864, 32768, 8, 60047360, 114688, 0, 0, 218104000, 1
    .long 2, 64, 72, 7168, 0, 0, 7340032, 3145728, 32768, 8, 65536000, 114688, 0, 0, 218104192, 1
    .long 1, 80, 80, 2048, 3670016, 3670272, 7340032, 61923328, 114688, 7, 178257920, 32768, 218104096, 7, 218106624, 1
    .long 0, 0, 0, 0, 0, 0, 0, 0, 0, 0, 0, 0, 0, 0, 0, 0
    .long 0, 0, 0, 0, 0, 0, 0, 0, 0, 0, 0, 0, 0, 0, 0, 0
    .long 6, 32, 32, 8192, 3072, 265216, 8388608, 0, 32768, 4, 37797888, 131072, 0, 0, 218104368, 1
    .long 4, 32, 32, 8192, 3072, 265216, 8388608, 262144, 32768, 4, 38846464, 131072, 0, 0, 218104496, 1
    .long 4, 16, 16, 8192, 3328, 265472, 8388608, 786432, 32768, 4, 7393280, 131072, 0, 0, 218104624, 1
    .long 1, 24, 24, 8192, 3072, 3328, 8388608, 1572864, 32768, 8, 27312128, 131072, 0, 0, 218105136, 4
    .long 2, 64, 72, 7168, 2304, 2304, 7340032, 0, 32768, 8, 54562816, 114688, 0, 0, 218103824, 1
    .long 2, 64, 72, 7168, 1280, 1280, 7340032, 1572864, 32768, 8, 60051456, 114688, 0, 0, 218104000, 1
    .long 2, 64, 72, 7168, 256, 256, 7340032, 3145728, 32768, 8, 65540096, 114688, 0, 0, 218104192, 1
    .long 1, 80, 80, 2048, 3670528, 3670784, 7340032, 61923328, 114688, 7, 178266112, 32768, 218104096, 7, 218106624, 1
    .long 0, 0, 0, 0, 0, 0, 0, 0, 0, 0, 0, 0, 0, 0, 0, 0
    .long 0, 0, 0, 0, 0, 0, 0, 0, 0, 0, 0, 0, 0, 0, 0, 0
    .long 6, 32, 32, 8192, 5120, 267264, 8388608, 0, 32768, 4, 37830656, 131072, 0, 0, 218104400, 1
    .long 4, 32, 32, 8192, 5120, 267264, 8388608, 262144, 32768, 4, 38879232, 131072, 0, 0, 218104528, 1
    .long 4, 16, 16, 8192, 5376, 267520, 8388608, 786432, 32768, 4, 7426048, 131072, 0, 0, 218104656, 1
    .long 1, 24, 24, 8192, 5120, 5376, 8388608, 1572864, 32768, 8, 27344896, 131072, 0, 0, 218105168, 4
    .long 2, 64, 72, 7168, 2560, 2560, 7340032, 0, 32768, 8, 54566912, 114688, 0, 0, 218103824, 1
    .long 2, 64, 72, 7168, 1536, 1536, 7340032, 1572864, 32768, 8, 60055552, 114688, 0, 0, 218104000, 1
    .long 2, 64, 72, 7168, 512, 512, 7340032, 3145728, 32768, 8, 65544192, 114688, 0, 0, 218104192, 1
    .long 1, 80, 80, 2048, 3671040, 3671296, 7340032, 61923328, 114688, 7, 178274304, 32768, 218104096, 7, 218106624, 1
    .long 0, 0, 0, 0, 0, 0, 0, 0, 0, 0, 0, 0, 0, 0, 0, 0
    .long 0, 0, 0, 0, 0, 0, 0, 0, 0, 0, 0, 0, 0, 0, 0, 0
    .long 6, 32, 32, 8192, 7168, 269312, 8388608, 0, 32768, 4, 37863424, 131072, 0, 0, 218104432, 1
    .long 4, 32, 32, 8192, 7168, 269312, 8388608, 262144, 32768, 4, 38912000, 131072, 0, 0, 218104560, 1
    .long 4, 16, 16, 8192, 7424, 269568, 8388608, 786432, 32768, 4, 7458816, 131072, 0, 0, 218104688, 1
    .long 1, 24, 24, 8192, 7168, 7424, 8388608, 1572864, 32768, 8, 27377664, 131072, 0, 0, 218105200, 4
    .long 2, 64, 72, 7168, 2816, 2816, 7340032, 0, 32768, 8, 54571008, 114688, 0, 0, 218103824, 1
    .long 2, 64, 72, 7168, 1792, 1792, 7340032, 1572864, 32768, 8, 60059648, 114688, 0, 0, 218104016, 1
    .long 2, 64, 72, 7168, 768, 768, 7340032, 3145728, 32768, 8, 65548288, 114688, 0, 0, 218104192, 1
    .long 1, 80, 80, 2048, 3671552, 3671808, 7340032, 61923328, 114688, 7, 178282496, 32768, 218104096, 7, 218106624, 1
    .long 0, 0, 0, 0, 0, 0, 0, 0, 0, 0, 0, 0, 0, 0, 0, 0
    .long 0, 0, 0, 0, 0, 0, 0, 0, 0, 0, 0, 0, 0, 0, 0, 0
    .long 6, 32, 32, 8192, 1280, 263424, 8388608, 0, 32768, 4, 37769216, 131072, 0, 0, 218104336, 1
    .long 4, 32, 32, 8192, 1280, 263424, 8388608, 262144, 32768, 4, 38817792, 131072, 0, 0, 218104464, 1
    .long 4, 16, 16, 8192, 1280, 263424, 8388608, 524288, 32768, 4, 6311936, 131072, 0, 0, 218104592, 1
    .long 1, 24, 24, 8192, 1536, 1792, 8388608, 1572864, 32768, 8, 27287552, 131072, 0, 0, 218105104, 4
    .long 2, 64, 72, 7168, 3072, 3072, 7340032, 0, 32768, 8, 54575104, 114688, 0, 0, 218103824, 1
    .long 2, 64, 72, 7168, 2048, 2048, 7340032, 1572864, 32768, 8, 60063744, 114688, 0, 0, 218104016, 1
    .long 2, 64, 72, 7168, 1024, 1024, 7340032, 3145728, 32768, 8, 65552384, 114688, 0, 0, 218104192, 1
    .long 1, 80, 80, 2048, 5505024, 5505280, 7340032, 61952000, 114688, 7, 182452224, 32768, 218104112, 7, 218106624, 1
    .long 0, 0, 0, 0, 0, 0, 0, 0, 0, 0, 0, 0, 0, 0, 0, 0
    .long 0, 0, 0, 0, 0, 0, 0, 0, 0, 0, 0, 0, 0, 0, 0, 0
    .long 6, 32, 32, 8192, 3328, 265472, 8388608, 0, 32768, 4, 37801984, 131072, 0, 0, 218104368, 1
    .long 4, 32, 32, 8192, 3328, 265472, 8388608, 262144, 32768, 4, 38850560, 131072, 0, 0, 218104496, 1
    .long 4, 16, 16, 8192, 3328, 265472, 8388608, 524288, 32768, 4, 6344704, 131072, 0, 0, 218104624, 1
    .long 1, 24, 24, 8192, 3584, 3840, 8388608, 1572864, 32768, 8, 27320320, 131072, 0, 0, 218105136, 4
    .long 2, 64, 72, 7168, 3328, 3328, 7340032, 0, 32768, 8, 54579200, 114688, 0, 0, 218103824, 1
    .long 2, 64, 72, 7168, 2304, 2304, 7340032, 1572864, 32768, 8, 60067840, 114688, 0, 0, 218104016, 1
    .long 2, 64, 72, 7168, 1280, 1280, 7340032, 3145728, 32768, 8, 65556480, 114688, 0, 0, 218104192, 1
    .long 1, 80, 80, 2048, 5505536, 5505792, 7340032, 61952000, 114688, 7, 182460416, 32768, 218104112, 7, 218106624, 1
    .long 0, 0, 0, 0, 0, 0, 0, 0, 0, 0, 0, 0, 0, 0, 0, 0
    .long 0, 0, 0, 0, 0, 0, 0, 0, 0, 0, 0, 0, 0, 0, 0, 0
    .long 6, 32, 32, 8192, 5376, 267520, 8388608, 0, 32768, 4, 37834752, 131072, 0, 0, 218104400, 1
    .long 4, 32, 32, 8192, 5376, 267520, 8388608, 262144, 32768, 4, 38883328, 131072, 0, 0, 218104528, 1
    .long 4, 16, 16, 8192, 5376, 267520, 8388608, 524288, 32768, 4, 6377472, 131072, 0, 0, 218104656, 1
    .long 1, 24, 24, 8192, 5632, 5888, 8388608, 1572864, 32768, 8, 27353088, 131072, 0, 0, 218105168, 4
    .long 2, 64, 72, 7168, 3584, 3584, 7340032, 0, 32768, 8, 54583296, 114688, 0, 0, 218103840, 1
    .long 2, 64, 72, 7168, 2560, 2560, 7340032, 1572864, 32768, 8, 60071936, 114688, 0, 0, 218104016, 1
    .long 2, 64, 72, 7168, 1536, 1536, 7340032, 3145728, 32768, 8, 65560576, 114688, 0, 0, 218104192, 1
    .long 1, 80, 80, 2048, 5506048, 5506304, 7340032, 61952000, 114688, 7, 182468608, 32768, 218104112, 7, 218106624, 1
    .long 0, 0, 0, 0, 0, 0, 0, 0, 0, 0, 0, 0, 0, 0, 0, 0
    .long 0, 0, 0, 0, 0, 0, 0, 0, 0, 0, 0, 0, 0, 0, 0, 0
    .long 6, 32, 32, 8192, 7424, 269568, 8388608, 0, 32768, 4, 37867520, 131072, 0, 0, 218104432, 1
    .long 4, 32, 32, 8192, 7424, 269568, 8388608, 262144, 32768, 4, 38916096, 131072, 0, 0, 218104560, 1
    .long 4, 16, 16, 8192, 7424, 269568, 8388608, 524288, 32768, 4, 6410240, 131072, 0, 0, 218104688, 1
    .long 1, 24, 24, 8192, 7680, 7936, 8388608, 1572864, 32768, 8, 27385856, 131072, 0, 0, 218105200, 4
    .long 2, 64, 72, 7168, 3840, 3840, 7340032, 0, 32768, 8, 54587392, 114688, 0, 0, 218103840, 1
    .long 2, 64, 72, 7168, 2816, 2816, 7340032, 1572864, 32768, 8, 60076032, 114688, 0, 0, 218104016, 1
    .long 2, 64, 72, 7168, 1792, 1792, 7340032, 3145728, 32768, 8, 65564672, 114688, 0, 0, 218104208, 1
    .long 1, 80, 80, 2048, 5506560, 5506816, 7340032, 61952000, 114688, 7, 182476800, 32768, 218104112, 7, 218106624, 1
    .long 0, 0, 0, 0, 0, 0, 0, 0, 0, 0, 0, 0, 0, 0, 0, 0
    .long 0, 0, 0, 0, 0, 0, 0, 0, 0, 0, 0, 0, 0, 0, 0, 0
    .long 6, 32, 32, 8192, 1536, 263680, 8388608, 0, 32768, 4, 37773312, 131072, 0, 0, 218104336, 1
    .long 4, 32, 32, 8192, 1536, 263680, 8388608, 262144, 32768, 4, 38821888, 131072, 0, 0, 218104464, 1
    .long 4, 16, 16, 8192, 1024, 263168, 8388608, 786432, 32768, 4, 7356416, 131072, 0, 0, 218104592, 1
    .long 1, 16, 16, 8192, 0, 256, 8388608, 1572864, 32768, 8, 10485760, 131072, 0, 0, 218105088, 4
    .long 2, 64, 72, 7168, 4096, 4096, 7340032, 0, 32768, 8, 54591488, 114688, 0, 0, 218103840, 1
    .long 2, 64, 72, 7168, 3072, 3072, 7340032, 1572864, 32768, 8, 60080128, 114688, 0, 0, 218104016, 1
    .long 2, 64, 72, 7168, 2048, 2048, 7340032, 3145728, 32768, 8, 65568768, 114688, 0, 0, 218104208, 1
    .long 1, 80, 80, 2048, 0, 256, 7340032, 63700992, 114688, 7, 170393600, 32768, 218104128, 7, 218106688, 1
    .long 0, 0, 0, 0, 0, 0, 0, 0, 0, 0, 0, 0, 0, 0, 0, 0
    .long 0, 0, 0, 0, 0, 0, 0, 0, 0, 0, 0, 0, 0, 0, 0, 0
    .long 6, 32, 32, 8192, 3584, 265728, 8388608, 0, 32768, 4, 37806080, 131072, 0, 0, 218104368, 1
    .long 4, 32, 32, 8192, 3584, 265728, 8388608, 262144, 32768, 4, 38854656, 131072, 0, 0, 218104496, 1
    .long 4, 16, 16, 8192, 3072, 265216, 8388608, 786432, 32768, 4, 7389184, 131072, 0, 0, 218104624, 1
    .long 1, 16, 16, 8192, 2048, 2304, 8388608, 1572864, 32768, 8, 10518528, 131072, 0, 0, 218105120, 4
    .long 2, 64, 72, 7168, 4352, 4352, 7340032, 0, 32768, 8, 54595584, 114688, 0, 0, 218103840, 1
    .long 2, 64, 72, 7168, 3328, 3328, 7340032, 1572864, 32768, 8, 60084224, 114688, 0, 0, 218104016, 1
    .long 2, 64, 72, 7168, 2304, 2304, 7340032, 3145728, 32768, 8, 65572864, 114688, 0, 0, 218104208, 1
    .long 1, 80, 80, 2048, 512, 768, 7340032, 63700992, 114688, 7, 170401792, 32768, 218104128, 7, 218106688, 1
    .long 0, 0, 0, 0, 0, 0, 0, 0, 0, 0, 0, 0, 0, 0, 0, 0
    .long 0, 0, 0, 0, 0, 0, 0, 0, 0, 0, 0, 0, 0, 0, 0, 0
    .long 6, 32, 32, 8192, 5632, 267776, 8388608, 0, 32768, 4, 37838848, 131072, 0, 0, 218104400, 1
    .long 4, 32, 32, 8192, 5632, 267776, 8388608, 262144, 32768, 4, 38887424, 131072, 0, 0, 218104528, 1
    .long 4, 16, 16, 8192, 5120, 267264, 8388608, 786432, 32768, 4, 7421952, 131072, 0, 0, 218104656, 1
    .long 1, 16, 16, 8192, 4096, 4352, 8388608, 1572864, 32768, 8, 10551296, 131072, 0, 0, 218105152, 4
    .long 2, 64, 72, 7168, 4608, 4608, 7340032, 0, 32768, 8, 54599680, 114688, 0, 0, 218103840, 1
    .long 2, 64, 72, 7168, 3584, 3584, 7340032, 1572864, 32768, 8, 60088320, 114688, 0, 0, 218104032, 1
    .long 2, 64, 72, 7168, 2560, 2560, 7340032, 3145728, 32768, 8, 65576960, 114688, 0, 0, 218104208, 1
    .long 1, 80, 80, 2048, 1024, 1280, 7340032, 63700992, 114688, 7, 170409984, 32768, 218104128, 7, 218106688, 1
    .long 0, 0, 0, 0, 0, 0, 0, 0, 0, 0, 0, 0, 0, 0, 0, 0
    .long 0, 0, 0, 0, 0, 0, 0, 0, 0, 0, 0, 0, 0, 0, 0, 0
    .long 6, 32, 32, 8192, 7680, 269824, 8388608, 0, 32768, 4, 37871616, 131072, 0, 0, 218104432, 1
    .long 4, 32, 32, 8192, 7680, 269824, 8388608, 262144, 32768, 4, 38920192, 131072, 0, 0, 218104560, 1
    .long 4, 16, 16, 8192, 7168, 269312, 8388608, 786432, 32768, 4, 7454720, 131072, 0, 0, 218104688, 1
    .long 1, 16, 16, 8192, 6144, 6400, 8388608, 1572864, 32768, 8, 10584064, 131072, 0, 0, 218105184, 4
    .long 2, 64, 72, 7168, 4864, 4864, 7340032, 0, 32768, 8, 54603776, 114688, 0, 0, 218103840, 1
    .long 2, 64, 72, 7168, 3840, 3840, 7340032, 1572864, 32768, 8, 60092416, 114688, 0, 0, 218104032, 1
    .long 2, 64, 72, 7168, 2816, 2816, 7340032, 3145728, 32768, 8, 65581056, 114688, 0, 0, 218104208, 1
    .long 1, 80, 80, 2048, 1536, 1792, 7340032, 63700992, 114688, 7, 170418176, 32768, 218104128, 7, 218106688, 1
    .long 0, 0, 0, 0, 0, 0, 0, 0, 0, 0, 0, 0, 0, 0, 0, 0
    .long 0, 0, 0, 0, 0, 0, 0, 0, 0, 0, 0, 0, 0, 0, 0, 0
    .long 6, 32, 32, 8192, 1792, 263936, 8388608, 0, 32768, 4, 37777408, 131072, 0, 0, 218104336, 1
    .long 4, 32, 32, 8192, 1792, 263936, 8388608, 262144, 32768, 4, 38825984, 131072, 0, 0, 218104464, 1
    .long 4, 16, 16, 8192, 1024, 263168, 8388608, 524288, 32768, 4, 6307840, 131072, 0, 0, 218104592, 1
    .long 1, 16, 16, 8192, 512, 768, 8388608, 1572864, 32768, 8, 10493952, 131072, 0, 0, 218105088, 4
    .long 2, 64, 72, 7168, 5120, 5120, 7340032, 0, 32768, 8, 54607872, 114688, 0, 0, 218103840, 1
    .long 2, 64, 72, 7168, 4096, 4096, 7340032, 1572864, 32768, 8, 60096512, 114688, 0, 0, 218104032, 1
    .long 2, 64, 72, 7168, 3072, 3072, 7340032, 3145728, 32768, 8, 65585152, 114688, 0, 0, 218104208, 1
    .long 1, 80, 80, 2048, 1835008, 1835264, 7340032, 63729664, 114688, 7, 174587904, 32768, 218104144, 7, 218106688, 1
    .long 0, 0, 0, 0, 0, 0, 0, 0, 0, 0, 0, 0, 0, 0, 0, 0
    .long 0, 0, 0, 0, 0, 0, 0, 0, 0, 0, 0, 0, 0, 0, 0, 0
    .long 6, 32, 32, 8192, 3840, 265984, 8388608, 0, 32768, 4, 37810176, 131072, 0, 0, 218104368, 1
    .long 4, 32, 32, 8192, 3840, 265984, 8388608, 262144, 32768, 4, 38858752, 131072, 0, 0, 218104496, 1
    .long 4, 16, 16, 8192, 3072, 265216, 8388608, 524288, 32768, 4, 6340608, 131072, 0, 0, 218104624, 1
    .long 1, 16, 16, 8192, 2560, 2816, 8388608, 1572864, 32768, 8, 10526720, 131072, 0, 0, 218105120, 4
    .long 2, 64, 72, 7168, 5376, 5376, 7340032, 0, 32768, 8, 54611968, 114688, 0, 0, 218103856, 1
    .long 2, 64, 72, 7168, 4352, 4352, 7340032, 1572864, 32768, 8, 60100608, 114688, 0, 0, 218104032, 1
    .long 2, 64, 72, 7168, 3328, 3328, 7340032, 3145728, 32768, 8, 65589248, 114688, 0, 0, 218104208, 1
    .long 1, 80, 80, 2048, 1835520, 1835776, 7340032, 63729664, 114688, 7, 174596096, 32768, 218104144, 7, 218106688, 1
    .long 0, 0, 0, 0, 0, 0, 0, 0, 0, 0, 0, 0, 0, 0, 0, 0
    .long 0, 0, 0, 0, 0, 0, 0, 0, 0, 0, 0, 0, 0, 0, 0, 0
    .long 6, 32, 32, 8192, 5888, 268032, 8388608, 0, 32768, 4, 37842944, 131072, 0, 0, 218104400, 1
    .long 4, 32, 32, 8192, 5888, 268032, 8388608, 262144, 32768, 4, 38891520, 131072, 0, 0, 218104528, 1
    .long 4, 16, 16, 8192, 5120, 267264, 8388608, 524288, 32768, 4, 6373376, 131072, 0, 0, 218104656, 1
    .long 1, 16, 16, 8192, 4608, 4864, 8388608, 1572864, 32768, 8, 10559488, 131072, 0, 0, 218105152, 4
    .long 2, 64, 72, 7168, 5632, 5632, 7340032, 0, 32768, 8, 54616064, 114688, 0, 0, 218103856, 1
    .long 2, 64, 72, 7168, 4608, 4608, 7340032, 1572864, 32768, 8, 60104704, 114688, 0, 0, 218104032, 1
    .long 2, 64, 72, 7168, 3584, 3584, 7340032, 3145728, 32768, 8, 65593344, 114688, 0, 0, 218104224, 1
    .long 1, 80, 80, 2048, 1836032, 1836288, 7340032, 63729664, 114688, 7, 174604288, 32768, 218104144, 7, 218106688, 1
    .long 0, 0, 0, 0, 0, 0, 0, 0, 0, 0, 0, 0, 0, 0, 0, 0
    .long 0, 0, 0, 0, 0, 0, 0, 0, 0, 0, 0, 0, 0, 0, 0, 0
    .long 6, 32, 32, 8192, 7936, 270080, 8388608, 0, 32768, 4, 37875712, 131072, 0, 0, 218104432, 1
    .long 4, 32, 32, 8192, 7936, 270080, 8388608, 262144, 32768, 4, 38924288, 131072, 0, 0, 218104560, 1
    .long 4, 16, 16, 8192, 7168, 269312, 8388608, 524288, 32768, 4, 6406144, 131072, 0, 0, 218104688, 1
    .long 1, 16, 16, 8192, 6656, 6912, 8388608, 1572864, 32768, 8, 10592256, 131072, 0, 0, 218105184, 4
    .long 2, 64, 72, 7168, 5888, 5888, 7340032, 0, 32768, 8, 54620160, 114688, 0, 0, 218103856, 1
    .long 2, 64, 72, 7168, 4864, 4864, 7340032, 1572864, 32768, 8, 60108800, 114688, 0, 0, 218104032, 1
    .long 2, 64, 72, 7168, 3840, 3840, 7340032, 3145728, 32768, 8, 65597440, 114688, 0, 0, 218104224, 1
    .long 1, 80, 80, 2048, 1836544, 1836800, 7340032, 63729664, 114688, 7, 174612480, 32768, 218104144, 7, 218106688, 1
    .long 0, 0, 0, 0, 0, 0, 0, 0, 0, 0, 0, 0, 0, 0, 0, 0
    .long 0, 0, 0, 0, 0, 0, 0, 0, 0, 0, 0, 0, 0, 0, 0, 0
    .long 6, 16, 16, 8192, 0, 262144, 8388608, 0, 32768, 4, 4194304, 131072, 0, 0, 218104320, 1
    .long 4, 16, 16, 8192, 0, 262144, 8388608, 262144, 32768, 4, 5242880, 131072, 0, 0, 218104448, 1
    .long 4, 16, 16, 8192, 0, 262144, 8388608, 524288, 32768, 4, 6291456, 131072, 0, 0, 218104576, 1
    .long 1, 16, 16, 8192, 1024, 1280, 8388608, 1572864, 32768, 8, 10502144, 131072, 0, 0, 218105104, 4
    .long 2, 64, 72, 7168, 6144, 6144, 7340032, 0, 32768, 8, 54624256, 114688, 0, 0, 218103856, 1
    .long 2, 64, 72, 7168, 5120, 5120, 7340032, 1572864, 32768, 8, 60112896, 114688, 0, 0, 218104032, 1
    .long 2, 64, 72, 7168, 4096, 4096, 7340032, 3145728, 32768, 8, 65601536, 114688, 0, 0, 218104224, 1
    .long 1, 80, 80, 2048, 3670016, 3670272, 7340032, 63758336, 114688, 7, 178782208, 32768, 218104160, 7, 218106688, 1
    .long 0, 0, 0, 0, 0, 0, 0, 0, 0, 0, 0, 0, 0, 0, 0, 0
    .long 0, 0, 0, 0, 0, 0, 0, 0, 0, 0, 0, 0, 0, 0, 0, 0
    .long 6, 16, 16, 8192, 2048, 264192, 8388608, 0, 32768, 4, 4227072, 131072, 0, 0, 218104352, 1
    .long 4, 16, 16, 8192, 2048, 264192, 8388608, 262144, 32768, 4, 5275648, 131072, 0, 0, 218104480, 1
    .long 4, 16, 16, 8192, 2048, 264192, 8388608, 524288, 32768, 4, 6324224, 131072, 0, 0, 218104608, 1
    .long 1, 16, 16, 8192, 3072, 3328, 8388608, 1572864, 32768, 8, 10534912, 131072, 0, 0, 218105136, 4
    .long 2, 64, 72, 7168, 6400, 6400, 7340032, 0, 32768, 8, 54628352, 114688, 0, 0, 218103856, 1
    .long 2, 64, 72, 7168, 5376, 5376, 7340032, 1572864, 32768, 8, 60116992, 114688, 0, 0, 218104048, 1
    .long 2, 64, 72, 7168, 4352, 4352, 7340032, 3145728, 32768, 8, 65605632, 114688, 0, 0, 218104224, 1
    .long 1, 80, 80, 2048, 3670528, 3670784, 7340032, 63758336, 114688, 7, 178790400, 32768, 218104160, 7, 218106688, 1
    .long 0, 0, 0, 0, 0, 0, 0, 0, 0, 0, 0, 0, 0, 0, 0, 0
    .long 0, 0, 0, 0, 0, 0, 0, 0, 0, 0, 0, 0, 0, 0, 0, 0
    .long 6, 16, 16, 8192, 4096, 266240, 8388608, 0, 32768, 4, 4259840, 131072, 0, 0, 218104384, 1
    .long 4, 16, 16, 8192, 4096, 266240, 8388608, 262144, 32768, 4, 5308416, 131072, 0, 0, 218104512, 1
    .long 4, 16, 16, 8192, 4096, 266240, 8388608, 524288, 32768, 4, 6356992, 131072, 0, 0, 218104640, 1
    .long 1, 16, 16, 8192, 5120, 5376, 8388608, 1572864, 32768, 8, 10567680, 131072, 0, 0, 218105168, 4
    .long 2, 64, 72, 7168, 6656, 6656, 7340032, 0, 32768, 8, 54632448, 114688, 0, 0, 218103856, 1
    .long 2, 64, 72, 7168, 5632, 5632, 7340032, 1572864, 32768, 8, 60121088, 114688, 0, 0, 218104048, 1
    .long 2, 64, 72, 7168, 4608, 4608, 7340032, 3145728, 32768, 8, 65609728, 114688, 0, 0, 218104224, 1
    .long 1, 80, 80, 2048, 3671040, 3671296, 7340032, 63758336, 114688, 7, 178798592, 32768, 218104160, 7, 218106688, 1
    .long 0, 0, 0, 0, 0, 0, 0, 0, 0, 0, 0, 0, 0, 0, 0, 0
    .long 0, 0, 0, 0, 0, 0, 0, 0, 0, 0, 0, 0, 0, 0, 0, 0
    .long 6, 16, 16, 8192, 6144, 268288, 8388608, 0, 32768, 4, 4292608, 131072, 0, 0, 218104416, 1
    .long 4, 16, 16, 8192, 6144, 268288, 8388608, 262144, 32768, 4, 5341184, 131072, 0, 0, 218104544, 1
    .long 4, 16, 16, 8192, 6144, 268288, 8388608, 524288, 32768, 4, 6389760, 131072, 0, 0, 218104672, 1
    .long 1, 16, 16, 8192, 7168, 7424, 8388608, 1572864, 32768, 8, 10600448, 131072, 0, 0, 218105200, 4
    .long 2, 64, 72, 7168, 6912, 6912, 7340032, 0, 32768, 8, 54636544, 114688, 0, 0, 218103856, 1
    .long 2, 64, 72, 7168, 5888, 5888, 7340032, 1572864, 32768, 8, 60125184, 114688, 0, 0, 218104048, 1
    .long 2, 64, 72, 7168, 4864, 4864, 7340032, 3145728, 32768, 8, 65613824, 114688, 0, 0, 218104224, 1
    .long 1, 80, 80, 2048, 3671552, 3671808, 7340032, 63758336, 114688, 7, 178806784, 32768, 218104160, 7, 218106688, 1
    .long 0, 0, 0, 0, 0, 0, 0, 0, 0, 0, 0, 0, 0, 0, 0, 0
    .long 0, 0, 0, 0, 0, 0, 0, 0, 0, 0, 0, 0, 0, 0, 0, 0
    .long 6, 16, 16, 8192, 256, 262400, 8388608, 0, 32768, 4, 4198400, 131072, 0, 0, 218104320, 1
    .long 4, 16, 16, 8192, 256, 262400, 8388608, 262144, 32768, 4, 5246976, 131072, 0, 0, 218104448, 1
    .long 4, 16, 16, 8192, 256, 262400, 8388608, 524288, 32768, 4, 6295552, 131072, 0, 0, 218104576, 1
    .long 1, 16, 16, 8192, 1536, 1792, 8388608, 1572864, 32768, 8, 10510336, 131072, 0, 0, 218105104, 4
    .long 2, 64, 72, 7168, 0, 0, 7340032, 524288, 32768, 8, 56360960, 114688, 0, 0, 218103872, 1
    .long 2, 64, 72, 7168, 6144, 6144, 7340032, 1572864, 32768, 8, 60129280, 114688, 0, 0, 218104048, 1
    .long 2, 64, 72, 7168, 5120, 5120, 7340032, 3145728, 32768, 8, 65617920, 114688, 0, 0, 218104224, 1
    .long 1, 80, 80, 2048, 5505024, 5505280, 7340032, 63787008, 114688, 7, 182976512, 32768, 218104176, 7, 218106688, 1
    .long 0, 0, 0, 0, 0, 0, 0, 0, 0, 0, 0, 0, 0, 0, 0, 0
    .long 0, 0, 0, 0, 0, 0, 0, 0, 0, 0, 0, 0, 0, 0, 0, 0
    .long 6, 16, 16, 8192, 2304, 264448, 8388608, 0, 32768, 4, 4231168, 131072, 0, 0, 218104352, 1
    .long 4, 16, 16, 8192, 2304, 264448, 8388608, 262144, 32768, 4, 5279744, 131072, 0, 0, 218104480, 1
    .long 4, 16, 16, 8192, 2304, 264448, 8388608, 524288, 32768, 4, 6328320, 131072, 0, 0, 218104608, 1
    .long 1, 16, 16, 8192, 3584, 3840, 8388608, 1572864, 32768, 8, 10543104, 131072, 0, 0, 218105136, 4
    .long 2, 64, 72, 7168, 256, 256, 7340032, 524288, 32768, 8, 56365056, 114688, 0, 0, 218103872, 1
    .long 2, 64, 72, 7168, 6400, 6400, 7340032, 1572864, 32768, 8, 60133376, 114688, 0, 0, 218104048, 1
    .long 2, 64, 72, 7168, 5376, 5376, 7340032, 3145728, 32768, 8, 65622016, 114688, 0, 0, 218104240, 1
    .long 1, 80, 80, 2048, 5505536, 5505792, 7340032, 63787008, 114688, 7, 182984704, 32768, 218104176, 7, 218106688, 1
    .long 0, 0, 0, 0, 0, 0, 0, 0, 0, 0, 0, 0, 0, 0, 0, 0
    .long 0, 0, 0, 0, 0, 0, 0, 0, 0, 0, 0, 0, 0, 0, 0, 0
    .long 6, 16, 16, 8192, 4352, 266496, 8388608, 0, 32768, 4, 4263936, 131072, 0, 0, 218104384, 1
    .long 4, 16, 16, 8192, 4352, 266496, 8388608, 262144, 32768, 4, 5312512, 131072, 0, 0, 218104512, 1
    .long 4, 16, 16, 8192, 4352, 266496, 8388608, 524288, 32768, 4, 6361088, 131072, 0, 0, 218104640, 1
    .long 1, 16, 16, 8192, 5632, 5888, 8388608, 1572864, 32768, 8, 10575872, 131072, 0, 0, 218105168, 4
    .long 2, 64, 72, 7168, 512, 512, 7340032, 524288, 32768, 8, 56369152, 114688, 0, 0, 218103872, 1
    .long 2, 64, 72, 7168, 6656, 6656, 7340032, 1572864, 32768, 8, 60137472, 114688, 0, 0, 218104048, 1
    .long 2, 64, 72, 7168, 5632, 5632, 7340032, 3145728, 32768, 8, 65626112, 114688, 0, 0, 218104240, 1
    .long 1, 80, 80, 2048, 5506048, 5506304, 7340032, 63787008, 114688, 7, 182992896, 32768, 218104176, 7, 218106688, 1
    .long 0, 0, 0, 0, 0, 0, 0, 0, 0, 0, 0, 0, 0, 0, 0, 0
    .long 0, 0, 0, 0, 0, 0, 0, 0, 0, 0, 0, 0, 0, 0, 0, 0
    .long 6, 16, 16, 8192, 6400, 268544, 8388608, 0, 32768, 4, 4296704, 131072, 0, 0, 218104416, 1
    .long 4, 16, 16, 8192, 6400, 268544, 8388608, 262144, 32768, 4, 5345280, 131072, 0, 0, 218104544, 1
    .long 4, 16, 16, 8192, 6400, 268544, 8388608, 524288, 32768, 4, 6393856, 131072, 0, 0, 218104672, 1
    .long 1, 16, 16, 8192, 7680, 7936, 8388608, 1572864, 32768, 8, 10608640, 131072, 0, 0, 218105200, 4
    .long 2, 64, 72, 7168, 768, 768, 7340032, 524288, 32768, 8, 56373248, 114688, 0, 0, 218103872, 1
    .long 2, 64, 72, 7168, 6912, 6912, 7340032, 1572864, 32768, 8, 60141568, 114688, 0, 0, 218104048, 1
    .long 2, 64, 72, 7168, 5888, 5888, 7340032, 3145728, 32768, 8, 65630208, 114688, 0, 0, 218104240, 1
    .long 1, 80, 80, 2048, 5506560, 5506816, 7340032, 63787008, 114688, 7, 183001088, 32768, 218104176, 7, 218106688, 1
    .long 0, 0, 0, 0, 0, 0, 0, 0, 0, 0, 0, 0, 0, 0, 0, 0
    .long 0, 0, 0, 0, 0, 0, 0, 0, 0, 0, 0, 0, 0, 0, 0, 0
    .long 6, 16, 16, 8192, 512, 262656, 8388608, 0, 32768, 4, 4202496, 131072, 0, 0, 218104320, 1
    .long 4, 16, 16, 8192, 512, 262656, 8388608, 262144, 32768, 4, 5251072, 131072, 0, 0, 218104448, 1
    .long 4, 16, 16, 8192, 512, 262656, 8388608, 524288, 32768, 4, 6299648, 131072, 0, 0, 218104576, 1
    .long 1, 32, 32, 8192, 0, 256, 8388608, 2097152, 32768, 8, 46137344, 131072, 0, 0, 218105344, 4
    .long 2, 64, 72, 7168, 1024, 1024, 7340032, 524288, 32768, 8, 56377344, 114688, 0, 0, 218103872, 1
    .long 2, 64, 72, 7168, 0, 0, 7340032, 2097152, 32768, 8, 61865984, 114688, 0, 0, 218104064, 1
    .long 2, 64, 72, 7168, 6144, 6144, 7340032, 3145728, 32768, 8, 65634304, 114688, 0, 0, 218104240, 1
    .long 1, 80, 80, 2048, 0, 256, 7340032, 65536000, 114688, 7, 170917888, 32768, 218104192, 7, 218106752, 1
    .long 0, 0, 0, 0, 0, 0, 0, 0, 0, 0, 0, 0, 0, 0, 0, 0
    .long 0, 0, 0, 0, 0, 0, 0, 0, 0, 0, 0, 0, 0, 0, 0, 0
    .long 6, 16, 16, 8192, 2560, 264704, 8388608, 0, 32768, 4, 4235264, 131072, 0, 0, 218104352, 1
    .long 4, 16, 16, 8192, 2560, 264704, 8388608, 262144, 32768, 4, 5283840, 131072, 0, 0, 218104480, 1
    .long 4, 16, 16, 8192, 2560, 264704, 8388608, 524288, 32768, 4, 6332416, 131072, 0, 0, 218104608, 1
    .long 1, 32, 32, 8192, 2048, 2304, 8388608, 2097152, 32768, 8, 46170112, 131072, 0, 0, 218105376, 4
    .long 2, 64, 72, 7168, 1280, 1280, 7340032, 524288, 32768, 8, 56381440, 114688, 0, 0, 218103872, 1
    .long 2, 64, 72, 7168, 256, 256, 7340032, 2097152, 32768, 8, 61870080, 114688, 0, 0, 218104064, 1
    .long 2, 64, 72, 7168, 6400, 6400, 7340032, 3145728, 32768, 8, 65638400, 114688, 0, 0, 218104240, 1
    .long 1, 80, 80, 2048, 512, 768, 7340032, 65536000, 114688, 7, 170926080, 32768, 218104192, 7, 218106752, 1
    .long 0, 0, 0, 0, 0, 0, 0, 0, 0, 0, 0, 0, 0, 0, 0, 0
    .long 0, 0, 0, 0, 0, 0, 0, 0, 0, 0, 0, 0, 0, 0, 0, 0
    .long 6, 16, 16, 8192, 4608, 266752, 8388608, 0, 32768, 4, 4268032, 131072, 0, 0, 218104384, 1
    .long 4, 16, 16, 8192, 4608, 266752, 8388608, 262144, 32768, 4, 5316608, 131072, 0, 0, 218104512, 1
    .long 4, 16, 16, 8192, 4608, 266752, 8388608, 524288, 32768, 4, 6365184, 131072, 0, 0, 218104640, 1
    .long 1, 32, 32, 8192, 4096, 4352, 8388608, 2097152, 32768, 8, 46202880, 131072, 0, 0, 218105408, 4
    .long 2, 64, 72, 7168, 1536, 1536, 7340032, 524288, 32768, 8, 56385536, 114688, 0, 0, 218103872, 1
    .long 2, 64, 72, 7168, 512, 512, 7340032, 2097152, 32768, 8, 61874176, 114688, 0, 0, 218104064, 1
    .long 2, 64, 72, 7168, 6656, 6656, 7340032, 3145728, 32768, 8, 65642496, 114688, 0, 0, 218104240, 1
    .long 1, 80, 80, 2048, 1024, 1280, 7340032, 65536000, 114688, 7, 170934272, 32768, 218104192, 7, 218106752, 1
    .long 0, 0, 0, 0, 0, 0, 0, 0, 0, 0, 0, 0, 0, 0, 0, 0
    .long 0, 0, 0, 0, 0, 0, 0, 0, 0, 0, 0, 0, 0, 0, 0, 0
    .long 6, 16, 16, 8192, 6656, 268800, 8388608, 0, 32768, 4, 4300800, 131072, 0, 0, 218104416, 1
    .long 4, 16, 16, 8192, 6656, 268800, 8388608, 262144, 32768, 4, 5349376, 131072, 0, 0, 218104544, 1
    .long 4, 16, 16, 8192, 6656, 268800, 8388608, 524288, 32768, 4, 6397952, 131072, 0, 0, 218104672, 1
    .long 1, 32, 32, 8192, 6144, 6400, 8388608, 2097152, 32768, 8, 46235648, 131072, 0, 0, 218105440, 4
    .long 2, 64, 72, 7168, 1792, 1792, 7340032, 524288, 32768, 8, 56389632, 114688, 0, 0, 218103888, 1
    .long 2, 64, 72, 7168, 768, 768, 7340032, 2097152, 32768, 8, 61878272, 114688, 0, 0, 218104064, 1
    .long 2, 64, 72, 7168, 6912, 6912, 7340032, 3145728, 32768, 8, 65646592, 114688, 0, 0, 218104240, 1
    .long 1, 80, 80, 2048, 1536, 1792, 7340032, 65536000, 114688, 7, 170942464, 32768, 218104192, 7, 218106752, 1
    .long 0, 0, 0, 0, 0, 0, 0, 0, 0, 0, 0, 0, 0, 0, 0, 0
    .long 0, 0, 0, 0, 0, 0, 0, 0, 0, 0, 0, 0, 0, 0, 0, 0
    .long 6, 16, 16, 8192, 768, 262912, 8388608, 0, 32768, 4, 4206592, 131072, 0, 0, 218104320, 1
    .long 4, 16, 16, 8192, 768, 262912, 8388608, 262144, 32768, 4, 5255168, 131072, 0, 0, 218104448, 1
    .long 4, 16, 16, 8192, 768, 262912, 8388608, 524288, 32768, 4, 6303744, 131072, 0, 0, 218104576, 1
    .long 1, 32, 32, 8192, 512, 768, 8388608, 2097152, 32768, 8, 46145536, 131072, 0, 0, 218105344, 4
    .long 2, 64, 72, 7168, 2048, 2048, 7340032, 524288, 32768, 8, 56393728, 114688, 0, 0, 218103888, 1
    .long 2, 64, 72, 7168, 1024, 1024, 7340032, 2097152, 32768, 8, 61882368, 114688, 0, 0, 218104064, 1
    .long 2, 64, 72, 7168, 0, 0, 7340032, 3670016, 32768, 8, 67371008, 114688, 0, 0, 218104256, 1
    .long 1, 80, 80, 2048, 1835008, 1835264, 7340032, 65564672, 114688, 7, 175112192, 32768, 218104208, 7, 218106752, 1
    .long 0, 0, 0, 0, 0, 0, 0, 0, 0, 0, 0, 0, 0, 0, 0, 0
    .long 0, 0, 0, 0, 0, 0, 0, 0, 0, 0, 0, 0, 0, 0, 0, 0
    .long 6, 16, 16, 8192, 2816, 264960, 8388608, 0, 32768, 4, 4239360, 131072, 0, 0, 218104352, 1
    .long 4, 16, 16, 8192, 2816, 264960, 8388608, 262144, 32768, 4, 5287936, 131072, 0, 0, 218104480, 1
    .long 4, 16, 16, 8192, 2816, 264960, 8388608, 524288, 32768, 4, 6336512, 131072, 0, 0, 218104608, 1
    .long 1, 32, 32, 8192, 2560, 2816, 8388608, 2097152, 32768, 8, 46178304, 131072, 0, 0, 218105376, 4
    .long 2, 64, 72, 7168, 2304, 2304, 7340032, 524288, 32768, 8, 56397824, 114688, 0, 0, 218103888, 1
    .long 2, 64, 72, 7168, 1280, 1280, 7340032, 2097152, 32768, 8, 61886464, 114688, 0, 0, 218104064, 1
    .long 2, 64, 72, 7168, 256, 256, 7340032, 3670016, 32768, 8, 67375104, 114688, 0, 0, 218104256, 1
    .long 1, 80, 80, 2048, 1835520, 1835776, 7340032, 65564672, 114688, 7, 175120384, 32768, 218104208, 7, 218106752, 1
    .long 0, 0, 0, 0, 0, 0, 0, 0, 0, 0, 0, 0, 0, 0, 0, 0
    .long 0, 0, 0, 0, 0, 0, 0, 0, 0, 0, 0, 0, 0, 0, 0, 0
    .long 6, 16, 16, 8192, 4864, 267008, 8388608, 0, 32768, 4, 4272128, 131072, 0, 0, 218104384, 1
    .long 4, 16, 16, 8192, 4864, 267008, 8388608, 262144, 32768, 4, 5320704, 131072, 0, 0, 218104512, 1
    .long 4, 16, 16, 8192, 4864, 267008, 8388608, 524288, 32768, 4, 6369280, 131072, 0, 0, 218104640, 1
    .long 1, 32, 32, 8192, 4608, 4864, 8388608, 2097152, 32768, 8, 46211072, 131072, 0, 0, 218105408, 4
    .long 2, 64, 72, 7168, 2560, 2560, 7340032, 524288, 32768, 8, 56401920, 114688, 0, 0, 218103888, 1
    .long 2, 64, 72, 7168, 1536, 1536, 7340032, 2097152, 32768, 8, 61890560, 114688, 0, 0, 218104064, 1
    .long 2, 64, 72, 7168, 512, 512, 7340032, 3670016, 32768, 8, 67379200, 114688, 0, 0, 218104256, 1
    .long 1, 80, 80, 2048, 1836032, 1836288, 7340032, 65564672, 114688, 7, 175128576, 32768, 218104208, 7, 218106752, 1
    .long 0, 0, 0, 0, 0, 0, 0, 0, 0, 0, 0, 0, 0, 0, 0, 0
    .long 0, 0, 0, 0, 0, 0, 0, 0, 0, 0, 0, 0, 0, 0, 0, 0
    .long 6, 16, 16, 8192, 6912, 269056, 8388608, 0, 32768, 4, 4304896, 131072, 0, 0, 218104416, 1
    .long 4, 16, 16, 8192, 6912, 269056, 8388608, 262144, 32768, 4, 5353472, 131072, 0, 0, 218104544, 1
    .long 4, 16, 16, 8192, 6912, 269056, 8388608, 524288, 32768, 4, 6402048, 131072, 0, 0, 218104672, 1
    .long 1, 32, 32, 8192, 6656, 6912, 8388608, 2097152, 32768, 8, 46243840, 131072, 0, 0, 218105440, 4
    .long 2, 64, 72, 7168, 2816, 2816, 7340032, 524288, 32768, 8, 56406016, 114688, 0, 0, 218103888, 1
    .long 2, 64, 72, 7168, 1792, 1792, 7340032, 2097152, 32768, 8, 61894656, 114688, 0, 0, 218104080, 1
    .long 2, 64, 72, 7168, 768, 768, 7340032, 3670016, 32768, 8, 67383296, 114688, 0, 0, 218104256, 1
    .long 1, 80, 80, 2048, 1836544, 1836800, 7340032, 65564672, 114688, 7, 175136768, 32768, 218104208, 7, 218106752, 1
    .long 0, 0, 0, 0, 0, 0, 0, 0, 0, 0, 0, 0, 0, 0, 0, 0
    .long 0, 0, 0, 0, 0, 0, 0, 0, 0, 0, 0, 0, 0, 0, 0, 0
    .long 6, 16, 16, 8192, 1024, 263168, 8388608, 0, 32768, 4, 4210688, 131072, 0, 0, 218104336, 1
    .long 4, 16, 16, 8192, 1024, 263168, 8388608, 262144, 32768, 4, 5259264, 131072, 0, 0, 218104464, 1
    .long 4, 16, 16, 8192, 768, 262912, 8388608, 786432, 32768, 4, 7352320, 131072, 0, 0, 218104576, 1
    .long 1, 32, 32, 8192, 1024, 1280, 8388608, 2097152, 32768, 8, 46153728, 131072, 0, 0, 218105360, 4
    .long 2, 64, 72, 7168, 3072, 3072, 7340032, 524288, 32768, 8, 56410112, 114688, 0, 0, 218103888, 1
    .long 2, 64, 72, 7168, 2048, 2048, 7340032, 2097152, 32768, 8, 61898752, 114688, 0, 0, 218104080, 1
    .long 2, 64, 72, 7168, 1024, 1024, 7340032, 3670016, 32768, 8, 67387392, 114688, 0, 0, 218104256, 1
    .long 1, 80, 80, 2048, 3670016, 3670272, 7340032, 65593344, 114688, 7, 179306496, 32768, 218104224, 7, 218106752, 1
    .long 0, 0, 0, 0, 0, 0, 0, 0, 0, 0, 0, 0, 0, 0, 0, 0
    .long 0, 0, 0, 0, 0, 0, 0, 0, 0, 0, 0, 0, 0, 0, 0, 0
    .long 6, 16, 16, 8192, 3072, 265216, 8388608, 0, 32768, 4, 4243456, 131072, 0, 0, 218104368, 1
    .long 4, 16, 16, 8192, 3072, 265216, 8388608, 262144, 32768, 4, 5292032, 131072, 0, 0, 218104496, 1
    .long 4, 16, 16, 8192, 2816, 264960, 8388608, 786432, 32768, 4, 7385088, 131072, 0, 0, 218104608, 1
    .long 1, 32, 32, 8192, 3072, 3328, 8388608, 2097152, 32768, 8, 46186496, 131072, 0, 0, 218105392, 4
    .long 2, 64, 72, 7168, 3328, 3328, 7340032, 524288, 32768, 8, 56414208, 114688, 0, 0, 218103888, 1
    .long 2, 64, 72, 7168, 2304, 2304, 7340032, 2097152, 32768, 8, 61902848, 114688, 0, 0, 218104080, 1
    .long 2, 64, 72, 7168, 1280, 1280, 7340032, 3670016, 32768, 8, 67391488, 114688, 0, 0, 218104256, 1
    .long 1, 80, 80, 2048, 3670528, 3670784, 7340032, 65593344, 114688, 7, 179314688, 32768, 218104224, 7, 218106752, 1
    .long 0, 0, 0, 0, 0, 0, 0, 0, 0, 0, 0, 0, 0, 0, 0, 0
    .long 0, 0, 0, 0, 0, 0, 0, 0, 0, 0, 0, 0, 0, 0, 0, 0
    .long 6, 16, 16, 8192, 5120, 267264, 8388608, 0, 32768, 4, 4276224, 131072, 0, 0, 218104400, 1
    .long 4, 16, 16, 8192, 5120, 267264, 8388608, 262144, 32768, 4, 5324800, 131072, 0, 0, 218104528, 1
    .long 4, 16, 16, 8192, 4864, 267008, 8388608, 786432, 32768, 4, 7417856, 131072, 0, 0, 218104640, 1
    .long 1, 32, 32, 8192, 5120, 5376, 8388608, 2097152, 32768, 8, 46219264, 131072, 0, 0, 218105424, 4
    .long 2, 64, 72, 7168, 3584, 3584, 7340032, 524288, 32768, 8, 56418304, 114688, 0, 0, 218103904, 1
    .long 2, 64, 72, 7168, 2560, 2560, 7340032, 2097152, 32768, 8, 61906944, 114688, 0, 0, 218104080, 1
    .long 2, 64, 72, 7168, 1536, 1536, 7340032, 3670016, 32768, 8, 67395584, 114688, 0, 0, 218104256, 1
    .long 1, 80, 80, 2048, 3671040, 3671296, 7340032, 65593344, 114688, 7, 179322880, 32768, 218104224, 7, 218106752, 1
    .long 0, 0, 0, 0, 0, 0, 0, 0, 0, 0, 0, 0, 0, 0, 0, 0
    .long 0, 0, 0, 0, 0, 0, 0, 0, 0, 0, 0, 0, 0, 0, 0, 0
    .long 6, 16, 16, 8192, 7168, 269312, 8388608, 0, 32768, 4, 4308992, 131072, 0, 0, 218104432, 1
    .long 4, 16, 16, 8192, 7168, 269312, 8388608, 262144, 32768, 4, 5357568, 131072, 0, 0, 218104560, 1
    .long 4, 16, 16, 8192, 6912, 269056, 8388608, 786432, 32768, 4, 7450624, 131072, 0, 0, 218104672, 1
    .long 1, 32, 32, 8192, 7168, 7424, 8388608, 2097152, 32768, 8, 46252032, 131072, 0, 0, 218105456, 4
    .long 2, 64, 72, 7168, 3840, 3840, 7340032, 524288, 32768, 8, 56422400, 114688, 0, 0, 218103904, 1
    .long 2, 64, 72, 7168, 2816, 2816, 7340032, 2097152, 32768, 8, 61911040, 114688, 0, 0, 218104080, 1
    .long 2, 64, 72, 7168, 1792, 1792, 7340032, 3670016, 32768, 8, 67399680, 114688, 0, 0, 218104272, 1
    .long 1, 80, 80, 2048, 3671552, 3671808, 7340032, 65593344, 114688, 7, 179331072, 32768, 218104224, 7, 218106752, 1
    .long 0, 0, 0, 0, 0, 0, 0, 0, 0, 0, 0, 0, 0, 0, 0, 0
    .long 0, 0, 0, 0, 0, 0, 0, 0, 0, 0, 0, 0, 0, 0, 0, 0
    .long 6, 16, 16, 8192, 1280, 263424, 8388608, 0, 32768, 4, 4214784, 131072, 0, 0, 218104336, 1
    .long 4, 16, 16, 8192, 1280, 263424, 8388608, 262144, 32768, 4, 5263360, 131072, 0, 0, 218104464, 1
    .long 4, 16, 16, 8192, 512, 262656, 8388608, 786432, 32768, 4, 7348224, 131072, 0, 0, 218104576, 1
    .long 1, 32, 32, 8192, 1536, 1792, 8388608, 2097152, 32768, 8, 46161920, 131072, 0, 0, 218105360, 4
    .long 2, 64, 72, 7168, 4096, 4096, 7340032, 524288, 32768, 8, 56426496, 114688, 0, 0, 218103904, 1
    .long 2, 64, 72, 7168, 3072, 3072, 7340032, 2097152, 32768, 8, 61915136, 114688, 0, 0, 218104080, 1
    .long 2, 64, 72, 7168, 2048, 2048, 7340032, 3670016, 32768, 8, 67403776, 114688, 0, 0, 218104272, 1
    .long 1, 80, 80, 2048, 5505024, 5505280, 7340032, 65622016, 114688, 7, 183500800, 32768, 218104240, 7, 218106752, 1
    .long 0, 0, 0, 0, 0, 0, 0, 0, 0, 0, 0, 0, 0, 0, 0, 0
    .long 0, 0, 0, 0, 0, 0, 0, 0, 0, 0, 0, 0, 0, 0, 0, 0
    .long 6, 16, 16, 8192, 3328, 265472, 8388608, 0, 32768, 4, 4247552, 131072, 0, 0, 218104368, 1
    .long 4, 16, 16, 8192, 3328, 265472, 8388608, 262144, 32768, 4, 5296128, 131072, 0, 0, 218104496, 1
    .long 4, 16, 16, 8192, 2560, 264704, 8388608, 786432, 32768, 4, 7380992, 131072, 0, 0, 218104608, 1
    .long 1, 32, 32, 8192, 3584, 3840, 8388608, 2097152, 32768, 8, 46194688, 131072, 0, 0, 218105392, 4
    .long 2, 64, 72, 7168, 4352, 4352, 7340032, 524288, 32768, 8, 56430592, 114688, 0, 0, 218103904, 1
    .long 2, 64, 72, 7168, 3328, 3328, 7340032, 2097152, 32768, 8, 61919232, 114688, 0, 0, 218104080, 1
    .long 2, 64, 72, 7168, 2304, 2304, 7340032, 3670016, 32768, 8, 67407872, 114688, 0, 0, 218104272, 1
    .long 1, 80, 80, 2048, 5505536, 5505792, 7340032, 65622016, 114688, 7, 183508992, 32768, 218104240, 7, 218106752, 1
    .long 0, 0, 0, 0, 0, 0, 0, 0, 0, 0, 0, 0, 0, 0, 0, 0
    .long 0, 0, 0, 0, 0, 0, 0, 0, 0, 0, 0, 0, 0, 0, 0, 0
    .long 6, 16, 16, 8192, 5376, 267520, 8388608, 0, 32768, 4, 4280320, 131072, 0, 0, 218104400, 1
    .long 4, 16, 16, 8192, 5376, 267520, 8388608, 262144, 32768, 4, 5328896, 131072, 0, 0, 218104528, 1
    .long 4, 16, 16, 8192, 4608, 266752, 8388608, 786432, 32768, 4, 7413760, 131072, 0, 0, 218104640, 1
    .long 1, 32, 32, 8192, 5632, 5888, 8388608, 2097152, 32768, 8, 46227456, 131072, 0, 0, 218105424, 4
    .long 2, 64, 72, 7168, 4608, 4608, 7340032, 524288, 32768, 8, 56434688, 114688, 0, 0, 218103904, 1
    .long 2, 64, 72, 7168, 3584, 3584, 7340032, 2097152, 32768, 8, 61923328, 114688, 0, 0, 218104096, 1
    .long 2, 64, 72, 7168, 2560, 2560, 7340032, 3670016, 32768, 8, 67411968, 114688, 0, 0, 218104272, 1
    .long 1, 80, 80, 2048, 5506048, 5506304, 7340032, 65622016, 114688, 7, 183517184, 32768, 218104240, 7, 218106752, 1
    .long 0, 0, 0, 0, 0, 0, 0, 0, 0, 0, 0, 0, 0, 0, 0, 0
    .long 0, 0, 0, 0, 0, 0, 0, 0, 0, 0, 0, 0, 0, 0, 0, 0
    .long 6, 16, 16, 8192, 7424, 269568, 8388608, 0, 32768, 4, 4313088, 131072, 0, 0, 218104432, 1
    .long 4, 16, 16, 8192, 7424, 269568, 8388608, 262144, 32768, 4, 5361664, 131072, 0, 0, 218104560, 1
    .long 4, 16, 16, 8192, 6656, 268800, 8388608, 786432, 32768, 4, 7446528, 131072, 0, 0, 218104672, 1
    .long 1, 32, 32, 8192, 7680, 7936, 8388608, 2097152, 32768, 8, 46260224, 131072, 0, 0, 218105456, 4
    .long 2, 64, 72, 7168, 4864, 4864, 7340032, 524288, 32768, 8, 56438784, 114688, 0, 0, 218103904, 1
    .long 2, 64, 72, 7168, 3840, 3840, 7340032, 2097152, 32768, 8, 61927424, 114688, 0, 0, 218104096, 1
    .long 2, 64, 72, 7168, 2816, 2816, 7340032, 3670016, 32768, 8, 67416064, 114688, 0, 0, 218104272, 1
    .long 1, 80, 80, 2048, 5506560, 5506816, 7340032, 65622016, 114688, 7, 183525376, 32768, 218104240, 7, 218106752, 1
    .long 0, 0, 0, 0, 0, 0, 0, 0, 0, 0, 0, 0, 0, 0, 0, 0
    .long 0, 0, 0, 0, 0, 0, 0, 0, 0, 0, 0, 0, 0, 0, 0, 0
    .long 6, 16, 16, 8192, 1536, 263680, 8388608, 0, 32768, 4, 4218880, 131072, 0, 0, 218104336, 1
    .long 4, 16, 16, 8192, 1536, 263680, 8388608, 262144, 32768, 4, 5267456, 131072, 0, 0, 218104464, 1
    .long 4, 16, 16, 8192, 256, 262400, 8388608, 786432, 32768, 4, 7344128, 131072, 0, 0, 218104576, 1
    .long 1, 24, 24, 8192, 0, 256, 8388608, 2097152, 32768, 8, 29360128, 131072, 0, 0, 218105344, 4
    .long 2, 64, 72, 7168, 5120, 5120, 7340032, 524288, 32768, 8, 56442880, 114688, 0, 0, 218103904, 1
    .long 2, 64, 72, 7168, 4096, 4096, 7340032, 2097152, 32768, 8, 61931520, 114688, 0, 0, 218104096, 1
    .long 2, 64, 72, 7168, 3072, 3072, 7340032, 3670016, 32768, 8, 67420160, 114688, 0, 0, 218104272, 1
    .long 1, 80, 80, 2048, 0, 256, 7340032, 67371008, 114688, 7, 171442176, 32768, 218104256, 7, 218106816, 1
    .long 0, 0, 0, 0, 0, 0, 0, 0, 0, 0, 0, 0, 0, 0, 0, 0
    .long 0, 0, 0, 0, 0, 0, 0, 0, 0, 0, 0, 0, 0, 0, 0, 0
    .long 6, 16, 16, 8192, 3584, 265728, 8388608, 0, 32768, 4, 4251648, 131072, 0, 0, 218104368, 1
    .long 4, 16, 16, 8192, 3584, 265728, 8388608, 262144, 32768, 4, 5300224, 131072, 0, 0, 218104496, 1
    .long 4, 16, 16, 8192, 2304, 264448, 8388608, 786432, 32768, 4, 7376896, 131072, 0, 0, 218104608, 1
    .long 1, 24, 24, 8192, 2048, 2304, 8388608, 2097152, 32768, 8, 29392896, 131072, 0, 0, 218105376, 4
    .long 2, 64, 72, 7168, 5376, 5376, 7340032, 524288, 32768, 8, 56446976, 114688, 0, 0, 218103920, 1
    .long 2, 64, 72, 7168, 4352, 4352, 7340032, 2097152, 32768, 8, 61935616, 114688, 0, 0, 218104096, 1
    .long 2, 64, 72, 7168, 3328, 3328, 7340032, 3670016, 32768, 8, 67424256, 114688, 0, 0, 218104272, 1
    .long 1, 80, 80, 2048, 512, 768, 7340032, 67371008, 114688, 7, 171450368, 32768, 218104256, 7, 218106816, 1
    .long 0, 0, 0, 0, 0, 0, 0, 0, 0, 0, 0, 0, 0, 0, 0, 0
    .long 0, 0, 0, 0, 0, 0, 0, 0, 0, 0, 0, 0, 0, 0, 0, 0
    .long 6, 16, 16, 8192, 5632, 267776, 8388608, 0, 32768, 4, 4284416, 131072, 0, 0, 218104400, 1
    .long 4, 16, 16, 8192, 5632, 267776, 8388608, 262144, 32768, 4, 5332992, 131072, 0, 0, 218104528, 1
    .long 4, 16, 16, 8192, 4352, 266496, 8388608, 786432, 32768, 4, 7409664, 131072, 0, 0, 218104640, 1
    .long 1, 24, 24, 8192, 4096, 4352, 8388608, 2097152, 32768, 8, 29425664, 131072, 0, 0, 218105408, 4
    .long 2, 64, 72, 7168, 5632, 5632, 7340032, 524288, 32768, 8, 56451072, 114688, 0, 0, 218103920, 1
    .long 2, 64, 72, 7168, 4608, 4608, 7340032, 2097152, 32768, 8, 61939712, 114688, 0, 0, 218104096, 1
    .long 2, 64, 72, 7168, 3584, 3584, 7340032, 3670016, 32768, 8, 67428352, 114688, 0, 0, 218104288, 1
    .long 1, 80, 80, 2048, 1024, 1280, 7340032, 67371008, 114688, 7, 171458560, 32768, 218104256, 7, 218106816, 1
    .long 0, 0, 0, 0, 0, 0, 0, 0, 0, 0, 0, 0, 0, 0, 0, 0
    .long 0, 0, 0, 0, 0, 0, 0, 0, 0, 0, 0, 0, 0, 0, 0, 0
    .long 6, 16, 16, 8192, 7680, 269824, 8388608, 0, 32768, 4, 4317184, 131072, 0, 0, 218104432, 1
    .long 4, 16, 16, 8192, 7680, 269824, 8388608, 262144, 32768, 4, 5365760, 131072, 0, 0, 218104560, 1
    .long 4, 16, 16, 8192, 6400, 268544, 8388608, 786432, 32768, 4, 7442432, 131072, 0, 0, 218104672, 1
    .long 1, 24, 24, 8192, 6144, 6400, 8388608, 2097152, 32768, 8, 29458432, 131072, 0, 0, 218105440, 4
    .long 2, 64, 72, 7168, 5888, 5888, 7340032, 524288, 32768, 8, 56455168, 114688, 0, 0, 218103920, 1
    .long 2, 64, 72, 7168, 4864, 4864, 7340032, 2097152, 32768, 8, 61943808, 114688, 0, 0, 218104096, 1
    .long 2, 64, 72, 7168, 3840, 3840, 7340032, 3670016, 32768, 8, 67432448, 114688, 0, 0, 218104288, 1
    .long 1, 80, 80, 2048, 1536, 1792, 7340032, 67371008, 114688, 7, 171466752, 32768, 218104256, 7, 218106816, 1
    .long 0, 0, 0, 0, 0, 0, 0, 0, 0, 0, 0, 0, 0, 0, 0, 0
    .long 0, 0, 0, 0, 0, 0, 0, 0, 0, 0, 0, 0, 0, 0, 0, 0
    .long 6, 16, 16, 8192, 1792, 263936, 8388608, 0, 32768, 4, 4222976, 131072, 0, 0, 218104336, 1
    .long 4, 16, 16, 8192, 1792, 263936, 8388608, 262144, 32768, 4, 5271552, 131072, 0, 0, 218104464, 1
    .long 4, 16, 16, 8192, 0, 262144, 8388608, 786432, 32768, 4, 7340032, 131072, 0, 0, 218104576, 1
    .long 1, 24, 24, 8192, 512, 768, 8388608, 2097152, 32768, 8, 29368320, 131072, 0, 0, 218105344, 4
    .long 2, 64, 72, 7168, 6144, 6144, 7340032, 524288, 32768, 8, 56459264, 114688, 0, 0, 218103920, 1
    .long 2, 64, 72, 7168, 5120, 5120, 7340032, 2097152, 32768, 8, 61947904, 114688, 0, 0, 218104096, 1
    .long 2, 64, 72, 7168, 4096, 4096, 7340032, 3670016, 32768, 8, 67436544, 114688, 0, 0, 218104288, 1
    .long 1, 80, 80, 2048, 1835008, 1835264, 7340032, 67399680, 114688, 7, 175636480, 32768, 218104272, 7, 218106816, 1
    .long 0, 0, 0, 0, 0, 0, 0, 0, 0, 0, 0, 0, 0, 0, 0, 0
    .long 0, 0, 0, 0, 0, 0, 0, 0, 0, 0, 0, 0, 0, 0, 0, 0
    .long 6, 16, 16, 8192, 3840, 265984, 8388608, 0, 32768, 4, 4255744, 131072, 0, 0, 218104368, 1
    .long 4, 16, 16, 8192, 3840, 265984, 8388608, 262144, 32768, 4, 5304320, 131072, 0, 0, 218104496, 1
    .long 4, 16, 16, 8192, 2048, 264192, 8388608, 786432, 32768, 4, 7372800, 131072, 0, 0, 218104608, 1
    .long 1, 24, 24, 8192, 2560, 2816, 8388608, 2097152, 32768, 8, 29401088, 131072, 0, 0, 218105376, 4
    .long 2, 64, 72, 7168, 6400, 6400, 7340032, 524288, 32768, 8, 56463360, 114688, 0, 0, 218103920, 1
    .long 2, 64, 72, 7168, 5376, 5376, 7340032, 2097152, 32768, 8, 61952000, 114688, 0, 0, 218104112, 1
    .long 2, 64, 72, 7168, 4352, 4352, 7340032, 3670016, 32768, 8, 67440640, 114688, 0, 0, 218104288, 1
    .long 1, 80, 80, 2048, 1835520, 1835776, 7340032, 67399680, 114688, 7, 175644672, 32768, 218104272, 7, 218106816, 1
    .long 0, 0, 0, 0, 0, 0, 0, 0, 0, 0, 0, 0, 0, 0, 0, 0
    .long 0, 0, 0, 0, 0, 0, 0, 0, 0, 0, 0, 0, 0, 0, 0, 0
    .long 6, 16, 16, 8192, 5888, 268032, 8388608, 0, 32768, 4, 4288512, 131072, 0, 0, 218104400, 1
    .long 4, 16, 16, 8192, 5888, 268032, 8388608, 262144, 32768, 4, 5337088, 131072, 0, 0, 218104528, 1
    .long 4, 16, 16, 8192, 4096, 266240, 8388608, 786432, 32768, 4, 7405568, 131072, 0, 0, 218104640, 1
    .long 1, 24, 24, 8192, 4608, 4864, 8388608, 2097152, 32768, 8, 29433856, 131072, 0, 0, 218105408, 4
    .long 2, 64, 72, 7168, 6656, 6656, 7340032, 524288, 32768, 8, 56467456, 114688, 0, 0, 218103920, 1
    .long 2, 64, 72, 7168, 5632, 5632, 7340032, 2097152, 32768, 8, 61956096, 114688, 0, 0, 218104112, 1
    .long 2, 64, 72, 7168, 4608, 4608, 7340032, 3670016, 32768, 8, 67444736, 114688, 0, 0, 218104288, 1
    .long 1, 80, 80, 2048, 1836032, 1836288, 7340032, 67399680, 114688, 7, 175652864, 32768, 218104272, 7, 218106816, 1
    .long 0, 0, 0, 0, 0, 0, 0, 0, 0, 0, 0, 0, 0, 0, 0, 0
    .long 0, 0, 0, 0, 0, 0, 0, 0, 0, 0, 0, 0, 0, 0, 0, 0
    .long 6, 16, 16, 8192, 7936, 270080, 8388608, 0, 32768, 4, 4321280, 131072, 0, 0, 218104432, 1
    .long 4, 16, 16, 8192, 7936, 270080, 8388608, 262144, 32768, 4, 5369856, 131072, 0, 0, 218104560, 1
    .long 4, 16, 16, 8192, 6144, 268288, 8388608, 786432, 32768, 4, 7438336, 131072, 0, 0, 218104672, 1
    .long 1, 24, 24, 8192, 6656, 6912, 8388608, 2097152, 32768, 8, 29466624, 131072, 0, 0, 218105440, 4
    .long 2, 64, 72, 7168, 6912, 6912, 7340032, 524288, 32768, 8, 56471552, 114688, 0, 0, 218103920, 1
    .long 2, 64, 72, 7168, 5888, 5888, 7340032, 2097152, 32768, 8, 61960192, 114688, 0, 0, 218104112, 1
    .long 2, 64, 72, 7168, 4864, 4864, 7340032, 3670016, 32768, 8, 67448832, 114688, 0, 0, 218104288, 1
    .long 1, 80, 80, 2048, 1836544, 1836800, 7340032, 67399680, 114688, 7, 175661056, 32768, 218104272, 7, 218106816, 1
    .long 0, 0, 0, 0, 0, 0, 0, 0, 0, 0, 0, 0, 0, 0, 0, 0
    .long 0, 0, 0, 0, 0, 0, 0, 0, 0, 0, 0, 0, 0, 0, 0, 0
    .long 1, 32, 32, 8192, 0, 256, 8388608, 524288, 32768, 8, 39845888, 131072, 0, 0, 218104576, 4
    .long 1, 16, 16, 8192, 0, 256, 8388608, 1048576, 32768, 8, 8388608, 131072, 0, 0, 218104832, 4
    .long 1, 24, 24, 8192, 0, 256, 8388608, 2621440, 32768, 8, 31457280, 131072, 0, 0, 218105600, 4
    .long 1, 16, 16, 8192, 0, 256, 8388608, 3145728, 32768, 8, 16777216, 131072, 0, 0, 218105856, 4
    .long 1, 16, 16, 8192, 0, 256, 8388608, 3670016, 32768, 8, 18874368, 131072, 0, 0, 218106112, 4
    .long 1, 80, 80, 2048, 0, 256, 7340032, 58195968, 114688, 7, 168820736, 32768, 218103936, 7, 218106496, 1
    .long 0, 0, 0, 0, 0, 0, 0, 0, 0, 0, 0, 0, 0, 0, 0, 0
    .long 0, 0, 0, 0, 0, 0, 0, 0, 0, 0, 0, 0, 0, 0, 0, 0
    .long 0, 0, 0, 0, 0, 0, 0, 0, 0, 0, 0, 0, 0, 0, 0, 0
    .long 0, 0, 0, 0, 0, 0, 0, 0, 0, 0, 0, 0, 0, 0, 0, 0
    .long 1, 32, 32, 8192, 2048, 2304, 8388608, 524288, 32768, 8, 39878656, 131072, 0, 0, 218104608, 4
    .long 1, 16, 16, 8192, 2048, 2304, 8388608, 1048576, 32768, 8, 8421376, 131072, 0, 0, 218104864, 4
    .long 1, 24, 24, 8192, 2048, 2304, 8388608, 2621440, 32768, 8, 31490048, 131072, 0, 0, 218105632, 4
    .long 1, 16, 16, 8192, 2048, 2304, 8388608, 3145728, 32768, 8, 16809984, 131072, 0, 0, 218105888, 4
    .long 1, 16, 16, 8192, 2048, 2304, 8388608, 3670016, 32768, 8, 18907136, 131072, 0, 0, 218106144, 4
    .long 1, 80, 80, 2048, 512, 768, 7340032, 58195968, 114688, 7, 168828928, 32768, 218103936, 7, 218106496, 1
    .long 0, 0, 0, 0, 0, 0, 0, 0, 0, 0, 0, 0, 0, 0, 0, 0
    .long 0, 0, 0, 0, 0, 0, 0, 0, 0, 0, 0, 0, 0, 0, 0, 0
    .long 0, 0, 0, 0, 0, 0, 0, 0, 0, 0, 0, 0, 0, 0, 0, 0
    .long 0, 0, 0, 0, 0, 0, 0, 0, 0, 0, 0, 0, 0, 0, 0, 0
    .long 1, 32, 32, 8192, 4096, 4352, 8388608, 524288, 32768, 8, 39911424, 131072, 0, 0, 218104640, 4
    .long 1, 16, 16, 8192, 4096, 4352, 8388608, 1048576, 32768, 8, 8454144, 131072, 0, 0, 218104896, 4
    .long 1, 24, 24, 8192, 4096, 4352, 8388608, 2621440, 32768, 8, 31522816, 131072, 0, 0, 218105664, 4
    .long 1, 16, 16, 8192, 4096, 4352, 8388608, 3145728, 32768, 8, 16842752, 131072, 0, 0, 218105920, 4
    .long 1, 16, 16, 8192, 4096, 4352, 8388608, 3670016, 32768, 8, 18939904, 131072, 0, 0, 218106176, 4
    .long 1, 80, 80, 2048, 1024, 1280, 7340032, 58195968, 114688, 7, 168837120, 32768, 218103936, 7, 218106496, 1
    .long 0, 0, 0, 0, 0, 0, 0, 0, 0, 0, 0, 0, 0, 0, 0, 0
    .long 0, 0, 0, 0, 0, 0, 0, 0, 0, 0, 0, 0, 0, 0, 0, 0
    .long 0, 0, 0, 0, 0, 0, 0, 0, 0, 0, 0, 0, 0, 0, 0, 0
    .long 0, 0, 0, 0, 0, 0, 0, 0, 0, 0, 0, 0, 0, 0, 0, 0
    .long 1, 32, 32, 8192, 6144, 6400, 8388608, 524288, 32768, 8, 39944192, 131072, 0, 0, 218104672, 4
    .long 1, 16, 16, 8192, 6144, 6400, 8388608, 1048576, 32768, 8, 8486912, 131072, 0, 0, 218104928, 4
    .long 1, 24, 24, 8192, 6144, 6400, 8388608, 2621440, 32768, 8, 31555584, 131072, 0, 0, 218105696, 4
    .long 1, 16, 16, 8192, 6144, 6400, 8388608, 3145728, 32768, 8, 16875520, 131072, 0, 0, 218105952, 4
    .long 1, 16, 16, 8192, 6144, 6400, 8388608, 3670016, 32768, 8, 18972672, 131072, 0, 0, 218106208, 4
    .long 1, 80, 80, 2048, 1536, 1792, 7340032, 58195968, 114688, 7, 168845312, 32768, 218103936, 7, 218106496, 1
    .long 0, 0, 0, 0, 0, 0, 0, 0, 0, 0, 0, 0, 0, 0, 0, 0
    .long 0, 0, 0, 0, 0, 0, 0, 0, 0, 0, 0, 0, 0, 0, 0, 0
    .long 0, 0, 0, 0, 0, 0, 0, 0, 0, 0, 0, 0, 0, 0, 0, 0
    .long 0, 0, 0, 0, 0, 0, 0, 0, 0, 0, 0, 0, 0, 0, 0, 0
    .long 1, 32, 32, 8192, 512, 768, 8388608, 524288, 32768, 8, 39854080, 131072, 0, 0, 218104576, 4
    .long 1, 16, 16, 8192, 512, 768, 8388608, 1048576, 32768, 8, 8396800, 131072, 0, 0, 218104832, 4
    .long 1, 24, 24, 8192, 512, 768, 8388608, 2621440, 32768, 8, 31465472, 131072, 0, 0, 218105600, 4
    .long 1, 16, 16, 8192, 512, 768, 8388608, 3145728, 32768, 8, 16785408, 131072, 0, 0, 218105856, 4
    .long 1, 16, 16, 8192, 512, 768, 8388608, 3670016, 32768, 8, 18882560, 131072, 0, 0, 218106112, 4
    .long 1, 80, 80, 2048, 1835008, 1835264, 7340032, 58224640, 114688, 7, 173015040, 32768, 218103952, 7, 218106496, 1
    .long 0, 0, 0, 0, 0, 0, 0, 0, 0, 0, 0, 0, 0, 0, 0, 0
    .long 0, 0, 0, 0, 0, 0, 0, 0, 0, 0, 0, 0, 0, 0, 0, 0
    .long 0, 0, 0, 0, 0, 0, 0, 0, 0, 0, 0, 0, 0, 0, 0, 0
    .long 0, 0, 0, 0, 0, 0, 0, 0, 0, 0, 0, 0, 0, 0, 0, 0
    .long 1, 32, 32, 8192, 2560, 2816, 8388608, 524288, 32768, 8, 39886848, 131072, 0, 0, 218104608, 4
    .long 1, 16, 16, 8192, 2560, 2816, 8388608, 1048576, 32768, 8, 8429568, 131072, 0, 0, 218104864, 4
    .long 1, 24, 24, 8192, 2560, 2816, 8388608, 2621440, 32768, 8, 31498240, 131072, 0, 0, 218105632, 4
    .long 1, 16, 16, 8192, 2560, 2816, 8388608, 3145728, 32768, 8, 16818176, 131072, 0, 0, 218105888, 4
    .long 1, 16, 16, 8192, 2560, 2816, 8388608, 3670016, 32768, 8, 18915328, 131072, 0, 0, 218106144, 4
    .long 1, 80, 80, 2048, 1835520, 1835776, 7340032, 58224640, 114688, 7, 173023232, 32768, 218103952, 7, 218106496, 1
    .long 0, 0, 0, 0, 0, 0, 0, 0, 0, 0, 0, 0, 0, 0, 0, 0
    .long 0, 0, 0, 0, 0, 0, 0, 0, 0, 0, 0, 0, 0, 0, 0, 0
    .long 0, 0, 0, 0, 0, 0, 0, 0, 0, 0, 0, 0, 0, 0, 0, 0
    .long 0, 0, 0, 0, 0, 0, 0, 0, 0, 0, 0, 0, 0, 0, 0, 0
    .long 1, 32, 32, 8192, 4608, 4864, 8388608, 524288, 32768, 8, 39919616, 131072, 0, 0, 218104640, 4
    .long 1, 16, 16, 8192, 4608, 4864, 8388608, 1048576, 32768, 8, 8462336, 131072, 0, 0, 218104896, 4
    .long 1, 24, 24, 8192, 4608, 4864, 8388608, 2621440, 32768, 8, 31531008, 131072, 0, 0, 218105664, 4
    .long 1, 16, 16, 8192, 4608, 4864, 8388608, 3145728, 32768, 8, 16850944, 131072, 0, 0, 218105920, 4
    .long 1, 16, 16, 8192, 4608, 4864, 8388608, 3670016, 32768, 8, 18948096, 131072, 0, 0, 218106176, 4
    .long 1, 80, 80, 2048, 1836032, 1836288, 7340032, 58224640, 114688, 7, 173031424, 32768, 218103952, 7, 218106496, 1
    .long 0, 0, 0, 0, 0, 0, 0, 0, 0, 0, 0, 0, 0, 0, 0, 0
    .long 0, 0, 0, 0, 0, 0, 0, 0, 0, 0, 0, 0, 0, 0, 0, 0
    .long 0, 0, 0, 0, 0, 0, 0, 0, 0, 0, 0, 0, 0, 0, 0, 0
    .long 0, 0, 0, 0, 0, 0, 0, 0, 0, 0, 0, 0, 0, 0, 0, 0
    .long 1, 32, 32, 8192, 6656, 6912, 8388608, 524288, 32768, 8, 39952384, 131072, 0, 0, 218104672, 4
    .long 1, 16, 16, 8192, 6656, 6912, 8388608, 1048576, 32768, 8, 8495104, 131072, 0, 0, 218104928, 4
    .long 1, 24, 24, 8192, 6656, 6912, 8388608, 2621440, 32768, 8, 31563776, 131072, 0, 0, 218105696, 4
    .long 1, 16, 16, 8192, 6656, 6912, 8388608, 3145728, 32768, 8, 16883712, 131072, 0, 0, 218105952, 4
    .long 1, 16, 16, 8192, 6656, 6912, 8388608, 3670016, 32768, 8, 18980864, 131072, 0, 0, 218106208, 4
    .long 1, 80, 80, 2048, 1836544, 1836800, 7340032, 58224640, 114688, 7, 173039616, 32768, 218103952, 7, 218106496, 1
    .long 0, 0, 0, 0, 0, 0, 0, 0, 0, 0, 0, 0, 0, 0, 0, 0
    .long 0, 0, 0, 0, 0, 0, 0, 0, 0, 0, 0, 0, 0, 0, 0, 0
    .long 0, 0, 0, 0, 0, 0, 0, 0, 0, 0, 0, 0, 0, 0, 0, 0
    .long 0, 0, 0, 0, 0, 0, 0, 0, 0, 0, 0, 0, 0, 0, 0, 0
    .long 1, 32, 32, 8192, 1024, 1280, 8388608, 524288, 32768, 8, 39862272, 131072, 0, 0, 218104592, 4
    .long 1, 16, 16, 8192, 1024, 1280, 8388608, 1048576, 32768, 8, 8404992, 131072, 0, 0, 218104848, 4
    .long 1, 24, 24, 8192, 1024, 1280, 8388608, 2621440, 32768, 8, 31473664, 131072, 0, 0, 218105616, 4
    .long 1, 16, 16, 8192, 1024, 1280, 8388608, 3145728, 32768, 8, 16793600, 131072, 0, 0, 218105872, 4
    .long 1, 16, 16, 8192, 1024, 1280, 8388608, 3670016, 32768, 8, 18890752, 131072, 0, 0, 218106128, 4
    .long 1, 80, 80, 2048, 3670016, 3670272, 7340032, 58253312, 114688, 7, 177209344, 32768, 218103968, 7, 218106496, 1
    .long 0, 0, 0, 0, 0, 0, 0, 0, 0, 0, 0, 0, 0, 0, 0, 0
    .long 0, 0, 0, 0, 0, 0, 0, 0, 0, 0, 0, 0, 0, 0, 0, 0
    .long 0, 0, 0, 0, 0, 0, 0, 0, 0, 0, 0, 0, 0, 0, 0, 0
    .long 0, 0, 0, 0, 0, 0, 0, 0, 0, 0, 0, 0, 0, 0, 0, 0
    .long 1, 32, 32, 8192, 3072, 3328, 8388608, 524288, 32768, 8, 39895040, 131072, 0, 0, 218104624, 4
    .long 1, 16, 16, 8192, 3072, 3328, 8388608, 1048576, 32768, 8, 8437760, 131072, 0, 0, 218104880, 4
    .long 1, 24, 24, 8192, 3072, 3328, 8388608, 2621440, 32768, 8, 31506432, 131072, 0, 0, 218105648, 4
    .long 1, 16, 16, 8192, 3072, 3328, 8388608, 3145728, 32768, 8, 16826368, 131072, 0, 0, 218105904, 4
    .long 1, 16, 16, 8192, 3072, 3328, 8388608, 3670016, 32768, 8, 18923520, 131072, 0, 0, 218106160, 4
    .long 1, 80, 80, 2048, 3670528, 3670784, 7340032, 58253312, 114688, 7, 177217536, 32768, 218103968, 7, 218106496, 1
    .long 0, 0, 0, 0, 0, 0, 0, 0, 0, 0, 0, 0, 0, 0, 0, 0
    .long 0, 0, 0, 0, 0, 0, 0, 0, 0, 0, 0, 0, 0, 0, 0, 0
    .long 0, 0, 0, 0, 0, 0, 0, 0, 0, 0, 0, 0, 0, 0, 0, 0
    .long 0, 0, 0, 0, 0, 0, 0, 0, 0, 0, 0, 0, 0, 0, 0, 0
    .long 1, 32, 32, 8192, 5120, 5376, 8388608, 524288, 32768, 8, 39927808, 131072, 0, 0, 218104656, 4
    .long 1, 16, 16, 8192, 5120, 5376, 8388608, 1048576, 32768, 8, 8470528, 131072, 0, 0, 218104912, 4
    .long 1, 24, 24, 8192, 5120, 5376, 8388608, 2621440, 32768, 8, 31539200, 131072, 0, 0, 218105680, 4
    .long 1, 16, 16, 8192, 5120, 5376, 8388608, 3145728, 32768, 8, 16859136, 131072, 0, 0, 218105936, 4
    .long 1, 16, 16, 8192, 5120, 5376, 8388608, 3670016, 32768, 8, 18956288, 131072, 0, 0, 218106192, 4
    .long 1, 80, 80, 2048, 3671040, 3671296, 7340032, 58253312, 114688, 7, 177225728, 32768, 218103968, 7, 218106496, 1
    .long 0, 0, 0, 0, 0, 0, 0, 0, 0, 0, 0, 0, 0, 0, 0, 0
    .long 0, 0, 0, 0, 0, 0, 0, 0, 0, 0, 0, 0, 0, 0, 0, 0
    .long 0, 0, 0, 0, 0, 0, 0, 0, 0, 0, 0, 0, 0, 0, 0, 0
    .long 0, 0, 0, 0, 0, 0, 0, 0, 0, 0, 0, 0, 0, 0, 0, 0
    .long 1, 32, 32, 8192, 7168, 7424, 8388608, 524288, 32768, 8, 39960576, 131072, 0, 0, 218104688, 4
    .long 1, 16, 16, 8192, 7168, 7424, 8388608, 1048576, 32768, 8, 8503296, 131072, 0, 0, 218104944, 4
    .long 1, 24, 24, 8192, 7168, 7424, 8388608, 2621440, 32768, 8, 31571968, 131072, 0, 0, 218105712, 4
    .long 1, 16, 16, 8192, 7168, 7424, 8388608, 3145728, 32768, 8, 16891904, 131072, 0, 0, 218105968, 4
    .long 1, 16, 16, 8192, 7168, 7424, 8388608, 3670016, 32768, 8, 18989056, 131072, 0, 0, 218106224, 4
    .long 1, 80, 80, 2048, 3671552, 3671808, 7340032, 58253312, 114688, 7, 177233920, 32768, 218103968, 7, 218106496, 1
    .long 0, 0, 0, 0, 0, 0, 0, 0, 0, 0, 0, 0, 0, 0, 0, 0
    .long 0, 0, 0, 0, 0, 0, 0, 0, 0, 0, 0, 0, 0, 0, 0, 0
    .long 0, 0, 0, 0, 0, 0, 0, 0, 0, 0, 0, 0, 0, 0, 0, 0
    .long 0, 0, 0, 0, 0, 0, 0, 0, 0, 0, 0, 0, 0, 0, 0, 0
    .long 1, 32, 32, 8192, 1536, 1792, 8388608, 524288, 32768, 8, 39870464, 131072, 0, 0, 218104592, 4
    .long 1, 16, 16, 8192, 1536, 1792, 8388608, 1048576, 32768, 8, 8413184, 131072, 0, 0, 218104848, 4
    .long 1, 24, 24, 8192, 1536, 1792, 8388608, 2621440, 32768, 8, 31481856, 131072, 0, 0, 218105616, 4
    .long 1, 16, 16, 8192, 1536, 1792, 8388608, 3145728, 32768, 8, 16801792, 131072, 0, 0, 218105872, 4
    .long 1, 16, 16, 8192, 1536, 1792, 8388608, 3670016, 32768, 8, 18898944, 131072, 0, 0, 218106128, 4
    .long 1, 80, 80, 2048, 5505024, 5505280, 7340032, 58281984, 114688, 7, 181403648, 32768, 218103984, 7, 218106496, 1
    .long 0, 0, 0, 0, 0, 0, 0, 0, 0, 0, 0, 0, 0, 0, 0, 0
    .long 0, 0, 0, 0, 0, 0, 0, 0, 0, 0, 0, 0, 0, 0, 0, 0
    .long 0, 0, 0, 0, 0, 0, 0, 0, 0, 0, 0, 0, 0, 0, 0, 0
    .long 0, 0, 0, 0, 0, 0, 0, 0, 0, 0, 0, 0, 0, 0, 0, 0
    .long 1, 32, 32, 8192, 3584, 3840, 8388608, 524288, 32768, 8, 39903232, 131072, 0, 0, 218104624, 4
    .long 1, 16, 16, 8192, 3584, 3840, 8388608, 1048576, 32768, 8, 8445952, 131072, 0, 0, 218104880, 4
    .long 1, 24, 24, 8192, 3584, 3840, 8388608, 2621440, 32768, 8, 31514624, 131072, 0, 0, 218105648, 4
    .long 1, 16, 16, 8192, 3584, 3840, 8388608, 3145728, 32768, 8, 16834560, 131072, 0, 0, 218105904, 4
    .long 1, 16, 16, 8192, 3584, 3840, 8388608, 3670016, 32768, 8, 18931712, 131072, 0, 0, 218106160, 4
    .long 1, 80, 80, 2048, 5505536, 5505792, 7340032, 58281984, 114688, 7, 181411840, 32768, 218103984, 7, 218106496, 1
    .long 0, 0, 0, 0, 0, 0, 0, 0, 0, 0, 0, 0, 0, 0, 0, 0
    .long 0, 0, 0, 0, 0, 0, 0, 0, 0, 0, 0, 0, 0, 0, 0, 0
    .long 0, 0, 0, 0, 0, 0, 0, 0, 0, 0, 0, 0, 0, 0, 0, 0
    .long 0, 0, 0, 0, 0, 0, 0, 0, 0, 0, 0, 0, 0, 0, 0, 0
    .long 1, 32, 32, 8192, 5632, 5888, 8388608, 524288, 32768, 8, 39936000, 131072, 0, 0, 218104656, 4
    .long 1, 16, 16, 8192, 5632, 5888, 8388608, 1048576, 32768, 8, 8478720, 131072, 0, 0, 218104912, 4
    .long 1, 24, 24, 8192, 5632, 5888, 8388608, 2621440, 32768, 8, 31547392, 131072, 0, 0, 218105680, 4
    .long 1, 16, 16, 8192, 5632, 5888, 8388608, 3145728, 32768, 8, 16867328, 131072, 0, 0, 218105936, 4
    .long 1, 16, 16, 8192, 5632, 5888, 8388608, 3670016, 32768, 8, 18964480, 131072, 0, 0, 218106192, 4
    .long 1, 80, 80, 2048, 5506048, 5506304, 7340032, 58281984, 114688, 7, 181420032, 32768, 218103984, 7, 218106496, 1
    .long 0, 0, 0, 0, 0, 0, 0, 0, 0, 0, 0, 0, 0, 0, 0, 0
    .long 0, 0, 0, 0, 0, 0, 0, 0, 0, 0, 0, 0, 0, 0, 0, 0
    .long 0, 0, 0, 0, 0, 0, 0, 0, 0, 0, 0, 0, 0, 0, 0, 0
    .long 0, 0, 0, 0, 0, 0, 0, 0, 0, 0, 0, 0, 0, 0, 0, 0
    .long 1, 32, 32, 8192, 7680, 7936, 8388608, 524288, 32768, 8, 39968768, 131072, 0, 0, 218104688, 4
    .long 1, 16, 16, 8192, 7680, 7936, 8388608, 1048576, 32768, 8, 8511488, 131072, 0, 0, 218104944, 4
    .long 1, 24, 24, 8192, 7680, 7936, 8388608, 2621440, 32768, 8, 31580160, 131072, 0, 0, 218105712, 4
    .long 1, 16, 16, 8192, 7680, 7936, 8388608, 3145728, 32768, 8, 16900096, 131072, 0, 0, 218105968, 4
    .long 1, 16, 16, 8192, 7680, 7936, 8388608, 3670016, 32768, 8, 18997248, 131072, 0, 0, 218106224, 4
    .long 1, 80, 80, 2048, 5506560, 5506816, 7340032, 58281984, 114688, 7, 181428224, 32768, 218103984, 7, 218106496, 1
    .long 0, 0, 0, 0, 0, 0, 0, 0, 0, 0, 0, 0, 0, 0, 0, 0
    .long 0, 0, 0, 0, 0, 0, 0, 0, 0, 0, 0, 0, 0, 0, 0, 0
    .long 0, 0, 0, 0, 0, 0, 0, 0, 0, 0, 0, 0, 0, 0, 0, 0
    .long 0, 0, 0, 0, 0, 0, 0, 0, 0, 0, 0, 0, 0, 0, 0, 0
    .long 1, 24, 24, 8192, 0, 256, 8388608, 524288, 32768, 8, 23068672, 131072, 0, 0, 218104576, 4
    .long 1, 32, 32, 8192, 0, 256, 8388608, 1572864, 32768, 8, 44040192, 131072, 0, 0, 218105088, 4
    .long 1, 16, 16, 8192, 0, 256, 8388608, 2621440, 32768, 8, 14680064, 131072, 0, 0, 218105600, 4
    .long 2, 64, 72, 7168, 2048, 2048, 7340032, 1048576, 32768, 8, 58228736, 114688, 0, 0, 218103952, 1
    .long 2, 64, 72, 7168, 1024, 1024, 7340032, 2621440, 32768, 8, 63717376, 114688, 0, 0, 218104128, 1
    .long 1, 80, 80, 2048, 0, 256, 7340032, 60030976, 114688, 7, 169345024, 32768, 218104000, 7, 218106560, 1
    .long 0, 0, 0, 0, 0, 0, 0, 0, 0, 0, 0, 0, 0, 0, 0, 0
    .long 0, 0, 0, 0, 0, 0, 0, 0, 0, 0, 0, 0, 0, 0, 0, 0
    .long 0, 0, 0, 0, 0, 0, 0, 0, 0, 0, 0, 0, 0, 0, 0, 0
    .long 0, 0, 0, 0, 0, 0, 0, 0, 0, 0, 0, 0, 0, 0, 0, 0
    .long 1, 24, 24, 8192, 2048, 2304, 8388608, 524288, 32768, 8, 23101440, 131072, 0, 0, 218104608, 4
    .long 1, 32, 32, 8192, 2048, 2304, 8388608, 1572864, 32768, 8, 44072960, 131072, 0, 0, 218105120, 4
    .long 1, 16, 16, 8192, 2048, 2304, 8388608, 2621440, 32768, 8, 14712832, 131072, 0, 0, 218105632, 4
    .long 2, 64, 72, 7168, 2304, 2304, 7340032, 1048576, 32768, 8, 58232832, 114688, 0, 0, 218103952, 1
    .long 2, 64, 72, 7168, 1280, 1280, 7340032, 2621440, 32768, 8, 63721472, 114688, 0, 0, 218104128, 1
    .long 1, 80, 80, 2048, 512, 768, 7340032, 60030976, 114688, 7, 169353216, 32768, 218104000, 7, 218106560, 1
    .long 0, 0, 0, 0, 0, 0, 0, 0, 0, 0, 0, 0, 0, 0, 0, 0
    .long 0, 0, 0, 0, 0, 0, 0, 0, 0, 0, 0, 0, 0, 0, 0, 0
    .long 0, 0, 0, 0, 0, 0, 0, 0, 0, 0, 0, 0, 0, 0, 0, 0
    .long 0, 0, 0, 0, 0, 0, 0, 0, 0, 0, 0, 0, 0, 0, 0, 0
    .long 1, 24, 24, 8192, 4096, 4352, 8388608, 524288, 32768, 8, 23134208, 131072, 0, 0, 218104640, 4
    .long 1, 32, 32, 8192, 4096, 4352, 8388608, 1572864, 32768, 8, 44105728, 131072, 0, 0, 218105152, 4
    .long 1, 16, 16, 8192, 4096, 4352, 8388608, 2621440, 32768, 8, 14745600, 131072, 0, 0, 218105664, 4
    .long 2, 64, 72, 7168, 2560, 2560, 7340032, 1048576, 32768, 8, 58236928, 114688, 0, 0, 218103952, 1
    .long 2, 64, 72, 7168, 1536, 1536, 7340032, 2621440, 32768, 8, 63725568, 114688, 0, 0, 218104128, 1
    .long 1, 80, 80, 2048, 1024, 1280, 7340032, 60030976, 114688, 7, 169361408, 32768, 218104000, 7, 218106560, 1
    .long 0, 0, 0, 0, 0, 0, 0, 0, 0, 0, 0, 0, 0, 0, 0, 0
    .long 0, 0, 0, 0, 0, 0, 0, 0, 0, 0, 0, 0, 0, 0, 0, 0
    .long 0, 0, 0, 0, 0, 0, 0, 0, 0, 0, 0, 0, 0, 0, 0, 0
    .long 0, 0, 0, 0, 0, 0, 0, 0, 0, 0, 0, 0, 0, 0, 0, 0
    .long 1, 24, 24, 8192, 6144, 6400, 8388608, 524288, 32768, 8, 23166976, 131072, 0, 0, 218104672, 4
    .long 1, 32, 32, 8192, 6144, 6400, 8388608, 1572864, 32768, 8, 44138496, 131072, 0, 0, 218105184, 4
    .long 1, 16, 16, 8192, 6144, 6400, 8388608, 2621440, 32768, 8, 14778368, 131072, 0, 0, 218105696, 4
    .long 2, 64, 72, 7168, 2816, 2816, 7340032, 1048576, 32768, 8, 58241024, 114688, 0, 0, 218103952, 1
    .long 2, 64, 72, 7168, 1792, 1792, 7340032, 2621440, 32768, 8, 63729664, 114688, 0, 0, 218104144, 1
    .long 1, 80, 80, 2048, 1536, 1792, 7340032, 60030976, 114688, 7, 169369600, 32768, 218104000, 7, 218106560, 1
    .long 0, 0, 0, 0, 0, 0, 0, 0, 0, 0, 0, 0, 0, 0, 0, 0
    .long 0, 0, 0, 0, 0, 0, 0, 0, 0, 0, 0, 0, 0, 0, 0, 0
    .long 0, 0, 0, 0, 0, 0, 0, 0, 0, 0, 0, 0, 0, 0, 0, 0
    .long 0, 0, 0, 0, 0, 0, 0, 0, 0, 0, 0, 0, 0, 0, 0, 0
    .long 1, 24, 24, 8192, 512, 768, 8388608, 524288, 32768, 8, 23076864, 131072, 0, 0, 218104576, 4
    .long 1, 32, 32, 8192, 512, 768, 8388608, 1572864, 32768, 8, 44048384, 131072, 0, 0, 218105088, 4
    .long 1, 16, 16, 8192, 512, 768, 8388608, 2621440, 32768, 8, 14688256, 131072, 0, 0, 218105600, 4
    .long 2, 64, 72, 7168, 3072, 3072, 7340032, 1048576, 32768, 8, 58245120, 114688, 0, 0, 218103952, 1
    .long 2, 64, 72, 7168, 2048, 2048, 7340032, 2621440, 32768, 8, 63733760, 114688, 0, 0, 218104144, 1
    .long 1, 80, 80, 2048, 1835008, 1835264, 7340032, 60059648, 114688, 7, 173539328, 32768, 218104016, 7, 218106560, 1
    .long 0, 0, 0, 0, 0, 0, 0, 0, 0, 0, 0, 0, 0, 0, 0, 0
    .long 0, 0, 0, 0, 0, 0, 0, 0, 0, 0, 0, 0, 0, 0, 0, 0
    .long 0, 0, 0, 0, 0, 0, 0, 0, 0, 0, 0, 0, 0, 0, 0, 0
    .long 0, 0, 0, 0, 0, 0, 0, 0, 0, 0, 0, 0, 0, 0, 0, 0
    .long 1, 24, 24, 8192, 2560, 2816, 8388608, 524288, 32768, 8, 23109632, 131072, 0, 0, 218104608, 4
    .long 1, 32, 32, 8192, 2560, 2816, 8388608, 1572864, 32768, 8, 44081152, 131072, 0, 0, 218105120, 4
    .long 1, 16, 16, 8192, 2560, 2816, 8388608, 2621440, 32768, 8, 14721024, 131072, 0, 0, 218105632, 4
    .long 2, 64, 72, 7168, 3328, 3328, 7340032, 1048576, 32768, 8, 58249216, 114688, 0, 0, 218103952, 1
    .long 2, 64, 72, 7168, 2304, 2304, 7340032, 2621440, 32768, 8, 63737856, 114688, 0, 0, 218104144, 1
    .long 1, 80, 80, 2048, 1835520, 1835776, 7340032, 60059648, 114688, 7, 173547520, 32768, 218104016, 7, 218106560, 1
    .long 0, 0, 0, 0, 0, 0, 0, 0, 0, 0, 0, 0, 0, 0, 0, 0
    .long 0, 0, 0, 0, 0, 0, 0, 0, 0, 0, 0, 0, 0, 0, 0, 0
    .long 0, 0, 0, 0, 0, 0, 0, 0, 0, 0, 0, 0, 0, 0, 0, 0
    .long 0, 0, 0, 0, 0, 0, 0, 0, 0, 0, 0, 0, 0, 0, 0, 0
    .long 1, 24, 24, 8192, 4608, 4864, 8388608, 524288, 32768, 8, 23142400, 131072, 0, 0, 218104640, 4
    .long 1, 32, 32, 8192, 4608, 4864, 8388608, 1572864, 32768, 8, 44113920, 131072, 0, 0, 218105152, 4
    .long 1, 16, 16, 8192, 4608, 4864, 8388608, 2621440, 32768, 8, 14753792, 131072, 0, 0, 218105664, 4
    .long 2, 64, 72, 7168, 3584, 3584, 7340032, 1048576, 32768, 8, 58253312, 114688, 0, 0, 218103968, 1
    .long 2, 64, 72, 7168, 2560, 2560, 7340032, 2621440, 32768, 8, 63741952, 114688, 0, 0, 218104144, 1
    .long 1, 80, 80, 2048, 1836032, 1836288, 7340032, 60059648, 114688, 7, 173555712, 32768, 218104016, 7, 218106560, 1
    .long 0, 0, 0, 0, 0, 0, 0, 0, 0, 0, 0, 0, 0, 0, 0, 0
    .long 0, 0, 0, 0, 0, 0, 0, 0, 0, 0, 0, 0, 0, 0, 0, 0
    .long 0, 0, 0, 0, 0, 0, 0, 0, 0, 0, 0, 0, 0, 0, 0, 0
    .long 0, 0, 0, 0, 0, 0, 0, 0, 0, 0, 0, 0, 0, 0, 0, 0
    .long 1, 24, 24, 8192, 6656, 6912, 8388608, 524288, 32768, 8, 23175168, 131072, 0, 0, 218104672, 4
    .long 1, 32, 32, 8192, 6656, 6912, 8388608, 1572864, 32768, 8, 44146688, 131072, 0, 0, 218105184, 4
    .long 1, 16, 16, 8192, 6656, 6912, 8388608, 2621440, 32768, 8, 14786560, 131072, 0, 0, 218105696, 4
    .long 2, 64, 72, 7168, 3840, 3840, 7340032, 1048576, 32768, 8, 58257408, 114688, 0, 0, 218103968, 1
    .long 2, 64, 72, 7168, 2816, 2816, 7340032, 2621440, 32768, 8, 63746048, 114688, 0, 0, 218104144, 1
    .long 1, 80, 80, 2048, 1836544, 1836800, 7340032, 60059648, 114688, 7, 173563904, 32768, 218104016, 7, 218106560, 1
    .long 0, 0, 0, 0, 0, 0, 0, 0, 0, 0, 0, 0, 0, 0, 0, 0
    .long 0, 0, 0, 0, 0, 0, 0, 0, 0, 0, 0, 0, 0, 0, 0, 0
    .long 0, 0, 0, 0, 0, 0, 0, 0, 0, 0, 0, 0, 0, 0, 0, 0
    .long 0, 0, 0, 0, 0, 0, 0, 0, 0, 0, 0, 0, 0, 0, 0, 0
    .long 1, 24, 24, 8192, 1024, 1280, 8388608, 524288, 32768, 8, 23085056, 131072, 0, 0, 218104592, 4
    .long 1, 24, 24, 8192, 1024, 1280, 8388608, 2097152, 32768, 8, 29376512, 131072, 0, 0, 218105360, 4
    .long 2, 64, 72, 7168, 0, 0, 7340032, 1048576, 32768, 8, 58195968, 114688, 0, 0, 218103936, 1
    .long 2, 64, 72, 7168, 6144, 6144, 7340032, 2097152, 32768, 8, 61964288, 114688, 0, 0, 218104112, 1
    .long 2, 64, 72, 7168, 5120, 5120, 7340032, 3670016, 32768, 8, 67452928, 114688, 0, 0, 218104288, 1
    .long 1, 80, 80, 2048, 3670016, 3670272, 7340032, 67428352, 114688, 7, 179830784, 32768, 218104288, 7, 218106816, 1
    .long 0, 0, 0, 0, 0, 0, 0, 0, 0, 0, 0, 0, 0, 0, 0, 0
    .long 0, 0, 0, 0, 0, 0, 0, 0, 0, 0, 0, 0, 0, 0, 0, 0
    .long 0, 0, 0, 0, 0, 0, 0, 0, 0, 0, 0, 0, 0, 0, 0, 0
    .long 0, 0, 0, 0, 0, 0, 0, 0, 0, 0, 0, 0, 0, 0, 0, 0
    .long 1, 24, 24, 8192, 3072, 3328, 8388608, 524288, 32768, 8, 23117824, 131072, 0, 0, 218104624, 4
    .long 1, 24, 24, 8192, 3072, 3328, 8388608, 2097152, 32768, 8, 29409280, 131072, 0, 0, 218105392, 4
    .long 2, 64, 72, 7168, 256, 256, 7340032, 1048576, 32768, 8, 58200064, 114688, 0, 0, 218103936, 1
    .long 2, 64, 72, 7168, 6400, 6400, 7340032, 2097152, 32768, 8, 61968384, 114688, 0, 0, 218104112, 1
    .long 2, 64, 72, 7168, 5376, 5376, 7340032, 3670016, 32768, 8, 67457024, 114688, 0, 0, 218104304, 1
    .long 1, 80, 80, 2048, 3670528, 3670784, 7340032, 67428352, 114688, 7, 179838976, 32768, 218104288, 7, 218106816, 1
    .long 0, 0, 0, 0, 0, 0, 0, 0, 0, 0, 0, 0, 0, 0, 0, 0
    .long 0, 0, 0, 0, 0, 0, 0, 0, 0, 0, 0, 0, 0, 0, 0, 0
    .long 0, 0, 0, 0, 0, 0, 0, 0, 0, 0, 0, 0, 0, 0, 0, 0
    .long 0, 0, 0, 0, 0, 0, 0, 0, 0, 0, 0, 0, 0, 0, 0, 0
    .long 1, 24, 24, 8192, 5120, 5376, 8388608, 524288, 32768, 8, 23150592, 131072, 0, 0, 218104656, 4
    .long 1, 24, 24, 8192, 5120, 5376, 8388608, 2097152, 32768, 8, 29442048, 131072, 0, 0, 218105424, 4
    .long 2, 64, 72, 7168, 512, 512, 7340032, 1048576, 32768, 8, 58204160, 114688, 0, 0, 218103936, 1
    .long 2, 64, 72, 7168, 6656, 6656, 7340032, 2097152, 32768, 8, 61972480, 114688, 0, 0, 218104112, 1
    .long 2, 64, 72, 7168, 5632, 5632, 7340032, 3670016, 32768, 8, 67461120, 114688, 0, 0, 218104304, 1
    .long 1, 80, 80, 2048, 3671040, 3671296, 7340032, 67428352, 114688, 7, 179847168, 32768, 218104288, 7, 218106816, 1
    .long 0, 0, 0, 0, 0, 0, 0, 0, 0, 0, 0, 0, 0, 0, 0, 0
    .long 0, 0, 0, 0, 0, 0, 0, 0, 0, 0, 0, 0, 0, 0, 0, 0
    .long 0, 0, 0, 0, 0, 0, 0, 0, 0, 0, 0, 0, 0, 0, 0, 0
    .long 0, 0, 0, 0, 0, 0, 0, 0, 0, 0, 0, 0, 0, 0, 0, 0
    .long 1, 24, 24, 8192, 7168, 7424, 8388608, 524288, 32768, 8, 23183360, 131072, 0, 0, 218104688, 4
    .long 1, 24, 24, 8192, 7168, 7424, 8388608, 2097152, 32768, 8, 29474816, 131072, 0, 0, 218105456, 4
    .long 2, 64, 72, 7168, 768, 768, 7340032, 1048576, 32768, 8, 58208256, 114688, 0, 0, 218103936, 1
    .long 2, 64, 72, 7168, 6912, 6912, 7340032, 2097152, 32768, 8, 61976576, 114688, 0, 0, 218104112, 1
    .long 2, 64, 72, 7168, 5888, 5888, 7340032, 3670016, 32768, 8, 67465216, 114688, 0, 0, 218104304, 1
    .long 1, 80, 80, 2048, 3671552, 3671808, 7340032, 67428352, 114688, 7, 179855360, 32768, 218104288, 7, 218106816, 1
    .long 0, 0, 0, 0, 0, 0, 0, 0, 0, 0, 0, 0, 0, 0, 0, 0
    .long 0, 0, 0, 0, 0, 0, 0, 0, 0, 0, 0, 0, 0, 0, 0, 0
    .long 0, 0, 0, 0, 0, 0, 0, 0, 0, 0, 0, 0, 0, 0, 0, 0
    .long 0, 0, 0, 0, 0, 0, 0, 0, 0, 0, 0, 0, 0, 0, 0, 0
    .long 1, 24, 24, 8192, 1536, 1792, 8388608, 524288, 32768, 8, 23093248, 131072, 0, 0, 218104592, 4
    .long 1, 24, 24, 8192, 1536, 1792, 8388608, 2097152, 32768, 8, 29384704, 131072, 0, 0, 218105360, 4
    .long 2, 64, 72, 7168, 1024, 1024, 7340032, 1048576, 32768, 8, 58212352, 114688, 0, 0, 218103936, 1
    .long 2, 64, 72, 7168, 0, 0, 7340032, 2621440, 32768, 8, 63700992, 114688, 0, 0, 218104128, 1
    .long 2, 64, 72, 7168, 6144, 6144, 7340032, 3670016, 32768, 8, 67469312, 114688, 0, 0, 218104304, 1
    .long 1, 80, 80, 2048, 5505024, 5505280, 7340032, 67457024, 114688, 7, 184025088, 32768, 218104304, 7, 218106816, 1
    .long 0, 0, 0, 0, 0, 0, 0, 0, 0, 0, 0, 0, 0, 0, 0, 0
    .long 0, 0, 0, 0, 0, 0, 0, 0, 0, 0, 0, 0, 0, 0, 0, 0
    .long 0, 0, 0, 0, 0, 0, 0, 0, 0, 0, 0, 0, 0, 0, 0, 0
    .long 0, 0, 0, 0, 0, 0, 0, 0, 0, 0, 0, 0, 0, 0, 0, 0
    .long 1, 24, 24, 8192, 3584, 3840, 8388608, 524288, 32768, 8, 23126016, 131072, 0, 0, 218104624, 4
    .long 1, 24, 24, 8192, 3584, 3840, 8388608, 2097152, 32768, 8, 29417472, 131072, 0, 0, 218105392, 4
    .long 2, 64, 72, 7168, 1280, 1280, 7340032, 1048576, 32768, 8, 58216448, 114688, 0, 0, 218103936, 1
    .long 2, 64, 72, 7168, 256, 256, 7340032, 2621440, 32768, 8, 63705088, 114688, 0, 0, 218104128, 1
    .long 2, 64, 72, 7168, 6400, 6400, 7340032, 3670016, 32768, 8, 67473408, 114688, 0, 0, 218104304, 1
    .long 1, 80, 80, 2048, 5505536, 5505792, 7340032, 67457024, 114688, 7, 184033280, 32768, 218104304, 7, 218106816, 1
    .long 0, 0, 0, 0, 0, 0, 0, 0, 0, 0, 0, 0, 0, 0, 0, 0
    .long 0, 0, 0, 0, 0, 0, 0, 0, 0, 0, 0, 0, 0, 0, 0, 0
    .long 0, 0, 0, 0, 0, 0, 0, 0, 0, 0, 0, 0, 0, 0, 0, 0
    .long 0, 0, 0, 0, 0, 0, 0, 0, 0, 0, 0, 0, 0, 0, 0, 0
    .long 1, 24, 24, 8192, 5632, 5888, 8388608, 524288, 32768, 8, 23158784, 131072, 0, 0, 218104656, 4
    .long 1, 24, 24, 8192, 5632, 5888, 8388608, 2097152, 32768, 8, 29450240, 131072, 0, 0, 218105424, 4
    .long 2, 64, 72, 7168, 1536, 1536, 7340032, 1048576, 32768, 8, 58220544, 114688, 0, 0, 218103936, 1
    .long 2, 64, 72, 7168, 512, 512, 7340032, 2621440, 32768, 8, 63709184, 114688, 0, 0, 218104128, 1
    .long 2, 64, 72, 7168, 6656, 6656, 7340032, 3670016, 32768, 8, 67477504, 114688, 0, 0, 218104304, 1
    .long 1, 80, 80, 2048, 5506048, 5506304, 7340032, 67457024, 114688, 7, 184041472, 32768, 218104304, 7, 218106816, 1
    .long 0, 0, 0, 0, 0, 0, 0, 0, 0, 0, 0, 0, 0, 0, 0, 0
    .long 0, 0, 0, 0, 0, 0, 0, 0, 0, 0, 0, 0, 0, 0, 0, 0
    .long 0, 0, 0, 0, 0, 0, 0, 0, 0, 0, 0, 0, 0, 0, 0, 0
    .long 0, 0, 0, 0, 0, 0, 0, 0, 0, 0, 0, 0, 0, 0, 0, 0
    .long 1, 24, 24, 8192, 7680, 7936, 8388608, 524288, 32768, 8, 23191552, 131072, 0, 0, 218104688, 4
    .long 1, 24, 24, 8192, 7680, 7936, 8388608, 2097152, 32768, 8, 29483008, 131072, 0, 0, 218105456, 4
    .long 2, 64, 72, 7168, 1792, 1792, 7340032, 1048576, 32768, 8, 58224640, 114688, 0, 0, 218103952, 1
    .long 2, 64, 72, 7168, 768, 768, 7340032, 2621440, 32768, 8, 63713280, 114688, 0, 0, 218104128, 1
    .long 2, 64, 72, 7168, 6912, 6912, 7340032, 3670016, 32768, 8, 67481600, 114688, 0, 0, 218104304, 1
    .long 1, 80, 80, 2048, 5506560, 5506816, 7340032, 67457024, 114688, 7, 184049664, 32768, 218104304, 7, 218106816, 1
    .long 0, 0, 0, 0, 0, 0, 0, 0, 0, 0, 0, 0, 0, 0, 0, 0
    .long 0, 0, 0, 0, 0, 0, 0, 0, 0, 0, 0, 0, 0, 0, 0, 0
    .long 0, 0, 0, 0, 0, 0, 0, 0, 0, 0, 0, 0, 0, 0, 0, 0
    .long 0, 0, 0, 0, 0, 0, 0, 0, 0, 0, 0, 0, 0, 0, 0, 0
.p2align 6
.amdhsa_kernel recurrent_scan__memory_aug_recurrent_mem_tr__glu_gated_glu__prompt_kernel
  .amdhsa_next_free_vgpr 256
  .amdhsa_next_free_sgpr 102
  .amdhsa_accum_offset 256
  .amdhsa_group_segment_fixed_size 0
  .amdhsa_kernarg_size 112
  .amdhsa_user_sgpr_count 2
  .amdhsa_user_sgpr_kernarg_segment_ptr 1
  .amdhsa_system_sgpr_workgroup_id_x 1
  .amdhsa_float_denorm_mode_32 3
.end_amdhsa_kernel
```

```asm
; @launch grid=(256,1,1) block=(512,1,1) lds=163840
.amdgcn_target "amdgcn-amd-amdhsa--gfx950"
.text
.globl recurrent_scan__memory_aug_recurrent_mem_tr__glu_gated_glu__prompt_kernel
.p2align 8
.type recurrent_scan__memory_aug_recurrent_mem_tr__glu_gated_glu__prompt_kernel,@function
recurrent_scan__memory_aug_recurrent_mem_tr__glu_gated_glu__prompt_kernel:
    s_cmp_ge_u32 s2, 256
    s_cbranch_scc1 k_exit
    s_mov_b32 s99, s2
    s_load_dwordx2 s[4:5], s[0:1], 104
    s_load_dwordx2 s[64:65], s[0:1], 96
    v_lshrrev_b32 v2, 6, v0
    s_mov_b32 s6, 268435456
    s_mov_b32 s7, 131072
    s_mov_b32 s66, 256
    s_mov_b32 s67, 131072
    v_readfirstlane_b32 s3, v2
    s_lshr_b32 s12, s2, 3
    s_and_b32 s13, s2, 3
    s_waitcnt lgkmcnt(0)
    s_bitcmp0_b32 s2, 2
    s_cbranch_scc1 chain_map
    s_lshl_b32 s63, s12, 2
    s_add_u32 s63, s63, s13
    s_mov_b32 s29, s63
    v_and_b32 v20, 63, v0
    v_lshlrev_b32 v1, 4, v20
    v_add_u32 v19, 0x1000, v1
    v_lshrrev_b32 v4, 4, v20
    v_mov_b32 v17, 0
    v_mov_b32 v18, 1
    s_lshr_b32 s26, s3, 2
    s_and_b32 s27, s3, 3
    s_lshl_b32 s21, s3, 11
    s_lshl_b32 s22, s3, 10
    s_add_u32 s22, s22, 16384
    s_mov_b32 s11, 131072
    s_mov_b32 s15, 131072
    s_mov_b32 s28, 0
    v_and_b32 v21, 15, v20
    v_lshlrev_b32 v22, 2, v4
    v_xor_b32 v21, v21, v22
    s_lshr_b32 s30, s3, 1
    s_and_b32 s30, s30, 1
    v_xor_b32 v21, s30, v21
    v_lshlrev_b32 v3, 4, v21
    s_lshl_b32 s30, s26, 13
    v_add_u32 v5, s30, v1
    v_add_u32 v6, 0x10000, v5
    v_bfe_u32 v21, v20, 2, 2
    v_and_b32 v22, 3, v20
    v_and_b32 v23, 1, v4
    v_xor_b32 v24, s27, v21
    v_xor_b32 v25, v22, v23
    v_lshl_add_u32 v24, v24, 2, v25
    v_lshlrev_b32 v24, 4, v24
    v_lshl_add_u32 v25, v4, 3, v21
    v_lshl_add_u32 v24, v25, 8, v24
    v_and_b32 v22, 1, v22
    v_xor_b32 v25, 0, v23
    v_lshl_add_u32 v8, v25, 10, v24
    v_xor_b32 v25, 0, v22
    v_lshl_add_u32 v8, v25, 3, v8
    v_add_u32 v12, 0x10000, v8
    v_xor_b32 v25, 1, v23
    v_lshl_add_u32 v9, v25, 10, v24
    v_xor_b32 v25, 0, v22
    v_lshl_add_u32 v9, v25, 3, v9
    v_add_u32 v13, 0x10000, v9
    v_xor_b32 v25, 0, v23
    v_lshl_add_u32 v10, v25, 10, v24
    v_xor_b32 v25, 1, v22
    v_lshl_add_u32 v10, v25, 3, v10
    v_add_u32 v14, 0x10000, v10
    v_xor_b32 v25, 1, v23
    v_lshl_add_u32 v11, v25, 10, v24
    v_xor_b32 v25, 1, v22
    v_lshl_add_u32 v11, v25, 3, v11
    v_add_u32 v15, 0x10000, v11
    s_lshl_b32 s30, s3, 2
    s_add_u32 s30, s30, 131072
    v_mov_b32 v7, s30
    s_getpc_b64 s[24:25]
    s_add_u32 s24, s24, jobtab@rel32@lo+4
    s_addc_u32 s25, s25, jobtab@rel32@hi+12
    s_mul_i32 s30, s29, 640
    s_add_u32 s24, s24, s30
    s_addc_u32 s25, s25, 0
    s_load_dwordx16 s[32:47], s[24:25], 0
    s_add_u32 s24, s24, 64
    s_addc_u32 s25, s25, 0
    s_waitcnt lgkmcnt(0)
    s_mov_b32 s8, s4
    s_mov_b32 s9, s5
    s_mov_b32 s10, 0
    s_mov_b32 s12, s4
    s_mov_b32 s13, s5
    s_mov_b32 s14, 0
    s_load_dwordx2 s[88:89], s[0:1], 0
    s_mov_b32 s90, 4194304
    s_mov_b32 s91, 131072
    s_mov_b32 s98, 0
    v_mov_b32 v22, 0
    s_mov_b32 s70, 1
    v_and_b32 v245, 15, v0
    v_lshlrev_b32 v246, 11, v245
    v_lshl_add_u32 v246, v4, 4, v246
    s_add_u32 s71, s63, 32
    s_and_b32 s71, s71, 127
    s_lshl_b32 s72, s71, 15
    s_lshl_b32 s73, s3, 8
    s_add_u32 s72, s72, s73
    s_waitcnt lgkmcnt(0)
    buffer_load_dwordx4 v[228:231], v246, s[88:91], s72 offen offset:0
    buffer_load_dwordx4 v[232:235], v246, s[88:91], s72 offen offset:64
    buffer_load_dwordx4 v[236:239], v246, s[88:91], s72 offen offset:128
    buffer_load_dwordx4 v[240:243], v246, s[88:91], s72 offen offset:192
    s_cmp_lg_u32 s32, 6
    s_cbranch_scc1 ln_nx
    s_mov_b32 s98, 3
    s_cmp_lg_u32 s32, 6
    s_cbranch_scc1 xs_1
    s_load_dwordx2 s[8:9], s[0:1], s33
    s_load_dwordx2 s[12:13], s[0:1], s34
    s_mov_b32 s10, s38
    s_mov_b32 s14, s38
    s_cmp_ge_u32 s32, 4
    s_cselect_b32 s31, 0, 1
    s_lshl_b32 s30, s3, s31
    s_mul_i32 s30, s30, s40
    s_add_u32 s16, s39, s30
    s_cmp_eq_u32 s32, 4
    s_cselect_b32 s30, 1024, s40
    s_cselect_b32 s31, 6, 5
    s_lshl_b32 s62, 32, s31
    s_add_u32 s17, s16, s30
    s_lshl_b32 s30, s3, 2
    s_mul_i32 s30, s30, s35
    s_add_u32 s18, s36, s30
    s_add_u32 s19, s37, s30
    s_lshl_b32 s20, s35, s31
    v_mul_u32_u24 v2, s35, v4
    v_add_u32 v2, v2, v3
    s_waitcnt lgkmcnt(0)
    s_lshl_b32 s16, s3, 15
    s_add_u32 s16, s16, s39
    s_add_u32 s92, s16, 2048
    s_lshl_b32 s93, s35, 10
    s_lshr_b32 s94, s63, 2
    s_mul_i32 s94, s94, 1
    s_and_b32 s94, s94, 15
    s_lshl_b32 s95, s94, 7
    s_add_u32 s16, s16, s95
    s_lshl_b32 s95, s35, 6
    s_mul_i32 s95, s95, s94
    s_add_u32 s18, s18, s95
    s_add_u32 s19, s19, s95
    s_add_u32 s17, s16, 16384
    s_mov_b32 s62, 128
    s_lshl_b32 s20, s35, 6
    v_lshrrev_b32 v21, 7, v1
    v_bfe_u32 v23, v1, 4, 3
    v_xor_b32 v23, v21, v23
    v_lshlrev_b32 v23, 4, v23
    v_lshl_add_u32 v23, v21, 11, v23
    s_add_u32 m0, s21, 0
    s_nop 0
    buffer_load_dwordx4 v23, s[88:91], s16 offen lds
    s_add_u32 s16, s16, s62
    s_add_u32 m0, s21, 1024
    s_nop 0
    buffer_load_dwordx4 v23, s[88:91], s17 offen lds
    s_add_u32 s17, s17, s62
    s_add_u32 m0, s22, 0
    s_nop 0
    buffer_load_dwordx4 v2, s[8:11], s18 offen lds
    s_add_u32 s18, s18, s20
    s_add_u32 m0, s22, 8192
    s_nop 0
    buffer_load_dwordx4 v2, s[12:15], s19 offen lds
    s_add_u32 s19, s19, s20
    s_cmp_ge_u32 s16, s92
    s_cselect_b32 s94, 2048, 0
    s_cselect_b32 s95, s93, 0
    s_sub_u32 s16, s16, s94
    s_sub_u32 s17, s17, s94
    s_sub_u32 s18, s18, s95
    s_sub_u32 s19, s19, s95
    s_add_u32 m0, s21, 32768
    s_nop 0
    buffer_load_dwordx4 v23, s[88:91], s16 offen lds
    s_add_u32 s16, s16, s62
    s_add_u32 m0, s21, 33792
    s_nop 0
    buffer_load_dwordx4 v23, s[88:91], s17 offen lds
    s_add_u32 s17, s17, s62
    s_add_u32 m0, s22, 32768
    s_nop 0
    buffer_load_dwordx4 v2, s[8:11], s18 offen lds
    s_add_u32 s18, s18, s20
    s_add_u32 m0, s22, 40960
    s_nop 0
    buffer_load_dwordx4 v2, s[12:15], s19 offen lds
    s_add_u32 s19, s19, s20
    s_cmp_ge_u32 s16, s92
    s_cselect_b32 s94, 2048, 0
    s_cselect_b32 s95, s93, 0
    s_sub_u32 s16, s16, s94
    s_sub_u32 s17, s17, s94
    s_sub_u32 s18, s18, s95
    s_sub_u32 s19, s19, s95
    s_add_u32 m0, s21, 65536
    s_nop 0
    buffer_load_dwordx4 v23, s[88:91], s16 offen lds
    s_add_u32 s16, s16, s62
    s_add_u32 m0, s21, 66560
    s_nop 0
    buffer_load_dwordx4 v23, s[88:91], s17 offen lds
    s_add_u32 s17, s17, s62
    s_add_u32 m0, s22, 65536
    s_nop 0
    buffer_load_dwordx4 v2, s[8:11], s18 offen lds
    s_add_u32 s18, s18, s20
    s_add_u32 m0, s22, 73728
    s_nop 0
    buffer_load_dwordx4 v2, s[12:15], s19 offen lds
    s_add_u32 s19, s19, s20
    s_cmp_ge_u32 s16, s92
    s_cselect_b32 s94, 2048, 0
    s_cselect_b32 s95, s93, 0
    s_sub_u32 s16, s16, s94
    s_sub_u32 s17, s17, s94
    s_sub_u32 s18, s18, s95
    s_sub_u32 s19, s19, s95
    s_add_u32 m0, s21, 98304
    s_nop 0
    buffer_load_dwordx4 v23, s[88:91], s16 offen lds
    s_add_u32 s16, s16, s62
    s_add_u32 m0, s21, 99328
    s_nop 0
    buffer_load_dwordx4 v23, s[88:91], s17 offen lds
    s_add_u32 s17, s17, s62
    s_add_u32 m0, s22, 98304
    s_nop 0
    buffer_load_dwordx4 v2, s[8:11], s18 offen lds
    s_add_u32 s18, s18, s20
    s_add_u32 m0, s22, 106496
    s_nop 0
    buffer_load_dwordx4 v2, s[12:15], s19 offen lds
    s_add_u32 s19, s19, s20
    s_cmp_ge_u32 s16, s92
    s_cselect_b32 s94, 2048, 0
    s_cselect_b32 s95, s93, 0
    s_sub_u32 s16, s16, s94
    s_sub_u32 s17, s17, s94
    s_sub_u32 s18, s18, s95
    s_sub_u32 s19, s19, s95
    v_and_b32 v21, 1, v4
    v_lshlrev_b32 v21, 10, v21
    v_xor_b32 v8, v21, v8
    v_xor_b32 v9, v21, v9
    v_xor_b32 v10, v21, v10
    v_xor_b32 v11, v21, v11
    v_xor_b32 v12, v21, v12
    v_xor_b32 v13, v21, v13
    v_xor_b32 v14, v21, v14
    v_xor_b32 v15, v21, v15
xs_1:
    s_branch w_adopt
ln_nx:
    s_lshl_b32 s73, s71, 9
    s_add_u32 s73, s73, 218103808
    v_lshlrev_b32 v252, 2, v0
    s_cmp_ge_u32 s71, 32
    s_cbranch_scc1 ln_nz
    s_cmp_ge_u32 s3, 2
    s_cbranch_scc1 ln_nz
    buffer_store_dword v17, v252, s[4:7], s73 offen sc1
ln_nz:
    s_waitcnt vmcnt(0)
ln_entry:
    v_lshlrev_b32 v247, 5, v245
    v_add_u32 v247, 135168, v247
    s_lshl_b32 s74, s3, 2
    v_add_u32 v248, s74, v247
    s_lshl_b32 s75, s71, 15
    s_lshl_b32 s76, s3, 12
    s_add_u32 s75, s75, s76
    v_and_b32 v249, 1, v4
    v_cmp_eq_u32 s[80:81], 1, v249
    v_lshlrev_b32 v56, 16, v228
    v_and_b32 v57, 0xffff0000, v228
    v_lshlrev_b32 v58, 16, v229
    v_and_b32 v59, 0xffff0000, v229
    v_lshlrev_b32 v60, 16, v230
    v_and_b32 v61, 0xffff0000, v230
    v_lshlrev_b32 v62, 16, v231
    v_and_b32 v63, 0xffff0000, v231
    v_lshlrev_b32 v64, 16, v232
    v_and_b32 v65, 0xffff0000, v232
    v_lshlrev_b32 v66, 16, v233
    v_and_b32 v67, 0xffff0000, v233
    v_lshlrev_b32 v68, 16, v234
    v_and_b32 v69, 0xffff0000, v234
    v_lshlrev_b32 v70, 16, v235
    v_and_b32 v71, 0xffff0000, v235
    v_lshlrev_b32 v72, 16, v236
    v_and_b32 v73, 0xffff0000, v236
    v_lshlrev_b32 v74, 16, v237
    v_and_b32 v75, 0xffff0000, v237
    v_lshlrev_b32 v76, 16, v238
    v_and_b32 v77, 0xffff0000, v238
    v_lshlrev_b32 v78, 16, v239
    v_and_b32 v79, 0xffff0000, v239
    v_lshlrev_b32 v80, 16, v240
    v_and_b32 v81, 0xffff0000, v240
    v_lshlrev_b32 v82, 16, v241
    v_and_b32 v83, 0xffff0000, v241
    v_lshlrev_b32 v84, 16, v242
    v_and_b32 v85, 0xffff0000, v242
    v_lshlrev_b32 v86, 16, v243
    v_and_b32 v87, 0xffff0000, v243
    v_add_f32 v120, v56, v72
    v_add_f32 v121, v57, v73
    v_add_f32 v122, v58, v74
    v_add_f32 v123, v59, v75
    v_add_f32 v124, v60, v76
    v_add_f32 v125, v61, v77
    v_add_f32 v126, v62, v78
    v_add_f32 v127, v63, v79
    v_add_f32 v128, v64, v80
    v_add_f32 v129, v65, v81
    v_add_f32 v130, v66, v82
    v_add_f32 v131, v67, v83
    v_add_f32 v132, v68, v84
    v_add_f32 v133, v69, v85
    v_add_f32 v134, v70, v86
    v_add_f32 v135, v71, v87
    v_add_f32 v120, v120, v128
    v_add_f32 v121, v121, v129
    v_add_f32 v122, v122, v130
    v_add_f32 v123, v123, v131
    v_add_f32 v124, v124, v132
    v_add_f32 v125, v125, v133
    v_add_f32 v126, v126, v134
    v_add_f32 v127, v127, v135
    v_add_f32 v120, v120, v124
    v_add_f32 v121, v121, v125
    v_add_f32 v122, v122, v126
    v_add_f32 v123, v123, v127
    v_add_f32 v120, v120, v122
    v_add_f32 v121, v121, v123
    v_add_f32 v120, v120, v121
    v_mov_b32 v121, v120
    s_nop 1
    v_permlane16_swap_b32 v121, v120
    v_add_f32 v120, v120, v121
    v_mov_b32 v121, v120
    s_nop 1
    v_permlane32_swap_b32 v121, v120
    v_add_f32 v120, v120, v121
    ds_write_b32 v248, v120 offset:0
    s_waitcnt lgkmcnt(0)
    s_barrier
    ds_read_b128 v[120:123], v247 offset:0
    ds_read_b128 v[124:127], v247 offset:16
    s_waitcnt lgkmcnt(0)
    v_add_f32 v120, v120, v124
    v_add_f32 v121, v121, v125
    v_add_f32 v122, v122, v126
    v_add_f32 v123, v123, v127
    v_add_f32 v120, v120, v122
    v_add_f32 v121, v121, v123
    v_add_f32 v120, v120, v121
    v_mul_f32 v250, 0x3a800000, v120
    v_sub_f32 v152, v56, v250
    v_sub_f32 v153, v57, v250
    v_sub_f32 v154, v58, v250
    v_sub_f32 v155, v59, v250
    v_sub_f32 v156, v60, v250
    v_sub_f32 v157, v61, v250
    v_sub_f32 v158, v62, v250
    v_sub_f32 v159, v63, v250
    v_sub_f32 v160, v64, v250
    v_sub_f32 v161, v65, v250
    v_sub_f32 v162, v66, v250
    v_sub_f32 v163, v67, v250
    v_sub_f32 v164, v68, v250
    v_sub_f32 v165, v69, v250
    v_sub_f32 v166, v70, v250
    v_sub_f32 v167, v71, v250
    v_sub_f32 v168, v72, v250
    v_sub_f32 v169, v73, v250
    v_sub_f32 v170, v74, v250
    v_sub_f32 v171, v75, v250
    v_sub_f32 v172, v76, v250
    v_sub_f32 v173, v77, v250
    v_sub_f32 v174, v78, v250
    v_sub_f32 v175, v79, v250
    v_sub_f32 v176, v80, v250
    v_sub_f32 v177, v81, v250
    v_sub_f32 v178, v82, v250
    v_sub_f32 v179, v83, v250
    v_sub_f32 v180, v84, v250
    v_sub_f32 v181, v85, v250
    v_sub_f32 v182, v86, v250
    v_sub_f32 v183, v87, v250
    v_mul_f32 v120, v152, v152
    v_fmac_f32 v120, v168, v168
    v_mul_f32 v121, v153, v153
    v_fmac_f32 v121, v169, v169
    v_mul_f32 v122, v154, v154
    v_fmac_f32 v122, v170, v170
    v_mul_f32 v123, v155, v155
    v_fmac_f32 v123, v171, v171
    v_mul_f32 v124, v156, v156
    v_fmac_f32 v124, v172, v172
    v_mul_f32 v125, v157, v157
    v_fmac_f32 v125, v173, v173
    v_mul_f32 v126, v158, v158
    v_fmac_f32 v126, v174, v174
    v_mul_f32 v127, v159, v159
    v_fmac_f32 v127, v175, v175
    v_mul_f32 v128, v160, v160
    v_fmac_f32 v128, v176, v176
    v_mul_f32 v129, v161, v161
    v_fmac_f32 v129, v177, v177
    v_mul_f32 v130, v162, v162
    v_fmac_f32 v130, v178, v178
    v_mul_f32 v131, v163, v163
    v_fmac_f32 v131, v179, v179
    v_mul_f32 v132, v164, v164
    v_fmac_f32 v132, v180, v180
    v_mul_f32 v133, v165, v165
    v_fmac_f32 v133, v181, v181
    v_mul_f32 v134, v166, v166
    v_fmac_f32 v134, v182, v182
    v_mul_f32 v135, v167, v167
    v_fmac_f32 v135, v183, v183
    v_add_f32 v120, v120, v128
    v_add_f32 v121, v121, v129
    v_add_f32 v122, v122, v130
    v_add_f32 v123, v123, v131
    v_add_f32 v124, v124, v132
    v_add_f32 v125, v125, v133
    v_add_f32 v126, v126, v134
    v_add_f32 v127, v127, v135
    v_add_f32 v120, v120, v124
    v_add_f32 v121, v121, v125
    v_add_f32 v122, v122, v126
    v_add_f32 v123, v123, v127
    v_add_f32 v120, v120, v122
    v_add_f32 v121, v121, v123
    v_add_f32 v120, v120, v121
    v_mov_b32 v121, v120
    s_nop 1
    v_permlane16_swap_b32 v121, v120
    v_add_f32 v120, v120, v121
    v_mov_b32 v121, v120
    s_nop 1
    v_permlane32_swap_b32 v121, v120
    v_add_f32 v120, v120, v121
    ds_write_b32 v248, v120 offset:512
    s_waitcnt lgkmcnt(0)
    s_barrier
    ds_read_b128 v[120:123], v247 offset:512
    ds_read_b128 v[124:127], v247 offset:528
    s_waitcnt lgkmcnt(0)
    v_add_f32 v120, v120, v124
    v_add_f32 v121, v121, v125
    v_add_f32 v122, v122, v126
    v_add_f32 v123, v123, v127
    v_add_f32 v120, v120, v122
    v_add_f32 v121, v121, v123
    v_add_f32 v120, v120, v121
    v_mul_f32 v251, 0x3a800000, v120
    v_cvt_pk_bf16_f32 v250, v250, v250
    v_lshlrev_b32 v250, 16, v250
    v_cvt_pk_bf16_f32 v251, v251, v251
    v_lshlrev_b32 v251, 16, v251
    v_add_f32 v251, 0x3727c5ac, v251
    v_cvt_pk_bf16_f32 v251, v251, v251
    v_lshlrev_b32 v251, 16, v251
    v_sqrt_f32 v251, v251
    s_nop 0
    v_cvt_pk_bf16_f32 v251, v251, v251
    v_lshlrev_b32 v251, 16, v251
    v_rcp_f32 v251, v251
    s_nop 0
    s_cmp_lg_u32 s3, 0
    s_cbranch_scc1 ln_nst
    s_lshl_b32 s77, s71, 7
    s_add_u32 s77, s77, 188743680
    v_lshlrev_b32 v249, 3, v245
    s_mov_b64 exec, 0xffff
    buffer_store_dwordx2 v[250:251], v249, s[4:7], s77 offen sc1
    s_mov_b64 exec, -1
ln_nst:
    v_sub_f32 v56, v56, v250
    v_sub_f32 v57, v57, v250
    v_cvt_pk_bf16_f32 v228, v56, v57
    v_lshlrev_b32 v56, 16, v228
    v_and_b32 v57, 0xffff0000, v228
    v_mul_f32 v56, v56, v251
    v_mul_f32 v57, v57, v251
    v_cvt_pk_bf16_f32 v228, v56, v57
    v_sub_f32 v58, v58, v250
    v_sub_f32 v59, v59, v250
    v_cvt_pk_bf16_f32 v229, v58, v59
    v_lshlrev_b32 v58, 16, v229
    v_and_b32 v59, 0xffff0000, v229
    v_mul_f32 v58, v58, v251
    v_mul_f32 v59, v59, v251
    v_cvt_pk_bf16_f32 v229, v58, v59
    v_sub_f32 v60, v60, v250
    v_sub_f32 v61, v61, v250
    v_cvt_pk_bf16_f32 v230, v60, v61
    v_lshlrev_b32 v60, 16, v230
    v_and_b32 v61, 0xffff0000, v230
    v_mul_f32 v60, v60, v251
    v_mul_f32 v61, v61, v251
    v_cvt_pk_bf16_f32 v230, v60, v61
    v_sub_f32 v62, v62, v250
    v_sub_f32 v63, v63, v250
    v_cvt_pk_bf16_f32 v231, v62, v63
    v_lshlrev_b32 v62, 16, v231
    v_and_b32 v63, 0xffff0000, v231
    v_mul_f32 v62, v62, v251
    v_mul_f32 v63, v63, v251
    v_cvt_pk_bf16_f32 v231, v62, v63
    v_cndmask_b32 v120, v228, v230, s[80:81]
    v_cndmask_b32 v121, v229, v231, s[80:81]
    v_cndmask_b32 v122, v230, v228, s[80:81]
    v_cndmask_b32 v123, v231, v229, s[80:81]
    buffer_store_dwordx4 v[120:123], v1, s[4:7], s75 offen offset:0 sc1
    v_sub_f32 v64, v64, v250
    v_sub_f32 v65, v65, v250
    v_cvt_pk_bf16_f32 v232, v64, v65
    v_lshlrev_b32 v64, 16, v232
    v_and_b32 v65, 0xffff0000, v232
    v_mul_f32 v64, v64, v251
    v_mul_f32 v65, v65, v251
    v_cvt_pk_bf16_f32 v232, v64, v65
    v_sub_f32 v66, v66, v250
    v_sub_f32 v67, v67, v250
    v_cvt_pk_bf16_f32 v233, v66, v67
    v_lshlrev_b32 v66, 16, v233
    v_and_b32 v67, 0xffff0000, v233
    v_mul_f32 v66, v66, v251
    v_mul_f32 v67, v67, v251
    v_cvt_pk_bf16_f32 v233, v66, v67
    v_sub_f32 v68, v68, v250
    v_sub_f32 v69, v69, v250
    v_cvt_pk_bf16_f32 v234, v68, v69
    v_lshlrev_b32 v68, 16, v234
    v_and_b32 v69, 0xffff0000, v234
    v_mul_f32 v68, v68, v251
    v_mul_f32 v69, v69, v251
    v_cvt_pk_bf16_f32 v234, v68, v69
    v_sub_f32 v70, v70, v250
    v_sub_f32 v71, v71, v250
    v_cvt_pk_bf16_f32 v235, v70, v71
    v_lshlrev_b32 v70, 16, v235
    v_and_b32 v71, 0xffff0000, v235
    v_mul_f32 v70, v70, v251
    v_mul_f32 v71, v71, v251
    v_cvt_pk_bf16_f32 v235, v70, v71
    v_cndmask_b32 v124, v232, v234, s[80:81]
    v_cndmask_b32 v125, v233, v235, s[80:81]
    v_cndmask_b32 v126, v234, v232, s[80:81]
    v_cndmask_b32 v127, v235, v233, s[80:81]
    buffer_store_dwordx4 v[124:127], v1, s[4:7], s75 offen offset:1024 sc1
    v_sub_f32 v72, v72, v250
    v_sub_f32 v73, v73, v250
    v_cvt_pk_bf16_f32 v236, v72, v73
    v_lshlrev_b32 v72, 16, v236
    v_and_b32 v73, 0xffff0000, v236
    v_mul_f32 v72, v72, v251
    v_mul_f32 v73, v73, v251
    v_cvt_pk_bf16_f32 v236, v72, v73
    v_sub_f32 v74, v74, v250
    v_sub_f32 v75, v75, v250
    v_cvt_pk_bf16_f32 v237, v74, v75
    v_lshlrev_b32 v74, 16, v237
    v_and_b32 v75, 0xffff0000, v237
    v_mul_f32 v74, v74, v251
    v_mul_f32 v75, v75, v251
    v_cvt_pk_bf16_f32 v237, v74, v75
    v_sub_f32 v76, v76, v250
    v_sub_f32 v77, v77, v250
    v_cvt_pk_bf16_f32 v238, v76, v77
    v_lshlrev_b32 v76, 16, v238
    v_and_b32 v77, 0xffff0000, v238
    v_mul_f32 v76, v76, v251
    v_mul_f32 v77, v77, v251
    v_cvt_pk_bf16_f32 v238, v76, v77
    v_sub_f32 v78, v78, v250
    v_sub_f32 v79, v79, v250
    v_cvt_pk_bf16_f32 v239, v78, v79
    v_lshlrev_b32 v78, 16, v239
    v_and_b32 v79, 0xffff0000, v239
    v_mul_f32 v78, v78, v251
    v_mul_f32 v79, v79, v251
    v_cvt_pk_bf16_f32 v239, v78, v79
    v_cndmask_b32 v128, v236, v238, s[80:81]
    v_cndmask_b32 v129, v237, v239, s[80:81]
    v_cndmask_b32 v130, v238, v236, s[80:81]
    v_cndmask_b32 v131, v239, v237, s[80:81]
    buffer_store_dwordx4 v[128:131], v1, s[4:7], s75 offen offset:2048 sc1
    v_sub_f32 v80, v80, v250
    v_sub_f32 v81, v81, v250
    v_cvt_pk_bf16_f32 v240, v80, v81
    v_lshlrev_b32 v80, 16, v240
    v_and_b32 v81, 0xffff0000, v240
    v_mul_f32 v80, v80, v251
    v_mul_f32 v81, v81, v251
    v_cvt_pk_bf16_f32 v240, v80, v81
    v_sub_f32 v82, v82, v250
    v_sub_f32 v83, v83, v250
    v_cvt_pk_bf16_f32 v241, v82, v83
    v_lshlrev_b32 v82, 16, v241
    v_and_b32 v83, 0xffff0000, v241
    v_mul_f32 v82, v82, v251
    v_mul_f32 v83, v83, v251
    v_cvt_pk_bf16_f32 v241, v82, v83
    v_sub_f32 v84, v84, v250
    v_sub_f32 v85, v85, v250
    v_cvt_pk_bf16_f32 v242, v84, v85
    v_lshlrev_b32 v84, 16, v242
    v_and_b32 v85, 0xffff0000, v242
    v_mul_f32 v84, v84, v251
    v_mul_f32 v85, v85, v251
    v_cvt_pk_bf16_f32 v242, v84, v85
    v_sub_f32 v86, v86, v250
    v_sub_f32 v87, v87, v250
    v_cvt_pk_bf16_f32 v243, v86, v87
    v_lshlrev_b32 v86, 16, v243
    v_and_b32 v87, 0xffff0000, v243
    v_mul_f32 v86, v86, v251
    v_mul_f32 v87, v87, v251
    v_cvt_pk_bf16_f32 v243, v86, v87
    v_cndmask_b32 v132, v240, v242, s[80:81]
    v_cndmask_b32 v133, v241, v243, s[80:81]
    v_cndmask_b32 v134, v242, v240, s[80:81]
    v_cndmask_b32 v135, v243, v241, s[80:81]
    buffer_store_dwordx4 v[132:135], v1, s[4:7], s75 offen offset:3072 sc1
    s_cmp_lg_u32 s98, 1
    s_cbranch_scc1 ln_now
    s_mov_b32 s98, 2
    s_branch w_adopt2
ln_now:
    v_mov_b32 v18, 1
    s_waitcnt vmcnt(0)
    s_barrier
    s_cmp_lg_u32 s3, 0
    s_cbranch_scc1 ln_sig
    s_mov_b64 exec, 1
    s_cmp_ge_u32 s71, 32
    s_cbranch_scc1 ln_sb
    buffer_atomic_add v18, off, s[64:67], 0 offset:192 sc1
ln_sb:
    buffer_atomic_add v18, off, s[64:67], 0 offset:0 sc1
    s_mov_b64 exec, -1
ln_sig:
    s_cmp_lt_u32 s63, 120
    s_cbranch_scc1 prb_done
    s_cmp_lg_u32 s3, 0
    s_cbranch_scc1 prb_bar
    s_sub_u32 s82, s63, 120
    s_lshl_b32 s83, s82, 7
    s_add_u32 s83, s83, 218112000
    s_lshl_b32 s84, s82, 10
    s_add_u32 s84, s84, 209715200
    s_mov_b32 s80, -1
    s_mov_b32 s81, -1
    s_mov_b64 exec, 1
    s_memtime s[74:75]
    s_add_u32 s87, s84, 0
    s_waitcnt lgkmcnt(0)
    buffer_load_dword v20, off, s[4:7], s87 sc1
    s_waitcnt vmcnt(0)
    s_memtime s[76:77]
    s_waitcnt lgkmcnt(0)
    s_sub_u32 s87, s76, s74
    s_min_u32 s80, s80, s87
    s_memtime s[74:75]
    s_add_u32 s87, s84, 8192
    s_waitcnt lgkmcnt(0)
    buffer_load_dword v20, off, s[4:7], s87 sc1
    s_waitcnt vmcnt(0)
    s_memtime s[76:77]
    s_waitcnt lgkmcnt(0)
    s_sub_u32 s87, s76, s74
    s_min_u32 s81, s81, s87
    s_memtime s[74:75]
    s_add_u32 s87, s84, 16384
    s_waitcnt lgkmcnt(0)
    buffer_load_dword v20, off, s[4:7], s87 sc1
    s_waitcnt vmcnt(0)
    s_memtime s[76:77]
    s_waitcnt lgkmcnt(0)
    s_sub_u32 s87, s76, s74
    s_min_u32 s80, s80, s87
    s_memtime s[74:75]
    s_add_u32 s87, s84, 24576
    s_waitcnt lgkmcnt(0)
    buffer_load_dword v20, off, s[4:7], s87 sc1
    s_waitcnt vmcnt(0)
    s_memtime s[76:77]
    s_waitcnt lgkmcnt(0)
    s_sub_u32 s87, s76, s74
    s_min_u32 s81, s81, s87
    s_memtime s[74:75]
    s_add_u32 s87, s84, 32768
    s_waitcnt lgkmcnt(0)
    buffer_load_dword v20, off, s[4:7], s87 sc1
    s_waitcnt vmcnt(0)
    s_memtime s[76:77]
    s_waitcnt lgkmcnt(0)
    s_sub_u32 s87, s76, s74
    s_min_u32 s80, s80, s87
    s_memtime s[74:75]
    s_add_u32 s87, s84, 40960
    s_waitcnt lgkmcnt(0)
    buffer_load_dword v20, off, s[4:7], s87 sc1
    s_waitcnt vmcnt(0)
    s_memtime s[76:77]
    s_waitcnt lgkmcnt(0)
    s_sub_u32 s87, s76, s74
    s_min_u32 s81, s81, s87
    s_memtime s[74:75]
    s_add_u32 s87, s84, 49152
    s_waitcnt lgkmcnt(0)
    buffer_load_dword v20, off, s[4:7], s87 sc1
    s_waitcnt vmcnt(0)
    s_memtime s[76:77]
    s_waitcnt lgkmcnt(0)
    s_sub_u32 s87, s76, s74
    s_min_u32 s80, s80, s87
    s_memtime s[74:75]
    s_add_u32 s87, s84, 57344
    s_waitcnt lgkmcnt(0)
    buffer_load_dword v20, off, s[4:7], s87 sc1
    s_waitcnt vmcnt(0)
    s_memtime s[76:77]
    s_waitcnt lgkmcnt(0)
    s_sub_u32 s87, s76, s74
    s_min_u32 s81, s81, s87
    s_memtime s[74:75]
    s_add_u32 s87, s84, 65536
    s_waitcnt lgkmcnt(0)
    buffer_load_dword v20, off, s[4:7], s87 sc1
    s_waitcnt vmcnt(0)
    s_memtime s[76:77]
    s_waitcnt lgkmcnt(0)
    s_sub_u32 s87, s76, s74
    s_min_u32 s80, s80, s87
    s_memtime s[74:75]
    s_add_u32 s87, s84, 73728
    s_waitcnt lgkmcnt(0)
    buffer_load_dword v20, off, s[4:7], s87 sc1
    s_waitcnt vmcnt(0)
    s_memtime s[76:77]
    s_waitcnt lgkmcnt(0)
    s_sub_u32 s87, s76, s74
    s_min_u32 s81, s81, s87
    s_memtime s[74:75]
    s_add_u32 s87, s84, 81920
    s_waitcnt lgkmcnt(0)
    buffer_load_dword v20, off, s[4:7], s87 sc1
    s_waitcnt vmcnt(0)
    s_memtime s[76:77]
    s_waitcnt lgkmcnt(0)
    s_sub_u32 s87, s76, s74
    s_min_u32 s80, s80, s87
    s_memtime s[74:75]
    s_add_u32 s87, s84, 90112
    s_waitcnt lgkmcnt(0)
    buffer_load_dword v20, off, s[4:7], s87 sc1
    s_waitcnt vmcnt(0)
    s_memtime s[76:77]
    s_waitcnt lgkmcnt(0)
    s_sub_u32 s87, s76, s74
    s_min_u32 s81, s81, s87
    s_sub_i32 s85, s80, s81
    s_min_i32 s85, s85, 400
    s_max_i32 s85, s85, -400
    s_lshl_b32 s85, s85, 8
    s_getreg_b32 s86, hwreg(HW_REG_XCC_ID)
    s_bfe_u32 s86, s86, 0x10002
    s_lshl_b32 s86, s86, 1
    s_or_b32 s85, s85, s86
    s_or_b32 s85, s85, 1
    s_mov_b32 s86, 65536
prb_i:
    buffer_load_dword v20, off, s[64:67], 0 offset:192 sc1
    s_waitcnt vmcnt(0)
    v_readfirstlane_b32 s84, v20
    s_cmp_ge_u32 s84, 32
    s_cbranch_scc1 prb_i_ok
    s_sleep 8
    s_sub_u32 s86, s86, 1
    s_cbranch_scc0 prb_i
prb_i_ok:
    v_mov_b32 v20, s85
    buffer_store_dword v20, off, s[4:7], s83 offset:8 sc1
    s_mov_b64 exec, -1
prb_bar:
    s_barrier
prb_done:
    s_cmp_lt_u32 s32, 4
    s_cbranch_scc1 w_nopre
    s_load_dwordx2 s[8:9], s[0:1], s33
    s_load_dwordx2 s[12:13], s[0:1], s34
    s_mov_b32 s10, s38
    s_mov_b32 s14, s38
    s_cmp_ge_u32 s32, 4
    s_cselect_b32 s31, 0, 1
    s_lshl_b32 s30, s3, s31
    s_mul_i32 s30, s30, s40
    s_add_u32 s16, s39, s30
    s_cmp_eq_u32 s32, 4
    s_cselect_b32 s30, 1024, s40
    s_cselect_b32 s31, 6, 5
    s_lshl_b32 s62, 32, s31
    s_add_u32 s17, s16, s30
    s_lshl_b32 s30, s3, 2
    s_mul_i32 s30, s30, s35
    s_add_u32 s18, s36, s30
    s_add_u32 s19, s37, s30
    s_lshl_b32 s20, s35, s31
    v_mul_u32_u24 v2, s35, v4
    v_add_u32 v2, v2, v3
    s_waitcnt lgkmcnt(0)
    s_add_u32 m0, s22, 0
    s_nop 0
    buffer_load_dwordx4 v2, s[8:11], s18 offen lds
    s_add_u32 s18, s18, s20
    s_add_u32 m0, s22, 8192
    s_nop 0
    buffer_load_dwordx4 v2, s[12:15], s19 offen lds
    s_add_u32 s19, s19, s20
    s_add_u32 m0, s22, 32768
    s_nop 0
    buffer_load_dwordx4 v2, s[8:11], s18 offen lds
    s_add_u32 s18, s18, s20
    s_add_u32 m0, s22, 40960
    s_nop 0
    buffer_load_dwordx4 v2, s[12:15], s19 offen lds
    s_add_u32 s19, s19, s20
    s_add_u32 m0, s22, 65536
    s_nop 0
    buffer_load_dwordx4 v2, s[8:11], s18 offen lds
    s_add_u32 s18, s18, s20
    s_add_u32 m0, s22, 73728
    s_nop 0
    buffer_load_dwordx4 v2, s[12:15], s19 offen lds
    s_add_u32 s19, s19, s20
    s_add_u32 m0, s22, 98304
    s_nop 0
    buffer_load_dwordx4 v2, s[8:11], s18 offen lds
    s_add_u32 s18, s18, s20
    s_add_u32 m0, s22, 106496
    s_nop 0
    buffer_load_dwordx4 v2, s[12:15], s19 offen lds
    s_add_u32 s19, s19, s20
    s_mov_b32 s70, 1
    s_cmp_lt_u32 s39, 1048576
    s_cselect_b32 s70, s70, 0
    s_cmp_lg_u32 s3, 0
    s_cbranch_scc1 lnwp_ok
    s_cmp_eq_u32 s70, 0
    s_cbranch_scc1 lnwp_full
    s_mov_b32 s69, 65536
lnwap:
    buffer_load_dword v20, off, s[64:67], 0 offset:192 sc1
    s_waitcnt vmcnt(0)
    v_readfirstlane_b32 s68, v20
    s_cmp_ge_u32 s68, 32
    s_cbranch_scc1 lnwap_ok
    s_sleep 8
    s_sub_u32 s69, s69, 1
    s_cbranch_scc0 lnwap
lnwap_ok:
    s_branch lnwp_ok
lnwp_full:
    s_mov_b32 s69, 65536
lnwp:
    buffer_load_dword v20, off, s[64:67], 0 offset:0 sc1
    s_waitcnt vmcnt(0)
    v_readfirstlane_b32 s68, v20
    s_cmp_ge_u32 s68, 128
    s_cbranch_scc1 lnwp_ok
    s_sleep 8
    s_sub_u32 s69, s69, 1
    s_cbranch_scc0 lnwp
lnwp_ok:
    s_barrier
    s_add_u32 m0, s21, 0
    s_nop 0
    buffer_load_dwordx4 v1, s[4:7], s16 offen sc1 lds
    s_add_u32 s16, s16, s62
    s_add_u32 m0, s21, 1024
    s_nop 0
    buffer_load_dwordx4 v1, s[4:7], s17 offen sc1 lds
    s_add_u32 s17, s17, s62
    s_add_u32 m0, s21, 32768
    s_nop 0
    buffer_load_dwordx4 v1, s[4:7], s16 offen sc1 lds
    s_add_u32 s16, s16, s62
    s_add_u32 m0, s21, 33792
    s_nop 0
    buffer_load_dwordx4 v1, s[4:7], s17 offen sc1 lds
    s_add_u32 s17, s17, s62
    s_add_u32 m0, s21, 65536
    s_nop 0
    buffer_load_dwordx4 v1, s[4:7], s16 offen sc1 lds
    s_add_u32 s16, s16, s62
    s_add_u32 m0, s21, 66560
    s_nop 0
    buffer_load_dwordx4 v1, s[4:7], s17 offen sc1 lds
    s_add_u32 s17, s17, s62
    s_add_u32 m0, s21, 98304
    s_nop 0
    buffer_load_dwordx4 v1, s[4:7], s16 offen sc1 lds
    s_add_u32 s16, s16, s62
    s_add_u32 m0, s21, 99328
    s_nop 0
    buffer_load_dwordx4 v1, s[4:7], s17 offen sc1 lds
    s_add_u32 s17, s17, s62
    s_branch w_adopt
w_nopre:
    s_mov_b32 s70, 1
    s_cmp_lt_u32 s39, 1048576
    s_cselect_b32 s70, s70, 0
    s_cmp_lg_u32 s3, 0
    s_cbranch_scc1 lnw_ok
    s_cmp_eq_u32 s70, 0
    s_cbranch_scc1 lnw_full
    s_mov_b32 s69, 65536
lnwa:
    buffer_load_dword v20, off, s[64:67], 0 offset:192 sc1
    s_waitcnt vmcnt(0)
    v_readfirstlane_b32 s68, v20
    s_cmp_ge_u32 s68, 32
    s_cbranch_scc1 lnwa_ok
    s_sleep 8
    s_sub_u32 s69, s69, 1
    s_cbranch_scc0 lnwa
lnwa_ok:
    s_branch lnw_ok
lnw_full:
    s_mov_b32 s69, 65536
lnw:
    buffer_load_dword v20, off, s[64:67], 0 offset:0 sc1
    s_waitcnt vmcnt(0)
    v_readfirstlane_b32 s68, v20
    s_cmp_ge_u32 s68, 128
    s_cbranch_scc1 lnw_ok
    s_sleep 8
    s_sub_u32 s69, s69, 1
    s_cbranch_scc0 lnw
lnw_ok:
    s_barrier
w_cold:
    s_cmp_eq_u32 s32, 0
    s_cbranch_scc1 fin_entry
    s_cmp_lg_u32 s3, 0
    s_cbranch_scc1 w_depok
    s_cmp_eq_u32 s45, 0
    s_cbranch_scc1 w_depok
    s_mov_b32 s31, 0x40000
w_waitdep:
    buffer_load_dword v16, v17, s[4:7], s44 offen sc1
    s_waitcnt vmcnt(0)
    v_readfirstlane_b32 s30, v16
    s_cmp_ge_u32 s30, s45
    s_cbranch_scc1 w_depok
    s_sleep 16
    s_sub_u32 s31, s31, 1
    s_cbranch_scc0 w_waitdep
w_depok:
    s_load_dwordx2 s[8:9], s[0:1], s33
    s_load_dwordx2 s[12:13], s[0:1], s34
    s_mov_b32 s10, s38
    s_mov_b32 s14, s38
    s_cmp_ge_u32 s32, 4
    s_cselect_b32 s31, 0, 1
    s_lshl_b32 s30, s3, s31
    s_mul_i32 s30, s30, s40
    s_add_u32 s16, s39, s30
    s_cmp_eq_u32 s32, 4
    s_cselect_b32 s30, 1024, s40
    s_cselect_b32 s31, 6, 5
    s_lshl_b32 s62, 32, s31
    s_add_u32 s17, s16, s30
    s_lshl_b32 s30, s3, 2
    s_mul_i32 s30, s30, s35
    s_add_u32 s18, s36, s30
    s_add_u32 s19, s37, s30
    s_lshl_b32 s20, s35, s31
    v_mul_u32_u24 v2, s35, v4
    v_add_u32 v2, v2, v3
    s_waitcnt lgkmcnt(0)
    s_barrier
    s_add_u32 m0, s21, 0
    s_nop 0
    buffer_load_dwordx4 v1, s[4:7], s16 offen sc1 lds
    s_add_u32 s16, s16, s62
    s_add_u32 m0, s21, 1024
    s_nop 0
    buffer_load_dwordx4 v1, s[4:7], s17 offen sc1 lds
    s_add_u32 s17, s17, s62
    s_add_u32 m0, s22, 0
    s_nop 0
    buffer_load_dwordx4 v2, s[8:11], s18 offen lds
    s_add_u32 s18, s18, s20
    s_add_u32 m0, s22, 8192
    s_nop 0
    buffer_load_dwordx4 v2, s[12:15], s19 offen lds
    s_add_u32 s19, s19, s20
    s_add_u32 m0, s21, 32768
    s_nop 0
    buffer_load_dwordx4 v1, s[4:7], s16 offen sc1 lds
    s_add_u32 s16, s16, s62
    s_add_u32 m0, s21, 33792
    s_nop 0
    buffer_load_dwordx4 v1, s[4:7], s17 offen sc1 lds
    s_add_u32 s17, s17, s62
    s_add_u32 m0, s22, 32768
    s_nop 0
    buffer_load_dwordx4 v2, s[8:11], s18 offen lds
    s_add_u32 s18, s18, s20
    s_add_u32 m0, s22, 40960
    s_nop 0
    buffer_load_dwordx4 v2, s[12:15], s19 offen lds
    s_add_u32 s19, s19, s20
    s_add_u32 m0, s21, 65536
    s_nop 0
    buffer_load_dwordx4 v1, s[4:7], s16 offen sc1 lds
    s_add_u32 s16, s16, s62
    s_add_u32 m0, s21, 66560
    s_nop 0
    buffer_load_dwordx4 v1, s[4:7], s17 offen sc1 lds
    s_add_u32 s17, s17, s62
    s_add_u32 m0, s22, 65536
    s_nop 0
    buffer_load_dwordx4 v2, s[8:11], s18 offen lds
    s_add_u32 s18, s18, s20
    s_add_u32 m0, s22, 73728
    s_nop 0
    buffer_load_dwordx4 v2, s[12:15], s19 offen lds
    s_add_u32 s19, s19, s20
    s_add_u32 m0, s21, 98304
    s_nop 0
    buffer_load_dwordx4 v1, s[4:7], s16 offen sc1 lds
    s_add_u32 s16, s16, s62
    s_add_u32 m0, s21, 99328
    s_nop 0
    buffer_load_dwordx4 v1, s[4:7], s17 offen sc1 lds
    s_add_u32 s17, s17, s62
    s_add_u32 m0, s22, 98304
    s_nop 0
    buffer_load_dwordx4 v2, s[8:11], s18 offen lds
    s_add_u32 s18, s18, s20
    s_add_u32 m0, s22, 106496
    s_nop 0
    buffer_load_dwordx4 v2, s[12:15], s19 offen lds
    s_add_u32 s19, s19, s20
w_adopt:
    s_cmp_eq_u32 s98, 1
    s_cbranch_scc1 ln_entry
w_adopt2:
    s_mov_b32 s48, s32
    s_cmp_ge_u32 s32, 4
    s_cselect_b32 s30, 2, 3
    s_lshl_b32 s30, s26, s30
    s_mul_i32 s30, s30, s43
    s_add_u32 s49, s42, s30
    s_mov_b32 s50, s43
    s_mov_b32 s51, s46
    s_mov_b32 s23, s41
    s_mov_b32 s53, s47
    s_nop 0
    s_load_dwordx16 s[32:47], s[24:25], 0
    s_add_u32 s24, s24, 64
    s_addc_u32 s25, s25, 0
    s_waitcnt vmcnt(0)
    s_cmp_eq_u32 s48, 6
    s_barrier
    s_cbranch_scc1 w_firstX
    s_cmp_lg_u32 s98, 2
    s_cbranch_scc1 lls_done
    s_mov_b32 s98, 0
    s_cmp_lg_u32 s3, 0
    s_cbranch_scc1 lls_done
    v_mov_b32 v20, 1
    s_mov_b64 exec, 1
    buffer_atomic_add v20, off, s[64:67], 0 offset:0 sc1
    s_mov_b64 exec, -1
lls_done:
    ds_read_b64_tr_b16 v[64:65], v8 offset:16384
    ds_read_b64_tr_b16 v[66:67], v9 offset:16384
    ds_read_b64_tr_b16 v[68:69], v10 offset:16384
    ds_read_b64_tr_b16 v[70:71], v11 offset:16384
    ds_read_b64_tr_b16 v[72:73], v8 offset:24576
    ds_read_b64_tr_b16 v[74:75], v9 offset:24576
    ds_read_b64_tr_b16 v[76:77], v10 offset:24576
    ds_read_b64_tr_b16 v[78:79], v11 offset:24576
    ds_read_b128 v[32:35], v5 offset:0
    ds_read_b128 v[36:39], v5 offset:1024
    ds_read_b128 v[40:43], v5 offset:2048
    ds_read_b128 v[44:47], v5 offset:3072
    ds_read_b128 v[48:51], v5 offset:4096
    ds_read_b128 v[52:55], v5 offset:5120
    ds_read_b128 v[56:59], v5 offset:6144
    ds_read_b128 v[60:63], v5 offset:7168
    s_waitcnt lgkmcnt(0)
    s_cmp_eq_u32 s48, 4
    s_cbranch_scc1 w_firstH
    s_cmp_eq_u32 s48, 5
    s_cbranch_scc1 w_firstM
    s_branch w_first16
w_first4:
    s_waitcnt vmcnt(12)
    s_barrier
    v_mfma_f32_16x16x32_bf16 v[128:131], v[64:67], v[32:35], 0
    ds_read_b64_tr_b16 v[112:113], v8 offset:49152
    v_mfma_f32_16x16x32_bf16 v[132:135], v[68:71], v[32:35], 0
    ds_read_b64_tr_b16 v[114:115], v9 offset:49152
    v_mfma_f32_16x16x32_bf16 v[136:139], v[72:75], v[32:35], 0
    ds_read_b64_tr_b16 v[116:117], v10 offset:49152
    v_mfma_f32_16x16x32_bf16 v[140:143], v[76:79], v[32:35], 0
    ds_read_b64_tr_b16 v[118:119], v11 offset:49152
    v_mfma_f32_16x16x32_bf16 v[144:147], v[64:67], v[36:39], 0
    ds_read_b64_tr_b16 v[120:121], v8 offset:57344
    v_mfma_f32_16x16x32_bf16 v[148:151], v[68:71], v[36:39], 0
    ds_read_b64_tr_b16 v[122:123], v9 offset:57344
    v_mfma_f32_16x16x32_bf16 v[152:155], v[72:75], v[36:39], 0
    ds_read_b64_tr_b16 v[124:125], v10 offset:57344
    v_mfma_f32_16x16x32_bf16 v[156:159], v[76:79], v[36:39], 0
    ds_read_b64_tr_b16 v[126:127], v11 offset:57344
    v_mfma_f32_16x16x32_bf16 v[160:163], v[64:67], v[40:43], 0
    ds_read_b128 v[80:83], v5 offset:32768
    v_mfma_f32_16x16x32_bf16 v[164:167], v[68:71], v[40:43], 0
    ds_read_b128 v[84:87], v5 offset:33792
    v_mfma_f32_16x16x32_bf16 v[168:171], v[72:75], v[40:43], 0
    ds_read_b128 v[88:91], v5 offset:34816
    v_mfma_f32_16x16x32_bf16 v[172:175], v[76:79], v[40:43], 0
    ds_read_b128 v[92:95], v5 offset:35840
    v_mfma_f32_16x16x32_bf16 v[176:179], v[64:67], v[44:47], 0
    ds_read_b128 v[96:99], v5 offset:36864
    v_mfma_f32_16x16x32_bf16 v[180:183], v[68:71], v[44:47], 0
    ds_read_b128 v[100:103], v5 offset:37888
    v_mfma_f32_16x16x32_bf16 v[184:187], v[72:75], v[44:47], 0
    ds_read_b128 v[104:107], v5 offset:38912
    v_mfma_f32_16x16x32_bf16 v[188:191], v[76:79], v[44:47], 0
    ds_read_b128 v[108:111], v5 offset:39936
    v_mfma_f32_16x16x32_bf16 v[192:195], v[64:67], v[48:51], 0
    v_mfma_f32_16x16x32_bf16 v[196:199], v[68:71], v[48:51], 0
    s_add_u32 m0, s21, 0
    s_nop 0
    buffer_load_dwordx4 v1, s[4:7], s16 offen sc1 lds
    s_add_u32 s16, s16, s62
    v_mfma_f32_16x16x32_bf16 v[200:203], v[72:75], v[48:51], 0
    v_mfma_f32_16x16x32_bf16 v[204:207], v[76:79], v[48:51], 0
    v_mfma_f32_16x16x32_bf16 v[208:211], v[64:67], v[52:55], 0
    s_add_u32 m0, s21, 1024
    s_nop 0
    buffer_load_dwordx4 v1, s[4:7], s17 offen sc1 lds
    s_add_u32 s17, s17, s62
    v_mfma_f32_16x16x32_bf16 v[212:215], v[68:71], v[52:55], 0
    v_mfma_f32_16x16x32_bf16 v[216:219], v[72:75], v[52:55], 0
    v_mfma_f32_16x16x32_bf16 v[220:223], v[76:79], v[52:55], 0
    s_add_u32 m0, s22, 0
    s_nop 0
    buffer_load_dwordx4 v2, s[8:11], s18 offen lds
    s_add_u32 s18, s18, s20
    v_mfma_f32_16x16x32_bf16 v[224:227], v[64:67], v[56:59], 0
    v_mfma_f32_16x16x32_bf16 v[228:231], v[68:71], v[56:59], 0
    v_mfma_f32_16x16x32_bf16 v[232:235], v[72:75], v[56:59], 0
    s_add_u32 m0, s22, 8192
    s_nop 0
    buffer_load_dwordx4 v2, s[12:15], s19 offen lds
    s_add_u32 s19, s19, s20
    v_mfma_f32_16x16x32_bf16 v[236:239], v[76:79], v[56:59], 0
    v_mfma_f32_16x16x32_bf16 v[240:243], v[64:67], v[60:63], 0
    v_mfma_f32_16x16x32_bf16 v[244:247], v[68:71], v[60:63], 0
    v_mfma_f32_16x16x32_bf16 v[248:251], v[72:75], v[60:63], 0
    v_mfma_f32_16x16x32_bf16 v[252:255], v[76:79], v[60:63], 0
    s_waitcnt lgkmcnt(0)
    s_waitcnt vmcnt(12)
    s_barrier
    v_mfma_f32_16x16x32_bf16 v[128:131], v[112:115], v[80:83], v[128:131]
    ds_read_b64_tr_b16 v[64:65], v12 offset:16384
    v_mfma_f32_16x16x32_bf16 v[132:135], v[116:119], v[80:83], v[132:135]
    ds_read_b64_tr_b16 v[66:67], v13 offset:16384
    v_mfma_f32_16x16x32_bf16 v[136:139], v[120:123], v[80:83], v[136:139]
    ds_read_b64_tr_b16 v[68:69], v14 offset:16384
    v_mfma_f32_16x16x32_bf16 v[140:143], v[124:127], v[80:83], v[140:143]
    ds_read_b64_tr_b16 v[70:71], v15 offset:16384
    v_mfma_f32_16x16x32_bf16 v[144:147], v[112:115], v[84:87], v[144:147]
    ds_read_b64_tr_b16 v[72:73], v12 offset:24576
    v_mfma_f32_16x16x32_bf16 v[148:151], v[116:119], v[84:87], v[148:151]
    ds_read_b64_tr_b16 v[74:75], v13 offset:24576
    v_mfma_f32_16x16x32_bf16 v[152:155], v[120:123], v[84:87], v[152:155]
    ds_read_b64_tr_b16 v[76:77], v14 offset:24576
    v_mfma_f32_16x16x32_bf16 v[156:159], v[124:127], v[84:87], v[156:159]
    ds_read_b64_tr_b16 v[78:79], v15 offset:24576
    v_mfma_f32_16x16x32_bf16 v[160:163], v[112:115], v[88:91], v[160:163]
    ds_read_b128 v[32:35], v6 offset:0
    v_mfma_f32_16x16x32_bf16 v[164:167], v[116:119], v[88:91], v[164:167]
    ds_read_b128 v[36:39], v6 offset:1024
    v_mfma_f32_16x16x32_bf16 v[168:171], v[120:123], v[88:91], v[168:171]
    ds_read_b128 v[40:43], v6 offset:2048
    v_mfma_f32_16x16x32_bf16 v[172:175], v[124:127], v[88:91], v[172:175]
    ds_read_b128 v[44:47], v6 offset:3072
    v_mfma_f32_16x16x32_bf16 v[176:179], v[112:115], v[92:95], v[176:179]
    ds_read_b128 v[48:51], v6 offset:4096
    v_mfma_f32_16x16x32_bf16 v[180:183], v[116:119], v[92:95], v[180:183]
    ds_read_b128 v[52:55], v6 offset:5120
    v_mfma_f32_16x16x32_bf16 v[184:187], v[120:123], v[92:95], v[184:187]
    ds_read_b128 v[56:59], v6 offset:6144
    v_mfma_f32_16x16x32_bf16 v[188:191], v[124:127], v[92:95], v[188:191]
    ds_read_b128 v[60:63], v6 offset:7168
    v_mfma_f32_16x16x32_bf16 v[192:195], v[112:115], v[96:99], v[192:195]
    v_mfma_f32_16x16x32_bf16 v[196:199], v[116:119], v[96:99], v[196:199]
    s_add_u32 m0, s21, 32768
    s_nop 0
    buffer_load_dwordx4 v1, s[4:7], s16 offen sc1 lds
    s_add_u32 s16, s16, s62
    v_mfma_f32_16x16x32_bf16 v[200:203], v[120:123], v[96:99], v[200:203]
    v_mfma_f32_16x16x32_bf16 v[204:207], v[124:127], v[96:99], v[204:207]
    v_mfma_f32_16x16x32_bf16 v[208:211], v[112:115], v[100:103], v[208:211]
    s_add_u32 m0, s21, 33792
    s_nop 0
    buffer_load_dwordx4 v1, s[4:7], s17 offen sc1 lds
    s_add_u32 s17, s17, s62
    v_mfma_f32_16x16x32_bf16 v[212:215], v[116:119], v[100:103], v[212:215]
    v_mfma_f32_16x16x32_bf16 v[216:219], v[120:123], v[100:103], v[216:219]
    v_mfma_f32_16x16x32_bf16 v[220:223], v[124:127], v[100:103], v[220:223]
    s_add_u32 m0, s22, 32768
    s_nop 0
    buffer_load_dwordx4 v2, s[8:11], s18 offen lds
    s_add_u32 s18, s18, s20
    v_mfma_f32_16x16x32_bf16 v[224:227], v[112:115], v[104:107], v[224:227]
    v_mfma_f32_16x16x32_bf16 v[228:231], v[116:119], v[104:107], v[228:231]
    v_mfma_f32_16x16x32_bf16 v[232:235], v[120:123], v[104:107], v[232:235]
    s_add_u32 m0, s22, 40960
    s_nop 0
    buffer_load_dwordx4 v2, s[12:15], s19 offen lds
    s_add_u32 s19, s19, s20
    v_mfma_f32_16x16x32_bf16 v[236:239], v[124:127], v[104:107], v[236:239]
    v_mfma_f32_16x16x32_bf16 v[240:243], v[112:115], v[108:111], v[240:243]
    v_mfma_f32_16x16x32_bf16 v[244:247], v[116:119], v[108:111], v[244:247]
    v_mfma_f32_16x16x32_bf16 v[248:251], v[120:123], v[108:111], v[248:251]
    v_mfma_f32_16x16x32_bf16 v[252:255], v[124:127], v[108:111], v[252:255]
    s_waitcnt lgkmcnt(0)
    s_waitcnt vmcnt(12)
    s_barrier
    v_mfma_f32_16x16x32_bf16 v[128:131], v[64:67], v[32:35], v[128:131]
    ds_read_b64_tr_b16 v[112:113], v12 offset:49152
    v_mfma_f32_16x16x32_bf16 v[132:135], v[68:71], v[32:35], v[132:135]
    ds_read_b64_tr_b16 v[114:115], v13 offset:49152
    v_mfma_f32_16x16x32_bf16 v[136:139], v[72:75], v[32:35], v[136:139]
    ds_read_b64_tr_b16 v[116:117], v14 offset:49152
    v_mfma_f32_16x16x32_bf16 v[140:143], v[76:79], v[32:35], v[140:143]
    ds_read_b64_tr_b16 v[118:119], v15 offset:49152
    v_mfma_f32_16x16x32_bf16 v[144:147], v[64:67], v[36:39], v[144:147]
    ds_read_b64_tr_b16 v[120:121], v12 offset:57344
    v_mfma_f32_16x16x32_bf16 v[148:151], v[68:71], v[36:39], v[148:151]
    ds_read_b64_tr_b16 v[122:123], v13 offset:57344
    v_mfma_f32_16x16x32_bf16 v[152:155], v[72:75], v[36:39], v[152:155]
    ds_read_b64_tr_b16 v[124:125], v14 offset:57344
    v_mfma_f32_16x16x32_bf16 v[156:159], v[76:79], v[36:39], v[156:159]
    ds_read_b64_tr_b16 v[126:127], v15 offset:57344
    v_mfma_f32_16x16x32_bf16 v[160:163], v[64:67], v[40:43], v[160:163]
    ds_read_b128 v[80:83], v6 offset:32768
    v_mfma_f32_16x16x32_bf16 v[164:167], v[68:71], v[40:43], v[164:167]
    ds_read_b128 v[84:87], v6 offset:33792
    v_mfma_f32_16x16x32_bf16 v[168:171], v[72:75], v[40:43], v[168:171]
    ds_read_b128 v[88:91], v6 offset:34816
    v_mfma_f32_16x16x32_bf16 v[172:175], v[76:79], v[40:43], v[172:175]
    ds_read_b128 v[92:95], v6 offset:35840
    v_mfma_f32_16x16x32_bf16 v[176:179], v[64:67], v[44:47], v[176:179]
    ds_read_b128 v[96:99], v6 offset:36864
    v_mfma_f32_16x16x32_bf16 v[180:183], v[68:71], v[44:47], v[180:183]
    ds_read_b128 v[100:103], v6 offset:37888
    v_mfma_f32_16x16x32_bf16 v[184:187], v[72:75], v[44:47], v[184:187]
    ds_read_b128 v[104:107], v6 offset:38912
    v_mfma_f32_16x16x32_bf16 v[188:191], v[76:79], v[44:47], v[188:191]
    ds_read_b128 v[108:111], v6 offset:39936
    v_mfma_f32_16x16x32_bf16 v[192:195], v[64:67], v[48:51], v[192:195]
    v_mfma_f32_16x16x32_bf16 v[196:199], v[68:71], v[48:51], v[196:199]
    s_add_u32 m0, s21, 65536
    s_nop 0
    buffer_load_dwordx4 v1, s[4:7], s16 offen sc1 lds
    s_add_u32 s16, s16, s62
    v_mfma_f32_16x16x32_bf16 v[200:203], v[72:75], v[48:51], v[200:203]
    v_mfma_f32_16x16x32_bf16 v[204:207], v[76:79], v[48:51], v[204:207]
    v_mfma_f32_16x16x32_bf16 v[208:211], v[64:67], v[52:55], v[208:211]
    s_add_u32 m0, s21, 66560
    s_nop 0
    buffer_load_dwordx4 v1, s[4:7], s17 offen sc1 lds
    s_add_u32 s17, s17, s62
    v_mfma_f32_16x16x32_bf16 v[212:215], v[68:71], v[52:55], v[212:215]
    v_mfma_f32_16x16x32_bf16 v[216:219], v[72:75], v[52:55], v[216:219]
    v_mfma_f32_16x16x32_bf16 v[220:223], v[76:79], v[52:55], v[220:223]
    s_add_u32 m0, s22, 65536
    s_nop 0
    buffer_load_dwordx4 v2, s[8:11], s18 offen lds
    s_add_u32 s18, s18, s20
    v_mfma_f32_16x16x32_bf16 v[224:227], v[64:67], v[56:59], v[224:227]
    v_mfma_f32_16x16x32_bf16 v[228:231], v[68:71], v[56:59], v[228:231]
    v_mfma_f32_16x16x32_bf16 v[232:235], v[72:75], v[56:59], v[232:235]
    s_add_u32 m0, s22, 73728
    s_nop 0
    buffer_load_dwordx4 v2, s[12:15], s19 offen lds
    s_add_u32 s19, s19, s20
    v_mfma_f32_16x16x32_bf16 v[236:239], v[76:79], v[56:59], v[236:239]
    v_mfma_f32_16x16x32_bf16 v[240:243], v[64:67], v[60:63], v[240:243]
    v_mfma_f32_16x16x32_bf16 v[244:247], v[68:71], v[60:63], v[244:247]
    v_mfma_f32_16x16x32_bf16 v[248:251], v[72:75], v[60:63], v[248:251]
    v_mfma_f32_16x16x32_bf16 v[252:255], v[76:79], v[60:63], v[252:255]
    s_waitcnt lgkmcnt(0)
    s_waitcnt vmcnt(8)
    s_barrier
    s_cmp_eq_u32 s28, 0
    s_cbranch_scc1 sig_2
    s_cmp_lg_u32 s3, 0
    s_cbranch_scc1 sig_2
    s_mov_b64 exec, 1
    v_mov_b32 v18, s57
    buffer_atomic_add v18, v17, s[4:7], s28 offen sc1
    s_mov_b64 exec, -1
sig_2:
    s_mov_b32 s28, 0
    v_mfma_f32_16x16x32_bf16 v[128:131], v[112:115], v[80:83], v[128:131]
    ds_read_b64_tr_b16 v[64:65], v8 offset:16384
    v_mfma_f32_16x16x32_bf16 v[132:135], v[116:119], v[80:83], v[132:135]
    ds_read_b64_tr_b16 v[66:67], v9 offset:16384
    v_mfma_f32_16x16x32_bf16 v[136:139], v[120:123], v[80:83], v[136:139]
    ds_read_b64_tr_b16 v[68:69], v10 offset:16384
    v_mfma_f32_16x16x32_bf16 v[140:143], v[124:127], v[80:83], v[140:143]
    ds_read_b64_tr_b16 v[70:71], v11 offset:16384
    v_mfma_f32_16x16x32_bf16 v[144:147], v[112:115], v[84:87], v[144:147]
    ds_read_b64_tr_b16 v[72:73], v8 offset:24576
    v_mfma_f32_16x16x32_bf16 v[148:151], v[116:119], v[84:87], v[148:151]
    ds_read_b64_tr_b16 v[74:75], v9 offset:24576
    v_mfma_f32_16x16x32_bf16 v[152:155], v[120:123], v[84:87], v[152:155]
    ds_read_b64_tr_b16 v[76:77], v10 offset:24576
    v_mfma_f32_16x16x32_bf16 v[156:159], v[124:127], v[84:87], v[156:159]
    ds_read_b64_tr_b16 v[78:79], v11 offset:24576
    v_mfma_f32_16x16x32_bf16 v[160:163], v[112:115], v[88:91], v[160:163]
    ds_read_b128 v[32:35], v5 offset:0
    v_mfma_f32_16x16x32_bf16 v[164:167], v[116:119], v[88:91], v[164:167]
    ds_read_b128 v[36:39], v5 offset:1024
    v_mfma_f32_16x16x32_bf16 v[168:171], v[120:123], v[88:91], v[168:171]
    ds_read_b128 v[40:43], v5 offset:2048
    v_mfma_f32_16x16x32_bf16 v[172:175], v[124:127], v[88:91], v[172:175]
    ds_read_b128 v[44:47], v5 offset:3072
    v_mfma_f32_16x16x32_bf16 v[176:179], v[112:115], v[92:95], v[176:179]
    ds_read_b128 v[48:51], v5 offset:4096
    v_mfma_f32_16x16x32_bf16 v[180:183], v[116:119], v[92:95], v[180:183]
    ds_read_b128 v[52:55], v5 offset:5120
    v_mfma_f32_16x16x32_bf16 v[184:187], v[120:123], v[92:95], v[184:187]
    ds_read_b128 v[56:59], v5 offset:6144
    v_mfma_f32_16x16x32_bf16 v[188:191], v[124:127], v[92:95], v[188:191]
    ds_read_b128 v[60:63], v5 offset:7168
    v_mfma_f32_16x16x32_bf16 v[192:195], v[112:115], v[96:99], v[192:195]
    v_mfma_f32_16x16x32_bf16 v[196:199], v[116:119], v[96:99], v[196:199]
    s_add_u32 m0, s21, 98304
    s_nop 0
    buffer_load_dwordx4 v1, s[4:7], s16 offen sc1 lds
    s_add_u32 s16, s16, s62
    v_mfma_f32_16x16x32_bf16 v[200:203], v[120:123], v[96:99], v[200:203]
    v_mfma_f32_16x16x32_bf16 v[204:207], v[124:127], v[96:99], v[204:207]
    v_mfma_f32_16x16x32_bf16 v[208:211], v[112:115], v[100:103], v[208:211]
    s_add_u32 m0, s21, 99328
    s_nop 0
    buffer_load_dwordx4 v1, s[4:7], s17 offen sc1 lds
    s_add_u32 s17, s17, s62
    v_mfma_f32_16x16x32_bf16 v[212:215], v[116:119], v[100:103], v[212:215]
    v_mfma_f32_16x16x32_bf16 v[216:219], v[120:123], v[100:103], v[216:219]
    v_mfma_f32_16x16x32_bf16 v[220:223], v[124:127], v[100:103], v[220:223]
    s_add_u32 m0, s22, 98304
    s_nop 0
    buffer_load_dwordx4 v2, s[8:11], s18 offen lds
    s_add_u32 s18, s18, s20
    v_mfma_f32_16x16x32_bf16 v[224:227], v[112:115], v[104:107], v[224:227]
    v_mfma_f32_16x16x32_bf16 v[228:231], v[116:119], v[104:107], v[228:231]
    v_mfma_f32_16x16x32_bf16 v[232:235], v[120:123], v[104:107], v[232:235]
    s_add_u32 m0, s22, 106496
    s_nop 0
    buffer_load_dwordx4 v2, s[12:15], s19 offen lds
    s_add_u32 s19, s19, s20
    v_mfma_f32_16x16x32_bf16 v[236:239], v[124:127], v[104:107], v[236:239]
    v_mfma_f32_16x16x32_bf16 v[240:243], v[112:115], v[108:111], v[240:243]
    v_mfma_f32_16x16x32_bf16 v[244:247], v[116:119], v[108:111], v[244:247]
    v_mfma_f32_16x16x32_bf16 v[248:251], v[120:123], v[108:111], v[248:251]
    v_mfma_f32_16x16x32_bf16 v[252:255], v[124:127], v[108:111], v[252:255]
    s_waitcnt lgkmcnt(0)
    s_branch w_loop_chk
w_first8:
    s_waitcnt vmcnt(16)
    s_barrier
    v_mfma_f32_16x16x32_bf16 v[128:131], v[64:67], v[32:35], 0
    ds_read_b64_tr_b16 v[112:113], v8 offset:49152
    v_mfma_f32_16x16x32_bf16 v[132:135], v[68:71], v[32:35], 0
    ds_read_b64_tr_b16 v[114:115], v9 offset:49152
    v_mfma_f32_16x16x32_bf16 v[136:139], v[72:75], v[32:35], 0
    ds_read_b64_tr_b16 v[116:117], v10 offset:49152
    v_mfma_f32_16x16x32_bf16 v[140:143], v[76:79], v[32:35], 0
    ds_read_b64_tr_b16 v[118:119], v11 offset:49152
    v_mfma_f32_16x16x32_bf16 v[144:147], v[64:67], v[36:39], 0
    ds_read_b64_tr_b16 v[120:121], v8 offset:57344
    v_mfma_f32_16x16x32_bf16 v[148:151], v[68:71], v[36:39], 0
    ds_read_b64_tr_b16 v[122:123], v9 offset:57344
    v_mfma_f32_16x16x32_bf16 v[152:155], v[72:75], v[36:39], 0
    ds_read_b64_tr_b16 v[124:125], v10 offset:57344
    v_mfma_f32_16x16x32_bf16 v[156:159], v[76:79], v[36:39], 0
    ds_read_b64_tr_b16 v[126:127], v11 offset:57344
    v_mfma_f32_16x16x32_bf16 v[160:163], v[64:67], v[40:43], 0
    ds_read_b128 v[80:83], v5 offset:32768
    v_mfma_f32_16x16x32_bf16 v[164:167], v[68:71], v[40:43], 0
    ds_read_b128 v[84:87], v5 offset:33792
    v_mfma_f32_16x16x32_bf16 v[168:171], v[72:75], v[40:43], 0
    ds_read_b128 v[88:91], v5 offset:34816
    v_mfma_f32_16x16x32_bf16 v[172:175], v[76:79], v[40:43], 0
    ds_read_b128 v[92:95], v5 offset:35840
    v_mfma_f32_16x16x32_bf16 v[176:179], v[64:67], v[44:47], 0
    ds_read_b128 v[96:99], v5 offset:36864
    v_mfma_f32_16x16x32_bf16 v[180:183], v[68:71], v[44:47], 0
    ds_read_b128 v[100:103], v5 offset:37888
    v_mfma_f32_16x16x32_bf16 v[184:187], v[72:75], v[44:47], 0
    ds_read_b128 v[104:107], v5 offset:38912
    v_mfma_f32_16x16x32_bf16 v[188:191], v[76:79], v[44:47], 0
    ds_read_b128 v[108:111], v5 offset:39936
    v_mfma_f32_16x16x32_bf16 v[192:195], v[64:67], v[48:51], 0
    v_mfma_f32_16x16x32_bf16 v[196:199], v[68:71], v[48:51], 0
    s_add_u32 m0, s21, 0
    s_nop 0
    buffer_load_dwordx4 v1, s[4:7], s16 offen sc1 lds
    s_add_u32 s16, s16, s62
    v_mfma_f32_16x16x32_bf16 v[200:203], v[72:75], v[48:51], 0
    v_mfma_f32_16x16x32_bf16 v[204:207], v[76:79], v[48:51], 0
    v_mfma_f32_16x16x32_bf16 v[208:211], v[64:67], v[52:55], 0
    s_add_u32 m0, s21, 1024
    s_nop 0
    buffer_load_dwordx4 v1, s[4:7], s17 offen sc1 lds
    s_add_u32 s17, s17, s62
    v_mfma_f32_16x16x32_bf16 v[212:215], v[68:71], v[52:55], 0
    v_mfma_f32_16x16x32_bf16 v[216:219], v[72:75], v[52:55], 0
    v_mfma_f32_16x16x32_bf16 v[220:223], v[76:79], v[52:55], 0
    s_add_u32 m0, s22, 0
    s_nop 0
    buffer_load_dwordx4 v2, s[8:11], s18 offen lds
    s_add_u32 s18, s18, s20
    v_mfma_f32_16x16x32_bf16 v[224:227], v[64:67], v[56:59], 0
    v_mfma_f32_16x16x32_bf16 v[228:231], v[68:71], v[56:59], 0
    v_mfma_f32_16x16x32_bf16 v[232:235], v[72:75], v[56:59], 0
    s_add_u32 m0, s22, 8192
    s_nop 0
    buffer_load_dwordx4 v2, s[12:15], s19 offen lds
    s_add_u32 s19, s19, s20
    v_mfma_f32_16x16x32_bf16 v[236:239], v[76:79], v[56:59], 0
    v_mfma_f32_16x16x32_bf16 v[240:243], v[64:67], v[60:63], 0
    v_mfma_f32_16x16x32_bf16 v[244:247], v[68:71], v[60:63], 0
    v_mfma_f32_16x16x32_bf16 v[248:251], v[72:75], v[60:63], 0
    v_mfma_f32_16x16x32_bf16 v[252:255], v[76:79], v[60:63], 0
    s_waitcnt lgkmcnt(0)
    s_waitcnt vmcnt(16)
    s_barrier
    v_mfma_f32_16x16x32_bf16 v[128:131], v[112:115], v[80:83], v[128:131]
    ds_read_b64_tr_b16 v[64:65], v12 offset:16384
    v_mfma_f32_16x16x32_bf16 v[132:135], v[116:119], v[80:83], v[132:135]
    ds_read_b64_tr_b16 v[66:67], v13 offset:16384
    v_mfma_f32_16x16x32_bf16 v[136:139], v[120:123], v[80:83], v[136:139]
    ds_read_b64_tr_b16 v[68:69], v14 offset:16384
    v_mfma_f32_16x16x32_bf16 v[140:143], v[124:127], v[80:83], v[140:143]
    ds_read_b64_tr_b16 v[70:71], v15 offset:16384
    v_mfma_f32_16x16x32_bf16 v[144:147], v[112:115], v[84:87], v[144:147]
    ds_read_b64_tr_b16 v[72:73], v12 offset:24576
    v_mfma_f32_16x16x32_bf16 v[148:151], v[116:119], v[84:87], v[148:151]
    ds_read_b64_tr_b16 v[74:75], v13 offset:24576
    v_mfma_f32_16x16x32_bf16 v[152:155], v[120:123], v[84:87], v[152:155]
    ds_read_b64_tr_b16 v[76:77], v14 offset:24576
    v_mfma_f32_16x16x32_bf16 v[156:159], v[124:127], v[84:87], v[156:159]
    ds_read_b64_tr_b16 v[78:79], v15 offset:24576
    v_mfma_f32_16x16x32_bf16 v[160:163], v[112:115], v[88:91], v[160:163]
    ds_read_b128 v[32:35], v6 offset:0
    v_mfma_f32_16x16x32_bf16 v[164:167], v[116:119], v[88:91], v[164:167]
    ds_read_b128 v[36:39], v6 offset:1024
    v_mfma_f32_16x16x32_bf16 v[168:171], v[120:123], v[88:91], v[168:171]
    ds_read_b128 v[40:43], v6 offset:2048
    v_mfma_f32_16x16x32_bf16 v[172:175], v[124:127], v[88:91], v[172:175]
    ds_read_b128 v[44:47], v6 offset:3072
    v_mfma_f32_16x16x32_bf16 v[176:179], v[112:115], v[92:95], v[176:179]
    ds_read_b128 v[48:51], v6 offset:4096
    v_mfma_f32_16x16x32_bf16 v[180:183], v[116:119], v[92:95], v[180:183]
    ds_read_b128 v[52:55], v6 offset:5120
    v_mfma_f32_16x16x32_bf16 v[184:187], v[120:123], v[92:95], v[184:187]
    ds_read_b128 v[56:59], v6 offset:6144
    v_mfma_f32_16x16x32_bf16 v[188:191], v[124:127], v[92:95], v[188:191]
    ds_read_b128 v[60:63], v6 offset:7168
    v_mfma_f32_16x16x32_bf16 v[192:195], v[112:115], v[96:99], v[192:195]
    v_mfma_f32_16x16x32_bf16 v[196:199], v[116:119], v[96:99], v[196:199]
    s_add_u32 m0, s21, 32768
    s_nop 0
    buffer_load_dwordx4 v1, s[4:7], s16 offen sc1 lds
    s_add_u32 s16, s16, s62
    v_mfma_f32_16x16x32_bf16 v[200:203], v[120:123], v[96:99], v[200:203]
    v_mfma_f32_16x16x32_bf16 v[204:207], v[124:127], v[96:99], v[204:207]
    v_mfma_f32_16x16x32_bf16 v[208:211], v[112:115], v[100:103], v[208:211]
    s_add_u32 m0, s21, 33792
    s_nop 0
    buffer_load_dwordx4 v1, s[4:7], s17 offen sc1 lds
    s_add_u32 s17, s17, s62
    v_mfma_f32_16x16x32_bf16 v[212:215], v[116:119], v[100:103], v[212:215]
    v_mfma_f32_16x16x32_bf16 v[216:219], v[120:123], v[100:103], v[216:219]
    v_mfma_f32_16x16x32_bf16 v[220:223], v[124:127], v[100:103], v[220:223]
    s_add_u32 m0, s22, 32768
    s_nop 0
    buffer_load_dwordx4 v2, s[8:11], s18 offen lds
    s_add_u32 s18, s18, s20
    v_mfma_f32_16x16x32_bf16 v[224:227], v[112:115], v[104:107], v[224:227]
    v_mfma_f32_16x16x32_bf16 v[228:231], v[116:119], v[104:107], v[228:231]
    v_mfma_f32_16x16x32_bf16 v[232:235], v[120:123], v[104:107], v[232:235]
    s_add_u32 m0, s22, 40960
    s_nop 0
    buffer_load_dwordx4 v2, s[12:15], s19 offen lds
    s_add_u32 s19, s19, s20
    v_mfma_f32_16x16x32_bf16 v[236:239], v[124:127], v[104:107], v[236:239]
    v_mfma_f32_16x16x32_bf16 v[240:243], v[112:115], v[108:111], v[240:243]
    v_mfma_f32_16x16x32_bf16 v[244:247], v[116:119], v[108:111], v[244:247]
    v_mfma_f32_16x16x32_bf16 v[248:251], v[120:123], v[108:111], v[248:251]
    v_mfma_f32_16x16x32_bf16 v[252:255], v[124:127], v[108:111], v[252:255]
    s_waitcnt lgkmcnt(0)
    s_waitcnt vmcnt(16)
    s_barrier
    v_mfma_f32_16x16x32_bf16 v[128:131], v[64:67], v[32:35], v[128:131]
    ds_read_b64_tr_b16 v[112:113], v12 offset:49152
    v_mfma_f32_16x16x32_bf16 v[132:135], v[68:71], v[32:35], v[132:135]
    ds_read_b64_tr_b16 v[114:115], v13 offset:49152
    v_mfma_f32_16x16x32_bf16 v[136:139], v[72:75], v[32:35], v[136:139]
    ds_read_b64_tr_b16 v[116:117], v14 offset:49152
    v_mfma_f32_16x16x32_bf16 v[140:143], v[76:79], v[32:35], v[140:143]
    ds_read_b64_tr_b16 v[118:119], v15 offset:49152
    v_mfma_f32_16x16x32_bf16 v[144:147], v[64:67], v[36:39], v[144:147]
    ds_read_b64_tr_b16 v[120:121], v12 offset:57344
    v_mfma_f32_16x16x32_bf16 v[148:151], v[68:71], v[36:39], v[148:151]
    ds_read_b64_tr_b16 v[122:123], v13 offset:57344
    v_mfma_f32_16x16x32_bf16 v[152:155], v[72:75], v[36:39], v[152:155]
    ds_read_b64_tr_b16 v[124:125], v14 offset:57344
    v_mfma_f32_16x16x32_bf16 v[156:159], v[76:79], v[36:39], v[156:159]
    ds_read_b64_tr_b16 v[126:127], v15 offset:57344
    v_mfma_f32_16x16x32_bf16 v[160:163], v[64:67], v[40:43], v[160:163]
    ds_read_b128 v[80:83], v6 offset:32768
    v_mfma_f32_16x16x32_bf16 v[164:167], v[68:71], v[40:43], v[164:167]
    ds_read_b128 v[84:87], v6 offset:33792
    v_mfma_f32_16x16x32_bf16 v[168:171], v[72:75], v[40:43], v[168:171]
    ds_read_b128 v[88:91], v6 offset:34816
    v_mfma_f32_16x16x32_bf16 v[172:175], v[76:79], v[40:43], v[172:175]
    ds_read_b128 v[92:95], v6 offset:35840
    v_mfma_f32_16x16x32_bf16 v[176:179], v[64:67], v[44:47], v[176:179]
    ds_read_b128 v[96:99], v6 offset:36864
    v_mfma_f32_16x16x32_bf16 v[180:183], v[68:71], v[44:47], v[180:183]
    ds_read_b128 v[100:103], v6 offset:37888
    v_mfma_f32_16x16x32_bf16 v[184:187], v[72:75], v[44:47], v[184:187]
    ds_read_b128 v[104:107], v6 offset:38912
    v_mfma_f32_16x16x32_bf16 v[188:191], v[76:79], v[44:47], v[188:191]
    ds_read_b128 v[108:111], v6 offset:39936
    v_mfma_f32_16x16x32_bf16 v[192:195], v[64:67], v[48:51], v[192:195]
    v_mfma_f32_16x16x32_bf16 v[196:199], v[68:71], v[48:51], v[196:199]
    s_add_u32 m0, s21, 65536
    s_nop 0
    buffer_load_dwordx4 v1, s[4:7], s16 offen sc1 lds
    s_add_u32 s16, s16, s62
    v_mfma_f32_16x16x32_bf16 v[200:203], v[72:75], v[48:51], v[200:203]
    v_mfma_f32_16x16x32_bf16 v[204:207], v[76:79], v[48:51], v[204:207]
    v_mfma_f32_16x16x32_bf16 v[208:211], v[64:67], v[52:55], v[208:211]
    s_add_u32 m0, s21, 66560
    s_nop 0
    buffer_load_dwordx4 v1, s[4:7], s17 offen sc1 lds
    s_add_u32 s17, s17, s62
    v_mfma_f32_16x16x32_bf16 v[212:215], v[68:71], v[52:55], v[212:215]
    v_mfma_f32_16x16x32_bf16 v[216:219], v[72:75], v[52:55], v[216:219]
    v_mfma_f32_16x16x32_bf16 v[220:223], v[76:79], v[52:55], v[220:223]
    s_add_u32 m0, s22, 65536
    s_nop 0
    buffer_load_dwordx4 v2, s[8:11], s18 offen lds
    s_add_u32 s18, s18, s20
    v_mfma_f32_16x16x32_bf16 v[224:227], v[64:67], v[56:59], v[224:227]
    v_mfma_f32_16x16x32_bf16 v[228:231], v[68:71], v[56:59], v[228:231]
    v_mfma_f32_16x16x32_bf16 v[232:235], v[72:75], v[56:59], v[232:235]
    s_add_u32 m0, s22, 73728
    s_nop 0
    buffer_load_dwordx4 v2, s[12:15], s19 offen lds
    s_add_u32 s19, s19, s20
    v_mfma_f32_16x16x32_bf16 v[236:239], v[76:79], v[56:59], v[236:239]
    v_mfma_f32_16x16x32_bf16 v[240:243], v[64:67], v[60:63], v[240:243]
    v_mfma_f32_16x16x32_bf16 v[244:247], v[68:71], v[60:63], v[244:247]
    v_mfma_f32_16x16x32_bf16 v[248:251], v[72:75], v[60:63], v[248:251]
    v_mfma_f32_16x16x32_bf16 v[252:255], v[76:79], v[60:63], v[252:255]
    s_waitcnt lgkmcnt(0)
    s_waitcnt vmcnt(8)
    s_barrier
    s_cmp_eq_u32 s28, 0
    s_cbranch_scc1 sig_3
    s_cmp_lg_u32 s3, 0
    s_cbranch_scc1 sig_3
    s_mov_b64 exec, 1
    v_mov_b32 v18, s57
    buffer_atomic_add v18, v17, s[4:7], s28 offen sc1
    s_mov_b64 exec, -1
sig_3:
    s_mov_b32 s28, 0
    v_mfma_f32_16x16x32_bf16 v[128:131], v[112:115], v[80:83], v[128:131]
    ds_read_b64_tr_b16 v[64:65], v8 offset:16384
    v_mfma_f32_16x16x32_bf16 v[132:135], v[116:119], v[80:83], v[132:135]
    ds_read_b64_tr_b16 v[66:67], v9 offset:16384
    v_mfma_f32_16x16x32_bf16 v[136:139], v[120:123], v[80:83], v[136:139]
    ds_read_b64_tr_b16 v[68:69], v10 offset:16384
    v_mfma_f32_16x16x32_bf16 v[140:143], v[124:127], v[80:83], v[140:143]
    ds_read_b64_tr_b16 v[70:71], v11 offset:16384
    v_mfma_f32_16x16x32_bf16 v[144:147], v[112:115], v[84:87], v[144:147]
    ds_read_b64_tr_b16 v[72:73], v8 offset:24576
    v_mfma_f32_16x16x32_bf16 v[148:151], v[116:119], v[84:87], v[148:151]
    ds_read_b64_tr_b16 v[74:75], v9 offset:24576
    v_mfma_f32_16x16x32_bf16 v[152:155], v[120:123], v[84:87], v[152:155]
    ds_read_b64_tr_b16 v[76:77], v10 offset:24576
    v_mfma_f32_16x16x32_bf16 v[156:159], v[124:127], v[84:87], v[156:159]
    ds_read_b64_tr_b16 v[78:79], v11 offset:24576
    v_mfma_f32_16x16x32_bf16 v[160:163], v[112:115], v[88:91], v[160:163]
    ds_read_b128 v[32:35], v5 offset:0
    v_mfma_f32_16x16x32_bf16 v[164:167], v[116:119], v[88:91], v[164:167]
    ds_read_b128 v[36:39], v5 offset:1024
    v_mfma_f32_16x16x32_bf16 v[168:171], v[120:123], v[88:91], v[168:171]
    ds_read_b128 v[40:43], v5 offset:2048
    v_mfma_f32_16x16x32_bf16 v[172:175], v[124:127], v[88:91], v[172:175]
    ds_read_b128 v[44:47], v5 offset:3072
    v_mfma_f32_16x16x32_bf16 v[176:179], v[112:115], v[92:95], v[176:179]
    ds_read_b128 v[48:51], v5 offset:4096
    v_mfma_f32_16x16x32_bf16 v[180:183], v[116:119], v[92:95], v[180:183]
    ds_read_b128 v[52:55], v5 offset:5120
    v_mfma_f32_16x16x32_bf16 v[184:187], v[120:123], v[92:95], v[184:187]
    ds_read_b128 v[56:59], v5 offset:6144
    v_mfma_f32_16x16x32_bf16 v[188:191], v[124:127], v[92:95], v[188:191]
    ds_read_b128 v[60:63], v5 offset:7168
    v_mfma_f32_16x16x32_bf16 v[192:195], v[112:115], v[96:99], v[192:195]
    v_mfma_f32_16x16x32_bf16 v[196:199], v[116:119], v[96:99], v[196:199]
    s_add_u32 m0, s21, 98304
    s_nop 0
    buffer_load_dwordx4 v1, s[4:7], s16 offen sc1 lds
    s_add_u32 s16, s16, s62
    v_mfma_f32_16x16x32_bf16 v[200:203], v[120:123], v[96:99], v[200:203]
    v_mfma_f32_16x16x32_bf16 v[204:207], v[124:127], v[96:99], v[204:207]
    v_mfma_f32_16x16x32_bf16 v[208:211], v[112:115], v[100:103], v[208:211]
    s_add_u32 m0, s21, 99328
    s_nop 0
    buffer_load_dwordx4 v1, s[4:7], s17 offen sc1 lds
    s_add_u32 s17, s17, s62
    v_mfma_f32_16x16x32_bf16 v[212:215], v[116:119], v[100:103], v[212:215]
    v_mfma_f32_16x16x32_bf16 v[216:219], v[120:123], v[100:103], v[216:219]
    v_mfma_f32_16x16x32_bf16 v[220:223], v[124:127], v[100:103], v[220:223]
    s_add_u32 m0, s22, 98304
    s_nop 0
    buffer_load_dwordx4 v2, s[8:11], s18 offen lds
    s_add_u32 s18, s18, s20
    v_mfma_f32_16x16x32_bf16 v[224:227], v[112:115], v[104:107], v[224:227]
    v_mfma_f32_16x16x32_bf16 v[228:231], v[116:119], v[104:107], v[228:231]
    v_mfma_f32_16x16x32_bf16 v[232:235], v[120:123], v[104:107], v[232:235]
    s_add_u32 m0, s22, 106496
    s_nop 0
    buffer_load_dwordx4 v2, s[12:15], s19 offen lds
    s_add_u32 s19, s19, s20
    v_mfma_f32_16x16x32_bf16 v[236:239], v[124:127], v[104:107], v[236:239]
    v_mfma_f32_16x16x32_bf16 v[240:243], v[112:115], v[108:111], v[240:243]
    v_mfma_f32_16x16x32_bf16 v[244:247], v[116:119], v[108:111], v[244:247]
    v_mfma_f32_16x16x32_bf16 v[248:251], v[120:123], v[108:111], v[248:251]
    v_mfma_f32_16x16x32_bf16 v[252:255], v[124:127], v[108:111], v[252:255]
    s_waitcnt lgkmcnt(0)
    s_branch w_loop_chk
w_first16:
    s_waitcnt vmcnt(24)
    s_barrier
    v_mfma_f32_16x16x32_bf16 v[128:131], v[64:67], v[32:35], 0
    ds_read_b64_tr_b16 v[112:113], v8 offset:49152
    v_mfma_f32_16x16x32_bf16 v[132:135], v[68:71], v[32:35], 0
    ds_read_b64_tr_b16 v[114:115], v9 offset:49152
    v_mfma_f32_16x16x32_bf16 v[136:139], v[72:75], v[32:35], 0
    ds_read_b64_tr_b16 v[116:117], v10 offset:49152
    v_mfma_f32_16x16x32_bf16 v[140:143], v[76:79], v[32:35], 0
    ds_read_b64_tr_b16 v[118:119], v11 offset:49152
    v_mfma_f32_16x16x32_bf16 v[144:147], v[64:67], v[36:39], 0
    ds_read_b64_tr_b16 v[120:121], v8 offset:57344
    v_mfma_f32_16x16x32_bf16 v[148:151], v[68:71], v[36:39], 0
    ds_read_b64_tr_b16 v[122:123], v9 offset:57344
    v_mfma_f32_16x16x32_bf16 v[152:155], v[72:75], v[36:39], 0
    ds_read_b64_tr_b16 v[124:125], v10 offset:57344
    v_mfma_f32_16x16x32_bf16 v[156:159], v[76:79], v[36:39], 0
    ds_read_b64_tr_b16 v[126:127], v11 offset:57344
    v_mfma_f32_16x16x32_bf16 v[160:163], v[64:67], v[40:43], 0
    ds_read_b128 v[80:83], v5 offset:32768
    v_mfma_f32_16x16x32_bf16 v[164:167], v[68:71], v[40:43], 0
    ds_read_b128 v[84:87], v5 offset:33792
    v_mfma_f32_16x16x32_bf16 v[168:171], v[72:75], v[40:43], 0
    ds_read_b128 v[88:91], v5 offset:34816
    v_mfma_f32_16x16x32_bf16 v[172:175], v[76:79], v[40:43], 0
    ds_read_b128 v[92:95], v5 offset:35840
    v_mfma_f32_16x16x32_bf16 v[176:179], v[64:67], v[44:47], 0
    ds_read_b128 v[96:99], v5 offset:36864
    v_mfma_f32_16x16x32_bf16 v[180:183], v[68:71], v[44:47], 0
    ds_read_b128 v[100:103], v5 offset:37888
    v_mfma_f32_16x16x32_bf16 v[184:187], v[72:75], v[44:47], 0
    ds_read_b128 v[104:107], v5 offset:38912
    v_mfma_f32_16x16x32_bf16 v[188:191], v[76:79], v[44:47], 0
    ds_read_b128 v[108:111], v5 offset:39936
    v_mfma_f32_16x16x32_bf16 v[192:195], v[64:67], v[48:51], 0
    v_mfma_f32_16x16x32_bf16 v[196:199], v[68:71], v[48:51], 0
    s_add_u32 m0, s21, 0
    s_nop 0
    buffer_load_dwordx4 v1, s[4:7], s16 offen sc1 lds
    s_add_u32 s16, s16, s62
    v_mfma_f32_16x16x32_bf16 v[200:203], v[72:75], v[48:51], 0
    v_mfma_f32_16x16x32_bf16 v[204:207], v[76:79], v[48:51], 0
    v_mfma_f32_16x16x32_bf16 v[208:211], v[64:67], v[52:55], 0
    s_add_u32 m0, s21, 1024
    s_nop 0
    buffer_load_dwordx4 v1, s[4:7], s17 offen sc1 lds
    s_add_u32 s17, s17, s62
    v_mfma_f32_16x16x32_bf16 v[212:215], v[68:71], v[52:55], 0
    v_mfma_f32_16x16x32_bf16 v[216:219], v[72:75], v[52:55], 0
    v_mfma_f32_16x16x32_bf16 v[220:223], v[76:79], v[52:55], 0
    s_add_u32 m0, s22, 0
    s_nop 0
    buffer_load_dwordx4 v2, s[8:11], s18 offen lds
    s_add_u32 s18, s18, s20
    v_mfma_f32_16x16x32_bf16 v[224:227], v[64:67], v[56:59], 0
    v_mfma_f32_16x16x32_bf16 v[228:231], v[68:71], v[56:59], 0
    v_mfma_f32_16x16x32_bf16 v[232:235], v[72:75], v[56:59], 0
    s_add_u32 m0, s22, 8192
    s_nop 0
    buffer_load_dwordx4 v2, s[12:15], s19 offen lds
    s_add_u32 s19, s19, s20
    v_mfma_f32_16x16x32_bf16 v[236:239], v[76:79], v[56:59], 0
    v_mfma_f32_16x16x32_bf16 v[240:243], v[64:67], v[60:63], 0
    v_mfma_f32_16x16x32_bf16 v[244:247], v[68:71], v[60:63], 0
    v_mfma_f32_16x16x32_bf16 v[248:251], v[72:75], v[60:63], 0
    v_mfma_f32_16x16x32_bf16 v[252:255], v[76:79], v[60:63], 0
    s_waitcnt lgkmcnt(0)
    s_waitcnt vmcnt(24)
    s_barrier
    v_mfma_f32_16x16x32_bf16 v[128:131], v[112:115], v[80:83], v[128:131]
    ds_read_b64_tr_b16 v[64:65], v12 offset:16384
    v_mfma_f32_16x16x32_bf16 v[132:135], v[116:119], v[80:83], v[132:135]
    ds_read_b64_tr_b16 v[66:67], v13 offset:16384
    v_mfma_f32_16x16x32_bf16 v[136:139], v[120:123], v[80:83], v[136:139]
    ds_read_b64_tr_b16 v[68:69], v14 offset:16384
    v_mfma_f32_16x16x32_bf16 v[140:143], v[124:127], v[80:83], v[140:143]
    ds_read_b64_tr_b16 v[70:71], v15 offset:16384
    v_mfma_f32_16x16x32_bf16 v[144:147], v[112:115], v[84:87], v[144:147]
    ds_read_b64_tr_b16 v[72:73], v12 offset:24576
    v_mfma_f32_16x16x32_bf16 v[148:151], v[116:119], v[84:87], v[148:151]
    ds_read_b64_tr_b16 v[74:75], v13 offset:24576
    v_mfma_f32_16x16x32_bf16 v[152:155], v[120:123], v[84:87], v[152:155]
    ds_read_b64_tr_b16 v[76:77], v14 offset:24576
    v_mfma_f32_16x16x32_bf16 v[156:159], v[124:127], v[84:87], v[156:159]
    ds_read_b64_tr_b16 v[78:79], v15 offset:24576
    v_mfma_f32_16x16x32_bf16 v[160:163], v[112:115], v[88:91], v[160:163]
    ds_read_b128 v[32:35], v6 offset:0
    v_mfma_f32_16x16x32_bf16 v[164:167], v[116:119], v[88:91], v[164:167]
    ds_read_b128 v[36:39], v6 offset:1024
    v_mfma_f32_16x16x32_bf16 v[168:171], v[120:123], v[88:91], v[168:171]
    ds_read_b128 v[40:43], v6 offset:2048
    v_mfma_f32_16x16x32_bf16 v[172:175], v[124:127], v[88:91], v[172:175]
    ds_read_b128 v[44:47], v6 offset:3072
    v_mfma_f32_16x16x32_bf16 v[176:179], v[112:115], v[92:95], v[176:179]
    ds_read_b128 v[48:51], v6 offset:4096
    v_mfma_f32_16x16x32_bf16 v[180:183], v[116:119], v[92:95], v[180:183]
    ds_read_b128 v[52:55], v6 offset:5120
    v_mfma_f32_16x16x32_bf16 v[184:187], v[120:123], v[92:95], v[184:187]
    ds_read_b128 v[56:59], v6 offset:6144
    v_mfma_f32_16x16x32_bf16 v[188:191], v[124:127], v[92:95], v[188:191]
    ds_read_b128 v[60:63], v6 offset:7168
    v_mfma_f32_16x16x32_bf16 v[192:195], v[112:115], v[96:99], v[192:195]
    v_mfma_f32_16x16x32_bf16 v[196:199], v[116:119], v[96:99], v[196:199]
    s_add_u32 m0, s21, 32768
    s_nop 0
    buffer_load_dwordx4 v1, s[4:7], s16 offen sc1 lds
    s_add_u32 s16, s16, s62
    v_mfma_f32_16x16x32_bf16 v[200:203], v[120:123], v[96:99], v[200:203]
    v_mfma_f32_16x16x32_bf16 v[204:207], v[124:127], v[96:99], v[204:207]
    v_mfma_f32_16x16x32_bf16 v[208:211], v[112:115], v[100:103], v[208:211]
    s_add_u32 m0, s21, 33792
    s_nop 0
    buffer_load_dwordx4 v1, s[4:7], s17 offen sc1 lds
    s_add_u32 s17, s17, s62
    v_mfma_f32_16x16x32_bf16 v[212:215], v[116:119], v[100:103], v[212:215]
    v_mfma_f32_16x16x32_bf16 v[216:219], v[120:123], v[100:103], v[216:219]
    v_mfma_f32_16x16x32_bf16 v[220:223], v[124:127], v[100:103], v[220:223]
    s_add_u32 m0, s22, 32768
    s_nop 0
    buffer_load_dwordx4 v2, s[8:11], s18 offen lds
    s_add_u32 s18, s18, s20
    v_mfma_f32_16x16x32_bf16 v[224:227], v[112:115], v[104:107], v[224:227]
    v_mfma_f32_16x16x32_bf16 v[228:231], v[116:119], v[104:107], v[228:231]
    v_mfma_f32_16x16x32_bf16 v[232:235], v[120:123], v[104:107], v[232:235]
    s_add_u32 m0, s22, 40960
    s_nop 0
    buffer_load_dwordx4 v2, s[12:15], s19 offen lds
    s_add_u32 s19, s19, s20
    v_mfma_f32_16x16x32_bf16 v[236:239], v[124:127], v[104:107], v[236:239]
    v_mfma_f32_16x16x32_bf16 v[240:243], v[112:115], v[108:111], v[240:243]
    v_mfma_f32_16x16x32_bf16 v[244:247], v[116:119], v[108:111], v[244:247]
    v_mfma_f32_16x16x32_bf16 v[248:251], v[120:123], v[108:111], v[248:251]
    v_mfma_f32_16x16x32_bf16 v[252:255], v[124:127], v[108:111], v[252:255]
    s_waitcnt lgkmcnt(0)
    s_waitcnt vmcnt(24)
    s_barrier
    v_mfma_f32_16x16x32_bf16 v[128:131], v[64:67], v[32:35], v[128:131]
    ds_read_b64_tr_b16 v[112:113], v12 offset:49152
    v_mfma_f32_16x16x32_bf16 v[132:135], v[68:71], v[32:35], v[132:135]
    ds_read_b64_tr_b16 v[114:115], v13 offset:49152
    v_mfma_f32_16x16x32_bf16 v[136:139], v[72:75], v[32:35], v[136:139]
    ds_read_b64_tr_b16 v[116:117], v14 offset:49152
    v_mfma_f32_16x16x32_bf16 v[140:143], v[76:79], v[32:35], v[140:143]
    ds_read_b64_tr_b16 v[118:119], v15 offset:49152
    v_mfma_f32_16x16x32_bf16 v[144:147], v[64:67], v[36:39], v[144:147]
    ds_read_b64_tr_b16 v[120:121], v12 offset:57344
    v_mfma_f32_16x16x32_bf16 v[148:151], v[68:71], v[36:39], v[148:151]
    ds_read_b64_tr_b16 v[122:123], v13 offset:57344
    v_mfma_f32_16x16x32_bf16 v[152:155], v[72:75], v[36:39], v[152:155]
    ds_read_b64_tr_b16 v[124:125], v14 offset:57344
    v_mfma_f32_16x16x32_bf16 v[156:159], v[76:79], v[36:39], v[156:159]
    ds_read_b64_tr_b16 v[126:127], v15 offset:57344
    v_mfma_f32_16x16x32_bf16 v[160:163], v[64:67], v[40:43], v[160:163]
    ds_read_b128 v[80:83], v6 offset:32768
    v_mfma_f32_16x16x32_bf16 v[164:167], v[68:71], v[40:43], v[164:167]
    ds_read_b128 v[84:87], v6 offset:33792
    v_mfma_f32_16x16x32_bf16 v[168:171], v[72:75], v[40:43], v[168:171]
    ds_read_b128 v[88:91], v6 offset:34816
    v_mfma_f32_16x16x32_bf16 v[172:175], v[76:79], v[40:43], v[172:175]
    ds_read_b128 v[92:95], v6 offset:35840
    v_mfma_f32_16x16x32_bf16 v[176:179], v[64:67], v[44:47], v[176:179]
    ds_read_b128 v[96:99], v6 offset:36864
    v_mfma_f32_16x16x32_bf16 v[180:183], v[68:71], v[44:47], v[180:183]
    ds_read_b128 v[100:103], v6 offset:37888
    v_mfma_f32_16x16x32_bf16 v[184:187], v[72:75], v[44:47], v[184:187]
    ds_read_b128 v[104:107], v6 offset:38912
    v_mfma_f32_16x16x32_bf16 v[188:191], v[76:79], v[44:47], v[188:191]
    ds_read_b128 v[108:111], v6 offset:39936
    v_mfma_f32_16x16x32_bf16 v[192:195], v[64:67], v[48:51], v[192:195]
    v_mfma_f32_16x16x32_bf16 v[196:199], v[68:71], v[48:51], v[196:199]
    s_add_u32 m0, s21, 65536
    s_nop 0
    buffer_load_dwordx4 v1, s[4:7], s16 offen sc1 lds
    s_add_u32 s16, s16, s62
    v_mfma_f32_16x16x32_bf16 v[200:203], v[72:75], v[48:51], v[200:203]
    v_mfma_f32_16x16x32_bf16 v[204:207], v[76:79], v[48:51], v[204:207]
    v_mfma_f32_16x16x32_bf16 v[208:211], v[64:67], v[52:55], v[208:211]
    s_add_u32 m0, s21, 66560
    s_nop 0
    buffer_load_dwordx4 v1, s[4:7], s17 offen sc1 lds
    s_add_u32 s17, s17, s62
    v_mfma_f32_16x16x32_bf16 v[212:215], v[68:71], v[52:55], v[212:215]
    v_mfma_f32_16x16x32_bf16 v[216:219], v[72:75], v[52:55], v[216:219]
    v_mfma_f32_16x16x32_bf16 v[220:223], v[76:79], v[52:55], v[220:223]
    s_add_u32 m0, s22, 65536
    s_nop 0
    buffer_load_dwordx4 v2, s[8:11], s18 offen lds
    s_add_u32 s18, s18, s20
    v_mfma_f32_16x16x32_bf16 v[224:227], v[64:67], v[56:59], v[224:227]
    v_mfma_f32_16x16x32_bf16 v[228:231], v[68:71], v[56:59], v[228:231]
    v_mfma_f32_16x16x32_bf16 v[232:235], v[72:75], v[56:59], v[232:235]
    s_add_u32 m0, s22, 73728
    s_nop 0
    buffer_load_dwordx4 v2, s[12:15], s19 offen lds
    s_add_u32 s19, s19, s20
    v_mfma_f32_16x16x32_bf16 v[236:239], v[76:79], v[56:59], v[236:239]
    v_mfma_f32_16x16x32_bf16 v[240:243], v[64:67], v[60:63], v[240:243]
    v_mfma_f32_16x16x32_bf16 v[244:247], v[68:71], v[60:63], v[244:247]
    v_mfma_f32_16x16x32_bf16 v[248:251], v[72:75], v[60:63], v[248:251]
    v_mfma_f32_16x16x32_bf16 v[252:255], v[76:79], v[60:63], v[252:255]
    s_waitcnt lgkmcnt(0)
    s_waitcnt vmcnt(8)
    s_barrier
    s_cmp_eq_u32 s28, 0
    s_cbranch_scc1 sig_4
    s_cmp_lg_u32 s3, 0
    s_cbranch_scc1 sig_4
    s_mov_b64 exec, 1
    v_mov_b32 v18, s57
    buffer_atomic_add v18, v17, s[4:7], s28 offen sc1
    s_mov_b64 exec, -1
sig_4:
    s_mov_b32 s28, 0
    v_mfma_f32_16x16x32_bf16 v[128:131], v[112:115], v[80:83], v[128:131]
    ds_read_b64_tr_b16 v[64:65], v8 offset:16384
    v_mfma_f32_16x16x32_bf16 v[132:135], v[116:119], v[80:83], v[132:135]
    ds_read_b64_tr_b16 v[66:67], v9 offset:16384
    v_mfma_f32_16x16x32_bf16 v[136:139], v[120:123], v[80:83], v[136:139]
    ds_read_b64_tr_b16 v[68:69], v10 offset:16384
    v_mfma_f32_16x16x32_bf16 v[140:143], v[124:127], v[80:83], v[140:143]
    ds_read_b64_tr_b16 v[70:71], v11 offset:16384
    v_mfma_f32_16x16x32_bf16 v[144:147], v[112:115], v[84:87], v[144:147]
    ds_read_b64_tr_b16 v[72:73], v8 offset:24576
    v_mfma_f32_16x16x32_bf16 v[148:151], v[116:119], v[84:87], v[148:151]
    ds_read_b64_tr_b16 v[74:75], v9 offset:24576
    v_mfma_f32_16x16x32_bf16 v[152:155], v[120:123], v[84:87], v[152:155]
    ds_read_b64_tr_b16 v[76:77], v10 offset:24576
    v_mfma_f32_16x16x32_bf16 v[156:159], v[124:127], v[84:87], v[156:159]
    ds_read_b64_tr_b16 v[78:79], v11 offset:24576
    v_mfma_f32_16x16x32_bf16 v[160:163], v[112:115], v[88:91], v[160:163]
    ds_read_b128 v[32:35], v5 offset:0
    v_mfma_f32_16x16x32_bf16 v[164:167], v[116:119], v[88:91], v[164:167]
    ds_read_b128 v[36:39], v5 offset:1024
    v_mfma_f32_16x16x32_bf16 v[168:171], v[120:123], v[88:91], v[168:171]
    ds_read_b128 v[40:43], v5 offset:2048
    v_mfma_f32_16x16x32_bf16 v[172:175], v[124:127], v[88:91], v[172:175]
    ds_read_b128 v[44:47], v5 offset:3072
    v_mfma_f32_16x16x32_bf16 v[176:179], v[112:115], v[92:95], v[176:179]
    ds_read_b128 v[48:51], v5 offset:4096
    v_mfma_f32_16x16x32_bf16 v[180:183], v[116:119], v[92:95], v[180:183]
    ds_read_b128 v[52:55], v5 offset:5120
    v_mfma_f32_16x16x32_bf16 v[184:187], v[120:123], v[92:95], v[184:187]
    ds_read_b128 v[56:59], v5 offset:6144
    v_mfma_f32_16x16x32_bf16 v[188:191], v[124:127], v[92:95], v[188:191]
    ds_read_b128 v[60:63], v5 offset:7168
    v_mfma_f32_16x16x32_bf16 v[192:195], v[112:115], v[96:99], v[192:195]
    v_mfma_f32_16x16x32_bf16 v[196:199], v[116:119], v[96:99], v[196:199]
    s_add_u32 m0, s21, 98304
    s_nop 0
    buffer_load_dwordx4 v1, s[4:7], s16 offen sc1 lds
    s_add_u32 s16, s16, s62
    v_mfma_f32_16x16x32_bf16 v[200:203], v[120:123], v[96:99], v[200:203]
    v_mfma_f32_16x16x32_bf16 v[204:207], v[124:127], v[96:99], v[204:207]
    v_mfma_f32_16x16x32_bf16 v[208:211], v[112:115], v[100:103], v[208:211]
    s_add_u32 m0, s21, 99328
    s_nop 0
    buffer_load_dwordx4 v1, s[4:7], s17 offen sc1 lds
    s_add_u32 s17, s17, s62
    v_mfma_f32_16x16x32_bf16 v[212:215], v[116:119], v[100:103], v[212:215]
    v_mfma_f32_16x16x32_bf16 v[216:219], v[120:123], v[100:103], v[216:219]
    v_mfma_f32_16x16x32_bf16 v[220:223], v[124:127], v[100:103], v[220:223]
    s_add_u32 m0, s22, 98304
    s_nop 0
    buffer_load_dwordx4 v2, s[8:11], s18 offen lds
    s_add_u32 s18, s18, s20
    v_mfma_f32_16x16x32_bf16 v[224:227], v[112:115], v[104:107], v[224:227]
    v_mfma_f32_16x16x32_bf16 v[228:231], v[116:119], v[104:107], v[228:231]
    v_mfma_f32_16x16x32_bf16 v[232:235], v[120:123], v[104:107], v[232:235]
    s_add_u32 m0, s22, 106496
    s_nop 0
    buffer_load_dwordx4 v2, s[12:15], s19 offen lds
    s_add_u32 s19, s19, s20
    v_mfma_f32_16x16x32_bf16 v[236:239], v[124:127], v[104:107], v[236:239]
    v_mfma_f32_16x16x32_bf16 v[240:243], v[112:115], v[108:111], v[240:243]
    v_mfma_f32_16x16x32_bf16 v[244:247], v[116:119], v[108:111], v[244:247]
    v_mfma_f32_16x16x32_bf16 v[248:251], v[120:123], v[108:111], v[248:251]
    v_mfma_f32_16x16x32_bf16 v[252:255], v[124:127], v[108:111], v[252:255]
    s_waitcnt lgkmcnt(0)
w_loop_chk:
    s_sub_u32 s23, s23, 1
w_loop:
    s_cmp_lg_u32 s23, 1
    s_cbranch_scc1 w_body
    v_readfirstlane_b32 s30, v16
    s_cmp_ge_u32 s30, s45
    s_cselect_b32 s30, 0, 1
    s_or_b32 s30, s30, s70
    s_cmp_ge_u32 s32, 4
    s_cselect_b32 s30, 1, s30
    s_cmp_eq_u32 s32, 0
    s_cselect_b32 s30, 1, s30
    v_mov_b32 v20, s30
    ds_write_b32 v7, v20
    s_cbranch_scc1 w_nd
    s_cmp_ge_u32 s32, 4
    s_cbranch_scc1 w_nd
    s_cmp_lg_u32 s70, 0
    s_cbranch_scc1 w_nd
    s_load_dwordx2 s[8:9], s[0:1], s33
    s_load_dwordx2 s[12:13], s[0:1], s34
    s_mov_b32 s10, s38
    s_mov_b32 s14, s38
    s_cmp_ge_u32 s32, 4
    s_cselect_b32 s31, 0, 1
    s_lshl_b32 s30, s3, s31
    s_mul_i32 s30, s30, s40
    s_add_u32 s16, s39, s30
    s_cmp_eq_u32 s32, 4
    s_cselect_b32 s30, 1024, s40
    s_cselect_b32 s31, 6, 5
    s_lshl_b32 s62, 32, s31
    s_add_u32 s17, s16, s30
    s_lshl_b32 s30, s3, 2
    s_mul_i32 s30, s30, s35
    s_add_u32 s18, s36, s30
    s_add_u32 s19, s37, s30
    s_lshl_b32 s20, s35, s31
    v_mul_u32_u24 v2, s35, v4
    v_add_u32 v2, v2, v3
    s_waitcnt lgkmcnt(0)
w_body:
    s_waitcnt vmcnt(8)
    s_barrier
    v_mfma_f32_16x16x32_bf16 v[128:131], v[64:67], v[32:35], v[128:131]
    ds_read_b64_tr_b16 v[112:113], v8 offset:49152
    v_mfma_f32_16x16x32_bf16 v[132:135], v[68:71], v[32:35], v[132:135]
    ds_read_b64_tr_b16 v[114:115], v9 offset:49152
    v_mfma_f32_16x16x32_bf16 v[136:139], v[72:75], v[32:35], v[136:139]
    ds_read_b64_tr_b16 v[116:117], v10 offset:49152
    v_mfma_f32_16x16x32_bf16 v[140:143], v[76:79], v[32:35], v[140:143]
    ds_read_b64_tr_b16 v[118:119], v11 offset:49152
    v_mfma_f32_16x16x32_bf16 v[144:147], v[64:67], v[36:39], v[144:147]
    ds_read_b64_tr_b16 v[120:121], v8 offset:57344
    v_mfma_f32_16x16x32_bf16 v[148:151], v[68:71], v[36:39], v[148:151]
    ds_read_b64_tr_b16 v[122:123], v9 offset:57344
    v_mfma_f32_16x16x32_bf16 v[152:155], v[72:75], v[36:39], v[152:155]
    ds_read_b64_tr_b16 v[124:125], v10 offset:57344
    v_mfma_f32_16x16x32_bf16 v[156:159], v[76:79], v[36:39], v[156:159]
    ds_read_b64_tr_b16 v[126:127], v11 offset:57344
    v_mfma_f32_16x16x32_bf16 v[160:163], v[64:67], v[40:43], v[160:163]
    ds_read_b128 v[80:83], v5 offset:32768
    v_mfma_f32_16x16x32_bf16 v[164:167], v[68:71], v[40:43], v[164:167]
    ds_read_b128 v[84:87], v5 offset:33792
    v_mfma_f32_16x16x32_bf16 v[168:171], v[72:75], v[40:43], v[168:171]
    ds_read_b128 v[88:91], v5 offset:34816
    v_mfma_f32_16x16x32_bf16 v[172:175], v[76:79], v[40:43], v[172:175]
    ds_read_b128 v[92:95], v5 offset:35840
    v_mfma_f32_16x16x32_bf16 v[176:179], v[64:67], v[44:47], v[176:179]
    ds_read_b128 v[96:99], v5 offset:36864
    v_mfma_f32_16x16x32_bf16 v[180:183], v[68:71], v[44:47], v[180:183]
    ds_read_b128 v[100:103], v5 offset:37888
    v_mfma_f32_16x16x32_bf16 v[184:187], v[72:75], v[44:47], v[184:187]
    ds_read_b128 v[104:107], v5 offset:38912
    v_mfma_f32_16x16x32_bf16 v[188:191], v[76:79], v[44:47], v[188:191]
    ds_read_b128 v[108:111], v5 offset:39936
    v_mfma_f32_16x16x32_bf16 v[192:195], v[64:67], v[48:51], v[192:195]
    v_mfma_f32_16x16x32_bf16 v[196:199], v[68:71], v[48:51], v[196:199]
    s_add_u32 m0, s21, 0
    s_nop 0
    buffer_load_dwordx4 v1, s[4:7], s16 offen sc1 lds
    s_add_u32 s16, s16, s62
    v_mfma_f32_16x16x32_bf16 v[200:203], v[72:75], v[48:51], v[200:203]
    v_mfma_f32_16x16x32_bf16 v[204:207], v[76:79], v[48:51], v[204:207]
    v_mfma_f32_16x16x32_bf16 v[208:211], v[64:67], v[52:55], v[208:211]
    s_add_u32 m0, s21, 1024
    s_nop 0
    buffer_load_dwordx4 v1, s[4:7], s17 offen sc1 lds
    s_add_u32 s17, s17, s62
    v_mfma_f32_16x16x32_bf16 v[212:215], v[68:71], v[52:55], v[212:215]
    v_mfma_f32_16x16x32_bf16 v[216:219], v[72:75], v[52:55], v[216:219]
    v_mfma_f32_16x16x32_bf16 v[220:223], v[76:79], v[52:55], v[220:223]
    s_add_u32 m0, s22, 0
    s_nop 0
    buffer_load_dwordx4 v2, s[8:11], s18 offen lds
    s_add_u32 s18, s18, s20
    v_mfma_f32_16x16x32_bf16 v[224:227], v[64:67], v[56:59], v[224:227]
    v_mfma_f32_16x16x32_bf16 v[228:231], v[68:71], v[56:59], v[228:231]
    v_mfma_f32_16x16x32_bf16 v[232:235], v[72:75], v[56:59], v[232:235]
    s_add_u32 m0, s22, 8192
    s_nop 0
    buffer_load_dwordx4 v2, s[12:15], s19 offen lds
    s_add_u32 s19, s19, s20
    v_mfma_f32_16x16x32_bf16 v[236:239], v[76:79], v[56:59], v[236:239]
    v_mfma_f32_16x16x32_bf16 v[240:243], v[64:67], v[60:63], v[240:243]
    v_mfma_f32_16x16x32_bf16 v[244:247], v[68:71], v[60:63], v[244:247]
    buffer_load_dword v16, v17, s[4:7], s44 offen sc1
    v_mfma_f32_16x16x32_bf16 v[248:251], v[72:75], v[60:63], v[248:251]
    v_mfma_f32_16x16x32_bf16 v[252:255], v[76:79], v[60:63], v[252:255]
    s_waitcnt lgkmcnt(0)
    s_waitcnt vmcnt(8)
    s_barrier
    v_mfma_f32_16x16x32_bf16 v[128:131], v[112:115], v[80:83], v[128:131]
    ds_read_b64_tr_b16 v[64:65], v12 offset:16384
    v_mfma_f32_16x16x32_bf16 v[132:135], v[116:119], v[80:83], v[132:135]
    ds_read_b64_tr_b16 v[66:67], v13 offset:16384
    v_mfma_f32_16x16x32_bf16 v[136:139], v[120:123], v[80:83], v[136:139]
    ds_read_b64_tr_b16 v[68:69], v14 offset:16384
    v_mfma_f32_16x16x32_bf16 v[140:143], v[124:127], v[80:83], v[140:143]
    ds_read_b64_tr_b16 v[70:71], v15 offset:16384
    v_mfma_f32_16x16x32_bf16 v[144:147], v[112:115], v[84:87], v[144:147]
    ds_read_b64_tr_b16 v[72:73], v12 offset:24576
    v_mfma_f32_16x16x32_bf16 v[148:151], v[116:119], v[84:87], v[148:151]
    ds_read_b64_tr_b16 v[74:75], v13 offset:24576
    v_mfma_f32_16x16x32_bf16 v[152:155], v[120:123], v[84:87], v[152:155]
    ds_read_b64_tr_b16 v[76:77], v14 offset:24576
    v_mfma_f32_16x16x32_bf16 v[156:159], v[124:127], v[84:87], v[156:159]
    ds_read_b64_tr_b16 v[78:79], v15 offset:24576
    v_mfma_f32_16x16x32_bf16 v[160:163], v[112:115], v[88:91], v[160:163]
    ds_read_b128 v[32:35], v6 offset:0
    v_mfma_f32_16x16x32_bf16 v[164:167], v[116:119], v[88:91], v[164:167]
    ds_read_b128 v[36:39], v6 offset:1024
    v_mfma_f32_16x16x32_bf16 v[168:171], v[120:123], v[88:91], v[168:171]
    ds_read_b128 v[40:43], v6 offset:2048
    v_mfma_f32_16x16x32_bf16 v[172:175], v[124:127], v[88:91], v[172:175]
    ds_read_b128 v[44:47], v6 offset:3072
    v_mfma_f32_16x16x32_bf16 v[176:179], v[112:115], v[92:95], v[176:179]
    ds_read_b128 v[48:51], v6 offset:4096
    v_mfma_f32_16x16x32_bf16 v[180:183], v[116:119], v[92:95], v[180:183]
    ds_read_b128 v[52:55], v6 offset:5120
    v_mfma_f32_16x16x32_bf16 v[184:187], v[120:123], v[92:95], v[184:187]
    ds_read_b128 v[56:59], v6 offset:6144
    v_mfma_f32_16x16x32_bf16 v[188:191], v[124:127], v[92:95], v[188:191]
    ds_read_b128 v[60:63], v6 offset:7168
    v_mfma_f32_16x16x32_bf16 v[192:195], v[112:115], v[96:99], v[192:195]
    v_mfma_f32_16x16x32_bf16 v[196:199], v[116:119], v[96:99], v[196:199]
    s_add_u32 m0, s21, 32768
    s_nop 0
    buffer_load_dwordx4 v1, s[4:7], s16 offen sc1 lds
    s_add_u32 s16, s16, s62
    v_mfma_f32_16x16x32_bf16 v[200:203], v[120:123], v[96:99], v[200:203]
    v_mfma_f32_16x16x32_bf16 v[204:207], v[124:127], v[96:99], v[204:207]
    v_mfma_f32_16x16x32_bf16 v[208:211], v[112:115], v[100:103], v[208:211]
    s_add_u32 m0, s21, 33792
    s_nop 0
    buffer_load_dwordx4 v1, s[4:7], s17 offen sc1 lds
    s_add_u32 s17, s17, s62
    v_mfma_f32_16x16x32_bf16 v[212:215], v[116:119], v[100:103], v[212:215]
    v_mfma_f32_16x16x32_bf16 v[216:219], v[120:123], v[100:103], v[216:219]
    v_mfma_f32_16x16x32_bf16 v[220:223], v[124:127], v[100:103], v[220:223]
    s_add_u32 m0, s22, 32768
    s_nop 0
    buffer_load_dwordx4 v2, s[8:11], s18 offen lds
    s_add_u32 s18, s18, s20
    v_mfma_f32_16x16x32_bf16 v[224:227], v[112:115], v[104:107], v[224:227]
    v_mfma_f32_16x16x32_bf16 v[228:231], v[116:119], v[104:107], v[228:231]
    v_mfma_f32_16x16x32_bf16 v[232:235], v[120:123], v[104:107], v[232:235]
    s_add_u32 m0, s22, 40960
    s_nop 0
    buffer_load_dwordx4 v2, s[12:15], s19 offen lds
    s_add_u32 s19, s19, s20
    v_mfma_f32_16x16x32_bf16 v[236:239], v[124:127], v[104:107], v[236:239]
    v_mfma_f32_16x16x32_bf16 v[240:243], v[112:115], v[108:111], v[240:243]
    v_mfma_f32_16x16x32_bf16 v[244:247], v[116:119], v[108:111], v[244:247]
    v_mfma_f32_16x16x32_bf16 v[248:251], v[120:123], v[108:111], v[248:251]
    v_mfma_f32_16x16x32_bf16 v[252:255], v[124:127], v[108:111], v[252:255]
    s_waitcnt lgkmcnt(0)
    s_waitcnt vmcnt(8)
    s_barrier
    v_mfma_f32_16x16x32_bf16 v[128:131], v[64:67], v[32:35], v[128:131]
    ds_read_b64_tr_b16 v[112:113], v12 offset:49152
    v_mfma_f32_16x16x32_bf16 v[132:135], v[68:71], v[32:35], v[132:135]
    ds_read_b64_tr_b16 v[114:115], v13 offset:49152
    v_mfma_f32_16x16x32_bf16 v[136:139], v[72:75], v[32:35], v[136:139]
    ds_read_b64_tr_b16 v[116:117], v14 offset:49152
    v_mfma_f32_16x16x32_bf16 v[140:143], v[76:79], v[32:35], v[140:143]
    ds_read_b64_tr_b16 v[118:119], v15 offset:49152
    v_mfma_f32_16x16x32_bf16 v[144:147], v[64:67], v[36:39], v[144:147]
    ds_read_b64_tr_b16 v[120:121], v12 offset:57344
    v_mfma_f32_16x16x32_bf16 v[148:151], v[68:71], v[36:39], v[148:151]
    ds_read_b64_tr_b16 v[122:123], v13 offset:57344
    v_mfma_f32_16x16x32_bf16 v[152:155], v[72:75], v[36:39], v[152:155]
    ds_read_b64_tr_b16 v[124:125], v14 offset:57344
    v_mfma_f32_16x16x32_bf16 v[156:159], v[76:79], v[36:39], v[156:159]
    ds_read_b64_tr_b16 v[126:127], v15 offset:57344
    v_mfma_f32_16x16x32_bf16 v[160:163], v[64:67], v[40:43], v[160:163]
    ds_read_b128 v[80:83], v6 offset:32768
    v_mfma_f32_16x16x32_bf16 v[164:167], v[68:71], v[40:43], v[164:167]
    ds_read_b128 v[84:87], v6 offset:33792
    v_mfma_f32_16x16x32_bf16 v[168:171], v[72:75], v[40:43], v[168:171]
    ds_read_b128 v[88:91], v6 offset:34816
    v_mfma_f32_16x16x32_bf16 v[172:175], v[76:79], v[40:43], v[172:175]
    ds_read_b128 v[92:95], v6 offset:35840
    v_mfma_f32_16x16x32_bf16 v[176:179], v[64:67], v[44:47], v[176:179]
    ds_read_b128 v[96:99], v6 offset:36864
    v_mfma_f32_16x16x32_bf16 v[180:183], v[68:71], v[44:47], v[180:183]
    ds_read_b128 v[100:103], v6 offset:37888
    v_mfma_f32_16x16x32_bf16 v[184:187], v[72:75], v[44:47], v[184:187]
    ds_read_b128 v[104:107], v6 offset:38912
    v_mfma_f32_16x16x32_bf16 v[188:191], v[76:79], v[44:47], v[188:191]
    ds_read_b128 v[108:111], v6 offset:39936
    v_mfma_f32_16x16x32_bf16 v[192:195], v[64:67], v[48:51], v[192:195]
    v_mfma_f32_16x16x32_bf16 v[196:199], v[68:71], v[48:51], v[196:199]
    s_add_u32 m0, s21, 65536
    s_nop 0
    buffer_load_dwordx4 v1, s[4:7], s16 offen sc1 lds
    s_add_u32 s16, s16, s62
    v_mfma_f32_16x16x32_bf16 v[200:203], v[72:75], v[48:51], v[200:203]
    v_mfma_f32_16x16x32_bf16 v[204:207], v[76:79], v[48:51], v[204:207]
    v_mfma_f32_16x16x32_bf16 v[208:211], v[64:67], v[52:55], v[208:211]
    s_add_u32 m0, s21, 66560
    s_nop 0
    buffer_load_dwordx4 v1, s[4:7], s17 offen sc1 lds
    s_add_u32 s17, s17, s62
    v_mfma_f32_16x16x32_bf16 v[212:215], v[68:71], v[52:55], v[212:215]
    v_mfma_f32_16x16x32_bf16 v[216:219], v[72:75], v[52:55], v[216:219]
    v_mfma_f32_16x16x32_bf16 v[220:223], v[76:79], v[52:55], v[220:223]
    s_add_u32 m0, s22, 65536
    s_nop 0
    buffer_load_dwordx4 v2, s[8:11], s18 offen lds
    s_add_u32 s18, s18, s20
    v_mfma_f32_16x16x32_bf16 v[224:227], v[64:67], v[56:59], v[224:227]
    v_mfma_f32_16x16x32_bf16 v[228:231], v[68:71], v[56:59], v[228:231]
    v_mfma_f32_16x16x32_bf16 v[232:235], v[72:75], v[56:59], v[232:235]
    s_add_u32 m0, s22, 73728
    s_nop 0
    buffer_load_dwordx4 v2, s[12:15], s19 offen lds
    s_add_u32 s19, s19, s20
    v_mfma_f32_16x16x32_bf16 v[236:239], v[76:79], v[56:59], v[236:239]
    v_mfma_f32_16x16x32_bf16 v[240:243], v[64:67], v[60:63], v[240:243]
    v_mfma_f32_16x16x32_bf16 v[244:247], v[68:71], v[60:63], v[244:247]
    v_mfma_f32_16x16x32_bf16 v[248:251], v[72:75], v[60:63], v[248:251]
    v_mfma_f32_16x16x32_bf16 v[252:255], v[76:79], v[60:63], v[252:255]
    s_waitcnt lgkmcnt(0)
    s_waitcnt vmcnt(8)
    s_barrier
    v_mfma_f32_16x16x32_bf16 v[128:131], v[112:115], v[80:83], v[128:131]
    ds_read_b64_tr_b16 v[64:65], v8 offset:16384
    v_mfma_f32_16x16x32_bf16 v[132:135], v[116:119], v[80:83], v[132:135]
    ds_read_b64_tr_b16 v[66:67], v9 offset:16384
    v_mfma_f32_16x16x32_bf16 v[136:139], v[120:123], v[80:83], v[136:139]
    ds_read_b64_tr_b16 v[68:69], v10 offset:16384
    v_mfma_f32_16x16x32_bf16 v[140:143], v[124:127], v[80:83], v[140:143]
    ds_read_b64_tr_b16 v[70:71], v11 offset:16384
    v_mfma_f32_16x16x32_bf16 v[144:147], v[112:115], v[84:87], v[144:147]
    ds_read_b64_tr_b16 v[72:73], v8 offset:24576
    v_mfma_f32_16x16x32_bf16 v[148:151], v[116:119], v[84:87], v[148:151]
    ds_read_b64_tr_b16 v[74:75], v9 offset:24576
    v_mfma_f32_16x16x32_bf16 v[152:155], v[120:123], v[84:87], v[152:155]
    ds_read_b64_tr_b16 v[76:77], v10 offset:24576
    v_mfma_f32_16x16x32_bf16 v[156:159], v[124:127], v[84:87], v[156:159]
    ds_read_b64_tr_b16 v[78:79], v11 offset:24576
    v_mfma_f32_16x16x32_bf16 v[160:163], v[112:115], v[88:91], v[160:163]
    ds_read_b128 v[32:35], v5 offset:0
    v_mfma_f32_16x16x32_bf16 v[164:167], v[116:119], v[88:91], v[164:167]
    ds_read_b128 v[36:39], v5 offset:1024
    v_mfma_f32_16x16x32_bf16 v[168:171], v[120:123], v[88:91], v[168:171]
    ds_read_b128 v[40:43], v5 offset:2048
    v_mfma_f32_16x16x32_bf16 v[172:175], v[124:127], v[88:91], v[172:175]
    ds_read_b128 v[44:47], v5 offset:3072
    v_mfma_f32_16x16x32_bf16 v[176:179], v[112:115], v[92:95], v[176:179]
    ds_read_b128 v[48:51], v5 offset:4096
    v_mfma_f32_16x16x32_bf16 v[180:183], v[116:119], v[92:95], v[180:183]
    ds_read_b128 v[52:55], v5 offset:5120
    v_mfma_f32_16x16x32_bf16 v[184:187], v[120:123], v[92:95], v[184:187]
    ds_read_b128 v[56:59], v5 offset:6144
    v_mfma_f32_16x16x32_bf16 v[188:191], v[124:127], v[92:95], v[188:191]
    ds_read_b128 v[60:63], v5 offset:7168
    v_mfma_f32_16x16x32_bf16 v[192:195], v[112:115], v[96:99], v[192:195]
    v_mfma_f32_16x16x32_bf16 v[196:199], v[116:119], v[96:99], v[196:199]
    s_add_u32 m0, s21, 98304
    s_nop 0
    buffer_load_dwordx4 v1, s[4:7], s16 offen sc1 lds
    s_add_u32 s16, s16, s62
    v_mfma_f32_16x16x32_bf16 v[200:203], v[120:123], v[96:99], v[200:203]
    v_mfma_f32_16x16x32_bf16 v[204:207], v[124:127], v[96:99], v[204:207]
    v_mfma_f32_16x16x32_bf16 v[208:211], v[112:115], v[100:103], v[208:211]
    s_add_u32 m0, s21, 99328
    s_nop 0
    buffer_load_dwordx4 v1, s[4:7], s17 offen sc1 lds
    s_add_u32 s17, s17, s62
    v_mfma_f32_16x16x32_bf16 v[212:215], v[116:119], v[100:103], v[212:215]
    v_mfma_f32_16x16x32_bf16 v[216:219], v[120:123], v[100:103], v[216:219]
    v_mfma_f32_16x16x32_bf16 v[220:223], v[124:127], v[100:103], v[220:223]
    s_add_u32 m0, s22, 98304
    s_nop 0
    buffer_load_dwordx4 v2, s[8:11], s18 offen lds
    s_add_u32 s18, s18, s20
    v_mfma_f32_16x16x32_bf16 v[224:227], v[112:115], v[104:107], v[224:227]
    v_mfma_f32_16x16x32_bf16 v[228:231], v[116:119], v[104:107], v[228:231]
    v_mfma_f32_16x16x32_bf16 v[232:235], v[120:123], v[104:107], v[232:235]
    s_add_u32 m0, s22, 106496
    s_nop 0
    buffer_load_dwordx4 v2, s[12:15], s19 offen lds
    s_add_u32 s19, s19, s20
    v_mfma_f32_16x16x32_bf16 v[236:239], v[124:127], v[104:107], v[236:239]
    v_mfma_f32_16x16x32_bf16 v[240:243], v[112:115], v[108:111], v[240:243]
    v_mfma_f32_16x16x32_bf16 v[244:247], v[116:119], v[108:111], v[244:247]
    v_mfma_f32_16x16x32_bf16 v[248:251], v[120:123], v[108:111], v[248:251]
    v_mfma_f32_16x16x32_bf16 v[252:255], v[124:127], v[108:111], v[252:255]
    s_waitcnt lgkmcnt(0)
    s_sub_u32 s23, s23, 1
    s_cmp_lg_u32 s23, 0
    s_cbranch_scc1 w_loop
    s_branch w_end
w_nd:
    s_waitcnt vmcnt(8)
    s_barrier
    v_mfma_f32_16x16x32_bf16 v[128:131], v[64:67], v[32:35], v[128:131]
    ds_read_b64_tr_b16 v[112:113], v8 offset:49152
    v_mfma_f32_16x16x32_bf16 v[132:135], v[68:71], v[32:35], v[132:135]
    ds_read_b64_tr_b16 v[114:115], v9 offset:49152
    v_mfma_f32_16x16x32_bf16 v[136:139], v[72:75], v[32:35], v[136:139]
    ds_read_b64_tr_b16 v[116:117], v10 offset:49152
    v_mfma_f32_16x16x32_bf16 v[140:143], v[76:79], v[32:35], v[140:143]
    ds_read_b64_tr_b16 v[118:119], v11 offset:49152
    v_mfma_f32_16x16x32_bf16 v[144:147], v[64:67], v[36:39], v[144:147]
    ds_read_b64_tr_b16 v[120:121], v8 offset:57344
    v_mfma_f32_16x16x32_bf16 v[148:151], v[68:71], v[36:39], v[148:151]
    ds_read_b64_tr_b16 v[122:123], v9 offset:57344
    v_mfma_f32_16x16x32_bf16 v[152:155], v[72:75], v[36:39], v[152:155]
    ds_read_b64_tr_b16 v[124:125], v10 offset:57344
    v_mfma_f32_16x16x32_bf16 v[156:159], v[76:79], v[36:39], v[156:159]
    ds_read_b64_tr_b16 v[126:127], v11 offset:57344
    v_mfma_f32_16x16x32_bf16 v[160:163], v[64:67], v[40:43], v[160:163]
    ds_read_b128 v[80:83], v5 offset:32768
    v_mfma_f32_16x16x32_bf16 v[164:167], v[68:71], v[40:43], v[164:167]
    ds_read_b128 v[84:87], v5 offset:33792
    v_mfma_f32_16x16x32_bf16 v[168:171], v[72:75], v[40:43], v[168:171]
    ds_read_b128 v[88:91], v5 offset:34816
    v_mfma_f32_16x16x32_bf16 v[172:175], v[76:79], v[40:43], v[172:175]
    ds_read_b128 v[92:95], v5 offset:35840
    v_mfma_f32_16x16x32_bf16 v[176:179], v[64:67], v[44:47], v[176:179]
    ds_read_b128 v[96:99], v5 offset:36864
    v_mfma_f32_16x16x32_bf16 v[180:183], v[68:71], v[44:47], v[180:183]
    ds_read_b128 v[100:103], v5 offset:37888
    v_mfma_f32_16x16x32_bf16 v[184:187], v[72:75], v[44:47], v[184:187]
    ds_read_b128 v[104:107], v5 offset:38912
    v_mfma_f32_16x16x32_bf16 v[188:191], v[76:79], v[44:47], v[188:191]
    ds_read_b128 v[108:111], v5 offset:39936
    v_mfma_f32_16x16x32_bf16 v[192:195], v[64:67], v[48:51], v[192:195]
    v_mfma_f32_16x16x32_bf16 v[196:199], v[68:71], v[48:51], v[196:199]
    v_mfma_f32_16x16x32_bf16 v[200:203], v[72:75], v[48:51], v[200:203]
    v_mfma_f32_16x16x32_bf16 v[204:207], v[76:79], v[48:51], v[204:207]
    v_mfma_f32_16x16x32_bf16 v[208:211], v[64:67], v[52:55], v[208:211]
    v_mfma_f32_16x16x32_bf16 v[212:215], v[68:71], v[52:55], v[212:215]
    v_mfma_f32_16x16x32_bf16 v[216:219], v[72:75], v[52:55], v[216:219]
    v_mfma_f32_16x16x32_bf16 v[220:223], v[76:79], v[52:55], v[220:223]
    v_mfma_f32_16x16x32_bf16 v[224:227], v[64:67], v[56:59], v[224:227]
    v_mfma_f32_16x16x32_bf16 v[228:231], v[68:71], v[56:59], v[228:231]
    v_mfma_f32_16x16x32_bf16 v[232:235], v[72:75], v[56:59], v[232:235]
    v_mfma_f32_16x16x32_bf16 v[236:239], v[76:79], v[56:59], v[236:239]
    v_mfma_f32_16x16x32_bf16 v[240:243], v[64:67], v[60:63], v[240:243]
    v_mfma_f32_16x16x32_bf16 v[244:247], v[68:71], v[60:63], v[244:247]
    v_mfma_f32_16x16x32_bf16 v[248:251], v[72:75], v[60:63], v[248:251]
    v_mfma_f32_16x16x32_bf16 v[252:255], v[76:79], v[60:63], v[252:255]
    s_waitcnt lgkmcnt(0)
    s_waitcnt vmcnt(4)
    s_barrier
    v_mfma_f32_16x16x32_bf16 v[128:131], v[112:115], v[80:83], v[128:131]
    ds_read_b64_tr_b16 v[64:65], v12 offset:16384
    v_mfma_f32_16x16x32_bf16 v[132:135], v[116:119], v[80:83], v[132:135]
    ds_read_b64_tr_b16 v[66:67], v13 offset:16384
    v_mfma_f32_16x16x32_bf16 v[136:139], v[120:123], v[80:83], v[136:139]
    ds_read_b64_tr_b16 v[68:69], v14 offset:16384
    v_mfma_f32_16x16x32_bf16 v[140:143], v[124:127], v[80:83], v[140:143]
    ds_read_b64_tr_b16 v[70:71], v15 offset:16384
    v_mfma_f32_16x16x32_bf16 v[144:147], v[112:115], v[84:87], v[144:147]
    ds_read_b64_tr_b16 v[72:73], v12 offset:24576
    v_mfma_f32_16x16x32_bf16 v[148:151], v[116:119], v[84:87], v[148:151]
    ds_read_b64_tr_b16 v[74:75], v13 offset:24576
    v_mfma_f32_16x16x32_bf16 v[152:155], v[120:123], v[84:87], v[152:155]
    ds_read_b64_tr_b16 v[76:77], v14 offset:24576
    v_mfma_f32_16x16x32_bf16 v[156:159], v[124:127], v[84:87], v[156:159]
    ds_read_b64_tr_b16 v[78:79], v15 offset:24576
    v_mfma_f32_16x16x32_bf16 v[160:163], v[112:115], v[88:91], v[160:163]
    ds_read_b128 v[32:35], v6 offset:0
    v_mfma_f32_16x16x32_bf16 v[164:167], v[116:119], v[88:91], v[164:167]
    ds_read_b128 v[36:39], v6 offset:1024
    v_mfma_f32_16x16x32_bf16 v[168:171], v[120:123], v[88:91], v[168:171]
    ds_read_b128 v[40:43], v6 offset:2048
    v_mfma_f32_16x16x32_bf16 v[172:175], v[124:127], v[88:91], v[172:175]
    ds_read_b128 v[44:47], v6 offset:3072
    v_mfma_f32_16x16x32_bf16 v[176:179], v[112:115], v[92:95], v[176:179]
    ds_read_b128 v[48:51], v6 offset:4096
    v_mfma_f32_16x16x32_bf16 v[180:183], v[116:119], v[92:95], v[180:183]
    ds_read_b128 v[52:55], v6 offset:5120
    v_mfma_f32_16x16x32_bf16 v[184:187], v[120:123], v[92:95], v[184:187]
    ds_read_b128 v[56:59], v6 offset:6144
    v_mfma_f32_16x16x32_bf16 v[188:191], v[124:127], v[92:95], v[188:191]
    ds_read_b128 v[60:63], v6 offset:7168
    v_mfma_f32_16x16x32_bf16 v[192:195], v[112:115], v[96:99], v[192:195]
    v_mfma_f32_16x16x32_bf16 v[196:199], v[116:119], v[96:99], v[196:199]
    v_mfma_f32_16x16x32_bf16 v[200:203], v[120:123], v[96:99], v[200:203]
    v_mfma_f32_16x16x32_bf16 v[204:207], v[124:127], v[96:99], v[204:207]
    v_mfma_f32_16x16x32_bf16 v[208:211], v[112:115], v[100:103], v[208:211]
    v_mfma_f32_16x16x32_bf16 v[212:215], v[116:119], v[100:103], v[212:215]
    v_mfma_f32_16x16x32_bf16 v[216:219], v[120:123], v[100:103], v[216:219]
    v_mfma_f32_16x16x32_bf16 v[220:223], v[124:127], v[100:103], v[220:223]
    v_mfma_f32_16x16x32_bf16 v[224:227], v[112:115], v[104:107], v[224:227]
    v_mfma_f32_16x16x32_bf16 v[228:231], v[116:119], v[104:107], v[228:231]
    v_mfma_f32_16x16x32_bf16 v[232:235], v[120:123], v[104:107], v[232:235]
    v_mfma_f32_16x16x32_bf16 v[236:239], v[124:127], v[104:107], v[236:239]
    v_mfma_f32_16x16x32_bf16 v[240:243], v[112:115], v[108:111], v[240:243]
    v_mfma_f32_16x16x32_bf16 v[244:247], v[116:119], v[108:111], v[244:247]
    v_mfma_f32_16x16x32_bf16 v[248:251], v[120:123], v[108:111], v[248:251]
    v_mfma_f32_16x16x32_bf16 v[252:255], v[124:127], v[108:111], v[252:255]
    s_waitcnt lgkmcnt(0)
    s_waitcnt vmcnt(0)
    s_barrier
    v_mfma_f32_16x16x32_bf16 v[128:131], v[64:67], v[32:35], v[128:131]
    ds_read_b64_tr_b16 v[112:113], v12 offset:49152
    v_mfma_f32_16x16x32_bf16 v[132:135], v[68:71], v[32:35], v[132:135]
    ds_read_b64_tr_b16 v[114:115], v13 offset:49152
    v_mfma_f32_16x16x32_bf16 v[136:139], v[72:75], v[32:35], v[136:139]
    ds_read_b64_tr_b16 v[116:117], v14 offset:49152
    v_mfma_f32_16x16x32_bf16 v[140:143], v[76:79], v[32:35], v[140:143]
    ds_read_b64_tr_b16 v[118:119], v15 offset:49152
    v_mfma_f32_16x16x32_bf16 v[144:147], v[64:67], v[36:39], v[144:147]
    ds_read_b64_tr_b16 v[120:121], v12 offset:57344
    v_mfma_f32_16x16x32_bf16 v[148:151], v[68:71], v[36:39], v[148:151]
    ds_read_b64_tr_b16 v[122:123], v13 offset:57344
    v_mfma_f32_16x16x32_bf16 v[152:155], v[72:75], v[36:39], v[152:155]
    ds_read_b64_tr_b16 v[124:125], v14 offset:57344
    v_mfma_f32_16x16x32_bf16 v[156:159], v[76:79], v[36:39], v[156:159]
    ds_read_b64_tr_b16 v[126:127], v15 offset:57344
    v_mfma_f32_16x16x32_bf16 v[160:163], v[64:67], v[40:43], v[160:163]
    ds_read_b128 v[80:83], v6 offset:32768
    v_mfma_f32_16x16x32_bf16 v[164:167], v[68:71], v[40:43], v[164:167]
    ds_read_b128 v[84:87], v6 offset:33792
    v_mfma_f32_16x16x32_bf16 v[168:171], v[72:75], v[40:43], v[168:171]
    ds_read_b128 v[88:91], v6 offset:34816
    v_mfma_f32_16x16x32_bf16 v[172:175], v[76:79], v[40:43], v[172:175]
    ds_read_b128 v[92:95], v6 offset:35840
    v_mfma_f32_16x16x32_bf16 v[176:179], v[64:67], v[44:47], v[176:179]
    ds_read_b128 v[96:99], v6 offset:36864
    v_mfma_f32_16x16x32_bf16 v[180:183], v[68:71], v[44:47], v[180:183]
    ds_read_b128 v[100:103], v6 offset:37888
    v_mfma_f32_16x16x32_bf16 v[184:187], v[72:75], v[44:47], v[184:187]
    ds_read_b128 v[104:107], v6 offset:38912
    v_mfma_f32_16x16x32_bf16 v[188:191], v[76:79], v[44:47], v[188:191]
    ds_read_b128 v[108:111], v6 offset:39936
    v_mfma_f32_16x16x32_bf16 v[192:195], v[64:67], v[48:51], v[192:195]
    v_mfma_f32_16x16x32_bf16 v[196:199], v[68:71], v[48:51], v[196:199]
    v_mfma_f32_16x16x32_bf16 v[200:203], v[72:75], v[48:51], v[200:203]
    v_mfma_f32_16x16x32_bf16 v[204:207], v[76:79], v[48:51], v[204:207]
    v_mfma_f32_16x16x32_bf16 v[208:211], v[64:67], v[52:55], v[208:211]
    v_mfma_f32_16x16x32_bf16 v[212:215], v[68:71], v[52:55], v[212:215]
    v_mfma_f32_16x16x32_bf16 v[216:219], v[72:75], v[52:55], v[216:219]
    v_mfma_f32_16x16x32_bf16 v[220:223], v[76:79], v[52:55], v[220:223]
    v_mfma_f32_16x16x32_bf16 v[224:227], v[64:67], v[56:59], v[224:227]
    v_mfma_f32_16x16x32_bf16 v[228:231], v[68:71], v[56:59], v[228:231]
    v_mfma_f32_16x16x32_bf16 v[232:235], v[72:75], v[56:59], v[232:235]
    v_mfma_f32_16x16x32_bf16 v[236:239], v[76:79], v[56:59], v[236:239]
    v_mfma_f32_16x16x32_bf16 v[240:243], v[64:67], v[60:63], v[240:243]
    v_mfma_f32_16x16x32_bf16 v[244:247], v[68:71], v[60:63], v[244:247]
    v_mfma_f32_16x16x32_bf16 v[248:251], v[72:75], v[60:63], v[248:251]
    v_mfma_f32_16x16x32_bf16 v[252:255], v[76:79], v[60:63], v[252:255]
    s_waitcnt lgkmcnt(0)
    s_waitcnt vmcnt(0)
    s_barrier
    v_mfma_f32_16x16x32_bf16 v[128:131], v[112:115], v[80:83], v[128:131]
    ds_read_b64_tr_b16 v[64:65], v8 offset:16384
    v_mfma_f32_16x16x32_bf16 v[132:135], v[116:119], v[80:83], v[132:135]
    ds_read_b64_tr_b16 v[66:67], v9 offset:16384
    v_mfma_f32_16x16x32_bf16 v[136:139], v[120:123], v[80:83], v[136:139]
    ds_read_b64_tr_b16 v[68:69], v10 offset:16384
    v_mfma_f32_16x16x32_bf16 v[140:143], v[124:127], v[80:83], v[140:143]
    ds_read_b64_tr_b16 v[70:71], v11 offset:16384
    v_mfma_f32_16x16x32_bf16 v[144:147], v[112:115], v[84:87], v[144:147]
    ds_read_b64_tr_b16 v[72:73], v8 offset:24576
    v_mfma_f32_16x16x32_bf16 v[148:151], v[116:119], v[84:87], v[148:151]
    ds_read_b64_tr_b16 v[74:75], v9 offset:24576
    v_mfma_f32_16x16x32_bf16 v[152:155], v[120:123], v[84:87], v[152:155]
    ds_read_b64_tr_b16 v[76:77], v10 offset:24576
    v_mfma_f32_16x16x32_bf16 v[156:159], v[124:127], v[84:87], v[156:159]
    ds_read_b64_tr_b16 v[78:79], v11 offset:24576
    v_mfma_f32_16x16x32_bf16 v[160:163], v[112:115], v[88:91], v[160:163]
    ds_read_b128 v[32:35], v5 offset:0
    v_mfma_f32_16x16x32_bf16 v[164:167], v[116:119], v[88:91], v[164:167]
    ds_read_b128 v[36:39], v5 offset:1024
    v_mfma_f32_16x16x32_bf16 v[168:171], v[120:123], v[88:91], v[168:171]
    ds_read_b128 v[40:43], v5 offset:2048
    v_mfma_f32_16x16x32_bf16 v[172:175], v[124:127], v[88:91], v[172:175]
    ds_read_b128 v[44:47], v5 offset:3072
    v_mfma_f32_16x16x32_bf16 v[176:179], v[112:115], v[92:95], v[176:179]
    ds_read_b128 v[48:51], v5 offset:4096
    v_mfma_f32_16x16x32_bf16 v[180:183], v[116:119], v[92:95], v[180:183]
    ds_read_b128 v[52:55], v5 offset:5120
    v_mfma_f32_16x16x32_bf16 v[184:187], v[120:123], v[92:95], v[184:187]
    ds_read_b128 v[56:59], v5 offset:6144
    v_mfma_f32_16x16x32_bf16 v[188:191], v[124:127], v[92:95], v[188:191]
    ds_read_b128 v[60:63], v5 offset:7168
    v_mfma_f32_16x16x32_bf16 v[192:195], v[112:115], v[96:99], v[192:195]
    v_mfma_f32_16x16x32_bf16 v[196:199], v[116:119], v[96:99], v[196:199]
    v_mfma_f32_16x16x32_bf16 v[200:203], v[120:123], v[96:99], v[200:203]
    v_mfma_f32_16x16x32_bf16 v[204:207], v[124:127], v[96:99], v[204:207]
    v_mfma_f32_16x16x32_bf16 v[208:211], v[112:115], v[100:103], v[208:211]
    v_mfma_f32_16x16x32_bf16 v[212:215], v[116:119], v[100:103], v[212:215]
    v_mfma_f32_16x16x32_bf16 v[216:219], v[120:123], v[100:103], v[216:219]
    v_mfma_f32_16x16x32_bf16 v[220:223], v[124:127], v[100:103], v[220:223]
    v_mfma_f32_16x16x32_bf16 v[224:227], v[112:115], v[104:107], v[224:227]
    v_mfma_f32_16x16x32_bf16 v[228:231], v[116:119], v[104:107], v[228:231]
    v_mfma_f32_16x16x32_bf16 v[232:235], v[120:123], v[104:107], v[232:235]
    v_mfma_f32_16x16x32_bf16 v[236:239], v[124:127], v[104:107], v[236:239]
    v_mfma_f32_16x16x32_bf16 v[240:243], v[112:115], v[108:111], v[240:243]
    v_mfma_f32_16x16x32_bf16 v[244:247], v[116:119], v[108:111], v[244:247]
    v_mfma_f32_16x16x32_bf16 v[248:251], v[120:123], v[108:111], v[248:251]
    v_mfma_f32_16x16x32_bf16 v[252:255], v[124:127], v[108:111], v[252:255]
    s_waitcnt lgkmcnt(0)
w_end:
    v_mov_b32 v20, 131072
    ds_read_b128 v[24:27], v20
    ds_read_b128 v[28:31], v20 offset:16
    s_cmp_eq_u32 s48, 2
    s_cbranch_scc1 w_epi_glu
    s_cmp_eq_u32 s48, 3
    s_cbranch_scc1 w_epi_silu
    s_lshl_b32 s30, s27, 10
    s_add_u32 s30, s30, s49
    s_nop 7
    v_cvt_pk_bf16_f32 v80, v128, v129
    v_cvt_pk_bf16_f32 v81, v130, v131
    v_cvt_pk_bf16_f32 v82, v132, v133
    v_cvt_pk_bf16_f32 v83, v134, v135
    buffer_store_dwordx4 v[80:83], v1, s[4:7], s30 offen sc1
    v_cvt_pk_bf16_f32 v84, v136, v137
    v_cvt_pk_bf16_f32 v85, v138, v139
    v_cvt_pk_bf16_f32 v86, v140, v141
    v_cvt_pk_bf16_f32 v87, v142, v143
    buffer_store_dwordx4 v[84:87], v19, s[4:7], s30 offen sc1
    s_add_u32 s30, s30, s50
    v_cvt_pk_bf16_f32 v88, v144, v145
    v_cvt_pk_bf16_f32 v89, v146, v147
    v_cvt_pk_bf16_f32 v90, v148, v149
    v_cvt_pk_bf16_f32 v91, v150, v151
    buffer_store_dwordx4 v[88:91], v1, s[4:7], s30 offen sc1
    v_cvt_pk_bf16_f32 v92, v152, v153
    v_cvt_pk_bf16_f32 v93, v154, v155
    v_cvt_pk_bf16_f32 v94, v156, v157
    v_cvt_pk_bf16_f32 v95, v158, v159
    buffer_store_dwordx4 v[92:95], v19, s[4:7], s30 offen sc1
    s_add_u32 s30, s30, s50
    v_cvt_pk_bf16_f32 v80, v160, v161
    v_cvt_pk_bf16_f32 v81, v162, v163
    v_cvt_pk_bf16_f32 v82, v164, v165
    v_cvt_pk_bf16_f32 v83, v166, v167
    buffer_store_dwordx4 v[80:83], v1, s[4:7], s30 offen sc1
    v_cvt_pk_bf16_f32 v84, v168, v169
    v_cvt_pk_bf16_f32 v85, v170, v171
    v_cvt_pk_bf16_f32 v86, v172, v173
    v_cvt_pk_bf16_f32 v87, v174, v175
    buffer_store_dwordx4 v[84:87], v19, s[4:7], s30 offen sc1
    s_add_u32 s30, s30, s50
    v_cvt_pk_bf16_f32 v88, v176, v177
    v_cvt_pk_bf16_f32 v89, v178, v179
    v_cvt_pk_bf16_f32 v90, v180, v181
    v_cvt_pk_bf16_f32 v91, v182, v183
    buffer_store_dwordx4 v[88:91], v1, s[4:7], s30 offen sc1
    v_cvt_pk_bf16_f32 v92, v184, v185
    v_cvt_pk_bf16_f32 v93, v186, v187
    v_cvt_pk_bf16_f32 v94, v188, v189
    v_cvt_pk_bf16_f32 v95, v190, v191
    buffer_store_dwordx4 v[92:95], v19, s[4:7], s30 offen sc1
    s_add_u32 s30, s30, s50
    v_cvt_pk_bf16_f32 v80, v192, v193
    v_cvt_pk_bf16_f32 v81, v194, v195
    v_cvt_pk_bf16_f32 v82, v196, v197
    v_cvt_pk_bf16_f32 v83, v198, v199
    buffer_store_dwordx4 v[80:83], v1, s[4:7], s30 offen sc1
    v_cvt_pk_bf16_f32 v84, v200, v201
    v_cvt_pk_bf16_f32 v85, v202, v203
    v_cvt_pk_bf16_f32 v86, v204, v205
    v_cvt_pk_bf16_f32 v87, v206, v207
    buffer_store_dwordx4 v[84:87], v19, s[4:7], s30 offen sc1
    s_add_u32 s30, s30, s50
    v_cvt_pk_bf16_f32 v88, v208, v209
    v_cvt_pk_bf16_f32 v89, v210, v211
    v_cvt_pk_bf16_f32 v90, v212, v213
    v_cvt_pk_bf16_f32 v91, v214, v215
    buffer_store_dwordx4 v[88:91], v1, s[4:7], s30 offen sc1
    v_cvt_pk_bf16_f32 v92, v216, v217
    v_cvt_pk_bf16_f32 v93, v218, v219
    v_cvt_pk_bf16_f32 v94, v220, v221
    v_cvt_pk_bf16_f32 v95, v222, v223
    buffer_store_dwordx4 v[92:95], v19, s[4:7], s30 offen sc1
    s_add_u32 s30, s30, s50
    v_cvt_pk_bf16_f32 v80, v224, v225
    v_cvt_pk_bf16_f32 v81, v226, v227
    v_cvt_pk_bf16_f32 v82, v228, v229
    v_cvt_pk_bf16_f32 v83, v230, v231
    buffer_store_dwordx4 v[80:83], v1, s[4:7], s30 offen sc1
    v_cvt_pk_bf16_f32 v84, v232, v233
    v_cvt_pk_bf16_f32 v85, v234, v235
    v_cvt_pk_bf16_f32 v86, v236, v237
    v_cvt_pk_bf16_f32 v87, v238, v239
    buffer_store_dwordx4 v[84:87], v19, s[4:7], s30 offen sc1
    s_add_u32 s30, s30, s50
    v_cvt_pk_bf16_f32 v88, v240, v241
    v_cvt_pk_bf16_f32 v89, v242, v243
    v_cvt_pk_bf16_f32 v90, v244, v245
    v_cvt_pk_bf16_f32 v91, v246, v247
    buffer_store_dwordx4 v[88:91], v1, s[4:7], s30 offen sc1
    v_cvt_pk_bf16_f32 v92, v248, v249
    v_cvt_pk_bf16_f32 v93, v250, v251
    v_cvt_pk_bf16_f32 v94, v252, v253
    v_cvt_pk_bf16_f32 v95, v254, v255
    buffer_store_dwordx4 v[92:95], v19, s[4:7], s30 offen sc1
    s_waitcnt lgkmcnt(0)
    v_or3_b32 v24, v24, v25, v26
    v_or3_b32 v28, v28, v29, v30
    v_or3_b32 v24, v24, v27, v31
    v_or_b32 v24, v24, v28
    s_mov_b32 s28, s51
    s_mov_b32 s57, s53
    v_readfirstlane_b32 s30, v24
    s_cmp_lg_u32 s30, 0
    s_cbranch_scc1 w_drain
    s_mov_b32 s48, s32
    s_cmp_ge_u32 s32, 4
    s_cselect_b32 s30, 2, 3
    s_lshl_b32 s30, s26, s30
    s_mul_i32 s30, s30, s43
    s_add_u32 s49, s42, s30
    s_mov_b32 s50, s43
    s_mov_b32 s51, s46
    s_mov_b32 s23, s41
    s_mov_b32 s53, s47
    s_nop 0
    s_load_dwordx16 s[32:47], s[24:25], 0
    s_add_u32 s24, s24, 64
    s_addc_u32 s25, s25, 0
    s_branch w_first16
w_epi_glu:
    s_lshl_b32 s30, s27, 10
    s_add_u32 s30, s30, s49
    s_mov_b32 s54, 0xbfb8aa3b
    s_nop 7
    v_cvt_pk_bf16_f32 v80, v128, v129
    v_cvt_pk_bf16_f32 v81, v130, v131
    v_cvt_pk_bf16_f32 v82, v132, v133
    v_cvt_pk_bf16_f32 v83, v134, v135
    v_lshlrev_b32 v96, 16, v80
    v_and_b32 v97, 0xffff0000, v80
    v_lshlrev_b32 v98, 16, v81
    v_and_b32 v99, 0xffff0000, v81
    v_lshlrev_b32 v100, 16, v82
    v_and_b32 v101, 0xffff0000, v82
    v_lshlrev_b32 v102, 16, v83
    v_and_b32 v103, 0xffff0000, v83
    v_mul_f32 v96, s54, v96
    v_mul_f32 v97, s54, v97
    v_mul_f32 v98, s54, v98
    v_mul_f32 v99, s54, v99
    v_mul_f32 v100, s54, v100
    v_mul_f32 v101, s54, v101
    v_mul_f32 v102, s54, v102
    v_mul_f32 v103, s54, v103
    v_exp_f32 v96, v96
    v_exp_f32 v97, v97
    v_exp_f32 v98, v98
    v_exp_f32 v99, v99
    v_exp_f32 v100, v100
    v_exp_f32 v101, v101
    v_exp_f32 v102, v102
    v_exp_f32 v103, v103
    v_add_f32 v96, 1.0, v96
    v_add_f32 v97, 1.0, v97
    v_add_f32 v98, 1.0, v98
    v_add_f32 v99, 1.0, v99
    v_add_f32 v100, 1.0, v100
    v_add_f32 v101, 1.0, v101
    v_add_f32 v102, 1.0, v102
    v_add_f32 v103, 1.0, v103
    v_rcp_f32 v96, v96
    v_rcp_f32 v97, v97
    v_rcp_f32 v98, v98
    v_rcp_f32 v99, v99
    v_rcp_f32 v100, v100
    v_rcp_f32 v101, v101
    v_rcp_f32 v102, v102
    v_rcp_f32 v103, v103
    v_mul_f32 v96, v96, v136
    v_mul_f32 v97, v97, v137
    v_mul_f32 v98, v98, v138
    v_mul_f32 v99, v99, v139
    v_mul_f32 v100, v100, v140
    v_mul_f32 v101, v101, v141
    v_mul_f32 v102, v102, v142
    v_mul_f32 v103, v103, v143
    v_cvt_pk_bf16_f32 v80, v96, v97
    v_cvt_pk_bf16_f32 v81, v98, v99
    v_cvt_pk_bf16_f32 v82, v100, v101
    v_cvt_pk_bf16_f32 v83, v102, v103
    buffer_store_dwordx4 v[80:83], v1, s[4:7], s30 offen sc1
    s_add_u32 s30, s30, s50
    v_cvt_pk_bf16_f32 v84, v144, v145
    v_cvt_pk_bf16_f32 v85, v146, v147
    v_cvt_pk_bf16_f32 v86, v148, v149
    v_cvt_pk_bf16_f32 v87, v150, v151
    v_lshlrev_b32 v104, 16, v84
    v_and_b32 v105, 0xffff0000, v84
    v_lshlrev_b32 v106, 16, v85
    v_and_b32 v107, 0xffff0000, v85
    v_lshlrev_b32 v108, 16, v86
    v_and_b32 v109, 0xffff0000, v86
    v_lshlrev_b32 v110, 16, v87
    v_and_b32 v111, 0xffff0000, v87
    v_mul_f32 v104, s54, v104
    v_mul_f32 v105, s54, v105
    v_mul_f32 v106, s54, v106
    v_mul_f32 v107, s54, v107
    v_mul_f32 v108, s54, v108
    v_mul_f32 v109, s54, v109
    v_mul_f32 v110, s54, v110
    v_mul_f32 v111, s54, v111
    v_exp_f32 v104, v104
    v_exp_f32 v105, v105
    v_exp_f32 v106, v106
    v_exp_f32 v107, v107
    v_exp_f32 v108, v108
    v_exp_f32 v109, v109
    v_exp_f32 v110, v110
    v_exp_f32 v111, v111
    v_add_f32 v104, 1.0, v104
    v_add_f32 v105, 1.0, v105
    v_add_f32 v106, 1.0, v106
    v_add_f32 v107, 1.0, v107
    v_add_f32 v108, 1.0, v108
    v_add_f32 v109, 1.0, v109
    v_add_f32 v110, 1.0, v110
    v_add_f32 v111, 1.0, v111
    v_rcp_f32 v104, v104
    v_rcp_f32 v105, v105
    v_rcp_f32 v106, v106
    v_rcp_f32 v107, v107
    v_rcp_f32 v108, v108
    v_rcp_f32 v109, v109
    v_rcp_f32 v110, v110
    v_rcp_f32 v111, v111
    v_mul_f32 v104, v104, v152
    v_mul_f32 v105, v105, v153
    v_mul_f32 v106, v106, v154
    v_mul_f32 v107, v107, v155
    v_mul_f32 v108, v108, v156
    v_mul_f32 v109, v109, v157
    v_mul_f32 v110, v110, v158
    v_mul_f32 v111, v111, v159
    v_cvt_pk_bf16_f32 v84, v104, v105
    v_cvt_pk_bf16_f32 v85, v106, v107
    v_cvt_pk_bf16_f32 v86, v108, v109
    v_cvt_pk_bf16_f32 v87, v110, v111
    buffer_store_dwordx4 v[84:87], v1, s[4:7], s30 offen sc1
    s_add_u32 s30, s30, s50
    v_cvt_pk_bf16_f32 v88, v160, v161
    v_cvt_pk_bf16_f32 v89, v162, v163
    v_cvt_pk_bf16_f32 v90, v164, v165
    v_cvt_pk_bf16_f32 v91, v166, v167
    v_lshlrev_b32 v96, 16, v88
    v_and_b32 v97, 0xffff0000, v88
    v_lshlrev_b32 v98, 16, v89
    v_and_b32 v99, 0xffff0000, v89
    v_lshlrev_b32 v100, 16, v90
    v_and_b32 v101, 0xffff0000, v90
    v_lshlrev_b32 v102, 16, v91
    v_and_b32 v103, 0xffff0000, v91
    v_mul_f32 v96, s54, v96
    v_mul_f32 v97, s54, v97
    v_mul_f32 v98, s54, v98
    v_mul_f32 v99, s54, v99
    v_mul_f32 v100, s54, v100
    v_mul_f32 v101, s54, v101
    v_mul_f32 v102, s54, v102
    v_mul_f32 v103, s54, v103
    v_exp_f32 v96, v96
    v_exp_f32 v97, v97
    v_exp_f32 v98, v98
    v_exp_f32 v99, v99
    v_exp_f32 v100, v100
    v_exp_f32 v101, v101
    v_exp_f32 v102, v102
    v_exp_f32 v103, v103
    v_add_f32 v96, 1.0, v96
    v_add_f32 v97, 1.0, v97
    v_add_f32 v98, 1.0, v98
    v_add_f32 v99, 1.0, v99
    v_add_f32 v100, 1.0, v100
    v_add_f32 v101, 1.0, v101
    v_add_f32 v102, 1.0, v102
    v_add_f32 v103, 1.0, v103
    v_rcp_f32 v96, v96
    v_rcp_f32 v97, v97
    v_rcp_f32 v98, v98
    v_rcp_f32 v99, v99
    v_rcp_f32 v100, v100
    v_rcp_f32 v101, v101
    v_rcp_f32 v102, v102
    v_rcp_f32 v103, v103
    v_mul_f32 v96, v96, v168
    v_mul_f32 v97, v97, v169
    v_mul_f32 v98, v98, v170
    v_mul_f32 v99, v99, v171
    v_mul_f32 v100, v100, v172
    v_mul_f32 v101, v101, v173
    v_mul_f32 v102, v102, v174
    v_mul_f32 v103, v103, v175
    v_cvt_pk_bf16_f32 v88, v96, v97
    v_cvt_pk_bf16_f32 v89, v98, v99
    v_cvt_pk_bf16_f32 v90, v100, v101
    v_cvt_pk_bf16_f32 v91, v102, v103
    buffer_store_dwordx4 v[88:91], v1, s[4:7], s30 offen sc1
    s_add_u32 s30, s30, s50
    v_cvt_pk_bf16_f32 v92, v176, v177
    v_cvt_pk_bf16_f32 v93, v178, v179
    v_cvt_pk_bf16_f32 v94, v180, v181
    v_cvt_pk_bf16_f32 v95, v182, v183
    v_lshlrev_b32 v104, 16, v92
    v_and_b32 v105, 0xffff0000, v92
    v_lshlrev_b32 v106, 16, v93
    v_and_b32 v107, 0xffff0000, v93
    v_lshlrev_b32 v108, 16, v94
    v_and_b32 v109, 0xffff0000, v94
    v_lshlrev_b32 v110, 16, v95
    v_and_b32 v111, 0xffff0000, v95
    v_mul_f32 v104, s54, v104
    v_mul_f32 v105, s54, v105
    v_mul_f32 v106, s54, v106
    v_mul_f32 v107, s54, v107
    v_mul_f32 v108, s54, v108
    v_mul_f32 v109, s54, v109
    v_mul_f32 v110, s54, v110
    v_mul_f32 v111, s54, v111
    v_exp_f32 v104, v104
    v_exp_f32 v105, v105
    v_exp_f32 v106, v106
    v_exp_f32 v107, v107
    v_exp_f32 v108, v108
    v_exp_f32 v109, v109
    v_exp_f32 v110, v110
    v_exp_f32 v111, v111
    v_add_f32 v104, 1.0, v104
    v_add_f32 v105, 1.0, v105
    v_add_f32 v106, 1.0, v106
    v_add_f32 v107, 1.0, v107
    v_add_f32 v108, 1.0, v108
    v_add_f32 v109, 1.0, v109
    v_add_f32 v110, 1.0, v110
    v_add_f32 v111, 1.0, v111
    v_rcp_f32 v104, v104
    v_rcp_f32 v105, v105
    v_rcp_f32 v106, v106
    v_rcp_f32 v107, v107
    v_rcp_f32 v108, v108
    v_rcp_f32 v109, v109
    v_rcp_f32 v110, v110
    v_rcp_f32 v111, v111
    v_mul_f32 v104, v104, v184
    v_mul_f32 v105, v105, v185
    v_mul_f32 v106, v106, v186
    v_mul_f32 v107, v107, v187
    v_mul_f32 v108, v108, v188
    v_mul_f32 v109, v109, v189
    v_mul_f32 v110, v110, v190
    v_mul_f32 v111, v111, v191
    v_cvt_pk_bf16_f32 v92, v104, v105
    v_cvt_pk_bf16_f32 v93, v106, v107
    v_cvt_pk_bf16_f32 v94, v108, v109
    v_cvt_pk_bf16_f32 v95, v110, v111
    buffer_store_dwordx4 v[92:95], v1, s[4:7], s30 offen sc1
    s_add_u32 s30, s30, s50
    v_cvt_pk_bf16_f32 v80, v192, v193
    v_cvt_pk_bf16_f32 v81, v194, v195
    v_cvt_pk_bf16_f32 v82, v196, v197
    v_cvt_pk_bf16_f32 v83, v198, v199
    v_lshlrev_b32 v96, 16, v80
    v_and_b32 v97, 0xffff0000, v80
    v_lshlrev_b32 v98, 16, v81
    v_and_b32 v99, 0xffff0000, v81
    v_lshlrev_b32 v100, 16, v82
    v_and_b32 v101, 0xffff0000, v82
    v_lshlrev_b32 v102, 16, v83
    v_and_b32 v103, 0xffff0000, v83
    v_mul_f32 v96, s54, v96
    v_mul_f32 v97, s54, v97
    v_mul_f32 v98, s54, v98
    v_mul_f32 v99, s54, v99
    v_mul_f32 v100, s54, v100
    v_mul_f32 v101, s54, v101
    v_mul_f32 v102, s54, v102
    v_mul_f32 v103, s54, v103
    v_exp_f32 v96, v96
    v_exp_f32 v97, v97
    v_exp_f32 v98, v98
    v_exp_f32 v99, v99
    v_exp_f32 v100, v100
    v_exp_f32 v101, v101
    v_exp_f32 v102, v102
    v_exp_f32 v103, v103
    v_add_f32 v96, 1.0, v96
    v_add_f32 v97, 1.0, v97
    v_add_f32 v98, 1.0, v98
    v_add_f32 v99, 1.0, v99
    v_add_f32 v100, 1.0, v100
    v_add_f32 v101, 1.0, v101
    v_add_f32 v102, 1.0, v102
    v_add_f32 v103, 1.0, v103
    v_rcp_f32 v96, v96
    v_rcp_f32 v97, v97
    v_rcp_f32 v98, v98
    v_rcp_f32 v99, v99
    v_rcp_f32 v100, v100
    v_rcp_f32 v101, v101
    v_rcp_f32 v102, v102
    v_rcp_f32 v103, v103
    v_mul_f32 v96, v96, v200
    v_mul_f32 v97, v97, v201
    v_mul_f32 v98, v98, v202
    v_mul_f32 v99, v99, v203
    v_mul_f32 v100, v100, v204
    v_mul_f32 v101, v101, v205
    v_mul_f32 v102, v102, v206
    v_mul_f32 v103, v103, v207
    v_cvt_pk_bf16_f32 v80, v96, v97
    v_cvt_pk_bf16_f32 v81, v98, v99
    v_cvt_pk_bf16_f32 v82, v100, v101
    v_cvt_pk_bf16_f32 v83, v102, v103
    buffer_store_dwordx4 v[80:83], v1, s[4:7], s30 offen sc1
    s_add_u32 s30, s30, s50
    v_cvt_pk_bf16_f32 v84, v208, v209
    v_cvt_pk_bf16_f32 v85, v210, v211
    v_cvt_pk_bf16_f32 v86, v212, v213
    v_cvt_pk_bf16_f32 v87, v214, v215
    v_lshlrev_b32 v104, 16, v84
    v_and_b32 v105, 0xffff0000, v84
    v_lshlrev_b32 v106, 16, v85
    v_and_b32 v107, 0xffff0000, v85
    v_lshlrev_b32 v108, 16, v86
    v_and_b32 v109, 0xffff0000, v86
    v_lshlrev_b32 v110, 16, v87
    v_and_b32 v111, 0xffff0000, v87
    v_mul_f32 v104, s54, v104
    v_mul_f32 v105, s54, v105
    v_mul_f32 v106, s54, v106
    v_mul_f32 v107, s54, v107
    v_mul_f32 v108, s54, v108
    v_mul_f32 v109, s54, v109
    v_mul_f32 v110, s54, v110
    v_mul_f32 v111, s54, v111
    v_exp_f32 v104, v104
    v_exp_f32 v105, v105
    v_exp_f32 v106, v106
    v_exp_f32 v107, v107
    v_exp_f32 v108, v108
    v_exp_f32 v109, v109
    v_exp_f32 v110, v110
    v_exp_f32 v111, v111
    v_add_f32 v104, 1.0, v104
    v_add_f32 v105, 1.0, v105
    v_add_f32 v106, 1.0, v106
    v_add_f32 v107, 1.0, v107
    v_add_f32 v108, 1.0, v108
    v_add_f32 v109, 1.0, v109
    v_add_f32 v110, 1.0, v110
    v_add_f32 v111, 1.0, v111
    v_rcp_f32 v104, v104
    v_rcp_f32 v105, v105
    v_rcp_f32 v106, v106
    v_rcp_f32 v107, v107
    v_rcp_f32 v108, v108
    v_rcp_f32 v109, v109
    v_rcp_f32 v110, v110
    v_rcp_f32 v111, v111
    v_mul_f32 v104, v104, v216
    v_mul_f32 v105, v105, v217
    v_mul_f32 v106, v106, v218
    v_mul_f32 v107, v107, v219
    v_mul_f32 v108, v108, v220
    v_mul_f32 v109, v109, v221
    v_mul_f32 v110, v110, v222
    v_mul_f32 v111, v111, v223
    v_cvt_pk_bf16_f32 v84, v104, v105
    v_cvt_pk_bf16_f32 v85, v106, v107
    v_cvt_pk_bf16_f32 v86, v108, v109
    v_cvt_pk_bf16_f32 v87, v110, v111
    buffer_store_dwordx4 v[84:87], v1, s[4:7], s30 offen sc1
    s_add_u32 s30, s30, s50
    v_cvt_pk_bf16_f32 v88, v224, v225
    v_cvt_pk_bf16_f32 v89, v226, v227
    v_cvt_pk_bf16_f32 v90, v228, v229
    v_cvt_pk_bf16_f32 v91, v230, v231
    v_lshlrev_b32 v96, 16, v88
    v_and_b32 v97, 0xffff0000, v88
    v_lshlrev_b32 v98, 16, v89
    v_and_b32 v99, 0xffff0000, v89
    v_lshlrev_b32 v100, 16, v90
    v_and_b32 v101, 0xffff0000, v90
    v_lshlrev_b32 v102, 16, v91
    v_and_b32 v103, 0xffff0000, v91
    v_mul_f32 v96, s54, v96
    v_mul_f32 v97, s54, v97
    v_mul_f32 v98, s54, v98
    v_mul_f32 v99, s54, v99
    v_mul_f32 v100, s54, v100
    v_mul_f32 v101, s54, v101
    v_mul_f32 v102, s54, v102
    v_mul_f32 v103, s54, v103
    v_exp_f32 v96, v96
    v_exp_f32 v97, v97
    v_exp_f32 v98, v98
    v_exp_f32 v99, v99
    v_exp_f32 v100, v100
    v_exp_f32 v101, v101
    v_exp_f32 v102, v102
    v_exp_f32 v103, v103
    v_add_f32 v96, 1.0, v96
    v_add_f32 v97, 1.0, v97
    v_add_f32 v98, 1.0, v98
    v_add_f32 v99, 1.0, v99
    v_add_f32 v100, 1.0, v100
    v_add_f32 v101, 1.0, v101
    v_add_f32 v102, 1.0, v102
    v_add_f32 v103, 1.0, v103
    v_rcp_f32 v96, v96
    v_rcp_f32 v97, v97
    v_rcp_f32 v98, v98
    v_rcp_f32 v99, v99
    v_rcp_f32 v100, v100
    v_rcp_f32 v101, v101
    v_rcp_f32 v102, v102
    v_rcp_f32 v103, v103
    v_mul_f32 v96, v96, v232
    v_mul_f32 v97, v97, v233
    v_mul_f32 v98, v98, v234
    v_mul_f32 v99, v99, v235
    v_mul_f32 v100, v100, v236
    v_mul_f32 v101, v101, v237
    v_mul_f32 v102, v102, v238
    v_mul_f32 v103, v103, v239
    v_cvt_pk_bf16_f32 v88, v96, v97
    v_cvt_pk_bf16_f32 v89, v98, v99
    v_cvt_pk_bf16_f32 v90, v100, v101
    v_cvt_pk_bf16_f32 v91, v102, v103
    buffer_store_dwordx4 v[88:91], v1, s[4:7], s30 offen sc1
    s_add_u32 s30, s30, s50
    v_cvt_pk_bf16_f32 v92, v240, v241
    v_cvt_pk_bf16_f32 v93, v242, v243
    v_cvt_pk_bf16_f32 v94, v244, v245
    v_cvt_pk_bf16_f32 v95, v246, v247
    v_lshlrev_b32 v104, 16, v92
    v_and_b32 v105, 0xffff0000, v92
    v_lshlrev_b32 v106, 16, v93
    v_and_b32 v107, 0xffff0000, v93
    v_lshlrev_b32 v108, 16, v94
    v_and_b32 v109, 0xffff0000, v94
    v_lshlrev_b32 v110, 16, v95
    v_and_b32 v111, 0xffff0000, v95
    v_mul_f32 v104, s54, v104
    v_mul_f32 v105, s54, v105
    v_mul_f32 v106, s54, v106
    v_mul_f32 v107, s54, v107
    v_mul_f32 v108, s54, v108
    v_mul_f32 v109, s54, v109
    v_mul_f32 v110, s54, v110
    v_mul_f32 v111, s54, v111
    v_exp_f32 v104, v104
    v_exp_f32 v105, v105
    v_exp_f32 v106, v106
    v_exp_f32 v107, v107
    v_exp_f32 v108, v108
    v_exp_f32 v109, v109
    v_exp_f32 v110, v110
    v_exp_f32 v111, v111
    v_add_f32 v104, 1.0, v104
    v_add_f32 v105, 1.0, v105
    v_add_f32 v106, 1.0, v106
    v_add_f32 v107, 1.0, v107
    v_add_f32 v108, 1.0, v108
    v_add_f32 v109, 1.0, v109
    v_add_f32 v110, 1.0, v110
    v_add_f32 v111, 1.0, v111
    v_rcp_f32 v104, v104
    v_rcp_f32 v105, v105
    v_rcp_f32 v106, v106
    v_rcp_f32 v107, v107
    v_rcp_f32 v108, v108
    v_rcp_f32 v109, v109
    v_rcp_f32 v110, v110
    v_rcp_f32 v111, v111
    v_mul_f32 v104, v104, v248
    v_mul_f32 v105, v105, v249
    v_mul_f32 v106, v106, v250
    v_mul_f32 v107, v107, v251
    v_mul_f32 v108, v108, v252
    v_mul_f32 v109, v109, v253
    v_mul_f32 v110, v110, v254
    v_mul_f32 v111, v111, v255
    v_cvt_pk_bf16_f32 v92, v104, v105
    v_cvt_pk_bf16_f32 v93, v106, v107
    v_cvt_pk_bf16_f32 v94, v108, v109
    v_cvt_pk_bf16_f32 v95, v110, v111
    buffer_store_dwordx4 v[92:95], v1, s[4:7], s30 offen sc1
    s_waitcnt lgkmcnt(0)
    v_or3_b32 v24, v24, v25, v26
    v_or3_b32 v28, v28, v29, v30
    v_or3_b32 v24, v24, v27, v31
    v_or_b32 v24, v24, v28
    s_mov_b32 s28, s51
    s_mov_b32 s57, s53
    v_readfirstlane_b32 s30, v24
    s_cmp_lg_u32 s30, 0
    s_cbranch_scc1 w_drain
    s_mov_b32 s48, s32
    s_cmp_ge_u32 s32, 4
    s_cselect_b32 s30, 2, 3
    s_lshl_b32 s30, s26, s30
    s_mul_i32 s30, s30, s43
    s_add_u32 s49, s42, s30
    s_mov_b32 s50, s43
    s_mov_b32 s51, s46
    s_mov_b32 s23, s41
    s_mov_b32 s53, s47
    s_nop 0
    s_load_dwordx16 s[32:47], s[24:25], 0
    s_add_u32 s24, s24, 64
    s_addc_u32 s25, s25, 0
    s_branch w_first8
w_epi_silu:
    s_lshl_b32 s30, s27, 10
    s_add_u32 s30, s30, s49
    s_mov_b32 s54, 0xbfb8aa3b
    s_nop 7
    v_cvt_pk_bf16_f32 v80, v128, v129
    v_cvt_pk_bf16_f32 v81, v130, v131
    v_cvt_pk_bf16_f32 v82, v132, v133
    v_cvt_pk_bf16_f32 v83, v134, v135
    v_lshlrev_b32 v128, 16, v80
    v_and_b32 v129, 0xffff0000, v80
    v_lshlrev_b32 v130, 16, v81
    v_and_b32 v131, 0xffff0000, v81
    v_lshlrev_b32 v132, 16, v82
    v_and_b32 v133, 0xffff0000, v82
    v_lshlrev_b32 v134, 16, v83
    v_and_b32 v135, 0xffff0000, v83
    v_mul_f32 v104, s54, v128
    v_mul_f32 v105, s54, v129
    v_mul_f32 v106, s54, v130
    v_mul_f32 v107, s54, v131
    v_mul_f32 v108, s54, v132
    v_mul_f32 v109, s54, v133
    v_mul_f32 v110, s54, v134
    v_mul_f32 v111, s54, v135
    v_exp_f32 v104, v104
    v_exp_f32 v105, v105
    v_exp_f32 v106, v106
    v_exp_f32 v107, v107
    v_exp_f32 v108, v108
    v_exp_f32 v109, v109
    v_exp_f32 v110, v110
    v_exp_f32 v111, v111
    v_add_f32 v104, 1.0, v104
    v_add_f32 v105, 1.0, v105
    v_add_f32 v106, 1.0, v106
    v_add_f32 v107, 1.0, v107
    v_add_f32 v108, 1.0, v108
    v_add_f32 v109, 1.0, v109
    v_add_f32 v110, 1.0, v110
    v_add_f32 v111, 1.0, v111
    v_rcp_f32 v104, v104
    v_rcp_f32 v105, v105
    v_rcp_f32 v106, v106
    v_rcp_f32 v107, v107
    v_rcp_f32 v108, v108
    v_rcp_f32 v109, v109
    v_rcp_f32 v110, v110
    v_rcp_f32 v111, v111
    v_mul_f32 v128, v128, v104
    v_mul_f32 v129, v129, v105
    v_mul_f32 v130, v130, v106
    v_mul_f32 v131, v131, v107
    v_mul_f32 v132, v132, v108
    v_mul_f32 v133, v133, v109
    v_mul_f32 v134, v134, v110
    v_mul_f32 v135, v135, v111
    v_cvt_pk_bf16_f32 v80, v128, v129
    v_cvt_pk_bf16_f32 v81, v130, v131
    v_cvt_pk_bf16_f32 v82, v132, v133
    v_cvt_pk_bf16_f32 v83, v134, v135
    buffer_store_dwordx4 v[80:83], v1, s[4:7], s30 offen sc1
    v_cvt_pk_bf16_f32 v84, v136, v137
    v_cvt_pk_bf16_f32 v85, v138, v139
    v_cvt_pk_bf16_f32 v86, v140, v141
    v_cvt_pk_bf16_f32 v87, v142, v143
    v_lshlrev_b32 v136, 16, v84
    v_and_b32 v137, 0xffff0000, v84
    v_lshlrev_b32 v138, 16, v85
    v_and_b32 v139, 0xffff0000, v85
    v_lshlrev_b32 v140, 16, v86
    v_and_b32 v141, 0xffff0000, v86
    v_lshlrev_b32 v142, 16, v87
    v_and_b32 v143, 0xffff0000, v87
    v_mul_f32 v96, s54, v136
    v_mul_f32 v97, s54, v137
    v_mul_f32 v98, s54, v138
    v_mul_f32 v99, s54, v139
    v_mul_f32 v100, s54, v140
    v_mul_f32 v101, s54, v141
    v_mul_f32 v102, s54, v142
    v_mul_f32 v103, s54, v143
    v_exp_f32 v96, v96
    v_exp_f32 v97, v97
    v_exp_f32 v98, v98
    v_exp_f32 v99, v99
    v_exp_f32 v100, v100
    v_exp_f32 v101, v101
    v_exp_f32 v102, v102
    v_exp_f32 v103, v103
    v_add_f32 v96, 1.0, v96
    v_add_f32 v97, 1.0, v97
    v_add_f32 v98, 1.0, v98
    v_add_f32 v99, 1.0, v99
    v_add_f32 v100, 1.0, v100
    v_add_f32 v101, 1.0, v101
    v_add_f32 v102, 1.0, v102
    v_add_f32 v103, 1.0, v103
    v_rcp_f32 v96, v96
    v_rcp_f32 v97, v97
    v_rcp_f32 v98, v98
    v_rcp_f32 v99, v99
    v_rcp_f32 v100, v100
    v_rcp_f32 v101, v101
    v_rcp_f32 v102, v102
    v_rcp_f32 v103, v103
    v_mul_f32 v136, v136, v96
    v_mul_f32 v137, v137, v97
    v_mul_f32 v138, v138, v98
    v_mul_f32 v139, v139, v99
    v_mul_f32 v140, v140, v100
    v_mul_f32 v141, v141, v101
    v_mul_f32 v142, v142, v102
    v_mul_f32 v143, v143, v103
    v_cvt_pk_bf16_f32 v84, v136, v137
    v_cvt_pk_bf16_f32 v85, v138, v139
    v_cvt_pk_bf16_f32 v86, v140, v141
    v_cvt_pk_bf16_f32 v87, v142, v143
    buffer_store_dwordx4 v[84:87], v19, s[4:7], s30 offen sc1
    s_add_u32 s30, s30, s50
    v_cvt_pk_bf16_f32 v88, v144, v145
    v_cvt_pk_bf16_f32 v89, v146, v147
    v_cvt_pk_bf16_f32 v90, v148, v149
    v_cvt_pk_bf16_f32 v91, v150, v151
    v_lshlrev_b32 v144, 16, v88
    v_and_b32 v145, 0xffff0000, v88
    v_lshlrev_b32 v146, 16, v89
    v_and_b32 v147, 0xffff0000, v89
    v_lshlrev_b32 v148, 16, v90
    v_and_b32 v149, 0xffff0000, v90
    v_lshlrev_b32 v150, 16, v91
    v_and_b32 v151, 0xffff0000, v91
    v_mul_f32 v104, s54, v144
    v_mul_f32 v105, s54, v145
    v_mul_f32 v106, s54, v146
    v_mul_f32 v107, s54, v147
    v_mul_f32 v108, s54, v148
    v_mul_f32 v109, s54, v149
    v_mul_f32 v110, s54, v150
    v_mul_f32 v111, s54, v151
    v_exp_f32 v104, v104
    v_exp_f32 v105, v105
    v_exp_f32 v106, v106
    v_exp_f32 v107, v107
    v_exp_f32 v108, v108
    v_exp_f32 v109, v109
    v_exp_f32 v110, v110
    v_exp_f32 v111, v111
    v_add_f32 v104, 1.0, v104
    v_add_f32 v105, 1.0, v105
    v_add_f32 v106, 1.0, v106
    v_add_f32 v107, 1.0, v107
    v_add_f32 v108, 1.0, v108
    v_add_f32 v109, 1.0, v109
    v_add_f32 v110, 1.0, v110
    v_add_f32 v111, 1.0, v111
    v_rcp_f32 v104, v104
    v_rcp_f32 v105, v105
    v_rcp_f32 v106, v106
    v_rcp_f32 v107, v107
    v_rcp_f32 v108, v108
    v_rcp_f32 v109, v109
    v_rcp_f32 v110, v110
    v_rcp_f32 v111, v111
    v_mul_f32 v144, v144, v104
    v_mul_f32 v145, v145, v105
    v_mul_f32 v146, v146, v106
    v_mul_f32 v147, v147, v107
    v_mul_f32 v148, v148, v108
    v_mul_f32 v149, v149, v109
    v_mul_f32 v150, v150, v110
    v_mul_f32 v151, v151, v111
    v_cvt_pk_bf16_f32 v88, v144, v145
    v_cvt_pk_bf16_f32 v89, v146, v147
    v_cvt_pk_bf16_f32 v90, v148, v149
    v_cvt_pk_bf16_f32 v91, v150, v151
    buffer_store_dwordx4 v[88:91], v1, s[4:7], s30 offen sc1
    v_cvt_pk_bf16_f32 v92, v152, v153
    v_cvt_pk_bf16_f32 v93, v154, v155
    v_cvt_pk_bf16_f32 v94, v156, v157
    v_cvt_pk_bf16_f32 v95, v158, v159
    v_lshlrev_b32 v152, 16, v92
    v_and_b32 v153, 0xffff0000, v92
    v_lshlrev_b32 v154, 16, v93
    v_and_b32 v155, 0xffff0000, v93
    v_lshlrev_b32 v156, 16, v94
    v_and_b32 v157, 0xffff0000, v94
    v_lshlrev_b32 v158, 16, v95
    v_and_b32 v159, 0xffff0000, v95
    v_mul_f32 v96, s54, v152
    v_mul_f32 v97, s54, v153
    v_mul_f32 v98, s54, v154
    v_mul_f32 v99, s54, v155
    v_mul_f32 v100, s54, v156
    v_mul_f32 v101, s54, v157
    v_mul_f32 v102, s54, v158
    v_mul_f32 v103, s54, v159
    v_exp_f32 v96, v96
    v_exp_f32 v97, v97
    v_exp_f32 v98, v98
    v_exp_f32 v99, v99
    v_exp_f32 v100, v100
    v_exp_f32 v101, v101
    v_exp_f32 v102, v102
    v_exp_f32 v103, v103
    v_add_f32 v96, 1.0, v96
    v_add_f32 v97, 1.0, v97
    v_add_f32 v98, 1.0, v98
    v_add_f32 v99, 1.0, v99
    v_add_f32 v100, 1.0, v100
    v_add_f32 v101, 1.0, v101
    v_add_f32 v102, 1.0, v102
    v_add_f32 v103, 1.0, v103
    v_rcp_f32 v96, v96
    v_rcp_f32 v97, v97
    v_rcp_f32 v98, v98
    v_rcp_f32 v99, v99
    v_rcp_f32 v100, v100
    v_rcp_f32 v101, v101
    v_rcp_f32 v102, v102
    v_rcp_f32 v103, v103
    v_mul_f32 v152, v152, v96
    v_mul_f32 v153, v153, v97
    v_mul_f32 v154, v154, v98
    v_mul_f32 v155, v155, v99
    v_mul_f32 v156, v156, v100
    v_mul_f32 v157, v157, v101
    v_mul_f32 v158, v158, v102
    v_mul_f32 v159, v159, v103
    v_cvt_pk_bf16_f32 v92, v152, v153
    v_cvt_pk_bf16_f32 v93, v154, v155
    v_cvt_pk_bf16_f32 v94, v156, v157
    v_cvt_pk_bf16_f32 v95, v158, v159
    buffer_store_dwordx4 v[92:95], v19, s[4:7], s30 offen sc1
    s_add_u32 s30, s30, s50
    v_cvt_pk_bf16_f32 v80, v160, v161
    v_cvt_pk_bf16_f32 v81, v162, v163
    v_cvt_pk_bf16_f32 v82, v164, v165
    v_cvt_pk_bf16_f32 v83, v166, v167
    v_lshlrev_b32 v160, 16, v80
    v_and_b32 v161, 0xffff0000, v80
    v_lshlrev_b32 v162, 16, v81
    v_and_b32 v163, 0xffff0000, v81
    v_lshlrev_b32 v164, 16, v82
    v_and_b32 v165, 0xffff0000, v82
    v_lshlrev_b32 v166, 16, v83
    v_and_b32 v167, 0xffff0000, v83
    v_mul_f32 v104, s54, v160
    v_mul_f32 v105, s54, v161
    v_mul_f32 v106, s54, v162
    v_mul_f32 v107, s54, v163
    v_mul_f32 v108, s54, v164
    v_mul_f32 v109, s54, v165
    v_mul_f32 v110, s54, v166
    v_mul_f32 v111, s54, v167
    v_exp_f32 v104, v104
    v_exp_f32 v105, v105
    v_exp_f32 v106, v106
    v_exp_f32 v107, v107
    v_exp_f32 v108, v108
    v_exp_f32 v109, v109
    v_exp_f32 v110, v110
    v_exp_f32 v111, v111
    v_add_f32 v104, 1.0, v104
    v_add_f32 v105, 1.0, v105
    v_add_f32 v106, 1.0, v106
    v_add_f32 v107, 1.0, v107
    v_add_f32 v108, 1.0, v108
    v_add_f32 v109, 1.0, v109
    v_add_f32 v110, 1.0, v110
    v_add_f32 v111, 1.0, v111
    v_rcp_f32 v104, v104
    v_rcp_f32 v105, v105
    v_rcp_f32 v106, v106
    v_rcp_f32 v107, v107
    v_rcp_f32 v108, v108
    v_rcp_f32 v109, v109
    v_rcp_f32 v110, v110
    v_rcp_f32 v111, v111
    v_mul_f32 v160, v160, v104
    v_mul_f32 v161, v161, v105
    v_mul_f32 v162, v162, v106
    v_mul_f32 v163, v163, v107
    v_mul_f32 v164, v164, v108
    v_mul_f32 v165, v165, v109
    v_mul_f32 v166, v166, v110
    v_mul_f32 v167, v167, v111
    v_cvt_pk_bf16_f32 v80, v160, v161
    v_cvt_pk_bf16_f32 v81, v162, v163
    v_cvt_pk_bf16_f32 v82, v164, v165
    v_cvt_pk_bf16_f32 v83, v166, v167
    buffer_store_dwordx4 v[80:83], v1, s[4:7], s30 offen sc1
    v_cvt_pk_bf16_f32 v84, v168, v169
    v_cvt_pk_bf16_f32 v85, v170, v171
    v_cvt_pk_bf16_f32 v86, v172, v173
    v_cvt_pk_bf16_f32 v87, v174, v175
    v_lshlrev_b32 v168, 16, v84
    v_and_b32 v169, 0xffff0000, v84
    v_lshlrev_b32 v170, 16, v85
    v_and_b32 v171, 0xffff0000, v85
    v_lshlrev_b32 v172, 16, v86
    v_and_b32 v173, 0xffff0000, v86
    v_lshlrev_b32 v174, 16, v87
    v_and_b32 v175, 0xffff0000, v87
    v_mul_f32 v96, s54, v168
    v_mul_f32 v97, s54, v169
    v_mul_f32 v98, s54, v170
    v_mul_f32 v99, s54, v171
    v_mul_f32 v100, s54, v172
    v_mul_f32 v101, s54, v173
    v_mul_f32 v102, s54, v174
    v_mul_f32 v103, s54, v175
    v_exp_f32 v96, v96
    v_exp_f32 v97, v97
    v_exp_f32 v98, v98
    v_exp_f32 v99, v99
    v_exp_f32 v100, v100
    v_exp_f32 v101, v101
    v_exp_f32 v102, v102
    v_exp_f32 v103, v103
    v_add_f32 v96, 1.0, v96
    v_add_f32 v97, 1.0, v97
    v_add_f32 v98, 1.0, v98
    v_add_f32 v99, 1.0, v99
    v_add_f32 v100, 1.0, v100
    v_add_f32 v101, 1.0, v101
    v_add_f32 v102, 1.0, v102
    v_add_f32 v103, 1.0, v103
    v_rcp_f32 v96, v96
    v_rcp_f32 v97, v97
    v_rcp_f32 v98, v98
    v_rcp_f32 v99, v99
    v_rcp_f32 v100, v100
    v_rcp_f32 v101, v101
    v_rcp_f32 v102, v102
    v_rcp_f32 v103, v103
    v_mul_f32 v168, v168, v96
    v_mul_f32 v169, v169, v97
    v_mul_f32 v170, v170, v98
    v_mul_f32 v171, v171, v99
    v_mul_f32 v172, v172, v100
    v_mul_f32 v173, v173, v101
    v_mul_f32 v174, v174, v102
    v_mul_f32 v175, v175, v103
    v_cvt_pk_bf16_f32 v84, v168, v169
    v_cvt_pk_bf16_f32 v85, v170, v171
    v_cvt_pk_bf16_f32 v86, v172, v173
    v_cvt_pk_bf16_f32 v87, v174, v175
    buffer_store_dwordx4 v[84:87], v19, s[4:7], s30 offen sc1
    s_add_u32 s30, s30, s50
    v_cvt_pk_bf16_f32 v88, v176, v177
    v_cvt_pk_bf16_f32 v89, v178, v179
    v_cvt_pk_bf16_f32 v90, v180, v181
    v_cvt_pk_bf16_f32 v91, v182, v183
    v_lshlrev_b32 v176, 16, v88
    v_and_b32 v177, 0xffff0000, v88
    v_lshlrev_b32 v178, 16, v89
    v_and_b32 v179, 0xffff0000, v89
    v_lshlrev_b32 v180, 16, v90
    v_and_b32 v181, 0xffff0000, v90
    v_lshlrev_b32 v182, 16, v91
    v_and_b32 v183, 0xffff0000, v91
    v_mul_f32 v104, s54, v176
    v_mul_f32 v105, s54, v177
    v_mul_f32 v106, s54, v178
    v_mul_f32 v107, s54, v179
    v_mul_f32 v108, s54, v180
    v_mul_f32 v109, s54, v181
    v_mul_f32 v110, s54, v182
    v_mul_f32 v111, s54, v183
    v_exp_f32 v104, v104
    v_exp_f32 v105, v105
    v_exp_f32 v106, v106
    v_exp_f32 v107, v107
    v_exp_f32 v108, v108
    v_exp_f32 v109, v109
    v_exp_f32 v110, v110
    v_exp_f32 v111, v111
    v_add_f32 v104, 1.0, v104
    v_add_f32 v105, 1.0, v105
    v_add_f32 v106, 1.0, v106
    v_add_f32 v107, 1.0, v107
    v_add_f32 v108, 1.0, v108
    v_add_f32 v109, 1.0, v109
    v_add_f32 v110, 1.0, v110
    v_add_f32 v111, 1.0, v111
    v_rcp_f32 v104, v104
    v_rcp_f32 v105, v105
    v_rcp_f32 v106, v106
    v_rcp_f32 v107, v107
    v_rcp_f32 v108, v108
    v_rcp_f32 v109, v109
    v_rcp_f32 v110, v110
    v_rcp_f32 v111, v111
    v_mul_f32 v176, v176, v104
    v_mul_f32 v177, v177, v105
    v_mul_f32 v178, v178, v106
    v_mul_f32 v179, v179, v107
    v_mul_f32 v180, v180, v108
    v_mul_f32 v181, v181, v109
    v_mul_f32 v182, v182, v110
    v_mul_f32 v183, v183, v111
    v_cvt_pk_bf16_f32 v88, v176, v177
    v_cvt_pk_bf16_f32 v89, v178, v179
    v_cvt_pk_bf16_f32 v90, v180, v181
    v_cvt_pk_bf16_f32 v91, v182, v183
    buffer_store_dwordx4 v[88:91], v1, s[4:7], s30 offen sc1
    v_cvt_pk_bf16_f32 v92, v184, v185
    v_cvt_pk_bf16_f32 v93, v186, v187
    v_cvt_pk_bf16_f32 v94, v188, v189
    v_cvt_pk_bf16_f32 v95, v190, v191
    v_lshlrev_b32 v184, 16, v92
    v_and_b32 v185, 0xffff0000, v92
    v_lshlrev_b32 v186, 16, v93
    v_and_b32 v187, 0xffff0000, v93
    v_lshlrev_b32 v188, 16, v94
    v_and_b32 v189, 0xffff0000, v94
    v_lshlrev_b32 v190, 16, v95
    v_and_b32 v191, 0xffff0000, v95
    v_mul_f32 v96, s54, v184
    v_mul_f32 v97, s54, v185
    v_mul_f32 v98, s54, v186
    v_mul_f32 v99, s54, v187
    v_mul_f32 v100, s54, v188
    v_mul_f32 v101, s54, v189
    v_mul_f32 v102, s54, v190
    v_mul_f32 v103, s54, v191
    v_exp_f32 v96, v96
    v_exp_f32 v97, v97
    v_exp_f32 v98, v98
    v_exp_f32 v99, v99
    v_exp_f32 v100, v100
    v_exp_f32 v101, v101
    v_exp_f32 v102, v102
    v_exp_f32 v103, v103
    v_add_f32 v96, 1.0, v96
    v_add_f32 v97, 1.0, v97
    v_add_f32 v98, 1.0, v98
    v_add_f32 v99, 1.0, v99
    v_add_f32 v100, 1.0, v100
    v_add_f32 v101, 1.0, v101
    v_add_f32 v102, 1.0, v102
    v_add_f32 v103, 1.0, v103
    v_rcp_f32 v96, v96
    v_rcp_f32 v97, v97
    v_rcp_f32 v98, v98
    v_rcp_f32 v99, v99
    v_rcp_f32 v100, v100
    v_rcp_f32 v101, v101
    v_rcp_f32 v102, v102
    v_rcp_f32 v103, v103
    v_mul_f32 v184, v184, v96
    v_mul_f32 v185, v185, v97
    v_mul_f32 v186, v186, v98
    v_mul_f32 v187, v187, v99
    v_mul_f32 v188, v188, v100
    v_mul_f32 v189, v189, v101
    v_mul_f32 v190, v190, v102
    v_mul_f32 v191, v191, v103
    v_cvt_pk_bf16_f32 v92, v184, v185
    v_cvt_pk_bf16_f32 v93, v186, v187
    v_cvt_pk_bf16_f32 v94, v188, v189
    v_cvt_pk_bf16_f32 v95, v190, v191
    buffer_store_dwordx4 v[92:95], v19, s[4:7], s30 offen sc1
    s_add_u32 s30, s30, s50
    v_cvt_pk_bf16_f32 v80, v192, v193
    v_cvt_pk_bf16_f32 v81, v194, v195
    v_cvt_pk_bf16_f32 v82, v196, v197
    v_cvt_pk_bf16_f32 v83, v198, v199
    v_lshlrev_b32 v192, 16, v80
    v_and_b32 v193, 0xffff0000, v80
    v_lshlrev_b32 v194, 16, v81
    v_and_b32 v195, 0xffff0000, v81
    v_lshlrev_b32 v196, 16, v82
    v_and_b32 v197, 0xffff0000, v82
    v_lshlrev_b32 v198, 16, v83
    v_and_b32 v199, 0xffff0000, v83
    v_mul_f32 v104, s54, v192
    v_mul_f32 v105, s54, v193
    v_mul_f32 v106, s54, v194
    v_mul_f32 v107, s54, v195
    v_mul_f32 v108, s54, v196
    v_mul_f32 v109, s54, v197
    v_mul_f32 v110, s54, v198
    v_mul_f32 v111, s54, v199
    v_exp_f32 v104, v104
    v_exp_f32 v105, v105
    v_exp_f32 v106, v106
    v_exp_f32 v107, v107
    v_exp_f32 v108, v108
    v_exp_f32 v109, v109
    v_exp_f32 v110, v110
    v_exp_f32 v111, v111
    v_add_f32 v104, 1.0, v104
    v_add_f32 v105, 1.0, v105
    v_add_f32 v106, 1.0, v106
    v_add_f32 v107, 1.0, v107
    v_add_f32 v108, 1.0, v108
    v_add_f32 v109, 1.0, v109
    v_add_f32 v110, 1.0, v110
    v_add_f32 v111, 1.0, v111
    v_rcp_f32 v104, v104
    v_rcp_f32 v105, v105
    v_rcp_f32 v106, v106
    v_rcp_f32 v107, v107
    v_rcp_f32 v108, v108
    v_rcp_f32 v109, v109
    v_rcp_f32 v110, v110
    v_rcp_f32 v111, v111
    v_mul_f32 v192, v192, v104
    v_mul_f32 v193, v193, v105
    v_mul_f32 v194, v194, v106
    v_mul_f32 v195, v195, v107
    v_mul_f32 v196, v196, v108
    v_mul_f32 v197, v197, v109
    v_mul_f32 v198, v198, v110
    v_mul_f32 v199, v199, v111
    v_cvt_pk_bf16_f32 v80, v192, v193
    v_cvt_pk_bf16_f32 v81, v194, v195
    v_cvt_pk_bf16_f32 v82, v196, v197
    v_cvt_pk_bf16_f32 v83, v198, v199
    buffer_store_dwordx4 v[80:83], v1, s[4:7], s30 offen sc1
    v_cvt_pk_bf16_f32 v84, v200, v201
    v_cvt_pk_bf16_f32 v85, v202, v203
    v_cvt_pk_bf16_f32 v86, v204, v205
    v_cvt_pk_bf16_f32 v87, v206, v207
    v_lshlrev_b32 v200, 16, v84
    v_and_b32 v201, 0xffff0000, v84
    v_lshlrev_b32 v202, 16, v85
    v_and_b32 v203, 0xffff0000, v85
    v_lshlrev_b32 v204, 16, v86
    v_and_b32 v205, 0xffff0000, v86
    v_lshlrev_b32 v206, 16, v87
    v_and_b32 v207, 0xffff0000, v87
    v_mul_f32 v96, s54, v200
    v_mul_f32 v97, s54, v201
    v_mul_f32 v98, s54, v202
    v_mul_f32 v99, s54, v203
    v_mul_f32 v100, s54, v204
    v_mul_f32 v101, s54, v205
    v_mul_f32 v102, s54, v206
    v_mul_f32 v103, s54, v207
    v_exp_f32 v96, v96
    v_exp_f32 v97, v97
    v_exp_f32 v98, v98
    v_exp_f32 v99, v99
    v_exp_f32 v100, v100
    v_exp_f32 v101, v101
    v_exp_f32 v102, v102
    v_exp_f32 v103, v103
    v_add_f32 v96, 1.0, v96
    v_add_f32 v97, 1.0, v97
    v_add_f32 v98, 1.0, v98
    v_add_f32 v99, 1.0, v99
    v_add_f32 v100, 1.0, v100
    v_add_f32 v101, 1.0, v101
    v_add_f32 v102, 1.0, v102
    v_add_f32 v103, 1.0, v103
    v_rcp_f32 v96, v96
    v_rcp_f32 v97, v97
    v_rcp_f32 v98, v98
    v_rcp_f32 v99, v99
    v_rcp_f32 v100, v100
    v_rcp_f32 v101, v101
    v_rcp_f32 v102, v102
    v_rcp_f32 v103, v103
    v_mul_f32 v200, v200, v96
    v_mul_f32 v201, v201, v97
    v_mul_f32 v202, v202, v98
    v_mul_f32 v203, v203, v99
    v_mul_f32 v204, v204, v100
    v_mul_f32 v205, v205, v101
    v_mul_f32 v206, v206, v102
    v_mul_f32 v207, v207, v103
    v_cvt_pk_bf16_f32 v84, v200, v201
    v_cvt_pk_bf16_f32 v85, v202, v203
    v_cvt_pk_bf16_f32 v86, v204, v205
    v_cvt_pk_bf16_f32 v87, v206, v207
    buffer_store_dwordx4 v[84:87], v19, s[4:7], s30 offen sc1
    s_add_u32 s30, s30, s50
    v_cvt_pk_bf16_f32 v88, v208, v209
    v_cvt_pk_bf16_f32 v89, v210, v211
    v_cvt_pk_bf16_f32 v90, v212, v213
    v_cvt_pk_bf16_f32 v91, v214, v215
    v_lshlrev_b32 v208, 16, v88
    v_and_b32 v209, 0xffff0000, v88
    v_lshlrev_b32 v210, 16, v89
    v_and_b32 v211, 0xffff0000, v89
    v_lshlrev_b32 v212, 16, v90
    v_and_b32 v213, 0xffff0000, v90
    v_lshlrev_b32 v214, 16, v91
    v_and_b32 v215, 0xffff0000, v91
    v_mul_f32 v104, s54, v208
    v_mul_f32 v105, s54, v209
    v_mul_f32 v106, s54, v210
    v_mul_f32 v107, s54, v211
    v_mul_f32 v108, s54, v212
    v_mul_f32 v109, s54, v213
    v_mul_f32 v110, s54, v214
    v_mul_f32 v111, s54, v215
    v_exp_f32 v104, v104
    v_exp_f32 v105, v105
    v_exp_f32 v106, v106
    v_exp_f32 v107, v107
    v_exp_f32 v108, v108
    v_exp_f32 v109, v109
    v_exp_f32 v110, v110
    v_exp_f32 v111, v111
    v_add_f32 v104, 1.0, v104
    v_add_f32 v105, 1.0, v105
    v_add_f32 v106, 1.0, v106
    v_add_f32 v107, 1.0, v107
    v_add_f32 v108, 1.0, v108
    v_add_f32 v109, 1.0, v109
    v_add_f32 v110, 1.0, v110
    v_add_f32 v111, 1.0, v111
    v_rcp_f32 v104, v104
    v_rcp_f32 v105, v105
    v_rcp_f32 v106, v106
    v_rcp_f32 v107, v107
    v_rcp_f32 v108, v108
    v_rcp_f32 v109, v109
    v_rcp_f32 v110, v110
    v_rcp_f32 v111, v111
    v_mul_f32 v208, v208, v104
    v_mul_f32 v209, v209, v105
    v_mul_f32 v210, v210, v106
    v_mul_f32 v211, v211, v107
    v_mul_f32 v212, v212, v108
    v_mul_f32 v213, v213, v109
    v_mul_f32 v214, v214, v110
    v_mul_f32 v215, v215, v111
    v_cvt_pk_bf16_f32 v88, v208, v209
    v_cvt_pk_bf16_f32 v89, v210, v211
    v_cvt_pk_bf16_f32 v90, v212, v213
    v_cvt_pk_bf16_f32 v91, v214, v215
    buffer_store_dwordx4 v[88:91], v1, s[4:7], s30 offen sc1
    v_cvt_pk_bf16_f32 v92, v216, v217
    v_cvt_pk_bf16_f32 v93, v218, v219
    v_cvt_pk_bf16_f32 v94, v220, v221
    v_cvt_pk_bf16_f32 v95, v222, v223
    v_lshlrev_b32 v216, 16, v92
    v_and_b32 v217, 0xffff0000, v92
    v_lshlrev_b32 v218, 16, v93
    v_and_b32 v219, 0xffff0000, v93
    v_lshlrev_b32 v220, 16, v94
    v_and_b32 v221, 0xffff0000, v94
    v_lshlrev_b32 v222, 16, v95
    v_and_b32 v223, 0xffff0000, v95
    v_mul_f32 v96, s54, v216
    v_mul_f32 v97, s54, v217
    v_mul_f32 v98, s54, v218
    v_mul_f32 v99, s54, v219
    v_mul_f32 v100, s54, v220
    v_mul_f32 v101, s54, v221
    v_mul_f32 v102, s54, v222
    v_mul_f32 v103, s54, v223
    v_exp_f32 v96, v96
    v_exp_f32 v97, v97
    v_exp_f32 v98, v98
    v_exp_f32 v99, v99
    v_exp_f32 v100, v100
    v_exp_f32 v101, v101
    v_exp_f32 v102, v102
    v_exp_f32 v103, v103
    v_add_f32 v96, 1.0, v96
    v_add_f32 v97, 1.0, v97
    v_add_f32 v98, 1.0, v98
    v_add_f32 v99, 1.0, v99
    v_add_f32 v100, 1.0, v100
    v_add_f32 v101, 1.0, v101
    v_add_f32 v102, 1.0, v102
    v_add_f32 v103, 1.0, v103
    v_rcp_f32 v96, v96
    v_rcp_f32 v97, v97
    v_rcp_f32 v98, v98
    v_rcp_f32 v99, v99
    v_rcp_f32 v100, v100
    v_rcp_f32 v101, v101
    v_rcp_f32 v102, v102
    v_rcp_f32 v103, v103
    v_mul_f32 v216, v216, v96
    v_mul_f32 v217, v217, v97
    v_mul_f32 v218, v218, v98
    v_mul_f32 v219, v219, v99
    v_mul_f32 v220, v220, v100
    v_mul_f32 v221, v221, v101
    v_mul_f32 v222, v222, v102
    v_mul_f32 v223, v223, v103
    v_cvt_pk_bf16_f32 v92, v216, v217
    v_cvt_pk_bf16_f32 v93, v218, v219
    v_cvt_pk_bf16_f32 v94, v220, v221
    v_cvt_pk_bf16_f32 v95, v222, v223
    buffer_store_dwordx4 v[92:95], v19, s[4:7], s30 offen sc1
    s_add_u32 s30, s30, s50
    v_cvt_pk_bf16_f32 v80, v224, v225
    v_cvt_pk_bf16_f32 v81, v226, v227
    v_cvt_pk_bf16_f32 v82, v228, v229
    v_cvt_pk_bf16_f32 v83, v230, v231
    v_lshlrev_b32 v224, 16, v80
    v_and_b32 v225, 0xffff0000, v80
    v_lshlrev_b32 v226, 16, v81
    v_and_b32 v227, 0xffff0000, v81
    v_lshlrev_b32 v228, 16, v82
    v_and_b32 v229, 0xffff0000, v82
    v_lshlrev_b32 v230, 16, v83
    v_and_b32 v231, 0xffff0000, v83
    v_mul_f32 v104, s54, v224
    v_mul_f32 v105, s54, v225
    v_mul_f32 v106, s54, v226
    v_mul_f32 v107, s54, v227
    v_mul_f32 v108, s54, v228
    v_mul_f32 v109, s54, v229
    v_mul_f32 v110, s54, v230
    v_mul_f32 v111, s54, v231
    v_exp_f32 v104, v104
    v_exp_f32 v105, v105
    v_exp_f32 v106, v106
    v_exp_f32 v107, v107
    v_exp_f32 v108, v108
    v_exp_f32 v109, v109
    v_exp_f32 v110, v110
    v_exp_f32 v111, v111
    v_add_f32 v104, 1.0, v104
    v_add_f32 v105, 1.0, v105
    v_add_f32 v106, 1.0, v106
    v_add_f32 v107, 1.0, v107
    v_add_f32 v108, 1.0, v108
    v_add_f32 v109, 1.0, v109
    v_add_f32 v110, 1.0, v110
    v_add_f32 v111, 1.0, v111
    v_rcp_f32 v104, v104
    v_rcp_f32 v105, v105
    v_rcp_f32 v106, v106
    v_rcp_f32 v107, v107
    v_rcp_f32 v108, v108
    v_rcp_f32 v109, v109
    v_rcp_f32 v110, v110
    v_rcp_f32 v111, v111
    v_mul_f32 v224, v224, v104
    v_mul_f32 v225, v225, v105
    v_mul_f32 v226, v226, v106
    v_mul_f32 v227, v227, v107
    v_mul_f32 v228, v228, v108
    v_mul_f32 v229, v229, v109
    v_mul_f32 v230, v230, v110
    v_mul_f32 v231, v231, v111
    v_cvt_pk_bf16_f32 v80, v224, v225
    v_cvt_pk_bf16_f32 v81, v226, v227
    v_cvt_pk_bf16_f32 v82, v228, v229
    v_cvt_pk_bf16_f32 v83, v230, v231
    buffer_store_dwordx4 v[80:83], v1, s[4:7], s30 offen sc1
    v_cvt_pk_bf16_f32 v84, v232, v233
    v_cvt_pk_bf16_f32 v85, v234, v235
    v_cvt_pk_bf16_f32 v86, v236, v237
    v_cvt_pk_bf16_f32 v87, v238, v239
    v_lshlrev_b32 v232, 16, v84
    v_and_b32 v233, 0xffff0000, v84
    v_lshlrev_b32 v234, 16, v85
    v_and_b32 v235, 0xffff0000, v85
    v_lshlrev_b32 v236, 16, v86
    v_and_b32 v237, 0xffff0000, v86
    v_lshlrev_b32 v238, 16, v87
    v_and_b32 v239, 0xffff0000, v87
    v_mul_f32 v96, s54, v232
    v_mul_f32 v97, s54, v233
    v_mul_f32 v98, s54, v234
    v_mul_f32 v99, s54, v235
    v_mul_f32 v100, s54, v236
    v_mul_f32 v101, s54, v237
    v_mul_f32 v102, s54, v238
    v_mul_f32 v103, s54, v239
    v_exp_f32 v96, v96
    v_exp_f32 v97, v97
    v_exp_f32 v98, v98
    v_exp_f32 v99, v99
    v_exp_f32 v100, v100
    v_exp_f32 v101, v101
    v_exp_f32 v102, v102
    v_exp_f32 v103, v103
    v_add_f32 v96, 1.0, v96
    v_add_f32 v97, 1.0, v97
    v_add_f32 v98, 1.0, v98
    v_add_f32 v99, 1.0, v99
    v_add_f32 v100, 1.0, v100
    v_add_f32 v101, 1.0, v101
    v_add_f32 v102, 1.0, v102
    v_add_f32 v103, 1.0, v103
    v_rcp_f32 v96, v96
    v_rcp_f32 v97, v97
    v_rcp_f32 v98, v98
    v_rcp_f32 v99, v99
    v_rcp_f32 v100, v100
    v_rcp_f32 v101, v101
    v_rcp_f32 v102, v102
    v_rcp_f32 v103, v103
    v_mul_f32 v232, v232, v96
    v_mul_f32 v233, v233, v97
    v_mul_f32 v234, v234, v98
    v_mul_f32 v235, v235, v99
    v_mul_f32 v236, v236, v100
    v_mul_f32 v237, v237, v101
    v_mul_f32 v238, v238, v102
    v_mul_f32 v239, v239, v103
    v_cvt_pk_bf16_f32 v84, v232, v233
    v_cvt_pk_bf16_f32 v85, v234, v235
    v_cvt_pk_bf16_f32 v86, v236, v237
    v_cvt_pk_bf16_f32 v87, v238, v239
    buffer_store_dwordx4 v[84:87], v19, s[4:7], s30 offen sc1
    s_add_u32 s30, s30, s50
    v_cvt_pk_bf16_f32 v88, v240, v241
    v_cvt_pk_bf16_f32 v89, v242, v243
    v_cvt_pk_bf16_f32 v90, v244, v245
    v_cvt_pk_bf16_f32 v91, v246, v247
    v_lshlrev_b32 v240, 16, v88
    v_and_b32 v241, 0xffff0000, v88
    v_lshlrev_b32 v242, 16, v89
    v_and_b32 v243, 0xffff0000, v89
    v_lshlrev_b32 v244, 16, v90
    v_and_b32 v245, 0xffff0000, v90
    v_lshlrev_b32 v246, 16, v91
    v_and_b32 v247, 0xffff0000, v91
    v_mul_f32 v104, s54, v240
    v_mul_f32 v105, s54, v241
    v_mul_f32 v106, s54, v242
    v_mul_f32 v107, s54, v243
    v_mul_f32 v108, s54, v244
    v_mul_f32 v109, s54, v245
    v_mul_f32 v110, s54, v246
    v_mul_f32 v111, s54, v247
    v_exp_f32 v104, v104
    v_exp_f32 v105, v105
    v_exp_f32 v106, v106
    v_exp_f32 v107, v107
    v_exp_f32 v108, v108
    v_exp_f32 v109, v109
    v_exp_f32 v110, v110
    v_exp_f32 v111, v111
    v_add_f32 v104, 1.0, v104
    v_add_f32 v105, 1.0, v105
    v_add_f32 v106, 1.0, v106
    v_add_f32 v107, 1.0, v107
    v_add_f32 v108, 1.0, v108
    v_add_f32 v109, 1.0, v109
    v_add_f32 v110, 1.0, v110
    v_add_f32 v111, 1.0, v111
    v_rcp_f32 v104, v104
    v_rcp_f32 v105, v105
    v_rcp_f32 v106, v106
    v_rcp_f32 v107, v107
    v_rcp_f32 v108, v108
    v_rcp_f32 v109, v109
    v_rcp_f32 v110, v110
    v_rcp_f32 v111, v111
    v_mul_f32 v240, v240, v104
    v_mul_f32 v241, v241, v105
    v_mul_f32 v242, v242, v106
    v_mul_f32 v243, v243, v107
    v_mul_f32 v244, v244, v108
    v_mul_f32 v245, v245, v109
    v_mul_f32 v246, v246, v110
    v_mul_f32 v247, v247, v111
    v_cvt_pk_bf16_f32 v88, v240, v241
    v_cvt_pk_bf16_f32 v89, v242, v243
    v_cvt_pk_bf16_f32 v90, v244, v245
    v_cvt_pk_bf16_f32 v91, v246, v247
    buffer_store_dwordx4 v[88:91], v1, s[4:7], s30 offen sc1
    v_cvt_pk_bf16_f32 v92, v248, v249
    v_cvt_pk_bf16_f32 v93, v250, v251
    v_cvt_pk_bf16_f32 v94, v252, v253
    v_cvt_pk_bf16_f32 v95, v254, v255
    v_lshlrev_b32 v248, 16, v92
    v_and_b32 v249, 0xffff0000, v92
    v_lshlrev_b32 v250, 16, v93
    v_and_b32 v251, 0xffff0000, v93
    v_lshlrev_b32 v252, 16, v94
    v_and_b32 v253, 0xffff0000, v94
    v_lshlrev_b32 v254, 16, v95
    v_and_b32 v255, 0xffff0000, v95
    v_mul_f32 v96, s54, v248
    v_mul_f32 v97, s54, v249
    v_mul_f32 v98, s54, v250
    v_mul_f32 v99, s54, v251
    v_mul_f32 v100, s54, v252
    v_mul_f32 v101, s54, v253
    v_mul_f32 v102, s54, v254
    v_mul_f32 v103, s54, v255
    v_exp_f32 v96, v96
    v_exp_f32 v97, v97
    v_exp_f32 v98, v98
    v_exp_f32 v99, v99
    v_exp_f32 v100, v100
    v_exp_f32 v101, v101
    v_exp_f32 v102, v102
    v_exp_f32 v103, v103
    v_add_f32 v96, 1.0, v96
    v_add_f32 v97, 1.0, v97
    v_add_f32 v98, 1.0, v98
    v_add_f32 v99, 1.0, v99
    v_add_f32 v100, 1.0, v100
    v_add_f32 v101, 1.0, v101
    v_add_f32 v102, 1.0, v102
    v_add_f32 v103, 1.0, v103
    v_rcp_f32 v96, v96
    v_rcp_f32 v97, v97
    v_rcp_f32 v98, v98
    v_rcp_f32 v99, v99
    v_rcp_f32 v100, v100
    v_rcp_f32 v101, v101
    v_rcp_f32 v102, v102
    v_rcp_f32 v103, v103
    v_mul_f32 v248, v248, v96
    v_mul_f32 v249, v249, v97
    v_mul_f32 v250, v250, v98
    v_mul_f32 v251, v251, v99
    v_mul_f32 v252, v252, v100
    v_mul_f32 v253, v253, v101
    v_mul_f32 v254, v254, v102
    v_mul_f32 v255, v255, v103
    v_cvt_pk_bf16_f32 v92, v248, v249
    v_cvt_pk_bf16_f32 v93, v250, v251
    v_cvt_pk_bf16_f32 v94, v252, v253
    v_cvt_pk_bf16_f32 v95, v254, v255
    buffer_store_dwordx4 v[92:95], v19, s[4:7], s30 offen sc1
    s_waitcnt lgkmcnt(0)
    v_or3_b32 v24, v24, v25, v26
    v_or3_b32 v28, v28, v29, v30
    v_or3_b32 v24, v24, v27, v31
    v_or_b32 v24, v24, v28
    s_mov_b32 s28, s51
    s_mov_b32 s57, s53
    v_readfirstlane_b32 s30, v24
    s_cmp_lg_u32 s30, 0
    s_cbranch_scc1 w_drain
    s_mov_b32 s48, s32
    s_cmp_ge_u32 s32, 4
    s_cselect_b32 s30, 2, 3
    s_lshl_b32 s30, s26, s30
    s_mul_i32 s30, s30, s43
    s_add_u32 s49, s42, s30
    s_mov_b32 s50, s43
    s_mov_b32 s51, s46
    s_mov_b32 s23, s41
    s_mov_b32 s53, s47
    s_nop 0
    s_load_dwordx16 s[32:47], s[24:25], 0
    s_add_u32 s24, s24, 64
    s_addc_u32 s25, s25, 0
    s_branch w_first16
w_firstH:
    s_waitcnt vmcnt(8)
    s_barrier
    s_add_u32 m0, s21, 0
    s_nop 0
    buffer_load_dwordx4 v1, s[4:7], s16 offen sc1 lds
    s_add_u32 s16, s16, s62
    s_add_u32 m0, s21, 1024
    s_nop 0
    buffer_load_dwordx4 v1, s[4:7], s17 offen sc1 lds
    s_add_u32 s17, s17, s62
    s_add_u32 m0, s22, 0
    s_nop 0
    buffer_load_dwordx4 v2, s[8:11], s18 offen lds
    s_add_u32 s18, s18, s20
    s_add_u32 m0, s22, 8192
    s_nop 0
    buffer_load_dwordx4 v2, s[12:15], s19 offen lds
    s_add_u32 s19, s19, s20
    v_mfma_f32_16x16x32_bf16 v[128:131], v[64:67], v[32:35], 0
    ds_read_b64_tr_b16 v[112:113], v8 offset:49152
    v_mfma_f32_16x16x32_bf16 v[132:135], v[68:71], v[32:35], 0
    ds_read_b64_tr_b16 v[114:115], v9 offset:49152
    v_mfma_f32_16x16x32_bf16 v[144:147], v[64:67], v[40:43], 0
    ds_read_b64_tr_b16 v[116:117], v10 offset:49152
    v_mfma_f32_16x16x32_bf16 v[148:151], v[68:71], v[40:43], 0
    ds_read_b64_tr_b16 v[118:119], v11 offset:49152
    v_mfma_f32_16x16x32_bf16 v[160:163], v[64:67], v[48:51], 0
    ds_read_b64_tr_b16 v[120:121], v8 offset:57344
    v_mfma_f32_16x16x32_bf16 v[164:167], v[68:71], v[48:51], 0
    ds_read_b64_tr_b16 v[122:123], v9 offset:57344
    v_mfma_f32_16x16x32_bf16 v[176:179], v[64:67], v[56:59], 0
    ds_read_b64_tr_b16 v[124:125], v10 offset:57344
    v_mfma_f32_16x16x32_bf16 v[180:183], v[68:71], v[56:59], 0
    ds_read_b64_tr_b16 v[126:127], v11 offset:57344
    v_mfma_f32_16x16x32_bf16 v[128:131], v[72:75], v[36:39], v[128:131]
    ds_read_b128 v[80:83], v5 offset:32768
    v_mfma_f32_16x16x32_bf16 v[132:135], v[76:79], v[36:39], v[132:135]
    ds_read_b128 v[84:87], v5 offset:33792
    v_mfma_f32_16x16x32_bf16 v[144:147], v[72:75], v[44:47], v[144:147]
    ds_read_b128 v[88:91], v5 offset:34816
    v_mfma_f32_16x16x32_bf16 v[148:151], v[76:79], v[44:47], v[148:151]
    ds_read_b128 v[92:95], v5 offset:35840
    v_mfma_f32_16x16x32_bf16 v[160:163], v[72:75], v[52:55], v[160:163]
    ds_read_b128 v[96:99], v5 offset:36864
    v_mfma_f32_16x16x32_bf16 v[164:167], v[76:79], v[52:55], v[164:167]
    ds_read_b128 v[100:103], v5 offset:37888
    v_mfma_f32_16x16x32_bf16 v[176:179], v[72:75], v[60:63], v[176:179]
    ds_read_b128 v[104:107], v5 offset:38912
    v_mfma_f32_16x16x32_bf16 v[180:183], v[76:79], v[60:63], v[180:183]
    ds_read_b128 v[108:111], v5 offset:39936
    s_waitcnt lgkmcnt(0)
    s_waitcnt vmcnt(8)
    s_barrier
    s_add_u32 m0, s21, 32768
    s_nop 0
    buffer_load_dwordx4 v1, s[4:7], s16 offen sc1 lds
    s_add_u32 s16, s16, s62
    s_add_u32 m0, s21, 33792
    s_nop 0
    buffer_load_dwordx4 v1, s[4:7], s17 offen sc1 lds
    s_add_u32 s17, s17, s62
    s_add_u32 m0, s22, 32768
    s_nop 0
    buffer_load_dwordx4 v2, s[8:11], s18 offen lds
    s_add_u32 s18, s18, s20
    s_add_u32 m0, s22, 40960
    s_nop 0
    buffer_load_dwordx4 v2, s[12:15], s19 offen lds
    s_add_u32 s19, s19, s20
    v_mfma_f32_16x16x32_bf16 v[128:131], v[112:115], v[80:83], v[128:131]
    ds_read_b64_tr_b16 v[64:65], v12 offset:16384
    v_mfma_f32_16x16x32_bf16 v[132:135], v[116:119], v[80:83], v[132:135]
    ds_read_b64_tr_b16 v[66:67], v13 offset:16384
    v_mfma_f32_16x16x32_bf16 v[144:147], v[112:115], v[88:91], v[144:147]
    ds_read_b64_tr_b16 v[68:69], v14 offset:16384
    v_mfma_f32_16x16x32_bf16 v[148:151], v[116:119], v[88:91], v[148:151]
    ds_read_b64_tr_b16 v[70:71], v15 offset:16384
    v_mfma_f32_16x16x32_bf16 v[160:163], v[112:115], v[96:99], v[160:163]
    ds_read_b64_tr_b16 v[72:73], v12 offset:24576
    v_mfma_f32_16x16x32_bf16 v[164:167], v[116:119], v[96:99], v[164:167]
    ds_read_b64_tr_b16 v[74:75], v13 offset:24576
    v_mfma_f32_16x16x32_bf16 v[176:179], v[112:115], v[104:107], v[176:179]
    ds_read_b64_tr_b16 v[76:77], v14 offset:24576
    v_mfma_f32_16x16x32_bf16 v[180:183], v[116:119], v[104:107], v[180:183]
    ds_read_b64_tr_b16 v[78:79], v15 offset:24576
    v_mfma_f32_16x16x32_bf16 v[128:131], v[120:123], v[84:87], v[128:131]
    ds_read_b128 v[32:35], v6 offset:0
    v_mfma_f32_16x16x32_bf16 v[132:135], v[124:127], v[84:87], v[132:135]
    ds_read_b128 v[36:39], v6 offset:1024
    v_mfma_f32_16x16x32_bf16 v[144:147], v[120:123], v[92:95], v[144:147]
    ds_read_b128 v[40:43], v6 offset:2048
    v_mfma_f32_16x16x32_bf16 v[148:151], v[124:127], v[92:95], v[148:151]
    ds_read_b128 v[44:47], v6 offset:3072
    v_mfma_f32_16x16x32_bf16 v[160:163], v[120:123], v[100:103], v[160:163]
    ds_read_b128 v[48:51], v6 offset:4096
    v_mfma_f32_16x16x32_bf16 v[164:167], v[124:127], v[100:103], v[164:167]
    ds_read_b128 v[52:55], v6 offset:5120
    v_mfma_f32_16x16x32_bf16 v[176:179], v[120:123], v[108:111], v[176:179]
    ds_read_b128 v[56:59], v6 offset:6144
    v_mfma_f32_16x16x32_bf16 v[180:183], v[124:127], v[108:111], v[180:183]
    ds_read_b128 v[60:63], v6 offset:7168
    s_waitcnt lgkmcnt(0)
    s_waitcnt vmcnt(8)
    s_barrier
    s_add_u32 m0, s21, 65536
    s_nop 0
    buffer_load_dwordx4 v1, s[4:7], s16 offen sc1 lds
    s_add_u32 s16, s16, s62
    s_add_u32 m0, s21, 66560
    s_nop 0
    buffer_load_dwordx4 v1, s[4:7], s17 offen sc1 lds
    s_add_u32 s17, s17, s62
    s_add_u32 m0, s22, 65536
    s_nop 0
    buffer_load_dwordx4 v2, s[8:11], s18 offen lds
    s_add_u32 s18, s18, s20
    s_add_u32 m0, s22, 73728
    s_nop 0
    buffer_load_dwordx4 v2, s[12:15], s19 offen lds
    s_add_u32 s19, s19, s20
    v_mfma_f32_16x16x32_bf16 v[128:131], v[64:67], v[32:35], v[128:131]
    ds_read_b64_tr_b16 v[112:113], v12 offset:49152
    v_mfma_f32_16x16x32_bf16 v[132:135], v[68:71], v[32:35], v[132:135]
    ds_read_b64_tr_b16 v[114:115], v13 offset:49152
    v_mfma_f32_16x16x32_bf16 v[144:147], v[64:67], v[40:43], v[144:147]
    ds_read_b64_tr_b16 v[116:117], v14 offset:49152
    v_mfma_f32_16x16x32_bf16 v[148:151], v[68:71], v[40:43], v[148:151]
    ds_read_b64_tr_b16 v[118:119], v15 offset:49152
    v_mfma_f32_16x16x32_bf16 v[160:163], v[64:67], v[48:51], v[160:163]
    ds_read_b64_tr_b16 v[120:121], v12 offset:57344
    v_mfma_f32_16x16x32_bf16 v[164:167], v[68:71], v[48:51], v[164:167]
    ds_read_b64_tr_b16 v[122:123], v13 offset:57344
    v_mfma_f32_16x16x32_bf16 v[176:179], v[64:67], v[56:59], v[176:179]
    ds_read_b64_tr_b16 v[124:125], v14 offset:57344
    v_mfma_f32_16x16x32_bf16 v[180:183], v[68:71], v[56:59], v[180:183]
    ds_read_b64_tr_b16 v[126:127], v15 offset:57344
    v_mfma_f32_16x16x32_bf16 v[128:131], v[72:75], v[36:39], v[128:131]
    ds_read_b128 v[80:83], v6 offset:32768
    v_mfma_f32_16x16x32_bf16 v[132:135], v[76:79], v[36:39], v[132:135]
    ds_read_b128 v[84:87], v6 offset:33792
    v_mfma_f32_16x16x32_bf16 v[144:147], v[72:75], v[44:47], v[144:147]
    ds_read_b128 v[88:91], v6 offset:34816
    v_mfma_f32_16x16x32_bf16 v[148:151], v[76:79], v[44:47], v[148:151]
    ds_read_b128 v[92:95], v6 offset:35840
    v_mfma_f32_16x16x32_bf16 v[160:163], v[72:75], v[52:55], v[160:163]
    ds_read_b128 v[96:99], v6 offset:36864
    v_mfma_f32_16x16x32_bf16 v[164:167], v[76:79], v[52:55], v[164:167]
    ds_read_b128 v[100:103], v6 offset:37888
    v_mfma_f32_16x16x32_bf16 v[176:179], v[72:75], v[60:63], v[176:179]
    ds_read_b128 v[104:107], v6 offset:38912
    v_mfma_f32_16x16x32_bf16 v[180:183], v[76:79], v[60:63], v[180:183]
    ds_read_b128 v[108:111], v6 offset:39936
    s_waitcnt lgkmcnt(0)
    s_waitcnt vmcnt(8)
    s_barrier
    s_add_u32 m0, s21, 98304
    s_nop 0
    buffer_load_dwordx4 v1, s[4:7], s16 offen sc1 lds
    s_add_u32 s16, s16, s62
    s_add_u32 m0, s21, 99328
    s_nop 0
    buffer_load_dwordx4 v1, s[4:7], s17 offen sc1 lds
    s_add_u32 s17, s17, s62
    s_add_u32 m0, s22, 98304
    s_nop 0
    buffer_load_dwordx4 v2, s[8:11], s18 offen lds
    s_add_u32 s18, s18, s20
    s_add_u32 m0, s22, 106496
    s_nop 0
    buffer_load_dwordx4 v2, s[12:15], s19 offen lds
    s_add_u32 s19, s19, s20
    v_mfma_f32_16x16x32_bf16 v[128:131], v[112:115], v[80:83], v[128:131]
    ds_read_b64_tr_b16 v[64:65], v8 offset:16384
    v_mfma_f32_16x16x32_bf16 v[132:135], v[116:119], v[80:83], v[132:135]
    ds_read_b64_tr_b16 v[66:67], v9 offset:16384
    v_mfma_f32_16x16x32_bf16 v[144:147], v[112:115], v[88:91], v[144:147]
    ds_read_b64_tr_b16 v[68:69], v10 offset:16384
    v_mfma_f32_16x16x32_bf16 v[148:151], v[116:119], v[88:91], v[148:151]
    ds_read_b64_tr_b16 v[70:71], v11 offset:16384
    v_mfma_f32_16x16x32_bf16 v[160:163], v[112:115], v[96:99], v[160:163]
    ds_read_b64_tr_b16 v[72:73], v8 offset:24576
    v_mfma_f32_16x16x32_bf16 v[164:167], v[116:119], v[96:99], v[164:167]
    ds_read_b64_tr_b16 v[74:75], v9 offset:24576
    v_mfma_f32_16x16x32_bf16 v[176:179], v[112:115], v[104:107], v[176:179]
    ds_read_b64_tr_b16 v[76:77], v10 offset:24576
    v_mfma_f32_16x16x32_bf16 v[180:183], v[116:119], v[104:107], v[180:183]
    ds_read_b64_tr_b16 v[78:79], v11 offset:24576
    v_mfma_f32_16x16x32_bf16 v[128:131], v[120:123], v[84:87], v[128:131]
    ds_read_b128 v[32:35], v5 offset:0
    v_mfma_f32_16x16x32_bf16 v[132:135], v[124:127], v[84:87], v[132:135]
    ds_read_b128 v[36:39], v5 offset:1024
    v_mfma_f32_16x16x32_bf16 v[144:147], v[120:123], v[92:95], v[144:147]
    ds_read_b128 v[40:43], v5 offset:2048
    v_mfma_f32_16x16x32_bf16 v[148:151], v[124:127], v[92:95], v[148:151]
    ds_read_b128 v[44:47], v5 offset:3072
    v_mfma_f32_16x16x32_bf16 v[160:163], v[120:123], v[100:103], v[160:163]
    ds_read_b128 v[48:51], v5 offset:4096
    v_mfma_f32_16x16x32_bf16 v[164:167], v[124:127], v[100:103], v[164:167]
    ds_read_b128 v[52:55], v5 offset:5120
    v_mfma_f32_16x16x32_bf16 v[176:179], v[120:123], v[108:111], v[176:179]
    ds_read_b128 v[56:59], v5 offset:6144
    v_mfma_f32_16x16x32_bf16 v[180:183], v[124:127], v[108:111], v[180:183]
    ds_read_b128 v[60:63], v5 offset:7168
    s_waitcnt lgkmcnt(0)
w_loop_chkH:
    s_sub_u32 s23, s23, 1
w_loopH:
    s_cmp_lg_u32 s23, 1
    s_cbranch_scc1 w_bodyH
    buffer_load_dword v22, off, s[64:67], 0 sc1
    v_readfirstlane_b32 s30, v16
    s_cmp_ge_u32 s30, s45
    s_cselect_b32 s30, 0, 1
    s_or_b32 s30, s30, s70
    s_cmp_ge_u32 s32, 4
    s_cselect_b32 s30, 1, s30
    s_cmp_eq_u32 s32, 0
    s_cselect_b32 s30, 1, s30
    v_mov_b32 v20, s30
    ds_write_b32 v7, v20
    s_cbranch_scc1 w_ndH
    s_cmp_ge_u32 s32, 4
    s_cbranch_scc1 w_ndH
    s_cmp_lg_u32 s70, 0
    s_cbranch_scc1 w_ndH
    s_load_dwordx2 s[8:9], s[0:1], s33
    s_load_dwordx2 s[12:13], s[0:1], s34
    s_mov_b32 s10, s38
    s_mov_b32 s14, s38
    s_cmp_ge_u32 s32, 4
    s_cselect_b32 s31, 0, 1
    s_lshl_b32 s30, s3, s31
    s_mul_i32 s30, s30, s40
    s_add_u32 s16, s39, s30
    s_cmp_eq_u32 s32, 4
    s_cselect_b32 s30, 1024, s40
    s_cselect_b32 s31, 6, 5
    s_lshl_b32 s62, 32, s31
    s_add_u32 s17, s16, s30
    s_lshl_b32 s30, s3, 2
    s_mul_i32 s30, s30, s35
    s_add_u32 s18, s36, s30
    s_add_u32 s19, s37, s30
    s_lshl_b32 s20, s35, s31
    v_mul_u32_u24 v2, s35, v4
    v_add_u32 v2, v2, v3
    s_waitcnt lgkmcnt(0)
w_bodyH:
    s_waitcnt vmcnt(8)
    s_barrier
    s_add_u32 m0, s21, 0
    s_nop 0
    buffer_load_dwordx4 v1, s[4:7], s16 offen sc1 lds
    s_add_u32 s16, s16, s62
    s_add_u32 m0, s21, 1024
    s_nop 0
    buffer_load_dwordx4 v1, s[4:7], s17 offen sc1 lds
    s_add_u32 s17, s17, s62
    s_add_u32 m0, s22, 0
    s_nop 0
    buffer_load_dwordx4 v2, s[8:11], s18 offen lds
    s_add_u32 s18, s18, s20
    s_add_u32 m0, s22, 8192
    s_nop 0
    buffer_load_dwordx4 v2, s[12:15], s19 offen lds
    s_add_u32 s19, s19, s20
    v_mfma_f32_16x16x32_bf16 v[128:131], v[64:67], v[32:35], v[128:131]
    ds_read_b64_tr_b16 v[112:113], v8 offset:49152
    v_mfma_f32_16x16x32_bf16 v[132:135], v[68:71], v[32:35], v[132:135]
    ds_read_b64_tr_b16 v[114:115], v9 offset:49152
    v_mfma_f32_16x16x32_bf16 v[144:147], v[64:67], v[40:43], v[144:147]
    ds_read_b64_tr_b16 v[116:117], v10 offset:49152
    v_mfma_f32_16x16x32_bf16 v[148:151], v[68:71], v[40:43], v[148:151]
    ds_read_b64_tr_b16 v[118:119], v11 offset:49152
    v_mfma_f32_16x16x32_bf16 v[160:163], v[64:67], v[48:51], v[160:163]
    ds_read_b64_tr_b16 v[120:121], v8 offset:57344
    v_mfma_f32_16x16x32_bf16 v[164:167], v[68:71], v[48:51], v[164:167]
    ds_read_b64_tr_b16 v[122:123], v9 offset:57344
    v_mfma_f32_16x16x32_bf16 v[176:179], v[64:67], v[56:59], v[176:179]
    ds_read_b64_tr_b16 v[124:125], v10 offset:57344
    v_mfma_f32_16x16x32_bf16 v[180:183], v[68:71], v[56:59], v[180:183]
    ds_read_b64_tr_b16 v[126:127], v11 offset:57344
    v_mfma_f32_16x16x32_bf16 v[128:131], v[72:75], v[36:39], v[128:131]
    ds_read_b128 v[80:83], v5 offset:32768
    v_mfma_f32_16x16x32_bf16 v[132:135], v[76:79], v[36:39], v[132:135]
    ds_read_b128 v[84:87], v5 offset:33792
    v_mfma_f32_16x16x32_bf16 v[144:147], v[72:75], v[44:47], v[144:147]
    ds_read_b128 v[88:91], v5 offset:34816
    v_mfma_f32_16x16x32_bf16 v[148:151], v[76:79], v[44:47], v[148:151]
    ds_read_b128 v[92:95], v5 offset:35840
    v_mfma_f32_16x16x32_bf16 v[160:163], v[72:75], v[52:55], v[160:163]
    ds_read_b128 v[96:99], v5 offset:36864
    v_mfma_f32_16x16x32_bf16 v[164:167], v[76:79], v[52:55], v[164:167]
    ds_read_b128 v[100:103], v5 offset:37888
    v_mfma_f32_16x16x32_bf16 v[176:179], v[72:75], v[60:63], v[176:179]
    ds_read_b128 v[104:107], v5 offset:38912
    v_mfma_f32_16x16x32_bf16 v[180:183], v[76:79], v[60:63], v[180:183]
    ds_read_b128 v[108:111], v5 offset:39936
    buffer_load_dword v16, v17, s[4:7], s44 offen sc1
    s_waitcnt lgkmcnt(0)
    s_waitcnt vmcnt(8)
    s_barrier
    s_add_u32 m0, s21, 32768
    s_nop 0
    buffer_load_dwordx4 v1, s[4:7], s16 offen sc1 lds
    s_add_u32 s16, s16, s62
    s_add_u32 m0, s21, 33792
    s_nop 0
    buffer_load_dwordx4 v1, s[4:7], s17 offen sc1 lds
    s_add_u32 s17, s17, s62
    s_add_u32 m0, s22, 32768
    s_nop 0
    buffer_load_dwordx4 v2, s[8:11], s18 offen lds
    s_add_u32 s18, s18, s20
    s_add_u32 m0, s22, 40960
    s_nop 0
    buffer_load_dwordx4 v2, s[12:15], s19 offen lds
    s_add_u32 s19, s19, s20
    v_mfma_f32_16x16x32_bf16 v[128:131], v[112:115], v[80:83], v[128:131]
    ds_read_b64_tr_b16 v[64:65], v12 offset:16384
    v_mfma_f32_16x16x32_bf16 v[132:135], v[116:119], v[80:83], v[132:135]
    ds_read_b64_tr_b16 v[66:67], v13 offset:16384
    v_mfma_f32_16x16x32_bf16 v[144:147], v[112:115], v[88:91], v[144:147]
    ds_read_b64_tr_b16 v[68:69], v14 offset:16384
    v_mfma_f32_16x16x32_bf16 v[148:151], v[116:119], v[88:91], v[148:151]
    ds_read_b64_tr_b16 v[70:71], v15 offset:16384
    v_mfma_f32_16x16x32_bf16 v[160:163], v[112:115], v[96:99], v[160:163]
    ds_read_b64_tr_b16 v[72:73], v12 offset:24576
    v_mfma_f32_16x16x32_bf16 v[164:167], v[116:119], v[96:99], v[164:167]
    ds_read_b64_tr_b16 v[74:75], v13 offset:24576
    v_mfma_f32_16x16x32_bf16 v[176:179], v[112:115], v[104:107], v[176:179]
    ds_read_b64_tr_b16 v[76:77], v14 offset:24576
    v_mfma_f32_16x16x32_bf16 v[180:183], v[116:119], v[104:107], v[180:183]
    ds_read_b64_tr_b16 v[78:79], v15 offset:24576
    v_mfma_f32_16x16x32_bf16 v[128:131], v[120:123], v[84:87], v[128:131]
    ds_read_b128 v[32:35], v6 offset:0
    v_mfma_f32_16x16x32_bf16 v[132:135], v[124:127], v[84:87], v[132:135]
    ds_read_b128 v[36:39], v6 offset:1024
    v_mfma_f32_16x16x32_bf16 v[144:147], v[120:123], v[92:95], v[144:147]
    ds_read_b128 v[40:43], v6 offset:2048
    v_mfma_f32_16x16x32_bf16 v[148:151], v[124:127], v[92:95], v[148:151]
    ds_read_b128 v[44:47], v6 offset:3072
    v_mfma_f32_16x16x32_bf16 v[160:163], v[120:123], v[100:103], v[160:163]
    ds_read_b128 v[48:51], v6 offset:4096
    v_mfma_f32_16x16x32_bf16 v[164:167], v[124:127], v[100:103], v[164:167]
    ds_read_b128 v[52:55], v6 offset:5120
    v_mfma_f32_16x16x32_bf16 v[176:179], v[120:123], v[108:111], v[176:179]
    ds_read_b128 v[56:59], v6 offset:6144
    v_mfma_f32_16x16x32_bf16 v[180:183], v[124:127], v[108:111], v[180:183]
    ds_read_b128 v[60:63], v6 offset:7168
    s_waitcnt lgkmcnt(0)
    s_waitcnt vmcnt(8)
    s_barrier
    s_add_u32 m0, s21, 65536
    s_nop 0
    buffer_load_dwordx4 v1, s[4:7], s16 offen sc1 lds
    s_add_u32 s16, s16, s62
    s_add_u32 m0, s21, 66560
    s_nop 0
    buffer_load_dwordx4 v1, s[4:7], s17 offen sc1 lds
    s_add_u32 s17, s17, s62
    s_add_u32 m0, s22, 65536
    s_nop 0
    buffer_load_dwordx4 v2, s[8:11], s18 offen lds
    s_add_u32 s18, s18, s20
    s_add_u32 m0, s22, 73728
    s_nop 0
    buffer_load_dwordx4 v2, s[12:15], s19 offen lds
    s_add_u32 s19, s19, s20
    v_mfma_f32_16x16x32_bf16 v[128:131], v[64:67], v[32:35], v[128:131]
    ds_read_b64_tr_b16 v[112:113], v12 offset:49152
    v_mfma_f32_16x16x32_bf16 v[132:135], v[68:71], v[32:35], v[132:135]
    ds_read_b64_tr_b16 v[114:115], v13 offset:49152
    v_mfma_f32_16x16x32_bf16 v[144:147], v[64:67], v[40:43], v[144:147]
    ds_read_b64_tr_b16 v[116:117], v14 offset:49152
    v_mfma_f32_16x16x32_bf16 v[148:151], v[68:71], v[40:43], v[148:151]
    ds_read_b64_tr_b16 v[118:119], v15 offset:49152
    v_mfma_f32_16x16x32_bf16 v[160:163], v[64:67], v[48:51], v[160:163]
    ds_read_b64_tr_b16 v[120:121], v12 offset:57344
    v_mfma_f32_16x16x32_bf16 v[164:167], v[68:71], v[48:51], v[164:167]
    ds_read_b64_tr_b16 v[122:123], v13 offset:57344
    v_mfma_f32_16x16x32_bf16 v[176:179], v[64:67], v[56:59], v[176:179]
    ds_read_b64_tr_b16 v[124:125], v14 offset:57344
    v_mfma_f32_16x16x32_bf16 v[180:183], v[68:71], v[56:59], v[180:183]
    ds_read_b64_tr_b16 v[126:127], v15 offset:57344
    v_mfma_f32_16x16x32_bf16 v[128:131], v[72:75], v[36:39], v[128:131]
    ds_read_b128 v[80:83], v6 offset:32768
    v_mfma_f32_16x16x32_bf16 v[132:135], v[76:79], v[36:39], v[132:135]
    ds_read_b128 v[84:87], v6 offset:33792
    v_mfma_f32_16x16x32_bf16 v[144:147], v[72:75], v[44:47], v[144:147]
    ds_read_b128 v[88:91], v6 offset:34816
    v_mfma_f32_16x16x32_bf16 v[148:151], v[76:79], v[44:47], v[148:151]
    ds_read_b128 v[92:95], v6 offset:35840
    v_mfma_f32_16x16x32_bf16 v[160:163], v[72:75], v[52:55], v[160:163]
    ds_read_b128 v[96:99], v6 offset:36864
    v_mfma_f32_16x16x32_bf16 v[164:167], v[76:79], v[52:55], v[164:167]
    ds_read_b128 v[100:103], v6 offset:37888
    v_mfma_f32_16x16x32_bf16 v[176:179], v[72:75], v[60:63], v[176:179]
    ds_read_b128 v[104:107], v6 offset:38912
    v_mfma_f32_16x16x32_bf16 v[180:183], v[76:79], v[60:63], v[180:183]
    ds_read_b128 v[108:111], v6 offset:39936
    s_waitcnt lgkmcnt(0)
    s_waitcnt vmcnt(8)
    s_barrier
    s_add_u32 m0, s21, 98304
    s_nop 0
    buffer_load_dwordx4 v1, s[4:7], s16 offen sc1 lds
    s_add_u32 s16, s16, s62
    s_add_u32 m0, s21, 99328
    s_nop 0
    buffer_load_dwordx4 v1, s[4:7], s17 offen sc1 lds
    s_add_u32 s17, s17, s62
    s_add_u32 m0, s22, 98304
    s_nop 0
    buffer_load_dwordx4 v2, s[8:11], s18 offen lds
    s_add_u32 s18, s18, s20
    s_add_u32 m0, s22, 106496
    s_nop 0
    buffer_load_dwordx4 v2, s[12:15], s19 offen lds
    s_add_u32 s19, s19, s20
    v_mfma_f32_16x16x32_bf16 v[128:131], v[112:115], v[80:83], v[128:131]
    ds_read_b64_tr_b16 v[64:65], v8 offset:16384
    v_mfma_f32_16x16x32_bf16 v[132:135], v[116:119], v[80:83], v[132:135]
    ds_read_b64_tr_b16 v[66:67], v9 offset:16384
    v_mfma_f32_16x16x32_bf16 v[144:147], v[112:115], v[88:91], v[144:147]
    ds_read_b64_tr_b16 v[68:69], v10 offset:16384
    v_mfma_f32_16x16x32_bf16 v[148:151], v[116:119], v[88:91], v[148:151]
    ds_read_b64_tr_b16 v[70:71], v11 offset:16384
    v_mfma_f32_16x16x32_bf16 v[160:163], v[112:115], v[96:99], v[160:163]
    ds_read_b64_tr_b16 v[72:73], v8 offset:24576
    v_mfma_f32_16x16x32_bf16 v[164:167], v[116:119], v[96:99], v[164:167]
    ds_read_b64_tr_b16 v[74:75], v9 offset:24576
    v_mfma_f32_16x16x32_bf16 v[176:179], v[112:115], v[104:107], v[176:179]
    ds_read_b64_tr_b16 v[76:77], v10 offset:24576
    v_mfma_f32_16x16x32_bf16 v[180:183], v[116:119], v[104:107], v[180:183]
    ds_read_b64_tr_b16 v[78:79], v11 offset:24576
    v_mfma_f32_16x16x32_bf16 v[128:131], v[120:123], v[84:87], v[128:131]
    ds_read_b128 v[32:35], v5 offset:0
    v_mfma_f32_16x16x32_bf16 v[132:135], v[124:127], v[84:87], v[132:135]
    ds_read_b128 v[36:39], v5 offset:1024
    v_mfma_f32_16x16x32_bf16 v[144:147], v[120:123], v[92:95], v[144:147]
    ds_read_b128 v[40:43], v5 offset:2048
    v_mfma_f32_16x16x32_bf16 v[148:151], v[124:127], v[92:95], v[148:151]
    ds_read_b128 v[44:47], v5 offset:3072
    v_mfma_f32_16x16x32_bf16 v[160:163], v[120:123], v[100:103], v[160:163]
    ds_read_b128 v[48:51], v5 offset:4096
    v_mfma_f32_16x16x32_bf16 v[164:167], v[124:127], v[100:103], v[164:167]
    ds_read_b128 v[52:55], v5 offset:5120
    v_mfma_f32_16x16x32_bf16 v[176:179], v[120:123], v[108:111], v[176:179]
    ds_read_b128 v[56:59], v5 offset:6144
    v_mfma_f32_16x16x32_bf16 v[180:183], v[124:127], v[108:111], v[180:183]
    ds_read_b128 v[60:63], v5 offset:7168
    s_waitcnt lgkmcnt(0)
    s_sub_u32 s23, s23, 1
    s_cmp_lg_u32 s23, 0
    s_cbranch_scc1 w_loopH
    s_branch w_endH
w_ndH:
    s_waitcnt vmcnt(8)
    s_barrier
    v_mfma_f32_16x16x32_bf16 v[128:131], v[64:67], v[32:35], v[128:131]
    ds_read_b64_tr_b16 v[112:113], v8 offset:49152
    v_mfma_f32_16x16x32_bf16 v[132:135], v[68:71], v[32:35], v[132:135]
    ds_read_b64_tr_b16 v[114:115], v9 offset:49152
    v_mfma_f32_16x16x32_bf16 v[144:147], v[64:67], v[40:43], v[144:147]
    ds_read_b64_tr_b16 v[116:117], v10 offset:49152
    v_mfma_f32_16x16x32_bf16 v[148:151], v[68:71], v[40:43], v[148:151]
    ds_read_b64_tr_b16 v[118:119], v11 offset:49152
    v_mfma_f32_16x16x32_bf16 v[160:163], v[64:67], v[48:51], v[160:163]
    ds_read_b64_tr_b16 v[120:121], v8 offset:57344
    v_mfma_f32_16x16x32_bf16 v[164:167], v[68:71], v[48:51], v[164:167]
    ds_read_b64_tr_b16 v[122:123], v9 offset:57344
    v_mfma_f32_16x16x32_bf16 v[176:179], v[64:67], v[56:59], v[176:179]
    ds_read_b64_tr_b16 v[124:125], v10 offset:57344
    v_mfma_f32_16x16x32_bf16 v[180:183], v[68:71], v[56:59], v[180:183]
    ds_read_b64_tr_b16 v[126:127], v11 offset:57344
    v_mfma_f32_16x16x32_bf16 v[128:131], v[72:75], v[36:39], v[128:131]
    ds_read_b128 v[80:83], v5 offset:32768
    v_mfma_f32_16x16x32_bf16 v[132:135], v[76:79], v[36:39], v[132:135]
    ds_read_b128 v[84:87], v5 offset:33792
    v_mfma_f32_16x16x32_bf16 v[144:147], v[72:75], v[44:47], v[144:147]
    ds_read_b128 v[88:91], v5 offset:34816
    v_mfma_f32_16x16x32_bf16 v[148:151], v[76:79], v[44:47], v[148:151]
    ds_read_b128 v[92:95], v5 offset:35840
    v_mfma_f32_16x16x32_bf16 v[160:163], v[72:75], v[52:55], v[160:163]
    ds_read_b128 v[96:99], v5 offset:36864
    v_mfma_f32_16x16x32_bf16 v[164:167], v[76:79], v[52:55], v[164:167]
    ds_read_b128 v[100:103], v5 offset:37888
    v_mfma_f32_16x16x32_bf16 v[176:179], v[72:75], v[60:63], v[176:179]
    ds_read_b128 v[104:107], v5 offset:38912
    v_mfma_f32_16x16x32_bf16 v[180:183], v[76:79], v[60:63], v[180:183]
    ds_read_b128 v[108:111], v5 offset:39936
    s_waitcnt lgkmcnt(0)
    s_waitcnt vmcnt(4)
    s_barrier
    v_mfma_f32_16x16x32_bf16 v[128:131], v[112:115], v[80:83], v[128:131]
    ds_read_b64_tr_b16 v[64:65], v12 offset:16384
    v_mfma_f32_16x16x32_bf16 v[132:135], v[116:119], v[80:83], v[132:135]
    ds_read_b64_tr_b16 v[66:67], v13 offset:16384
    v_mfma_f32_16x16x32_bf16 v[144:147], v[112:115], v[88:91], v[144:147]
    ds_read_b64_tr_b16 v[68:69], v14 offset:16384
    v_mfma_f32_16x16x32_bf16 v[148:151], v[116:119], v[88:91], v[148:151]
    ds_read_b64_tr_b16 v[70:71], v15 offset:16384
    v_mfma_f32_16x16x32_bf16 v[160:163], v[112:115], v[96:99], v[160:163]
    ds_read_b64_tr_b16 v[72:73], v12 offset:24576
    v_mfma_f32_16x16x32_bf16 v[164:167], v[116:119], v[96:99], v[164:167]
    ds_read_b64_tr_b16 v[74:75], v13 offset:24576
    v_mfma_f32_16x16x32_bf16 v[176:179], v[112:115], v[104:107], v[176:179]
    ds_read_b64_tr_b16 v[76:77], v14 offset:24576
    v_mfma_f32_16x16x32_bf16 v[180:183], v[116:119], v[104:107], v[180:183]
    ds_read_b64_tr_b16 v[78:79], v15 offset:24576
    v_mfma_f32_16x16x32_bf16 v[128:131], v[120:123], v[84:87], v[128:131]
    ds_read_b128 v[32:35], v6 offset:0
    v_mfma_f32_16x16x32_bf16 v[132:135], v[124:127], v[84:87], v[132:135]
    ds_read_b128 v[36:39], v6 offset:1024
    v_mfma_f32_16x16x32_bf16 v[144:147], v[120:123], v[92:95], v[144:147]
    ds_read_b128 v[40:43], v6 offset:2048
    v_mfma_f32_16x16x32_bf16 v[148:151], v[124:127], v[92:95], v[148:151]
    ds_read_b128 v[44:47], v6 offset:3072
    v_mfma_f32_16x16x32_bf16 v[160:163], v[120:123], v[100:103], v[160:163]
    ds_read_b128 v[48:51], v6 offset:4096
    v_mfma_f32_16x16x32_bf16 v[164:167], v[124:127], v[100:103], v[164:167]
    ds_read_b128 v[52:55], v6 offset:5120
    v_mfma_f32_16x16x32_bf16 v[176:179], v[120:123], v[108:111], v[176:179]
    ds_read_b128 v[56:59], v6 offset:6144
    v_mfma_f32_16x16x32_bf16 v[180:183], v[124:127], v[108:111], v[180:183]
    ds_read_b128 v[60:63], v6 offset:7168
    s_waitcnt lgkmcnt(0)
    s_waitcnt vmcnt(0)
    s_barrier
    v_mfma_f32_16x16x32_bf16 v[128:131], v[64:67], v[32:35], v[128:131]
    ds_read_b64_tr_b16 v[112:113], v12 offset:49152
    v_mfma_f32_16x16x32_bf16 v[132:135], v[68:71], v[32:35], v[132:135]
    ds_read_b64_tr_b16 v[114:115], v13 offset:49152
    v_mfma_f32_16x16x32_bf16 v[144:147], v[64:67], v[40:43], v[144:147]
    ds_read_b64_tr_b16 v[116:117], v14 offset:49152
    v_mfma_f32_16x16x32_bf16 v[148:151], v[68:71], v[40:43], v[148:151]
    ds_read_b64_tr_b16 v[118:119], v15 offset:49152
    v_mfma_f32_16x16x32_bf16 v[160:163], v[64:67], v[48:51], v[160:163]
    ds_read_b64_tr_b16 v[120:121], v12 offset:57344
    v_mfma_f32_16x16x32_bf16 v[164:167], v[68:71], v[48:51], v[164:167]
    ds_read_b64_tr_b16 v[122:123], v13 offset:57344
    v_mfma_f32_16x16x32_bf16 v[176:179], v[64:67], v[56:59], v[176:179]
    ds_read_b64_tr_b16 v[124:125], v14 offset:57344
    v_mfma_f32_16x16x32_bf16 v[180:183], v[68:71], v[56:59], v[180:183]
    ds_read_b64_tr_b16 v[126:127], v15 offset:57344
    v_mfma_f32_16x16x32_bf16 v[128:131], v[72:75], v[36:39], v[128:131]
    ds_read_b128 v[80:83], v6 offset:32768
    v_mfma_f32_16x16x32_bf16 v[132:135], v[76:79], v[36:39], v[132:135]
    ds_read_b128 v[84:87], v6 offset:33792
    v_mfma_f32_16x16x32_bf16 v[144:147], v[72:75], v[44:47], v[144:147]
    ds_read_b128 v[88:91], v6 offset:34816
    v_mfma_f32_16x16x32_bf16 v[148:151], v[76:79], v[44:47], v[148:151]
    ds_read_b128 v[92:95], v6 offset:35840
    v_mfma_f32_16x16x32_bf16 v[160:163], v[72:75], v[52:55], v[160:163]
    ds_read_b128 v[96:99], v6 offset:36864
    v_mfma_f32_16x16x32_bf16 v[164:167], v[76:79], v[52:55], v[164:167]
    ds_read_b128 v[100:103], v6 offset:37888
    v_mfma_f32_16x16x32_bf16 v[176:179], v[72:75], v[60:63], v[176:179]
    ds_read_b128 v[104:107], v6 offset:38912
    v_mfma_f32_16x16x32_bf16 v[180:183], v[76:79], v[60:63], v[180:183]
    ds_read_b128 v[108:111], v6 offset:39936
    s_waitcnt lgkmcnt(0)
    s_waitcnt vmcnt(0)
    s_barrier
    v_mfma_f32_16x16x32_bf16 v[128:131], v[112:115], v[80:83], v[128:131]
    ds_read_b64_tr_b16 v[64:65], v8 offset:16384
    v_mfma_f32_16x16x32_bf16 v[132:135], v[116:119], v[80:83], v[132:135]
    ds_read_b64_tr_b16 v[66:67], v9 offset:16384
    v_mfma_f32_16x16x32_bf16 v[144:147], v[112:115], v[88:91], v[144:147]
    ds_read_b64_tr_b16 v[68:69], v10 offset:16384
    v_mfma_f32_16x16x32_bf16 v[148:151], v[116:119], v[88:91], v[148:151]
    ds_read_b64_tr_b16 v[70:71], v11 offset:16384
    v_mfma_f32_16x16x32_bf16 v[160:163], v[112:115], v[96:99], v[160:163]
    ds_read_b64_tr_b16 v[72:73], v8 offset:24576
    v_mfma_f32_16x16x32_bf16 v[164:167], v[116:119], v[96:99], v[164:167]
    ds_read_b64_tr_b16 v[74:75], v9 offset:24576
    v_mfma_f32_16x16x32_bf16 v[176:179], v[112:115], v[104:107], v[176:179]
    ds_read_b64_tr_b16 v[76:77], v10 offset:24576
    v_mfma_f32_16x16x32_bf16 v[180:183], v[116:119], v[104:107], v[180:183]
    ds_read_b64_tr_b16 v[78:79], v11 offset:24576
    v_mfma_f32_16x16x32_bf16 v[128:131], v[120:123], v[84:87], v[128:131]
    ds_read_b128 v[32:35], v5 offset:0
    v_mfma_f32_16x16x32_bf16 v[132:135], v[124:127], v[84:87], v[132:135]
    ds_read_b128 v[36:39], v5 offset:1024
    v_mfma_f32_16x16x32_bf16 v[144:147], v[120:123], v[92:95], v[144:147]
    ds_read_b128 v[40:43], v5 offset:2048
    v_mfma_f32_16x16x32_bf16 v[148:151], v[124:127], v[92:95], v[148:151]
    ds_read_b128 v[44:47], v5 offset:3072
    v_mfma_f32_16x16x32_bf16 v[160:163], v[120:123], v[100:103], v[160:163]
    ds_read_b128 v[48:51], v5 offset:4096
    v_mfma_f32_16x16x32_bf16 v[164:167], v[124:127], v[100:103], v[164:167]
    ds_read_b128 v[52:55], v5 offset:5120
    v_mfma_f32_16x16x32_bf16 v[176:179], v[120:123], v[108:111], v[176:179]
    ds_read_b128 v[56:59], v5 offset:6144
    v_mfma_f32_16x16x32_bf16 v[180:183], v[124:127], v[108:111], v[180:183]
    ds_read_b128 v[60:63], v5 offset:7168
    s_waitcnt lgkmcnt(0)
w_endH:
    v_mov_b32 v20, 131072
    ds_read_b128 v[24:27], v20
    ds_read_b128 v[28:31], v20 offset:16
    s_cmp_lg_u32 s53, s53
    s_cbranch_scc1 w_epi_siluH
    s_lshl_b32 s30, s27, 10
    s_add_u32 s30, s30, s49
    s_nop 7
    v_cvt_pk_bf16_f32 v80, v128, v129
    v_cvt_pk_bf16_f32 v81, v130, v131
    v_cvt_pk_bf16_f32 v82, v132, v133
    v_cvt_pk_bf16_f32 v83, v134, v135
    buffer_store_dwordx4 v[80:83], v1, s[4:7], s30 offen sc1
    s_add_u32 s30, s30, s50
    v_cvt_pk_bf16_f32 v84, v144, v145
    v_cvt_pk_bf16_f32 v85, v146, v147
    v_cvt_pk_bf16_f32 v86, v148, v149
    v_cvt_pk_bf16_f32 v87, v150, v151
    buffer_store_dwordx4 v[84:87], v1, s[4:7], s30 offen sc1
    s_add_u32 s30, s30, s50
    v_cvt_pk_bf16_f32 v88, v160, v161
    v_cvt_pk_bf16_f32 v89, v162, v163
    v_cvt_pk_bf16_f32 v90, v164, v165
    v_cvt_pk_bf16_f32 v91, v166, v167
    buffer_store_dwordx4 v[88:91], v1, s[4:7], s30 offen sc1
    s_add_u32 s30, s30, s50
    v_cvt_pk_bf16_f32 v92, v176, v177
    v_cvt_pk_bf16_f32 v93, v178, v179
    v_cvt_pk_bf16_f32 v94, v180, v181
    v_cvt_pk_bf16_f32 v95, v182, v183
    buffer_store_dwordx4 v[92:95], v1, s[4:7], s30 offen sc1
    s_add_u32 s30, s30, s50
    s_waitcnt lgkmcnt(0)
    v_or3_b32 v24, v24, v25, v26
    v_or3_b32 v28, v28, v29, v30
    v_or3_b32 v24, v24, v27, v31
    v_or_b32 v24, v24, v28
    s_mov_b32 s28, s51
    s_mov_b32 s57, s53
    v_readfirstlane_b32 s30, v24
    s_cmp_lg_u32 s30, 0
    s_cbranch_scc1 w_drain
    s_mov_b32 s48, s32
    s_cmp_ge_u32 s32, 4
    s_cselect_b32 s30, 2, 3
    s_lshl_b32 s30, s26, s30
    s_mul_i32 s30, s30, s43
    s_add_u32 s49, s42, s30
    s_mov_b32 s50, s43
    s_mov_b32 s51, s46
    s_mov_b32 s23, s41
    s_mov_b32 s53, s47
    s_nop 0
    s_load_dwordx16 s[32:47], s[24:25], 0
    s_add_u32 s24, s24, 64
    s_addc_u32 s25, s25, 0
    s_branch w_first4
w_epi_siluH:
    s_lshl_b32 s30, s27, 10
    s_add_u32 s30, s30, s49
    s_mov_b32 s54, 0xbfb8aa3b
    s_nop 7
    v_cvt_pk_bf16_f32 v80, v128, v129
    v_cvt_pk_bf16_f32 v81, v130, v131
    v_cvt_pk_bf16_f32 v82, v132, v133
    v_cvt_pk_bf16_f32 v83, v134, v135
    v_lshlrev_b32 v128, 16, v80
    v_and_b32 v129, 0xffff0000, v80
    v_lshlrev_b32 v130, 16, v81
    v_and_b32 v131, 0xffff0000, v81
    v_lshlrev_b32 v132, 16, v82
    v_and_b32 v133, 0xffff0000, v82
    v_lshlrev_b32 v134, 16, v83
    v_and_b32 v135, 0xffff0000, v83
    v_mul_f32 v104, s54, v128
    v_mul_f32 v105, s54, v129
    v_mul_f32 v106, s54, v130
    v_mul_f32 v107, s54, v131
    v_mul_f32 v108, s54, v132
    v_mul_f32 v109, s54, v133
    v_mul_f32 v110, s54, v134
    v_mul_f32 v111, s54, v135
    v_exp_f32 v104, v104
    v_exp_f32 v105, v105
    v_exp_f32 v106, v106
    v_exp_f32 v107, v107
    v_exp_f32 v108, v108
    v_exp_f32 v109, v109
    v_exp_f32 v110, v110
    v_exp_f32 v111, v111
    v_add_f32 v104, 1.0, v104
    v_add_f32 v105, 1.0, v105
    v_add_f32 v106, 1.0, v106
    v_add_f32 v107, 1.0, v107
    v_add_f32 v108, 1.0, v108
    v_add_f32 v109, 1.0, v109
    v_add_f32 v110, 1.0, v110
    v_add_f32 v111, 1.0, v111
    v_rcp_f32 v104, v104
    v_rcp_f32 v105, v105
    v_rcp_f32 v106, v106
    v_rcp_f32 v107, v107
    v_rcp_f32 v108, v108
    v_rcp_f32 v109, v109
    v_rcp_f32 v110, v110
    v_rcp_f32 v111, v111
    v_mul_f32 v128, v128, v104
    v_mul_f32 v129, v129, v105
    v_mul_f32 v130, v130, v106
    v_mul_f32 v131, v131, v107
    v_mul_f32 v132, v132, v108
    v_mul_f32 v133, v133, v109
    v_mul_f32 v134, v134, v110
    v_mul_f32 v135, v135, v111
    v_cvt_pk_bf16_f32 v80, v128, v129
    v_cvt_pk_bf16_f32 v81, v130, v131
    v_cvt_pk_bf16_f32 v82, v132, v133
    v_cvt_pk_bf16_f32 v83, v134, v135
    buffer_store_dwordx4 v[80:83], v1, s[4:7], s30 offen sc1
    s_add_u32 s30, s30, s50
    v_cvt_pk_bf16_f32 v84, v144, v145
    v_cvt_pk_bf16_f32 v85, v146, v147
    v_cvt_pk_bf16_f32 v86, v148, v149
    v_cvt_pk_bf16_f32 v87, v150, v151
    v_lshlrev_b32 v144, 16, v84
    v_and_b32 v145, 0xffff0000, v84
    v_lshlrev_b32 v146, 16, v85
    v_and_b32 v147, 0xffff0000, v85
    v_lshlrev_b32 v148, 16, v86
    v_and_b32 v149, 0xffff0000, v86
    v_lshlrev_b32 v150, 16, v87
    v_and_b32 v151, 0xffff0000, v87
    v_mul_f32 v96, s54, v144
    v_mul_f32 v97, s54, v145
    v_mul_f32 v98, s54, v146
    v_mul_f32 v99, s54, v147
    v_mul_f32 v100, s54, v148
    v_mul_f32 v101, s54, v149
    v_mul_f32 v102, s54, v150
    v_mul_f32 v103, s54, v151
    v_exp_f32 v96, v96
    v_exp_f32 v97, v97
    v_exp_f32 v98, v98
    v_exp_f32 v99, v99
    v_exp_f32 v100, v100
    v_exp_f32 v101, v101
    v_exp_f32 v102, v102
    v_exp_f32 v103, v103
    v_add_f32 v96, 1.0, v96
    v_add_f32 v97, 1.0, v97
    v_add_f32 v98, 1.0, v98
    v_add_f32 v99, 1.0, v99
    v_add_f32 v100, 1.0, v100
    v_add_f32 v101, 1.0, v101
    v_add_f32 v102, 1.0, v102
    v_add_f32 v103, 1.0, v103
    v_rcp_f32 v96, v96
    v_rcp_f32 v97, v97
    v_rcp_f32 v98, v98
    v_rcp_f32 v99, v99
    v_rcp_f32 v100, v100
    v_rcp_f32 v101, v101
    v_rcp_f32 v102, v102
    v_rcp_f32 v103, v103
    v_mul_f32 v144, v144, v96
    v_mul_f32 v145, v145, v97
    v_mul_f32 v146, v146, v98
    v_mul_f32 v147, v147, v99
    v_mul_f32 v148, v148, v100
    v_mul_f32 v149, v149, v101
    v_mul_f32 v150, v150, v102
    v_mul_f32 v151, v151, v103
    v_cvt_pk_bf16_f32 v84, v144, v145
    v_cvt_pk_bf16_f32 v85, v146, v147
    v_cvt_pk_bf16_f32 v86, v148, v149
    v_cvt_pk_bf16_f32 v87, v150, v151
    buffer_store_dwordx4 v[84:87], v1, s[4:7], s30 offen sc1
    s_add_u32 s30, s30, s50
    v_cvt_pk_bf16_f32 v88, v160, v161
    v_cvt_pk_bf16_f32 v89, v162, v163
    v_cvt_pk_bf16_f32 v90, v164, v165
    v_cvt_pk_bf16_f32 v91, v166, v167
    v_lshlrev_b32 v160, 16, v88
    v_and_b32 v161, 0xffff0000, v88
    v_lshlrev_b32 v162, 16, v89
    v_and_b32 v163, 0xffff0000, v89
    v_lshlrev_b32 v164, 16, v90
    v_and_b32 v165, 0xffff0000, v90
    v_lshlrev_b32 v166, 16, v91
    v_and_b32 v167, 0xffff0000, v91
    v_mul_f32 v104, s54, v160
    v_mul_f32 v105, s54, v161
    v_mul_f32 v106, s54, v162
    v_mul_f32 v107, s54, v163
    v_mul_f32 v108, s54, v164
    v_mul_f32 v109, s54, v165
    v_mul_f32 v110, s54, v166
    v_mul_f32 v111, s54, v167
    v_exp_f32 v104, v104
    v_exp_f32 v105, v105
    v_exp_f32 v106, v106
    v_exp_f32 v107, v107
    v_exp_f32 v108, v108
    v_exp_f32 v109, v109
    v_exp_f32 v110, v110
    v_exp_f32 v111, v111
    v_add_f32 v104, 1.0, v104
    v_add_f32 v105, 1.0, v105
    v_add_f32 v106, 1.0, v106
    v_add_f32 v107, 1.0, v107
    v_add_f32 v108, 1.0, v108
    v_add_f32 v109, 1.0, v109
    v_add_f32 v110, 1.0, v110
    v_add_f32 v111, 1.0, v111
    v_rcp_f32 v104, v104
    v_rcp_f32 v105, v105
    v_rcp_f32 v106, v106
    v_rcp_f32 v107, v107
    v_rcp_f32 v108, v108
    v_rcp_f32 v109, v109
    v_rcp_f32 v110, v110
    v_rcp_f32 v111, v111
    v_mul_f32 v160, v160, v104
    v_mul_f32 v161, v161, v105
    v_mul_f32 v162, v162, v106
    v_mul_f32 v163, v163, v107
    v_mul_f32 v164, v164, v108
    v_mul_f32 v165, v165, v109
    v_mul_f32 v166, v166, v110
    v_mul_f32 v167, v167, v111
    v_cvt_pk_bf16_f32 v88, v160, v161
    v_cvt_pk_bf16_f32 v89, v162, v163
    v_cvt_pk_bf16_f32 v90, v164, v165
    v_cvt_pk_bf16_f32 v91, v166, v167
    buffer_store_dwordx4 v[88:91], v1, s[4:7], s30 offen sc1
    s_add_u32 s30, s30, s50
    v_cvt_pk_bf16_f32 v92, v176, v177
    v_cvt_pk_bf16_f32 v93, v178, v179
    v_cvt_pk_bf16_f32 v94, v180, v181
    v_cvt_pk_bf16_f32 v95, v182, v183
    v_lshlrev_b32 v176, 16, v92
    v_and_b32 v177, 0xffff0000, v92
    v_lshlrev_b32 v178, 16, v93
    v_and_b32 v179, 0xffff0000, v93
    v_lshlrev_b32 v180, 16, v94
    v_and_b32 v181, 0xffff0000, v94
    v_lshlrev_b32 v182, 16, v95
    v_and_b32 v183, 0xffff0000, v95
    v_mul_f32 v96, s54, v176
    v_mul_f32 v97, s54, v177
    v_mul_f32 v98, s54, v178
    v_mul_f32 v99, s54, v179
    v_mul_f32 v100, s54, v180
    v_mul_f32 v101, s54, v181
    v_mul_f32 v102, s54, v182
    v_mul_f32 v103, s54, v183
    v_exp_f32 v96, v96
    v_exp_f32 v97, v97
    v_exp_f32 v98, v98
    v_exp_f32 v99, v99
    v_exp_f32 v100, v100
    v_exp_f32 v101, v101
    v_exp_f32 v102, v102
    v_exp_f32 v103, v103
    v_add_f32 v96, 1.0, v96
    v_add_f32 v97, 1.0, v97
    v_add_f32 v98, 1.0, v98
    v_add_f32 v99, 1.0, v99
    v_add_f32 v100, 1.0, v100
    v_add_f32 v101, 1.0, v101
    v_add_f32 v102, 1.0, v102
    v_add_f32 v103, 1.0, v103
    v_rcp_f32 v96, v96
    v_rcp_f32 v97, v97
    v_rcp_f32 v98, v98
    v_rcp_f32 v99, v99
    v_rcp_f32 v100, v100
    v_rcp_f32 v101, v101
    v_rcp_f32 v102, v102
    v_rcp_f32 v103, v103
    v_mul_f32 v176, v176, v96
    v_mul_f32 v177, v177, v97
    v_mul_f32 v178, v178, v98
    v_mul_f32 v179, v179, v99
    v_mul_f32 v180, v180, v100
    v_mul_f32 v181, v181, v101
    v_mul_f32 v182, v182, v102
    v_mul_f32 v183, v183, v103
    v_cvt_pk_bf16_f32 v92, v176, v177
    v_cvt_pk_bf16_f32 v93, v178, v179
    v_cvt_pk_bf16_f32 v94, v180, v181
    v_cvt_pk_bf16_f32 v95, v182, v183
    buffer_store_dwordx4 v[92:95], v1, s[4:7], s30 offen sc1
    s_add_u32 s30, s30, s50
    s_waitcnt lgkmcnt(0)
    v_or3_b32 v24, v24, v25, v26
    v_or3_b32 v28, v28, v29, v30
    v_or3_b32 v24, v24, v27, v31
    v_or_b32 v24, v24, v28
    s_mov_b32 s28, s51
    s_mov_b32 s57, s53
    v_readfirstlane_b32 s30, v24
    s_cmp_lg_u32 s30, 0
    s_cbranch_scc1 w_drain
    s_mov_b32 s48, s32
    s_cmp_ge_u32 s32, 4
    s_cselect_b32 s30, 2, 3
    s_lshl_b32 s30, s26, s30
    s_mul_i32 s30, s30, s43
    s_add_u32 s49, s42, s30
    s_mov_b32 s50, s43
    s_mov_b32 s51, s46
    s_mov_b32 s23, s41
    s_mov_b32 s53, s47
    s_nop 0
    s_load_dwordx16 s[32:47], s[24:25], 0
    s_add_u32 s24, s24, 64
    s_addc_u32 s25, s25, 0
    s_branch w_first4
w_firstX:
    v_bfe_u32 v20, v1, 4, 3
    v_xor_b32 v21, v4, v20
    v_lshlrev_b32 v21, 4, v21
    v_lshl_add_u32 v21, v20, 7, v21
    v_bfe_u32 v20, v1, 7, 1
    v_lshl_add_u32 v21, v20, 10, v21
    s_lshl_b32 s30, s26, 13
    v_add_u32 v24, s30, v21
    v_xor_b32 v25, 64, v24
    v_add_u32 v26, 0x10000, v24
    v_add_u32 v27, 0x10000, v25
    ds_read_b64_tr_b16 v[64:65], v8 offset:16384
    ds_read_b64_tr_b16 v[66:67], v9 offset:16384
    ds_read_b64_tr_b16 v[68:69], v10 offset:16384
    ds_read_b64_tr_b16 v[70:71], v11 offset:16384
    ds_read_b64_tr_b16 v[72:73], v8 offset:24576
    ds_read_b64_tr_b16 v[74:75], v9 offset:24576
    ds_read_b64_tr_b16 v[76:77], v10 offset:24576
    ds_read_b64_tr_b16 v[78:79], v11 offset:24576
    ds_read_b128 v[32:35], v24 offset:0
    ds_read_b128 v[36:39], v25 offset:0
    ds_read_b128 v[40:43], v24 offset:2048
    ds_read_b128 v[44:47], v25 offset:2048
    ds_read_b128 v[48:51], v24 offset:4096
    ds_read_b128 v[52:55], v25 offset:4096
    ds_read_b128 v[56:59], v24 offset:6144
    ds_read_b128 v[60:63], v25 offset:6144
    v_mov_b32 v208, 0x3f803f80
    v_mov_b32 v209, 0x3f803f80
    v_mov_b32 v210, 0x3f803f80
    v_mov_b32 v211, 0x3f803f80
    s_waitcnt lgkmcnt(0)
    s_waitcnt vmcnt(8)
    s_barrier
    s_add_u32 m0, s21, 0
    s_nop 0
    buffer_load_dwordx4 v23, s[88:91], s16 offen lds
    s_add_u32 s16, s16, s62
    s_add_u32 m0, s21, 1024
    s_nop 0
    buffer_load_dwordx4 v23, s[88:91], s17 offen lds
    s_add_u32 s17, s17, s62
    s_add_u32 m0, s22, 0
    s_nop 0
    buffer_load_dwordx4 v2, s[8:11], s18 offen lds
    s_add_u32 s18, s18, s20
    s_add_u32 m0, s22, 8192
    s_nop 0
    buffer_load_dwordx4 v2, s[12:15], s19 offen lds
    s_add_u32 s19, s19, s20
    s_cmp_ge_u32 s16, s92
    s_cselect_b32 s94, 2048, 0
    s_cselect_b32 s95, s93, 0
    s_sub_u32 s16, s16, s94
    s_sub_u32 s17, s17, s94
    s_sub_u32 s18, s18, s95
    s_sub_u32 s19, s19, s95
    v_mfma_f32_16x16x32_bf16 v[128:131], v[64:67], v[32:35], 0
    ds_read_b64_tr_b16 v[112:113], v8 offset:49152
    v_mfma_f32_16x16x32_bf16 v[132:135], v[68:71], v[32:35], 0
    ds_read_b64_tr_b16 v[114:115], v9 offset:49152
    v_mfma_f32_16x16x32_bf16 v[144:147], v[64:67], v[40:43], 0
    ds_read_b64_tr_b16 v[116:117], v10 offset:49152
    v_mfma_f32_16x16x32_bf16 v[148:151], v[68:71], v[40:43], 0
    ds_read_b64_tr_b16 v[118:119], v11 offset:49152
    v_mfma_f32_16x16x32_bf16 v[160:163], v[64:67], v[48:51], 0
    ds_read_b64_tr_b16 v[120:121], v8 offset:57344
    v_mfma_f32_16x16x32_bf16 v[164:167], v[68:71], v[48:51], 0
    ds_read_b64_tr_b16 v[122:123], v9 offset:57344
    v_mfma_f32_16x16x32_bf16 v[176:179], v[64:67], v[56:59], 0
    ds_read_b64_tr_b16 v[124:125], v10 offset:57344
    v_mfma_f32_16x16x32_bf16 v[180:183], v[68:71], v[56:59], 0
    ds_read_b64_tr_b16 v[126:127], v11 offset:57344
    v_mfma_f32_16x16x32_bf16 v[192:195], v[64:67], v[208:211], 0
    ds_read_b128 v[80:83], v24 offset:32768
    v_mfma_f32_16x16x32_bf16 v[196:199], v[68:71], v[208:211], 0
    ds_read_b128 v[84:87], v25 offset:32768
    v_mfma_f32_16x16x32_bf16 v[128:131], v[72:75], v[36:39], v[128:131]
    ds_read_b128 v[88:91], v24 offset:34816
    v_mfma_f32_16x16x32_bf16 v[132:135], v[76:79], v[36:39], v[132:135]
    ds_read_b128 v[92:95], v25 offset:34816
    v_mfma_f32_16x16x32_bf16 v[144:147], v[72:75], v[44:47], v[144:147]
    ds_read_b128 v[96:99], v24 offset:36864
    v_mfma_f32_16x16x32_bf16 v[148:151], v[76:79], v[44:47], v[148:151]
    ds_read_b128 v[100:103], v25 offset:36864
    v_mfma_f32_16x16x32_bf16 v[160:163], v[72:75], v[52:55], v[160:163]
    ds_read_b128 v[104:107], v24 offset:38912
    v_mfma_f32_16x16x32_bf16 v[164:167], v[76:79], v[52:55], v[164:167]
    ds_read_b128 v[108:111], v25 offset:38912
    v_mfma_f32_16x16x32_bf16 v[176:179], v[72:75], v[60:63], v[176:179]
    v_mfma_f32_16x16x32_bf16 v[180:183], v[76:79], v[60:63], v[180:183]
    v_mfma_f32_16x16x32_bf16 v[192:195], v[72:75], v[208:211], v[192:195]
    v_mfma_f32_16x16x32_bf16 v[196:199], v[76:79], v[208:211], v[196:199]
    s_waitcnt lgkmcnt(0)
    s_waitcnt vmcnt(8)
    s_barrier
    s_add_u32 m0, s21, 32768
    s_nop 0
    buffer_load_dwordx4 v23, s[88:91], s16 offen lds
    s_add_u32 s16, s16, s62
    s_add_u32 m0, s21, 33792
    s_nop 0
    buffer_load_dwordx4 v23, s[88:91], s17 offen lds
    s_add_u32 s17, s17, s62
    s_add_u32 m0, s22, 32768
    s_nop 0
    buffer_load_dwordx4 v2, s[8:11], s18 offen lds
    s_add_u32 s18, s18, s20
    s_add_u32 m0, s22, 40960
    s_nop 0
    buffer_load_dwordx4 v2, s[12:15], s19 offen lds
    s_add_u32 s19, s19, s20
    s_cmp_ge_u32 s16, s92
    s_cselect_b32 s94, 2048, 0
    s_cselect_b32 s95, s93, 0
    s_sub_u32 s16, s16, s94
    s_sub_u32 s17, s17, s94
    s_sub_u32 s18, s18, s95
    s_sub_u32 s19, s19, s95
    v_mfma_f32_16x16x32_bf16 v[128:131], v[112:115], v[80:83], v[128:131]
    ds_read_b64_tr_b16 v[64:65], v12 offset:16384
    v_mfma_f32_16x16x32_bf16 v[132:135], v[116:119], v[80:83], v[132:135]
    ds_read_b64_tr_b16 v[66:67], v13 offset:16384
    v_mfma_f32_16x16x32_bf16 v[144:147], v[112:115], v[88:91], v[144:147]
    ds_read_b64_tr_b16 v[68:69], v14 offset:16384
    v_mfma_f32_16x16x32_bf16 v[148:151], v[116:119], v[88:91], v[148:151]
    ds_read_b64_tr_b16 v[70:71], v15 offset:16384
    v_mfma_f32_16x16x32_bf16 v[160:163], v[112:115], v[96:99], v[160:163]
    ds_read_b64_tr_b16 v[72:73], v12 offset:24576
    v_mfma_f32_16x16x32_bf16 v[164:167], v[116:119], v[96:99], v[164:167]
    ds_read_b64_tr_b16 v[74:75], v13 offset:24576
    v_mfma_f32_16x16x32_bf16 v[176:179], v[112:115], v[104:107], v[176:179]
    ds_read_b64_tr_b16 v[76:77], v14 offset:24576
    v_mfma_f32_16x16x32_bf16 v[180:183], v[116:119], v[104:107], v[180:183]
    ds_read_b64_tr_b16 v[78:79], v15 offset:24576
    v_mfma_f32_16x16x32_bf16 v[192:195], v[112:115], v[208:211], v[192:195]
    ds_read_b128 v[32:35], v26 offset:0
    v_mfma_f32_16x16x32_bf16 v[196:199], v[116:119], v[208:211], v[196:199]
    ds_read_b128 v[36:39], v27 offset:0
    v_mfma_f32_16x16x32_bf16 v[128:131], v[120:123], v[84:87], v[128:131]
    ds_read_b128 v[40:43], v26 offset:2048
    v_mfma_f32_16x16x32_bf16 v[132:135], v[124:127], v[84:87], v[132:135]
    ds_read_b128 v[44:47], v27 offset:2048
    v_mfma_f32_16x16x32_bf16 v[144:147], v[120:123], v[92:95], v[144:147]
    ds_read_b128 v[48:51], v26 offset:4096
    v_mfma_f32_16x16x32_bf16 v[148:151], v[124:127], v[92:95], v[148:151]
    ds_read_b128 v[52:55], v27 offset:4096
    v_mfma_f32_16x16x32_bf16 v[160:163], v[120:123], v[100:103], v[160:163]
    ds_read_b128 v[56:59], v26 offset:6144
    v_mfma_f32_16x16x32_bf16 v[164:167], v[124:127], v[100:103], v[164:167]
    ds_read_b128 v[60:63], v27 offset:6144
    v_mfma_f32_16x16x32_bf16 v[176:179], v[120:123], v[108:111], v[176:179]
    v_mfma_f32_16x16x32_bf16 v[180:183], v[124:127], v[108:111], v[180:183]
    v_mfma_f32_16x16x32_bf16 v[192:195], v[120:123], v[208:211], v[192:195]
    v_mfma_f32_16x16x32_bf16 v[196:199], v[124:127], v[208:211], v[196:199]
    s_waitcnt lgkmcnt(0)
    s_waitcnt vmcnt(8)
    s_barrier
    s_add_u32 m0, s21, 65536
    s_nop 0
    buffer_load_dwordx4 v23, s[88:91], s16 offen lds
    s_add_u32 s16, s16, s62
    s_add_u32 m0, s21, 66560
    s_nop 0
    buffer_load_dwordx4 v23, s[88:91], s17 offen lds
    s_add_u32 s17, s17, s62
    s_add_u32 m0, s22, 65536
    s_nop 0
    buffer_load_dwordx4 v2, s[8:11], s18 offen lds
    s_add_u32 s18, s18, s20
    s_add_u32 m0, s22, 73728
    s_nop 0
    buffer_load_dwordx4 v2, s[12:15], s19 offen lds
    s_add_u32 s19, s19, s20
    s_cmp_ge_u32 s16, s92
    s_cselect_b32 s94, 2048, 0
    s_cselect_b32 s95, s93, 0
    s_sub_u32 s16, s16, s94
    s_sub_u32 s17, s17, s94
    s_sub_u32 s18, s18, s95
    s_sub_u32 s19, s19, s95
    v_mfma_f32_16x16x32_bf16 v[128:131], v[64:67], v[32:35], v[128:131]
    ds_read_b64_tr_b16 v[112:113], v12 offset:49152
    v_mfma_f32_16x16x32_bf16 v[132:135], v[68:71], v[32:35], v[132:135]
    ds_read_b64_tr_b16 v[114:115], v13 offset:49152
    v_mfma_f32_16x16x32_bf16 v[144:147], v[64:67], v[40:43], v[144:147]
    ds_read_b64_tr_b16 v[116:117], v14 offset:49152
    v_mfma_f32_16x16x32_bf16 v[148:151], v[68:71], v[40:43], v[148:151]
    ds_read_b64_tr_b16 v[118:119], v15 offset:49152
    v_mfma_f32_16x16x32_bf16 v[160:163], v[64:67], v[48:51], v[160:163]
    ds_read_b64_tr_b16 v[120:121], v12 offset:57344
    v_mfma_f32_16x16x32_bf16 v[164:167], v[68:71], v[48:51], v[164:167]
    ds_read_b64_tr_b16 v[122:123], v13 offset:57344
    v_mfma_f32_16x16x32_bf16 v[176:179], v[64:67], v[56:59], v[176:179]
    ds_read_b64_tr_b16 v[124:125], v14 offset:57344
    v_mfma_f32_16x16x32_bf16 v[180:183], v[68:71], v[56:59], v[180:183]
    ds_read_b64_tr_b16 v[126:127], v15 offset:57344
    v_mfma_f32_16x16x32_bf16 v[192:195], v[64:67], v[208:211], v[192:195]
    ds_read_b128 v[80:83], v26 offset:32768
    v_mfma_f32_16x16x32_bf16 v[196:199], v[68:71], v[208:211], v[196:199]
    ds_read_b128 v[84:87], v27 offset:32768
    v_mfma_f32_16x16x32_bf16 v[128:131], v[72:75], v[36:39], v[128:131]
    ds_read_b128 v[88:91], v26 offset:34816
    v_mfma_f32_16x16x32_bf16 v[132:135], v[76:79], v[36:39], v[132:135]
    ds_read_b128 v[92:95], v27 offset:34816
    v_mfma_f32_16x16x32_bf16 v[144:147], v[72:75], v[44:47], v[144:147]
    ds_read_b128 v[96:99], v26 offset:36864
    v_mfma_f32_16x16x32_bf16 v[148:151], v[76:79], v[44:47], v[148:151]
    ds_read_b128 v[100:103], v27 offset:36864
    v_mfma_f32_16x16x32_bf16 v[160:163], v[72:75], v[52:55], v[160:163]
    ds_read_b128 v[104:107], v26 offset:38912
    v_mfma_f32_16x16x32_bf16 v[164:167], v[76:79], v[52:55], v[164:167]
    ds_read_b128 v[108:111], v27 offset:38912
    v_mfma_f32_16x16x32_bf16 v[176:179], v[72:75], v[60:63], v[176:179]
    v_mfma_f32_16x16x32_bf16 v[180:183], v[76:79], v[60:63], v[180:183]
    v_mfma_f32_16x16x32_bf16 v[192:195], v[72:75], v[208:211], v[192:195]
    v_mfma_f32_16x16x32_bf16 v[196:199], v[76:79], v[208:211], v[196:199]
    s_waitcnt lgkmcnt(0)
    s_waitcnt vmcnt(8)
    s_barrier
    s_add_u32 m0, s21, 98304
    s_nop 0
    buffer_load_dwordx4 v23, s[88:91], s16 offen lds
    s_add_u32 s16, s16, s62
    s_add_u32 m0, s21, 99328
    s_nop 0
    buffer_load_dwordx4 v23, s[88:91], s17 offen lds
    s_add_u32 s17, s17, s62
    s_add_u32 m0, s22, 98304
    s_nop 0
    buffer_load_dwordx4 v2, s[8:11], s18 offen lds
    s_add_u32 s18, s18, s20
    s_add_u32 m0, s22, 106496
    s_nop 0
    buffer_load_dwordx4 v2, s[12:15], s19 offen lds
    s_add_u32 s19, s19, s20
    s_cmp_ge_u32 s16, s92
    s_cselect_b32 s94, 2048, 0
    s_cselect_b32 s95, s93, 0
    s_sub_u32 s16, s16, s94
    s_sub_u32 s17, s17, s94
    s_sub_u32 s18, s18, s95
    s_sub_u32 s19, s19, s95
    v_mfma_f32_16x16x32_bf16 v[128:131], v[112:115], v[80:83], v[128:131]
    ds_read_b64_tr_b16 v[64:65], v8 offset:16384
    v_mfma_f32_16x16x32_bf16 v[132:135], v[116:119], v[80:83], v[132:135]
    ds_read_b64_tr_b16 v[66:67], v9 offset:16384
    v_mfma_f32_16x16x32_bf16 v[144:147], v[112:115], v[88:91], v[144:147]
    ds_read_b64_tr_b16 v[68:69], v10 offset:16384
    v_mfma_f32_16x16x32_bf16 v[148:151], v[116:119], v[88:91], v[148:151]
    ds_read_b64_tr_b16 v[70:71], v11 offset:16384
    v_mfma_f32_16x16x32_bf16 v[160:163], v[112:115], v[96:99], v[160:163]
    ds_read_b64_tr_b16 v[72:73], v8 offset:24576
    v_mfma_f32_16x16x32_bf16 v[164:167], v[116:119], v[96:99], v[164:167]
    ds_read_b64_tr_b16 v[74:75], v9 offset:24576
    v_mfma_f32_16x16x32_bf16 v[176:179], v[112:115], v[104:107], v[176:179]
    ds_read_b64_tr_b16 v[76:77], v10 offset:24576
    v_mfma_f32_16x16x32_bf16 v[180:183], v[116:119], v[104:107], v[180:183]
    ds_read_b64_tr_b16 v[78:79], v11 offset:24576
    v_mfma_f32_16x16x32_bf16 v[192:195], v[112:115], v[208:211], v[192:195]
    ds_read_b128 v[32:35], v24 offset:0
    v_mfma_f32_16x16x32_bf16 v[196:199], v[116:119], v[208:211], v[196:199]
    ds_read_b128 v[36:39], v25 offset:0
    v_mfma_f32_16x16x32_bf16 v[128:131], v[120:123], v[84:87], v[128:131]
    ds_read_b128 v[40:43], v24 offset:2048
    v_mfma_f32_16x16x32_bf16 v[132:135], v[124:127], v[84:87], v[132:135]
    ds_read_b128 v[44:47], v25 offset:2048
    v_mfma_f32_16x16x32_bf16 v[144:147], v[120:123], v[92:95], v[144:147]
    ds_read_b128 v[48:51], v24 offset:4096
    v_mfma_f32_16x16x32_bf16 v[148:151], v[124:127], v[92:95], v[148:151]
    ds_read_b128 v[52:55], v25 offset:4096
    v_mfma_f32_16x16x32_bf16 v[160:163], v[120:123], v[100:103], v[160:163]
    ds_read_b128 v[56:59], v24 offset:6144
    v_mfma_f32_16x16x32_bf16 v[164:167], v[124:127], v[100:103], v[164:167]
    ds_read_b128 v[60:63], v25 offset:6144
    v_mfma_f32_16x16x32_bf16 v[176:179], v[120:123], v[108:111], v[176:179]
    v_mfma_f32_16x16x32_bf16 v[180:183], v[124:127], v[108:111], v[180:183]
    v_mfma_f32_16x16x32_bf16 v[192:195], v[120:123], v[208:211], v[192:195]
    v_mfma_f32_16x16x32_bf16 v[196:199], v[124:127], v[208:211], v[196:199]
    s_waitcnt lgkmcnt(0)
    s_mov_b32 s23, 2
w_loopX:
    s_waitcnt vmcnt(8)
    s_barrier
    s_add_u32 m0, s21, 0
    s_nop 0
    buffer_load_dwordx4 v23, s[88:91], s16 offen lds
    s_add_u32 s16, s16, s62
    s_add_u32 m0, s21, 1024
    s_nop 0
    buffer_load_dwordx4 v23, s[88:91], s17 offen lds
    s_add_u32 s17, s17, s62
    s_add_u32 m0, s22, 0
    s_nop 0
    buffer_load_dwordx4 v2, s[8:11], s18 offen lds
    s_add_u32 s18, s18, s20
    s_add_u32 m0, s22, 8192
    s_nop 0
    buffer_load_dwordx4 v2, s[12:15], s19 offen lds
    s_add_u32 s19, s19, s20
    s_cmp_ge_u32 s16, s92
    s_cselect_b32 s94, 2048, 0
    s_cselect_b32 s95, s93, 0
    s_sub_u32 s16, s16, s94
    s_sub_u32 s17, s17, s94
    s_sub_u32 s18, s18, s95
    s_sub_u32 s19, s19, s95
    v_mfma_f32_16x16x32_bf16 v[128:131], v[64:67], v[32:35], v[128:131]
    ds_read_b64_tr_b16 v[112:113], v8 offset:49152
    v_mfma_f32_16x16x32_bf16 v[132:135], v[68:71], v[32:35], v[132:135]
    ds_read_b64_tr_b16 v[114:115], v9 offset:49152
    v_mfma_f32_16x16x32_bf16 v[144:147], v[64:67], v[40:43], v[144:147]
    ds_read_b64_tr_b16 v[116:117], v10 offset:49152
    v_mfma_f32_16x16x32_bf16 v[148:151], v[68:71], v[40:43], v[148:151]
    ds_read_b64_tr_b16 v[118:119], v11 offset:49152
    v_mfma_f32_16x16x32_bf16 v[160:163], v[64:67], v[48:51], v[160:163]
    ds_read_b64_tr_b16 v[120:121], v8 offset:57344
    v_mfma_f32_16x16x32_bf16 v[164:167], v[68:71], v[48:51], v[164:167]
    ds_read_b64_tr_b16 v[122:123], v9 offset:57344
    v_mfma_f32_16x16x32_bf16 v[176:179], v[64:67], v[56:59], v[176:179]
    ds_read_b64_tr_b16 v[124:125], v10 offset:57344
    v_mfma_f32_16x16x32_bf16 v[180:183], v[68:71], v[56:59], v[180:183]
    ds_read_b64_tr_b16 v[126:127], v11 offset:57344
    v_mfma_f32_16x16x32_bf16 v[192:195], v[64:67], v[208:211], v[192:195]
    ds_read_b128 v[80:83], v24 offset:32768
    v_mfma_f32_16x16x32_bf16 v[196:199], v[68:71], v[208:211], v[196:199]
    ds_read_b128 v[84:87], v25 offset:32768
    v_mfma_f32_16x16x32_bf16 v[128:131], v[72:75], v[36:39], v[128:131]
    ds_read_b128 v[88:91], v24 offset:34816
    v_mfma_f32_16x16x32_bf16 v[132:135], v[76:79], v[36:39], v[132:135]
    ds_read_b128 v[92:95], v25 offset:34816
    v_mfma_f32_16x16x32_bf16 v[144:147], v[72:75], v[44:47], v[144:147]
    ds_read_b128 v[96:99], v24 offset:36864
    v_mfma_f32_16x16x32_bf16 v[148:151], v[76:79], v[44:47], v[148:151]
    ds_read_b128 v[100:103], v25 offset:36864
    v_mfma_f32_16x16x32_bf16 v[160:163], v[72:75], v[52:55], v[160:163]
    ds_read_b128 v[104:107], v24 offset:38912
    v_mfma_f32_16x16x32_bf16 v[164:167], v[76:79], v[52:55], v[164:167]
    ds_read_b128 v[108:111], v25 offset:38912
    v_mfma_f32_16x16x32_bf16 v[176:179], v[72:75], v[60:63], v[176:179]
    v_mfma_f32_16x16x32_bf16 v[180:183], v[76:79], v[60:63], v[180:183]
    v_mfma_f32_16x16x32_bf16 v[192:195], v[72:75], v[208:211], v[192:195]
    v_mfma_f32_16x16x32_bf16 v[196:199], v[76:79], v[208:211], v[196:199]
    s_waitcnt lgkmcnt(0)
    s_waitcnt vmcnt(8)
    s_barrier
    s_add_u32 m0, s21, 32768
    s_nop 0
    buffer_load_dwordx4 v23, s[88:91], s16 offen lds
    s_add_u32 s16, s16, s62
    s_add_u32 m0, s21, 33792
    s_nop 0
    buffer_load_dwordx4 v23, s[88:91], s17 offen lds
    s_add_u32 s17, s17, s62
    s_add_u32 m0, s22, 32768
    s_nop 0
    buffer_load_dwordx4 v2, s[8:11], s18 offen lds
    s_add_u32 s18, s18, s20
    s_add_u32 m0, s22, 40960
    s_nop 0
    buffer_load_dwordx4 v2, s[12:15], s19 offen lds
    s_add_u32 s19, s19, s20
    s_cmp_ge_u32 s16, s92
    s_cselect_b32 s94, 2048, 0
    s_cselect_b32 s95, s93, 0
    s_sub_u32 s16, s16, s94
    s_sub_u32 s17, s17, s94
    s_sub_u32 s18, s18, s95
    s_sub_u32 s19, s19, s95
    v_mfma_f32_16x16x32_bf16 v[128:131], v[112:115], v[80:83], v[128:131]
    ds_read_b64_tr_b16 v[64:65], v12 offset:16384
    v_mfma_f32_16x16x32_bf16 v[132:135], v[116:119], v[80:83], v[132:135]
    ds_read_b64_tr_b16 v[66:67], v13 offset:16384
    v_mfma_f32_16x16x32_bf16 v[144:147], v[112:115], v[88:91], v[144:147]
    ds_read_b64_tr_b16 v[68:69], v14 offset:16384
    v_mfma_f32_16x16x32_bf16 v[148:151], v[116:119], v[88:91], v[148:151]
    ds_read_b64_tr_b16 v[70:71], v15 offset:16384
    v_mfma_f32_16x16x32_bf16 v[160:163], v[112:115], v[96:99], v[160:163]
    ds_read_b64_tr_b16 v[72:73], v12 offset:24576
    v_mfma_f32_16x16x32_bf16 v[164:167], v[116:119], v[96:99], v[164:167]
    ds_read_b64_tr_b16 v[74:75], v13 offset:24576
    v_mfma_f32_16x16x32_bf16 v[176:179], v[112:115], v[104:107], v[176:179]
    ds_read_b64_tr_b16 v[76:77], v14 offset:24576
    v_mfma_f32_16x16x32_bf16 v[180:183], v[116:119], v[104:107], v[180:183]
    ds_read_b64_tr_b16 v[78:79], v15 offset:24576
    v_mfma_f32_16x16x32_bf16 v[192:195], v[112:115], v[208:211], v[192:195]
    ds_read_b128 v[32:35], v26 offset:0
    v_mfma_f32_16x16x32_bf16 v[196:199], v[116:119], v[208:211], v[196:199]
    ds_read_b128 v[36:39], v27 offset:0
    v_mfma_f32_16x16x32_bf16 v[128:131], v[120:123], v[84:87], v[128:131]
    ds_read_b128 v[40:43], v26 offset:2048
    v_mfma_f32_16x16x32_bf16 v[132:135], v[124:127], v[84:87], v[132:135]
    ds_read_b128 v[44:47], v27 offset:2048
    v_mfma_f32_16x16x32_bf16 v[144:147], v[120:123], v[92:95], v[144:147]
    ds_read_b128 v[48:51], v26 offset:4096
    v_mfma_f32_16x16x32_bf16 v[148:151], v[124:127], v[92:95], v[148:151]
    ds_read_b128 v[52:55], v27 offset:4096
    v_mfma_f32_16x16x32_bf16 v[160:163], v[120:123], v[100:103], v[160:163]
    ds_read_b128 v[56:59], v26 offset:6144
    v_mfma_f32_16x16x32_bf16 v[164:167], v[124:127], v[100:103], v[164:167]
    ds_read_b128 v[60:63], v27 offset:6144
    v_mfma_f32_16x16x32_bf16 v[176:179], v[120:123], v[108:111], v[176:179]
    v_mfma_f32_16x16x32_bf16 v[180:183], v[124:127], v[108:111], v[180:183]
    v_mfma_f32_16x16x32_bf16 v[192:195], v[120:123], v[208:211], v[192:195]
    v_mfma_f32_16x16x32_bf16 v[196:199], v[124:127], v[208:211], v[196:199]
    s_waitcnt lgkmcnt(0)
    s_waitcnt vmcnt(8)
    s_barrier
    s_add_u32 m0, s21, 65536
    s_nop 0
    buffer_load_dwordx4 v23, s[88:91], s16 offen lds
    s_add_u32 s16, s16, s62
    s_add_u32 m0, s21, 66560
    s_nop 0
    buffer_load_dwordx4 v23, s[88:91], s17 offen lds
    s_add_u32 s17, s17, s62
    s_add_u32 m0, s22, 65536
    s_nop 0
    buffer_load_dwordx4 v2, s[8:11], s18 offen lds
    s_add_u32 s18, s18, s20
    s_add_u32 m0, s22, 73728
    s_nop 0
    buffer_load_dwordx4 v2, s[12:15], s19 offen lds
    s_add_u32 s19, s19, s20
    s_cmp_ge_u32 s16, s92
    s_cselect_b32 s94, 2048, 0
    s_cselect_b32 s95, s93, 0
    s_sub_u32 s16, s16, s94
    s_sub_u32 s17, s17, s94
    s_sub_u32 s18, s18, s95
    s_sub_u32 s19, s19, s95
    v_mfma_f32_16x16x32_bf16 v[128:131], v[64:67], v[32:35], v[128:131]
    ds_read_b64_tr_b16 v[112:113], v12 offset:49152
    v_mfma_f32_16x16x32_bf16 v[132:135], v[68:71], v[32:35], v[132:135]
    ds_read_b64_tr_b16 v[114:115], v13 offset:49152
    v_mfma_f32_16x16x32_bf16 v[144:147], v[64:67], v[40:43], v[144:147]
    ds_read_b64_tr_b16 v[116:117], v14 offset:49152
    v_mfma_f32_16x16x32_bf16 v[148:151], v[68:71], v[40:43], v[148:151]
    ds_read_b64_tr_b16 v[118:119], v15 offset:49152
    v_mfma_f32_16x16x32_bf16 v[160:163], v[64:67], v[48:51], v[160:163]
    ds_read_b64_tr_b16 v[120:121], v12 offset:57344
    v_mfma_f32_16x16x32_bf16 v[164:167], v[68:71], v[48:51], v[164:167]
    ds_read_b64_tr_b16 v[122:123], v13 offset:57344
    v_mfma_f32_16x16x32_bf16 v[176:179], v[64:67], v[56:59], v[176:179]
    ds_read_b64_tr_b16 v[124:125], v14 offset:57344
    v_mfma_f32_16x16x32_bf16 v[180:183], v[68:71], v[56:59], v[180:183]
    ds_read_b64_tr_b16 v[126:127], v15 offset:57344
    v_mfma_f32_16x16x32_bf16 v[192:195], v[64:67], v[208:211], v[192:195]
    ds_read_b128 v[80:83], v26 offset:32768
    v_mfma_f32_16x16x32_bf16 v[196:199], v[68:71], v[208:211], v[196:199]
    ds_read_b128 v[84:87], v27 offset:32768
    v_mfma_f32_16x16x32_bf16 v[128:131], v[72:75], v[36:39], v[128:131]
    ds_read_b128 v[88:91], v26 offset:34816
    v_mfma_f32_16x16x32_bf16 v[132:135], v[76:79], v[36:39], v[132:135]
    ds_read_b128 v[92:95], v27 offset:34816
    v_mfma_f32_16x16x32_bf16 v[144:147], v[72:75], v[44:47], v[144:147]
    ds_read_b128 v[96:99], v26 offset:36864
    v_mfma_f32_16x16x32_bf16 v[148:151], v[76:79], v[44:47], v[148:151]
    ds_read_b128 v[100:103], v27 offset:36864
    v_mfma_f32_16x16x32_bf16 v[160:163], v[72:75], v[52:55], v[160:163]
    ds_read_b128 v[104:107], v26 offset:38912
    v_mfma_f32_16x16x32_bf16 v[164:167], v[76:79], v[52:55], v[164:167]
    ds_read_b128 v[108:111], v27 offset:38912
    v_mfma_f32_16x16x32_bf16 v[176:179], v[72:75], v[60:63], v[176:179]
    v_mfma_f32_16x16x32_bf16 v[180:183], v[76:79], v[60:63], v[180:183]
    v_mfma_f32_16x16x32_bf16 v[192:195], v[72:75], v[208:211], v[192:195]
    v_mfma_f32_16x16x32_bf16 v[196:199], v[76:79], v[208:211], v[196:199]
    s_waitcnt lgkmcnt(0)
    s_waitcnt vmcnt(8)
    s_barrier
    s_add_u32 m0, s21, 98304
    s_nop 0
    buffer_load_dwordx4 v23, s[88:91], s16 offen lds
    s_add_u32 s16, s16, s62
    s_add_u32 m0, s21, 99328
    s_nop 0
    buffer_load_dwordx4 v23, s[88:91], s17 offen lds
    s_add_u32 s17, s17, s62
    s_add_u32 m0, s22, 98304
    s_nop 0
    buffer_load_dwordx4 v2, s[8:11], s18 offen lds
    s_add_u32 s18, s18, s20
    s_add_u32 m0, s22, 106496
    s_nop 0
    buffer_load_dwordx4 v2, s[12:15], s19 offen lds
    s_add_u32 s19, s19, s20
    s_cmp_ge_u32 s16, s92
    s_cselect_b32 s94, 2048, 0
    s_cselect_b32 s95, s93, 0
    s_sub_u32 s16, s16, s94
    s_sub_u32 s17, s17, s94
    s_sub_u32 s18, s18, s95
    s_sub_u32 s19, s19, s95
    v_mfma_f32_16x16x32_bf16 v[128:131], v[112:115], v[80:83], v[128:131]
    ds_read_b64_tr_b16 v[64:65], v8 offset:16384
    v_mfma_f32_16x16x32_bf16 v[132:135], v[116:119], v[80:83], v[132:135]
    ds_read_b64_tr_b16 v[66:67], v9 offset:16384
    v_mfma_f32_16x16x32_bf16 v[144:147], v[112:115], v[88:91], v[144:147]
    ds_read_b64_tr_b16 v[68:69], v10 offset:16384
    v_mfma_f32_16x16x32_bf16 v[148:151], v[116:119], v[88:91], v[148:151]
    ds_read_b64_tr_b16 v[70:71], v11 offset:16384
    v_mfma_f32_16x16x32_bf16 v[160:163], v[112:115], v[96:99], v[160:163]
    ds_read_b64_tr_b16 v[72:73], v8 offset:24576
    v_mfma_f32_16x16x32_bf16 v[164:167], v[116:119], v[96:99], v[164:167]
    ds_read_b64_tr_b16 v[74:75], v9 offset:24576
    v_mfma_f32_16x16x32_bf16 v[176:179], v[112:115], v[104:107], v[176:179]
    ds_read_b64_tr_b16 v[76:77], v10 offset:24576
    v_mfma_f32_16x16x32_bf16 v[180:183], v[116:119], v[104:107], v[180:183]
    ds_read_b64_tr_b16 v[78:79], v11 offset:24576
    v_mfma_f32_16x16x32_bf16 v[192:195], v[112:115], v[208:211], v[192:195]
    ds_read_b128 v[32:35], v24 offset:0
    v_mfma_f32_16x16x32_bf16 v[196:199], v[116:119], v[208:211], v[196:199]
    ds_read_b128 v[36:39], v25 offset:0
    v_mfma_f32_16x16x32_bf16 v[128:131], v[120:123], v[84:87], v[128:131]
    ds_read_b128 v[40:43], v24 offset:2048
    v_mfma_f32_16x16x32_bf16 v[132:135], v[124:127], v[84:87], v[132:135]
    ds_read_b128 v[44:47], v25 offset:2048
    v_mfma_f32_16x16x32_bf16 v[144:147], v[120:123], v[92:95], v[144:147]
    ds_read_b128 v[48:51], v24 offset:4096
    v_mfma_f32_16x16x32_bf16 v[148:151], v[124:127], v[92:95], v[148:151]
    ds_read_b128 v[52:55], v25 offset:4096
    v_mfma_f32_16x16x32_bf16 v[160:163], v[120:123], v[100:103], v[160:163]
    ds_read_b128 v[56:59], v24 offset:6144
    v_mfma_f32_16x16x32_bf16 v[164:167], v[124:127], v[100:103], v[164:167]
    ds_read_b128 v[60:63], v25 offset:6144
    v_mfma_f32_16x16x32_bf16 v[176:179], v[120:123], v[108:111], v[176:179]
    v_mfma_f32_16x16x32_bf16 v[180:183], v[124:127], v[108:111], v[180:183]
    v_mfma_f32_16x16x32_bf16 v[192:195], v[120:123], v[208:211], v[192:195]
    v_mfma_f32_16x16x32_bf16 v[196:199], v[124:127], v[208:211], v[196:199]
    s_waitcnt lgkmcnt(0)
    s_sub_u32 s23, s23, 1
    s_cmp_lg_u32 s23, 0
    s_cbranch_scc1 w_loopX
    s_waitcnt vmcnt(8)
    s_barrier
    v_mfma_f32_16x16x32_bf16 v[128:131], v[64:67], v[32:35], v[128:131]
    ds_read_b64_tr_b16 v[112:113], v8 offset:49152
    v_mfma_f32_16x16x32_bf16 v[132:135], v[68:71], v[32:35], v[132:135]
    ds_read_b64_tr_b16 v[114:115], v9 offset:49152
    v_mfma_f32_16x16x32_bf16 v[144:147], v[64:67], v[40:43], v[144:147]
    ds_read_b64_tr_b16 v[116:117], v10 offset:49152
    v_mfma_f32_16x16x32_bf16 v[148:151], v[68:71], v[40:43], v[148:151]
    ds_read_b64_tr_b16 v[118:119], v11 offset:49152
    v_mfma_f32_16x16x32_bf16 v[160:163], v[64:67], v[48:51], v[160:163]
    ds_read_b64_tr_b16 v[120:121], v8 offset:57344
    v_mfma_f32_16x16x32_bf16 v[164:167], v[68:71], v[48:51], v[164:167]
    ds_read_b64_tr_b16 v[122:123], v9 offset:57344
    v_mfma_f32_16x16x32_bf16 v[176:179], v[64:67], v[56:59], v[176:179]
    ds_read_b64_tr_b16 v[124:125], v10 offset:57344
    v_mfma_f32_16x16x32_bf16 v[180:183], v[68:71], v[56:59], v[180:183]
    ds_read_b64_tr_b16 v[126:127], v11 offset:57344
    v_mfma_f32_16x16x32_bf16 v[192:195], v[64:67], v[208:211], v[192:195]
    ds_read_b128 v[80:83], v24 offset:32768
    v_mfma_f32_16x16x32_bf16 v[196:199], v[68:71], v[208:211], v[196:199]
    ds_read_b128 v[84:87], v25 offset:32768
    v_mfma_f32_16x16x32_bf16 v[128:131], v[72:75], v[36:39], v[128:131]
    ds_read_b128 v[88:91], v24 offset:34816
    v_mfma_f32_16x16x32_bf16 v[132:135], v[76:79], v[36:39], v[132:135]
    ds_read_b128 v[92:95], v25 offset:34816
    v_mfma_f32_16x16x32_bf16 v[144:147], v[72:75], v[44:47], v[144:147]
    ds_read_b128 v[96:99], v24 offset:36864
    v_mfma_f32_16x16x32_bf16 v[148:151], v[76:79], v[44:47], v[148:151]
    ds_read_b128 v[100:103], v25 offset:36864
    v_mfma_f32_16x16x32_bf16 v[160:163], v[72:75], v[52:55], v[160:163]
    ds_read_b128 v[104:107], v24 offset:38912
    v_mfma_f32_16x16x32_bf16 v[164:167], v[76:79], v[52:55], v[164:167]
    ds_read_b128 v[108:111], v25 offset:38912
    v_mfma_f32_16x16x32_bf16 v[176:179], v[72:75], v[60:63], v[176:179]
    v_mfma_f32_16x16x32_bf16 v[180:183], v[76:79], v[60:63], v[180:183]
    v_mfma_f32_16x16x32_bf16 v[192:195], v[72:75], v[208:211], v[192:195]
    v_mfma_f32_16x16x32_bf16 v[196:199], v[76:79], v[208:211], v[196:199]
    s_waitcnt lgkmcnt(0)
    s_waitcnt vmcnt(4)
    s_barrier
    v_mfma_f32_16x16x32_bf16 v[128:131], v[112:115], v[80:83], v[128:131]
    ds_read_b64_tr_b16 v[64:65], v12 offset:16384
    v_mfma_f32_16x16x32_bf16 v[132:135], v[116:119], v[80:83], v[132:135]
    ds_read_b64_tr_b16 v[66:67], v13 offset:16384
    v_mfma_f32_16x16x32_bf16 v[144:147], v[112:115], v[88:91], v[144:147]
    ds_read_b64_tr_b16 v[68:69], v14 offset:16384
    v_mfma_f32_16x16x32_bf16 v[148:151], v[116:119], v[88:91], v[148:151]
    ds_read_b64_tr_b16 v[70:71], v15 offset:16384
    v_mfma_f32_16x16x32_bf16 v[160:163], v[112:115], v[96:99], v[160:163]
    ds_read_b64_tr_b16 v[72:73], v12 offset:24576
    v_mfma_f32_16x16x32_bf16 v[164:167], v[116:119], v[96:99], v[164:167]
    ds_read_b64_tr_b16 v[74:75], v13 offset:24576
    v_mfma_f32_16x16x32_bf16 v[176:179], v[112:115], v[104:107], v[176:179]
    ds_read_b64_tr_b16 v[76:77], v14 offset:24576
    v_mfma_f32_16x16x32_bf16 v[180:183], v[116:119], v[104:107], v[180:183]
    ds_read_b64_tr_b16 v[78:79], v15 offset:24576
    v_mfma_f32_16x16x32_bf16 v[192:195], v[112:115], v[208:211], v[192:195]
    ds_read_b128 v[32:35], v26 offset:0
    v_mfma_f32_16x16x32_bf16 v[196:199], v[116:119], v[208:211], v[196:199]
    ds_read_b128 v[36:39], v27 offset:0
    v_mfma_f32_16x16x32_bf16 v[128:131], v[120:123], v[84:87], v[128:131]
    ds_read_b128 v[40:43], v26 offset:2048
    v_mfma_f32_16x16x32_bf16 v[132:135], v[124:127], v[84:87], v[132:135]
    ds_read_b128 v[44:47], v27 offset:2048
    v_mfma_f32_16x16x32_bf16 v[144:147], v[120:123], v[92:95], v[144:147]
    ds_read_b128 v[48:51], v26 offset:4096
    v_mfma_f32_16x16x32_bf16 v[148:151], v[124:127], v[92:95], v[148:151]
    ds_read_b128 v[52:55], v27 offset:4096
    v_mfma_f32_16x16x32_bf16 v[160:163], v[120:123], v[100:103], v[160:163]
    ds_read_b128 v[56:59], v26 offset:6144
    v_mfma_f32_16x16x32_bf16 v[164:167], v[124:127], v[100:103], v[164:167]
    ds_read_b128 v[60:63], v27 offset:6144
    v_mfma_f32_16x16x32_bf16 v[176:179], v[120:123], v[108:111], v[176:179]
    v_mfma_f32_16x16x32_bf16 v[180:183], v[124:127], v[108:111], v[180:183]
    v_mfma_f32_16x16x32_bf16 v[192:195], v[120:123], v[208:211], v[192:195]
    v_mfma_f32_16x16x32_bf16 v[196:199], v[124:127], v[208:211], v[196:199]
    s_waitcnt lgkmcnt(0)
    s_waitcnt vmcnt(0)
    s_barrier
    v_mfma_f32_16x16x32_bf16 v[128:131], v[64:67], v[32:35], v[128:131]
    ds_read_b64_tr_b16 v[112:113], v12 offset:49152
    v_mfma_f32_16x16x32_bf16 v[132:135], v[68:71], v[32:35], v[132:135]
    ds_read_b64_tr_b16 v[114:115], v13 offset:49152
    v_mfma_f32_16x16x32_bf16 v[144:147], v[64:67], v[40:43], v[144:147]
    ds_read_b64_tr_b16 v[116:117], v14 offset:49152
    v_mfma_f32_16x16x32_bf16 v[148:151], v[68:71], v[40:43], v[148:151]
    ds_read_b64_tr_b16 v[118:119], v15 offset:49152
    v_mfma_f32_16x16x32_bf16 v[160:163], v[64:67], v[48:51], v[160:163]
    ds_read_b64_tr_b16 v[120:121], v12 offset:57344
    v_mfma_f32_16x16x32_bf16 v[164:167], v[68:71], v[48:51], v[164:167]
    ds_read_b64_tr_b16 v[122:123], v13 offset:57344
    v_mfma_f32_16x16x32_bf16 v[176:179], v[64:67], v[56:59], v[176:179]
    ds_read_b64_tr_b16 v[124:125], v14 offset:57344
    v_mfma_f32_16x16x32_bf16 v[180:183], v[68:71], v[56:59], v[180:183]
    ds_read_b64_tr_b16 v[126:127], v15 offset:57344
    v_mfma_f32_16x16x32_bf16 v[192:195], v[64:67], v[208:211], v[192:195]
    ds_read_b128 v[80:83], v26 offset:32768
    v_mfma_f32_16x16x32_bf16 v[196:199], v[68:71], v[208:211], v[196:199]
    ds_read_b128 v[84:87], v27 offset:32768
    v_mfma_f32_16x16x32_bf16 v[128:131], v[72:75], v[36:39], v[128:131]
    ds_read_b128 v[88:91], v26 offset:34816
    v_mfma_f32_16x16x32_bf16 v[132:135], v[76:79], v[36:39], v[132:135]
    ds_read_b128 v[92:95], v27 offset:34816
    v_mfma_f32_16x16x32_bf16 v[144:147], v[72:75], v[44:47], v[144:147]
    ds_read_b128 v[96:99], v26 offset:36864
    v_mfma_f32_16x16x32_bf16 v[148:151], v[76:79], v[44:47], v[148:151]
    ds_read_b128 v[100:103], v27 offset:36864
    v_mfma_f32_16x16x32_bf16 v[160:163], v[72:75], v[52:55], v[160:163]
    ds_read_b128 v[104:107], v26 offset:38912
    v_mfma_f32_16x16x32_bf16 v[164:167], v[76:79], v[52:55], v[164:167]
    ds_read_b128 v[108:111], v27 offset:38912
    v_mfma_f32_16x16x32_bf16 v[176:179], v[72:75], v[60:63], v[176:179]
    v_mfma_f32_16x16x32_bf16 v[180:183], v[76:79], v[60:63], v[180:183]
    v_mfma_f32_16x16x32_bf16 v[192:195], v[72:75], v[208:211], v[192:195]
    v_mfma_f32_16x16x32_bf16 v[196:199], v[76:79], v[208:211], v[196:199]
    s_waitcnt lgkmcnt(0)
    s_waitcnt vmcnt(0)
    s_barrier
    v_mfma_f32_16x16x32_bf16 v[128:131], v[112:115], v[80:83], v[128:131]
    ds_read_b64_tr_b16 v[64:65], v8 offset:16384
    v_mfma_f32_16x16x32_bf16 v[132:135], v[116:119], v[80:83], v[132:135]
    ds_read_b64_tr_b16 v[66:67], v9 offset:16384
    v_mfma_f32_16x16x32_bf16 v[144:147], v[112:115], v[88:91], v[144:147]
    ds_read_b64_tr_b16 v[68:69], v10 offset:16384
    v_mfma_f32_16x16x32_bf16 v[148:151], v[116:119], v[88:91], v[148:151]
    ds_read_b64_tr_b16 v[70:71], v11 offset:16384
    v_mfma_f32_16x16x32_bf16 v[160:163], v[112:115], v[96:99], v[160:163]
    ds_read_b64_tr_b16 v[72:73], v8 offset:24576
    v_mfma_f32_16x16x32_bf16 v[164:167], v[116:119], v[96:99], v[164:167]
    ds_read_b64_tr_b16 v[74:75], v9 offset:24576
    v_mfma_f32_16x16x32_bf16 v[176:179], v[112:115], v[104:107], v[176:179]
    ds_read_b64_tr_b16 v[76:77], v10 offset:24576
    v_mfma_f32_16x16x32_bf16 v[180:183], v[116:119], v[104:107], v[180:183]
    ds_read_b64_tr_b16 v[78:79], v11 offset:24576
    v_mfma_f32_16x16x32_bf16 v[192:195], v[112:115], v[208:211], v[192:195]
    ds_read_b128 v[32:35], v24 offset:0
    v_mfma_f32_16x16x32_bf16 v[196:199], v[116:119], v[208:211], v[196:199]
    ds_read_b128 v[36:39], v25 offset:0
    v_mfma_f32_16x16x32_bf16 v[128:131], v[120:123], v[84:87], v[128:131]
    ds_read_b128 v[40:43], v24 offset:2048
    v_mfma_f32_16x16x32_bf16 v[132:135], v[124:127], v[84:87], v[132:135]
    ds_read_b128 v[44:47], v25 offset:2048
    v_mfma_f32_16x16x32_bf16 v[144:147], v[120:123], v[92:95], v[144:147]
    ds_read_b128 v[48:51], v24 offset:4096
    v_mfma_f32_16x16x32_bf16 v[148:151], v[124:127], v[92:95], v[148:151]
    ds_read_b128 v[52:55], v25 offset:4096
    v_mfma_f32_16x16x32_bf16 v[160:163], v[120:123], v[100:103], v[160:163]
    ds_read_b128 v[56:59], v24 offset:6144
    v_mfma_f32_16x16x32_bf16 v[164:167], v[124:127], v[100:103], v[164:167]
    ds_read_b128 v[60:63], v25 offset:6144
    v_mfma_f32_16x16x32_bf16 v[176:179], v[120:123], v[108:111], v[176:179]
    v_mfma_f32_16x16x32_bf16 v[180:183], v[124:127], v[108:111], v[180:183]
    v_mfma_f32_16x16x32_bf16 v[192:195], v[120:123], v[208:211], v[192:195]
    v_mfma_f32_16x16x32_bf16 v[196:199], v[124:127], v[208:211], v[196:199]
    s_waitcnt lgkmcnt(0)
    v_and_b32 v20, 0xf0, v1
    v_lshrrev_b32 v20, 1, v20
    s_lshl_b32 s30, s26, 9
    s_add_u32 s30, s30, 188743680
    s_mov_b32 s31, 0x40000
    v_and_b32 v21, 1, v4
    v_lshlrev_b32 v21, 10, v21
    v_xor_b32 v8, v21, v8
    v_xor_b32 v9, v21, v9
    v_xor_b32 v10, v21, v10
    v_xor_b32 v11, v21, v11
    v_xor_b32 v12, v21, v12
    v_xor_b32 v13, v21, v13
    v_xor_b32 v14, v21, v14
    v_xor_b32 v15, v21, v15
w_stX:
    buffer_load_dword v22, off, s[64:67], 0 offset:192 sc1
    buffer_load_dwordx2 v[24:25], v20, s[4:7], s30 offen offset:0 sc1
    buffer_load_dwordx2 v[26:27], v20, s[4:7], s30 offen offset:128 sc1
    buffer_load_dwordx2 v[28:29], v20, s[4:7], s30 offen offset:256 sc1
    buffer_load_dwordx2 v[30:31], v20, s[4:7], s30 offen offset:384 sc1
    s_waitcnt vmcnt(0)
    v_readfirstlane_b32 s29, v22
    s_cmp_ge_u32 s29, 32
    s_cbranch_scc1 w_stXok
    s_sleep 4
    s_sub_u32 s31, s31, 1
    s_cbranch_scc0 w_stX
w_stXok:
    buffer_load_dword v22, off, s[64:67], 0 sc1
    v_fma_f32 v128, -v24, v192, v128
    v_fma_f32 v129, -v24, v193, v129
    v_fma_f32 v130, -v24, v194, v130
    v_fma_f32 v131, -v24, v195, v131
    v_fma_f32 v132, -v24, v196, v132
    v_fma_f32 v133, -v24, v197, v133
    v_fma_f32 v134, -v24, v198, v134
    v_fma_f32 v135, -v24, v199, v135
    v_mul_f32 v128, v128, v25
    v_mul_f32 v129, v129, v25
    v_mul_f32 v130, v130, v25
    v_mul_f32 v131, v131, v25
    v_mul_f32 v132, v132, v25
    v_mul_f32 v133, v133, v25
    v_mul_f32 v134, v134, v25
    v_mul_f32 v135, v135, v25
    v_fma_f32 v144, -v26, v192, v144
    v_fma_f32 v145, -v26, v193, v145
    v_fma_f32 v146, -v26, v194, v146
    v_fma_f32 v147, -v26, v195, v147
    v_fma_f32 v148, -v26, v196, v148
    v_fma_f32 v149, -v26, v197, v149
    v_fma_f32 v150, -v26, v198, v150
    v_fma_f32 v151, -v26, v199, v151
    v_mul_f32 v144, v144, v27
    v_mul_f32 v145, v145, v27
    v_mul_f32 v146, v146, v27
    v_mul_f32 v147, v147, v27
    v_mul_f32 v148, v148, v27
    v_mul_f32 v149, v149, v27
    v_mul_f32 v150, v150, v27
    v_mul_f32 v151, v151, v27
    v_fma_f32 v160, -v28, v192, v160
    v_fma_f32 v161, -v28, v193, v161
    v_fma_f32 v162, -v28, v194, v162
    v_fma_f32 v163, -v28, v195, v163
    v_fma_f32 v164, -v28, v196, v164
    v_fma_f32 v165, -v28, v197, v165
    v_fma_f32 v166, -v28, v198, v166
    v_fma_f32 v167, -v28, v199, v167
    v_mul_f32 v160, v160, v29
    v_mul_f32 v161, v161, v29
    v_mul_f32 v162, v162, v29
    v_mul_f32 v163, v163, v29
    v_mul_f32 v164, v164, v29
    v_mul_f32 v165, v165, v29
    v_mul_f32 v166, v166, v29
    v_mul_f32 v167, v167, v29
    v_fma_f32 v176, -v30, v192, v176
    v_fma_f32 v177, -v30, v193, v177
    v_fma_f32 v178, -v30, v194, v178
    v_fma_f32 v179, -v30, v195, v179
    v_fma_f32 v180, -v30, v196, v180
    v_fma_f32 v181, -v30, v197, v181
    v_fma_f32 v182, -v30, v198, v182
    v_fma_f32 v183, -v30, v199, v183
    v_mul_f32 v176, v176, v31
    v_mul_f32 v177, v177, v31
    v_mul_f32 v178, v178, v31
    v_mul_f32 v179, v179, v31
    v_mul_f32 v180, v180, v31
    v_mul_f32 v181, v181, v31
    v_mul_f32 v182, v182, v31
    v_mul_f32 v183, v183, v31
    s_lshl_b32 s30, s27, 10
    s_add_u32 s30, s30, s49
    s_nop 7
    v_cvt_pk_bf16_f32 v80, v128, v129
    v_cvt_pk_bf16_f32 v81, v130, v131
    v_cvt_pk_bf16_f32 v82, v132, v133
    v_cvt_pk_bf16_f32 v83, v134, v135
    buffer_store_dwordx4 v[80:83], v1, s[4:7], s30 offen sc1
    s_add_u32 s30, s30, s50
    v_cvt_pk_bf16_f32 v84, v144, v145
    v_cvt_pk_bf16_f32 v85, v146, v147
    v_cvt_pk_bf16_f32 v86, v148, v149
    v_cvt_pk_bf16_f32 v87, v150, v151
    buffer_store_dwordx4 v[84:87], v1, s[4:7], s30 offen sc1
    s_add_u32 s30, s30, s50
    v_cvt_pk_bf16_f32 v88, v160, v161
    v_cvt_pk_bf16_f32 v89, v162, v163
    v_cvt_pk_bf16_f32 v90, v164, v165
    v_cvt_pk_bf16_f32 v91, v166, v167
    buffer_store_dwordx4 v[88:91], v1, s[4:7], s30 offen sc1
    s_add_u32 s30, s30, s50
    v_cvt_pk_bf16_f32 v92, v176, v177
    v_cvt_pk_bf16_f32 v93, v178, v179
    v_cvt_pk_bf16_f32 v94, v180, v181
    v_cvt_pk_bf16_f32 v95, v182, v183
    buffer_store_dwordx4 v[92:95], v1, s[4:7], s30 offen sc1
    s_add_u32 s30, s30, s50
    s_mov_b32 s28, s51
    s_mov_b32 s57, s53
    s_branch w_drain
w_firstM:
    s_waitcnt vmcnt(6)
    s_barrier
    s_add_u32 m0, s21, 0
    s_nop 0
    buffer_load_dwordx4 v1, s[4:7], s16 offen sc1 lds
    s_add_u32 s16, s16, s62
    s_add_u32 m0, s22, 0
    s_nop 0
    buffer_load_dwordx4 v2, s[8:11], s18 offen lds
    s_add_u32 s18, s18, s20
    s_add_u32 m0, s22, 8192
    s_nop 0
    buffer_load_dwordx4 v2, s[12:15], s19 offen lds
    s_add_u32 s19, s19, s20
    v_mfma_f32_16x16x32_bf16 v[128:131], v[64:67], v[32:35], 0
    ds_read_b64_tr_b16 v[112:113], v8 offset:49152
    v_mfma_f32_16x16x32_bf16 v[132:135], v[68:71], v[32:35], 0
    ds_read_b64_tr_b16 v[114:115], v9 offset:49152
    v_mfma_f32_16x16x32_bf16 v[136:139], v[72:75], v[32:35], 0
    ds_read_b64_tr_b16 v[116:117], v10 offset:49152
    v_mfma_f32_16x16x32_bf16 v[140:143], v[76:79], v[32:35], 0
    ds_read_b64_tr_b16 v[118:119], v11 offset:49152
    v_mfma_f32_16x16x32_bf16 v[144:147], v[64:67], v[40:43], 0
    ds_read_b64_tr_b16 v[120:121], v8 offset:57344
    v_mfma_f32_16x16x32_bf16 v[148:151], v[68:71], v[40:43], 0
    ds_read_b64_tr_b16 v[122:123], v9 offset:57344
    v_mfma_f32_16x16x32_bf16 v[152:155], v[72:75], v[40:43], 0
    ds_read_b64_tr_b16 v[124:125], v10 offset:57344
    v_mfma_f32_16x16x32_bf16 v[156:159], v[76:79], v[40:43], 0
    ds_read_b64_tr_b16 v[126:127], v11 offset:57344
    v_mfma_f32_16x16x32_bf16 v[160:163], v[64:67], v[48:51], 0
    ds_read_b128 v[80:83], v5 offset:32768
    v_mfma_f32_16x16x32_bf16 v[164:167], v[68:71], v[48:51], 0
    ds_read_b128 v[88:91], v5 offset:34816
    v_mfma_f32_16x16x32_bf16 v[168:171], v[72:75], v[48:51], 0
    ds_read_b128 v[96:99], v5 offset:36864
    v_mfma_f32_16x16x32_bf16 v[172:175], v[76:79], v[48:51], 0
    ds_read_b128 v[104:107], v5 offset:38912
    v_mfma_f32_16x16x32_bf16 v[176:179], v[64:67], v[56:59], 0
    v_mfma_f32_16x16x32_bf16 v[180:183], v[68:71], v[56:59], 0
    v_mfma_f32_16x16x32_bf16 v[184:187], v[72:75], v[56:59], 0
    v_mfma_f32_16x16x32_bf16 v[188:191], v[76:79], v[56:59], 0
    s_waitcnt lgkmcnt(0)
    s_waitcnt vmcnt(6)
    s_barrier
    s_add_u32 m0, s21, 32768
    s_nop 0
    buffer_load_dwordx4 v1, s[4:7], s16 offen sc1 lds
    s_add_u32 s16, s16, s62
    s_add_u32 m0, s22, 32768
    s_nop 0
    buffer_load_dwordx4 v2, s[8:11], s18 offen lds
    s_add_u32 s18, s18, s20
    s_add_u32 m0, s22, 40960
    s_nop 0
    buffer_load_dwordx4 v2, s[12:15], s19 offen lds
    s_add_u32 s19, s19, s20
    v_mfma_f32_16x16x32_bf16 v[128:131], v[112:115], v[80:83], v[128:131]
    ds_read_b64_tr_b16 v[64:65], v12 offset:16384
    v_mfma_f32_16x16x32_bf16 v[132:135], v[116:119], v[80:83], v[132:135]
    ds_read_b64_tr_b16 v[66:67], v13 offset:16384
    v_mfma_f32_16x16x32_bf16 v[136:139], v[120:123], v[80:83], v[136:139]
    ds_read_b64_tr_b16 v[68:69], v14 offset:16384
    v_mfma_f32_16x16x32_bf16 v[140:143], v[124:127], v[80:83], v[140:143]
    ds_read_b64_tr_b16 v[70:71], v15 offset:16384
    v_mfma_f32_16x16x32_bf16 v[144:147], v[112:115], v[88:91], v[144:147]
    ds_read_b64_tr_b16 v[72:73], v12 offset:24576
    v_mfma_f32_16x16x32_bf16 v[148:151], v[116:119], v[88:91], v[148:151]
    ds_read_b64_tr_b16 v[74:75], v13 offset:24576
    v_mfma_f32_16x16x32_bf16 v[152:155], v[120:123], v[88:91], v[152:155]
    ds_read_b64_tr_b16 v[76:77], v14 offset:24576
    v_mfma_f32_16x16x32_bf16 v[156:159], v[124:127], v[88:91], v[156:159]
    ds_read_b64_tr_b16 v[78:79], v15 offset:24576
    v_mfma_f32_16x16x32_bf16 v[160:163], v[112:115], v[96:99], v[160:163]
    ds_read_b128 v[32:35], v6 offset:0
    v_mfma_f32_16x16x32_bf16 v[164:167], v[116:119], v[96:99], v[164:167]
    ds_read_b128 v[40:43], v6 offset:2048
    v_mfma_f32_16x16x32_bf16 v[168:171], v[120:123], v[96:99], v[168:171]
    ds_read_b128 v[48:51], v6 offset:4096
    v_mfma_f32_16x16x32_bf16 v[172:175], v[124:127], v[96:99], v[172:175]
    ds_read_b128 v[56:59], v6 offset:6144
    v_mfma_f32_16x16x32_bf16 v[176:179], v[112:115], v[104:107], v[176:179]
    v_mfma_f32_16x16x32_bf16 v[180:183], v[116:119], v[104:107], v[180:183]
    v_mfma_f32_16x16x32_bf16 v[184:187], v[120:123], v[104:107], v[184:187]
    v_mfma_f32_16x16x32_bf16 v[188:191], v[124:127], v[104:107], v[188:191]
    s_waitcnt lgkmcnt(0)
    s_waitcnt vmcnt(6)
    s_barrier
    s_add_u32 m0, s21, 65536
    s_nop 0
    buffer_load_dwordx4 v1, s[4:7], s16 offen sc1 lds
    s_add_u32 s16, s16, s62
    s_add_u32 m0, s22, 65536
    s_nop 0
    buffer_load_dwordx4 v2, s[8:11], s18 offen lds
    s_add_u32 s18, s18, s20
    s_add_u32 m0, s22, 73728
    s_nop 0
    buffer_load_dwordx4 v2, s[12:15], s19 offen lds
    s_add_u32 s19, s19, s20
    v_mfma_f32_16x16x32_bf16 v[128:131], v[64:67], v[32:35], v[128:131]
    ds_read_b64_tr_b16 v[112:113], v12 offset:49152
    v_mfma_f32_16x16x32_bf16 v[132:135], v[68:71], v[32:35], v[132:135]
    ds_read_b64_tr_b16 v[114:115], v13 offset:49152
    v_mfma_f32_16x16x32_bf16 v[136:139], v[72:75], v[32:35], v[136:139]
    ds_read_b64_tr_b16 v[116:117], v14 offset:49152
    v_mfma_f32_16x16x32_bf16 v[140:143], v[76:79], v[32:35], v[140:143]
    ds_read_b64_tr_b16 v[118:119], v15 offset:49152
    v_mfma_f32_16x16x32_bf16 v[144:147], v[64:67], v[40:43], v[144:147]
    ds_read_b64_tr_b16 v[120:121], v12 offset:57344
    v_mfma_f32_16x16x32_bf16 v[148:151], v[68:71], v[40:43], v[148:151]
    ds_read_b64_tr_b16 v[122:123], v13 offset:57344
    v_mfma_f32_16x16x32_bf16 v[152:155], v[72:75], v[40:43], v[152:155]
    ds_read_b64_tr_b16 v[124:125], v14 offset:57344
    v_mfma_f32_16x16x32_bf16 v[156:159], v[76:79], v[40:43], v[156:159]
    ds_read_b64_tr_b16 v[126:127], v15 offset:57344
    v_mfma_f32_16x16x32_bf16 v[160:163], v[64:67], v[48:51], v[160:163]
    ds_read_b128 v[80:83], v6 offset:32768
    v_mfma_f32_16x16x32_bf16 v[164:167], v[68:71], v[48:51], v[164:167]
    ds_read_b128 v[88:91], v6 offset:34816
    v_mfma_f32_16x16x32_bf16 v[168:171], v[72:75], v[48:51], v[168:171]
    ds_read_b128 v[96:99], v6 offset:36864
    v_mfma_f32_16x16x32_bf16 v[172:175], v[76:79], v[48:51], v[172:175]
    ds_read_b128 v[104:107], v6 offset:38912
    v_mfma_f32_16x16x32_bf16 v[176:179], v[64:67], v[56:59], v[176:179]
    v_mfma_f32_16x16x32_bf16 v[180:183], v[68:71], v[56:59], v[180:183]
    v_mfma_f32_16x16x32_bf16 v[184:187], v[72:75], v[56:59], v[184:187]
    v_mfma_f32_16x16x32_bf16 v[188:191], v[76:79], v[56:59], v[188:191]
    s_waitcnt lgkmcnt(0)
    s_waitcnt vmcnt(6)
    s_barrier
    s_add_u32 m0, s21, 98304
    s_nop 0
    buffer_load_dwordx4 v1, s[4:7], s16 offen sc1 lds
    s_add_u32 s16, s16, s62
    s_add_u32 m0, s22, 98304
    s_nop 0
    buffer_load_dwordx4 v2, s[8:11], s18 offen lds
    s_add_u32 s18, s18, s20
    s_add_u32 m0, s22, 106496
    s_nop 0
    buffer_load_dwordx4 v2, s[12:15], s19 offen lds
    s_add_u32 s19, s19, s20
    v_mfma_f32_16x16x32_bf16 v[128:131], v[112:115], v[80:83], v[128:131]
    ds_read_b64_tr_b16 v[64:65], v8 offset:16384
    v_mfma_f32_16x16x32_bf16 v[132:135], v[116:119], v[80:83], v[132:135]
    ds_read_b64_tr_b16 v[66:67], v9 offset:16384
    v_mfma_f32_16x16x32_bf16 v[136:139], v[120:123], v[80:83], v[136:139]
    ds_read_b64_tr_b16 v[68:69], v10 offset:16384
    v_mfma_f32_16x16x32_bf16 v[140:143], v[124:127], v[80:83], v[140:143]
    ds_read_b64_tr_b16 v[70:71], v11 offset:16384
    v_mfma_f32_16x16x32_bf16 v[144:147], v[112:115], v[88:91], v[144:147]
    ds_read_b64_tr_b16 v[72:73], v8 offset:24576
    v_mfma_f32_16x16x32_bf16 v[148:151], v[116:119], v[88:91], v[148:151]
    ds_read_b64_tr_b16 v[74:75], v9 offset:24576
    v_mfma_f32_16x16x32_bf16 v[152:155], v[120:123], v[88:91], v[152:155]
    ds_read_b64_tr_b16 v[76:77], v10 offset:24576
    v_mfma_f32_16x16x32_bf16 v[156:159], v[124:127], v[88:91], v[156:159]
    ds_read_b64_tr_b16 v[78:79], v11 offset:24576
    v_mfma_f32_16x16x32_bf16 v[160:163], v[112:115], v[96:99], v[160:163]
    ds_read_b128 v[32:35], v5 offset:0
    v_mfma_f32_16x16x32_bf16 v[164:167], v[116:119], v[96:99], v[164:167]
    ds_read_b128 v[40:43], v5 offset:2048
    v_mfma_f32_16x16x32_bf16 v[168:171], v[120:123], v[96:99], v[168:171]
    ds_read_b128 v[48:51], v5 offset:4096
    v_mfma_f32_16x16x32_bf16 v[172:175], v[124:127], v[96:99], v[172:175]
    ds_read_b128 v[56:59], v5 offset:6144
    v_mfma_f32_16x16x32_bf16 v[176:179], v[112:115], v[104:107], v[176:179]
    v_mfma_f32_16x16x32_bf16 v[180:183], v[116:119], v[104:107], v[180:183]
    v_mfma_f32_16x16x32_bf16 v[184:187], v[120:123], v[104:107], v[184:187]
    v_mfma_f32_16x16x32_bf16 v[188:191], v[124:127], v[104:107], v[188:191]
    s_waitcnt lgkmcnt(0)
w_loop_chkM:
    s_sub_u32 s23, s23, 1
w_loopM:
    s_cmp_lg_u32 s23, 1
    s_cbranch_scc1 w_bodyM
    v_readfirstlane_b32 s68, v22
    s_cmp_ge_u32 s68, 128
    s_cselect_b32 s70, 0, s70
    v_readfirstlane_b32 s30, v16
    s_cmp_ge_u32 s30, s45
    s_cselect_b32 s30, 0, 1
    s_or_b32 s30, s30, s70
    s_cmp_ge_u32 s32, 4
    s_cselect_b32 s30, 1, s30
    s_cmp_eq_u32 s32, 0
    s_cselect_b32 s30, 1, s30
    v_mov_b32 v20, s30
    ds_write_b32 v7, v20
    s_cbranch_scc1 w_bodyM
    s_load_dwordx2 s[8:9], s[0:1], s33
    s_load_dwordx2 s[12:13], s[0:1], s34
    s_mov_b32 s10, s38
    s_mov_b32 s14, s38
    s_cmp_ge_u32 s32, 4
    s_cselect_b32 s31, 0, 1
    s_lshl_b32 s30, s3, s31
    s_mul_i32 s30, s30, s40
    s_add_u32 s16, s39, s30
    s_cmp_eq_u32 s32, 4
    s_cselect_b32 s30, 1024, s40
    s_cselect_b32 s31, 6, 5
    s_lshl_b32 s62, 32, s31
    s_add_u32 s17, s16, s30
    s_lshl_b32 s30, s3, 2
    s_mul_i32 s30, s30, s35
    s_add_u32 s18, s36, s30
    s_add_u32 s19, s37, s30
    s_lshl_b32 s20, s35, s31
    v_mul_u32_u24 v2, s35, v4
    v_add_u32 v2, v2, v3
    s_waitcnt lgkmcnt(0)
    s_waitcnt vmcnt(6)
    s_barrier
    s_add_u32 m0, s21, 0
    s_nop 0
    buffer_load_dwordx4 v1, s[4:7], s16 offen sc1 lds
    s_add_u32 s16, s16, s62
    s_add_u32 m0, s21, 1024
    s_nop 0
    buffer_load_dwordx4 v1, s[4:7], s17 offen sc1 lds
    s_add_u32 s17, s17, s62
    s_add_u32 m0, s22, 0
    s_nop 0
    buffer_load_dwordx4 v2, s[8:11], s18 offen lds
    s_add_u32 s18, s18, s20
    s_add_u32 m0, s22, 8192
    s_nop 0
    buffer_load_dwordx4 v2, s[12:15], s19 offen lds
    s_add_u32 s19, s19, s20
    v_mfma_f32_16x16x32_bf16 v[128:131], v[64:67], v[32:35], v[128:131]
    ds_read_b64_tr_b16 v[112:113], v8 offset:49152
    v_mfma_f32_16x16x32_bf16 v[132:135], v[68:71], v[32:35], v[132:135]
    ds_read_b64_tr_b16 v[114:115], v9 offset:49152
    v_mfma_f32_16x16x32_bf16 v[136:139], v[72:75], v[32:35], v[136:139]
    ds_read_b64_tr_b16 v[116:117], v10 offset:49152
    v_mfma_f32_16x16x32_bf16 v[140:143], v[76:79], v[32:35], v[140:143]
    ds_read_b64_tr_b16 v[118:119], v11 offset:49152
    v_mfma_f32_16x16x32_bf16 v[144:147], v[64:67], v[40:43], v[144:147]
    ds_read_b64_tr_b16 v[120:121], v8 offset:57344
    v_mfma_f32_16x16x32_bf16 v[148:151], v[68:71], v[40:43], v[148:151]
    ds_read_b64_tr_b16 v[122:123], v9 offset:57344
    v_mfma_f32_16x16x32_bf16 v[152:155], v[72:75], v[40:43], v[152:155]
    ds_read_b64_tr_b16 v[124:125], v10 offset:57344
    v_mfma_f32_16x16x32_bf16 v[156:159], v[76:79], v[40:43], v[156:159]
    ds_read_b64_tr_b16 v[126:127], v11 offset:57344
    v_mfma_f32_16x16x32_bf16 v[160:163], v[64:67], v[48:51], v[160:163]
    ds_read_b128 v[80:83], v5 offset:32768
    v_mfma_f32_16x16x32_bf16 v[164:167], v[68:71], v[48:51], v[164:167]
    ds_read_b128 v[88:91], v5 offset:34816
    v_mfma_f32_16x16x32_bf16 v[168:171], v[72:75], v[48:51], v[168:171]
    ds_read_b128 v[96:99], v5 offset:36864
    v_mfma_f32_16x16x32_bf16 v[172:175], v[76:79], v[48:51], v[172:175]
    ds_read_b128 v[104:107], v5 offset:38912
    v_mfma_f32_16x16x32_bf16 v[176:179], v[64:67], v[56:59], v[176:179]
    v_mfma_f32_16x16x32_bf16 v[180:183], v[68:71], v[56:59], v[180:183]
    v_mfma_f32_16x16x32_bf16 v[184:187], v[72:75], v[56:59], v[184:187]
    v_mfma_f32_16x16x32_bf16 v[188:191], v[76:79], v[56:59], v[188:191]
    s_waitcnt lgkmcnt(0)
    s_waitcnt vmcnt(7)
    s_barrier
    s_add_u32 m0, s21, 32768
    s_nop 0
    buffer_load_dwordx4 v1, s[4:7], s16 offen sc1 lds
    s_add_u32 s16, s16, s62
    s_add_u32 m0, s21, 33792
    s_nop 0
    buffer_load_dwordx4 v1, s[4:7], s17 offen sc1 lds
    s_add_u32 s17, s17, s62
    s_add_u32 m0, s22, 32768
    s_nop 0
    buffer_load_dwordx4 v2, s[8:11], s18 offen lds
    s_add_u32 s18, s18, s20
    s_add_u32 m0, s22, 40960
    s_nop 0
    buffer_load_dwordx4 v2, s[12:15], s19 offen lds
    s_add_u32 s19, s19, s20
    v_mfma_f32_16x16x32_bf16 v[128:131], v[112:115], v[80:83], v[128:131]
    ds_read_b64_tr_b16 v[64:65], v12 offset:16384
    v_mfma_f32_16x16x32_bf16 v[132:135], v[116:119], v[80:83], v[132:135]
    ds_read_b64_tr_b16 v[66:67], v13 offset:16384
    v_mfma_f32_16x16x32_bf16 v[136:139], v[120:123], v[80:83], v[136:139]
    ds_read_b64_tr_b16 v[68:69], v14 offset:16384
    v_mfma_f32_16x16x32_bf16 v[140:143], v[124:127], v[80:83], v[140:143]
    ds_read_b64_tr_b16 v[70:71], v15 offset:16384
    v_mfma_f32_16x16x32_bf16 v[144:147], v[112:115], v[88:91], v[144:147]
    ds_read_b64_tr_b16 v[72:73], v12 offset:24576
    v_mfma_f32_16x16x32_bf16 v[148:151], v[116:119], v[88:91], v[148:151]
    ds_read_b64_tr_b16 v[74:75], v13 offset:24576
    v_mfma_f32_16x16x32_bf16 v[152:155], v[120:123], v[88:91], v[152:155]
    ds_read_b64_tr_b16 v[76:77], v14 offset:24576
    v_mfma_f32_16x16x32_bf16 v[156:159], v[124:127], v[88:91], v[156:159]
    ds_read_b64_tr_b16 v[78:79], v15 offset:24576
    v_mfma_f32_16x16x32_bf16 v[160:163], v[112:115], v[96:99], v[160:163]
    ds_read_b128 v[32:35], v6 offset:0
    v_mfma_f32_16x16x32_bf16 v[164:167], v[116:119], v[96:99], v[164:167]
    ds_read_b128 v[40:43], v6 offset:2048
    v_mfma_f32_16x16x32_bf16 v[168:171], v[120:123], v[96:99], v[168:171]
    ds_read_b128 v[48:51], v6 offset:4096
    v_mfma_f32_16x16x32_bf16 v[172:175], v[124:127], v[96:99], v[172:175]
    ds_read_b128 v[56:59], v6 offset:6144
    v_mfma_f32_16x16x32_bf16 v[176:179], v[112:115], v[104:107], v[176:179]
    v_mfma_f32_16x16x32_bf16 v[180:183], v[116:119], v[104:107], v[180:183]
    v_mfma_f32_16x16x32_bf16 v[184:187], v[120:123], v[104:107], v[184:187]
    v_mfma_f32_16x16x32_bf16 v[188:191], v[124:127], v[104:107], v[188:191]
    s_waitcnt lgkmcnt(0)
    s_waitcnt vmcnt(8)
    s_barrier
    s_add_u32 m0, s21, 65536
    s_nop 0
    buffer_load_dwordx4 v1, s[4:7], s16 offen sc1 lds
    s_add_u32 s16, s16, s62
    s_add_u32 m0, s21, 66560
    s_nop 0
    buffer_load_dwordx4 v1, s[4:7], s17 offen sc1 lds
    s_add_u32 s17, s17, s62
    s_add_u32 m0, s22, 65536
    s_nop 0
    buffer_load_dwordx4 v2, s[8:11], s18 offen lds
    s_add_u32 s18, s18, s20
    s_add_u32 m0, s22, 73728
    s_nop 0
    buffer_load_dwordx4 v2, s[12:15], s19 offen lds
    s_add_u32 s19, s19, s20
    v_mfma_f32_16x16x32_bf16 v[128:131], v[64:67], v[32:35], v[128:131]
    ds_read_b64_tr_b16 v[112:113], v12 offset:49152
    v_mfma_f32_16x16x32_bf16 v[132:135], v[68:71], v[32:35], v[132:135]
    ds_read_b64_tr_b16 v[114:115], v13 offset:49152
    v_mfma_f32_16x16x32_bf16 v[136:139], v[72:75], v[32:35], v[136:139]
    ds_read_b64_tr_b16 v[116:117], v14 offset:49152
    v_mfma_f32_16x16x32_bf16 v[140:143], v[76:79], v[32:35], v[140:143]
    ds_read_b64_tr_b16 v[118:119], v15 offset:49152
    v_mfma_f32_16x16x32_bf16 v[144:147], v[64:67], v[40:43], v[144:147]
    ds_read_b64_tr_b16 v[120:121], v12 offset:57344
    v_mfma_f32_16x16x32_bf16 v[148:151], v[68:71], v[40:43], v[148:151]
    ds_read_b64_tr_b16 v[122:123], v13 offset:57344
    v_mfma_f32_16x16x32_bf16 v[152:155], v[72:75], v[40:43], v[152:155]
    ds_read_b64_tr_b16 v[124:125], v14 offset:57344
    v_mfma_f32_16x16x32_bf16 v[156:159], v[76:79], v[40:43], v[156:159]
    ds_read_b64_tr_b16 v[126:127], v15 offset:57344
    v_mfma_f32_16x16x32_bf16 v[160:163], v[64:67], v[48:51], v[160:163]
    ds_read_b128 v[80:83], v6 offset:32768
    v_mfma_f32_16x16x32_bf16 v[164:167], v[68:71], v[48:51], v[164:167]
    ds_read_b128 v[88:91], v6 offset:34816
    v_mfma_f32_16x16x32_bf16 v[168:171], v[72:75], v[48:51], v[168:171]
    ds_read_b128 v[96:99], v6 offset:36864
    v_mfma_f32_16x16x32_bf16 v[172:175], v[76:79], v[48:51], v[172:175]
    ds_read_b128 v[104:107], v6 offset:38912
    v_mfma_f32_16x16x32_bf16 v[176:179], v[64:67], v[56:59], v[176:179]
    v_mfma_f32_16x16x32_bf16 v[180:183], v[68:71], v[56:59], v[180:183]
    v_mfma_f32_16x16x32_bf16 v[184:187], v[72:75], v[56:59], v[184:187]
    v_mfma_f32_16x16x32_bf16 v[188:191], v[76:79], v[56:59], v[188:191]
    s_waitcnt lgkmcnt(0)
    s_waitcnt vmcnt(8)
    s_barrier
    s_add_u32 m0, s21, 98304
    s_nop 0
    buffer_load_dwordx4 v1, s[4:7], s16 offen sc1 lds
    s_add_u32 s16, s16, s62
    s_add_u32 m0, s21, 99328
    s_nop 0
    buffer_load_dwordx4 v1, s[4:7], s17 offen sc1 lds
    s_add_u32 s17, s17, s62
    s_add_u32 m0, s22, 98304
    s_nop 0
    buffer_load_dwordx4 v2, s[8:11], s18 offen lds
    s_add_u32 s18, s18, s20
    s_add_u32 m0, s22, 106496
    s_nop 0
    buffer_load_dwordx4 v2, s[12:15], s19 offen lds
    s_add_u32 s19, s19, s20
    v_mfma_f32_16x16x32_bf16 v[128:131], v[112:115], v[80:83], v[128:131]
    ds_read_b64_tr_b16 v[64:65], v8 offset:16384
    v_mfma_f32_16x16x32_bf16 v[132:135], v[116:119], v[80:83], v[132:135]
    ds_read_b64_tr_b16 v[66:67], v9 offset:16384
    v_mfma_f32_16x16x32_bf16 v[136:139], v[120:123], v[80:83], v[136:139]
    ds_read_b64_tr_b16 v[68:69], v10 offset:16384
    v_mfma_f32_16x16x32_bf16 v[140:143], v[124:127], v[80:83], v[140:143]
    ds_read_b64_tr_b16 v[70:71], v11 offset:16384
    v_mfma_f32_16x16x32_bf16 v[144:147], v[112:115], v[88:91], v[144:147]
    ds_read_b64_tr_b16 v[72:73], v8 offset:24576
    v_mfma_f32_16x16x32_bf16 v[148:151], v[116:119], v[88:91], v[148:151]
    ds_read_b64_tr_b16 v[74:75], v9 offset:24576
    v_mfma_f32_16x16x32_bf16 v[152:155], v[120:123], v[88:91], v[152:155]
    ds_read_b64_tr_b16 v[76:77], v10 offset:24576
    v_mfma_f32_16x16x32_bf16 v[156:159], v[124:127], v[88:91], v[156:159]
    ds_read_b64_tr_b16 v[78:79], v11 offset:24576
    v_mfma_f32_16x16x32_bf16 v[160:163], v[112:115], v[96:99], v[160:163]
    ds_read_b128 v[32:35], v5 offset:0
    v_mfma_f32_16x16x32_bf16 v[164:167], v[116:119], v[96:99], v[164:167]
    ds_read_b128 v[36:39], v5 offset:1024
    v_mfma_f32_16x16x32_bf16 v[168:171], v[120:123], v[96:99], v[168:171]
    ds_read_b128 v[40:43], v5 offset:2048
    v_mfma_f32_16x16x32_bf16 v[172:175], v[124:127], v[96:99], v[172:175]
    ds_read_b128 v[44:47], v5 offset:3072
    v_mfma_f32_16x16x32_bf16 v[176:179], v[112:115], v[104:107], v[176:179]
    ds_read_b128 v[48:51], v5 offset:4096
    v_mfma_f32_16x16x32_bf16 v[180:183], v[116:119], v[104:107], v[180:183]
    ds_read_b128 v[52:55], v5 offset:5120
    v_mfma_f32_16x16x32_bf16 v[184:187], v[120:123], v[104:107], v[184:187]
    ds_read_b128 v[56:59], v5 offset:6144
    v_mfma_f32_16x16x32_bf16 v[188:191], v[124:127], v[104:107], v[188:191]
    ds_read_b128 v[60:63], v5 offset:7168
    s_waitcnt lgkmcnt(0)
    s_branch w_doneM
w_bodyM:
    buffer_load_dword v22, off, s[64:67], 0 sc1
    s_waitcnt vmcnt(6)
    s_barrier
    s_add_u32 m0, s21, 0
    s_nop 0
    buffer_load_dwordx4 v1, s[4:7], s16 offen sc1 lds
    s_add_u32 s16, s16, s62
    s_add_u32 m0, s22, 0
    s_nop 0
    buffer_load_dwordx4 v2, s[8:11], s18 offen lds
    s_add_u32 s18, s18, s20
    s_add_u32 m0, s22, 8192
    s_nop 0
    buffer_load_dwordx4 v2, s[12:15], s19 offen lds
    s_add_u32 s19, s19, s20
    v_mfma_f32_16x16x32_bf16 v[128:131], v[64:67], v[32:35], v[128:131]
    ds_read_b64_tr_b16 v[112:113], v8 offset:49152
    v_mfma_f32_16x16x32_bf16 v[132:135], v[68:71], v[32:35], v[132:135]
    ds_read_b64_tr_b16 v[114:115], v9 offset:49152
    v_mfma_f32_16x16x32_bf16 v[136:139], v[72:75], v[32:35], v[136:139]
    ds_read_b64_tr_b16 v[116:117], v10 offset:49152
    v_mfma_f32_16x16x32_bf16 v[140:143], v[76:79], v[32:35], v[140:143]
    ds_read_b64_tr_b16 v[118:119], v11 offset:49152
    v_mfma_f32_16x16x32_bf16 v[144:147], v[64:67], v[40:43], v[144:147]
    ds_read_b64_tr_b16 v[120:121], v8 offset:57344
    v_mfma_f32_16x16x32_bf16 v[148:151], v[68:71], v[40:43], v[148:151]
    ds_read_b64_tr_b16 v[122:123], v9 offset:57344
    v_mfma_f32_16x16x32_bf16 v[152:155], v[72:75], v[40:43], v[152:155]
    ds_read_b64_tr_b16 v[124:125], v10 offset:57344
    v_mfma_f32_16x16x32_bf16 v[156:159], v[76:79], v[40:43], v[156:159]
    ds_read_b64_tr_b16 v[126:127], v11 offset:57344
    v_mfma_f32_16x16x32_bf16 v[160:163], v[64:67], v[48:51], v[160:163]
    ds_read_b128 v[80:83], v5 offset:32768
    v_mfma_f32_16x16x32_bf16 v[164:167], v[68:71], v[48:51], v[164:167]
    ds_read_b128 v[88:91], v5 offset:34816
    v_mfma_f32_16x16x32_bf16 v[168:171], v[72:75], v[48:51], v[168:171]
    ds_read_b128 v[96:99], v5 offset:36864
    v_mfma_f32_16x16x32_bf16 v[172:175], v[76:79], v[48:51], v[172:175]
    ds_read_b128 v[104:107], v5 offset:38912
    v_mfma_f32_16x16x32_bf16 v[176:179], v[64:67], v[56:59], v[176:179]
    v_mfma_f32_16x16x32_bf16 v[180:183], v[68:71], v[56:59], v[180:183]
    v_mfma_f32_16x16x32_bf16 v[184:187], v[72:75], v[56:59], v[184:187]
    v_mfma_f32_16x16x32_bf16 v[188:191], v[76:79], v[56:59], v[188:191]
    buffer_load_dword v16, v17, s[4:7], s44 offen sc1
    s_waitcnt lgkmcnt(0)
    s_waitcnt vmcnt(6)
    s_barrier
    s_add_u32 m0, s21, 32768
    s_nop 0
    buffer_load_dwordx4 v1, s[4:7], s16 offen sc1 lds
    s_add_u32 s16, s16, s62
    s_add_u32 m0, s22, 32768
    s_nop 0
    buffer_load_dwordx4 v2, s[8:11], s18 offen lds
    s_add_u32 s18, s18, s20
    s_add_u32 m0, s22, 40960
    s_nop 0
    buffer_load_dwordx4 v2, s[12:15], s19 offen lds
    s_add_u32 s19, s19, s20
    v_mfma_f32_16x16x32_bf16 v[128:131], v[112:115], v[80:83], v[128:131]
    ds_read_b64_tr_b16 v[64:65], v12 offset:16384
    v_mfma_f32_16x16x32_bf16 v[132:135], v[116:119], v[80:83], v[132:135]
    ds_read_b64_tr_b16 v[66:67], v13 offset:16384
    v_mfma_f32_16x16x32_bf16 v[136:139], v[120:123], v[80:83], v[136:139]
    ds_read_b64_tr_b16 v[68:69], v14 offset:16384
    v_mfma_f32_16x16x32_bf16 v[140:143], v[124:127], v[80:83], v[140:143]
    ds_read_b64_tr_b16 v[70:71], v15 offset:16384
    v_mfma_f32_16x16x32_bf16 v[144:147], v[112:115], v[88:91], v[144:147]
    ds_read_b64_tr_b16 v[72:73], v12 offset:24576
    v_mfma_f32_16x16x32_bf16 v[148:151], v[116:119], v[88:91], v[148:151]
    ds_read_b64_tr_b16 v[74:75], v13 offset:24576
    v_mfma_f32_16x16x32_bf16 v[152:155], v[120:123], v[88:91], v[152:155]
    ds_read_b64_tr_b16 v[76:77], v14 offset:24576
    v_mfma_f32_16x16x32_bf16 v[156:159], v[124:127], v[88:91], v[156:159]
    ds_read_b64_tr_b16 v[78:79], v15 offset:24576
    v_mfma_f32_16x16x32_bf16 v[160:163], v[112:115], v[96:99], v[160:163]
    ds_read_b128 v[32:35], v6 offset:0
    v_mfma_f32_16x16x32_bf16 v[164:167], v[116:119], v[96:99], v[164:167]
    ds_read_b128 v[40:43], v6 offset:2048
    v_mfma_f32_16x16x32_bf16 v[168:171], v[120:123], v[96:99], v[168:171]
    ds_read_b128 v[48:51], v6 offset:4096
    v_mfma_f32_16x16x32_bf16 v[172:175], v[124:127], v[96:99], v[172:175]
    ds_read_b128 v[56:59], v6 offset:6144
    v_mfma_f32_16x16x32_bf16 v[176:179], v[112:115], v[104:107], v[176:179]
    v_mfma_f32_16x16x32_bf16 v[180:183], v[116:119], v[104:107], v[180:183]
    v_mfma_f32_16x16x32_bf16 v[184:187], v[120:123], v[104:107], v[184:187]
    v_mfma_f32_16x16x32_bf16 v[188:191], v[124:127], v[104:107], v[188:191]
    s_waitcnt lgkmcnt(0)
    s_waitcnt vmcnt(6)
    s_barrier
    s_add_u32 m0, s21, 65536
    s_nop 0
    buffer_load_dwordx4 v1, s[4:7], s16 offen sc1 lds
    s_add_u32 s16, s16, s62
    s_add_u32 m0, s22, 65536
    s_nop 0
    buffer_load_dwordx4 v2, s[8:11], s18 offen lds
    s_add_u32 s18, s18, s20
    s_add_u32 m0, s22, 73728
    s_nop 0
    buffer_load_dwordx4 v2, s[12:15], s19 offen lds
    s_add_u32 s19, s19, s20
    v_mfma_f32_16x16x32_bf16 v[128:131], v[64:67], v[32:35], v[128:131]
    ds_read_b64_tr_b16 v[112:113], v12 offset:49152
    v_mfma_f32_16x16x32_bf16 v[132:135], v[68:71], v[32:35], v[132:135]
    ds_read_b64_tr_b16 v[114:115], v13 offset:49152
    v_mfma_f32_16x16x32_bf16 v[136:139], v[72:75], v[32:35], v[136:139]
    ds_read_b64_tr_b16 v[116:117], v14 offset:49152
    v_mfma_f32_16x16x32_bf16 v[140:143], v[76:79], v[32:35], v[140:143]
    ds_read_b64_tr_b16 v[118:119], v15 offset:49152
    v_mfma_f32_16x16x32_bf16 v[144:147], v[64:67], v[40:43], v[144:147]
    ds_read_b64_tr_b16 v[120:121], v12 offset:57344
    v_mfma_f32_16x16x32_bf16 v[148:151], v[68:71], v[40:43], v[148:151]
    ds_read_b64_tr_b16 v[122:123], v13 offset:57344
    v_mfma_f32_16x16x32_bf16 v[152:155], v[72:75], v[40:43], v[152:155]
    ds_read_b64_tr_b16 v[124:125], v14 offset:57344
    v_mfma_f32_16x16x32_bf16 v[156:159], v[76:79], v[40:43], v[156:159]
    ds_read_b64_tr_b16 v[126:127], v15 offset:57344
    v_mfma_f32_16x16x32_bf16 v[160:163], v[64:67], v[48:51], v[160:163]
    ds_read_b128 v[80:83], v6 offset:32768
    v_mfma_f32_16x16x32_bf16 v[164:167], v[68:71], v[48:51], v[164:167]
    ds_read_b128 v[88:91], v6 offset:34816
    v_mfma_f32_16x16x32_bf16 v[168:171], v[72:75], v[48:51], v[168:171]
    ds_read_b128 v[96:99], v6 offset:36864
    v_mfma_f32_16x16x32_bf16 v[172:175], v[76:79], v[48:51], v[172:175]
    ds_read_b128 v[104:107], v6 offset:38912
    v_mfma_f32_16x16x32_bf16 v[176:179], v[64:67], v[56:59], v[176:179]
    v_mfma_f32_16x16x32_bf16 v[180:183], v[68:71], v[56:59], v[180:183]
    v_mfma_f32_16x16x32_bf16 v[184:187], v[72:75], v[56:59], v[184:187]
    v_mfma_f32_16x16x32_bf16 v[188:191], v[76:79], v[56:59], v[188:191]
    s_waitcnt lgkmcnt(0)
    s_waitcnt vmcnt(6)
    s_barrier
    s_add_u32 m0, s21, 98304
    s_nop 0
    buffer_load_dwordx4 v1, s[4:7], s16 offen sc1 lds
    s_add_u32 s16, s16, s62
    s_add_u32 m0, s22, 98304
    s_nop 0
    buffer_load_dwordx4 v2, s[8:11], s18 offen lds
    s_add_u32 s18, s18, s20
    s_add_u32 m0, s22, 106496
    s_nop 0
    buffer_load_dwordx4 v2, s[12:15], s19 offen lds
    s_add_u32 s19, s19, s20
    v_mfma_f32_16x16x32_bf16 v[128:131], v[112:115], v[80:83], v[128:131]
    ds_read_b64_tr_b16 v[64:65], v8 offset:16384
    v_mfma_f32_16x16x32_bf16 v[132:135], v[116:119], v[80:83], v[132:135]
    ds_read_b64_tr_b16 v[66:67], v9 offset:16384
    v_mfma_f32_16x16x32_bf16 v[136:139], v[120:123], v[80:83], v[136:139]
    ds_read_b64_tr_b16 v[68:69], v10 offset:16384
    v_mfma_f32_16x16x32_bf16 v[140:143], v[124:127], v[80:83], v[140:143]
    ds_read_b64_tr_b16 v[70:71], v11 offset:16384
    v_mfma_f32_16x16x32_bf16 v[144:147], v[112:115], v[88:91], v[144:147]
    ds_read_b64_tr_b16 v[72:73], v8 offset:24576
    v_mfma_f32_16x16x32_bf16 v[148:151], v[116:119], v[88:91], v[148:151]
    ds_read_b64_tr_b16 v[74:75], v9 offset:24576
    v_mfma_f32_16x16x32_bf16 v[152:155], v[120:123], v[88:91], v[152:155]
    ds_read_b64_tr_b16 v[76:77], v10 offset:24576
    v_mfma_f32_16x16x32_bf16 v[156:159], v[124:127], v[88:91], v[156:159]
    ds_read_b64_tr_b16 v[78:79], v11 offset:24576
    v_mfma_f32_16x16x32_bf16 v[160:163], v[112:115], v[96:99], v[160:163]
    ds_read_b128 v[32:35], v5 offset:0
    v_mfma_f32_16x16x32_bf16 v[164:167], v[116:119], v[96:99], v[164:167]
    ds_read_b128 v[40:43], v5 offset:2048
    v_mfma_f32_16x16x32_bf16 v[168:171], v[120:123], v[96:99], v[168:171]
    ds_read_b128 v[48:51], v5 offset:4096
    v_mfma_f32_16x16x32_bf16 v[172:175], v[124:127], v[96:99], v[172:175]
    ds_read_b128 v[56:59], v5 offset:6144
    v_mfma_f32_16x16x32_bf16 v[176:179], v[112:115], v[104:107], v[176:179]
    v_mfma_f32_16x16x32_bf16 v[180:183], v[116:119], v[104:107], v[180:183]
    v_mfma_f32_16x16x32_bf16 v[184:187], v[120:123], v[104:107], v[184:187]
    v_mfma_f32_16x16x32_bf16 v[188:191], v[124:127], v[104:107], v[188:191]
    s_waitcnt lgkmcnt(0)
    s_sub_u32 s23, s23, 1
    s_cmp_lg_u32 s23, 0
    s_cbranch_scc1 w_loopM
w_doneM:
    v_mov_b32 v20, 131072
    ds_read_b128 v[24:27], v20
    ds_read_b128 v[28:31], v20 offset:16
    s_lshl_b32 s30, s27, 10
    s_add_u32 s30, s30, s49
    s_nop 7
    v_cvt_pk_bf16_f32 v80, v128, v129
    v_cvt_pk_bf16_f32 v81, v130, v131
    v_cvt_pk_bf16_f32 v82, v132, v133
    v_cvt_pk_bf16_f32 v83, v134, v135
    buffer_store_dwordx4 v[80:83], v1, s[4:7], s30 offen sc1
    v_cvt_pk_bf16_f32 v84, v136, v137
    v_cvt_pk_bf16_f32 v85, v138, v139
    v_cvt_pk_bf16_f32 v86, v140, v141
    v_cvt_pk_bf16_f32 v87, v142, v143
    buffer_store_dwordx4 v[84:87], v19, s[4:7], s30 offen sc1
    s_add_u32 s30, s30, s50
    v_cvt_pk_bf16_f32 v88, v144, v145
    v_cvt_pk_bf16_f32 v89, v146, v147
    v_cvt_pk_bf16_f32 v90, v148, v149
    v_cvt_pk_bf16_f32 v91, v150, v151
    buffer_store_dwordx4 v[88:91], v1, s[4:7], s30 offen sc1
    v_cvt_pk_bf16_f32 v92, v152, v153
    v_cvt_pk_bf16_f32 v93, v154, v155
    v_cvt_pk_bf16_f32 v94, v156, v157
    v_cvt_pk_bf16_f32 v95, v158, v159
    buffer_store_dwordx4 v[92:95], v19, s[4:7], s30 offen sc1
    s_add_u32 s30, s30, s50
    v_cvt_pk_bf16_f32 v80, v160, v161
    v_cvt_pk_bf16_f32 v81, v162, v163
    v_cvt_pk_bf16_f32 v82, v164, v165
    v_cvt_pk_bf16_f32 v83, v166, v167
    buffer_store_dwordx4 v[80:83], v1, s[4:7], s30 offen sc1
    v_cvt_pk_bf16_f32 v84, v168, v169
    v_cvt_pk_bf16_f32 v85, v170, v171
    v_cvt_pk_bf16_f32 v86, v172, v173
    v_cvt_pk_bf16_f32 v87, v174, v175
    buffer_store_dwordx4 v[84:87], v19, s[4:7], s30 offen sc1
    s_add_u32 s30, s30, s50
    v_cvt_pk_bf16_f32 v88, v176, v177
    v_cvt_pk_bf16_f32 v89, v178, v179
    v_cvt_pk_bf16_f32 v90, v180, v181
    v_cvt_pk_bf16_f32 v91, v182, v183
    buffer_store_dwordx4 v[88:91], v1, s[4:7], s30 offen sc1
    v_cvt_pk_bf16_f32 v92, v184, v185
    v_cvt_pk_bf16_f32 v93, v186, v187
    v_cvt_pk_bf16_f32 v94, v188, v189
    v_cvt_pk_bf16_f32 v95, v190, v191
    buffer_store_dwordx4 v[92:95], v19, s[4:7], s30 offen sc1
    s_add_u32 s30, s30, s50
    s_waitcnt lgkmcnt(0)
    v_or3_b32 v24, v24, v25, v26
    v_or3_b32 v28, v28, v29, v30
    v_or3_b32 v24, v24, v27, v31
    v_or_b32 v24, v24, v28
    s_mov_b32 s28, s51
    s_mov_b32 s57, s53
    v_readfirstlane_b32 s30, v24
    s_cmp_lg_u32 s30, 0
    s_cbranch_scc1 w_drain
    s_mov_b32 s48, s32
    s_cmp_ge_u32 s32, 4
    s_cselect_b32 s30, 2, 3
    s_lshl_b32 s30, s26, s30
    s_mul_i32 s30, s30, s43
    s_add_u32 s49, s42, s30
    s_mov_b32 s50, s43
    s_mov_b32 s51, s46
    s_mov_b32 s23, s41
    s_mov_b32 s53, s47
    s_nop 0
    s_load_dwordx16 s[32:47], s[24:25], 0
    s_add_u32 s24, s24, 64
    s_addc_u32 s25, s25, 0
    s_branch w_first8
w_drain:
    s_waitcnt vmcnt(0)
    s_barrier
    s_cmp_eq_u32 s28, 0
    s_cbranch_scc1 sig_5
    s_cmp_lg_u32 s3, 0
    s_cbranch_scc1 sig_5
    s_mov_b64 exec, 1
    v_mov_b32 v18, s57
    buffer_atomic_add v18, v17, s[4:7], s28 offen sc1
    s_mov_b64 exec, -1
sig_5:
    s_mov_b32 s28, 0
    s_cmp_eq_u32 s98, 3
    s_cselect_b32 s98, 1, s98
w_hook:
    s_cmp_eq_u32 s70, 0
    s_cbranch_scc1 drw_ok
    s_cmp_lt_u32 s39, 1048576
    s_cbranch_scc1 drw_ok
    s_mov_b32 s70, 0
    s_cmp_lg_u32 s3, 0
    s_cbranch_scc1 drw_ok
    v_readfirstlane_b32 s68, v22
    s_cmp_ge_u32 s68, 128
    s_cbranch_scc1 drw_ok
    s_mov_b32 s69, 65536
drw:
    buffer_load_dword v20, off, s[64:67], 0 offset:0 sc1
    s_waitcnt vmcnt(0)
    v_readfirstlane_b32 s68, v20
    s_cmp_ge_u32 s68, 128
    s_cbranch_scc1 drw_ok
    s_sleep 8
    s_sub_u32 s69, s69, 1
    s_cbranch_scc0 drw
drw_ok:
    s_branch w_cold
fin_entry:
    s_load_dwordx2 s[8:9], s[0:1], 0
    s_load_dwordx2 s[12:13], s[0:1], 88
    v_mbcnt_lo_u32_b32 v1, -1, 0
    v_mbcnt_hi_u32_b32 v1, -1, v1
    s_mov_b32 s10, 4194304
    s_mov_b32 s11, 131072
    s_mov_b32 s14, 4194304
    s_mov_b32 s15, 131072
    v_lshlrev_b32 v3, 4, v1
    v_and_b32 v4, 15, v1
    v_lshrrev_b32 v5, 4, v1
    v_lshlrev_b32 v4, 11, v4
    v_lshl_add_u32 v4, v5, 4, v4
    v_and_b32 v5, 1, v5
    v_cmp_eq_u32 s[20:21], 1, v5
    v_and_b32 v6, 7, v1
    v_lshlrev_b32 v6, 7, v6
    s_lshr_b32 s24, s63, 2
    s_and_b32 s25, s63, 3
    s_lshl_b32 s25, s25, 2
    s_and_b32 s26, s3, 3
    s_add_u32 s25, s25, s26
    s_lshr_b32 s26, s3, 2
    s_mov_b32 s28, 65536
    s_waitcnt lgkmcnt(0)
fin_job:
    s_lshl_b32 s16, s24, 1
    s_add_u32 s16, s16, s26
    s_lshl_b32 s18, s16, 15
    s_lshl_b32 s17, s25, 11
    s_add_u32 s17, s17, s18
    s_lshl_b32 s19, s25, 7
    s_add_u32 s18, s18, s19
    s_add_u32 s22, s17, 167772160
    s_add_u32 s23, s17, 75497472
    s_lshr_b32 s27, s24, 3
    s_lshl_b32 s27, s27, 6
    s_add_u32 s27, s27, 218106368
    s_cmp_ge_u32 s24, 64
    s_cselect_b32 s29, 16, 16
    s_mov_b32 s30, 218112000
    s_add_u32 s32, s24, 1
    s_mov_b32 s33, 0
    s_mov_b32 s34, 255
    s_cmp_lt_u32 s24, 62
    s_cbranch_scc1 fin_tg
    s_mov_b32 s32, 16
    s_add_u32 s30, s30, 4
    s_sub_u32 s33, s24, 62
    s_lshl_b32 s33, s33, 3
fin_tg:
    s_mul_i32 s35, s24, 3
    s_lshr_b32 s35, s35, 4
    s_add_u32 s35, s35, 49
    s_min_u32 s35, s35, 61
    s_max_u32 s32, s32, s35
    buffer_load_dwordx4 v[88:91], v4, s[8:11], s18 offen offset:0
    buffer_load_dwordx4 v[92:95], v4, s[8:11], s18 offen offset:64
    s_cmp_lg_u32 s3, 0
    s_cbranch_scc1 fin_ws_ok
fin_wd:
    buffer_load_dword v7, off, s[4:7], s27 sc1
    s_waitcnt vmcnt(0)
    v_readfirstlane_b32 s31, v7
    s_cmp_ge_u32 s31, s29
    s_cbranch_scc1 fin_wd_ok
    s_sleep 127
    s_sub_u32 s28, s28, 1
    s_cbranch_scc0 fin_wd
    s_mov_b32 s28, 0
fin_wd_ok:
fin_ws:
    buffer_load_dword v7, v6, s[4:7], s30 offen sc1
    s_waitcnt vmcnt(0)
    v_lshrrev_b32 v7, s33, v7
    v_and_b32 v7, s34, v7
    v_cmp_gt_u32 vcc, s32, v7
    s_cbranch_vccz fin_ws_ok
    s_sleep 12
    v_add_u32 v7, 1, v7
    v_cmp_gt_u32 vcc, s32, v7
    s_cbranch_vccz fin_ws_f
    s_sleep 48
    v_add_u32 v7, 3, v7
    v_cmp_gt_u32 vcc, s32, v7
    s_cbranch_vccz fin_ws_f
    s_sleep 127
    s_sleep 127
fin_ws_f:
    s_sub_u32 s28, s28, 1
    s_cbranch_scc0 fin_ws
    s_mov_b32 s28, 0
fin_ws_ok:
    s_barrier
    buffer_load_dwordx4 v[144:147], v3, s[4:7], s22 offen offset:0 sc1
    buffer_load_dwordx4 v[160:163], v3, s[4:7], s22 offen offset:1024 sc1
    s_add_u32 s22, s22, 4194304
    buffer_load_dwordx4 v[148:151], v3, s[4:7], s22 offen offset:0 sc1
    buffer_load_dwordx4 v[164:167], v3, s[4:7], s22 offen offset:1024 sc1
    s_add_u32 s22, s22, 4194304
    buffer_load_dwordx4 v[152:155], v3, s[4:7], s22 offen offset:0 sc1
    buffer_load_dwordx4 v[168:171], v3, s[4:7], s22 offen offset:1024 sc1
    s_add_u32 s22, s22, 4194304
    buffer_load_dwordx4 v[156:159], v3, s[4:7], s22 offen offset:0 sc1
    buffer_load_dwordx4 v[172:175], v3, s[4:7], s22 offen offset:1024 sc1
    buffer_load_dwordx4 v[16:19], v3, s[4:7], s23 offen offset:0 sc1
    buffer_load_dwordx4 v[48:51], v3, s[4:7], s23 offen offset:1024 sc1
    s_add_u32 s23, s23, 4194304
    buffer_load_dwordx4 v[20:23], v3, s[4:7], s23 offen offset:0 sc1
    buffer_load_dwordx4 v[52:55], v3, s[4:7], s23 offen offset:1024 sc1
    s_add_u32 s23, s23, 4194304
    buffer_load_dwordx4 v[24:27], v3, s[4:7], s23 offen offset:0 sc1
    buffer_load_dwordx4 v[56:59], v3, s[4:7], s23 offen offset:1024 sc1
    s_add_u32 s23, s23, 4194304
    buffer_load_dwordx4 v[28:31], v3, s[4:7], s23 offen offset:0 sc1
    buffer_load_dwordx4 v[60:63], v3, s[4:7], s23 offen offset:1024 sc1
    s_add_u32 s23, s23, 4194304
    buffer_load_dwordx4 v[32:35], v3, s[4:7], s23 offen offset:0 sc1
    buffer_load_dwordx4 v[64:67], v3, s[4:7], s23 offen offset:1024 sc1
    s_add_u32 s23, s23, 4194304
    buffer_load_dwordx4 v[36:39], v3, s[4:7], s23 offen offset:0 sc1
    buffer_load_dwordx4 v[68:71], v3, s[4:7], s23 offen offset:1024 sc1
    s_add_u32 s23, s23, 4194304
    buffer_load_dwordx4 v[40:43], v3, s[4:7], s23 offen offset:0 sc1
    buffer_load_dwordx4 v[72:75], v3, s[4:7], s23 offen offset:1024 sc1
    s_add_u32 s23, s23, 4194304
    buffer_load_dwordx4 v[44:47], v3, s[4:7], s23 offen offset:0 sc1
    buffer_load_dwordx4 v[76:79], v3, s[4:7], s23 offen offset:1024 sc1
    s_add_u32 s23, s23, 4194304
    s_waitcnt vmcnt(16)
    v_lshlrev_b32 v96, 16, v144
    v_and_b32 v97, 0xffff0000, v144
    v_lshlrev_b32 v98, 16, v145
    v_and_b32 v99, 0xffff0000, v145
    v_lshlrev_b32 v100, 16, v146
    v_and_b32 v101, 0xffff0000, v146
    v_lshlrev_b32 v102, 16, v147
    v_and_b32 v103, 0xffff0000, v147
    v_lshlrev_b32 v120, 16, v148
    v_and_b32 v121, 0xffff0000, v148
    v_lshlrev_b32 v122, 16, v149
    v_and_b32 v123, 0xffff0000, v149
    v_lshlrev_b32 v124, 16, v150
    v_and_b32 v125, 0xffff0000, v150
    v_lshlrev_b32 v126, 16, v151
    v_and_b32 v127, 0xffff0000, v151
    v_add_f32 v96, v96, v120
    v_add_f32 v97, v97, v121
    v_add_f32 v98, v98, v122
    v_add_f32 v99, v99, v123
    v_add_f32 v100, v100, v124
    v_add_f32 v101, v101, v125
    v_add_f32 v102, v102, v126
    v_add_f32 v103, v103, v127
    v_lshlrev_b32 v120, 16, v152
    v_and_b32 v121, 0xffff0000, v152
    v_lshlrev_b32 v122, 16, v153
    v_and_b32 v123, 0xffff0000, v153
    v_lshlrev_b32 v124, 16, v154
    v_and_b32 v125, 0xffff0000, v154
    v_lshlrev_b32 v126, 16, v155
    v_and_b32 v127, 0xffff0000, v155
    v_add_f32 v96, v96, v120
    v_add_f32 v97, v97, v121
    v_add_f32 v98, v98, v122
    v_add_f32 v99, v99, v123
    v_add_f32 v100, v100, v124
    v_add_f32 v101, v101, v125
    v_add_f32 v102, v102, v126
    v_add_f32 v103, v103, v127
    v_lshlrev_b32 v120, 16, v156
    v_and_b32 v121, 0xffff0000, v156
    v_lshlrev_b32 v122, 16, v157
    v_and_b32 v123, 0xffff0000, v157
    v_lshlrev_b32 v124, 16, v158
    v_and_b32 v125, 0xffff0000, v158
    v_lshlrev_b32 v126, 16, v159
    v_and_b32 v127, 0xffff0000, v159
    v_add_f32 v96, v96, v120
    v_add_f32 v97, v97, v121
    v_add_f32 v98, v98, v122
    v_add_f32 v99, v99, v123
    v_add_f32 v100, v100, v124
    v_add_f32 v101, v101, v125
    v_add_f32 v102, v102, v126
    v_add_f32 v103, v103, v127
    v_cvt_pk_bf16_f32 v120, v96, v97
    v_cvt_pk_bf16_f32 v121, v98, v99
    v_cvt_pk_bf16_f32 v122, v100, v101
    v_cvt_pk_bf16_f32 v123, v102, v103
    v_lshlrev_b32 v96, 16, v120
    v_and_b32 v97, 0xffff0000, v120
    v_lshlrev_b32 v98, 16, v121
    v_and_b32 v99, 0xffff0000, v121
    v_lshlrev_b32 v100, 16, v122
    v_and_b32 v101, 0xffff0000, v122
    v_lshlrev_b32 v102, 16, v123
    v_and_b32 v103, 0xffff0000, v123
    v_mul_f32 v104, 0xbfb8aa3b, v96
    v_mul_f32 v105, 0xbfb8aa3b, v97
    v_mul_f32 v106, 0xbfb8aa3b, v98
    v_mul_f32 v107, 0xbfb8aa3b, v99
    v_mul_f32 v108, 0xbfb8aa3b, v100
    v_mul_f32 v109, 0xbfb8aa3b, v101
    v_mul_f32 v110, 0xbfb8aa3b, v102
    v_mul_f32 v111, 0xbfb8aa3b, v103
    v_exp_f32 v104, v104
    v_exp_f32 v105, v105
    v_exp_f32 v106, v106
    v_exp_f32 v107, v107
    v_exp_f32 v108, v108
    v_exp_f32 v109, v109
    v_exp_f32 v110, v110
    v_exp_f32 v111, v111
    v_add_f32 v104, 1.0, v104
    v_add_f32 v105, 1.0, v105
    v_add_f32 v106, 1.0, v106
    v_add_f32 v107, 1.0, v107
    v_add_f32 v108, 1.0, v108
    v_add_f32 v109, 1.0, v109
    v_add_f32 v110, 1.0, v110
    v_add_f32 v111, 1.0, v111
    v_rcp_f32 v104, v104
    v_rcp_f32 v105, v105
    v_rcp_f32 v106, v106
    v_rcp_f32 v107, v107
    v_rcp_f32 v108, v108
    v_rcp_f32 v109, v109
    v_rcp_f32 v110, v110
    v_rcp_f32 v111, v111
    v_mul_f32 v96, v96, v104
    v_mul_f32 v97, v97, v105
    v_mul_f32 v98, v98, v106
    v_mul_f32 v99, v99, v107
    v_mul_f32 v100, v100, v108
    v_mul_f32 v101, v101, v109
    v_mul_f32 v102, v102, v110
    v_mul_f32 v103, v103, v111
    v_cvt_pk_bf16_f32 v80, v96, v97
    v_cvt_pk_bf16_f32 v81, v98, v99
    v_cvt_pk_bf16_f32 v82, v100, v101
    v_cvt_pk_bf16_f32 v83, v102, v103
    v_lshlrev_b32 v96, 16, v160
    v_and_b32 v97, 0xffff0000, v160
    v_lshlrev_b32 v98, 16, v161
    v_and_b32 v99, 0xffff0000, v161
    v_lshlrev_b32 v100, 16, v162
    v_and_b32 v101, 0xffff0000, v162
    v_lshlrev_b32 v102, 16, v163
    v_and_b32 v103, 0xffff0000, v163
    v_lshlrev_b32 v120, 16, v164
    v_and_b32 v121, 0xffff0000, v164
    v_lshlrev_b32 v122, 16, v165
    v_and_b32 v123, 0xffff0000, v165
    v_lshlrev_b32 v124, 16, v166
    v_and_b32 v125, 0xffff0000, v166
    v_lshlrev_b32 v126, 16, v167
    v_and_b32 v127, 0xffff0000, v167
    v_add_f32 v96, v96, v120
    v_add_f32 v97, v97, v121
    v_add_f32 v98, v98, v122
    v_add_f32 v99, v99, v123
    v_add_f32 v100, v100, v124
    v_add_f32 v101, v101, v125
    v_add_f32 v102, v102, v126
    v_add_f32 v103, v103, v127
    v_lshlrev_b32 v120, 16, v168
    v_and_b32 v121, 0xffff0000, v168
    v_lshlrev_b32 v122, 16, v169
    v_and_b32 v123, 0xffff0000, v169
    v_lshlrev_b32 v124, 16, v170
    v_and_b32 v125, 0xffff0000, v170
    v_lshlrev_b32 v126, 16, v171
    v_and_b32 v127, 0xffff0000, v171
    v_add_f32 v96, v96, v120
    v_add_f32 v97, v97, v121
    v_add_f32 v98, v98, v122
    v_add_f32 v99, v99, v123
    v_add_f32 v100, v100, v124
    v_add_f32 v101, v101, v125
    v_add_f32 v102, v102, v126
    v_add_f32 v103, v103, v127
    v_lshlrev_b32 v120, 16, v172
    v_and_b32 v121, 0xffff0000, v172
    v_lshlrev_b32 v122, 16, v173
    v_and_b32 v123, 0xffff0000, v173
    v_lshlrev_b32 v124, 16, v174
    v_and_b32 v125, 0xffff0000, v174
    v_lshlrev_b32 v126, 16, v175
    v_and_b32 v127, 0xffff0000, v175
    v_add_f32 v96, v96, v120
    v_add_f32 v97, v97, v121
    v_add_f32 v98, v98, v122
    v_add_f32 v99, v99, v123
    v_add_f32 v100, v100, v124
    v_add_f32 v101, v101, v125
    v_add_f32 v102, v102, v126
    v_add_f32 v103, v103, v127
    v_cvt_pk_bf16_f32 v120, v96, v97
    v_cvt_pk_bf16_f32 v121, v98, v99
    v_cvt_pk_bf16_f32 v122, v100, v101
    v_cvt_pk_bf16_f32 v123, v102, v103
    v_lshlrev_b32 v96, 16, v120
    v_and_b32 v97, 0xffff0000, v120
    v_lshlrev_b32 v98, 16, v121
    v_and_b32 v99, 0xffff0000, v121
    v_lshlrev_b32 v100, 16, v122
    v_and_b32 v101, 0xffff0000, v122
    v_lshlrev_b32 v102, 16, v123
    v_and_b32 v103, 0xffff0000, v123
    v_mul_f32 v104, 0xbfb8aa3b, v96
    v_mul_f32 v105, 0xbfb8aa3b, v97
    v_mul_f32 v106, 0xbfb8aa3b, v98
    v_mul_f32 v107, 0xbfb8aa3b, v99
    v_mul_f32 v108, 0xbfb8aa3b, v100
    v_mul_f32 v109, 0xbfb8aa3b, v101
    v_mul_f32 v110, 0xbfb8aa3b, v102
    v_mul_f32 v111, 0xbfb8aa3b, v103
    v_exp_f32 v104, v104
    v_exp_f32 v105, v105
    v_exp_f32 v106, v106
    v_exp_f32 v107, v107
    v_exp_f32 v108, v108
    v_exp_f32 v109, v109
    v_exp_f32 v110, v110
    v_exp_f32 v111, v111
    v_add_f32 v104, 1.0, v104
    v_add_f32 v105, 1.0, v105
    v_add_f32 v106, 1.0, v106
    v_add_f32 v107, 1.0, v107
    v_add_f32 v108, 1.0, v108
    v_add_f32 v109, 1.0, v109
    v_add_f32 v110, 1.0, v110
    v_add_f32 v111, 1.0, v111
    v_rcp_f32 v104, v104
    v_rcp_f32 v105, v105
    v_rcp_f32 v106, v106
    v_rcp_f32 v107, v107
    v_rcp_f32 v108, v108
    v_rcp_f32 v109, v109
    v_rcp_f32 v110, v110
    v_rcp_f32 v111, v111
    v_mul_f32 v96, v96, v104
    v_mul_f32 v97, v97, v105
    v_mul_f32 v98, v98, v106
    v_mul_f32 v99, v99, v107
    v_mul_f32 v100, v100, v108
    v_mul_f32 v101, v101, v109
    v_mul_f32 v102, v102, v110
    v_mul_f32 v103, v103, v111
    v_cvt_pk_bf16_f32 v84, v96, v97
    v_cvt_pk_bf16_f32 v85, v98, v99
    v_cvt_pk_bf16_f32 v86, v100, v101
    v_cvt_pk_bf16_f32 v87, v102, v103
    s_waitcnt vmcnt(0)
    v_lshlrev_b32 v96, 16, v16
    v_and_b32 v97, 0xffff0000, v16
    v_lshlrev_b32 v98, 16, v17
    v_and_b32 v99, 0xffff0000, v17
    v_lshlrev_b32 v100, 16, v18
    v_and_b32 v101, 0xffff0000, v18
    v_lshlrev_b32 v102, 16, v19
    v_and_b32 v103, 0xffff0000, v19
    v_lshlrev_b32 v120, 16, v20
    v_and_b32 v121, 0xffff0000, v20
    v_lshlrev_b32 v122, 16, v21
    v_and_b32 v123, 0xffff0000, v21
    v_lshlrev_b32 v124, 16, v22
    v_and_b32 v125, 0xffff0000, v22
    v_lshlrev_b32 v126, 16, v23
    v_and_b32 v127, 0xffff0000, v23
    v_add_f32 v96, v96, v120
    v_add_f32 v97, v97, v121
    v_add_f32 v98, v98, v122
    v_add_f32 v99, v99, v123
    v_add_f32 v100, v100, v124
    v_add_f32 v101, v101, v125
    v_add_f32 v102, v102, v126
    v_add_f32 v103, v103, v127
    v_lshlrev_b32 v120, 16, v24
    v_and_b32 v121, 0xffff0000, v24
    v_lshlrev_b32 v122, 16, v25
    v_and_b32 v123, 0xffff0000, v25
    v_lshlrev_b32 v124, 16, v26
    v_and_b32 v125, 0xffff0000, v26
    v_lshlrev_b32 v126, 16, v27
    v_and_b32 v127, 0xffff0000, v27
    v_add_f32 v96, v96, v120
    v_add_f32 v97, v97, v121
    v_add_f32 v98, v98, v122
    v_add_f32 v99, v99, v123
    v_add_f32 v100, v100, v124
    v_add_f32 v101, v101, v125
    v_add_f32 v102, v102, v126
    v_add_f32 v103, v103, v127
    v_lshlrev_b32 v120, 16, v28
    v_and_b32 v121, 0xffff0000, v28
    v_lshlrev_b32 v122, 16, v29
    v_and_b32 v123, 0xffff0000, v29
    v_lshlrev_b32 v124, 16, v30
    v_and_b32 v125, 0xffff0000, v30
    v_lshlrev_b32 v126, 16, v31
    v_and_b32 v127, 0xffff0000, v31
    v_add_f32 v96, v96, v120
    v_add_f32 v97, v97, v121
    v_add_f32 v98, v98, v122
    v_add_f32 v99, v99, v123
    v_add_f32 v100, v100, v124
    v_add_f32 v101, v101, v125
    v_add_f32 v102, v102, v126
    v_add_f32 v103, v103, v127
    v_lshlrev_b32 v120, 16, v32
    v_and_b32 v121, 0xffff0000, v32
    v_lshlrev_b32 v122, 16, v33
    v_and_b32 v123, 0xffff0000, v33
    v_lshlrev_b32 v124, 16, v34
    v_and_b32 v125, 0xffff0000, v34
    v_lshlrev_b32 v126, 16, v35
    v_and_b32 v127, 0xffff0000, v35
    v_add_f32 v96, v96, v120
    v_add_f32 v97, v97, v121
    v_add_f32 v98, v98, v122
    v_add_f32 v99, v99, v123
    v_add_f32 v100, v100, v124
    v_add_f32 v101, v101, v125
    v_add_f32 v102, v102, v126
    v_add_f32 v103, v103, v127
    v_lshlrev_b32 v120, 16, v36
    v_and_b32 v121, 0xffff0000, v36
    v_lshlrev_b32 v122, 16, v37
    v_and_b32 v123, 0xffff0000, v37
    v_lshlrev_b32 v124, 16, v38
    v_and_b32 v125, 0xffff0000, v38
    v_lshlrev_b32 v126, 16, v39
    v_and_b32 v127, 0xffff0000, v39
    v_add_f32 v96, v96, v120
    v_add_f32 v97, v97, v121
    v_add_f32 v98, v98, v122
    v_add_f32 v99, v99, v123
    v_add_f32 v100, v100, v124
    v_add_f32 v101, v101, v125
    v_add_f32 v102, v102, v126
    v_add_f32 v103, v103, v127
    v_lshlrev_b32 v120, 16, v40
    v_and_b32 v121, 0xffff0000, v40
    v_lshlrev_b32 v122, 16, v41
    v_and_b32 v123, 0xffff0000, v41
    v_lshlrev_b32 v124, 16, v42
    v_and_b32 v125, 0xffff0000, v42
    v_lshlrev_b32 v126, 16, v43
    v_and_b32 v127, 0xffff0000, v43
    v_add_f32 v96, v96, v120
    v_add_f32 v97, v97, v121
    v_add_f32 v98, v98, v122
    v_add_f32 v99, v99, v123
    v_add_f32 v100, v100, v124
    v_add_f32 v101, v101, v125
    v_add_f32 v102, v102, v126
    v_add_f32 v103, v103, v127
    v_lshlrev_b32 v120, 16, v44
    v_and_b32 v121, 0xffff0000, v44
    v_lshlrev_b32 v122, 16, v45
    v_and_b32 v123, 0xffff0000, v45
    v_lshlrev_b32 v124, 16, v46
    v_and_b32 v125, 0xffff0000, v46
    v_lshlrev_b32 v126, 16, v47
    v_and_b32 v127, 0xffff0000, v47
    v_add_f32 v96, v96, v120
    v_add_f32 v97, v97, v121
    v_add_f32 v98, v98, v122
    v_add_f32 v99, v99, v123
    v_add_f32 v100, v100, v124
    v_add_f32 v101, v101, v125
    v_add_f32 v102, v102, v126
    v_add_f32 v103, v103, v127
    v_cndmask_b32 v108, v88, v90, s[20:21]
    v_cndmask_b32 v109, v89, v91, s[20:21]
    v_cndmask_b32 v110, v90, v88, s[20:21]
    v_cndmask_b32 v111, v91, v89, s[20:21]
    v_cvt_pk_bf16_f32 v104, v96, v97
    v_lshlrev_b32 v96, 16, v104
    v_and_b32 v97, 0xffff0000, v104
    v_lshlrev_b32 v104, 16, v80
    v_and_b32 v105, 0xffff0000, v80
    v_mul_f32 v96, v96, v104
    v_mul_f32 v97, v97, v105
    v_cvt_pk_bf16_f32 v104, v96, v97
    v_lshlrev_b32 v96, 16, v104
    v_and_b32 v97, 0xffff0000, v104
    v_lshlrev_b32 v104, 16, v108
    v_and_b32 v105, 0xffff0000, v108
    v_add_f32 v96, v96, v104
    v_add_f32 v97, v97, v105
    v_cvt_pk_bf16_f32 v112, v96, v97
    v_cvt_pk_bf16_f32 v104, v98, v99
    v_lshlrev_b32 v98, 16, v104
    v_and_b32 v99, 0xffff0000, v104
    v_lshlrev_b32 v104, 16, v81
    v_and_b32 v105, 0xffff0000, v81
    v_mul_f32 v98, v98, v104
    v_mul_f32 v99, v99, v105
    v_cvt_pk_bf16_f32 v104, v98, v99
    v_lshlrev_b32 v98, 16, v104
    v_and_b32 v99, 0xffff0000, v104
    v_lshlrev_b32 v104, 16, v109
    v_and_b32 v105, 0xffff0000, v109
    v_add_f32 v98, v98, v104
    v_add_f32 v99, v99, v105
    v_cvt_pk_bf16_f32 v113, v98, v99
    v_cvt_pk_bf16_f32 v104, v100, v101
    v_lshlrev_b32 v100, 16, v104
    v_and_b32 v101, 0xffff0000, v104
    v_lshlrev_b32 v104, 16, v82
    v_and_b32 v105, 0xffff0000, v82
    v_mul_f32 v100, v100, v104
    v_mul_f32 v101, v101, v105
    v_cvt_pk_bf16_f32 v104, v100, v101
    v_lshlrev_b32 v100, 16, v104
    v_and_b32 v101, 0xffff0000, v104
    v_lshlrev_b32 v104, 16, v110
    v_and_b32 v105, 0xffff0000, v110
    v_add_f32 v100, v100, v104
    v_add_f32 v101, v101, v105
    v_cvt_pk_bf16_f32 v114, v100, v101
    v_cvt_pk_bf16_f32 v104, v102, v103
    v_lshlrev_b32 v102, 16, v104
    v_and_b32 v103, 0xffff0000, v104
    v_lshlrev_b32 v104, 16, v83
    v_and_b32 v105, 0xffff0000, v83
    v_mul_f32 v102, v102, v104
    v_mul_f32 v103, v103, v105
    v_cvt_pk_bf16_f32 v104, v102, v103
    v_lshlrev_b32 v102, 16, v104
    v_and_b32 v103, 0xffff0000, v104
    v_lshlrev_b32 v104, 16, v111
    v_and_b32 v105, 0xffff0000, v111
    v_add_f32 v102, v102, v104
    v_add_f32 v103, v103, v105
    v_cvt_pk_bf16_f32 v115, v102, v103
    v_cndmask_b32 v128, v112, v114, s[20:21]
    v_cndmask_b32 v129, v113, v115, s[20:21]
    v_cndmask_b32 v130, v114, v112, s[20:21]
    v_cndmask_b32 v131, v115, v113, s[20:21]
    buffer_store_dwordx4 v[128:131], v4, s[12:15], s18 offen offset:0
    v_lshlrev_b32 v96, 16, v48
    v_and_b32 v97, 0xffff0000, v48
    v_lshlrev_b32 v98, 16, v49
    v_and_b32 v99, 0xffff0000, v49
    v_lshlrev_b32 v100, 16, v50
    v_and_b32 v101, 0xffff0000, v50
    v_lshlrev_b32 v102, 16, v51
    v_and_b32 v103, 0xffff0000, v51
    v_lshlrev_b32 v120, 16, v52
    v_and_b32 v121, 0xffff0000, v52
    v_lshlrev_b32 v122, 16, v53
    v_and_b32 v123, 0xffff0000, v53
    v_lshlrev_b32 v124, 16, v54
    v_and_b32 v125, 0xffff0000, v54
    v_lshlrev_b32 v126, 16, v55
    v_and_b32 v127, 0xffff0000, v55
    v_add_f32 v96, v96, v120
    v_add_f32 v97, v97, v121
    v_add_f32 v98, v98, v122
    v_add_f32 v99, v99, v123
    v_add_f32 v100, v100, v124
    v_add_f32 v101, v101, v125
    v_add_f32 v102, v102, v126
    v_add_f32 v103, v103, v127
    v_lshlrev_b32 v120, 16, v56
    v_and_b32 v121, 0xffff0000, v56
    v_lshlrev_b32 v122, 16, v57
    v_and_b32 v123, 0xffff0000, v57
    v_lshlrev_b32 v124, 16, v58
    v_and_b32 v125, 0xffff0000, v58
    v_lshlrev_b32 v126, 16, v59
    v_and_b32 v127, 0xffff0000, v59
    v_add_f32 v96, v96, v120
    v_add_f32 v97, v97, v121
    v_add_f32 v98, v98, v122
    v_add_f32 v99, v99, v123
    v_add_f32 v100, v100, v124
    v_add_f32 v101, v101, v125
    v_add_f32 v102, v102, v126
    v_add_f32 v103, v103, v127
    v_lshlrev_b32 v120, 16, v60
    v_and_b32 v121, 0xffff0000, v60
    v_lshlrev_b32 v122, 16, v61
    v_and_b32 v123, 0xffff0000, v61
    v_lshlrev_b32 v124, 16, v62
    v_and_b32 v125, 0xffff0000, v62
    v_lshlrev_b32 v126, 16, v63
    v_and_b32 v127, 0xffff0000, v63
    v_add_f32 v96, v96, v120
    v_add_f32 v97, v97, v121
    v_add_f32 v98, v98, v122
    v_add_f32 v99, v99, v123
    v_add_f32 v100, v100, v124
    v_add_f32 v101, v101, v125
    v_add_f32 v102, v102, v126
    v_add_f32 v103, v103, v127
    v_lshlrev_b32 v120, 16, v64
    v_and_b32 v121, 0xffff0000, v64
    v_lshlrev_b32 v122, 16, v65
    v_and_b32 v123, 0xffff0000, v65
    v_lshlrev_b32 v124, 16, v66
    v_and_b32 v125, 0xffff0000, v66
    v_lshlrev_b32 v126, 16, v67
    v_and_b32 v127, 0xffff0000, v67
    v_add_f32 v96, v96, v120
    v_add_f32 v97, v97, v121
    v_add_f32 v98, v98, v122
    v_add_f32 v99, v99, v123
    v_add_f32 v100, v100, v124
    v_add_f32 v101, v101, v125
    v_add_f32 v102, v102, v126
    v_add_f32 v103, v103, v127
    v_lshlrev_b32 v120, 16, v68
    v_and_b32 v121, 0xffff0000, v68
    v_lshlrev_b32 v122, 16, v69
    v_and_b32 v123, 0xffff0000, v69
    v_lshlrev_b32 v124, 16, v70
    v_and_b32 v125, 0xffff0000, v70
    v_lshlrev_b32 v126, 16, v71
    v_and_b32 v127, 0xffff0000, v71
    v_add_f32 v96, v96, v120
    v_add_f32 v97, v97, v121
    v_add_f32 v98, v98, v122
    v_add_f32 v99, v99, v123
    v_add_f32 v100, v100, v124
    v_add_f32 v101, v101, v125
    v_add_f32 v102, v102, v126
    v_add_f32 v103, v103, v127
    v_lshlrev_b32 v120, 16, v72
    v_and_b32 v121, 0xffff0000, v72
    v_lshlrev_b32 v122, 16, v73
    v_and_b32 v123, 0xffff0000, v73
    v_lshlrev_b32 v124, 16, v74
    v_and_b32 v125, 0xffff0000, v74
    v_lshlrev_b32 v126, 16, v75
    v_and_b32 v127, 0xffff0000, v75
    v_add_f32 v96, v96, v120
    v_add_f32 v97, v97, v121
    v_add_f32 v98, v98, v122
    v_add_f32 v99, v99, v123
    v_add_f32 v100, v100, v124
    v_add_f32 v101, v101, v125
    v_add_f32 v102, v102, v126
    v_add_f32 v103, v103, v127
    v_lshlrev_b32 v120, 16, v76
    v_and_b32 v121, 0xffff0000, v76
    v_lshlrev_b32 v122, 16, v77
    v_and_b32 v123, 0xffff0000, v77
    v_lshlrev_b32 v124, 16, v78
    v_and_b32 v125, 0xffff0000, v78
    v_lshlrev_b32 v126, 16, v79
    v_and_b32 v127, 0xffff0000, v79
    v_add_f32 v96, v96, v120
    v_add_f32 v97, v97, v121
    v_add_f32 v98, v98, v122
    v_add_f32 v99, v99, v123
    v_add_f32 v100, v100, v124
    v_add_f32 v101, v101, v125
    v_add_f32 v102, v102, v126
    v_add_f32 v103, v103, v127
    v_cndmask_b32 v108, v92, v94, s[20:21]
    v_cndmask_b32 v109, v93, v95, s[20:21]
    v_cndmask_b32 v110, v94, v92, s[20:21]
    v_cndmask_b32 v111, v95, v93, s[20:21]
    v_cvt_pk_bf16_f32 v104, v96, v97
    v_lshlrev_b32 v96, 16, v104
    v_and_b32 v97, 0xffff0000, v104
    v_lshlrev_b32 v104, 16, v84
    v_and_b32 v105, 0xffff0000, v84
    v_mul_f32 v96, v96, v104
    v_mul_f32 v97, v97, v105
    v_cvt_pk_bf16_f32 v104, v96, v97
    v_lshlrev_b32 v96, 16, v104
    v_and_b32 v97, 0xffff0000, v104
    v_lshlrev_b32 v104, 16, v108
    v_and_b32 v105, 0xffff0000, v108
    v_add_f32 v96, v96, v104
    v_add_f32 v97, v97, v105
    v_cvt_pk_bf16_f32 v112, v96, v97
    v_cvt_pk_bf16_f32 v104, v98, v99
    v_lshlrev_b32 v98, 16, v104
    v_and_b32 v99, 0xffff0000, v104
    v_lshlrev_b32 v104, 16, v85
    v_and_b32 v105, 0xffff0000, v85
    v_mul_f32 v98, v98, v104
    v_mul_f32 v99, v99, v105
    v_cvt_pk_bf16_f32 v104, v98, v99
    v_lshlrev_b32 v98, 16, v104
    v_and_b32 v99, 0xffff0000, v104
    v_lshlrev_b32 v104, 16, v109
    v_and_b32 v105, 0xffff0000, v109
    v_add_f32 v98, v98, v104
    v_add_f32 v99, v99, v105
    v_cvt_pk_bf16_f32 v113, v98, v99
    v_cvt_pk_bf16_f32 v104, v100, v101
    v_lshlrev_b32 v100, 16, v104
    v_and_b32 v101, 0xffff0000, v104
    v_lshlrev_b32 v104, 16, v86
    v_and_b32 v105, 0xffff0000, v86
    v_mul_f32 v100, v100, v104
    v_mul_f32 v101, v101, v105
    v_cvt_pk_bf16_f32 v104, v100, v101
    v_lshlrev_b32 v100, 16, v104
    v_and_b32 v101, 0xffff0000, v104
    v_lshlrev_b32 v104, 16, v110
    v_and_b32 v105, 0xffff0000, v110
    v_add_f32 v100, v100, v104
    v_add_f32 v101, v101, v105
    v_cvt_pk_bf16_f32 v114, v100, v101
    v_cvt_pk_bf16_f32 v104, v102, v103
    v_lshlrev_b32 v102, 16, v104
    v_and_b32 v103, 0xffff0000, v104
    v_lshlrev_b32 v104, 16, v87
    v_and_b32 v105, 0xffff0000, v87
    v_mul_f32 v102, v102, v104
    v_mul_f32 v103, v103, v105
    v_cvt_pk_bf16_f32 v104, v102, v103
    v_lshlrev_b32 v102, 16, v104
    v_and_b32 v103, 0xffff0000, v104
    v_lshlrev_b32 v104, 16, v111
    v_and_b32 v105, 0xffff0000, v111
    v_add_f32 v102, v102, v104
    v_add_f32 v103, v103, v105
    v_cvt_pk_bf16_f32 v115, v102, v103
    v_cndmask_b32 v132, v112, v114, s[20:21]
    v_cndmask_b32 v133, v113, v115, s[20:21]
    v_cndmask_b32 v134, v114, v112, s[20:21]
    v_cndmask_b32 v135, v115, v113, s[20:21]
    buffer_store_dwordx4 v[132:135], v4, s[12:15], s18 offen offset:64
    s_add_u32 s24, s24, 32
    s_cmp_lt_u32 s24, 61
    s_cbranch_scc1 fin_job
    s_cmp_ge_u32 s63, 48
    s_cbranch_scc1 k_end
    s_lshr_b32 s24, s63, 4
    s_sub_u32 s24, 63, s24
    s_and_b32 s25, s63, 15
    s_lshl_b32 s25, s25, 2
    s_and_b32 s26, s3, 3
    s_add_u32 s25, s25, s26
    s_lshr_b32 s26, s25, 5
    s_and_b32 s25, s25, 31
    s_lshl_b32 s16, s24, 1
    s_add_u32 s16, s16, s26
    s_lshl_b32 s18, s16, 15
    s_lshl_b32 s17, s25, 10
    s_add_u32 s17, s17, s18
    s_lshl_b32 s19, s25, 6
    s_add_u32 s18, s18, s19
    s_add_u32 s22, s17, 167772160
    s_add_u32 s23, s17, 75497472
    s_mov_b32 s27, 218106816
    s_mov_b32 s30, 218112000
    s_mov_b32 s28, 65536
    v_and_b32 v8, 7, v1
    v_lshlrev_b32 v8, 22, v8
    s_cmp_lg_u32 s3, 0
    s_cbranch_scc1 ft_ok
ft_wd:
    buffer_load_dword v7, off, s[4:7], s27 sc1
    s_waitcnt vmcnt(0)
    v_readfirstlane_b32 s31, v7
    s_cmp_ge_u32 s31, 16
    s_cbranch_scc1 ft_ws
    s_sleep 127
    s_sub_u32 s28, s28, 1
    s_cbranch_scc0 ft_wd
    s_mov_b32 s28, 0
ft_ws:
    buffer_load_dword v7, v6, s[4:7], s30 offen sc1
    s_waitcnt vmcnt(0)
    v_cmp_gt_u32 vcc, 61, v7
    s_cbranch_vccz ft_ok
    s_sleep 12
    v_cmp_gt_u32 vcc, 59, v7
    s_cbranch_vccz ft_wsf
    s_sleep 64
    v_cmp_gt_u32 vcc, 56, v7
    s_cbranch_vccz ft_wsf
    s_sleep 127
    s_sleep 127
ft_wsf:
    s_sub_u32 s28, s28, 1
    s_cbranch_scc0 ft_ws
    s_mov_b32 s28, 0
ft_ok:
    s_barrier
    s_cmp_ge_u32 s3, 4
    s_cbranch_scc1 k_end
    buffer_load_dwordx4 v[88:91], v4, s[8:11], s18 offen
    buffer_load_dwordx4 v[144:147], v3, s[4:7], s22 offen offset:0 sc1
    s_add_u32 s22, s22, 4194304
    buffer_load_dwordx4 v[148:151], v3, s[4:7], s22 offen offset:0 sc1
    s_add_u32 s22, s22, 4194304
    buffer_load_dwordx4 v[152:155], v3, s[4:7], s22 offen offset:0 sc1
    s_add_u32 s22, s22, 4194304
    buffer_load_dwordx4 v[156:159], v3, s[4:7], s22 offen offset:0 sc1
    s_waitcnt vmcnt(0)
    v_lshlrev_b32 v96, 16, v144
    v_and_b32 v97, 0xffff0000, v144
    v_lshlrev_b32 v98, 16, v145
    v_and_b32 v99, 0xffff0000, v145
    v_lshlrev_b32 v100, 16, v146
    v_and_b32 v101, 0xffff0000, v146
    v_lshlrev_b32 v102, 16, v147
    v_and_b32 v103, 0xffff0000, v147
    v_lshlrev_b32 v120, 16, v148
    v_and_b32 v121, 0xffff0000, v148
    v_lshlrev_b32 v122, 16, v149
    v_and_b32 v123, 0xffff0000, v149
    v_lshlrev_b32 v124, 16, v150
    v_and_b32 v125, 0xffff0000, v150
    v_lshlrev_b32 v126, 16, v151
    v_and_b32 v127, 0xffff0000, v151
    v_add_f32 v96, v96, v120
    v_add_f32 v97, v97, v121
    v_add_f32 v98, v98, v122
    v_add_f32 v99, v99, v123
    v_add_f32 v100, v100, v124
    v_add_f32 v101, v101, v125
    v_add_f32 v102, v102, v126
    v_add_f32 v103, v103, v127
    v_lshlrev_b32 v120, 16, v152
    v_and_b32 v121, 0xffff0000, v152
    v_lshlrev_b32 v122, 16, v153
    v_and_b32 v123, 0xffff0000, v153
    v_lshlrev_b32 v124, 16, v154
    v_and_b32 v125, 0xffff0000, v154
    v_lshlrev_b32 v126, 16, v155
    v_and_b32 v127, 0xffff0000, v155
    v_add_f32 v96, v96, v120
    v_add_f32 v97, v97, v121
    v_add_f32 v98, v98, v122
    v_add_f32 v99, v99, v123
    v_add_f32 v100, v100, v124
    v_add_f32 v101, v101, v125
    v_add_f32 v102, v102, v126
    v_add_f32 v103, v103, v127
    v_lshlrev_b32 v120, 16, v156
    v_and_b32 v121, 0xffff0000, v156
    v_lshlrev_b32 v122, 16, v157
    v_and_b32 v123, 0xffff0000, v157
    v_lshlrev_b32 v124, 16, v158
    v_and_b32 v125, 0xffff0000, v158
    v_lshlrev_b32 v126, 16, v159
    v_and_b32 v127, 0xffff0000, v159
    v_add_f32 v96, v96, v120
    v_add_f32 v97, v97, v121
    v_add_f32 v98, v98, v122
    v_add_f32 v99, v99, v123
    v_add_f32 v100, v100, v124
    v_add_f32 v101, v101, v125
    v_add_f32 v102, v102, v126
    v_add_f32 v103, v103, v127
    v_cvt_pk_bf16_f32 v120, v96, v97
    v_cvt_pk_bf16_f32 v121, v98, v99
    v_cvt_pk_bf16_f32 v122, v100, v101
    v_cvt_pk_bf16_f32 v123, v102, v103
    v_lshlrev_b32 v96, 16, v120
    v_and_b32 v97, 0xffff0000, v120
    v_lshlrev_b32 v98, 16, v121
    v_and_b32 v99, 0xffff0000, v121
    v_lshlrev_b32 v100, 16, v122
    v_and_b32 v101, 0xffff0000, v122
    v_lshlrev_b32 v102, 16, v123
    v_and_b32 v103, 0xffff0000, v123
    v_mul_f32 v104, 0xbfb8aa3b, v96
    v_mul_f32 v105, 0xbfb8aa3b, v97
    v_mul_f32 v106, 0xbfb8aa3b, v98
    v_mul_f32 v107, 0xbfb8aa3b, v99
    v_mul_f32 v108, 0xbfb8aa3b, v100
    v_mul_f32 v109, 0xbfb8aa3b, v101
    v_mul_f32 v110, 0xbfb8aa3b, v102
    v_mul_f32 v111, 0xbfb8aa3b, v103
    v_exp_f32 v104, v104
    v_exp_f32 v105, v105
    v_exp_f32 v106, v106
    v_exp_f32 v107, v107
    v_exp_f32 v108, v108
    v_exp_f32 v109, v109
    v_exp_f32 v110, v110
    v_exp_f32 v111, v111
    v_add_f32 v104, 1.0, v104
    v_add_f32 v105, 1.0, v105
    v_add_f32 v106, 1.0, v106
    v_add_f32 v107, 1.0, v107
    v_add_f32 v108, 1.0, v108
    v_add_f32 v109, 1.0, v109
    v_add_f32 v110, 1.0, v110
    v_add_f32 v111, 1.0, v111
    v_rcp_f32 v104, v104
    v_rcp_f32 v105, v105
    v_rcp_f32 v106, v106
    v_rcp_f32 v107, v107
    v_rcp_f32 v108, v108
    v_rcp_f32 v109, v109
    v_rcp_f32 v110, v110
    v_rcp_f32 v111, v111
    v_mul_f32 v96, v96, v104
    v_mul_f32 v97, v97, v105
    v_mul_f32 v98, v98, v106
    v_mul_f32 v99, v99, v107
    v_mul_f32 v100, v100, v108
    v_mul_f32 v101, v101, v109
    v_mul_f32 v102, v102, v110
    v_mul_f32 v103, v103, v111
    v_cvt_pk_bf16_f32 v80, v96, v97
    v_cvt_pk_bf16_f32 v81, v98, v99
    v_cvt_pk_bf16_f32 v82, v100, v101
    v_cvt_pk_bf16_f32 v83, v102, v103
ft_p:
    buffer_load_dword v7, v8, s[4:7], s23 offen offset:1020 sc1
    s_waitcnt vmcnt(0)
    v_cmp_eq_u32 vcc, -1, v7
    s_cbranch_vccz ft_l
    s_sleep 4
    s_sub_u32 s28, s28, 1
    s_cbranch_scc0 ft_p
    s_mov_b32 s28, 0
ft_l:
    s_mov_b32 s31, s23
    buffer_load_dwordx4 v[16:19], v3, s[4:7], s31 offen sc1
    s_add_u32 s31, s31, 4194304
    buffer_load_dwordx4 v[20:23], v3, s[4:7], s31 offen sc1
    s_add_u32 s31, s31, 4194304
    buffer_load_dwordx4 v[24:27], v3, s[4:7], s31 offen sc1
    s_add_u32 s31, s31, 4194304
    buffer_load_dwordx4 v[28:31], v3, s[4:7], s31 offen sc1
    s_add_u32 s31, s31, 4194304
    buffer_load_dwordx4 v[32:35], v3, s[4:7], s31 offen sc1
    s_add_u32 s31, s31, 4194304
    buffer_load_dwordx4 v[36:39], v3, s[4:7], s31 offen sc1
    s_add_u32 s31, s31, 4194304
    buffer_load_dwordx4 v[40:43], v3, s[4:7], s31 offen sc1
    s_add_u32 s31, s31, 4194304
    buffer_load_dwordx4 v[44:47], v3, s[4:7], s31 offen sc1
    s_waitcnt vmcnt(0)
    v_max3_u32 v7, v16, v17, v18
    v_max3_u32 v7, v7, v19, v20
    v_max3_u32 v7, v7, v21, v22
    v_max3_u32 v7, v7, v23, v24
    v_max3_u32 v7, v7, v25, v26
    v_max3_u32 v7, v7, v27, v28
    v_max3_u32 v7, v7, v29, v30
    v_max3_u32 v7, v7, v31, v32
    v_max3_u32 v7, v7, v33, v34
    v_max3_u32 v7, v7, v35, v36
    v_max3_u32 v7, v7, v37, v38
    v_max3_u32 v7, v7, v39, v40
    v_max3_u32 v7, v7, v41, v42
    v_max3_u32 v7, v7, v43, v44
    v_max3_u32 v7, v7, v45, v46
    v_max_u32 v7, v7, v47
    v_cmp_eq_u32 vcc, -1, v7
    s_cbranch_vccz ft_go
    s_sub_u32 s28, s28, 1
    s_cbranch_scc0 ft_l
ft_go:
    v_lshlrev_b32 v96, 16, v16
    v_and_b32 v97, 0xffff0000, v16
    v_lshlrev_b32 v98, 16, v17
    v_and_b32 v99, 0xffff0000, v17
    v_lshlrev_b32 v100, 16, v18
    v_and_b32 v101, 0xffff0000, v18
    v_lshlrev_b32 v102, 16, v19
    v_and_b32 v103, 0xffff0000, v19
    v_lshlrev_b32 v120, 16, v20
    v_and_b32 v121, 0xffff0000, v20
    v_lshlrev_b32 v122, 16, v21
    v_and_b32 v123, 0xffff0000, v21
    v_lshlrev_b32 v124, 16, v22
    v_and_b32 v125, 0xffff0000, v22
    v_lshlrev_b32 v126, 16, v23
    v_and_b32 v127, 0xffff0000, v23
    v_add_f32 v96, v96, v120
    v_add_f32 v97, v97, v121
    v_add_f32 v98, v98, v122
    v_add_f32 v99, v99, v123
    v_add_f32 v100, v100, v124
    v_add_f32 v101, v101, v125
    v_add_f32 v102, v102, v126
    v_add_f32 v103, v103, v127
    v_lshlrev_b32 v120, 16, v24
    v_and_b32 v121, 0xffff0000, v24
    v_lshlrev_b32 v122, 16, v25
    v_and_b32 v123, 0xffff0000, v25
    v_lshlrev_b32 v124, 16, v26
    v_and_b32 v125, 0xffff0000, v26
    v_lshlrev_b32 v126, 16, v27
    v_and_b32 v127, 0xffff0000, v27
    v_add_f32 v96, v96, v120
    v_add_f32 v97, v97, v121
    v_add_f32 v98, v98, v122
    v_add_f32 v99, v99, v123
    v_add_f32 v100, v100, v124
    v_add_f32 v101, v101, v125
    v_add_f32 v102, v102, v126
    v_add_f32 v103, v103, v127
    v_lshlrev_b32 v120, 16, v28
    v_and_b32 v121, 0xffff0000, v28
    v_lshlrev_b32 v122, 16, v29
    v_and_b32 v123, 0xffff0000, v29
    v_lshlrev_b32 v124, 16, v30
    v_and_b32 v125, 0xffff0000, v30
    v_lshlrev_b32 v126, 16, v31
    v_and_b32 v127, 0xffff0000, v31
    v_add_f32 v96, v96, v120
    v_add_f32 v97, v97, v121
    v_add_f32 v98, v98, v122
    v_add_f32 v99, v99, v123
    v_add_f32 v100, v100, v124
    v_add_f32 v101, v101, v125
    v_add_f32 v102, v102, v126
    v_add_f32 v103, v103, v127
    v_lshlrev_b32 v120, 16, v32
    v_and_b32 v121, 0xffff0000, v32
    v_lshlrev_b32 v122, 16, v33
    v_and_b32 v123, 0xffff0000, v33
    v_lshlrev_b32 v124, 16, v34
    v_and_b32 v125, 0xffff0000, v34
    v_lshlrev_b32 v126, 16, v35
    v_and_b32 v127, 0xffff0000, v35
    v_add_f32 v96, v96, v120
    v_add_f32 v97, v97, v121
    v_add_f32 v98, v98, v122
    v_add_f32 v99, v99, v123
    v_add_f32 v100, v100, v124
    v_add_f32 v101, v101, v125
    v_add_f32 v102, v102, v126
    v_add_f32 v103, v103, v127
    v_lshlrev_b32 v120, 16, v36
    v_and_b32 v121, 0xffff0000, v36
    v_lshlrev_b32 v122, 16, v37
    v_and_b32 v123, 0xffff0000, v37
    v_lshlrev_b32 v124, 16, v38
    v_and_b32 v125, 0xffff0000, v38
    v_lshlrev_b32 v126, 16, v39
    v_and_b32 v127, 0xffff0000, v39
    v_add_f32 v96, v96, v120
    v_add_f32 v97, v97, v121
    v_add_f32 v98, v98, v122
    v_add_f32 v99, v99, v123
    v_add_f32 v100, v100, v124
    v_add_f32 v101, v101, v125
    v_add_f32 v102, v102, v126
    v_add_f32 v103, v103, v127
    v_lshlrev_b32 v120, 16, v40
    v_and_b32 v121, 0xffff0000, v40
    v_lshlrev_b32 v122, 16, v41
    v_and_b32 v123, 0xffff0000, v41
    v_lshlrev_b32 v124, 16, v42
    v_and_b32 v125, 0xffff0000, v42
    v_lshlrev_b32 v126, 16, v43
    v_and_b32 v127, 0xffff0000, v43
    v_add_f32 v96, v96, v120
    v_add_f32 v97, v97, v121
    v_add_f32 v98, v98, v122
    v_add_f32 v99, v99, v123
    v_add_f32 v100, v100, v124
    v_add_f32 v101, v101, v125
    v_add_f32 v102, v102, v126
    v_add_f32 v103, v103, v127
    v_lshlrev_b32 v120, 16, v44
    v_and_b32 v121, 0xffff0000, v44
    v_lshlrev_b32 v122, 16, v45
    v_and_b32 v123, 0xffff0000, v45
    v_lshlrev_b32 v124, 16, v46
    v_and_b32 v125, 0xffff0000, v46
    v_lshlrev_b32 v126, 16, v47
    v_and_b32 v127, 0xffff0000, v47
    v_add_f32 v96, v96, v120
    v_add_f32 v97, v97, v121
    v_add_f32 v98, v98, v122
    v_add_f32 v99, v99, v123
    v_add_f32 v100, v100, v124
    v_add_f32 v101, v101, v125
    v_add_f32 v102, v102, v126
    v_add_f32 v103, v103, v127
    v_cndmask_b32 v108, v88, v90, s[20:21]
    v_cndmask_b32 v109, v89, v91, s[20:21]
    v_cndmask_b32 v110, v90, v88, s[20:21]
    v_cndmask_b32 v111, v91, v89, s[20:21]
    v_cvt_pk_bf16_f32 v104, v96, v97
    v_lshlrev_b32 v96, 16, v104
    v_and_b32 v97, 0xffff0000, v104
    v_lshlrev_b32 v104, 16, v80
    v_and_b32 v105, 0xffff0000, v80
    v_mul_f32 v96, v96, v104
    v_mul_f32 v97, v97, v105
    v_cvt_pk_bf16_f32 v104, v96, v97
    v_lshlrev_b32 v96, 16, v104
    v_and_b32 v97, 0xffff0000, v104
    v_lshlrev_b32 v104, 16, v108
    v_and_b32 v105, 0xffff0000, v108
    v_add_f32 v96, v96, v104
    v_add_f32 v97, v97, v105
    v_cvt_pk_bf16_f32 v112, v96, v97
    v_cvt_pk_bf16_f32 v104, v98, v99
    v_lshlrev_b32 v98, 16, v104
    v_and_b32 v99, 0xffff0000, v104
    v_lshlrev_b32 v104, 16, v81
    v_and_b32 v105, 0xffff0000, v81
    v_mul_f32 v98, v98, v104
    v_mul_f32 v99, v99, v105
    v_cvt_pk_bf16_f32 v104, v98, v99
    v_lshlrev_b32 v98, 16, v104
    v_and_b32 v99, 0xffff0000, v104
    v_lshlrev_b32 v104, 16, v109
    v_and_b32 v105, 0xffff0000, v109
    v_add_f32 v98, v98, v104
    v_add_f32 v99, v99, v105
    v_cvt_pk_bf16_f32 v113, v98, v99
    v_cvt_pk_bf16_f32 v104, v100, v101
    v_lshlrev_b32 v100, 16, v104
    v_and_b32 v101, 0xffff0000, v104
    v_lshlrev_b32 v104, 16, v82
    v_and_b32 v105, 0xffff0000, v82
    v_mul_f32 v100, v100, v104
    v_mul_f32 v101, v101, v105
    v_cvt_pk_bf16_f32 v104, v100, v101
    v_lshlrev_b32 v100, 16, v104
    v_and_b32 v101, 0xffff0000, v104
    v_lshlrev_b32 v104, 16, v110
    v_and_b32 v105, 0xffff0000, v110
    v_add_f32 v100, v100, v104
    v_add_f32 v101, v101, v105
    v_cvt_pk_bf16_f32 v114, v100, v101
    v_cvt_pk_bf16_f32 v104, v102, v103
    v_lshlrev_b32 v102, 16, v104
    v_and_b32 v103, 0xffff0000, v104
    v_lshlrev_b32 v104, 16, v83
    v_and_b32 v105, 0xffff0000, v83
    v_mul_f32 v102, v102, v104
    v_mul_f32 v103, v103, v105
    v_cvt_pk_bf16_f32 v104, v102, v103
    v_lshlrev_b32 v102, 16, v104
    v_and_b32 v103, 0xffff0000, v104
    v_lshlrev_b32 v104, 16, v111
    v_and_b32 v105, 0xffff0000, v111
    v_add_f32 v102, v102, v104
    v_add_f32 v103, v103, v105
    v_cvt_pk_bf16_f32 v115, v102, v103
    v_cndmask_b32 v128, v112, v114, s[20:21]
    v_cndmask_b32 v129, v113, v115, s[20:21]
    v_cndmask_b32 v130, v114, v112, s[20:21]
    v_cndmask_b32 v131, v115, v113, s[20:21]
    buffer_store_dwordx4 v[128:131], v4, s[12:15], s18 offen offset:0
    s_branch k_end
chain_map:
    s_and_b32 s14, s12, 1
    s_lshl_b32 s13, s13, 1
    s_lshr_b32 s15, s12, 1
    s_add_u32 s12, s13, s14
    s_mov_b32 s13, s15
    s_lshl_b32 s2, s13, 3
    s_add_u32 s2, s2, s12
    s_lshr_b32 s14, s13, 2
    s_and_b32 s15, s13, 3
    s_mov_b32 s16, 0
    s_mov_b32 s17, 209715200
    s_mov_b32 s18, 209977344
    s_mov_b32 s19, 210239488
    s_mov_b32 s20, 210501632
    s_mov_b32 s26, 131072
    s_mov_b32 s68, 0
    s_getreg_b32 s29, hwreg(HW_REG_XCC_ID)
    s_and_b32 s29, s29, 15
    s_mul_i32 s23, s29, s29
    s_lshl_b32 s23, s23, 18
    s_lshl_b32 s29, s29, 8
    s_add_u32 s29, s29, s23
    s_add_u32 s29, s29, 1
    s_lshr_b32 s28, s12, 1
    s_lshl_b32 s28, s28, 2
    s_add_u32 s28, s28, 128
    s_cmp_ge_u32 s3, 4
    s_cbranch_scc1 ch_a_pro
    s_lshl_b32 s32, s12, 15
    s_lshl_b32 s21, s14, 13
    s_add_u32 s32, s32, s21
    s_lshl_b32 s21, s15, 10
    s_add_u32 s32, s32, s21
    s_add_u32 s32, s32, 2097152
    s_lshr_b32 s33, s12, 1
    s_lshl_b32 s33, s33, 14
    s_add_u32 s33, s33, 1048576
    s_lshl_b32 s21, s13, 10
    s_add_u32 s36, s33, s21
    s_lshl_b32 s21, s3, 12
    s_add_u32 s33, s33, s21
    s_lshl_b32 s34, s13, 14
    s_lshl_b32 s21, s12, 10
    s_add_u32 s35, s34, s21
    s_lshl_b32 s37, s12, 22
    s_lshl_b32 s21, s13, 11
    s_add_u32 s37, s37, s21
    s_and_b32 s21, s3, 1
    s_lshl_b32 s21, s21, 15
    s_add_u32 s37, s37, s21
    s_lshr_b32 s21, s3, 1
    s_lshl_b32 s21, s21, 10
    s_add_u32 s37, s37, s21
    s_add_u32 s37, s37, 75497472
    v_and_b32 v20, 63, v0
    v_lshlrev_b32 v1, 4, v20
    v_mov_b32 v10, -1
    v_mov_b32 v11, -1
    v_lshrrev_b32 v21, 2, v20
    v_and_b32 v22, 3, v20
    v_lshlrev_b32 v21, 13, v21
    v_lshl_add_u32 v21, v22, 4, v21
    s_lshl_b32 s21, s3, 21
    s_lshl_b32 s22, s12, 10
    s_add_u32 s21, s21, s22
    s_lshl_b32 s23, s3, 15
    s_mov_b32 s10, 8388608
    s_mov_b32 s11, 131072
    v_lshrrev_b32 v24, 4, v20
    v_bfe_u32 v25, v20, 2, 2
    v_lshl_add_u32 v24, v24, 4, v25
    v_lshlrev_b32 v24, 6, v24
    v_lshl_add_u32 v24, v22, 3, v24
    v_add_u32 v24, s23, v24
    s_and_b32 s70, s13, 1
    s_lshl_b32 s71, s12, 4
    s_add_u32 s71, s71, s13
    s_cmp_eq_u32 s71, 127
    s_cselect_b32 s70, 1, 0
    s_cmp_eq_u32 s13, 7
    s_cselect_b32 s70, 1, s70
    s_lshl_b32 s72, s70, 20
    s_lshl_b32 s73, s70, 21
    s_lshl_b32 s70, s70, 13
    s_sub_u32 s71, s23, s70
    s_add_u32 s70, s23, s70
    s_load_dwordx2 s[8:9], s[0:1], 16
    s_lshl_b32 s25, s13, 6
    s_add_u32 s24, s21, s25
    s_add_u32 s24, s24, s72
    s_waitcnt lgkmcnt(0)
    s_add_u32 m0, s70, 0
    s_nop 0
    buffer_load_dwordx4 v21, s[8:11], s24 offen lds
    s_add_u32 s24, s24, 131072
    s_add_u32 m0, s70, 1024
    s_nop 0
    buffer_load_dwordx4 v21, s[8:11], s24 offen lds
    s_add_u32 s24, s24, 131072
    s_add_u32 m0, s70, 2048
    s_nop 0
    buffer_load_dwordx4 v21, s[8:11], s24 offen lds
    s_add_u32 s24, s24, 131072
    s_add_u32 m0, s70, 3072
    s_nop 0
    buffer_load_dwordx4 v21, s[8:11], s24 offen lds
    s_add_u32 s24, s24, 131072
    s_add_u32 m0, s70, 4096
    s_nop 0
    buffer_load_dwordx4 v21, s[8:11], s24 offen lds
    s_add_u32 s24, s24, 131072
    s_add_u32 m0, s70, 5120
    s_nop 0
    buffer_load_dwordx4 v21, s[8:11], s24 offen lds
    s_add_u32 s24, s24, 131072
    s_add_u32 m0, s70, 6144
    s_nop 0
    buffer_load_dwordx4 v21, s[8:11], s24 offen lds
    s_add_u32 s24, s24, 131072
    s_add_u32 m0, s70, 7168
    s_nop 0
    buffer_load_dwordx4 v21, s[8:11], s24 offen lds
    s_add_u32 s24, s24, 131072
    s_sub_u32 s24, s24, s73
    s_add_u32 m0, s71, 8192
    s_nop 0
    buffer_load_dwordx4 v21, s[8:11], s24 offen lds
    s_add_u32 s24, s24, 131072
    s_add_u32 m0, s71, 9216
    s_nop 0
    buffer_load_dwordx4 v21, s[8:11], s24 offen lds
    s_add_u32 s24, s24, 131072
    s_add_u32 m0, s71, 10240
    s_nop 0
    buffer_load_dwordx4 v21, s[8:11], s24 offen lds
    s_add_u32 s24, s24, 131072
    s_add_u32 m0, s71, 11264
    s_nop 0
    buffer_load_dwordx4 v21, s[8:11], s24 offen lds
    s_add_u32 s24, s24, 131072
    s_add_u32 m0, s71, 12288
    s_nop 0
    buffer_load_dwordx4 v21, s[8:11], s24 offen lds
    s_add_u32 s24, s24, 131072
    s_add_u32 m0, s71, 13312
    s_nop 0
    buffer_load_dwordx4 v21, s[8:11], s24 offen lds
    s_add_u32 s24, s24, 131072
    s_add_u32 m0, s71, 14336
    s_nop 0
    buffer_load_dwordx4 v21, s[8:11], s24 offen lds
    s_add_u32 s24, s24, 131072
    s_add_u32 m0, s71, 15360
    s_nop 0
    buffer_load_dwordx4 v21, s[8:11], s24 offen lds
    s_add_u32 s24, s24, 131072
    s_load_dwordx2 s[8:9], s[0:1], 24
    s_lshl_b32 s25, s13, 6
    s_add_u32 s24, s21, s25
    s_add_u32 s24, s24, s72
    s_waitcnt lgkmcnt(0)
    s_add_u32 m0, s70, 16384
    s_nop 0
    buffer_load_dwordx4 v21, s[8:11], s24 offen lds
    s_add_u32 s24, s24, 131072
    s_add_u32 m0, s70, 17408
    s_nop 0
    buffer_load_dwordx4 v21, s[8:11], s24 offen lds
    s_add_u32 s24, s24, 131072
    s_add_u32 m0, s70, 18432
    s_nop 0
    buffer_load_dwordx4 v21, s[8:11], s24 offen lds
    s_add_u32 s24, s24, 131072
    s_add_u32 m0, s70, 19456
    s_nop 0
    buffer_load_dwordx4 v21, s[8:11], s24 offen lds
    s_add_u32 s24, s24, 131072
    s_add_u32 m0, s70, 20480
    s_nop 0
    buffer_load_dwordx4 v21, s[8:11], s24 offen lds
    s_add_u32 s24, s24, 131072
    s_add_u32 m0, s70, 21504
    s_nop 0
    buffer_load_dwordx4 v21, s[8:11], s24 offen lds
    s_add_u32 s24, s24, 131072
    s_add_u32 m0, s70, 22528
    s_nop 0
    buffer_load_dwordx4 v21, s[8:11], s24 offen lds
    s_add_u32 s24, s24, 131072
    s_add_u32 m0, s70, 23552
    s_nop 0
    buffer_load_dwordx4 v21, s[8:11], s24 offen lds
    s_add_u32 s24, s24, 131072
    s_sub_u32 s24, s24, s73
    s_add_u32 m0, s71, 24576
    s_nop 0
    buffer_load_dwordx4 v21, s[8:11], s24 offen lds
    s_add_u32 s24, s24, 131072
    s_add_u32 m0, s71, 25600
    s_nop 0
    buffer_load_dwordx4 v21, s[8:11], s24 offen lds
    s_add_u32 s24, s24, 131072
    s_add_u32 m0, s71, 26624
    s_nop 0
    buffer_load_dwordx4 v21, s[8:11], s24 offen lds
    s_add_u32 s24, s24, 131072
    s_add_u32 m0, s71, 27648
    s_nop 0
    buffer_load_dwordx4 v21, s[8:11], s24 offen lds
    s_add_u32 s24, s24, 131072
    s_add_u32 m0, s71, 28672
    s_nop 0
    buffer_load_dwordx4 v21, s[8:11], s24 offen lds
    s_add_u32 s24, s24, 131072
    s_add_u32 m0, s71, 29696
    s_nop 0
    buffer_load_dwordx4 v21, s[8:11], s24 offen lds
    s_add_u32 s24, s24, 131072
    s_add_u32 m0, s71, 30720
    s_nop 0
    buffer_load_dwordx4 v21, s[8:11], s24 offen lds
    s_add_u32 s24, s24, 131072
    s_add_u32 m0, s71, 31744
    s_nop 0
    buffer_load_dwordx4 v21, s[8:11], s24 offen lds
    s_add_u32 s24, s24, 131072
    s_load_dwordx2 s[8:9], s[0:1], 32
    s_lshl_b32 s25, s13, 6
    s_add_u32 s24, s21, s25
    s_add_u32 s24, s24, s72
    s_waitcnt lgkmcnt(0)
    buffer_load_dwordx4 v[96:99], v21, s[8:11], s24 offen
    s_add_u32 s24, s24, 131072
    buffer_load_dwordx4 v[100:103], v21, s[8:11], s24 offen
    s_add_u32 s24, s24, 131072
    buffer_load_dwordx4 v[104:107], v21, s[8:11], s24 offen
    s_add_u32 s24, s24, 131072
    buffer_load_dwordx4 v[108:111], v21, s[8:11], s24 offen
    s_add_u32 s24, s24, 131072
    buffer_load_dwordx4 v[144:147], v21, s[8:11], s24 offen
    s_add_u32 s24, s24, 131072
    buffer_load_dwordx4 v[148:151], v21, s[8:11], s24 offen
    s_add_u32 s24, s24, 131072
    buffer_load_dwordx4 v[152:155], v21, s[8:11], s24 offen
    s_add_u32 s24, s24, 131072
    buffer_load_dwordx4 v[156:159], v21, s[8:11], s24 offen
    s_add_u32 s24, s24, 131072
    s_sub_u32 s24, s24, s73
    buffer_load_dwordx4 v[192:195], v21, s[8:11], s24 offen
    s_add_u32 s24, s24, 131072
    buffer_load_dwordx4 v[196:199], v21, s[8:11], s24 offen
    s_add_u32 s24, s24, 131072
    buffer_load_dwordx4 v[200:203], v21, s[8:11], s24 offen
    s_add_u32 s24, s24, 131072
    buffer_load_dwordx4 v[204:207], v21, s[8:11], s24 offen
    s_add_u32 s24, s24, 131072
    buffer_load_dwordx4 v[240:243], v21, s[8:11], s24 offen
    s_add_u32 s24, s24, 131072
    buffer_load_dwordx4 v[244:247], v21, s[8:11], s24 offen
    s_add_u32 s24, s24, 131072
    buffer_load_dwordx4 v[248:251], v21, s[8:11], s24 offen
    s_add_u32 s24, s24, 131072
    buffer_load_dwordx4 v[252:255], v21, s[8:11], s24 offen
    s_add_u32 s24, s24, 131072
    s_load_dwordx2 s[8:9], s[0:1], 8
    s_mov_b32 s10, 16384
    v_bfe_u32 v57, v20, 4, 1
    v_lshrrev_b32 v58, 5, v20
    v_and_b32 v59, 1, v20
    v_bfe_u32 v60, v20, 1, 3
    v_lshlrev_b32 v60, 11, v60
    v_lshl_add_u32 v60, v57, 6, v60
    v_lshl_add_u32 v60, v58, 4, v60
    v_lshl_add_u32 v15, v59, 2, v60
    s_lshl_b32 s24, s3, 9
    s_waitcnt lgkmcnt(0)
    buffer_load_dword v32, v15, s[8:11], s24 offen offset:0
    buffer_load_dword v33, v15, s[8:11], s24 offen offset:8
    buffer_load_dword v34, v15, s[8:11], s24 offen offset:32
    buffer_load_dword v35, v15, s[8:11], s24 offen offset:40
    buffer_load_dword v36, v15, s[8:11], s24 offen offset:128
    buffer_load_dword v37, v15, s[8:11], s24 offen offset:136
    buffer_load_dword v38, v15, s[8:11], s24 offen offset:160
    buffer_load_dword v39, v15, s[8:11], s24 offen offset:168
    buffer_load_dword v40, v15, s[8:11], s24 offen offset:256
    buffer_load_dword v41, v15, s[8:11], s24 offen offset:264
    buffer_load_dword v42, v15, s[8:11], s24 offen offset:288
    buffer_load_dword v43, v15, s[8:11], s24 offen offset:296
    buffer_load_dword v44, v15, s[8:11], s24 offen offset:384
    buffer_load_dword v45, v15, s[8:11], s24 offen offset:392
    buffer_load_dword v46, v15, s[8:11], s24 offen offset:416
    buffer_load_dword v47, v15, s[8:11], s24 offen offset:424
    s_barrier
    v_add_u32 v56, s70, v1
    s_add_u32 s71, s71, 8192
    v_add_u32 v26, s71, v1
    s_waitcnt vmcnt(48)
    ds_read_b64_tr_b16 v[64:65], v24 offset:0
    ds_read_b64_tr_b16 v[66:67], v24 offset:256
    ds_read_b64_tr_b16 v[68:69], v24 offset:512
    ds_read_b64_tr_b16 v[70:71], v24 offset:768
    ds_read_b64_tr_b16 v[72:73], v24 offset:32
    ds_read_b64_tr_b16 v[74:75], v24 offset:288
    ds_read_b64_tr_b16 v[76:77], v24 offset:544
    ds_read_b64_tr_b16 v[78:79], v24 offset:800
    s_waitcnt lgkmcnt(0)
    ds_read_b64_tr_b16 v[112:113], v24 offset:4096
    ds_read_b64_tr_b16 v[114:115], v24 offset:4352
    ds_read_b64_tr_b16 v[116:117], v24 offset:4608
    ds_read_b64_tr_b16 v[118:119], v24 offset:4864
    ds_read_b64_tr_b16 v[120:121], v24 offset:4128
    ds_read_b64_tr_b16 v[122:123], v24 offset:4384
    ds_read_b64_tr_b16 v[124:125], v24 offset:4640
    ds_read_b64_tr_b16 v[126:127], v24 offset:4896
    s_waitcnt lgkmcnt(0)
    ds_read_b64_tr_b16 v[160:161], v24 offset:8192
    ds_read_b64_tr_b16 v[162:163], v24 offset:8448
    ds_read_b64_tr_b16 v[164:165], v24 offset:8704
    ds_read_b64_tr_b16 v[166:167], v24 offset:8960
    ds_read_b64_tr_b16 v[168:169], v24 offset:8224
    ds_read_b64_tr_b16 v[170:171], v24 offset:8480
    ds_read_b64_tr_b16 v[172:173], v24 offset:8736
    ds_read_b64_tr_b16 v[174:175], v24 offset:8992
    s_waitcnt lgkmcnt(0)
    ds_read_b64_tr_b16 v[208:209], v24 offset:12288
    ds_read_b64_tr_b16 v[210:211], v24 offset:12544
    ds_read_b64_tr_b16 v[212:213], v24 offset:12800
    ds_read_b64_tr_b16 v[214:215], v24 offset:13056
    ds_read_b64_tr_b16 v[216:217], v24 offset:12320
    ds_read_b64_tr_b16 v[218:219], v24 offset:12576
    ds_read_b64_tr_b16 v[220:221], v24 offset:12832
    ds_read_b64_tr_b16 v[222:223], v24 offset:13088
    s_waitcnt lgkmcnt(0)
    s_waitcnt vmcnt(32)
    ds_read_b64_tr_b16 v[80:81], v24 offset:16384
    ds_read_b64_tr_b16 v[82:83], v24 offset:16640
    ds_read_b64_tr_b16 v[84:85], v24 offset:16896
    ds_read_b64_tr_b16 v[86:87], v24 offset:17152
    ds_read_b64_tr_b16 v[88:89], v24 offset:16416
    ds_read_b64_tr_b16 v[90:91], v24 offset:16672
    ds_read_b64_tr_b16 v[92:93], v24 offset:16928
    ds_read_b64_tr_b16 v[94:95], v24 offset:17184
    s_waitcnt lgkmcnt(0)
    ds_read_b64_tr_b16 v[128:129], v24 offset:20480
    ds_read_b64_tr_b16 v[130:131], v24 offset:20736
    ds_read_b64_tr_b16 v[132:133], v24 offset:20992
    ds_read_b64_tr_b16 v[134:135], v24 offset:21248
    ds_read_b64_tr_b16 v[136:137], v24 offset:20512
    ds_read_b64_tr_b16 v[138:139], v24 offset:20768
    ds_read_b64_tr_b16 v[140:141], v24 offset:21024
    ds_read_b64_tr_b16 v[142:143], v24 offset:21280
    s_waitcnt lgkmcnt(0)
    ds_read_b64_tr_b16 v[176:177], v24 offset:24576
    ds_read_b64_tr_b16 v[178:179], v24 offset:24832
    ds_read_b64_tr_b16 v[180:181], v24 offset:25088
    ds_read_b64_tr_b16 v[182:183], v24 offset:25344
    ds_read_b64_tr_b16 v[184:185], v24 offset:24608
    ds_read_b64_tr_b16 v[186:187], v24 offset:24864
    ds_read_b64_tr_b16 v[188:189], v24 offset:25120
    ds_read_b64_tr_b16 v[190:191], v24 offset:25376
    s_waitcnt lgkmcnt(0)
    ds_read_b64_tr_b16 v[224:225], v24 offset:28672
    ds_read_b64_tr_b16 v[226:227], v24 offset:28928
    ds_read_b64_tr_b16 v[228:229], v24 offset:29184
    ds_read_b64_tr_b16 v[230:231], v24 offset:29440
    ds_read_b64_tr_b16 v[232:233], v24 offset:28704
    ds_read_b64_tr_b16 v[234:235], v24 offset:28960
    ds_read_b64_tr_b16 v[236:237], v24 offset:29216
    ds_read_b64_tr_b16 v[238:239], v24 offset:29472
    s_waitcnt lgkmcnt(0)
    s_waitcnt vmcnt(16)
    ds_write_b128 v56, v[96:99] offset:0
    ds_write_b128 v56, v[100:103] offset:1024
    ds_write_b128 v56, v[104:107] offset:2048
    ds_write_b128 v56, v[108:111] offset:3072
    ds_write_b128 v56, v[144:147] offset:4096
    ds_write_b128 v56, v[148:151] offset:5120
    ds_write_b128 v56, v[152:155] offset:6144
    ds_write_b128 v56, v[156:159] offset:7168
    ds_write_b128 v26, v[192:195] offset:0
    ds_write_b128 v26, v[196:199] offset:1024
    ds_write_b128 v26, v[200:203] offset:2048
    ds_write_b128 v26, v[204:207] offset:3072
    ds_write_b128 v26, v[240:243] offset:4096
    ds_write_b128 v26, v[244:247] offset:5120
    ds_write_b128 v26, v[248:251] offset:6144
    ds_write_b128 v26, v[252:255] offset:7168
    s_waitcnt lgkmcnt(0)
    ds_read_b64_tr_b16 v[96:97], v24 offset:0
    ds_read_b64_tr_b16 v[98:99], v24 offset:256
    ds_read_b64_tr_b16 v[100:101], v24 offset:512
    ds_read_b64_tr_b16 v[102:103], v24 offset:768
    ds_read_b64_tr_b16 v[104:105], v24 offset:32
    ds_read_b64_tr_b16 v[106:107], v24 offset:288
    ds_read_b64_tr_b16 v[108:109], v24 offset:544
    ds_read_b64_tr_b16 v[110:111], v24 offset:800
    s_waitcnt lgkmcnt(0)
    ds_read_b64_tr_b16 v[144:145], v24 offset:4096
    ds_read_b64_tr_b16 v[146:147], v24 offset:4352
    ds_read_b64_tr_b16 v[148:149], v24 offset:4608
    ds_read_b64_tr_b16 v[150:151], v24 offset:4864
    ds_read_b64_tr_b16 v[152:153], v24 offset:4128
    ds_read_b64_tr_b16 v[154:155], v24 offset:4384
    ds_read_b64_tr_b16 v[156:157], v24 offset:4640
    ds_read_b64_tr_b16 v[158:159], v24 offset:4896
    s_waitcnt lgkmcnt(0)
    ds_read_b64_tr_b16 v[192:193], v24 offset:8192
    ds_read_b64_tr_b16 v[194:195], v24 offset:8448
    ds_read_b64_tr_b16 v[196:197], v24 offset:8704
    ds_read_b64_tr_b16 v[198:199], v24 offset:8960
    ds_read_b64_tr_b16 v[200:201], v24 offset:8224
    ds_read_b64_tr_b16 v[202:203], v24 offset:8480
    ds_read_b64_tr_b16 v[204:205], v24 offset:8736
    ds_read_b64_tr_b16 v[206:207], v24 offset:8992
    s_waitcnt lgkmcnt(0)
    ds_read_b64_tr_b16 v[240:241], v24 offset:12288
    ds_read_b64_tr_b16 v[242:243], v24 offset:12544
    ds_read_b64_tr_b16 v[244:245], v24 offset:12800
    ds_read_b64_tr_b16 v[246:247], v24 offset:13056
    ds_read_b64_tr_b16 v[248:249], v24 offset:12320
    ds_read_b64_tr_b16 v[250:251], v24 offset:12576
    ds_read_b64_tr_b16 v[252:253], v24 offset:12832
    ds_read_b64_tr_b16 v[254:255], v24 offset:13088
    s_waitcnt lgkmcnt(0)
    v_mov_b32 v21, 0x44444444
    v_mov_b32 v22, 0xeeeeeeee
    v_and_b32 v23, 1, v20
    v_cmp_eq_u32 vcc, 0, v23
    v_and_b32 v27, 255, v0
    v_lshlrev_b32 v2, 2, v27
    v_cndmask_b32 v62, v22, v21, vcc
    s_lshr_b32 s21, s15, 1
    s_sub_u32 s21, s21, s15
    s_add_u32 s21, s21, 4
    s_lshl_b32 s21, s21, 10
    s_and_b32 s22, s15, 1
    s_lshl_b32 s22, s22, 9
    s_add_u32 s21, s21, s22
    s_lshl_b32 s22, s3, 7
    s_add_u32 s21, s21, s22
    v_and_b32 v21, 31, v20
    v_lshlrev_b32 v21, 2, v21
    v_add_u32 v3, s21, v21
    v_lshrrev_b32 v21, 4, v20
    v_and_b32 v22, 15, v20
    v_mul_u32_u24 v21, 208, v21
    v_add_lshl_u32 v21, v21, v22, 2
    s_mul_i32 s21, s3, 3328
    v_add_u32 v4, s21, v21
    v_lshrrev_b32 v21, 4, v20
    v_bfe_u32 v22, v20, 2, 1
    v_lshl_add_u32 v21, v21, 1, v22
    v_mul_u32_u24 v21, 104, v21
    v_bfe_u32 v22, v20, 3, 1
    v_xor_b32 v22, 1, v22
    v_lshl_add_u32 v21, v22, 5, v21
    v_and_b32 v22, 3, v20
    v_lshlrev_b32 v22, 1, v22
    s_and_b32 s21, s3, 1
    s_lshl_b32 s21, s21, 2
    v_xor_b32 v22, s21, v22
    v_add_u32 v21, v21, v22
    s_lshl_b32 s21, s3, 3
    v_add_u32 v21, s21, v21
    v_lshlrev_b32 v5, 2, v21
    s_and_b32 s21, s3, 1
    s_lshl_b32 s21, s21, 2
    v_bfe_u32 v21, v20, 3, 2
    v_add_u32 v21, s21, v21
    v_mul_u32_u24 v21, 104, v21
    v_bfe_u32 v22, v20, 1, 1
    v_lshl_add_u32 v21, v22, 3, v21
    v_and_b32 v23, 1, v20
    v_xor_b32 v22, v22, v23
    v_lshl_add_u32 v21, v22, 2, v21
    v_bfe_u32 v22, v20, 2, 1
    v_lshl_add_u32 v21, v22, 1, v21
    s_lshr_b32 s21, s3, 1
    s_lshl_b32 s21, s21, 4
    s_add_u32 s21, s21, 64
    v_add_u32 v21, s21, v21
    v_lshlrev_b32 v6, 2, v21
    v_lshrrev_b32 v21, 6, v27
    v_bfe_u32 v22, v27, 1, 1
    v_lshrrev_b32 v23, 1, v21
    v_lshl_add_u32 v22, v22, 1, v23
    v_xor_b32 v23, v27, v22
    v_and_b32 v23, 1, v23
    v_and_b32 v21, 1, v21
    v_lshl_add_u32 v21, v21, 1, v23
    v_mul_u32_u24 v21, 544, v21
    v_lshl_add_u32 v21, v22, 5, v21
    v_bfe_u32 v23, v27, 4, 2
    v_mul_u32_u24 v23, 136, v23
    v_add_u32 v21, v21, v23
    v_bfe_u32 v24, v27, 3, 1
    v_lshl_add_u32 v21, v24, 2, v21
    v_bfe_u32 v24, v27, 2, 1
    v_lshl_add_u32 v21, v24, 4, v21
    v_add_u32 v7, 16384, v21
    v_lshlrev_b32 v8, 2, v20
    s_and_b32 s21, s12, 1
    s_lshl_b32 s21, s21, 9
    s_lshl_b32 s22, s3, 7
    s_add_u32 s21, s21, s22
    v_and_b32 v21, 7, v20
    v_lshlrev_b32 v21, 4, v21
    v_add_u32 v21, s21, v21
    v_lshrrev_b32 v22, 3, v20
    v_lshl_add_u32 v12, v22, 10, v21
    v_bfe_u32 v22, v20, 4, 1
    v_lshl_add_u32 v13, v22, 3, v21
    s_and_b32 s21, s3, 1
    s_lshl_b32 s21, s21, 12
    s_lshr_b32 s22, s3, 1
    s_lshl_b32 s22, s22, 11
    s_add_u32 s21, s21, s22
    s_add_u32 s21, s21, 18560
    v_add_u32 v61, s21, v1
    s_lshl_b32 s21, s3, 2
    s_add_u32 s21, s21, 13312
    v_mov_b32 v14, s21
    v_and_b32 v21, 15, v20
    v_and_b32 v22, 1, v20
    v_lshlrev_b32 v22, 4, v22
    v_mov_b32 v23, 0x3f80
    v_lshlrev_b32 v22, v22, v23
    v_lshrrev_b32 v21, 1, v21
    v_cmp_eq_u32 vcc, 0, v21
    s_nop 1
    v_cndmask_b32 v56, 0, v22, vcc
    v_cmp_eq_u32 vcc, 1, v21
    s_nop 1
    v_cndmask_b32 v57, 0, v22, vcc
    v_cmp_eq_u32 vcc, 2, v21
    s_nop 1
    v_cndmask_b32 v58, 0, v22, vcc
    v_cmp_eq_u32 vcc, 3, v21
    s_nop 1
    v_cndmask_b32 v59, 0, v22, vcc
    v_and_b32 v21, 7, v20
    v_lshlrev_b32 v21, 7, v21
    v_bfe_u32 v22, v20, 3, 1
    v_lshl_add_u32 v21, v22, 17, v21
    s_lshl_b32 s21, s12, 14
    s_lshl_b32 s22, s13, 10
    s_add_u32 s21, s21, s22
    s_add_u32 s21, s21, 4980736
    v_lshrrev_b32 v22, 4, v20
    v_lshl_add_u32 v21, v22, 24, v21
    v_add_u32 v63, s21, v21
    s_mov_b32 s47, 0x3e0293ee
    s_lshl_b32 s14, s12, 2
    s_add_u32 s14, s14, s3
    s_lshl_b32 s61, s14, 13
    s_add_u32 s61, s61, 2097152
    s_lshl_b32 s14, s14, 12
    s_and_b32 s22, s13, 1
    s_lshl_b32 s69, s22, 17
    s_add_u32 s69, s69, s14
    s_add_u32 s69, s69, 4194304
    s_add_u32 s52, s14, 20971520
    s_lshl_b32 s21, s22, 11
    s_add_u32 s14, s14, s21
    s_add_u32 s14, s14, 1179648
    s_lshr_b32 s21, s13, 1
    s_sub_u32 s21, s21, 0
    s_cmp_eq_u32 s21, s3
    s_cselect_b32 s15, 1, 0
    s_add_u32 s23, s3, 3
    s_and_b32 s23, s23, 3
    s_cmp_eq_u32 s21, s23
    s_cselect_b32 s31, 1, 0
    s_and_b32 s24, s23, 1
    s_and_b32 s25, s3, 1
    s_sub_i32 s24, s24, s25
    s_lshr_b32 s23, s23, 1
    s_lshr_b32 s25, s3, 1
    s_sub_i32 s23, s23, s25
    s_mul_i32 s46, s24, 4096
    s_mul_i32 s25, s23, 2048
    s_add_i32 s46, s46, s25
    s_mul_i32 s27, s24, 32768
    s_mul_i32 s25, s23, 1024
    s_add_i32 s27, s27, s25
    v_lshrrev_b32 v21, 4, v20
    v_and_b32 v23, 15, v20
    v_lshlrev_b32 v21, 2, v21
    v_add_u32 v24, 0, v21
    v_cmp_gt_u32 vcc, v24, v23
    s_cmp_eq_u32 s22, 0
    s_cselect_b64 s[38:39], vcc, 0
    s_cselect_b64 s[48:49], -1, vcc
    v_add_u32 v24, 1, v21
    v_cmp_gt_u32 vcc, v24, v23
    s_cmp_eq_u32 s22, 0
    s_cselect_b64 s[40:41], vcc, 0
    s_cselect_b64 s[50:51], -1, vcc
    v_add_u32 v24, 2, v21
    v_cmp_gt_u32 vcc, v24, v23
    s_cmp_eq_u32 s22, 0
    s_cselect_b64 s[42:43], vcc, 0
    s_cselect_b64 s[54:55], -1, vcc
    v_add_u32 v24, 3, v21
    v_cmp_gt_u32 vcc, v24, v23
    s_cmp_eq_u32 s22, 0
    s_cselect_b64 s[44:45], vcc, 0
    s_cselect_b64 s[56:57], -1, vcc
    s_waitcnt vmcnt(0)
    v_mov_b32 v16, v32
    v_mov_b32 v17, v33
    v_mov_b32 v18, v34
    v_mov_b32 v19, v35
    v_mov_b32 v20, v36
    v_mov_b32 v21, v37
    v_mov_b32 v22, v38
    v_mov_b32 v23, v39
    v_mov_b32 v24, v40
    v_mov_b32 v25, v41
    v_mov_b32 v26, v42
    v_mov_b32 v27, v43
    v_mov_b32 v28, v44
    v_mov_b32 v29, v45
    v_mov_b32 v30, v46
    v_mov_b32 v31, v47
    v_mov_b32 v32, -1
    v_mov_b32 v33, -1
    v_mov_b32 v34, -1
    v_mov_b32 v35, -1
    s_add_u32 s21, s37, 3997696
    buffer_store_dwordx4 v[32:35], v1, s[4:7], s21 offen sc1
    s_add_u32 s21, s37, 4063232
    buffer_store_dwordx4 v[32:35], v1, s[4:7], s21 offen sc1
    s_add_u32 s21, s37, 4128768
    buffer_store_dwordx4 v[32:35], v1, s[4:7], s21 offen sc1
    s_lshl_b32 s29, s29, 5
    s_barrier
    ds_write_b32 v14, v10
    ds_write_b32 v14, v10 offset:16
    ds_write_b32 v14, v10 offset:32
    s_lshl_b32 s53, s3, 13
    s_add_u32 s53, s53, 92160
    v_add_u32 v32, 14336, v1
    ds_write_b128 v32, v[56:59]
    s_lshl_b32 s60, s12, 4
    s_add_u32 s60, s60, 218104320
    v_mov_b32 v15, 0
    s_add_u32 s25, s16, 0
    s_min_u32 s25, s25, 63
    s_cmp_lt_u32 s25, 8
    s_cselect_b32 s59, 12, 24
    s_cselect_b32 s58, -4, -8
    s_and_b32 s25, s25, s58
    s_lshl_b32 s25, s25, 5
    s_add_u32 s58, s25, s60
    v_mov_b32 v32, 131072
    s_waitcnt vmcnt(0) lgkmcnt(0)
    s_barrier
    ds_read_b64 v[32:33], v32
    s_waitcnt lgkmcnt(0)
    v_cmp_ne_u32 vcc, s29, v32
    s_setprio 3
    v_readfirstlane_b32 s63, v33
    s_add_u32 s34, s34, s63
    s_add_u32 s35, s35, s63
gate_6:
    v_readfirstlane_b32 s25, v15
    s_cmp_ge_u32 s25, s59
    s_cbranch_scc1 gate_6_ok
    s_sleep 8
    buffer_load_dword v15, off, s[4:7], s58 sc1
    s_waitcnt vmcnt(0)
    s_sub_u32 s26, s26, 1
    s_cbranch_scc0 gate_6
    s_mov_b32 s26, 0
gate_6_ok:
    s_add_u32 m0, s53, 0
    s_add_u32 s22, s52, 0
    buffer_load_dwordx4 v1, s[4:7], s22 offen offset:0 sc1 lds
    buffer_load_dwordx4 v1, s[4:7], s22 offen offset:1024 sc1 lds
    buffer_load_dwordx4 v1, s[4:7], s22 offen offset:2048 sc1 lds
    buffer_load_dwordx4 v1, s[4:7], s22 offen offset:3072 sc1 lds
    s_add_u32 m0, s53, 4096
    s_add_u32 s22, s52, 131072
    buffer_load_dwordx4 v1, s[4:7], s22 offen offset:0 sc1 lds
    buffer_load_dwordx4 v1, s[4:7], s22 offen offset:1024 sc1 lds
    buffer_load_dwordx4 v1, s[4:7], s22 offen offset:2048 sc1 lds
    buffer_load_dwordx4 v1, s[4:7], s22 offen offset:3072 sc1 lds
    s_add_u32 s52, s52, 262144
    s_cmp_lg_u32 s3, 2
    s_cbranch_scc1 ch_npf
    v_subrev_u32 v32, 786432, v63
    s_mov_b32 exec_hi, 0xffff
    s_mov_b32 s22, 262144
    buffer_load_dword v33, v32, s[4:7], s22 offen sc1
    buffer_load_dword v33, v32, s[4:7], s22 offen offset:64 sc1
    s_mov_b32 s22, 524288
    buffer_load_dword v33, v32, s[4:7], s22 offen sc1
    buffer_load_dword v33, v32, s[4:7], s22 offen offset:64 sc1
    s_mov_b32 exec_hi, -1
    s_waitcnt vmcnt(0)
ch_npf:
    s_cmp_eq_u32 s15, 0
    s_cbranch_scc1 ch_p_nd
    s_mov_b32 m0, 124928
    s_nop 0
    buffer_load_dwordx4 v1, s[4:7], s69 offen offset:0 sc1 lds
    buffer_load_dwordx4 v1, s[4:7], s69 offen offset:1024 sc1 lds
    buffer_load_dwordx4 v1, s[4:7], s69 offen offset:2048 sc1 lds
    buffer_load_dwordx4 v1, s[4:7], s69 offen offset:3072 sc1 lds
    s_add_u32 s69, s69, 262144
ch_p_nd:
    s_cbranch_vccnz ch_p_slow
    v_mov_b32 v32, 0
    v_mov_b32 v33, 0
    v_mov_b32 v34, 0
    v_mov_b32 v35, 0
    v_mov_b32 v36, 0
    v_mov_b32 v37, 0
    v_mov_b32 v38, 0
    v_mov_b32 v39, 0
    v_mov_b32 v40, 0
    v_mov_b32 v41, 0
    v_mov_b32 v42, 0
    v_mov_b32 v43, 0
    v_mov_b32 v44, 0
    v_mov_b32 v45, 0
    v_mov_b32 v46, 0
    v_mov_b32 v47, 0
    v_mov_b32 v48, 0
    v_mov_b32 v49, 0
    v_mov_b32 v50, 0
    v_mov_b32 v51, 0
    v_mov_b32 v52, 0
    v_mov_b32 v53, 0
    v_mov_b32 v54, 0
    v_mov_b32 v55, 0
    v_mov_b32 v0, 1.0
    s_mov_b32 exec_lo, 0xff00ff00
    s_mov_b32 exec_hi, 0xff00ff00
    v_mov_b32 v0, s47
    s_mov_b64 exec, -1
    v_mov_b32 v60, s16
    s_branch pnc_8
.p2align 6
ploop_7:
    s_add_u32 s21, s17, s33
    s_nop 15
    s_nop 5
    buffer_load_dwordx4 v[16:19], v1, s[4:7], s21 offen offset:0 sc1
    s_nop 7
    buffer_load_dwordx4 v[20:23], v1, s[4:7], s21 offen offset:1024 sc1
    s_nop 7
    buffer_load_dwordx4 v[24:27], v1, s[4:7], s21 offen offset:2048 sc1
    s_nop 7
    buffer_load_dwordx4 v[28:31], v1, s[4:7], s21 offen offset:3072 sc1
    s_waitcnt vmcnt(3)
    v_max3_u32 v9, v16, v17, v18
    v_max_u32 v9, v9, v19
    v_cmp_eq_u32 vcc, -1, v9
    s_cbranch_vccnz prm_10_0
prm_10_0ok:
    v_smfmac_f32_16x16x64_bf16 v[32:35], v[16:19], v[64:71], v62
    v_smfmac_f32_16x16x64_bf16 v[36:39], v[16:19], v[72:79], v62
    v_smfmac_f32_16x16x64_bf16 v[40:43], v[16:19], v[80:87], v62
    s_waitcnt vmcnt(2)
    v_max3_u32 v9, v20, v21, v22
    v_max_u32 v9, v9, v23
    v_cmp_eq_u32 vcc, -1, v9
    v_smfmac_f32_16x16x64_bf16 v[44:47], v[16:19], v[88:95], v62
    v_smfmac_f32_16x16x64_bf16 v[48:51], v[16:19], v[96:103], v62
    v_smfmac_f32_16x16x64_bf16 v[52:55], v[16:19], v[104:111], v62
    s_cbranch_vccnz prm_10_1
prm_10_1ok:
    v_smfmac_f32_16x16x64_bf16 v[32:35], v[20:23], v[112:119], v62
    v_readfirstlane_b32 s23, v15
    v_smfmac_f32_16x16x64_bf16 v[36:39], v[20:23], v[120:127], v62
    v_smfmac_f32_16x16x64_bf16 v[40:43], v[20:23], v[128:135], v62
    s_waitcnt vmcnt(1)
    v_max3_u32 v9, v24, v25, v26
    v_max_u32 v9, v9, v27
    v_cmp_eq_u32 vcc, -1, v9
    v_smfmac_f32_16x16x64_bf16 v[44:47], v[20:23], v[136:143], v62
    v_smfmac_f32_16x16x64_bf16 v[48:51], v[20:23], v[144:151], v62
    v_smfmac_f32_16x16x64_bf16 v[52:55], v[20:23], v[152:159], v62
    s_cbranch_vccnz prm_10_2
prm_10_2ok:
    v_smfmac_f32_16x16x64_bf16 v[32:35], v[24:27], v[160:167], v62
    v_smfmac_f32_16x16x64_bf16 v[36:39], v[24:27], v[168:175], v62
    v_smfmac_f32_16x16x64_bf16 v[40:43], v[24:27], v[176:183], v62
    s_waitcnt vmcnt(0)
    v_max3_u32 v9, v28, v29, v30
    v_max_u32 v9, v9, v31
    v_cmp_eq_u32 vcc, -1, v9
    v_smfmac_f32_16x16x64_bf16 v[44:47], v[24:27], v[184:191], v62
    v_smfmac_f32_16x16x64_bf16 v[48:51], v[24:27], v[192:199], v62
    v_smfmac_f32_16x16x64_bf16 v[52:55], v[24:27], v[200:207], v62
    s_cbranch_vccnz prm_10_3
prm_10_3ok:
    v_smfmac_f32_16x16x64_bf16 v[32:35], v[28:31], v[208:215], v62
    s_cmp_lt_u32 s23, s59
    s_cbranch_scc1 prm_10_gt
prm_10_gtb:
    ds_write_b32 v14, v60
    v_smfmac_f32_16x16x64_bf16 v[36:39], v[28:31], v[216:223], v62
    v_smfmac_f32_16x16x64_bf16 v[40:43], v[28:31], v[224:231], v62
    v_smfmac_f32_16x16x64_bf16 v[44:47], v[28:31], v[232:239], v62
    v_add_f32 v32, v32, v33
    v_add_f32 v34, v34, v35
    v_smfmac_f32_16x16x64_bf16 v[48:51], v[28:31], v[240:247], v62
    v_add_f32 v36, v36, v37
    v_add_f32 v38, v38, v39
    ds_write2_b32 v4, v32, v34 offset0:0 offset1:104
    v_smfmac_f32_16x16x64_bf16 v[52:55], v[28:31], v[248:255], v62
    v_add_f32 v40, v40, v41
    v_add_f32 v42, v42, v43
    ds_write2_b32 v4, v36, v38 offset0:16 offset1:120
    v_add_f32 v44, v44, v45
    v_add_f32 v46, v46, v47
    ds_write2_b32 v4, v40, v42 offset0:32 offset1:136
    v_add_f32 v48, v48, v49
    v_add_f32 v50, v50, v51
    ds_write2_b32 v4, v44, v46 offset0:48 offset1:152
    v_add_f32 v52, v52, v53
    v_add_f32 v54, v54, v55
    ds_write2_b32 v4, v48, v50 offset0:64 offset1:168
    ds_write2_b32 v4, v52, v54 offset0:80 offset1:184
    s_branch pnc_8_done
pnc_8:
    v_smfmac_f32_16x16x64_bf16 v[32:35], v[16:19], v[64:71], v62
    v_smfmac_f32_16x16x64_bf16 v[36:39], v[16:19], v[72:79], v62
    v_smfmac_f32_16x16x64_bf16 v[40:43], v[16:19], v[80:87], v62
    v_smfmac_f32_16x16x64_bf16 v[44:47], v[16:19], v[88:95], v62
    v_smfmac_f32_16x16x64_bf16 v[48:51], v[16:19], v[96:103], v62
    v_smfmac_f32_16x16x64_bf16 v[52:55], v[16:19], v[104:111], v62
    v_smfmac_f32_16x16x64_bf16 v[32:35], v[20:23], v[112:119], v62
    v_smfmac_f32_16x16x64_bf16 v[36:39], v[20:23], v[120:127], v62
    v_smfmac_f32_16x16x64_bf16 v[40:43], v[20:23], v[128:135], v62
    v_smfmac_f32_16x16x64_bf16 v[44:47], v[20:23], v[136:143], v62
    v_smfmac_f32_16x16x64_bf16 v[48:51], v[20:23], v[144:151], v62
    v_smfmac_f32_16x16x64_bf16 v[52:55], v[20:23], v[152:159], v62
    v_smfmac_f32_16x16x64_bf16 v[32:35], v[24:27], v[160:167], v62
    v_smfmac_f32_16x16x64_bf16 v[36:39], v[24:27], v[168:175], v62
    v_smfmac_f32_16x16x64_bf16 v[40:43], v[24:27], v[176:183], v62
    v_smfmac_f32_16x16x64_bf16 v[44:47], v[24:27], v[184:191], v62
    v_smfmac_f32_16x16x64_bf16 v[48:51], v[24:27], v[192:199], v62
    v_smfmac_f32_16x16x64_bf16 v[52:55], v[24:27], v[200:207], v62
    v_smfmac_f32_16x16x64_bf16 v[32:35], v[28:31], v[208:215], v62
    ds_write_b32 v14, v60
    v_smfmac_f32_16x16x64_bf16 v[36:39], v[28:31], v[216:223], v62
    v_smfmac_f32_16x16x64_bf16 v[40:43], v[28:31], v[224:231], v62
    v_smfmac_f32_16x16x64_bf16 v[44:47], v[28:31], v[232:239], v62
    v_add_f32 v32, v32, v33
    v_add_f32 v34, v34, v35
    v_smfmac_f32_16x16x64_bf16 v[48:51], v[28:31], v[240:247], v62
    v_add_f32 v36, v36, v37
    v_add_f32 v38, v38, v39
    ds_write2_b32 v4, v32, v34 offset0:0 offset1:104
    v_smfmac_f32_16x16x64_bf16 v[52:55], v[28:31], v[248:255], v62
    v_add_f32 v40, v40, v41
    v_add_f32 v42, v42, v43
    ds_write2_b32 v4, v36, v38 offset0:16 offset1:120
    v_add_f32 v44, v44, v45
    v_add_f32 v46, v46, v47
    ds_write2_b32 v4, v40, v42 offset0:32 offset1:136
    v_add_f32 v48, v48, v49
    v_add_f32 v50, v50, v51
    ds_write2_b32 v4, v44, v46 offset0:48 offset1:152
    v_add_f32 v52, v52, v53
    v_add_f32 v54, v54, v55
    ds_write2_b32 v4, v48, v50 offset0:64 offset1:168
    ds_write2_b32 v4, v52, v54 offset0:80 offset1:184
    s_waitcnt vmcnt(0)
pnc_8_done:
    s_add_u32 s21, s17, s32
    s_add_u32 s22, s19, s32
    s_add_u32 s24, s19, s35
    s_waitcnt lgkmcnt(0)
    s_barrier
    ds_read_b64 v[32:33], v5 offset:0
    ds_read_b64 v[34:35], v5 offset:3328
    ds_read_b64 v[36:37], v5 offset:6656
    ds_read_b64 v[38:39], v5 offset:9984
    ds_read_b64 v[40:41], v6 offset:0
    ds_read_b64 v[42:43], v6 offset:3328
    ds_read_b64 v[44:45], v6 offset:6656
    ds_read_b64 v[46:47], v6 offset:9984
    s_waitcnt lgkmcnt(6)
    v_add_f32 v32, v32, v34
    v_add_f32 v33, v33, v35
    s_waitcnt lgkmcnt(4)
    v_add_f32 v36, v36, v38
    v_add_f32 v37, v37, v39
    v_add_f32 v32, v32, v36
    v_add_f32 v33, v33, v37
    v_mul_f32 v32, v32, v0
    v_mul_f32 v33, v33, v0
    v_cvt_pk_bf16_f32 v32, v32, v33
    v_min_u32 v32, -2, v32
    buffer_store_dword v32, v2, s[4:7], s21 offen
    s_waitcnt lgkmcnt(2)
    v_add_f32 v40, v40, v42
    v_add_f32 v41, v41, v43
    s_waitcnt lgkmcnt(0)
    v_add_f32 v44, v44, v46
    v_add_f32 v45, v45, v47
    v_add_f32 v40, v40, v44
    v_add_f32 v41, v41, v45
    v_cvt_pk_bf16_f32 v40, v40, v41
    v_min_u32 v40, -2, v40
    s_mov_b32 exec_hi, 0
    buffer_store_dword v40, v3, s[4:7], s21 offen
    s_setprio 0
    s_mov_b64 exec, -1
    s_add_u32 s21, s17, s35
    s_add_u32 s30, s17, s34
    s_add_u32 s23, s18, s36
    s_add_u32 s25, s16, 2
    s_min_u32 s25, s25, 63
    s_cmp_lt_u32 s25, 8
    s_cselect_b32 s59, 12, 24
    s_cselect_b32 s58, -4, -8
    s_and_b32 s25, s25, s58
    s_lshl_b32 s25, s25, 5
    s_add_u32 s58, s25, s60
    s_cmp_eq_u32 s15, 0
    s_cbranch_scc1 ploop_7_nd
    v_add_u32 v9, s53, v1
    v_add_u32 v0, 124928, v1
    ds_read_b128 v[16:19], v0 offset:0
    ds_read_b128 v[32:35], v9 offset:0
    ds_read_b128 v[20:23], v0 offset:1024
    ds_read_b128 v[36:39], v9 offset:1024
    ds_read_b128 v[24:27], v0 offset:2048
    ds_read_b128 v[40:43], v9 offset:2048
    ds_read_b128 v[28:31], v0 offset:3072
    ds_read_b128 v[44:47], v9 offset:3072
    s_add_u32 s22, s17, s61
    s_waitcnt lgkmcnt(6)
    v_mfma_f32_16x16x32_bf16 v[48:51], v[32:35], v[16:19], 0
    ds_read_b128 v[32:35], v9 offset:4096
    s_waitcnt lgkmcnt(5)
    v_mfma_f32_16x16x32_bf16 v[48:51], v[36:39], v[20:23], v[48:51]
    ds_read_b128 v[36:39], v9 offset:5120
    s_waitcnt lgkmcnt(4)
    v_mfma_f32_16x16x32_bf16 v[48:51], v[40:43], v[24:27], v[48:51]
    ds_read_b128 v[40:43], v9 offset:6144
    s_waitcnt lgkmcnt(3)
    v_mfma_f32_16x16x32_bf16 v[48:51], v[44:47], v[28:31], v[48:51]
    ds_read_b128 v[44:47], v9 offset:7168
    s_waitcnt lgkmcnt(3)
    v_mfma_f32_16x16x32_bf16 v[52:55], v[32:35], v[16:19], 0
    s_waitcnt lgkmcnt(2)
    v_mfma_f32_16x16x32_bf16 v[52:55], v[36:39], v[20:23], v[52:55]
    s_waitcnt lgkmcnt(1)
    v_mfma_f32_16x16x32_bf16 v[52:55], v[40:43], v[24:27], v[52:55]
    s_waitcnt lgkmcnt(0)
    v_mfma_f32_16x16x32_bf16 v[52:55], v[44:47], v[28:31], v[52:55]
    buffer_load_dwordx4 v[32:35], v1, s[4:7], s22 offen offset:0 sc1
    buffer_load_dwordx4 v[36:39], v1, s[4:7], s22 offen offset:1024 sc1
    buffer_load_dwordx4 v[40:43], v1, s[4:7], s22 offen offset:2048 sc1
    buffer_load_dwordx4 v[44:47], v1, s[4:7], s22 offen offset:3072 sc1
    v_mov_b32 v60, 0xff61b1e6
    s_nop 2
    v_cndmask_b32 v48, v48, v60, s[38:39]
    v_cndmask_b32 v49, v49, v60, s[40:41]
    v_cndmask_b32 v50, v50, v60, s[42:43]
    v_cndmask_b32 v51, v51, v60, s[44:45]
    v_cndmask_b32 v52, v52, v60, s[48:49]
    v_cndmask_b32 v53, v53, v60, s[50:51]
    v_cndmask_b32 v54, v54, v60, s[54:55]
    v_cndmask_b32 v55, v55, v60, s[56:57]
    v_max3_f32 v0, v48, v49, v50
    v_max3_f32 v9, v51, v52, v53
    v_max3_f32 v0, v0, v54, v55
    v_max_f32 v0, v0, v9
    v_mov_b32 v9, v0
    s_nop 1
    v_permlane16_swap_b32 v9, v0
    v_max_f32 v0, v0, v9
    v_mov_b32 v9, v0
    s_nop 1
    v_permlane32_swap_b32 v9, v0
    v_max_f32 v0, v0, v9
    v_mul_f32 v0, s47, v0
    v_fma_f32 v48, v48, s47, -v0
    v_fma_f32 v49, v49, s47, -v0
    v_fma_f32 v50, v50, s47, -v0
    v_fma_f32 v51, v51, s47, -v0
    v_fma_f32 v52, v52, s47, -v0
    v_fma_f32 v53, v53, s47, -v0
    v_fma_f32 v54, v54, s47, -v0
    v_fma_f32 v55, v55, s47, -v0
    v_exp_f32 v48, v48
    v_exp_f32 v49, v49
    v_exp_f32 v50, v50
    v_exp_f32 v51, v51
    v_exp_f32 v52, v52
    v_exp_f32 v53, v53
    v_exp_f32 v54, v54
    v_exp_f32 v55, v55
    v_add_f32 v15, v48, v49
    v_add_f32 v15, v15, v50
    v_add_f32 v15, v15, v51
    v_add_f32 v15, v15, v52
    v_add_f32 v15, v15, v53
    v_add_f32 v15, v15, v54
    v_add_f32 v15, v15, v55
ploop_7_za:
    s_waitcnt vmcnt(0)
    v_max3_u32 v9, v32, v33, v34
    v_max3_u32 v9, v9, v35, v36
    v_max3_u32 v9, v9, v37, v38
    v_max3_u32 v9, v9, v39, v40
    v_max3_u32 v9, v9, v41, v42
    v_max3_u32 v9, v9, v43, v44
    v_max3_u32 v9, v9, v45, v46
    v_max_u32 v9, v9, v47
    v_cmp_eq_u32 vcc, -1, v9
    s_cbranch_vccnz ploop_7_zr
ploop_7_zok:
    v_mfma_f32_16x16x32_bf16 v[56:59], v[32:35], v[16:19], 0
    v_mfma_f32_16x16x32_bf16 v[56:59], v[36:39], v[20:23], v[56:59]
    v_mfma_f32_16x16x32_bf16 v[56:59], v[40:43], v[24:27], v[56:59]
    v_mfma_f32_16x16x32_bf16 v[56:59], v[44:47], v[28:31], v[56:59]
    s_add_u32 s22, s17, s14
    s_nop 6
    v_max_f32 v60, v56, v57
    v_mov_b32 v9, v60
    s_nop 1
    v_permlane16_swap_b32 v9, v60
    v_max_f32 v60, v60, v9
    v_mov_b32 v9, v60
    s_nop 1
    v_permlane32_swap_b32 v9, v60
    v_max_f32 v60, v60, v9
    v_mul_f32 v60, s47, v60
    v_max_f32 v58, v60, v0
    v_sub_f32 v60, v0, v58
    v_fma_f32 v56, v56, s47, -v58
    v_fma_f32 v57, v57, s47, -v58
    v_exp_f32 v60, v60
    v_exp_f32 v56, v56
    v_exp_f32 v57, v57
    v_fma_f32 v15, v15, v60, v56
    v_add_f32 v15, v15, v57
    v_mov_b32 v9, v15
    s_nop 1
    v_permlane16_swap_b32 v9, v15
    v_add_f32 v15, v15, v9
    v_mov_b32 v9, v15
    s_nop 1
    v_permlane32_swap_b32 v9, v15
    v_add_f32 v15, v15, v9
    v_rcp_f32 v15, v15
    s_add_u32 s25, s19, s14
    v_mul_f32 v56, v56, v15
    v_mul_f32 v57, v57, v15
    v_mul_f32 v60, v60, v15
    v_mul_f32 v48, v48, v60
    v_mul_f32 v49, v49, v60
    v_mul_f32 v50, v50, v60
    v_mul_f32 v51, v51, v60
    v_mul_f32 v52, v52, v60
    v_mul_f32 v53, v53, v60
    v_mul_f32 v54, v54, v60
    v_mul_f32 v55, v55, v60
    v_cvt_pk_bf16_f32 v48, v48, v49
    v_cvt_pk_bf16_f32 v49, v50, v51
    v_cvt_pk_bf16_f32 v50, v52, v53
    v_cvt_pk_bf16_f32 v51, v54, v55
    v_min_u32 v48, -2, v48
    v_min_u32 v49, -2, v49
    v_min_u32 v50, -2, v50
    v_min_u32 v51, -2, v51
    v_lshlrev_b32 v54, 1, v8
    v_add_u32 v55, 14336, v1
    v_mov_b32 v53, 1.0
    v_cvt_pk_bf16_f32 v52, v56, v57
    v_min_u32 v53, -2, v53
    v_min_u32 v52, -2, v52
    buffer_store_dwordx4 v[48:51], v1, s[4:7], s22 offen
    buffer_store_dwordx2 v[52:53], v54, s[4:7], s22 offen offset:1024
    ds_read_b128 v[56:59], v55
    s_branch ploop_7_nd2
ploop_7_nd:
    s_cmp_eq_u32 s16, 0
    s_cbranch_scc1 ploop_7_ns
    s_cmp_eq_u32 s31, 0
    s_cbranch_scc1 ploop_7_n2
    s_add_u32 s25, s68, s46
    v_add_u32 v55, s25, v61
    ds_read_b128 v[24:27], v55 offset:0
    ds_read_b128 v[28:31], v55 offset:1024
    ds_read_b128 v[32:35], v55 offset:18560
    ds_read_b128 v[36:39], v55 offset:19584
    ds_read_b128 v[40:43], v55 offset:37120
    ds_read_b128 v[44:47], v55 offset:38144
    ds_read_b128 v[48:51], v55 offset:55680
    ds_read_b128 v[52:55], v55 offset:56704
    s_waitcnt lgkmcnt(4)
    v_add_f32 v24, v24, v32
    v_add_f32 v25, v25, v33
    v_add_f32 v26, v26, v34
    v_add_f32 v27, v27, v35
    v_add_f32 v28, v28, v36
    v_add_f32 v29, v29, v37
    v_add_f32 v30, v30, v38
    v_add_f32 v31, v31, v39
    s_waitcnt lgkmcnt(0)
    v_add_f32 v40, v40, v48
    v_add_f32 v41, v41, v49
    v_add_f32 v42, v42, v50
    v_add_f32 v43, v43, v51
    v_add_f32 v44, v44, v52
    v_add_f32 v45, v45, v53
    v_add_f32 v46, v46, v54
    v_add_f32 v47, v47, v55
    v_add_f32 v24, v24, v40
    v_add_f32 v25, v25, v41
    v_add_f32 v26, v26, v42
    v_add_f32 v27, v27, v43
    v_add_f32 v28, v28, v44
    v_add_f32 v29, v29, v45
    v_add_f32 v30, v30, v46
    v_add_f32 v31, v31, v47
    v_cvt_pk_bf16_f32 v24, v24, v25
    v_cvt_pk_bf16_f32 v25, v26, v27
    v_cvt_pk_bf16_f32 v26, v28, v29
    v_cvt_pk_bf16_f32 v27, v30, v31
    v_min_u32 v24, -2, v24
    v_min_u32 v25, -2, v25
    v_min_u32 v26, -2, v26
    v_min_u32 v27, -2, v27
    v_mov_b32 v16, v24
    v_mov_b32 v17, v25
    v_mov_b32 v18, v26
    v_mov_b32 v19, v27
ploop_7_n2:
    v_add_u32 v55, s68, v61
    ds_read_b128 v[24:27], v55 offset:0
    ds_read_b128 v[28:31], v55 offset:1024
    ds_read_b128 v[32:35], v55 offset:18560
    ds_read_b128 v[36:39], v55 offset:19584
    ds_read_b128 v[40:43], v55 offset:37120
    ds_read_b128 v[44:47], v55 offset:38144
    ds_read_b128 v[48:51], v55 offset:55680
    ds_read_b128 v[52:55], v55 offset:56704
    s_waitcnt lgkmcnt(4)
    v_add_f32 v24, v24, v32
    v_add_f32 v25, v25, v33
    v_add_f32 v26, v26, v34
    v_add_f32 v27, v27, v35
    v_add_f32 v28, v28, v36
    v_add_f32 v29, v29, v37
    v_add_f32 v30, v30, v38
    v_add_f32 v31, v31, v39
    s_waitcnt lgkmcnt(0)
    v_add_f32 v40, v40, v48
    v_add_f32 v41, v41, v49
    v_add_f32 v42, v42, v50
    v_add_f32 v43, v43, v51
    v_add_f32 v44, v44, v52
    v_add_f32 v45, v45, v53
    v_add_f32 v46, v46, v54
    v_add_f32 v47, v47, v55
    v_add_f32 v24, v24, v40
    v_add_f32 v25, v25, v41
    v_add_f32 v26, v26, v42
    v_add_f32 v27, v27, v43
    v_add_f32 v28, v28, v44
    v_add_f32 v29, v29, v45
    v_add_f32 v30, v30, v46
    v_add_f32 v31, v31, v47
    v_cvt_pk_bf16_f32 v24, v24, v25
    v_cvt_pk_bf16_f32 v25, v26, v27
    v_cvt_pk_bf16_f32 v26, v28, v29
    v_cvt_pk_bf16_f32 v27, v30, v31
    v_min_u32 v24, -2, v24
    v_min_u32 v25, -2, v25
    v_min_u32 v26, -2, v26
    v_min_u32 v27, -2, v27
ploop_7_ns:
ploop_7_flag:
    ds_read_b32 v9, v14 offset:16
    s_waitcnt lgkmcnt(0)
    v_readfirstlane_b32 s25, v9
    s_cmp_eq_u32 s25, s16
    s_cbranch_scc0 ploop_7_flag
    s_add_u32 m0, s53, 0
    s_add_u32 s22, s52, 0
    buffer_load_dwordx4 v1, s[4:7], s22 offen offset:0 sc1 lds
    buffer_load_dwordx4 v1, s[4:7], s22 offen offset:1024 sc1 lds
    buffer_load_dwordx4 v1, s[4:7], s22 offen offset:2048 sc1 lds
    buffer_load_dwordx4 v1, s[4:7], s22 offen offset:3072 sc1 lds
    s_add_u32 m0, s53, 4096
    s_add_u32 s22, s52, 131072
    buffer_load_dwordx4 v1, s[4:7], s22 offen offset:0 sc1 lds
    buffer_load_dwordx4 v1, s[4:7], s22 offen offset:1024 sc1 lds
    buffer_load_dwordx4 v1, s[4:7], s22 offen offset:2048 sc1 lds
    buffer_load_dwordx4 v1, s[4:7], s22 offen offset:3072 sc1 lds
    s_add_u32 s52, s52, 262144
    s_cmp_eq_u32 s16, 0
    s_cbranch_scc1 ploop_7_nd2
    buffer_store_dwordx4 v[24:27], v1, s[4:7], s37 offen sc1
    s_cmp_eq_u32 s31, 0
    s_cbranch_scc1 ploop_7_nd2
    s_add_u32 s25, s37, s27
    buffer_store_dwordx4 v[16:19], v1, s[4:7], s25 offen sc1
ploop_7_nd2:
    s_cmp_eq_u32 s16, 0
    s_cbranch_scc1 ploop_7_nn
    s_add_u32 s37, s37, 65536
    s_xor_b32 s68, s68, 8192
ploop_7_nn:
    s_cmp_lg_u32 s3, 2
    s_cbranch_scc1 ppf_12
    s_lshl_b32 s22, s16, 18
    s_mov_b32 exec_hi, 0xffff
    buffer_load_dword v9, v63, s[4:7], s22 offen sc1
    s_mov_b32 exec_hi, -1
ppf_12:
    v_add_u32 v24, 18560, v7
    v_add_u32 v25, 37120, v7
    v_add_u32 v26, 55680, v7
    s_cmp_eq_u32 s16, 63
    s_setprio 3
    s_barrier
    s_cbranch_scc1 ptail_9
    ds_read2_b32 v[16:17], v7 offset0:0 offset1:2
    ds_read2_b32 v[18:19], v24 offset0:0 offset1:2
    ds_read2_b32 v[20:21], v25 offset0:0 offset1:2
    ds_read2_b32 v[22:23], v26 offset0:0 offset1:2
    s_waitcnt lgkmcnt(2)
    v_add_f32 v16, v16, v18
    v_add_f32 v17, v17, v19
    s_waitcnt lgkmcnt(0)
    v_add_f32 v20, v20, v22
    v_add_f32 v21, v21, v23
    v_add_f32 v16, v16, v20
    v_add_f32 v17, v17, v21
    v_cvt_pk_bf16_f32 v16, v16, v17
    v_min_u32 v16, -2, v16
    buffer_store_dword v16, v2, s[4:7], s21 offen sc1
    buffer_store_dword v10, v2, s[4:7], s24 offen sc1
    s_cmp_eq_u32 s15, 0
    s_cbranch_scc1 ploop_7_pnd
    s_sleep 6
    s_nop 8
    buffer_load_dwordx4 v[16:19], v12, s[4:7], s30 offen sc1
    buffer_load_dword v15, off, s[4:7], s58 sc1
    s_add_u32 s25, s19, s14
    v_mov_b32 v20, -1
    v_mov_b32 v21, -1
    v_mov_b32 v22, -1
    v_mov_b32 v23, -1
    buffer_store_dwordx4 v[20:23], v1, s[4:7], s25 offen
    buffer_store_dwordx2 v[20:21], v54, s[4:7], s25 offen offset:1024
    s_mov_b32 m0, 124928
    s_nop 0
    buffer_load_dwordx4 v1, s[4:7], s69 offen offset:0 sc1 lds
    buffer_load_dwordx4 v1, s[4:7], s69 offen offset:1024 sc1 lds
    buffer_load_dwordx4 v1, s[4:7], s69 offen offset:2048 sc1 lds
    buffer_load_dwordx4 v1, s[4:7], s69 offen offset:3072 sc1 lds
    s_add_u32 s69, s69, 262144
    s_add_u32 m0, s53, 0
    s_add_u32 s22, s52, 0
    buffer_load_dwordx4 v1, s[4:7], s22 offen offset:0 sc1 lds
    buffer_load_dwordx4 v1, s[4:7], s22 offen offset:1024 sc1 lds
    buffer_load_dwordx4 v1, s[4:7], s22 offen offset:2048 sc1 lds
    buffer_load_dwordx4 v1, s[4:7], s22 offen offset:3072 sc1 lds
    s_add_u32 m0, s53, 4096
    s_add_u32 s22, s52, 131072
    buffer_load_dwordx4 v1, s[4:7], s22 offen offset:0 sc1 lds
    buffer_load_dwordx4 v1, s[4:7], s22 offen offset:1024 sc1 lds
    buffer_load_dwordx4 v1, s[4:7], s22 offen offset:2048 sc1 lds
    buffer_load_dwordx4 v1, s[4:7], s22 offen offset:3072 sc1 lds
    s_add_u32 s52, s52, 262144
    s_add_u32 s22, s16, 1
    v_mov_b32 v60, s22
    v_mov_b32 v32, 0
    v_mov_b32 v33, 0
    v_mov_b32 v34, 0
    v_mov_b32 v35, 0
    v_mov_b32 v36, 0
    v_mov_b32 v37, 0
    v_mov_b32 v38, 0
    v_mov_b32 v39, 0
    v_mov_b32 v40, 0
    v_mov_b32 v41, 0
    v_mov_b32 v42, 0
    v_mov_b32 v43, 0
    v_mov_b32 v44, 0
    v_mov_b32 v45, 0
    v_mov_b32 v46, 0
    v_mov_b32 v47, 0
    v_mov_b32 v48, 0
    v_mov_b32 v49, 0
    v_mov_b32 v50, 0
    v_mov_b32 v51, 0
    v_mov_b32 v52, 0
    v_mov_b32 v53, 0
    v_mov_b32 v54, 0
    v_mov_b32 v55, 0
    v_mov_b32 v0, 1.0
    s_mov_b32 exec_lo, 0xff00ff00
    s_mov_b32 exec_hi, 0xff00ff00
    v_mov_b32 v0, s47
    s_mov_b64 exec, -1
    s_waitcnt vmcnt(15) lgkmcnt(0)
    s_branch ploop_7_pchk
ploop_7_pnd:
    s_sleep 6
    s_nop 8
    buffer_load_dwordx4 v[16:19], v12, s[4:7], s30 offen sc1
    buffer_load_dword v15, off, s[4:7], s58 sc1
    s_add_u32 s22, s16, 1
    v_mov_b32 v60, s22
    v_mov_b32 v32, 0
    v_mov_b32 v33, 0
    v_mov_b32 v34, 0
    v_mov_b32 v35, 0
    v_mov_b32 v36, 0
    v_mov_b32 v37, 0
    v_mov_b32 v38, 0
    v_mov_b32 v39, 0
    v_mov_b32 v40, 0
    v_mov_b32 v41, 0
    v_mov_b32 v42, 0
    v_mov_b32 v43, 0
    v_mov_b32 v44, 0
    v_mov_b32 v45, 0
    v_mov_b32 v46, 0
    v_mov_b32 v47, 0
    v_mov_b32 v48, 0
    v_mov_b32 v49, 0
    v_mov_b32 v50, 0
    v_mov_b32 v51, 0
    v_mov_b32 v52, 0
    v_mov_b32 v53, 0
    v_mov_b32 v54, 0
    v_mov_b32 v55, 0
    v_mov_b32 v0, 1.0
    s_mov_b32 exec_lo, 0xff00ff00
    s_mov_b32 exec_hi, 0xff00ff00
    v_mov_b32 v0, s47
    s_mov_b64 exec, -1
    s_waitcnt vmcnt(1) lgkmcnt(0)
    s_branch ploop_7_pchk
ploop_7_pagain:
    s_waitcnt vmcnt(1) lgkmcnt(0)
ploop_7_pchk:
    v_mfma_f32_16x16x32_bf16 v[20:23], v[56:59], v[16:19], 0
    v_max3_u32 v9, v16, v17, v18
    v_max_u32 v9, v9, v19
    v_cmp_eq_u32 vcc, -1, v9
    s_cbranch_vccnz prp_11
ploop_7_pgo:
    s_nop 3
    v_add_f32_dpp v20, v20, v20 row_ror:8 row_mask:0xf bank_mask:0xf
    v_add_f32_dpp v21, v21, v21 row_ror:8 row_mask:0xf bank_mask:0xf
    v_add_f32_dpp v22, v22, v22 row_ror:8 row_mask:0xf bank_mask:0xf
    v_add_f32_dpp v23, v23, v23 row_ror:8 row_mask:0xf bank_mask:0xf
    v_cvt_pk_bf16_f32 v20, v20, v21
    v_cvt_pk_bf16_f32 v21, v22, v23
    s_mov_b32 exec_hi, 0
    v_min_u32 v20, -2, v20
    v_min_u32 v21, -2, v21
    s_mov_b32 exec_lo, 0x00ff00ff
    buffer_store_dwordx2 v[20:21], v13, s[4:7], s23 offen
    s_mov_b64 exec, -1
    s_add_u32 s22, s19, s32
    s_add_u32 s25, s20, s36
    buffer_store_dword v10, v2, s[4:7], s22 offen
    s_mov_b32 exec_hi, 0
    buffer_store_dword v10, v3, s[4:7], s22 offen
    s_mov_b32 exec_lo, 0x00ff00ff
    buffer_store_dwordx2 v[10:11], v13, s[4:7], s25 offen
    s_mov_b64 exec, -1
    s_add_u32 s16, s16, 1
    s_mov_b32 s17, s18
    s_mov_b32 s18, s19
    s_mov_b32 s19, s20
    s_add_u32 s20, s20, 262144
    s_cmp_eq_u32 s20, 210763776
    s_cselect_b32 s20, 209715200, s20
    s_branch ploop_7
prm_10_gt:
gate_13:
    v_readfirstlane_b32 s25, v15
    s_cmp_ge_u32 s25, s59
    s_cbranch_scc1 gate_13_ok
    s_sleep 8
    buffer_load_dword v15, off, s[4:7], s58 sc1
    s_waitcnt vmcnt(0)
    s_sub_u32 s26, s26, 1
    s_cbranch_scc0 gate_13
    s_mov_b32 s26, 0
gate_13_ok:
    s_branch prm_10_gtb
prm_10_0:
    s_sub_u32 s26, s26, 1
    s_cbranch_scc1 prm_10_0_g
    buffer_load_dwordx4 v[16:19], v1, s[4:7], s21 offen offset:0 sc1
    buffer_load_dwordx4 v[20:23], v1, s[4:7], s21 offen offset:1024 sc1
    buffer_load_dwordx4 v[24:27], v1, s[4:7], s21 offen offset:2048 sc1
    buffer_load_dwordx4 v[28:31], v1, s[4:7], s21 offen offset:3072 sc1
    s_waitcnt vmcnt(3)
    v_max3_u32 v9, v16, v17, v18
    v_max_u32 v9, v9, v19
    v_cmp_eq_u32 vcc, -1, v9
    s_cbranch_vccnz prm_10_0
    s_branch prm_10_0ok
prm_10_0_g:
    s_mov_b32 s26, 0
    s_waitcnt vmcnt(0)
    s_branch prm_10_0ok
prm_10_1:
    s_sub_u32 s26, s26, 1
    s_cbranch_scc1 prm_10_1_g
    buffer_load_dwordx4 v[20:23], v1, s[4:7], s21 offen offset:1024 sc1
    buffer_load_dwordx4 v[24:27], v1, s[4:7], s21 offen offset:2048 sc1
    buffer_load_dwordx4 v[28:31], v1, s[4:7], s21 offen offset:3072 sc1
    s_waitcnt vmcnt(2)
    v_max3_u32 v9, v20, v21, v22
    v_max_u32 v9, v9, v23
    v_cmp_eq_u32 vcc, -1, v9
    s_cbranch_vccnz prm_10_1
    s_branch prm_10_1ok
prm_10_1_g:
    s_mov_b32 s26, 0
    s_waitcnt vmcnt(0)
    s_branch prm_10_1ok
prm_10_2:
    s_sub_u32 s26, s26, 1
    s_cbranch_scc1 prm_10_2_g
    buffer_load_dwordx4 v[24:27], v1, s[4:7], s21 offen offset:2048 sc1
    buffer_load_dwordx4 v[28:31], v1, s[4:7], s21 offen offset:3072 sc1
    s_waitcnt vmcnt(1)
    v_max3_u32 v9, v24, v25, v26
    v_max_u32 v9, v9, v27
    v_cmp_eq_u32 vcc, -1, v9
    s_cbranch_vccnz prm_10_2
    s_branch prm_10_2ok
prm_10_2_g:
    s_mov_b32 s26, 0
    s_waitcnt vmcnt(0)
    s_branch prm_10_2ok
prm_10_3:
    s_sub_u32 s26, s26, 1
    s_cbranch_scc1 prm_10_3_g
    buffer_load_dwordx4 v[28:31], v1, s[4:7], s21 offen offset:3072 sc1
    s_waitcnt vmcnt(0)
    v_max3_u32 v9, v28, v29, v30
    v_max_u32 v9, v9, v31
    v_cmp_eq_u32 vcc, -1, v9
    s_cbranch_vccnz prm_10_3
    s_branch prm_10_3ok
prm_10_3_g:
    s_mov_b32 s26, 0
    s_waitcnt vmcnt(0)
    s_branch prm_10_3ok
prm_10_d:
gate_14:
    v_readfirstlane_b32 s25, v15
    s_cmp_ge_u32 s25, s59
    s_cbranch_scc1 gate_14_ok
    s_sleep 8
    buffer_load_dword v15, off, s[4:7], s58 sc1
    s_waitcnt vmcnt(0)
    s_sub_u32 s26, s26, 1
    s_cbranch_scc0 gate_14
    s_mov_b32 s26, 0
gate_14_ok:
    ds_write_b32 v14, v60
    v_add_f32 v32, v32, v33
    v_add_f32 v34, v34, v35
    ds_write2_b32 v4, v32, v34 offset0:0 offset1:104
    v_add_f32 v36, v36, v37
    v_add_f32 v38, v38, v39
    ds_write2_b32 v4, v36, v38 offset0:16 offset1:120
    v_add_f32 v40, v40, v41
    v_add_f32 v42, v42, v43
    ds_write2_b32 v4, v40, v42 offset0:32 offset1:136
    v_add_f32 v44, v44, v45
    v_add_f32 v46, v46, v47
    ds_write2_b32 v4, v44, v46 offset0:48 offset1:152
    v_add_f32 v48, v48, v49
    v_add_f32 v50, v50, v51
    ds_write2_b32 v4, v48, v50 offset0:64 offset1:168
    v_add_f32 v52, v52, v53
    v_add_f32 v54, v54, v55
    ds_write2_b32 v4, v52, v54 offset0:80 offset1:184
    s_branch pnc_8_done
prp_11:
    s_sub_u32 s26, s26, 1
    s_nop 3
    s_cbranch_scc1 prp_11_g
    buffer_load_dwordx4 v[16:19], v12, s[4:7], s30 offen sc1
    buffer_load_dword v15, off, s[4:7], s58 sc1
    s_branch ploop_7_pagain
prp_11_g:
    s_mov_b32 s26, 0
    s_branch ploop_7_pgo
ploop_7_zr:
    s_sub_u32 s26, s26, 1
    s_cbranch_scc1 ploop_7_zg
    buffer_load_dwordx4 v[32:35], v1, s[4:7], s22 offen offset:0 sc1
    buffer_load_dwordx4 v[36:39], v1, s[4:7], s22 offen offset:1024 sc1
    buffer_load_dwordx4 v[40:43], v1, s[4:7], s22 offen offset:2048 sc1
    buffer_load_dwordx4 v[44:47], v1, s[4:7], s22 offen offset:3072 sc1
    s_branch ploop_7_za
ploop_7_zg:
    s_mov_b32 s26, 0
    s_branch ploop_7_zok
ptail_9:
    s_cmp_eq_u32 s15, 0
    s_cbranch_scc1 ptail_9_nd
    s_nop 0
ptail_9_nd:
    s_barrier
    v_add_u32 v55, s68, v61
    ds_read_b128 v[24:27], v55 offset:0
    ds_read_b128 v[28:31], v55 offset:1024
    ds_read_b128 v[32:35], v55 offset:18560
    ds_read_b128 v[36:39], v55 offset:19584
    ds_read_b128 v[40:43], v55 offset:37120
    ds_read_b128 v[44:47], v55 offset:38144
    ds_read_b128 v[48:51], v55 offset:55680
    ds_read_b128 v[52:55], v55 offset:56704
    s_waitcnt lgkmcnt(4)
    v_add_f32 v24, v24, v32
    v_add_f32 v25, v25, v33
    v_add_f32 v26, v26, v34
    v_add_f32 v27, v27, v35
    v_add_f32 v28, v28, v36
    v_add_f32 v29, v29, v37
    v_add_f32 v30, v30, v38
    v_add_f32 v31, v31, v39
    s_waitcnt lgkmcnt(0)
    v_add_f32 v40, v40, v48
    v_add_f32 v41, v41, v49
    v_add_f32 v42, v42, v50
    v_add_f32 v43, v43, v51
    v_add_f32 v44, v44, v52
    v_add_f32 v45, v45, v53
    v_add_f32 v46, v46, v54
    v_add_f32 v47, v47, v55
    v_add_f32 v24, v24, v40
    v_add_f32 v25, v25, v41
    v_add_f32 v26, v26, v42
    v_add_f32 v27, v27, v43
    v_add_f32 v28, v28, v44
    v_add_f32 v29, v29, v45
    v_add_f32 v30, v30, v46
    v_add_f32 v31, v31, v47
    v_cvt_pk_bf16_f32 v24, v24, v25
    v_cvt_pk_bf16_f32 v25, v26, v27
    v_cvt_pk_bf16_f32 v26, v28, v29
    v_cvt_pk_bf16_f32 v27, v30, v31
    v_min_u32 v24, -2, v24
    v_min_u32 v25, -2, v25
    v_min_u32 v26, -2, v26
    v_min_u32 v27, -2, v27
    buffer_store_dwordx4 v[24:27], v1, s[4:7], s37 offen sc1
    s_branch k_end
ch_p_slow:
    v_mov_b32 v32, 0
    v_mov_b32 v33, 0
    v_mov_b32 v34, 0
    v_mov_b32 v35, 0
    v_mov_b32 v36, 0
    v_mov_b32 v37, 0
    v_mov_b32 v38, 0
    v_mov_b32 v39, 0
    v_mov_b32 v40, 0
    v_mov_b32 v41, 0
    v_mov_b32 v42, 0
    v_mov_b32 v43, 0
    v_mov_b32 v44, 0
    v_mov_b32 v45, 0
    v_mov_b32 v46, 0
    v_mov_b32 v47, 0
    v_mov_b32 v48, 0
    v_mov_b32 v49, 0
    v_mov_b32 v50, 0
    v_mov_b32 v51, 0
    v_mov_b32 v52, 0
    v_mov_b32 v53, 0
    v_mov_b32 v54, 0
    v_mov_b32 v55, 0
    v_mov_b32 v0, 1.0
    s_mov_b32 exec_lo, 0xff00ff00
    s_mov_b32 exec_hi, 0xff00ff00
    v_mov_b32 v0, s47
    s_mov_b64 exec, -1
    v_mov_b32 v60, s16
    s_branch pnc_16
.p2align 6
ploop_15:
    s_add_u32 s21, s17, s33
    s_nop 15
    s_nop 5
    buffer_load_dwordx4 v[16:19], v1, s[4:7], s21 offen offset:0 sc1
    s_nop 7
    buffer_load_dwordx4 v[20:23], v1, s[4:7], s21 offen offset:1024 sc1
    s_nop 7
    buffer_load_dwordx4 v[24:27], v1, s[4:7], s21 offen offset:2048 sc1
    s_nop 7
    buffer_load_dwordx4 v[28:31], v1, s[4:7], s21 offen offset:3072 sc1
    s_waitcnt vmcnt(3)
    v_max3_u32 v9, v16, v17, v18
    v_max_u32 v9, v9, v19
    v_cmp_eq_u32 vcc, -1, v9
    s_cbranch_vccnz prm_18_0
prm_18_0ok:
    v_smfmac_f32_16x16x64_bf16 v[32:35], v[16:19], v[64:71], v62
    v_smfmac_f32_16x16x64_bf16 v[36:39], v[16:19], v[72:79], v62
    v_smfmac_f32_16x16x64_bf16 v[40:43], v[16:19], v[80:87], v62
    s_waitcnt vmcnt(2)
    v_max3_u32 v9, v20, v21, v22
    v_max_u32 v9, v9, v23
    v_cmp_eq_u32 vcc, -1, v9
    v_smfmac_f32_16x16x64_bf16 v[44:47], v[16:19], v[88:95], v62
    v_smfmac_f32_16x16x64_bf16 v[48:51], v[16:19], v[96:103], v62
    v_smfmac_f32_16x16x64_bf16 v[52:55], v[16:19], v[104:111], v62
    s_cbranch_vccnz prm_18_1
prm_18_1ok:
    v_smfmac_f32_16x16x64_bf16 v[32:35], v[20:23], v[112:119], v62
    v_readfirstlane_b32 s23, v15
    v_smfmac_f32_16x16x64_bf16 v[36:39], v[20:23], v[120:127], v62
    v_smfmac_f32_16x16x64_bf16 v[40:43], v[20:23], v[128:135], v62
    s_waitcnt vmcnt(1)
    v_max3_u32 v9, v24, v25, v26
    v_max_u32 v9, v9, v27
    v_cmp_eq_u32 vcc, -1, v9
    v_smfmac_f32_16x16x64_bf16 v[44:47], v[20:23], v[136:143], v62
    v_smfmac_f32_16x16x64_bf16 v[48:51], v[20:23], v[144:151], v62
    v_smfmac_f32_16x16x64_bf16 v[52:55], v[20:23], v[152:159], v62
    s_cbranch_vccnz prm_18_2
prm_18_2ok:
    v_smfmac_f32_16x16x64_bf16 v[32:35], v[24:27], v[160:167], v62
    v_smfmac_f32_16x16x64_bf16 v[36:39], v[24:27], v[168:175], v62
    v_smfmac_f32_16x16x64_bf16 v[40:43], v[24:27], v[176:183], v62
    s_waitcnt vmcnt(0)
    v_max3_u32 v9, v28, v29, v30
    v_max_u32 v9, v9, v31
    v_cmp_eq_u32 vcc, -1, v9
    v_smfmac_f32_16x16x64_bf16 v[44:47], v[24:27], v[184:191], v62
    v_smfmac_f32_16x16x64_bf16 v[48:51], v[24:27], v[192:199], v62
    v_smfmac_f32_16x16x64_bf16 v[52:55], v[24:27], v[200:207], v62
    s_cbranch_vccnz prm_18_3
prm_18_3ok:
    v_smfmac_f32_16x16x64_bf16 v[32:35], v[28:31], v[208:215], v62
    s_cmp_lt_u32 s23, s59
    s_cbranch_scc1 prm_18_gt
prm_18_gtb:
    ds_write_b32 v14, v60
    v_smfmac_f32_16x16x64_bf16 v[36:39], v[28:31], v[216:223], v62
    v_smfmac_f32_16x16x64_bf16 v[40:43], v[28:31], v[224:231], v62
    v_smfmac_f32_16x16x64_bf16 v[44:47], v[28:31], v[232:239], v62
    v_add_f32 v32, v32, v33
    v_add_f32 v34, v34, v35
    v_smfmac_f32_16x16x64_bf16 v[48:51], v[28:31], v[240:247], v62
    v_add_f32 v36, v36, v37
    v_add_f32 v38, v38, v39
    ds_write2_b32 v4, v32, v34 offset0:0 offset1:104
    v_smfmac_f32_16x16x64_bf16 v[52:55], v[28:31], v[248:255], v62
    v_add_f32 v40, v40, v41
    v_add_f32 v42, v42, v43
    ds_write2_b32 v4, v36, v38 offset0:16 offset1:120
    v_add_f32 v44, v44, v45
    v_add_f32 v46, v46, v47
    ds_write2_b32 v4, v40, v42 offset0:32 offset1:136
    v_add_f32 v48, v48, v49
    v_add_f32 v50, v50, v51
    ds_write2_b32 v4, v44, v46 offset0:48 offset1:152
    v_add_f32 v52, v52, v53
    v_add_f32 v54, v54, v55
    ds_write2_b32 v4, v48, v50 offset0:64 offset1:168
    ds_write2_b32 v4, v52, v54 offset0:80 offset1:184
    s_branch pnc_16_done
pnc_16:
    v_smfmac_f32_16x16x64_bf16 v[32:35], v[16:19], v[64:71], v62
    v_smfmac_f32_16x16x64_bf16 v[36:39], v[16:19], v[72:79], v62
    v_smfmac_f32_16x16x64_bf16 v[40:43], v[16:19], v[80:87], v62
    v_smfmac_f32_16x16x64_bf16 v[44:47], v[16:19], v[88:95], v62
    v_smfmac_f32_16x16x64_bf16 v[48:51], v[16:19], v[96:103], v62
    v_smfmac_f32_16x16x64_bf16 v[52:55], v[16:19], v[104:111], v62
    v_smfmac_f32_16x16x64_bf16 v[32:35], v[20:23], v[112:119], v62
    v_smfmac_f32_16x16x64_bf16 v[36:39], v[20:23], v[120:127], v62
    v_smfmac_f32_16x16x64_bf16 v[40:43], v[20:23], v[128:135], v62
    v_smfmac_f32_16x16x64_bf16 v[44:47], v[20:23], v[136:143], v62
    v_smfmac_f32_16x16x64_bf16 v[48:51], v[20:23], v[144:151], v62
    v_smfmac_f32_16x16x64_bf16 v[52:55], v[20:23], v[152:159], v62
    v_smfmac_f32_16x16x64_bf16 v[32:35], v[24:27], v[160:167], v62
    v_smfmac_f32_16x16x64_bf16 v[36:39], v[24:27], v[168:175], v62
    v_smfmac_f32_16x16x64_bf16 v[40:43], v[24:27], v[176:183], v62
    v_smfmac_f32_16x16x64_bf16 v[44:47], v[24:27], v[184:191], v62
    v_smfmac_f32_16x16x64_bf16 v[48:51], v[24:27], v[192:199], v62
    v_smfmac_f32_16x16x64_bf16 v[52:55], v[24:27], v[200:207], v62
    v_smfmac_f32_16x16x64_bf16 v[32:35], v[28:31], v[208:215], v62
    ds_write_b32 v14, v60
    v_smfmac_f32_16x16x64_bf16 v[36:39], v[28:31], v[216:223], v62
    v_smfmac_f32_16x16x64_bf16 v[40:43], v[28:31], v[224:231], v62
    v_smfmac_f32_16x16x64_bf16 v[44:47], v[28:31], v[232:239], v62
    v_add_f32 v32, v32, v33
    v_add_f32 v34, v34, v35
    v_smfmac_f32_16x16x64_bf16 v[48:51], v[28:31], v[240:247], v62
    v_add_f32 v36, v36, v37
    v_add_f32 v38, v38, v39
    ds_write2_b32 v4, v32, v34 offset0:0 offset1:104
    v_smfmac_f32_16x16x64_bf16 v[52:55], v[28:31], v[248:255], v62
    v_add_f32 v40, v40, v41
    v_add_f32 v42, v42, v43
    ds_write2_b32 v4, v36, v38 offset0:16 offset1:120
    v_add_f32 v44, v44, v45
    v_add_f32 v46, v46, v47
    ds_write2_b32 v4, v40, v42 offset0:32 offset1:136
    v_add_f32 v48, v48, v49
    v_add_f32 v50, v50, v51
    ds_write2_b32 v4, v44, v46 offset0:48 offset1:152
    v_add_f32 v52, v52, v53
    v_add_f32 v54, v54, v55
    ds_write2_b32 v4, v48, v50 offset0:64 offset1:168
    ds_write2_b32 v4, v52, v54 offset0:80 offset1:184
    s_waitcnt vmcnt(0)
pnc_16_done:
    s_add_u32 s21, s17, s32
    s_add_u32 s22, s19, s32
    s_add_u32 s24, s19, s35
    s_waitcnt lgkmcnt(0)
    s_barrier
    ds_read_b64 v[32:33], v5 offset:0
    ds_read_b64 v[34:35], v5 offset:3328
    ds_read_b64 v[36:37], v5 offset:6656
    ds_read_b64 v[38:39], v5 offset:9984
    ds_read_b64 v[40:41], v6 offset:0
    ds_read_b64 v[42:43], v6 offset:3328
    ds_read_b64 v[44:45], v6 offset:6656
    ds_read_b64 v[46:47], v6 offset:9984
    s_waitcnt lgkmcnt(6)
    v_add_f32 v32, v32, v34
    v_add_f32 v33, v33, v35
    s_waitcnt lgkmcnt(4)
    v_add_f32 v36, v36, v38
    v_add_f32 v37, v37, v39
    v_add_f32 v32, v32, v36
    v_add_f32 v33, v33, v37
    v_mul_f32 v32, v32, v0
    v_mul_f32 v33, v33, v0
    v_cvt_pk_bf16_f32 v32, v32, v33
    v_min_u32 v32, -2, v32
    buffer_store_dword v32, v2, s[4:7], s21 offen sc1
    s_waitcnt lgkmcnt(2)
    v_add_f32 v40, v40, v42
    v_add_f32 v41, v41, v43
    s_waitcnt lgkmcnt(0)
    v_add_f32 v44, v44, v46
    v_add_f32 v45, v45, v47
    v_add_f32 v40, v40, v44
    v_add_f32 v41, v41, v45
    v_cvt_pk_bf16_f32 v40, v40, v41
    v_min_u32 v40, -2, v40
    s_mov_b32 exec_hi, 0
    buffer_store_dword v40, v3, s[4:7], s21 offen sc1
    s_setprio 0
    s_mov_b64 exec, -1
    s_add_u32 s21, s17, s35
    s_add_u32 s30, s17, s34
    s_add_u32 s23, s18, s36
    s_add_u32 s25, s16, 2
    s_min_u32 s25, s25, 63
    s_cmp_lt_u32 s25, 8
    s_cselect_b32 s59, 12, 24
    s_cselect_b32 s58, -4, -8
    s_and_b32 s25, s25, s58
    s_lshl_b32 s25, s25, 5
    s_add_u32 s58, s25, s60
    s_cmp_eq_u32 s15, 0
    s_cbranch_scc1 ploop_15_nd
    v_add_u32 v9, s53, v1
    v_add_u32 v0, 124928, v1
    ds_read_b128 v[16:19], v0 offset:0
    ds_read_b128 v[32:35], v9 offset:0
    ds_read_b128 v[20:23], v0 offset:1024
    ds_read_b128 v[36:39], v9 offset:1024
    ds_read_b128 v[24:27], v0 offset:2048
    ds_read_b128 v[40:43], v9 offset:2048
    ds_read_b128 v[28:31], v0 offset:3072
    ds_read_b128 v[44:47], v9 offset:3072
    s_add_u32 s22, s17, s61
    s_waitcnt lgkmcnt(6)
    v_mfma_f32_16x16x32_bf16 v[48:51], v[32:35], v[16:19], 0
    ds_read_b128 v[32:35], v9 offset:4096
    s_waitcnt lgkmcnt(5)
    v_mfma_f32_16x16x32_bf16 v[48:51], v[36:39], v[20:23], v[48:51]
    ds_read_b128 v[36:39], v9 offset:5120
    s_waitcnt lgkmcnt(4)
    v_mfma_f32_16x16x32_bf16 v[48:51], v[40:43], v[24:27], v[48:51]
    ds_read_b128 v[40:43], v9 offset:6144
    s_waitcnt lgkmcnt(3)
    v_mfma_f32_16x16x32_bf16 v[48:51], v[44:47], v[28:31], v[48:51]
    ds_read_b128 v[44:47], v9 offset:7168
    s_waitcnt lgkmcnt(3)
    v_mfma_f32_16x16x32_bf16 v[52:55], v[32:35], v[16:19], 0
    s_waitcnt lgkmcnt(2)
    v_mfma_f32_16x16x32_bf16 v[52:55], v[36:39], v[20:23], v[52:55]
    s_waitcnt lgkmcnt(1)
    v_mfma_f32_16x16x32_bf16 v[52:55], v[40:43], v[24:27], v[52:55]
    s_waitcnt lgkmcnt(0)
    v_mfma_f32_16x16x32_bf16 v[52:55], v[44:47], v[28:31], v[52:55]
    buffer_load_dwordx4 v[32:35], v1, s[4:7], s22 offen offset:0 sc1
    buffer_load_dwordx4 v[36:39], v1, s[4:7], s22 offen offset:1024 sc1
    buffer_load_dwordx4 v[40:43], v1, s[4:7], s22 offen offset:2048 sc1
    buffer_load_dwordx4 v[44:47], v1, s[4:7], s22 offen offset:3072 sc1
    v_mov_b32 v60, 0xff61b1e6
    s_nop 2
    v_cndmask_b32 v48, v48, v60, s[38:39]
    v_cndmask_b32 v49, v49, v60, s[40:41]
    v_cndmask_b32 v50, v50, v60, s[42:43]
    v_cndmask_b32 v51, v51, v60, s[44:45]
    v_cndmask_b32 v52, v52, v60, s[48:49]
    v_cndmask_b32 v53, v53, v60, s[50:51]
    v_cndmask_b32 v54, v54, v60, s[54:55]
    v_cndmask_b32 v55, v55, v60, s[56:57]
    v_max3_f32 v0, v48, v49, v50
    v_max3_f32 v9, v51, v52, v53
    v_max3_f32 v0, v0, v54, v55
    v_max_f32 v0, v0, v9
    v_mov_b32 v9, v0
    s_nop 1
    v_permlane16_swap_b32 v9, v0
    v_max_f32 v0, v0, v9
    v_mov_b32 v9, v0
    s_nop 1
    v_permlane32_swap_b32 v9, v0
    v_max_f32 v0, v0, v9
    v_mul_f32 v0, s47, v0
    v_fma_f32 v48, v48, s47, -v0
    v_fma_f32 v49, v49, s47, -v0
    v_fma_f32 v50, v50, s47, -v0
    v_fma_f32 v51, v51, s47, -v0
    v_fma_f32 v52, v52, s47, -v0
    v_fma_f32 v53, v53, s47, -v0
    v_fma_f32 v54, v54, s47, -v0
    v_fma_f32 v55, v55, s47, -v0
    v_exp_f32 v48, v48
    v_exp_f32 v49, v49
    v_exp_f32 v50, v50
    v_exp_f32 v51, v51
    v_exp_f32 v52, v52
    v_exp_f32 v53, v53
    v_exp_f32 v54, v54
    v_exp_f32 v55, v55
    v_add_f32 v15, v48, v49
    v_add_f32 v15, v15, v50
    v_add_f32 v15, v15, v51
    v_add_f32 v15, v15, v52
    v_add_f32 v15, v15, v53
    v_add_f32 v15, v15, v54
    v_add_f32 v15, v15, v55
ploop_15_za:
    s_waitcnt vmcnt(0)
    v_max3_u32 v9, v32, v33, v34
    v_max3_u32 v9, v9, v35, v36
    v_max3_u32 v9, v9, v37, v38
    v_max3_u32 v9, v9, v39, v40
    v_max3_u32 v9, v9, v41, v42
    v_max3_u32 v9, v9, v43, v44
    v_max3_u32 v9, v9, v45, v46
    v_max_u32 v9, v9, v47
    v_cmp_eq_u32 vcc, -1, v9
    s_cbranch_vccnz ploop_15_zr
ploop_15_zok:
    v_mfma_f32_16x16x32_bf16 v[56:59], v[32:35], v[16:19], 0
    v_mfma_f32_16x16x32_bf16 v[56:59], v[36:39], v[20:23], v[56:59]
    v_mfma_f32_16x16x32_bf16 v[56:59], v[40:43], v[24:27], v[56:59]
    v_mfma_f32_16x16x32_bf16 v[56:59], v[44:47], v[28:31], v[56:59]
    s_add_u32 s22, s17, s14
    s_nop 6
    v_max_f32 v60, v56, v57
    v_mov_b32 v9, v60
    s_nop 1
    v_permlane16_swap_b32 v9, v60
    v_max_f32 v60, v60, v9
    v_mov_b32 v9, v60
    s_nop 1
    v_permlane32_swap_b32 v9, v60
    v_max_f32 v60, v60, v9
    v_mul_f32 v60, s47, v60
    v_max_f32 v58, v60, v0
    v_sub_f32 v60, v0, v58
    v_fma_f32 v56, v56, s47, -v58
    v_fma_f32 v57, v57, s47, -v58
    v_exp_f32 v60, v60
    v_exp_f32 v56, v56
    v_exp_f32 v57, v57
    v_fma_f32 v15, v15, v60, v56
    v_add_f32 v15, v15, v57
    v_mov_b32 v9, v15
    s_nop 1
    v_permlane16_swap_b32 v9, v15
    v_add_f32 v15, v15, v9
    v_mov_b32 v9, v15
    s_nop 1
    v_permlane32_swap_b32 v9, v15
    v_add_f32 v15, v15, v9
    v_rcp_f32 v15, v15
    s_add_u32 s25, s19, s14
    v_mul_f32 v56, v56, v15
    v_mul_f32 v57, v57, v15
    v_mul_f32 v60, v60, v15
    v_mul_f32 v48, v48, v60
    v_mul_f32 v49, v49, v60
    v_mul_f32 v50, v50, v60
    v_mul_f32 v51, v51, v60
    v_mul_f32 v52, v52, v60
    v_mul_f32 v53, v53, v60
    v_mul_f32 v54, v54, v60
    v_mul_f32 v55, v55, v60
    v_cvt_pk_bf16_f32 v48, v48, v49
    v_cvt_pk_bf16_f32 v49, v50, v51
    v_cvt_pk_bf16_f32 v50, v52, v53
    v_cvt_pk_bf16_f32 v51, v54, v55
    v_min_u32 v48, -2, v48
    v_min_u32 v49, -2, v49
    v_min_u32 v50, -2, v50
    v_min_u32 v51, -2, v51
    v_lshlrev_b32 v54, 1, v8
    v_add_u32 v55, 14336, v1
    v_mov_b32 v53, 1.0
    v_cvt_pk_bf16_f32 v52, v56, v57
    v_min_u32 v53, -2, v53
    v_min_u32 v52, -2, v52
    buffer_store_dwordx4 v[48:51], v1, s[4:7], s22 offen sc1
    buffer_store_dwordx2 v[52:53], v54, s[4:7], s22 offen offset:1024 sc1
    ds_read_b128 v[56:59], v55
    s_branch ploop_15_nd2
ploop_15_nd:
    s_cmp_eq_u32 s16, 0
    s_cbranch_scc1 ploop_15_ns
    s_cmp_eq_u32 s31, 0
    s_cbranch_scc1 ploop_15_n2
    s_add_u32 s25, s68, s46
    v_add_u32 v55, s25, v61
    ds_read_b128 v[24:27], v55 offset:0
    ds_read_b128 v[28:31], v55 offset:1024
    ds_read_b128 v[32:35], v55 offset:18560
    ds_read_b128 v[36:39], v55 offset:19584
    ds_read_b128 v[40:43], v55 offset:37120
    ds_read_b128 v[44:47], v55 offset:38144
    ds_read_b128 v[48:51], v55 offset:55680
    ds_read_b128 v[52:55], v55 offset:56704
    s_waitcnt lgkmcnt(4)
    v_add_f32 v24, v24, v32
    v_add_f32 v25, v25, v33
    v_add_f32 v26, v26, v34
    v_add_f32 v27, v27, v35
    v_add_f32 v28, v28, v36
    v_add_f32 v29, v29, v37
    v_add_f32 v30, v30, v38
    v_add_f32 v31, v31, v39
    s_waitcnt lgkmcnt(0)
    v_add_f32 v40, v40, v48
    v_add_f32 v41, v41, v49
    v_add_f32 v42, v42, v50
    v_add_f32 v43, v43, v51
    v_add_f32 v44, v44, v52
    v_add_f32 v45, v45, v53
    v_add_f32 v46, v46, v54
    v_add_f32 v47, v47, v55
    v_add_f32 v24, v24, v40
    v_add_f32 v25, v25, v41
    v_add_f32 v26, v26, v42
    v_add_f32 v27, v27, v43
    v_add_f32 v28, v28, v44
    v_add_f32 v29, v29, v45
    v_add_f32 v30, v30, v46
    v_add_f32 v31, v31, v47
    v_cvt_pk_bf16_f32 v24, v24, v25
    v_cvt_pk_bf16_f32 v25, v26, v27
    v_cvt_pk_bf16_f32 v26, v28, v29
    v_cvt_pk_bf16_f32 v27, v30, v31
    v_min_u32 v24, -2, v24
    v_min_u32 v25, -2, v25
    v_min_u32 v26, -2, v26
    v_min_u32 v27, -2, v27
    v_mov_b32 v16, v24
    v_mov_b32 v17, v25
    v_mov_b32 v18, v26
    v_mov_b32 v19, v27
ploop_15_n2:
    v_add_u32 v55, s68, v61
    ds_read_b128 v[24:27], v55 offset:0
    ds_read_b128 v[28:31], v55 offset:1024
    ds_read_b128 v[32:35], v55 offset:18560
    ds_read_b128 v[36:39], v55 offset:19584
    ds_read_b128 v[40:43], v55 offset:37120
    ds_read_b128 v[44:47], v55 offset:38144
    ds_read_b128 v[48:51], v55 offset:55680
    ds_read_b128 v[52:55], v55 offset:56704
    s_waitcnt lgkmcnt(4)
    v_add_f32 v24, v24, v32
    v_add_f32 v25, v25, v33
    v_add_f32 v26, v26, v34
    v_add_f32 v27, v27, v35
    v_add_f32 v28, v28, v36
    v_add_f32 v29, v29, v37
    v_add_f32 v30, v30, v38
    v_add_f32 v31, v31, v39
    s_waitcnt lgkmcnt(0)
    v_add_f32 v40, v40, v48
    v_add_f32 v41, v41, v49
    v_add_f32 v42, v42, v50
    v_add_f32 v43, v43, v51
    v_add_f32 v44, v44, v52
    v_add_f32 v45, v45, v53
    v_add_f32 v46, v46, v54
    v_add_f32 v47, v47, v55
    v_add_f32 v24, v24, v40
    v_add_f32 v25, v25, v41
    v_add_f32 v26, v26, v42
    v_add_f32 v27, v27, v43
    v_add_f32 v28, v28, v44
    v_add_f32 v29, v29, v45
    v_add_f32 v30, v30, v46
    v_add_f32 v31, v31, v47
    v_cvt_pk_bf16_f32 v24, v24, v25
    v_cvt_pk_bf16_f32 v25, v26, v27
    v_cvt_pk_bf16_f32 v26, v28, v29
    v_cvt_pk_bf16_f32 v27, v30, v31
    v_min_u32 v24, -2, v24
    v_min_u32 v25, -2, v25
    v_min_u32 v26, -2, v26
    v_min_u32 v27, -2, v27
ploop_15_ns:
ploop_15_flag:
    ds_read_b32 v9, v14 offset:16
    s_waitcnt lgkmcnt(0)
    v_readfirstlane_b32 s25, v9
    s_cmp_eq_u32 s25, s16
    s_cbranch_scc0 ploop_15_flag
    s_add_u32 m0, s53, 0
    s_add_u32 s22, s52, 0
    buffer_load_dwordx4 v1, s[4:7], s22 offen offset:0 sc1 lds
    buffer_load_dwordx4 v1, s[4:7], s22 offen offset:1024 sc1 lds
    buffer_load_dwordx4 v1, s[4:7], s22 offen offset:2048 sc1 lds
    buffer_load_dwordx4 v1, s[4:7], s22 offen offset:3072 sc1 lds
    s_add_u32 m0, s53, 4096
    s_add_u32 s22, s52, 131072
    buffer_load_dwordx4 v1, s[4:7], s22 offen offset:0 sc1 lds
    buffer_load_dwordx4 v1, s[4:7], s22 offen offset:1024 sc1 lds
    buffer_load_dwordx4 v1, s[4:7], s22 offen offset:2048 sc1 lds
    buffer_load_dwordx4 v1, s[4:7], s22 offen offset:3072 sc1 lds
    s_add_u32 s52, s52, 262144
    s_cmp_eq_u32 s16, 0
    s_cbranch_scc1 ploop_15_nd2
    buffer_store_dwordx4 v[24:27], v1, s[4:7], s37 offen sc1
    s_cmp_eq_u32 s31, 0
    s_cbranch_scc1 ploop_15_nd2
    s_add_u32 s25, s37, s27
    buffer_store_dwordx4 v[16:19], v1, s[4:7], s25 offen sc1
ploop_15_nd2:
    s_cmp_eq_u32 s16, 0
    s_cbranch_scc1 ploop_15_nn
    s_add_u32 s37, s37, 65536
    s_xor_b32 s68, s68, 8192
ploop_15_nn:
    s_cmp_lg_u32 s3, 2
    s_cbranch_scc1 ppf_20
    s_lshl_b32 s22, s16, 18
    s_mov_b32 exec_hi, 0xffff
    buffer_load_dword v9, v63, s[4:7], s22 offen sc1
    s_mov_b32 exec_hi, -1
ppf_20:
    v_add_u32 v24, 18560, v7
    v_add_u32 v25, 37120, v7
    v_add_u32 v26, 55680, v7
    s_cmp_eq_u32 s16, 63
    s_setprio 3
    s_barrier
    s_cbranch_scc1 ptail_17
    ds_read2_b32 v[16:17], v7 offset0:0 offset1:2
    ds_read2_b32 v[18:19], v24 offset0:0 offset1:2
    ds_read2_b32 v[20:21], v25 offset0:0 offset1:2
    ds_read2_b32 v[22:23], v26 offset0:0 offset1:2
    s_waitcnt lgkmcnt(2)
    v_add_f32 v16, v16, v18
    v_add_f32 v17, v17, v19
    s_waitcnt lgkmcnt(0)
    v_add_f32 v20, v20, v22
    v_add_f32 v21, v21, v23
    v_add_f32 v16, v16, v20
    v_add_f32 v17, v17, v21
    v_cvt_pk_bf16_f32 v16, v16, v17
    v_min_u32 v16, -2, v16
    buffer_store_dword v16, v2, s[4:7], s21 offen sc1
    buffer_store_dword v10, v2, s[4:7], s24 offen sc1
    s_cmp_eq_u32 s15, 0
    s_cbranch_scc1 ploop_15_pnd
    s_sleep 6
    s_nop 8
    buffer_load_dwordx4 v[16:19], v12, s[4:7], s30 offen sc1
    buffer_load_dword v15, off, s[4:7], s58 sc1
    s_add_u32 s25, s19, s14
    v_mov_b32 v20, -1
    v_mov_b32 v21, -1
    v_mov_b32 v22, -1
    v_mov_b32 v23, -1
    buffer_store_dwordx4 v[20:23], v1, s[4:7], s25 offen sc1
    buffer_store_dwordx2 v[20:21], v54, s[4:7], s25 offen offset:1024 sc1
    s_mov_b32 m0, 124928
    s_nop 0
    buffer_load_dwordx4 v1, s[4:7], s69 offen offset:0 sc1 lds
    buffer_load_dwordx4 v1, s[4:7], s69 offen offset:1024 sc1 lds
    buffer_load_dwordx4 v1, s[4:7], s69 offen offset:2048 sc1 lds
    buffer_load_dwordx4 v1, s[4:7], s69 offen offset:3072 sc1 lds
    s_add_u32 s69, s69, 262144
    s_add_u32 m0, s53, 0
    s_add_u32 s22, s52, 0
    buffer_load_dwordx4 v1, s[4:7], s22 offen offset:0 sc1 lds
    buffer_load_dwordx4 v1, s[4:7], s22 offen offset:1024 sc1 lds
    buffer_load_dwordx4 v1, s[4:7], s22 offen offset:2048 sc1 lds
    buffer_load_dwordx4 v1, s[4:7], s22 offen offset:3072 sc1 lds
    s_add_u32 m0, s53, 4096
    s_add_u32 s22, s52, 131072
    buffer_load_dwordx4 v1, s[4:7], s22 offen offset:0 sc1 lds
    buffer_load_dwordx4 v1, s[4:7], s22 offen offset:1024 sc1 lds
    buffer_load_dwordx4 v1, s[4:7], s22 offen offset:2048 sc1 lds
    buffer_load_dwordx4 v1, s[4:7], s22 offen offset:3072 sc1 lds
    s_add_u32 s52, s52, 262144
    s_add_u32 s22, s16, 1
    v_mov_b32 v60, s22
    v_mov_b32 v32, 0
    v_mov_b32 v33, 0
    v_mov_b32 v34, 0
    v_mov_b32 v35, 0
    v_mov_b32 v36, 0
    v_mov_b32 v37, 0
    v_mov_b32 v38, 0
    v_mov_b32 v39, 0
    v_mov_b32 v40, 0
    v_mov_b32 v41, 0
    v_mov_b32 v42, 0
    v_mov_b32 v43, 0
    v_mov_b32 v44, 0
    v_mov_b32 v45, 0
    v_mov_b32 v46, 0
    v_mov_b32 v47, 0
    v_mov_b32 v48, 0
    v_mov_b32 v49, 0
    v_mov_b32 v50, 0
    v_mov_b32 v51, 0
    v_mov_b32 v52, 0
    v_mov_b32 v53, 0
    v_mov_b32 v54, 0
    v_mov_b32 v55, 0
    v_mov_b32 v0, 1.0
    s_mov_b32 exec_lo, 0xff00ff00
    s_mov_b32 exec_hi, 0xff00ff00
    v_mov_b32 v0, s47
    s_mov_b64 exec, -1
    s_waitcnt vmcnt(15) lgkmcnt(0)
    s_branch ploop_15_pchk
ploop_15_pnd:
    s_sleep 6
    s_nop 8
    buffer_load_dwordx4 v[16:19], v12, s[4:7], s30 offen sc1
    buffer_load_dword v15, off, s[4:7], s58 sc1
    s_add_u32 s22, s16, 1
    v_mov_b32 v60, s22
    v_mov_b32 v32, 0
    v_mov_b32 v33, 0
    v_mov_b32 v34, 0
    v_mov_b32 v35, 0
    v_mov_b32 v36, 0
    v_mov_b32 v37, 0
    v_mov_b32 v38, 0
    v_mov_b32 v39, 0
    v_mov_b32 v40, 0
    v_mov_b32 v41, 0
    v_mov_b32 v42, 0
    v_mov_b32 v43, 0
    v_mov_b32 v44, 0
    v_mov_b32 v45, 0
    v_mov_b32 v46, 0
    v_mov_b32 v47, 0
    v_mov_b32 v48, 0
    v_mov_b32 v49, 0
    v_mov_b32 v50, 0
    v_mov_b32 v51, 0
    v_mov_b32 v52, 0
    v_mov_b32 v53, 0
    v_mov_b32 v54, 0
    v_mov_b32 v55, 0
    v_mov_b32 v0, 1.0
    s_mov_b32 exec_lo, 0xff00ff00
    s_mov_b32 exec_hi, 0xff00ff00
    v_mov_b32 v0, s47
    s_mov_b64 exec, -1
    s_waitcnt vmcnt(1) lgkmcnt(0)
    s_branch ploop_15_pchk
ploop_15_pagain:
    s_waitcnt vmcnt(1) lgkmcnt(0)
ploop_15_pchk:
    v_mfma_f32_16x16x32_bf16 v[20:23], v[56:59], v[16:19], 0
    v_max3_u32 v9, v16, v17, v18
    v_max_u32 v9, v9, v19
    v_cmp_eq_u32 vcc, -1, v9
    s_cbranch_vccnz prp_19
ploop_15_pgo:
    s_nop 3
    v_add_f32_dpp v20, v20, v20 row_ror:8 row_mask:0xf bank_mask:0xf
    v_add_f32_dpp v21, v21, v21 row_ror:8 row_mask:0xf bank_mask:0xf
    v_add_f32_dpp v22, v22, v22 row_ror:8 row_mask:0xf bank_mask:0xf
    v_add_f32_dpp v23, v23, v23 row_ror:8 row_mask:0xf bank_mask:0xf
    v_cvt_pk_bf16_f32 v20, v20, v21
    v_cvt_pk_bf16_f32 v21, v22, v23
    s_mov_b32 exec_hi, 0
    v_min_u32 v20, -2, v20
    v_min_u32 v21, -2, v21
    s_mov_b32 exec_lo, 0x00ff00ff
    buffer_store_dwordx2 v[20:21], v13, s[4:7], s23 offen sc1
    s_mov_b64 exec, -1
    s_add_u32 s22, s19, s32
    s_add_u32 s25, s20, s36
    buffer_store_dword v10, v2, s[4:7], s22 offen sc1
    s_mov_b32 exec_hi, 0
    buffer_store_dword v10, v3, s[4:7], s22 offen sc1
    s_mov_b32 exec_lo, 0x00ff00ff
    buffer_store_dwordx2 v[10:11], v13, s[4:7], s25 offen sc1
    s_mov_b64 exec, -1
    s_add_u32 s16, s16, 1
    s_mov_b32 s17, s18
    s_mov_b32 s18, s19
    s_mov_b32 s19, s20
    s_add_u32 s20, s20, 262144
    s_cmp_eq_u32 s20, 210763776
    s_cselect_b32 s20, 209715200, s20
    s_branch ploop_15
prm_18_gt:
gate_21:
    v_readfirstlane_b32 s25, v15
    s_cmp_ge_u32 s25, s59
    s_cbranch_scc1 gate_21_ok
    s_sleep 8
    buffer_load_dword v15, off, s[4:7], s58 sc1
    s_waitcnt vmcnt(0)
    s_sub_u32 s26, s26, 1
    s_cbranch_scc0 gate_21
    s_mov_b32 s26, 0
gate_21_ok:
    s_branch prm_18_gtb
prm_18_0:
    s_sub_u32 s26, s26, 1
    s_cbranch_scc1 prm_18_0_g
    buffer_load_dwordx4 v[16:19], v1, s[4:7], s21 offen offset:0 sc1
    buffer_load_dwordx4 v[20:23], v1, s[4:7], s21 offen offset:1024 sc1
    buffer_load_dwordx4 v[24:27], v1, s[4:7], s21 offen offset:2048 sc1
    buffer_load_dwordx4 v[28:31], v1, s[4:7], s21 offen offset:3072 sc1
    s_waitcnt vmcnt(3)
    v_max3_u32 v9, v16, v17, v18
    v_max_u32 v9, v9, v19
    v_cmp_eq_u32 vcc, -1, v9
    s_cbranch_vccnz prm_18_0
    s_branch prm_18_0ok
prm_18_0_g:
    s_mov_b32 s26, 0
    s_waitcnt vmcnt(0)
    s_branch prm_18_0ok
prm_18_1:
    s_sub_u32 s26, s26, 1
    s_cbranch_scc1 prm_18_1_g
    buffer_load_dwordx4 v[20:23], v1, s[4:7], s21 offen offset:1024 sc1
    buffer_load_dwordx4 v[24:27], v1, s[4:7], s21 offen offset:2048 sc1
    buffer_load_dwordx4 v[28:31], v1, s[4:7], s21 offen offset:3072 sc1
    s_waitcnt vmcnt(2)
    v_max3_u32 v9, v20, v21, v22
    v_max_u32 v9, v9, v23
    v_cmp_eq_u32 vcc, -1, v9
    s_cbranch_vccnz prm_18_1
    s_branch prm_18_1ok
prm_18_1_g:
    s_mov_b32 s26, 0
    s_waitcnt vmcnt(0)
    s_branch prm_18_1ok
prm_18_2:
    s_sub_u32 s26, s26, 1
    s_cbranch_scc1 prm_18_2_g
    buffer_load_dwordx4 v[24:27], v1, s[4:7], s21 offen offset:2048 sc1
    buffer_load_dwordx4 v[28:31], v1, s[4:7], s21 offen offset:3072 sc1
    s_waitcnt vmcnt(1)
    v_max3_u32 v9, v24, v25, v26
    v_max_u32 v9, v9, v27
    v_cmp_eq_u32 vcc, -1, v9
    s_cbranch_vccnz prm_18_2
    s_branch prm_18_2ok
prm_18_2_g:
    s_mov_b32 s26, 0
    s_waitcnt vmcnt(0)
    s_branch prm_18_2ok
prm_18_3:
    s_sub_u32 s26, s26, 1
    s_cbranch_scc1 prm_18_3_g
    buffer_load_dwordx4 v[28:31], v1, s[4:7], s21 offen offset:3072 sc1
    s_waitcnt vmcnt(0)
    v_max3_u32 v9, v28, v29, v30
    v_max_u32 v9, v9, v31
    v_cmp_eq_u32 vcc, -1, v9
    s_cbranch_vccnz prm_18_3
    s_branch prm_18_3ok
prm_18_3_g:
    s_mov_b32 s26, 0
    s_waitcnt vmcnt(0)
    s_branch prm_18_3ok
prm_18_d:
gate_22:
    v_readfirstlane_b32 s25, v15
    s_cmp_ge_u32 s25, s59
    s_cbranch_scc1 gate_22_ok
    s_sleep 8
    buffer_load_dword v15, off, s[4:7], s58 sc1
    s_waitcnt vmcnt(0)
    s_sub_u32 s26, s26, 1
    s_cbranch_scc0 gate_22
    s_mov_b32 s26, 0
gate_22_ok:
    ds_write_b32 v14, v60
    v_add_f32 v32, v32, v33
    v_add_f32 v34, v34, v35
    ds_write2_b32 v4, v32, v34 offset0:0 offset1:104
    v_add_f32 v36, v36, v37
    v_add_f32 v38, v38, v39
    ds_write2_b32 v4, v36, v38 offset0:16 offset1:120
    v_add_f32 v40, v40, v41
    v_add_f32 v42, v42, v43
    ds_write2_b32 v4, v40, v42 offset0:32 offset1:136
    v_add_f32 v44, v44, v45
    v_add_f32 v46, v46, v47
    ds_write2_b32 v4, v44, v46 offset0:48 offset1:152
    v_add_f32 v48, v48, v49
    v_add_f32 v50, v50, v51
    ds_write2_b32 v4, v48, v50 offset0:64 offset1:168
    v_add_f32 v52, v52, v53
    v_add_f32 v54, v54, v55
    ds_write2_b32 v4, v52, v54 offset0:80 offset1:184
    s_branch pnc_16_done
prp_19:
    s_sub_u32 s26, s26, 1
    s_nop 3
    s_cbranch_scc1 prp_19_g
    buffer_load_dwordx4 v[16:19], v12, s[4:7], s30 offen sc1
    buffer_load_dword v15, off, s[4:7], s58 sc1
    s_branch ploop_15_pagain
prp_19_g:
    s_mov_b32 s26, 0
    s_branch ploop_15_pgo
ploop_15_zr:
    s_sub_u32 s26, s26, 1
    s_cbranch_scc1 ploop_15_zg
    buffer_load_dwordx4 v[32:35], v1, s[4:7], s22 offen offset:0 sc1
    buffer_load_dwordx4 v[36:39], v1, s[4:7], s22 offen offset:1024 sc1
    buffer_load_dwordx4 v[40:43], v1, s[4:7], s22 offen offset:2048 sc1
    buffer_load_dwordx4 v[44:47], v1, s[4:7], s22 offen offset:3072 sc1
    s_branch ploop_15_za
ploop_15_zg:
    s_mov_b32 s26, 0
    s_branch ploop_15_zok
ptail_17:
    s_cmp_eq_u32 s15, 0
    s_cbranch_scc1 ptail_17_nd
    s_nop 0
ptail_17_nd:
    s_barrier
    v_add_u32 v55, s68, v61
    ds_read_b128 v[24:27], v55 offset:0
    ds_read_b128 v[28:31], v55 offset:1024
    ds_read_b128 v[32:35], v55 offset:18560
    ds_read_b128 v[36:39], v55 offset:19584
    ds_read_b128 v[40:43], v55 offset:37120
    ds_read_b128 v[44:47], v55 offset:38144
    ds_read_b128 v[48:51], v55 offset:55680
    ds_read_b128 v[52:55], v55 offset:56704
    s_waitcnt lgkmcnt(4)
    v_add_f32 v24, v24, v32
    v_add_f32 v25, v25, v33
    v_add_f32 v26, v26, v34
    v_add_f32 v27, v27, v35
    v_add_f32 v28, v28, v36
    v_add_f32 v29, v29, v37
    v_add_f32 v30, v30, v38
    v_add_f32 v31, v31, v39
    s_waitcnt lgkmcnt(0)
    v_add_f32 v40, v40, v48
    v_add_f32 v41, v41, v49
    v_add_f32 v42, v42, v50
    v_add_f32 v43, v43, v51
    v_add_f32 v44, v44, v52
    v_add_f32 v45, v45, v53
    v_add_f32 v46, v46, v54
    v_add_f32 v47, v47, v55
    v_add_f32 v24, v24, v40
    v_add_f32 v25, v25, v41
    v_add_f32 v26, v26, v42
    v_add_f32 v27, v27, v43
    v_add_f32 v28, v28, v44
    v_add_f32 v29, v29, v45
    v_add_f32 v30, v30, v46
    v_add_f32 v31, v31, v47
    v_cvt_pk_bf16_f32 v24, v24, v25
    v_cvt_pk_bf16_f32 v25, v26, v27
    v_cvt_pk_bf16_f32 v26, v28, v29
    v_cvt_pk_bf16_f32 v27, v30, v31
    v_min_u32 v24, -2, v24
    v_min_u32 v25, -2, v25
    v_min_u32 v26, -2, v26
    v_min_u32 v27, -2, v27
    buffer_store_dwordx4 v[24:27], v1, s[4:7], s37 offen sc1
    s_branch k_end
ch_a_pro:
    s_mul_i32 s21, s2, 24576
    s_add_u32 s21, s21, 209711104
    v_lshlrev_b32 v1, 4, v0
    v_mov_b32 v4, -1
    v_mov_b32 v5, -1
    v_mov_b32 v6, -1
    v_mov_b32 v7, -1
    buffer_store_dwordx4 v[4:7], v1, s[4:7], s21 offen sc1
    s_add_u32 s21, s21, 4096
    buffer_store_dwordx4 v[4:7], v1, s[4:7], s21 offen sc1
    s_add_u32 s21, s21, 4096
    buffer_store_dwordx4 v[4:7], v1, s[4:7], s21 offen sc1
    s_add_u32 s21, s21, 4096
    buffer_store_dwordx4 v[4:7], v1, s[4:7], s21 offen sc1
    s_add_u32 s21, s21, 4096
    buffer_store_dwordx4 v[4:7], v1, s[4:7], s21 offen sc1
    s_add_u32 s21, s21, 4096
    buffer_store_dwordx4 v[4:7], v1, s[4:7], s21 offen sc1
    s_add_u32 s21, s21, 4096
    v_mov_b32 v2, s29
    s_waitcnt vmcnt(0)
    s_barrier
    s_cmp_lg_u32 s3, 4
    s_cbranch_scc1 ch_nox
    s_mov_b64 exec, 1
    buffer_atomic_add v2, off, s[64:67], s28 sc1
    s_mov_b64 exec, -1
ch_nox:
    v_and_b32 v20, 63, v0
    v_lshlrev_b32 v0, 4, v20
    s_sub_u32 s25, s3, 4
    s_lshl_b32 s46, s12, 2
    s_add_u32 s46, s46, s25
    s_lshl_b32 s21, s46, 18
    s_lshl_b32 s22, s13, 7
    s_add_u32 s21, s21, s22
    s_lshl_b32 s46, s46, 12
    s_lshl_b32 s23, s25, 13
    s_add_u32 s23, s23, 131072
    s_load_dwordx2 s[8:9], s[0:1], 40
    s_mov_b32 s10, 8388608
    s_mov_b32 s11, 131072
    v_lshrrev_b32 v21, 3, v20
    v_and_b32 v22, 7, v20
    v_lshlrev_b32 v21, 11, v21
    v_lshl_add_u32 v21, v22, 4, v21
    v_lshrrev_b32 v28, 4, v20
    v_and_b32 v29, 1, v28
    v_xor_b32 v29, 0, v29
    v_lshlrev_b32 v29, 2, v29
    v_lshl_add_u32 v29, v28, 3, v29
    v_bfe_u32 v28, v20, 2, 2
    v_add_u32 v29, v29, v28
    v_lshlrev_b32 v29, 7, v29
    v_and_b32 v28, 3, v20
    v_lshl_add_u32 v29, v28, 4, v29
    v_and_b32 v28, 1, v28
    v_xor_b32 v28, 0, v28
    v_lshl_add_u32 v24, v28, 3, v29
    v_add_u32 v24, s23, v24
    v_lshrrev_b32 v28, 4, v20
    v_and_b32 v29, 1, v28
    v_xor_b32 v29, 1, v29
    v_lshlrev_b32 v29, 2, v29
    v_lshl_add_u32 v29, v28, 3, v29
    v_bfe_u32 v28, v20, 2, 2
    v_add_u32 v29, v29, v28
    v_lshlrev_b32 v29, 7, v29
    v_and_b32 v28, 3, v20
    v_lshl_add_u32 v29, v28, 4, v29
    v_and_b32 v28, 1, v28
    v_xor_b32 v28, 0, v28
    v_lshl_add_u32 v25, v28, 3, v29
    v_add_u32 v25, s23, v25
    v_lshrrev_b32 v28, 4, v20
    v_and_b32 v29, 1, v28
    v_xor_b32 v29, 0, v29
    v_lshlrev_b32 v29, 2, v29
    v_lshl_add_u32 v29, v28, 3, v29
    v_bfe_u32 v28, v20, 2, 2
    v_add_u32 v29, v29, v28
    v_lshlrev_b32 v29, 7, v29
    v_and_b32 v28, 3, v20
    v_lshl_add_u32 v29, v28, 4, v29
    v_and_b32 v28, 1, v28
    v_xor_b32 v28, 1, v28
    v_lshl_add_u32 v26, v28, 3, v29
    v_add_u32 v26, s23, v26
    v_lshrrev_b32 v28, 4, v20
    v_and_b32 v29, 1, v28
    v_xor_b32 v29, 1, v29
    v_lshlrev_b32 v29, 2, v29
    v_lshl_add_u32 v29, v28, 3, v29
    v_bfe_u32 v28, v20, 2, 2
    v_add_u32 v29, v29, v28
    v_lshlrev_b32 v29, 7, v29
    v_and_b32 v28, 3, v20
    v_lshl_add_u32 v29, v28, 4, v29
    v_and_b32 v28, 1, v28
    v_xor_b32 v28, 1, v28
    v_lshl_add_u32 v27, v28, 3, v29
    v_add_u32 v27, s23, v27
    s_waitcnt lgkmcnt(0)
    s_add_u32 m0, s23, 0
    s_nop 0
    buffer_load_dwordx4 v21, s[8:11], s21 offen lds
    s_add_u32 s21, s21, 16384
    s_add_u32 m0, s23, 1024
    s_nop 0
    buffer_load_dwordx4 v21, s[8:11], s21 offen lds
    s_add_u32 s21, s21, 16384
    s_add_u32 m0, s23, 2048
    s_nop 0
    buffer_load_dwordx4 v21, s[8:11], s21 offen lds
    s_add_u32 s21, s21, 16384
    s_add_u32 m0, s23, 3072
    s_nop 0
    buffer_load_dwordx4 v21, s[8:11], s21 offen lds
    s_add_u32 s21, s21, 16384
    s_add_u32 m0, s23, 4096
    s_nop 0
    buffer_load_dwordx4 v21, s[8:11], s21 offen lds
    s_add_u32 s21, s21, 16384
    s_add_u32 m0, s23, 5120
    s_nop 0
    buffer_load_dwordx4 v21, s[8:11], s21 offen lds
    s_add_u32 s21, s21, 16384
    s_add_u32 m0, s23, 6144
    s_nop 0
    buffer_load_dwordx4 v21, s[8:11], s21 offen lds
    s_add_u32 s21, s21, 16384
    s_add_u32 m0, s23, 7168
    s_nop 0
    buffer_load_dwordx4 v21, s[8:11], s21 offen lds
    s_add_u32 s21, s21, 16384
    buffer_load_dwordx4 v[98:101], v21, s[8:11], s21 offen
    s_add_u32 s21, s21, 16384
    buffer_load_dwordx4 v[102:105], v21, s[8:11], s21 offen
    s_add_u32 s21, s21, 16384
    buffer_load_dwordx4 v[106:109], v21, s[8:11], s21 offen
    s_add_u32 s21, s21, 16384
    buffer_load_dwordx4 v[110:113], v21, s[8:11], s21 offen
    s_add_u32 s21, s21, 16384
    buffer_load_dwordx4 v[114:117], v21, s[8:11], s21 offen
    s_add_u32 s21, s21, 16384
    buffer_load_dwordx4 v[118:121], v21, s[8:11], s21 offen
    s_add_u32 s21, s21, 16384
    buffer_load_dwordx4 v[122:125], v21, s[8:11], s21 offen
    s_add_u32 s21, s21, 16384
    buffer_load_dwordx4 v[126:129], v21, s[8:11], s21 offen
    s_add_u32 s21, s21, 16384
    v_add_u32 v30, s23, v0
    s_waitcnt vmcnt(8)
    ds_read_b64_tr_b16 v[192:193], v24 offset:0
    ds_read_b64_tr_b16 v[194:195], v25 offset:0
    ds_read_b64_tr_b16 v[200:201], v26 offset:0
    ds_read_b64_tr_b16 v[202:203], v27 offset:0
    ds_read_b64_tr_b16 v[208:209], v24 offset:64
    ds_read_b64_tr_b16 v[210:211], v25 offset:64
    ds_read_b64_tr_b16 v[216:217], v26 offset:64
    ds_read_b64_tr_b16 v[218:219], v27 offset:64
    s_waitcnt lgkmcnt(0)
    ds_read_b64_tr_b16 v[196:197], v24 offset:4096
    ds_read_b64_tr_b16 v[198:199], v25 offset:4096
    ds_read_b64_tr_b16 v[204:205], v26 offset:4096
    ds_read_b64_tr_b16 v[206:207], v27 offset:4096
    ds_read_b64_tr_b16 v[212:213], v24 offset:4160
    ds_read_b64_tr_b16 v[214:215], v25 offset:4160
    ds_read_b64_tr_b16 v[220:221], v26 offset:4160
    ds_read_b64_tr_b16 v[222:223], v27 offset:4160
    s_waitcnt lgkmcnt(0)
    s_waitcnt vmcnt(0)
    ds_write_b128 v30, v[98:101] offset:0
    ds_write_b128 v30, v[102:105] offset:1024
    ds_write_b128 v30, v[106:109] offset:2048
    ds_write_b128 v30, v[110:113] offset:3072
    ds_write_b128 v30, v[114:117] offset:4096
    ds_write_b128 v30, v[118:121] offset:5120
    ds_write_b128 v30, v[122:125] offset:6144
    ds_write_b128 v30, v[126:129] offset:7168
    s_waitcnt lgkmcnt(0)
    ds_read_b64_tr_b16 v[224:225], v24 offset:0
    ds_read_b64_tr_b16 v[226:227], v25 offset:0
    ds_read_b64_tr_b16 v[232:233], v26 offset:0
    ds_read_b64_tr_b16 v[234:235], v27 offset:0
    ds_read_b64_tr_b16 v[240:241], v24 offset:64
    ds_read_b64_tr_b16 v[242:243], v25 offset:64
    ds_read_b64_tr_b16 v[248:249], v26 offset:64
    ds_read_b64_tr_b16 v[250:251], v27 offset:64
    s_waitcnt lgkmcnt(0)
    ds_read_b64_tr_b16 v[228:229], v24 offset:4096
    ds_read_b64_tr_b16 v[230:231], v25 offset:4096
    ds_read_b64_tr_b16 v[236:237], v26 offset:4096
    ds_read_b64_tr_b16 v[238:239], v27 offset:4096
    ds_read_b64_tr_b16 v[244:245], v24 offset:4160
    ds_read_b64_tr_b16 v[246:247], v25 offset:4160
    ds_read_b64_tr_b16 v[252:253], v26 offset:4160
    ds_read_b64_tr_b16 v[254:255], v27 offset:4160
    s_waitcnt lgkmcnt(0)
    v_lshrrev_b32 v21, 4, v20
    s_mul_i32 s21, s25, 18560
    s_add_u32 s21, s21, 16384
    v_add_u32 v1, s21, v0
    v_and_b32 v23, 15, v20
    v_mul_u32_u24 v21, 136, v21
    v_lshl_add_u32 v21, v23, 3, v21
    v_add_u32 v45, s21, v21
    s_lshl_b32 s53, s25, 13
    s_add_u32 s53, s53, 92160
    v_add_u32 v49, s53, v0
    v_mov_b32 v48, 0
    v_mov_b32 v4, 0x3f803f80
    v_mov_b32 v5, 0x3f803f80
    v_mov_b32 v6, 0x3f803f80
    v_mov_b32 v7, 0x3f803f80
    v_mov_b32 v8, 0
    v_mov_b32 v9, 0
    v_mov_b32 v10, 0
    v_mov_b32 v11, 0
    v_lshlrev_b32 v43, 2, v20
    v_mov_b32 v26, 0x44444444
    v_mov_b32 v27, 0xeeeeeeee
    v_and_b32 v28, 1, v20
    v_cmp_eq_u32 vcc, 0, v28
    s_mov_b32 s47, 0x3e0293ee
    s_lshl_b32 s32, s12, 15
    v_cndmask_b32 v41, v27, v26, vcc
    s_lshl_b32 s21, s25, 13
    s_add_u32 s32, s32, s21
    s_add_u32 s32, s32, 2097152
    s_lshl_b32 s21, s25, 2
    s_add_u32 s21, s21, 13312
    v_mov_b32 v47, s21
    s_lshl_b32 s27, s13, 2
    s_add_u32 s27, s27, s25
    s_lshl_b32 s62, s12, 7
    s_add_u32 s62, s62, 218112000
    s_lshl_b32 s33, s12, 14
    s_lshl_b32 s21, s25, 12
    s_add_u32 s33, s33, s21
    s_add_u32 s33, s33, 1179648
    v_mov_b32 v139, 0
    v_mov_b32 v140, 0
    v_mov_b32 v141, 0
    v_mov_b32 v143, 0
    v_mov_b32 v144, 0
    v_mov_b32 v145, 0
    v_mov_b32 v40, 0
    v_mov_b32 v42, 0
    v_mov_b32 v44, 0
    v_mov_b32 v46, 0
    v_mov_b32 v158, 0x7f800000
    s_mov_b32 exec_lo, 0xcccccccc
    s_mov_b32 exec_hi, 0xcccccccc
    v_mov_b32 v158, 0x42700000
    s_mov_b64 exec, -1
    s_cmp_lg_u32 s3, 4
    s_cbranch_scc1 ch_xcc_skip
    v_add_u32 v56, 128, v43
    s_movk_i32 s21, 192
    v_writelane_b32 v56, s21, 4
    v_mov_b32 v59, 63
    v_writelane_b32 v59, -1, 4
    v_mov_b32 v60, 32
    s_mov_b64 exec, 0x1f
ch_xcc:
    buffer_load_dword v57, v56, s[64:67], 0 offen sc1
    s_waitcnt vmcnt(0)
    v_and_b32 v62, v59, v57
    v_cmp_ne_u32 vcc, v62, v60
    s_cbranch_vccz ch_xcc_ok
    s_sleep 16
    s_sub_u32 s26, s26, 1
    s_cbranch_scc0 ch_xcc
    s_mov_b32 s26, 0
ch_xcc_ok:
    s_lshr_b32 s22, s12, 1
    v_readlane_b32 s23, v57, 0
    s_nop 2
    v_readlane_b32 s21, v57, s22
    s_mov_b64 exec, -1
    v_mov_b32 v58, 131072
    v_mov_b32 v57, s21
    ds_write_b32 v58, v57
    s_bfe_u32 s23, s23, 0x1000f
    v_and_b32 v60, 0x70, v0
    v_lshlrev_b32 v60, 3, v60
    s_mov_b32 s22, 218112000
ch_pgv:
    buffer_load_dword v61, v60, s[4:7], s22 offen offset:8 sc1
    s_waitcnt vmcnt(0) lgkmcnt(0)
    v_and_b32 v62, 1, v61
    v_cmp_eq_u32 vcc, 0, v62
    s_cbranch_vccz ch_pgvok
    s_sleep 8
    s_sub_u32 s26, s26, 1
    s_cbranch_scc0 ch_pgv
    s_mov_b32 s26, 0
ch_pgvok:
    v_bfe_u32 v62, v61, 1, 1
    v_ashrrev_i32 v61, 8, v61
    v_sub_u32 v59, 0, v61
    v_cmp_eq_u32 vcc, s23, v62
    s_mov_b32 s21, 0
    s_nop 1
    v_cndmask_b32 v61, v59, v61, vcc
    s_nop 1
    v_readlane_b32 s22, v61, 0
    s_add_i32 s21, s21, s22
    v_readlane_b32 s22, v61, 1
    s_add_i32 s21, s21, s22
    v_readlane_b32 s22, v61, 2
    s_add_i32 s21, s21, s22
    v_readlane_b32 s22, v61, 3
    s_add_i32 s21, s21, s22
    v_readlane_b32 s22, v61, 4
    s_add_i32 s21, s21, s22
    v_readlane_b32 s22, v61, 5
    s_add_i32 s21, s21, s22
    v_readlane_b32 s22, v61, 6
    s_add_i32 s21, s21, s22
    v_readlane_b32 s22, v61, 7
    s_add_i32 s21, s21, s22
    s_cmp_gt_i32 s21, 0
    s_cselect_b32 s21, 0x2000, 0
    v_mov_b32 v59, s21
    ds_write_b32 v58, v59 offset:4
    s_waitcnt lgkmcnt(0)
ch_xcc_skip:
    s_barrier
    s_barrier
    s_lshl_b32 s60, s12, 4
    s_add_u32 s60, s60, 218104320
ch_g0:
    buffer_load_dword v57, off, s[4:7], s60 sc1
    s_waitcnt vmcnt(0)
    v_readfirstlane_b32 s21, v57
    s_cmp_ge_u32 s21, 12
    s_cbranch_scc1 ch_g0b
    s_sleep 8
    s_sub_u32 s26, s26, 1
    s_cbranch_scc0 ch_g0
    s_mov_b32 s26, 0
ch_g0b:
    s_add_u32 s21, s16, 0
    s_lshl_b32 s21, s21, 18
    s_add_u32 s21, s21, s46
    s_add_u32 s21, s21, 37748736
    s_add_u32 s22, s21, 131072
    buffer_load_dwordx4 v[160:163], v0, s[4:7], s21 offen offset:0 sc1
    buffer_load_dwordx4 v[164:167], v0, s[4:7], s21 offen offset:1024 sc1
    buffer_load_dwordx4 v[168:171], v0, s[4:7], s21 offen offset:2048 sc1
    buffer_load_dwordx4 v[172:175], v0, s[4:7], s21 offen offset:3072 sc1
    buffer_load_dwordx4 v[176:179], v0, s[4:7], s22 offen offset:0 sc1
    buffer_load_dwordx4 v[180:183], v0, s[4:7], s22 offen offset:1024 sc1
    buffer_load_dwordx4 v[184:187], v0, s[4:7], s22 offen offset:2048 sc1
    buffer_load_dwordx4 v[188:191], v0, s[4:7], s22 offen offset:3072 sc1
    s_waitcnt vmcnt(0)
    v_mfma_f32_16x16x32_bf16 v[50:53], v[160:163], v[192:195], 0
    v_mfma_f32_16x16x32_bf16 v[54:57], v[160:163], v[200:203], 0
    v_mfma_f32_16x16x32_bf16 v[58:61], v[160:163], v[208:211], 0
    v_mfma_f32_16x16x32_bf16 v[62:65], v[160:163], v[216:219], 0
    v_mfma_f32_16x16x32_bf16 v[66:69], v[176:179], v[192:195], 0
    v_mfma_f32_16x16x32_bf16 v[70:73], v[176:179], v[200:203], 0
    v_mfma_f32_16x16x32_bf16 v[74:77], v[176:179], v[208:211], 0
    v_mfma_f32_16x16x32_bf16 v[78:81], v[176:179], v[216:219], 0
    v_mfma_f32_16x16x32_bf16 v[50:53], v[164:167], v[196:199], v[50:53]
    v_mfma_f32_16x16x32_bf16 v[54:57], v[164:167], v[204:207], v[54:57]
    v_mfma_f32_16x16x32_bf16 v[58:61], v[164:167], v[212:215], v[58:61]
    v_mfma_f32_16x16x32_bf16 v[62:65], v[164:167], v[220:223], v[62:65]
    v_mfma_f32_16x16x32_bf16 v[66:69], v[180:183], v[196:199], v[66:69]
    v_mfma_f32_16x16x32_bf16 v[70:73], v[180:183], v[204:207], v[70:73]
    v_mfma_f32_16x16x32_bf16 v[74:77], v[180:183], v[212:215], v[74:77]
    v_mfma_f32_16x16x32_bf16 v[78:81], v[180:183], v[220:223], v[78:81]
    v_mfma_f32_16x16x32_bf16 v[50:53], v[168:171], v[224:227], v[50:53]
    v_mfma_f32_16x16x32_bf16 v[54:57], v[168:171], v[232:235], v[54:57]
    v_mfma_f32_16x16x32_bf16 v[58:61], v[168:171], v[240:243], v[58:61]
    v_mfma_f32_16x16x32_bf16 v[62:65], v[168:171], v[248:251], v[62:65]
    v_mfma_f32_16x16x32_bf16 v[66:69], v[184:187], v[224:227], v[66:69]
    v_mfma_f32_16x16x32_bf16 v[70:73], v[184:187], v[232:235], v[70:73]
    v_mfma_f32_16x16x32_bf16 v[74:77], v[184:187], v[240:243], v[74:77]
    v_mfma_f32_16x16x32_bf16 v[78:81], v[184:187], v[248:251], v[78:81]
    v_mfma_f32_16x16x32_bf16 v[50:53], v[172:175], v[228:231], v[50:53]
    v_mfma_f32_16x16x32_bf16 v[54:57], v[172:175], v[236:239], v[54:57]
    v_mfma_f32_16x16x32_bf16 v[58:61], v[172:175], v[244:247], v[58:61]
    v_mfma_f32_16x16x32_bf16 v[62:65], v[172:175], v[252:255], v[62:65]
    v_mfma_f32_16x16x32_bf16 v[66:69], v[188:191], v[228:231], v[66:69]
    v_mfma_f32_16x16x32_bf16 v[70:73], v[188:191], v[236:239], v[70:73]
    v_mfma_f32_16x16x32_bf16 v[74:77], v[188:191], v[244:247], v[74:77]
    v_mfma_f32_16x16x32_bf16 v[78:81], v[188:191], v[252:255], v[78:81]
    s_add_u32 s21, s16, 1
    s_lshl_b32 s21, s21, 18
    s_add_u32 s21, s21, s46
    s_add_u32 s21, s21, 37748736
    s_add_u32 s22, s21, 131072
    s_mov_b32 s34, 1
    s_nop 7
    v_cvt_pk_bf16_f32 v82, v50, v51
    v_cvt_pk_bf16_f32 v83, v52, v53
    v_cvt_pk_bf16_f32 v84, v66, v67
    v_cvt_pk_bf16_f32 v85, v68, v69
    v_cvt_pk_bf16_f32 v86, v54, v55
    v_cvt_pk_bf16_f32 v87, v56, v57
    v_cvt_pk_bf16_f32 v88, v70, v71
    v_cvt_pk_bf16_f32 v89, v72, v73
    v_cvt_pk_bf16_f32 v90, v58, v59
    v_cvt_pk_bf16_f32 v91, v60, v61
    v_cvt_pk_bf16_f32 v92, v74, v75
    v_cvt_pk_bf16_f32 v93, v76, v77
    v_cvt_pk_bf16_f32 v94, v62, v63
    v_cvt_pk_bf16_f32 v95, v64, v65
    v_cvt_pk_bf16_f32 v96, v78, v79
    v_cvt_pk_bf16_f32 v97, v80, v81
.p2align 6
aloop_23:
    s_add_u32 s21, s17, s32
    s_add_u32 s22, s21, 4096
    v_mov_b32 v74, 0
    v_mov_b32 v75, 0
    v_mov_b32 v76, 0
    v_mov_b32 v77, 0
    v_mov_b32 v78, 0
    v_mov_b32 v79, 0
    v_mov_b32 v80, 0
    v_mov_b32 v81, 0
    v_mov_b32 v146, 0
    v_mov_b32 v147, 0
    v_mov_b32 v148, 0
    v_mov_b32 v149, 0
    v_mov_b32 v150, 0
    v_mov_b32 v151, 0
    v_mov_b32 v152, 0
    v_mov_b32 v153, 0
    s_add_u32 s30, s16, 1
    s_lshl_b32 s30, s30, 18
    s_add_u32 s30, s30, s46
    s_add_u32 s30, s30, 37748736
    s_add_u32 s31, s30, 131072
aloop_23_wm:
    ds_read_b32 v3, v47
    s_waitcnt lgkmcnt(0)
    v_readfirstlane_b32 s23, v3
    s_cmp_eq_u32 s23, s16
    s_cbranch_scc1 aloop_23_wmok
    s_sleep 1
    s_branch aloop_23_wm
aloop_23_wmok:
    buffer_load_dwordx4 v[160:163], v0, s[4:7], s30 offen offset:0 sc1
    buffer_load_dwordx4 v[164:167], v0, s[4:7], s30 offen offset:1024 sc1
    buffer_load_dwordx4 v[168:171], v0, s[4:7], s30 offen offset:2048 sc1
    buffer_load_dwordx4 v[172:175], v0, s[4:7], s30 offen offset:3072 sc1
    buffer_load_dwordx4 v[176:179], v0, s[4:7], s31 offen offset:0 sc1
    buffer_load_dwordx4 v[180:183], v0, s[4:7], s31 offen offset:1024 sc1
    buffer_load_dwordx4 v[184:187], v0, s[4:7], s31 offen offset:2048 sc1
    buffer_load_dwordx4 v[188:191], v0, s[4:7], s31 offen offset:3072 sc1
    s_setprio 2
    v_mov_b32 v2, s16
    s_barrier
    s_nop 15
    s_nop 13
    ds_read_b128 v[98:101], v49 offset:0
    ds_read_b128 v[102:105], v49 offset:1024
    ds_read_b128 v[106:109], v49 offset:2048
    ds_read_b128 v[110:113], v49 offset:3072
    ds_read_b128 v[114:117], v49 offset:4096
    ds_read_b128 v[118:121], v49 offset:5120
    ds_read_b128 v[122:125], v49 offset:6144
    ds_read_b128 v[126:129], v49 offset:7168
    v_mov_b32 v12, 0
    v_mov_b32 v13, 0
    v_mov_b32 v14, 0
    v_mov_b32 v15, 0
    v_mov_b32 v16, 0
    v_mov_b32 v17, 0
    v_mov_b32 v18, 0
    v_mov_b32 v19, 0
    v_mov_b32 v20, 0
    v_mov_b32 v21, 0
    v_mov_b32 v22, 0
    v_mov_b32 v23, 0
    s_sleep 3
    s_nop 13
    buffer_load_dwordx4 v[50:53], v0, s[4:7], s21 offen offset:0 sc1
    s_nop 7
    buffer_load_dwordx4 v[54:57], v0, s[4:7], s21 offen offset:1024 sc1
    s_nop 7
    buffer_load_dwordx4 v[58:61], v0, s[4:7], s21 offen offset:2048 sc1
    s_nop 7
    buffer_load_dwordx4 v[62:65], v0, s[4:7], s21 offen offset:3072 sc1
    s_nop 7
    buffer_load_dwordx4 v[66:69], v0, s[4:7], s22 offen offset:0 sc1
    s_nop 7
    buffer_load_dwordx4 v[70:73], v0, s[4:7], s22 offen offset:1024 sc1
    s_waitcnt lgkmcnt(0)
    s_waitcnt vmcnt(5)
    v_max3_u32 v3, v50, v51, v52
    v_max_u32 v3, v3, v53
    v_cmp_eq_u32 vcc, -1, v3
    s_cbranch_vccnz arq_24_0
arq_24_0ok:
    v_mfma_f32_16x16x32_bf16 v[12:15], v[98:101], v[50:53], v[12:15]
    v_mfma_f32_16x16x32_bf16 v[16:19], v[114:117], v[50:53], v[16:19]
    s_waitcnt vmcnt(4)
    v_max3_u32 v3, v54, v55, v56
    v_max_u32 v3, v3, v57
    v_cmp_eq_u32 vcc, -1, v3
    v_mfma_f32_16x16x32_bf16 v[20:23], v[50:53], v[50:53], v[20:23]
    s_cbranch_vccnz arq_24_1
arq_24_1ok:
    v_mfma_f32_16x16x32_bf16 v[12:15], v[102:105], v[54:57], v[12:15]
    v_mfma_f32_16x16x32_bf16 v[16:19], v[118:121], v[54:57], v[16:19]
    s_waitcnt vmcnt(3)
    v_max3_u32 v3, v58, v59, v60
    v_max_u32 v3, v3, v61
    v_cmp_eq_u32 vcc, -1, v3
    v_mfma_f32_16x16x32_bf16 v[20:23], v[54:57], v[54:57], v[20:23]
    s_cbranch_vccnz arq_24_2
arq_24_2ok:
    v_mfma_f32_16x16x32_bf16 v[12:15], v[106:109], v[58:61], v[12:15]
    v_mfma_f32_16x16x32_bf16 v[16:19], v[122:125], v[58:61], v[16:19]
    s_waitcnt vmcnt(2)
    v_max3_u32 v3, v62, v63, v64
    v_max_u32 v3, v3, v65
    v_cmp_eq_u32 vcc, -1, v3
    v_mfma_f32_16x16x32_bf16 v[20:23], v[58:61], v[58:61], v[20:23]
    s_cbranch_vccnz arq_24_3
arq_24_3ok:
    v_mfma_f32_16x16x32_bf16 v[12:15], v[110:113], v[62:65], v[12:15]
    ds_write_b32 v47, v2 offset:16
    v_mfma_f32_16x16x32_bf16 v[16:19], v[126:129], v[62:65], v[16:19]
    v_mfma_f32_16x16x32_bf16 v[20:23], v[62:65], v[62:65], v[20:23]
aloop_23_sdone:
    s_nop 0
    s_cmp_eq_u32 s16, 63
    s_cbranch_scc1 aloop_23_lsk
    s_nop 1
    v_exp_f32 v54, v12
    v_exp_f32 v55, v13
    s_waitcnt vmcnt(0)
    v_max3_u32 v24, v66, v67, v68
    v_max3_u32 v24, v24, v69, v70
    v_max3_u32 v24, v24, v71, v72
    v_max_u32 v24, v24, v73
    v_cmp_eq_u32 vcc, -1, v24
    s_cbranch_vccnz arq_24_v
    v_smfmac_f32_16x16x64_bf16 v[74:77], v[66:69], v[192:199], v41
    v_exp_f32 v56, v14
    v_smfmac_f32_16x16x64_bf16 v[78:81], v[66:69], v[200:207], v41
    v_exp_f32 v57, v15
    v_smfmac_f32_16x16x64_bf16 v[146:149], v[66:69], v[208:215], v41
    v_exp_f32 v58, v16
    v_smfmac_f32_16x16x64_bf16 v[150:153], v[66:69], v[216:223], v41
    v_exp_f32 v59, v17
    v_smfmac_f32_16x16x64_bf16 v[74:77], v[70:73], v[224:231], v41
    v_exp_f32 v60, v18
    v_smfmac_f32_16x16x64_bf16 v[78:81], v[70:73], v[232:239], v41
    v_exp_f32 v61, v19
    v_smfmac_f32_16x16x64_bf16 v[146:149], v[70:73], v[240:247], v41
    v_exp_f32 v62, v20
    v_smfmac_f32_16x16x64_bf16 v[150:153], v[70:73], v[248:255], v41
    v_exp_f32 v63, v21
    v_cvt_pk_bf16_f32 v154, v54, v55
    v_cvt_pk_bf16_f32 v155, v56, v57
    v_cvt_pk_bf16_f32 v156, v58, v59
    v_cvt_pk_bf16_f32 v157, v60, v61
    v_cvt_pk_bf16_f32 v8, v62, v63
    v_max3_f32 v2, |v12|, |v13|, |v14|
    v_mfma_f32_16x16x32_bf16 v[50:53], v[154:157], v[4:7], 0
    v_max3_f32 v3, |v15|, |v16|, |v17|
    v_add_f32 v74, v74, v75
    v_mfma_f32_16x16x32_bf16 v[50:53], v[8:11], v[4:7], v[50:53]
    v_add_f32 v76, v76, v77
    v_cvt_pk_bf16_f32 v40, v74, v76
    v_mfma_f32_16x16x32_bf16 v[24:27], v[154:157], v[82:85], 0
    v_add_f32 v78, v78, v79
    v_add_f32 v80, v80, v81
    v_mfma_f32_16x16x32_bf16 v[24:27], v[8:11], v[40:43], v[24:27]
    v_cvt_pk_bf16_f32 v42, v78, v80
    v_add_f32 v146, v146, v147
    v_mfma_f32_16x16x32_bf16 v[28:31], v[154:157], v[86:89], 0
    v_add_f32 v148, v148, v149
    v_cvt_pk_bf16_f32 v44, v146, v148
    v_mfma_f32_16x16x32_bf16 v[28:31], v[8:11], v[42:45], v[28:31]
    v_add_f32 v150, v150, v151
    v_add_f32 v152, v152, v153
    v_mfma_f32_16x16x32_bf16 v[32:35], v[154:157], v[90:93], 0
    v_cvt_pk_bf16_f32 v46, v150, v152
    v_rcp_f32 v52, v52
    v_mfma_f32_16x16x32_bf16 v[32:35], v[8:11], v[44:47], v[32:35]
    v_rcp_f32 v53, v53
    v_max3_f32 v2, v2, |v18|, |v19|
    v_mfma_f32_16x16x32_bf16 v[36:39], v[154:157], v[94:97], 0
    v_max3_f32 v3, v3, |v20|, |v21|
    v_max_f32 v2, v2, v3
    v_mfma_f32_16x16x32_bf16 v[36:39], v[8:11], v[46:49], v[36:39]
    v_cmp_nle_f32 vcc, v2, v158
    v_mul_f32 v26, v26, v52
    v_mul_f32 v27, v27, v53
    s_cbranch_vccnz aloop_23_tm
    v_mul_f32 v30, v30, v52
    v_mul_f32 v31, v31, v53
aloop_23_pvd:
    ds_write_b64 v45, v[26:27] offset:0
    v_mul_f32 v34, v34, v52
    v_mul_f32 v35, v35, v53
    ds_write_b64 v45, v[30:31] offset:544
    v_mul_f32 v38, v38, v52
    v_mul_f32 v39, v39, v53
    ds_write_b64 v45, v[34:35] offset:1088
    ds_write_b64 v45, v[38:39] offset:1632
aloop_23_lskb:
    s_waitcnt lgkmcnt(0)
    s_barrier
    s_setprio 0
    s_cmp_lg_u32 s27, 0
    s_cbranch_scc1 pg_25
    s_sub_u32 s25, s16, 1
    s_cbranch_scc1 pg_25
    v_mov_b32 v3, s25
    s_mov_b64 exec, 1
    buffer_store_dword v3, off, s[4:7], s62 sc1
    s_mov_b64 exec, -1
pg_25:
    s_add_u32 s21, s17, s33
    v_lshlrev_b32 v2, 1, v43
    s_cmp_eq_u32 s16, 63
    s_cbranch_scc1 aloop_23_nvw
    v_mfma_f32_16x16x32_bf16 v[50:53], v[160:163], v[192:195], 0
    v_mfma_f32_16x16x32_bf16 v[54:57], v[160:163], v[200:203], 0
    v_mfma_f32_16x16x32_bf16 v[58:61], v[160:163], v[208:211], 0
    v_mfma_f32_16x16x32_bf16 v[62:65], v[160:163], v[216:219], 0
    v_mfma_f32_16x16x32_bf16 v[66:69], v[176:179], v[192:195], 0
    v_mfma_f32_16x16x32_bf16 v[70:73], v[176:179], v[200:203], 0
    v_mfma_f32_16x16x32_bf16 v[74:77], v[176:179], v[208:211], 0
    v_mfma_f32_16x16x32_bf16 v[78:81], v[176:179], v[216:219], 0
    v_mfma_f32_16x16x32_bf16 v[50:53], v[164:167], v[196:199], v[50:53]
    v_mfma_f32_16x16x32_bf16 v[54:57], v[164:167], v[204:207], v[54:57]
    v_mfma_f32_16x16x32_bf16 v[58:61], v[164:167], v[212:215], v[58:61]
    v_mfma_f32_16x16x32_bf16 v[62:65], v[164:167], v[220:223], v[62:65]
    v_mfma_f32_16x16x32_bf16 v[66:69], v[180:183], v[196:199], v[66:69]
    v_mfma_f32_16x16x32_bf16 v[70:73], v[180:183], v[204:207], v[70:73]
    v_mfma_f32_16x16x32_bf16 v[74:77], v[180:183], v[212:215], v[74:77]
    v_mfma_f32_16x16x32_bf16 v[78:81], v[180:183], v[220:223], v[78:81]
    v_mfma_f32_16x16x32_bf16 v[50:53], v[168:171], v[224:227], v[50:53]
    v_mfma_f32_16x16x32_bf16 v[54:57], v[168:171], v[232:235], v[54:57]
    v_mfma_f32_16x16x32_bf16 v[58:61], v[168:171], v[240:243], v[58:61]
    v_mfma_f32_16x16x32_bf16 v[62:65], v[168:171], v[248:251], v[62:65]
    v_mfma_f32_16x16x32_bf16 v[66:69], v[184:187], v[224:227], v[66:69]
    v_mfma_f32_16x16x32_bf16 v[70:73], v[184:187], v[232:235], v[70:73]
    v_mfma_f32_16x16x32_bf16 v[74:77], v[184:187], v[240:243], v[74:77]
    v_mfma_f32_16x16x32_bf16 v[78:81], v[184:187], v[248:251], v[78:81]
    v_mfma_f32_16x16x32_bf16 v[50:53], v[172:175], v[228:231], v[50:53]
    v_mfma_f32_16x16x32_bf16 v[54:57], v[172:175], v[236:239], v[54:57]
    v_mfma_f32_16x16x32_bf16 v[58:61], v[172:175], v[244:247], v[58:61]
    v_mfma_f32_16x16x32_bf16 v[62:65], v[172:175], v[252:255], v[62:65]
    v_mfma_f32_16x16x32_bf16 v[66:69], v[188:191], v[228:231], v[66:69]
    v_mfma_f32_16x16x32_bf16 v[70:73], v[188:191], v[236:239], v[70:73]
    v_mfma_f32_16x16x32_bf16 v[74:77], v[188:191], v[244:247], v[74:77]
    v_mfma_f32_16x16x32_bf16 v[78:81], v[188:191], v[252:255], v[78:81]
    buffer_load_dwordx4 v[130:133], v0, s[4:7], s21 offen sc1
    buffer_load_dwordx2 v[146:147], v2, s[4:7], s21 offen offset:1024 sc1
    buffer_load_dwordx4 v[134:137], v0, s[4:7], s21 offen offset:2048 sc1
    buffer_load_dwordx2 v[148:149], v2, s[4:7], s21 offen offset:3072 sc1
    s_add_u32 s30, s16, 2
    s_lshl_b32 s30, s30, 18
    s_add_u32 s30, s30, s46
    s_add_u32 s30, s30, 37748736
    s_add_u32 s31, s30, 131072
    s_branch aloop_23_vwd
aloop_23_nvw:
    buffer_load_dwordx4 v[130:133], v0, s[4:7], s21 offen sc1
    buffer_load_dwordx2 v[146:147], v2, s[4:7], s21 offen offset:1024 sc1
    buffer_load_dwordx4 v[134:137], v0, s[4:7], s21 offen offset:2048 sc1
    buffer_load_dwordx2 v[148:149], v2, s[4:7], s21 offen offset:3072 sc1
aloop_23_vwd:
    v_add_u32 v48, s68, v1
    s_xor_b32 s68, s68, 8192
aloop_23_psa:
    s_waitcnt vmcnt(0)
    v_max3_u32 v3, v130, v131, v132
    v_max3_u32 v3, v3, v133, v134
    v_max3_u32 v3, v3, v135, v136
    v_max3_u32 v3, v3, v137, v146
    v_max3_u32 v3, v3, v147, v148
    v_max_u32 v3, v3, v149
    v_cmp_eq_u32 vcc, -1, v3
    s_cbranch_vccnz arq_24_ps
aloop_23_psok:
    v_mfma_f32_16x16x32_bf16 v[24:27], v[82:85], v[130:133], 0
    v_mfma_f32_16x16x32_bf16 v[28:31], v[86:89], v[130:133], 0
    v_mfma_f32_16x16x32_bf16 v[32:35], v[90:93], v[130:133], 0
    v_mfma_f32_16x16x32_bf16 v[36:39], v[94:97], v[130:133], 0
    v_mov_b32 v138, v146
    v_mfma_f32_16x16x32_bf16 v[12:15], v[82:85], v[134:137], 0
    v_mfma_f32_16x16x32_bf16 v[16:19], v[86:89], v[134:137], 0
    v_mfma_f32_16x16x32_bf16 v[20:23], v[90:93], v[134:137], 0
    v_mfma_f32_16x16x32_bf16 v[154:157], v[94:97], v[134:137], 0
    v_mov_b32 v142, v148
    v_mfma_f32_16x16x32_bf16 v[24:27], v[40:43], v[138:141], v[24:27]
    v_mfma_f32_16x16x32_bf16 v[28:31], v[42:45], v[138:141], v[28:31]
    v_mfma_f32_16x16x32_bf16 v[32:35], v[44:47], v[138:141], v[32:35]
    v_mfma_f32_16x16x32_bf16 v[36:39], v[46:49], v[138:141], v[36:39]
    v_mfma_f32_16x16x32_bf16 v[12:15], v[40:43], v[142:145], v[12:15]
    v_mfma_f32_16x16x32_bf16 v[16:19], v[42:45], v[142:145], v[16:19]
    v_mfma_f32_16x16x32_bf16 v[20:23], v[44:47], v[142:145], v[20:23]
    s_nop 1
    v_mfma_f32_16x16x32_bf16 v[154:157], v[46:49], v[142:145], v[154:157]
aloop_23_nev:
    ds_write_b128 v48, v[24:27] offset:2176
    v_cvt_pk_bf16_f32 v82, v50, v51
    v_cvt_pk_bf16_f32 v83, v52, v53
    ds_write_b128 v48, v[28:31] offset:3200
    v_cvt_pk_bf16_f32 v84, v66, v67
    v_cvt_pk_bf16_f32 v85, v68, v69
    ds_write_b128 v48, v[32:35] offset:4224
    v_cvt_pk_bf16_f32 v86, v54, v55
    v_cvt_pk_bf16_f32 v87, v56, v57
    ds_write_b128 v48, v[36:39] offset:5248
    v_cvt_pk_bf16_f32 v88, v70, v71
    v_cvt_pk_bf16_f32 v89, v72, v73
    ds_write_b128 v48, v[12:15] offset:6272
    v_cvt_pk_bf16_f32 v90, v58, v59
    v_cvt_pk_bf16_f32 v91, v60, v61
    ds_write_b128 v48, v[16:19] offset:7296
    v_cvt_pk_bf16_f32 v92, v74, v75
    v_cvt_pk_bf16_f32 v93, v76, v77
    ds_write_b128 v48, v[20:23] offset:8320
    v_cvt_pk_bf16_f32 v94, v62, v63
    v_cvt_pk_bf16_f32 v95, v64, v65
    ds_write_b128 v48, v[154:157] offset:9344
    v_cvt_pk_bf16_f32 v96, v78, v79
    v_cvt_pk_bf16_f32 v97, v80, v81
aloop_23_bgskip:
    s_waitcnt lgkmcnt(0)
    s_cmp_eq_u32 s16, 63
    s_cbranch_scc1 aloop_23_fin
    s_add_u32 s16, s16, 1
    s_mov_b32 s17, s18
    s_mov_b32 s18, s19
    s_mov_b32 s19, s20
    s_add_u32 s20, s20, 262144
    s_cmp_eq_u32 s20, 210763776
    s_cselect_b32 s20, 209715200, s20
    s_branch aloop_23
arq_24_0:
    s_sub_u32 s26, s26, 1
    s_cbranch_scc1 arq_24_0_g
    buffer_load_dwordx4 v[50:53], v0, s[4:7], s21 offen offset:0 sc1
    buffer_load_dwordx4 v[54:57], v0, s[4:7], s21 offen offset:1024 sc1
    buffer_load_dwordx4 v[58:61], v0, s[4:7], s21 offen offset:2048 sc1
    buffer_load_dwordx4 v[62:65], v0, s[4:7], s21 offen offset:3072 sc1
    buffer_load_dwordx4 v[66:69], v0, s[4:7], s22 offen offset:0 sc1
    buffer_load_dwordx4 v[70:73], v0, s[4:7], s22 offen offset:1024 sc1
    s_waitcnt vmcnt(5)
    v_max3_u32 v3, v50, v51, v52
    v_max_u32 v3, v3, v53
    v_cmp_eq_u32 vcc, -1, v3
    s_cbranch_vccnz arq_24_0
    s_branch arq_24_0ok
arq_24_0_g:
    s_mov_b32 s26, 0
    s_waitcnt vmcnt(0)
    s_branch arq_24_0ok
arq_24_1:
    s_sub_u32 s26, s26, 1
    s_cbranch_scc1 arq_24_1_g
    buffer_load_dwordx4 v[54:57], v0, s[4:7], s21 offen offset:1024 sc1
    buffer_load_dwordx4 v[58:61], v0, s[4:7], s21 offen offset:2048 sc1
    buffer_load_dwordx4 v[62:65], v0, s[4:7], s21 offen offset:3072 sc1
    buffer_load_dwordx4 v[66:69], v0, s[4:7], s22 offen offset:0 sc1
    buffer_load_dwordx4 v[70:73], v0, s[4:7], s22 offen offset:1024 sc1
    s_waitcnt vmcnt(4)
    v_max3_u32 v3, v54, v55, v56
    v_max_u32 v3, v3, v57
    v_cmp_eq_u32 vcc, -1, v3
    s_cbranch_vccnz arq_24_1
    s_branch arq_24_1ok
arq_24_1_g:
    s_mov_b32 s26, 0
    s_waitcnt vmcnt(0)
    s_branch arq_24_1ok
arq_24_2:
    s_sub_u32 s26, s26, 1
    s_cbranch_scc1 arq_24_2_g
    buffer_load_dwordx4 v[58:61], v0, s[4:7], s21 offen offset:2048 sc1
    buffer_load_dwordx4 v[62:65], v0, s[4:7], s21 offen offset:3072 sc1
    buffer_load_dwordx4 v[66:69], v0, s[4:7], s22 offen offset:0 sc1
    buffer_load_dwordx4 v[70:73], v0, s[4:7], s22 offen offset:1024 sc1
    s_waitcnt vmcnt(3)
    v_max3_u32 v3, v58, v59, v60
    v_max_u32 v3, v3, v61
    v_cmp_eq_u32 vcc, -1, v3
    s_cbranch_vccnz arq_24_2
    s_branch arq_24_2ok
arq_24_2_g:
    s_mov_b32 s26, 0
    s_waitcnt vmcnt(0)
    s_branch arq_24_2ok
arq_24_3:
    s_sub_u32 s26, s26, 1
    s_cbranch_scc1 arq_24_3_g
    buffer_load_dwordx4 v[62:65], v0, s[4:7], s21 offen offset:3072 sc1
    buffer_load_dwordx4 v[66:69], v0, s[4:7], s22 offen offset:0 sc1
    buffer_load_dwordx4 v[70:73], v0, s[4:7], s22 offen offset:1024 sc1
    s_waitcnt vmcnt(2)
    v_max3_u32 v3, v62, v63, v64
    v_max_u32 v3, v3, v65
    v_cmp_eq_u32 vcc, -1, v3
    s_cbranch_vccnz arq_24_3
    s_branch arq_24_3ok
arq_24_3_g:
    s_mov_b32 s26, 0
    s_waitcnt vmcnt(0)
    s_branch arq_24_3ok
arq_24_v:
    buffer_load_dwordx4 v[66:69], v0, s[4:7], s22 offen offset:0 sc1
    buffer_load_dwordx4 v[70:73], v0, s[4:7], s22 offen offset:1024 sc1
    v_max3_f32 v2, v12, v13, v14
    v_max3_f32 v3, v15, v16, v17
    v_max3_f32 v2, v2, v18, v19
    v_max3_f32 v3, v3, v20, v21
    v_max_f32 v2, v2, v3
    v_mov_b32 v3, v2
    s_nop 1
    v_permlane16_swap_b32 v3, v2
    v_max_f32 v2, v2, v3
    v_mov_b32 v3, v2
    s_nop 1
    v_permlane32_swap_b32 v3, v2
    v_max_f32 v2, v2, v3
    v_sub_f32 v12, v12, v2
    v_sub_f32 v13, v13, v2
    v_sub_f32 v14, v14, v2
    v_sub_f32 v15, v15, v2
    v_sub_f32 v16, v16, v2
    v_sub_f32 v17, v17, v2
    v_sub_f32 v18, v18, v2
    v_sub_f32 v19, v19, v2
    v_sub_f32 v20, v20, v2
    v_sub_f32 v21, v21, v2
    v_exp_f32 v54, v12
    v_exp_f32 v55, v13
    v_exp_f32 v56, v14
    v_exp_f32 v57, v15
    v_exp_f32 v58, v16
    v_exp_f32 v59, v17
    v_exp_f32 v60, v18
    v_exp_f32 v61, v19
    v_exp_f32 v62, v20
    v_exp_f32 v63, v21
    s_nop 0
    v_cvt_pk_bf16_f32 v154, v54, v55
    v_cvt_pk_bf16_f32 v155, v56, v57
    v_cvt_pk_bf16_f32 v156, v58, v59
    v_cvt_pk_bf16_f32 v157, v60, v61
    v_cvt_pk_bf16_f32 v8, v62, v63
    s_nop 0
    v_mfma_f32_16x16x32_bf16 v[50:53], v[154:157], v[4:7], 0
    v_mfma_f32_16x16x32_bf16 v[50:53], v[8:11], v[4:7], v[50:53]
    v_mfma_f32_16x16x32_bf16 v[24:27], v[154:157], v[82:85], 0
    v_mfma_f32_16x16x32_bf16 v[28:31], v[154:157], v[86:89], 0
    v_mfma_f32_16x16x32_bf16 v[32:35], v[154:157], v[90:93], 0
    v_mfma_f32_16x16x32_bf16 v[36:39], v[154:157], v[94:97], 0
arq_24_vs:
    s_waitcnt vmcnt(0)
    v_max3_u32 v3, v66, v67, v68
    v_max3_u32 v3, v3, v69, v70
    v_max3_u32 v3, v3, v71, v72
    v_max_u32 v3, v3, v73
    v_cmp_eq_u32 vcc, -1, v3
    s_cbranch_vccnz arq_24_vsr
    s_branch arq_24_vsok
arq_24_vsr:
    s_sub_u32 s26, s26, 1
    s_cbranch_scc1 arq_24_vsg
    buffer_load_dwordx4 v[66:69], v0, s[4:7], s22 offen offset:0 sc1
    buffer_load_dwordx4 v[70:73], v0, s[4:7], s22 offen offset:1024 sc1
    s_branch arq_24_vs
arq_24_vsg:
    s_mov_b32 s26, 0
arq_24_vsok:
    v_smfmac_f32_16x16x64_bf16 v[74:77], v[66:69], v[192:199], v41
    v_smfmac_f32_16x16x64_bf16 v[78:81], v[66:69], v[200:207], v41
    v_smfmac_f32_16x16x64_bf16 v[146:149], v[66:69], v[208:215], v41
    v_smfmac_f32_16x16x64_bf16 v[150:153], v[66:69], v[216:223], v41
    v_smfmac_f32_16x16x64_bf16 v[74:77], v[70:73], v[224:231], v41
    v_smfmac_f32_16x16x64_bf16 v[78:81], v[70:73], v[232:239], v41
    v_smfmac_f32_16x16x64_bf16 v[146:149], v[70:73], v[240:247], v41
    v_smfmac_f32_16x16x64_bf16 v[150:153], v[70:73], v[248:255], v41
    v_rcp_f32 v52, v52
    v_rcp_f32 v53, v53
    s_nop 2
    v_add_f32 v74, v74, v75
    v_add_f32 v76, v76, v77
    v_cvt_pk_bf16_f32 v40, v74, v76
    v_add_f32 v78, v78, v79
    v_add_f32 v80, v80, v81
    v_cvt_pk_bf16_f32 v42, v78, v80
    v_add_f32 v146, v146, v147
    v_add_f32 v148, v148, v149
    v_cvt_pk_bf16_f32 v44, v146, v148
    v_add_f32 v150, v150, v151
    v_add_f32 v152, v152, v153
    v_cvt_pk_bf16_f32 v46, v150, v152
    s_nop 1
    v_mfma_f32_16x16x32_bf16 v[24:27], v[8:11], v[40:43], v[24:27]
    v_mfma_f32_16x16x32_bf16 v[28:31], v[8:11], v[42:45], v[28:31]
    v_mfma_f32_16x16x32_bf16 v[32:35], v[8:11], v[44:47], v[32:35]
    v_mfma_f32_16x16x32_bf16 v[36:39], v[8:11], v[46:49], v[36:39]
    s_nop 4
    v_mul_f32 v26, v26, v52
    v_mul_f32 v27, v27, v53
    v_mul_f32 v30, v30, v52
    v_mul_f32 v31, v31, v53
    s_branch aloop_23_pvd
aloop_23_tm:
    s_nop 7
    v_max3_f32 v2, v12, v13, v14
    v_max3_f32 v3, v15, v16, v17
    v_max3_f32 v2, v2, v18, v19
    v_max3_f32 v3, v3, v20, v21
    v_max_f32 v2, v2, v3
    v_mov_b32 v3, v2
    s_nop 1
    v_permlane16_swap_b32 v3, v2
    v_max_f32 v2, v2, v3
    v_mov_b32 v3, v2
    s_nop 1
    v_permlane32_swap_b32 v3, v2
    v_max_f32 v2, v2, v3
    v_sub_f32 v12, v12, v2
    v_sub_f32 v13, v13, v2
    v_sub_f32 v14, v14, v2
    v_sub_f32 v15, v15, v2
    v_sub_f32 v16, v16, v2
    v_sub_f32 v17, v17, v2
    v_sub_f32 v18, v18, v2
    v_sub_f32 v19, v19, v2
    v_sub_f32 v20, v20, v2
    v_sub_f32 v21, v21, v2
    v_exp_f32 v54, v12
    v_exp_f32 v55, v13
    v_exp_f32 v56, v14
    v_exp_f32 v57, v15
    v_exp_f32 v58, v16
    v_exp_f32 v59, v17
    v_exp_f32 v60, v18
    v_exp_f32 v61, v19
    v_exp_f32 v62, v20
    v_exp_f32 v63, v21
    s_nop 0
    v_cvt_pk_bf16_f32 v154, v54, v55
    v_cvt_pk_bf16_f32 v155, v56, v57
    v_cvt_pk_bf16_f32 v156, v58, v59
    v_cvt_pk_bf16_f32 v157, v60, v61
    v_cvt_pk_bf16_f32 v8, v62, v63
    s_nop 0
    v_mfma_f32_16x16x32_bf16 v[50:53], v[154:157], v[4:7], 0
    v_mfma_f32_16x16x32_bf16 v[50:53], v[8:11], v[4:7], v[50:53]
    v_mfma_f32_16x16x32_bf16 v[24:27], v[154:157], v[82:85], 0
    v_mfma_f32_16x16x32_bf16 v[28:31], v[154:157], v[86:89], 0
    v_mfma_f32_16x16x32_bf16 v[32:35], v[154:157], v[90:93], 0
    v_mfma_f32_16x16x32_bf16 v[36:39], v[154:157], v[94:97], 0
    v_mfma_f32_16x16x32_bf16 v[24:27], v[8:11], v[40:43], v[24:27]
    v_mfma_f32_16x16x32_bf16 v[28:31], v[8:11], v[42:45], v[28:31]
    v_mfma_f32_16x16x32_bf16 v[32:35], v[8:11], v[44:47], v[32:35]
    v_mfma_f32_16x16x32_bf16 v[36:39], v[8:11], v[46:49], v[36:39]
    v_rcp_f32 v52, v52
    v_rcp_f32 v53, v53
    s_nop 4
    v_mul_f32 v26, v26, v52
    v_mul_f32 v27, v27, v53
    v_mul_f32 v30, v30, v52
    v_mul_f32 v31, v31, v53
    s_branch aloop_23_pvd
aloop_23_lsk:
arq_24_vl:
    s_waitcnt vmcnt(0)
    v_max3_u32 v3, v66, v67, v68
    v_max3_u32 v3, v3, v69, v70
    v_max3_u32 v3, v3, v71, v72
    v_max_u32 v3, v3, v73
    v_cmp_eq_u32 vcc, -1, v3
    s_cbranch_vccnz arq_24_vlr
    s_branch arq_24_vlok
arq_24_vlr:
    s_sub_u32 s26, s26, 1
    s_cbranch_scc1 arq_24_vlg
    buffer_load_dwordx4 v[66:69], v0, s[4:7], s22 offen offset:0 sc1
    buffer_load_dwordx4 v[70:73], v0, s[4:7], s22 offen offset:1024 sc1
    s_branch arq_24_vl
arq_24_vlg:
    s_mov_b32 s26, 0
arq_24_vlok:
    v_smfmac_f32_16x16x64_bf16 v[74:77], v[66:69], v[192:199], v41
    v_smfmac_f32_16x16x64_bf16 v[78:81], v[66:69], v[200:207], v41
    v_smfmac_f32_16x16x64_bf16 v[146:149], v[66:69], v[208:215], v41
    v_smfmac_f32_16x16x64_bf16 v[150:153], v[66:69], v[216:223], v41
    v_smfmac_f32_16x16x64_bf16 v[74:77], v[70:73], v[224:231], v41
    v_smfmac_f32_16x16x64_bf16 v[78:81], v[70:73], v[232:239], v41
    v_smfmac_f32_16x16x64_bf16 v[146:149], v[70:73], v[240:247], v41
    v_smfmac_f32_16x16x64_bf16 v[150:153], v[70:73], v[248:255], v41
    s_nop 4
    v_add_f32 v74, v74, v75
    v_add_f32 v76, v76, v77
    v_cvt_pk_bf16_f32 v40, v74, v76
    v_add_f32 v78, v78, v79
    v_add_f32 v80, v80, v81
    v_cvt_pk_bf16_f32 v42, v78, v80
    v_add_f32 v146, v146, v147
    v_add_f32 v148, v148, v149
    v_cvt_pk_bf16_f32 v44, v146, v148
    v_add_f32 v150, v150, v151
    v_add_f32 v152, v152, v153
    v_cvt_pk_bf16_f32 v46, v150, v152
    s_branch aloop_23_lskb
arq_24_ps:
    s_sub_u32 s26, s26, 1
    s_cbranch_scc1 arq_24_psg
    s_sleep 2
    buffer_load_dwordx4 v[130:133], v0, s[4:7], s21 offen sc1
    buffer_load_dwordx2 v[146:147], v2, s[4:7], s21 offen offset:1024 sc1
    buffer_load_dwordx4 v[134:137], v0, s[4:7], s21 offen offset:2048 sc1
    buffer_load_dwordx2 v[148:149], v2, s[4:7], s21 offen offset:3072 sc1
    s_branch aloop_23_psa
arq_24_psg:
    s_mov_b32 s26, 0
    s_branch aloop_23_psok
aloop_23_fin:
    s_barrier
    s_branch k_end
k_end:
k_exit:
    s_endpgm
.section .rodata,"a"
.p2align 6
jobtab:
    .long 6, 24, 24, 8192, 0, 262144, 8388608, 0, 32768, 4, 20971520, 131072, 0, 0, 218104320, 1
    .long 4, 24, 24, 8192, 0, 262144, 8388608, 262144, 32768, 4, 22020096, 131072, 0, 0, 218104448, 1
    .long 1, 32, 32, 8192, 0, 256, 8388608, 1048576, 32768, 8, 41943040, 131072, 0, 0, 218104832, 4
    .long 1, 16, 16, 8192, 0, 256, 8388608, 2097152, 32768, 8, 12582912, 131072, 0, 0, 218105344, 4
    .long 1, 32, 32, 8192, 0, 256, 8388608, 3145728, 32768, 8, 50331648, 131072, 0, 0, 218105856, 4
    .long 1, 32, 32, 8192, 0, 256, 8388608, 3670016, 32768, 8, 52428800, 131072, 0, 0, 218106112, 4
    .long 1, 80, 80, 2048, 0, 256, 7340032, 54525952, 114688, 7, 167772160, 32768, 218103808, 7, 218106368, 1
    .long 0, 0, 0, 0, 0, 0, 0, 0, 0, 0, 0, 0, 0, 0, 0, 0
    .long 0, 0, 0, 0, 0, 0, 0, 0, 0, 0, 0, 0, 0, 0, 0, 0
    .long 0, 0, 0, 0, 0, 0, 0, 0, 0, 0, 0, 0, 0, 0, 0, 0
    .long 6, 24, 24, 8192, 2048, 264192, 8388608, 0, 32768, 4, 21004288, 131072, 0, 0, 218104352, 1
    .long 4, 24, 24, 8192, 2048, 264192, 8388608, 262144, 32768, 4, 22052864, 131072, 0, 0, 218104480, 1
    .long 1, 32, 32, 8192, 2048, 2304, 8388608, 1048576, 32768, 8, 41975808, 131072, 0, 0, 218104864, 4
    .long 1, 16, 16, 8192, 2048, 2304, 8388608, 2097152, 32768, 8, 12615680, 131072, 0, 0, 218105376, 4
    .long 1, 32, 32, 8192, 2048, 2304, 8388608, 3145728, 32768, 8, 50364416, 131072, 0, 0, 218105888, 4
    .long 1, 32, 32, 8192, 2048, 2304, 8388608, 3670016, 32768, 8, 52461568, 131072, 0, 0, 218106144, 4
    .long 1, 80, 80, 2048, 1835008, 1835264, 7340032, 54554624, 114688, 7, 171966464, 32768, 218103824, 7, 218106368, 1
    .long 0, 0, 0, 0, 0, 0, 0, 0, 0, 0, 0, 0, 0, 0, 0, 0
    .long 0, 0, 0, 0, 0, 0, 0, 0, 0, 0, 0, 0, 0, 0, 0, 0
    .long 0, 0, 0, 0, 0, 0, 0, 0, 0, 0, 0, 0, 0, 0, 0, 0
    .long 6, 24, 24, 8192, 4096, 266240, 8388608, 0, 32768, 4, 21037056, 131072, 0, 0, 218104384, 1
    .long 4, 24, 24, 8192, 4096, 266240, 8388608, 262144, 32768, 4, 22085632, 131072, 0, 0, 218104512, 1
    .long 1, 32, 32, 8192, 4096, 4352, 8388608, 1048576, 32768, 8, 42008576, 131072, 0, 0, 218104896, 4
    .long 1, 16, 16, 8192, 4096, 4352, 8388608, 2097152, 32768, 8, 12648448, 131072, 0, 0, 218105408, 4
    .long 1, 32, 32, 8192, 4096, 4352, 8388608, 3145728, 32768, 8, 50397184, 131072, 0, 0, 218105920, 4
    .long 1, 32, 32, 8192, 4096, 4352, 8388608, 3670016, 32768, 8, 52494336, 131072, 0, 0, 218106176, 4
    .long 1, 80, 80, 2048, 3670016, 3670272, 7340032, 54583296, 114688, 7, 176160768, 32768, 218103840, 7, 218106368, 1
    .long 0, 0, 0, 0, 0, 0, 0, 0, 0, 0, 0, 0, 0, 0, 0, 0
    .long 0, 0, 0, 0, 0, 0, 0, 0, 0, 0, 0, 0, 0, 0, 0, 0
    .long 0, 0, 0, 0, 0, 0, 0, 0, 0, 0, 0, 0, 0, 0, 0, 0
    .long 6, 24, 24, 8192, 6144, 268288, 8388608, 0, 32768, 4, 21069824, 131072, 0, 0, 218104416, 1
    .long 4, 24, 24, 8192, 6144, 268288, 8388608, 262144, 32768, 4, 22118400, 131072, 0, 0, 218104544, 1
    .long 1, 32, 32, 8192, 6144, 6400, 8388608, 1048576, 32768, 8, 42041344, 131072, 0, 0, 218104928, 4
    .long 1, 16, 16, 8192, 6144, 6400, 8388608, 2097152, 32768, 8, 12681216, 131072, 0, 0, 218105440, 4
    .long 1, 32, 32, 8192, 6144, 6400, 8388608, 3145728, 32768, 8, 50429952, 131072, 0, 0, 218105952, 4
    .long 1, 32, 32, 8192, 6144, 6400, 8388608, 3670016, 32768, 8, 52527104, 131072, 0, 0, 218106208, 4
    .long 1, 80, 80, 2048, 5505024, 5505280, 7340032, 54611968, 114688, 7, 180355072, 32768, 218103856, 7, 218106368, 1
    .long 0, 0, 0, 0, 0, 0, 0, 0, 0, 0, 0, 0, 0, 0, 0, 0
    .long 0, 0, 0, 0, 0, 0, 0, 0, 0, 0, 0, 0, 0, 0, 0, 0
    .long 0, 0, 0, 0, 0, 0, 0, 0, 0, 0, 0, 0, 0, 0, 0, 0
    .long 6, 24, 24, 8192, 256, 262400, 8388608, 0, 32768, 4, 20975616, 131072, 0, 0, 218104320, 1
    .long 4, 24, 24, 8192, 256, 262400, 8388608, 262144, 32768, 4, 22024192, 131072, 0, 0, 218104448, 1
    .long 1, 32, 32, 8192, 512, 768, 8388608, 1048576, 32768, 8, 41951232, 131072, 0, 0, 218104832, 4
    .long 1, 16, 16, 8192, 512, 768, 8388608, 2097152, 32768, 8, 12591104, 131072, 0, 0, 218105344, 4
    .long 1, 32, 32, 8192, 512, 768, 8388608, 3145728, 32768, 8, 50339840, 131072, 0, 0, 218105856, 4
    .long 1, 32, 32, 8192, 512, 768, 8388608, 3670016, 32768, 8, 52436992, 131072, 0, 0, 218106112, 4
    .long 1, 80, 80, 2048, 512, 768, 7340032, 54525952, 114688, 7, 167780352, 32768, 218103808, 7, 218106368, 1
    .long 0, 0, 0, 0, 0, 0, 0, 0, 0, 0, 0, 0, 0, 0, 0, 0
    .long 0, 0, 0, 0, 0, 0, 0, 0, 0, 0, 0, 0, 0, 0, 0, 0
    .long 0, 0, 0, 0, 0, 0, 0, 0, 0, 0, 0, 0, 0, 0, 0, 0
    .long 6, 24, 24, 8192, 2304, 264448, 8388608, 0, 32768, 4, 21008384, 131072, 0, 0, 218104352, 1
    .long 4, 24, 24, 8192, 2304, 264448, 8388608, 262144, 32768, 4, 22056960, 131072, 0, 0, 218104480, 1
    .long 1, 32, 32, 8192, 2560, 2816, 8388608, 1048576, 32768, 8, 41984000, 131072, 0, 0, 218104864, 4
    .long 1, 16, 16, 8192, 2560, 2816, 8388608, 2097152, 32768, 8, 12623872, 131072, 0, 0, 218105376, 4
    .long 1, 32, 32, 8192, 2560, 2816, 8388608, 3145728, 32768, 8, 50372608, 131072, 0, 0, 218105888, 4
    .long 1, 32, 32, 8192, 2560, 2816, 8388608, 3670016, 32768, 8, 52469760, 131072, 0, 0, 218106144, 4
    .long 1, 80, 80, 2048, 1835520, 1835776, 7340032, 54554624, 114688, 7, 171974656, 32768, 218103824, 7, 218106368, 1
    .long 0, 0, 0, 0, 0, 0, 0, 0, 0, 0, 0, 0, 0, 0, 0, 0
    .long 0, 0, 0, 0, 0, 0, 0, 0, 0, 0, 0, 0, 0, 0, 0, 0
    .long 0, 0, 0, 0, 0, 0, 0, 0, 0, 0, 0, 0, 0, 0, 0, 0
    .long 6, 24, 24, 8192, 4352, 266496, 8388608, 0, 32768, 4, 21041152, 131072, 0, 0, 218104384, 1
    .long 4, 24, 24, 8192, 4352, 266496, 8388608, 262144, 32768, 4, 22089728, 131072, 0, 0, 218104512, 1
    .long 1, 32, 32, 8192, 4608, 4864, 8388608, 1048576, 32768, 8, 42016768, 131072, 0, 0, 218104896, 4
    .long 1, 16, 16, 8192, 4608, 4864, 8388608, 2097152, 32768, 8, 12656640, 131072, 0, 0, 218105408, 4
    .long 1, 32, 32, 8192, 4608, 4864, 8388608, 3145728, 32768, 8, 50405376, 131072, 0, 0, 218105920, 4
    .long 1, 32, 32, 8192, 4608, 4864, 8388608, 3670016, 32768, 8, 52502528, 131072, 0, 0, 218106176, 4
    .long 1, 80, 80, 2048, 3670528, 3670784, 7340032, 54583296, 114688, 7, 176168960, 32768, 218103840, 7, 218106368, 1
    .long 0, 0, 0, 0, 0, 0, 0, 0, 0, 0, 0, 0, 0, 0, 0, 0
    .long 0, 0, 0, 0, 0, 0, 0, 0, 0, 0, 0, 0, 0, 0, 0, 0
    .long 0, 0, 0, 0, 0, 0, 0, 0, 0, 0, 0, 0, 0, 0, 0, 0
    .long 6, 24, 24, 8192, 6400, 268544, 8388608, 0, 32768, 4, 21073920, 131072, 0, 0, 218104416, 1
    .long 4, 24, 24, 8192, 6400, 268544, 8388608, 262144, 32768, 4, 22122496, 131072, 0, 0, 218104544, 1
    .long 1, 32, 32, 8192, 6656, 6912, 8388608, 1048576, 32768, 8, 42049536, 131072, 0, 0, 218104928, 4
    .long 1, 16, 16, 8192, 6656, 6912, 8388608, 2097152, 32768, 8, 12689408, 131072, 0, 0, 218105440, 4
    .long 1, 32, 32, 8192, 6656, 6912, 8388608, 3145728, 32768, 8, 50438144, 131072, 0, 0, 218105952, 4
    .long 1, 32, 32, 8192, 6656, 6912, 8388608, 3670016, 32768, 8, 52535296, 131072, 0, 0, 218106208, 4
    .long 1, 80, 80, 2048, 5505536, 5505792, 7340032, 54611968, 114688, 7, 180363264, 32768, 218103856, 7, 218106368, 1
    .long 0, 0, 0, 0, 0, 0, 0, 0, 0, 0, 0, 0, 0, 0, 0, 0
    .long 0, 0, 0, 0, 0, 0, 0, 0, 0, 0, 0, 0, 0, 0, 0, 0
    .long 0, 0, 0, 0, 0, 0, 0, 0, 0, 0, 0, 0, 0, 0, 0, 0
    .long 6, 24, 24, 8192, 512, 262656, 8388608, 0, 32768, 4, 20979712, 131072, 0, 0, 218104320, 1
    .long 4, 24, 24, 8192, 512, 262656, 8388608, 262144, 32768, 4, 22028288, 131072, 0, 0, 218104448, 1
    .long 1, 32, 32, 8192, 1024, 1280, 8388608, 1048576, 32768, 8, 41959424, 131072, 0, 0, 218104848, 4
    .long 1, 16, 16, 8192, 1024, 1280, 8388608, 2097152, 32768, 8, 12599296, 131072, 0, 0, 218105360, 4
    .long 1, 32, 32, 8192, 1024, 1280, 8388608, 3145728, 32768, 8, 50348032, 131072, 0, 0, 218105872, 4
    .long 1, 32, 32, 8192, 1024, 1280, 8388608, 3670016, 32768, 8, 52445184, 131072, 0, 0, 218106128, 4
    .long 1, 80, 80, 2048, 1024, 1280, 7340032, 54525952, 114688, 7, 167788544, 32768, 218103808, 7, 218106368, 1
    .long 0, 0, 0, 0, 0, 0, 0, 0, 0, 0, 0, 0, 0, 0, 0, 0
    .long 0, 0, 0, 0, 0, 0, 0, 0, 0, 0, 0, 0, 0, 0, 0, 0
    .long 0, 0, 0, 0, 0, 0, 0, 0, 0, 0, 0, 0, 0, 0, 0, 0
    .long 6, 24, 24, 8192, 2560, 264704, 8388608, 0, 32768, 4, 21012480, 131072, 0, 0, 218104352, 1
    .long 4, 24, 24, 8192, 2560, 264704, 8388608, 262144, 32768, 4, 22061056, 131072, 0, 0, 218104480, 1
    .long 1, 32, 32, 8192, 3072, 3328, 8388608, 1048576, 32768, 8, 41992192, 131072, 0, 0, 218104880, 4
    .long 1, 16, 16, 8192, 3072, 3328, 8388608, 2097152, 32768, 8, 12632064, 131072, 0, 0, 218105392, 4
    .long 1, 32, 32, 8192, 3072, 3328, 8388608, 3145728, 32768, 8, 50380800, 131072, 0, 0, 218105904, 4
    .long 1, 32, 32, 8192, 3072, 3328, 8388608, 3670016, 32768, 8, 52477952, 131072, 0, 0, 218106160, 4
    .long 1, 80, 80, 2048, 1836032, 1836288, 7340032, 54554624, 114688, 7, 171982848, 32768, 218103824, 7, 218106368, 1
    .long 0, 0, 0, 0, 0, 0, 0, 0, 0, 0, 0, 0, 0, 0, 0, 0
    .long 0, 0, 0, 0, 0, 0, 0, 0, 0, 0, 0, 0, 0, 0, 0, 0
    .long 0, 0, 0, 0, 0, 0, 0, 0, 0, 0, 0, 0, 0, 0, 0, 0
    .long 6, 24, 24, 8192, 4608, 266752, 8388608, 0, 32768, 4, 21045248, 131072, 0, 0, 218104384, 1
    .long 4, 24, 24, 8192, 4608, 266752, 8388608, 262144, 32768, 4, 22093824, 131072, 0, 0, 218104512, 1
    .long 1, 32, 32, 8192, 5120, 5376, 8388608, 1048576, 32768, 8, 42024960, 131072, 0, 0, 218104912, 4
    .long 1, 16, 16, 8192, 5120, 5376, 8388608, 2097152, 32768, 8, 12664832, 131072, 0, 0, 218105424, 4
    .long 1, 32, 32, 8192, 5120, 5376, 8388608, 3145728, 32768, 8, 50413568, 131072, 0, 0, 218105936, 4
    .long 1, 32, 32, 8192, 5120, 5376, 8388608, 3670016, 32768, 8, 52510720, 131072, 0, 0, 218106192, 4
    .long 1, 80, 80, 2048, 3671040, 3671296, 7340032, 54583296, 114688, 7, 176177152, 32768, 218103840, 7, 218106368, 1
    .long 0, 0, 0, 0, 0, 0, 0, 0, 0, 0, 0, 0, 0, 0, 0, 0
    .long 0, 0, 0, 0, 0, 0, 0, 0, 0, 0, 0, 0, 0, 0, 0, 0
    .long 0, 0, 0, 0, 0, 0, 0, 0, 0, 0, 0, 0, 0, 0, 0, 0
    .long 6, 24, 24, 8192, 6656, 268800, 8388608, 0, 32768, 4, 21078016, 131072, 0, 0, 218104416, 1
    .long 4, 24, 24, 8192, 6656, 268800, 8388608, 262144, 32768, 4, 22126592, 131072, 0, 0, 218104544, 1
    .long 1, 32, 32, 8192, 7168, 7424, 8388608, 1048576, 32768, 8, 42057728, 131072, 0, 0, 218104944, 4
    .long 1, 16, 16, 8192, 7168, 7424, 8388608, 2097152, 32768, 8, 12697600, 131072, 0, 0, 218105456, 4
    .long 1, 32, 32, 8192, 7168, 7424, 8388608, 3145728, 32768, 8, 50446336, 131072, 0, 0, 218105968, 4
    .long 1, 32, 32, 8192, 7168, 7424, 8388608, 3670016, 32768, 8, 52543488, 131072, 0, 0, 218106224, 4
    .long 1, 80, 80, 2048, 5506048, 5506304, 7340032, 54611968, 114688, 7, 180371456, 32768, 218103856, 7, 218106368, 1
    .long 0, 0, 0, 0, 0, 0, 0, 0, 0, 0, 0, 0, 0, 0, 0, 0
    .long 0, 0, 0, 0, 0, 0, 0, 0, 0, 0, 0, 0, 0, 0, 0, 0
    .long 0, 0, 0, 0, 0, 0, 0, 0, 0, 0, 0, 0, 0, 0, 0, 0
    .long 6, 24, 24, 8192, 768, 262912, 8388608, 0, 32768, 4, 20983808, 131072, 0, 0, 218104320, 1
    .long 4, 24, 24, 8192, 768, 262912, 8388608, 262144, 32768, 4, 22032384, 131072, 0, 0, 218104448, 1
    .long 1, 32, 32, 8192, 1536, 1792, 8388608, 1048576, 32768, 8, 41967616, 131072, 0, 0, 218104848, 4
    .long 1, 16, 16, 8192, 1536, 1792, 8388608, 2097152, 32768, 8, 12607488, 131072, 0, 0, 218105360, 4
    .long 1, 32, 32, 8192, 1536, 1792, 8388608, 3145728, 32768, 8, 50356224, 131072, 0, 0, 218105872, 4
    .long 1, 32, 32, 8192, 1536, 1792, 8388608, 3670016, 32768, 8, 52453376, 131072, 0, 0, 218106128, 4
    .long 1, 80, 80, 2048, 1536, 1792, 7340032, 54525952, 114688, 7, 167796736, 32768, 218103808, 7, 218106368, 1
    .long 0, 0, 0, 0, 0, 0, 0, 0, 0, 0, 0, 0, 0, 0, 0, 0
    .long 0, 0, 0, 0, 0, 0, 0, 0, 0, 0, 0, 0, 0, 0, 0, 0
    .long 0, 0, 0, 0, 0, 0, 0, 0, 0, 0, 0, 0, 0, 0, 0, 0
    .long 6, 24, 24, 8192, 2816, 264960, 8388608, 0, 32768, 4, 21016576, 131072, 0, 0, 218104352, 1
    .long 4, 24, 24, 8192, 2816, 264960, 8388608, 262144, 32768, 4, 22065152, 131072, 0, 0, 218104480, 1
    .long 1, 32, 32, 8192, 3584, 3840, 8388608, 1048576, 32768, 8, 42000384, 131072, 0, 0, 218104880, 4
    .long 1, 16, 16, 8192, 3584, 3840, 8388608, 2097152, 32768, 8, 12640256, 131072, 0, 0, 218105392, 4
    .long 1, 32, 32, 8192, 3584, 3840, 8388608, 3145728, 32768, 8, 50388992, 131072, 0, 0, 218105904, 4
    .long 1, 32, 32, 8192, 3584, 3840, 8388608, 3670016, 32768, 8, 52486144, 131072, 0, 0, 218106160, 4
    .long 1, 80, 80, 2048, 1836544, 1836800, 7340032, 54554624, 114688, 7, 171991040, 32768, 218103824, 7, 218106368, 1
    .long 0, 0, 0, 0, 0, 0, 0, 0, 0, 0, 0, 0, 0, 0, 0, 0
    .long 0, 0, 0, 0, 0, 0, 0, 0, 0, 0, 0, 0, 0, 0, 0, 0
    .long 0, 0, 0, 0, 0, 0, 0, 0, 0, 0, 0, 0, 0, 0, 0, 0
    .long 6, 24, 24, 8192, 4864, 267008, 8388608, 0, 32768, 4, 21049344, 131072, 0, 0, 218104384, 1
    .long 4, 24, 24, 8192, 4864, 267008, 8388608, 262144, 32768, 4, 22097920, 131072, 0, 0, 218104512, 1
    .long 1, 32, 32, 8192, 5632, 5888, 8388608, 1048576, 32768, 8, 42033152, 131072, 0, 0, 218104912, 4
    .long 1, 16, 16, 8192, 5632, 5888, 8388608, 2097152, 32768, 8, 12673024, 131072, 0, 0, 218105424, 4
    .long 1, 32, 32, 8192, 5632, 5888, 8388608, 3145728, 32768, 8, 50421760, 131072, 0, 0, 218105936, 4
    .long 1, 32, 32, 8192, 5632, 5888, 8388608, 3670016, 32768, 8, 52518912, 131072, 0, 0, 218106192, 4
    .long 1, 80, 80, 2048, 3671552, 3671808, 7340032, 54583296, 114688, 7, 176185344, 32768, 218103840, 7, 218106368, 1
    .long 0, 0, 0, 0, 0, 0, 0, 0, 0, 0, 0, 0, 0, 0, 0, 0
    .long 0, 0, 0, 0, 0, 0, 0, 0, 0, 0, 0, 0, 0, 0, 0, 0
    .long 0, 0, 0, 0, 0, 0, 0, 0, 0, 0, 0, 0, 0, 0, 0, 0
    .long 6, 24, 24, 8192, 6912, 269056, 8388608, 0, 32768, 4, 21082112, 131072, 0, 0, 218104416, 1
    .long 4, 24, 24, 8192, 6912, 269056, 8388608, 262144, 32768, 4, 22130688, 131072, 0, 0, 218104544, 1
    .long 1, 32, 32, 8192, 7680, 7936, 8388608, 1048576, 32768, 8, 42065920, 131072, 0, 0, 218104944, 4
    .long 1, 16, 16, 8192, 7680, 7936, 8388608, 2097152, 32768, 8, 12705792, 131072, 0, 0, 218105456, 4
    .long 1, 32, 32, 8192, 7680, 7936, 8388608, 3145728, 32768, 8, 50454528, 131072, 0, 0, 218105968, 4
    .long 1, 32, 32, 8192, 7680, 7936, 8388608, 3670016, 32768, 8, 52551680, 131072, 0, 0, 218106224, 4
    .long 1, 80, 80, 2048, 5506560, 5506816, 7340032, 54611968, 114688, 7, 180379648, 32768, 218103856, 7, 218106368, 1
    .long 0, 0, 0, 0, 0, 0, 0, 0, 0, 0, 0, 0, 0, 0, 0, 0
    .long 0, 0, 0, 0, 0, 0, 0, 0, 0, 0, 0, 0, 0, 0, 0, 0
    .long 0, 0, 0, 0, 0, 0, 0, 0, 0, 0, 0, 0, 0, 0, 0, 0
    .long 6, 24, 24, 8192, 1024, 263168, 8388608, 0, 32768, 4, 20987904, 131072, 0, 0, 218104336, 1
    .long 4, 24, 24, 8192, 1024, 263168, 8388608, 262144, 32768, 4, 22036480, 131072, 0, 0, 218104464, 1
    .long 1, 24, 24, 8192, 0, 256, 8388608, 1048576, 32768, 8, 25165824, 131072, 0, 0, 218104832, 4
    .long 1, 32, 32, 8192, 0, 256, 8388608, 2621440, 32768, 8, 48234496, 131072, 0, 0, 218105600, 4
    .long 1, 24, 24, 8192, 0, 256, 8388608, 3145728, 32768, 8, 33554432, 131072, 0, 0, 218105856, 4
    .long 1, 24, 24, 8192, 0, 256, 8388608, 3670016, 32768, 8, 35651584, 131072, 0, 0, 218106112, 4
    .long 1, 80, 80, 2048, 0, 256, 7340032, 56360960, 114688, 7, 168296448, 32768, 218103872, 7, 218106432, 1
    .long 0, 0, 0, 0, 0, 0, 0, 0, 0, 0, 0, 0, 0, 0, 0, 0
    .long 0, 0, 0, 0, 0, 0, 0, 0, 0, 0, 0, 0, 0, 0, 0, 0
    .long 0, 0, 0, 0, 0, 0, 0, 0, 0, 0, 0, 0, 0, 0, 0, 0
    .long 6, 24, 24, 8192, 3072, 265216, 8388608, 0, 32768, 4, 21020672, 131072, 0, 0, 218104368, 1
    .long 4, 24, 24, 8192, 3072, 265216, 8388608, 262144, 32768, 4, 22069248, 131072, 0, 0, 218104496, 1
    .long 1, 24, 24, 8192, 2048, 2304, 8388608, 1048576, 32768, 8, 25198592, 131072, 0, 0, 218104864, 4
    .long 1, 32, 32, 8192, 2048, 2304, 8388608, 2621440, 32768, 8, 48267264, 131072, 0, 0, 218105632, 4
    .long 1, 24, 24, 8192, 2048, 2304, 8388608, 3145728, 32768, 8, 33587200, 131072, 0, 0, 218105888, 4
    .long 1, 24, 24, 8192, 2048, 2304, 8388608, 3670016, 32768, 8, 35684352, 131072, 0, 0, 218106144, 4
    .long 1, 80, 80, 2048, 1835008, 1835264, 7340032, 56389632, 114688, 7, 172490752, 32768, 218103888, 7, 218106432, 1
    .long 0, 0, 0, 0, 0, 0, 0, 0, 0, 0, 0, 0, 0, 0, 0, 0
    .long 0, 0, 0, 0, 0, 0, 0, 0, 0, 0, 0, 0, 0, 0, 0, 0
    .long 0, 0, 0, 0, 0, 0, 0, 0, 0, 0, 0, 0, 0, 0, 0, 0
    .long 6, 24, 24, 8192, 5120, 267264, 8388608, 0, 32768, 4, 21053440, 131072, 0, 0, 218104400, 1
    .long 4, 24, 24, 8192, 5120, 267264, 8388608, 262144, 32768, 4, 22102016, 131072, 0, 0, 218104528, 1
    .long 1, 24, 24, 8192, 4096, 4352, 8388608, 1048576, 32768, 8, 25231360, 131072, 0, 0, 218104896, 4
    .long 1, 32, 32, 8192, 4096, 4352, 8388608, 2621440, 32768, 8, 48300032, 131072, 0, 0, 218105664, 4
    .long 1, 24, 24, 8192, 4096, 4352, 8388608, 3145728, 32768, 8, 33619968, 131072, 0, 0, 218105920, 4
    .long 1, 24, 24, 8192, 4096, 4352, 8388608, 3670016, 32768, 8, 35717120, 131072, 0, 0, 218106176, 4
    .long 1, 80, 80, 2048, 3670016, 3670272, 7340032, 56418304, 114688, 7, 176685056, 32768, 218103904, 7, 218106432, 1
    .long 0, 0, 0, 0, 0, 0, 0, 0, 0, 0, 0, 0, 0, 0, 0, 0
    .long 0, 0, 0, 0, 0, 0, 0, 0, 0, 0, 0, 0, 0, 0, 0, 0
    .long 0, 0, 0, 0, 0, 0, 0, 0, 0, 0, 0, 0, 0, 0, 0, 0
    .long 6, 24, 24, 8192, 7168, 269312, 8388608, 0, 32768, 4, 21086208, 131072, 0, 0, 218104432, 1
    .long 4, 24, 24, 8192, 7168, 269312, 8388608, 262144, 32768, 4, 22134784, 131072, 0, 0, 218104560, 1
    .long 1, 24, 24, 8192, 6144, 6400, 8388608, 1048576, 32768, 8, 25264128, 131072, 0, 0, 218104928, 4
    .long 1, 32, 32, 8192, 6144, 6400, 8388608, 2621440, 32768, 8, 48332800, 131072, 0, 0, 218105696, 4
    .long 1, 24, 24, 8192, 6144, 6400, 8388608, 3145728, 32768, 8, 33652736, 131072, 0, 0, 218105952, 4
    .long 1, 24, 24, 8192, 6144, 6400, 8388608, 3670016, 32768, 8, 35749888, 131072, 0, 0, 218106208, 4
    .long 1, 80, 80, 2048, 5505024, 5505280, 7340032, 56446976, 114688, 7, 180879360, 32768, 218103920, 7, 218106432, 1
    .long 0, 0, 0, 0, 0, 0, 0, 0, 0, 0, 0, 0, 0, 0, 0, 0
    .long 0, 0, 0, 0, 0, 0, 0, 0, 0, 0, 0, 0, 0, 0, 0, 0
    .long 0, 0, 0, 0, 0, 0, 0, 0, 0, 0, 0, 0, 0, 0, 0, 0
    .long 6, 24, 24, 8192, 1280, 263424, 8388608, 0, 32768, 4, 20992000, 131072, 0, 0, 218104336, 1
    .long 4, 24, 24, 8192, 1280, 263424, 8388608, 262144, 32768, 4, 22040576, 131072, 0, 0, 218104464, 1
    .long 1, 24, 24, 8192, 512, 768, 8388608, 1048576, 32768, 8, 25174016, 131072, 0, 0, 218104832, 4
    .long 1, 32, 32, 8192, 512, 768, 8388608, 2621440, 32768, 8, 48242688, 131072, 0, 0, 218105600, 4
    .long 1, 24, 24, 8192, 512, 768, 8388608, 3145728, 32768, 8, 33562624, 131072, 0, 0, 218105856, 4
    .long 1, 24, 24, 8192, 512, 768, 8388608, 3670016, 32768, 8, 35659776, 131072, 0, 0, 218106112, 4
    .long 1, 80, 80, 2048, 512, 768, 7340032, 56360960, 114688, 7, 168304640, 32768, 218103872, 7, 218106432, 1
    .long 0, 0, 0, 0, 0, 0, 0, 0, 0, 0, 0, 0, 0, 0, 0, 0
    .long 0, 0, 0, 0, 0, 0, 0, 0, 0, 0, 0, 0, 0, 0, 0, 0
    .long 0, 0, 0, 0, 0, 0, 0, 0, 0, 0, 0, 0, 0, 0, 0, 0
    .long 6, 24, 24, 8192, 3328, 265472, 8388608, 0, 32768, 4, 21024768, 131072, 0, 0, 218104368, 1
    .long 4, 24, 24, 8192, 3328, 265472, 8388608, 262144, 32768, 4, 22073344, 131072, 0, 0, 218104496, 1
    .long 1, 24, 24, 8192, 2560, 2816, 8388608, 1048576, 32768, 8, 25206784, 131072, 0, 0, 218104864, 4
    .long 1, 32, 32, 8192, 2560, 2816, 8388608, 2621440, 32768, 8, 48275456, 131072, 0, 0, 218105632, 4
    .long 1, 24, 24, 8192, 2560, 2816, 8388608, 3145728, 32768, 8, 33595392, 131072, 0, 0, 218105888, 4
    .long 1, 24, 24, 8192, 2560, 2816, 8388608, 3670016, 32768, 8, 35692544, 131072, 0, 0, 218106144, 4
    .long 1, 80, 80, 2048, 1835520, 1835776, 7340032, 56389632, 114688, 7, 172498944, 32768, 218103888, 7, 218106432, 1
    .long 0, 0, 0, 0, 0, 0, 0, 0, 0, 0, 0, 0, 0, 0, 0, 0
    .long 0, 0, 0, 0, 0, 0, 0, 0, 0, 0, 0, 0, 0, 0, 0, 0
    .long 0, 0, 0, 0, 0, 0, 0, 0, 0, 0, 0, 0, 0, 0, 0, 0
    .long 6, 24, 24, 8192, 5376, 267520, 8388608, 0, 32768, 4, 21057536, 131072, 0, 0, 218104400, 1
    .long 4, 24, 24, 8192, 5376, 267520, 8388608, 262144, 32768, 4, 22106112, 131072, 0, 0, 218104528, 1
    .long 1, 24, 24, 8192, 4608, 4864, 8388608, 1048576, 32768, 8, 25239552, 131072, 0, 0, 218104896, 4
    .long 1, 32, 32, 8192, 4608, 4864, 8388608, 2621440, 32768, 8, 48308224, 131072, 0, 0, 218105664, 4
    .long 1, 24, 24, 8192, 4608, 4864, 8388608, 3145728, 32768, 8, 33628160, 131072, 0, 0, 218105920, 4
    .long 1, 24, 24, 8192, 4608, 4864, 8388608, 3670016, 32768, 8, 35725312, 131072, 0, 0, 218106176, 4
    .long 1, 80, 80, 2048, 3670528, 3670784, 7340032, 56418304, 114688, 7, 176693248, 32768, 218103904, 7, 218106432, 1
    .long 0, 0, 0, 0, 0, 0, 0, 0, 0, 0, 0, 0, 0, 0, 0, 0
    .long 0, 0, 0, 0, 0, 0, 0, 0, 0, 0, 0, 0, 0, 0, 0, 0
    .long 0, 0, 0, 0, 0, 0, 0, 0, 0, 0, 0, 0, 0, 0, 0, 0
    .long 6, 24, 24, 8192, 7424, 269568, 8388608, 0, 32768, 4, 21090304, 131072, 0, 0, 218104432, 1
    .long 4, 24, 24, 8192, 7424, 269568, 8388608, 262144, 32768, 4, 22138880, 131072, 0, 0, 218104560, 1
    .long 1, 24, 24, 8192, 6656, 6912, 8388608, 1048576, 32768, 8, 25272320, 131072, 0, 0, 218104928, 4
    .long 1, 32, 32, 8192, 6656, 6912, 8388608, 2621440, 32768, 8, 48340992, 131072, 0, 0, 218105696, 4
    .long 1, 24, 24, 8192, 6656, 6912, 8388608, 3145728, 32768, 8, 33660928, 131072, 0, 0, 218105952, 4
    .long 1, 24, 24, 8192, 6656, 6912, 8388608, 3670016, 32768, 8, 35758080, 131072, 0, 0, 218106208, 4
    .long 1, 80, 80, 2048, 5505536, 5505792, 7340032, 56446976, 114688, 7, 180887552, 32768, 218103920, 7, 218106432, 1
    .long 0, 0, 0, 0, 0, 0, 0, 0, 0, 0, 0, 0, 0, 0, 0, 0
    .long 0, 0, 0, 0, 0, 0, 0, 0, 0, 0, 0, 0, 0, 0, 0, 0
    .long 0, 0, 0, 0, 0, 0, 0, 0, 0, 0, 0, 0, 0, 0, 0, 0
    .long 6, 24, 24, 8192, 1536, 263680, 8388608, 0, 32768, 4, 20996096, 131072, 0, 0, 218104336, 1
    .long 4, 24, 24, 8192, 1536, 263680, 8388608, 262144, 32768, 4, 22044672, 131072, 0, 0, 218104464, 1
    .long 1, 24, 24, 8192, 1024, 1280, 8388608, 1048576, 32768, 8, 25182208, 131072, 0, 0, 218104848, 4
    .long 1, 32, 32, 8192, 1024, 1280, 8388608, 2621440, 32768, 8, 48250880, 131072, 0, 0, 218105616, 4
    .long 1, 24, 24, 8192, 1024, 1280, 8388608, 3145728, 32768, 8, 33570816, 131072, 0, 0, 218105872, 4
    .long 1, 24, 24, 8192, 1024, 1280, 8388608, 3670016, 32768, 8, 35667968, 131072, 0, 0, 218106128, 4
    .long 1, 80, 80, 2048, 1024, 1280, 7340032, 56360960, 114688, 7, 168312832, 32768, 218103872, 7, 218106432, 1
    .long 0, 0, 0, 0, 0, 0, 0, 0, 0, 0, 0, 0, 0, 0, 0, 0
    .long 0, 0, 0, 0, 0, 0, 0, 0, 0, 0, 0, 0, 0, 0, 0, 0
    .long 0, 0, 0, 0, 0, 0, 0, 0, 0, 0, 0, 0, 0, 0, 0, 0
    .long 6, 24, 24, 8192, 3584, 265728, 8388608, 0, 32768, 4, 21028864, 131072, 0, 0, 218104368, 1
    .long 4, 24, 24, 8192, 3584, 265728, 8388608, 262144, 32768, 4, 22077440, 131072, 0, 0, 218104496, 1
    .long 1, 24, 24, 8192, 3072, 3328, 8388608, 1048576, 32768, 8, 25214976, 131072, 0, 0, 218104880, 4
    .long 1, 32, 32, 8192, 3072, 3328, 8388608, 2621440, 32768, 8, 48283648, 131072, 0, 0, 218105648, 4
    .long 1, 24, 24, 8192, 3072, 3328, 8388608, 3145728, 32768, 8, 33603584, 131072, 0, 0, 218105904, 4
    .long 1, 24, 24, 8192, 3072, 3328, 8388608, 3670016, 32768, 8, 35700736, 131072, 0, 0, 218106160, 4
    .long 1, 80, 80, 2048, 1836032, 1836288, 7340032, 56389632, 114688, 7, 172507136, 32768, 218103888, 7, 218106432, 1
    .long 0, 0, 0, 0, 0, 0, 0, 0, 0, 0, 0, 0, 0, 0, 0, 0
    .long 0, 0, 0, 0, 0, 0, 0, 0, 0, 0, 0, 0, 0, 0, 0, 0
    .long 0, 0, 0, 0, 0, 0, 0, 0, 0, 0, 0, 0, 0, 0, 0, 0
    .long 6, 24, 24, 8192, 5632, 267776, 8388608, 0, 32768, 4, 21061632, 131072, 0, 0, 218104400, 1
    .long 4, 24, 24, 8192, 5632, 267776, 8388608, 262144, 32768, 4, 22110208, 131072, 0, 0, 218104528, 1
    .long 1, 24, 24, 8192, 5120, 5376, 8388608, 1048576, 32768, 8, 25247744, 131072, 0, 0, 218104912, 4
    .long 1, 32, 32, 8192, 5120, 5376, 8388608, 2621440, 32768, 8, 48316416, 131072, 0, 0, 218105680, 4
    .long 1, 24, 24, 8192, 5120, 5376, 8388608, 3145728, 32768, 8, 33636352, 131072, 0, 0, 218105936, 4
    .long 1, 24, 24, 8192, 5120, 5376, 8388608, 3670016, 32768, 8, 35733504, 131072, 0, 0, 218106192, 4
    .long 1, 80, 80, 2048, 3671040, 3671296, 7340032, 56418304, 114688, 7, 176701440, 32768, 218103904, 7, 218106432, 1
    .long 0, 0, 0, 0, 0, 0, 0, 0, 0, 0, 0, 0, 0, 0, 0, 0
    .long 0, 0, 0, 0, 0, 0, 0, 0, 0, 0, 0, 0, 0, 0, 0, 0
    .long 0, 0, 0, 0, 0, 0, 0, 0, 0, 0, 0, 0, 0, 0, 0, 0
    .long 6, 24, 24, 8192, 7680, 269824, 8388608, 0, 32768, 4, 21094400, 131072, 0, 0, 218104432, 1
    .long 4, 24, 24, 8192, 7680, 269824, 8388608, 262144, 32768, 4, 22142976, 131072, 0, 0, 218104560, 1
    .long 1, 24, 24, 8192, 7168, 7424, 8388608, 1048576, 32768, 8, 25280512, 131072, 0, 0, 218104944, 4
    .long 1, 32, 32, 8192, 7168, 7424, 8388608, 2621440, 32768, 8, 48349184, 131072, 0, 0, 218105712, 4
    .long 1, 24, 24, 8192, 7168, 7424, 8388608, 3145728, 32768, 8, 33669120, 131072, 0, 0, 218105968, 4
    .long 1, 24, 24, 8192, 7168, 7424, 8388608, 3670016, 32768, 8, 35766272, 131072, 0, 0, 218106224, 4
    .long 1, 80, 80, 2048, 5506048, 5506304, 7340032, 56446976, 114688, 7, 180895744, 32768, 218103920, 7, 218106432, 1
    .long 0, 0, 0, 0, 0, 0, 0, 0, 0, 0, 0, 0, 0, 0, 0, 0
    .long 0, 0, 0, 0, 0, 0, 0, 0, 0, 0, 0, 0, 0, 0, 0, 0
    .long 0, 0, 0, 0, 0, 0, 0, 0, 0, 0, 0, 0, 0, 0, 0, 0
    .long 6, 24, 24, 8192, 1792, 263936, 8388608, 0, 32768, 4, 21000192, 131072, 0, 0, 218104336, 1
    .long 4, 24, 24, 8192, 1792, 263936, 8388608, 262144, 32768, 4, 22048768, 131072, 0, 0, 218104464, 1
    .long 1, 24, 24, 8192, 1536, 1792, 8388608, 1048576, 32768, 8, 25190400, 131072, 0, 0, 218104848, 4
    .long 1, 32, 32, 8192, 1536, 1792, 8388608, 2621440, 32768, 8, 48259072, 131072, 0, 0, 218105616, 4
    .long 1, 24, 24, 8192, 1536, 1792, 8388608, 3145728, 32768, 8, 33579008, 131072, 0, 0, 218105872, 4
    .long 1, 24, 24, 8192, 1536, 1792, 8388608, 3670016, 32768, 8, 35676160, 131072, 0, 0, 218106128, 4
    .long 1, 80, 80, 2048, 1536, 1792, 7340032, 56360960, 114688, 7, 168321024, 32768, 218103872, 7, 218106432, 1
    .long 0, 0, 0, 0, 0, 0, 0, 0, 0, 0, 0, 0, 0, 0, 0, 0
    .long 0, 0, 0, 0, 0, 0, 0, 0, 0, 0, 0, 0, 0, 0, 0, 0
    .long 0, 0, 0, 0, 0, 0, 0, 0, 0, 0, 0, 0, 0, 0, 0, 0
    .long 6, 24, 24, 8192, 3840, 265984, 8388608, 0, 32768, 4, 21032960, 131072, 0, 0, 218104368, 1
    .long 4, 24, 24, 8192, 3840, 265984, 8388608, 262144, 32768, 4, 22081536, 131072, 0, 0, 218104496, 1
    .long 1, 24, 24, 8192, 3584, 3840, 8388608, 1048576, 32768, 8, 25223168, 131072, 0, 0, 218104880, 4
    .long 1, 32, 32, 8192, 3584, 3840, 8388608, 2621440, 32768, 8, 48291840, 131072, 0, 0, 218105648, 4
    .long 1, 24, 24, 8192, 3584, 3840, 8388608, 3145728, 32768, 8, 33611776, 131072, 0, 0, 218105904, 4
    .long 1, 24, 24, 8192, 3584, 3840, 8388608, 3670016, 32768, 8, 35708928, 131072, 0, 0, 218106160, 4
    .long 1, 80, 80, 2048, 1836544, 1836800, 7340032, 56389632, 114688, 7, 172515328, 32768, 218103888, 7, 218106432, 1
    .long 0, 0, 0, 0, 0, 0, 0, 0, 0, 0, 0, 0, 0, 0, 0, 0
    .long 0, 0, 0, 0, 0, 0, 0, 0, 0, 0, 0, 0, 0, 0, 0, 0
    .long 0, 0, 0, 0, 0, 0, 0, 0, 0, 0, 0, 0, 0, 0, 0, 0
    .long 6, 24, 24, 8192, 5888, 268032, 8388608, 0, 32768, 4, 21065728, 131072, 0, 0, 218104400, 1
    .long 4, 24, 24, 8192, 5888, 268032, 8388608, 262144, 32768, 4, 22114304, 131072, 0, 0, 218104528, 1
    .long 1, 24, 24, 8192, 5632, 5888, 8388608, 1048576, 32768, 8, 25255936, 131072, 0, 0, 218104912, 4
    .long 1, 32, 32, 8192, 5632, 5888, 8388608, 2621440, 32768, 8, 48324608, 131072, 0, 0, 218105680, 4
    .long 1, 24, 24, 8192, 5632, 5888, 8388608, 3145728, 32768, 8, 33644544, 131072, 0, 0, 218105936, 4
    .long 1, 24, 24, 8192, 5632, 5888, 8388608, 3670016, 32768, 8, 35741696, 131072, 0, 0, 218106192, 4
    .long 1, 80, 80, 2048, 3671552, 3671808, 7340032, 56418304, 114688, 7, 176709632, 32768, 218103904, 7, 218106432, 1
    .long 0, 0, 0, 0, 0, 0, 0, 0, 0, 0, 0, 0, 0, 0, 0, 0
    .long 0, 0, 0, 0, 0, 0, 0, 0, 0, 0, 0, 0, 0, 0, 0, 0
    .long 0, 0, 0, 0, 0, 0, 0, 0, 0, 0, 0, 0, 0, 0, 0, 0
    .long 6, 24, 24, 8192, 7936, 270080, 8388608, 0, 32768, 4, 21098496, 131072, 0, 0, 218104432, 1
    .long 4, 24, 24, 8192, 7936, 270080, 8388608, 262144, 32768, 4, 22147072, 131072, 0, 0, 218104560, 1
    .long 1, 24, 24, 8192, 7680, 7936, 8388608, 1048576, 32768, 8, 25288704, 131072, 0, 0, 218104944, 4
    .long 1, 32, 32, 8192, 7680, 7936, 8388608, 2621440, 32768, 8, 48357376, 131072, 0, 0, 218105712, 4
    .long 1, 24, 24, 8192, 7680, 7936, 8388608, 3145728, 32768, 8, 33677312, 131072, 0, 0, 218105968, 4
    .long 1, 24, 24, 8192, 7680, 7936, 8388608, 3670016, 32768, 8, 35774464, 131072, 0, 0, 218106224, 4
    .long 1, 80, 80, 2048, 5506560, 5506816, 7340032, 56446976, 114688, 7, 180903936, 32768, 218103920, 7, 218106432, 1
    .long 0, 0, 0, 0, 0, 0, 0, 0, 0, 0, 0, 0, 0, 0, 0, 0
    .long 0, 0, 0, 0, 0, 0, 0, 0, 0, 0, 0, 0, 0, 0, 0, 0
    .long 0, 0, 0, 0, 0, 0, 0, 0, 0, 0, 0, 0, 0, 0, 0, 0
    .long 6, 32, 32, 8192, 0, 262144, 8388608, 0, 32768, 4, 37748736, 131072, 0, 0, 218104320, 1
    .long 4, 32, 32, 8192, 0, 262144, 8388608, 262144, 32768, 4, 38797312, 131072, 0, 0, 218104448, 1
    .long 4, 16, 16, 8192, 1792, 263936, 8388608, 786432, 32768, 4, 7368704, 131072, 0, 0, 218104592, 1
    .long 1, 32, 32, 8192, 1024, 1280, 8388608, 1572864, 32768, 8, 44056576, 131072, 0, 0, 218105104, 4
    .long 1, 16, 16, 8192, 1024, 1280, 8388608, 2621440, 32768, 8, 14696448, 131072, 0, 0, 218105616, 4
    .long 2, 64, 72, 7168, 4096, 4096, 7340032, 1048576, 32768, 8, 58261504, 114688, 0, 0, 218103968, 1
    .long 2, 64, 72, 7168, 3072, 3072, 7340032, 2621440, 32768, 8, 63750144, 114688, 0, 0, 218104144, 1
    .long 1, 80, 80, 2048, 1024, 1280, 7340032, 60030976, 114688, 7, 169361408, 32768, 218104000, 7, 218106560, 1
    .long 0, 0, 0, 0, 0, 0, 0, 0, 0, 0, 0, 0, 0, 0, 0, 0
    .long 0, 0, 0, 0, 0, 0, 0, 0, 0, 0, 0, 0, 0, 0, 0, 0
    .long 6, 32, 32, 8192, 2048, 264192, 8388608, 0, 32768, 4, 37781504, 131072, 0, 0, 218104352, 1
    .long 4, 32, 32, 8192, 2048, 264192, 8388608, 262144, 32768, 4, 38830080, 131072, 0, 0, 218104480, 1
    .long 4, 16, 16, 8192, 3840, 265984, 8388608, 786432, 32768, 4, 7401472, 131072, 0, 0, 218104624, 1
    .long 1, 32, 32, 8192, 3072, 3328, 8388608, 1572864, 32768, 8, 44089344, 131072, 0, 0, 218105136, 4
    .long 1, 16, 16, 8192, 3072, 3328, 8388608, 2621440, 32768, 8, 14729216, 131072, 0, 0, 218105648, 4
    .long 2, 64, 72, 7168, 4352, 4352, 7340032, 1048576, 32768, 8, 58265600, 114688, 0, 0, 218103968, 1
    .long 2, 64, 72, 7168, 3328, 3328, 7340032, 2621440, 32768, 8, 63754240, 114688, 0, 0, 218104144, 1
    .long 1, 80, 80, 2048, 1836032, 1836288, 7340032, 60059648, 114688, 7, 173555712, 32768, 218104016, 7, 218106560, 1
    .long 0, 0, 0, 0, 0, 0, 0, 0, 0, 0, 0, 0, 0, 0, 0, 0
    .long 0, 0, 0, 0, 0, 0, 0, 0, 0, 0, 0, 0, 0, 0, 0, 0
    .long 6, 32, 32, 8192, 4096, 266240, 8388608, 0, 32768, 4, 37814272, 131072, 0, 0, 218104384, 1
    .long 4, 32, 32, 8192, 4096, 266240, 8388608, 262144, 32768, 4, 38862848, 131072, 0, 0, 218104512, 1
    .long 4, 16, 16, 8192, 5888, 268032, 8388608, 786432, 32768, 4, 7434240, 131072, 0, 0, 218104656, 1
    .long 1, 32, 32, 8192, 5120, 5376, 8388608, 1572864, 32768, 8, 44122112, 131072, 0, 0, 218105168, 4
    .long 1, 16, 16, 8192, 5120, 5376, 8388608, 2621440, 32768, 8, 14761984, 131072, 0, 0, 218105680, 4
    .long 2, 64, 72, 7168, 4608, 4608, 7340032, 1048576, 32768, 8, 58269696, 114688, 0, 0, 218103968, 1
    .long 2, 64, 72, 7168, 3584, 3584, 7340032, 2621440, 32768, 8, 63758336, 114688, 0, 0, 218104160, 1
    .long 1, 80, 80, 2048, 3671040, 3671296, 7340032, 60088320, 114688, 7, 177750016, 32768, 218104032, 7, 218106560, 1
    .long 0, 0, 0, 0, 0, 0, 0, 0, 0, 0, 0, 0, 0, 0, 0, 0
    .long 0, 0, 0, 0, 0, 0, 0, 0, 0, 0, 0, 0, 0, 0, 0, 0
    .long 6, 32, 32, 8192, 6144, 268288, 8388608, 0, 32768, 4, 37847040, 131072, 0, 0, 218104416, 1
    .long 4, 32, 32, 8192, 6144, 268288, 8388608, 262144, 32768, 4, 38895616, 131072, 0, 0, 218104544, 1
    .long 4, 16, 16, 8192, 7936, 270080, 8388608, 786432, 32768, 4, 7467008, 131072, 0, 0, 218104688, 1
    .long 1, 32, 32, 8192, 7168, 7424, 8388608, 1572864, 32768, 8, 44154880, 131072, 0, 0, 218105200, 4
    .long 1, 16, 16, 8192, 7168, 7424, 8388608, 2621440, 32768, 8, 14794752, 131072, 0, 0, 218105712, 4
    .long 2, 64, 72, 7168, 4864, 4864, 7340032, 1048576, 32768, 8, 58273792, 114688, 0, 0, 218103968, 1
    .long 2, 64, 72, 7168, 3840, 3840, 7340032, 2621440, 32768, 8, 63762432, 114688, 0, 0, 218104160, 1
    .long 1, 80, 80, 2048, 5506048, 5506304, 7340032, 60116992, 114688, 7, 181944320, 32768, 218104048, 7, 218106560, 1
    .long 0, 0, 0, 0, 0, 0, 0, 0, 0, 0, 0, 0, 0, 0, 0, 0
    .long 0, 0, 0, 0, 0, 0, 0, 0, 0, 0, 0, 0, 0, 0, 0, 0
    .long 6, 32, 32, 8192, 256, 262400, 8388608, 0, 32768, 4, 37752832, 131072, 0, 0, 218104320, 1
    .long 4, 32, 32, 8192, 256, 262400, 8388608, 262144, 32768, 4, 38801408, 131072, 0, 0, 218104448, 1
    .long 4, 16, 16, 8192, 1792, 263936, 8388608, 524288, 32768, 4, 6320128, 131072, 0, 0, 218104592, 1
    .long 1, 32, 32, 8192, 1536, 1792, 8388608, 1572864, 32768, 8, 44064768, 131072, 0, 0, 218105104, 4
    .long 1, 16, 16, 8192, 1536, 1792, 8388608, 2621440, 32768, 8, 14704640, 131072, 0, 0, 218105616, 4
    .long 2, 64, 72, 7168, 5120, 5120, 7340032, 1048576, 32768, 8, 58277888, 114688, 0, 0, 218103968, 1
    .long 2, 64, 72, 7168, 4096, 4096, 7340032, 2621440, 32768, 8, 63766528, 114688, 0, 0, 218104160, 1
    .long 1, 80, 80, 2048, 1536, 1792, 7340032, 60030976, 114688, 7, 169369600, 32768, 218104000, 7, 218106560, 1
    .long 0, 0, 0, 0, 0, 0, 0, 0, 0, 0, 0, 0, 0, 0, 0, 0
    .long 0, 0, 0, 0, 0, 0, 0, 0, 0, 0, 0, 0, 0, 0, 0, 0
    .long 6, 32, 32, 8192, 2304, 264448, 8388608, 0, 32768, 4, 37785600, 131072, 0, 0, 218104352, 1
    .long 4, 32, 32, 8192, 2304, 264448, 8388608, 262144, 32768, 4, 38834176, 131072, 0, 0, 218104480, 1
    .long 4, 16, 16, 8192, 3840, 265984, 8388608, 524288, 32768, 4, 6352896, 131072, 0, 0, 218104624, 1
    .long 1, 32, 32, 8192, 3584, 3840, 8388608, 1572864, 32768, 8, 44097536, 131072, 0, 0, 218105136, 4
    .long 1, 16, 16, 8192, 3584, 3840, 8388608, 2621440, 32768, 8, 14737408, 131072, 0, 0, 218105648, 4
    .long 2, 64, 72, 7168, 5376, 5376, 7340032, 1048576, 32768, 8, 58281984, 114688, 0, 0, 218103984, 1
    .long 2, 64, 72, 7168, 4352, 4352, 7340032, 2621440, 32768, 8, 63770624, 114688, 0, 0, 218104160, 1
    .long 1, 80, 80, 2048, 1836544, 1836800, 7340032, 60059648, 114688, 7, 173563904, 32768, 218104016, 7, 218106560, 1
    .long 0, 0, 0, 0, 0, 0, 0, 0, 0, 0, 0, 0, 0, 0, 0, 0
    .long 0, 0, 0, 0, 0, 0, 0, 0, 0, 0, 0, 0, 0, 0, 0, 0
    .long 6, 32, 32, 8192, 4352, 266496, 8388608, 0, 32768, 4, 37818368, 131072, 0, 0, 218104384, 1
    .long 4, 32, 32, 8192, 4352, 266496, 8388608, 262144, 32768, 4, 38866944, 131072, 0, 0, 218104512, 1
    .long 4, 16, 16, 8192, 5888, 268032, 8388608, 524288, 32768, 4, 6385664, 131072, 0, 0, 218104656, 1
    .long 1, 32, 32, 8192, 5632, 5888, 8388608, 1572864, 32768, 8, 44130304, 131072, 0, 0, 218105168, 4
    .long 1, 16, 16, 8192, 5632, 5888, 8388608, 2621440, 32768, 8, 14770176, 131072, 0, 0, 218105680, 4
    .long 2, 64, 72, 7168, 5632, 5632, 7340032, 1048576, 32768, 8, 58286080, 114688, 0, 0, 218103984, 1
    .long 2, 64, 72, 7168, 4608, 4608, 7340032, 2621440, 32768, 8, 63774720, 114688, 0, 0, 218104160, 1
    .long 1, 80, 80, 2048, 3671552, 3671808, 7340032, 60088320, 114688, 7, 177758208, 32768, 218104032, 7, 218106560, 1
    .long 0, 0, 0, 0, 0, 0, 0, 0, 0, 0, 0, 0, 0, 0, 0, 0
    .long 0, 0, 0, 0, 0, 0, 0, 0, 0, 0, 0, 0, 0, 0, 0, 0
    .long 6, 32, 32, 8192, 6400, 268544, 8388608, 0, 32768, 4, 37851136, 131072, 0, 0, 218104416, 1
    .long 4, 32, 32, 8192, 6400, 268544, 8388608, 262144, 32768, 4, 38899712, 131072, 0, 0, 218104544, 1
    .long 4, 16, 16, 8192, 7936, 270080, 8388608, 524288, 32768, 4, 6418432, 131072, 0, 0, 218104688, 1
    .long 1, 32, 32, 8192, 7680, 7936, 8388608, 1572864, 32768, 8, 44163072, 131072, 0, 0, 218105200, 4
    .long 1, 16, 16, 8192, 7680, 7936, 8388608, 2621440, 32768, 8, 14802944, 131072, 0, 0, 218105712, 4
    .long 2, 64, 72, 7168, 5888, 5888, 7340032, 1048576, 32768, 8, 58290176, 114688, 0, 0, 218103984, 1
    .long 2, 64, 72, 7168, 4864, 4864, 7340032, 2621440, 32768, 8, 63778816, 114688, 0, 0, 218104160, 1
    .long 1, 80, 80, 2048, 5506560, 5506816, 7340032, 60116992, 114688, 7, 181952512, 32768, 218104048, 7, 218106560, 1
    .long 0, 0, 0, 0, 0, 0, 0, 0, 0, 0, 0, 0, 0, 0, 0, 0
    .long 0, 0, 0, 0, 0, 0, 0, 0, 0, 0, 0, 0, 0, 0, 0, 0
    .long 6, 32, 32, 8192, 512, 262656, 8388608, 0, 32768, 4, 37756928, 131072, 0, 0, 218104320, 1
    .long 4, 32, 32, 8192, 512, 262656, 8388608, 262144, 32768, 4, 38805504, 131072, 0, 0, 218104448, 1
    .long 4, 16, 16, 8192, 1536, 263680, 8388608, 786432, 32768, 4, 7364608, 131072, 0, 0, 218104592, 1
    .long 1, 24, 24, 8192, 0, 256, 8388608, 1572864, 32768, 8, 27262976, 131072, 0, 0, 218105088, 4
    .long 2, 64, 72, 7168, 0, 0, 7340032, 0, 32768, 8, 54525952, 114688, 0, 0, 218103808, 1
    .long 2, 64, 72, 7168, 6144, 6144, 7340032, 1048576, 32768, 8, 58294272, 114688, 0, 0, 218103984, 1
    .long 2, 64, 72, 7168, 5120, 5120, 7340032, 2621440, 32768, 8, 63782912, 114688, 0, 0, 218104160, 1
    .long 1, 80, 80, 2048, 0, 256, 7340032, 61865984, 114688, 7, 169869312, 32768, 218104064, 7, 218106624, 1
    .long 0, 0, 0, 0, 0, 0, 0, 0, 0, 0, 0, 0, 0, 0, 0, 0
    .long 0, 0, 0, 0, 0, 0, 0, 0, 0, 0, 0, 0, 0, 0, 0, 0
    .long 6, 32, 32, 8192, 2560, 264704, 8388608, 0, 32768, 4, 37789696, 131072, 0, 0, 218104352, 1
    .long 4, 32, 32, 8192, 2560, 264704, 8388608, 262144, 32768, 4, 38838272, 131072, 0, 0, 218104480, 1
    .long 4, 16, 16, 8192, 3584, 265728, 8388608, 786432, 32768, 4, 7397376, 131072, 0, 0, 218104624, 1
    .long 1, 24, 24, 8192, 2048, 2304, 8388608, 1572864, 32768, 8, 27295744, 131072, 0, 0, 218105120, 4
    .long 2, 64, 72, 7168, 256, 256, 7340032, 0, 32768, 8, 54530048, 114688, 0, 0, 218103808, 1
    .long 2, 64, 72, 7168, 6400, 6400, 7340032, 1048576, 32768, 8, 58298368, 114688, 0, 0, 218103984, 1
    .long 2, 64, 72, 7168, 5376, 5376, 7340032, 2621440, 32768, 8, 63787008, 114688, 0, 0, 218104176, 1
    .long 1, 80, 80, 2048, 1835008, 1835264, 7340032, 61894656, 114688, 7, 174063616, 32768, 218104080, 7, 218106624, 1
    .long 0, 0, 0, 0, 0, 0, 0, 0, 0, 0, 0, 0, 0, 0, 0, 0
    .long 0, 0, 0, 0, 0, 0, 0, 0, 0, 0, 0, 0, 0, 0, 0, 0
    .long 6, 32, 32, 8192, 4608, 266752, 8388608, 0, 32768, 4, 37822464, 131072, 0, 0, 218104384, 1
    .long 4, 32, 32, 8192, 4608, 266752, 8388608, 262144, 32768, 4, 38871040, 131072, 0, 0, 218104512, 1
    .long 4, 16, 16, 8192, 5632, 267776, 8388608, 786432, 32768, 4, 7430144, 131072, 0, 0, 218104656, 1
    .long 1, 24, 24, 8192, 4096, 4352, 8388608, 1572864, 32768, 8, 27328512, 131072, 0, 0, 218105152, 4
    .long 2, 64, 72, 7168, 512, 512, 7340032, 0, 32768, 8, 54534144, 114688, 0, 0, 218103808, 1
    .long 2, 64, 72, 7168, 6656, 6656, 7340032, 1048576, 32768, 8, 58302464, 114688, 0, 0, 218103984, 1
    .long 2, 64, 72, 7168, 5632, 5632, 7340032, 2621440, 32768, 8, 63791104, 114688, 0, 0, 218104176, 1
    .long 1, 80, 80, 2048, 3670016, 3670272, 7340032, 61923328, 114688, 7, 178257920, 32768, 218104096, 7, 218106624, 1
    .long 0, 0, 0, 0, 0, 0, 0, 0, 0, 0, 0, 0, 0, 0, 0, 0
    .long 0, 0, 0, 0, 0, 0, 0, 0, 0, 0, 0, 0, 0, 0, 0, 0
    .long 6, 32, 32, 8192, 6656, 268800, 8388608, 0, 32768, 4, 37855232, 131072, 0, 0, 218104416, 1
    .long 4, 32, 32, 8192, 6656, 268800, 8388608, 262144, 32768, 4, 38903808, 131072, 0, 0, 218104544, 1
    .long 4, 16, 16, 8192, 7680, 269824, 8388608, 786432, 32768, 4, 7462912, 131072, 0, 0, 218104688, 1
    .long 1, 24, 24, 8192, 6144, 6400, 8388608, 1572864, 32768, 8, 27361280, 131072, 0, 0, 218105184, 4
    .long 2, 64, 72, 7168, 768, 768, 7340032, 0, 32768, 8, 54538240, 114688, 0, 0, 218103808, 1
    .long 2, 64, 72, 7168, 6912, 6912, 7340032, 1048576, 32768, 8, 58306560, 114688, 0, 0, 218103984, 1
    .long 2, 64, 72, 7168, 5888, 5888, 7340032, 2621440, 32768, 8, 63795200, 114688, 0, 0, 218104176, 1
    .long 1, 80, 80, 2048, 5505024, 5505280, 7340032, 61952000, 114688, 7, 182452224, 32768, 218104112, 7, 218106624, 1
    .long 0, 0, 0, 0, 0, 0, 0, 0, 0, 0, 0, 0, 0, 0, 0, 0
    .long 0, 0, 0, 0, 0, 0, 0, 0, 0, 0, 0, 0, 0, 0, 0, 0
    .long 6, 32, 32, 8192, 768, 262912, 8388608, 0, 32768, 4, 37761024, 131072, 0, 0, 218104320, 1
    .long 4, 32, 32, 8192, 768, 262912, 8388608, 262144, 32768, 4, 38809600, 131072, 0, 0, 218104448, 1
    .long 4, 16, 16, 8192, 1536, 263680, 8388608, 524288, 32768, 4, 6316032, 131072, 0, 0, 218104592, 1
    .long 1, 24, 24, 8192, 512, 768, 8388608, 1572864, 32768, 8, 27271168, 131072, 0, 0, 218105088, 4
    .long 2, 64, 72, 7168, 1024, 1024, 7340032, 0, 32768, 8, 54542336, 114688, 0, 0, 218103808, 1
    .long 2, 64, 72, 7168, 0, 0, 7340032, 1572864, 32768, 8, 60030976, 114688, 0, 0, 218104000, 1
    .long 2, 64, 72, 7168, 6144, 6144, 7340032, 2621440, 32768, 8, 63799296, 114688, 0, 0, 218104176, 1
    .long 1, 80, 80, 2048, 512, 768, 7340032, 61865984, 114688, 7, 169877504, 32768, 218104064, 7, 218106624, 1
    .long 0, 0, 0, 0, 0, 0, 0, 0, 0, 0, 0, 0, 0, 0, 0, 0
    .long 0, 0, 0, 0, 0, 0, 0, 0, 0, 0, 0, 0, 0, 0, 0, 0
    .long 6, 32, 32, 8192, 2816, 264960, 8388608, 0, 32768, 4, 37793792, 131072, 0, 0, 218104352, 1
    .long 4, 32, 32, 8192, 2816, 264960, 8388608, 262144, 32768, 4, 38842368, 131072, 0, 0, 218104480, 1
    .long 4, 16, 16, 8192, 3584, 265728, 8388608, 524288, 32768, 4, 6348800, 131072, 0, 0, 218104624, 1
    .long 1, 24, 24, 8192, 2560, 2816, 8388608, 1572864, 32768, 8, 27303936, 131072, 0, 0, 218105120, 4
    .long 2, 64, 72, 7168, 1280, 1280, 7340032, 0, 32768, 8, 54546432, 114688, 0, 0, 218103808, 1
    .long 2, 64, 72, 7168, 256, 256, 7340032, 1572864, 32768, 8, 60035072, 114688, 0, 0, 218104000, 1
    .long 2, 64, 72, 7168, 6400, 6400, 7340032, 2621440, 32768, 8, 63803392, 114688, 0, 0, 218104176, 1
    .long 1, 80, 80, 2048, 1835520, 1835776, 7340032, 61894656, 114688, 7, 174071808, 32768, 218104080, 7, 218106624, 1
    .long 0, 0, 0, 0, 0, 0, 0, 0, 0, 0, 0, 0, 0, 0, 0, 0
    .long 0, 0, 0, 0, 0, 0, 0, 0, 0, 0, 0, 0, 0, 0, 0, 0
    .long 6, 32, 32, 8192, 4864, 267008, 8388608, 0, 32768, 4, 37826560, 131072, 0, 0, 218104384, 1
    .long 4, 32, 32, 8192, 4864, 267008, 8388608, 262144, 32768, 4, 38875136, 131072, 0, 0, 218104512, 1
    .long 4, 16, 16, 8192, 5632, 267776, 8388608, 524288, 32768, 4, 6381568, 131072, 0, 0, 218104656, 1
    .long 1, 24, 24, 8192, 4608, 4864, 8388608, 1572864, 32768, 8, 27336704, 131072, 0, 0, 218105152, 4
    .long 2, 64, 72, 7168, 1536, 1536, 7340032, 0, 32768, 8, 54550528, 114688, 0, 0, 218103808, 1
    .long 2, 64, 72, 7168, 512, 512, 7340032, 1572864, 32768, 8, 60039168, 114688, 0, 0, 218104000, 1
    .long 2, 64, 72, 7168, 6656, 6656, 7340032, 2621440, 32768, 8, 63807488, 114688, 0, 0, 218104176, 1
    .long 1, 80, 80, 2048, 3670528, 3670784, 7340032, 61923328, 114688, 7, 178266112, 32768, 218104096, 7, 218106624, 1
    .long 0, 0, 0, 0, 0, 0, 0, 0, 0, 0, 0, 0, 0, 0, 0, 0
    .long 0, 0, 0, 0, 0, 0, 0, 0, 0, 0, 0, 0, 0, 0, 0, 0
    .long 6, 32, 32, 8192, 6912, 269056, 8388608, 0, 32768, 4, 37859328, 131072, 0, 0, 218104416, 1
    .long 4, 32, 32, 8192, 6912, 269056, 8388608, 262144, 32768, 4, 38907904, 131072, 0, 0, 218104544, 1
    .long 4, 16, 16, 8192, 7680, 269824, 8388608, 524288, 32768, 4, 6414336, 131072, 0, 0, 218104688, 1
    .long 1, 24, 24, 8192, 6656, 6912, 8388608, 1572864, 32768, 8, 27369472, 131072, 0, 0, 218105184, 4
    .long 2, 64, 72, 7168, 1792, 1792, 7340032, 0, 32768, 8, 54554624, 114688, 0, 0, 218103824, 1
    .long 2, 64, 72, 7168, 768, 768, 7340032, 1572864, 32768, 8, 60043264, 114688, 0, 0, 218104000, 1
    .long 2, 64, 72, 7168, 6912, 6912, 7340032, 2621440, 32768, 8, 63811584, 114688, 0, 0, 218104176, 1
    .long 1, 80, 80, 2048, 5505536, 5505792, 7340032, 61952000, 114688, 7, 182460416, 32768, 218104112, 7, 218106624, 1
    .long 0, 0, 0, 0, 0, 0, 0, 0, 0, 0, 0, 0, 0, 0, 0, 0
    .long 0, 0, 0, 0, 0, 0, 0, 0, 0, 0, 0, 0, 0, 0, 0, 0
    .long 6, 32, 32, 8192, 1024, 263168, 8388608, 0, 32768, 4, 37765120, 131072, 0, 0, 218104336, 1
    .long 4, 32, 32, 8192, 1024, 263168, 8388608, 262144, 32768, 4, 38813696, 131072, 0, 0, 218104464, 1
    .long 4, 16, 16, 8192, 1280, 263424, 8388608, 786432, 32768, 4, 7360512, 131072, 0, 0, 218104592, 1
    .long 1, 24, 24, 8192, 1024, 1280, 8388608, 1572864, 32768, 8, 27279360, 131072, 0, 0, 218105104, 4
    .long 2, 64, 72, 7168, 2048, 2048, 7340032, 0, 32768, 8, 54558720, 114688, 0, 0, 218103824, 1
    .long 2, 64, 72, 7168, 1024, 1024, 7340032, 1572864, 32768, 8, 60047360, 114688, 0, 0, 218104000, 1
    .long 2, 64, 72, 7168, 0, 0, 7340032, 3145728, 32768, 8, 65536000, 114688, 0, 0, 218104192, 1
    .long 1, 80, 80, 2048, 1024, 1280, 7340032, 61865984, 114688, 7, 169885696, 32768, 218104064, 7, 218106624, 1
    .long 0, 0, 0, 0, 0, 0, 0, 0, 0, 0, 0, 0, 0, 0, 0, 0
    .long 0, 0, 0, 0, 0, 0, 0, 0, 0, 0, 0, 0, 0, 0, 0, 0
    .long 6, 32, 32, 8192, 3072, 265216, 8388608, 0, 32768, 4, 37797888, 131072, 0, 0, 218104368, 1
    .long 4, 32, 32, 8192, 3072, 265216, 8388608, 262144, 32768, 4, 38846464, 131072, 0, 0, 218104496, 1
    .long 4, 16, 16, 8192, 3328, 265472, 8388608, 786432, 32768, 4, 7393280, 131072, 0, 0, 218104624, 1
    .long 1, 24, 24, 8192, 3072, 3328, 8388608, 1572864, 32768, 8, 27312128, 131072, 0, 0, 218105136, 4
    .long 2, 64, 72, 7168, 2304, 2304, 7340032, 0, 32768, 8, 54562816, 114688, 0, 0, 218103824, 1
    .long 2, 64, 72, 7168, 1280, 1280, 7340032, 1572864, 32768, 8, 60051456, 114688, 0, 0, 218104000, 1
    .long 2, 64, 72, 7168, 256, 256, 7340032, 3145728, 32768, 8, 65540096, 114688, 0, 0, 218104192, 1
    .long 1, 80, 80, 2048, 1836032, 1836288, 7340032, 61894656, 114688, 7, 174080000, 32768, 218104080, 7, 218106624, 1
    .long 0, 0, 0, 0, 0, 0, 0, 0, 0, 0, 0, 0, 0, 0, 0, 0
    .long 0, 0, 0, 0, 0, 0, 0, 0, 0, 0, 0, 0, 0, 0, 0, 0
    .long 6, 32, 32, 8192, 5120, 267264, 8388608, 0, 32768, 4, 37830656, 131072, 0, 0, 218104400, 1
    .long 4, 32, 32, 8192, 5120, 267264, 8388608, 262144, 32768, 4, 38879232, 131072, 0, 0, 218104528, 1
    .long 4, 16, 16, 8192, 5376, 267520, 8388608, 786432, 32768, 4, 7426048, 131072, 0, 0, 218104656, 1
    .long 1, 24, 24, 8192, 5120, 5376, 8388608, 1572864, 32768, 8, 27344896, 131072, 0, 0, 218105168, 4
    .long 2, 64, 72, 7168, 2560, 2560, 7340032, 0, 32768, 8, 54566912, 114688, 0, 0, 218103824, 1
    .long 2, 64, 72, 7168, 1536, 1536, 7340032, 1572864, 32768, 8, 60055552, 114688, 0, 0, 218104000, 1
    .long 2, 64, 72, 7168, 512, 512, 7340032, 3145728, 32768, 8, 65544192, 114688, 0, 0, 218104192, 1
    .long 1, 80, 80, 2048, 3671040, 3671296, 7340032, 61923328, 114688, 7, 178274304, 32768, 218104096, 7, 218106624, 1
    .long 0, 0, 0, 0, 0, 0, 0, 0, 0, 0, 0, 0, 0, 0, 0, 0
    .long 0, 0, 0, 0, 0, 0, 0, 0, 0, 0, 0, 0, 0, 0, 0, 0
    .long 6, 32, 32, 8192, 7168, 269312, 8388608, 0, 32768, 4, 37863424, 131072, 0, 0, 218104432, 1
    .long 4, 32, 32, 8192, 7168, 269312, 8388608, 262144, 32768, 4, 38912000, 131072, 0, 0, 218104560, 1
    .long 4, 16, 16, 8192, 7424, 269568, 8388608, 786432, 32768, 4, 7458816, 131072, 0, 0, 218104688, 1
    .long 1, 24, 24, 8192, 7168, 7424, 8388608, 1572864, 32768, 8, 27377664, 131072, 0, 0, 218105200, 4
    .long 2, 64, 72, 7168, 2816, 2816, 7340032, 0, 32768, 8, 54571008, 114688, 0, 0, 218103824, 1
    .long 2, 64, 72, 7168, 1792, 1792, 7340032, 1572864, 32768, 8, 60059648, 114688, 0, 0, 218104016, 1
    .long 2, 64, 72, 7168, 768, 768, 7340032, 3145728, 32768, 8, 65548288, 114688, 0, 0, 218104192, 1
    .long 1, 80, 80, 2048, 5506048, 5506304, 7340032, 61952000, 114688, 7, 182468608, 32768, 218104112, 7, 218106624, 1
    .long 0, 0, 0, 0, 0, 0, 0, 0, 0, 0, 0, 0, 0, 0, 0, 0
    .long 0, 0, 0, 0, 0, 0, 0, 0, 0, 0, 0, 0, 0, 0, 0, 0
    .long 6, 32, 32, 8192, 1280, 263424, 8388608, 0, 32768, 4, 37769216, 131072, 0, 0, 218104336, 1
    .long 4, 32, 32, 8192, 1280, 263424, 8388608, 262144, 32768, 4, 38817792, 131072, 0, 0, 218104464, 1
    .long 4, 16, 16, 8192, 1280, 263424, 8388608, 524288, 32768, 4, 6311936, 131072, 0, 0, 218104592, 1
    .long 1, 24, 24, 8192, 1536, 1792, 8388608, 1572864, 32768, 8, 27287552, 131072, 0, 0, 218105104, 4
    .long 2, 64, 72, 7168, 3072, 3072, 7340032, 0, 32768, 8, 54575104, 114688, 0, 0, 218103824, 1
    .long 2, 64, 72, 7168, 2048, 2048, 7340032, 1572864, 32768, 8, 60063744, 114688, 0, 0, 218104016, 1
    .long 2, 64, 72, 7168, 1024, 1024, 7340032, 3145728, 32768, 8, 65552384, 114688, 0, 0, 218104192, 1
    .long 1, 80, 80, 2048, 1536, 1792, 7340032, 61865984, 114688, 7, 169893888, 32768, 218104064, 7, 218106624, 1
    .long 0, 0, 0, 0, 0, 0, 0, 0, 0, 0, 0, 0, 0, 0, 0, 0
    .long 0, 0, 0, 0, 0, 0, 0, 0, 0, 0, 0, 0, 0, 0, 0, 0
    .long 6, 32, 32, 8192, 3328, 265472, 8388608, 0, 32768, 4, 37801984, 131072, 0, 0, 218104368, 1
    .long 4, 32, 32, 8192, 3328, 265472, 8388608, 262144, 32768, 4, 38850560, 131072, 0, 0, 218104496, 1
    .long 4, 16, 16, 8192, 3328, 265472, 8388608, 524288, 32768, 4, 6344704, 131072, 0, 0, 218104624, 1
    .long 1, 24, 24, 8192, 3584, 3840, 8388608, 1572864, 32768, 8, 27320320, 131072, 0, 0, 218105136, 4
    .long 2, 64, 72, 7168, 3328, 3328, 7340032, 0, 32768, 8, 54579200, 114688, 0, 0, 218103824, 1
    .long 2, 64, 72, 7168, 2304, 2304, 7340032, 1572864, 32768, 8, 60067840, 114688, 0, 0, 218104016, 1
    .long 2, 64, 72, 7168, 1280, 1280, 7340032, 3145728, 32768, 8, 65556480, 114688, 0, 0, 218104192, 1
    .long 1, 80, 80, 2048, 1836544, 1836800, 7340032, 61894656, 114688, 7, 174088192, 32768, 218104080, 7, 218106624, 1
    .long 0, 0, 0, 0, 0, 0, 0, 0, 0, 0, 0, 0, 0, 0, 0, 0
    .long 0, 0, 0, 0, 0, 0, 0, 0, 0, 0, 0, 0, 0, 0, 0, 0
    .long 6, 32, 32, 8192, 5376, 267520, 8388608, 0, 32768, 4, 37834752, 131072, 0, 0, 218104400, 1
    .long 4, 32, 32, 8192, 5376, 267520, 8388608, 262144, 32768, 4, 38883328, 131072, 0, 0, 218104528, 1
    .long 4, 16, 16, 8192, 5376, 267520, 8388608, 524288, 32768, 4, 6377472, 131072, 0, 0, 218104656, 1
    .long 1, 24, 24, 8192, 5632, 5888, 8388608, 1572864, 32768, 8, 27353088, 131072, 0, 0, 218105168, 4
    .long 2, 64, 72, 7168, 3584, 3584, 7340032, 0, 32768, 8, 54583296, 114688, 0, 0, 218103840, 1
    .long 2, 64, 72, 7168, 2560, 2560, 7340032, 1572864, 32768, 8, 60071936, 114688, 0, 0, 218104016, 1
    .long 2, 64, 72, 7168, 1536, 1536, 7340032, 3145728, 32768, 8, 65560576, 114688, 0, 0, 218104192, 1
    .long 1, 80, 80, 2048, 3671552, 3671808, 7340032, 61923328, 114688, 7, 178282496, 32768, 218104096, 7, 218106624, 1
    .long 0, 0, 0, 0, 0, 0, 0, 0, 0, 0, 0, 0, 0, 0, 0, 0
    .long 0, 0, 0, 0, 0, 0, 0, 0, 0, 0, 0, 0, 0, 0, 0, 0
    .long 6, 32, 32, 8192, 7424, 269568, 8388608, 0, 32768, 4, 37867520, 131072, 0, 0, 218104432, 1
    .long 4, 32, 32, 8192, 7424, 269568, 8388608, 262144, 32768, 4, 38916096, 131072, 0, 0, 218104560, 1
    .long 4, 16, 16, 8192, 7424, 269568, 8388608, 524288, 32768, 4, 6410240, 131072, 0, 0, 218104688, 1
    .long 1, 24, 24, 8192, 7680, 7936, 8388608, 1572864, 32768, 8, 27385856, 131072, 0, 0, 218105200, 4
    .long 2, 64, 72, 7168, 3840, 3840, 7340032, 0, 32768, 8, 54587392, 114688, 0, 0, 218103840, 1
    .long 2, 64, 72, 7168, 2816, 2816, 7340032, 1572864, 32768, 8, 60076032, 114688, 0, 0, 218104016, 1
    .long 2, 64, 72, 7168, 1792, 1792, 7340032, 3145728, 32768, 8, 65564672, 114688, 0, 0, 218104208, 1
    .long 1, 80, 80, 2048, 5506560, 5506816, 7340032, 61952000, 114688, 7, 182476800, 32768, 218104112, 7, 218106624, 1
    .long 0, 0, 0, 0, 0, 0, 0, 0, 0, 0, 0, 0, 0, 0, 0, 0
    .long 0, 0, 0, 0, 0, 0, 0, 0, 0, 0, 0, 0, 0, 0, 0, 0
    .long 6, 32, 32, 8192, 1536, 263680, 8388608, 0, 32768, 4, 37773312, 131072, 0, 0, 218104336, 1
    .long 4, 32, 32, 8192, 1536, 263680, 8388608, 262144, 32768, 4, 38821888, 131072, 0, 0, 218104464, 1
    .long 4, 16, 16, 8192, 1024, 263168, 8388608, 786432, 32768, 4, 7356416, 131072, 0, 0, 218104592, 1
    .long 1, 16, 16, 8192, 0, 256, 8388608, 1572864, 32768, 8, 10485760, 131072, 0, 0, 218105088, 4
    .long 2, 64, 72, 7168, 4096, 4096, 7340032, 0, 32768, 8, 54591488, 114688, 0, 0, 218103840, 1
    .long 2, 64, 72, 7168, 3072, 3072, 7340032, 1572864, 32768, 8, 60080128, 114688, 0, 0, 218104016, 1
    .long 2, 64, 72, 7168, 2048, 2048, 7340032, 3145728, 32768, 8, 65568768, 114688, 0, 0, 218104208, 1
    .long 1, 80, 80, 2048, 0, 256, 7340032, 63700992, 114688, 7, 170393600, 32768, 218104128, 7, 218106688, 1
    .long 0, 0, 0, 0, 0, 0, 0, 0, 0, 0, 0, 0, 0, 0, 0, 0
    .long 0, 0, 0, 0, 0, 0, 0, 0, 0, 0, 0, 0, 0, 0, 0, 0
    .long 6, 32, 32, 8192, 3584, 265728, 8388608, 0, 32768, 4, 37806080, 131072, 0, 0, 218104368, 1
    .long 4, 32, 32, 8192, 3584, 265728, 8388608, 262144, 32768, 4, 38854656, 131072, 0, 0, 218104496, 1
    .long 4, 16, 16, 8192, 3072, 265216, 8388608, 786432, 32768, 4, 7389184, 131072, 0, 0, 218104624, 1
    .long 1, 16, 16, 8192, 2048, 2304, 8388608, 1572864, 32768, 8, 10518528, 131072, 0, 0, 218105120, 4
    .long 2, 64, 72, 7168, 4352, 4352, 7340032, 0, 32768, 8, 54595584, 114688, 0, 0, 218103840, 1
    .long 2, 64, 72, 7168, 3328, 3328, 7340032, 1572864, 32768, 8, 60084224, 114688, 0, 0, 218104016, 1
    .long 2, 64, 72, 7168, 2304, 2304, 7340032, 3145728, 32768, 8, 65572864, 114688, 0, 0, 218104208, 1
    .long 1, 80, 80, 2048, 1835008, 1835264, 7340032, 63729664, 114688, 7, 174587904, 32768, 218104144, 7, 218106688, 1
    .long 0, 0, 0, 0, 0, 0, 0, 0, 0, 0, 0, 0, 0, 0, 0, 0
    .long 0, 0, 0, 0, 0, 0, 0, 0, 0, 0, 0, 0, 0, 0, 0, 0
    .long 6, 32, 32, 8192, 5632, 267776, 8388608, 0, 32768, 4, 37838848, 131072, 0, 0, 218104400, 1
    .long 4, 32, 32, 8192, 5632, 267776, 8388608, 262144, 32768, 4, 38887424, 131072, 0, 0, 218104528, 1
    .long 4, 16, 16, 8192, 5120, 267264, 8388608, 786432, 32768, 4, 7421952, 131072, 0, 0, 218104656, 1
    .long 1, 16, 16, 8192, 4096, 4352, 8388608, 1572864, 32768, 8, 10551296, 131072, 0, 0, 218105152, 4
    .long 2, 64, 72, 7168, 4608, 4608, 7340032, 0, 32768, 8, 54599680, 114688, 0, 0, 218103840, 1
    .long 2, 64, 72, 7168, 3584, 3584, 7340032, 1572864, 32768, 8, 60088320, 114688, 0, 0, 218104032, 1
    .long 2, 64, 72, 7168, 2560, 2560, 7340032, 3145728, 32768, 8, 65576960, 114688, 0, 0, 218104208, 1
    .long 1, 80, 80, 2048, 3670016, 3670272, 7340032, 63758336, 114688, 7, 178782208, 32768, 218104160, 7, 218106688, 1
    .long 0, 0, 0, 0, 0, 0, 0, 0, 0, 0, 0, 0, 0, 0, 0, 0
    .long 0, 0, 0, 0, 0, 0, 0, 0, 0, 0, 0, 0, 0, 0, 0, 0
    .long 6, 32, 32, 8192, 7680, 269824, 8388608, 0, 32768, 4, 37871616, 131072, 0, 0, 218104432, 1
    .long 4, 32, 32, 8192, 7680, 269824, 8388608, 262144, 32768, 4, 38920192, 131072, 0, 0, 218104560, 1
    .long 4, 16, 16, 8192, 7168, 269312, 8388608, 786432, 32768, 4, 7454720, 131072, 0, 0, 218104688, 1
    .long 1, 16, 16, 8192, 6144, 6400, 8388608, 1572864, 32768, 8, 10584064, 131072, 0, 0, 218105184, 4
    .long 2, 64, 72, 7168, 4864, 4864, 7340032, 0, 32768, 8, 54603776, 114688, 0, 0, 218103840, 1
    .long 2, 64, 72, 7168, 3840, 3840, 7340032, 1572864, 32768, 8, 60092416, 114688, 0, 0, 218104032, 1
    .long 2, 64, 72, 7168, 2816, 2816, 7340032, 3145728, 32768, 8, 65581056, 114688, 0, 0, 218104208, 1
    .long 1, 80, 80, 2048, 5505024, 5505280, 7340032, 63787008, 114688, 7, 182976512, 32768, 218104176, 7, 218106688, 1
    .long 0, 0, 0, 0, 0, 0, 0, 0, 0, 0, 0, 0, 0, 0, 0, 0
    .long 0, 0, 0, 0, 0, 0, 0, 0, 0, 0, 0, 0, 0, 0, 0, 0
    .long 6, 32, 32, 8192, 1792, 263936, 8388608, 0, 32768, 4, 37777408, 131072, 0, 0, 218104336, 1
    .long 4, 32, 32, 8192, 1792, 263936, 8388608, 262144, 32768, 4, 38825984, 131072, 0, 0, 218104464, 1
    .long 4, 16, 16, 8192, 1024, 263168, 8388608, 524288, 32768, 4, 6307840, 131072, 0, 0, 218104592, 1
    .long 1, 16, 16, 8192, 512, 768, 8388608, 1572864, 32768, 8, 10493952, 131072, 0, 0, 218105088, 4
    .long 2, 64, 72, 7168, 5120, 5120, 7340032, 0, 32768, 8, 54607872, 114688, 0, 0, 218103840, 1
    .long 2, 64, 72, 7168, 4096, 4096, 7340032, 1572864, 32768, 8, 60096512, 114688, 0, 0, 218104032, 1
    .long 2, 64, 72, 7168, 3072, 3072, 7340032, 3145728, 32768, 8, 65585152, 114688, 0, 0, 218104208, 1
    .long 1, 80, 80, 2048, 512, 768, 7340032, 63700992, 114688, 7, 170401792, 32768, 218104128, 7, 218106688, 1
    .long 0, 0, 0, 0, 0, 0, 0, 0, 0, 0, 0, 0, 0, 0, 0, 0
    .long 0, 0, 0, 0, 0, 0, 0, 0, 0, 0, 0, 0, 0, 0, 0, 0
    .long 6, 32, 32, 8192, 3840, 265984, 8388608, 0, 32768, 4, 37810176, 131072, 0, 0, 218104368, 1
    .long 4, 32, 32, 8192, 3840, 265984, 8388608, 262144, 32768, 4, 38858752, 131072, 0, 0, 218104496, 1
    .long 4, 16, 16, 8192, 3072, 265216, 8388608, 524288, 32768, 4, 6340608, 131072, 0, 0, 218104624, 1
    .long 1, 16, 16, 8192, 2560, 2816, 8388608, 1572864, 32768, 8, 10526720, 131072, 0, 0, 218105120, 4
    .long 2, 64, 72, 7168, 5376, 5376, 7340032, 0, 32768, 8, 54611968, 114688, 0, 0, 218103856, 1
    .long 2, 64, 72, 7168, 4352, 4352, 7340032, 1572864, 32768, 8, 60100608, 114688, 0, 0, 218104032, 1
    .long 2, 64, 72, 7168, 3328, 3328, 7340032, 3145728, 32768, 8, 65589248, 114688, 0, 0, 218104208, 1
    .long 1, 80, 80, 2048, 1835520, 1835776, 7340032, 63729664, 114688, 7, 174596096, 32768, 218104144, 7, 218106688, 1
    .long 0, 0, 0, 0, 0, 0, 0, 0, 0, 0, 0, 0, 0, 0, 0, 0
    .long 0, 0, 0, 0, 0, 0, 0, 0, 0, 0, 0, 0, 0, 0, 0, 0
    .long 6, 32, 32, 8192, 5888, 268032, 8388608, 0, 32768, 4, 37842944, 131072, 0, 0, 218104400, 1
    .long 4, 32, 32, 8192, 5888, 268032, 8388608, 262144, 32768, 4, 38891520, 131072, 0, 0, 218104528, 1
    .long 4, 16, 16, 8192, 5120, 267264, 8388608, 524288, 32768, 4, 6373376, 131072, 0, 0, 218104656, 1
    .long 1, 16, 16, 8192, 4608, 4864, 8388608, 1572864, 32768, 8, 10559488, 131072, 0, 0, 218105152, 4
    .long 2, 64, 72, 7168, 5632, 5632, 7340032, 0, 32768, 8, 54616064, 114688, 0, 0, 218103856, 1
    .long 2, 64, 72, 7168, 4608, 4608, 7340032, 1572864, 32768, 8, 60104704, 114688, 0, 0, 218104032, 1
    .long 2, 64, 72, 7168, 3584, 3584, 7340032, 3145728, 32768, 8, 65593344, 114688, 0, 0, 218104224, 1
    .long 1, 80, 80, 2048, 3670528, 3670784, 7340032, 63758336, 114688, 7, 178790400, 32768, 218104160, 7, 218106688, 1
    .long 0, 0, 0, 0, 0, 0, 0, 0, 0, 0, 0, 0, 0, 0, 0, 0
    .long 0, 0, 0, 0, 0, 0, 0, 0, 0, 0, 0, 0, 0, 0, 0, 0
    .long 6, 32, 32, 8192, 7936, 270080, 8388608, 0, 32768, 4, 37875712, 131072, 0, 0, 218104432, 1
    .long 4, 32, 32, 8192, 7936, 270080, 8388608, 262144, 32768, 4, 38924288, 131072, 0, 0, 218104560, 1
    .long 4, 16, 16, 8192, 7168, 269312, 8388608, 524288, 32768, 4, 6406144, 131072, 0, 0, 218104688, 1
    .long 1, 16, 16, 8192, 6656, 6912, 8388608, 1572864, 32768, 8, 10592256, 131072, 0, 0, 218105184, 4
    .long 2, 64, 72, 7168, 5888, 5888, 7340032, 0, 32768, 8, 54620160, 114688, 0, 0, 218103856, 1
    .long 2, 64, 72, 7168, 4864, 4864, 7340032, 1572864, 32768, 8, 60108800, 114688, 0, 0, 218104032, 1
    .long 2, 64, 72, 7168, 3840, 3840, 7340032, 3145728, 32768, 8, 65597440, 114688, 0, 0, 218104224, 1
    .long 1, 80, 80, 2048, 5505536, 5505792, 7340032, 63787008, 114688, 7, 182984704, 32768, 218104176, 7, 218106688, 1
    .long 0, 0, 0, 0, 0, 0, 0, 0, 0, 0, 0, 0, 0, 0, 0, 0
    .long 0, 0, 0, 0, 0, 0, 0, 0, 0, 0, 0, 0, 0, 0, 0, 0
    .long 6, 16, 16, 8192, 0, 262144, 8388608, 0, 32768, 4, 4194304, 131072, 0, 0, 218104320, 1
    .long 4, 16, 16, 8192, 0, 262144, 8388608, 262144, 32768, 4, 5242880, 131072, 0, 0, 218104448, 1
    .long 4, 16, 16, 8192, 0, 262144, 8388608, 524288, 32768, 4, 6291456, 131072, 0, 0, 218104576, 1
    .long 1, 16, 16, 8192, 1024, 1280, 8388608, 1572864, 32768, 8, 10502144, 131072, 0, 0, 218105104, 4
    .long 2, 64, 72, 7168, 6144, 6144, 7340032, 0, 32768, 8, 54624256, 114688, 0, 0, 218103856, 1
    .long 2, 64, 72, 7168, 5120, 5120, 7340032, 1572864, 32768, 8, 60112896, 114688, 0, 0, 218104032, 1
    .long 2, 64, 72, 7168, 4096, 4096, 7340032, 3145728, 32768, 8, 65601536, 114688, 0, 0, 218104224, 1
    .long 1, 80, 80, 2048, 1024, 1280, 7340032, 63700992, 114688, 7, 170409984, 32768, 218104128, 7, 218106688, 1
    .long 0, 0, 0, 0, 0, 0, 0, 0, 0, 0, 0, 0, 0, 0, 0, 0
    .long 0, 0, 0, 0, 0, 0, 0, 0, 0, 0, 0, 0, 0, 0, 0, 0
    .long 6, 16, 16, 8192, 2048, 264192, 8388608, 0, 32768, 4, 4227072, 131072, 0, 0, 218104352, 1
    .long 4, 16, 16, 8192, 2048, 264192, 8388608, 262144, 32768, 4, 5275648, 131072, 0, 0, 218104480, 1
    .long 4, 16, 16, 8192, 2048, 264192, 8388608, 524288, 32768, 4, 6324224, 131072, 0, 0, 218104608, 1
    .long 1, 16, 16, 8192, 3072, 3328, 8388608, 1572864, 32768, 8, 10534912, 131072, 0, 0, 218105136, 4
    .long 2, 64, 72, 7168, 6400, 6400, 7340032, 0, 32768, 8, 54628352, 114688, 0, 0, 218103856, 1
    .long 2, 64, 72, 7168, 5376, 5376, 7340032, 1572864, 32768, 8, 60116992, 114688, 0, 0, 218104048, 1
    .long 2, 64, 72, 7168, 4352, 4352, 7340032, 3145728, 32768, 8, 65605632, 114688, 0, 0, 218104224, 1
    .long 1, 80, 80, 2048, 1836032, 1836288, 7340032, 63729664, 114688, 7, 174604288, 32768, 218104144, 7, 218106688, 1
    .long 0, 0, 0, 0, 0, 0, 0, 0, 0, 0, 0, 0, 0, 0, 0, 0
    .long 0, 0, 0, 0, 0, 0, 0, 0, 0, 0, 0, 0, 0, 0, 0, 0
    .long 6, 16, 16, 8192, 4096, 266240, 8388608, 0, 32768, 4, 4259840, 131072, 0, 0, 218104384, 1
    .long 4, 16, 16, 8192, 4096, 266240, 8388608, 262144, 32768, 4, 5308416, 131072, 0, 0, 218104512, 1
    .long 4, 16, 16, 8192, 4096, 266240, 8388608, 524288, 32768, 4, 6356992, 131072, 0, 0, 218104640, 1
    .long 1, 16, 16, 8192, 5120, 5376, 8388608, 1572864, 32768, 8, 10567680, 131072, 0, 0, 218105168, 4
    .long 2, 64, 72, 7168, 6656, 6656, 7340032, 0, 32768, 8, 54632448, 114688, 0, 0, 218103856, 1
    .long 2, 64, 72, 7168, 5632, 5632, 7340032, 1572864, 32768, 8, 60121088, 114688, 0, 0, 218104048, 1
    .long 2, 64, 72, 7168, 4608, 4608, 7340032, 3145728, 32768, 8, 65609728, 114688, 0, 0, 218104224, 1
    .long 1, 80, 80, 2048, 3671040, 3671296, 7340032, 63758336, 114688, 7, 178798592, 32768, 218104160, 7, 218106688, 1
    .long 0, 0, 0, 0, 0, 0, 0, 0, 0, 0, 0, 0, 0, 0, 0, 0
    .long 0, 0, 0, 0, 0, 0, 0, 0, 0, 0, 0, 0, 0, 0, 0, 0
    .long 6, 16, 16, 8192, 6144, 268288, 8388608, 0, 32768, 4, 4292608, 131072, 0, 0, 218104416, 1
    .long 4, 16, 16, 8192, 6144, 268288, 8388608, 262144, 32768, 4, 5341184, 131072, 0, 0, 218104544, 1
    .long 4, 16, 16, 8192, 6144, 268288, 8388608, 524288, 32768, 4, 6389760, 131072, 0, 0, 218104672, 1
    .long 1, 16, 16, 8192, 7168, 7424, 8388608, 1572864, 32768, 8, 10600448, 131072, 0, 0, 218105200, 4
    .long 2, 64, 72, 7168, 6912, 6912, 7340032, 0, 32768, 8, 54636544, 114688, 0, 0, 218103856, 1
    .long 2, 64, 72, 7168, 5888, 5888, 7340032, 1572864, 32768, 8, 60125184, 114688, 0, 0, 218104048, 1
    .long 2, 64, 72, 7168, 4864, 4864, 7340032, 3145728, 32768, 8, 65613824, 114688, 0, 0, 218104224, 1
    .long 1, 80, 80, 2048, 5506048, 5506304, 7340032, 63787008, 114688, 7, 182992896, 32768, 218104176, 7, 218106688, 1
    .long 0, 0, 0, 0, 0, 0, 0, 0, 0, 0, 0, 0, 0, 0, 0, 0
    .long 0, 0, 0, 0, 0, 0, 0, 0, 0, 0, 0, 0, 0, 0, 0, 0
    .long 6, 16, 16, 8192, 256, 262400, 8388608, 0, 32768, 4, 4198400, 131072, 0, 0, 218104320, 1
    .long 4, 16, 16, 8192, 256, 262400, 8388608, 262144, 32768, 4, 5246976, 131072, 0, 0, 218104448, 1
    .long 4, 16, 16, 8192, 256, 262400, 8388608, 524288, 32768, 4, 6295552, 131072, 0, 0, 218104576, 1
    .long 1, 16, 16, 8192, 1536, 1792, 8388608, 1572864, 32768, 8, 10510336, 131072, 0, 0, 218105104, 4
    .long 2, 64, 72, 7168, 0, 0, 7340032, 524288, 32768, 8, 56360960, 114688, 0, 0, 218103872, 1
    .long 2, 64, 72, 7168, 6144, 6144, 7340032, 1572864, 32768, 8, 60129280, 114688, 0, 0, 218104048, 1
    .long 2, 64, 72, 7168, 5120, 5120, 7340032, 3145728, 32768, 8, 65617920, 114688, 0, 0, 218104224, 1
    .long 1, 80, 80, 2048, 1536, 1792, 7340032, 63700992, 114688, 7, 170418176, 32768, 218104128, 7, 218106688, 1
    .long 0, 0, 0, 0, 0, 0, 0, 0, 0, 0, 0, 0, 0, 0, 0, 0
    .long 0, 0, 0, 0, 0, 0, 0, 0, 0, 0, 0, 0, 0, 0, 0, 0
    .long 6, 16, 16, 8192, 2304, 264448, 8388608, 0, 32768, 4, 4231168, 131072, 0, 0, 218104352, 1
    .long 4, 16, 16, 8192, 2304, 264448, 8388608, 262144, 32768, 4, 5279744, 131072, 0, 0, 218104480, 1
    .long 4, 16, 16, 8192, 2304, 264448, 8388608, 524288, 32768, 4, 6328320, 131072, 0, 0, 218104608, 1
    .long 1, 16, 16, 8192, 3584, 3840, 8388608, 1572864, 32768, 8, 10543104, 131072, 0, 0, 218105136, 4
    .long 2, 64, 72, 7168, 256, 256, 7340032, 524288, 32768, 8, 56365056, 114688, 0, 0, 218103872, 1
    .long 2, 64, 72, 7168, 6400, 6400, 7340032, 1572864, 32768, 8, 60133376, 114688, 0, 0, 218104048, 1
    .long 2, 64, 72, 7168, 5376, 5376, 7340032, 3145728, 32768, 8, 65622016, 114688, 0, 0, 218104240, 1
    .long 1, 80, 80, 2048, 1836544, 1836800, 7340032, 63729664, 114688, 7, 174612480, 32768, 218104144, 7, 218106688, 1
    .long 0, 0, 0, 0, 0, 0, 0, 0, 0, 0, 0, 0, 0, 0, 0, 0
    .long 0, 0, 0, 0, 0, 0, 0, 0, 0, 0, 0, 0, 0, 0, 0, 0
    .long 6, 16, 16, 8192, 4352, 266496, 8388608, 0, 32768, 4, 4263936, 131072, 0, 0, 218104384, 1
    .long 4, 16, 16, 8192, 4352, 266496, 8388608, 262144, 32768, 4, 5312512, 131072, 0, 0, 218104512, 1
    .long 4, 16, 16, 8192, 4352, 266496, 8388608, 524288, 32768, 4, 6361088, 131072, 0, 0, 218104640, 1
    .long 1, 16, 16, 8192, 5632, 5888, 8388608, 1572864, 32768, 8, 10575872, 131072, 0, 0, 218105168, 4
    .long 2, 64, 72, 7168, 512, 512, 7340032, 524288, 32768, 8, 56369152, 114688, 0, 0, 218103872, 1
    .long 2, 64, 72, 7168, 6656, 6656, 7340032, 1572864, 32768, 8, 60137472, 114688, 0, 0, 218104048, 1
    .long 2, 64, 72, 7168, 5632, 5632, 7340032, 3145728, 32768, 8, 65626112, 114688, 0, 0, 218104240, 1
    .long 1, 80, 80, 2048, 3671552, 3671808, 7340032, 63758336, 114688, 7, 178806784, 32768, 218104160, 7, 218106688, 1
    .long 0, 0, 0, 0, 0, 0, 0, 0, 0, 0, 0, 0, 0, 0, 0, 0
    .long 0, 0, 0, 0, 0, 0, 0, 0, 0, 0, 0, 0, 0, 0, 0, 0
    .long 6, 16, 16, 8192, 6400, 268544, 8388608, 0, 32768, 4, 4296704, 131072, 0, 0, 218104416, 1
    .long 4, 16, 16, 8192, 6400, 268544, 8388608, 262144, 32768, 4, 5345280, 131072, 0, 0, 218104544, 1
    .long 4, 16, 16, 8192, 6400, 268544, 8388608, 524288, 32768, 4, 6393856, 131072, 0, 0, 218104672, 1
    .long 1, 16, 16, 8192, 7680, 7936, 8388608, 1572864, 32768, 8, 10608640, 131072, 0, 0, 218105200, 4
    .long 2, 64, 72, 7168, 768, 768, 7340032, 524288, 32768, 8, 56373248, 114688, 0, 0, 218103872, 1
    .long 2, 64, 72, 7168, 6912, 6912, 7340032, 1572864, 32768, 8, 60141568, 114688, 0, 0, 218104048, 1
    .long 2, 64, 72, 7168, 5888, 5888, 7340032, 3145728, 32768, 8, 65630208, 114688, 0, 0, 218104240, 1
    .long 1, 80, 80, 2048, 5506560, 5506816, 7340032, 63787008, 114688, 7, 183001088, 32768, 218104176, 7, 218106688, 1
    .long 0, 0, 0, 0, 0, 0, 0, 0, 0, 0, 0, 0, 0, 0, 0, 0
    .long 0, 0, 0, 0, 0, 0, 0, 0, 0, 0, 0, 0, 0, 0, 0, 0
    .long 6, 16, 16, 8192, 512, 262656, 8388608, 0, 32768, 4, 4202496, 131072, 0, 0, 218104320, 1
    .long 4, 16, 16, 8192, 512, 262656, 8388608, 262144, 32768, 4, 5251072, 131072, 0, 0, 218104448, 1
    .long 4, 16, 16, 8192, 512, 262656, 8388608, 524288, 32768, 4, 6299648, 131072, 0, 0, 218104576, 1
    .long 1, 32, 32, 8192, 0, 256, 8388608, 2097152, 32768, 8, 46137344, 131072, 0, 0, 218105344, 4
    .long 2, 64, 72, 7168, 1024, 1024, 7340032, 524288, 32768, 8, 56377344, 114688, 0, 0, 218103872, 1
    .long 2, 64, 72, 7168, 0, 0, 7340032, 2097152, 32768, 8, 61865984, 114688, 0, 0, 218104064, 1
    .long 2, 64, 72, 7168, 6144, 6144, 7340032, 3145728, 32768, 8, 65634304, 114688, 0, 0, 218104240, 1
    .long 1, 80, 80, 2048, 0, 256, 7340032, 65536000, 114688, 7, 170917888, 32768, 218104192, 7, 218106752, 1
    .long 0, 0, 0, 0, 0, 0, 0, 0, 0, 0, 0, 0, 0, 0, 0, 0
    .long 0, 0, 0, 0, 0, 0, 0, 0, 0, 0, 0, 0, 0, 0, 0, 0
    .long 6, 16, 16, 8192, 2560, 264704, 8388608, 0, 32768, 4, 4235264, 131072, 0, 0, 218104352, 1
    .long 4, 16, 16, 8192, 2560, 264704, 8388608, 262144, 32768, 4, 5283840, 131072, 0, 0, 218104480, 1
    .long 4, 16, 16, 8192, 2560, 264704, 8388608, 524288, 32768, 4, 6332416, 131072, 0, 0, 218104608, 1
    .long 1, 32, 32, 8192, 2048, 2304, 8388608, 2097152, 32768, 8, 46170112, 131072, 0, 0, 218105376, 4
    .long 2, 64, 72, 7168, 1280, 1280, 7340032, 524288, 32768, 8, 56381440, 114688, 0, 0, 218103872, 1
    .long 2, 64, 72, 7168, 256, 256, 7340032, 2097152, 32768, 8, 61870080, 114688, 0, 0, 218104064, 1
    .long 2, 64, 72, 7168, 6400, 6400, 7340032, 3145728, 32768, 8, 65638400, 114688, 0, 0, 218104240, 1
    .long 1, 80, 80, 2048, 1835008, 1835264, 7340032, 65564672, 114688, 7, 175112192, 32768, 218104208, 7, 218106752, 1
    .long 0, 0, 0, 0, 0, 0, 0, 0, 0, 0, 0, 0, 0, 0, 0, 0
    .long 0, 0, 0, 0, 0, 0, 0, 0, 0, 0, 0, 0, 0, 0, 0, 0
    .long 6, 16, 16, 8192, 4608, 266752, 8388608, 0, 32768, 4, 4268032, 131072, 0, 0, 218104384, 1
    .long 4, 16, 16, 8192, 4608, 266752, 8388608, 262144, 32768, 4, 5316608, 131072, 0, 0, 218104512, 1
    .long 4, 16, 16, 8192, 4608, 266752, 8388608, 524288, 32768, 4, 6365184, 131072, 0, 0, 218104640, 1
    .long 1, 32, 32, 8192, 4096, 4352, 8388608, 2097152, 32768, 8, 46202880, 131072, 0, 0, 218105408, 4
    .long 2, 64, 72, 7168, 1536, 1536, 7340032, 524288, 32768, 8, 56385536, 114688, 0, 0, 218103872, 1
    .long 2, 64, 72, 7168, 512, 512, 7340032, 2097152, 32768, 8, 61874176, 114688, 0, 0, 218104064, 1
    .long 2, 64, 72, 7168, 6656, 6656, 7340032, 3145728, 32768, 8, 65642496, 114688, 0, 0, 218104240, 1
    .long 1, 80, 80, 2048, 3670016, 3670272, 7340032, 65593344, 114688, 7, 179306496, 32768, 218104224, 7, 218106752, 1
    .long 0, 0, 0, 0, 0, 0, 0, 0, 0, 0, 0, 0, 0, 0, 0, 0
    .long 0, 0, 0, 0, 0, 0, 0, 0, 0, 0, 0, 0, 0, 0, 0, 0
    .long 6, 16, 16, 8192, 6656, 268800, 8388608, 0, 32768, 4, 4300800, 131072, 0, 0, 218104416, 1
    .long 4, 16, 16, 8192, 6656, 268800, 8388608, 262144, 32768, 4, 5349376, 131072, 0, 0, 218104544, 1
    .long 4, 16, 16, 8192, 6656, 268800, 8388608, 524288, 32768, 4, 6397952, 131072, 0, 0, 218104672, 1
    .long 1, 32, 32, 8192, 6144, 6400, 8388608, 2097152, 32768, 8, 46235648, 131072, 0, 0, 218105440, 4
    .long 2, 64, 72, 7168, 1792, 1792, 7340032, 524288, 32768, 8, 56389632, 114688, 0, 0, 218103888, 1
    .long 2, 64, 72, 7168, 768, 768, 7340032, 2097152, 32768, 8, 61878272, 114688, 0, 0, 218104064, 1
    .long 2, 64, 72, 7168, 6912, 6912, 7340032, 3145728, 32768, 8, 65646592, 114688, 0, 0, 218104240, 1
    .long 1, 80, 80, 2048, 5505024, 5505280, 7340032, 65622016, 114688, 7, 183500800, 32768, 218104240, 7, 218106752, 1
    .long 0, 0, 0, 0, 0, 0, 0, 0, 0, 0, 0, 0, 0, 0, 0, 0
    .long 0, 0, 0, 0, 0, 0, 0, 0, 0, 0, 0, 0, 0, 0, 0, 0
    .long 6, 16, 16, 8192, 768, 262912, 8388608, 0, 32768, 4, 4206592, 131072, 0, 0, 218104320, 1
    .long 4, 16, 16, 8192, 768, 262912, 8388608, 262144, 32768, 4, 5255168, 131072, 0, 0, 218104448, 1
    .long 4, 16, 16, 8192, 768, 262912, 8388608, 524288, 32768, 4, 6303744, 131072, 0, 0, 218104576, 1
    .long 1, 32, 32, 8192, 512, 768, 8388608, 2097152, 32768, 8, 46145536, 131072, 0, 0, 218105344, 4
    .long 2, 64, 72, 7168, 2048, 2048, 7340032, 524288, 32768, 8, 56393728, 114688, 0, 0, 218103888, 1
    .long 2, 64, 72, 7168, 1024, 1024, 7340032, 2097152, 32768, 8, 61882368, 114688, 0, 0, 218104064, 1
    .long 2, 64, 72, 7168, 0, 0, 7340032, 3670016, 32768, 8, 67371008, 114688, 0, 0, 218104256, 1
    .long 1, 80, 80, 2048, 512, 768, 7340032, 65536000, 114688, 7, 170926080, 32768, 218104192, 7, 218106752, 1
    .long 0, 0, 0, 0, 0, 0, 0, 0, 0, 0, 0, 0, 0, 0, 0, 0
    .long 0, 0, 0, 0, 0, 0, 0, 0, 0, 0, 0, 0, 0, 0, 0, 0
    .long 6, 16, 16, 8192, 2816, 264960, 8388608, 0, 32768, 4, 4239360, 131072, 0, 0, 218104352, 1
    .long 4, 16, 16, 8192, 2816, 264960, 8388608, 262144, 32768, 4, 5287936, 131072, 0, 0, 218104480, 1
    .long 4, 16, 16, 8192, 2816, 264960, 8388608, 524288, 32768, 4, 6336512, 131072, 0, 0, 218104608, 1
    .long 1, 32, 32, 8192, 2560, 2816, 8388608, 2097152, 32768, 8, 46178304, 131072, 0, 0, 218105376, 4
    .long 2, 64, 72, 7168, 2304, 2304, 7340032, 524288, 32768, 8, 56397824, 114688, 0, 0, 218103888, 1
    .long 2, 64, 72, 7168, 1280, 1280, 7340032, 2097152, 32768, 8, 61886464, 114688, 0, 0, 218104064, 1
    .long 2, 64, 72, 7168, 256, 256, 7340032, 3670016, 32768, 8, 67375104, 114688, 0, 0, 218104256, 1
    .long 1, 80, 80, 2048, 1835520, 1835776, 7340032, 65564672, 114688, 7, 175120384, 32768, 218104208, 7, 218106752, 1
    .long 0, 0, 0, 0, 0, 0, 0, 0, 0, 0, 0, 0, 0, 0, 0, 0
    .long 0, 0, 0, 0, 0, 0, 0, 0, 0, 0, 0, 0, 0, 0, 0, 0
    .long 6, 16, 16, 8192, 4864, 267008, 8388608, 0, 32768, 4, 4272128, 131072, 0, 0, 218104384, 1
    .long 4, 16, 16, 8192, 4864, 267008, 8388608, 262144, 32768, 4, 5320704, 131072, 0, 0, 218104512, 1
    .long 4, 16, 16, 8192, 4864, 267008, 8388608, 524288, 32768, 4, 6369280, 131072, 0, 0, 218104640, 1
    .long 1, 32, 32, 8192, 4608, 4864, 8388608, 2097152, 32768, 8, 46211072, 131072, 0, 0, 218105408, 4
    .long 2, 64, 72, 7168, 2560, 2560, 7340032, 524288, 32768, 8, 56401920, 114688, 0, 0, 218103888, 1
    .long 2, 64, 72, 7168, 1536, 1536, 7340032, 2097152, 32768, 8, 61890560, 114688, 0, 0, 218104064, 1
    .long 2, 64, 72, 7168, 512, 512, 7340032, 3670016, 32768, 8, 67379200, 114688, 0, 0, 218104256, 1
    .long 1, 80, 80, 2048, 3670528, 3670784, 7340032, 65593344, 114688, 7, 179314688, 32768, 218104224, 7, 218106752, 1
    .long 0, 0, 0, 0, 0, 0, 0, 0, 0, 0, 0, 0, 0, 0, 0, 0
    .long 0, 0, 0, 0, 0, 0, 0, 0, 0, 0, 0, 0, 0, 0, 0, 0
    .long 6, 16, 16, 8192, 6912, 269056, 8388608, 0, 32768, 4, 4304896, 131072, 0, 0, 218104416, 1
    .long 4, 16, 16, 8192, 6912, 269056, 8388608, 262144, 32768, 4, 5353472, 131072, 0, 0, 218104544, 1
    .long 4, 16, 16, 8192, 6912, 269056, 8388608, 524288, 32768, 4, 6402048, 131072, 0, 0, 218104672, 1
    .long 1, 32, 32, 8192, 6656, 6912, 8388608, 2097152, 32768, 8, 46243840, 131072, 0, 0, 218105440, 4
    .long 2, 64, 72, 7168, 2816, 2816, 7340032, 524288, 32768, 8, 56406016, 114688, 0, 0, 218103888, 1
    .long 2, 64, 72, 7168, 1792, 1792, 7340032, 2097152, 32768, 8, 61894656, 114688, 0, 0, 218104080, 1
    .long 2, 64, 72, 7168, 768, 768, 7340032, 3670016, 32768, 8, 67383296, 114688, 0, 0, 218104256, 1
    .long 1, 80, 80, 2048, 5505536, 5505792, 7340032, 65622016, 114688, 7, 183508992, 32768, 218104240, 7, 218106752, 1
    .long 0, 0, 0, 0, 0, 0, 0, 0, 0, 0, 0, 0, 0, 0, 0, 0
    .long 0, 0, 0, 0, 0, 0, 0, 0, 0, 0, 0, 0, 0, 0, 0, 0
    .long 6, 16, 16, 8192, 1024, 263168, 8388608, 0, 32768, 4, 4210688, 131072, 0, 0, 218104336, 1
    .long 4, 16, 16, 8192, 1024, 263168, 8388608, 262144, 32768, 4, 5259264, 131072, 0, 0, 218104464, 1
    .long 4, 16, 16, 8192, 768, 262912, 8388608, 786432, 32768, 4, 7352320, 131072, 0, 0, 218104576, 1
    .long 1, 32, 32, 8192, 1024, 1280, 8388608, 2097152, 32768, 8, 46153728, 131072, 0, 0, 218105360, 4
    .long 2, 64, 72, 7168, 3072, 3072, 7340032, 524288, 32768, 8, 56410112, 114688, 0, 0, 218103888, 1
    .long 2, 64, 72, 7168, 2048, 2048, 7340032, 2097152, 32768, 8, 61898752, 114688, 0, 0, 218104080, 1
    .long 2, 64, 72, 7168, 1024, 1024, 7340032, 3670016, 32768, 8, 67387392, 114688, 0, 0, 218104256, 1
    .long 1, 80, 80, 2048, 1024, 1280, 7340032, 65536000, 114688, 7, 170934272, 32768, 218104192, 7, 218106752, 1
    .long 0, 0, 0, 0, 0, 0, 0, 0, 0, 0, 0, 0, 0, 0, 0, 0
    .long 0, 0, 0, 0, 0, 0, 0, 0, 0, 0, 0, 0, 0, 0, 0, 0
    .long 6, 16, 16, 8192, 3072, 265216, 8388608, 0, 32768, 4, 4243456, 131072, 0, 0, 218104368, 1
    .long 4, 16, 16, 8192, 3072, 265216, 8388608, 262144, 32768, 4, 5292032, 131072, 0, 0, 218104496, 1
    .long 4, 16, 16, 8192, 2816, 264960, 8388608, 786432, 32768, 4, 7385088, 131072, 0, 0, 218104608, 1
    .long 1, 32, 32, 8192, 3072, 3328, 8388608, 2097152, 32768, 8, 46186496, 131072, 0, 0, 218105392, 4
    .long 2, 64, 72, 7168, 3328, 3328, 7340032, 524288, 32768, 8, 56414208, 114688, 0, 0, 218103888, 1
    .long 2, 64, 72, 7168, 2304, 2304, 7340032, 2097152, 32768, 8, 61902848, 114688, 0, 0, 218104080, 1
    .long 2, 64, 72, 7168, 1280, 1280, 7340032, 3670016, 32768, 8, 67391488, 114688, 0, 0, 218104256, 1
    .long 1, 80, 80, 2048, 1836032, 1836288, 7340032, 65564672, 114688, 7, 175128576, 32768, 218104208, 7, 218106752, 1
    .long 0, 0, 0, 0, 0, 0, 0, 0, 0, 0, 0, 0, 0, 0, 0, 0
    .long 0, 0, 0, 0, 0, 0, 0, 0, 0, 0, 0, 0, 0, 0, 0, 0
    .long 6, 16, 16, 8192, 5120, 267264, 8388608, 0, 32768, 4, 4276224, 131072, 0, 0, 218104400, 1
    .long 4, 16, 16, 8192, 5120, 267264, 8388608, 262144, 32768, 4, 5324800, 131072, 0, 0, 218104528, 1
    .long 4, 16, 16, 8192, 4864, 267008, 8388608, 786432, 32768, 4, 7417856, 131072, 0, 0, 218104640, 1
    .long 1, 32, 32, 8192, 5120, 5376, 8388608, 2097152, 32768, 8, 46219264, 131072, 0, 0, 218105424, 4
    .long 2, 64, 72, 7168, 3584, 3584, 7340032, 524288, 32768, 8, 56418304, 114688, 0, 0, 218103904, 1
    .long 2, 64, 72, 7168, 2560, 2560, 7340032, 2097152, 32768, 8, 61906944, 114688, 0, 0, 218104080, 1
    .long 2, 64, 72, 7168, 1536, 1536, 7340032, 3670016, 32768, 8, 67395584, 114688, 0, 0, 218104256, 1
    .long 1, 80, 80, 2048, 3671040, 3671296, 7340032, 65593344, 114688, 7, 179322880, 32768, 218104224, 7, 218106752, 1
    .long 0, 0, 0, 0, 0, 0, 0, 0, 0, 0, 0, 0, 0, 0, 0, 0
    .long 0, 0, 0, 0, 0, 0, 0, 0, 0, 0, 0, 0, 0, 0, 0, 0
    .long 6, 16, 16, 8192, 7168, 269312, 8388608, 0, 32768, 4, 4308992, 131072, 0, 0, 218104432, 1
    .long 4, 16, 16, 8192, 7168, 269312, 8388608, 262144, 32768, 4, 5357568, 131072, 0, 0, 218104560, 1
    .long 4, 16, 16, 8192, 6912, 269056, 8388608, 786432, 32768, 4, 7450624, 131072, 0, 0, 218104672, 1
    .long 1, 32, 32, 8192, 7168, 7424, 8388608, 2097152, 32768, 8, 46252032, 131072, 0, 0, 218105456, 4
    .long 2, 64, 72, 7168, 3840, 3840, 7340032, 524288, 32768, 8, 56422400, 114688, 0, 0, 218103904, 1
    .long 2, 64, 72, 7168, 2816, 2816, 7340032, 2097152, 32768, 8, 61911040, 114688, 0, 0, 218104080, 1
    .long 2, 64, 72, 7168, 1792, 1792, 7340032, 3670016, 32768, 8, 67399680, 114688, 0, 0, 218104272, 1
    .long 1, 80, 80, 2048, 5506048, 5506304, 7340032, 65622016, 114688, 7, 183517184, 32768, 218104240, 7, 218106752, 1
    .long 0, 0, 0, 0, 0, 0, 0, 0, 0, 0, 0, 0, 0, 0, 0, 0
    .long 0, 0, 0, 0, 0, 0, 0, 0, 0, 0, 0, 0, 0, 0, 0, 0
    .long 6, 16, 16, 8192, 1280, 263424, 8388608, 0, 32768, 4, 4214784, 131072, 0, 0, 218104336, 1
    .long 4, 16, 16, 8192, 1280, 263424, 8388608, 262144, 32768, 4, 5263360, 131072, 0, 0, 218104464, 1
    .long 4, 16, 16, 8192, 512, 262656, 8388608, 786432, 32768, 4, 7348224, 131072, 0, 0, 218104576, 1
    .long 1, 32, 32, 8192, 1536, 1792, 8388608, 2097152, 32768, 8, 46161920, 131072, 0, 0, 218105360, 4
    .long 2, 64, 72, 7168, 4096, 4096, 7340032, 524288, 32768, 8, 56426496, 114688, 0, 0, 218103904, 1
    .long 2, 64, 72, 7168, 3072, 3072, 7340032, 2097152, 32768, 8, 61915136, 114688, 0, 0, 218104080, 1
    .long 2, 64, 72, 7168, 2048, 2048, 7340032, 3670016, 32768, 8, 67403776, 114688, 0, 0, 218104272, 1
    .long 1, 80, 80, 2048, 1536, 1792, 7340032, 65536000, 114688, 7, 170942464, 32768, 218104192, 7, 218106752, 1
    .long 0, 0, 0, 0, 0, 0, 0, 0, 0, 0, 0, 0, 0, 0, 0, 0
    .long 0, 0, 0, 0, 0, 0, 0, 0, 0, 0, 0, 0, 0, 0, 0, 0
    .long 6, 16, 16, 8192, 3328, 265472, 8388608, 0, 32768, 4, 4247552, 131072, 0, 0, 218104368, 1
    .long 4, 16, 16, 8192, 3328, 265472, 8388608, 262144, 32768, 4, 5296128, 131072, 0, 0, 218104496, 1
    .long 4, 16, 16, 8192, 2560, 264704, 8388608, 786432, 32768, 4, 7380992, 131072, 0, 0, 218104608, 1
    .long 1, 32, 32, 8192, 3584, 3840, 8388608, 2097152, 32768, 8, 46194688, 131072, 0, 0, 218105392, 4
    .long 2, 64, 72, 7168, 4352, 4352, 7340032, 524288, 32768, 8, 56430592, 114688, 0, 0, 218103904, 1
    .long 2, 64, 72, 7168, 3328, 3328, 7340032, 2097152, 32768, 8, 61919232, 114688, 0, 0, 218104080, 1
    .long 2, 64, 72, 7168, 2304, 2304, 7340032, 3670016, 32768, 8, 67407872, 114688, 0, 0, 218104272, 1
    .long 1, 80, 80, 2048, 1836544, 1836800, 7340032, 65564672, 114688, 7, 175136768, 32768, 218104208, 7, 218106752, 1
    .long 0, 0, 0, 0, 0, 0, 0, 0, 0, 0, 0, 0, 0, 0, 0, 0
    .long 0, 0, 0, 0, 0, 0, 0, 0, 0, 0, 0, 0, 0, 0, 0, 0
    .long 6, 16, 16, 8192, 5376, 267520, 8388608, 0, 32768, 4, 4280320, 131072, 0, 0, 218104400, 1
    .long 4, 16, 16, 8192, 5376, 267520, 8388608, 262144, 32768, 4, 5328896, 131072, 0, 0, 218104528, 1
    .long 4, 16, 16, 8192, 4608, 266752, 8388608, 786432, 32768, 4, 7413760, 131072, 0, 0, 218104640, 1
    .long 1, 32, 32, 8192, 5632, 5888, 8388608, 2097152, 32768, 8, 46227456, 131072, 0, 0, 218105424, 4
    .long 2, 64, 72, 7168, 4608, 4608, 7340032, 524288, 32768, 8, 56434688, 114688, 0, 0, 218103904, 1
    .long 2, 64, 72, 7168, 3584, 3584, 7340032, 2097152, 32768, 8, 61923328, 114688, 0, 0, 218104096, 1
    .long 2, 64, 72, 7168, 2560, 2560, 7340032, 3670016, 32768, 8, 67411968, 114688, 0, 0, 218104272, 1
    .long 1, 80, 80, 2048, 3671552, 3671808, 7340032, 65593344, 114688, 7, 179331072, 32768, 218104224, 7, 218106752, 1
    .long 0, 0, 0, 0, 0, 0, 0, 0, 0, 0, 0, 0, 0, 0, 0, 0
    .long 0, 0, 0, 0, 0, 0, 0, 0, 0, 0, 0, 0, 0, 0, 0, 0
    .long 6, 16, 16, 8192, 7424, 269568, 8388608, 0, 32768, 4, 4313088, 131072, 0, 0, 218104432, 1
    .long 4, 16, 16, 8192, 7424, 269568, 8388608, 262144, 32768, 4, 5361664, 131072, 0, 0, 218104560, 1
    .long 4, 16, 16, 8192, 6656, 268800, 8388608, 786432, 32768, 4, 7446528, 131072, 0, 0, 218104672, 1
    .long 1, 32, 32, 8192, 7680, 7936, 8388608, 2097152, 32768, 8, 46260224, 131072, 0, 0, 218105456, 4
    .long 2, 64, 72, 7168, 4864, 4864, 7340032, 524288, 32768, 8, 56438784, 114688, 0, 0, 218103904, 1
    .long 2, 64, 72, 7168, 3840, 3840, 7340032, 2097152, 32768, 8, 61927424, 114688, 0, 0, 218104096, 1
    .long 2, 64, 72, 7168, 2816, 2816, 7340032, 3670016, 32768, 8, 67416064, 114688, 0, 0, 218104272, 1
    .long 1, 80, 80, 2048, 5506560, 5506816, 7340032, 65622016, 114688, 7, 183525376, 32768, 218104240, 7, 218106752, 1
    .long 0, 0, 0, 0, 0, 0, 0, 0, 0, 0, 0, 0, 0, 0, 0, 0
    .long 0, 0, 0, 0, 0, 0, 0, 0, 0, 0, 0, 0, 0, 0, 0, 0
    .long 6, 16, 16, 8192, 1536, 263680, 8388608, 0, 32768, 4, 4218880, 131072, 0, 0, 218104336, 1
    .long 4, 16, 16, 8192, 1536, 263680, 8388608, 262144, 32768, 4, 5267456, 131072, 0, 0, 218104464, 1
    .long 4, 16, 16, 8192, 256, 262400, 8388608, 786432, 32768, 4, 7344128, 131072, 0, 0, 218104576, 1
    .long 1, 24, 24, 8192, 0, 256, 8388608, 2097152, 32768, 8, 29360128, 131072, 0, 0, 218105344, 4
    .long 2, 64, 72, 7168, 5120, 5120, 7340032, 524288, 32768, 8, 56442880, 114688, 0, 0, 218103904, 1
    .long 2, 64, 72, 7168, 4096, 4096, 7340032, 2097152, 32768, 8, 61931520, 114688, 0, 0, 218104096, 1
    .long 2, 64, 72, 7168, 3072, 3072, 7340032, 3670016, 32768, 8, 67420160, 114688, 0, 0, 218104272, 1
    .long 1, 80, 80, 2048, 0, 256, 7340032, 67371008, 114688, 7, 171442176, 32768, 218104256, 7, 218106816, 1
    .long 0, 0, 0, 0, 0, 0, 0, 0, 0, 0, 0, 0, 0, 0, 0, 0
    .long 0, 0, 0, 0, 0, 0, 0, 0, 0, 0, 0, 0, 0, 0, 0, 0
    .long 6, 16, 16, 8192, 3584, 265728, 8388608, 0, 32768, 4, 4251648, 131072, 0, 0, 218104368, 1
    .long 4, 16, 16, 8192, 3584, 265728, 8388608, 262144, 32768, 4, 5300224, 131072, 0, 0, 218104496, 1
    .long 4, 16, 16, 8192, 2304, 264448, 8388608, 786432, 32768, 4, 7376896, 131072, 0, 0, 218104608, 1
    .long 1, 24, 24, 8192, 2048, 2304, 8388608, 2097152, 32768, 8, 29392896, 131072, 0, 0, 218105376, 4
    .long 2, 64, 72, 7168, 5376, 5376, 7340032, 524288, 32768, 8, 56446976, 114688, 0, 0, 218103920, 1
    .long 2, 64, 72, 7168, 4352, 4352, 7340032, 2097152, 32768, 8, 61935616, 114688, 0, 0, 218104096, 1
    .long 2, 64, 72, 7168, 3328, 3328, 7340032, 3670016, 32768, 8, 67424256, 114688, 0, 0, 218104272, 1
    .long 1, 80, 80, 2048, 1835008, 1835264, 7340032, 67399680, 114688, 7, 175636480, 32768, 218104272, 7, 218106816, 1
    .long 0, 0, 0, 0, 0, 0, 0, 0, 0, 0, 0, 0, 0, 0, 0, 0
    .long 0, 0, 0, 0, 0, 0, 0, 0, 0, 0, 0, 0, 0, 0, 0, 0
    .long 6, 16, 16, 8192, 5632, 267776, 8388608, 0, 32768, 4, 4284416, 131072, 0, 0, 218104400, 1
    .long 4, 16, 16, 8192, 5632, 267776, 8388608, 262144, 32768, 4, 5332992, 131072, 0, 0, 218104528, 1
    .long 4, 16, 16, 8192, 4352, 266496, 8388608, 786432, 32768, 4, 7409664, 131072, 0, 0, 218104640, 1
    .long 1, 24, 24, 8192, 4096, 4352, 8388608, 2097152, 32768, 8, 29425664, 131072, 0, 0, 218105408, 4
    .long 2, 64, 72, 7168, 5632, 5632, 7340032, 524288, 32768, 8, 56451072, 114688, 0, 0, 218103920, 1
    .long 2, 64, 72, 7168, 4608, 4608, 7340032, 2097152, 32768, 8, 61939712, 114688, 0, 0, 218104096, 1
    .long 2, 64, 72, 7168, 3584, 3584, 7340032, 3670016, 32768, 8, 67428352, 114688, 0, 0, 218104288, 1
    .long 1, 80, 80, 2048, 512, 768, 7340032, 67371008, 114688, 7, 171450368, 32768, 218104256, 7, 218106816, 1
    .long 0, 0, 0, 0, 0, 0, 0, 0, 0, 0, 0, 0, 0, 0, 0, 0
    .long 0, 0, 0, 0, 0, 0, 0, 0, 0, 0, 0, 0, 0, 0, 0, 0
    .long 6, 16, 16, 8192, 7680, 269824, 8388608, 0, 32768, 4, 4317184, 131072, 0, 0, 218104432, 1
    .long 4, 16, 16, 8192, 7680, 269824, 8388608, 262144, 32768, 4, 5365760, 131072, 0, 0, 218104560, 1
    .long 4, 16, 16, 8192, 6400, 268544, 8388608, 786432, 32768, 4, 7442432, 131072, 0, 0, 218104672, 1
    .long 1, 24, 24, 8192, 6144, 6400, 8388608, 2097152, 32768, 8, 29458432, 131072, 0, 0, 218105440, 4
    .long 2, 64, 72, 7168, 5888, 5888, 7340032, 524288, 32768, 8, 56455168, 114688, 0, 0, 218103920, 1
    .long 2, 64, 72, 7168, 4864, 4864, 7340032, 2097152, 32768, 8, 61943808, 114688, 0, 0, 218104096, 1
    .long 2, 64, 72, 7168, 3840, 3840, 7340032, 3670016, 32768, 8, 67432448, 114688, 0, 0, 218104288, 1
    .long 1, 80, 80, 2048, 1024, 1280, 7340032, 67371008, 114688, 7, 171458560, 32768, 218104256, 7, 218106816, 1
    .long 0, 0, 0, 0, 0, 0, 0, 0, 0, 0, 0, 0, 0, 0, 0, 0
    .long 0, 0, 0, 0, 0, 0, 0, 0, 0, 0, 0, 0, 0, 0, 0, 0
    .long 6, 16, 16, 8192, 1792, 263936, 8388608, 0, 32768, 4, 4222976, 131072, 0, 0, 218104336, 1
    .long 4, 16, 16, 8192, 1792, 263936, 8388608, 262144, 32768, 4, 5271552, 131072, 0, 0, 218104464, 1
    .long 4, 16, 16, 8192, 0, 262144, 8388608, 786432, 32768, 4, 7340032, 131072, 0, 0, 218104576, 1
    .long 1, 24, 24, 8192, 512, 768, 8388608, 2097152, 32768, 8, 29368320, 131072, 0, 0, 218105344, 4
    .long 2, 64, 72, 7168, 6144, 6144, 7340032, 524288, 32768, 8, 56459264, 114688, 0, 0, 218103920, 1
    .long 2, 64, 72, 7168, 5120, 5120, 7340032, 2097152, 32768, 8, 61947904, 114688, 0, 0, 218104096, 1
    .long 2, 64, 72, 7168, 4096, 4096, 7340032, 3670016, 32768, 8, 67436544, 114688, 0, 0, 218104288, 1
    .long 1, 80, 80, 2048, 1536, 1792, 7340032, 67371008, 114688, 7, 171466752, 32768, 218104256, 7, 218106816, 1
    .long 0, 0, 0, 0, 0, 0, 0, 0, 0, 0, 0, 0, 0, 0, 0, 0
    .long 0, 0, 0, 0, 0, 0, 0, 0, 0, 0, 0, 0, 0, 0, 0, 0
    .long 6, 16, 16, 8192, 3840, 265984, 8388608, 0, 32768, 4, 4255744, 131072, 0, 0, 218104368, 1
    .long 4, 16, 16, 8192, 3840, 265984, 8388608, 262144, 32768, 4, 5304320, 131072, 0, 0, 218104496, 1
    .long 4, 16, 16, 8192, 2048, 264192, 8388608, 786432, 32768, 4, 7372800, 131072, 0, 0, 218104608, 1
    .long 1, 24, 24, 8192, 2560, 2816, 8388608, 2097152, 32768, 8, 29401088, 131072, 0, 0, 218105376, 4
    .long 2, 64, 72, 7168, 6400, 6400, 7340032, 524288, 32768, 8, 56463360, 114688, 0, 0, 218103920, 1
    .long 2, 64, 72, 7168, 5376, 5376, 7340032, 2097152, 32768, 8, 61952000, 114688, 0, 0, 218104112, 1
    .long 2, 64, 72, 7168, 4352, 4352, 7340032, 3670016, 32768, 8, 67440640, 114688, 0, 0, 218104288, 1
    .long 1, 80, 80, 2048, 1835520, 1835776, 7340032, 67399680, 114688, 7, 175644672, 32768, 218104272, 7, 218106816, 1
    .long 0, 0, 0, 0, 0, 0, 0, 0, 0, 0, 0, 0, 0, 0, 0, 0
    .long 0, 0, 0, 0, 0, 0, 0, 0, 0, 0, 0, 0, 0, 0, 0, 0
    .long 6, 16, 16, 8192, 5888, 268032, 8388608, 0, 32768, 4, 4288512, 131072, 0, 0, 218104400, 1
    .long 4, 16, 16, 8192, 5888, 268032, 8388608, 262144, 32768, 4, 5337088, 131072, 0, 0, 218104528, 1
    .long 4, 16, 16, 8192, 4096, 266240, 8388608, 786432, 32768, 4, 7405568, 131072, 0, 0, 218104640, 1
    .long 1, 24, 24, 8192, 4608, 4864, 8388608, 2097152, 32768, 8, 29433856, 131072, 0, 0, 218105408, 4
    .long 2, 64, 72, 7168, 6656, 6656, 7340032, 524288, 32768, 8, 56467456, 114688, 0, 0, 218103920, 1
    .long 2, 64, 72, 7168, 5632, 5632, 7340032, 2097152, 32768, 8, 61956096, 114688, 0, 0, 218104112, 1
    .long 2, 64, 72, 7168, 4608, 4608, 7340032, 3670016, 32768, 8, 67444736, 114688, 0, 0, 218104288, 1
    .long 1, 80, 80, 2048, 1836032, 1836288, 7340032, 67399680, 114688, 7, 175652864, 32768, 218104272, 7, 218106816, 1
    .long 0, 0, 0, 0, 0, 0, 0, 0, 0, 0, 0, 0, 0, 0, 0, 0
    .long 0, 0, 0, 0, 0, 0, 0, 0, 0, 0, 0, 0, 0, 0, 0, 0
    .long 6, 16, 16, 8192, 7936, 270080, 8388608, 0, 32768, 4, 4321280, 131072, 0, 0, 218104432, 1
    .long 4, 16, 16, 8192, 7936, 270080, 8388608, 262144, 32768, 4, 5369856, 131072, 0, 0, 218104560, 1
    .long 4, 16, 16, 8192, 6144, 268288, 8388608, 786432, 32768, 4, 7438336, 131072, 0, 0, 218104672, 1
    .long 1, 24, 24, 8192, 6656, 6912, 8388608, 2097152, 32768, 8, 29466624, 131072, 0, 0, 218105440, 4
    .long 2, 64, 72, 7168, 6912, 6912, 7340032, 524288, 32768, 8, 56471552, 114688, 0, 0, 218103920, 1
    .long 2, 64, 72, 7168, 5888, 5888, 7340032, 2097152, 32768, 8, 61960192, 114688, 0, 0, 218104112, 1
    .long 2, 64, 72, 7168, 4864, 4864, 7340032, 3670016, 32768, 8, 67448832, 114688, 0, 0, 218104288, 1
    .long 1, 80, 80, 2048, 1836544, 1836800, 7340032, 67399680, 114688, 7, 175661056, 32768, 218104272, 7, 218106816, 1
    .long 0, 0, 0, 0, 0, 0, 0, 0, 0, 0, 0, 0, 0, 0, 0, 0
    .long 0, 0, 0, 0, 0, 0, 0, 0, 0, 0, 0, 0, 0, 0, 0, 0
    .long 1, 32, 32, 8192, 0, 256, 8388608, 524288, 32768, 8, 39845888, 131072, 0, 0, 218104576, 4
    .long 1, 16, 16, 8192, 0, 256, 8388608, 1048576, 32768, 8, 8388608, 131072, 0, 0, 218104832, 4
    .long 1, 24, 24, 8192, 0, 256, 8388608, 2621440, 32768, 8, 31457280, 131072, 0, 0, 218105600, 4
    .long 1, 16, 16, 8192, 0, 256, 8388608, 3145728, 32768, 8, 16777216, 131072, 0, 0, 218105856, 4
    .long 1, 16, 16, 8192, 0, 256, 8388608, 3670016, 32768, 8, 18874368, 131072, 0, 0, 218106112, 4
    .long 1, 80, 80, 2048, 0, 256, 7340032, 58195968, 114688, 7, 168820736, 32768, 218103936, 7, 218106496, 1
    .long 0, 0, 0, 0, 0, 0, 0, 0, 0, 0, 0, 0, 0, 0, 0, 0
    .long 0, 0, 0, 0, 0, 0, 0, 0, 0, 0, 0, 0, 0, 0, 0, 0
    .long 0, 0, 0, 0, 0, 0, 0, 0, 0, 0, 0, 0, 0, 0, 0, 0
    .long 0, 0, 0, 0, 0, 0, 0, 0, 0, 0, 0, 0, 0, 0, 0, 0
    .long 1, 32, 32, 8192, 2048, 2304, 8388608, 524288, 32768, 8, 39878656, 131072, 0, 0, 218104608, 4
    .long 1, 16, 16, 8192, 2048, 2304, 8388608, 1048576, 32768, 8, 8421376, 131072, 0, 0, 218104864, 4
    .long 1, 24, 24, 8192, 2048, 2304, 8388608, 2621440, 32768, 8, 31490048, 131072, 0, 0, 218105632, 4
    .long 1, 16, 16, 8192, 2048, 2304, 8388608, 3145728, 32768, 8, 16809984, 131072, 0, 0, 218105888, 4
    .long 1, 16, 16, 8192, 2048, 2304, 8388608, 3670016, 32768, 8, 18907136, 131072, 0, 0, 218106144, 4
    .long 1, 80, 80, 2048, 1835008, 1835264, 7340032, 58224640, 114688, 7, 173015040, 32768, 218103952, 7, 218106496, 1
    .long 0, 0, 0, 0, 0, 0, 0, 0, 0, 0, 0, 0, 0, 0, 0, 0
    .long 0, 0, 0, 0, 0, 0, 0, 0, 0, 0, 0, 0, 0, 0, 0, 0
    .long 0, 0, 0, 0, 0, 0, 0, 0, 0, 0, 0, 0, 0, 0, 0, 0
    .long 0, 0, 0, 0, 0, 0, 0, 0, 0, 0, 0, 0, 0, 0, 0, 0
    .long 1, 32, 32, 8192, 4096, 4352, 8388608, 524288, 32768, 8, 39911424, 131072, 0, 0, 218104640, 4
    .long 1, 16, 16, 8192, 4096, 4352, 8388608, 1048576, 32768, 8, 8454144, 131072, 0, 0, 218104896, 4
    .long 1, 24, 24, 8192, 4096, 4352, 8388608, 2621440, 32768, 8, 31522816, 131072, 0, 0, 218105664, 4
    .long 1, 16, 16, 8192, 4096, 4352, 8388608, 3145728, 32768, 8, 16842752, 131072, 0, 0, 218105920, 4
    .long 1, 16, 16, 8192, 4096, 4352, 8388608, 3670016, 32768, 8, 18939904, 131072, 0, 0, 218106176, 4
    .long 1, 80, 80, 2048, 3670016, 3670272, 7340032, 58253312, 114688, 7, 177209344, 32768, 218103968, 7, 218106496, 1
    .long 0, 0, 0, 0, 0, 0, 0, 0, 0, 0, 0, 0, 0, 0, 0, 0
    .long 0, 0, 0, 0, 0, 0, 0, 0, 0, 0, 0, 0, 0, 0, 0, 0
    .long 0, 0, 0, 0, 0, 0, 0, 0, 0, 0, 0, 0, 0, 0, 0, 0
    .long 0, 0, 0, 0, 0, 0, 0, 0, 0, 0, 0, 0, 0, 0, 0, 0
    .long 1, 32, 32, 8192, 6144, 6400, 8388608, 524288, 32768, 8, 39944192, 131072, 0, 0, 218104672, 4
    .long 1, 16, 16, 8192, 6144, 6400, 8388608, 1048576, 32768, 8, 8486912, 131072, 0, 0, 218104928, 4
    .long 1, 24, 24, 8192, 6144, 6400, 8388608, 2621440, 32768, 8, 31555584, 131072, 0, 0, 218105696, 4
    .long 1, 16, 16, 8192, 6144, 6400, 8388608, 3145728, 32768, 8, 16875520, 131072, 0, 0, 218105952, 4
    .long 1, 16, 16, 8192, 6144, 6400, 8388608, 3670016, 32768, 8, 18972672, 131072, 0, 0, 218106208, 4
    .long 1, 80, 80, 2048, 5505024, 5505280, 7340032, 58281984, 114688, 7, 181403648, 32768, 218103984, 7, 218106496, 1
    .long 0, 0, 0, 0, 0, 0, 0, 0, 0, 0, 0, 0, 0, 0, 0, 0
    .long 0, 0, 0, 0, 0, 0, 0, 0, 0, 0, 0, 0, 0, 0, 0, 0
    .long 0, 0, 0, 0, 0, 0, 0, 0, 0, 0, 0, 0, 0, 0, 0, 0
    .long 0, 0, 0, 0, 0, 0, 0, 0, 0, 0, 0, 0, 0, 0, 0, 0
    .long 1, 32, 32, 8192, 512, 768, 8388608, 524288, 32768, 8, 39854080, 131072, 0, 0, 218104576, 4
    .long 1, 16, 16, 8192, 512, 768, 8388608, 1048576, 32768, 8, 8396800, 131072, 0, 0, 218104832, 4
    .long 1, 24, 24, 8192, 512, 768, 8388608, 2621440, 32768, 8, 31465472, 131072, 0, 0, 218105600, 4
    .long 1, 16, 16, 8192, 512, 768, 8388608, 3145728, 32768, 8, 16785408, 131072, 0, 0, 218105856, 4
    .long 1, 16, 16, 8192, 512, 768, 8388608, 3670016, 32768, 8, 18882560, 131072, 0, 0, 218106112, 4
    .long 1, 80, 80, 2048, 512, 768, 7340032, 58195968, 114688, 7, 168828928, 32768, 218103936, 7, 218106496, 1
    .long 0, 0, 0, 0, 0, 0, 0, 0, 0, 0, 0, 0, 0, 0, 0, 0
    .long 0, 0, 0, 0, 0, 0, 0, 0, 0, 0, 0, 0, 0, 0, 0, 0
    .long 0, 0, 0, 0, 0, 0, 0, 0, 0, 0, 0, 0, 0, 0, 0, 0
    .long 0, 0, 0, 0, 0, 0, 0, 0, 0, 0, 0, 0, 0, 0, 0, 0
    .long 1, 32, 32, 8192, 2560, 2816, 8388608, 524288, 32768, 8, 39886848, 131072, 0, 0, 218104608, 4
    .long 1, 16, 16, 8192, 2560, 2816, 8388608, 1048576, 32768, 8, 8429568, 131072, 0, 0, 218104864, 4
    .long 1, 24, 24, 8192, 2560, 2816, 8388608, 2621440, 32768, 8, 31498240, 131072, 0, 0, 218105632, 4
    .long 1, 16, 16, 8192, 2560, 2816, 8388608, 3145728, 32768, 8, 16818176, 131072, 0, 0, 218105888, 4
    .long 1, 16, 16, 8192, 2560, 2816, 8388608, 3670016, 32768, 8, 18915328, 131072, 0, 0, 218106144, 4
    .long 1, 80, 80, 2048, 1835520, 1835776, 7340032, 58224640, 114688, 7, 173023232, 32768, 218103952, 7, 218106496, 1
    .long 0, 0, 0, 0, 0, 0, 0, 0, 0, 0, 0, 0, 0, 0, 0, 0
    .long 0, 0, 0, 0, 0, 0, 0, 0, 0, 0, 0, 0, 0, 0, 0, 0
    .long 0, 0, 0, 0, 0, 0, 0, 0, 0, 0, 0, 0, 0, 0, 0, 0
    .long 0, 0, 0, 0, 0, 0, 0, 0, 0, 0, 0, 0, 0, 0, 0, 0
    .long 1, 32, 32, 8192, 4608, 4864, 8388608, 524288, 32768, 8, 39919616, 131072, 0, 0, 218104640, 4
    .long 1, 16, 16, 8192, 4608, 4864, 8388608, 1048576, 32768, 8, 8462336, 131072, 0, 0, 218104896, 4
    .long 1, 24, 24, 8192, 4608, 4864, 8388608, 2621440, 32768, 8, 31531008, 131072, 0, 0, 218105664, 4
    .long 1, 16, 16, 8192, 4608, 4864, 8388608, 3145728, 32768, 8, 16850944, 131072, 0, 0, 218105920, 4
    .long 1, 16, 16, 8192, 4608, 4864, 8388608, 3670016, 32768, 8, 18948096, 131072, 0, 0, 218106176, 4
    .long 1, 80, 80, 2048, 3670528, 3670784, 7340032, 58253312, 114688, 7, 177217536, 32768, 218103968, 7, 218106496, 1
    .long 0, 0, 0, 0, 0, 0, 0, 0, 0, 0, 0, 0, 0, 0, 0, 0
    .long 0, 0, 0, 0, 0, 0, 0, 0, 0, 0, 0, 0, 0, 0, 0, 0
    .long 0, 0, 0, 0, 0, 0, 0, 0, 0, 0, 0, 0, 0, 0, 0, 0
    .long 0, 0, 0, 0, 0, 0, 0, 0, 0, 0, 0, 0, 0, 0, 0, 0
    .long 1, 32, 32, 8192, 6656, 6912, 8388608, 524288, 32768, 8, 39952384, 131072, 0, 0, 218104672, 4
    .long 1, 16, 16, 8192, 6656, 6912, 8388608, 1048576, 32768, 8, 8495104, 131072, 0, 0, 218104928, 4
    .long 1, 24, 24, 8192, 6656, 6912, 8388608, 2621440, 32768, 8, 31563776, 131072, 0, 0, 218105696, 4
    .long 1, 16, 16, 8192, 6656, 6912, 8388608, 3145728, 32768, 8, 16883712, 131072, 0, 0, 218105952, 4
    .long 1, 16, 16, 8192, 6656, 6912, 8388608, 3670016, 32768, 8, 18980864, 131072, 0, 0, 218106208, 4
    .long 1, 80, 80, 2048, 5505536, 5505792, 7340032, 58281984, 114688, 7, 181411840, 32768, 218103984, 7, 218106496, 1
    .long 0, 0, 0, 0, 0, 0, 0, 0, 0, 0, 0, 0, 0, 0, 0, 0
    .long 0, 0, 0, 0, 0, 0, 0, 0, 0, 0, 0, 0, 0, 0, 0, 0
    .long 0, 0, 0, 0, 0, 0, 0, 0, 0, 0, 0, 0, 0, 0, 0, 0
    .long 0, 0, 0, 0, 0, 0, 0, 0, 0, 0, 0, 0, 0, 0, 0, 0
    .long 1, 32, 32, 8192, 1024, 1280, 8388608, 524288, 32768, 8, 39862272, 131072, 0, 0, 218104592, 4
    .long 1, 16, 16, 8192, 1024, 1280, 8388608, 1048576, 32768, 8, 8404992, 131072, 0, 0, 218104848, 4
    .long 1, 24, 24, 8192, 1024, 1280, 8388608, 2621440, 32768, 8, 31473664, 131072, 0, 0, 218105616, 4
    .long 1, 16, 16, 8192, 1024, 1280, 8388608, 3145728, 32768, 8, 16793600, 131072, 0, 0, 218105872, 4
    .long 1, 16, 16, 8192, 1024, 1280, 8388608, 3670016, 32768, 8, 18890752, 131072, 0, 0, 218106128, 4
    .long 1, 80, 80, 2048, 1024, 1280, 7340032, 58195968, 114688, 7, 168837120, 32768, 218103936, 7, 218106496, 1
    .long 0, 0, 0, 0, 0, 0, 0, 0, 0, 0, 0, 0, 0, 0, 0, 0
    .long 0, 0, 0, 0, 0, 0, 0, 0, 0, 0, 0, 0, 0, 0, 0, 0
    .long 0, 0, 0, 0, 0, 0, 0, 0, 0, 0, 0, 0, 0, 0, 0, 0
    .long 0, 0, 0, 0, 0, 0, 0, 0, 0, 0, 0, 0, 0, 0, 0, 0
    .long 1, 32, 32, 8192, 3072, 3328, 8388608, 524288, 32768, 8, 39895040, 131072, 0, 0, 218104624, 4
    .long 1, 16, 16, 8192, 3072, 3328, 8388608, 1048576, 32768, 8, 8437760, 131072, 0, 0, 218104880, 4
    .long 1, 24, 24, 8192, 3072, 3328, 8388608, 2621440, 32768, 8, 31506432, 131072, 0, 0, 218105648, 4
    .long 1, 16, 16, 8192, 3072, 3328, 8388608, 3145728, 32768, 8, 16826368, 131072, 0, 0, 218105904, 4
    .long 1, 16, 16, 8192, 3072, 3328, 8388608, 3670016, 32768, 8, 18923520, 131072, 0, 0, 218106160, 4
    .long 1, 80, 80, 2048, 1836032, 1836288, 7340032, 58224640, 114688, 7, 173031424, 32768, 218103952, 7, 218106496, 1
    .long 0, 0, 0, 0, 0, 0, 0, 0, 0, 0, 0, 0, 0, 0, 0, 0
    .long 0, 0, 0, 0, 0, 0, 0, 0, 0, 0, 0, 0, 0, 0, 0, 0
    .long 0, 0, 0, 0, 0, 0, 0, 0, 0, 0, 0, 0, 0, 0, 0, 0
    .long 0, 0, 0, 0, 0, 0, 0, 0, 0, 0, 0, 0, 0, 0, 0, 0
    .long 1, 32, 32, 8192, 5120, 5376, 8388608, 524288, 32768, 8, 39927808, 131072, 0, 0, 218104656, 4
    .long 1, 16, 16, 8192, 5120, 5376, 8388608, 1048576, 32768, 8, 8470528, 131072, 0, 0, 218104912, 4
    .long 1, 24, 24, 8192, 5120, 5376, 8388608, 2621440, 32768, 8, 31539200, 131072, 0, 0, 218105680, 4
    .long 1, 16, 16, 8192, 5120, 5376, 8388608, 3145728, 32768, 8, 16859136, 131072, 0, 0, 218105936, 4
    .long 1, 16, 16, 8192, 5120, 5376, 8388608, 3670016, 32768, 8, 18956288, 131072, 0, 0, 218106192, 4
    .long 1, 80, 80, 2048, 3671040, 3671296, 7340032, 58253312, 114688, 7, 177225728, 32768, 218103968, 7, 218106496, 1
    .long 0, 0, 0, 0, 0, 0, 0, 0, 0, 0, 0, 0, 0, 0, 0, 0
    .long 0, 0, 0, 0, 0, 0, 0, 0, 0, 0, 0, 0, 0, 0, 0, 0
    .long 0, 0, 0, 0, 0, 0, 0, 0, 0, 0, 0, 0, 0, 0, 0, 0
    .long 0, 0, 0, 0, 0, 0, 0, 0, 0, 0, 0, 0, 0, 0, 0, 0
    .long 1, 32, 32, 8192, 7168, 7424, 8388608, 524288, 32768, 8, 39960576, 131072, 0, 0, 218104688, 4
    .long 1, 16, 16, 8192, 7168, 7424, 8388608, 1048576, 32768, 8, 8503296, 131072, 0, 0, 218104944, 4
    .long 1, 24, 24, 8192, 7168, 7424, 8388608, 2621440, 32768, 8, 31571968, 131072, 0, 0, 218105712, 4
    .long 1, 16, 16, 8192, 7168, 7424, 8388608, 3145728, 32768, 8, 16891904, 131072, 0, 0, 218105968, 4
    .long 1, 16, 16, 8192, 7168, 7424, 8388608, 3670016, 32768, 8, 18989056, 131072, 0, 0, 218106224, 4
    .long 1, 80, 80, 2048, 5506048, 5506304, 7340032, 58281984, 114688, 7, 181420032, 32768, 218103984, 7, 218106496, 1
    .long 0, 0, 0, 0, 0, 0, 0, 0, 0, 0, 0, 0, 0, 0, 0, 0
    .long 0, 0, 0, 0, 0, 0, 0, 0, 0, 0, 0, 0, 0, 0, 0, 0
    .long 0, 0, 0, 0, 0, 0, 0, 0, 0, 0, 0, 0, 0, 0, 0, 0
    .long 0, 0, 0, 0, 0, 0, 0, 0, 0, 0, 0, 0, 0, 0, 0, 0
    .long 1, 32, 32, 8192, 1536, 1792, 8388608, 524288, 32768, 8, 39870464, 131072, 0, 0, 218104592, 4
    .long 1, 16, 16, 8192, 1536, 1792, 8388608, 1048576, 32768, 8, 8413184, 131072, 0, 0, 218104848, 4
    .long 1, 24, 24, 8192, 1536, 1792, 8388608, 2621440, 32768, 8, 31481856, 131072, 0, 0, 218105616, 4
    .long 1, 16, 16, 8192, 1536, 1792, 8388608, 3145728, 32768, 8, 16801792, 131072, 0, 0, 218105872, 4
    .long 1, 16, 16, 8192, 1536, 1792, 8388608, 3670016, 32768, 8, 18898944, 131072, 0, 0, 218106128, 4
    .long 1, 80, 80, 2048, 1536, 1792, 7340032, 58195968, 114688, 7, 168845312, 32768, 218103936, 7, 218106496, 1
    .long 0, 0, 0, 0, 0, 0, 0, 0, 0, 0, 0, 0, 0, 0, 0, 0
    .long 0, 0, 0, 0, 0, 0, 0, 0, 0, 0, 0, 0, 0, 0, 0, 0
    .long 0, 0, 0, 0, 0, 0, 0, 0, 0, 0, 0, 0, 0, 0, 0, 0
    .long 0, 0, 0, 0, 0, 0, 0, 0, 0, 0, 0, 0, 0, 0, 0, 0
    .long 1, 32, 32, 8192, 3584, 3840, 8388608, 524288, 32768, 8, 39903232, 131072, 0, 0, 218104624, 4
    .long 1, 16, 16, 8192, 3584, 3840, 8388608, 1048576, 32768, 8, 8445952, 131072, 0, 0, 218104880, 4
    .long 1, 24, 24, 8192, 3584, 3840, 8388608, 2621440, 32768, 8, 31514624, 131072, 0, 0, 218105648, 4
    .long 1, 16, 16, 8192, 3584, 3840, 8388608, 3145728, 32768, 8, 16834560, 131072, 0, 0, 218105904, 4
    .long 1, 16, 16, 8192, 3584, 3840, 8388608, 3670016, 32768, 8, 18931712, 131072, 0, 0, 218106160, 4
    .long 1, 80, 80, 2048, 1836544, 1836800, 7340032, 58224640, 114688, 7, 173039616, 32768, 218103952, 7, 218106496, 1
    .long 0, 0, 0, 0, 0, 0, 0, 0, 0, 0, 0, 0, 0, 0, 0, 0
    .long 0, 0, 0, 0, 0, 0, 0, 0, 0, 0, 0, 0, 0, 0, 0, 0
    .long 0, 0, 0, 0, 0, 0, 0, 0, 0, 0, 0, 0, 0, 0, 0, 0
    .long 0, 0, 0, 0, 0, 0, 0, 0, 0, 0, 0, 0, 0, 0, 0, 0
    .long 1, 32, 32, 8192, 5632, 5888, 8388608, 524288, 32768, 8, 39936000, 131072, 0, 0, 218104656, 4
    .long 1, 16, 16, 8192, 5632, 5888, 8388608, 1048576, 32768, 8, 8478720, 131072, 0, 0, 218104912, 4
    .long 1, 24, 24, 8192, 5632, 5888, 8388608, 2621440, 32768, 8, 31547392, 131072, 0, 0, 218105680, 4
    .long 1, 16, 16, 8192, 5632, 5888, 8388608, 3145728, 32768, 8, 16867328, 131072, 0, 0, 218105936, 4
    .long 1, 16, 16, 8192, 5632, 5888, 8388608, 3670016, 32768, 8, 18964480, 131072, 0, 0, 218106192, 4
    .long 1, 80, 80, 2048, 3671552, 3671808, 7340032, 58253312, 114688, 7, 177233920, 32768, 218103968, 7, 218106496, 1
    .long 0, 0, 0, 0, 0, 0, 0, 0, 0, 0, 0, 0, 0, 0, 0, 0
    .long 0, 0, 0, 0, 0, 0, 0, 0, 0, 0, 0, 0, 0, 0, 0, 0
    .long 0, 0, 0, 0, 0, 0, 0, 0, 0, 0, 0, 0, 0, 0, 0, 0
    .long 0, 0, 0, 0, 0, 0, 0, 0, 0, 0, 0, 0, 0, 0, 0, 0
    .long 1, 32, 32, 8192, 7680, 7936, 8388608, 524288, 32768, 8, 39968768, 131072, 0, 0, 218104688, 4
    .long 1, 16, 16, 8192, 7680, 7936, 8388608, 1048576, 32768, 8, 8511488, 131072, 0, 0, 218104944, 4
    .long 1, 24, 24, 8192, 7680, 7936, 8388608, 2621440, 32768, 8, 31580160, 131072, 0, 0, 218105712, 4
    .long 1, 16, 16, 8192, 7680, 7936, 8388608, 3145728, 32768, 8, 16900096, 131072, 0, 0, 218105968, 4
    .long 1, 16, 16, 8192, 7680, 7936, 8388608, 3670016, 32768, 8, 18997248, 131072, 0, 0, 218106224, 4
    .long 1, 80, 80, 2048, 5506560, 5506816, 7340032, 58281984, 114688, 7, 181428224, 32768, 218103984, 7, 218106496, 1
    .long 0, 0, 0, 0, 0, 0, 0, 0, 0, 0, 0, 0, 0, 0, 0, 0
    .long 0, 0, 0, 0, 0, 0, 0, 0, 0, 0, 0, 0, 0, 0, 0, 0
    .long 0, 0, 0, 0, 0, 0, 0, 0, 0, 0, 0, 0, 0, 0, 0, 0
    .long 0, 0, 0, 0, 0, 0, 0, 0, 0, 0, 0, 0, 0, 0, 0, 0
    .long 1, 24, 24, 8192, 0, 256, 8388608, 524288, 32768, 8, 23068672, 131072, 0, 0, 218104576, 4
    .long 1, 32, 32, 8192, 0, 256, 8388608, 1572864, 32768, 8, 44040192, 131072, 0, 0, 218105088, 4
    .long 1, 16, 16, 8192, 0, 256, 8388608, 2621440, 32768, 8, 14680064, 131072, 0, 0, 218105600, 4
    .long 2, 64, 72, 7168, 2048, 2048, 7340032, 1048576, 32768, 8, 58228736, 114688, 0, 0, 218103952, 1
    .long 2, 64, 72, 7168, 1024, 1024, 7340032, 2621440, 32768, 8, 63717376, 114688, 0, 0, 218104128, 1
    .long 1, 80, 80, 2048, 0, 256, 7340032, 60030976, 114688, 7, 169345024, 32768, 218104000, 7, 218106560, 1
    .long 0, 0, 0, 0, 0, 0, 0, 0, 0, 0, 0, 0, 0, 0, 0, 0
    .long 0, 0, 0, 0, 0, 0, 0, 0, 0, 0, 0, 0, 0, 0, 0, 0
    .long 0, 0, 0, 0, 0, 0, 0, 0, 0, 0, 0, 0, 0, 0, 0, 0
    .long 0, 0, 0, 0, 0, 0, 0, 0, 0, 0, 0, 0, 0, 0, 0, 0
    .long 1, 24, 24, 8192, 2048, 2304, 8388608, 524288, 32768, 8, 23101440, 131072, 0, 0, 218104608, 4
    .long 1, 32, 32, 8192, 2048, 2304, 8388608, 1572864, 32768, 8, 44072960, 131072, 0, 0, 218105120, 4
    .long 1, 16, 16, 8192, 2048, 2304, 8388608, 2621440, 32768, 8, 14712832, 131072, 0, 0, 218105632, 4
    .long 2, 64, 72, 7168, 2304, 2304, 7340032, 1048576, 32768, 8, 58232832, 114688, 0, 0, 218103952, 1
    .long 2, 64, 72, 7168, 1280, 1280, 7340032, 2621440, 32768, 8, 63721472, 114688, 0, 0, 218104128, 1
    .long 1, 80, 80, 2048, 1835008, 1835264, 7340032, 60059648, 114688, 7, 173539328, 32768, 218104016, 7, 218106560, 1
    .long 0, 0, 0, 0, 0, 0, 0, 0, 0, 0, 0, 0, 0, 0, 0, 0
    .long 0, 0, 0, 0, 0, 0, 0, 0, 0, 0, 0, 0, 0, 0, 0, 0
    .long 0, 0, 0, 0, 0, 0, 0, 0, 0, 0, 0, 0, 0, 0, 0, 0
    .long 0, 0, 0, 0, 0, 0, 0, 0, 0, 0, 0, 0, 0, 0, 0, 0
    .long 1, 24, 24, 8192, 4096, 4352, 8388608, 524288, 32768, 8, 23134208, 131072, 0, 0, 218104640, 4
    .long 1, 32, 32, 8192, 4096, 4352, 8388608, 1572864, 32768, 8, 44105728, 131072, 0, 0, 218105152, 4
    .long 1, 16, 16, 8192, 4096, 4352, 8388608, 2621440, 32768, 8, 14745600, 131072, 0, 0, 218105664, 4
    .long 2, 64, 72, 7168, 2560, 2560, 7340032, 1048576, 32768, 8, 58236928, 114688, 0, 0, 218103952, 1
    .long 2, 64, 72, 7168, 1536, 1536, 7340032, 2621440, 32768, 8, 63725568, 114688, 0, 0, 218104128, 1
    .long 1, 80, 80, 2048, 3670016, 3670272, 7340032, 60088320, 114688, 7, 177733632, 32768, 218104032, 7, 218106560, 1
    .long 0, 0, 0, 0, 0, 0, 0, 0, 0, 0, 0, 0, 0, 0, 0, 0
    .long 0, 0, 0, 0, 0, 0, 0, 0, 0, 0, 0, 0, 0, 0, 0, 0
    .long 0, 0, 0, 0, 0, 0, 0, 0, 0, 0, 0, 0, 0, 0, 0, 0
    .long 0, 0, 0, 0, 0, 0, 0, 0, 0, 0, 0, 0, 0, 0, 0, 0
    .long 1, 24, 24, 8192, 6144, 6400, 8388608, 524288, 32768, 8, 23166976, 131072, 0, 0, 218104672, 4
    .long 1, 32, 32, 8192, 6144, 6400, 8388608, 1572864, 32768, 8, 44138496, 131072, 0, 0, 218105184, 4
    .long 1, 16, 16, 8192, 6144, 6400, 8388608, 2621440, 32768, 8, 14778368, 131072, 0, 0, 218105696, 4
    .long 2, 64, 72, 7168, 2816, 2816, 7340032, 1048576, 32768, 8, 58241024, 114688, 0, 0, 218103952, 1
    .long 2, 64, 72, 7168, 1792, 1792, 7340032, 2621440, 32768, 8, 63729664, 114688, 0, 0, 218104144, 1
    .long 1, 80, 80, 2048, 5505024, 5505280, 7340032, 60116992, 114688, 7, 181927936, 32768, 218104048, 7, 218106560, 1
    .long 0, 0, 0, 0, 0, 0, 0, 0, 0, 0, 0, 0, 0, 0, 0, 0
    .long 0, 0, 0, 0, 0, 0, 0, 0, 0, 0, 0, 0, 0, 0, 0, 0
    .long 0, 0, 0, 0, 0, 0, 0, 0, 0, 0, 0, 0, 0, 0, 0, 0
    .long 0, 0, 0, 0, 0, 0, 0, 0, 0, 0, 0, 0, 0, 0, 0, 0
    .long 1, 24, 24, 8192, 512, 768, 8388608, 524288, 32768, 8, 23076864, 131072, 0, 0, 218104576, 4
    .long 1, 32, 32, 8192, 512, 768, 8388608, 1572864, 32768, 8, 44048384, 131072, 0, 0, 218105088, 4
    .long 1, 16, 16, 8192, 512, 768, 8388608, 2621440, 32768, 8, 14688256, 131072, 0, 0, 218105600, 4
    .long 2, 64, 72, 7168, 3072, 3072, 7340032, 1048576, 32768, 8, 58245120, 114688, 0, 0, 218103952, 1
    .long 2, 64, 72, 7168, 2048, 2048, 7340032, 2621440, 32768, 8, 63733760, 114688, 0, 0, 218104144, 1
    .long 1, 80, 80, 2048, 512, 768, 7340032, 60030976, 114688, 7, 169353216, 32768, 218104000, 7, 218106560, 1
    .long 0, 0, 0, 0, 0, 0, 0, 0, 0, 0, 0, 0, 0, 0, 0, 0
    .long 0, 0, 0, 0, 0, 0, 0, 0, 0, 0, 0, 0, 0, 0, 0, 0
    .long 0, 0, 0, 0, 0, 0, 0, 0, 0, 0, 0, 0, 0, 0, 0, 0
    .long 0, 0, 0, 0, 0, 0, 0, 0, 0, 0, 0, 0, 0, 0, 0, 0
    .long 1, 24, 24, 8192, 2560, 2816, 8388608, 524288, 32768, 8, 23109632, 131072, 0, 0, 218104608, 4
    .long 1, 32, 32, 8192, 2560, 2816, 8388608, 1572864, 32768, 8, 44081152, 131072, 0, 0, 218105120, 4
    .long 1, 16, 16, 8192, 2560, 2816, 8388608, 2621440, 32768, 8, 14721024, 131072, 0, 0, 218105632, 4
    .long 2, 64, 72, 7168, 3328, 3328, 7340032, 1048576, 32768, 8, 58249216, 114688, 0, 0, 218103952, 1
    .long 2, 64, 72, 7168, 2304, 2304, 7340032, 2621440, 32768, 8, 63737856, 114688, 0, 0, 218104144, 1
    .long 1, 80, 80, 2048, 1835520, 1835776, 7340032, 60059648, 114688, 7, 173547520, 32768, 218104016, 7, 218106560, 1
    .long 0, 0, 0, 0, 0, 0, 0, 0, 0, 0, 0, 0, 0, 0, 0, 0
    .long 0, 0, 0, 0, 0, 0, 0, 0, 0, 0, 0, 0, 0, 0, 0, 0
    .long 0, 0, 0, 0, 0, 0, 0, 0, 0, 0, 0, 0, 0, 0, 0, 0
    .long 0, 0, 0, 0, 0, 0, 0, 0, 0, 0, 0, 0, 0, 0, 0, 0
    .long 1, 24, 24, 8192, 4608, 4864, 8388608, 524288, 32768, 8, 23142400, 131072, 0, 0, 218104640, 4
    .long 1, 32, 32, 8192, 4608, 4864, 8388608, 1572864, 32768, 8, 44113920, 131072, 0, 0, 218105152, 4
    .long 1, 16, 16, 8192, 4608, 4864, 8388608, 2621440, 32768, 8, 14753792, 131072, 0, 0, 218105664, 4
    .long 2, 64, 72, 7168, 3584, 3584, 7340032, 1048576, 32768, 8, 58253312, 114688, 0, 0, 218103968, 1
    .long 2, 64, 72, 7168, 2560, 2560, 7340032, 2621440, 32768, 8, 63741952, 114688, 0, 0, 218104144, 1
    .long 1, 80, 80, 2048, 3670528, 3670784, 7340032, 60088320, 114688, 7, 177741824, 32768, 218104032, 7, 218106560, 1
    .long 0, 0, 0, 0, 0, 0, 0, 0, 0, 0, 0, 0, 0, 0, 0, 0
    .long 0, 0, 0, 0, 0, 0, 0, 0, 0, 0, 0, 0, 0, 0, 0, 0
    .long 0, 0, 0, 0, 0, 0, 0, 0, 0, 0, 0, 0, 0, 0, 0, 0
    .long 0, 0, 0, 0, 0, 0, 0, 0, 0, 0, 0, 0, 0, 0, 0, 0
    .long 1, 24, 24, 8192, 6656, 6912, 8388608, 524288, 32768, 8, 23175168, 131072, 0, 0, 218104672, 4
    .long 1, 32, 32, 8192, 6656, 6912, 8388608, 1572864, 32768, 8, 44146688, 131072, 0, 0, 218105184, 4
    .long 1, 16, 16, 8192, 6656, 6912, 8388608, 2621440, 32768, 8, 14786560, 131072, 0, 0, 218105696, 4
    .long 2, 64, 72, 7168, 3840, 3840, 7340032, 1048576, 32768, 8, 58257408, 114688, 0, 0, 218103968, 1
    .long 2, 64, 72, 7168, 2816, 2816, 7340032, 2621440, 32768, 8, 63746048, 114688, 0, 0, 218104144, 1
    .long 1, 80, 80, 2048, 5505536, 5505792, 7340032, 60116992, 114688, 7, 181936128, 32768, 218104048, 7, 218106560, 1
    .long 0, 0, 0, 0, 0, 0, 0, 0, 0, 0, 0, 0, 0, 0, 0, 0
    .long 0, 0, 0, 0, 0, 0, 0, 0, 0, 0, 0, 0, 0, 0, 0, 0
    .long 0, 0, 0, 0, 0, 0, 0, 0, 0, 0, 0, 0, 0, 0, 0, 0
    .long 0, 0, 0, 0, 0, 0, 0, 0, 0, 0, 0, 0, 0, 0, 0, 0
    .long 1, 24, 24, 8192, 1024, 1280, 8388608, 524288, 32768, 8, 23085056, 131072, 0, 0, 218104592, 4
    .long 1, 24, 24, 8192, 1024, 1280, 8388608, 2097152, 32768, 8, 29376512, 131072, 0, 0, 218105360, 4
    .long 2, 64, 72, 7168, 0, 0, 7340032, 1048576, 32768, 8, 58195968, 114688, 0, 0, 218103936, 1
    .long 2, 64, 72, 7168, 6144, 6144, 7340032, 2097152, 32768, 8, 61964288, 114688, 0, 0, 218104112, 1
    .long 2, 64, 72, 7168, 5120, 5120, 7340032, 3670016, 32768, 8, 67452928, 114688, 0, 0, 218104288, 1
    .long 1, 80, 80, 2048, 3670016, 3670272, 7340032, 67428352, 114688, 7, 179830784, 32768, 218104288, 7, 218106816, 1
    .long 0, 0, 0, 0, 0, 0, 0, 0, 0, 0, 0, 0, 0, 0, 0, 0
    .long 0, 0, 0, 0, 0, 0, 0, 0, 0, 0, 0, 0, 0, 0, 0, 0
    .long 0, 0, 0, 0, 0, 0, 0, 0, 0, 0, 0, 0, 0, 0, 0, 0
    .long 0, 0, 0, 0, 0, 0, 0, 0, 0, 0, 0, 0, 0, 0, 0, 0
    .long 1, 24, 24, 8192, 3072, 3328, 8388608, 524288, 32768, 8, 23117824, 131072, 0, 0, 218104624, 4
    .long 1, 24, 24, 8192, 3072, 3328, 8388608, 2097152, 32768, 8, 29409280, 131072, 0, 0, 218105392, 4
    .long 2, 64, 72, 7168, 256, 256, 7340032, 1048576, 32768, 8, 58200064, 114688, 0, 0, 218103936, 1
    .long 2, 64, 72, 7168, 6400, 6400, 7340032, 2097152, 32768, 8, 61968384, 114688, 0, 0, 218104112, 1
    .long 2, 64, 72, 7168, 5376, 5376, 7340032, 3670016, 32768, 8, 67457024, 114688, 0, 0, 218104304, 1
    .long 1, 80, 80, 2048, 3670528, 3670784, 7340032, 67428352, 114688, 7, 179838976, 32768, 218104288, 7, 218106816, 1
    .long 0, 0, 0, 0, 0, 0, 0, 0, 0, 0, 0, 0, 0, 0, 0, 0
    .long 0, 0, 0, 0, 0, 0, 0, 0, 0, 0, 0, 0, 0, 0, 0, 0
    .long 0, 0, 0, 0, 0, 0, 0, 0, 0, 0, 0, 0, 0, 0, 0, 0
    .long 0, 0, 0, 0, 0, 0, 0, 0, 0, 0, 0, 0, 0, 0, 0, 0
    .long 1, 24, 24, 8192, 5120, 5376, 8388608, 524288, 32768, 8, 23150592, 131072, 0, 0, 218104656, 4
    .long 1, 24, 24, 8192, 5120, 5376, 8388608, 2097152, 32768, 8, 29442048, 131072, 0, 0, 218105424, 4
    .long 2, 64, 72, 7168, 512, 512, 7340032, 1048576, 32768, 8, 58204160, 114688, 0, 0, 218103936, 1
    .long 2, 64, 72, 7168, 6656, 6656, 7340032, 2097152, 32768, 8, 61972480, 114688, 0, 0, 218104112, 1
    .long 2, 64, 72, 7168, 5632, 5632, 7340032, 3670016, 32768, 8, 67461120, 114688, 0, 0, 218104304, 1
    .long 1, 80, 80, 2048, 3671040, 3671296, 7340032, 67428352, 114688, 7, 179847168, 32768, 218104288, 7, 218106816, 1
    .long 0, 0, 0, 0, 0, 0, 0, 0, 0, 0, 0, 0, 0, 0, 0, 0
    .long 0, 0, 0, 0, 0, 0, 0, 0, 0, 0, 0, 0, 0, 0, 0, 0
    .long 0, 0, 0, 0, 0, 0, 0, 0, 0, 0, 0, 0, 0, 0, 0, 0
    .long 0, 0, 0, 0, 0, 0, 0, 0, 0, 0, 0, 0, 0, 0, 0, 0
    .long 1, 24, 24, 8192, 7168, 7424, 8388608, 524288, 32768, 8, 23183360, 131072, 0, 0, 218104688, 4
    .long 1, 24, 24, 8192, 7168, 7424, 8388608, 2097152, 32768, 8, 29474816, 131072, 0, 0, 218105456, 4
    .long 2, 64, 72, 7168, 768, 768, 7340032, 1048576, 32768, 8, 58208256, 114688, 0, 0, 218103936, 1
    .long 2, 64, 72, 7168, 6912, 6912, 7340032, 2097152, 32768, 8, 61976576, 114688, 0, 0, 218104112, 1
    .long 2, 64, 72, 7168, 5888, 5888, 7340032, 3670016, 32768, 8, 67465216, 114688, 0, 0, 218104304, 1
    .long 1, 80, 80, 2048, 5505024, 5505280, 7340032, 67457024, 114688, 7, 184025088, 32768, 218104304, 7, 218106816, 1
    .long 0, 0, 0, 0, 0, 0, 0, 0, 0, 0, 0, 0, 0, 0, 0, 0
    .long 0, 0, 0, 0, 0, 0, 0, 0, 0, 0, 0, 0, 0, 0, 0, 0
    .long 0, 0, 0, 0, 0, 0, 0, 0, 0, 0, 0, 0, 0, 0, 0, 0
    .long 0, 0, 0, 0, 0, 0, 0, 0, 0, 0, 0, 0, 0, 0, 0, 0
    .long 1, 24, 24, 8192, 1536, 1792, 8388608, 524288, 32768, 8, 23093248, 131072, 0, 0, 218104592, 4
    .long 1, 24, 24, 8192, 1536, 1792, 8388608, 2097152, 32768, 8, 29384704, 131072, 0, 0, 218105360, 4
    .long 2, 64, 72, 7168, 1024, 1024, 7340032, 1048576, 32768, 8, 58212352, 114688, 0, 0, 218103936, 1
    .long 2, 64, 72, 7168, 0, 0, 7340032, 2621440, 32768, 8, 63700992, 114688, 0, 0, 218104128, 1
    .long 2, 64, 72, 7168, 6144, 6144, 7340032, 3670016, 32768, 8, 67469312, 114688, 0, 0, 218104304, 1
    .long 1, 80, 80, 2048, 3671552, 3671808, 7340032, 67428352, 114688, 7, 179855360, 32768, 218104288, 7, 218106816, 1
    .long 0, 0, 0, 0, 0, 0, 0, 0, 0, 0, 0, 0, 0, 0, 0, 0
    .long 0, 0, 0, 0, 0, 0, 0, 0, 0, 0, 0, 0, 0, 0, 0, 0
    .long 0, 0, 0, 0, 0, 0, 0, 0, 0, 0, 0, 0, 0, 0, 0, 0
    .long 0, 0, 0, 0, 0, 0, 0, 0, 0, 0, 0, 0, 0, 0, 0, 0
    .long 1, 24, 24, 8192, 3584, 3840, 8388608, 524288, 32768, 8, 23126016, 131072, 0, 0, 218104624, 4
    .long 1, 24, 24, 8192, 3584, 3840, 8388608, 2097152, 32768, 8, 29417472, 131072, 0, 0, 218105392, 4
    .long 2, 64, 72, 7168, 1280, 1280, 7340032, 1048576, 32768, 8, 58216448, 114688, 0, 0, 218103936, 1
    .long 2, 64, 72, 7168, 256, 256, 7340032, 2621440, 32768, 8, 63705088, 114688, 0, 0, 218104128, 1
    .long 2, 64, 72, 7168, 6400, 6400, 7340032, 3670016, 32768, 8, 67473408, 114688, 0, 0, 218104304, 1
    .long 1, 80, 80, 2048, 5505536, 5505792, 7340032, 67457024, 114688, 7, 184033280, 32768, 218104304, 7, 218106816, 1
    .long 0, 0, 0, 0, 0, 0, 0, 0, 0, 0, 0, 0, 0, 0, 0, 0
    .long 0, 0, 0, 0, 0, 0, 0, 0, 0, 0, 0, 0, 0, 0, 0, 0
    .long 0, 0, 0, 0, 0, 0, 0, 0, 0, 0, 0, 0, 0, 0, 0, 0
    .long 0, 0, 0, 0, 0, 0, 0, 0, 0, 0, 0, 0, 0, 0, 0, 0
    .long 1, 24, 24, 8192, 5632, 5888, 8388608, 524288, 32768, 8, 23158784, 131072, 0, 0, 218104656, 4
    .long 1, 24, 24, 8192, 5632, 5888, 8388608, 2097152, 32768, 8, 29450240, 131072, 0, 0, 218105424, 4
    .long 2, 64, 72, 7168, 1536, 1536, 7340032, 1048576, 32768, 8, 58220544, 114688, 0, 0, 218103936, 1
    .long 2, 64, 72, 7168, 512, 512, 7340032, 2621440, 32768, 8, 63709184, 114688, 0, 0, 218104128, 1
    .long 2, 64, 72, 7168, 6656, 6656, 7340032, 3670016, 32768, 8, 67477504, 114688, 0, 0, 218104304, 1
    .long 1, 80, 80, 2048, 5506048, 5506304, 7340032, 67457024, 114688, 7, 184041472, 32768, 218104304, 7, 218106816, 1
    .long 0, 0, 0, 0, 0, 0, 0, 0, 0, 0, 0, 0, 0, 0, 0, 0
    .long 0, 0, 0, 0, 0, 0, 0, 0, 0, 0, 0, 0, 0, 0, 0, 0
    .long 0, 0, 0, 0, 0, 0, 0, 0, 0, 0, 0, 0, 0, 0, 0, 0
    .long 0, 0, 0, 0, 0, 0, 0, 0, 0, 0, 0, 0, 0, 0, 0, 0
    .long 1, 24, 24, 8192, 7680, 7936, 8388608, 524288, 32768, 8, 23191552, 131072, 0, 0, 218104688, 4
    .long 1, 24, 24, 8192, 7680, 7936, 8388608, 2097152, 32768, 8, 29483008, 131072, 0, 0, 218105456, 4
    .long 2, 64, 72, 7168, 1792, 1792, 7340032, 1048576, 32768, 8, 58224640, 114688, 0, 0, 218103952, 1
    .long 2, 64, 72, 7168, 768, 768, 7340032, 2621440, 32768, 8, 63713280, 114688, 0, 0, 218104128, 1
    .long 2, 64, 72, 7168, 6912, 6912, 7340032, 3670016, 32768, 8, 67481600, 114688, 0, 0, 218104304, 1
    .long 1, 80, 80, 2048, 5506560, 5506816, 7340032, 67457024, 114688, 7, 184049664, 32768, 218104304, 7, 218106816, 1
    .long 0, 0, 0, 0, 0, 0, 0, 0, 0, 0, 0, 0, 0, 0, 0, 0
    .long 0, 0, 0, 0, 0, 0, 0, 0, 0, 0, 0, 0, 0, 0, 0, 0
    .long 0, 0, 0, 0, 0, 0, 0, 0, 0, 0, 0, 0, 0, 0, 0, 0
    .long 0, 0, 0, 0, 0, 0, 0, 0, 0, 0, 0, 0, 0, 0, 0, 0
.p2align 6
.amdhsa_kernel recurrent_scan__memory_aug_recurrent_mem_tr__glu_gated_glu__prompt_kernel
  .amdhsa_next_free_vgpr 256
  .amdhsa_next_free_sgpr 102
  .amdhsa_accum_offset 256
  .amdhsa_group_segment_fixed_size 0
  .amdhsa_kernarg_size 112
  .amdhsa_user_sgpr_count 2
  .amdhsa_user_sgpr_kernarg_segment_ptr 1
  .amdhsa_system_sgpr_workgroup_id_x 1
  .amdhsa_float_denorm_mode_32 3
.end_amdhsa_kernel
```

```asm
; @launch grid=(256,1,1) block=(512,1,1) lds=163840
.amdgcn_target "amdgcn-amd-amdhsa--gfx950"
.text
.globl recurrent_scan__memory_aug_recurrent_mem_tr__glu_gated_glu__prompt_kernel
.p2align 8
.type recurrent_scan__memory_aug_recurrent_mem_tr__glu_gated_glu__prompt_kernel,@function
recurrent_scan__memory_aug_recurrent_mem_tr__glu_gated_glu__prompt_kernel:
    s_cmp_ge_u32 s2, 256
    s_cbranch_scc1 k_exit
    s_mov_b32 s99, s2
    s_load_dwordx2 s[4:5], s[0:1], 104
    s_load_dwordx2 s[64:65], s[0:1], 96
    v_lshrrev_b32 v2, 6, v0
    s_mov_b32 s6, 268435456
    s_mov_b32 s7, 131072
    s_mov_b32 s66, 256
    s_mov_b32 s67, 131072
    v_readfirstlane_b32 s3, v2
    s_lshr_b32 s12, s2, 3
    s_and_b32 s13, s2, 3
    s_waitcnt lgkmcnt(0)
    s_bitcmp0_b32 s2, 2
    s_cbranch_scc1 chain_map
    s_lshl_b32 s63, s12, 2
    s_add_u32 s63, s63, s13
    s_mov_b32 s29, s63
    v_and_b32 v20, 63, v0
    v_lshlrev_b32 v1, 4, v20
    v_add_u32 v19, 0x1000, v1
    v_lshrrev_b32 v4, 4, v20
    v_mov_b32 v17, 0
    v_mov_b32 v18, 1
    s_lshr_b32 s26, s3, 2
    s_and_b32 s27, s3, 3
    s_lshl_b32 s21, s3, 11
    s_lshl_b32 s22, s3, 10
    s_add_u32 s22, s22, 16384
    s_mov_b32 s11, 131072
    s_mov_b32 s15, 131072
    s_mov_b32 s28, 0
    v_and_b32 v21, 15, v20
    v_lshlrev_b32 v22, 2, v4
    v_xor_b32 v21, v21, v22
    s_lshr_b32 s30, s3, 1
    s_and_b32 s30, s30, 1
    v_xor_b32 v21, s30, v21
    v_lshlrev_b32 v3, 4, v21
    s_lshl_b32 s30, s26, 13
    v_add_u32 v5, s30, v1
    v_add_u32 v6, 0x10000, v5
    v_bfe_u32 v21, v20, 2, 2
    v_and_b32 v22, 3, v20
    v_and_b32 v23, 1, v4
    v_xor_b32 v24, s27, v21
    v_xor_b32 v25, v22, v23
    v_lshl_add_u32 v24, v24, 2, v25
    v_lshlrev_b32 v24, 4, v24
    v_lshl_add_u32 v25, v4, 3, v21
    v_lshl_add_u32 v24, v25, 8, v24
    v_and_b32 v22, 1, v22
    v_xor_b32 v25, 0, v23
    v_lshl_add_u32 v8, v25, 10, v24
    v_xor_b32 v25, 0, v22
    v_lshl_add_u32 v8, v25, 3, v8
    v_add_u32 v12, 0x10000, v8
    v_xor_b32 v25, 1, v23
    v_lshl_add_u32 v9, v25, 10, v24
    v_xor_b32 v25, 0, v22
    v_lshl_add_u32 v9, v25, 3, v9
    v_add_u32 v13, 0x10000, v9
    v_xor_b32 v25, 0, v23
    v_lshl_add_u32 v10, v25, 10, v24
    v_xor_b32 v25, 1, v22
    v_lshl_add_u32 v10, v25, 3, v10
    v_add_u32 v14, 0x10000, v10
    v_xor_b32 v25, 1, v23
    v_lshl_add_u32 v11, v25, 10, v24
    v_xor_b32 v25, 1, v22
    v_lshl_add_u32 v11, v25, 3, v11
    v_add_u32 v15, 0x10000, v11
    s_lshl_b32 s30, s3, 2
    s_add_u32 s30, s30, 131072
    v_mov_b32 v7, s30
    s_getpc_b64 s[24:25]
    s_add_u32 s24, s24, jobtab@rel32@lo+4
    s_addc_u32 s25, s25, jobtab@rel32@hi+12
    s_mul_i32 s30, s29, 640
    s_add_u32 s24, s24, s30
    s_addc_u32 s25, s25, 0
    s_load_dwordx16 s[32:47], s[24:25], 0
    s_add_u32 s24, s24, 64
    s_addc_u32 s25, s25, 0
    s_waitcnt lgkmcnt(0)
    s_mov_b32 s8, s4
    s_mov_b32 s9, s5
    s_mov_b32 s10, 0
    s_mov_b32 s12, s4
    s_mov_b32 s13, s5
    s_mov_b32 s14, 0
    s_load_dwordx2 s[88:89], s[0:1], 0
    s_mov_b32 s90, 4194304
    s_mov_b32 s91, 131072
    s_mov_b32 s98, 0
    v_mov_b32 v22, 0
    s_mov_b32 s70, 1
    v_and_b32 v245, 15, v0
    v_lshlrev_b32 v246, 11, v245
    v_lshl_add_u32 v246, v4, 4, v246
    s_add_u32 s71, s63, 32
    s_and_b32 s71, s71, 127
    s_lshl_b32 s72, s71, 15
    s_lshl_b32 s73, s3, 8
    s_add_u32 s72, s72, s73
    s_waitcnt lgkmcnt(0)
    buffer_load_dwordx4 v[228:231], v246, s[88:91], s72 offen offset:0
    buffer_load_dwordx4 v[232:235], v246, s[88:91], s72 offen offset:64
    buffer_load_dwordx4 v[236:239], v246, s[88:91], s72 offen offset:128
    buffer_load_dwordx4 v[240:243], v246, s[88:91], s72 offen offset:192
    s_cmp_lg_u32 s32, 6
    s_cbranch_scc1 ln_nx
    s_mov_b32 s98, 3
    s_cmp_lg_u32 s32, 6
    s_cbranch_scc1 xs_1
    s_load_dwordx2 s[8:9], s[0:1], s33
    s_load_dwordx2 s[12:13], s[0:1], s34
    s_mov_b32 s10, s38
    s_mov_b32 s14, s38
    s_cmp_ge_u32 s32, 4
    s_cselect_b32 s31, 0, 1
    s_lshl_b32 s30, s3, s31
    s_mul_i32 s30, s30, s40
    s_add_u32 s16, s39, s30
    s_cmp_eq_u32 s32, 4
    s_cselect_b32 s30, 1024, s40
    s_cselect_b32 s31, 6, 5
    s_lshl_b32 s62, 32, s31
    s_add_u32 s17, s16, s30
    s_lshl_b32 s30, s3, 2
    s_mul_i32 s30, s30, s35
    s_add_u32 s18, s36, s30
    s_add_u32 s19, s37, s30
    s_lshl_b32 s20, s35, s31
    v_mul_u32_u24 v2, s35, v4
    v_add_u32 v2, v2, v3
    s_waitcnt lgkmcnt(0)
    s_lshl_b32 s16, s3, 15
    s_add_u32 s16, s16, s39
    s_add_u32 s92, s16, 2048
    s_lshl_b32 s93, s35, 10
    s_lshr_b32 s94, s63, 2
    s_mul_i32 s94, s94, 1
    s_and_b32 s94, s94, 15
    s_lshl_b32 s95, s94, 7
    s_add_u32 s16, s16, s95
    s_lshl_b32 s95, s35, 6
    s_mul_i32 s95, s95, s94
    s_add_u32 s18, s18, s95
    s_add_u32 s19, s19, s95
    s_add_u32 s17, s16, 16384
    s_mov_b32 s62, 128
    s_lshl_b32 s20, s35, 6
    v_lshrrev_b32 v21, 7, v1
    v_bfe_u32 v23, v1, 4, 3
    v_xor_b32 v23, v21, v23
    v_lshlrev_b32 v23, 4, v23
    v_lshl_add_u32 v23, v21, 11, v23
    s_add_u32 m0, s21, 0
    s_nop 0
    buffer_load_dwordx4 v23, s[88:91], s16 offen lds
    s_add_u32 s16, s16, s62
    s_add_u32 m0, s21, 1024
    s_nop 0
    buffer_load_dwordx4 v23, s[88:91], s17 offen lds
    s_add_u32 s17, s17, s62
    s_add_u32 m0, s22, 0
    s_nop 0
    buffer_load_dwordx4 v2, s[8:11], s18 offen lds
    s_add_u32 s18, s18, s20
    s_add_u32 m0, s22, 8192
    s_nop 0
    buffer_load_dwordx4 v2, s[12:15], s19 offen lds
    s_add_u32 s19, s19, s20
    s_cmp_ge_u32 s16, s92
    s_cselect_b32 s94, 2048, 0
    s_cselect_b32 s95, s93, 0
    s_sub_u32 s16, s16, s94
    s_sub_u32 s17, s17, s94
    s_sub_u32 s18, s18, s95
    s_sub_u32 s19, s19, s95
    s_add_u32 m0, s21, 32768
    s_nop 0
    buffer_load_dwordx4 v23, s[88:91], s16 offen lds
    s_add_u32 s16, s16, s62
    s_add_u32 m0, s21, 33792
    s_nop 0
    buffer_load_dwordx4 v23, s[88:91], s17 offen lds
    s_add_u32 s17, s17, s62
    s_add_u32 m0, s22, 32768
    s_nop 0
    buffer_load_dwordx4 v2, s[8:11], s18 offen lds
    s_add_u32 s18, s18, s20
    s_add_u32 m0, s22, 40960
    s_nop 0
    buffer_load_dwordx4 v2, s[12:15], s19 offen lds
    s_add_u32 s19, s19, s20
    s_cmp_ge_u32 s16, s92
    s_cselect_b32 s94, 2048, 0
    s_cselect_b32 s95, s93, 0
    s_sub_u32 s16, s16, s94
    s_sub_u32 s17, s17, s94
    s_sub_u32 s18, s18, s95
    s_sub_u32 s19, s19, s95
    s_add_u32 m0, s21, 65536
    s_nop 0
    buffer_load_dwordx4 v23, s[88:91], s16 offen lds
    s_add_u32 s16, s16, s62
    s_add_u32 m0, s21, 66560
    s_nop 0
    buffer_load_dwordx4 v23, s[88:91], s17 offen lds
    s_add_u32 s17, s17, s62
    s_add_u32 m0, s22, 65536
    s_nop 0
    buffer_load_dwordx4 v2, s[8:11], s18 offen lds
    s_add_u32 s18, s18, s20
    s_add_u32 m0, s22, 73728
    s_nop 0
    buffer_load_dwordx4 v2, s[12:15], s19 offen lds
    s_add_u32 s19, s19, s20
    s_cmp_ge_u32 s16, s92
    s_cselect_b32 s94, 2048, 0
    s_cselect_b32 s95, s93, 0
    s_sub_u32 s16, s16, s94
    s_sub_u32 s17, s17, s94
    s_sub_u32 s18, s18, s95
    s_sub_u32 s19, s19, s95
    s_add_u32 m0, s21, 98304
    s_nop 0
    buffer_load_dwordx4 v23, s[88:91], s16 offen lds
    s_add_u32 s16, s16, s62
    s_add_u32 m0, s21, 99328
    s_nop 0
    buffer_load_dwordx4 v23, s[88:91], s17 offen lds
    s_add_u32 s17, s17, s62
    s_add_u32 m0, s22, 98304
    s_nop 0
    buffer_load_dwordx4 v2, s[8:11], s18 offen lds
    s_add_u32 s18, s18, s20
    s_add_u32 m0, s22, 106496
    s_nop 0
    buffer_load_dwordx4 v2, s[12:15], s19 offen lds
    s_add_u32 s19, s19, s20
    s_cmp_ge_u32 s16, s92
    s_cselect_b32 s94, 2048, 0
    s_cselect_b32 s95, s93, 0
    s_sub_u32 s16, s16, s94
    s_sub_u32 s17, s17, s94
    s_sub_u32 s18, s18, s95
    s_sub_u32 s19, s19, s95
    v_and_b32 v21, 1, v4
    v_lshlrev_b32 v21, 10, v21
    v_xor_b32 v8, v21, v8
    v_xor_b32 v9, v21, v9
    v_xor_b32 v10, v21, v10
    v_xor_b32 v11, v21, v11
    v_xor_b32 v12, v21, v12
    v_xor_b32 v13, v21, v13
    v_xor_b32 v14, v21, v14
    v_xor_b32 v15, v21, v15
xs_1:
    s_branch w_adopt
ln_nx:
    s_lshl_b32 s73, s71, 9
    s_add_u32 s73, s73, 218103808
    v_lshlrev_b32 v252, 2, v0
    s_cmp_ge_u32 s71, 32
    s_cbranch_scc1 ln_nz
    s_cmp_ge_u32 s3, 2
    s_cbranch_scc1 ln_nz
    buffer_store_dword v17, v252, s[4:7], s73 offen sc1
ln_nz:
    s_waitcnt vmcnt(0)
ln_entry:
    v_lshlrev_b32 v247, 5, v245
    v_add_u32 v247, 135168, v247
    s_lshl_b32 s74, s3, 2
    v_add_u32 v248, s74, v247
    s_lshl_b32 s75, s71, 15
    s_lshl_b32 s76, s3, 12
    s_add_u32 s75, s75, s76
    v_and_b32 v249, 1, v4
    v_cmp_eq_u32 s[80:81], 1, v249
    v_lshlrev_b32 v56, 16, v228
    v_and_b32 v57, 0xffff0000, v228
    v_lshlrev_b32 v58, 16, v229
    v_and_b32 v59, 0xffff0000, v229
    v_lshlrev_b32 v60, 16, v230
    v_and_b32 v61, 0xffff0000, v230
    v_lshlrev_b32 v62, 16, v231
    v_and_b32 v63, 0xffff0000, v231
    v_lshlrev_b32 v64, 16, v232
    v_and_b32 v65, 0xffff0000, v232
    v_lshlrev_b32 v66, 16, v233
    v_and_b32 v67, 0xffff0000, v233
    v_lshlrev_b32 v68, 16, v234
    v_and_b32 v69, 0xffff0000, v234
    v_lshlrev_b32 v70, 16, v235
    v_and_b32 v71, 0xffff0000, v235
    v_lshlrev_b32 v72, 16, v236
    v_and_b32 v73, 0xffff0000, v236
    v_lshlrev_b32 v74, 16, v237
    v_and_b32 v75, 0xffff0000, v237
    v_lshlrev_b32 v76, 16, v238
    v_and_b32 v77, 0xffff0000, v238
    v_lshlrev_b32 v78, 16, v239
    v_and_b32 v79, 0xffff0000, v239
    v_lshlrev_b32 v80, 16, v240
    v_and_b32 v81, 0xffff0000, v240
    v_lshlrev_b32 v82, 16, v241
    v_and_b32 v83, 0xffff0000, v241
    v_lshlrev_b32 v84, 16, v242
    v_and_b32 v85, 0xffff0000, v242
    v_lshlrev_b32 v86, 16, v243
    v_and_b32 v87, 0xffff0000, v243
    v_add_f32 v120, v56, v72
    v_add_f32 v121, v57, v73
    v_add_f32 v122, v58, v74
    v_add_f32 v123, v59, v75
    v_add_f32 v124, v60, v76
    v_add_f32 v125, v61, v77
    v_add_f32 v126, v62, v78
    v_add_f32 v127, v63, v79
    v_add_f32 v128, v64, v80
    v_add_f32 v129, v65, v81
    v_add_f32 v130, v66, v82
    v_add_f32 v131, v67, v83
    v_add_f32 v132, v68, v84
    v_add_f32 v133, v69, v85
    v_add_f32 v134, v70, v86
    v_add_f32 v135, v71, v87
    v_add_f32 v120, v120, v128
    v_add_f32 v121, v121, v129
    v_add_f32 v122, v122, v130
    v_add_f32 v123, v123, v131
    v_add_f32 v124, v124, v132
    v_add_f32 v125, v125, v133
    v_add_f32 v126, v126, v134
    v_add_f32 v127, v127, v135
    v_add_f32 v120, v120, v124
    v_add_f32 v121, v121, v125
    v_add_f32 v122, v122, v126
    v_add_f32 v123, v123, v127
    v_add_f32 v120, v120, v122
    v_add_f32 v121, v121, v123
    v_add_f32 v120, v120, v121
    v_mov_b32 v121, v120
    s_nop 1
    v_permlane16_swap_b32 v121, v120
    v_add_f32 v120, v120, v121
    v_mov_b32 v121, v120
    s_nop 1
    v_permlane32_swap_b32 v121, v120
    v_add_f32 v120, v120, v121
    ds_write_b32 v248, v120 offset:0
    s_waitcnt lgkmcnt(0)
    s_barrier
    ds_read_b128 v[120:123], v247 offset:0
    ds_read_b128 v[124:127], v247 offset:16
    s_waitcnt lgkmcnt(0)
    v_add_f32 v120, v120, v124
    v_add_f32 v121, v121, v125
    v_add_f32 v122, v122, v126
    v_add_f32 v123, v123, v127
    v_add_f32 v120, v120, v122
    v_add_f32 v121, v121, v123
    v_add_f32 v120, v120, v121
    v_mul_f32 v250, 0x3a800000, v120
    v_sub_f32 v152, v56, v250
    v_sub_f32 v153, v57, v250
    v_sub_f32 v154, v58, v250
    v_sub_f32 v155, v59, v250
    v_sub_f32 v156, v60, v250
    v_sub_f32 v157, v61, v250
    v_sub_f32 v158, v62, v250
    v_sub_f32 v159, v63, v250
    v_sub_f32 v160, v64, v250
    v_sub_f32 v161, v65, v250
    v_sub_f32 v162, v66, v250
    v_sub_f32 v163, v67, v250
    v_sub_f32 v164, v68, v250
    v_sub_f32 v165, v69, v250
    v_sub_f32 v166, v70, v250
    v_sub_f32 v167, v71, v250
    v_sub_f32 v168, v72, v250
    v_sub_f32 v169, v73, v250
    v_sub_f32 v170, v74, v250
    v_sub_f32 v171, v75, v250
    v_sub_f32 v172, v76, v250
    v_sub_f32 v173, v77, v250
    v_sub_f32 v174, v78, v250
    v_sub_f32 v175, v79, v250
    v_sub_f32 v176, v80, v250
    v_sub_f32 v177, v81, v250
    v_sub_f32 v178, v82, v250
    v_sub_f32 v179, v83, v250
    v_sub_f32 v180, v84, v250
    v_sub_f32 v181, v85, v250
    v_sub_f32 v182, v86, v250
    v_sub_f32 v183, v87, v250
    v_mul_f32 v120, v152, v152
    v_fmac_f32 v120, v168, v168
    v_mul_f32 v121, v153, v153
    v_fmac_f32 v121, v169, v169
    v_mul_f32 v122, v154, v154
    v_fmac_f32 v122, v170, v170
    v_mul_f32 v123, v155, v155
    v_fmac_f32 v123, v171, v171
    v_mul_f32 v124, v156, v156
    v_fmac_f32 v124, v172, v172
    v_mul_f32 v125, v157, v157
    v_fmac_f32 v125, v173, v173
    v_mul_f32 v126, v158, v158
    v_fmac_f32 v126, v174, v174
    v_mul_f32 v127, v159, v159
    v_fmac_f32 v127, v175, v175
    v_mul_f32 v128, v160, v160
    v_fmac_f32 v128, v176, v176
    v_mul_f32 v129, v161, v161
    v_fmac_f32 v129, v177, v177
    v_mul_f32 v130, v162, v162
    v_fmac_f32 v130, v178, v178
    v_mul_f32 v131, v163, v163
    v_fmac_f32 v131, v179, v179
    v_mul_f32 v132, v164, v164
    v_fmac_f32 v132, v180, v180
    v_mul_f32 v133, v165, v165
    v_fmac_f32 v133, v181, v181
    v_mul_f32 v134, v166, v166
    v_fmac_f32 v134, v182, v182
    v_mul_f32 v135, v167, v167
    v_fmac_f32 v135, v183, v183
    v_add_f32 v120, v120, v128
    v_add_f32 v121, v121, v129
    v_add_f32 v122, v122, v130
    v_add_f32 v123, v123, v131
    v_add_f32 v124, v124, v132
    v_add_f32 v125, v125, v133
    v_add_f32 v126, v126, v134
    v_add_f32 v127, v127, v135
    v_add_f32 v120, v120, v124
    v_add_f32 v121, v121, v125
    v_add_f32 v122, v122, v126
    v_add_f32 v123, v123, v127
    v_add_f32 v120, v120, v122
    v_add_f32 v121, v121, v123
    v_add_f32 v120, v120, v121
    v_mov_b32 v121, v120
    s_nop 1
    v_permlane16_swap_b32 v121, v120
    v_add_f32 v120, v120, v121
    v_mov_b32 v121, v120
    s_nop 1
    v_permlane32_swap_b32 v121, v120
    v_add_f32 v120, v120, v121
    ds_write_b32 v248, v120 offset:512
    s_waitcnt lgkmcnt(0)
    s_barrier
    ds_read_b128 v[120:123], v247 offset:512
    ds_read_b128 v[124:127], v247 offset:528
    s_waitcnt lgkmcnt(0)
    v_add_f32 v120, v120, v124
    v_add_f32 v121, v121, v125
    v_add_f32 v122, v122, v126
    v_add_f32 v123, v123, v127
    v_add_f32 v120, v120, v122
    v_add_f32 v121, v121, v123
    v_add_f32 v120, v120, v121
    v_mul_f32 v251, 0x3a800000, v120
    v_cvt_pk_bf16_f32 v250, v250, v250
    v_lshlrev_b32 v250, 16, v250
    v_cvt_pk_bf16_f32 v251, v251, v251
    v_lshlrev_b32 v251, 16, v251
    v_add_f32 v251, 0x3727c5ac, v251
    v_cvt_pk_bf16_f32 v251, v251, v251
    v_lshlrev_b32 v251, 16, v251
    v_sqrt_f32 v251, v251
    s_nop 0
    v_cvt_pk_bf16_f32 v251, v251, v251
    v_lshlrev_b32 v251, 16, v251
    v_rcp_f32 v251, v251
    s_nop 0
    s_cmp_lg_u32 s3, 0
    s_cbranch_scc1 ln_nst
    s_lshl_b32 s77, s71, 7
    s_add_u32 s77, s77, 188743680
    v_lshlrev_b32 v249, 3, v245
    s_mov_b64 exec, 0xffff
    buffer_store_dwordx2 v[250:251], v249, s[4:7], s77 offen sc1
    s_mov_b64 exec, -1
ln_nst:
    v_sub_f32 v56, v56, v250
    v_sub_f32 v57, v57, v250
    v_cvt_pk_bf16_f32 v228, v56, v57
    v_lshlrev_b32 v56, 16, v228
    v_and_b32 v57, 0xffff0000, v228
    v_mul_f32 v56, v56, v251
    v_mul_f32 v57, v57, v251
    v_cvt_pk_bf16_f32 v228, v56, v57
    v_sub_f32 v58, v58, v250
    v_sub_f32 v59, v59, v250
    v_cvt_pk_bf16_f32 v229, v58, v59
    v_lshlrev_b32 v58, 16, v229
    v_and_b32 v59, 0xffff0000, v229
    v_mul_f32 v58, v58, v251
    v_mul_f32 v59, v59, v251
    v_cvt_pk_bf16_f32 v229, v58, v59
    v_sub_f32 v60, v60, v250
    v_sub_f32 v61, v61, v250
    v_cvt_pk_bf16_f32 v230, v60, v61
    v_lshlrev_b32 v60, 16, v230
    v_and_b32 v61, 0xffff0000, v230
    v_mul_f32 v60, v60, v251
    v_mul_f32 v61, v61, v251
    v_cvt_pk_bf16_f32 v230, v60, v61
    v_sub_f32 v62, v62, v250
    v_sub_f32 v63, v63, v250
    v_cvt_pk_bf16_f32 v231, v62, v63
    v_lshlrev_b32 v62, 16, v231
    v_and_b32 v63, 0xffff0000, v231
    v_mul_f32 v62, v62, v251
    v_mul_f32 v63, v63, v251
    v_cvt_pk_bf16_f32 v231, v62, v63
    v_cndmask_b32 v120, v228, v230, s[80:81]
    v_cndmask_b32 v121, v229, v231, s[80:81]
    v_cndmask_b32 v122, v230, v228, s[80:81]
    v_cndmask_b32 v123, v231, v229, s[80:81]
    buffer_store_dwordx4 v[120:123], v1, s[4:7], s75 offen offset:0 sc1
    v_sub_f32 v64, v64, v250
    v_sub_f32 v65, v65, v250
    v_cvt_pk_bf16_f32 v232, v64, v65
    v_lshlrev_b32 v64, 16, v232
    v_and_b32 v65, 0xffff0000, v232
    v_mul_f32 v64, v64, v251
    v_mul_f32 v65, v65, v251
    v_cvt_pk_bf16_f32 v232, v64, v65
    v_sub_f32 v66, v66, v250
    v_sub_f32 v67, v67, v250
    v_cvt_pk_bf16_f32 v233, v66, v67
    v_lshlrev_b32 v66, 16, v233
    v_and_b32 v67, 0xffff0000, v233
    v_mul_f32 v66, v66, v251
    v_mul_f32 v67, v67, v251
    v_cvt_pk_bf16_f32 v233, v66, v67
    v_sub_f32 v68, v68, v250
    v_sub_f32 v69, v69, v250
    v_cvt_pk_bf16_f32 v234, v68, v69
    v_lshlrev_b32 v68, 16, v234
    v_and_b32 v69, 0xffff0000, v234
    v_mul_f32 v68, v68, v251
    v_mul_f32 v69, v69, v251
    v_cvt_pk_bf16_f32 v234, v68, v69
    v_sub_f32 v70, v70, v250
    v_sub_f32 v71, v71, v250
    v_cvt_pk_bf16_f32 v235, v70, v71
    v_lshlrev_b32 v70, 16, v235
    v_and_b32 v71, 0xffff0000, v235
    v_mul_f32 v70, v70, v251
    v_mul_f32 v71, v71, v251
    v_cvt_pk_bf16_f32 v235, v70, v71
    v_cndmask_b32 v124, v232, v234, s[80:81]
    v_cndmask_b32 v125, v233, v235, s[80:81]
    v_cndmask_b32 v126, v234, v232, s[80:81]
    v_cndmask_b32 v127, v235, v233, s[80:81]
    buffer_store_dwordx4 v[124:127], v1, s[4:7], s75 offen offset:1024 sc1
    v_sub_f32 v72, v72, v250
    v_sub_f32 v73, v73, v250
    v_cvt_pk_bf16_f32 v236, v72, v73
    v_lshlrev_b32 v72, 16, v236
    v_and_b32 v73, 0xffff0000, v236
    v_mul_f32 v72, v72, v251
    v_mul_f32 v73, v73, v251
    v_cvt_pk_bf16_f32 v236, v72, v73
    v_sub_f32 v74, v74, v250
    v_sub_f32 v75, v75, v250
    v_cvt_pk_bf16_f32 v237, v74, v75
    v_lshlrev_b32 v74, 16, v237
    v_and_b32 v75, 0xffff0000, v237
    v_mul_f32 v74, v74, v251
    v_mul_f32 v75, v75, v251
    v_cvt_pk_bf16_f32 v237, v74, v75
    v_sub_f32 v76, v76, v250
    v_sub_f32 v77, v77, v250
    v_cvt_pk_bf16_f32 v238, v76, v77
    v_lshlrev_b32 v76, 16, v238
    v_and_b32 v77, 0xffff0000, v238
    v_mul_f32 v76, v76, v251
    v_mul_f32 v77, v77, v251
    v_cvt_pk_bf16_f32 v238, v76, v77
    v_sub_f32 v78, v78, v250
    v_sub_f32 v79, v79, v250
    v_cvt_pk_bf16_f32 v239, v78, v79
    v_lshlrev_b32 v78, 16, v239
    v_and_b32 v79, 0xffff0000, v239
    v_mul_f32 v78, v78, v251
    v_mul_f32 v79, v79, v251
    v_cvt_pk_bf16_f32 v239, v78, v79
    v_cndmask_b32 v128, v236, v238, s[80:81]
    v_cndmask_b32 v129, v237, v239, s[80:81]
    v_cndmask_b32 v130, v238, v236, s[80:81]
    v_cndmask_b32 v131, v239, v237, s[80:81]
    buffer_store_dwordx4 v[128:131], v1, s[4:7], s75 offen offset:2048 sc1
    v_sub_f32 v80, v80, v250
    v_sub_f32 v81, v81, v250
    v_cvt_pk_bf16_f32 v240, v80, v81
    v_lshlrev_b32 v80, 16, v240
    v_and_b32 v81, 0xffff0000, v240
    v_mul_f32 v80, v80, v251
    v_mul_f32 v81, v81, v251
    v_cvt_pk_bf16_f32 v240, v80, v81
    v_sub_f32 v82, v82, v250
    v_sub_f32 v83, v83, v250
    v_cvt_pk_bf16_f32 v241, v82, v83
    v_lshlrev_b32 v82, 16, v241
    v_and_b32 v83, 0xffff0000, v241
    v_mul_f32 v82, v82, v251
    v_mul_f32 v83, v83, v251
    v_cvt_pk_bf16_f32 v241, v82, v83
    v_sub_f32 v84, v84, v250
    v_sub_f32 v85, v85, v250
    v_cvt_pk_bf16_f32 v242, v84, v85
    v_lshlrev_b32 v84, 16, v242
    v_and_b32 v85, 0xffff0000, v242
    v_mul_f32 v84, v84, v251
    v_mul_f32 v85, v85, v251
    v_cvt_pk_bf16_f32 v242, v84, v85
    v_sub_f32 v86, v86, v250
    v_sub_f32 v87, v87, v250
    v_cvt_pk_bf16_f32 v243, v86, v87
    v_lshlrev_b32 v86, 16, v243
    v_and_b32 v87, 0xffff0000, v243
    v_mul_f32 v86, v86, v251
    v_mul_f32 v87, v87, v251
    v_cvt_pk_bf16_f32 v243, v86, v87
    v_cndmask_b32 v132, v240, v242, s[80:81]
    v_cndmask_b32 v133, v241, v243, s[80:81]
    v_cndmask_b32 v134, v242, v240, s[80:81]
    v_cndmask_b32 v135, v243, v241, s[80:81]
    buffer_store_dwordx4 v[132:135], v1, s[4:7], s75 offen offset:3072 sc1
    s_cmp_lg_u32 s98, 1
    s_cbranch_scc1 ln_now
    s_mov_b32 s98, 2
    s_branch w_adopt2
ln_now:
    v_mov_b32 v18, 1
    s_waitcnt vmcnt(0)
    s_barrier
    s_cmp_lg_u32 s3, 0
    s_cbranch_scc1 ln_sig
    s_mov_b64 exec, 1
    s_cmp_ge_u32 s71, 32
    s_cbranch_scc1 ln_sb
    buffer_atomic_add v18, off, s[64:67], 0 offset:192 sc1
ln_sb:
    buffer_atomic_add v18, off, s[64:67], 0 offset:0 sc1
    s_mov_b64 exec, -1
ln_sig:
    s_cmp_lt_u32 s63, 120
    s_cbranch_scc1 prb_done
    s_cmp_lg_u32 s3, 0
    s_cbranch_scc1 prb_bar
    s_sub_u32 s82, s63, 120
    s_lshl_b32 s83, s82, 7
    s_add_u32 s83, s83, 218112000
    s_lshl_b32 s84, s82, 10
    s_add_u32 s84, s84, 209715200
    s_mov_b32 s80, -1
    s_mov_b32 s81, -1
    s_mov_b64 exec, 1
    s_memtime s[74:75]
    s_add_u32 s87, s84, 0
    s_waitcnt lgkmcnt(0)
    buffer_load_dword v20, off, s[4:7], s87 sc1
    s_waitcnt vmcnt(0)
    s_memtime s[76:77]
    s_waitcnt lgkmcnt(0)
    s_sub_u32 s87, s76, s74
    s_min_u32 s80, s80, s87
    s_memtime s[74:75]
    s_add_u32 s87, s84, 8192
    s_waitcnt lgkmcnt(0)
    buffer_load_dword v20, off, s[4:7], s87 sc1
    s_waitcnt vmcnt(0)
    s_memtime s[76:77]
    s_waitcnt lgkmcnt(0)
    s_sub_u32 s87, s76, s74
    s_min_u32 s81, s81, s87
    s_memtime s[74:75]
    s_add_u32 s87, s84, 16384
    s_waitcnt lgkmcnt(0)
    buffer_load_dword v20, off, s[4:7], s87 sc1
    s_waitcnt vmcnt(0)
    s_memtime s[76:77]
    s_waitcnt lgkmcnt(0)
    s_sub_u32 s87, s76, s74
    s_min_u32 s80, s80, s87
    s_memtime s[74:75]
    s_add_u32 s87, s84, 24576
    s_waitcnt lgkmcnt(0)
    buffer_load_dword v20, off, s[4:7], s87 sc1
    s_waitcnt vmcnt(0)
    s_memtime s[76:77]
    s_waitcnt lgkmcnt(0)
    s_sub_u32 s87, s76, s74
    s_min_u32 s81, s81, s87
    s_memtime s[74:75]
    s_add_u32 s87, s84, 32768
    s_waitcnt lgkmcnt(0)
    buffer_load_dword v20, off, s[4:7], s87 sc1
    s_waitcnt vmcnt(0)
    s_memtime s[76:77]
    s_waitcnt lgkmcnt(0)
    s_sub_u32 s87, s76, s74
    s_min_u32 s80, s80, s87
    s_memtime s[74:75]
    s_add_u32 s87, s84, 40960
    s_waitcnt lgkmcnt(0)
    buffer_load_dword v20, off, s[4:7], s87 sc1
    s_waitcnt vmcnt(0)
    s_memtime s[76:77]
    s_waitcnt lgkmcnt(0)
    s_sub_u32 s87, s76, s74
    s_min_u32 s81, s81, s87
    s_memtime s[74:75]
    s_add_u32 s87, s84, 49152
    s_waitcnt lgkmcnt(0)
    buffer_load_dword v20, off, s[4:7], s87 sc1
    s_waitcnt vmcnt(0)
    s_memtime s[76:77]
    s_waitcnt lgkmcnt(0)
    s_sub_u32 s87, s76, s74
    s_min_u32 s80, s80, s87
    s_memtime s[74:75]
    s_add_u32 s87, s84, 57344
    s_waitcnt lgkmcnt(0)
    buffer_load_dword v20, off, s[4:7], s87 sc1
    s_waitcnt vmcnt(0)
    s_memtime s[76:77]
    s_waitcnt lgkmcnt(0)
    s_sub_u32 s87, s76, s74
    s_min_u32 s81, s81, s87
    s_memtime s[74:75]
    s_add_u32 s87, s84, 65536
    s_waitcnt lgkmcnt(0)
    buffer_load_dword v20, off, s[4:7], s87 sc1
    s_waitcnt vmcnt(0)
    s_memtime s[76:77]
    s_waitcnt lgkmcnt(0)
    s_sub_u32 s87, s76, s74
    s_min_u32 s80, s80, s87
    s_memtime s[74:75]
    s_add_u32 s87, s84, 73728
    s_waitcnt lgkmcnt(0)
    buffer_load_dword v20, off, s[4:7], s87 sc1
    s_waitcnt vmcnt(0)
    s_memtime s[76:77]
    s_waitcnt lgkmcnt(0)
    s_sub_u32 s87, s76, s74
    s_min_u32 s81, s81, s87
    s_memtime s[74:75]
    s_add_u32 s87, s84, 81920
    s_waitcnt lgkmcnt(0)
    buffer_load_dword v20, off, s[4:7], s87 sc1
    s_waitcnt vmcnt(0)
    s_memtime s[76:77]
    s_waitcnt lgkmcnt(0)
    s_sub_u32 s87, s76, s74
    s_min_u32 s80, s80, s87
    s_memtime s[74:75]
    s_add_u32 s87, s84, 90112
    s_waitcnt lgkmcnt(0)
    buffer_load_dword v20, off, s[4:7], s87 sc1
    s_waitcnt vmcnt(0)
    s_memtime s[76:77]
    s_waitcnt lgkmcnt(0)
    s_sub_u32 s87, s76, s74
    s_min_u32 s81, s81, s87
    s_sub_i32 s85, s80, s81
    s_min_i32 s85, s85, 400
    s_max_i32 s85, s85, -400
    s_lshl_b32 s85, s85, 8
    s_getreg_b32 s86, hwreg(HW_REG_XCC_ID)
    s_bfe_u32 s86, s86, 0x10002
    s_lshl_b32 s86, s86, 1
    s_or_b32 s85, s85, s86
    s_or_b32 s85, s85, 1
    s_mov_b32 s86, 65536
prb_i:
    buffer_load_dword v20, off, s[64:67], 0 offset:192 sc1
    s_waitcnt vmcnt(0)
    v_readfirstlane_b32 s84, v20
    s_cmp_ge_u32 s84, 32
    s_cbranch_scc1 prb_i_ok
    s_sleep 8
    s_sub_u32 s86, s86, 1
    s_cbranch_scc0 prb_i
prb_i_ok:
    v_mov_b32 v20, s85
    buffer_store_dword v20, off, s[4:7], s83 offset:8 sc1
    s_mov_b64 exec, -1
prb_bar:
    s_barrier
prb_done:
    s_cmp_lt_u32 s32, 4
    s_cbranch_scc1 w_nopre
    s_load_dwordx2 s[8:9], s[0:1], s33
    s_load_dwordx2 s[12:13], s[0:1], s34
    s_mov_b32 s10, s38
    s_mov_b32 s14, s38
    s_cmp_ge_u32 s32, 4
    s_cselect_b32 s31, 0, 1
    s_lshl_b32 s30, s3, s31
    s_mul_i32 s30, s30, s40
    s_add_u32 s16, s39, s30
    s_cmp_eq_u32 s32, 4
    s_cselect_b32 s30, 1024, s40
    s_cselect_b32 s31, 6, 5
    s_lshl_b32 s62, 32, s31
    s_add_u32 s17, s16, s30
    s_lshl_b32 s30, s3, 2
    s_mul_i32 s30, s30, s35
    s_add_u32 s18, s36, s30
    s_add_u32 s19, s37, s30
    s_lshl_b32 s20, s35, s31
    v_mul_u32_u24 v2, s35, v4
    v_add_u32 v2, v2, v3
    s_waitcnt lgkmcnt(0)
    s_add_u32 m0, s22, 0
    s_nop 0
    buffer_load_dwordx4 v2, s[8:11], s18 offen lds
    s_add_u32 s18, s18, s20
    s_add_u32 m0, s22, 8192
    s_nop 0
    buffer_load_dwordx4 v2, s[12:15], s19 offen lds
    s_add_u32 s19, s19, s20
    s_add_u32 m0, s22, 32768
    s_nop 0
    buffer_load_dwordx4 v2, s[8:11], s18 offen lds
    s_add_u32 s18, s18, s20
    s_add_u32 m0, s22, 40960
    s_nop 0
    buffer_load_dwordx4 v2, s[12:15], s19 offen lds
    s_add_u32 s19, s19, s20
    s_add_u32 m0, s22, 65536
    s_nop 0
    buffer_load_dwordx4 v2, s[8:11], s18 offen lds
    s_add_u32 s18, s18, s20
    s_add_u32 m0, s22, 73728
    s_nop 0
    buffer_load_dwordx4 v2, s[12:15], s19 offen lds
    s_add_u32 s19, s19, s20
    s_add_u32 m0, s22, 98304
    s_nop 0
    buffer_load_dwordx4 v2, s[8:11], s18 offen lds
    s_add_u32 s18, s18, s20
    s_add_u32 m0, s22, 106496
    s_nop 0
    buffer_load_dwordx4 v2, s[12:15], s19 offen lds
    s_add_u32 s19, s19, s20
    s_mov_b32 s70, 1
    s_cmp_lt_u32 s39, 1048576
    s_cselect_b32 s70, s70, 0
    s_cmp_lg_u32 s3, 0
    s_cbranch_scc1 lnwp_ok
    s_cmp_eq_u32 s70, 0
    s_cbranch_scc1 lnwp_full
    s_mov_b32 s69, 65536
lnwap:
    buffer_load_dword v20, off, s[64:67], 0 offset:192 sc1
    s_waitcnt vmcnt(0)
    v_readfirstlane_b32 s68, v20
    s_cmp_ge_u32 s68, 32
    s_cbranch_scc1 lnwap_ok
    s_sleep 8
    s_sub_u32 s69, s69, 1
    s_cbranch_scc0 lnwap
lnwap_ok:
    s_branch lnwp_ok
lnwp_full:
    s_mov_b32 s69, 65536
lnwp:
    buffer_load_dword v20, off, s[64:67], 0 offset:0 sc1
    s_waitcnt vmcnt(0)
    v_readfirstlane_b32 s68, v20
    s_cmp_ge_u32 s68, 128
    s_cbranch_scc1 lnwp_ok
    s_sleep 8
    s_sub_u32 s69, s69, 1
    s_cbranch_scc0 lnwp
lnwp_ok:
    s_barrier
    s_add_u32 m0, s21, 0
    s_nop 0
    buffer_load_dwordx4 v1, s[4:7], s16 offen sc1 lds
    s_add_u32 s16, s16, s62
    s_add_u32 m0, s21, 1024
    s_nop 0
    buffer_load_dwordx4 v1, s[4:7], s17 offen sc1 lds
    s_add_u32 s17, s17, s62
    s_add_u32 m0, s21, 32768
    s_nop 0
    buffer_load_dwordx4 v1, s[4:7], s16 offen sc1 lds
    s_add_u32 s16, s16, s62
    s_add_u32 m0, s21, 33792
    s_nop 0
    buffer_load_dwordx4 v1, s[4:7], s17 offen sc1 lds
    s_add_u32 s17, s17, s62
    s_add_u32 m0, s21, 65536
    s_nop 0
    buffer_load_dwordx4 v1, s[4:7], s16 offen sc1 lds
    s_add_u32 s16, s16, s62
    s_add_u32 m0, s21, 66560
    s_nop 0
    buffer_load_dwordx4 v1, s[4:7], s17 offen sc1 lds
    s_add_u32 s17, s17, s62
    s_add_u32 m0, s21, 98304
    s_nop 0
    buffer_load_dwordx4 v1, s[4:7], s16 offen sc1 lds
    s_add_u32 s16, s16, s62
    s_add_u32 m0, s21, 99328
    s_nop 0
    buffer_load_dwordx4 v1, s[4:7], s17 offen sc1 lds
    s_add_u32 s17, s17, s62
    s_branch w_adopt
w_nopre:
    s_mov_b32 s70, 1
    s_cmp_lt_u32 s39, 1048576
    s_cselect_b32 s70, s70, 0
    s_cmp_lg_u32 s3, 0
    s_cbranch_scc1 lnw_ok
    s_cmp_eq_u32 s70, 0
    s_cbranch_scc1 lnw_full
    s_mov_b32 s69, 65536
lnwa:
    buffer_load_dword v20, off, s[64:67], 0 offset:192 sc1
    s_waitcnt vmcnt(0)
    v_readfirstlane_b32 s68, v20
    s_cmp_ge_u32 s68, 32
    s_cbranch_scc1 lnwa_ok
    s_sleep 8
    s_sub_u32 s69, s69, 1
    s_cbranch_scc0 lnwa
lnwa_ok:
    s_branch lnw_ok
lnw_full:
    s_mov_b32 s69, 65536
lnw:
    buffer_load_dword v20, off, s[64:67], 0 offset:0 sc1
    s_waitcnt vmcnt(0)
    v_readfirstlane_b32 s68, v20
    s_cmp_ge_u32 s68, 128
    s_cbranch_scc1 lnw_ok
    s_sleep 8
    s_sub_u32 s69, s69, 1
    s_cbranch_scc0 lnw
lnw_ok:
    s_barrier
w_cold:
    s_cmp_eq_u32 s32, 0
    s_cbranch_scc1 fin_entry
    s_cmp_lg_u32 s3, 0
    s_cbranch_scc1 w_depok
    s_cmp_eq_u32 s45, 0
    s_cbranch_scc1 w_depok
    s_mov_b32 s31, 0x40000
w_waitdep:
    buffer_load_dword v16, v17, s[4:7], s44 offen sc1
    s_waitcnt vmcnt(0)
    v_readfirstlane_b32 s30, v16
    s_cmp_ge_u32 s30, s45
    s_cbranch_scc1 w_depok
    s_sleep 16
    s_sub_u32 s31, s31, 1
    s_cbranch_scc0 w_waitdep
w_depok:
    s_load_dwordx2 s[8:9], s[0:1], s33
    s_load_dwordx2 s[12:13], s[0:1], s34
    s_mov_b32 s10, s38
    s_mov_b32 s14, s38
    s_cmp_ge_u32 s32, 4
    s_cselect_b32 s31, 0, 1
    s_lshl_b32 s30, s3, s31
    s_mul_i32 s30, s30, s40
    s_add_u32 s16, s39, s30
    s_cmp_eq_u32 s32, 4
    s_cselect_b32 s30, 1024, s40
    s_cselect_b32 s31, 6, 5
    s_lshl_b32 s62, 32, s31
    s_add_u32 s17, s16, s30
    s_lshl_b32 s30, s3, 2
    s_mul_i32 s30, s30, s35
    s_add_u32 s18, s36, s30
    s_add_u32 s19, s37, s30
    s_lshl_b32 s20, s35, s31
    v_mul_u32_u24 v2, s35, v4
    v_add_u32 v2, v2, v3
    s_waitcnt lgkmcnt(0)
    s_barrier
    s_add_u32 m0, s21, 0
    s_nop 0
    buffer_load_dwordx4 v1, s[4:7], s16 offen sc1 lds
    s_add_u32 s16, s16, s62
    s_add_u32 m0, s21, 1024
    s_nop 0
    buffer_load_dwordx4 v1, s[4:7], s17 offen sc1 lds
    s_add_u32 s17, s17, s62
    s_add_u32 m0, s22, 0
    s_nop 0
    buffer_load_dwordx4 v2, s[8:11], s18 offen lds
    s_add_u32 s18, s18, s20
    s_add_u32 m0, s22, 8192
    s_nop 0
    buffer_load_dwordx4 v2, s[12:15], s19 offen lds
    s_add_u32 s19, s19, s20
    s_add_u32 m0, s21, 32768
    s_nop 0
    buffer_load_dwordx4 v1, s[4:7], s16 offen sc1 lds
    s_add_u32 s16, s16, s62
    s_add_u32 m0, s21, 33792
    s_nop 0
    buffer_load_dwordx4 v1, s[4:7], s17 offen sc1 lds
    s_add_u32 s17, s17, s62
    s_add_u32 m0, s22, 32768
    s_nop 0
    buffer_load_dwordx4 v2, s[8:11], s18 offen lds
    s_add_u32 s18, s18, s20
    s_add_u32 m0, s22, 40960
    s_nop 0
    buffer_load_dwordx4 v2, s[12:15], s19 offen lds
    s_add_u32 s19, s19, s20
    s_add_u32 m0, s21, 65536
    s_nop 0
    buffer_load_dwordx4 v1, s[4:7], s16 offen sc1 lds
    s_add_u32 s16, s16, s62
    s_add_u32 m0, s21, 66560
    s_nop 0
    buffer_load_dwordx4 v1, s[4:7], s17 offen sc1 lds
    s_add_u32 s17, s17, s62
    s_add_u32 m0, s22, 65536
    s_nop 0
    buffer_load_dwordx4 v2, s[8:11], s18 offen lds
    s_add_u32 s18, s18, s20
    s_add_u32 m0, s22, 73728
    s_nop 0
    buffer_load_dwordx4 v2, s[12:15], s19 offen lds
    s_add_u32 s19, s19, s20
    s_add_u32 m0, s21, 98304
    s_nop 0
    buffer_load_dwordx4 v1, s[4:7], s16 offen sc1 lds
    s_add_u32 s16, s16, s62
    s_add_u32 m0, s21, 99328
    s_nop 0
    buffer_load_dwordx4 v1, s[4:7], s17 offen sc1 lds
    s_add_u32 s17, s17, s62
    s_add_u32 m0, s22, 98304
    s_nop 0
    buffer_load_dwordx4 v2, s[8:11], s18 offen lds
    s_add_u32 s18, s18, s20
    s_add_u32 m0, s22, 106496
    s_nop 0
    buffer_load_dwordx4 v2, s[12:15], s19 offen lds
    s_add_u32 s19, s19, s20
w_adopt:
    s_cmp_eq_u32 s98, 1
    s_cbranch_scc1 ln_entry
w_adopt2:
    s_mov_b32 s48, s32
    s_cmp_ge_u32 s32, 4
    s_cselect_b32 s30, 2, 3
    s_lshl_b32 s30, s26, s30
    s_mul_i32 s30, s30, s43
    s_add_u32 s49, s42, s30
    s_mov_b32 s50, s43
    s_mov_b32 s51, s46
    s_mov_b32 s23, s41
    s_mov_b32 s53, s47
    s_nop 0
    s_load_dwordx16 s[32:47], s[24:25], 0
    s_add_u32 s24, s24, 64
    s_addc_u32 s25, s25, 0
    s_waitcnt vmcnt(0)
    s_cmp_eq_u32 s48, 6
    s_barrier
    s_cbranch_scc1 w_firstX
    s_cmp_lg_u32 s98, 2
    s_cbranch_scc1 lls_done
    s_mov_b32 s98, 0
    s_cmp_lg_u32 s3, 0
    s_cbranch_scc1 lls_done
    v_mov_b32 v20, 1
    s_mov_b64 exec, 1
    buffer_atomic_add v20, off, s[64:67], 0 offset:0 sc1
    s_mov_b64 exec, -1
lls_done:
    ds_read_b64_tr_b16 v[64:65], v8 offset:16384
    ds_read_b64_tr_b16 v[66:67], v9 offset:16384
    ds_read_b64_tr_b16 v[68:69], v10 offset:16384
    ds_read_b64_tr_b16 v[70:71], v11 offset:16384
    ds_read_b64_tr_b16 v[72:73], v8 offset:24576
    ds_read_b64_tr_b16 v[74:75], v9 offset:24576
    ds_read_b64_tr_b16 v[76:77], v10 offset:24576
    ds_read_b64_tr_b16 v[78:79], v11 offset:24576
    ds_read_b128 v[32:35], v5 offset:0
    ds_read_b128 v[36:39], v5 offset:1024
    ds_read_b128 v[40:43], v5 offset:2048
    ds_read_b128 v[44:47], v5 offset:3072
    ds_read_b128 v[48:51], v5 offset:4096
    ds_read_b128 v[52:55], v5 offset:5120
    ds_read_b128 v[56:59], v5 offset:6144
    ds_read_b128 v[60:63], v5 offset:7168
    s_waitcnt lgkmcnt(0)
    s_cmp_eq_u32 s48, 4
    s_cbranch_scc1 w_firstH
    s_cmp_eq_u32 s48, 5
    s_cbranch_scc1 w_firstM
    s_branch w_first16
w_first4:
    s_waitcnt vmcnt(12)
    s_barrier
    v_mfma_f32_16x16x32_bf16 v[128:131], v[64:67], v[32:35], 0
    ds_read_b64_tr_b16 v[112:113], v8 offset:49152
    v_mfma_f32_16x16x32_bf16 v[132:135], v[68:71], v[32:35], 0
    ds_read_b64_tr_b16 v[114:115], v9 offset:49152
    v_mfma_f32_16x16x32_bf16 v[136:139], v[72:75], v[32:35], 0
    ds_read_b64_tr_b16 v[116:117], v10 offset:49152
    v_mfma_f32_16x16x32_bf16 v[140:143], v[76:79], v[32:35], 0
    ds_read_b64_tr_b16 v[118:119], v11 offset:49152
    v_mfma_f32_16x16x32_bf16 v[144:147], v[64:67], v[36:39], 0
    ds_read_b64_tr_b16 v[120:121], v8 offset:57344
    v_mfma_f32_16x16x32_bf16 v[148:151], v[68:71], v[36:39], 0
    ds_read_b64_tr_b16 v[122:123], v9 offset:57344
    v_mfma_f32_16x16x32_bf16 v[152:155], v[72:75], v[36:39], 0
    ds_read_b64_tr_b16 v[124:125], v10 offset:57344
    v_mfma_f32_16x16x32_bf16 v[156:159], v[76:79], v[36:39], 0
    ds_read_b64_tr_b16 v[126:127], v11 offset:57344
    v_mfma_f32_16x16x32_bf16 v[160:163], v[64:67], v[40:43], 0
    ds_read_b128 v[80:83], v5 offset:32768
    v_mfma_f32_16x16x32_bf16 v[164:167], v[68:71], v[40:43], 0
    ds_read_b128 v[84:87], v5 offset:33792
    v_mfma_f32_16x16x32_bf16 v[168:171], v[72:75], v[40:43], 0
    ds_read_b128 v[88:91], v5 offset:34816
    v_mfma_f32_16x16x32_bf16 v[172:175], v[76:79], v[40:43], 0
    ds_read_b128 v[92:95], v5 offset:35840
    v_mfma_f32_16x16x32_bf16 v[176:179], v[64:67], v[44:47], 0
    ds_read_b128 v[96:99], v5 offset:36864
    v_mfma_f32_16x16x32_bf16 v[180:183], v[68:71], v[44:47], 0
    ds_read_b128 v[100:103], v5 offset:37888
    v_mfma_f32_16x16x32_bf16 v[184:187], v[72:75], v[44:47], 0
    ds_read_b128 v[104:107], v5 offset:38912
    v_mfma_f32_16x16x32_bf16 v[188:191], v[76:79], v[44:47], 0
    ds_read_b128 v[108:111], v5 offset:39936
    v_mfma_f32_16x16x32_bf16 v[192:195], v[64:67], v[48:51], 0
    v_mfma_f32_16x16x32_bf16 v[196:199], v[68:71], v[48:51], 0
    s_add_u32 m0, s21, 0
    s_nop 0
    buffer_load_dwordx4 v1, s[4:7], s16 offen sc1 lds
    s_add_u32 s16, s16, s62
    v_mfma_f32_16x16x32_bf16 v[200:203], v[72:75], v[48:51], 0
    v_mfma_f32_16x16x32_bf16 v[204:207], v[76:79], v[48:51], 0
    v_mfma_f32_16x16x32_bf16 v[208:211], v[64:67], v[52:55], 0
    s_add_u32 m0, s21, 1024
    s_nop 0
    buffer_load_dwordx4 v1, s[4:7], s17 offen sc1 lds
    s_add_u32 s17, s17, s62
    v_mfma_f32_16x16x32_bf16 v[212:215], v[68:71], v[52:55], 0
    v_mfma_f32_16x16x32_bf16 v[216:219], v[72:75], v[52:55], 0
    v_mfma_f32_16x16x32_bf16 v[220:223], v[76:79], v[52:55], 0
    s_add_u32 m0, s22, 0
    s_nop 0
    buffer_load_dwordx4 v2, s[8:11], s18 offen lds
    s_add_u32 s18, s18, s20
    v_mfma_f32_16x16x32_bf16 v[224:227], v[64:67], v[56:59], 0
    v_mfma_f32_16x16x32_bf16 v[228:231], v[68:71], v[56:59], 0
    v_mfma_f32_16x16x32_bf16 v[232:235], v[72:75], v[56:59], 0
    s_add_u32 m0, s22, 8192
    s_nop 0
    buffer_load_dwordx4 v2, s[12:15], s19 offen lds
    s_add_u32 s19, s19, s20
    v_mfma_f32_16x16x32_bf16 v[236:239], v[76:79], v[56:59], 0
    v_mfma_f32_16x16x32_bf16 v[240:243], v[64:67], v[60:63], 0
    v_mfma_f32_16x16x32_bf16 v[244:247], v[68:71], v[60:63], 0
    v_mfma_f32_16x16x32_bf16 v[248:251], v[72:75], v[60:63], 0
    v_mfma_f32_16x16x32_bf16 v[252:255], v[76:79], v[60:63], 0
    s_waitcnt lgkmcnt(0)
    s_waitcnt vmcnt(12)
    s_barrier
    v_mfma_f32_16x16x32_bf16 v[128:131], v[112:115], v[80:83], v[128:131]
    ds_read_b64_tr_b16 v[64:65], v12 offset:16384
    v_mfma_f32_16x16x32_bf16 v[132:135], v[116:119], v[80:83], v[132:135]
    ds_read_b64_tr_b16 v[66:67], v13 offset:16384
    v_mfma_f32_16x16x32_bf16 v[136:139], v[120:123], v[80:83], v[136:139]
    ds_read_b64_tr_b16 v[68:69], v14 offset:16384
    v_mfma_f32_16x16x32_bf16 v[140:143], v[124:127], v[80:83], v[140:143]
    ds_read_b64_tr_b16 v[70:71], v15 offset:16384
    v_mfma_f32_16x16x32_bf16 v[144:147], v[112:115], v[84:87], v[144:147]
    ds_read_b64_tr_b16 v[72:73], v12 offset:24576
    v_mfma_f32_16x16x32_bf16 v[148:151], v[116:119], v[84:87], v[148:151]
    ds_read_b64_tr_b16 v[74:75], v13 offset:24576
    v_mfma_f32_16x16x32_bf16 v[152:155], v[120:123], v[84:87], v[152:155]
    ds_read_b64_tr_b16 v[76:77], v14 offset:24576
    v_mfma_f32_16x16x32_bf16 v[156:159], v[124:127], v[84:87], v[156:159]
    ds_read_b64_tr_b16 v[78:79], v15 offset:24576
    v_mfma_f32_16x16x32_bf16 v[160:163], v[112:115], v[88:91], v[160:163]
    ds_read_b128 v[32:35], v6 offset:0
    v_mfma_f32_16x16x32_bf16 v[164:167], v[116:119], v[88:91], v[164:167]
    ds_read_b128 v[36:39], v6 offset:1024
    v_mfma_f32_16x16x32_bf16 v[168:171], v[120:123], v[88:91], v[168:171]
    ds_read_b128 v[40:43], v6 offset:2048
    v_mfma_f32_16x16x32_bf16 v[172:175], v[124:127], v[88:91], v[172:175]
    ds_read_b128 v[44:47], v6 offset:3072
    v_mfma_f32_16x16x32_bf16 v[176:179], v[112:115], v[92:95], v[176:179]
    ds_read_b128 v[48:51], v6 offset:4096
    v_mfma_f32_16x16x32_bf16 v[180:183], v[116:119], v[92:95], v[180:183]
    ds_read_b128 v[52:55], v6 offset:5120
    v_mfma_f32_16x16x32_bf16 v[184:187], v[120:123], v[92:95], v[184:187]
    ds_read_b128 v[56:59], v6 offset:6144
    v_mfma_f32_16x16x32_bf16 v[188:191], v[124:127], v[92:95], v[188:191]
    ds_read_b128 v[60:63], v6 offset:7168
    v_mfma_f32_16x16x32_bf16 v[192:195], v[112:115], v[96:99], v[192:195]
    v_mfma_f32_16x16x32_bf16 v[196:199], v[116:119], v[96:99], v[196:199]
    s_add_u32 m0, s21, 32768
    s_nop 0
    buffer_load_dwordx4 v1, s[4:7], s16 offen sc1 lds
    s_add_u32 s16, s16, s62
    v_mfma_f32_16x16x32_bf16 v[200:203], v[120:123], v[96:99], v[200:203]
    v_mfma_f32_16x16x32_bf16 v[204:207], v[124:127], v[96:99], v[204:207]
    v_mfma_f32_16x16x32_bf16 v[208:211], v[112:115], v[100:103], v[208:211]
    s_add_u32 m0, s21, 33792
    s_nop 0
    buffer_load_dwordx4 v1, s[4:7], s17 offen sc1 lds
    s_add_u32 s17, s17, s62
    v_mfma_f32_16x16x32_bf16 v[212:215], v[116:119], v[100:103], v[212:215]
    v_mfma_f32_16x16x32_bf16 v[216:219], v[120:123], v[100:103], v[216:219]
    v_mfma_f32_16x16x32_bf16 v[220:223], v[124:127], v[100:103], v[220:223]
    s_add_u32 m0, s22, 32768
    s_nop 0
    buffer_load_dwordx4 v2, s[8:11], s18 offen lds
    s_add_u32 s18, s18, s20
    v_mfma_f32_16x16x32_bf16 v[224:227], v[112:115], v[104:107], v[224:227]
    v_mfma_f32_16x16x32_bf16 v[228:231], v[116:119], v[104:107], v[228:231]
    v_mfma_f32_16x16x32_bf16 v[232:235], v[120:123], v[104:107], v[232:235]
    s_add_u32 m0, s22, 40960
    s_nop 0
    buffer_load_dwordx4 v2, s[12:15], s19 offen lds
    s_add_u32 s19, s19, s20
    v_mfma_f32_16x16x32_bf16 v[236:239], v[124:127], v[104:107], v[236:239]
    v_mfma_f32_16x16x32_bf16 v[240:243], v[112:115], v[108:111], v[240:243]
    v_mfma_f32_16x16x32_bf16 v[244:247], v[116:119], v[108:111], v[244:247]
    v_mfma_f32_16x16x32_bf16 v[248:251], v[120:123], v[108:111], v[248:251]
    v_mfma_f32_16x16x32_bf16 v[252:255], v[124:127], v[108:111], v[252:255]
    s_waitcnt lgkmcnt(0)
    s_waitcnt vmcnt(12)
    s_barrier
    v_mfma_f32_16x16x32_bf16 v[128:131], v[64:67], v[32:35], v[128:131]
    ds_read_b64_tr_b16 v[112:113], v12 offset:49152
    v_mfma_f32_16x16x32_bf16 v[132:135], v[68:71], v[32:35], v[132:135]
    ds_read_b64_tr_b16 v[114:115], v13 offset:49152
    v_mfma_f32_16x16x32_bf16 v[136:139], v[72:75], v[32:35], v[136:139]
    ds_read_b64_tr_b16 v[116:117], v14 offset:49152
    v_mfma_f32_16x16x32_bf16 v[140:143], v[76:79], v[32:35], v[140:143]
    ds_read_b64_tr_b16 v[118:119], v15 offset:49152
    v_mfma_f32_16x16x32_bf16 v[144:147], v[64:67], v[36:39], v[144:147]
    ds_read_b64_tr_b16 v[120:121], v12 offset:57344
    v_mfma_f32_16x16x32_bf16 v[148:151], v[68:71], v[36:39], v[148:151]
    ds_read_b64_tr_b16 v[122:123], v13 offset:57344
    v_mfma_f32_16x16x32_bf16 v[152:155], v[72:75], v[36:39], v[152:155]
    ds_read_b64_tr_b16 v[124:125], v14 offset:57344
    v_mfma_f32_16x16x32_bf16 v[156:159], v[76:79], v[36:39], v[156:159]
    ds_read_b64_tr_b16 v[126:127], v15 offset:57344
    v_mfma_f32_16x16x32_bf16 v[160:163], v[64:67], v[40:43], v[160:163]
    ds_read_b128 v[80:83], v6 offset:32768
    v_mfma_f32_16x16x32_bf16 v[164:167], v[68:71], v[40:43], v[164:167]
    ds_read_b128 v[84:87], v6 offset:33792
    v_mfma_f32_16x16x32_bf16 v[168:171], v[72:75], v[40:43], v[168:171]
    ds_read_b128 v[88:91], v6 offset:34816
    v_mfma_f32_16x16x32_bf16 v[172:175], v[76:79], v[40:43], v[172:175]
    ds_read_b128 v[92:95], v6 offset:35840
    v_mfma_f32_16x16x32_bf16 v[176:179], v[64:67], v[44:47], v[176:179]
    ds_read_b128 v[96:99], v6 offset:36864
    v_mfma_f32_16x16x32_bf16 v[180:183], v[68:71], v[44:47], v[180:183]
    ds_read_b128 v[100:103], v6 offset:37888
    v_mfma_f32_16x16x32_bf16 v[184:187], v[72:75], v[44:47], v[184:187]
    ds_read_b128 v[104:107], v6 offset:38912
    v_mfma_f32_16x16x32_bf16 v[188:191], v[76:79], v[44:47], v[188:191]
    ds_read_b128 v[108:111], v6 offset:39936
    v_mfma_f32_16x16x32_bf16 v[192:195], v[64:67], v[48:51], v[192:195]
    v_mfma_f32_16x16x32_bf16 v[196:199], v[68:71], v[48:51], v[196:199]
    s_add_u32 m0, s21, 65536
    s_nop 0
    buffer_load_dwordx4 v1, s[4:7], s16 offen sc1 lds
    s_add_u32 s16, s16, s62
    v_mfma_f32_16x16x32_bf16 v[200:203], v[72:75], v[48:51], v[200:203]
    v_mfma_f32_16x16x32_bf16 v[204:207], v[76:79], v[48:51], v[204:207]
    v_mfma_f32_16x16x32_bf16 v[208:211], v[64:67], v[52:55], v[208:211]
    s_add_u32 m0, s21, 66560
    s_nop 0
    buffer_load_dwordx4 v1, s[4:7], s17 offen sc1 lds
    s_add_u32 s17, s17, s62
    v_mfma_f32_16x16x32_bf16 v[212:215], v[68:71], v[52:55], v[212:215]
    v_mfma_f32_16x16x32_bf16 v[216:219], v[72:75], v[52:55], v[216:219]
    v_mfma_f32_16x16x32_bf16 v[220:223], v[76:79], v[52:55], v[220:223]
    s_add_u32 m0, s22, 65536
    s_nop 0
    buffer_load_dwordx4 v2, s[8:11], s18 offen lds
    s_add_u32 s18, s18, s20
    v_mfma_f32_16x16x32_bf16 v[224:227], v[64:67], v[56:59], v[224:227]
    v_mfma_f32_16x16x32_bf16 v[228:231], v[68:71], v[56:59], v[228:231]
    v_mfma_f32_16x16x32_bf16 v[232:235], v[72:75], v[56:59], v[232:235]
    s_add_u32 m0, s22, 73728
    s_nop 0
    buffer_load_dwordx4 v2, s[12:15], s19 offen lds
    s_add_u32 s19, s19, s20
    v_mfma_f32_16x16x32_bf16 v[236:239], v[76:79], v[56:59], v[236:239]
    v_mfma_f32_16x16x32_bf16 v[240:243], v[64:67], v[60:63], v[240:243]
    v_mfma_f32_16x16x32_bf16 v[244:247], v[68:71], v[60:63], v[244:247]
    v_mfma_f32_16x16x32_bf16 v[248:251], v[72:75], v[60:63], v[248:251]
    v_mfma_f32_16x16x32_bf16 v[252:255], v[76:79], v[60:63], v[252:255]
    s_waitcnt lgkmcnt(0)
    s_waitcnt vmcnt(8)
    s_barrier
    s_cmp_eq_u32 s28, 0
    s_cbranch_scc1 sig_2
    s_cmp_lg_u32 s3, 0
    s_cbranch_scc1 sig_2
    s_mov_b64 exec, 1
    v_mov_b32 v18, s57
    buffer_atomic_add v18, v17, s[4:7], s28 offen sc1
    s_mov_b64 exec, -1
sig_2:
    s_mov_b32 s28, 0
    v_mfma_f32_16x16x32_bf16 v[128:131], v[112:115], v[80:83], v[128:131]
    ds_read_b64_tr_b16 v[64:65], v8 offset:16384
    v_mfma_f32_16x16x32_bf16 v[132:135], v[116:119], v[80:83], v[132:135]
    ds_read_b64_tr_b16 v[66:67], v9 offset:16384
    v_mfma_f32_16x16x32_bf16 v[136:139], v[120:123], v[80:83], v[136:139]
    ds_read_b64_tr_b16 v[68:69], v10 offset:16384
    v_mfma_f32_16x16x32_bf16 v[140:143], v[124:127], v[80:83], v[140:143]
    ds_read_b64_tr_b16 v[70:71], v11 offset:16384
    v_mfma_f32_16x16x32_bf16 v[144:147], v[112:115], v[84:87], v[144:147]
    ds_read_b64_tr_b16 v[72:73], v8 offset:24576
    v_mfma_f32_16x16x32_bf16 v[148:151], v[116:119], v[84:87], v[148:151]
    ds_read_b64_tr_b16 v[74:75], v9 offset:24576
    v_mfma_f32_16x16x32_bf16 v[152:155], v[120:123], v[84:87], v[152:155]
    ds_read_b64_tr_b16 v[76:77], v10 offset:24576
    v_mfma_f32_16x16x32_bf16 v[156:159], v[124:127], v[84:87], v[156:159]
    ds_read_b64_tr_b16 v[78:79], v11 offset:24576
    v_mfma_f32_16x16x32_bf16 v[160:163], v[112:115], v[88:91], v[160:163]
    ds_read_b128 v[32:35], v5 offset:0
    v_mfma_f32_16x16x32_bf16 v[164:167], v[116:119], v[88:91], v[164:167]
    ds_read_b128 v[36:39], v5 offset:1024
    v_mfma_f32_16x16x32_bf16 v[168:171], v[120:123], v[88:91], v[168:171]
    ds_read_b128 v[40:43], v5 offset:2048
    v_mfma_f32_16x16x32_bf16 v[172:175], v[124:127], v[88:91], v[172:175]
    ds_read_b128 v[44:47], v5 offset:3072
    v_mfma_f32_16x16x32_bf16 v[176:179], v[112:115], v[92:95], v[176:179]
    ds_read_b128 v[48:51], v5 offset:4096
    v_mfma_f32_16x16x32_bf16 v[180:183], v[116:119], v[92:95], v[180:183]
    ds_read_b128 v[52:55], v5 offset:5120
    v_mfma_f32_16x16x32_bf16 v[184:187], v[120:123], v[92:95], v[184:187]
    ds_read_b128 v[56:59], v5 offset:6144
    v_mfma_f32_16x16x32_bf16 v[188:191], v[124:127], v[92:95], v[188:191]
    ds_read_b128 v[60:63], v5 offset:7168
    v_mfma_f32_16x16x32_bf16 v[192:195], v[112:115], v[96:99], v[192:195]
    v_mfma_f32_16x16x32_bf16 v[196:199], v[116:119], v[96:99], v[196:199]
    s_add_u32 m0, s21, 98304
    s_nop 0
    buffer_load_dwordx4 v1, s[4:7], s16 offen sc1 lds
    s_add_u32 s16, s16, s62
    v_mfma_f32_16x16x32_bf16 v[200:203], v[120:123], v[96:99], v[200:203]
    v_mfma_f32_16x16x32_bf16 v[204:207], v[124:127], v[96:99], v[204:207]
    v_mfma_f32_16x16x32_bf16 v[208:211], v[112:115], v[100:103], v[208:211]
    s_add_u32 m0, s21, 99328
    s_nop 0
    buffer_load_dwordx4 v1, s[4:7], s17 offen sc1 lds
    s_add_u32 s17, s17, s62
    v_mfma_f32_16x16x32_bf16 v[212:215], v[116:119], v[100:103], v[212:215]
    v_mfma_f32_16x16x32_bf16 v[216:219], v[120:123], v[100:103], v[216:219]
    v_mfma_f32_16x16x32_bf16 v[220:223], v[124:127], v[100:103], v[220:223]
    s_add_u32 m0, s22, 98304
    s_nop 0
    buffer_load_dwordx4 v2, s[8:11], s18 offen lds
    s_add_u32 s18, s18, s20
    v_mfma_f32_16x16x32_bf16 v[224:227], v[112:115], v[104:107], v[224:227]
    v_mfma_f32_16x16x32_bf16 v[228:231], v[116:119], v[104:107], v[228:231]
    v_mfma_f32_16x16x32_bf16 v[232:235], v[120:123], v[104:107], v[232:235]
    s_add_u32 m0, s22, 106496
    s_nop 0
    buffer_load_dwordx4 v2, s[12:15], s19 offen lds
    s_add_u32 s19, s19, s20
    v_mfma_f32_16x16x32_bf16 v[236:239], v[124:127], v[104:107], v[236:239]
    v_mfma_f32_16x16x32_bf16 v[240:243], v[112:115], v[108:111], v[240:243]
    v_mfma_f32_16x16x32_bf16 v[244:247], v[116:119], v[108:111], v[244:247]
    v_mfma_f32_16x16x32_bf16 v[248:251], v[120:123], v[108:111], v[248:251]
    v_mfma_f32_16x16x32_bf16 v[252:255], v[124:127], v[108:111], v[252:255]
    s_waitcnt lgkmcnt(0)
    s_branch w_loop_chk
w_first8:
    s_waitcnt vmcnt(16)
    s_barrier
    v_mfma_f32_16x16x32_bf16 v[128:131], v[64:67], v[32:35], 0
    ds_read_b64_tr_b16 v[112:113], v8 offset:49152
    v_mfma_f32_16x16x32_bf16 v[132:135], v[68:71], v[32:35], 0
    ds_read_b64_tr_b16 v[114:115], v9 offset:49152
    v_mfma_f32_16x16x32_bf16 v[136:139], v[72:75], v[32:35], 0
    ds_read_b64_tr_b16 v[116:117], v10 offset:49152
    v_mfma_f32_16x16x32_bf16 v[140:143], v[76:79], v[32:35], 0
    ds_read_b64_tr_b16 v[118:119], v11 offset:49152
    v_mfma_f32_16x16x32_bf16 v[144:147], v[64:67], v[36:39], 0
    ds_read_b64_tr_b16 v[120:121], v8 offset:57344
    v_mfma_f32_16x16x32_bf16 v[148:151], v[68:71], v[36:39], 0
    ds_read_b64_tr_b16 v[122:123], v9 offset:57344
    v_mfma_f32_16x16x32_bf16 v[152:155], v[72:75], v[36:39], 0
    ds_read_b64_tr_b16 v[124:125], v10 offset:57344
    v_mfma_f32_16x16x32_bf16 v[156:159], v[76:79], v[36:39], 0
    ds_read_b64_tr_b16 v[126:127], v11 offset:57344
    v_mfma_f32_16x16x32_bf16 v[160:163], v[64:67], v[40:43], 0
    ds_read_b128 v[80:83], v5 offset:32768
    v_mfma_f32_16x16x32_bf16 v[164:167], v[68:71], v[40:43], 0
    ds_read_b128 v[84:87], v5 offset:33792
    v_mfma_f32_16x16x32_bf16 v[168:171], v[72:75], v[40:43], 0
    ds_read_b128 v[88:91], v5 offset:34816
    v_mfma_f32_16x16x32_bf16 v[172:175], v[76:79], v[40:43], 0
    ds_read_b128 v[92:95], v5 offset:35840
    v_mfma_f32_16x16x32_bf16 v[176:179], v[64:67], v[44:47], 0
    ds_read_b128 v[96:99], v5 offset:36864
    v_mfma_f32_16x16x32_bf16 v[180:183], v[68:71], v[44:47], 0
    ds_read_b128 v[100:103], v5 offset:37888
    v_mfma_f32_16x16x32_bf16 v[184:187], v[72:75], v[44:47], 0
    ds_read_b128 v[104:107], v5 offset:38912
    v_mfma_f32_16x16x32_bf16 v[188:191], v[76:79], v[44:47], 0
    ds_read_b128 v[108:111], v5 offset:39936
    v_mfma_f32_16x16x32_bf16 v[192:195], v[64:67], v[48:51], 0
    v_mfma_f32_16x16x32_bf16 v[196:199], v[68:71], v[48:51], 0
    s_add_u32 m0, s21, 0
    s_nop 0
    buffer_load_dwordx4 v1, s[4:7], s16 offen sc1 lds
    s_add_u32 s16, s16, s62
    v_mfma_f32_16x16x32_bf16 v[200:203], v[72:75], v[48:51], 0
    v_mfma_f32_16x16x32_bf16 v[204:207], v[76:79], v[48:51], 0
    v_mfma_f32_16x16x32_bf16 v[208:211], v[64:67], v[52:55], 0
    s_add_u32 m0, s21, 1024
    s_nop 0
    buffer_load_dwordx4 v1, s[4:7], s17 offen sc1 lds
    s_add_u32 s17, s17, s62
    v_mfma_f32_16x16x32_bf16 v[212:215], v[68:71], v[52:55], 0
    v_mfma_f32_16x16x32_bf16 v[216:219], v[72:75], v[52:55], 0
    v_mfma_f32_16x16x32_bf16 v[220:223], v[76:79], v[52:55], 0
    s_add_u32 m0, s22, 0
    s_nop 0
    buffer_load_dwordx4 v2, s[8:11], s18 offen lds
    s_add_u32 s18, s18, s20
    v_mfma_f32_16x16x32_bf16 v[224:227], v[64:67], v[56:59], 0
    v_mfma_f32_16x16x32_bf16 v[228:231], v[68:71], v[56:59], 0
    v_mfma_f32_16x16x32_bf16 v[232:235], v[72:75], v[56:59], 0
    s_add_u32 m0, s22, 8192
    s_nop 0
    buffer_load_dwordx4 v2, s[12:15], s19 offen lds
    s_add_u32 s19, s19, s20
    v_mfma_f32_16x16x32_bf16 v[236:239], v[76:79], v[56:59], 0
    v_mfma_f32_16x16x32_bf16 v[240:243], v[64:67], v[60:63], 0
    v_mfma_f32_16x16x32_bf16 v[244:247], v[68:71], v[60:63], 0
    v_mfma_f32_16x16x32_bf16 v[248:251], v[72:75], v[60:63], 0
    v_mfma_f32_16x16x32_bf16 v[252:255], v[76:79], v[60:63], 0
    s_waitcnt lgkmcnt(0)
    s_waitcnt vmcnt(16)
    s_barrier
    v_mfma_f32_16x16x32_bf16 v[128:131], v[112:115], v[80:83], v[128:131]
    ds_read_b64_tr_b16 v[64:65], v12 offset:16384
    v_mfma_f32_16x16x32_bf16 v[132:135], v[116:119], v[80:83], v[132:135]
    ds_read_b64_tr_b16 v[66:67], v13 offset:16384
    v_mfma_f32_16x16x32_bf16 v[136:139], v[120:123], v[80:83], v[136:139]
    ds_read_b64_tr_b16 v[68:69], v14 offset:16384
    v_mfma_f32_16x16x32_bf16 v[140:143], v[124:127], v[80:83], v[140:143]
    ds_read_b64_tr_b16 v[70:71], v15 offset:16384
    v_mfma_f32_16x16x32_bf16 v[144:147], v[112:115], v[84:87], v[144:147]
    ds_read_b64_tr_b16 v[72:73], v12 offset:24576
    v_mfma_f32_16x16x32_bf16 v[148:151], v[116:119], v[84:87], v[148:151]
    ds_read_b64_tr_b16 v[74:75], v13 offset:24576
    v_mfma_f32_16x16x32_bf16 v[152:155], v[120:123], v[84:87], v[152:155]
    ds_read_b64_tr_b16 v[76:77], v14 offset:24576
    v_mfma_f32_16x16x32_bf16 v[156:159], v[124:127], v[84:87], v[156:159]
    ds_read_b64_tr_b16 v[78:79], v15 offset:24576
    v_mfma_f32_16x16x32_bf16 v[160:163], v[112:115], v[88:91], v[160:163]
    ds_read_b128 v[32:35], v6 offset:0
    v_mfma_f32_16x16x32_bf16 v[164:167], v[116:119], v[88:91], v[164:167]
    ds_read_b128 v[36:39], v6 offset:1024
    v_mfma_f32_16x16x32_bf16 v[168:171], v[120:123], v[88:91], v[168:171]
    ds_read_b128 v[40:43], v6 offset:2048
    v_mfma_f32_16x16x32_bf16 v[172:175], v[124:127], v[88:91], v[172:175]
    ds_read_b128 v[44:47], v6 offset:3072
    v_mfma_f32_16x16x32_bf16 v[176:179], v[112:115], v[92:95], v[176:179]
    ds_read_b128 v[48:51], v6 offset:4096
    v_mfma_f32_16x16x32_bf16 v[180:183], v[116:119], v[92:95], v[180:183]
    ds_read_b128 v[52:55], v6 offset:5120
    v_mfma_f32_16x16x32_bf16 v[184:187], v[120:123], v[92:95], v[184:187]
    ds_read_b128 v[56:59], v6 offset:6144
    v_mfma_f32_16x16x32_bf16 v[188:191], v[124:127], v[92:95], v[188:191]
    ds_read_b128 v[60:63], v6 offset:7168
    v_mfma_f32_16x16x32_bf16 v[192:195], v[112:115], v[96:99], v[192:195]
    v_mfma_f32_16x16x32_bf16 v[196:199], v[116:119], v[96:99], v[196:199]
    s_add_u32 m0, s21, 32768
    s_nop 0
    buffer_load_dwordx4 v1, s[4:7], s16 offen sc1 lds
    s_add_u32 s16, s16, s62
    v_mfma_f32_16x16x32_bf16 v[200:203], v[120:123], v[96:99], v[200:203]
    v_mfma_f32_16x16x32_bf16 v[204:207], v[124:127], v[96:99], v[204:207]
    v_mfma_f32_16x16x32_bf16 v[208:211], v[112:115], v[100:103], v[208:211]
    s_add_u32 m0, s21, 33792
    s_nop 0
    buffer_load_dwordx4 v1, s[4:7], s17 offen sc1 lds
    s_add_u32 s17, s17, s62
    v_mfma_f32_16x16x32_bf16 v[212:215], v[116:119], v[100:103], v[212:215]
    v_mfma_f32_16x16x32_bf16 v[216:219], v[120:123], v[100:103], v[216:219]
    v_mfma_f32_16x16x32_bf16 v[220:223], v[124:127], v[100:103], v[220:223]
    s_add_u32 m0, s22, 32768
    s_nop 0
    buffer_load_dwordx4 v2, s[8:11], s18 offen lds
    s_add_u32 s18, s18, s20
    v_mfma_f32_16x16x32_bf16 v[224:227], v[112:115], v[104:107], v[224:227]
    v_mfma_f32_16x16x32_bf16 v[228:231], v[116:119], v[104:107], v[228:231]
    v_mfma_f32_16x16x32_bf16 v[232:235], v[120:123], v[104:107], v[232:235]
    s_add_u32 m0, s22, 40960
    s_nop 0
    buffer_load_dwordx4 v2, s[12:15], s19 offen lds
    s_add_u32 s19, s19, s20
    v_mfma_f32_16x16x32_bf16 v[236:239], v[124:127], v[104:107], v[236:239]
    v_mfma_f32_16x16x32_bf16 v[240:243], v[112:115], v[108:111], v[240:243]
    v_mfma_f32_16x16x32_bf16 v[244:247], v[116:119], v[108:111], v[244:247]
    v_mfma_f32_16x16x32_bf16 v[248:251], v[120:123], v[108:111], v[248:251]
    v_mfma_f32_16x16x32_bf16 v[252:255], v[124:127], v[108:111], v[252:255]
    s_waitcnt lgkmcnt(0)
    s_waitcnt vmcnt(16)
    s_barrier
    v_mfma_f32_16x16x32_bf16 v[128:131], v[64:67], v[32:35], v[128:131]
    ds_read_b64_tr_b16 v[112:113], v12 offset:49152
    v_mfma_f32_16x16x32_bf16 v[132:135], v[68:71], v[32:35], v[132:135]
    ds_read_b64_tr_b16 v[114:115], v13 offset:49152
    v_mfma_f32_16x16x32_bf16 v[136:139], v[72:75], v[32:35], v[136:139]
    ds_read_b64_tr_b16 v[116:117], v14 offset:49152
    v_mfma_f32_16x16x32_bf16 v[140:143], v[76:79], v[32:35], v[140:143]
    ds_read_b64_tr_b16 v[118:119], v15 offset:49152
    v_mfma_f32_16x16x32_bf16 v[144:147], v[64:67], v[36:39], v[144:147]
    ds_read_b64_tr_b16 v[120:121], v12 offset:57344
    v_mfma_f32_16x16x32_bf16 v[148:151], v[68:71], v[36:39], v[148:151]
    ds_read_b64_tr_b16 v[122:123], v13 offset:57344
    v_mfma_f32_16x16x32_bf16 v[152:155], v[72:75], v[36:39], v[152:155]
    ds_read_b64_tr_b16 v[124:125], v14 offset:57344
    v_mfma_f32_16x16x32_bf16 v[156:159], v[76:79], v[36:39], v[156:159]
    ds_read_b64_tr_b16 v[126:127], v15 offset:57344
    v_mfma_f32_16x16x32_bf16 v[160:163], v[64:67], v[40:43], v[160:163]
    ds_read_b128 v[80:83], v6 offset:32768
    v_mfma_f32_16x16x32_bf16 v[164:167], v[68:71], v[40:43], v[164:167]
    ds_read_b128 v[84:87], v6 offset:33792
    v_mfma_f32_16x16x32_bf16 v[168:171], v[72:75], v[40:43], v[168:171]
    ds_read_b128 v[88:91], v6 offset:34816
    v_mfma_f32_16x16x32_bf16 v[172:175], v[76:79], v[40:43], v[172:175]
    ds_read_b128 v[92:95], v6 offset:35840
    v_mfma_f32_16x16x32_bf16 v[176:179], v[64:67], v[44:47], v[176:179]
    ds_read_b128 v[96:99], v6 offset:36864
    v_mfma_f32_16x16x32_bf16 v[180:183], v[68:71], v[44:47], v[180:183]
    ds_read_b128 v[100:103], v6 offset:37888
    v_mfma_f32_16x16x32_bf16 v[184:187], v[72:75], v[44:47], v[184:187]
    ds_read_b128 v[104:107], v6 offset:38912
    v_mfma_f32_16x16x32_bf16 v[188:191], v[76:79], v[44:47], v[188:191]
    ds_read_b128 v[108:111], v6 offset:39936
    v_mfma_f32_16x16x32_bf16 v[192:195], v[64:67], v[48:51], v[192:195]
    v_mfma_f32_16x16x32_bf16 v[196:199], v[68:71], v[48:51], v[196:199]
    s_add_u32 m0, s21, 65536
    s_nop 0
    buffer_load_dwordx4 v1, s[4:7], s16 offen sc1 lds
    s_add_u32 s16, s16, s62
    v_mfma_f32_16x16x32_bf16 v[200:203], v[72:75], v[48:51], v[200:203]
    v_mfma_f32_16x16x32_bf16 v[204:207], v[76:79], v[48:51], v[204:207]
    v_mfma_f32_16x16x32_bf16 v[208:211], v[64:67], v[52:55], v[208:211]
    s_add_u32 m0, s21, 66560
    s_nop 0
    buffer_load_dwordx4 v1, s[4:7], s17 offen sc1 lds
    s_add_u32 s17, s17, s62
    v_mfma_f32_16x16x32_bf16 v[212:215], v[68:71], v[52:55], v[212:215]
    v_mfma_f32_16x16x32_bf16 v[216:219], v[72:75], v[52:55], v[216:219]
    v_mfma_f32_16x16x32_bf16 v[220:223], v[76:79], v[52:55], v[220:223]
    s_add_u32 m0, s22, 65536
    s_nop 0
    buffer_load_dwordx4 v2, s[8:11], s18 offen lds
    s_add_u32 s18, s18, s20
    v_mfma_f32_16x16x32_bf16 v[224:227], v[64:67], v[56:59], v[224:227]
    v_mfma_f32_16x16x32_bf16 v[228:231], v[68:71], v[56:59], v[228:231]
    v_mfma_f32_16x16x32_bf16 v[232:235], v[72:75], v[56:59], v[232:235]
    s_add_u32 m0, s22, 73728
    s_nop 0
    buffer_load_dwordx4 v2, s[12:15], s19 offen lds
    s_add_u32 s19, s19, s20
    v_mfma_f32_16x16x32_bf16 v[236:239], v[76:79], v[56:59], v[236:239]
    v_mfma_f32_16x16x32_bf16 v[240:243], v[64:67], v[60:63], v[240:243]
    v_mfma_f32_16x16x32_bf16 v[244:247], v[68:71], v[60:63], v[244:247]
    v_mfma_f32_16x16x32_bf16 v[248:251], v[72:75], v[60:63], v[248:251]
    v_mfma_f32_16x16x32_bf16 v[252:255], v[76:79], v[60:63], v[252:255]
    s_waitcnt lgkmcnt(0)
    s_waitcnt vmcnt(8)
    s_barrier
    s_cmp_eq_u32 s28, 0
    s_cbranch_scc1 sig_3
    s_cmp_lg_u32 s3, 0
    s_cbranch_scc1 sig_3
    s_mov_b64 exec, 1
    v_mov_b32 v18, s57
    buffer_atomic_add v18, v17, s[4:7], s28 offen sc1
    s_mov_b64 exec, -1
sig_3:
    s_mov_b32 s28, 0
    v_mfma_f32_16x16x32_bf16 v[128:131], v[112:115], v[80:83], v[128:131]
    ds_read_b64_tr_b16 v[64:65], v8 offset:16384
    v_mfma_f32_16x16x32_bf16 v[132:135], v[116:119], v[80:83], v[132:135]
    ds_read_b64_tr_b16 v[66:67], v9 offset:16384
    v_mfma_f32_16x16x32_bf16 v[136:139], v[120:123], v[80:83], v[136:139]
    ds_read_b64_tr_b16 v[68:69], v10 offset:16384
    v_mfma_f32_16x16x32_bf16 v[140:143], v[124:127], v[80:83], v[140:143]
    ds_read_b64_tr_b16 v[70:71], v11 offset:16384
    v_mfma_f32_16x16x32_bf16 v[144:147], v[112:115], v[84:87], v[144:147]
    ds_read_b64_tr_b16 v[72:73], v8 offset:24576
    v_mfma_f32_16x16x32_bf16 v[148:151], v[116:119], v[84:87], v[148:151]
    ds_read_b64_tr_b16 v[74:75], v9 offset:24576
    v_mfma_f32_16x16x32_bf16 v[152:155], v[120:123], v[84:87], v[152:155]
    ds_read_b64_tr_b16 v[76:77], v10 offset:24576
    v_mfma_f32_16x16x32_bf16 v[156:159], v[124:127], v[84:87], v[156:159]
    ds_read_b64_tr_b16 v[78:79], v11 offset:24576
    v_mfma_f32_16x16x32_bf16 v[160:163], v[112:115], v[88:91], v[160:163]
    ds_read_b128 v[32:35], v5 offset:0
    v_mfma_f32_16x16x32_bf16 v[164:167], v[116:119], v[88:91], v[164:167]
    ds_read_b128 v[36:39], v5 offset:1024
    v_mfma_f32_16x16x32_bf16 v[168:171], v[120:123], v[88:91], v[168:171]
    ds_read_b128 v[40:43], v5 offset:2048
    v_mfma_f32_16x16x32_bf16 v[172:175], v[124:127], v[88:91], v[172:175]
    ds_read_b128 v[44:47], v5 offset:3072
    v_mfma_f32_16x16x32_bf16 v[176:179], v[112:115], v[92:95], v[176:179]
    ds_read_b128 v[48:51], v5 offset:4096
    v_mfma_f32_16x16x32_bf16 v[180:183], v[116:119], v[92:95], v[180:183]
    ds_read_b128 v[52:55], v5 offset:5120
    v_mfma_f32_16x16x32_bf16 v[184:187], v[120:123], v[92:95], v[184:187]
    ds_read_b128 v[56:59], v5 offset:6144
    v_mfma_f32_16x16x32_bf16 v[188:191], v[124:127], v[92:95], v[188:191]
    ds_read_b128 v[60:63], v5 offset:7168
    v_mfma_f32_16x16x32_bf16 v[192:195], v[112:115], v[96:99], v[192:195]
    v_mfma_f32_16x16x32_bf16 v[196:199], v[116:119], v[96:99], v[196:199]
    s_add_u32 m0, s21, 98304
    s_nop 0
    buffer_load_dwordx4 v1, s[4:7], s16 offen sc1 lds
    s_add_u32 s16, s16, s62
    v_mfma_f32_16x16x32_bf16 v[200:203], v[120:123], v[96:99], v[200:203]
    v_mfma_f32_16x16x32_bf16 v[204:207], v[124:127], v[96:99], v[204:207]
    v_mfma_f32_16x16x32_bf16 v[208:211], v[112:115], v[100:103], v[208:211]
    s_add_u32 m0, s21, 99328
    s_nop 0
    buffer_load_dwordx4 v1, s[4:7], s17 offen sc1 lds
    s_add_u32 s17, s17, s62
    v_mfma_f32_16x16x32_bf16 v[212:215], v[116:119], v[100:103], v[212:215]
    v_mfma_f32_16x16x32_bf16 v[216:219], v[120:123], v[100:103], v[216:219]
    v_mfma_f32_16x16x32_bf16 v[220:223], v[124:127], v[100:103], v[220:223]
    s_add_u32 m0, s22, 98304
    s_nop 0
    buffer_load_dwordx4 v2, s[8:11], s18 offen lds
    s_add_u32 s18, s18, s20
    v_mfma_f32_16x16x32_bf16 v[224:227], v[112:115], v[104:107], v[224:227]
    v_mfma_f32_16x16x32_bf16 v[228:231], v[116:119], v[104:107], v[228:231]
    v_mfma_f32_16x16x32_bf16 v[232:235], v[120:123], v[104:107], v[232:235]
    s_add_u32 m0, s22, 106496
    s_nop 0
    buffer_load_dwordx4 v2, s[12:15], s19 offen lds
    s_add_u32 s19, s19, s20
    v_mfma_f32_16x16x32_bf16 v[236:239], v[124:127], v[104:107], v[236:239]
    v_mfma_f32_16x16x32_bf16 v[240:243], v[112:115], v[108:111], v[240:243]
    v_mfma_f32_16x16x32_bf16 v[244:247], v[116:119], v[108:111], v[244:247]
    v_mfma_f32_16x16x32_bf16 v[248:251], v[120:123], v[108:111], v[248:251]
    v_mfma_f32_16x16x32_bf16 v[252:255], v[124:127], v[108:111], v[252:255]
    s_waitcnt lgkmcnt(0)
    s_branch w_loop_chk
w_first16:
    s_waitcnt vmcnt(24)
    s_barrier
    v_mfma_f32_16x16x32_bf16 v[128:131], v[64:67], v[32:35], 0
    ds_read_b64_tr_b16 v[112:113], v8 offset:49152
    v_mfma_f32_16x16x32_bf16 v[132:135], v[68:71], v[32:35], 0
    ds_read_b64_tr_b16 v[114:115], v9 offset:49152
    v_mfma_f32_16x16x32_bf16 v[136:139], v[72:75], v[32:35], 0
    ds_read_b64_tr_b16 v[116:117], v10 offset:49152
    v_mfma_f32_16x16x32_bf16 v[140:143], v[76:79], v[32:35], 0
    ds_read_b64_tr_b16 v[118:119], v11 offset:49152
    v_mfma_f32_16x16x32_bf16 v[144:147], v[64:67], v[36:39], 0
    ds_read_b64_tr_b16 v[120:121], v8 offset:57344
    v_mfma_f32_16x16x32_bf16 v[148:151], v[68:71], v[36:39], 0
    ds_read_b64_tr_b16 v[122:123], v9 offset:57344
    v_mfma_f32_16x16x32_bf16 v[152:155], v[72:75], v[36:39], 0
    ds_read_b64_tr_b16 v[124:125], v10 offset:57344
    v_mfma_f32_16x16x32_bf16 v[156:159], v[76:79], v[36:39], 0
    ds_read_b64_tr_b16 v[126:127], v11 offset:57344
    v_mfma_f32_16x16x32_bf16 v[160:163], v[64:67], v[40:43], 0
    ds_read_b128 v[80:83], v5 offset:32768
    v_mfma_f32_16x16x32_bf16 v[164:167], v[68:71], v[40:43], 0
    ds_read_b128 v[84:87], v5 offset:33792
    v_mfma_f32_16x16x32_bf16 v[168:171], v[72:75], v[40:43], 0
    ds_read_b128 v[88:91], v5 offset:34816
    v_mfma_f32_16x16x32_bf16 v[172:175], v[76:79], v[40:43], 0
    ds_read_b128 v[92:95], v5 offset:35840
    v_mfma_f32_16x16x32_bf16 v[176:179], v[64:67], v[44:47], 0
    ds_read_b128 v[96:99], v5 offset:36864
    v_mfma_f32_16x16x32_bf16 v[180:183], v[68:71], v[44:47], 0
    ds_read_b128 v[100:103], v5 offset:37888
    v_mfma_f32_16x16x32_bf16 v[184:187], v[72:75], v[44:47], 0
    ds_read_b128 v[104:107], v5 offset:38912
    v_mfma_f32_16x16x32_bf16 v[188:191], v[76:79], v[44:47], 0
    ds_read_b128 v[108:111], v5 offset:39936
    v_mfma_f32_16x16x32_bf16 v[192:195], v[64:67], v[48:51], 0
    v_mfma_f32_16x16x32_bf16 v[196:199], v[68:71], v[48:51], 0
    s_add_u32 m0, s21, 0
    s_nop 0
    buffer_load_dwordx4 v1, s[4:7], s16 offen sc1 lds
    s_add_u32 s16, s16, s62
    v_mfma_f32_16x16x32_bf16 v[200:203], v[72:75], v[48:51], 0
    v_mfma_f32_16x16x32_bf16 v[204:207], v[76:79], v[48:51], 0
    v_mfma_f32_16x16x32_bf16 v[208:211], v[64:67], v[52:55], 0
    s_add_u32 m0, s21, 1024
    s_nop 0
    buffer_load_dwordx4 v1, s[4:7], s17 offen sc1 lds
    s_add_u32 s17, s17, s62
    v_mfma_f32_16x16x32_bf16 v[212:215], v[68:71], v[52:55], 0
    v_mfma_f32_16x16x32_bf16 v[216:219], v[72:75], v[52:55], 0
    v_mfma_f32_16x16x32_bf16 v[220:223], v[76:79], v[52:55], 0
    s_add_u32 m0, s22, 0
    s_nop 0
    buffer_load_dwordx4 v2, s[8:11], s18 offen lds
    s_add_u32 s18, s18, s20
    v_mfma_f32_16x16x32_bf16 v[224:227], v[64:67], v[56:59], 0
    v_mfma_f32_16x16x32_bf16 v[228:231], v[68:71], v[56:59], 0
    v_mfma_f32_16x16x32_bf16 v[232:235], v[72:75], v[56:59], 0
    s_add_u32 m0, s22, 8192
    s_nop 0
    buffer_load_dwordx4 v2, s[12:15], s19 offen lds
    s_add_u32 s19, s19, s20
    v_mfma_f32_16x16x32_bf16 v[236:239], v[76:79], v[56:59], 0
    v_mfma_f32_16x16x32_bf16 v[240:243], v[64:67], v[60:63], 0
    v_mfma_f32_16x16x32_bf16 v[244:247], v[68:71], v[60:63], 0
    v_mfma_f32_16x16x32_bf16 v[248:251], v[72:75], v[60:63], 0
    v_mfma_f32_16x16x32_bf16 v[252:255], v[76:79], v[60:63], 0
    s_waitcnt lgkmcnt(0)
    s_waitcnt vmcnt(24)
    s_barrier
    v_mfma_f32_16x16x32_bf16 v[128:131], v[112:115], v[80:83], v[128:131]
    ds_read_b64_tr_b16 v[64:65], v12 offset:16384
    v_mfma_f32_16x16x32_bf16 v[132:135], v[116:119], v[80:83], v[132:135]
    ds_read_b64_tr_b16 v[66:67], v13 offset:16384
    v_mfma_f32_16x16x32_bf16 v[136:139], v[120:123], v[80:83], v[136:139]
    ds_read_b64_tr_b16 v[68:69], v14 offset:16384
    v_mfma_f32_16x16x32_bf16 v[140:143], v[124:127], v[80:83], v[140:143]
    ds_read_b64_tr_b16 v[70:71], v15 offset:16384
    v_mfma_f32_16x16x32_bf16 v[144:147], v[112:115], v[84:87], v[144:147]
    ds_read_b64_tr_b16 v[72:73], v12 offset:24576
    v_mfma_f32_16x16x32_bf16 v[148:151], v[116:119], v[84:87], v[148:151]
    ds_read_b64_tr_b16 v[74:75], v13 offset:24576
    v_mfma_f32_16x16x32_bf16 v[152:155], v[120:123], v[84:87], v[152:155]
    ds_read_b64_tr_b16 v[76:77], v14 offset:24576
    v_mfma_f32_16x16x32_bf16 v[156:159], v[124:127], v[84:87], v[156:159]
    ds_read_b64_tr_b16 v[78:79], v15 offset:24576
    v_mfma_f32_16x16x32_bf16 v[160:163], v[112:115], v[88:91], v[160:163]
    ds_read_b128 v[32:35], v6 offset:0
    v_mfma_f32_16x16x32_bf16 v[164:167], v[116:119], v[88:91], v[164:167]
    ds_read_b128 v[36:39], v6 offset:1024
    v_mfma_f32_16x16x32_bf16 v[168:171], v[120:123], v[88:91], v[168:171]
    ds_read_b128 v[40:43], v6 offset:2048
    v_mfma_f32_16x16x32_bf16 v[172:175], v[124:127], v[88:91], v[172:175]
    ds_read_b128 v[44:47], v6 offset:3072
    v_mfma_f32_16x16x32_bf16 v[176:179], v[112:115], v[92:95], v[176:179]
    ds_read_b128 v[48:51], v6 offset:4096
    v_mfma_f32_16x16x32_bf16 v[180:183], v[116:119], v[92:95], v[180:183]
    ds_read_b128 v[52:55], v6 offset:5120
    v_mfma_f32_16x16x32_bf16 v[184:187], v[120:123], v[92:95], v[184:187]
    ds_read_b128 v[56:59], v6 offset:6144
    v_mfma_f32_16x16x32_bf16 v[188:191], v[124:127], v[92:95], v[188:191]
    ds_read_b128 v[60:63], v6 offset:7168
    v_mfma_f32_16x16x32_bf16 v[192:195], v[112:115], v[96:99], v[192:195]
    v_mfma_f32_16x16x32_bf16 v[196:199], v[116:119], v[96:99], v[196:199]
    s_add_u32 m0, s21, 32768
    s_nop 0
    buffer_load_dwordx4 v1, s[4:7], s16 offen sc1 lds
    s_add_u32 s16, s16, s62
    v_mfma_f32_16x16x32_bf16 v[200:203], v[120:123], v[96:99], v[200:203]
    v_mfma_f32_16x16x32_bf16 v[204:207], v[124:127], v[96:99], v[204:207]
    v_mfma_f32_16x16x32_bf16 v[208:211], v[112:115], v[100:103], v[208:211]
    s_add_u32 m0, s21, 33792
    s_nop 0
    buffer_load_dwordx4 v1, s[4:7], s17 offen sc1 lds
    s_add_u32 s17, s17, s62
    v_mfma_f32_16x16x32_bf16 v[212:215], v[116:119], v[100:103], v[212:215]
    v_mfma_f32_16x16x32_bf16 v[216:219], v[120:123], v[100:103], v[216:219]
    v_mfma_f32_16x16x32_bf16 v[220:223], v[124:127], v[100:103], v[220:223]
    s_add_u32 m0, s22, 32768
    s_nop 0
    buffer_load_dwordx4 v2, s[8:11], s18 offen lds
    s_add_u32 s18, s18, s20
    v_mfma_f32_16x16x32_bf16 v[224:227], v[112:115], v[104:107], v[224:227]
    v_mfma_f32_16x16x32_bf16 v[228:231], v[116:119], v[104:107], v[228:231]
    v_mfma_f32_16x16x32_bf16 v[232:235], v[120:123], v[104:107], v[232:235]
    s_add_u32 m0, s22, 40960
    s_nop 0
    buffer_load_dwordx4 v2, s[12:15], s19 offen lds
    s_add_u32 s19, s19, s20
    v_mfma_f32_16x16x32_bf16 v[236:239], v[124:127], v[104:107], v[236:239]
    v_mfma_f32_16x16x32_bf16 v[240:243], v[112:115], v[108:111], v[240:243]
    v_mfma_f32_16x16x32_bf16 v[244:247], v[116:119], v[108:111], v[244:247]
    v_mfma_f32_16x16x32_bf16 v[248:251], v[120:123], v[108:111], v[248:251]
    v_mfma_f32_16x16x32_bf16 v[252:255], v[124:127], v[108:111], v[252:255]
    s_waitcnt lgkmcnt(0)
    s_waitcnt vmcnt(24)
    s_barrier
    v_mfma_f32_16x16x32_bf16 v[128:131], v[64:67], v[32:35], v[128:131]
    ds_read_b64_tr_b16 v[112:113], v12 offset:49152
    v_mfma_f32_16x16x32_bf16 v[132:135], v[68:71], v[32:35], v[132:135]
    ds_read_b64_tr_b16 v[114:115], v13 offset:49152
    v_mfma_f32_16x16x32_bf16 v[136:139], v[72:75], v[32:35], v[136:139]
    ds_read_b64_tr_b16 v[116:117], v14 offset:49152
    v_mfma_f32_16x16x32_bf16 v[140:143], v[76:79], v[32:35], v[140:143]
    ds_read_b64_tr_b16 v[118:119], v15 offset:49152
    v_mfma_f32_16x16x32_bf16 v[144:147], v[64:67], v[36:39], v[144:147]
    ds_read_b64_tr_b16 v[120:121], v12 offset:57344
    v_mfma_f32_16x16x32_bf16 v[148:151], v[68:71], v[36:39], v[148:151]
    ds_read_b64_tr_b16 v[122:123], v13 offset:57344
    v_mfma_f32_16x16x32_bf16 v[152:155], v[72:75], v[36:39], v[152:155]
    ds_read_b64_tr_b16 v[124:125], v14 offset:57344
    v_mfma_f32_16x16x32_bf16 v[156:159], v[76:79], v[36:39], v[156:159]
    ds_read_b64_tr_b16 v[126:127], v15 offset:57344
    v_mfma_f32_16x16x32_bf16 v[160:163], v[64:67], v[40:43], v[160:163]
    ds_read_b128 v[80:83], v6 offset:32768
    v_mfma_f32_16x16x32_bf16 v[164:167], v[68:71], v[40:43], v[164:167]
    ds_read_b128 v[84:87], v6 offset:33792
    v_mfma_f32_16x16x32_bf16 v[168:171], v[72:75], v[40:43], v[168:171]
    ds_read_b128 v[88:91], v6 offset:34816
    v_mfma_f32_16x16x32_bf16 v[172:175], v[76:79], v[40:43], v[172:175]
    ds_read_b128 v[92:95], v6 offset:35840
    v_mfma_f32_16x16x32_bf16 v[176:179], v[64:67], v[44:47], v[176:179]
    ds_read_b128 v[96:99], v6 offset:36864
    v_mfma_f32_16x16x32_bf16 v[180:183], v[68:71], v[44:47], v[180:183]
    ds_read_b128 v[100:103], v6 offset:37888
    v_mfma_f32_16x16x32_bf16 v[184:187], v[72:75], v[44:47], v[184:187]
    ds_read_b128 v[104:107], v6 offset:38912
    v_mfma_f32_16x16x32_bf16 v[188:191], v[76:79], v[44:47], v[188:191]
    ds_read_b128 v[108:111], v6 offset:39936
    v_mfma_f32_16x16x32_bf16 v[192:195], v[64:67], v[48:51], v[192:195]
    v_mfma_f32_16x16x32_bf16 v[196:199], v[68:71], v[48:51], v[196:199]
    s_add_u32 m0, s21, 65536
    s_nop 0
    buffer_load_dwordx4 v1, s[4:7], s16 offen sc1 lds
    s_add_u32 s16, s16, s62
    v_mfma_f32_16x16x32_bf16 v[200:203], v[72:75], v[48:51], v[200:203]
    v_mfma_f32_16x16x32_bf16 v[204:207], v[76:79], v[48:51], v[204:207]
    v_mfma_f32_16x16x32_bf16 v[208:211], v[64:67], v[52:55], v[208:211]
    s_add_u32 m0, s21, 66560
    s_nop 0
    buffer_load_dwordx4 v1, s[4:7], s17 offen sc1 lds
    s_add_u32 s17, s17, s62
    v_mfma_f32_16x16x32_bf16 v[212:215], v[68:71], v[52:55], v[212:215]
    v_mfma_f32_16x16x32_bf16 v[216:219], v[72:75], v[52:55], v[216:219]
    v_mfma_f32_16x16x32_bf16 v[220:223], v[76:79], v[52:55], v[220:223]
    s_add_u32 m0, s22, 65536
    s_nop 0
    buffer_load_dwordx4 v2, s[8:11], s18 offen lds
    s_add_u32 s18, s18, s20
    v_mfma_f32_16x16x32_bf16 v[224:227], v[64:67], v[56:59], v[224:227]
    v_mfma_f32_16x16x32_bf16 v[228:231], v[68:71], v[56:59], v[228:231]
    v_mfma_f32_16x16x32_bf16 v[232:235], v[72:75], v[56:59], v[232:235]
    s_add_u32 m0, s22, 73728
    s_nop 0
    buffer_load_dwordx4 v2, s[12:15], s19 offen lds
    s_add_u32 s19, s19, s20
    v_mfma_f32_16x16x32_bf16 v[236:239], v[76:79], v[56:59], v[236:239]
    v_mfma_f32_16x16x32_bf16 v[240:243], v[64:67], v[60:63], v[240:243]
    v_mfma_f32_16x16x32_bf16 v[244:247], v[68:71], v[60:63], v[244:247]
    v_mfma_f32_16x16x32_bf16 v[248:251], v[72:75], v[60:63], v[248:251]
    v_mfma_f32_16x16x32_bf16 v[252:255], v[76:79], v[60:63], v[252:255]
    s_waitcnt lgkmcnt(0)
    s_waitcnt vmcnt(8)
    s_barrier
    s_cmp_eq_u32 s28, 0
    s_cbranch_scc1 sig_4
    s_cmp_lg_u32 s3, 0
    s_cbranch_scc1 sig_4
    s_mov_b64 exec, 1
    v_mov_b32 v18, s57
    buffer_atomic_add v18, v17, s[4:7], s28 offen sc1
    s_mov_b64 exec, -1
sig_4:
    s_mov_b32 s28, 0
    v_mfma_f32_16x16x32_bf16 v[128:131], v[112:115], v[80:83], v[128:131]
    ds_read_b64_tr_b16 v[64:65], v8 offset:16384
    v_mfma_f32_16x16x32_bf16 v[132:135], v[116:119], v[80:83], v[132:135]
    ds_read_b64_tr_b16 v[66:67], v9 offset:16384
    v_mfma_f32_16x16x32_bf16 v[136:139], v[120:123], v[80:83], v[136:139]
    ds_read_b64_tr_b16 v[68:69], v10 offset:16384
    v_mfma_f32_16x16x32_bf16 v[140:143], v[124:127], v[80:83], v[140:143]
    ds_read_b64_tr_b16 v[70:71], v11 offset:16384
    v_mfma_f32_16x16x32_bf16 v[144:147], v[112:115], v[84:87], v[144:147]
    ds_read_b64_tr_b16 v[72:73], v8 offset:24576
    v_mfma_f32_16x16x32_bf16 v[148:151], v[116:119], v[84:87], v[148:151]
    ds_read_b64_tr_b16 v[74:75], v9 offset:24576
    v_mfma_f32_16x16x32_bf16 v[152:155], v[120:123], v[84:87], v[152:155]
    ds_read_b64_tr_b16 v[76:77], v10 offset:24576
    v_mfma_f32_16x16x32_bf16 v[156:159], v[124:127], v[84:87], v[156:159]
    ds_read_b64_tr_b16 v[78:79], v11 offset:24576
    v_mfma_f32_16x16x32_bf16 v[160:163], v[112:115], v[88:91], v[160:163]
    ds_read_b128 v[32:35], v5 offset:0
    v_mfma_f32_16x16x32_bf16 v[164:167], v[116:119], v[88:91], v[164:167]
    ds_read_b128 v[36:39], v5 offset:1024
    v_mfma_f32_16x16x32_bf16 v[168:171], v[120:123], v[88:91], v[168:171]
    ds_read_b128 v[40:43], v5 offset:2048
    v_mfma_f32_16x16x32_bf16 v[172:175], v[124:127], v[88:91], v[172:175]
    ds_read_b128 v[44:47], v5 offset:3072
    v_mfma_f32_16x16x32_bf16 v[176:179], v[112:115], v[92:95], v[176:179]
    ds_read_b128 v[48:51], v5 offset:4096
    v_mfma_f32_16x16x32_bf16 v[180:183], v[116:119], v[92:95], v[180:183]
    ds_read_b128 v[52:55], v5 offset:5120
    v_mfma_f32_16x16x32_bf16 v[184:187], v[120:123], v[92:95], v[184:187]
    ds_read_b128 v[56:59], v5 offset:6144
    v_mfma_f32_16x16x32_bf16 v[188:191], v[124:127], v[92:95], v[188:191]
    ds_read_b128 v[60:63], v5 offset:7168
    v_mfma_f32_16x16x32_bf16 v[192:195], v[112:115], v[96:99], v[192:195]
    v_mfma_f32_16x16x32_bf16 v[196:199], v[116:119], v[96:99], v[196:199]
    s_add_u32 m0, s21, 98304
    s_nop 0
    buffer_load_dwordx4 v1, s[4:7], s16 offen sc1 lds
    s_add_u32 s16, s16, s62
    v_mfma_f32_16x16x32_bf16 v[200:203], v[120:123], v[96:99], v[200:203]
    v_mfma_f32_16x16x32_bf16 v[204:207], v[124:127], v[96:99], v[204:207]
    v_mfma_f32_16x16x32_bf16 v[208:211], v[112:115], v[100:103], v[208:211]
    s_add_u32 m0, s21, 99328
    s_nop 0
    buffer_load_dwordx4 v1, s[4:7], s17 offen sc1 lds
    s_add_u32 s17, s17, s62
    v_mfma_f32_16x16x32_bf16 v[212:215], v[116:119], v[100:103], v[212:215]
    v_mfma_f32_16x16x32_bf16 v[216:219], v[120:123], v[100:103], v[216:219]
    v_mfma_f32_16x16x32_bf16 v[220:223], v[124:127], v[100:103], v[220:223]
    s_add_u32 m0, s22, 98304
    s_nop 0
    buffer_load_dwordx4 v2, s[8:11], s18 offen lds
    s_add_u32 s18, s18, s20
    v_mfma_f32_16x16x32_bf16 v[224:227], v[112:115], v[104:107], v[224:227]
    v_mfma_f32_16x16x32_bf16 v[228:231], v[116:119], v[104:107], v[228:231]
    v_mfma_f32_16x16x32_bf16 v[232:235], v[120:123], v[104:107], v[232:235]
    s_add_u32 m0, s22, 106496
    s_nop 0
    buffer_load_dwordx4 v2, s[12:15], s19 offen lds
    s_add_u32 s19, s19, s20
    v_mfma_f32_16x16x32_bf16 v[236:239], v[124:127], v[104:107], v[236:239]
    v_mfma_f32_16x16x32_bf16 v[240:243], v[112:115], v[108:111], v[240:243]
    v_mfma_f32_16x16x32_bf16 v[244:247], v[116:119], v[108:111], v[244:247]
    v_mfma_f32_16x16x32_bf16 v[248:251], v[120:123], v[108:111], v[248:251]
    v_mfma_f32_16x16x32_bf16 v[252:255], v[124:127], v[108:111], v[252:255]
    s_waitcnt lgkmcnt(0)
w_loop_chk:
    s_sub_u32 s23, s23, 1
w_loop:
    s_cmp_lg_u32 s23, 1
    s_cbranch_scc1 w_body
    v_readfirstlane_b32 s30, v16
    s_cmp_ge_u32 s30, s45
    s_cselect_b32 s30, 0, 1
    s_or_b32 s30, s30, s70
    s_cmp_ge_u32 s32, 4
    s_cselect_b32 s30, 1, s30
    s_cmp_eq_u32 s32, 0
    s_cselect_b32 s30, 1, s30
    v_mov_b32 v20, s30
    ds_write_b32 v7, v20
    s_cbranch_scc1 w_nd
    s_cmp_ge_u32 s32, 4
    s_cbranch_scc1 w_nd
    s_cmp_lg_u32 s70, 0
    s_cbranch_scc1 w_nd
    s_load_dwordx2 s[8:9], s[0:1], s33
    s_load_dwordx2 s[12:13], s[0:1], s34
    s_mov_b32 s10, s38
    s_mov_b32 s14, s38
    s_cmp_ge_u32 s32, 4
    s_cselect_b32 s31, 0, 1
    s_lshl_b32 s30, s3, s31
    s_mul_i32 s30, s30, s40
    s_add_u32 s16, s39, s30
    s_cmp_eq_u32 s32, 4
    s_cselect_b32 s30, 1024, s40
    s_cselect_b32 s31, 6, 5
    s_lshl_b32 s62, 32, s31
    s_add_u32 s17, s16, s30
    s_lshl_b32 s30, s3, 2
    s_mul_i32 s30, s30, s35
    s_add_u32 s18, s36, s30
    s_add_u32 s19, s37, s30
    s_lshl_b32 s20, s35, s31
    v_mul_u32_u24 v2, s35, v4
    v_add_u32 v2, v2, v3
    s_waitcnt lgkmcnt(0)
w_body:
    s_waitcnt vmcnt(8)
    s_barrier
    v_mfma_f32_16x16x32_bf16 v[128:131], v[64:67], v[32:35], v[128:131]
    ds_read_b64_tr_b16 v[112:113], v8 offset:49152
    v_mfma_f32_16x16x32_bf16 v[132:135], v[68:71], v[32:35], v[132:135]
    ds_read_b64_tr_b16 v[114:115], v9 offset:49152
    v_mfma_f32_16x16x32_bf16 v[136:139], v[72:75], v[32:35], v[136:139]
    ds_read_b64_tr_b16 v[116:117], v10 offset:49152
    v_mfma_f32_16x16x32_bf16 v[140:143], v[76:79], v[32:35], v[140:143]
    ds_read_b64_tr_b16 v[118:119], v11 offset:49152
    v_mfma_f32_16x16x32_bf16 v[144:147], v[64:67], v[36:39], v[144:147]
    ds_read_b64_tr_b16 v[120:121], v8 offset:57344
    v_mfma_f32_16x16x32_bf16 v[148:151], v[68:71], v[36:39], v[148:151]
    ds_read_b64_tr_b16 v[122:123], v9 offset:57344
    v_mfma_f32_16x16x32_bf16 v[152:155], v[72:75], v[36:39], v[152:155]
    ds_read_b64_tr_b16 v[124:125], v10 offset:57344
    v_mfma_f32_16x16x32_bf16 v[156:159], v[76:79], v[36:39], v[156:159]
    ds_read_b64_tr_b16 v[126:127], v11 offset:57344
    v_mfma_f32_16x16x32_bf16 v[160:163], v[64:67], v[40:43], v[160:163]
    ds_read_b128 v[80:83], v5 offset:32768
    v_mfma_f32_16x16x32_bf16 v[164:167], v[68:71], v[40:43], v[164:167]
    ds_read_b128 v[84:87], v5 offset:33792
    v_mfma_f32_16x16x32_bf16 v[168:171], v[72:75], v[40:43], v[168:171]
    ds_read_b128 v[88:91], v5 offset:34816
    v_mfma_f32_16x16x32_bf16 v[172:175], v[76:79], v[40:43], v[172:175]
    ds_read_b128 v[92:95], v5 offset:35840
    v_mfma_f32_16x16x32_bf16 v[176:179], v[64:67], v[44:47], v[176:179]
    ds_read_b128 v[96:99], v5 offset:36864
    v_mfma_f32_16x16x32_bf16 v[180:183], v[68:71], v[44:47], v[180:183]
    ds_read_b128 v[100:103], v5 offset:37888
    v_mfma_f32_16x16x32_bf16 v[184:187], v[72:75], v[44:47], v[184:187]
    ds_read_b128 v[104:107], v5 offset:38912
    v_mfma_f32_16x16x32_bf16 v[188:191], v[76:79], v[44:47], v[188:191]
    ds_read_b128 v[108:111], v5 offset:39936
    v_mfma_f32_16x16x32_bf16 v[192:195], v[64:67], v[48:51], v[192:195]
    v_mfma_f32_16x16x32_bf16 v[196:199], v[68:71], v[48:51], v[196:199]
    s_add_u32 m0, s21, 0
    s_nop 0
    buffer_load_dwordx4 v1, s[4:7], s16 offen sc1 lds
    s_add_u32 s16, s16, s62
    v_mfma_f32_16x16x32_bf16 v[200:203], v[72:75], v[48:51], v[200:203]
    v_mfma_f32_16x16x32_bf16 v[204:207], v[76:79], v[48:51], v[204:207]
    v_mfma_f32_16x16x32_bf16 v[208:211], v[64:67], v[52:55], v[208:211]
    s_add_u32 m0, s21, 1024
    s_nop 0
    buffer_load_dwordx4 v1, s[4:7], s17 offen sc1 lds
    s_add_u32 s17, s17, s62
    v_mfma_f32_16x16x32_bf16 v[212:215], v[68:71], v[52:55], v[212:215]
    v_mfma_f32_16x16x32_bf16 v[216:219], v[72:75], v[52:55], v[216:219]
    v_mfma_f32_16x16x32_bf16 v[220:223], v[76:79], v[52:55], v[220:223]
    s_add_u32 m0, s22, 0
    s_nop 0
    buffer_load_dwordx4 v2, s[8:11], s18 offen lds
    s_add_u32 s18, s18, s20
    v_mfma_f32_16x16x32_bf16 v[224:227], v[64:67], v[56:59], v[224:227]
    v_mfma_f32_16x16x32_bf16 v[228:231], v[68:71], v[56:59], v[228:231]
    v_mfma_f32_16x16x32_bf16 v[232:235], v[72:75], v[56:59], v[232:235]
    s_add_u32 m0, s22, 8192
    s_nop 0
    buffer_load_dwordx4 v2, s[12:15], s19 offen lds
    s_add_u32 s19, s19, s20
    v_mfma_f32_16x16x32_bf16 v[236:239], v[76:79], v[56:59], v[236:239]
    v_mfma_f32_16x16x32_bf16 v[240:243], v[64:67], v[60:63], v[240:243]
    v_mfma_f32_16x16x32_bf16 v[244:247], v[68:71], v[60:63], v[244:247]
    buffer_load_dword v16, v17, s[4:7], s44 offen sc1
    v_mfma_f32_16x16x32_bf16 v[248:251], v[72:75], v[60:63], v[248:251]
    v_mfma_f32_16x16x32_bf16 v[252:255], v[76:79], v[60:63], v[252:255]
    s_waitcnt lgkmcnt(0)
    s_waitcnt vmcnt(8)
    s_barrier
    v_mfma_f32_16x16x32_bf16 v[128:131], v[112:115], v[80:83], v[128:131]
    ds_read_b64_tr_b16 v[64:65], v12 offset:16384
    v_mfma_f32_16x16x32_bf16 v[132:135], v[116:119], v[80:83], v[132:135]
    ds_read_b64_tr_b16 v[66:67], v13 offset:16384
    v_mfma_f32_16x16x32_bf16 v[136:139], v[120:123], v[80:83], v[136:139]
    ds_read_b64_tr_b16 v[68:69], v14 offset:16384
    v_mfma_f32_16x16x32_bf16 v[140:143], v[124:127], v[80:83], v[140:143]
    ds_read_b64_tr_b16 v[70:71], v15 offset:16384
    v_mfma_f32_16x16x32_bf16 v[144:147], v[112:115], v[84:87], v[144:147]
    ds_read_b64_tr_b16 v[72:73], v12 offset:24576
    v_mfma_f32_16x16x32_bf16 v[148:151], v[116:119], v[84:87], v[148:151]
    ds_read_b64_tr_b16 v[74:75], v13 offset:24576
    v_mfma_f32_16x16x32_bf16 v[152:155], v[120:123], v[84:87], v[152:155]
    ds_read_b64_tr_b16 v[76:77], v14 offset:24576
    v_mfma_f32_16x16x32_bf16 v[156:159], v[124:127], v[84:87], v[156:159]
    ds_read_b64_tr_b16 v[78:79], v15 offset:24576
    v_mfma_f32_16x16x32_bf16 v[160:163], v[112:115], v[88:91], v[160:163]
    ds_read_b128 v[32:35], v6 offset:0
    v_mfma_f32_16x16x32_bf16 v[164:167], v[116:119], v[88:91], v[164:167]
    ds_read_b128 v[36:39], v6 offset:1024
    v_mfma_f32_16x16x32_bf16 v[168:171], v[120:123], v[88:91], v[168:171]
    ds_read_b128 v[40:43], v6 offset:2048
    v_mfma_f32_16x16x32_bf16 v[172:175], v[124:127], v[88:91], v[172:175]
    ds_read_b128 v[44:47], v6 offset:3072
    v_mfma_f32_16x16x32_bf16 v[176:179], v[112:115], v[92:95], v[176:179]
    ds_read_b128 v[48:51], v6 offset:4096
    v_mfma_f32_16x16x32_bf16 v[180:183], v[116:119], v[92:95], v[180:183]
    ds_read_b128 v[52:55], v6 offset:5120
    v_mfma_f32_16x16x32_bf16 v[184:187], v[120:123], v[92:95], v[184:187]
    ds_read_b128 v[56:59], v6 offset:6144
    v_mfma_f32_16x16x32_bf16 v[188:191], v[124:127], v[92:95], v[188:191]
    ds_read_b128 v[60:63], v6 offset:7168
    v_mfma_f32_16x16x32_bf16 v[192:195], v[112:115], v[96:99], v[192:195]
    v_mfma_f32_16x16x32_bf16 v[196:199], v[116:119], v[96:99], v[196:199]
    s_add_u32 m0, s21, 32768
    s_nop 0
    buffer_load_dwordx4 v1, s[4:7], s16 offen sc1 lds
    s_add_u32 s16, s16, s62
    v_mfma_f32_16x16x32_bf16 v[200:203], v[120:123], v[96:99], v[200:203]
    v_mfma_f32_16x16x32_bf16 v[204:207], v[124:127], v[96:99], v[204:207]
    v_mfma_f32_16x16x32_bf16 v[208:211], v[112:115], v[100:103], v[208:211]
    s_add_u32 m0, s21, 33792
    s_nop 0
    buffer_load_dwordx4 v1, s[4:7], s17 offen sc1 lds
    s_add_u32 s17, s17, s62
    v_mfma_f32_16x16x32_bf16 v[212:215], v[116:119], v[100:103], v[212:215]
    v_mfma_f32_16x16x32_bf16 v[216:219], v[120:123], v[100:103], v[216:219]
    v_mfma_f32_16x16x32_bf16 v[220:223], v[124:127], v[100:103], v[220:223]
    s_add_u32 m0, s22, 32768
    s_nop 0
    buffer_load_dwordx4 v2, s[8:11], s18 offen lds
    s_add_u32 s18, s18, s20
    v_mfma_f32_16x16x32_bf16 v[224:227], v[112:115], v[104:107], v[224:227]
    v_mfma_f32_16x16x32_bf16 v[228:231], v[116:119], v[104:107], v[228:231]
    v_mfma_f32_16x16x32_bf16 v[232:235], v[120:123], v[104:107], v[232:235]
    s_add_u32 m0, s22, 40960
    s_nop 0
    buffer_load_dwordx4 v2, s[12:15], s19 offen lds
    s_add_u32 s19, s19, s20
    v_mfma_f32_16x16x32_bf16 v[236:239], v[124:127], v[104:107], v[236:239]
    v_mfma_f32_16x16x32_bf16 v[240:243], v[112:115], v[108:111], v[240:243]
    v_mfma_f32_16x16x32_bf16 v[244:247], v[116:119], v[108:111], v[244:247]
    v_mfma_f32_16x16x32_bf16 v[248:251], v[120:123], v[108:111], v[248:251]
    v_mfma_f32_16x16x32_bf16 v[252:255], v[124:127], v[108:111], v[252:255]
    s_waitcnt lgkmcnt(0)
    s_waitcnt vmcnt(8)
    s_barrier
    v_mfma_f32_16x16x32_bf16 v[128:131], v[64:67], v[32:35], v[128:131]
    ds_read_b64_tr_b16 v[112:113], v12 offset:49152
    v_mfma_f32_16x16x32_bf16 v[132:135], v[68:71], v[32:35], v[132:135]
    ds_read_b64_tr_b16 v[114:115], v13 offset:49152
    v_mfma_f32_16x16x32_bf16 v[136:139], v[72:75], v[32:35], v[136:139]
    ds_read_b64_tr_b16 v[116:117], v14 offset:49152
    v_mfma_f32_16x16x32_bf16 v[140:143], v[76:79], v[32:35], v[140:143]
    ds_read_b64_tr_b16 v[118:119], v15 offset:49152
    v_mfma_f32_16x16x32_bf16 v[144:147], v[64:67], v[36:39], v[144:147]
    ds_read_b64_tr_b16 v[120:121], v12 offset:57344
    v_mfma_f32_16x16x32_bf16 v[148:151], v[68:71], v[36:39], v[148:151]
    ds_read_b64_tr_b16 v[122:123], v13 offset:57344
    v_mfma_f32_16x16x32_bf16 v[152:155], v[72:75], v[36:39], v[152:155]
    ds_read_b64_tr_b16 v[124:125], v14 offset:57344
    v_mfma_f32_16x16x32_bf16 v[156:159], v[76:79], v[36:39], v[156:159]
    ds_read_b64_tr_b16 v[126:127], v15 offset:57344
    v_mfma_f32_16x16x32_bf16 v[160:163], v[64:67], v[40:43], v[160:163]
    ds_read_b128 v[80:83], v6 offset:32768
    v_mfma_f32_16x16x32_bf16 v[164:167], v[68:71], v[40:43], v[164:167]
    ds_read_b128 v[84:87], v6 offset:33792
    v_mfma_f32_16x16x32_bf16 v[168:171], v[72:75], v[40:43], v[168:171]
    ds_read_b128 v[88:91], v6 offset:34816
    v_mfma_f32_16x16x32_bf16 v[172:175], v[76:79], v[40:43], v[172:175]
    ds_read_b128 v[92:95], v6 offset:35840
    v_mfma_f32_16x16x32_bf16 v[176:179], v[64:67], v[44:47], v[176:179]
    ds_read_b128 v[96:99], v6 offset:36864
    v_mfma_f32_16x16x32_bf16 v[180:183], v[68:71], v[44:47], v[180:183]
    ds_read_b128 v[100:103], v6 offset:37888
    v_mfma_f32_16x16x32_bf16 v[184:187], v[72:75], v[44:47], v[184:187]
    ds_read_b128 v[104:107], v6 offset:38912
    v_mfma_f32_16x16x32_bf16 v[188:191], v[76:79], v[44:47], v[188:191]
    ds_read_b128 v[108:111], v6 offset:39936
    v_mfma_f32_16x16x32_bf16 v[192:195], v[64:67], v[48:51], v[192:195]
    v_mfma_f32_16x16x32_bf16 v[196:199], v[68:71], v[48:51], v[196:199]
    s_add_u32 m0, s21, 65536
    s_nop 0
    buffer_load_dwordx4 v1, s[4:7], s16 offen sc1 lds
    s_add_u32 s16, s16, s62
    v_mfma_f32_16x16x32_bf16 v[200:203], v[72:75], v[48:51], v[200:203]
    v_mfma_f32_16x16x32_bf16 v[204:207], v[76:79], v[48:51], v[204:207]
    v_mfma_f32_16x16x32_bf16 v[208:211], v[64:67], v[52:55], v[208:211]
    s_add_u32 m0, s21, 66560
    s_nop 0
    buffer_load_dwordx4 v1, s[4:7], s17 offen sc1 lds
    s_add_u32 s17, s17, s62
    v_mfma_f32_16x16x32_bf16 v[212:215], v[68:71], v[52:55], v[212:215]
    v_mfma_f32_16x16x32_bf16 v[216:219], v[72:75], v[52:55], v[216:219]
    v_mfma_f32_16x16x32_bf16 v[220:223], v[76:79], v[52:55], v[220:223]
    s_add_u32 m0, s22, 65536
    s_nop 0
    buffer_load_dwordx4 v2, s[8:11], s18 offen lds
    s_add_u32 s18, s18, s20
    v_mfma_f32_16x16x32_bf16 v[224:227], v[64:67], v[56:59], v[224:227]
    v_mfma_f32_16x16x32_bf16 v[228:231], v[68:71], v[56:59], v[228:231]
    v_mfma_f32_16x16x32_bf16 v[232:235], v[72:75], v[56:59], v[232:235]
    s_add_u32 m0, s22, 73728
    s_nop 0
    buffer_load_dwordx4 v2, s[12:15], s19 offen lds
    s_add_u32 s19, s19, s20
    v_mfma_f32_16x16x32_bf16 v[236:239], v[76:79], v[56:59], v[236:239]
    v_mfma_f32_16x16x32_bf16 v[240:243], v[64:67], v[60:63], v[240:243]
    v_mfma_f32_16x16x32_bf16 v[244:247], v[68:71], v[60:63], v[244:247]
    v_mfma_f32_16x16x32_bf16 v[248:251], v[72:75], v[60:63], v[248:251]
    v_mfma_f32_16x16x32_bf16 v[252:255], v[76:79], v[60:63], v[252:255]
    s_waitcnt lgkmcnt(0)
    s_waitcnt vmcnt(8)
    s_barrier
    v_mfma_f32_16x16x32_bf16 v[128:131], v[112:115], v[80:83], v[128:131]
    ds_read_b64_tr_b16 v[64:65], v8 offset:16384
    v_mfma_f32_16x16x32_bf16 v[132:135], v[116:119], v[80:83], v[132:135]
    ds_read_b64_tr_b16 v[66:67], v9 offset:16384
    v_mfma_f32_16x16x32_bf16 v[136:139], v[120:123], v[80:83], v[136:139]
    ds_read_b64_tr_b16 v[68:69], v10 offset:16384
    v_mfma_f32_16x16x32_bf16 v[140:143], v[124:127], v[80:83], v[140:143]
    ds_read_b64_tr_b16 v[70:71], v11 offset:16384
    v_mfma_f32_16x16x32_bf16 v[144:147], v[112:115], v[84:87], v[144:147]
    ds_read_b64_tr_b16 v[72:73], v8 offset:24576
    v_mfma_f32_16x16x32_bf16 v[148:151], v[116:119], v[84:87], v[148:151]
    ds_read_b64_tr_b16 v[74:75], v9 offset:24576
    v_mfma_f32_16x16x32_bf16 v[152:155], v[120:123], v[84:87], v[152:155]
    ds_read_b64_tr_b16 v[76:77], v10 offset:24576
    v_mfma_f32_16x16x32_bf16 v[156:159], v[124:127], v[84:87], v[156:159]
    ds_read_b64_tr_b16 v[78:79], v11 offset:24576
    v_mfma_f32_16x16x32_bf16 v[160:163], v[112:115], v[88:91], v[160:163]
    ds_read_b128 v[32:35], v5 offset:0
    v_mfma_f32_16x16x32_bf16 v[164:167], v[116:119], v[88:91], v[164:167]
    ds_read_b128 v[36:39], v5 offset:1024
    v_mfma_f32_16x16x32_bf16 v[168:171], v[120:123], v[88:91], v[168:171]
    ds_read_b128 v[40:43], v5 offset:2048
    v_mfma_f32_16x16x32_bf16 v[172:175], v[124:127], v[88:91], v[172:175]
    ds_read_b128 v[44:47], v5 offset:3072
    v_mfma_f32_16x16x32_bf16 v[176:179], v[112:115], v[92:95], v[176:179]
    ds_read_b128 v[48:51], v5 offset:4096
    v_mfma_f32_16x16x32_bf16 v[180:183], v[116:119], v[92:95], v[180:183]
    ds_read_b128 v[52:55], v5 offset:5120
    v_mfma_f32_16x16x32_bf16 v[184:187], v[120:123], v[92:95], v[184:187]
    ds_read_b128 v[56:59], v5 offset:6144
    v_mfma_f32_16x16x32_bf16 v[188:191], v[124:127], v[92:95], v[188:191]
    ds_read_b128 v[60:63], v5 offset:7168
    v_mfma_f32_16x16x32_bf16 v[192:195], v[112:115], v[96:99], v[192:195]
    v_mfma_f32_16x16x32_bf16 v[196:199], v[116:119], v[96:99], v[196:199]
    s_add_u32 m0, s21, 98304
    s_nop 0
    buffer_load_dwordx4 v1, s[4:7], s16 offen sc1 lds
    s_add_u32 s16, s16, s62
    v_mfma_f32_16x16x32_bf16 v[200:203], v[120:123], v[96:99], v[200:203]
    v_mfma_f32_16x16x32_bf16 v[204:207], v[124:127], v[96:99], v[204:207]
    v_mfma_f32_16x16x32_bf16 v[208:211], v[112:115], v[100:103], v[208:211]
    s_add_u32 m0, s21, 99328
    s_nop 0
    buffer_load_dwordx4 v1, s[4:7], s17 offen sc1 lds
    s_add_u32 s17, s17, s62
    v_mfma_f32_16x16x32_bf16 v[212:215], v[116:119], v[100:103], v[212:215]
    v_mfma_f32_16x16x32_bf16 v[216:219], v[120:123], v[100:103], v[216:219]
    v_mfma_f32_16x16x32_bf16 v[220:223], v[124:127], v[100:103], v[220:223]
    s_add_u32 m0, s22, 98304
    s_nop 0
    buffer_load_dwordx4 v2, s[8:11], s18 offen lds
    s_add_u32 s18, s18, s20
    v_mfma_f32_16x16x32_bf16 v[224:227], v[112:115], v[104:107], v[224:227]
    v_mfma_f32_16x16x32_bf16 v[228:231], v[116:119], v[104:107], v[228:231]
    v_mfma_f32_16x16x32_bf16 v[232:235], v[120:123], v[104:107], v[232:235]
    s_add_u32 m0, s22, 106496
    s_nop 0
    buffer_load_dwordx4 v2, s[12:15], s19 offen lds
    s_add_u32 s19, s19, s20
    v_mfma_f32_16x16x32_bf16 v[236:239], v[124:127], v[104:107], v[236:239]
    v_mfma_f32_16x16x32_bf16 v[240:243], v[112:115], v[108:111], v[240:243]
    v_mfma_f32_16x16x32_bf16 v[244:247], v[116:119], v[108:111], v[244:247]
    v_mfma_f32_16x16x32_bf16 v[248:251], v[120:123], v[108:111], v[248:251]
    v_mfma_f32_16x16x32_bf16 v[252:255], v[124:127], v[108:111], v[252:255]
    s_waitcnt lgkmcnt(0)
    s_sub_u32 s23, s23, 1
    s_cmp_lg_u32 s23, 0
    s_cbranch_scc1 w_loop
    s_branch w_end
w_nd:
    s_waitcnt vmcnt(8)
    s_barrier
    v_mfma_f32_16x16x32_bf16 v[128:131], v[64:67], v[32:35], v[128:131]
    ds_read_b64_tr_b16 v[112:113], v8 offset:49152
    v_mfma_f32_16x16x32_bf16 v[132:135], v[68:71], v[32:35], v[132:135]
    ds_read_b64_tr_b16 v[114:115], v9 offset:49152
    v_mfma_f32_16x16x32_bf16 v[136:139], v[72:75], v[32:35], v[136:139]
    ds_read_b64_tr_b16 v[116:117], v10 offset:49152
    v_mfma_f32_16x16x32_bf16 v[140:143], v[76:79], v[32:35], v[140:143]
    ds_read_b64_tr_b16 v[118:119], v11 offset:49152
    v_mfma_f32_16x16x32_bf16 v[144:147], v[64:67], v[36:39], v[144:147]
    ds_read_b64_tr_b16 v[120:121], v8 offset:57344
    v_mfma_f32_16x16x32_bf16 v[148:151], v[68:71], v[36:39], v[148:151]
    ds_read_b64_tr_b16 v[122:123], v9 offset:57344
    v_mfma_f32_16x16x32_bf16 v[152:155], v[72:75], v[36:39], v[152:155]
    ds_read_b64_tr_b16 v[124:125], v10 offset:57344
    v_mfma_f32_16x16x32_bf16 v[156:159], v[76:79], v[36:39], v[156:159]
    ds_read_b64_tr_b16 v[126:127], v11 offset:57344
    v_mfma_f32_16x16x32_bf16 v[160:163], v[64:67], v[40:43], v[160:163]
    ds_read_b128 v[80:83], v5 offset:32768
    v_mfma_f32_16x16x32_bf16 v[164:167], v[68:71], v[40:43], v[164:167]
    ds_read_b128 v[84:87], v5 offset:33792
    v_mfma_f32_16x16x32_bf16 v[168:171], v[72:75], v[40:43], v[168:171]
    ds_read_b128 v[88:91], v5 offset:34816
    v_mfma_f32_16x16x32_bf16 v[172:175], v[76:79], v[40:43], v[172:175]
    ds_read_b128 v[92:95], v5 offset:35840
    v_mfma_f32_16x16x32_bf16 v[176:179], v[64:67], v[44:47], v[176:179]
    ds_read_b128 v[96:99], v5 offset:36864
    v_mfma_f32_16x16x32_bf16 v[180:183], v[68:71], v[44:47], v[180:183]
    ds_read_b128 v[100:103], v5 offset:37888
    v_mfma_f32_16x16x32_bf16 v[184:187], v[72:75], v[44:47], v[184:187]
    ds_read_b128 v[104:107], v5 offset:38912
    v_mfma_f32_16x16x32_bf16 v[188:191], v[76:79], v[44:47], v[188:191]
    ds_read_b128 v[108:111], v5 offset:39936
    v_mfma_f32_16x16x32_bf16 v[192:195], v[64:67], v[48:51], v[192:195]
    v_mfma_f32_16x16x32_bf16 v[196:199], v[68:71], v[48:51], v[196:199]
    v_mfma_f32_16x16x32_bf16 v[200:203], v[72:75], v[48:51], v[200:203]
    v_mfma_f32_16x16x32_bf16 v[204:207], v[76:79], v[48:51], v[204:207]
    v_mfma_f32_16x16x32_bf16 v[208:211], v[64:67], v[52:55], v[208:211]
    v_mfma_f32_16x16x32_bf16 v[212:215], v[68:71], v[52:55], v[212:215]
    v_mfma_f32_16x16x32_bf16 v[216:219], v[72:75], v[52:55], v[216:219]
    v_mfma_f32_16x16x32_bf16 v[220:223], v[76:79], v[52:55], v[220:223]
    v_mfma_f32_16x16x32_bf16 v[224:227], v[64:67], v[56:59], v[224:227]
    v_mfma_f32_16x16x32_bf16 v[228:231], v[68:71], v[56:59], v[228:231]
    v_mfma_f32_16x16x32_bf16 v[232:235], v[72:75], v[56:59], v[232:235]
    v_mfma_f32_16x16x32_bf16 v[236:239], v[76:79], v[56:59], v[236:239]
    v_mfma_f32_16x16x32_bf16 v[240:243], v[64:67], v[60:63], v[240:243]
    v_mfma_f32_16x16x32_bf16 v[244:247], v[68:71], v[60:63], v[244:247]
    v_mfma_f32_16x16x32_bf16 v[248:251], v[72:75], v[60:63], v[248:251]
    v_mfma_f32_16x16x32_bf16 v[252:255], v[76:79], v[60:63], v[252:255]
    s_waitcnt lgkmcnt(0)
    s_waitcnt vmcnt(4)
    s_barrier
    v_mfma_f32_16x16x32_bf16 v[128:131], v[112:115], v[80:83], v[128:131]
    ds_read_b64_tr_b16 v[64:65], v12 offset:16384
    v_mfma_f32_16x16x32_bf16 v[132:135], v[116:119], v[80:83], v[132:135]
    ds_read_b64_tr_b16 v[66:67], v13 offset:16384
    v_mfma_f32_16x16x32_bf16 v[136:139], v[120:123], v[80:83], v[136:139]
    ds_read_b64_tr_b16 v[68:69], v14 offset:16384
    v_mfma_f32_16x16x32_bf16 v[140:143], v[124:127], v[80:83], v[140:143]
    ds_read_b64_tr_b16 v[70:71], v15 offset:16384
    v_mfma_f32_16x16x32_bf16 v[144:147], v[112:115], v[84:87], v[144:147]
    ds_read_b64_tr_b16 v[72:73], v12 offset:24576
    v_mfma_f32_16x16x32_bf16 v[148:151], v[116:119], v[84:87], v[148:151]
    ds_read_b64_tr_b16 v[74:75], v13 offset:24576
    v_mfma_f32_16x16x32_bf16 v[152:155], v[120:123], v[84:87], v[152:155]
    ds_read_b64_tr_b16 v[76:77], v14 offset:24576
    v_mfma_f32_16x16x32_bf16 v[156:159], v[124:127], v[84:87], v[156:159]
    ds_read_b64_tr_b16 v[78:79], v15 offset:24576
    v_mfma_f32_16x16x32_bf16 v[160:163], v[112:115], v[88:91], v[160:163]
    ds_read_b128 v[32:35], v6 offset:0
    v_mfma_f32_16x16x32_bf16 v[164:167], v[116:119], v[88:91], v[164:167]
    ds_read_b128 v[36:39], v6 offset:1024
    v_mfma_f32_16x16x32_bf16 v[168:171], v[120:123], v[88:91], v[168:171]
    ds_read_b128 v[40:43], v6 offset:2048
    v_mfma_f32_16x16x32_bf16 v[172:175], v[124:127], v[88:91], v[172:175]
    ds_read_b128 v[44:47], v6 offset:3072
    v_mfma_f32_16x16x32_bf16 v[176:179], v[112:115], v[92:95], v[176:179]
    ds_read_b128 v[48:51], v6 offset:4096
    v_mfma_f32_16x16x32_bf16 v[180:183], v[116:119], v[92:95], v[180:183]
    ds_read_b128 v[52:55], v6 offset:5120
    v_mfma_f32_16x16x32_bf16 v[184:187], v[120:123], v[92:95], v[184:187]
    ds_read_b128 v[56:59], v6 offset:6144
    v_mfma_f32_16x16x32_bf16 v[188:191], v[124:127], v[92:95], v[188:191]
    ds_read_b128 v[60:63], v6 offset:7168
    v_mfma_f32_16x16x32_bf16 v[192:195], v[112:115], v[96:99], v[192:195]
    v_mfma_f32_16x16x32_bf16 v[196:199], v[116:119], v[96:99], v[196:199]
    v_mfma_f32_16x16x32_bf16 v[200:203], v[120:123], v[96:99], v[200:203]
    v_mfma_f32_16x16x32_bf16 v[204:207], v[124:127], v[96:99], v[204:207]
    v_mfma_f32_16x16x32_bf16 v[208:211], v[112:115], v[100:103], v[208:211]
    v_mfma_f32_16x16x32_bf16 v[212:215], v[116:119], v[100:103], v[212:215]
    v_mfma_f32_16x16x32_bf16 v[216:219], v[120:123], v[100:103], v[216:219]
    v_mfma_f32_16x16x32_bf16 v[220:223], v[124:127], v[100:103], v[220:223]
    v_mfma_f32_16x16x32_bf16 v[224:227], v[112:115], v[104:107], v[224:227]
    v_mfma_f32_16x16x32_bf16 v[228:231], v[116:119], v[104:107], v[228:231]
    v_mfma_f32_16x16x32_bf16 v[232:235], v[120:123], v[104:107], v[232:235]
    v_mfma_f32_16x16x32_bf16 v[236:239], v[124:127], v[104:107], v[236:239]
    v_mfma_f32_16x16x32_bf16 v[240:243], v[112:115], v[108:111], v[240:243]
    v_mfma_f32_16x16x32_bf16 v[244:247], v[116:119], v[108:111], v[244:247]
    v_mfma_f32_16x16x32_bf16 v[248:251], v[120:123], v[108:111], v[248:251]
    v_mfma_f32_16x16x32_bf16 v[252:255], v[124:127], v[108:111], v[252:255]
    s_waitcnt lgkmcnt(0)
    s_waitcnt vmcnt(0)
    s_barrier
    v_mfma_f32_16x16x32_bf16 v[128:131], v[64:67], v[32:35], v[128:131]
    ds_read_b64_tr_b16 v[112:113], v12 offset:49152
    v_mfma_f32_16x16x32_bf16 v[132:135], v[68:71], v[32:35], v[132:135]
    ds_read_b64_tr_b16 v[114:115], v13 offset:49152
    v_mfma_f32_16x16x32_bf16 v[136:139], v[72:75], v[32:35], v[136:139]
    ds_read_b64_tr_b16 v[116:117], v14 offset:49152
    v_mfma_f32_16x16x32_bf16 v[140:143], v[76:79], v[32:35], v[140:143]
    ds_read_b64_tr_b16 v[118:119], v15 offset:49152
    v_mfma_f32_16x16x32_bf16 v[144:147], v[64:67], v[36:39], v[144:147]
    ds_read_b64_tr_b16 v[120:121], v12 offset:57344
    v_mfma_f32_16x16x32_bf16 v[148:151], v[68:71], v[36:39], v[148:151]
    ds_read_b64_tr_b16 v[122:123], v13 offset:57344
    v_mfma_f32_16x16x32_bf16 v[152:155], v[72:75], v[36:39], v[152:155]
    ds_read_b64_tr_b16 v[124:125], v14 offset:57344
    v_mfma_f32_16x16x32_bf16 v[156:159], v[76:79], v[36:39], v[156:159]
    ds_read_b64_tr_b16 v[126:127], v15 offset:57344
    v_mfma_f32_16x16x32_bf16 v[160:163], v[64:67], v[40:43], v[160:163]
    ds_read_b128 v[80:83], v6 offset:32768
    v_mfma_f32_16x16x32_bf16 v[164:167], v[68:71], v[40:43], v[164:167]
    ds_read_b128 v[84:87], v6 offset:33792
    v_mfma_f32_16x16x32_bf16 v[168:171], v[72:75], v[40:43], v[168:171]
    ds_read_b128 v[88:91], v6 offset:34816
    v_mfma_f32_16x16x32_bf16 v[172:175], v[76:79], v[40:43], v[172:175]
    ds_read_b128 v[92:95], v6 offset:35840
    v_mfma_f32_16x16x32_bf16 v[176:179], v[64:67], v[44:47], v[176:179]
    ds_read_b128 v[96:99], v6 offset:36864
    v_mfma_f32_16x16x32_bf16 v[180:183], v[68:71], v[44:47], v[180:183]
    ds_read_b128 v[100:103], v6 offset:37888
    v_mfma_f32_16x16x32_bf16 v[184:187], v[72:75], v[44:47], v[184:187]
    ds_read_b128 v[104:107], v6 offset:38912
    v_mfma_f32_16x16x32_bf16 v[188:191], v[76:79], v[44:47], v[188:191]
    ds_read_b128 v[108:111], v6 offset:39936
    v_mfma_f32_16x16x32_bf16 v[192:195], v[64:67], v[48:51], v[192:195]
    v_mfma_f32_16x16x32_bf16 v[196:199], v[68:71], v[48:51], v[196:199]
    v_mfma_f32_16x16x32_bf16 v[200:203], v[72:75], v[48:51], v[200:203]
    v_mfma_f32_16x16x32_bf16 v[204:207], v[76:79], v[48:51], v[204:207]
    v_mfma_f32_16x16x32_bf16 v[208:211], v[64:67], v[52:55], v[208:211]
    v_mfma_f32_16x16x32_bf16 v[212:215], v[68:71], v[52:55], v[212:215]
    v_mfma_f32_16x16x32_bf16 v[216:219], v[72:75], v[52:55], v[216:219]
    v_mfma_f32_16x16x32_bf16 v[220:223], v[76:79], v[52:55], v[220:223]
    v_mfma_f32_16x16x32_bf16 v[224:227], v[64:67], v[56:59], v[224:227]
    v_mfma_f32_16x16x32_bf16 v[228:231], v[68:71], v[56:59], v[228:231]
    v_mfma_f32_16x16x32_bf16 v[232:235], v[72:75], v[56:59], v[232:235]
    v_mfma_f32_16x16x32_bf16 v[236:239], v[76:79], v[56:59], v[236:239]
    v_mfma_f32_16x16x32_bf16 v[240:243], v[64:67], v[60:63], v[240:243]
    v_mfma_f32_16x16x32_bf16 v[244:247], v[68:71], v[60:63], v[244:247]
    v_mfma_f32_16x16x32_bf16 v[248:251], v[72:75], v[60:63], v[248:251]
    v_mfma_f32_16x16x32_bf16 v[252:255], v[76:79], v[60:63], v[252:255]
    s_waitcnt lgkmcnt(0)
    s_waitcnt vmcnt(0)
    s_barrier
    v_mfma_f32_16x16x32_bf16 v[128:131], v[112:115], v[80:83], v[128:131]
    ds_read_b64_tr_b16 v[64:65], v8 offset:16384
    v_mfma_f32_16x16x32_bf16 v[132:135], v[116:119], v[80:83], v[132:135]
    ds_read_b64_tr_b16 v[66:67], v9 offset:16384
    v_mfma_f32_16x16x32_bf16 v[136:139], v[120:123], v[80:83], v[136:139]
    ds_read_b64_tr_b16 v[68:69], v10 offset:16384
    v_mfma_f32_16x16x32_bf16 v[140:143], v[124:127], v[80:83], v[140:143]
    ds_read_b64_tr_b16 v[70:71], v11 offset:16384
    v_mfma_f32_16x16x32_bf16 v[144:147], v[112:115], v[84:87], v[144:147]
    ds_read_b64_tr_b16 v[72:73], v8 offset:24576
    v_mfma_f32_16x16x32_bf16 v[148:151], v[116:119], v[84:87], v[148:151]
    ds_read_b64_tr_b16 v[74:75], v9 offset:24576
    v_mfma_f32_16x16x32_bf16 v[152:155], v[120:123], v[84:87], v[152:155]
    ds_read_b64_tr_b16 v[76:77], v10 offset:24576
    v_mfma_f32_16x16x32_bf16 v[156:159], v[124:127], v[84:87], v[156:159]
    ds_read_b64_tr_b16 v[78:79], v11 offset:24576
    v_mfma_f32_16x16x32_bf16 v[160:163], v[112:115], v[88:91], v[160:163]
    ds_read_b128 v[32:35], v5 offset:0
    v_mfma_f32_16x16x32_bf16 v[164:167], v[116:119], v[88:91], v[164:167]
    ds_read_b128 v[36:39], v5 offset:1024
    v_mfma_f32_16x16x32_bf16 v[168:171], v[120:123], v[88:91], v[168:171]
    ds_read_b128 v[40:43], v5 offset:2048
    v_mfma_f32_16x16x32_bf16 v[172:175], v[124:127], v[88:91], v[172:175]
    ds_read_b128 v[44:47], v5 offset:3072
    v_mfma_f32_16x16x32_bf16 v[176:179], v[112:115], v[92:95], v[176:179]
    ds_read_b128 v[48:51], v5 offset:4096
    v_mfma_f32_16x16x32_bf16 v[180:183], v[116:119], v[92:95], v[180:183]
    ds_read_b128 v[52:55], v5 offset:5120
    v_mfma_f32_16x16x32_bf16 v[184:187], v[120:123], v[92:95], v[184:187]
    ds_read_b128 v[56:59], v5 offset:6144
    v_mfma_f32_16x16x32_bf16 v[188:191], v[124:127], v[92:95], v[188:191]
    ds_read_b128 v[60:63], v5 offset:7168
    v_mfma_f32_16x16x32_bf16 v[192:195], v[112:115], v[96:99], v[192:195]
    v_mfma_f32_16x16x32_bf16 v[196:199], v[116:119], v[96:99], v[196:199]
    v_mfma_f32_16x16x32_bf16 v[200:203], v[120:123], v[96:99], v[200:203]
    v_mfma_f32_16x16x32_bf16 v[204:207], v[124:127], v[96:99], v[204:207]
    v_mfma_f32_16x16x32_bf16 v[208:211], v[112:115], v[100:103], v[208:211]
    v_mfma_f32_16x16x32_bf16 v[212:215], v[116:119], v[100:103], v[212:215]
    v_mfma_f32_16x16x32_bf16 v[216:219], v[120:123], v[100:103], v[216:219]
    v_mfma_f32_16x16x32_bf16 v[220:223], v[124:127], v[100:103], v[220:223]
    v_mfma_f32_16x16x32_bf16 v[224:227], v[112:115], v[104:107], v[224:227]
    v_mfma_f32_16x16x32_bf16 v[228:231], v[116:119], v[104:107], v[228:231]
    v_mfma_f32_16x16x32_bf16 v[232:235], v[120:123], v[104:107], v[232:235]
    v_mfma_f32_16x16x32_bf16 v[236:239], v[124:127], v[104:107], v[236:239]
    v_mfma_f32_16x16x32_bf16 v[240:243], v[112:115], v[108:111], v[240:243]
    v_mfma_f32_16x16x32_bf16 v[244:247], v[116:119], v[108:111], v[244:247]
    v_mfma_f32_16x16x32_bf16 v[248:251], v[120:123], v[108:111], v[248:251]
    v_mfma_f32_16x16x32_bf16 v[252:255], v[124:127], v[108:111], v[252:255]
    s_waitcnt lgkmcnt(0)
w_end:
    v_mov_b32 v20, 131072
    ds_read_b128 v[24:27], v20
    ds_read_b128 v[28:31], v20 offset:16
    s_cmp_eq_u32 s48, 2
    s_cbranch_scc1 w_epi_glu
    s_cmp_eq_u32 s48, 3
    s_cbranch_scc1 w_epi_silu
    s_lshl_b32 s30, s27, 10
    s_add_u32 s30, s30, s49
    s_nop 7
    v_cvt_pk_bf16_f32 v80, v128, v129
    v_cvt_pk_bf16_f32 v81, v130, v131
    v_cvt_pk_bf16_f32 v82, v132, v133
    v_cvt_pk_bf16_f32 v83, v134, v135
    buffer_store_dwordx4 v[80:83], v1, s[4:7], s30 offen sc1
    v_cvt_pk_bf16_f32 v84, v136, v137
    v_cvt_pk_bf16_f32 v85, v138, v139
    v_cvt_pk_bf16_f32 v86, v140, v141
    v_cvt_pk_bf16_f32 v87, v142, v143
    buffer_store_dwordx4 v[84:87], v19, s[4:7], s30 offen sc1
    s_add_u32 s30, s30, s50
    v_cvt_pk_bf16_f32 v88, v144, v145
    v_cvt_pk_bf16_f32 v89, v146, v147
    v_cvt_pk_bf16_f32 v90, v148, v149
    v_cvt_pk_bf16_f32 v91, v150, v151
    buffer_store_dwordx4 v[88:91], v1, s[4:7], s30 offen sc1
    v_cvt_pk_bf16_f32 v92, v152, v153
    v_cvt_pk_bf16_f32 v93, v154, v155
    v_cvt_pk_bf16_f32 v94, v156, v157
    v_cvt_pk_bf16_f32 v95, v158, v159
    buffer_store_dwordx4 v[92:95], v19, s[4:7], s30 offen sc1
    s_add_u32 s30, s30, s50
    v_cvt_pk_bf16_f32 v80, v160, v161
    v_cvt_pk_bf16_f32 v81, v162, v163
    v_cvt_pk_bf16_f32 v82, v164, v165
    v_cvt_pk_bf16_f32 v83, v166, v167
    buffer_store_dwordx4 v[80:83], v1, s[4:7], s30 offen sc1
    v_cvt_pk_bf16_f32 v84, v168, v169
    v_cvt_pk_bf16_f32 v85, v170, v171
    v_cvt_pk_bf16_f32 v86, v172, v173
    v_cvt_pk_bf16_f32 v87, v174, v175
    buffer_store_dwordx4 v[84:87], v19, s[4:7], s30 offen sc1
    s_add_u32 s30, s30, s50
    v_cvt_pk_bf16_f32 v88, v176, v177
    v_cvt_pk_bf16_f32 v89, v178, v179
    v_cvt_pk_bf16_f32 v90, v180, v181
    v_cvt_pk_bf16_f32 v91, v182, v183
    buffer_store_dwordx4 v[88:91], v1, s[4:7], s30 offen sc1
    v_cvt_pk_bf16_f32 v92, v184, v185
    v_cvt_pk_bf16_f32 v93, v186, v187
    v_cvt_pk_bf16_f32 v94, v188, v189
    v_cvt_pk_bf16_f32 v95, v190, v191
    buffer_store_dwordx4 v[92:95], v19, s[4:7], s30 offen sc1
    s_add_u32 s30, s30, s50
    v_cvt_pk_bf16_f32 v80, v192, v193
    v_cvt_pk_bf16_f32 v81, v194, v195
    v_cvt_pk_bf16_f32 v82, v196, v197
    v_cvt_pk_bf16_f32 v83, v198, v199
    buffer_store_dwordx4 v[80:83], v1, s[4:7], s30 offen sc1
    v_cvt_pk_bf16_f32 v84, v200, v201
    v_cvt_pk_bf16_f32 v85, v202, v203
    v_cvt_pk_bf16_f32 v86, v204, v205
    v_cvt_pk_bf16_f32 v87, v206, v207
    buffer_store_dwordx4 v[84:87], v19, s[4:7], s30 offen sc1
    s_add_u32 s30, s30, s50
    v_cvt_pk_bf16_f32 v88, v208, v209
    v_cvt_pk_bf16_f32 v89, v210, v211
    v_cvt_pk_bf16_f32 v90, v212, v213
    v_cvt_pk_bf16_f32 v91, v214, v215
    buffer_store_dwordx4 v[88:91], v1, s[4:7], s30 offen sc1
    v_cvt_pk_bf16_f32 v92, v216, v217
    v_cvt_pk_bf16_f32 v93, v218, v219
    v_cvt_pk_bf16_f32 v94, v220, v221
    v_cvt_pk_bf16_f32 v95, v222, v223
    buffer_store_dwordx4 v[92:95], v19, s[4:7], s30 offen sc1
    s_add_u32 s30, s30, s50
    v_cvt_pk_bf16_f32 v80, v224, v225
    v_cvt_pk_bf16_f32 v81, v226, v227
    v_cvt_pk_bf16_f32 v82, v228, v229
    v_cvt_pk_bf16_f32 v83, v230, v231
    buffer_store_dwordx4 v[80:83], v1, s[4:7], s30 offen sc1
    v_cvt_pk_bf16_f32 v84, v232, v233
    v_cvt_pk_bf16_f32 v85, v234, v235
    v_cvt_pk_bf16_f32 v86, v236, v237
    v_cvt_pk_bf16_f32 v87, v238, v239
    buffer_store_dwordx4 v[84:87], v19, s[4:7], s30 offen sc1
    s_add_u32 s30, s30, s50
    v_cvt_pk_bf16_f32 v88, v240, v241
    v_cvt_pk_bf16_f32 v89, v242, v243
    v_cvt_pk_bf16_f32 v90, v244, v245
    v_cvt_pk_bf16_f32 v91, v246, v247
    buffer_store_dwordx4 v[88:91], v1, s[4:7], s30 offen sc1
    v_cvt_pk_bf16_f32 v92, v248, v249
    v_cvt_pk_bf16_f32 v93, v250, v251
    v_cvt_pk_bf16_f32 v94, v252, v253
    v_cvt_pk_bf16_f32 v95, v254, v255
    buffer_store_dwordx4 v[92:95], v19, s[4:7], s30 offen sc1
    s_waitcnt lgkmcnt(0)
    v_or3_b32 v24, v24, v25, v26
    v_or3_b32 v28, v28, v29, v30
    v_or3_b32 v24, v24, v27, v31
    v_or_b32 v24, v24, v28
    s_mov_b32 s28, s51
    s_mov_b32 s57, s53
    v_readfirstlane_b32 s30, v24
    s_cmp_lg_u32 s30, 0
    s_cbranch_scc1 w_drain
    s_mov_b32 s48, s32
    s_cmp_ge_u32 s32, 4
    s_cselect_b32 s30, 2, 3
    s_lshl_b32 s30, s26, s30
    s_mul_i32 s30, s30, s43
    s_add_u32 s49, s42, s30
    s_mov_b32 s50, s43
    s_mov_b32 s51, s46
    s_mov_b32 s23, s41
    s_mov_b32 s53, s47
    s_nop 0
    s_load_dwordx16 s[32:47], s[24:25], 0
    s_add_u32 s24, s24, 64
    s_addc_u32 s25, s25, 0
    s_branch w_first16
w_epi_glu:
    s_lshl_b32 s30, s27, 10
    s_add_u32 s30, s30, s49
    s_mov_b32 s54, 0xbfb8aa3b
    s_nop 7
    v_cvt_pk_bf16_f32 v80, v128, v129
    v_cvt_pk_bf16_f32 v81, v130, v131
    v_cvt_pk_bf16_f32 v82, v132, v133
    v_cvt_pk_bf16_f32 v83, v134, v135
    v_lshlrev_b32 v96, 16, v80
    v_and_b32 v97, 0xffff0000, v80
    v_lshlrev_b32 v98, 16, v81
    v_and_b32 v99, 0xffff0000, v81
    v_lshlrev_b32 v100, 16, v82
    v_and_b32 v101, 0xffff0000, v82
    v_lshlrev_b32 v102, 16, v83
    v_and_b32 v103, 0xffff0000, v83
    v_mul_f32 v96, s54, v96
    v_mul_f32 v97, s54, v97
    v_mul_f32 v98, s54, v98
    v_mul_f32 v99, s54, v99
    v_mul_f32 v100, s54, v100
    v_mul_f32 v101, s54, v101
    v_mul_f32 v102, s54, v102
    v_mul_f32 v103, s54, v103
    v_exp_f32 v96, v96
    v_exp_f32 v97, v97
    v_exp_f32 v98, v98
    v_exp_f32 v99, v99
    v_exp_f32 v100, v100
    v_exp_f32 v101, v101
    v_exp_f32 v102, v102
    v_exp_f32 v103, v103
    v_add_f32 v96, 1.0, v96
    v_add_f32 v97, 1.0, v97
    v_add_f32 v98, 1.0, v98
    v_add_f32 v99, 1.0, v99
    v_add_f32 v100, 1.0, v100
    v_add_f32 v101, 1.0, v101
    v_add_f32 v102, 1.0, v102
    v_add_f32 v103, 1.0, v103
    v_rcp_f32 v96, v96
    v_rcp_f32 v97, v97
    v_rcp_f32 v98, v98
    v_rcp_f32 v99, v99
    v_rcp_f32 v100, v100
    v_rcp_f32 v101, v101
    v_rcp_f32 v102, v102
    v_rcp_f32 v103, v103
    v_mul_f32 v96, v96, v136
    v_mul_f32 v97, v97, v137
    v_mul_f32 v98, v98, v138
    v_mul_f32 v99, v99, v139
    v_mul_f32 v100, v100, v140
    v_mul_f32 v101, v101, v141
    v_mul_f32 v102, v102, v142
    v_mul_f32 v103, v103, v143
    v_cvt_pk_bf16_f32 v80, v96, v97
    v_cvt_pk_bf16_f32 v81, v98, v99
    v_cvt_pk_bf16_f32 v82, v100, v101
    v_cvt_pk_bf16_f32 v83, v102, v103
    buffer_store_dwordx4 v[80:83], v1, s[4:7], s30 offen sc1
    s_add_u32 s30, s30, s50
    v_cvt_pk_bf16_f32 v84, v144, v145
    v_cvt_pk_bf16_f32 v85, v146, v147
    v_cvt_pk_bf16_f32 v86, v148, v149
    v_cvt_pk_bf16_f32 v87, v150, v151
    v_lshlrev_b32 v104, 16, v84
    v_and_b32 v105, 0xffff0000, v84
    v_lshlrev_b32 v106, 16, v85
    v_and_b32 v107, 0xffff0000, v85
    v_lshlrev_b32 v108, 16, v86
    v_and_b32 v109, 0xffff0000, v86
    v_lshlrev_b32 v110, 16, v87
    v_and_b32 v111, 0xffff0000, v87
    v_mul_f32 v104, s54, v104
    v_mul_f32 v105, s54, v105
    v_mul_f32 v106, s54, v106
    v_mul_f32 v107, s54, v107
    v_mul_f32 v108, s54, v108
    v_mul_f32 v109, s54, v109
    v_mul_f32 v110, s54, v110
    v_mul_f32 v111, s54, v111
    v_exp_f32 v104, v104
    v_exp_f32 v105, v105
    v_exp_f32 v106, v106
    v_exp_f32 v107, v107
    v_exp_f32 v108, v108
    v_exp_f32 v109, v109
    v_exp_f32 v110, v110
    v_exp_f32 v111, v111
    v_add_f32 v104, 1.0, v104
    v_add_f32 v105, 1.0, v105
    v_add_f32 v106, 1.0, v106
    v_add_f32 v107, 1.0, v107
    v_add_f32 v108, 1.0, v108
    v_add_f32 v109, 1.0, v109
    v_add_f32 v110, 1.0, v110
    v_add_f32 v111, 1.0, v111
    v_rcp_f32 v104, v104
    v_rcp_f32 v105, v105
    v_rcp_f32 v106, v106
    v_rcp_f32 v107, v107
    v_rcp_f32 v108, v108
    v_rcp_f32 v109, v109
    v_rcp_f32 v110, v110
    v_rcp_f32 v111, v111
    v_mul_f32 v104, v104, v152
    v_mul_f32 v105, v105, v153
    v_mul_f32 v106, v106, v154
    v_mul_f32 v107, v107, v155
    v_mul_f32 v108, v108, v156
    v_mul_f32 v109, v109, v157
    v_mul_f32 v110, v110, v158
    v_mul_f32 v111, v111, v159
    v_cvt_pk_bf16_f32 v84, v104, v105
    v_cvt_pk_bf16_f32 v85, v106, v107
    v_cvt_pk_bf16_f32 v86, v108, v109
    v_cvt_pk_bf16_f32 v87, v110, v111
    buffer_store_dwordx4 v[84:87], v1, s[4:7], s30 offen sc1
    s_add_u32 s30, s30, s50
    v_cvt_pk_bf16_f32 v88, v160, v161
    v_cvt_pk_bf16_f32 v89, v162, v163
    v_cvt_pk_bf16_f32 v90, v164, v165
    v_cvt_pk_bf16_f32 v91, v166, v167
    v_lshlrev_b32 v96, 16, v88
    v_and_b32 v97, 0xffff0000, v88
    v_lshlrev_b32 v98, 16, v89
    v_and_b32 v99, 0xffff0000, v89
    v_lshlrev_b32 v100, 16, v90
    v_and_b32 v101, 0xffff0000, v90
    v_lshlrev_b32 v102, 16, v91
    v_and_b32 v103, 0xffff0000, v91
    v_mul_f32 v96, s54, v96
    v_mul_f32 v97, s54, v97
    v_mul_f32 v98, s54, v98
    v_mul_f32 v99, s54, v99
    v_mul_f32 v100, s54, v100
    v_mul_f32 v101, s54, v101
    v_mul_f32 v102, s54, v102
    v_mul_f32 v103, s54, v103
    v_exp_f32 v96, v96
    v_exp_f32 v97, v97
    v_exp_f32 v98, v98
    v_exp_f32 v99, v99
    v_exp_f32 v100, v100
    v_exp_f32 v101, v101
    v_exp_f32 v102, v102
    v_exp_f32 v103, v103
    v_add_f32 v96, 1.0, v96
    v_add_f32 v97, 1.0, v97
    v_add_f32 v98, 1.0, v98
    v_add_f32 v99, 1.0, v99
    v_add_f32 v100, 1.0, v100
    v_add_f32 v101, 1.0, v101
    v_add_f32 v102, 1.0, v102
    v_add_f32 v103, 1.0, v103
    v_rcp_f32 v96, v96
    v_rcp_f32 v97, v97
    v_rcp_f32 v98, v98
    v_rcp_f32 v99, v99
    v_rcp_f32 v100, v100
    v_rcp_f32 v101, v101
    v_rcp_f32 v102, v102
    v_rcp_f32 v103, v103
    v_mul_f32 v96, v96, v168
    v_mul_f32 v97, v97, v169
    v_mul_f32 v98, v98, v170
    v_mul_f32 v99, v99, v171
    v_mul_f32 v100, v100, v172
    v_mul_f32 v101, v101, v173
    v_mul_f32 v102, v102, v174
    v_mul_f32 v103, v103, v175
    v_cvt_pk_bf16_f32 v88, v96, v97
    v_cvt_pk_bf16_f32 v89, v98, v99
    v_cvt_pk_bf16_f32 v90, v100, v101
    v_cvt_pk_bf16_f32 v91, v102, v103
    buffer_store_dwordx4 v[88:91], v1, s[4:7], s30 offen sc1
    s_add_u32 s30, s30, s50
    v_cvt_pk_bf16_f32 v92, v176, v177
    v_cvt_pk_bf16_f32 v93, v178, v179
    v_cvt_pk_bf16_f32 v94, v180, v181
    v_cvt_pk_bf16_f32 v95, v182, v183
    v_lshlrev_b32 v104, 16, v92
    v_and_b32 v105, 0xffff0000, v92
    v_lshlrev_b32 v106, 16, v93
    v_and_b32 v107, 0xffff0000, v93
    v_lshlrev_b32 v108, 16, v94
    v_and_b32 v109, 0xffff0000, v94
    v_lshlrev_b32 v110, 16, v95
    v_and_b32 v111, 0xffff0000, v95
    v_mul_f32 v104, s54, v104
    v_mul_f32 v105, s54, v105
    v_mul_f32 v106, s54, v106
    v_mul_f32 v107, s54, v107
    v_mul_f32 v108, s54, v108
    v_mul_f32 v109, s54, v109
    v_mul_f32 v110, s54, v110
    v_mul_f32 v111, s54, v111
    v_exp_f32 v104, v104
    v_exp_f32 v105, v105
    v_exp_f32 v106, v106
    v_exp_f32 v107, v107
    v_exp_f32 v108, v108
    v_exp_f32 v109, v109
    v_exp_f32 v110, v110
    v_exp_f32 v111, v111
    v_add_f32 v104, 1.0, v104
    v_add_f32 v105, 1.0, v105
    v_add_f32 v106, 1.0, v106
    v_add_f32 v107, 1.0, v107
    v_add_f32 v108, 1.0, v108
    v_add_f32 v109, 1.0, v109
    v_add_f32 v110, 1.0, v110
    v_add_f32 v111, 1.0, v111
    v_rcp_f32 v104, v104
    v_rcp_f32 v105, v105
    v_rcp_f32 v106, v106
    v_rcp_f32 v107, v107
    v_rcp_f32 v108, v108
    v_rcp_f32 v109, v109
    v_rcp_f32 v110, v110
    v_rcp_f32 v111, v111
    v_mul_f32 v104, v104, v184
    v_mul_f32 v105, v105, v185
    v_mul_f32 v106, v106, v186
    v_mul_f32 v107, v107, v187
    v_mul_f32 v108, v108, v188
    v_mul_f32 v109, v109, v189
    v_mul_f32 v110, v110, v190
    v_mul_f32 v111, v111, v191
    v_cvt_pk_bf16_f32 v92, v104, v105
    v_cvt_pk_bf16_f32 v93, v106, v107
    v_cvt_pk_bf16_f32 v94, v108, v109
    v_cvt_pk_bf16_f32 v95, v110, v111
    buffer_store_dwordx4 v[92:95], v1, s[4:7], s30 offen sc1
    s_add_u32 s30, s30, s50
    v_cvt_pk_bf16_f32 v80, v192, v193
    v_cvt_pk_bf16_f32 v81, v194, v195
    v_cvt_pk_bf16_f32 v82, v196, v197
    v_cvt_pk_bf16_f32 v83, v198, v199
    v_lshlrev_b32 v96, 16, v80
    v_and_b32 v97, 0xffff0000, v80
    v_lshlrev_b32 v98, 16, v81
    v_and_b32 v99, 0xffff0000, v81
    v_lshlrev_b32 v100, 16, v82
    v_and_b32 v101, 0xffff0000, v82
    v_lshlrev_b32 v102, 16, v83
    v_and_b32 v103, 0xffff0000, v83
    v_mul_f32 v96, s54, v96
    v_mul_f32 v97, s54, v97
    v_mul_f32 v98, s54, v98
    v_mul_f32 v99, s54, v99
    v_mul_f32 v100, s54, v100
    v_mul_f32 v101, s54, v101
    v_mul_f32 v102, s54, v102
    v_mul_f32 v103, s54, v103
    v_exp_f32 v96, v96
    v_exp_f32 v97, v97
    v_exp_f32 v98, v98
    v_exp_f32 v99, v99
    v_exp_f32 v100, v100
    v_exp_f32 v101, v101
    v_exp_f32 v102, v102
    v_exp_f32 v103, v103
    v_add_f32 v96, 1.0, v96
    v_add_f32 v97, 1.0, v97
    v_add_f32 v98, 1.0, v98
    v_add_f32 v99, 1.0, v99
    v_add_f32 v100, 1.0, v100
    v_add_f32 v101, 1.0, v101
    v_add_f32 v102, 1.0, v102
    v_add_f32 v103, 1.0, v103
    v_rcp_f32 v96, v96
    v_rcp_f32 v97, v97
    v_rcp_f32 v98, v98
    v_rcp_f32 v99, v99
    v_rcp_f32 v100, v100
    v_rcp_f32 v101, v101
    v_rcp_f32 v102, v102
    v_rcp_f32 v103, v103
    v_mul_f32 v96, v96, v200
    v_mul_f32 v97, v97, v201
    v_mul_f32 v98, v98, v202
    v_mul_f32 v99, v99, v203
    v_mul_f32 v100, v100, v204
    v_mul_f32 v101, v101, v205
    v_mul_f32 v102, v102, v206
    v_mul_f32 v103, v103, v207
    v_cvt_pk_bf16_f32 v80, v96, v97
    v_cvt_pk_bf16_f32 v81, v98, v99
    v_cvt_pk_bf16_f32 v82, v100, v101
    v_cvt_pk_bf16_f32 v83, v102, v103
    buffer_store_dwordx4 v[80:83], v1, s[4:7], s30 offen sc1
    s_add_u32 s30, s30, s50
    v_cvt_pk_bf16_f32 v84, v208, v209
    v_cvt_pk_bf16_f32 v85, v210, v211
    v_cvt_pk_bf16_f32 v86, v212, v213
    v_cvt_pk_bf16_f32 v87, v214, v215
    v_lshlrev_b32 v104, 16, v84
    v_and_b32 v105, 0xffff0000, v84
    v_lshlrev_b32 v106, 16, v85
    v_and_b32 v107, 0xffff0000, v85
    v_lshlrev_b32 v108, 16, v86
    v_and_b32 v109, 0xffff0000, v86
    v_lshlrev_b32 v110, 16, v87
    v_and_b32 v111, 0xffff0000, v87
    v_mul_f32 v104, s54, v104
    v_mul_f32 v105, s54, v105
    v_mul_f32 v106, s54, v106
    v_mul_f32 v107, s54, v107
    v_mul_f32 v108, s54, v108
    v_mul_f32 v109, s54, v109
    v_mul_f32 v110, s54, v110
    v_mul_f32 v111, s54, v111
    v_exp_f32 v104, v104
    v_exp_f32 v105, v105
    v_exp_f32 v106, v106
    v_exp_f32 v107, v107
    v_exp_f32 v108, v108
    v_exp_f32 v109, v109
    v_exp_f32 v110, v110
    v_exp_f32 v111, v111
    v_add_f32 v104, 1.0, v104
    v_add_f32 v105, 1.0, v105
    v_add_f32 v106, 1.0, v106
    v_add_f32 v107, 1.0, v107
    v_add_f32 v108, 1.0, v108
    v_add_f32 v109, 1.0, v109
    v_add_f32 v110, 1.0, v110
    v_add_f32 v111, 1.0, v111
    v_rcp_f32 v104, v104
    v_rcp_f32 v105, v105
    v_rcp_f32 v106, v106
    v_rcp_f32 v107, v107
    v_rcp_f32 v108, v108
    v_rcp_f32 v109, v109
    v_rcp_f32 v110, v110
    v_rcp_f32 v111, v111
    v_mul_f32 v104, v104, v216
    v_mul_f32 v105, v105, v217
    v_mul_f32 v106, v106, v218
    v_mul_f32 v107, v107, v219
    v_mul_f32 v108, v108, v220
    v_mul_f32 v109, v109, v221
    v_mul_f32 v110, v110, v222
    v_mul_f32 v111, v111, v223
    v_cvt_pk_bf16_f32 v84, v104, v105
    v_cvt_pk_bf16_f32 v85, v106, v107
    v_cvt_pk_bf16_f32 v86, v108, v109
    v_cvt_pk_bf16_f32 v87, v110, v111
    buffer_store_dwordx4 v[84:87], v1, s[4:7], s30 offen sc1
    s_add_u32 s30, s30, s50
    v_cvt_pk_bf16_f32 v88, v224, v225
    v_cvt_pk_bf16_f32 v89, v226, v227
    v_cvt_pk_bf16_f32 v90, v228, v229
    v_cvt_pk_bf16_f32 v91, v230, v231
    v_lshlrev_b32 v96, 16, v88
    v_and_b32 v97, 0xffff0000, v88
    v_lshlrev_b32 v98, 16, v89
    v_and_b32 v99, 0xffff0000, v89
    v_lshlrev_b32 v100, 16, v90
    v_and_b32 v101, 0xffff0000, v90
    v_lshlrev_b32 v102, 16, v91
    v_and_b32 v103, 0xffff0000, v91
    v_mul_f32 v96, s54, v96
    v_mul_f32 v97, s54, v97
    v_mul_f32 v98, s54, v98
    v_mul_f32 v99, s54, v99
    v_mul_f32 v100, s54, v100
    v_mul_f32 v101, s54, v101
    v_mul_f32 v102, s54, v102
    v_mul_f32 v103, s54, v103
    v_exp_f32 v96, v96
    v_exp_f32 v97, v97
    v_exp_f32 v98, v98
    v_exp_f32 v99, v99
    v_exp_f32 v100, v100
    v_exp_f32 v101, v101
    v_exp_f32 v102, v102
    v_exp_f32 v103, v103
    v_add_f32 v96, 1.0, v96
    v_add_f32 v97, 1.0, v97
    v_add_f32 v98, 1.0, v98
    v_add_f32 v99, 1.0, v99
    v_add_f32 v100, 1.0, v100
    v_add_f32 v101, 1.0, v101
    v_add_f32 v102, 1.0, v102
    v_add_f32 v103, 1.0, v103
    v_rcp_f32 v96, v96
    v_rcp_f32 v97, v97
    v_rcp_f32 v98, v98
    v_rcp_f32 v99, v99
    v_rcp_f32 v100, v100
    v_rcp_f32 v101, v101
    v_rcp_f32 v102, v102
    v_rcp_f32 v103, v103
    v_mul_f32 v96, v96, v232
    v_mul_f32 v97, v97, v233
    v_mul_f32 v98, v98, v234
    v_mul_f32 v99, v99, v235
    v_mul_f32 v100, v100, v236
    v_mul_f32 v101, v101, v237
    v_mul_f32 v102, v102, v238
    v_mul_f32 v103, v103, v239
    v_cvt_pk_bf16_f32 v88, v96, v97
    v_cvt_pk_bf16_f32 v89, v98, v99
    v_cvt_pk_bf16_f32 v90, v100, v101
    v_cvt_pk_bf16_f32 v91, v102, v103
    buffer_store_dwordx4 v[88:91], v1, s[4:7], s30 offen sc1
    s_add_u32 s30, s30, s50
    v_cvt_pk_bf16_f32 v92, v240, v241
    v_cvt_pk_bf16_f32 v93, v242, v243
    v_cvt_pk_bf16_f32 v94, v244, v245
    v_cvt_pk_bf16_f32 v95, v246, v247
    v_lshlrev_b32 v104, 16, v92
    v_and_b32 v105, 0xffff0000, v92
    v_lshlrev_b32 v106, 16, v93
    v_and_b32 v107, 0xffff0000, v93
    v_lshlrev_b32 v108, 16, v94
    v_and_b32 v109, 0xffff0000, v94
    v_lshlrev_b32 v110, 16, v95
    v_and_b32 v111, 0xffff0000, v95
    v_mul_f32 v104, s54, v104
    v_mul_f32 v105, s54, v105
    v_mul_f32 v106, s54, v106
    v_mul_f32 v107, s54, v107
    v_mul_f32 v108, s54, v108
    v_mul_f32 v109, s54, v109
    v_mul_f32 v110, s54, v110
    v_mul_f32 v111, s54, v111
    v_exp_f32 v104, v104
    v_exp_f32 v105, v105
    v_exp_f32 v106, v106
    v_exp_f32 v107, v107
    v_exp_f32 v108, v108
    v_exp_f32 v109, v109
    v_exp_f32 v110, v110
    v_exp_f32 v111, v111
    v_add_f32 v104, 1.0, v104
    v_add_f32 v105, 1.0, v105
    v_add_f32 v106, 1.0, v106
    v_add_f32 v107, 1.0, v107
    v_add_f32 v108, 1.0, v108
    v_add_f32 v109, 1.0, v109
    v_add_f32 v110, 1.0, v110
    v_add_f32 v111, 1.0, v111
    v_rcp_f32 v104, v104
    v_rcp_f32 v105, v105
    v_rcp_f32 v106, v106
    v_rcp_f32 v107, v107
    v_rcp_f32 v108, v108
    v_rcp_f32 v109, v109
    v_rcp_f32 v110, v110
    v_rcp_f32 v111, v111
    v_mul_f32 v104, v104, v248
    v_mul_f32 v105, v105, v249
    v_mul_f32 v106, v106, v250
    v_mul_f32 v107, v107, v251
    v_mul_f32 v108, v108, v252
    v_mul_f32 v109, v109, v253
    v_mul_f32 v110, v110, v254
    v_mul_f32 v111, v111, v255
    v_cvt_pk_bf16_f32 v92, v104, v105
    v_cvt_pk_bf16_f32 v93, v106, v107
    v_cvt_pk_bf16_f32 v94, v108, v109
    v_cvt_pk_bf16_f32 v95, v110, v111
    buffer_store_dwordx4 v[92:95], v1, s[4:7], s30 offen sc1
    s_waitcnt lgkmcnt(0)
    v_or3_b32 v24, v24, v25, v26
    v_or3_b32 v28, v28, v29, v30
    v_or3_b32 v24, v24, v27, v31
    v_or_b32 v24, v24, v28
    s_mov_b32 s28, s51
    s_mov_b32 s57, s53
    v_readfirstlane_b32 s30, v24
    s_cmp_lg_u32 s30, 0
    s_cbranch_scc1 w_drain
    s_mov_b32 s48, s32
    s_cmp_ge_u32 s32, 4
    s_cselect_b32 s30, 2, 3
    s_lshl_b32 s30, s26, s30
    s_mul_i32 s30, s30, s43
    s_add_u32 s49, s42, s30
    s_mov_b32 s50, s43
    s_mov_b32 s51, s46
    s_mov_b32 s23, s41
    s_mov_b32 s53, s47
    s_nop 0
    s_load_dwordx16 s[32:47], s[24:25], 0
    s_add_u32 s24, s24, 64
    s_addc_u32 s25, s25, 0
    s_branch w_first8
w_epi_silu:
    s_lshl_b32 s30, s27, 10
    s_add_u32 s30, s30, s49
    s_mov_b32 s54, 0xbfb8aa3b
    s_nop 7
    v_cvt_pk_bf16_f32 v80, v128, v129
    v_cvt_pk_bf16_f32 v81, v130, v131
    v_cvt_pk_bf16_f32 v82, v132, v133
    v_cvt_pk_bf16_f32 v83, v134, v135
    v_lshlrev_b32 v128, 16, v80
    v_and_b32 v129, 0xffff0000, v80
    v_lshlrev_b32 v130, 16, v81
    v_and_b32 v131, 0xffff0000, v81
    v_lshlrev_b32 v132, 16, v82
    v_and_b32 v133, 0xffff0000, v82
    v_lshlrev_b32 v134, 16, v83
    v_and_b32 v135, 0xffff0000, v83
    v_mul_f32 v104, s54, v128
    v_mul_f32 v105, s54, v129
    v_mul_f32 v106, s54, v130
    v_mul_f32 v107, s54, v131
    v_mul_f32 v108, s54, v132
    v_mul_f32 v109, s54, v133
    v_mul_f32 v110, s54, v134
    v_mul_f32 v111, s54, v135
    v_exp_f32 v104, v104
    v_exp_f32 v105, v105
    v_exp_f32 v106, v106
    v_exp_f32 v107, v107
    v_exp_f32 v108, v108
    v_exp_f32 v109, v109
    v_exp_f32 v110, v110
    v_exp_f32 v111, v111
    v_add_f32 v104, 1.0, v104
    v_add_f32 v105, 1.0, v105
    v_add_f32 v106, 1.0, v106
    v_add_f32 v107, 1.0, v107
    v_add_f32 v108, 1.0, v108
    v_add_f32 v109, 1.0, v109
    v_add_f32 v110, 1.0, v110
    v_add_f32 v111, 1.0, v111
    v_rcp_f32 v104, v104
    v_rcp_f32 v105, v105
    v_rcp_f32 v106, v106
    v_rcp_f32 v107, v107
    v_rcp_f32 v108, v108
    v_rcp_f32 v109, v109
    v_rcp_f32 v110, v110
    v_rcp_f32 v111, v111
    v_mul_f32 v128, v128, v104
    v_mul_f32 v129, v129, v105
    v_mul_f32 v130, v130, v106
    v_mul_f32 v131, v131, v107
    v_mul_f32 v132, v132, v108
    v_mul_f32 v133, v133, v109
    v_mul_f32 v134, v134, v110
    v_mul_f32 v135, v135, v111
    v_cvt_pk_bf16_f32 v80, v128, v129
    v_cvt_pk_bf16_f32 v81, v130, v131
    v_cvt_pk_bf16_f32 v82, v132, v133
    v_cvt_pk_bf16_f32 v83, v134, v135
    buffer_store_dwordx4 v[80:83], v1, s[4:7], s30 offen sc1
    v_cvt_pk_bf16_f32 v84, v136, v137
    v_cvt_pk_bf16_f32 v85, v138, v139
    v_cvt_pk_bf16_f32 v86, v140, v141
    v_cvt_pk_bf16_f32 v87, v142, v143
    v_lshlrev_b32 v136, 16, v84
    v_and_b32 v137, 0xffff0000, v84
    v_lshlrev_b32 v138, 16, v85
    v_and_b32 v139, 0xffff0000, v85
    v_lshlrev_b32 v140, 16, v86
    v_and_b32 v141, 0xffff0000, v86
    v_lshlrev_b32 v142, 16, v87
    v_and_b32 v143, 0xffff0000, v87
    v_mul_f32 v96, s54, v136
    v_mul_f32 v97, s54, v137
    v_mul_f32 v98, s54, v138
    v_mul_f32 v99, s54, v139
    v_mul_f32 v100, s54, v140
    v_mul_f32 v101, s54, v141
    v_mul_f32 v102, s54, v142
    v_mul_f32 v103, s54, v143
    v_exp_f32 v96, v96
    v_exp_f32 v97, v97
    v_exp_f32 v98, v98
    v_exp_f32 v99, v99
    v_exp_f32 v100, v100
    v_exp_f32 v101, v101
    v_exp_f32 v102, v102
    v_exp_f32 v103, v103
    v_add_f32 v96, 1.0, v96
    v_add_f32 v97, 1.0, v97
    v_add_f32 v98, 1.0, v98
    v_add_f32 v99, 1.0, v99
    v_add_f32 v100, 1.0, v100
    v_add_f32 v101, 1.0, v101
    v_add_f32 v102, 1.0, v102
    v_add_f32 v103, 1.0, v103
    v_rcp_f32 v96, v96
    v_rcp_f32 v97, v97
    v_rcp_f32 v98, v98
    v_rcp_f32 v99, v99
    v_rcp_f32 v100, v100
    v_rcp_f32 v101, v101
    v_rcp_f32 v102, v102
    v_rcp_f32 v103, v103
    v_mul_f32 v136, v136, v96
    v_mul_f32 v137, v137, v97
    v_mul_f32 v138, v138, v98
    v_mul_f32 v139, v139, v99
    v_mul_f32 v140, v140, v100
    v_mul_f32 v141, v141, v101
    v_mul_f32 v142, v142, v102
    v_mul_f32 v143, v143, v103
    v_cvt_pk_bf16_f32 v84, v136, v137
    v_cvt_pk_bf16_f32 v85, v138, v139
    v_cvt_pk_bf16_f32 v86, v140, v141
    v_cvt_pk_bf16_f32 v87, v142, v143
    buffer_store_dwordx4 v[84:87], v19, s[4:7], s30 offen sc1
    s_add_u32 s30, s30, s50
    v_cvt_pk_bf16_f32 v88, v144, v145
    v_cvt_pk_bf16_f32 v89, v146, v147
    v_cvt_pk_bf16_f32 v90, v148, v149
    v_cvt_pk_bf16_f32 v91, v150, v151
    v_lshlrev_b32 v144, 16, v88
    v_and_b32 v145, 0xffff0000, v88
    v_lshlrev_b32 v146, 16, v89
    v_and_b32 v147, 0xffff0000, v89
    v_lshlrev_b32 v148, 16, v90
    v_and_b32 v149, 0xffff0000, v90
    v_lshlrev_b32 v150, 16, v91
    v_and_b32 v151, 0xffff0000, v91
    v_mul_f32 v104, s54, v144
    v_mul_f32 v105, s54, v145
    v_mul_f32 v106, s54, v146
    v_mul_f32 v107, s54, v147
    v_mul_f32 v108, s54, v148
    v_mul_f32 v109, s54, v149
    v_mul_f32 v110, s54, v150
    v_mul_f32 v111, s54, v151
    v_exp_f32 v104, v104
    v_exp_f32 v105, v105
    v_exp_f32 v106, v106
    v_exp_f32 v107, v107
    v_exp_f32 v108, v108
    v_exp_f32 v109, v109
    v_exp_f32 v110, v110
    v_exp_f32 v111, v111
    v_add_f32 v104, 1.0, v104
    v_add_f32 v105, 1.0, v105
    v_add_f32 v106, 1.0, v106
    v_add_f32 v107, 1.0, v107
    v_add_f32 v108, 1.0, v108
    v_add_f32 v109, 1.0, v109
    v_add_f32 v110, 1.0, v110
    v_add_f32 v111, 1.0, v111
    v_rcp_f32 v104, v104
    v_rcp_f32 v105, v105
    v_rcp_f32 v106, v106
    v_rcp_f32 v107, v107
    v_rcp_f32 v108, v108
    v_rcp_f32 v109, v109
    v_rcp_f32 v110, v110
    v_rcp_f32 v111, v111
    v_mul_f32 v144, v144, v104
    v_mul_f32 v145, v145, v105
    v_mul_f32 v146, v146, v106
    v_mul_f32 v147, v147, v107
    v_mul_f32 v148, v148, v108
    v_mul_f32 v149, v149, v109
    v_mul_f32 v150, v150, v110
    v_mul_f32 v151, v151, v111
    v_cvt_pk_bf16_f32 v88, v144, v145
    v_cvt_pk_bf16_f32 v89, v146, v147
    v_cvt_pk_bf16_f32 v90, v148, v149
    v_cvt_pk_bf16_f32 v91, v150, v151
    buffer_store_dwordx4 v[88:91], v1, s[4:7], s30 offen sc1
    v_cvt_pk_bf16_f32 v92, v152, v153
    v_cvt_pk_bf16_f32 v93, v154, v155
    v_cvt_pk_bf16_f32 v94, v156, v157
    v_cvt_pk_bf16_f32 v95, v158, v159
    v_lshlrev_b32 v152, 16, v92
    v_and_b32 v153, 0xffff0000, v92
    v_lshlrev_b32 v154, 16, v93
    v_and_b32 v155, 0xffff0000, v93
    v_lshlrev_b32 v156, 16, v94
    v_and_b32 v157, 0xffff0000, v94
    v_lshlrev_b32 v158, 16, v95
    v_and_b32 v159, 0xffff0000, v95
    v_mul_f32 v96, s54, v152
    v_mul_f32 v97, s54, v153
    v_mul_f32 v98, s54, v154
    v_mul_f32 v99, s54, v155
    v_mul_f32 v100, s54, v156
    v_mul_f32 v101, s54, v157
    v_mul_f32 v102, s54, v158
    v_mul_f32 v103, s54, v159
    v_exp_f32 v96, v96
    v_exp_f32 v97, v97
    v_exp_f32 v98, v98
    v_exp_f32 v99, v99
    v_exp_f32 v100, v100
    v_exp_f32 v101, v101
    v_exp_f32 v102, v102
    v_exp_f32 v103, v103
    v_add_f32 v96, 1.0, v96
    v_add_f32 v97, 1.0, v97
    v_add_f32 v98, 1.0, v98
    v_add_f32 v99, 1.0, v99
    v_add_f32 v100, 1.0, v100
    v_add_f32 v101, 1.0, v101
    v_add_f32 v102, 1.0, v102
    v_add_f32 v103, 1.0, v103
    v_rcp_f32 v96, v96
    v_rcp_f32 v97, v97
    v_rcp_f32 v98, v98
    v_rcp_f32 v99, v99
    v_rcp_f32 v100, v100
    v_rcp_f32 v101, v101
    v_rcp_f32 v102, v102
    v_rcp_f32 v103, v103
    v_mul_f32 v152, v152, v96
    v_mul_f32 v153, v153, v97
    v_mul_f32 v154, v154, v98
    v_mul_f32 v155, v155, v99
    v_mul_f32 v156, v156, v100
    v_mul_f32 v157, v157, v101
    v_mul_f32 v158, v158, v102
    v_mul_f32 v159, v159, v103
    v_cvt_pk_bf16_f32 v92, v152, v153
    v_cvt_pk_bf16_f32 v93, v154, v155
    v_cvt_pk_bf16_f32 v94, v156, v157
    v_cvt_pk_bf16_f32 v95, v158, v159
    buffer_store_dwordx4 v[92:95], v19, s[4:7], s30 offen sc1
    s_add_u32 s30, s30, s50
    v_cvt_pk_bf16_f32 v80, v160, v161
    v_cvt_pk_bf16_f32 v81, v162, v163
    v_cvt_pk_bf16_f32 v82, v164, v165
    v_cvt_pk_bf16_f32 v83, v166, v167
    v_lshlrev_b32 v160, 16, v80
    v_and_b32 v161, 0xffff0000, v80
    v_lshlrev_b32 v162, 16, v81
    v_and_b32 v163, 0xffff0000, v81
    v_lshlrev_b32 v164, 16, v82
    v_and_b32 v165, 0xffff0000, v82
    v_lshlrev_b32 v166, 16, v83
    v_and_b32 v167, 0xffff0000, v83
    v_mul_f32 v104, s54, v160
    v_mul_f32 v105, s54, v161
    v_mul_f32 v106, s54, v162
    v_mul_f32 v107, s54, v163
    v_mul_f32 v108, s54, v164
    v_mul_f32 v109, s54, v165
    v_mul_f32 v110, s54, v166
    v_mul_f32 v111, s54, v167
    v_exp_f32 v104, v104
    v_exp_f32 v105, v105
    v_exp_f32 v106, v106
    v_exp_f32 v107, v107
    v_exp_f32 v108, v108
    v_exp_f32 v109, v109
    v_exp_f32 v110, v110
    v_exp_f32 v111, v111
    v_add_f32 v104, 1.0, v104
    v_add_f32 v105, 1.0, v105
    v_add_f32 v106, 1.0, v106
    v_add_f32 v107, 1.0, v107
    v_add_f32 v108, 1.0, v108
    v_add_f32 v109, 1.0, v109
    v_add_f32 v110, 1.0, v110
    v_add_f32 v111, 1.0, v111
    v_rcp_f32 v104, v104
    v_rcp_f32 v105, v105
    v_rcp_f32 v106, v106
    v_rcp_f32 v107, v107
    v_rcp_f32 v108, v108
    v_rcp_f32 v109, v109
    v_rcp_f32 v110, v110
    v_rcp_f32 v111, v111
    v_mul_f32 v160, v160, v104
    v_mul_f32 v161, v161, v105
    v_mul_f32 v162, v162, v106
    v_mul_f32 v163, v163, v107
    v_mul_f32 v164, v164, v108
    v_mul_f32 v165, v165, v109
    v_mul_f32 v166, v166, v110
    v_mul_f32 v167, v167, v111
    v_cvt_pk_bf16_f32 v80, v160, v161
    v_cvt_pk_bf16_f32 v81, v162, v163
    v_cvt_pk_bf16_f32 v82, v164, v165
    v_cvt_pk_bf16_f32 v83, v166, v167
    buffer_store_dwordx4 v[80:83], v1, s[4:7], s30 offen sc1
    v_cvt_pk_bf16_f32 v84, v168, v169
    v_cvt_pk_bf16_f32 v85, v170, v171
    v_cvt_pk_bf16_f32 v86, v172, v173
    v_cvt_pk_bf16_f32 v87, v174, v175
    v_lshlrev_b32 v168, 16, v84
    v_and_b32 v169, 0xffff0000, v84
    v_lshlrev_b32 v170, 16, v85
    v_and_b32 v171, 0xffff0000, v85
    v_lshlrev_b32 v172, 16, v86
    v_and_b32 v173, 0xffff0000, v86
    v_lshlrev_b32 v174, 16, v87
    v_and_b32 v175, 0xffff0000, v87
    v_mul_f32 v96, s54, v168
    v_mul_f32 v97, s54, v169
    v_mul_f32 v98, s54, v170
    v_mul_f32 v99, s54, v171
    v_mul_f32 v100, s54, v172
    v_mul_f32 v101, s54, v173
    v_mul_f32 v102, s54, v174
    v_mul_f32 v103, s54, v175
    v_exp_f32 v96, v96
    v_exp_f32 v97, v97
    v_exp_f32 v98, v98
    v_exp_f32 v99, v99
    v_exp_f32 v100, v100
    v_exp_f32 v101, v101
    v_exp_f32 v102, v102
    v_exp_f32 v103, v103
    v_add_f32 v96, 1.0, v96
    v_add_f32 v97, 1.0, v97
    v_add_f32 v98, 1.0, v98
    v_add_f32 v99, 1.0, v99
    v_add_f32 v100, 1.0, v100
    v_add_f32 v101, 1.0, v101
    v_add_f32 v102, 1.0, v102
    v_add_f32 v103, 1.0, v103
    v_rcp_f32 v96, v96
    v_rcp_f32 v97, v97
    v_rcp_f32 v98, v98
    v_rcp_f32 v99, v99
    v_rcp_f32 v100, v100
    v_rcp_f32 v101, v101
    v_rcp_f32 v102, v102
    v_rcp_f32 v103, v103
    v_mul_f32 v168, v168, v96
    v_mul_f32 v169, v169, v97
    v_mul_f32 v170, v170, v98
    v_mul_f32 v171, v171, v99
    v_mul_f32 v172, v172, v100
    v_mul_f32 v173, v173, v101
    v_mul_f32 v174, v174, v102
    v_mul_f32 v175, v175, v103
    v_cvt_pk_bf16_f32 v84, v168, v169
    v_cvt_pk_bf16_f32 v85, v170, v171
    v_cvt_pk_bf16_f32 v86, v172, v173
    v_cvt_pk_bf16_f32 v87, v174, v175
    buffer_store_dwordx4 v[84:87], v19, s[4:7], s30 offen sc1
    s_add_u32 s30, s30, s50
    v_cvt_pk_bf16_f32 v88, v176, v177
    v_cvt_pk_bf16_f32 v89, v178, v179
    v_cvt_pk_bf16_f32 v90, v180, v181
    v_cvt_pk_bf16_f32 v91, v182, v183
    v_lshlrev_b32 v176, 16, v88
    v_and_b32 v177, 0xffff0000, v88
    v_lshlrev_b32 v178, 16, v89
    v_and_b32 v179, 0xffff0000, v89
    v_lshlrev_b32 v180, 16, v90
    v_and_b32 v181, 0xffff0000, v90
    v_lshlrev_b32 v182, 16, v91
    v_and_b32 v183, 0xffff0000, v91
    v_mul_f32 v104, s54, v176
    v_mul_f32 v105, s54, v177
    v_mul_f32 v106, s54, v178
    v_mul_f32 v107, s54, v179
    v_mul_f32 v108, s54, v180
    v_mul_f32 v109, s54, v181
    v_mul_f32 v110, s54, v182
    v_mul_f32 v111, s54, v183
    v_exp_f32 v104, v104
    v_exp_f32 v105, v105
    v_exp_f32 v106, v106
    v_exp_f32 v107, v107
    v_exp_f32 v108, v108
    v_exp_f32 v109, v109
    v_exp_f32 v110, v110
    v_exp_f32 v111, v111
    v_add_f32 v104, 1.0, v104
    v_add_f32 v105, 1.0, v105
    v_add_f32 v106, 1.0, v106
    v_add_f32 v107, 1.0, v107
    v_add_f32 v108, 1.0, v108
    v_add_f32 v109, 1.0, v109
    v_add_f32 v110, 1.0, v110
    v_add_f32 v111, 1.0, v111
    v_rcp_f32 v104, v104
    v_rcp_f32 v105, v105
    v_rcp_f32 v106, v106
    v_rcp_f32 v107, v107
    v_rcp_f32 v108, v108
    v_rcp_f32 v109, v109
    v_rcp_f32 v110, v110
    v_rcp_f32 v111, v111
    v_mul_f32 v176, v176, v104
    v_mul_f32 v177, v177, v105
    v_mul_f32 v178, v178, v106
    v_mul_f32 v179, v179, v107
    v_mul_f32 v180, v180, v108
    v_mul_f32 v181, v181, v109
    v_mul_f32 v182, v182, v110
    v_mul_f32 v183, v183, v111
    v_cvt_pk_bf16_f32 v88, v176, v177
    v_cvt_pk_bf16_f32 v89, v178, v179
    v_cvt_pk_bf16_f32 v90, v180, v181
    v_cvt_pk_bf16_f32 v91, v182, v183
    buffer_store_dwordx4 v[88:91], v1, s[4:7], s30 offen sc1
    v_cvt_pk_bf16_f32 v92, v184, v185
    v_cvt_pk_bf16_f32 v93, v186, v187
    v_cvt_pk_bf16_f32 v94, v188, v189
    v_cvt_pk_bf16_f32 v95, v190, v191
    v_lshlrev_b32 v184, 16, v92
    v_and_b32 v185, 0xffff0000, v92
    v_lshlrev_b32 v186, 16, v93
    v_and_b32 v187, 0xffff0000, v93
    v_lshlrev_b32 v188, 16, v94
    v_and_b32 v189, 0xffff0000, v94
    v_lshlrev_b32 v190, 16, v95
    v_and_b32 v191, 0xffff0000, v95
    v_mul_f32 v96, s54, v184
    v_mul_f32 v97, s54, v185
    v_mul_f32 v98, s54, v186
    v_mul_f32 v99, s54, v187
    v_mul_f32 v100, s54, v188
    v_mul_f32 v101, s54, v189
    v_mul_f32 v102, s54, v190
    v_mul_f32 v103, s54, v191
    v_exp_f32 v96, v96
    v_exp_f32 v97, v97
    v_exp_f32 v98, v98
    v_exp_f32 v99, v99
    v_exp_f32 v100, v100
    v_exp_f32 v101, v101
    v_exp_f32 v102, v102
    v_exp_f32 v103, v103
    v_add_f32 v96, 1.0, v96
    v_add_f32 v97, 1.0, v97
    v_add_f32 v98, 1.0, v98
    v_add_f32 v99, 1.0, v99
    v_add_f32 v100, 1.0, v100
    v_add_f32 v101, 1.0, v101
    v_add_f32 v102, 1.0, v102
    v_add_f32 v103, 1.0, v103
    v_rcp_f32 v96, v96
    v_rcp_f32 v97, v97
    v_rcp_f32 v98, v98
    v_rcp_f32 v99, v99
    v_rcp_f32 v100, v100
    v_rcp_f32 v101, v101
    v_rcp_f32 v102, v102
    v_rcp_f32 v103, v103
    v_mul_f32 v184, v184, v96
    v_mul_f32 v185, v185, v97
    v_mul_f32 v186, v186, v98
    v_mul_f32 v187, v187, v99
    v_mul_f32 v188, v188, v100
    v_mul_f32 v189, v189, v101
    v_mul_f32 v190, v190, v102
    v_mul_f32 v191, v191, v103
    v_cvt_pk_bf16_f32 v92, v184, v185
    v_cvt_pk_bf16_f32 v93, v186, v187
    v_cvt_pk_bf16_f32 v94, v188, v189
    v_cvt_pk_bf16_f32 v95, v190, v191
    buffer_store_dwordx4 v[92:95], v19, s[4:7], s30 offen sc1
    s_add_u32 s30, s30, s50
    v_cvt_pk_bf16_f32 v80, v192, v193
    v_cvt_pk_bf16_f32 v81, v194, v195
    v_cvt_pk_bf16_f32 v82, v196, v197
    v_cvt_pk_bf16_f32 v83, v198, v199
    v_lshlrev_b32 v192, 16, v80
    v_and_b32 v193, 0xffff0000, v80
    v_lshlrev_b32 v194, 16, v81
    v_and_b32 v195, 0xffff0000, v81
    v_lshlrev_b32 v196, 16, v82
    v_and_b32 v197, 0xffff0000, v82
    v_lshlrev_b32 v198, 16, v83
    v_and_b32 v199, 0xffff0000, v83
    v_mul_f32 v104, s54, v192
    v_mul_f32 v105, s54, v193
    v_mul_f32 v106, s54, v194
    v_mul_f32 v107, s54, v195
    v_mul_f32 v108, s54, v196
    v_mul_f32 v109, s54, v197
    v_mul_f32 v110, s54, v198
    v_mul_f32 v111, s54, v199
    v_exp_f32 v104, v104
    v_exp_f32 v105, v105
    v_exp_f32 v106, v106
    v_exp_f32 v107, v107
    v_exp_f32 v108, v108
    v_exp_f32 v109, v109
    v_exp_f32 v110, v110
    v_exp_f32 v111, v111
    v_add_f32 v104, 1.0, v104
    v_add_f32 v105, 1.0, v105
    v_add_f32 v106, 1.0, v106
    v_add_f32 v107, 1.0, v107
    v_add_f32 v108, 1.0, v108
    v_add_f32 v109, 1.0, v109
    v_add_f32 v110, 1.0, v110
    v_add_f32 v111, 1.0, v111
    v_rcp_f32 v104, v104
    v_rcp_f32 v105, v105
    v_rcp_f32 v106, v106
    v_rcp_f32 v107, v107
    v_rcp_f32 v108, v108
    v_rcp_f32 v109, v109
    v_rcp_f32 v110, v110
    v_rcp_f32 v111, v111
    v_mul_f32 v192, v192, v104
    v_mul_f32 v193, v193, v105
    v_mul_f32 v194, v194, v106
    v_mul_f32 v195, v195, v107
    v_mul_f32 v196, v196, v108
    v_mul_f32 v197, v197, v109
    v_mul_f32 v198, v198, v110
    v_mul_f32 v199, v199, v111
    v_cvt_pk_bf16_f32 v80, v192, v193
    v_cvt_pk_bf16_f32 v81, v194, v195
    v_cvt_pk_bf16_f32 v82, v196, v197
    v_cvt_pk_bf16_f32 v83, v198, v199
    buffer_store_dwordx4 v[80:83], v1, s[4:7], s30 offen sc1
    v_cvt_pk_bf16_f32 v84, v200, v201
    v_cvt_pk_bf16_f32 v85, v202, v203
    v_cvt_pk_bf16_f32 v86, v204, v205
    v_cvt_pk_bf16_f32 v87, v206, v207
    v_lshlrev_b32 v200, 16, v84
    v_and_b32 v201, 0xffff0000, v84
    v_lshlrev_b32 v202, 16, v85
    v_and_b32 v203, 0xffff0000, v85
    v_lshlrev_b32 v204, 16, v86
    v_and_b32 v205, 0xffff0000, v86
    v_lshlrev_b32 v206, 16, v87
    v_and_b32 v207, 0xffff0000, v87
    v_mul_f32 v96, s54, v200
    v_mul_f32 v97, s54, v201
    v_mul_f32 v98, s54, v202
    v_mul_f32 v99, s54, v203
    v_mul_f32 v100, s54, v204
    v_mul_f32 v101, s54, v205
    v_mul_f32 v102, s54, v206
    v_mul_f32 v103, s54, v207
    v_exp_f32 v96, v96
    v_exp_f32 v97, v97
    v_exp_f32 v98, v98
    v_exp_f32 v99, v99
    v_exp_f32 v100, v100
    v_exp_f32 v101, v101
    v_exp_f32 v102, v102
    v_exp_f32 v103, v103
    v_add_f32 v96, 1.0, v96
    v_add_f32 v97, 1.0, v97
    v_add_f32 v98, 1.0, v98
    v_add_f32 v99, 1.0, v99
    v_add_f32 v100, 1.0, v100
    v_add_f32 v101, 1.0, v101
    v_add_f32 v102, 1.0, v102
    v_add_f32 v103, 1.0, v103
    v_rcp_f32 v96, v96
    v_rcp_f32 v97, v97
    v_rcp_f32 v98, v98
    v_rcp_f32 v99, v99
    v_rcp_f32 v100, v100
    v_rcp_f32 v101, v101
    v_rcp_f32 v102, v102
    v_rcp_f32 v103, v103
    v_mul_f32 v200, v200, v96
    v_mul_f32 v201, v201, v97
    v_mul_f32 v202, v202, v98
    v_mul_f32 v203, v203, v99
    v_mul_f32 v204, v204, v100
    v_mul_f32 v205, v205, v101
    v_mul_f32 v206, v206, v102
    v_mul_f32 v207, v207, v103
    v_cvt_pk_bf16_f32 v84, v200, v201
    v_cvt_pk_bf16_f32 v85, v202, v203
    v_cvt_pk_bf16_f32 v86, v204, v205
    v_cvt_pk_bf16_f32 v87, v206, v207
    buffer_store_dwordx4 v[84:87], v19, s[4:7], s30 offen sc1
    s_add_u32 s30, s30, s50
    v_cvt_pk_bf16_f32 v88, v208, v209
    v_cvt_pk_bf16_f32 v89, v210, v211
    v_cvt_pk_bf16_f32 v90, v212, v213
    v_cvt_pk_bf16_f32 v91, v214, v215
    v_lshlrev_b32 v208, 16, v88
    v_and_b32 v209, 0xffff0000, v88
    v_lshlrev_b32 v210, 16, v89
    v_and_b32 v211, 0xffff0000, v89
    v_lshlrev_b32 v212, 16, v90
    v_and_b32 v213, 0xffff0000, v90
    v_lshlrev_b32 v214, 16, v91
    v_and_b32 v215, 0xffff0000, v91
    v_mul_f32 v104, s54, v208
    v_mul_f32 v105, s54, v209
    v_mul_f32 v106, s54, v210
    v_mul_f32 v107, s54, v211
    v_mul_f32 v108, s54, v212
    v_mul_f32 v109, s54, v213
    v_mul_f32 v110, s54, v214
    v_mul_f32 v111, s54, v215
    v_exp_f32 v104, v104
    v_exp_f32 v105, v105
    v_exp_f32 v106, v106
    v_exp_f32 v107, v107
    v_exp_f32 v108, v108
    v_exp_f32 v109, v109
    v_exp_f32 v110, v110
    v_exp_f32 v111, v111
    v_add_f32 v104, 1.0, v104
    v_add_f32 v105, 1.0, v105
    v_add_f32 v106, 1.0, v106
    v_add_f32 v107, 1.0, v107
    v_add_f32 v108, 1.0, v108
    v_add_f32 v109, 1.0, v109
    v_add_f32 v110, 1.0, v110
    v_add_f32 v111, 1.0, v111
    v_rcp_f32 v104, v104
    v_rcp_f32 v105, v105
    v_rcp_f32 v106, v106
    v_rcp_f32 v107, v107
    v_rcp_f32 v108, v108
    v_rcp_f32 v109, v109
    v_rcp_f32 v110, v110
    v_rcp_f32 v111, v111
    v_mul_f32 v208, v208, v104
    v_mul_f32 v209, v209, v105
    v_mul_f32 v210, v210, v106
    v_mul_f32 v211, v211, v107
    v_mul_f32 v212, v212, v108
    v_mul_f32 v213, v213, v109
    v_mul_f32 v214, v214, v110
    v_mul_f32 v215, v215, v111
    v_cvt_pk_bf16_f32 v88, v208, v209
    v_cvt_pk_bf16_f32 v89, v210, v211
    v_cvt_pk_bf16_f32 v90, v212, v213
    v_cvt_pk_bf16_f32 v91, v214, v215
    buffer_store_dwordx4 v[88:91], v1, s[4:7], s30 offen sc1
    v_cvt_pk_bf16_f32 v92, v216, v217
    v_cvt_pk_bf16_f32 v93, v218, v219
    v_cvt_pk_bf16_f32 v94, v220, v221
    v_cvt_pk_bf16_f32 v95, v222, v223
    v_lshlrev_b32 v216, 16, v92
    v_and_b32 v217, 0xffff0000, v92
    v_lshlrev_b32 v218, 16, v93
    v_and_b32 v219, 0xffff0000, v93
    v_lshlrev_b32 v220, 16, v94
    v_and_b32 v221, 0xffff0000, v94
    v_lshlrev_b32 v222, 16, v95
    v_and_b32 v223, 0xffff0000, v95
    v_mul_f32 v96, s54, v216
    v_mul_f32 v97, s54, v217
    v_mul_f32 v98, s54, v218
    v_mul_f32 v99, s54, v219
    v_mul_f32 v100, s54, v220
    v_mul_f32 v101, s54, v221
    v_mul_f32 v102, s54, v222
    v_mul_f32 v103, s54, v223
    v_exp_f32 v96, v96
    v_exp_f32 v97, v97
    v_exp_f32 v98, v98
    v_exp_f32 v99, v99
    v_exp_f32 v100, v100
    v_exp_f32 v101, v101
    v_exp_f32 v102, v102
    v_exp_f32 v103, v103
    v_add_f32 v96, 1.0, v96
    v_add_f32 v97, 1.0, v97
    v_add_f32 v98, 1.0, v98
    v_add_f32 v99, 1.0, v99
    v_add_f32 v100, 1.0, v100
    v_add_f32 v101, 1.0, v101
    v_add_f32 v102, 1.0, v102
    v_add_f32 v103, 1.0, v103
    v_rcp_f32 v96, v96
    v_rcp_f32 v97, v97
    v_rcp_f32 v98, v98
    v_rcp_f32 v99, v99
    v_rcp_f32 v100, v100
    v_rcp_f32 v101, v101
    v_rcp_f32 v102, v102
    v_rcp_f32 v103, v103
    v_mul_f32 v216, v216, v96
    v_mul_f32 v217, v217, v97
    v_mul_f32 v218, v218, v98
    v_mul_f32 v219, v219, v99
    v_mul_f32 v220, v220, v100
    v_mul_f32 v221, v221, v101
    v_mul_f32 v222, v222, v102
    v_mul_f32 v223, v223, v103
    v_cvt_pk_bf16_f32 v92, v216, v217
    v_cvt_pk_bf16_f32 v93, v218, v219
    v_cvt_pk_bf16_f32 v94, v220, v221
    v_cvt_pk_bf16_f32 v95, v222, v223
    buffer_store_dwordx4 v[92:95], v19, s[4:7], s30 offen sc1
    s_add_u32 s30, s30, s50
    v_cvt_pk_bf16_f32 v80, v224, v225
    v_cvt_pk_bf16_f32 v81, v226, v227
    v_cvt_pk_bf16_f32 v82, v228, v229
    v_cvt_pk_bf16_f32 v83, v230, v231
    v_lshlrev_b32 v224, 16, v80
    v_and_b32 v225, 0xffff0000, v80
    v_lshlrev_b32 v226, 16, v81
    v_and_b32 v227, 0xffff0000, v81
    v_lshlrev_b32 v228, 16, v82
    v_and_b32 v229, 0xffff0000, v82
    v_lshlrev_b32 v230, 16, v83
    v_and_b32 v231, 0xffff0000, v83
    v_mul_f32 v104, s54, v224
    v_mul_f32 v105, s54, v225
    v_mul_f32 v106, s54, v226
    v_mul_f32 v107, s54, v227
    v_mul_f32 v108, s54, v228
    v_mul_f32 v109, s54, v229
    v_mul_f32 v110, s54, v230
    v_mul_f32 v111, s54, v231
    v_exp_f32 v104, v104
    v_exp_f32 v105, v105
    v_exp_f32 v106, v106
    v_exp_f32 v107, v107
    v_exp_f32 v108, v108
    v_exp_f32 v109, v109
    v_exp_f32 v110, v110
    v_exp_f32 v111, v111
    v_add_f32 v104, 1.0, v104
    v_add_f32 v105, 1.0, v105
    v_add_f32 v106, 1.0, v106
    v_add_f32 v107, 1.0, v107
    v_add_f32 v108, 1.0, v108
    v_add_f32 v109, 1.0, v109
    v_add_f32 v110, 1.0, v110
    v_add_f32 v111, 1.0, v111
    v_rcp_f32 v104, v104
    v_rcp_f32 v105, v105
    v_rcp_f32 v106, v106
    v_rcp_f32 v107, v107
    v_rcp_f32 v108, v108
    v_rcp_f32 v109, v109
    v_rcp_f32 v110, v110
    v_rcp_f32 v111, v111
    v_mul_f32 v224, v224, v104
    v_mul_f32 v225, v225, v105
    v_mul_f32 v226, v226, v106
    v_mul_f32 v227, v227, v107
    v_mul_f32 v228, v228, v108
    v_mul_f32 v229, v229, v109
    v_mul_f32 v230, v230, v110
    v_mul_f32 v231, v231, v111
    v_cvt_pk_bf16_f32 v80, v224, v225
    v_cvt_pk_bf16_f32 v81, v226, v227
    v_cvt_pk_bf16_f32 v82, v228, v229
    v_cvt_pk_bf16_f32 v83, v230, v231
    buffer_store_dwordx4 v[80:83], v1, s[4:7], s30 offen sc1
    v_cvt_pk_bf16_f32 v84, v232, v233
    v_cvt_pk_bf16_f32 v85, v234, v235
    v_cvt_pk_bf16_f32 v86, v236, v237
    v_cvt_pk_bf16_f32 v87, v238, v239
    v_lshlrev_b32 v232, 16, v84
    v_and_b32 v233, 0xffff0000, v84
    v_lshlrev_b32 v234, 16, v85
    v_and_b32 v235, 0xffff0000, v85
    v_lshlrev_b32 v236, 16, v86
    v_and_b32 v237, 0xffff0000, v86
    v_lshlrev_b32 v238, 16, v87
    v_and_b32 v239, 0xffff0000, v87
    v_mul_f32 v96, s54, v232
    v_mul_f32 v97, s54, v233
    v_mul_f32 v98, s54, v234
    v_mul_f32 v99, s54, v235
    v_mul_f32 v100, s54, v236
    v_mul_f32 v101, s54, v237
    v_mul_f32 v102, s54, v238
    v_mul_f32 v103, s54, v239
    v_exp_f32 v96, v96
    v_exp_f32 v97, v97
    v_exp_f32 v98, v98
    v_exp_f32 v99, v99
    v_exp_f32 v100, v100
    v_exp_f32 v101, v101
    v_exp_f32 v102, v102
    v_exp_f32 v103, v103
    v_add_f32 v96, 1.0, v96
    v_add_f32 v97, 1.0, v97
    v_add_f32 v98, 1.0, v98
    v_add_f32 v99, 1.0, v99
    v_add_f32 v100, 1.0, v100
    v_add_f32 v101, 1.0, v101
    v_add_f32 v102, 1.0, v102
    v_add_f32 v103, 1.0, v103
    v_rcp_f32 v96, v96
    v_rcp_f32 v97, v97
    v_rcp_f32 v98, v98
    v_rcp_f32 v99, v99
    v_rcp_f32 v100, v100
    v_rcp_f32 v101, v101
    v_rcp_f32 v102, v102
    v_rcp_f32 v103, v103
    v_mul_f32 v232, v232, v96
    v_mul_f32 v233, v233, v97
    v_mul_f32 v234, v234, v98
    v_mul_f32 v235, v235, v99
    v_mul_f32 v236, v236, v100
    v_mul_f32 v237, v237, v101
    v_mul_f32 v238, v238, v102
    v_mul_f32 v239, v239, v103
    v_cvt_pk_bf16_f32 v84, v232, v233
    v_cvt_pk_bf16_f32 v85, v234, v235
    v_cvt_pk_bf16_f32 v86, v236, v237
    v_cvt_pk_bf16_f32 v87, v238, v239
    buffer_store_dwordx4 v[84:87], v19, s[4:7], s30 offen sc1
    s_add_u32 s30, s30, s50
    v_cvt_pk_bf16_f32 v88, v240, v241
    v_cvt_pk_bf16_f32 v89, v242, v243
    v_cvt_pk_bf16_f32 v90, v244, v245
    v_cvt_pk_bf16_f32 v91, v246, v247
    v_lshlrev_b32 v240, 16, v88
    v_and_b32 v241, 0xffff0000, v88
    v_lshlrev_b32 v242, 16, v89
    v_and_b32 v243, 0xffff0000, v89
    v_lshlrev_b32 v244, 16, v90
    v_and_b32 v245, 0xffff0000, v90
    v_lshlrev_b32 v246, 16, v91
    v_and_b32 v247, 0xffff0000, v91
    v_mul_f32 v104, s54, v240
    v_mul_f32 v105, s54, v241
    v_mul_f32 v106, s54, v242
    v_mul_f32 v107, s54, v243
    v_mul_f32 v108, s54, v244
    v_mul_f32 v109, s54, v245
    v_mul_f32 v110, s54, v246
    v_mul_f32 v111, s54, v247
    v_exp_f32 v104, v104
    v_exp_f32 v105, v105
    v_exp_f32 v106, v106
    v_exp_f32 v107, v107
    v_exp_f32 v108, v108
    v_exp_f32 v109, v109
    v_exp_f32 v110, v110
    v_exp_f32 v111, v111
    v_add_f32 v104, 1.0, v104
    v_add_f32 v105, 1.0, v105
    v_add_f32 v106, 1.0, v106
    v_add_f32 v107, 1.0, v107
    v_add_f32 v108, 1.0, v108
    v_add_f32 v109, 1.0, v109
    v_add_f32 v110, 1.0, v110
    v_add_f32 v111, 1.0, v111
    v_rcp_f32 v104, v104
    v_rcp_f32 v105, v105
    v_rcp_f32 v106, v106
    v_rcp_f32 v107, v107
    v_rcp_f32 v108, v108
    v_rcp_f32 v109, v109
    v_rcp_f32 v110, v110
    v_rcp_f32 v111, v111
    v_mul_f32 v240, v240, v104
    v_mul_f32 v241, v241, v105
    v_mul_f32 v242, v242, v106
    v_mul_f32 v243, v243, v107
    v_mul_f32 v244, v244, v108
    v_mul_f32 v245, v245, v109
    v_mul_f32 v246, v246, v110
    v_mul_f32 v247, v247, v111
    v_cvt_pk_bf16_f32 v88, v240, v241
    v_cvt_pk_bf16_f32 v89, v242, v243
    v_cvt_pk_bf16_f32 v90, v244, v245
    v_cvt_pk_bf16_f32 v91, v246, v247
    buffer_store_dwordx4 v[88:91], v1, s[4:7], s30 offen sc1
    v_cvt_pk_bf16_f32 v92, v248, v249
    v_cvt_pk_bf16_f32 v93, v250, v251
    v_cvt_pk_bf16_f32 v94, v252, v253
    v_cvt_pk_bf16_f32 v95, v254, v255
    v_lshlrev_b32 v248, 16, v92
    v_and_b32 v249, 0xffff0000, v92
    v_lshlrev_b32 v250, 16, v93
    v_and_b32 v251, 0xffff0000, v93
    v_lshlrev_b32 v252, 16, v94
    v_and_b32 v253, 0xffff0000, v94
    v_lshlrev_b32 v254, 16, v95
    v_and_b32 v255, 0xffff0000, v95
    v_mul_f32 v96, s54, v248
    v_mul_f32 v97, s54, v249
    v_mul_f32 v98, s54, v250
    v_mul_f32 v99, s54, v251
    v_mul_f32 v100, s54, v252
    v_mul_f32 v101, s54, v253
    v_mul_f32 v102, s54, v254
    v_mul_f32 v103, s54, v255
    v_exp_f32 v96, v96
    v_exp_f32 v97, v97
    v_exp_f32 v98, v98
    v_exp_f32 v99, v99
    v_exp_f32 v100, v100
    v_exp_f32 v101, v101
    v_exp_f32 v102, v102
    v_exp_f32 v103, v103
    v_add_f32 v96, 1.0, v96
    v_add_f32 v97, 1.0, v97
    v_add_f32 v98, 1.0, v98
    v_add_f32 v99, 1.0, v99
    v_add_f32 v100, 1.0, v100
    v_add_f32 v101, 1.0, v101
    v_add_f32 v102, 1.0, v102
    v_add_f32 v103, 1.0, v103
    v_rcp_f32 v96, v96
    v_rcp_f32 v97, v97
    v_rcp_f32 v98, v98
    v_rcp_f32 v99, v99
    v_rcp_f32 v100, v100
    v_rcp_f32 v101, v101
    v_rcp_f32 v102, v102
    v_rcp_f32 v103, v103
    v_mul_f32 v248, v248, v96
    v_mul_f32 v249, v249, v97
    v_mul_f32 v250, v250, v98
    v_mul_f32 v251, v251, v99
    v_mul_f32 v252, v252, v100
    v_mul_f32 v253, v253, v101
    v_mul_f32 v254, v254, v102
    v_mul_f32 v255, v255, v103
    v_cvt_pk_bf16_f32 v92, v248, v249
    v_cvt_pk_bf16_f32 v93, v250, v251
    v_cvt_pk_bf16_f32 v94, v252, v253
    v_cvt_pk_bf16_f32 v95, v254, v255
    buffer_store_dwordx4 v[92:95], v19, s[4:7], s30 offen sc1
    s_waitcnt lgkmcnt(0)
    v_or3_b32 v24, v24, v25, v26
    v_or3_b32 v28, v28, v29, v30
    v_or3_b32 v24, v24, v27, v31
    v_or_b32 v24, v24, v28
    s_mov_b32 s28, s51
    s_mov_b32 s57, s53
    v_readfirstlane_b32 s30, v24
    s_cmp_lg_u32 s30, 0
    s_cbranch_scc1 w_drain
    s_mov_b32 s48, s32
    s_cmp_ge_u32 s32, 4
    s_cselect_b32 s30, 2, 3
    s_lshl_b32 s30, s26, s30
    s_mul_i32 s30, s30, s43
    s_add_u32 s49, s42, s30
    s_mov_b32 s50, s43
    s_mov_b32 s51, s46
    s_mov_b32 s23, s41
    s_mov_b32 s53, s47
    s_nop 0
    s_load_dwordx16 s[32:47], s[24:25], 0
    s_add_u32 s24, s24, 64
    s_addc_u32 s25, s25, 0
    s_branch w_first16
w_firstH:
    s_waitcnt vmcnt(8)
    s_barrier
    s_add_u32 m0, s21, 0
    s_nop 0
    buffer_load_dwordx4 v1, s[4:7], s16 offen sc1 lds
    s_add_u32 s16, s16, s62
    s_add_u32 m0, s21, 1024
    s_nop 0
    buffer_load_dwordx4 v1, s[4:7], s17 offen sc1 lds
    s_add_u32 s17, s17, s62
    s_add_u32 m0, s22, 0
    s_nop 0
    buffer_load_dwordx4 v2, s[8:11], s18 offen lds
    s_add_u32 s18, s18, s20
    s_add_u32 m0, s22, 8192
    s_nop 0
    buffer_load_dwordx4 v2, s[12:15], s19 offen lds
    s_add_u32 s19, s19, s20
    v_mfma_f32_16x16x32_bf16 v[128:131], v[64:67], v[32:35], 0
    ds_read_b64_tr_b16 v[112:113], v8 offset:49152
    v_mfma_f32_16x16x32_bf16 v[132:135], v[68:71], v[32:35], 0
    ds_read_b64_tr_b16 v[114:115], v9 offset:49152
    v_mfma_f32_16x16x32_bf16 v[144:147], v[64:67], v[40:43], 0
    ds_read_b64_tr_b16 v[116:117], v10 offset:49152
    v_mfma_f32_16x16x32_bf16 v[148:151], v[68:71], v[40:43], 0
    ds_read_b64_tr_b16 v[118:119], v11 offset:49152
    v_mfma_f32_16x16x32_bf16 v[160:163], v[64:67], v[48:51], 0
    ds_read_b64_tr_b16 v[120:121], v8 offset:57344
    v_mfma_f32_16x16x32_bf16 v[164:167], v[68:71], v[48:51], 0
    ds_read_b64_tr_b16 v[122:123], v9 offset:57344
    v_mfma_f32_16x16x32_bf16 v[176:179], v[64:67], v[56:59], 0
    ds_read_b64_tr_b16 v[124:125], v10 offset:57344
    v_mfma_f32_16x16x32_bf16 v[180:183], v[68:71], v[56:59], 0
    ds_read_b64_tr_b16 v[126:127], v11 offset:57344
    v_mfma_f32_16x16x32_bf16 v[128:131], v[72:75], v[36:39], v[128:131]
    ds_read_b128 v[80:83], v5 offset:32768
    v_mfma_f32_16x16x32_bf16 v[132:135], v[76:79], v[36:39], v[132:135]
    ds_read_b128 v[84:87], v5 offset:33792
    v_mfma_f32_16x16x32_bf16 v[144:147], v[72:75], v[44:47], v[144:147]
    ds_read_b128 v[88:91], v5 offset:34816
    v_mfma_f32_16x16x32_bf16 v[148:151], v[76:79], v[44:47], v[148:151]
    ds_read_b128 v[92:95], v5 offset:35840
    v_mfma_f32_16x16x32_bf16 v[160:163], v[72:75], v[52:55], v[160:163]
    ds_read_b128 v[96:99], v5 offset:36864
    v_mfma_f32_16x16x32_bf16 v[164:167], v[76:79], v[52:55], v[164:167]
    ds_read_b128 v[100:103], v5 offset:37888
    v_mfma_f32_16x16x32_bf16 v[176:179], v[72:75], v[60:63], v[176:179]
    ds_read_b128 v[104:107], v5 offset:38912
    v_mfma_f32_16x16x32_bf16 v[180:183], v[76:79], v[60:63], v[180:183]
    ds_read_b128 v[108:111], v5 offset:39936
    s_waitcnt lgkmcnt(0)
    s_waitcnt vmcnt(8)
    s_barrier
    s_add_u32 m0, s21, 32768
    s_nop 0
    buffer_load_dwordx4 v1, s[4:7], s16 offen sc1 lds
    s_add_u32 s16, s16, s62
    s_add_u32 m0, s21, 33792
    s_nop 0
    buffer_load_dwordx4 v1, s[4:7], s17 offen sc1 lds
    s_add_u32 s17, s17, s62
    s_add_u32 m0, s22, 32768
    s_nop 0
    buffer_load_dwordx4 v2, s[8:11], s18 offen lds
    s_add_u32 s18, s18, s20
    s_add_u32 m0, s22, 40960
    s_nop 0
    buffer_load_dwordx4 v2, s[12:15], s19 offen lds
    s_add_u32 s19, s19, s20
    v_mfma_f32_16x16x32_bf16 v[128:131], v[112:115], v[80:83], v[128:131]
    ds_read_b64_tr_b16 v[64:65], v12 offset:16384
    v_mfma_f32_16x16x32_bf16 v[132:135], v[116:119], v[80:83], v[132:135]
    ds_read_b64_tr_b16 v[66:67], v13 offset:16384
    v_mfma_f32_16x16x32_bf16 v[144:147], v[112:115], v[88:91], v[144:147]
    ds_read_b64_tr_b16 v[68:69], v14 offset:16384
    v_mfma_f32_16x16x32_bf16 v[148:151], v[116:119], v[88:91], v[148:151]
    ds_read_b64_tr_b16 v[70:71], v15 offset:16384
    v_mfma_f32_16x16x32_bf16 v[160:163], v[112:115], v[96:99], v[160:163]
    ds_read_b64_tr_b16 v[72:73], v12 offset:24576
    v_mfma_f32_16x16x32_bf16 v[164:167], v[116:119], v[96:99], v[164:167]
    ds_read_b64_tr_b16 v[74:75], v13 offset:24576
    v_mfma_f32_16x16x32_bf16 v[176:179], v[112:115], v[104:107], v[176:179]
    ds_read_b64_tr_b16 v[76:77], v14 offset:24576
    v_mfma_f32_16x16x32_bf16 v[180:183], v[116:119], v[104:107], v[180:183]
    ds_read_b64_tr_b16 v[78:79], v15 offset:24576
    v_mfma_f32_16x16x32_bf16 v[128:131], v[120:123], v[84:87], v[128:131]
    ds_read_b128 v[32:35], v6 offset:0
    v_mfma_f32_16x16x32_bf16 v[132:135], v[124:127], v[84:87], v[132:135]
    ds_read_b128 v[36:39], v6 offset:1024
    v_mfma_f32_16x16x32_bf16 v[144:147], v[120:123], v[92:95], v[144:147]
    ds_read_b128 v[40:43], v6 offset:2048
    v_mfma_f32_16x16x32_bf16 v[148:151], v[124:127], v[92:95], v[148:151]
    ds_read_b128 v[44:47], v6 offset:3072
    v_mfma_f32_16x16x32_bf16 v[160:163], v[120:123], v[100:103], v[160:163]
    ds_read_b128 v[48:51], v6 offset:4096
    v_mfma_f32_16x16x32_bf16 v[164:167], v[124:127], v[100:103], v[164:167]
    ds_read_b128 v[52:55], v6 offset:5120
    v_mfma_f32_16x16x32_bf16 v[176:179], v[120:123], v[108:111], v[176:179]
    ds_read_b128 v[56:59], v6 offset:6144
    v_mfma_f32_16x16x32_bf16 v[180:183], v[124:127], v[108:111], v[180:183]
    ds_read_b128 v[60:63], v6 offset:7168
    s_waitcnt lgkmcnt(0)
    s_waitcnt vmcnt(8)
    s_barrier
    s_add_u32 m0, s21, 65536
    s_nop 0
    buffer_load_dwordx4 v1, s[4:7], s16 offen sc1 lds
    s_add_u32 s16, s16, s62
    s_add_u32 m0, s21, 66560
    s_nop 0
    buffer_load_dwordx4 v1, s[4:7], s17 offen sc1 lds
    s_add_u32 s17, s17, s62
    s_add_u32 m0, s22, 65536
    s_nop 0
    buffer_load_dwordx4 v2, s[8:11], s18 offen lds
    s_add_u32 s18, s18, s20
    s_add_u32 m0, s22, 73728
    s_nop 0
    buffer_load_dwordx4 v2, s[12:15], s19 offen lds
    s_add_u32 s19, s19, s20
    v_mfma_f32_16x16x32_bf16 v[128:131], v[64:67], v[32:35], v[128:131]
    ds_read_b64_tr_b16 v[112:113], v12 offset:49152
    v_mfma_f32_16x16x32_bf16 v[132:135], v[68:71], v[32:35], v[132:135]
    ds_read_b64_tr_b16 v[114:115], v13 offset:49152
    v_mfma_f32_16x16x32_bf16 v[144:147], v[64:67], v[40:43], v[144:147]
    ds_read_b64_tr_b16 v[116:117], v14 offset:49152
    v_mfma_f32_16x16x32_bf16 v[148:151], v[68:71], v[40:43], v[148:151]
    ds_read_b64_tr_b16 v[118:119], v15 offset:49152
    v_mfma_f32_16x16x32_bf16 v[160:163], v[64:67], v[48:51], v[160:163]
    ds_read_b64_tr_b16 v[120:121], v12 offset:57344
    v_mfma_f32_16x16x32_bf16 v[164:167], v[68:71], v[48:51], v[164:167]
    ds_read_b64_tr_b16 v[122:123], v13 offset:57344
    v_mfma_f32_16x16x32_bf16 v[176:179], v[64:67], v[56:59], v[176:179]
    ds_read_b64_tr_b16 v[124:125], v14 offset:57344
    v_mfma_f32_16x16x32_bf16 v[180:183], v[68:71], v[56:59], v[180:183]
    ds_read_b64_tr_b16 v[126:127], v15 offset:57344
    v_mfma_f32_16x16x32_bf16 v[128:131], v[72:75], v[36:39], v[128:131]
    ds_read_b128 v[80:83], v6 offset:32768
    v_mfma_f32_16x16x32_bf16 v[132:135], v[76:79], v[36:39], v[132:135]
    ds_read_b128 v[84:87], v6 offset:33792
    v_mfma_f32_16x16x32_bf16 v[144:147], v[72:75], v[44:47], v[144:147]
    ds_read_b128 v[88:91], v6 offset:34816
    v_mfma_f32_16x16x32_bf16 v[148:151], v[76:79], v[44:47], v[148:151]
    ds_read_b128 v[92:95], v6 offset:35840
    v_mfma_f32_16x16x32_bf16 v[160:163], v[72:75], v[52:55], v[160:163]
    ds_read_b128 v[96:99], v6 offset:36864
    v_mfma_f32_16x16x32_bf16 v[164:167], v[76:79], v[52:55], v[164:167]
    ds_read_b128 v[100:103], v6 offset:37888
    v_mfma_f32_16x16x32_bf16 v[176:179], v[72:75], v[60:63], v[176:179]
    ds_read_b128 v[104:107], v6 offset:38912
    v_mfma_f32_16x16x32_bf16 v[180:183], v[76:79], v[60:63], v[180:183]
    ds_read_b128 v[108:111], v6 offset:39936
    s_waitcnt lgkmcnt(0)
    s_waitcnt vmcnt(8)
    s_barrier
    s_add_u32 m0, s21, 98304
    s_nop 0
    buffer_load_dwordx4 v1, s[4:7], s16 offen sc1 lds
    s_add_u32 s16, s16, s62
    s_add_u32 m0, s21, 99328
    s_nop 0
    buffer_load_dwordx4 v1, s[4:7], s17 offen sc1 lds
    s_add_u32 s17, s17, s62
    s_add_u32 m0, s22, 98304
    s_nop 0
    buffer_load_dwordx4 v2, s[8:11], s18 offen lds
    s_add_u32 s18, s18, s20
    s_add_u32 m0, s22, 106496
    s_nop 0
    buffer_load_dwordx4 v2, s[12:15], s19 offen lds
    s_add_u32 s19, s19, s20
    v_mfma_f32_16x16x32_bf16 v[128:131], v[112:115], v[80:83], v[128:131]
    ds_read_b64_tr_b16 v[64:65], v8 offset:16384
    v_mfma_f32_16x16x32_bf16 v[132:135], v[116:119], v[80:83], v[132:135]
    ds_read_b64_tr_b16 v[66:67], v9 offset:16384
    v_mfma_f32_16x16x32_bf16 v[144:147], v[112:115], v[88:91], v[144:147]
    ds_read_b64_tr_b16 v[68:69], v10 offset:16384
    v_mfma_f32_16x16x32_bf16 v[148:151], v[116:119], v[88:91], v[148:151]
    ds_read_b64_tr_b16 v[70:71], v11 offset:16384
    v_mfma_f32_16x16x32_bf16 v[160:163], v[112:115], v[96:99], v[160:163]
    ds_read_b64_tr_b16 v[72:73], v8 offset:24576
    v_mfma_f32_16x16x32_bf16 v[164:167], v[116:119], v[96:99], v[164:167]
    ds_read_b64_tr_b16 v[74:75], v9 offset:24576
    v_mfma_f32_16x16x32_bf16 v[176:179], v[112:115], v[104:107], v[176:179]
    ds_read_b64_tr_b16 v[76:77], v10 offset:24576
    v_mfma_f32_16x16x32_bf16 v[180:183], v[116:119], v[104:107], v[180:183]
    ds_read_b64_tr_b16 v[78:79], v11 offset:24576
    v_mfma_f32_16x16x32_bf16 v[128:131], v[120:123], v[84:87], v[128:131]
    ds_read_b128 v[32:35], v5 offset:0
    v_mfma_f32_16x16x32_bf16 v[132:135], v[124:127], v[84:87], v[132:135]
    ds_read_b128 v[36:39], v5 offset:1024
    v_mfma_f32_16x16x32_bf16 v[144:147], v[120:123], v[92:95], v[144:147]
    ds_read_b128 v[40:43], v5 offset:2048
    v_mfma_f32_16x16x32_bf16 v[148:151], v[124:127], v[92:95], v[148:151]
    ds_read_b128 v[44:47], v5 offset:3072
    v_mfma_f32_16x16x32_bf16 v[160:163], v[120:123], v[100:103], v[160:163]
    ds_read_b128 v[48:51], v5 offset:4096
    v_mfma_f32_16x16x32_bf16 v[164:167], v[124:127], v[100:103], v[164:167]
    ds_read_b128 v[52:55], v5 offset:5120
    v_mfma_f32_16x16x32_bf16 v[176:179], v[120:123], v[108:111], v[176:179]
    ds_read_b128 v[56:59], v5 offset:6144
    v_mfma_f32_16x16x32_bf16 v[180:183], v[124:127], v[108:111], v[180:183]
    ds_read_b128 v[60:63], v5 offset:7168
    s_waitcnt lgkmcnt(0)
w_loop_chkH:
    s_sub_u32 s23, s23, 1
w_loopH:
    s_cmp_lg_u32 s23, 1
    s_cbranch_scc1 w_bodyH
    buffer_load_dword v22, off, s[64:67], 0 sc1
    v_readfirstlane_b32 s30, v16
    s_cmp_ge_u32 s30, s45
    s_cselect_b32 s30, 0, 1
    s_or_b32 s30, s30, s70
    s_cmp_ge_u32 s32, 4
    s_cselect_b32 s30, 1, s30
    s_cmp_eq_u32 s32, 0
    s_cselect_b32 s30, 1, s30
    v_mov_b32 v20, s30
    ds_write_b32 v7, v20
    s_cbranch_scc1 w_ndH
    s_cmp_ge_u32 s32, 4
    s_cbranch_scc1 w_ndH
    s_cmp_lg_u32 s70, 0
    s_cbranch_scc1 w_ndH
    s_load_dwordx2 s[8:9], s[0:1], s33
    s_load_dwordx2 s[12:13], s[0:1], s34
    s_mov_b32 s10, s38
    s_mov_b32 s14, s38
    s_cmp_ge_u32 s32, 4
    s_cselect_b32 s31, 0, 1
    s_lshl_b32 s30, s3, s31
    s_mul_i32 s30, s30, s40
    s_add_u32 s16, s39, s30
    s_cmp_eq_u32 s32, 4
    s_cselect_b32 s30, 1024, s40
    s_cselect_b32 s31, 6, 5
    s_lshl_b32 s62, 32, s31
    s_add_u32 s17, s16, s30
    s_lshl_b32 s30, s3, 2
    s_mul_i32 s30, s30, s35
    s_add_u32 s18, s36, s30
    s_add_u32 s19, s37, s30
    s_lshl_b32 s20, s35, s31
    v_mul_u32_u24 v2, s35, v4
    v_add_u32 v2, v2, v3
    s_waitcnt lgkmcnt(0)
w_bodyH:
    s_waitcnt vmcnt(8)
    s_barrier
    s_add_u32 m0, s21, 0
    s_nop 0
    buffer_load_dwordx4 v1, s[4:7], s16 offen sc1 lds
    s_add_u32 s16, s16, s62
    s_add_u32 m0, s21, 1024
    s_nop 0
    buffer_load_dwordx4 v1, s[4:7], s17 offen sc1 lds
    s_add_u32 s17, s17, s62
    s_add_u32 m0, s22, 0
    s_nop 0
    buffer_load_dwordx4 v2, s[8:11], s18 offen lds
    s_add_u32 s18, s18, s20
    s_add_u32 m0, s22, 8192
    s_nop 0
    buffer_load_dwordx4 v2, s[12:15], s19 offen lds
    s_add_u32 s19, s19, s20
    v_mfma_f32_16x16x32_bf16 v[128:131], v[64:67], v[32:35], v[128:131]
    ds_read_b64_tr_b16 v[112:113], v8 offset:49152
    v_mfma_f32_16x16x32_bf16 v[132:135], v[68:71], v[32:35], v[132:135]
    ds_read_b64_tr_b16 v[114:115], v9 offset:49152
    v_mfma_f32_16x16x32_bf16 v[144:147], v[64:67], v[40:43], v[144:147]
    ds_read_b64_tr_b16 v[116:117], v10 offset:49152
    v_mfma_f32_16x16x32_bf16 v[148:151], v[68:71], v[40:43], v[148:151]
    ds_read_b64_tr_b16 v[118:119], v11 offset:49152
    v_mfma_f32_16x16x32_bf16 v[160:163], v[64:67], v[48:51], v[160:163]
    ds_read_b64_tr_b16 v[120:121], v8 offset:57344
    v_mfma_f32_16x16x32_bf16 v[164:167], v[68:71], v[48:51], v[164:167]
    ds_read_b64_tr_b16 v[122:123], v9 offset:57344
    v_mfma_f32_16x16x32_bf16 v[176:179], v[64:67], v[56:59], v[176:179]
    ds_read_b64_tr_b16 v[124:125], v10 offset:57344
    v_mfma_f32_16x16x32_bf16 v[180:183], v[68:71], v[56:59], v[180:183]
    ds_read_b64_tr_b16 v[126:127], v11 offset:57344
    v_mfma_f32_16x16x32_bf16 v[128:131], v[72:75], v[36:39], v[128:131]
    ds_read_b128 v[80:83], v5 offset:32768
    v_mfma_f32_16x16x32_bf16 v[132:135], v[76:79], v[36:39], v[132:135]
    ds_read_b128 v[84:87], v5 offset:33792
    v_mfma_f32_16x16x32_bf16 v[144:147], v[72:75], v[44:47], v[144:147]
    ds_read_b128 v[88:91], v5 offset:34816
    v_mfma_f32_16x16x32_bf16 v[148:151], v[76:79], v[44:47], v[148:151]
    ds_read_b128 v[92:95], v5 offset:35840
    v_mfma_f32_16x16x32_bf16 v[160:163], v[72:75], v[52:55], v[160:163]
    ds_read_b128 v[96:99], v5 offset:36864
    v_mfma_f32_16x16x32_bf16 v[164:167], v[76:79], v[52:55], v[164:167]
    ds_read_b128 v[100:103], v5 offset:37888
    v_mfma_f32_16x16x32_bf16 v[176:179], v[72:75], v[60:63], v[176:179]
    ds_read_b128 v[104:107], v5 offset:38912
    v_mfma_f32_16x16x32_bf16 v[180:183], v[76:79], v[60:63], v[180:183]
    ds_read_b128 v[108:111], v5 offset:39936
    buffer_load_dword v16, v17, s[4:7], s44 offen sc1
    s_waitcnt lgkmcnt(0)
    s_waitcnt vmcnt(8)
    s_barrier
    s_add_u32 m0, s21, 32768
    s_nop 0
    buffer_load_dwordx4 v1, s[4:7], s16 offen sc1 lds
    s_add_u32 s16, s16, s62
    s_add_u32 m0, s21, 33792
    s_nop 0
    buffer_load_dwordx4 v1, s[4:7], s17 offen sc1 lds
    s_add_u32 s17, s17, s62
    s_add_u32 m0, s22, 32768
    s_nop 0
    buffer_load_dwordx4 v2, s[8:11], s18 offen lds
    s_add_u32 s18, s18, s20
    s_add_u32 m0, s22, 40960
    s_nop 0
    buffer_load_dwordx4 v2, s[12:15], s19 offen lds
    s_add_u32 s19, s19, s20
    v_mfma_f32_16x16x32_bf16 v[128:131], v[112:115], v[80:83], v[128:131]
    ds_read_b64_tr_b16 v[64:65], v12 offset:16384
    v_mfma_f32_16x16x32_bf16 v[132:135], v[116:119], v[80:83], v[132:135]
    ds_read_b64_tr_b16 v[66:67], v13 offset:16384
    v_mfma_f32_16x16x32_bf16 v[144:147], v[112:115], v[88:91], v[144:147]
    ds_read_b64_tr_b16 v[68:69], v14 offset:16384
    v_mfma_f32_16x16x32_bf16 v[148:151], v[116:119], v[88:91], v[148:151]
    ds_read_b64_tr_b16 v[70:71], v15 offset:16384
    v_mfma_f32_16x16x32_bf16 v[160:163], v[112:115], v[96:99], v[160:163]
    ds_read_b64_tr_b16 v[72:73], v12 offset:24576
    v_mfma_f32_16x16x32_bf16 v[164:167], v[116:119], v[96:99], v[164:167]
    ds_read_b64_tr_b16 v[74:75], v13 offset:24576
    v_mfma_f32_16x16x32_bf16 v[176:179], v[112:115], v[104:107], v[176:179]
    ds_read_b64_tr_b16 v[76:77], v14 offset:24576
    v_mfma_f32_16x16x32_bf16 v[180:183], v[116:119], v[104:107], v[180:183]
    ds_read_b64_tr_b16 v[78:79], v15 offset:24576
    v_mfma_f32_16x16x32_bf16 v[128:131], v[120:123], v[84:87], v[128:131]
    ds_read_b128 v[32:35], v6 offset:0
    v_mfma_f32_16x16x32_bf16 v[132:135], v[124:127], v[84:87], v[132:135]
    ds_read_b128 v[36:39], v6 offset:1024
    v_mfma_f32_16x16x32_bf16 v[144:147], v[120:123], v[92:95], v[144:147]
    ds_read_b128 v[40:43], v6 offset:2048
    v_mfma_f32_16x16x32_bf16 v[148:151], v[124:127], v[92:95], v[148:151]
    ds_read_b128 v[44:47], v6 offset:3072
    v_mfma_f32_16x16x32_bf16 v[160:163], v[120:123], v[100:103], v[160:163]
    ds_read_b128 v[48:51], v6 offset:4096
    v_mfma_f32_16x16x32_bf16 v[164:167], v[124:127], v[100:103], v[164:167]
    ds_read_b128 v[52:55], v6 offset:5120
    v_mfma_f32_16x16x32_bf16 v[176:179], v[120:123], v[108:111], v[176:179]
    ds_read_b128 v[56:59], v6 offset:6144
    v_mfma_f32_16x16x32_bf16 v[180:183], v[124:127], v[108:111], v[180:183]
    ds_read_b128 v[60:63], v6 offset:7168
    s_waitcnt lgkmcnt(0)
    s_waitcnt vmcnt(8)
    s_barrier
    s_add_u32 m0, s21, 65536
    s_nop 0
    buffer_load_dwordx4 v1, s[4:7], s16 offen sc1 lds
    s_add_u32 s16, s16, s62
    s_add_u32 m0, s21, 66560
    s_nop 0
    buffer_load_dwordx4 v1, s[4:7], s17 offen sc1 lds
    s_add_u32 s17, s17, s62
    s_add_u32 m0, s22, 65536
    s_nop 0
    buffer_load_dwordx4 v2, s[8:11], s18 offen lds
    s_add_u32 s18, s18, s20
    s_add_u32 m0, s22, 73728
    s_nop 0
    buffer_load_dwordx4 v2, s[12:15], s19 offen lds
    s_add_u32 s19, s19, s20
    v_mfma_f32_16x16x32_bf16 v[128:131], v[64:67], v[32:35], v[128:131]
    ds_read_b64_tr_b16 v[112:113], v12 offset:49152
    v_mfma_f32_16x16x32_bf16 v[132:135], v[68:71], v[32:35], v[132:135]
    ds_read_b64_tr_b16 v[114:115], v13 offset:49152
    v_mfma_f32_16x16x32_bf16 v[144:147], v[64:67], v[40:43], v[144:147]
    ds_read_b64_tr_b16 v[116:117], v14 offset:49152
    v_mfma_f32_16x16x32_bf16 v[148:151], v[68:71], v[40:43], v[148:151]
    ds_read_b64_tr_b16 v[118:119], v15 offset:49152
    v_mfma_f32_16x16x32_bf16 v[160:163], v[64:67], v[48:51], v[160:163]
    ds_read_b64_tr_b16 v[120:121], v12 offset:57344
    v_mfma_f32_16x16x32_bf16 v[164:167], v[68:71], v[48:51], v[164:167]
    ds_read_b64_tr_b16 v[122:123], v13 offset:57344
    v_mfma_f32_16x16x32_bf16 v[176:179], v[64:67], v[56:59], v[176:179]
    ds_read_b64_tr_b16 v[124:125], v14 offset:57344
    v_mfma_f32_16x16x32_bf16 v[180:183], v[68:71], v[56:59], v[180:183]
    ds_read_b64_tr_b16 v[126:127], v15 offset:57344
    v_mfma_f32_16x16x32_bf16 v[128:131], v[72:75], v[36:39], v[128:131]
    ds_read_b128 v[80:83], v6 offset:32768
    v_mfma_f32_16x16x32_bf16 v[132:135], v[76:79], v[36:39], v[132:135]
    ds_read_b128 v[84:87], v6 offset:33792
    v_mfma_f32_16x16x32_bf16 v[144:147], v[72:75], v[44:47], v[144:147]
    ds_read_b128 v[88:91], v6 offset:34816
    v_mfma_f32_16x16x32_bf16 v[148:151], v[76:79], v[44:47], v[148:151]
    ds_read_b128 v[92:95], v6 offset:35840
    v_mfma_f32_16x16x32_bf16 v[160:163], v[72:75], v[52:55], v[160:163]
    ds_read_b128 v[96:99], v6 offset:36864
    v_mfma_f32_16x16x32_bf16 v[164:167], v[76:79], v[52:55], v[164:167]
    ds_read_b128 v[100:103], v6 offset:37888
    v_mfma_f32_16x16x32_bf16 v[176:179], v[72:75], v[60:63], v[176:179]
    ds_read_b128 v[104:107], v6 offset:38912
    v_mfma_f32_16x16x32_bf16 v[180:183], v[76:79], v[60:63], v[180:183]
    ds_read_b128 v[108:111], v6 offset:39936
    s_waitcnt lgkmcnt(0)
    s_waitcnt vmcnt(8)
    s_barrier
    s_add_u32 m0, s21, 98304
    s_nop 0
    buffer_load_dwordx4 v1, s[4:7], s16 offen sc1 lds
    s_add_u32 s16, s16, s62
    s_add_u32 m0, s21, 99328
    s_nop 0
    buffer_load_dwordx4 v1, s[4:7], s17 offen sc1 lds
    s_add_u32 s17, s17, s62
    s_add_u32 m0, s22, 98304
    s_nop 0
    buffer_load_dwordx4 v2, s[8:11], s18 offen lds
    s_add_u32 s18, s18, s20
    s_add_u32 m0, s22, 106496
    s_nop 0
    buffer_load_dwordx4 v2, s[12:15], s19 offen lds
    s_add_u32 s19, s19, s20
    v_mfma_f32_16x16x32_bf16 v[128:131], v[112:115], v[80:83], v[128:131]
    ds_read_b64_tr_b16 v[64:65], v8 offset:16384
    v_mfma_f32_16x16x32_bf16 v[132:135], v[116:119], v[80:83], v[132:135]
    ds_read_b64_tr_b16 v[66:67], v9 offset:16384
    v_mfma_f32_16x16x32_bf16 v[144:147], v[112:115], v[88:91], v[144:147]
    ds_read_b64_tr_b16 v[68:69], v10 offset:16384
    v_mfma_f32_16x16x32_bf16 v[148:151], v[116:119], v[88:91], v[148:151]
    ds_read_b64_tr_b16 v[70:71], v11 offset:16384
    v_mfma_f32_16x16x32_bf16 v[160:163], v[112:115], v[96:99], v[160:163]
    ds_read_b64_tr_b16 v[72:73], v8 offset:24576
    v_mfma_f32_16x16x32_bf16 v[164:167], v[116:119], v[96:99], v[164:167]
    ds_read_b64_tr_b16 v[74:75], v9 offset:24576
    v_mfma_f32_16x16x32_bf16 v[176:179], v[112:115], v[104:107], v[176:179]
    ds_read_b64_tr_b16 v[76:77], v10 offset:24576
    v_mfma_f32_16x16x32_bf16 v[180:183], v[116:119], v[104:107], v[180:183]
    ds_read_b64_tr_b16 v[78:79], v11 offset:24576
    v_mfma_f32_16x16x32_bf16 v[128:131], v[120:123], v[84:87], v[128:131]
    ds_read_b128 v[32:35], v5 offset:0
    v_mfma_f32_16x16x32_bf16 v[132:135], v[124:127], v[84:87], v[132:135]
    ds_read_b128 v[36:39], v5 offset:1024
    v_mfma_f32_16x16x32_bf16 v[144:147], v[120:123], v[92:95], v[144:147]
    ds_read_b128 v[40:43], v5 offset:2048
    v_mfma_f32_16x16x32_bf16 v[148:151], v[124:127], v[92:95], v[148:151]
    ds_read_b128 v[44:47], v5 offset:3072
    v_mfma_f32_16x16x32_bf16 v[160:163], v[120:123], v[100:103], v[160:163]
    ds_read_b128 v[48:51], v5 offset:4096
    v_mfma_f32_16x16x32_bf16 v[164:167], v[124:127], v[100:103], v[164:167]
    ds_read_b128 v[52:55], v5 offset:5120
    v_mfma_f32_16x16x32_bf16 v[176:179], v[120:123], v[108:111], v[176:179]
    ds_read_b128 v[56:59], v5 offset:6144
    v_mfma_f32_16x16x32_bf16 v[180:183], v[124:127], v[108:111], v[180:183]
    ds_read_b128 v[60:63], v5 offset:7168
    s_waitcnt lgkmcnt(0)
    s_sub_u32 s23, s23, 1
    s_cmp_lg_u32 s23, 0
    s_cbranch_scc1 w_loopH
    s_branch w_endH
w_ndH:
    s_waitcnt vmcnt(8)
    s_barrier
    v_mfma_f32_16x16x32_bf16 v[128:131], v[64:67], v[32:35], v[128:131]
    ds_read_b64_tr_b16 v[112:113], v8 offset:49152
    v_mfma_f32_16x16x32_bf16 v[132:135], v[68:71], v[32:35], v[132:135]
    ds_read_b64_tr_b16 v[114:115], v9 offset:49152
    v_mfma_f32_16x16x32_bf16 v[144:147], v[64:67], v[40:43], v[144:147]
    ds_read_b64_tr_b16 v[116:117], v10 offset:49152
    v_mfma_f32_16x16x32_bf16 v[148:151], v[68:71], v[40:43], v[148:151]
    ds_read_b64_tr_b16 v[118:119], v11 offset:49152
    v_mfma_f32_16x16x32_bf16 v[160:163], v[64:67], v[48:51], v[160:163]
    ds_read_b64_tr_b16 v[120:121], v8 offset:57344
    v_mfma_f32_16x16x32_bf16 v[164:167], v[68:71], v[48:51], v[164:167]
    ds_read_b64_tr_b16 v[122:123], v9 offset:57344
    v_mfma_f32_16x16x32_bf16 v[176:179], v[64:67], v[56:59], v[176:179]
    ds_read_b64_tr_b16 v[124:125], v10 offset:57344
    v_mfma_f32_16x16x32_bf16 v[180:183], v[68:71], v[56:59], v[180:183]
    ds_read_b64_tr_b16 v[126:127], v11 offset:57344
    v_mfma_f32_16x16x32_bf16 v[128:131], v[72:75], v[36:39], v[128:131]
    ds_read_b128 v[80:83], v5 offset:32768
    v_mfma_f32_16x16x32_bf16 v[132:135], v[76:79], v[36:39], v[132:135]
    ds_read_b128 v[84:87], v5 offset:33792
    v_mfma_f32_16x16x32_bf16 v[144:147], v[72:75], v[44:47], v[144:147]
    ds_read_b128 v[88:91], v5 offset:34816
    v_mfma_f32_16x16x32_bf16 v[148:151], v[76:79], v[44:47], v[148:151]
    ds_read_b128 v[92:95], v5 offset:35840
    v_mfma_f32_16x16x32_bf16 v[160:163], v[72:75], v[52:55], v[160:163]
    ds_read_b128 v[96:99], v5 offset:36864
    v_mfma_f32_16x16x32_bf16 v[164:167], v[76:79], v[52:55], v[164:167]
    ds_read_b128 v[100:103], v5 offset:37888
    v_mfma_f32_16x16x32_bf16 v[176:179], v[72:75], v[60:63], v[176:179]
    ds_read_b128 v[104:107], v5 offset:38912
    v_mfma_f32_16x16x32_bf16 v[180:183], v[76:79], v[60:63], v[180:183]
    ds_read_b128 v[108:111], v5 offset:39936
    s_waitcnt lgkmcnt(0)
    s_waitcnt vmcnt(4)
    s_barrier
    v_mfma_f32_16x16x32_bf16 v[128:131], v[112:115], v[80:83], v[128:131]
    ds_read_b64_tr_b16 v[64:65], v12 offset:16384
    v_mfma_f32_16x16x32_bf16 v[132:135], v[116:119], v[80:83], v[132:135]
    ds_read_b64_tr_b16 v[66:67], v13 offset:16384
    v_mfma_f32_16x16x32_bf16 v[144:147], v[112:115], v[88:91], v[144:147]
    ds_read_b64_tr_b16 v[68:69], v14 offset:16384
    v_mfma_f32_16x16x32_bf16 v[148:151], v[116:119], v[88:91], v[148:151]
    ds_read_b64_tr_b16 v[70:71], v15 offset:16384
    v_mfma_f32_16x16x32_bf16 v[160:163], v[112:115], v[96:99], v[160:163]
    ds_read_b64_tr_b16 v[72:73], v12 offset:24576
    v_mfma_f32_16x16x32_bf16 v[164:167], v[116:119], v[96:99], v[164:167]
    ds_read_b64_tr_b16 v[74:75], v13 offset:24576
    v_mfma_f32_16x16x32_bf16 v[176:179], v[112:115], v[104:107], v[176:179]
    ds_read_b64_tr_b16 v[76:77], v14 offset:24576
    v_mfma_f32_16x16x32_bf16 v[180:183], v[116:119], v[104:107], v[180:183]
    ds_read_b64_tr_b16 v[78:79], v15 offset:24576
    v_mfma_f32_16x16x32_bf16 v[128:131], v[120:123], v[84:87], v[128:131]
    ds_read_b128 v[32:35], v6 offset:0
    v_mfma_f32_16x16x32_bf16 v[132:135], v[124:127], v[84:87], v[132:135]
    ds_read_b128 v[36:39], v6 offset:1024
    v_mfma_f32_16x16x32_bf16 v[144:147], v[120:123], v[92:95], v[144:147]
    ds_read_b128 v[40:43], v6 offset:2048
    v_mfma_f32_16x16x32_bf16 v[148:151], v[124:127], v[92:95], v[148:151]
    ds_read_b128 v[44:47], v6 offset:3072
    v_mfma_f32_16x16x32_bf16 v[160:163], v[120:123], v[100:103], v[160:163]
    ds_read_b128 v[48:51], v6 offset:4096
    v_mfma_f32_16x16x32_bf16 v[164:167], v[124:127], v[100:103], v[164:167]
    ds_read_b128 v[52:55], v6 offset:5120
    v_mfma_f32_16x16x32_bf16 v[176:179], v[120:123], v[108:111], v[176:179]
    ds_read_b128 v[56:59], v6 offset:6144
    v_mfma_f32_16x16x32_bf16 v[180:183], v[124:127], v[108:111], v[180:183]
    ds_read_b128 v[60:63], v6 offset:7168
    s_waitcnt lgkmcnt(0)
    s_waitcnt vmcnt(0)
    s_barrier
    v_mfma_f32_16x16x32_bf16 v[128:131], v[64:67], v[32:35], v[128:131]
    ds_read_b64_tr_b16 v[112:113], v12 offset:49152
    v_mfma_f32_16x16x32_bf16 v[132:135], v[68:71], v[32:35], v[132:135]
    ds_read_b64_tr_b16 v[114:115], v13 offset:49152
    v_mfma_f32_16x16x32_bf16 v[144:147], v[64:67], v[40:43], v[144:147]
    ds_read_b64_tr_b16 v[116:117], v14 offset:49152
    v_mfma_f32_16x16x32_bf16 v[148:151], v[68:71], v[40:43], v[148:151]
    ds_read_b64_tr_b16 v[118:119], v15 offset:49152
    v_mfma_f32_16x16x32_bf16 v[160:163], v[64:67], v[48:51], v[160:163]
    ds_read_b64_tr_b16 v[120:121], v12 offset:57344
    v_mfma_f32_16x16x32_bf16 v[164:167], v[68:71], v[48:51], v[164:167]
    ds_read_b64_tr_b16 v[122:123], v13 offset:57344
    v_mfma_f32_16x16x32_bf16 v[176:179], v[64:67], v[56:59], v[176:179]
    ds_read_b64_tr_b16 v[124:125], v14 offset:57344
    v_mfma_f32_16x16x32_bf16 v[180:183], v[68:71], v[56:59], v[180:183]
    ds_read_b64_tr_b16 v[126:127], v15 offset:57344
    v_mfma_f32_16x16x32_bf16 v[128:131], v[72:75], v[36:39], v[128:131]
    ds_read_b128 v[80:83], v6 offset:32768
    v_mfma_f32_16x16x32_bf16 v[132:135], v[76:79], v[36:39], v[132:135]
    ds_read_b128 v[84:87], v6 offset:33792
    v_mfma_f32_16x16x32_bf16 v[144:147], v[72:75], v[44:47], v[144:147]
    ds_read_b128 v[88:91], v6 offset:34816
    v_mfma_f32_16x16x32_bf16 v[148:151], v[76:79], v[44:47], v[148:151]
    ds_read_b128 v[92:95], v6 offset:35840
    v_mfma_f32_16x16x32_bf16 v[160:163], v[72:75], v[52:55], v[160:163]
    ds_read_b128 v[96:99], v6 offset:36864
    v_mfma_f32_16x16x32_bf16 v[164:167], v[76:79], v[52:55], v[164:167]
    ds_read_b128 v[100:103], v6 offset:37888
    v_mfma_f32_16x16x32_bf16 v[176:179], v[72:75], v[60:63], v[176:179]
    ds_read_b128 v[104:107], v6 offset:38912
    v_mfma_f32_16x16x32_bf16 v[180:183], v[76:79], v[60:63], v[180:183]
    ds_read_b128 v[108:111], v6 offset:39936
    s_waitcnt lgkmcnt(0)
    s_waitcnt vmcnt(0)
    s_barrier
    v_mfma_f32_16x16x32_bf16 v[128:131], v[112:115], v[80:83], v[128:131]
    ds_read_b64_tr_b16 v[64:65], v8 offset:16384
    v_mfma_f32_16x16x32_bf16 v[132:135], v[116:119], v[80:83], v[132:135]
    ds_read_b64_tr_b16 v[66:67], v9 offset:16384
    v_mfma_f32_16x16x32_bf16 v[144:147], v[112:115], v[88:91], v[144:147]
    ds_read_b64_tr_b16 v[68:69], v10 offset:16384
    v_mfma_f32_16x16x32_bf16 v[148:151], v[116:119], v[88:91], v[148:151]
    ds_read_b64_tr_b16 v[70:71], v11 offset:16384
    v_mfma_f32_16x16x32_bf16 v[160:163], v[112:115], v[96:99], v[160:163]
    ds_read_b64_tr_b16 v[72:73], v8 offset:24576
    v_mfma_f32_16x16x32_bf16 v[164:167], v[116:119], v[96:99], v[164:167]
    ds_read_b64_tr_b16 v[74:75], v9 offset:24576
    v_mfma_f32_16x16x32_bf16 v[176:179], v[112:115], v[104:107], v[176:179]
    ds_read_b64_tr_b16 v[76:77], v10 offset:24576
    v_mfma_f32_16x16x32_bf16 v[180:183], v[116:119], v[104:107], v[180:183]
    ds_read_b64_tr_b16 v[78:79], v11 offset:24576
    v_mfma_f32_16x16x32_bf16 v[128:131], v[120:123], v[84:87], v[128:131]
    ds_read_b128 v[32:35], v5 offset:0
    v_mfma_f32_16x16x32_bf16 v[132:135], v[124:127], v[84:87], v[132:135]
    ds_read_b128 v[36:39], v5 offset:1024
    v_mfma_f32_16x16x32_bf16 v[144:147], v[120:123], v[92:95], v[144:147]
    ds_read_b128 v[40:43], v5 offset:2048
    v_mfma_f32_16x16x32_bf16 v[148:151], v[124:127], v[92:95], v[148:151]
    ds_read_b128 v[44:47], v5 offset:3072
    v_mfma_f32_16x16x32_bf16 v[160:163], v[120:123], v[100:103], v[160:163]
    ds_read_b128 v[48:51], v5 offset:4096
    v_mfma_f32_16x16x32_bf16 v[164:167], v[124:127], v[100:103], v[164:167]
    ds_read_b128 v[52:55], v5 offset:5120
    v_mfma_f32_16x16x32_bf16 v[176:179], v[120:123], v[108:111], v[176:179]
    ds_read_b128 v[56:59], v5 offset:6144
    v_mfma_f32_16x16x32_bf16 v[180:183], v[124:127], v[108:111], v[180:183]
    ds_read_b128 v[60:63], v5 offset:7168
    s_waitcnt lgkmcnt(0)
w_endH:
    v_mov_b32 v20, 131072
    ds_read_b128 v[24:27], v20
    ds_read_b128 v[28:31], v20 offset:16
    s_cmp_lg_u32 s53, s53
    s_cbranch_scc1 w_epi_siluH
    s_lshl_b32 s30, s27, 10
    s_add_u32 s30, s30, s49
    s_nop 7
    v_cvt_pk_bf16_f32 v80, v128, v129
    v_cvt_pk_bf16_f32 v81, v130, v131
    v_cvt_pk_bf16_f32 v82, v132, v133
    v_cvt_pk_bf16_f32 v83, v134, v135
    buffer_store_dwordx4 v[80:83], v1, s[4:7], s30 offen sc1
    s_add_u32 s30, s30, s50
    v_cvt_pk_bf16_f32 v84, v144, v145
    v_cvt_pk_bf16_f32 v85, v146, v147
    v_cvt_pk_bf16_f32 v86, v148, v149
    v_cvt_pk_bf16_f32 v87, v150, v151
    buffer_store_dwordx4 v[84:87], v1, s[4:7], s30 offen sc1
    s_add_u32 s30, s30, s50
    v_cvt_pk_bf16_f32 v88, v160, v161
    v_cvt_pk_bf16_f32 v89, v162, v163
    v_cvt_pk_bf16_f32 v90, v164, v165
    v_cvt_pk_bf16_f32 v91, v166, v167
    buffer_store_dwordx4 v[88:91], v1, s[4:7], s30 offen sc1
    s_add_u32 s30, s30, s50
    v_cvt_pk_bf16_f32 v92, v176, v177
    v_cvt_pk_bf16_f32 v93, v178, v179
    v_cvt_pk_bf16_f32 v94, v180, v181
    v_cvt_pk_bf16_f32 v95, v182, v183
    buffer_store_dwordx4 v[92:95], v1, s[4:7], s30 offen sc1
    s_add_u32 s30, s30, s50
    s_waitcnt lgkmcnt(0)
    v_or3_b32 v24, v24, v25, v26
    v_or3_b32 v28, v28, v29, v30
    v_or3_b32 v24, v24, v27, v31
    v_or_b32 v24, v24, v28
    s_mov_b32 s28, s51
    s_mov_b32 s57, s53
    v_readfirstlane_b32 s30, v24
    s_cmp_lg_u32 s30, 0
    s_cbranch_scc1 w_drain
    s_mov_b32 s48, s32
    s_cmp_ge_u32 s32, 4
    s_cselect_b32 s30, 2, 3
    s_lshl_b32 s30, s26, s30
    s_mul_i32 s30, s30, s43
    s_add_u32 s49, s42, s30
    s_mov_b32 s50, s43
    s_mov_b32 s51, s46
    s_mov_b32 s23, s41
    s_mov_b32 s53, s47
    s_nop 0
    s_load_dwordx16 s[32:47], s[24:25], 0
    s_add_u32 s24, s24, 64
    s_addc_u32 s25, s25, 0
    s_branch w_first4
w_epi_siluH:
    s_lshl_b32 s30, s27, 10
    s_add_u32 s30, s30, s49
    s_mov_b32 s54, 0xbfb8aa3b
    s_nop 7
    v_cvt_pk_bf16_f32 v80, v128, v129
    v_cvt_pk_bf16_f32 v81, v130, v131
    v_cvt_pk_bf16_f32 v82, v132, v133
    v_cvt_pk_bf16_f32 v83, v134, v135
    v_lshlrev_b32 v128, 16, v80
    v_and_b32 v129, 0xffff0000, v80
    v_lshlrev_b32 v130, 16, v81
    v_and_b32 v131, 0xffff0000, v81
    v_lshlrev_b32 v132, 16, v82
    v_and_b32 v133, 0xffff0000, v82
    v_lshlrev_b32 v134, 16, v83
    v_and_b32 v135, 0xffff0000, v83
    v_mul_f32 v104, s54, v128
    v_mul_f32 v105, s54, v129
    v_mul_f32 v106, s54, v130
    v_mul_f32 v107, s54, v131
    v_mul_f32 v108, s54, v132
    v_mul_f32 v109, s54, v133
    v_mul_f32 v110, s54, v134
    v_mul_f32 v111, s54, v135
    v_exp_f32 v104, v104
    v_exp_f32 v105, v105
    v_exp_f32 v106, v106
    v_exp_f32 v107, v107
    v_exp_f32 v108, v108
    v_exp_f32 v109, v109
    v_exp_f32 v110, v110
    v_exp_f32 v111, v111
    v_add_f32 v104, 1.0, v104
    v_add_f32 v105, 1.0, v105
    v_add_f32 v106, 1.0, v106
    v_add_f32 v107, 1.0, v107
    v_add_f32 v108, 1.0, v108
    v_add_f32 v109, 1.0, v109
    v_add_f32 v110, 1.0, v110
    v_add_f32 v111, 1.0, v111
    v_rcp_f32 v104, v104
    v_rcp_f32 v105, v105
    v_rcp_f32 v106, v106
    v_rcp_f32 v107, v107
    v_rcp_f32 v108, v108
    v_rcp_f32 v109, v109
    v_rcp_f32 v110, v110
    v_rcp_f32 v111, v111
    v_mul_f32 v128, v128, v104
    v_mul_f32 v129, v129, v105
    v_mul_f32 v130, v130, v106
    v_mul_f32 v131, v131, v107
    v_mul_f32 v132, v132, v108
    v_mul_f32 v133, v133, v109
    v_mul_f32 v134, v134, v110
    v_mul_f32 v135, v135, v111
    v_cvt_pk_bf16_f32 v80, v128, v129
    v_cvt_pk_bf16_f32 v81, v130, v131
    v_cvt_pk_bf16_f32 v82, v132, v133
    v_cvt_pk_bf16_f32 v83, v134, v135
    buffer_store_dwordx4 v[80:83], v1, s[4:7], s30 offen sc1
    s_add_u32 s30, s30, s50
    v_cvt_pk_bf16_f32 v84, v144, v145
    v_cvt_pk_bf16_f32 v85, v146, v147
    v_cvt_pk_bf16_f32 v86, v148, v149
    v_cvt_pk_bf16_f32 v87, v150, v151
    v_lshlrev_b32 v144, 16, v84
    v_and_b32 v145, 0xffff0000, v84
    v_lshlrev_b32 v146, 16, v85
    v_and_b32 v147, 0xffff0000, v85
    v_lshlrev_b32 v148, 16, v86
    v_and_b32 v149, 0xffff0000, v86
    v_lshlrev_b32 v150, 16, v87
    v_and_b32 v151, 0xffff0000, v87
    v_mul_f32 v96, s54, v144
    v_mul_f32 v97, s54, v145
    v_mul_f32 v98, s54, v146
    v_mul_f32 v99, s54, v147
    v_mul_f32 v100, s54, v148
    v_mul_f32 v101, s54, v149
    v_mul_f32 v102, s54, v150
    v_mul_f32 v103, s54, v151
    v_exp_f32 v96, v96
    v_exp_f32 v97, v97
    v_exp_f32 v98, v98
    v_exp_f32 v99, v99
    v_exp_f32 v100, v100
    v_exp_f32 v101, v101
    v_exp_f32 v102, v102
    v_exp_f32 v103, v103
    v_add_f32 v96, 1.0, v96
    v_add_f32 v97, 1.0, v97
    v_add_f32 v98, 1.0, v98
    v_add_f32 v99, 1.0, v99
    v_add_f32 v100, 1.0, v100
    v_add_f32 v101, 1.0, v101
    v_add_f32 v102, 1.0, v102
    v_add_f32 v103, 1.0, v103
    v_rcp_f32 v96, v96
    v_rcp_f32 v97, v97
    v_rcp_f32 v98, v98
    v_rcp_f32 v99, v99
    v_rcp_f32 v100, v100
    v_rcp_f32 v101, v101
    v_rcp_f32 v102, v102
    v_rcp_f32 v103, v103
    v_mul_f32 v144, v144, v96
    v_mul_f32 v145, v145, v97
    v_mul_f32 v146, v146, v98
    v_mul_f32 v147, v147, v99
    v_mul_f32 v148, v148, v100
    v_mul_f32 v149, v149, v101
    v_mul_f32 v150, v150, v102
    v_mul_f32 v151, v151, v103
    v_cvt_pk_bf16_f32 v84, v144, v145
    v_cvt_pk_bf16_f32 v85, v146, v147
    v_cvt_pk_bf16_f32 v86, v148, v149
    v_cvt_pk_bf16_f32 v87, v150, v151
    buffer_store_dwordx4 v[84:87], v1, s[4:7], s30 offen sc1
    s_add_u32 s30, s30, s50
    v_cvt_pk_bf16_f32 v88, v160, v161
    v_cvt_pk_bf16_f32 v89, v162, v163
    v_cvt_pk_bf16_f32 v90, v164, v165
    v_cvt_pk_bf16_f32 v91, v166, v167
    v_lshlrev_b32 v160, 16, v88
    v_and_b32 v161, 0xffff0000, v88
    v_lshlrev_b32 v162, 16, v89
    v_and_b32 v163, 0xffff0000, v89
    v_lshlrev_b32 v164, 16, v90
    v_and_b32 v165, 0xffff0000, v90
    v_lshlrev_b32 v166, 16, v91
    v_and_b32 v167, 0xffff0000, v91
    v_mul_f32 v104, s54, v160
    v_mul_f32 v105, s54, v161
    v_mul_f32 v106, s54, v162
    v_mul_f32 v107, s54, v163
    v_mul_f32 v108, s54, v164
    v_mul_f32 v109, s54, v165
    v_mul_f32 v110, s54, v166
    v_mul_f32 v111, s54, v167
    v_exp_f32 v104, v104
    v_exp_f32 v105, v105
    v_exp_f32 v106, v106
    v_exp_f32 v107, v107
    v_exp_f32 v108, v108
    v_exp_f32 v109, v109
    v_exp_f32 v110, v110
    v_exp_f32 v111, v111
    v_add_f32 v104, 1.0, v104
    v_add_f32 v105, 1.0, v105
    v_add_f32 v106, 1.0, v106
    v_add_f32 v107, 1.0, v107
    v_add_f32 v108, 1.0, v108
    v_add_f32 v109, 1.0, v109
    v_add_f32 v110, 1.0, v110
    v_add_f32 v111, 1.0, v111
    v_rcp_f32 v104, v104
    v_rcp_f32 v105, v105
    v_rcp_f32 v106, v106
    v_rcp_f32 v107, v107
    v_rcp_f32 v108, v108
    v_rcp_f32 v109, v109
    v_rcp_f32 v110, v110
    v_rcp_f32 v111, v111
    v_mul_f32 v160, v160, v104
    v_mul_f32 v161, v161, v105
    v_mul_f32 v162, v162, v106
    v_mul_f32 v163, v163, v107
    v_mul_f32 v164, v164, v108
    v_mul_f32 v165, v165, v109
    v_mul_f32 v166, v166, v110
    v_mul_f32 v167, v167, v111
    v_cvt_pk_bf16_f32 v88, v160, v161
    v_cvt_pk_bf16_f32 v89, v162, v163
    v_cvt_pk_bf16_f32 v90, v164, v165
    v_cvt_pk_bf16_f32 v91, v166, v167
    buffer_store_dwordx4 v[88:91], v1, s[4:7], s30 offen sc1
    s_add_u32 s30, s30, s50
    v_cvt_pk_bf16_f32 v92, v176, v177
    v_cvt_pk_bf16_f32 v93, v178, v179
    v_cvt_pk_bf16_f32 v94, v180, v181
    v_cvt_pk_bf16_f32 v95, v182, v183
    v_lshlrev_b32 v176, 16, v92
    v_and_b32 v177, 0xffff0000, v92
    v_lshlrev_b32 v178, 16, v93
    v_and_b32 v179, 0xffff0000, v93
    v_lshlrev_b32 v180, 16, v94
    v_and_b32 v181, 0xffff0000, v94
    v_lshlrev_b32 v182, 16, v95
    v_and_b32 v183, 0xffff0000, v95
    v_mul_f32 v96, s54, v176
    v_mul_f32 v97, s54, v177
    v_mul_f32 v98, s54, v178
    v_mul_f32 v99, s54, v179
    v_mul_f32 v100, s54, v180
    v_mul_f32 v101, s54, v181
    v_mul_f32 v102, s54, v182
    v_mul_f32 v103, s54, v183
    v_exp_f32 v96, v96
    v_exp_f32 v97, v97
    v_exp_f32 v98, v98
    v_exp_f32 v99, v99
    v_exp_f32 v100, v100
    v_exp_f32 v101, v101
    v_exp_f32 v102, v102
    v_exp_f32 v103, v103
    v_add_f32 v96, 1.0, v96
    v_add_f32 v97, 1.0, v97
    v_add_f32 v98, 1.0, v98
    v_add_f32 v99, 1.0, v99
    v_add_f32 v100, 1.0, v100
    v_add_f32 v101, 1.0, v101
    v_add_f32 v102, 1.0, v102
    v_add_f32 v103, 1.0, v103
    v_rcp_f32 v96, v96
    v_rcp_f32 v97, v97
    v_rcp_f32 v98, v98
    v_rcp_f32 v99, v99
    v_rcp_f32 v100, v100
    v_rcp_f32 v101, v101
    v_rcp_f32 v102, v102
    v_rcp_f32 v103, v103
    v_mul_f32 v176, v176, v96
    v_mul_f32 v177, v177, v97
    v_mul_f32 v178, v178, v98
    v_mul_f32 v179, v179, v99
    v_mul_f32 v180, v180, v100
    v_mul_f32 v181, v181, v101
    v_mul_f32 v182, v182, v102
    v_mul_f32 v183, v183, v103
    v_cvt_pk_bf16_f32 v92, v176, v177
    v_cvt_pk_bf16_f32 v93, v178, v179
    v_cvt_pk_bf16_f32 v94, v180, v181
    v_cvt_pk_bf16_f32 v95, v182, v183
    buffer_store_dwordx4 v[92:95], v1, s[4:7], s30 offen sc1
    s_add_u32 s30, s30, s50
    s_waitcnt lgkmcnt(0)
    v_or3_b32 v24, v24, v25, v26
    v_or3_b32 v28, v28, v29, v30
    v_or3_b32 v24, v24, v27, v31
    v_or_b32 v24, v24, v28
    s_mov_b32 s28, s51
    s_mov_b32 s57, s53
    v_readfirstlane_b32 s30, v24
    s_cmp_lg_u32 s30, 0
    s_cbranch_scc1 w_drain
    s_mov_b32 s48, s32
    s_cmp_ge_u32 s32, 4
    s_cselect_b32 s30, 2, 3
    s_lshl_b32 s30, s26, s30
    s_mul_i32 s30, s30, s43
    s_add_u32 s49, s42, s30
    s_mov_b32 s50, s43
    s_mov_b32 s51, s46
    s_mov_b32 s23, s41
    s_mov_b32 s53, s47
    s_nop 0
    s_load_dwordx16 s[32:47], s[24:25], 0
    s_add_u32 s24, s24, 64
    s_addc_u32 s25, s25, 0
    s_branch w_first4
w_firstX:
    v_bfe_u32 v20, v1, 4, 3
    v_xor_b32 v21, v4, v20
    v_lshlrev_b32 v21, 4, v21
    v_lshl_add_u32 v21, v20, 7, v21
    v_bfe_u32 v20, v1, 7, 1
    v_lshl_add_u32 v21, v20, 10, v21
    s_lshl_b32 s30, s26, 13
    v_add_u32 v24, s30, v21
    v_xor_b32 v25, 64, v24
    v_add_u32 v26, 0x10000, v24
    v_add_u32 v27, 0x10000, v25
    ds_read_b64_tr_b16 v[64:65], v8 offset:16384
    ds_read_b64_tr_b16 v[66:67], v9 offset:16384
    ds_read_b64_tr_b16 v[68:69], v10 offset:16384
    ds_read_b64_tr_b16 v[70:71], v11 offset:16384
    ds_read_b64_tr_b16 v[72:73], v8 offset:24576
    ds_read_b64_tr_b16 v[74:75], v9 offset:24576
    ds_read_b64_tr_b16 v[76:77], v10 offset:24576
    ds_read_b64_tr_b16 v[78:79], v11 offset:24576
    ds_read_b128 v[32:35], v24 offset:0
    ds_read_b128 v[36:39], v25 offset:0
    ds_read_b128 v[40:43], v24 offset:2048
    ds_read_b128 v[44:47], v25 offset:2048
    ds_read_b128 v[48:51], v24 offset:4096
    ds_read_b128 v[52:55], v25 offset:4096
    ds_read_b128 v[56:59], v24 offset:6144
    ds_read_b128 v[60:63], v25 offset:6144
    v_mov_b32 v208, 0x3f803f80
    v_mov_b32 v209, 0x3f803f80
    v_mov_b32 v210, 0x3f803f80
    v_mov_b32 v211, 0x3f803f80
    s_waitcnt lgkmcnt(0)
    s_waitcnt vmcnt(8)
    s_barrier
    s_add_u32 m0, s21, 0
    s_nop 0
    buffer_load_dwordx4 v23, s[88:91], s16 offen lds
    s_add_u32 s16, s16, s62
    s_add_u32 m0, s21, 1024
    s_nop 0
    buffer_load_dwordx4 v23, s[88:91], s17 offen lds
    s_add_u32 s17, s17, s62
    s_add_u32 m0, s22, 0
    s_nop 0
    buffer_load_dwordx4 v2, s[8:11], s18 offen lds
    s_add_u32 s18, s18, s20
    s_add_u32 m0, s22, 8192
    s_nop 0
    buffer_load_dwordx4 v2, s[12:15], s19 offen lds
    s_add_u32 s19, s19, s20
    s_cmp_ge_u32 s16, s92
    s_cselect_b32 s94, 2048, 0
    s_cselect_b32 s95, s93, 0
    s_sub_u32 s16, s16, s94
    s_sub_u32 s17, s17, s94
    s_sub_u32 s18, s18, s95
    s_sub_u32 s19, s19, s95
    v_mfma_f32_16x16x32_bf16 v[128:131], v[64:67], v[32:35], 0
    ds_read_b64_tr_b16 v[112:113], v8 offset:49152
    v_mfma_f32_16x16x32_bf16 v[132:135], v[68:71], v[32:35], 0
    ds_read_b64_tr_b16 v[114:115], v9 offset:49152
    v_mfma_f32_16x16x32_bf16 v[144:147], v[64:67], v[40:43], 0
    ds_read_b64_tr_b16 v[116:117], v10 offset:49152
    v_mfma_f32_16x16x32_bf16 v[148:151], v[68:71], v[40:43], 0
    ds_read_b64_tr_b16 v[118:119], v11 offset:49152
    v_mfma_f32_16x16x32_bf16 v[160:163], v[64:67], v[48:51], 0
    ds_read_b64_tr_b16 v[120:121], v8 offset:57344
    v_mfma_f32_16x16x32_bf16 v[164:167], v[68:71], v[48:51], 0
    ds_read_b64_tr_b16 v[122:123], v9 offset:57344
    v_mfma_f32_16x16x32_bf16 v[176:179], v[64:67], v[56:59], 0
    ds_read_b64_tr_b16 v[124:125], v10 offset:57344
    v_mfma_f32_16x16x32_bf16 v[180:183], v[68:71], v[56:59], 0
    ds_read_b64_tr_b16 v[126:127], v11 offset:57344
    v_mfma_f32_16x16x32_bf16 v[192:195], v[64:67], v[208:211], 0
    ds_read_b128 v[80:83], v24 offset:32768
    v_mfma_f32_16x16x32_bf16 v[196:199], v[68:71], v[208:211], 0
    ds_read_b128 v[84:87], v25 offset:32768
    v_mfma_f32_16x16x32_bf16 v[128:131], v[72:75], v[36:39], v[128:131]
    ds_read_b128 v[88:91], v24 offset:34816
    v_mfma_f32_16x16x32_bf16 v[132:135], v[76:79], v[36:39], v[132:135]
    ds_read_b128 v[92:95], v25 offset:34816
    v_mfma_f32_16x16x32_bf16 v[144:147], v[72:75], v[44:47], v[144:147]
    ds_read_b128 v[96:99], v24 offset:36864
    v_mfma_f32_16x16x32_bf16 v[148:151], v[76:79], v[44:47], v[148:151]
    ds_read_b128 v[100:103], v25 offset:36864
    v_mfma_f32_16x16x32_bf16 v[160:163], v[72:75], v[52:55], v[160:163]
    ds_read_b128 v[104:107], v24 offset:38912
    v_mfma_f32_16x16x32_bf16 v[164:167], v[76:79], v[52:55], v[164:167]
    ds_read_b128 v[108:111], v25 offset:38912
    v_mfma_f32_16x16x32_bf16 v[176:179], v[72:75], v[60:63], v[176:179]
    v_mfma_f32_16x16x32_bf16 v[180:183], v[76:79], v[60:63], v[180:183]
    v_mfma_f32_16x16x32_bf16 v[192:195], v[72:75], v[208:211], v[192:195]
    v_mfma_f32_16x16x32_bf16 v[196:199], v[76:79], v[208:211], v[196:199]
    s_waitcnt lgkmcnt(0)
    s_waitcnt vmcnt(8)
    s_barrier
    s_add_u32 m0, s21, 32768
    s_nop 0
    buffer_load_dwordx4 v23, s[88:91], s16 offen lds
    s_add_u32 s16, s16, s62
    s_add_u32 m0, s21, 33792
    s_nop 0
    buffer_load_dwordx4 v23, s[88:91], s17 offen lds
    s_add_u32 s17, s17, s62
    s_add_u32 m0, s22, 32768
    s_nop 0
    buffer_load_dwordx4 v2, s[8:11], s18 offen lds
    s_add_u32 s18, s18, s20
    s_add_u32 m0, s22, 40960
    s_nop 0
    buffer_load_dwordx4 v2, s[12:15], s19 offen lds
    s_add_u32 s19, s19, s20
    s_cmp_ge_u32 s16, s92
    s_cselect_b32 s94, 2048, 0
    s_cselect_b32 s95, s93, 0
    s_sub_u32 s16, s16, s94
    s_sub_u32 s17, s17, s94
    s_sub_u32 s18, s18, s95
    s_sub_u32 s19, s19, s95
    v_mfma_f32_16x16x32_bf16 v[128:131], v[112:115], v[80:83], v[128:131]
    ds_read_b64_tr_b16 v[64:65], v12 offset:16384
    v_mfma_f32_16x16x32_bf16 v[132:135], v[116:119], v[80:83], v[132:135]
    ds_read_b64_tr_b16 v[66:67], v13 offset:16384
    v_mfma_f32_16x16x32_bf16 v[144:147], v[112:115], v[88:91], v[144:147]
    ds_read_b64_tr_b16 v[68:69], v14 offset:16384
    v_mfma_f32_16x16x32_bf16 v[148:151], v[116:119], v[88:91], v[148:151]
    ds_read_b64_tr_b16 v[70:71], v15 offset:16384
    v_mfma_f32_16x16x32_bf16 v[160:163], v[112:115], v[96:99], v[160:163]
    ds_read_b64_tr_b16 v[72:73], v12 offset:24576
    v_mfma_f32_16x16x32_bf16 v[164:167], v[116:119], v[96:99], v[164:167]
    ds_read_b64_tr_b16 v[74:75], v13 offset:24576
    v_mfma_f32_16x16x32_bf16 v[176:179], v[112:115], v[104:107], v[176:179]
    ds_read_b64_tr_b16 v[76:77], v14 offset:24576
    v_mfma_f32_16x16x32_bf16 v[180:183], v[116:119], v[104:107], v[180:183]
    ds_read_b64_tr_b16 v[78:79], v15 offset:24576
    v_mfma_f32_16x16x32_bf16 v[192:195], v[112:115], v[208:211], v[192:195]
    ds_read_b128 v[32:35], v26 offset:0
    v_mfma_f32_16x16x32_bf16 v[196:199], v[116:119], v[208:211], v[196:199]
    ds_read_b128 v[36:39], v27 offset:0
    v_mfma_f32_16x16x32_bf16 v[128:131], v[120:123], v[84:87], v[128:131]
    ds_read_b128 v[40:43], v26 offset:2048
    v_mfma_f32_16x16x32_bf16 v[132:135], v[124:127], v[84:87], v[132:135]
    ds_read_b128 v[44:47], v27 offset:2048
    v_mfma_f32_16x16x32_bf16 v[144:147], v[120:123], v[92:95], v[144:147]
    ds_read_b128 v[48:51], v26 offset:4096
    v_mfma_f32_16x16x32_bf16 v[148:151], v[124:127], v[92:95], v[148:151]
    ds_read_b128 v[52:55], v27 offset:4096
    v_mfma_f32_16x16x32_bf16 v[160:163], v[120:123], v[100:103], v[160:163]
    ds_read_b128 v[56:59], v26 offset:6144
    v_mfma_f32_16x16x32_bf16 v[164:167], v[124:127], v[100:103], v[164:167]
    ds_read_b128 v[60:63], v27 offset:6144
    v_mfma_f32_16x16x32_bf16 v[176:179], v[120:123], v[108:111], v[176:179]
    v_mfma_f32_16x16x32_bf16 v[180:183], v[124:127], v[108:111], v[180:183]
    v_mfma_f32_16x16x32_bf16 v[192:195], v[120:123], v[208:211], v[192:195]
    v_mfma_f32_16x16x32_bf16 v[196:199], v[124:127], v[208:211], v[196:199]
    s_waitcnt lgkmcnt(0)
    s_waitcnt vmcnt(8)
    s_barrier
    s_add_u32 m0, s21, 65536
    s_nop 0
    buffer_load_dwordx4 v23, s[88:91], s16 offen lds
    s_add_u32 s16, s16, s62
    s_add_u32 m0, s21, 66560
    s_nop 0
    buffer_load_dwordx4 v23, s[88:91], s17 offen lds
    s_add_u32 s17, s17, s62
    s_add_u32 m0, s22, 65536
    s_nop 0
    buffer_load_dwordx4 v2, s[8:11], s18 offen lds
    s_add_u32 s18, s18, s20
    s_add_u32 m0, s22, 73728
    s_nop 0
    buffer_load_dwordx4 v2, s[12:15], s19 offen lds
    s_add_u32 s19, s19, s20
    s_cmp_ge_u32 s16, s92
    s_cselect_b32 s94, 2048, 0
    s_cselect_b32 s95, s93, 0
    s_sub_u32 s16, s16, s94
    s_sub_u32 s17, s17, s94
    s_sub_u32 s18, s18, s95
    s_sub_u32 s19, s19, s95
    v_mfma_f32_16x16x32_bf16 v[128:131], v[64:67], v[32:35], v[128:131]
    ds_read_b64_tr_b16 v[112:113], v12 offset:49152
    v_mfma_f32_16x16x32_bf16 v[132:135], v[68:71], v[32:35], v[132:135]
    ds_read_b64_tr_b16 v[114:115], v13 offset:49152
    v_mfma_f32_16x16x32_bf16 v[144:147], v[64:67], v[40:43], v[144:147]
    ds_read_b64_tr_b16 v[116:117], v14 offset:49152
    v_mfma_f32_16x16x32_bf16 v[148:151], v[68:71], v[40:43], v[148:151]
    ds_read_b64_tr_b16 v[118:119], v15 offset:49152
    v_mfma_f32_16x16x32_bf16 v[160:163], v[64:67], v[48:51], v[160:163]
    ds_read_b64_tr_b16 v[120:121], v12 offset:57344
    v_mfma_f32_16x16x32_bf16 v[164:167], v[68:71], v[48:51], v[164:167]
    ds_read_b64_tr_b16 v[122:123], v13 offset:57344
    v_mfma_f32_16x16x32_bf16 v[176:179], v[64:67], v[56:59], v[176:179]
    ds_read_b64_tr_b16 v[124:125], v14 offset:57344
    v_mfma_f32_16x16x32_bf16 v[180:183], v[68:71], v[56:59], v[180:183]
    ds_read_b64_tr_b16 v[126:127], v15 offset:57344
    v_mfma_f32_16x16x32_bf16 v[192:195], v[64:67], v[208:211], v[192:195]
    ds_read_b128 v[80:83], v26 offset:32768
    v_mfma_f32_16x16x32_bf16 v[196:199], v[68:71], v[208:211], v[196:199]
    ds_read_b128 v[84:87], v27 offset:32768
    v_mfma_f32_16x16x32_bf16 v[128:131], v[72:75], v[36:39], v[128:131]
    ds_read_b128 v[88:91], v26 offset:34816
    v_mfma_f32_16x16x32_bf16 v[132:135], v[76:79], v[36:39], v[132:135]
    ds_read_b128 v[92:95], v27 offset:34816
    v_mfma_f32_16x16x32_bf16 v[144:147], v[72:75], v[44:47], v[144:147]
    ds_read_b128 v[96:99], v26 offset:36864
    v_mfma_f32_16x16x32_bf16 v[148:151], v[76:79], v[44:47], v[148:151]
    ds_read_b128 v[100:103], v27 offset:36864
    v_mfma_f32_16x16x32_bf16 v[160:163], v[72:75], v[52:55], v[160:163]
    ds_read_b128 v[104:107], v26 offset:38912
    v_mfma_f32_16x16x32_bf16 v[164:167], v[76:79], v[52:55], v[164:167]
    ds_read_b128 v[108:111], v27 offset:38912
    v_mfma_f32_16x16x32_bf16 v[176:179], v[72:75], v[60:63], v[176:179]
    v_mfma_f32_16x16x32_bf16 v[180:183], v[76:79], v[60:63], v[180:183]
    v_mfma_f32_16x16x32_bf16 v[192:195], v[72:75], v[208:211], v[192:195]
    v_mfma_f32_16x16x32_bf16 v[196:199], v[76:79], v[208:211], v[196:199]
    s_waitcnt lgkmcnt(0)
    s_waitcnt vmcnt(8)
    s_barrier
    s_add_u32 m0, s21, 98304
    s_nop 0
    buffer_load_dwordx4 v23, s[88:91], s16 offen lds
    s_add_u32 s16, s16, s62
    s_add_u32 m0, s21, 99328
    s_nop 0
    buffer_load_dwordx4 v23, s[88:91], s17 offen lds
    s_add_u32 s17, s17, s62
    s_add_u32 m0, s22, 98304
    s_nop 0
    buffer_load_dwordx4 v2, s[8:11], s18 offen lds
    s_add_u32 s18, s18, s20
    s_add_u32 m0, s22, 106496
    s_nop 0
    buffer_load_dwordx4 v2, s[12:15], s19 offen lds
    s_add_u32 s19, s19, s20
    s_cmp_ge_u32 s16, s92
    s_cselect_b32 s94, 2048, 0
    s_cselect_b32 s95, s93, 0
    s_sub_u32 s16, s16, s94
    s_sub_u32 s17, s17, s94
    s_sub_u32 s18, s18, s95
    s_sub_u32 s19, s19, s95
    v_mfma_f32_16x16x32_bf16 v[128:131], v[112:115], v[80:83], v[128:131]
    ds_read_b64_tr_b16 v[64:65], v8 offset:16384
    v_mfma_f32_16x16x32_bf16 v[132:135], v[116:119], v[80:83], v[132:135]
    ds_read_b64_tr_b16 v[66:67], v9 offset:16384
    v_mfma_f32_16x16x32_bf16 v[144:147], v[112:115], v[88:91], v[144:147]
    ds_read_b64_tr_b16 v[68:69], v10 offset:16384
    v_mfma_f32_16x16x32_bf16 v[148:151], v[116:119], v[88:91], v[148:151]
    ds_read_b64_tr_b16 v[70:71], v11 offset:16384
    v_mfma_f32_16x16x32_bf16 v[160:163], v[112:115], v[96:99], v[160:163]
    ds_read_b64_tr_b16 v[72:73], v8 offset:24576
    v_mfma_f32_16x16x32_bf16 v[164:167], v[116:119], v[96:99], v[164:167]
    ds_read_b64_tr_b16 v[74:75], v9 offset:24576
    v_mfma_f32_16x16x32_bf16 v[176:179], v[112:115], v[104:107], v[176:179]
    ds_read_b64_tr_b16 v[76:77], v10 offset:24576
    v_mfma_f32_16x16x32_bf16 v[180:183], v[116:119], v[104:107], v[180:183]
    ds_read_b64_tr_b16 v[78:79], v11 offset:24576
    v_mfma_f32_16x16x32_bf16 v[192:195], v[112:115], v[208:211], v[192:195]
    ds_read_b128 v[32:35], v24 offset:0
    v_mfma_f32_16x16x32_bf16 v[196:199], v[116:119], v[208:211], v[196:199]
    ds_read_b128 v[36:39], v25 offset:0
    v_mfma_f32_16x16x32_bf16 v[128:131], v[120:123], v[84:87], v[128:131]
    ds_read_b128 v[40:43], v24 offset:2048
    v_mfma_f32_16x16x32_bf16 v[132:135], v[124:127], v[84:87], v[132:135]
    ds_read_b128 v[44:47], v25 offset:2048
    v_mfma_f32_16x16x32_bf16 v[144:147], v[120:123], v[92:95], v[144:147]
    ds_read_b128 v[48:51], v24 offset:4096
    v_mfma_f32_16x16x32_bf16 v[148:151], v[124:127], v[92:95], v[148:151]
    ds_read_b128 v[52:55], v25 offset:4096
    v_mfma_f32_16x16x32_bf16 v[160:163], v[120:123], v[100:103], v[160:163]
    ds_read_b128 v[56:59], v24 offset:6144
    v_mfma_f32_16x16x32_bf16 v[164:167], v[124:127], v[100:103], v[164:167]
    ds_read_b128 v[60:63], v25 offset:6144
    v_mfma_f32_16x16x32_bf16 v[176:179], v[120:123], v[108:111], v[176:179]
    v_mfma_f32_16x16x32_bf16 v[180:183], v[124:127], v[108:111], v[180:183]
    v_mfma_f32_16x16x32_bf16 v[192:195], v[120:123], v[208:211], v[192:195]
    v_mfma_f32_16x16x32_bf16 v[196:199], v[124:127], v[208:211], v[196:199]
    s_waitcnt lgkmcnt(0)
    s_mov_b32 s23, 2
w_loopX:
    s_waitcnt vmcnt(8)
    s_barrier
    s_add_u32 m0, s21, 0
    s_nop 0
    buffer_load_dwordx4 v23, s[88:91], s16 offen lds
    s_add_u32 s16, s16, s62
    s_add_u32 m0, s21, 1024
    s_nop 0
    buffer_load_dwordx4 v23, s[88:91], s17 offen lds
    s_add_u32 s17, s17, s62
    s_add_u32 m0, s22, 0
    s_nop 0
    buffer_load_dwordx4 v2, s[8:11], s18 offen lds
    s_add_u32 s18, s18, s20
    s_add_u32 m0, s22, 8192
    s_nop 0
    buffer_load_dwordx4 v2, s[12:15], s19 offen lds
    s_add_u32 s19, s19, s20
    s_cmp_ge_u32 s16, s92
    s_cselect_b32 s94, 2048, 0
    s_cselect_b32 s95, s93, 0
    s_sub_u32 s16, s16, s94
    s_sub_u32 s17, s17, s94
    s_sub_u32 s18, s18, s95
    s_sub_u32 s19, s19, s95
    v_mfma_f32_16x16x32_bf16 v[128:131], v[64:67], v[32:35], v[128:131]
    ds_read_b64_tr_b16 v[112:113], v8 offset:49152
    v_mfma_f32_16x16x32_bf16 v[132:135], v[68:71], v[32:35], v[132:135]
    ds_read_b64_tr_b16 v[114:115], v9 offset:49152
    v_mfma_f32_16x16x32_bf16 v[144:147], v[64:67], v[40:43], v[144:147]
    ds_read_b64_tr_b16 v[116:117], v10 offset:49152
    v_mfma_f32_16x16x32_bf16 v[148:151], v[68:71], v[40:43], v[148:151]
    ds_read_b64_tr_b16 v[118:119], v11 offset:49152
    v_mfma_f32_16x16x32_bf16 v[160:163], v[64:67], v[48:51], v[160:163]
    ds_read_b64_tr_b16 v[120:121], v8 offset:57344
    v_mfma_f32_16x16x32_bf16 v[164:167], v[68:71], v[48:51], v[164:167]
    ds_read_b64_tr_b16 v[122:123], v9 offset:57344
    v_mfma_f32_16x16x32_bf16 v[176:179], v[64:67], v[56:59], v[176:179]
    ds_read_b64_tr_b16 v[124:125], v10 offset:57344
    v_mfma_f32_16x16x32_bf16 v[180:183], v[68:71], v[56:59], v[180:183]
    ds_read_b64_tr_b16 v[126:127], v11 offset:57344
    v_mfma_f32_16x16x32_bf16 v[192:195], v[64:67], v[208:211], v[192:195]
    ds_read_b128 v[80:83], v24 offset:32768
    v_mfma_f32_16x16x32_bf16 v[196:199], v[68:71], v[208:211], v[196:199]
    ds_read_b128 v[84:87], v25 offset:32768
    v_mfma_f32_16x16x32_bf16 v[128:131], v[72:75], v[36:39], v[128:131]
    ds_read_b128 v[88:91], v24 offset:34816
    v_mfma_f32_16x16x32_bf16 v[132:135], v[76:79], v[36:39], v[132:135]
    ds_read_b128 v[92:95], v25 offset:34816
    v_mfma_f32_16x16x32_bf16 v[144:147], v[72:75], v[44:47], v[144:147]
    ds_read_b128 v[96:99], v24 offset:36864
    v_mfma_f32_16x16x32_bf16 v[148:151], v[76:79], v[44:47], v[148:151]
    ds_read_b128 v[100:103], v25 offset:36864
    v_mfma_f32_16x16x32_bf16 v[160:163], v[72:75], v[52:55], v[160:163]
    ds_read_b128 v[104:107], v24 offset:38912
    v_mfma_f32_16x16x32_bf16 v[164:167], v[76:79], v[52:55], v[164:167]
    ds_read_b128 v[108:111], v25 offset:38912
    v_mfma_f32_16x16x32_bf16 v[176:179], v[72:75], v[60:63], v[176:179]
    v_mfma_f32_16x16x32_bf16 v[180:183], v[76:79], v[60:63], v[180:183]
    v_mfma_f32_16x16x32_bf16 v[192:195], v[72:75], v[208:211], v[192:195]
    v_mfma_f32_16x16x32_bf16 v[196:199], v[76:79], v[208:211], v[196:199]
    s_waitcnt lgkmcnt(0)
    s_waitcnt vmcnt(8)
    s_barrier
    s_add_u32 m0, s21, 32768
    s_nop 0
    buffer_load_dwordx4 v23, s[88:91], s16 offen lds
    s_add_u32 s16, s16, s62
    s_add_u32 m0, s21, 33792
    s_nop 0
    buffer_load_dwordx4 v23, s[88:91], s17 offen lds
    s_add_u32 s17, s17, s62
    s_add_u32 m0, s22, 32768
    s_nop 0
    buffer_load_dwordx4 v2, s[8:11], s18 offen lds
    s_add_u32 s18, s18, s20
    s_add_u32 m0, s22, 40960
    s_nop 0
    buffer_load_dwordx4 v2, s[12:15], s19 offen lds
    s_add_u32 s19, s19, s20
    s_cmp_ge_u32 s16, s92
    s_cselect_b32 s94, 2048, 0
    s_cselect_b32 s95, s93, 0
    s_sub_u32 s16, s16, s94
    s_sub_u32 s17, s17, s94
    s_sub_u32 s18, s18, s95
    s_sub_u32 s19, s19, s95
    v_mfma_f32_16x16x32_bf16 v[128:131], v[112:115], v[80:83], v[128:131]
    ds_read_b64_tr_b16 v[64:65], v12 offset:16384
    v_mfma_f32_16x16x32_bf16 v[132:135], v[116:119], v[80:83], v[132:135]
    ds_read_b64_tr_b16 v[66:67], v13 offset:16384
    v_mfma_f32_16x16x32_bf16 v[144:147], v[112:115], v[88:91], v[144:147]
    ds_read_b64_tr_b16 v[68:69], v14 offset:16384
    v_mfma_f32_16x16x32_bf16 v[148:151], v[116:119], v[88:91], v[148:151]
    ds_read_b64_tr_b16 v[70:71], v15 offset:16384
    v_mfma_f32_16x16x32_bf16 v[160:163], v[112:115], v[96:99], v[160:163]
    ds_read_b64_tr_b16 v[72:73], v12 offset:24576
    v_mfma_f32_16x16x32_bf16 v[164:167], v[116:119], v[96:99], v[164:167]
    ds_read_b64_tr_b16 v[74:75], v13 offset:24576
    v_mfma_f32_16x16x32_bf16 v[176:179], v[112:115], v[104:107], v[176:179]
    ds_read_b64_tr_b16 v[76:77], v14 offset:24576
    v_mfma_f32_16x16x32_bf16 v[180:183], v[116:119], v[104:107], v[180:183]
    ds_read_b64_tr_b16 v[78:79], v15 offset:24576
    v_mfma_f32_16x16x32_bf16 v[192:195], v[112:115], v[208:211], v[192:195]
    ds_read_b128 v[32:35], v26 offset:0
    v_mfma_f32_16x16x32_bf16 v[196:199], v[116:119], v[208:211], v[196:199]
    ds_read_b128 v[36:39], v27 offset:0
    v_mfma_f32_16x16x32_bf16 v[128:131], v[120:123], v[84:87], v[128:131]
    ds_read_b128 v[40:43], v26 offset:2048
    v_mfma_f32_16x16x32_bf16 v[132:135], v[124:127], v[84:87], v[132:135]
    ds_read_b128 v[44:47], v27 offset:2048
    v_mfma_f32_16x16x32_bf16 v[144:147], v[120:123], v[92:95], v[144:147]
    ds_read_b128 v[48:51], v26 offset:4096
    v_mfma_f32_16x16x32_bf16 v[148:151], v[124:127], v[92:95], v[148:151]
    ds_read_b128 v[52:55], v27 offset:4096
    v_mfma_f32_16x16x32_bf16 v[160:163], v[120:123], v[100:103], v[160:163]
    ds_read_b128 v[56:59], v26 offset:6144
    v_mfma_f32_16x16x32_bf16 v[164:167], v[124:127], v[100:103], v[164:167]
    ds_read_b128 v[60:63], v27 offset:6144
    v_mfma_f32_16x16x32_bf16 v[176:179], v[120:123], v[108:111], v[176:179]
    v_mfma_f32_16x16x32_bf16 v[180:183], v[124:127], v[108:111], v[180:183]
    v_mfma_f32_16x16x32_bf16 v[192:195], v[120:123], v[208:211], v[192:195]
    v_mfma_f32_16x16x32_bf16 v[196:199], v[124:127], v[208:211], v[196:199]
    s_waitcnt lgkmcnt(0)
    s_waitcnt vmcnt(8)
    s_barrier
    s_add_u32 m0, s21, 65536
    s_nop 0
    buffer_load_dwordx4 v23, s[88:91], s16 offen lds
    s_add_u32 s16, s16, s62
    s_add_u32 m0, s21, 66560
    s_nop 0
    buffer_load_dwordx4 v23, s[88:91], s17 offen lds
    s_add_u32 s17, s17, s62
    s_add_u32 m0, s22, 65536
    s_nop 0
    buffer_load_dwordx4 v2, s[8:11], s18 offen lds
    s_add_u32 s18, s18, s20
    s_add_u32 m0, s22, 73728
    s_nop 0
    buffer_load_dwordx4 v2, s[12:15], s19 offen lds
    s_add_u32 s19, s19, s20
    s_cmp_ge_u32 s16, s92
    s_cselect_b32 s94, 2048, 0
    s_cselect_b32 s95, s93, 0
    s_sub_u32 s16, s16, s94
    s_sub_u32 s17, s17, s94
    s_sub_u32 s18, s18, s95
    s_sub_u32 s19, s19, s95
    v_mfma_f32_16x16x32_bf16 v[128:131], v[64:67], v[32:35], v[128:131]
    ds_read_b64_tr_b16 v[112:113], v12 offset:49152
    v_mfma_f32_16x16x32_bf16 v[132:135], v[68:71], v[32:35], v[132:135]
    ds_read_b64_tr_b16 v[114:115], v13 offset:49152
    v_mfma_f32_16x16x32_bf16 v[144:147], v[64:67], v[40:43], v[144:147]
    ds_read_b64_tr_b16 v[116:117], v14 offset:49152
    v_mfma_f32_16x16x32_bf16 v[148:151], v[68:71], v[40:43], v[148:151]
    ds_read_b64_tr_b16 v[118:119], v15 offset:49152
    v_mfma_f32_16x16x32_bf16 v[160:163], v[64:67], v[48:51], v[160:163]
    ds_read_b64_tr_b16 v[120:121], v12 offset:57344
    v_mfma_f32_16x16x32_bf16 v[164:167], v[68:71], v[48:51], v[164:167]
    ds_read_b64_tr_b16 v[122:123], v13 offset:57344
    v_mfma_f32_16x16x32_bf16 v[176:179], v[64:67], v[56:59], v[176:179]
    ds_read_b64_tr_b16 v[124:125], v14 offset:57344
    v_mfma_f32_16x16x32_bf16 v[180:183], v[68:71], v[56:59], v[180:183]
    ds_read_b64_tr_b16 v[126:127], v15 offset:57344
    v_mfma_f32_16x16x32_bf16 v[192:195], v[64:67], v[208:211], v[192:195]
    ds_read_b128 v[80:83], v26 offset:32768
    v_mfma_f32_16x16x32_bf16 v[196:199], v[68:71], v[208:211], v[196:199]
    ds_read_b128 v[84:87], v27 offset:32768
    v_mfma_f32_16x16x32_bf16 v[128:131], v[72:75], v[36:39], v[128:131]
    ds_read_b128 v[88:91], v26 offset:34816
    v_mfma_f32_16x16x32_bf16 v[132:135], v[76:79], v[36:39], v[132:135]
    ds_read_b128 v[92:95], v27 offset:34816
    v_mfma_f32_16x16x32_bf16 v[144:147], v[72:75], v[44:47], v[144:147]
    ds_read_b128 v[96:99], v26 offset:36864
    v_mfma_f32_16x16x32_bf16 v[148:151], v[76:79], v[44:47], v[148:151]
    ds_read_b128 v[100:103], v27 offset:36864
    v_mfma_f32_16x16x32_bf16 v[160:163], v[72:75], v[52:55], v[160:163]
    ds_read_b128 v[104:107], v26 offset:38912
    v_mfma_f32_16x16x32_bf16 v[164:167], v[76:79], v[52:55], v[164:167]
    ds_read_b128 v[108:111], v27 offset:38912
    v_mfma_f32_16x16x32_bf16 v[176:179], v[72:75], v[60:63], v[176:179]
    v_mfma_f32_16x16x32_bf16 v[180:183], v[76:79], v[60:63], v[180:183]
    v_mfma_f32_16x16x32_bf16 v[192:195], v[72:75], v[208:211], v[192:195]
    v_mfma_f32_16x16x32_bf16 v[196:199], v[76:79], v[208:211], v[196:199]
    s_waitcnt lgkmcnt(0)
    s_waitcnt vmcnt(8)
    s_barrier
    s_add_u32 m0, s21, 98304
    s_nop 0
    buffer_load_dwordx4 v23, s[88:91], s16 offen lds
    s_add_u32 s16, s16, s62
    s_add_u32 m0, s21, 99328
    s_nop 0
    buffer_load_dwordx4 v23, s[88:91], s17 offen lds
    s_add_u32 s17, s17, s62
    s_add_u32 m0, s22, 98304
    s_nop 0
    buffer_load_dwordx4 v2, s[8:11], s18 offen lds
    s_add_u32 s18, s18, s20
    s_add_u32 m0, s22, 106496
    s_nop 0
    buffer_load_dwordx4 v2, s[12:15], s19 offen lds
    s_add_u32 s19, s19, s20
    s_cmp_ge_u32 s16, s92
    s_cselect_b32 s94, 2048, 0
    s_cselect_b32 s95, s93, 0
    s_sub_u32 s16, s16, s94
    s_sub_u32 s17, s17, s94
    s_sub_u32 s18, s18, s95
    s_sub_u32 s19, s19, s95
    v_mfma_f32_16x16x32_bf16 v[128:131], v[112:115], v[80:83], v[128:131]
    ds_read_b64_tr_b16 v[64:65], v8 offset:16384
    v_mfma_f32_16x16x32_bf16 v[132:135], v[116:119], v[80:83], v[132:135]
    ds_read_b64_tr_b16 v[66:67], v9 offset:16384
    v_mfma_f32_16x16x32_bf16 v[144:147], v[112:115], v[88:91], v[144:147]
    ds_read_b64_tr_b16 v[68:69], v10 offset:16384
    v_mfma_f32_16x16x32_bf16 v[148:151], v[116:119], v[88:91], v[148:151]
    ds_read_b64_tr_b16 v[70:71], v11 offset:16384
    v_mfma_f32_16x16x32_bf16 v[160:163], v[112:115], v[96:99], v[160:163]
    ds_read_b64_tr_b16 v[72:73], v8 offset:24576
    v_mfma_f32_16x16x32_bf16 v[164:167], v[116:119], v[96:99], v[164:167]
    ds_read_b64_tr_b16 v[74:75], v9 offset:24576
    v_mfma_f32_16x16x32_bf16 v[176:179], v[112:115], v[104:107], v[176:179]
    ds_read_b64_tr_b16 v[76:77], v10 offset:24576
    v_mfma_f32_16x16x32_bf16 v[180:183], v[116:119], v[104:107], v[180:183]
    ds_read_b64_tr_b16 v[78:79], v11 offset:24576
    v_mfma_f32_16x16x32_bf16 v[192:195], v[112:115], v[208:211], v[192:195]
    ds_read_b128 v[32:35], v24 offset:0
    v_mfma_f32_16x16x32_bf16 v[196:199], v[116:119], v[208:211], v[196:199]
    ds_read_b128 v[36:39], v25 offset:0
    v_mfma_f32_16x16x32_bf16 v[128:131], v[120:123], v[84:87], v[128:131]
    ds_read_b128 v[40:43], v24 offset:2048
    v_mfma_f32_16x16x32_bf16 v[132:135], v[124:127], v[84:87], v[132:135]
    ds_read_b128 v[44:47], v25 offset:2048
    v_mfma_f32_16x16x32_bf16 v[144:147], v[120:123], v[92:95], v[144:147]
    ds_read_b128 v[48:51], v24 offset:4096
    v_mfma_f32_16x16x32_bf16 v[148:151], v[124:127], v[92:95], v[148:151]
    ds_read_b128 v[52:55], v25 offset:4096
    v_mfma_f32_16x16x32_bf16 v[160:163], v[120:123], v[100:103], v[160:163]
    ds_read_b128 v[56:59], v24 offset:6144
    v_mfma_f32_16x16x32_bf16 v[164:167], v[124:127], v[100:103], v[164:167]
    ds_read_b128 v[60:63], v25 offset:6144
    v_mfma_f32_16x16x32_bf16 v[176:179], v[120:123], v[108:111], v[176:179]
    v_mfma_f32_16x16x32_bf16 v[180:183], v[124:127], v[108:111], v[180:183]
    v_mfma_f32_16x16x32_bf16 v[192:195], v[120:123], v[208:211], v[192:195]
    v_mfma_f32_16x16x32_bf16 v[196:199], v[124:127], v[208:211], v[196:199]
    s_waitcnt lgkmcnt(0)
    s_sub_u32 s23, s23, 1
    s_cmp_lg_u32 s23, 0
    s_cbranch_scc1 w_loopX
    s_waitcnt vmcnt(8)
    s_barrier
    v_mfma_f32_16x16x32_bf16 v[128:131], v[64:67], v[32:35], v[128:131]
    ds_read_b64_tr_b16 v[112:113], v8 offset:49152
    v_mfma_f32_16x16x32_bf16 v[132:135], v[68:71], v[32:35], v[132:135]
    ds_read_b64_tr_b16 v[114:115], v9 offset:49152
    v_mfma_f32_16x16x32_bf16 v[144:147], v[64:67], v[40:43], v[144:147]
    ds_read_b64_tr_b16 v[116:117], v10 offset:49152
    v_mfma_f32_16x16x32_bf16 v[148:151], v[68:71], v[40:43], v[148:151]
    ds_read_b64_tr_b16 v[118:119], v11 offset:49152
    v_mfma_f32_16x16x32_bf16 v[160:163], v[64:67], v[48:51], v[160:163]
    ds_read_b64_tr_b16 v[120:121], v8 offset:57344
    v_mfma_f32_16x16x32_bf16 v[164:167], v[68:71], v[48:51], v[164:167]
    ds_read_b64_tr_b16 v[122:123], v9 offset:57344
    v_mfma_f32_16x16x32_bf16 v[176:179], v[64:67], v[56:59], v[176:179]
    ds_read_b64_tr_b16 v[124:125], v10 offset:57344
    v_mfma_f32_16x16x32_bf16 v[180:183], v[68:71], v[56:59], v[180:183]
    ds_read_b64_tr_b16 v[126:127], v11 offset:57344
    v_mfma_f32_16x16x32_bf16 v[192:195], v[64:67], v[208:211], v[192:195]
    ds_read_b128 v[80:83], v24 offset:32768
    v_mfma_f32_16x16x32_bf16 v[196:199], v[68:71], v[208:211], v[196:199]
    ds_read_b128 v[84:87], v25 offset:32768
    v_mfma_f32_16x16x32_bf16 v[128:131], v[72:75], v[36:39], v[128:131]
    ds_read_b128 v[88:91], v24 offset:34816
    v_mfma_f32_16x16x32_bf16 v[132:135], v[76:79], v[36:39], v[132:135]
    ds_read_b128 v[92:95], v25 offset:34816
    v_mfma_f32_16x16x32_bf16 v[144:147], v[72:75], v[44:47], v[144:147]
    ds_read_b128 v[96:99], v24 offset:36864
    v_mfma_f32_16x16x32_bf16 v[148:151], v[76:79], v[44:47], v[148:151]
    ds_read_b128 v[100:103], v25 offset:36864
    v_mfma_f32_16x16x32_bf16 v[160:163], v[72:75], v[52:55], v[160:163]
    ds_read_b128 v[104:107], v24 offset:38912
    v_mfma_f32_16x16x32_bf16 v[164:167], v[76:79], v[52:55], v[164:167]
    ds_read_b128 v[108:111], v25 offset:38912
    v_mfma_f32_16x16x32_bf16 v[176:179], v[72:75], v[60:63], v[176:179]
    v_mfma_f32_16x16x32_bf16 v[180:183], v[76:79], v[60:63], v[180:183]
    v_mfma_f32_16x16x32_bf16 v[192:195], v[72:75], v[208:211], v[192:195]
    v_mfma_f32_16x16x32_bf16 v[196:199], v[76:79], v[208:211], v[196:199]
    s_waitcnt lgkmcnt(0)
    s_waitcnt vmcnt(4)
    s_barrier
    v_mfma_f32_16x16x32_bf16 v[128:131], v[112:115], v[80:83], v[128:131]
    ds_read_b64_tr_b16 v[64:65], v12 offset:16384
    v_mfma_f32_16x16x32_bf16 v[132:135], v[116:119], v[80:83], v[132:135]
    ds_read_b64_tr_b16 v[66:67], v13 offset:16384
    v_mfma_f32_16x16x32_bf16 v[144:147], v[112:115], v[88:91], v[144:147]
    ds_read_b64_tr_b16 v[68:69], v14 offset:16384
    v_mfma_f32_16x16x32_bf16 v[148:151], v[116:119], v[88:91], v[148:151]
    ds_read_b64_tr_b16 v[70:71], v15 offset:16384
    v_mfma_f32_16x16x32_bf16 v[160:163], v[112:115], v[96:99], v[160:163]
    ds_read_b64_tr_b16 v[72:73], v12 offset:24576
    v_mfma_f32_16x16x32_bf16 v[164:167], v[116:119], v[96:99], v[164:167]
    ds_read_b64_tr_b16 v[74:75], v13 offset:24576
    v_mfma_f32_16x16x32_bf16 v[176:179], v[112:115], v[104:107], v[176:179]
    ds_read_b64_tr_b16 v[76:77], v14 offset:24576
    v_mfma_f32_16x16x32_bf16 v[180:183], v[116:119], v[104:107], v[180:183]
    ds_read_b64_tr_b16 v[78:79], v15 offset:24576
    v_mfma_f32_16x16x32_bf16 v[192:195], v[112:115], v[208:211], v[192:195]
    ds_read_b128 v[32:35], v26 offset:0
    v_mfma_f32_16x16x32_bf16 v[196:199], v[116:119], v[208:211], v[196:199]
    ds_read_b128 v[36:39], v27 offset:0
    v_mfma_f32_16x16x32_bf16 v[128:131], v[120:123], v[84:87], v[128:131]
    ds_read_b128 v[40:43], v26 offset:2048
    v_mfma_f32_16x16x32_bf16 v[132:135], v[124:127], v[84:87], v[132:135]
    ds_read_b128 v[44:47], v27 offset:2048
    v_mfma_f32_16x16x32_bf16 v[144:147], v[120:123], v[92:95], v[144:147]
    ds_read_b128 v[48:51], v26 offset:4096
    v_mfma_f32_16x16x32_bf16 v[148:151], v[124:127], v[92:95], v[148:151]
    ds_read_b128 v[52:55], v27 offset:4096
    v_mfma_f32_16x16x32_bf16 v[160:163], v[120:123], v[100:103], v[160:163]
    ds_read_b128 v[56:59], v26 offset:6144
    v_mfma_f32_16x16x32_bf16 v[164:167], v[124:127], v[100:103], v[164:167]
    ds_read_b128 v[60:63], v27 offset:6144
    v_mfma_f32_16x16x32_bf16 v[176:179], v[120:123], v[108:111], v[176:179]
    v_mfma_f32_16x16x32_bf16 v[180:183], v[124:127], v[108:111], v[180:183]
    v_mfma_f32_16x16x32_bf16 v[192:195], v[120:123], v[208:211], v[192:195]
    v_mfma_f32_16x16x32_bf16 v[196:199], v[124:127], v[208:211], v[196:199]
    s_waitcnt lgkmcnt(0)
    s_waitcnt vmcnt(0)
    s_barrier
    v_mfma_f32_16x16x32_bf16 v[128:131], v[64:67], v[32:35], v[128:131]
    ds_read_b64_tr_b16 v[112:113], v12 offset:49152
    v_mfma_f32_16x16x32_bf16 v[132:135], v[68:71], v[32:35], v[132:135]
    ds_read_b64_tr_b16 v[114:115], v13 offset:49152
    v_mfma_f32_16x16x32_bf16 v[144:147], v[64:67], v[40:43], v[144:147]
    ds_read_b64_tr_b16 v[116:117], v14 offset:49152
    v_mfma_f32_16x16x32_bf16 v[148:151], v[68:71], v[40:43], v[148:151]
    ds_read_b64_tr_b16 v[118:119], v15 offset:49152
    v_mfma_f32_16x16x32_bf16 v[160:163], v[64:67], v[48:51], v[160:163]
    ds_read_b64_tr_b16 v[120:121], v12 offset:57344
    v_mfma_f32_16x16x32_bf16 v[164:167], v[68:71], v[48:51], v[164:167]
    ds_read_b64_tr_b16 v[122:123], v13 offset:57344
    v_mfma_f32_16x16x32_bf16 v[176:179], v[64:67], v[56:59], v[176:179]
    ds_read_b64_tr_b16 v[124:125], v14 offset:57344
    v_mfma_f32_16x16x32_bf16 v[180:183], v[68:71], v[56:59], v[180:183]
    ds_read_b64_tr_b16 v[126:127], v15 offset:57344
    v_mfma_f32_16x16x32_bf16 v[192:195], v[64:67], v[208:211], v[192:195]
    ds_read_b128 v[80:83], v26 offset:32768
    v_mfma_f32_16x16x32_bf16 v[196:199], v[68:71], v[208:211], v[196:199]
    ds_read_b128 v[84:87], v27 offset:32768
    v_mfma_f32_16x16x32_bf16 v[128:131], v[72:75], v[36:39], v[128:131]
    ds_read_b128 v[88:91], v26 offset:34816
    v_mfma_f32_16x16x32_bf16 v[132:135], v[76:79], v[36:39], v[132:135]
    ds_read_b128 v[92:95], v27 offset:34816
    v_mfma_f32_16x16x32_bf16 v[144:147], v[72:75], v[44:47], v[144:147]
    ds_read_b128 v[96:99], v26 offset:36864
    v_mfma_f32_16x16x32_bf16 v[148:151], v[76:79], v[44:47], v[148:151]
    ds_read_b128 v[100:103], v27 offset:36864
    v_mfma_f32_16x16x32_bf16 v[160:163], v[72:75], v[52:55], v[160:163]
    ds_read_b128 v[104:107], v26 offset:38912
    v_mfma_f32_16x16x32_bf16 v[164:167], v[76:79], v[52:55], v[164:167]
    ds_read_b128 v[108:111], v27 offset:38912
    v_mfma_f32_16x16x32_bf16 v[176:179], v[72:75], v[60:63], v[176:179]
    v_mfma_f32_16x16x32_bf16 v[180:183], v[76:79], v[60:63], v[180:183]
    v_mfma_f32_16x16x32_bf16 v[192:195], v[72:75], v[208:211], v[192:195]
    v_mfma_f32_16x16x32_bf16 v[196:199], v[76:79], v[208:211], v[196:199]
    s_waitcnt lgkmcnt(0)
    s_waitcnt vmcnt(0)
    s_barrier
    v_mfma_f32_16x16x32_bf16 v[128:131], v[112:115], v[80:83], v[128:131]
    ds_read_b64_tr_b16 v[64:65], v8 offset:16384
    v_mfma_f32_16x16x32_bf16 v[132:135], v[116:119], v[80:83], v[132:135]
    ds_read_b64_tr_b16 v[66:67], v9 offset:16384
    v_mfma_f32_16x16x32_bf16 v[144:147], v[112:115], v[88:91], v[144:147]
    ds_read_b64_tr_b16 v[68:69], v10 offset:16384
    v_mfma_f32_16x16x32_bf16 v[148:151], v[116:119], v[88:91], v[148:151]
    ds_read_b64_tr_b16 v[70:71], v11 offset:16384
    v_mfma_f32_16x16x32_bf16 v[160:163], v[112:115], v[96:99], v[160:163]
    ds_read_b64_tr_b16 v[72:73], v8 offset:24576
    v_mfma_f32_16x16x32_bf16 v[164:167], v[116:119], v[96:99], v[164:167]
    ds_read_b64_tr_b16 v[74:75], v9 offset:24576
    v_mfma_f32_16x16x32_bf16 v[176:179], v[112:115], v[104:107], v[176:179]
    ds_read_b64_tr_b16 v[76:77], v10 offset:24576
    v_mfma_f32_16x16x32_bf16 v[180:183], v[116:119], v[104:107], v[180:183]
    ds_read_b64_tr_b16 v[78:79], v11 offset:24576
    v_mfma_f32_16x16x32_bf16 v[192:195], v[112:115], v[208:211], v[192:195]
    ds_read_b128 v[32:35], v24 offset:0
    v_mfma_f32_16x16x32_bf16 v[196:199], v[116:119], v[208:211], v[196:199]
    ds_read_b128 v[36:39], v25 offset:0
    v_mfma_f32_16x16x32_bf16 v[128:131], v[120:123], v[84:87], v[128:131]
    ds_read_b128 v[40:43], v24 offset:2048
    v_mfma_f32_16x16x32_bf16 v[132:135], v[124:127], v[84:87], v[132:135]
    ds_read_b128 v[44:47], v25 offset:2048
    v_mfma_f32_16x16x32_bf16 v[144:147], v[120:123], v[92:95], v[144:147]
    ds_read_b128 v[48:51], v24 offset:4096
    v_mfma_f32_16x16x32_bf16 v[148:151], v[124:127], v[92:95], v[148:151]
    ds_read_b128 v[52:55], v25 offset:4096
    v_mfma_f32_16x16x32_bf16 v[160:163], v[120:123], v[100:103], v[160:163]
    ds_read_b128 v[56:59], v24 offset:6144
    v_mfma_f32_16x16x32_bf16 v[164:167], v[124:127], v[100:103], v[164:167]
    ds_read_b128 v[60:63], v25 offset:6144
    v_mfma_f32_16x16x32_bf16 v[176:179], v[120:123], v[108:111], v[176:179]
    v_mfma_f32_16x16x32_bf16 v[180:183], v[124:127], v[108:111], v[180:183]
    v_mfma_f32_16x16x32_bf16 v[192:195], v[120:123], v[208:211], v[192:195]
    v_mfma_f32_16x16x32_bf16 v[196:199], v[124:127], v[208:211], v[196:199]
    s_waitcnt lgkmcnt(0)
    v_and_b32 v20, 0xf0, v1
    v_lshrrev_b32 v20, 1, v20
    s_lshl_b32 s30, s26, 9
    s_add_u32 s30, s30, 188743680
    s_mov_b32 s31, 0x40000
    v_and_b32 v21, 1, v4
    v_lshlrev_b32 v21, 10, v21
    v_xor_b32 v8, v21, v8
    v_xor_b32 v9, v21, v9
    v_xor_b32 v10, v21, v10
    v_xor_b32 v11, v21, v11
    v_xor_b32 v12, v21, v12
    v_xor_b32 v13, v21, v13
    v_xor_b32 v14, v21, v14
    v_xor_b32 v15, v21, v15
w_stX:
    buffer_load_dword v22, off, s[64:67], 0 offset:192 sc1
    buffer_load_dwordx2 v[24:25], v20, s[4:7], s30 offen offset:0 sc1
    buffer_load_dwordx2 v[26:27], v20, s[4:7], s30 offen offset:128 sc1
    buffer_load_dwordx2 v[28:29], v20, s[4:7], s30 offen offset:256 sc1
    buffer_load_dwordx2 v[30:31], v20, s[4:7], s30 offen offset:384 sc1
    s_waitcnt vmcnt(0)
    v_readfirstlane_b32 s29, v22
    s_cmp_ge_u32 s29, 32
    s_cbranch_scc1 w_stXok
    s_sleep 4
    s_sub_u32 s31, s31, 1
    s_cbranch_scc0 w_stX
w_stXok:
    buffer_load_dword v22, off, s[64:67], 0 sc1
    v_fma_f32 v128, -v24, v192, v128
    v_fma_f32 v129, -v24, v193, v129
    v_fma_f32 v130, -v24, v194, v130
    v_fma_f32 v131, -v24, v195, v131
    v_fma_f32 v132, -v24, v196, v132
    v_fma_f32 v133, -v24, v197, v133
    v_fma_f32 v134, -v24, v198, v134
    v_fma_f32 v135, -v24, v199, v135
    v_mul_f32 v128, v128, v25
    v_mul_f32 v129, v129, v25
    v_mul_f32 v130, v130, v25
    v_mul_f32 v131, v131, v25
    v_mul_f32 v132, v132, v25
    v_mul_f32 v133, v133, v25
    v_mul_f32 v134, v134, v25
    v_mul_f32 v135, v135, v25
    v_fma_f32 v144, -v26, v192, v144
    v_fma_f32 v145, -v26, v193, v145
    v_fma_f32 v146, -v26, v194, v146
    v_fma_f32 v147, -v26, v195, v147
    v_fma_f32 v148, -v26, v196, v148
    v_fma_f32 v149, -v26, v197, v149
    v_fma_f32 v150, -v26, v198, v150
    v_fma_f32 v151, -v26, v199, v151
    v_mul_f32 v144, v144, v27
    v_mul_f32 v145, v145, v27
    v_mul_f32 v146, v146, v27
    v_mul_f32 v147, v147, v27
    v_mul_f32 v148, v148, v27
    v_mul_f32 v149, v149, v27
    v_mul_f32 v150, v150, v27
    v_mul_f32 v151, v151, v27
    v_fma_f32 v160, -v28, v192, v160
    v_fma_f32 v161, -v28, v193, v161
    v_fma_f32 v162, -v28, v194, v162
    v_fma_f32 v163, -v28, v195, v163
    v_fma_f32 v164, -v28, v196, v164
    v_fma_f32 v165, -v28, v197, v165
    v_fma_f32 v166, -v28, v198, v166
    v_fma_f32 v167, -v28, v199, v167
    v_mul_f32 v160, v160, v29
    v_mul_f32 v161, v161, v29
    v_mul_f32 v162, v162, v29
    v_mul_f32 v163, v163, v29
    v_mul_f32 v164, v164, v29
    v_mul_f32 v165, v165, v29
    v_mul_f32 v166, v166, v29
    v_mul_f32 v167, v167, v29
    v_fma_f32 v176, -v30, v192, v176
    v_fma_f32 v177, -v30, v193, v177
    v_fma_f32 v178, -v30, v194, v178
    v_fma_f32 v179, -v30, v195, v179
    v_fma_f32 v180, -v30, v196, v180
    v_fma_f32 v181, -v30, v197, v181
    v_fma_f32 v182, -v30, v198, v182
    v_fma_f32 v183, -v30, v199, v183
    v_mul_f32 v176, v176, v31
    v_mul_f32 v177, v177, v31
    v_mul_f32 v178, v178, v31
    v_mul_f32 v179, v179, v31
    v_mul_f32 v180, v180, v31
    v_mul_f32 v181, v181, v31
    v_mul_f32 v182, v182, v31
    v_mul_f32 v183, v183, v31
    s_lshl_b32 s30, s27, 10
    s_add_u32 s30, s30, s49
    s_nop 7
    v_cvt_pk_bf16_f32 v80, v128, v129
    v_cvt_pk_bf16_f32 v81, v130, v131
    v_cvt_pk_bf16_f32 v82, v132, v133
    v_cvt_pk_bf16_f32 v83, v134, v135
    buffer_store_dwordx4 v[80:83], v1, s[4:7], s30 offen sc1
    s_add_u32 s30, s30, s50
    v_cvt_pk_bf16_f32 v84, v144, v145
    v_cvt_pk_bf16_f32 v85, v146, v147
    v_cvt_pk_bf16_f32 v86, v148, v149
    v_cvt_pk_bf16_f32 v87, v150, v151
    buffer_store_dwordx4 v[84:87], v1, s[4:7], s30 offen sc1
    s_add_u32 s30, s30, s50
    v_cvt_pk_bf16_f32 v88, v160, v161
    v_cvt_pk_bf16_f32 v89, v162, v163
    v_cvt_pk_bf16_f32 v90, v164, v165
    v_cvt_pk_bf16_f32 v91, v166, v167
    buffer_store_dwordx4 v[88:91], v1, s[4:7], s30 offen sc1
    s_add_u32 s30, s30, s50
    v_cvt_pk_bf16_f32 v92, v176, v177
    v_cvt_pk_bf16_f32 v93, v178, v179
    v_cvt_pk_bf16_f32 v94, v180, v181
    v_cvt_pk_bf16_f32 v95, v182, v183
    buffer_store_dwordx4 v[92:95], v1, s[4:7], s30 offen sc1
    s_add_u32 s30, s30, s50
    s_mov_b32 s28, s51
    s_mov_b32 s57, s53
    s_branch w_drain
w_firstM:
    s_waitcnt vmcnt(6)
    s_barrier
    s_add_u32 m0, s21, 0
    s_nop 0
    buffer_load_dwordx4 v1, s[4:7], s16 offen sc1 lds
    s_add_u32 s16, s16, s62
    s_add_u32 m0, s22, 0
    s_nop 0
    buffer_load_dwordx4 v2, s[8:11], s18 offen lds
    s_add_u32 s18, s18, s20
    s_add_u32 m0, s22, 8192
    s_nop 0
    buffer_load_dwordx4 v2, s[12:15], s19 offen lds
    s_add_u32 s19, s19, s20
    v_mfma_f32_16x16x32_bf16 v[128:131], v[64:67], v[32:35], 0
    ds_read_b64_tr_b16 v[112:113], v8 offset:49152
    v_mfma_f32_16x16x32_bf16 v[132:135], v[68:71], v[32:35], 0
    ds_read_b64_tr_b16 v[114:115], v9 offset:49152
    v_mfma_f32_16x16x32_bf16 v[136:139], v[72:75], v[32:35], 0
    ds_read_b64_tr_b16 v[116:117], v10 offset:49152
    v_mfma_f32_16x16x32_bf16 v[140:143], v[76:79], v[32:35], 0
    ds_read_b64_tr_b16 v[118:119], v11 offset:49152
    v_mfma_f32_16x16x32_bf16 v[144:147], v[64:67], v[40:43], 0
    ds_read_b64_tr_b16 v[120:121], v8 offset:57344
    v_mfma_f32_16x16x32_bf16 v[148:151], v[68:71], v[40:43], 0
    ds_read_b64_tr_b16 v[122:123], v9 offset:57344
    v_mfma_f32_16x16x32_bf16 v[152:155], v[72:75], v[40:43], 0
    ds_read_b64_tr_b16 v[124:125], v10 offset:57344
    v_mfma_f32_16x16x32_bf16 v[156:159], v[76:79], v[40:43], 0
    ds_read_b64_tr_b16 v[126:127], v11 offset:57344
    v_mfma_f32_16x16x32_bf16 v[160:163], v[64:67], v[48:51], 0
    ds_read_b128 v[80:83], v5 offset:32768
    v_mfma_f32_16x16x32_bf16 v[164:167], v[68:71], v[48:51], 0
    ds_read_b128 v[88:91], v5 offset:34816
    v_mfma_f32_16x16x32_bf16 v[168:171], v[72:75], v[48:51], 0
    ds_read_b128 v[96:99], v5 offset:36864
    v_mfma_f32_16x16x32_bf16 v[172:175], v[76:79], v[48:51], 0
    ds_read_b128 v[104:107], v5 offset:38912
    v_mfma_f32_16x16x32_bf16 v[176:179], v[64:67], v[56:59], 0
    v_mfma_f32_16x16x32_bf16 v[180:183], v[68:71], v[56:59], 0
    v_mfma_f32_16x16x32_bf16 v[184:187], v[72:75], v[56:59], 0
    v_mfma_f32_16x16x32_bf16 v[188:191], v[76:79], v[56:59], 0
    s_waitcnt lgkmcnt(0)
    s_waitcnt vmcnt(6)
    s_barrier
    s_add_u32 m0, s21, 32768
    s_nop 0
    buffer_load_dwordx4 v1, s[4:7], s16 offen sc1 lds
    s_add_u32 s16, s16, s62
    s_add_u32 m0, s22, 32768
    s_nop 0
    buffer_load_dwordx4 v2, s[8:11], s18 offen lds
    s_add_u32 s18, s18, s20
    s_add_u32 m0, s22, 40960
    s_nop 0
    buffer_load_dwordx4 v2, s[12:15], s19 offen lds
    s_add_u32 s19, s19, s20
    v_mfma_f32_16x16x32_bf16 v[128:131], v[112:115], v[80:83], v[128:131]
    ds_read_b64_tr_b16 v[64:65], v12 offset:16384
    v_mfma_f32_16x16x32_bf16 v[132:135], v[116:119], v[80:83], v[132:135]
    ds_read_b64_tr_b16 v[66:67], v13 offset:16384
    v_mfma_f32_16x16x32_bf16 v[136:139], v[120:123], v[80:83], v[136:139]
    ds_read_b64_tr_b16 v[68:69], v14 offset:16384
    v_mfma_f32_16x16x32_bf16 v[140:143], v[124:127], v[80:83], v[140:143]
    ds_read_b64_tr_b16 v[70:71], v15 offset:16384
    v_mfma_f32_16x16x32_bf16 v[144:147], v[112:115], v[88:91], v[144:147]
    ds_read_b64_tr_b16 v[72:73], v12 offset:24576
    v_mfma_f32_16x16x32_bf16 v[148:151], v[116:119], v[88:91], v[148:151]
    ds_read_b64_tr_b16 v[74:75], v13 offset:24576
    v_mfma_f32_16x16x32_bf16 v[152:155], v[120:123], v[88:91], v[152:155]
    ds_read_b64_tr_b16 v[76:77], v14 offset:24576
    v_mfma_f32_16x16x32_bf16 v[156:159], v[124:127], v[88:91], v[156:159]
    ds_read_b64_tr_b16 v[78:79], v15 offset:24576
    v_mfma_f32_16x16x32_bf16 v[160:163], v[112:115], v[96:99], v[160:163]
    ds_read_b128 v[32:35], v6 offset:0
    v_mfma_f32_16x16x32_bf16 v[164:167], v[116:119], v[96:99], v[164:167]
    ds_read_b128 v[40:43], v6 offset:2048
    v_mfma_f32_16x16x32_bf16 v[168:171], v[120:123], v[96:99], v[168:171]
    ds_read_b128 v[48:51], v6 offset:4096
    v_mfma_f32_16x16x32_bf16 v[172:175], v[124:127], v[96:99], v[172:175]
    ds_read_b128 v[56:59], v6 offset:6144
    v_mfma_f32_16x16x32_bf16 v[176:179], v[112:115], v[104:107], v[176:179]
    v_mfma_f32_16x16x32_bf16 v[180:183], v[116:119], v[104:107], v[180:183]
    v_mfma_f32_16x16x32_bf16 v[184:187], v[120:123], v[104:107], v[184:187]
    v_mfma_f32_16x16x32_bf16 v[188:191], v[124:127], v[104:107], v[188:191]
    s_waitcnt lgkmcnt(0)
    s_waitcnt vmcnt(6)
    s_barrier
    s_add_u32 m0, s21, 65536
    s_nop 0
    buffer_load_dwordx4 v1, s[4:7], s16 offen sc1 lds
    s_add_u32 s16, s16, s62
    s_add_u32 m0, s22, 65536
    s_nop 0
    buffer_load_dwordx4 v2, s[8:11], s18 offen lds
    s_add_u32 s18, s18, s20
    s_add_u32 m0, s22, 73728
    s_nop 0
    buffer_load_dwordx4 v2, s[12:15], s19 offen lds
    s_add_u32 s19, s19, s20
    v_mfma_f32_16x16x32_bf16 v[128:131], v[64:67], v[32:35], v[128:131]
    ds_read_b64_tr_b16 v[112:113], v12 offset:49152
    v_mfma_f32_16x16x32_bf16 v[132:135], v[68:71], v[32:35], v[132:135]
    ds_read_b64_tr_b16 v[114:115], v13 offset:49152
    v_mfma_f32_16x16x32_bf16 v[136:139], v[72:75], v[32:35], v[136:139]
    ds_read_b64_tr_b16 v[116:117], v14 offset:49152
    v_mfma_f32_16x16x32_bf16 v[140:143], v[76:79], v[32:35], v[140:143]
    ds_read_b64_tr_b16 v[118:119], v15 offset:49152
    v_mfma_f32_16x16x32_bf16 v[144:147], v[64:67], v[40:43], v[144:147]
    ds_read_b64_tr_b16 v[120:121], v12 offset:57344
    v_mfma_f32_16x16x32_bf16 v[148:151], v[68:71], v[40:43], v[148:151]
    ds_read_b64_tr_b16 v[122:123], v13 offset:57344
    v_mfma_f32_16x16x32_bf16 v[152:155], v[72:75], v[40:43], v[152:155]
    ds_read_b64_tr_b16 v[124:125], v14 offset:57344
    v_mfma_f32_16x16x32_bf16 v[156:159], v[76:79], v[40:43], v[156:159]
    ds_read_b64_tr_b16 v[126:127], v15 offset:57344
    v_mfma_f32_16x16x32_bf16 v[160:163], v[64:67], v[48:51], v[160:163]
    ds_read_b128 v[80:83], v6 offset:32768
    v_mfma_f32_16x16x32_bf16 v[164:167], v[68:71], v[48:51], v[164:167]
    ds_read_b128 v[88:91], v6 offset:34816
    v_mfma_f32_16x16x32_bf16 v[168:171], v[72:75], v[48:51], v[168:171]
    ds_read_b128 v[96:99], v6 offset:36864
    v_mfma_f32_16x16x32_bf16 v[172:175], v[76:79], v[48:51], v[172:175]
    ds_read_b128 v[104:107], v6 offset:38912
    v_mfma_f32_16x16x32_bf16 v[176:179], v[64:67], v[56:59], v[176:179]
    v_mfma_f32_16x16x32_bf16 v[180:183], v[68:71], v[56:59], v[180:183]
    v_mfma_f32_16x16x32_bf16 v[184:187], v[72:75], v[56:59], v[184:187]
    v_mfma_f32_16x16x32_bf16 v[188:191], v[76:79], v[56:59], v[188:191]
    s_waitcnt lgkmcnt(0)
    s_waitcnt vmcnt(6)
    s_barrier
    s_add_u32 m0, s21, 98304
    s_nop 0
    buffer_load_dwordx4 v1, s[4:7], s16 offen sc1 lds
    s_add_u32 s16, s16, s62
    s_add_u32 m0, s22, 98304
    s_nop 0
    buffer_load_dwordx4 v2, s[8:11], s18 offen lds
    s_add_u32 s18, s18, s20
    s_add_u32 m0, s22, 106496
    s_nop 0
    buffer_load_dwordx4 v2, s[12:15], s19 offen lds
    s_add_u32 s19, s19, s20
    v_mfma_f32_16x16x32_bf16 v[128:131], v[112:115], v[80:83], v[128:131]
    ds_read_b64_tr_b16 v[64:65], v8 offset:16384
    v_mfma_f32_16x16x32_bf16 v[132:135], v[116:119], v[80:83], v[132:135]
    ds_read_b64_tr_b16 v[66:67], v9 offset:16384
    v_mfma_f32_16x16x32_bf16 v[136:139], v[120:123], v[80:83], v[136:139]
    ds_read_b64_tr_b16 v[68:69], v10 offset:16384
    v_mfma_f32_16x16x32_bf16 v[140:143], v[124:127], v[80:83], v[140:143]
    ds_read_b64_tr_b16 v[70:71], v11 offset:16384
    v_mfma_f32_16x16x32_bf16 v[144:147], v[112:115], v[88:91], v[144:147]
    ds_read_b64_tr_b16 v[72:73], v8 offset:24576
    v_mfma_f32_16x16x32_bf16 v[148:151], v[116:119], v[88:91], v[148:151]
    ds_read_b64_tr_b16 v[74:75], v9 offset:24576
    v_mfma_f32_16x16x32_bf16 v[152:155], v[120:123], v[88:91], v[152:155]
    ds_read_b64_tr_b16 v[76:77], v10 offset:24576
    v_mfma_f32_16x16x32_bf16 v[156:159], v[124:127], v[88:91], v[156:159]
    ds_read_b64_tr_b16 v[78:79], v11 offset:24576
    v_mfma_f32_16x16x32_bf16 v[160:163], v[112:115], v[96:99], v[160:163]
    ds_read_b128 v[32:35], v5 offset:0
    v_mfma_f32_16x16x32_bf16 v[164:167], v[116:119], v[96:99], v[164:167]
    ds_read_b128 v[40:43], v5 offset:2048
    v_mfma_f32_16x16x32_bf16 v[168:171], v[120:123], v[96:99], v[168:171]
    ds_read_b128 v[48:51], v5 offset:4096
    v_mfma_f32_16x16x32_bf16 v[172:175], v[124:127], v[96:99], v[172:175]
    ds_read_b128 v[56:59], v5 offset:6144
    v_mfma_f32_16x16x32_bf16 v[176:179], v[112:115], v[104:107], v[176:179]
    v_mfma_f32_16x16x32_bf16 v[180:183], v[116:119], v[104:107], v[180:183]
    v_mfma_f32_16x16x32_bf16 v[184:187], v[120:123], v[104:107], v[184:187]
    v_mfma_f32_16x16x32_bf16 v[188:191], v[124:127], v[104:107], v[188:191]
    s_waitcnt lgkmcnt(0)
w_loop_chkM:
    s_sub_u32 s23, s23, 1
w_loopM:
    s_cmp_lg_u32 s23, 1
    s_cbranch_scc1 w_bodyM
    v_readfirstlane_b32 s68, v22
    s_cmp_ge_u32 s68, 128
    s_cselect_b32 s70, 0, s70
    v_readfirstlane_b32 s30, v16
    s_cmp_ge_u32 s30, s45
    s_cselect_b32 s30, 0, 1
    s_or_b32 s30, s30, s70
    s_cmp_ge_u32 s32, 4
    s_cselect_b32 s30, 1, s30
    s_cmp_eq_u32 s32, 0
    s_cselect_b32 s30, 1, s30
    v_mov_b32 v20, s30
    ds_write_b32 v7, v20
    s_cbranch_scc1 w_bodyM
    s_load_dwordx2 s[8:9], s[0:1], s33
    s_load_dwordx2 s[12:13], s[0:1], s34
    s_mov_b32 s10, s38
    s_mov_b32 s14, s38
    s_cmp_ge_u32 s32, 4
    s_cselect_b32 s31, 0, 1
    s_lshl_b32 s30, s3, s31
    s_mul_i32 s30, s30, s40
    s_add_u32 s16, s39, s30
    s_cmp_eq_u32 s32, 4
    s_cselect_b32 s30, 1024, s40
    s_cselect_b32 s31, 6, 5
    s_lshl_b32 s62, 32, s31
    s_add_u32 s17, s16, s30
    s_lshl_b32 s30, s3, 2
    s_mul_i32 s30, s30, s35
    s_add_u32 s18, s36, s30
    s_add_u32 s19, s37, s30
    s_lshl_b32 s20, s35, s31
    v_mul_u32_u24 v2, s35, v4
    v_add_u32 v2, v2, v3
    s_waitcnt lgkmcnt(0)
    s_waitcnt vmcnt(6)
    s_barrier
    s_add_u32 m0, s21, 0
    s_nop 0
    buffer_load_dwordx4 v1, s[4:7], s16 offen sc1 lds
    s_add_u32 s16, s16, s62
    s_add_u32 m0, s21, 1024
    s_nop 0
    buffer_load_dwordx4 v1, s[4:7], s17 offen sc1 lds
    s_add_u32 s17, s17, s62
    s_add_u32 m0, s22, 0
    s_nop 0
    buffer_load_dwordx4 v2, s[8:11], s18 offen lds
    s_add_u32 s18, s18, s20
    s_add_u32 m0, s22, 8192
    s_nop 0
    buffer_load_dwordx4 v2, s[12:15], s19 offen lds
    s_add_u32 s19, s19, s20
    v_mfma_f32_16x16x32_bf16 v[128:131], v[64:67], v[32:35], v[128:131]
    ds_read_b64_tr_b16 v[112:113], v8 offset:49152
    v_mfma_f32_16x16x32_bf16 v[132:135], v[68:71], v[32:35], v[132:135]
    ds_read_b64_tr_b16 v[114:115], v9 offset:49152
    v_mfma_f32_16x16x32_bf16 v[136:139], v[72:75], v[32:35], v[136:139]
    ds_read_b64_tr_b16 v[116:117], v10 offset:49152
    v_mfma_f32_16x16x32_bf16 v[140:143], v[76:79], v[32:35], v[140:143]
    ds_read_b64_tr_b16 v[118:119], v11 offset:49152
    v_mfma_f32_16x16x32_bf16 v[144:147], v[64:67], v[40:43], v[144:147]
    ds_read_b64_tr_b16 v[120:121], v8 offset:57344
    v_mfma_f32_16x16x32_bf16 v[148:151], v[68:71], v[40:43], v[148:151]
    ds_read_b64_tr_b16 v[122:123], v9 offset:57344
    v_mfma_f32_16x16x32_bf16 v[152:155], v[72:75], v[40:43], v[152:155]
    ds_read_b64_tr_b16 v[124:125], v10 offset:57344
    v_mfma_f32_16x16x32_bf16 v[156:159], v[76:79], v[40:43], v[156:159]
    ds_read_b64_tr_b16 v[126:127], v11 offset:57344
    v_mfma_f32_16x16x32_bf16 v[160:163], v[64:67], v[48:51], v[160:163]
    ds_read_b128 v[80:83], v5 offset:32768
    v_mfma_f32_16x16x32_bf16 v[164:167], v[68:71], v[48:51], v[164:167]
    ds_read_b128 v[88:91], v5 offset:34816
    v_mfma_f32_16x16x32_bf16 v[168:171], v[72:75], v[48:51], v[168:171]
    ds_read_b128 v[96:99], v5 offset:36864
    v_mfma_f32_16x16x32_bf16 v[172:175], v[76:79], v[48:51], v[172:175]
    ds_read_b128 v[104:107], v5 offset:38912
    v_mfma_f32_16x16x32_bf16 v[176:179], v[64:67], v[56:59], v[176:179]
    v_mfma_f32_16x16x32_bf16 v[180:183], v[68:71], v[56:59], v[180:183]
    v_mfma_f32_16x16x32_bf16 v[184:187], v[72:75], v[56:59], v[184:187]
    v_mfma_f32_16x16x32_bf16 v[188:191], v[76:79], v[56:59], v[188:191]
    s_waitcnt lgkmcnt(0)
    s_waitcnt vmcnt(7)
    s_barrier
    s_add_u32 m0, s21, 32768
    s_nop 0
    buffer_load_dwordx4 v1, s[4:7], s16 offen sc1 lds
    s_add_u32 s16, s16, s62
    s_add_u32 m0, s21, 33792
    s_nop 0
    buffer_load_dwordx4 v1, s[4:7], s17 offen sc1 lds
    s_add_u32 s17, s17, s62
    s_add_u32 m0, s22, 32768
    s_nop 0
    buffer_load_dwordx4 v2, s[8:11], s18 offen lds
    s_add_u32 s18, s18, s20
    s_add_u32 m0, s22, 40960
    s_nop 0
    buffer_load_dwordx4 v2, s[12:15], s19 offen lds
    s_add_u32 s19, s19, s20
    v_mfma_f32_16x16x32_bf16 v[128:131], v[112:115], v[80:83], v[128:131]
    ds_read_b64_tr_b16 v[64:65], v12 offset:16384
    v_mfma_f32_16x16x32_bf16 v[132:135], v[116:119], v[80:83], v[132:135]
    ds_read_b64_tr_b16 v[66:67], v13 offset:16384
    v_mfma_f32_16x16x32_bf16 v[136:139], v[120:123], v[80:83], v[136:139]
    ds_read_b64_tr_b16 v[68:69], v14 offset:16384
    v_mfma_f32_16x16x32_bf16 v[140:143], v[124:127], v[80:83], v[140:143]
    ds_read_b64_tr_b16 v[70:71], v15 offset:16384
    v_mfma_f32_16x16x32_bf16 v[144:147], v[112:115], v[88:91], v[144:147]
    ds_read_b64_tr_b16 v[72:73], v12 offset:24576
    v_mfma_f32_16x16x32_bf16 v[148:151], v[116:119], v[88:91], v[148:151]
    ds_read_b64_tr_b16 v[74:75], v13 offset:24576
    v_mfma_f32_16x16x32_bf16 v[152:155], v[120:123], v[88:91], v[152:155]
    ds_read_b64_tr_b16 v[76:77], v14 offset:24576
    v_mfma_f32_16x16x32_bf16 v[156:159], v[124:127], v[88:91], v[156:159]
    ds_read_b64_tr_b16 v[78:79], v15 offset:24576
    v_mfma_f32_16x16x32_bf16 v[160:163], v[112:115], v[96:99], v[160:163]
    ds_read_b128 v[32:35], v6 offset:0
    v_mfma_f32_16x16x32_bf16 v[164:167], v[116:119], v[96:99], v[164:167]
    ds_read_b128 v[40:43], v6 offset:2048
    v_mfma_f32_16x16x32_bf16 v[168:171], v[120:123], v[96:99], v[168:171]
    ds_read_b128 v[48:51], v6 offset:4096
    v_mfma_f32_16x16x32_bf16 v[172:175], v[124:127], v[96:99], v[172:175]
    ds_read_b128 v[56:59], v6 offset:6144
    v_mfma_f32_16x16x32_bf16 v[176:179], v[112:115], v[104:107], v[176:179]
    v_mfma_f32_16x16x32_bf16 v[180:183], v[116:119], v[104:107], v[180:183]
    v_mfma_f32_16x16x32_bf16 v[184:187], v[120:123], v[104:107], v[184:187]
    v_mfma_f32_16x16x32_bf16 v[188:191], v[124:127], v[104:107], v[188:191]
    s_waitcnt lgkmcnt(0)
    s_waitcnt vmcnt(8)
    s_barrier
    s_add_u32 m0, s21, 65536
    s_nop 0
    buffer_load_dwordx4 v1, s[4:7], s16 offen sc1 lds
    s_add_u32 s16, s16, s62
    s_add_u32 m0, s21, 66560
    s_nop 0
    buffer_load_dwordx4 v1, s[4:7], s17 offen sc1 lds
    s_add_u32 s17, s17, s62
    s_add_u32 m0, s22, 65536
    s_nop 0
    buffer_load_dwordx4 v2, s[8:11], s18 offen lds
    s_add_u32 s18, s18, s20
    s_add_u32 m0, s22, 73728
    s_nop 0
    buffer_load_dwordx4 v2, s[12:15], s19 offen lds
    s_add_u32 s19, s19, s20
    v_mfma_f32_16x16x32_bf16 v[128:131], v[64:67], v[32:35], v[128:131]
    ds_read_b64_tr_b16 v[112:113], v12 offset:49152
    v_mfma_f32_16x16x32_bf16 v[132:135], v[68:71], v[32:35], v[132:135]
    ds_read_b64_tr_b16 v[114:115], v13 offset:49152
    v_mfma_f32_16x16x32_bf16 v[136:139], v[72:75], v[32:35], v[136:139]
    ds_read_b64_tr_b16 v[116:117], v14 offset:49152
    v_mfma_f32_16x16x32_bf16 v[140:143], v[76:79], v[32:35], v[140:143]
    ds_read_b64_tr_b16 v[118:119], v15 offset:49152
    v_mfma_f32_16x16x32_bf16 v[144:147], v[64:67], v[40:43], v[144:147]
    ds_read_b64_tr_b16 v[120:121], v12 offset:57344
    v_mfma_f32_16x16x32_bf16 v[148:151], v[68:71], v[40:43], v[148:151]
    ds_read_b64_tr_b16 v[122:123], v13 offset:57344
    v_mfma_f32_16x16x32_bf16 v[152:155], v[72:75], v[40:43], v[152:155]
    ds_read_b64_tr_b16 v[124:125], v14 offset:57344
    v_mfma_f32_16x16x32_bf16 v[156:159], v[76:79], v[40:43], v[156:159]
    ds_read_b64_tr_b16 v[126:127], v15 offset:57344
    v_mfma_f32_16x16x32_bf16 v[160:163], v[64:67], v[48:51], v[160:163]
    ds_read_b128 v[80:83], v6 offset:32768
    v_mfma_f32_16x16x32_bf16 v[164:167], v[68:71], v[48:51], v[164:167]
    ds_read_b128 v[88:91], v6 offset:34816
    v_mfma_f32_16x16x32_bf16 v[168:171], v[72:75], v[48:51], v[168:171]
    ds_read_b128 v[96:99], v6 offset:36864
    v_mfma_f32_16x16x32_bf16 v[172:175], v[76:79], v[48:51], v[172:175]
    ds_read_b128 v[104:107], v6 offset:38912
    v_mfma_f32_16x16x32_bf16 v[176:179], v[64:67], v[56:59], v[176:179]
    v_mfma_f32_16x16x32_bf16 v[180:183], v[68:71], v[56:59], v[180:183]
    v_mfma_f32_16x16x32_bf16 v[184:187], v[72:75], v[56:59], v[184:187]
    v_mfma_f32_16x16x32_bf16 v[188:191], v[76:79], v[56:59], v[188:191]
    s_waitcnt lgkmcnt(0)
    s_waitcnt vmcnt(8)
    s_barrier
    s_add_u32 m0, s21, 98304
    s_nop 0
    buffer_load_dwordx4 v1, s[4:7], s16 offen sc1 lds
    s_add_u32 s16, s16, s62
    s_add_u32 m0, s21, 99328
    s_nop 0
    buffer_load_dwordx4 v1, s[4:7], s17 offen sc1 lds
    s_add_u32 s17, s17, s62
    s_add_u32 m0, s22, 98304
    s_nop 0
    buffer_load_dwordx4 v2, s[8:11], s18 offen lds
    s_add_u32 s18, s18, s20
    s_add_u32 m0, s22, 106496
    s_nop 0
    buffer_load_dwordx4 v2, s[12:15], s19 offen lds
    s_add_u32 s19, s19, s20
    v_mfma_f32_16x16x32_bf16 v[128:131], v[112:115], v[80:83], v[128:131]
    ds_read_b64_tr_b16 v[64:65], v8 offset:16384
    v_mfma_f32_16x16x32_bf16 v[132:135], v[116:119], v[80:83], v[132:135]
    ds_read_b64_tr_b16 v[66:67], v9 offset:16384
    v_mfma_f32_16x16x32_bf16 v[136:139], v[120:123], v[80:83], v[136:139]
    ds_read_b64_tr_b16 v[68:69], v10 offset:16384
    v_mfma_f32_16x16x32_bf16 v[140:143], v[124:127], v[80:83], v[140:143]
    ds_read_b64_tr_b16 v[70:71], v11 offset:16384
    v_mfma_f32_16x16x32_bf16 v[144:147], v[112:115], v[88:91], v[144:147]
    ds_read_b64_tr_b16 v[72:73], v8 offset:24576
    v_mfma_f32_16x16x32_bf16 v[148:151], v[116:119], v[88:91], v[148:151]
    ds_read_b64_tr_b16 v[74:75], v9 offset:24576
    v_mfma_f32_16x16x32_bf16 v[152:155], v[120:123], v[88:91], v[152:155]
    ds_read_b64_tr_b16 v[76:77], v10 offset:24576
    v_mfma_f32_16x16x32_bf16 v[156:159], v[124:127], v[88:91], v[156:159]
    ds_read_b64_tr_b16 v[78:79], v11 offset:24576
    v_mfma_f32_16x16x32_bf16 v[160:163], v[112:115], v[96:99], v[160:163]
    ds_read_b128 v[32:35], v5 offset:0
    v_mfma_f32_16x16x32_bf16 v[164:167], v[116:119], v[96:99], v[164:167]
    ds_read_b128 v[36:39], v5 offset:1024
    v_mfma_f32_16x16x32_bf16 v[168:171], v[120:123], v[96:99], v[168:171]
    ds_read_b128 v[40:43], v5 offset:2048
    v_mfma_f32_16x16x32_bf16 v[172:175], v[124:127], v[96:99], v[172:175]
    ds_read_b128 v[44:47], v5 offset:3072
    v_mfma_f32_16x16x32_bf16 v[176:179], v[112:115], v[104:107], v[176:179]
    ds_read_b128 v[48:51], v5 offset:4096
    v_mfma_f32_16x16x32_bf16 v[180:183], v[116:119], v[104:107], v[180:183]
    ds_read_b128 v[52:55], v5 offset:5120
    v_mfma_f32_16x16x32_bf16 v[184:187], v[120:123], v[104:107], v[184:187]
    ds_read_b128 v[56:59], v5 offset:6144
    v_mfma_f32_16x16x32_bf16 v[188:191], v[124:127], v[104:107], v[188:191]
    ds_read_b128 v[60:63], v5 offset:7168
    s_waitcnt lgkmcnt(0)
    s_branch w_doneM
w_bodyM:
    buffer_load_dword v22, off, s[64:67], 0 sc1
    s_waitcnt vmcnt(6)
    s_barrier
    s_add_u32 m0, s21, 0
    s_nop 0
    buffer_load_dwordx4 v1, s[4:7], s16 offen sc1 lds
    s_add_u32 s16, s16, s62
    s_add_u32 m0, s22, 0
    s_nop 0
    buffer_load_dwordx4 v2, s[8:11], s18 offen lds
    s_add_u32 s18, s18, s20
    s_add_u32 m0, s22, 8192
    s_nop 0
    buffer_load_dwordx4 v2, s[12:15], s19 offen lds
    s_add_u32 s19, s19, s20
    v_mfma_f32_16x16x32_bf16 v[128:131], v[64:67], v[32:35], v[128:131]
    ds_read_b64_tr_b16 v[112:113], v8 offset:49152
    v_mfma_f32_16x16x32_bf16 v[132:135], v[68:71], v[32:35], v[132:135]
    ds_read_b64_tr_b16 v[114:115], v9 offset:49152
    v_mfma_f32_16x16x32_bf16 v[136:139], v[72:75], v[32:35], v[136:139]
    ds_read_b64_tr_b16 v[116:117], v10 offset:49152
    v_mfma_f32_16x16x32_bf16 v[140:143], v[76:79], v[32:35], v[140:143]
    ds_read_b64_tr_b16 v[118:119], v11 offset:49152
    v_mfma_f32_16x16x32_bf16 v[144:147], v[64:67], v[40:43], v[144:147]
    ds_read_b64_tr_b16 v[120:121], v8 offset:57344
    v_mfma_f32_16x16x32_bf16 v[148:151], v[68:71], v[40:43], v[148:151]
    ds_read_b64_tr_b16 v[122:123], v9 offset:57344
    v_mfma_f32_16x16x32_bf16 v[152:155], v[72:75], v[40:43], v[152:155]
    ds_read_b64_tr_b16 v[124:125], v10 offset:57344
    v_mfma_f32_16x16x32_bf16 v[156:159], v[76:79], v[40:43], v[156:159]
    ds_read_b64_tr_b16 v[126:127], v11 offset:57344
    v_mfma_f32_16x16x32_bf16 v[160:163], v[64:67], v[48:51], v[160:163]
    ds_read_b128 v[80:83], v5 offset:32768
    v_mfma_f32_16x16x32_bf16 v[164:167], v[68:71], v[48:51], v[164:167]
    ds_read_b128 v[88:91], v5 offset:34816
    v_mfma_f32_16x16x32_bf16 v[168:171], v[72:75], v[48:51], v[168:171]
    ds_read_b128 v[96:99], v5 offset:36864
    v_mfma_f32_16x16x32_bf16 v[172:175], v[76:79], v[48:51], v[172:175]
    ds_read_b128 v[104:107], v5 offset:38912
    v_mfma_f32_16x16x32_bf16 v[176:179], v[64:67], v[56:59], v[176:179]
    v_mfma_f32_16x16x32_bf16 v[180:183], v[68:71], v[56:59], v[180:183]
    v_mfma_f32_16x16x32_bf16 v[184:187], v[72:75], v[56:59], v[184:187]
    v_mfma_f32_16x16x32_bf16 v[188:191], v[76:79], v[56:59], v[188:191]
    buffer_load_dword v16, v17, s[4:7], s44 offen sc1
    s_waitcnt lgkmcnt(0)
    s_waitcnt vmcnt(6)
    s_barrier
    s_add_u32 m0, s21, 32768
    s_nop 0
    buffer_load_dwordx4 v1, s[4:7], s16 offen sc1 lds
    s_add_u32 s16, s16, s62
    s_add_u32 m0, s22, 32768
    s_nop 0
    buffer_load_dwordx4 v2, s[8:11], s18 offen lds
    s_add_u32 s18, s18, s20
    s_add_u32 m0, s22, 40960
    s_nop 0
    buffer_load_dwordx4 v2, s[12:15], s19 offen lds
    s_add_u32 s19, s19, s20
    v_mfma_f32_16x16x32_bf16 v[128:131], v[112:115], v[80:83], v[128:131]
    ds_read_b64_tr_b16 v[64:65], v12 offset:16384
    v_mfma_f32_16x16x32_bf16 v[132:135], v[116:119], v[80:83], v[132:135]
    ds_read_b64_tr_b16 v[66:67], v13 offset:16384
    v_mfma_f32_16x16x32_bf16 v[136:139], v[120:123], v[80:83], v[136:139]
    ds_read_b64_tr_b16 v[68:69], v14 offset:16384
    v_mfma_f32_16x16x32_bf16 v[140:143], v[124:127], v[80:83], v[140:143]
    ds_read_b64_tr_b16 v[70:71], v15 offset:16384
    v_mfma_f32_16x16x32_bf16 v[144:147], v[112:115], v[88:91], v[144:147]
    ds_read_b64_tr_b16 v[72:73], v12 offset:24576
    v_mfma_f32_16x16x32_bf16 v[148:151], v[116:119], v[88:91], v[148:151]
    ds_read_b64_tr_b16 v[74:75], v13 offset:24576
    v_mfma_f32_16x16x32_bf16 v[152:155], v[120:123], v[88:91], v[152:155]
    ds_read_b64_tr_b16 v[76:77], v14 offset:24576
    v_mfma_f32_16x16x32_bf16 v[156:159], v[124:127], v[88:91], v[156:159]
    ds_read_b64_tr_b16 v[78:79], v15 offset:24576
    v_mfma_f32_16x16x32_bf16 v[160:163], v[112:115], v[96:99], v[160:163]
    ds_read_b128 v[32:35], v6 offset:0
    v_mfma_f32_16x16x32_bf16 v[164:167], v[116:119], v[96:99], v[164:167]
    ds_read_b128 v[40:43], v6 offset:2048
    v_mfma_f32_16x16x32_bf16 v[168:171], v[120:123], v[96:99], v[168:171]
    ds_read_b128 v[48:51], v6 offset:4096
    v_mfma_f32_16x16x32_bf16 v[172:175], v[124:127], v[96:99], v[172:175]
    ds_read_b128 v[56:59], v6 offset:6144
    v_mfma_f32_16x16x32_bf16 v[176:179], v[112:115], v[104:107], v[176:179]
    v_mfma_f32_16x16x32_bf16 v[180:183], v[116:119], v[104:107], v[180:183]
    v_mfma_f32_16x16x32_bf16 v[184:187], v[120:123], v[104:107], v[184:187]
    v_mfma_f32_16x16x32_bf16 v[188:191], v[124:127], v[104:107], v[188:191]
    s_waitcnt lgkmcnt(0)
    s_waitcnt vmcnt(6)
    s_barrier
    s_add_u32 m0, s21, 65536
    s_nop 0
    buffer_load_dwordx4 v1, s[4:7], s16 offen sc1 lds
    s_add_u32 s16, s16, s62
    s_add_u32 m0, s22, 65536
    s_nop 0
    buffer_load_dwordx4 v2, s[8:11], s18 offen lds
    s_add_u32 s18, s18, s20
    s_add_u32 m0, s22, 73728
    s_nop 0
    buffer_load_dwordx4 v2, s[12:15], s19 offen lds
    s_add_u32 s19, s19, s20
    v_mfma_f32_16x16x32_bf16 v[128:131], v[64:67], v[32:35], v[128:131]
    ds_read_b64_tr_b16 v[112:113], v12 offset:49152
    v_mfma_f32_16x16x32_bf16 v[132:135], v[68:71], v[32:35], v[132:135]
    ds_read_b64_tr_b16 v[114:115], v13 offset:49152
    v_mfma_f32_16x16x32_bf16 v[136:139], v[72:75], v[32:35], v[136:139]
    ds_read_b64_tr_b16 v[116:117], v14 offset:49152
    v_mfma_f32_16x16x32_bf16 v[140:143], v[76:79], v[32:35], v[140:143]
    ds_read_b64_tr_b16 v[118:119], v15 offset:49152
    v_mfma_f32_16x16x32_bf16 v[144:147], v[64:67], v[40:43], v[144:147]
    ds_read_b64_tr_b16 v[120:121], v12 offset:57344
    v_mfma_f32_16x16x32_bf16 v[148:151], v[68:71], v[40:43], v[148:151]
    ds_read_b64_tr_b16 v[122:123], v13 offset:57344
    v_mfma_f32_16x16x32_bf16 v[152:155], v[72:75], v[40:43], v[152:155]
    ds_read_b64_tr_b16 v[124:125], v14 offset:57344
    v_mfma_f32_16x16x32_bf16 v[156:159], v[76:79], v[40:43], v[156:159]
    ds_read_b64_tr_b16 v[126:127], v15 offset:57344
    v_mfma_f32_16x16x32_bf16 v[160:163], v[64:67], v[48:51], v[160:163]
    ds_read_b128 v[80:83], v6 offset:32768
    v_mfma_f32_16x16x32_bf16 v[164:167], v[68:71], v[48:51], v[164:167]
    ds_read_b128 v[88:91], v6 offset:34816
    v_mfma_f32_16x16x32_bf16 v[168:171], v[72:75], v[48:51], v[168:171]
    ds_read_b128 v[96:99], v6 offset:36864
    v_mfma_f32_16x16x32_bf16 v[172:175], v[76:79], v[48:51], v[172:175]
    ds_read_b128 v[104:107], v6 offset:38912
    v_mfma_f32_16x16x32_bf16 v[176:179], v[64:67], v[56:59], v[176:179]
    v_mfma_f32_16x16x32_bf16 v[180:183], v[68:71], v[56:59], v[180:183]
    v_mfma_f32_16x16x32_bf16 v[184:187], v[72:75], v[56:59], v[184:187]
    v_mfma_f32_16x16x32_bf16 v[188:191], v[76:79], v[56:59], v[188:191]
    s_waitcnt lgkmcnt(0)
    s_waitcnt vmcnt(6)
    s_barrier
    s_add_u32 m0, s21, 98304
    s_nop 0
    buffer_load_dwordx4 v1, s[4:7], s16 offen sc1 lds
    s_add_u32 s16, s16, s62
    s_add_u32 m0, s22, 98304
    s_nop 0
    buffer_load_dwordx4 v2, s[8:11], s18 offen lds
    s_add_u32 s18, s18, s20
    s_add_u32 m0, s22, 106496
    s_nop 0
    buffer_load_dwordx4 v2, s[12:15], s19 offen lds
    s_add_u32 s19, s19, s20
    v_mfma_f32_16x16x32_bf16 v[128:131], v[112:115], v[80:83], v[128:131]
    ds_read_b64_tr_b16 v[64:65], v8 offset:16384
    v_mfma_f32_16x16x32_bf16 v[132:135], v[116:119], v[80:83], v[132:135]
    ds_read_b64_tr_b16 v[66:67], v9 offset:16384
    v_mfma_f32_16x16x32_bf16 v[136:139], v[120:123], v[80:83], v[136:139]
    ds_read_b64_tr_b16 v[68:69], v10 offset:16384
    v_mfma_f32_16x16x32_bf16 v[140:143], v[124:127], v[80:83], v[140:143]
    ds_read_b64_tr_b16 v[70:71], v11 offset:16384
    v_mfma_f32_16x16x32_bf16 v[144:147], v[112:115], v[88:91], v[144:147]
    ds_read_b64_tr_b16 v[72:73], v8 offset:24576
    v_mfma_f32_16x16x32_bf16 v[148:151], v[116:119], v[88:91], v[148:151]
    ds_read_b64_tr_b16 v[74:75], v9 offset:24576
    v_mfma_f32_16x16x32_bf16 v[152:155], v[120:123], v[88:91], v[152:155]
    ds_read_b64_tr_b16 v[76:77], v10 offset:24576
    v_mfma_f32_16x16x32_bf16 v[156:159], v[124:127], v[88:91], v[156:159]
    ds_read_b64_tr_b16 v[78:79], v11 offset:24576
    v_mfma_f32_16x16x32_bf16 v[160:163], v[112:115], v[96:99], v[160:163]
    ds_read_b128 v[32:35], v5 offset:0
    v_mfma_f32_16x16x32_bf16 v[164:167], v[116:119], v[96:99], v[164:167]
    ds_read_b128 v[40:43], v5 offset:2048
    v_mfma_f32_16x16x32_bf16 v[168:171], v[120:123], v[96:99], v[168:171]
    ds_read_b128 v[48:51], v5 offset:4096
    v_mfma_f32_16x16x32_bf16 v[172:175], v[124:127], v[96:99], v[172:175]
    ds_read_b128 v[56:59], v5 offset:6144
    v_mfma_f32_16x16x32_bf16 v[176:179], v[112:115], v[104:107], v[176:179]
    v_mfma_f32_16x16x32_bf16 v[180:183], v[116:119], v[104:107], v[180:183]
    v_mfma_f32_16x16x32_bf16 v[184:187], v[120:123], v[104:107], v[184:187]
    v_mfma_f32_16x16x32_bf16 v[188:191], v[124:127], v[104:107], v[188:191]
    s_waitcnt lgkmcnt(0)
    s_sub_u32 s23, s23, 1
    s_cmp_lg_u32 s23, 0
    s_cbranch_scc1 w_loopM
w_doneM:
    v_mov_b32 v20, 131072
    ds_read_b128 v[24:27], v20
    ds_read_b128 v[28:31], v20 offset:16
    s_lshl_b32 s30, s27, 10
    s_add_u32 s30, s30, s49
    s_nop 7
    v_cvt_pk_bf16_f32 v80, v128, v129
    v_cvt_pk_bf16_f32 v81, v130, v131
    v_cvt_pk_bf16_f32 v82, v132, v133
    v_cvt_pk_bf16_f32 v83, v134, v135
    buffer_store_dwordx4 v[80:83], v1, s[4:7], s30 offen sc1
    v_cvt_pk_bf16_f32 v84, v136, v137
    v_cvt_pk_bf16_f32 v85, v138, v139
    v_cvt_pk_bf16_f32 v86, v140, v141
    v_cvt_pk_bf16_f32 v87, v142, v143
    buffer_store_dwordx4 v[84:87], v19, s[4:7], s30 offen sc1
    s_add_u32 s30, s30, s50
    v_cvt_pk_bf16_f32 v88, v144, v145
    v_cvt_pk_bf16_f32 v89, v146, v147
    v_cvt_pk_bf16_f32 v90, v148, v149
    v_cvt_pk_bf16_f32 v91, v150, v151
    buffer_store_dwordx4 v[88:91], v1, s[4:7], s30 offen sc1
    v_cvt_pk_bf16_f32 v92, v152, v153
    v_cvt_pk_bf16_f32 v93, v154, v155
    v_cvt_pk_bf16_f32 v94, v156, v157
    v_cvt_pk_bf16_f32 v95, v158, v159
    buffer_store_dwordx4 v[92:95], v19, s[4:7], s30 offen sc1
    s_add_u32 s30, s30, s50
    v_cvt_pk_bf16_f32 v80, v160, v161
    v_cvt_pk_bf16_f32 v81, v162, v163
    v_cvt_pk_bf16_f32 v82, v164, v165
    v_cvt_pk_bf16_f32 v83, v166, v167
    buffer_store_dwordx4 v[80:83], v1, s[4:7], s30 offen sc1
    v_cvt_pk_bf16_f32 v84, v168, v169
    v_cvt_pk_bf16_f32 v85, v170, v171
    v_cvt_pk_bf16_f32 v86, v172, v173
    v_cvt_pk_bf16_f32 v87, v174, v175
    buffer_store_dwordx4 v[84:87], v19, s[4:7], s30 offen sc1
    s_add_u32 s30, s30, s50
    v_cvt_pk_bf16_f32 v88, v176, v177
    v_cvt_pk_bf16_f32 v89, v178, v179
    v_cvt_pk_bf16_f32 v90, v180, v181
    v_cvt_pk_bf16_f32 v91, v182, v183
    buffer_store_dwordx4 v[88:91], v1, s[4:7], s30 offen sc1
    v_cvt_pk_bf16_f32 v92, v184, v185
    v_cvt_pk_bf16_f32 v93, v186, v187
    v_cvt_pk_bf16_f32 v94, v188, v189
    v_cvt_pk_bf16_f32 v95, v190, v191
    buffer_store_dwordx4 v[92:95], v19, s[4:7], s30 offen sc1
    s_add_u32 s30, s30, s50
    s_waitcnt lgkmcnt(0)
    v_or3_b32 v24, v24, v25, v26
    v_or3_b32 v28, v28, v29, v30
    v_or3_b32 v24, v24, v27, v31
    v_or_b32 v24, v24, v28
    s_mov_b32 s28, s51
    s_mov_b32 s57, s53
    v_readfirstlane_b32 s30, v24
    s_cmp_lg_u32 s30, 0
    s_cbranch_scc1 w_drain
    s_mov_b32 s48, s32
    s_cmp_ge_u32 s32, 4
    s_cselect_b32 s30, 2, 3
    s_lshl_b32 s30, s26, s30
    s_mul_i32 s30, s30, s43
    s_add_u32 s49, s42, s30
    s_mov_b32 s50, s43
    s_mov_b32 s51, s46
    s_mov_b32 s23, s41
    s_mov_b32 s53, s47
    s_nop 0
    s_load_dwordx16 s[32:47], s[24:25], 0
    s_add_u32 s24, s24, 64
    s_addc_u32 s25, s25, 0
    s_branch w_first8
w_drain:
    s_waitcnt vmcnt(0)
    s_barrier
    s_cmp_eq_u32 s28, 0
    s_cbranch_scc1 sig_5
    s_cmp_lg_u32 s3, 0
    s_cbranch_scc1 sig_5
    s_mov_b64 exec, 1
    v_mov_b32 v18, s57
    buffer_atomic_add v18, v17, s[4:7], s28 offen sc1
    s_mov_b64 exec, -1
sig_5:
    s_mov_b32 s28, 0
    s_cmp_eq_u32 s98, 3
    s_cselect_b32 s98, 1, s98
w_hook:
    s_cmp_eq_u32 s70, 0
    s_cbranch_scc1 drw_ok
    s_cmp_lt_u32 s39, 1048576
    s_cbranch_scc1 drw_ok
    s_mov_b32 s70, 0
    s_cmp_lg_u32 s3, 0
    s_cbranch_scc1 drw_ok
    v_readfirstlane_b32 s68, v22
    s_cmp_ge_u32 s68, 128
    s_cbranch_scc1 drw_ok
    s_mov_b32 s69, 65536
drw:
    buffer_load_dword v20, off, s[64:67], 0 offset:0 sc1
    s_waitcnt vmcnt(0)
    v_readfirstlane_b32 s68, v20
    s_cmp_ge_u32 s68, 128
    s_cbranch_scc1 drw_ok
    s_sleep 8
    s_sub_u32 s69, s69, 1
    s_cbranch_scc0 drw
drw_ok:
    s_branch w_cold
fin_entry:
    s_load_dwordx2 s[8:9], s[0:1], 0
    s_load_dwordx2 s[12:13], s[0:1], 88
    v_mbcnt_lo_u32_b32 v1, -1, 0
    v_mbcnt_hi_u32_b32 v1, -1, v1
    s_mov_b32 s10, 4194304
    s_mov_b32 s11, 131072
    s_mov_b32 s14, 4194304
    s_mov_b32 s15, 131072
    v_lshlrev_b32 v3, 4, v1
    v_and_b32 v4, 15, v1
    v_lshrrev_b32 v5, 4, v1
    v_lshlrev_b32 v4, 11, v4
    v_lshl_add_u32 v4, v5, 4, v4
    v_and_b32 v5, 1, v5
    v_cmp_eq_u32 s[20:21], 1, v5
    v_and_b32 v6, 7, v1
    v_lshlrev_b32 v6, 7, v6
    s_lshr_b32 s24, s63, 2
    s_and_b32 s25, s63, 3
    s_lshl_b32 s25, s25, 2
    s_and_b32 s26, s3, 3
    s_add_u32 s25, s25, s26
    s_lshr_b32 s26, s3, 2
    s_mov_b32 s28, 65536
    s_waitcnt lgkmcnt(0)
fin_job:
    s_lshl_b32 s16, s24, 1
    s_add_u32 s16, s16, s26
    s_lshl_b32 s18, s16, 15
    s_lshl_b32 s17, s25, 11
    s_add_u32 s17, s17, s18
    s_lshl_b32 s19, s25, 7
    s_add_u32 s18, s18, s19
    s_add_u32 s22, s17, 167772160
    s_add_u32 s23, s17, 75497472
    s_lshr_b32 s27, s24, 3
    s_lshl_b32 s27, s27, 6
    s_add_u32 s27, s27, 218106368
    s_cmp_ge_u32 s24, 64
    s_cselect_b32 s29, 16, 16
    s_mov_b32 s30, 218112000
    s_add_u32 s32, s24, 1
    s_mov_b32 s33, 0
    s_mov_b32 s34, 255
    s_cmp_lt_u32 s24, 62
    s_cbranch_scc1 fin_tg
    s_mov_b32 s32, 16
    s_add_u32 s30, s30, 4
    s_sub_u32 s33, s24, 62
    s_lshl_b32 s33, s33, 3
fin_tg:
    s_mul_i32 s35, s24, 3
    s_lshr_b32 s35, s35, 4
    s_add_u32 s35, s35, 49
    s_min_u32 s35, s35, 61
    s_max_u32 s32, s32, s35
    buffer_load_dwordx4 v[88:91], v4, s[8:11], s18 offen offset:0
    buffer_load_dwordx4 v[92:95], v4, s[8:11], s18 offen offset:64
    s_cmp_lg_u32 s3, 0
    s_cbranch_scc1 fin_ws_ok
fin_wd:
    buffer_load_dword v7, off, s[4:7], s27 sc1
    s_waitcnt vmcnt(0)
    v_readfirstlane_b32 s31, v7
    s_cmp_ge_u32 s31, s29
    s_cbranch_scc1 fin_wd_ok
    s_sleep 127
    s_sub_u32 s28, s28, 1
    s_cbranch_scc0 fin_wd
    s_mov_b32 s28, 0
fin_wd_ok:
fin_ws:
    buffer_load_dword v7, v6, s[4:7], s30 offen sc1
    s_waitcnt vmcnt(0)
    v_lshrrev_b32 v7, s33, v7
    v_and_b32 v7, s34, v7
    v_cmp_gt_u32 vcc, s32, v7
    s_cbranch_vccz fin_ws_ok
    s_sleep 12
    v_add_u32 v7, 1, v7
    v_cmp_gt_u32 vcc, s32, v7
    s_cbranch_vccz fin_ws_f
    s_sleep 48
    v_add_u32 v7, 3, v7
    v_cmp_gt_u32 vcc, s32, v7
    s_cbranch_vccz fin_ws_f
    s_sleep 127
    s_sleep 127
fin_ws_f:
    s_sub_u32 s28, s28, 1
    s_cbranch_scc0 fin_ws
    s_mov_b32 s28, 0
fin_ws_ok:
    s_barrier
    buffer_load_dwordx4 v[144:147], v3, s[4:7], s22 offen offset:0 sc1
    buffer_load_dwordx4 v[160:163], v3, s[4:7], s22 offen offset:1024 sc1
    s_add_u32 s22, s22, 4194304
    buffer_load_dwordx4 v[148:151], v3, s[4:7], s22 offen offset:0 sc1
    buffer_load_dwordx4 v[164:167], v3, s[4:7], s22 offen offset:1024 sc1
    s_add_u32 s22, s22, 4194304
    buffer_load_dwordx4 v[152:155], v3, s[4:7], s22 offen offset:0 sc1
    buffer_load_dwordx4 v[168:171], v3, s[4:7], s22 offen offset:1024 sc1
    s_add_u32 s22, s22, 4194304
    buffer_load_dwordx4 v[156:159], v3, s[4:7], s22 offen offset:0 sc1
    buffer_load_dwordx4 v[172:175], v3, s[4:7], s22 offen offset:1024 sc1
    buffer_load_dwordx4 v[16:19], v3, s[4:7], s23 offen offset:0 sc1
    buffer_load_dwordx4 v[48:51], v3, s[4:7], s23 offen offset:1024 sc1
    s_add_u32 s23, s23, 4194304
    buffer_load_dwordx4 v[20:23], v3, s[4:7], s23 offen offset:0 sc1
    buffer_load_dwordx4 v[52:55], v3, s[4:7], s23 offen offset:1024 sc1
    s_add_u32 s23, s23, 4194304
    buffer_load_dwordx4 v[24:27], v3, s[4:7], s23 offen offset:0 sc1
    buffer_load_dwordx4 v[56:59], v3, s[4:7], s23 offen offset:1024 sc1
    s_add_u32 s23, s23, 4194304
    buffer_load_dwordx4 v[28:31], v3, s[4:7], s23 offen offset:0 sc1
    buffer_load_dwordx4 v[60:63], v3, s[4:7], s23 offen offset:1024 sc1
    s_add_u32 s23, s23, 4194304
    buffer_load_dwordx4 v[32:35], v3, s[4:7], s23 offen offset:0 sc1
    buffer_load_dwordx4 v[64:67], v3, s[4:7], s23 offen offset:1024 sc1
    s_add_u32 s23, s23, 4194304
    buffer_load_dwordx4 v[36:39], v3, s[4:7], s23 offen offset:0 sc1
    buffer_load_dwordx4 v[68:71], v3, s[4:7], s23 offen offset:1024 sc1
    s_add_u32 s23, s23, 4194304
    buffer_load_dwordx4 v[40:43], v3, s[4:7], s23 offen offset:0 sc1
    buffer_load_dwordx4 v[72:75], v3, s[4:7], s23 offen offset:1024 sc1
    s_add_u32 s23, s23, 4194304
    buffer_load_dwordx4 v[44:47], v3, s[4:7], s23 offen offset:0 sc1
    buffer_load_dwordx4 v[76:79], v3, s[4:7], s23 offen offset:1024 sc1
    s_add_u32 s23, s23, 4194304
    s_waitcnt vmcnt(16)
    v_lshlrev_b32 v96, 16, v144
    v_and_b32 v97, 0xffff0000, v144
    v_lshlrev_b32 v98, 16, v145
    v_and_b32 v99, 0xffff0000, v145
    v_lshlrev_b32 v100, 16, v146
    v_and_b32 v101, 0xffff0000, v146
    v_lshlrev_b32 v102, 16, v147
    v_and_b32 v103, 0xffff0000, v147
    v_lshlrev_b32 v120, 16, v148
    v_and_b32 v121, 0xffff0000, v148
    v_lshlrev_b32 v122, 16, v149
    v_and_b32 v123, 0xffff0000, v149
    v_lshlrev_b32 v124, 16, v150
    v_and_b32 v125, 0xffff0000, v150
    v_lshlrev_b32 v126, 16, v151
    v_and_b32 v127, 0xffff0000, v151
    v_add_f32 v96, v96, v120
    v_add_f32 v97, v97, v121
    v_add_f32 v98, v98, v122
    v_add_f32 v99, v99, v123
    v_add_f32 v100, v100, v124
    v_add_f32 v101, v101, v125
    v_add_f32 v102, v102, v126
    v_add_f32 v103, v103, v127
    v_lshlrev_b32 v120, 16, v152
    v_and_b32 v121, 0xffff0000, v152
    v_lshlrev_b32 v122, 16, v153
    v_and_b32 v123, 0xffff0000, v153
    v_lshlrev_b32 v124, 16, v154
    v_and_b32 v125, 0xffff0000, v154
    v_lshlrev_b32 v126, 16, v155
    v_and_b32 v127, 0xffff0000, v155
    v_add_f32 v96, v96, v120
    v_add_f32 v97, v97, v121
    v_add_f32 v98, v98, v122
    v_add_f32 v99, v99, v123
    v_add_f32 v100, v100, v124
    v_add_f32 v101, v101, v125
    v_add_f32 v102, v102, v126
    v_add_f32 v103, v103, v127
    v_lshlrev_b32 v120, 16, v156
    v_and_b32 v121, 0xffff0000, v156
    v_lshlrev_b32 v122, 16, v157
    v_and_b32 v123, 0xffff0000, v157
    v_lshlrev_b32 v124, 16, v158
    v_and_b32 v125, 0xffff0000, v158
    v_lshlrev_b32 v126, 16, v159
    v_and_b32 v127, 0xffff0000, v159
    v_add_f32 v96, v96, v120
    v_add_f32 v97, v97, v121
    v_add_f32 v98, v98, v122
    v_add_f32 v99, v99, v123
    v_add_f32 v100, v100, v124
    v_add_f32 v101, v101, v125
    v_add_f32 v102, v102, v126
    v_add_f32 v103, v103, v127
    v_cvt_pk_bf16_f32 v120, v96, v97
    v_cvt_pk_bf16_f32 v121, v98, v99
    v_cvt_pk_bf16_f32 v122, v100, v101
    v_cvt_pk_bf16_f32 v123, v102, v103
    v_lshlrev_b32 v96, 16, v120
    v_and_b32 v97, 0xffff0000, v120
    v_lshlrev_b32 v98, 16, v121
    v_and_b32 v99, 0xffff0000, v121
    v_lshlrev_b32 v100, 16, v122
    v_and_b32 v101, 0xffff0000, v122
    v_lshlrev_b32 v102, 16, v123
    v_and_b32 v103, 0xffff0000, v123
    v_mul_f32 v104, 0xbfb8aa3b, v96
    v_mul_f32 v105, 0xbfb8aa3b, v97
    v_mul_f32 v106, 0xbfb8aa3b, v98
    v_mul_f32 v107, 0xbfb8aa3b, v99
    v_mul_f32 v108, 0xbfb8aa3b, v100
    v_mul_f32 v109, 0xbfb8aa3b, v101
    v_mul_f32 v110, 0xbfb8aa3b, v102
    v_mul_f32 v111, 0xbfb8aa3b, v103
    v_exp_f32 v104, v104
    v_exp_f32 v105, v105
    v_exp_f32 v106, v106
    v_exp_f32 v107, v107
    v_exp_f32 v108, v108
    v_exp_f32 v109, v109
    v_exp_f32 v110, v110
    v_exp_f32 v111, v111
    v_add_f32 v104, 1.0, v104
    v_add_f32 v105, 1.0, v105
    v_add_f32 v106, 1.0, v106
    v_add_f32 v107, 1.0, v107
    v_add_f32 v108, 1.0, v108
    v_add_f32 v109, 1.0, v109
    v_add_f32 v110, 1.0, v110
    v_add_f32 v111, 1.0, v111
    v_rcp_f32 v104, v104
    v_rcp_f32 v105, v105
    v_rcp_f32 v106, v106
    v_rcp_f32 v107, v107
    v_rcp_f32 v108, v108
    v_rcp_f32 v109, v109
    v_rcp_f32 v110, v110
    v_rcp_f32 v111, v111
    v_mul_f32 v96, v96, v104
    v_mul_f32 v97, v97, v105
    v_mul_f32 v98, v98, v106
    v_mul_f32 v99, v99, v107
    v_mul_f32 v100, v100, v108
    v_mul_f32 v101, v101, v109
    v_mul_f32 v102, v102, v110
    v_mul_f32 v103, v103, v111
    v_cvt_pk_bf16_f32 v80, v96, v97
    v_cvt_pk_bf16_f32 v81, v98, v99
    v_cvt_pk_bf16_f32 v82, v100, v101
    v_cvt_pk_bf16_f32 v83, v102, v103
    v_lshlrev_b32 v96, 16, v160
    v_and_b32 v97, 0xffff0000, v160
    v_lshlrev_b32 v98, 16, v161
    v_and_b32 v99, 0xffff0000, v161
    v_lshlrev_b32 v100, 16, v162
    v_and_b32 v101, 0xffff0000, v162
    v_lshlrev_b32 v102, 16, v163
    v_and_b32 v103, 0xffff0000, v163
    v_lshlrev_b32 v120, 16, v164
    v_and_b32 v121, 0xffff0000, v164
    v_lshlrev_b32 v122, 16, v165
    v_and_b32 v123, 0xffff0000, v165
    v_lshlrev_b32 v124, 16, v166
    v_and_b32 v125, 0xffff0000, v166
    v_lshlrev_b32 v126, 16, v167
    v_and_b32 v127, 0xffff0000, v167
    v_add_f32 v96, v96, v120
    v_add_f32 v97, v97, v121
    v_add_f32 v98, v98, v122
    v_add_f32 v99, v99, v123
    v_add_f32 v100, v100, v124
    v_add_f32 v101, v101, v125
    v_add_f32 v102, v102, v126
    v_add_f32 v103, v103, v127
    v_lshlrev_b32 v120, 16, v168
    v_and_b32 v121, 0xffff0000, v168
    v_lshlrev_b32 v122, 16, v169
    v_and_b32 v123, 0xffff0000, v169
    v_lshlrev_b32 v124, 16, v170
    v_and_b32 v125, 0xffff0000, v170
    v_lshlrev_b32 v126, 16, v171
    v_and_b32 v127, 0xffff0000, v171
    v_add_f32 v96, v96, v120
    v_add_f32 v97, v97, v121
    v_add_f32 v98, v98, v122
    v_add_f32 v99, v99, v123
    v_add_f32 v100, v100, v124
    v_add_f32 v101, v101, v125
    v_add_f32 v102, v102, v126
    v_add_f32 v103, v103, v127
    v_lshlrev_b32 v120, 16, v172
    v_and_b32 v121, 0xffff0000, v172
    v_lshlrev_b32 v122, 16, v173
    v_and_b32 v123, 0xffff0000, v173
    v_lshlrev_b32 v124, 16, v174
    v_and_b32 v125, 0xffff0000, v174
    v_lshlrev_b32 v126, 16, v175
    v_and_b32 v127, 0xffff0000, v175
    v_add_f32 v96, v96, v120
    v_add_f32 v97, v97, v121
    v_add_f32 v98, v98, v122
    v_add_f32 v99, v99, v123
    v_add_f32 v100, v100, v124
    v_add_f32 v101, v101, v125
    v_add_f32 v102, v102, v126
    v_add_f32 v103, v103, v127
    v_cvt_pk_bf16_f32 v120, v96, v97
    v_cvt_pk_bf16_f32 v121, v98, v99
    v_cvt_pk_bf16_f32 v122, v100, v101
    v_cvt_pk_bf16_f32 v123, v102, v103
    v_lshlrev_b32 v96, 16, v120
    v_and_b32 v97, 0xffff0000, v120
    v_lshlrev_b32 v98, 16, v121
    v_and_b32 v99, 0xffff0000, v121
    v_lshlrev_b32 v100, 16, v122
    v_and_b32 v101, 0xffff0000, v122
    v_lshlrev_b32 v102, 16, v123
    v_and_b32 v103, 0xffff0000, v123
    v_mul_f32 v104, 0xbfb8aa3b, v96
    v_mul_f32 v105, 0xbfb8aa3b, v97
    v_mul_f32 v106, 0xbfb8aa3b, v98
    v_mul_f32 v107, 0xbfb8aa3b, v99
    v_mul_f32 v108, 0xbfb8aa3b, v100
    v_mul_f32 v109, 0xbfb8aa3b, v101
    v_mul_f32 v110, 0xbfb8aa3b, v102
    v_mul_f32 v111, 0xbfb8aa3b, v103
    v_exp_f32 v104, v104
    v_exp_f32 v105, v105
    v_exp_f32 v106, v106
    v_exp_f32 v107, v107
    v_exp_f32 v108, v108
    v_exp_f32 v109, v109
    v_exp_f32 v110, v110
    v_exp_f32 v111, v111
    v_add_f32 v104, 1.0, v104
    v_add_f32 v105, 1.0, v105
    v_add_f32 v106, 1.0, v106
    v_add_f32 v107, 1.0, v107
    v_add_f32 v108, 1.0, v108
    v_add_f32 v109, 1.0, v109
    v_add_f32 v110, 1.0, v110
    v_add_f32 v111, 1.0, v111
    v_rcp_f32 v104, v104
    v_rcp_f32 v105, v105
    v_rcp_f32 v106, v106
    v_rcp_f32 v107, v107
    v_rcp_f32 v108, v108
    v_rcp_f32 v109, v109
    v_rcp_f32 v110, v110
    v_rcp_f32 v111, v111
    v_mul_f32 v96, v96, v104
    v_mul_f32 v97, v97, v105
    v_mul_f32 v98, v98, v106
    v_mul_f32 v99, v99, v107
    v_mul_f32 v100, v100, v108
    v_mul_f32 v101, v101, v109
    v_mul_f32 v102, v102, v110
    v_mul_f32 v103, v103, v111
    v_cvt_pk_bf16_f32 v84, v96, v97
    v_cvt_pk_bf16_f32 v85, v98, v99
    v_cvt_pk_bf16_f32 v86, v100, v101
    v_cvt_pk_bf16_f32 v87, v102, v103
    s_waitcnt vmcnt(0)
    v_lshlrev_b32 v96, 16, v16
    v_and_b32 v97, 0xffff0000, v16
    v_lshlrev_b32 v98, 16, v17
    v_and_b32 v99, 0xffff0000, v17
    v_lshlrev_b32 v100, 16, v18
    v_and_b32 v101, 0xffff0000, v18
    v_lshlrev_b32 v102, 16, v19
    v_and_b32 v103, 0xffff0000, v19
    v_lshlrev_b32 v120, 16, v20
    v_and_b32 v121, 0xffff0000, v20
    v_lshlrev_b32 v122, 16, v21
    v_and_b32 v123, 0xffff0000, v21
    v_lshlrev_b32 v124, 16, v22
    v_and_b32 v125, 0xffff0000, v22
    v_lshlrev_b32 v126, 16, v23
    v_and_b32 v127, 0xffff0000, v23
    v_add_f32 v96, v96, v120
    v_add_f32 v97, v97, v121
    v_add_f32 v98, v98, v122
    v_add_f32 v99, v99, v123
    v_add_f32 v100, v100, v124
    v_add_f32 v101, v101, v125
    v_add_f32 v102, v102, v126
    v_add_f32 v103, v103, v127
    v_lshlrev_b32 v120, 16, v24
    v_and_b32 v121, 0xffff0000, v24
    v_lshlrev_b32 v122, 16, v25
    v_and_b32 v123, 0xffff0000, v25
    v_lshlrev_b32 v124, 16, v26
    v_and_b32 v125, 0xffff0000, v26
    v_lshlrev_b32 v126, 16, v27
    v_and_b32 v127, 0xffff0000, v27
    v_add_f32 v96, v96, v120
    v_add_f32 v97, v97, v121
    v_add_f32 v98, v98, v122
    v_add_f32 v99, v99, v123
    v_add_f32 v100, v100, v124
    v_add_f32 v101, v101, v125
    v_add_f32 v102, v102, v126
    v_add_f32 v103, v103, v127
    v_lshlrev_b32 v120, 16, v28
    v_and_b32 v121, 0xffff0000, v28
    v_lshlrev_b32 v122, 16, v29
    v_and_b32 v123, 0xffff0000, v29
    v_lshlrev_b32 v124, 16, v30
    v_and_b32 v125, 0xffff0000, v30
    v_lshlrev_b32 v126, 16, v31
    v_and_b32 v127, 0xffff0000, v31
    v_add_f32 v96, v96, v120
    v_add_f32 v97, v97, v121
    v_add_f32 v98, v98, v122
    v_add_f32 v99, v99, v123
    v_add_f32 v100, v100, v124
    v_add_f32 v101, v101, v125
    v_add_f32 v102, v102, v126
    v_add_f32 v103, v103, v127
    v_lshlrev_b32 v120, 16, v32
    v_and_b32 v121, 0xffff0000, v32
    v_lshlrev_b32 v122, 16, v33
    v_and_b32 v123, 0xffff0000, v33
    v_lshlrev_b32 v124, 16, v34
    v_and_b32 v125, 0xffff0000, v34
    v_lshlrev_b32 v126, 16, v35
    v_and_b32 v127, 0xffff0000, v35
    v_add_f32 v96, v96, v120
    v_add_f32 v97, v97, v121
    v_add_f32 v98, v98, v122
    v_add_f32 v99, v99, v123
    v_add_f32 v100, v100, v124
    v_add_f32 v101, v101, v125
    v_add_f32 v102, v102, v126
    v_add_f32 v103, v103, v127
    v_lshlrev_b32 v120, 16, v36
    v_and_b32 v121, 0xffff0000, v36
    v_lshlrev_b32 v122, 16, v37
    v_and_b32 v123, 0xffff0000, v37
    v_lshlrev_b32 v124, 16, v38
    v_and_b32 v125, 0xffff0000, v38
    v_lshlrev_b32 v126, 16, v39
    v_and_b32 v127, 0xffff0000, v39
    v_add_f32 v96, v96, v120
    v_add_f32 v97, v97, v121
    v_add_f32 v98, v98, v122
    v_add_f32 v99, v99, v123
    v_add_f32 v100, v100, v124
    v_add_f32 v101, v101, v125
    v_add_f32 v102, v102, v126
    v_add_f32 v103, v103, v127
    v_lshlrev_b32 v120, 16, v40
    v_and_b32 v121, 0xffff0000, v40
    v_lshlrev_b32 v122, 16, v41
    v_and_b32 v123, 0xffff0000, v41
    v_lshlrev_b32 v124, 16, v42
    v_and_b32 v125, 0xffff0000, v42
    v_lshlrev_b32 v126, 16, v43
    v_and_b32 v127, 0xffff0000, v43
    v_add_f32 v96, v96, v120
    v_add_f32 v97, v97, v121
    v_add_f32 v98, v98, v122
    v_add_f32 v99, v99, v123
    v_add_f32 v100, v100, v124
    v_add_f32 v101, v101, v125
    v_add_f32 v102, v102, v126
    v_add_f32 v103, v103, v127
    v_lshlrev_b32 v120, 16, v44
    v_and_b32 v121, 0xffff0000, v44
    v_lshlrev_b32 v122, 16, v45
    v_and_b32 v123, 0xffff0000, v45
    v_lshlrev_b32 v124, 16, v46
    v_and_b32 v125, 0xffff0000, v46
    v_lshlrev_b32 v126, 16, v47
    v_and_b32 v127, 0xffff0000, v47
    v_add_f32 v96, v96, v120
    v_add_f32 v97, v97, v121
    v_add_f32 v98, v98, v122
    v_add_f32 v99, v99, v123
    v_add_f32 v100, v100, v124
    v_add_f32 v101, v101, v125
    v_add_f32 v102, v102, v126
    v_add_f32 v103, v103, v127
    v_cndmask_b32 v108, v88, v90, s[20:21]
    v_cndmask_b32 v109, v89, v91, s[20:21]
    v_cndmask_b32 v110, v90, v88, s[20:21]
    v_cndmask_b32 v111, v91, v89, s[20:21]
    v_cvt_pk_bf16_f32 v104, v96, v97
    v_lshlrev_b32 v96, 16, v104
    v_and_b32 v97, 0xffff0000, v104
    v_lshlrev_b32 v104, 16, v80
    v_and_b32 v105, 0xffff0000, v80
    v_mul_f32 v96, v96, v104
    v_mul_f32 v97, v97, v105
    v_cvt_pk_bf16_f32 v104, v96, v97
    v_lshlrev_b32 v96, 16, v104
    v_and_b32 v97, 0xffff0000, v104
    v_lshlrev_b32 v104, 16, v108
    v_and_b32 v105, 0xffff0000, v108
    v_add_f32 v96, v96, v104
    v_add_f32 v97, v97, v105
    v_cvt_pk_bf16_f32 v112, v96, v97
    v_cvt_pk_bf16_f32 v104, v98, v99
    v_lshlrev_b32 v98, 16, v104
    v_and_b32 v99, 0xffff0000, v104
    v_lshlrev_b32 v104, 16, v81
    v_and_b32 v105, 0xffff0000, v81
    v_mul_f32 v98, v98, v104
    v_mul_f32 v99, v99, v105
    v_cvt_pk_bf16_f32 v104, v98, v99
    v_lshlrev_b32 v98, 16, v104
    v_and_b32 v99, 0xffff0000, v104
    v_lshlrev_b32 v104, 16, v109
    v_and_b32 v105, 0xffff0000, v109
    v_add_f32 v98, v98, v104
    v_add_f32 v99, v99, v105
    v_cvt_pk_bf16_f32 v113, v98, v99
    v_cvt_pk_bf16_f32 v104, v100, v101
    v_lshlrev_b32 v100, 16, v104
    v_and_b32 v101, 0xffff0000, v104
    v_lshlrev_b32 v104, 16, v82
    v_and_b32 v105, 0xffff0000, v82
    v_mul_f32 v100, v100, v104
    v_mul_f32 v101, v101, v105
    v_cvt_pk_bf16_f32 v104, v100, v101
    v_lshlrev_b32 v100, 16, v104
    v_and_b32 v101, 0xffff0000, v104
    v_lshlrev_b32 v104, 16, v110
    v_and_b32 v105, 0xffff0000, v110
    v_add_f32 v100, v100, v104
    v_add_f32 v101, v101, v105
    v_cvt_pk_bf16_f32 v114, v100, v101
    v_cvt_pk_bf16_f32 v104, v102, v103
    v_lshlrev_b32 v102, 16, v104
    v_and_b32 v103, 0xffff0000, v104
    v_lshlrev_b32 v104, 16, v83
    v_and_b32 v105, 0xffff0000, v83
    v_mul_f32 v102, v102, v104
    v_mul_f32 v103, v103, v105
    v_cvt_pk_bf16_f32 v104, v102, v103
    v_lshlrev_b32 v102, 16, v104
    v_and_b32 v103, 0xffff0000, v104
    v_lshlrev_b32 v104, 16, v111
    v_and_b32 v105, 0xffff0000, v111
    v_add_f32 v102, v102, v104
    v_add_f32 v103, v103, v105
    v_cvt_pk_bf16_f32 v115, v102, v103
    v_cndmask_b32 v128, v112, v114, s[20:21]
    v_cndmask_b32 v129, v113, v115, s[20:21]
    v_cndmask_b32 v130, v114, v112, s[20:21]
    v_cndmask_b32 v131, v115, v113, s[20:21]
    buffer_store_dwordx4 v[128:131], v4, s[12:15], s18 offen offset:0
    v_lshlrev_b32 v96, 16, v48
    v_and_b32 v97, 0xffff0000, v48
    v_lshlrev_b32 v98, 16, v49
    v_and_b32 v99, 0xffff0000, v49
    v_lshlrev_b32 v100, 16, v50
    v_and_b32 v101, 0xffff0000, v50
    v_lshlrev_b32 v102, 16, v51
    v_and_b32 v103, 0xffff0000, v51
    v_lshlrev_b32 v120, 16, v52
    v_and_b32 v121, 0xffff0000, v52
    v_lshlrev_b32 v122, 16, v53
    v_and_b32 v123, 0xffff0000, v53
    v_lshlrev_b32 v124, 16, v54
    v_and_b32 v125, 0xffff0000, v54
    v_lshlrev_b32 v126, 16, v55
    v_and_b32 v127, 0xffff0000, v55
    v_add_f32 v96, v96, v120
    v_add_f32 v97, v97, v121
    v_add_f32 v98, v98, v122
    v_add_f32 v99, v99, v123
    v_add_f32 v100, v100, v124
    v_add_f32 v101, v101, v125
    v_add_f32 v102, v102, v126
    v_add_f32 v103, v103, v127
    v_lshlrev_b32 v120, 16, v56
    v_and_b32 v121, 0xffff0000, v56
    v_lshlrev_b32 v122, 16, v57
    v_and_b32 v123, 0xffff0000, v57
    v_lshlrev_b32 v124, 16, v58
    v_and_b32 v125, 0xffff0000, v58
    v_lshlrev_b32 v126, 16, v59
    v_and_b32 v127, 0xffff0000, v59
    v_add_f32 v96, v96, v120
    v_add_f32 v97, v97, v121
    v_add_f32 v98, v98, v122
    v_add_f32 v99, v99, v123
    v_add_f32 v100, v100, v124
    v_add_f32 v101, v101, v125
    v_add_f32 v102, v102, v126
    v_add_f32 v103, v103, v127
    v_lshlrev_b32 v120, 16, v60
    v_and_b32 v121, 0xffff0000, v60
    v_lshlrev_b32 v122, 16, v61
    v_and_b32 v123, 0xffff0000, v61
    v_lshlrev_b32 v124, 16, v62
    v_and_b32 v125, 0xffff0000, v62
    v_lshlrev_b32 v126, 16, v63
    v_and_b32 v127, 0xffff0000, v63
    v_add_f32 v96, v96, v120
    v_add_f32 v97, v97, v121
    v_add_f32 v98, v98, v122
    v_add_f32 v99, v99, v123
    v_add_f32 v100, v100, v124
    v_add_f32 v101, v101, v125
    v_add_f32 v102, v102, v126
    v_add_f32 v103, v103, v127
    v_lshlrev_b32 v120, 16, v64
    v_and_b32 v121, 0xffff0000, v64
    v_lshlrev_b32 v122, 16, v65
    v_and_b32 v123, 0xffff0000, v65
    v_lshlrev_b32 v124, 16, v66
    v_and_b32 v125, 0xffff0000, v66
    v_lshlrev_b32 v126, 16, v67
    v_and_b32 v127, 0xffff0000, v67
    v_add_f32 v96, v96, v120
    v_add_f32 v97, v97, v121
    v_add_f32 v98, v98, v122
    v_add_f32 v99, v99, v123
    v_add_f32 v100, v100, v124
    v_add_f32 v101, v101, v125
    v_add_f32 v102, v102, v126
    v_add_f32 v103, v103, v127
    v_lshlrev_b32 v120, 16, v68
    v_and_b32 v121, 0xffff0000, v68
    v_lshlrev_b32 v122, 16, v69
    v_and_b32 v123, 0xffff0000, v69
    v_lshlrev_b32 v124, 16, v70
    v_and_b32 v125, 0xffff0000, v70
    v_lshlrev_b32 v126, 16, v71
    v_and_b32 v127, 0xffff0000, v71
    v_add_f32 v96, v96, v120
    v_add_f32 v97, v97, v121
    v_add_f32 v98, v98, v122
    v_add_f32 v99, v99, v123
    v_add_f32 v100, v100, v124
    v_add_f32 v101, v101, v125
    v_add_f32 v102, v102, v126
    v_add_f32 v103, v103, v127
    v_lshlrev_b32 v120, 16, v72
    v_and_b32 v121, 0xffff0000, v72
    v_lshlrev_b32 v122, 16, v73
    v_and_b32 v123, 0xffff0000, v73
    v_lshlrev_b32 v124, 16, v74
    v_and_b32 v125, 0xffff0000, v74
    v_lshlrev_b32 v126, 16, v75
    v_and_b32 v127, 0xffff0000, v75
    v_add_f32 v96, v96, v120
    v_add_f32 v97, v97, v121
    v_add_f32 v98, v98, v122
    v_add_f32 v99, v99, v123
    v_add_f32 v100, v100, v124
    v_add_f32 v101, v101, v125
    v_add_f32 v102, v102, v126
    v_add_f32 v103, v103, v127
    v_lshlrev_b32 v120, 16, v76
    v_and_b32 v121, 0xffff0000, v76
    v_lshlrev_b32 v122, 16, v77
    v_and_b32 v123, 0xffff0000, v77
    v_lshlrev_b32 v124, 16, v78
    v_and_b32 v125, 0xffff0000, v78
    v_lshlrev_b32 v126, 16, v79
    v_and_b32 v127, 0xffff0000, v79
    v_add_f32 v96, v96, v120
    v_add_f32 v97, v97, v121
    v_add_f32 v98, v98, v122
    v_add_f32 v99, v99, v123
    v_add_f32 v100, v100, v124
    v_add_f32 v101, v101, v125
    v_add_f32 v102, v102, v126
    v_add_f32 v103, v103, v127
    v_cndmask_b32 v108, v92, v94, s[20:21]
    v_cndmask_b32 v109, v93, v95, s[20:21]
    v_cndmask_b32 v110, v94, v92, s[20:21]
    v_cndmask_b32 v111, v95, v93, s[20:21]
    v_cvt_pk_bf16_f32 v104, v96, v97
    v_lshlrev_b32 v96, 16, v104
    v_and_b32 v97, 0xffff0000, v104
    v_lshlrev_b32 v104, 16, v84
    v_and_b32 v105, 0xffff0000, v84
    v_mul_f32 v96, v96, v104
    v_mul_f32 v97, v97, v105
    v_cvt_pk_bf16_f32 v104, v96, v97
    v_lshlrev_b32 v96, 16, v104
    v_and_b32 v97, 0xffff0000, v104
    v_lshlrev_b32 v104, 16, v108
    v_and_b32 v105, 0xffff0000, v108
    v_add_f32 v96, v96, v104
    v_add_f32 v97, v97, v105
    v_cvt_pk_bf16_f32 v112, v96, v97
    v_cvt_pk_bf16_f32 v104, v98, v99
    v_lshlrev_b32 v98, 16, v104
    v_and_b32 v99, 0xffff0000, v104
    v_lshlrev_b32 v104, 16, v85
    v_and_b32 v105, 0xffff0000, v85
    v_mul_f32 v98, v98, v104
    v_mul_f32 v99, v99, v105
    v_cvt_pk_bf16_f32 v104, v98, v99
    v_lshlrev_b32 v98, 16, v104
    v_and_b32 v99, 0xffff0000, v104
    v_lshlrev_b32 v104, 16, v109
    v_and_b32 v105, 0xffff0000, v109
    v_add_f32 v98, v98, v104
    v_add_f32 v99, v99, v105
    v_cvt_pk_bf16_f32 v113, v98, v99
    v_cvt_pk_bf16_f32 v104, v100, v101
    v_lshlrev_b32 v100, 16, v104
    v_and_b32 v101, 0xffff0000, v104
    v_lshlrev_b32 v104, 16, v86
    v_and_b32 v105, 0xffff0000, v86
    v_mul_f32 v100, v100, v104
    v_mul_f32 v101, v101, v105
    v_cvt_pk_bf16_f32 v104, v100, v101
    v_lshlrev_b32 v100, 16, v104
    v_and_b32 v101, 0xffff0000, v104
    v_lshlrev_b32 v104, 16, v110
    v_and_b32 v105, 0xffff0000, v110
    v_add_f32 v100, v100, v104
    v_add_f32 v101, v101, v105
    v_cvt_pk_bf16_f32 v114, v100, v101
    v_cvt_pk_bf16_f32 v104, v102, v103
    v_lshlrev_b32 v102, 16, v104
    v_and_b32 v103, 0xffff0000, v104
    v_lshlrev_b32 v104, 16, v87
    v_and_b32 v105, 0xffff0000, v87
    v_mul_f32 v102, v102, v104
    v_mul_f32 v103, v103, v105
    v_cvt_pk_bf16_f32 v104, v102, v103
    v_lshlrev_b32 v102, 16, v104
    v_and_b32 v103, 0xffff0000, v104
    v_lshlrev_b32 v104, 16, v111
    v_and_b32 v105, 0xffff0000, v111
    v_add_f32 v102, v102, v104
    v_add_f32 v103, v103, v105
    v_cvt_pk_bf16_f32 v115, v102, v103
    v_cndmask_b32 v132, v112, v114, s[20:21]
    v_cndmask_b32 v133, v113, v115, s[20:21]
    v_cndmask_b32 v134, v114, v112, s[20:21]
    v_cndmask_b32 v135, v115, v113, s[20:21]
    buffer_store_dwordx4 v[132:135], v4, s[12:15], s18 offen offset:64
    s_add_u32 s24, s24, 32
    s_cmp_lt_u32 s24, 61
    s_cbranch_scc1 fin_job
    s_cmp_ge_u32 s63, 48
    s_cbranch_scc1 k_end
    s_lshr_b32 s24, s63, 4
    s_sub_u32 s24, 63, s24
    s_and_b32 s25, s63, 15
    s_lshl_b32 s25, s25, 2
    s_and_b32 s26, s3, 3
    s_add_u32 s25, s25, s26
    s_lshr_b32 s26, s25, 5
    s_and_b32 s25, s25, 31
    s_lshl_b32 s16, s24, 1
    s_add_u32 s16, s16, s26
    s_lshl_b32 s18, s16, 15
    s_lshl_b32 s17, s25, 10
    s_add_u32 s17, s17, s18
    s_lshl_b32 s19, s25, 6
    s_add_u32 s18, s18, s19
    s_add_u32 s22, s17, 167772160
    s_add_u32 s23, s17, 75497472
    s_mov_b32 s27, 218106816
    s_mov_b32 s30, 218112000
    s_mov_b32 s28, 65536
    v_and_b32 v8, 7, v1
    v_lshlrev_b32 v8, 22, v8
    s_cmp_lg_u32 s3, 0
    s_cbranch_scc1 ft_ok
ft_wd:
    buffer_load_dword v7, off, s[4:7], s27 sc1
    s_waitcnt vmcnt(0)
    v_readfirstlane_b32 s31, v7
    s_cmp_ge_u32 s31, 16
    s_cbranch_scc1 ft_ws
    s_sleep 127
    s_sub_u32 s28, s28, 1
    s_cbranch_scc0 ft_wd
    s_mov_b32 s28, 0
ft_ws:
    buffer_load_dword v7, v6, s[4:7], s30 offen sc1
    s_waitcnt vmcnt(0)
    v_cmp_gt_u32 vcc, 61, v7
    s_cbranch_vccz ft_ok
    s_sleep 12
    v_cmp_gt_u32 vcc, 59, v7
    s_cbranch_vccz ft_wsf
    s_sleep 64
    v_cmp_gt_u32 vcc, 56, v7
    s_cbranch_vccz ft_wsf
    s_sleep 127
    s_sleep 127
ft_wsf:
    s_sub_u32 s28, s28, 1
    s_cbranch_scc0 ft_ws
    s_mov_b32 s28, 0
ft_ok:
    s_barrier
    s_cmp_ge_u32 s3, 4
    s_cbranch_scc1 k_end
    buffer_load_dwordx4 v[88:91], v4, s[8:11], s18 offen
    buffer_load_dwordx4 v[144:147], v3, s[4:7], s22 offen offset:0 sc1
    s_add_u32 s22, s22, 4194304
    buffer_load_dwordx4 v[148:151], v3, s[4:7], s22 offen offset:0 sc1
    s_add_u32 s22, s22, 4194304
    buffer_load_dwordx4 v[152:155], v3, s[4:7], s22 offen offset:0 sc1
    s_add_u32 s22, s22, 4194304
    buffer_load_dwordx4 v[156:159], v3, s[4:7], s22 offen offset:0 sc1
    s_waitcnt vmcnt(0)
    v_lshlrev_b32 v96, 16, v144
    v_and_b32 v97, 0xffff0000, v144
    v_lshlrev_b32 v98, 16, v145
    v_and_b32 v99, 0xffff0000, v145
    v_lshlrev_b32 v100, 16, v146
    v_and_b32 v101, 0xffff0000, v146
    v_lshlrev_b32 v102, 16, v147
    v_and_b32 v103, 0xffff0000, v147
    v_lshlrev_b32 v120, 16, v148
    v_and_b32 v121, 0xffff0000, v148
    v_lshlrev_b32 v122, 16, v149
    v_and_b32 v123, 0xffff0000, v149
    v_lshlrev_b32 v124, 16, v150
    v_and_b32 v125, 0xffff0000, v150
    v_lshlrev_b32 v126, 16, v151
    v_and_b32 v127, 0xffff0000, v151
    v_add_f32 v96, v96, v120
    v_add_f32 v97, v97, v121
    v_add_f32 v98, v98, v122
    v_add_f32 v99, v99, v123
    v_add_f32 v100, v100, v124
    v_add_f32 v101, v101, v125
    v_add_f32 v102, v102, v126
    v_add_f32 v103, v103, v127
    v_lshlrev_b32 v120, 16, v152
    v_and_b32 v121, 0xffff0000, v152
    v_lshlrev_b32 v122, 16, v153
    v_and_b32 v123, 0xffff0000, v153
    v_lshlrev_b32 v124, 16, v154
    v_and_b32 v125, 0xffff0000, v154
    v_lshlrev_b32 v126, 16, v155
    v_and_b32 v127, 0xffff0000, v155
    v_add_f32 v96, v96, v120
    v_add_f32 v97, v97, v121
    v_add_f32 v98, v98, v122
    v_add_f32 v99, v99, v123
    v_add_f32 v100, v100, v124
    v_add_f32 v101, v101, v125
    v_add_f32 v102, v102, v126
    v_add_f32 v103, v103, v127
    v_lshlrev_b32 v120, 16, v156
    v_and_b32 v121, 0xffff0000, v156
    v_lshlrev_b32 v122, 16, v157
    v_and_b32 v123, 0xffff0000, v157
    v_lshlrev_b32 v124, 16, v158
    v_and_b32 v125, 0xffff0000, v158
    v_lshlrev_b32 v126, 16, v159
    v_and_b32 v127, 0xffff0000, v159
    v_add_f32 v96, v96, v120
    v_add_f32 v97, v97, v121
    v_add_f32 v98, v98, v122
    v_add_f32 v99, v99, v123
    v_add_f32 v100, v100, v124
    v_add_f32 v101, v101, v125
    v_add_f32 v102, v102, v126
    v_add_f32 v103, v103, v127
    v_cvt_pk_bf16_f32 v120, v96, v97
    v_cvt_pk_bf16_f32 v121, v98, v99
    v_cvt_pk_bf16_f32 v122, v100, v101
    v_cvt_pk_bf16_f32 v123, v102, v103
    v_lshlrev_b32 v96, 16, v120
    v_and_b32 v97, 0xffff0000, v120
    v_lshlrev_b32 v98, 16, v121
    v_and_b32 v99, 0xffff0000, v121
    v_lshlrev_b32 v100, 16, v122
    v_and_b32 v101, 0xffff0000, v122
    v_lshlrev_b32 v102, 16, v123
    v_and_b32 v103, 0xffff0000, v123
    v_mul_f32 v104, 0xbfb8aa3b, v96
    v_mul_f32 v105, 0xbfb8aa3b, v97
    v_mul_f32 v106, 0xbfb8aa3b, v98
    v_mul_f32 v107, 0xbfb8aa3b, v99
    v_mul_f32 v108, 0xbfb8aa3b, v100
    v_mul_f32 v109, 0xbfb8aa3b, v101
    v_mul_f32 v110, 0xbfb8aa3b, v102
    v_mul_f32 v111, 0xbfb8aa3b, v103
    v_exp_f32 v104, v104
    v_exp_f32 v105, v105
    v_exp_f32 v106, v106
    v_exp_f32 v107, v107
    v_exp_f32 v108, v108
    v_exp_f32 v109, v109
    v_exp_f32 v110, v110
    v_exp_f32 v111, v111
    v_add_f32 v104, 1.0, v104
    v_add_f32 v105, 1.0, v105
    v_add_f32 v106, 1.0, v106
    v_add_f32 v107, 1.0, v107
    v_add_f32 v108, 1.0, v108
    v_add_f32 v109, 1.0, v109
    v_add_f32 v110, 1.0, v110
    v_add_f32 v111, 1.0, v111
    v_rcp_f32 v104, v104
    v_rcp_f32 v105, v105
    v_rcp_f32 v106, v106
    v_rcp_f32 v107, v107
    v_rcp_f32 v108, v108
    v_rcp_f32 v109, v109
    v_rcp_f32 v110, v110
    v_rcp_f32 v111, v111
    v_mul_f32 v96, v96, v104
    v_mul_f32 v97, v97, v105
    v_mul_f32 v98, v98, v106
    v_mul_f32 v99, v99, v107
    v_mul_f32 v100, v100, v108
    v_mul_f32 v101, v101, v109
    v_mul_f32 v102, v102, v110
    v_mul_f32 v103, v103, v111
    v_cvt_pk_bf16_f32 v80, v96, v97
    v_cvt_pk_bf16_f32 v81, v98, v99
    v_cvt_pk_bf16_f32 v82, v100, v101
    v_cvt_pk_bf16_f32 v83, v102, v103
    s_cmp_eq_u32 s24, 63
    s_cbranch_scc1 ft_p63
ft_p:
    buffer_load_dword v7, v8, s[4:7], s23 offen offset:1020 sc1
    s_waitcnt vmcnt(0)
    v_cmp_eq_u32 vcc, -1, v7
    s_cbranch_vccz ft_l
    s_sleep 4
    s_sub_u32 s28, s28, 1
    s_cbranch_scc0 ft_p
    s_mov_b32 s28, 0
ft_l:
    s_mov_b32 s31, s23
    buffer_load_dwordx4 v[16:19], v3, s[4:7], s31 offen sc1
    s_add_u32 s31, s31, 4194304
    buffer_load_dwordx4 v[20:23], v3, s[4:7], s31 offen sc1
    s_add_u32 s31, s31, 4194304
    buffer_load_dwordx4 v[24:27], v3, s[4:7], s31 offen sc1
    s_add_u32 s31, s31, 4194304
    buffer_load_dwordx4 v[28:31], v3, s[4:7], s31 offen sc1
    s_add_u32 s31, s31, 4194304
    buffer_load_dwordx4 v[32:35], v3, s[4:7], s31 offen sc1
    s_add_u32 s31, s31, 4194304
    buffer_load_dwordx4 v[36:39], v3, s[4:7], s31 offen sc1
    s_add_u32 s31, s31, 4194304
    buffer_load_dwordx4 v[40:43], v3, s[4:7], s31 offen sc1
    s_add_u32 s31, s31, 4194304
    buffer_load_dwordx4 v[44:47], v3, s[4:7], s31 offen sc1
    s_waitcnt vmcnt(0)
    v_max3_u32 v7, v16, v17, v18
    v_max3_u32 v7, v7, v19, v20
    v_max3_u32 v7, v7, v21, v22
    v_max3_u32 v7, v7, v23, v24
    v_max3_u32 v7, v7, v25, v26
    v_max3_u32 v7, v7, v27, v28
    v_max3_u32 v7, v7, v29, v30
    v_max3_u32 v7, v7, v31, v32
    v_max3_u32 v7, v7, v33, v34
    v_max3_u32 v7, v7, v35, v36
    v_max3_u32 v7, v7, v37, v38
    v_max3_u32 v7, v7, v39, v40
    v_max3_u32 v7, v7, v41, v42
    v_max3_u32 v7, v7, v43, v44
    v_max3_u32 v7, v7, v45, v46
    v_max_u32 v7, v7, v47
    v_cmp_eq_u32 vcc, -1, v7
    s_cbranch_vccz ft_go
    s_sleep 2
    s_sub_u32 s28, s28, 1
    s_cbranch_scc0 ft_l
    s_branch ft_go
ft_p63:
    s_sub_u32 s31, s23, 65536
    buffer_load_dword v7, v8, s[4:7], s31 offen offset:1020 sc1
    s_waitcnt vmcnt(0)
    v_cmp_eq_u32 vcc, -1, v7
    s_cbranch_vccz ft_l
    s_sleep 4
    s_sub_u32 s28, s28, 1
    s_cbranch_scc0 ft_p63
    s_mov_b32 s28, 0
    s_branch ft_l
ft_go:
    v_lshlrev_b32 v96, 16, v16
    v_and_b32 v97, 0xffff0000, v16
    v_lshlrev_b32 v98, 16, v17
    v_and_b32 v99, 0xffff0000, v17
    v_lshlrev_b32 v100, 16, v18
    v_and_b32 v101, 0xffff0000, v18
    v_lshlrev_b32 v102, 16, v19
    v_and_b32 v103, 0xffff0000, v19
    v_lshlrev_b32 v120, 16, v20
    v_and_b32 v121, 0xffff0000, v20
    v_lshlrev_b32 v122, 16, v21
    v_and_b32 v123, 0xffff0000, v21
    v_lshlrev_b32 v124, 16, v22
    v_and_b32 v125, 0xffff0000, v22
    v_lshlrev_b32 v126, 16, v23
    v_and_b32 v127, 0xffff0000, v23
    v_add_f32 v96, v96, v120
    v_add_f32 v97, v97, v121
    v_add_f32 v98, v98, v122
    v_add_f32 v99, v99, v123
    v_add_f32 v100, v100, v124
    v_add_f32 v101, v101, v125
    v_add_f32 v102, v102, v126
    v_add_f32 v103, v103, v127
    v_lshlrev_b32 v120, 16, v24
    v_and_b32 v121, 0xffff0000, v24
    v_lshlrev_b32 v122, 16, v25
    v_and_b32 v123, 0xffff0000, v25
    v_lshlrev_b32 v124, 16, v26
    v_and_b32 v125, 0xffff0000, v26
    v_lshlrev_b32 v126, 16, v27
    v_and_b32 v127, 0xffff0000, v27
    v_add_f32 v96, v96, v120
    v_add_f32 v97, v97, v121
    v_add_f32 v98, v98, v122
    v_add_f32 v99, v99, v123
    v_add_f32 v100, v100, v124
    v_add_f32 v101, v101, v125
    v_add_f32 v102, v102, v126
    v_add_f32 v103, v103, v127
    v_lshlrev_b32 v120, 16, v28
    v_and_b32 v121, 0xffff0000, v28
    v_lshlrev_b32 v122, 16, v29
    v_and_b32 v123, 0xffff0000, v29
    v_lshlrev_b32 v124, 16, v30
    v_and_b32 v125, 0xffff0000, v30
    v_lshlrev_b32 v126, 16, v31
    v_and_b32 v127, 0xffff0000, v31
    v_add_f32 v96, v96, v120
    v_add_f32 v97, v97, v121
    v_add_f32 v98, v98, v122
    v_add_f32 v99, v99, v123
    v_add_f32 v100, v100, v124
    v_add_f32 v101, v101, v125
    v_add_f32 v102, v102, v126
    v_add_f32 v103, v103, v127
    v_lshlrev_b32 v120, 16, v32
    v_and_b32 v121, 0xffff0000, v32
    v_lshlrev_b32 v122, 16, v33
    v_and_b32 v123, 0xffff0000, v33
    v_lshlrev_b32 v124, 16, v34
    v_and_b32 v125, 0xffff0000, v34
    v_lshlrev_b32 v126, 16, v35
    v_and_b32 v127, 0xffff0000, v35
    v_add_f32 v96, v96, v120
    v_add_f32 v97, v97, v121
    v_add_f32 v98, v98, v122
    v_add_f32 v99, v99, v123
    v_add_f32 v100, v100, v124
    v_add_f32 v101, v101, v125
    v_add_f32 v102, v102, v126
    v_add_f32 v103, v103, v127
    v_lshlrev_b32 v120, 16, v36
    v_and_b32 v121, 0xffff0000, v36
    v_lshlrev_b32 v122, 16, v37
    v_and_b32 v123, 0xffff0000, v37
    v_lshlrev_b32 v124, 16, v38
    v_and_b32 v125, 0xffff0000, v38
    v_lshlrev_b32 v126, 16, v39
    v_and_b32 v127, 0xffff0000, v39
    v_add_f32 v96, v96, v120
    v_add_f32 v97, v97, v121
    v_add_f32 v98, v98, v122
    v_add_f32 v99, v99, v123
    v_add_f32 v100, v100, v124
    v_add_f32 v101, v101, v125
    v_add_f32 v102, v102, v126
    v_add_f32 v103, v103, v127
    v_lshlrev_b32 v120, 16, v40
    v_and_b32 v121, 0xffff0000, v40
    v_lshlrev_b32 v122, 16, v41
    v_and_b32 v123, 0xffff0000, v41
    v_lshlrev_b32 v124, 16, v42
    v_and_b32 v125, 0xffff0000, v42
    v_lshlrev_b32 v126, 16, v43
    v_and_b32 v127, 0xffff0000, v43
    v_add_f32 v96, v96, v120
    v_add_f32 v97, v97, v121
    v_add_f32 v98, v98, v122
    v_add_f32 v99, v99, v123
    v_add_f32 v100, v100, v124
    v_add_f32 v101, v101, v125
    v_add_f32 v102, v102, v126
    v_add_f32 v103, v103, v127
    v_lshlrev_b32 v120, 16, v44
    v_and_b32 v121, 0xffff0000, v44
    v_lshlrev_b32 v122, 16, v45
    v_and_b32 v123, 0xffff0000, v45
    v_lshlrev_b32 v124, 16, v46
    v_and_b32 v125, 0xffff0000, v46
    v_lshlrev_b32 v126, 16, v47
    v_and_b32 v127, 0xffff0000, v47
    v_add_f32 v96, v96, v120
    v_add_f32 v97, v97, v121
    v_add_f32 v98, v98, v122
    v_add_f32 v99, v99, v123
    v_add_f32 v100, v100, v124
    v_add_f32 v101, v101, v125
    v_add_f32 v102, v102, v126
    v_add_f32 v103, v103, v127
    v_cndmask_b32 v108, v88, v90, s[20:21]
    v_cndmask_b32 v109, v89, v91, s[20:21]
    v_cndmask_b32 v110, v90, v88, s[20:21]
    v_cndmask_b32 v111, v91, v89, s[20:21]
    v_cvt_pk_bf16_f32 v104, v96, v97
    v_lshlrev_b32 v96, 16, v104
    v_and_b32 v97, 0xffff0000, v104
    v_lshlrev_b32 v104, 16, v80
    v_and_b32 v105, 0xffff0000, v80
    v_mul_f32 v96, v96, v104
    v_mul_f32 v97, v97, v105
    v_cvt_pk_bf16_f32 v104, v96, v97
    v_lshlrev_b32 v96, 16, v104
    v_and_b32 v97, 0xffff0000, v104
    v_lshlrev_b32 v104, 16, v108
    v_and_b32 v105, 0xffff0000, v108
    v_add_f32 v96, v96, v104
    v_add_f32 v97, v97, v105
    v_cvt_pk_bf16_f32 v112, v96, v97
    v_cvt_pk_bf16_f32 v104, v98, v99
    v_lshlrev_b32 v98, 16, v104
    v_and_b32 v99, 0xffff0000, v104
    v_lshlrev_b32 v104, 16, v81
    v_and_b32 v105, 0xffff0000, v81
    v_mul_f32 v98, v98, v104
    v_mul_f32 v99, v99, v105
    v_cvt_pk_bf16_f32 v104, v98, v99
    v_lshlrev_b32 v98, 16, v104
    v_and_b32 v99, 0xffff0000, v104
    v_lshlrev_b32 v104, 16, v109
    v_and_b32 v105, 0xffff0000, v109
    v_add_f32 v98, v98, v104
    v_add_f32 v99, v99, v105
    v_cvt_pk_bf16_f32 v113, v98, v99
    v_cvt_pk_bf16_f32 v104, v100, v101
    v_lshlrev_b32 v100, 16, v104
    v_and_b32 v101, 0xffff0000, v104
    v_lshlrev_b32 v104, 16, v82
    v_and_b32 v105, 0xffff0000, v82
    v_mul_f32 v100, v100, v104
    v_mul_f32 v101, v101, v105
    v_cvt_pk_bf16_f32 v104, v100, v101
    v_lshlrev_b32 v100, 16, v104
    v_and_b32 v101, 0xffff0000, v104
    v_lshlrev_b32 v104, 16, v110
    v_and_b32 v105, 0xffff0000, v110
    v_add_f32 v100, v100, v104
    v_add_f32 v101, v101, v105
    v_cvt_pk_bf16_f32 v114, v100, v101
    v_cvt_pk_bf16_f32 v104, v102, v103
    v_lshlrev_b32 v102, 16, v104
    v_and_b32 v103, 0xffff0000, v104
    v_lshlrev_b32 v104, 16, v83
    v_and_b32 v105, 0xffff0000, v83
    v_mul_f32 v102, v102, v104
    v_mul_f32 v103, v103, v105
    v_cvt_pk_bf16_f32 v104, v102, v103
    v_lshlrev_b32 v102, 16, v104
    v_and_b32 v103, 0xffff0000, v104
    v_lshlrev_b32 v104, 16, v111
    v_and_b32 v105, 0xffff0000, v111
    v_add_f32 v102, v102, v104
    v_add_f32 v103, v103, v105
    v_cvt_pk_bf16_f32 v115, v102, v103
    v_cndmask_b32 v128, v112, v114, s[20:21]
    v_cndmask_b32 v129, v113, v115, s[20:21]
    v_cndmask_b32 v130, v114, v112, s[20:21]
    v_cndmask_b32 v131, v115, v113, s[20:21]
    buffer_store_dwordx4 v[128:131], v4, s[12:15], s18 offen offset:0
    s_branch k_end
chain_map:
    s_and_b32 s14, s12, 1
    s_lshl_b32 s13, s13, 1
    s_lshr_b32 s15, s12, 1
    s_add_u32 s12, s13, s14
    s_mov_b32 s13, s15
    s_lshl_b32 s2, s13, 3
    s_add_u32 s2, s2, s12
    s_lshr_b32 s14, s13, 2
    s_and_b32 s15, s13, 3
    s_mov_b32 s16, 0
    s_mov_b32 s17, 209715200
    s_mov_b32 s18, 209977344
    s_mov_b32 s19, 210239488
    s_mov_b32 s20, 210501632
    s_mov_b32 s26, 131072
    s_mov_b32 s68, 0
    s_getreg_b32 s29, hwreg(HW_REG_XCC_ID)
    s_and_b32 s29, s29, 15
    s_mul_i32 s23, s29, s29
    s_lshl_b32 s23, s23, 18
    s_lshl_b32 s29, s29, 8
    s_add_u32 s29, s29, s23
    s_add_u32 s29, s29, 1
    s_lshr_b32 s28, s12, 1
    s_lshl_b32 s28, s28, 2
    s_add_u32 s28, s28, 128
    s_cmp_ge_u32 s3, 4
    s_cbranch_scc1 ch_a_pro
    s_lshl_b32 s32, s12, 15
    s_lshl_b32 s21, s14, 13
    s_add_u32 s32, s32, s21
    s_lshl_b32 s21, s15, 10
    s_add_u32 s32, s32, s21
    s_add_u32 s32, s32, 2097152
    s_lshr_b32 s33, s12, 1
    s_lshl_b32 s33, s33, 14
    s_add_u32 s33, s33, 1048576
    s_lshl_b32 s21, s13, 10
    s_add_u32 s36, s33, s21
    s_lshl_b32 s21, s3, 12
    s_add_u32 s33, s33, s21
    s_lshl_b32 s34, s13, 14
    s_lshl_b32 s21, s12, 10
    s_add_u32 s35, s34, s21
    s_lshl_b32 s37, s12, 22
    s_lshl_b32 s21, s13, 11
    s_add_u32 s37, s37, s21
    s_and_b32 s21, s3, 1
    s_lshl_b32 s21, s21, 15
    s_add_u32 s37, s37, s21
    s_lshr_b32 s21, s3, 1
    s_lshl_b32 s21, s21, 10
    s_add_u32 s37, s37, s21
    s_add_u32 s37, s37, 75497472
    v_and_b32 v20, 63, v0
    v_lshlrev_b32 v1, 4, v20
    v_mov_b32 v10, -1
    v_mov_b32 v11, -1
    v_lshrrev_b32 v21, 2, v20
    v_and_b32 v22, 3, v20
    v_lshlrev_b32 v21, 13, v21
    v_lshl_add_u32 v21, v22, 4, v21
    s_lshl_b32 s21, s3, 21
    s_lshl_b32 s22, s12, 10
    s_add_u32 s21, s21, s22
    s_lshl_b32 s23, s3, 15
    s_mov_b32 s10, 8388608
    s_mov_b32 s11, 131072
    v_lshrrev_b32 v24, 4, v20
    v_bfe_u32 v25, v20, 2, 2
    v_lshl_add_u32 v24, v24, 4, v25
    v_lshlrev_b32 v24, 6, v24
    v_lshl_add_u32 v24, v22, 3, v24
    v_add_u32 v24, s23, v24
    s_and_b32 s70, s13, 1
    s_lshl_b32 s71, s12, 4
    s_add_u32 s71, s71, s13
    s_cmp_eq_u32 s71, 127
    s_cselect_b32 s70, 1, 0
    s_cmp_eq_u32 s13, 7
    s_cselect_b32 s70, 1, s70
    s_lshl_b32 s72, s70, 20
    s_lshl_b32 s73, s70, 21
    s_lshl_b32 s70, s70, 13
    s_sub_u32 s71, s23, s70
    s_add_u32 s70, s23, s70
    s_load_dwordx2 s[8:9], s[0:1], 16
    s_lshl_b32 s25, s13, 6
    s_add_u32 s24, s21, s25
    s_add_u32 s24, s24, s72
    s_waitcnt lgkmcnt(0)
    s_add_u32 m0, s70, 0
    s_nop 0
    buffer_load_dwordx4 v21, s[8:11], s24 offen lds
    s_add_u32 s24, s24, 131072
    s_add_u32 m0, s70, 1024
    s_nop 0
    buffer_load_dwordx4 v21, s[8:11], s24 offen lds
    s_add_u32 s24, s24, 131072
    s_add_u32 m0, s70, 2048
    s_nop 0
    buffer_load_dwordx4 v21, s[8:11], s24 offen lds
    s_add_u32 s24, s24, 131072
    s_add_u32 m0, s70, 3072
    s_nop 0
    buffer_load_dwordx4 v21, s[8:11], s24 offen lds
    s_add_u32 s24, s24, 131072
    s_add_u32 m0, s70, 4096
    s_nop 0
    buffer_load_dwordx4 v21, s[8:11], s24 offen lds
    s_add_u32 s24, s24, 131072
    s_add_u32 m0, s70, 5120
    s_nop 0
    buffer_load_dwordx4 v21, s[8:11], s24 offen lds
    s_add_u32 s24, s24, 131072
    s_add_u32 m0, s70, 6144
    s_nop 0
    buffer_load_dwordx4 v21, s[8:11], s24 offen lds
    s_add_u32 s24, s24, 131072
    s_add_u32 m0, s70, 7168
    s_nop 0
    buffer_load_dwordx4 v21, s[8:11], s24 offen lds
    s_add_u32 s24, s24, 131072
    s_sub_u32 s24, s24, s73
    s_add_u32 m0, s71, 8192
    s_nop 0
    buffer_load_dwordx4 v21, s[8:11], s24 offen lds
    s_add_u32 s24, s24, 131072
    s_add_u32 m0, s71, 9216
    s_nop 0
    buffer_load_dwordx4 v21, s[8:11], s24 offen lds
    s_add_u32 s24, s24, 131072
    s_add_u32 m0, s71, 10240
    s_nop 0
    buffer_load_dwordx4 v21, s[8:11], s24 offen lds
    s_add_u32 s24, s24, 131072
    s_add_u32 m0, s71, 11264
    s_nop 0
    buffer_load_dwordx4 v21, s[8:11], s24 offen lds
    s_add_u32 s24, s24, 131072
    s_add_u32 m0, s71, 12288
    s_nop 0
    buffer_load_dwordx4 v21, s[8:11], s24 offen lds
    s_add_u32 s24, s24, 131072
    s_add_u32 m0, s71, 13312
    s_nop 0
    buffer_load_dwordx4 v21, s[8:11], s24 offen lds
    s_add_u32 s24, s24, 131072
    s_add_u32 m0, s71, 14336
    s_nop 0
    buffer_load_dwordx4 v21, s[8:11], s24 offen lds
    s_add_u32 s24, s24, 131072
    s_add_u32 m0, s71, 15360
    s_nop 0
    buffer_load_dwordx4 v21, s[8:11], s24 offen lds
    s_add_u32 s24, s24, 131072
    s_load_dwordx2 s[8:9], s[0:1], 24
    s_lshl_b32 s25, s13, 6
    s_add_u32 s24, s21, s25
    s_add_u32 s24, s24, s72
    s_waitcnt lgkmcnt(0)
    s_add_u32 m0, s70, 16384
    s_nop 0
    buffer_load_dwordx4 v21, s[8:11], s24 offen lds
    s_add_u32 s24, s24, 131072
    s_add_u32 m0, s70, 17408
    s_nop 0
    buffer_load_dwordx4 v21, s[8:11], s24 offen lds
    s_add_u32 s24, s24, 131072
    s_add_u32 m0, s70, 18432
    s_nop 0
    buffer_load_dwordx4 v21, s[8:11], s24 offen lds
    s_add_u32 s24, s24, 131072
    s_add_u32 m0, s70, 19456
    s_nop 0
    buffer_load_dwordx4 v21, s[8:11], s24 offen lds
    s_add_u32 s24, s24, 131072
    s_add_u32 m0, s70, 20480
    s_nop 0
    buffer_load_dwordx4 v21, s[8:11], s24 offen lds
    s_add_u32 s24, s24, 131072
    s_add_u32 m0, s70, 21504
    s_nop 0
    buffer_load_dwordx4 v21, s[8:11], s24 offen lds
    s_add_u32 s24, s24, 131072
    s_add_u32 m0, s70, 22528
    s_nop 0
    buffer_load_dwordx4 v21, s[8:11], s24 offen lds
    s_add_u32 s24, s24, 131072
    s_add_u32 m0, s70, 23552
    s_nop 0
    buffer_load_dwordx4 v21, s[8:11], s24 offen lds
    s_add_u32 s24, s24, 131072
    s_sub_u32 s24, s24, s73
    s_add_u32 m0, s71, 24576
    s_nop 0
    buffer_load_dwordx4 v21, s[8:11], s24 offen lds
    s_add_u32 s24, s24, 131072
    s_add_u32 m0, s71, 25600
    s_nop 0
    buffer_load_dwordx4 v21, s[8:11], s24 offen lds
    s_add_u32 s24, s24, 131072
    s_add_u32 m0, s71, 26624
    s_nop 0
    buffer_load_dwordx4 v21, s[8:11], s24 offen lds
    s_add_u32 s24, s24, 131072
    s_add_u32 m0, s71, 27648
    s_nop 0
    buffer_load_dwordx4 v21, s[8:11], s24 offen lds
    s_add_u32 s24, s24, 131072
    s_add_u32 m0, s71, 28672
    s_nop 0
    buffer_load_dwordx4 v21, s[8:11], s24 offen lds
    s_add_u32 s24, s24, 131072
    s_add_u32 m0, s71, 29696
    s_nop 0
    buffer_load_dwordx4 v21, s[8:11], s24 offen lds
    s_add_u32 s24, s24, 131072
    s_add_u32 m0, s71, 30720
    s_nop 0
    buffer_load_dwordx4 v21, s[8:11], s24 offen lds
    s_add_u32 s24, s24, 131072
    s_add_u32 m0, s71, 31744
    s_nop 0
    buffer_load_dwordx4 v21, s[8:11], s24 offen lds
    s_add_u32 s24, s24, 131072
    s_load_dwordx2 s[8:9], s[0:1], 32
    s_lshl_b32 s25, s13, 6
    s_add_u32 s24, s21, s25
    s_add_u32 s24, s24, s72
    s_waitcnt lgkmcnt(0)
    buffer_load_dwordx4 v[96:99], v21, s[8:11], s24 offen
    s_add_u32 s24, s24, 131072
    buffer_load_dwordx4 v[100:103], v21, s[8:11], s24 offen
    s_add_u32 s24, s24, 131072
    buffer_load_dwordx4 v[104:107], v21, s[8:11], s24 offen
    s_add_u32 s24, s24, 131072
    buffer_load_dwordx4 v[108:111], v21, s[8:11], s24 offen
    s_add_u32 s24, s24, 131072
    buffer_load_dwordx4 v[144:147], v21, s[8:11], s24 offen
    s_add_u32 s24, s24, 131072
    buffer_load_dwordx4 v[148:151], v21, s[8:11], s24 offen
    s_add_u32 s24, s24, 131072
    buffer_load_dwordx4 v[152:155], v21, s[8:11], s24 offen
    s_add_u32 s24, s24, 131072
    buffer_load_dwordx4 v[156:159], v21, s[8:11], s24 offen
    s_add_u32 s24, s24, 131072
    s_sub_u32 s24, s24, s73
    buffer_load_dwordx4 v[192:195], v21, s[8:11], s24 offen
    s_add_u32 s24, s24, 131072
    buffer_load_dwordx4 v[196:199], v21, s[8:11], s24 offen
    s_add_u32 s24, s24, 131072
    buffer_load_dwordx4 v[200:203], v21, s[8:11], s24 offen
    s_add_u32 s24, s24, 131072
    buffer_load_dwordx4 v[204:207], v21, s[8:11], s24 offen
    s_add_u32 s24, s24, 131072
    buffer_load_dwordx4 v[240:243], v21, s[8:11], s24 offen
    s_add_u32 s24, s24, 131072
    buffer_load_dwordx4 v[244:247], v21, s[8:11], s24 offen
    s_add_u32 s24, s24, 131072
    buffer_load_dwordx4 v[248:251], v21, s[8:11], s24 offen
    s_add_u32 s24, s24, 131072
    buffer_load_dwordx4 v[252:255], v21, s[8:11], s24 offen
    s_add_u32 s24, s24, 131072
    s_load_dwordx2 s[8:9], s[0:1], 8
    s_mov_b32 s10, 16384
    v_bfe_u32 v57, v20, 4, 1
    v_lshrrev_b32 v58, 5, v20
    v_and_b32 v59, 1, v20
    v_bfe_u32 v60, v20, 1, 3
    v_lshlrev_b32 v60, 11, v60
    v_lshl_add_u32 v60, v57, 6, v60
    v_lshl_add_u32 v60, v58, 4, v60
    v_lshl_add_u32 v15, v59, 2, v60
    s_lshl_b32 s24, s3, 9
    s_waitcnt lgkmcnt(0)
    buffer_load_dword v32, v15, s[8:11], s24 offen offset:0
    buffer_load_dword v33, v15, s[8:11], s24 offen offset:8
    buffer_load_dword v34, v15, s[8:11], s24 offen offset:32
    buffer_load_dword v35, v15, s[8:11], s24 offen offset:40
    buffer_load_dword v36, v15, s[8:11], s24 offen offset:128
    buffer_load_dword v37, v15, s[8:11], s24 offen offset:136
    buffer_load_dword v38, v15, s[8:11], s24 offen offset:160
    buffer_load_dword v39, v15, s[8:11], s24 offen offset:168
    buffer_load_dword v40, v15, s[8:11], s24 offen offset:256
    buffer_load_dword v41, v15, s[8:11], s24 offen offset:264
    buffer_load_dword v42, v15, s[8:11], s24 offen offset:288
    buffer_load_dword v43, v15, s[8:11], s24 offen offset:296
    buffer_load_dword v44, v15, s[8:11], s24 offen offset:384
    buffer_load_dword v45, v15, s[8:11], s24 offen offset:392
    buffer_load_dword v46, v15, s[8:11], s24 offen offset:416
    buffer_load_dword v47, v15, s[8:11], s24 offen offset:424
    s_barrier
    v_add_u32 v56, s70, v1
    s_add_u32 s71, s71, 8192
    v_add_u32 v26, s71, v1
    s_waitcnt vmcnt(48)
    ds_read_b64_tr_b16 v[64:65], v24 offset:0
    ds_read_b64_tr_b16 v[66:67], v24 offset:256
    ds_read_b64_tr_b16 v[68:69], v24 offset:512
    ds_read_b64_tr_b16 v[70:71], v24 offset:768
    ds_read_b64_tr_b16 v[72:73], v24 offset:32
    ds_read_b64_tr_b16 v[74:75], v24 offset:288
    ds_read_b64_tr_b16 v[76:77], v24 offset:544
    ds_read_b64_tr_b16 v[78:79], v24 offset:800
    s_waitcnt lgkmcnt(0)
    ds_read_b64_tr_b16 v[112:113], v24 offset:4096
    ds_read_b64_tr_b16 v[114:115], v24 offset:4352
    ds_read_b64_tr_b16 v[116:117], v24 offset:4608
    ds_read_b64_tr_b16 v[118:119], v24 offset:4864
    ds_read_b64_tr_b16 v[120:121], v24 offset:4128
    ds_read_b64_tr_b16 v[122:123], v24 offset:4384
    ds_read_b64_tr_b16 v[124:125], v24 offset:4640
    ds_read_b64_tr_b16 v[126:127], v24 offset:4896
    s_waitcnt lgkmcnt(0)
    ds_read_b64_tr_b16 v[160:161], v24 offset:8192
    ds_read_b64_tr_b16 v[162:163], v24 offset:8448
    ds_read_b64_tr_b16 v[164:165], v24 offset:8704
    ds_read_b64_tr_b16 v[166:167], v24 offset:8960
    ds_read_b64_tr_b16 v[168:169], v24 offset:8224
    ds_read_b64_tr_b16 v[170:171], v24 offset:8480
    ds_read_b64_tr_b16 v[172:173], v24 offset:8736
    ds_read_b64_tr_b16 v[174:175], v24 offset:8992
    s_waitcnt lgkmcnt(0)
    ds_read_b64_tr_b16 v[208:209], v24 offset:12288
    ds_read_b64_tr_b16 v[210:211], v24 offset:12544
    ds_read_b64_tr_b16 v[212:213], v24 offset:12800
    ds_read_b64_tr_b16 v[214:215], v24 offset:13056
    ds_read_b64_tr_b16 v[216:217], v24 offset:12320
    ds_read_b64_tr_b16 v[218:219], v24 offset:12576
    ds_read_b64_tr_b16 v[220:221], v24 offset:12832
    ds_read_b64_tr_b16 v[222:223], v24 offset:13088
    s_waitcnt lgkmcnt(0)
    s_waitcnt vmcnt(32)
    ds_read_b64_tr_b16 v[80:81], v24 offset:16384
    ds_read_b64_tr_b16 v[82:83], v24 offset:16640
    ds_read_b64_tr_b16 v[84:85], v24 offset:16896
    ds_read_b64_tr_b16 v[86:87], v24 offset:17152
    ds_read_b64_tr_b16 v[88:89], v24 offset:16416
    ds_read_b64_tr_b16 v[90:91], v24 offset:16672
    ds_read_b64_tr_b16 v[92:93], v24 offset:16928
    ds_read_b64_tr_b16 v[94:95], v24 offset:17184
    s_waitcnt lgkmcnt(0)
    ds_read_b64_tr_b16 v[128:129], v24 offset:20480
    ds_read_b64_tr_b16 v[130:131], v24 offset:20736
    ds_read_b64_tr_b16 v[132:133], v24 offset:20992
    ds_read_b64_tr_b16 v[134:135], v24 offset:21248
    ds_read_b64_tr_b16 v[136:137], v24 offset:20512
    ds_read_b64_tr_b16 v[138:139], v24 offset:20768
    ds_read_b64_tr_b16 v[140:141], v24 offset:21024
    ds_read_b64_tr_b16 v[142:143], v24 offset:21280
    s_waitcnt lgkmcnt(0)
    ds_read_b64_tr_b16 v[176:177], v24 offset:24576
    ds_read_b64_tr_b16 v[178:179], v24 offset:24832
    ds_read_b64_tr_b16 v[180:181], v24 offset:25088
    ds_read_b64_tr_b16 v[182:183], v24 offset:25344
    ds_read_b64_tr_b16 v[184:185], v24 offset:24608
    ds_read_b64_tr_b16 v[186:187], v24 offset:24864
    ds_read_b64_tr_b16 v[188:189], v24 offset:25120
    ds_read_b64_tr_b16 v[190:191], v24 offset:25376
    s_waitcnt lgkmcnt(0)
    ds_read_b64_tr_b16 v[224:225], v24 offset:28672
    ds_read_b64_tr_b16 v[226:227], v24 offset:28928
    ds_read_b64_tr_b16 v[228:229], v24 offset:29184
    ds_read_b64_tr_b16 v[230:231], v24 offset:29440
    ds_read_b64_tr_b16 v[232:233], v24 offset:28704
    ds_read_b64_tr_b16 v[234:235], v24 offset:28960
    ds_read_b64_tr_b16 v[236:237], v24 offset:29216
    ds_read_b64_tr_b16 v[238:239], v24 offset:29472
    s_waitcnt lgkmcnt(0)
    s_waitcnt vmcnt(16)
    ds_write_b128 v56, v[96:99] offset:0
    ds_write_b128 v56, v[100:103] offset:1024
    ds_write_b128 v56, v[104:107] offset:2048
    ds_write_b128 v56, v[108:111] offset:3072
    ds_write_b128 v56, v[144:147] offset:4096
    ds_write_b128 v56, v[148:151] offset:5120
    ds_write_b128 v56, v[152:155] offset:6144
    ds_write_b128 v56, v[156:159] offset:7168
    ds_write_b128 v26, v[192:195] offset:0
    ds_write_b128 v26, v[196:199] offset:1024
    ds_write_b128 v26, v[200:203] offset:2048
    ds_write_b128 v26, v[204:207] offset:3072
    ds_write_b128 v26, v[240:243] offset:4096
    ds_write_b128 v26, v[244:247] offset:5120
    ds_write_b128 v26, v[248:251] offset:6144
    ds_write_b128 v26, v[252:255] offset:7168
    s_waitcnt lgkmcnt(0)
    ds_read_b64_tr_b16 v[96:97], v24 offset:0
    ds_read_b64_tr_b16 v[98:99], v24 offset:256
    ds_read_b64_tr_b16 v[100:101], v24 offset:512
    ds_read_b64_tr_b16 v[102:103], v24 offset:768
    ds_read_b64_tr_b16 v[104:105], v24 offset:32
    ds_read_b64_tr_b16 v[106:107], v24 offset:288
    ds_read_b64_tr_b16 v[108:109], v24 offset:544
    ds_read_b64_tr_b16 v[110:111], v24 offset:800
    s_waitcnt lgkmcnt(0)
    ds_read_b64_tr_b16 v[144:145], v24 offset:4096
    ds_read_b64_tr_b16 v[146:147], v24 offset:4352
    ds_read_b64_tr_b16 v[148:149], v24 offset:4608
    ds_read_b64_tr_b16 v[150:151], v24 offset:4864
    ds_read_b64_tr_b16 v[152:153], v24 offset:4128
    ds_read_b64_tr_b16 v[154:155], v24 offset:4384
    ds_read_b64_tr_b16 v[156:157], v24 offset:4640
    ds_read_b64_tr_b16 v[158:159], v24 offset:4896
    s_waitcnt lgkmcnt(0)
    ds_read_b64_tr_b16 v[192:193], v24 offset:8192
    ds_read_b64_tr_b16 v[194:195], v24 offset:8448
    ds_read_b64_tr_b16 v[196:197], v24 offset:8704
    ds_read_b64_tr_b16 v[198:199], v24 offset:8960
    ds_read_b64_tr_b16 v[200:201], v24 offset:8224
    ds_read_b64_tr_b16 v[202:203], v24 offset:8480
    ds_read_b64_tr_b16 v[204:205], v24 offset:8736
    ds_read_b64_tr_b16 v[206:207], v24 offset:8992
    s_waitcnt lgkmcnt(0)
    ds_read_b64_tr_b16 v[240:241], v24 offset:12288
    ds_read_b64_tr_b16 v[242:243], v24 offset:12544
    ds_read_b64_tr_b16 v[244:245], v24 offset:12800
    ds_read_b64_tr_b16 v[246:247], v24 offset:13056
    ds_read_b64_tr_b16 v[248:249], v24 offset:12320
    ds_read_b64_tr_b16 v[250:251], v24 offset:12576
    ds_read_b64_tr_b16 v[252:253], v24 offset:12832
    ds_read_b64_tr_b16 v[254:255], v24 offset:13088
    s_waitcnt lgkmcnt(0)
    v_mov_b32 v21, 0x44444444
    v_mov_b32 v22, 0xeeeeeeee
    v_and_b32 v23, 1, v20
    v_cmp_eq_u32 vcc, 0, v23
    v_and_b32 v27, 255, v0
    v_lshlrev_b32 v2, 2, v27
    v_cndmask_b32 v62, v22, v21, vcc
    s_lshr_b32 s21, s15, 1
    s_sub_u32 s21, s21, s15
    s_add_u32 s21, s21, 4
    s_lshl_b32 s21, s21, 10
    s_and_b32 s22, s15, 1
    s_lshl_b32 s22, s22, 9
    s_add_u32 s21, s21, s22
    s_lshl_b32 s22, s3, 7
    s_add_u32 s21, s21, s22
    v_and_b32 v21, 31, v20
    v_lshlrev_b32 v21, 2, v21
    v_add_u32 v3, s21, v21
    v_lshrrev_b32 v21, 4, v20
    v_and_b32 v22, 15, v20
    v_mul_u32_u24 v21, 208, v21
    v_add_lshl_u32 v21, v21, v22, 2
    s_mul_i32 s21, s3, 3328
    v_add_u32 v4, s21, v21
    v_lshrrev_b32 v21, 4, v20
    v_bfe_u32 v22, v20, 2, 1
    v_lshl_add_u32 v21, v21, 1, v22
    v_mul_u32_u24 v21, 104, v21
    v_bfe_u32 v22, v20, 3, 1
    v_xor_b32 v22, 1, v22
    v_lshl_add_u32 v21, v22, 5, v21
    v_and_b32 v22, 3, v20
    v_lshlrev_b32 v22, 1, v22
    s_and_b32 s21, s3, 1
    s_lshl_b32 s21, s21, 2
    v_xor_b32 v22, s21, v22
    v_add_u32 v21, v21, v22
    s_lshl_b32 s21, s3, 3
    v_add_u32 v21, s21, v21
    v_lshlrev_b32 v5, 2, v21
    s_and_b32 s21, s3, 1
    s_lshl_b32 s21, s21, 2
    v_bfe_u32 v21, v20, 3, 2
    v_add_u32 v21, s21, v21
    v_mul_u32_u24 v21, 104, v21
    v_bfe_u32 v22, v20, 1, 1
    v_lshl_add_u32 v21, v22, 3, v21
    v_and_b32 v23, 1, v20
    v_xor_b32 v22, v22, v23
    v_lshl_add_u32 v21, v22, 2, v21
    v_bfe_u32 v22, v20, 2, 1
    v_lshl_add_u32 v21, v22, 1, v21
    s_lshr_b32 s21, s3, 1
    s_lshl_b32 s21, s21, 4
    s_add_u32 s21, s21, 64
    v_add_u32 v21, s21, v21
    v_lshlrev_b32 v6, 2, v21
    v_lshrrev_b32 v21, 6, v27
    v_bfe_u32 v22, v27, 1, 1
    v_lshrrev_b32 v23, 1, v21
    v_lshl_add_u32 v22, v22, 1, v23
    v_xor_b32 v23, v27, v22
    v_and_b32 v23, 1, v23
    v_and_b32 v21, 1, v21
    v_lshl_add_u32 v21, v21, 1, v23
    v_mul_u32_u24 v21, 544, v21
    v_lshl_add_u32 v21, v22, 5, v21
    v_bfe_u32 v23, v27, 4, 2
    v_mul_u32_u24 v23, 136, v23
    v_add_u32 v21, v21, v23
    v_bfe_u32 v24, v27, 3, 1
    v_lshl_add_u32 v21, v24, 2, v21
    v_bfe_u32 v24, v27, 2, 1
    v_lshl_add_u32 v21, v24, 4, v21
    v_add_u32 v7, 16384, v21
    v_lshlrev_b32 v8, 2, v20
    s_and_b32 s21, s12, 1
    s_lshl_b32 s21, s21, 9
    s_lshl_b32 s22, s3, 7
    s_add_u32 s21, s21, s22
    v_and_b32 v21, 7, v20
    v_lshlrev_b32 v21, 4, v21
    v_add_u32 v21, s21, v21
    v_lshrrev_b32 v22, 3, v20
    v_lshl_add_u32 v12, v22, 10, v21
    v_bfe_u32 v22, v20, 4, 1
    v_lshl_add_u32 v13, v22, 3, v21
    s_and_b32 s21, s3, 1
    s_lshl_b32 s21, s21, 12
    s_lshr_b32 s22, s3, 1
    s_lshl_b32 s22, s22, 11
    s_add_u32 s21, s21, s22
    s_add_u32 s21, s21, 18560
    v_add_u32 v61, s21, v1
    s_lshl_b32 s21, s3, 2
    s_add_u32 s21, s21, 13312
    v_mov_b32 v14, s21
    v_and_b32 v21, 15, v20
    v_and_b32 v22, 1, v20
    v_lshlrev_b32 v22, 4, v22
    v_mov_b32 v23, 0x3f80
    v_lshlrev_b32 v22, v22, v23
    v_lshrrev_b32 v21, 1, v21
    v_cmp_eq_u32 vcc, 0, v21
    s_nop 1
    v_cndmask_b32 v56, 0, v22, vcc
    v_cmp_eq_u32 vcc, 1, v21
    s_nop 1
    v_cndmask_b32 v57, 0, v22, vcc
    v_cmp_eq_u32 vcc, 2, v21
    s_nop 1
    v_cndmask_b32 v58, 0, v22, vcc
    v_cmp_eq_u32 vcc, 3, v21
    s_nop 1
    v_cndmask_b32 v59, 0, v22, vcc
    v_and_b32 v21, 7, v20
    v_lshlrev_b32 v21, 7, v21
    v_bfe_u32 v22, v20, 3, 1
    v_lshl_add_u32 v21, v22, 17, v21
    s_lshl_b32 s21, s12, 14
    s_lshl_b32 s22, s13, 10
    s_add_u32 s21, s21, s22
    s_add_u32 s21, s21, 4980736
    v_lshrrev_b32 v22, 4, v20
    v_lshl_add_u32 v21, v22, 24, v21
    v_add_u32 v63, s21, v21
    s_mov_b32 s47, 0x3e0293ee
    s_lshl_b32 s14, s12, 2
    s_add_u32 s14, s14, s3
    s_lshl_b32 s61, s14, 13
    s_add_u32 s61, s61, 2097152
    s_lshl_b32 s14, s14, 12
    s_and_b32 s22, s13, 1
    s_lshl_b32 s69, s22, 17
    s_add_u32 s69, s69, s14
    s_add_u32 s69, s69, 4194304
    s_add_u32 s52, s14, 20971520
    s_lshl_b32 s21, s22, 11
    s_add_u32 s14, s14, s21
    s_add_u32 s14, s14, 1179648
    s_lshr_b32 s21, s13, 1
    s_sub_u32 s21, s21, 0
    s_cmp_eq_u32 s21, s3
    s_cselect_b32 s15, 1, 0
    s_add_u32 s23, s3, 3
    s_and_b32 s23, s23, 3
    s_cmp_eq_u32 s21, s23
    s_cselect_b32 s31, 1, 0
    s_and_b32 s24, s23, 1
    s_and_b32 s25, s3, 1
    s_sub_i32 s24, s24, s25
    s_lshr_b32 s23, s23, 1
    s_lshr_b32 s25, s3, 1
    s_sub_i32 s23, s23, s25
    s_mul_i32 s46, s24, 4096
    s_mul_i32 s25, s23, 2048
    s_add_i32 s46, s46, s25
    s_mul_i32 s27, s24, 32768
    s_mul_i32 s25, s23, 1024
    s_add_i32 s27, s27, s25
    v_lshrrev_b32 v21, 4, v20
    v_and_b32 v23, 15, v20
    v_lshlrev_b32 v21, 2, v21
    v_add_u32 v24, 0, v21
    v_cmp_gt_u32 vcc, v24, v23
    s_cmp_eq_u32 s22, 0
    s_cselect_b64 s[38:39], vcc, 0
    s_cselect_b64 s[48:49], -1, vcc
    v_add_u32 v24, 1, v21
    v_cmp_gt_u32 vcc, v24, v23
    s_cmp_eq_u32 s22, 0
    s_cselect_b64 s[40:41], vcc, 0
    s_cselect_b64 s[50:51], -1, vcc
    v_add_u32 v24, 2, v21
    v_cmp_gt_u32 vcc, v24, v23
    s_cmp_eq_u32 s22, 0
    s_cselect_b64 s[42:43], vcc, 0
    s_cselect_b64 s[54:55], -1, vcc
    v_add_u32 v24, 3, v21
    v_cmp_gt_u32 vcc, v24, v23
    s_cmp_eq_u32 s22, 0
    s_cselect_b64 s[44:45], vcc, 0
    s_cselect_b64 s[56:57], -1, vcc
    s_waitcnt vmcnt(0)
    v_mov_b32 v16, v32
    v_mov_b32 v17, v33
    v_mov_b32 v18, v34
    v_mov_b32 v19, v35
    v_mov_b32 v20, v36
    v_mov_b32 v21, v37
    v_mov_b32 v22, v38
    v_mov_b32 v23, v39
    v_mov_b32 v24, v40
    v_mov_b32 v25, v41
    v_mov_b32 v26, v42
    v_mov_b32 v27, v43
    v_mov_b32 v28, v44
    v_mov_b32 v29, v45
    v_mov_b32 v30, v46
    v_mov_b32 v31, v47
    v_mov_b32 v32, -1
    v_mov_b32 v33, -1
    v_mov_b32 v34, -1
    v_mov_b32 v35, -1
    s_add_u32 s21, s37, 3997696
    buffer_store_dwordx4 v[32:35], v1, s[4:7], s21 offen sc1
    s_add_u32 s21, s37, 4063232
    buffer_store_dwordx4 v[32:35], v1, s[4:7], s21 offen sc1
    s_add_u32 s21, s37, 4128768
    buffer_store_dwordx4 v[32:35], v1, s[4:7], s21 offen sc1
    s_lshl_b32 s29, s29, 5
    s_barrier
    ds_write_b32 v14, v10
    ds_write_b32 v14, v10 offset:16
    ds_write_b32 v14, v10 offset:32
    s_lshl_b32 s53, s3, 13
    s_add_u32 s53, s53, 92160
    v_add_u32 v32, 14336, v1
    ds_write_b128 v32, v[56:59]
    s_lshl_b32 s60, s12, 4
    s_add_u32 s60, s60, 218104320
    v_mov_b32 v15, 0
    s_add_u32 s25, s16, 0
    s_min_u32 s25, s25, 63
    s_cmp_lt_u32 s25, 8
    s_cselect_b32 s59, 12, 24
    s_cselect_b32 s58, -4, -8
    s_and_b32 s25, s25, s58
    s_lshl_b32 s25, s25, 5
    s_add_u32 s58, s25, s60
    v_mov_b32 v32, 131072
    s_waitcnt vmcnt(0) lgkmcnt(0)
    s_barrier
    ds_read_b64 v[32:33], v32
    s_waitcnt lgkmcnt(0)
    v_cmp_ne_u32 vcc, s29, v32
    s_setprio 3
    v_readfirstlane_b32 s63, v33
    s_add_u32 s34, s34, s63
    s_add_u32 s35, s35, s63
    s_cbranch_vccnz ch_p_slow
    v_mov_b32 v32, 0
    v_mov_b32 v33, 0
    v_mov_b32 v34, 0
    v_mov_b32 v35, 0
    v_mov_b32 v36, 0
    v_mov_b32 v37, 0
    v_mov_b32 v38, 0
    v_mov_b32 v39, 0
    v_mov_b32 v40, 0
    v_mov_b32 v41, 0
    v_mov_b32 v42, 0
    v_mov_b32 v43, 0
    v_mov_b32 v44, 0
    v_mov_b32 v45, 0
    v_mov_b32 v46, 0
    v_mov_b32 v47, 0
    v_mov_b32 v48, 0
    v_mov_b32 v49, 0
    v_mov_b32 v50, 0
    v_mov_b32 v51, 0
    v_mov_b32 v52, 0
    v_mov_b32 v53, 0
    v_mov_b32 v54, 0
    v_mov_b32 v55, 0
    v_mov_b32 v0, 1.0
    s_mov_b32 exec_lo, 0xff00ff00
    s_mov_b32 exec_hi, 0xff00ff00
    v_mov_b32 v0, s47
    s_mov_b64 exec, -1
    v_mov_b32 v60, s16
    s_branch pnc_7
.p2align 6
ploop_6:
    s_add_u32 s21, s17, s33
    s_nop 15
    s_nop 5
    buffer_load_dwordx4 v[16:19], v1, s[4:7], s21 offen offset:0 sc1
    s_nop 7
    buffer_load_dwordx4 v[20:23], v1, s[4:7], s21 offen offset:1024 sc1
    s_nop 7
    buffer_load_dwordx4 v[24:27], v1, s[4:7], s21 offen offset:2048 sc1
    s_nop 7
    buffer_load_dwordx4 v[28:31], v1, s[4:7], s21 offen offset:3072 sc1
    s_waitcnt vmcnt(3)
    v_max3_u32 v9, v16, v17, v18
    v_max_u32 v9, v9, v19
    v_cmp_eq_u32 vcc, -1, v9
    s_cbranch_vccnz prm_9_0
prm_9_0ok:
    v_smfmac_f32_16x16x64_bf16 v[32:35], v[16:19], v[64:71], v62
    v_smfmac_f32_16x16x64_bf16 v[36:39], v[16:19], v[72:79], v62
    v_smfmac_f32_16x16x64_bf16 v[40:43], v[16:19], v[80:87], v62
    s_waitcnt vmcnt(2)
    v_max3_u32 v9, v20, v21, v22
    v_max_u32 v9, v9, v23
    v_cmp_eq_u32 vcc, -1, v9
    v_smfmac_f32_16x16x64_bf16 v[44:47], v[16:19], v[88:95], v62
    v_smfmac_f32_16x16x64_bf16 v[48:51], v[16:19], v[96:103], v62
    v_smfmac_f32_16x16x64_bf16 v[52:55], v[16:19], v[104:111], v62
    s_cbranch_vccnz prm_9_1
prm_9_1ok:
    v_smfmac_f32_16x16x64_bf16 v[32:35], v[20:23], v[112:119], v62
    v_readfirstlane_b32 s23, v15
    v_smfmac_f32_16x16x64_bf16 v[36:39], v[20:23], v[120:127], v62
    v_smfmac_f32_16x16x64_bf16 v[40:43], v[20:23], v[128:135], v62
    s_waitcnt vmcnt(1)
    v_max3_u32 v9, v24, v25, v26
    v_max_u32 v9, v9, v27
    v_cmp_eq_u32 vcc, -1, v9
    v_smfmac_f32_16x16x64_bf16 v[44:47], v[20:23], v[136:143], v62
    v_smfmac_f32_16x16x64_bf16 v[48:51], v[20:23], v[144:151], v62
    v_smfmac_f32_16x16x64_bf16 v[52:55], v[20:23], v[152:159], v62
    s_cbranch_vccnz prm_9_2
prm_9_2ok:
    v_smfmac_f32_16x16x64_bf16 v[32:35], v[24:27], v[160:167], v62
    v_smfmac_f32_16x16x64_bf16 v[36:39], v[24:27], v[168:175], v62
    v_smfmac_f32_16x16x64_bf16 v[40:43], v[24:27], v[176:183], v62
    s_waitcnt vmcnt(0)
    v_max3_u32 v9, v28, v29, v30
    v_max_u32 v9, v9, v31
    v_cmp_eq_u32 vcc, -1, v9
    v_smfmac_f32_16x16x64_bf16 v[44:47], v[24:27], v[184:191], v62
    v_smfmac_f32_16x16x64_bf16 v[48:51], v[24:27], v[192:199], v62
    v_smfmac_f32_16x16x64_bf16 v[52:55], v[24:27], v[200:207], v62
    s_cbranch_vccnz prm_9_3
prm_9_3ok:
    v_smfmac_f32_16x16x64_bf16 v[32:35], v[28:31], v[208:215], v62
    s_cmp_lt_u32 s23, s59
    s_cbranch_scc1 prm_9_gt
prm_9_gtb:
    ds_write_b32 v14, v60
    v_smfmac_f32_16x16x64_bf16 v[36:39], v[28:31], v[216:223], v62
    v_smfmac_f32_16x16x64_bf16 v[40:43], v[28:31], v[224:231], v62
    v_smfmac_f32_16x16x64_bf16 v[44:47], v[28:31], v[232:239], v62
    v_add_f32 v32, v32, v33
    v_add_f32 v34, v34, v35
    v_smfmac_f32_16x16x64_bf16 v[48:51], v[28:31], v[240:247], v62
    v_add_f32 v36, v36, v37
    v_add_f32 v38, v38, v39
    ds_write2_b32 v4, v32, v34 offset0:0 offset1:104
    v_smfmac_f32_16x16x64_bf16 v[52:55], v[28:31], v[248:255], v62
    v_add_f32 v40, v40, v41
    v_add_f32 v42, v42, v43
    ds_write2_b32 v4, v36, v38 offset0:16 offset1:120
    v_add_f32 v44, v44, v45
    v_add_f32 v46, v46, v47
    ds_write2_b32 v4, v40, v42 offset0:32 offset1:136
    v_add_f32 v48, v48, v49
    v_add_f32 v50, v50, v51
    ds_write2_b32 v4, v44, v46 offset0:48 offset1:152
    v_add_f32 v52, v52, v53
    v_add_f32 v54, v54, v55
    ds_write2_b32 v4, v48, v50 offset0:64 offset1:168
    ds_write2_b32 v4, v52, v54 offset0:80 offset1:184
    s_branch pnc_7_done
pnc_7:
    v_smfmac_f32_16x16x64_bf16 v[32:35], v[16:19], v[64:71], v62
    v_smfmac_f32_16x16x64_bf16 v[36:39], v[16:19], v[72:79], v62
    v_smfmac_f32_16x16x64_bf16 v[40:43], v[16:19], v[80:87], v62
    v_smfmac_f32_16x16x64_bf16 v[44:47], v[16:19], v[88:95], v62
    v_smfmac_f32_16x16x64_bf16 v[48:51], v[16:19], v[96:103], v62
    v_smfmac_f32_16x16x64_bf16 v[52:55], v[16:19], v[104:111], v62
    v_smfmac_f32_16x16x64_bf16 v[32:35], v[20:23], v[112:119], v62
    v_smfmac_f32_16x16x64_bf16 v[36:39], v[20:23], v[120:127], v62
    v_smfmac_f32_16x16x64_bf16 v[40:43], v[20:23], v[128:135], v62
    v_smfmac_f32_16x16x64_bf16 v[44:47], v[20:23], v[136:143], v62
    v_smfmac_f32_16x16x64_bf16 v[48:51], v[20:23], v[144:151], v62
    v_smfmac_f32_16x16x64_bf16 v[52:55], v[20:23], v[152:159], v62
    v_smfmac_f32_16x16x64_bf16 v[32:35], v[24:27], v[160:167], v62
    v_smfmac_f32_16x16x64_bf16 v[36:39], v[24:27], v[168:175], v62
    v_smfmac_f32_16x16x64_bf16 v[40:43], v[24:27], v[176:183], v62
    v_smfmac_f32_16x16x64_bf16 v[44:47], v[24:27], v[184:191], v62
    v_smfmac_f32_16x16x64_bf16 v[48:51], v[24:27], v[192:199], v62
    v_smfmac_f32_16x16x64_bf16 v[52:55], v[24:27], v[200:207], v62
    v_smfmac_f32_16x16x64_bf16 v[32:35], v[28:31], v[208:215], v62
    ds_write_b32 v14, v60
    v_smfmac_f32_16x16x64_bf16 v[36:39], v[28:31], v[216:223], v62
    v_smfmac_f32_16x16x64_bf16 v[40:43], v[28:31], v[224:231], v62
    v_smfmac_f32_16x16x64_bf16 v[44:47], v[28:31], v[232:239], v62
    v_add_f32 v32, v32, v33
    v_add_f32 v34, v34, v35
    v_smfmac_f32_16x16x64_bf16 v[48:51], v[28:31], v[240:247], v62
    v_add_f32 v36, v36, v37
    v_add_f32 v38, v38, v39
    ds_write2_b32 v4, v32, v34 offset0:0 offset1:104
    v_smfmac_f32_16x16x64_bf16 v[52:55], v[28:31], v[248:255], v62
    v_add_f32 v40, v40, v41
    v_add_f32 v42, v42, v43
    ds_write2_b32 v4, v36, v38 offset0:16 offset1:120
    v_add_f32 v44, v44, v45
    v_add_f32 v46, v46, v47
    ds_write2_b32 v4, v40, v42 offset0:32 offset1:136
    v_add_f32 v48, v48, v49
    v_add_f32 v50, v50, v51
    ds_write2_b32 v4, v44, v46 offset0:48 offset1:152
    v_add_f32 v52, v52, v53
    v_add_f32 v54, v54, v55
    ds_write2_b32 v4, v48, v50 offset0:64 offset1:168
    ds_write2_b32 v4, v52, v54 offset0:80 offset1:184
    s_waitcnt vmcnt(0)
pnc_7_done:
    s_add_u32 s21, s17, s32
    s_add_u32 s22, s19, s32
    s_add_u32 s24, s19, s35
    s_waitcnt lgkmcnt(0)
    s_barrier
    ds_read_b64 v[32:33], v5 offset:0
    ds_read_b64 v[34:35], v5 offset:3328
    ds_read_b64 v[36:37], v5 offset:6656
    ds_read_b64 v[38:39], v5 offset:9984
    ds_read_b64 v[40:41], v6 offset:0
    ds_read_b64 v[42:43], v6 offset:3328
    ds_read_b64 v[44:45], v6 offset:6656
    ds_read_b64 v[46:47], v6 offset:9984
    s_waitcnt lgkmcnt(6)
    v_add_f32 v32, v32, v34
    v_add_f32 v33, v33, v35
    s_waitcnt lgkmcnt(4)
    v_add_f32 v36, v36, v38
    v_add_f32 v37, v37, v39
    v_add_f32 v32, v32, v36
    v_add_f32 v33, v33, v37
    v_mul_f32 v32, v32, v0
    v_mul_f32 v33, v33, v0
    v_cvt_pk_bf16_f32 v32, v32, v33
    v_min_u32 v32, -2, v32
    buffer_store_dword v32, v2, s[4:7], s21 offen
    s_waitcnt lgkmcnt(2)
    v_add_f32 v40, v40, v42
    v_add_f32 v41, v41, v43
    s_waitcnt lgkmcnt(0)
    v_add_f32 v44, v44, v46
    v_add_f32 v45, v45, v47
    v_add_f32 v40, v40, v44
    v_add_f32 v41, v41, v45
    v_cvt_pk_bf16_f32 v40, v40, v41
    v_min_u32 v40, -2, v40
    s_mov_b32 exec_hi, 0
    buffer_store_dword v40, v3, s[4:7], s21 offen
    s_setprio 0
    s_mov_b64 exec, -1
    s_add_u32 s21, s17, s35
    s_add_u32 s30, s17, s34
    s_add_u32 s23, s18, s36
    s_cmp_lg_u32 s16, 0
    s_cbranch_scc1 ploop_6_n0
gate_11:
    v_readfirstlane_b32 s25, v15
    s_cmp_ge_u32 s25, s59
    s_cbranch_scc1 gate_11_ok
    s_sleep 8
    buffer_load_dword v15, off, s[4:7], s58 sc1
    s_waitcnt vmcnt(0)
    s_sub_u32 s26, s26, 1
    s_cbranch_scc0 gate_11
    s_mov_b32 s26, 0
gate_11_ok:
    s_cmp_eq_u32 s15, 0
    s_cbranch_scc1 ploop_6_st_nk
    s_add_u32 m0, s53, 0
    s_add_u32 s22, s52, 0
    buffer_load_dwordx4 v1, s[4:7], s22 offen offset:0 sc1 lds
    buffer_load_dwordx4 v1, s[4:7], s22 offen offset:1024 sc1 lds
    buffer_load_dwordx4 v1, s[4:7], s22 offen offset:2048 sc1 lds
    buffer_load_dwordx4 v1, s[4:7], s22 offen offset:3072 sc1 lds
    s_add_u32 m0, s53, 4096
    s_add_u32 s22, s52, 131072
    buffer_load_dwordx4 v1, s[4:7], s22 offen offset:0 sc1 lds
    buffer_load_dwordx4 v1, s[4:7], s22 offen offset:1024 sc1 lds
    buffer_load_dwordx4 v1, s[4:7], s22 offen offset:2048 sc1 lds
    buffer_load_dwordx4 v1, s[4:7], s22 offen offset:3072 sc1 lds
    s_add_u32 s52, s52, 262144
    s_sub_u32 s52, s52, 262144
ploop_6_st_nk:
    s_add_u32 s52, s52, 262144
    s_cmp_lg_u32 s3, 2
    s_cbranch_scc1 ploop_6_st_npf
    v_subrev_u32 v32, 786432, v63
    s_mov_b32 exec_hi, 0xffff
    s_mov_b32 s22, 262144
    buffer_load_dword v33, v32, s[4:7], s22 offen sc1
    s_mov_b32 s22, 524288
    buffer_load_dword v33, v32, s[4:7], s22 offen sc1
    s_mov_b32 exec_hi, -1
    s_waitcnt vmcnt(0)
ploop_6_st_npf:
    s_cmp_eq_u32 s15, 0
    s_cbranch_scc1 ploop_6_st_p_nd
    s_mov_b32 m0, 124928
    s_nop 0
    buffer_load_dwordx4 v1, s[4:7], s69 offen offset:0 sc1 lds
    buffer_load_dwordx4 v1, s[4:7], s69 offen offset:1024 sc1 lds
    buffer_load_dwordx4 v1, s[4:7], s69 offen offset:2048 sc1 lds
    buffer_load_dwordx4 v1, s[4:7], s69 offen offset:3072 sc1 lds
    s_add_u32 s69, s69, 262144
    s_waitcnt vmcnt(0)
ploop_6_st_p_nd:
ploop_6_n0:
    s_add_u32 s25, s16, 2
    s_min_u32 s25, s25, 63
    s_cmp_lt_u32 s25, 8
    s_cselect_b32 s59, 12, 24
    s_cselect_b32 s58, -4, -8
    s_and_b32 s25, s25, s58
    s_lshl_b32 s25, s25, 5
    s_add_u32 s58, s25, s60
    s_cmp_eq_u32 s15, 0
    s_cbranch_scc1 ploop_6_nd
    v_add_u32 v9, s53, v1
    v_add_u32 v0, 124928, v1
    ds_read_b128 v[16:19], v0 offset:0
    ds_read_b128 v[32:35], v9 offset:0
    ds_read_b128 v[20:23], v0 offset:1024
    ds_read_b128 v[36:39], v9 offset:1024
    ds_read_b128 v[24:27], v0 offset:2048
    ds_read_b128 v[40:43], v9 offset:2048
    ds_read_b128 v[28:31], v0 offset:3072
    ds_read_b128 v[44:47], v9 offset:3072
    s_add_u32 s22, s17, s61
    s_waitcnt lgkmcnt(6)
    v_mfma_f32_16x16x32_bf16 v[48:51], v[32:35], v[16:19], 0
    ds_read_b128 v[32:35], v9 offset:4096
    s_waitcnt lgkmcnt(5)
    v_mfma_f32_16x16x32_bf16 v[48:51], v[36:39], v[20:23], v[48:51]
    ds_read_b128 v[36:39], v9 offset:5120
    s_waitcnt lgkmcnt(4)
    v_mfma_f32_16x16x32_bf16 v[48:51], v[40:43], v[24:27], v[48:51]
    ds_read_b128 v[40:43], v9 offset:6144
    s_waitcnt lgkmcnt(3)
    v_mfma_f32_16x16x32_bf16 v[48:51], v[44:47], v[28:31], v[48:51]
    ds_read_b128 v[44:47], v9 offset:7168
    s_waitcnt lgkmcnt(3)
    v_mfma_f32_16x16x32_bf16 v[52:55], v[32:35], v[16:19], 0
    s_waitcnt lgkmcnt(2)
    v_mfma_f32_16x16x32_bf16 v[52:55], v[36:39], v[20:23], v[52:55]
    s_waitcnt lgkmcnt(1)
    v_mfma_f32_16x16x32_bf16 v[52:55], v[40:43], v[24:27], v[52:55]
    s_waitcnt lgkmcnt(0)
    v_mfma_f32_16x16x32_bf16 v[52:55], v[44:47], v[28:31], v[52:55]
    buffer_load_dwordx4 v[32:35], v1, s[4:7], s22 offen offset:0 sc1
    buffer_load_dwordx4 v[36:39], v1, s[4:7], s22 offen offset:1024 sc1
    buffer_load_dwordx4 v[40:43], v1, s[4:7], s22 offen offset:2048 sc1
    buffer_load_dwordx4 v[44:47], v1, s[4:7], s22 offen offset:3072 sc1
    v_mov_b32 v60, 0xff61b1e6
    s_nop 2
    v_cndmask_b32 v48, v48, v60, s[38:39]
    v_cndmask_b32 v49, v49, v60, s[40:41]
    v_cndmask_b32 v50, v50, v60, s[42:43]
    v_cndmask_b32 v51, v51, v60, s[44:45]
    v_cndmask_b32 v52, v52, v60, s[48:49]
    v_cndmask_b32 v53, v53, v60, s[50:51]
    v_cndmask_b32 v54, v54, v60, s[54:55]
    v_cndmask_b32 v55, v55, v60, s[56:57]
    v_max3_f32 v0, v48, v49, v50
    v_max3_f32 v9, v51, v52, v53
    v_max3_f32 v0, v0, v54, v55
    v_max_f32 v0, v0, v9
    v_mov_b32 v9, v0
    s_nop 1
    v_permlane16_swap_b32 v9, v0
    v_max_f32 v0, v0, v9
    v_mov_b32 v9, v0
    s_nop 1
    v_permlane32_swap_b32 v9, v0
    v_max_f32 v0, v0, v9
    v_mul_f32 v0, s47, v0
    v_fma_f32 v48, v48, s47, -v0
    v_fma_f32 v49, v49, s47, -v0
    v_fma_f32 v50, v50, s47, -v0
    v_fma_f32 v51, v51, s47, -v0
    v_fma_f32 v52, v52, s47, -v0
    v_fma_f32 v53, v53, s47, -v0
    v_fma_f32 v54, v54, s47, -v0
    v_fma_f32 v55, v55, s47, -v0
    v_exp_f32 v48, v48
    v_exp_f32 v49, v49
    v_exp_f32 v50, v50
    v_exp_f32 v51, v51
    v_exp_f32 v52, v52
    v_exp_f32 v53, v53
    v_exp_f32 v54, v54
    v_exp_f32 v55, v55
    v_add_f32 v15, v48, v49
    v_add_f32 v15, v15, v50
    v_add_f32 v15, v15, v51
    v_add_f32 v15, v15, v52
    v_add_f32 v15, v15, v53
    v_add_f32 v15, v15, v54
    v_add_f32 v15, v15, v55
ploop_6_za:
    s_waitcnt vmcnt(0)
    v_max3_u32 v9, v32, v33, v34
    v_max3_u32 v9, v9, v35, v36
    v_max3_u32 v9, v9, v37, v38
    v_max3_u32 v9, v9, v39, v40
    v_max3_u32 v9, v9, v41, v42
    v_max3_u32 v9, v9, v43, v44
    v_max3_u32 v9, v9, v45, v46
    v_max_u32 v9, v9, v47
    v_cmp_eq_u32 vcc, -1, v9
    s_cbranch_vccnz ploop_6_zr
ploop_6_zok:
    v_mfma_f32_16x16x32_bf16 v[56:59], v[32:35], v[16:19], 0
    v_mfma_f32_16x16x32_bf16 v[56:59], v[36:39], v[20:23], v[56:59]
    v_mfma_f32_16x16x32_bf16 v[56:59], v[40:43], v[24:27], v[56:59]
    v_mfma_f32_16x16x32_bf16 v[56:59], v[44:47], v[28:31], v[56:59]
    s_add_u32 s22, s17, s14
    s_nop 6
    v_max_f32 v60, v56, v57
    v_mov_b32 v9, v60
    s_nop 1
    v_permlane16_swap_b32 v9, v60
    v_max_f32 v60, v60, v9
    v_mov_b32 v9, v60
    s_nop 1
    v_permlane32_swap_b32 v9, v60
    v_max_f32 v60, v60, v9
    v_mul_f32 v60, s47, v60
    v_max_f32 v58, v60, v0
    v_sub_f32 v60, v0, v58
    v_fma_f32 v56, v56, s47, -v58
    v_fma_f32 v57, v57, s47, -v58
    v_exp_f32 v60, v60
    v_exp_f32 v56, v56
    v_exp_f32 v57, v57
    v_fma_f32 v15, v15, v60, v56
    v_add_f32 v15, v15, v57
    v_mov_b32 v9, v15
    s_nop 1
    v_permlane16_swap_b32 v9, v15
    v_add_f32 v15, v15, v9
    v_mov_b32 v9, v15
    s_nop 1
    v_permlane32_swap_b32 v9, v15
    v_add_f32 v15, v15, v9
    v_rcp_f32 v15, v15
    s_add_u32 s25, s19, s14
    v_mul_f32 v56, v56, v15
    v_mul_f32 v57, v57, v15
    v_mul_f32 v60, v60, v15
    v_mul_f32 v48, v48, v60
    v_mul_f32 v49, v49, v60
    v_mul_f32 v50, v50, v60
    v_mul_f32 v51, v51, v60
    v_mul_f32 v52, v52, v60
    v_mul_f32 v53, v53, v60
    v_mul_f32 v54, v54, v60
    v_mul_f32 v55, v55, v60
    v_cvt_pk_bf16_f32 v48, v48, v49
    v_cvt_pk_bf16_f32 v49, v50, v51
    v_cvt_pk_bf16_f32 v50, v52, v53
    v_cvt_pk_bf16_f32 v51, v54, v55
    v_min_u32 v48, -2, v48
    v_min_u32 v49, -2, v49
    v_min_u32 v50, -2, v50
    v_min_u32 v51, -2, v51
    v_lshlrev_b32 v54, 1, v8
    v_add_u32 v55, 14336, v1
    v_mov_b32 v53, 1.0
    v_cvt_pk_bf16_f32 v52, v56, v57
    v_min_u32 v53, -2, v53
    v_min_u32 v52, -2, v52
    buffer_store_dwordx4 v[48:51], v1, s[4:7], s22 offen
    buffer_store_dwordx2 v[52:53], v54, s[4:7], s22 offen offset:1024
    ds_read_b128 v[56:59], v55
    s_branch ploop_6_nd2
ploop_6_nd:
    s_cmp_eq_u32 s16, 0
    s_cbranch_scc1 ploop_6_ns
    s_cmp_eq_u32 s31, 0
    s_cbranch_scc1 ploop_6_n2
    s_add_u32 s25, s68, s46
    v_add_u32 v55, s25, v61
    ds_read_b128 v[24:27], v55 offset:0
    ds_read_b128 v[28:31], v55 offset:1024
    ds_read_b128 v[32:35], v55 offset:18560
    ds_read_b128 v[36:39], v55 offset:19584
    ds_read_b128 v[40:43], v55 offset:37120
    ds_read_b128 v[44:47], v55 offset:38144
    ds_read_b128 v[48:51], v55 offset:55680
    ds_read_b128 v[52:55], v55 offset:56704
    s_waitcnt lgkmcnt(4)
    v_add_f32 v24, v24, v32
    v_add_f32 v25, v25, v33
    v_add_f32 v26, v26, v34
    v_add_f32 v27, v27, v35
    v_add_f32 v28, v28, v36
    v_add_f32 v29, v29, v37
    v_add_f32 v30, v30, v38
    v_add_f32 v31, v31, v39
    s_waitcnt lgkmcnt(0)
    v_add_f32 v40, v40, v48
    v_add_f32 v41, v41, v49
    v_add_f32 v42, v42, v50
    v_add_f32 v43, v43, v51
    v_add_f32 v44, v44, v52
    v_add_f32 v45, v45, v53
    v_add_f32 v46, v46, v54
    v_add_f32 v47, v47, v55
    v_add_f32 v24, v24, v40
    v_add_f32 v25, v25, v41
    v_add_f32 v26, v26, v42
    v_add_f32 v27, v27, v43
    v_add_f32 v28, v28, v44
    v_add_f32 v29, v29, v45
    v_add_f32 v30, v30, v46
    v_add_f32 v31, v31, v47
    v_cvt_pk_bf16_f32 v24, v24, v25
    v_cvt_pk_bf16_f32 v25, v26, v27
    v_cvt_pk_bf16_f32 v26, v28, v29
    v_cvt_pk_bf16_f32 v27, v30, v31
    v_min_u32 v24, -2, v24
    v_min_u32 v25, -2, v25
    v_min_u32 v26, -2, v26
    v_min_u32 v27, -2, v27
    v_mov_b32 v16, v24
    v_mov_b32 v17, v25
    v_mov_b32 v18, v26
    v_mov_b32 v19, v27
ploop_6_n2:
    v_add_u32 v55, s68, v61
    ds_read_b128 v[24:27], v55 offset:0
    ds_read_b128 v[28:31], v55 offset:1024
    ds_read_b128 v[32:35], v55 offset:18560
    ds_read_b128 v[36:39], v55 offset:19584
    ds_read_b128 v[40:43], v55 offset:37120
    ds_read_b128 v[44:47], v55 offset:38144
    ds_read_b128 v[48:51], v55 offset:55680
    ds_read_b128 v[52:55], v55 offset:56704
    s_waitcnt lgkmcnt(4)
    v_add_f32 v24, v24, v32
    v_add_f32 v25, v25, v33
    v_add_f32 v26, v26, v34
    v_add_f32 v27, v27, v35
    v_add_f32 v28, v28, v36
    v_add_f32 v29, v29, v37
    v_add_f32 v30, v30, v38
    v_add_f32 v31, v31, v39
    s_waitcnt lgkmcnt(0)
    v_add_f32 v40, v40, v48
    v_add_f32 v41, v41, v49
    v_add_f32 v42, v42, v50
    v_add_f32 v43, v43, v51
    v_add_f32 v44, v44, v52
    v_add_f32 v45, v45, v53
    v_add_f32 v46, v46, v54
    v_add_f32 v47, v47, v55
    v_add_f32 v24, v24, v40
    v_add_f32 v25, v25, v41
    v_add_f32 v26, v26, v42
    v_add_f32 v27, v27, v43
    v_add_f32 v28, v28, v44
    v_add_f32 v29, v29, v45
    v_add_f32 v30, v30, v46
    v_add_f32 v31, v31, v47
    v_cvt_pk_bf16_f32 v24, v24, v25
    v_cvt_pk_bf16_f32 v25, v26, v27
    v_cvt_pk_bf16_f32 v26, v28, v29
    v_cvt_pk_bf16_f32 v27, v30, v31
    v_min_u32 v24, -2, v24
    v_min_u32 v25, -2, v25
    v_min_u32 v26, -2, v26
    v_min_u32 v27, -2, v27
ploop_6_ns:
ploop_6_flag:
    ds_read_b32 v9, v14 offset:16
    s_waitcnt lgkmcnt(0)
    v_readfirstlane_b32 s25, v9
    s_cmp_eq_u32 s25, s16
    s_cbranch_scc0 ploop_6_flag
    s_add_u32 m0, s53, 0
    s_add_u32 s22, s52, 0
    buffer_load_dwordx4 v1, s[4:7], s22 offen offset:0 sc1 lds
    buffer_load_dwordx4 v1, s[4:7], s22 offen offset:1024 sc1 lds
    buffer_load_dwordx4 v1, s[4:7], s22 offen offset:2048 sc1 lds
    buffer_load_dwordx4 v1, s[4:7], s22 offen offset:3072 sc1 lds
    s_add_u32 m0, s53, 4096
    s_add_u32 s22, s52, 131072
    buffer_load_dwordx4 v1, s[4:7], s22 offen offset:0 sc1 lds
    buffer_load_dwordx4 v1, s[4:7], s22 offen offset:1024 sc1 lds
    buffer_load_dwordx4 v1, s[4:7], s22 offen offset:2048 sc1 lds
    buffer_load_dwordx4 v1, s[4:7], s22 offen offset:3072 sc1 lds
    s_add_u32 s52, s52, 262144
ploop_6_nk:
    s_cmp_eq_u32 s16, 0
    s_cbranch_scc1 ploop_6_nd2
    buffer_store_dwordx4 v[24:27], v1, s[4:7], s37 offen sc1
    s_cmp_eq_u32 s31, 0
    s_cbranch_scc1 ploop_6_nd2
    s_add_u32 s25, s37, s27
    buffer_store_dwordx4 v[16:19], v1, s[4:7], s25 offen sc1
ploop_6_nd2:
    s_cmp_eq_u32 s16, 0
    s_cbranch_scc1 ploop_6_nn
    s_add_u32 s37, s37, 65536
    s_xor_b32 s68, s68, 8192
ploop_6_nn:
    s_cmp_lg_u32 s3, 2
    s_cbranch_scc1 ppf_12
    s_lshl_b32 s22, s16, 18
    s_mov_b32 exec_hi, 0xffff
    buffer_load_dword v9, v63, s[4:7], s22 offen sc1
    s_mov_b32 exec_hi, -1
ppf_12:
    v_add_u32 v24, 18560, v7
    v_add_u32 v25, 37120, v7
    v_add_u32 v26, 55680, v7
    s_cmp_eq_u32 s16, 63
    s_setprio 3
    s_barrier
    s_cbranch_scc1 ptail_8
    ds_read2_b32 v[16:17], v7 offset0:0 offset1:2
    ds_read2_b32 v[18:19], v24 offset0:0 offset1:2
    ds_read2_b32 v[20:21], v25 offset0:0 offset1:2
    ds_read2_b32 v[22:23], v26 offset0:0 offset1:2
    s_waitcnt lgkmcnt(2)
    v_add_f32 v16, v16, v18
    v_add_f32 v17, v17, v19
    s_waitcnt lgkmcnt(0)
    v_add_f32 v20, v20, v22
    v_add_f32 v21, v21, v23
    v_add_f32 v16, v16, v20
    v_add_f32 v17, v17, v21
    v_cvt_pk_bf16_f32 v16, v16, v17
    v_min_u32 v16, -2, v16
    buffer_store_dword v16, v2, s[4:7], s21 offen sc1
    buffer_store_dword v10, v2, s[4:7], s24 offen sc1
    s_cmp_eq_u32 s15, 0
    s_cbranch_scc1 ploop_6_pnd
    s_sleep 6
    s_nop 8
    buffer_load_dwordx4 v[16:19], v12, s[4:7], s30 offen sc1
    buffer_load_dword v15, off, s[4:7], s58 sc1
    s_add_u32 s25, s19, s14
    v_mov_b32 v20, -1
    v_mov_b32 v21, -1
    v_mov_b32 v22, -1
    v_mov_b32 v23, -1
    buffer_store_dwordx4 v[20:23], v1, s[4:7], s25 offen
    buffer_store_dwordx2 v[20:21], v54, s[4:7], s25 offen offset:1024
    s_mov_b32 m0, 124928
    s_nop 0
    buffer_load_dwordx4 v1, s[4:7], s69 offen offset:0 sc1 lds
    buffer_load_dwordx4 v1, s[4:7], s69 offen offset:1024 sc1 lds
    buffer_load_dwordx4 v1, s[4:7], s69 offen offset:2048 sc1 lds
    buffer_load_dwordx4 v1, s[4:7], s69 offen offset:3072 sc1 lds
    s_add_u32 s69, s69, 262144
    s_add_u32 m0, s53, 0
    s_add_u32 s22, s52, 0
    buffer_load_dwordx4 v1, s[4:7], s22 offen offset:0 sc1 lds
    buffer_load_dwordx4 v1, s[4:7], s22 offen offset:1024 sc1 lds
    buffer_load_dwordx4 v1, s[4:7], s22 offen offset:2048 sc1 lds
    buffer_load_dwordx4 v1, s[4:7], s22 offen offset:3072 sc1 lds
    s_add_u32 m0, s53, 4096
    s_add_u32 s22, s52, 131072
    buffer_load_dwordx4 v1, s[4:7], s22 offen offset:0 sc1 lds
    buffer_load_dwordx4 v1, s[4:7], s22 offen offset:1024 sc1 lds
    buffer_load_dwordx4 v1, s[4:7], s22 offen offset:2048 sc1 lds
    buffer_load_dwordx4 v1, s[4:7], s22 offen offset:3072 sc1 lds
    s_add_u32 s52, s52, 262144
    s_add_u32 s22, s16, 1
    v_mov_b32 v60, s22
    v_mov_b32 v32, 0
    v_mov_b32 v33, 0
    v_mov_b32 v34, 0
    v_mov_b32 v35, 0
    v_mov_b32 v36, 0
    v_mov_b32 v37, 0
    v_mov_b32 v38, 0
    v_mov_b32 v39, 0
    v_mov_b32 v40, 0
    v_mov_b32 v41, 0
    v_mov_b32 v42, 0
    v_mov_b32 v43, 0
    v_mov_b32 v44, 0
    v_mov_b32 v45, 0
    v_mov_b32 v46, 0
    v_mov_b32 v47, 0
    v_mov_b32 v48, 0
    v_mov_b32 v49, 0
    v_mov_b32 v50, 0
    v_mov_b32 v51, 0
    v_mov_b32 v52, 0
    v_mov_b32 v53, 0
    v_mov_b32 v54, 0
    v_mov_b32 v55, 0
    v_mov_b32 v0, 1.0
    s_mov_b32 exec_lo, 0xff00ff00
    s_mov_b32 exec_hi, 0xff00ff00
    v_mov_b32 v0, s47
    s_mov_b64 exec, -1
    s_waitcnt vmcnt(15) lgkmcnt(0)
    s_branch ploop_6_pchk
ploop_6_pnd:
    s_sleep 6
    s_nop 8
    buffer_load_dwordx4 v[16:19], v12, s[4:7], s30 offen sc1
    buffer_load_dword v15, off, s[4:7], s58 sc1
    s_add_u32 s22, s16, 1
    v_mov_b32 v60, s22
    v_mov_b32 v32, 0
    v_mov_b32 v33, 0
    v_mov_b32 v34, 0
    v_mov_b32 v35, 0
    v_mov_b32 v36, 0
    v_mov_b32 v37, 0
    v_mov_b32 v38, 0
    v_mov_b32 v39, 0
    v_mov_b32 v40, 0
    v_mov_b32 v41, 0
    v_mov_b32 v42, 0
    v_mov_b32 v43, 0
    v_mov_b32 v44, 0
    v_mov_b32 v45, 0
    v_mov_b32 v46, 0
    v_mov_b32 v47, 0
    v_mov_b32 v48, 0
    v_mov_b32 v49, 0
    v_mov_b32 v50, 0
    v_mov_b32 v51, 0
    v_mov_b32 v52, 0
    v_mov_b32 v53, 0
    v_mov_b32 v54, 0
    v_mov_b32 v55, 0
    v_mov_b32 v0, 1.0
    s_mov_b32 exec_lo, 0xff00ff00
    s_mov_b32 exec_hi, 0xff00ff00
    v_mov_b32 v0, s47
    s_mov_b64 exec, -1
    s_waitcnt vmcnt(1) lgkmcnt(0)
    s_branch ploop_6_pchk
ploop_6_pagain:
    s_waitcnt vmcnt(1) lgkmcnt(0)
ploop_6_pchk:
    v_mfma_f32_16x16x32_bf16 v[20:23], v[56:59], v[16:19], 0
    v_max3_u32 v9, v16, v17, v18
    v_max_u32 v9, v9, v19
    v_cmp_eq_u32 vcc, -1, v9
    s_cbranch_vccnz prp_10
ploop_6_pgo:
    s_nop 3
    v_add_f32_dpp v20, v20, v20 row_ror:8 row_mask:0xf bank_mask:0xf
    v_add_f32_dpp v21, v21, v21 row_ror:8 row_mask:0xf bank_mask:0xf
    v_add_f32_dpp v22, v22, v22 row_ror:8 row_mask:0xf bank_mask:0xf
    v_add_f32_dpp v23, v23, v23 row_ror:8 row_mask:0xf bank_mask:0xf
    v_cvt_pk_bf16_f32 v20, v20, v21
    v_cvt_pk_bf16_f32 v21, v22, v23
    s_mov_b32 exec_hi, 0
    v_min_u32 v20, -2, v20
    v_min_u32 v21, -2, v21
    s_mov_b32 exec_lo, 0x00ff00ff
    buffer_store_dwordx2 v[20:21], v13, s[4:7], s23 offen
    s_mov_b64 exec, -1
    s_add_u32 s22, s19, s32
    s_add_u32 s25, s20, s36
    buffer_store_dword v10, v2, s[4:7], s22 offen
    s_mov_b32 exec_hi, 0
    buffer_store_dword v10, v3, s[4:7], s22 offen
    s_mov_b32 exec_lo, 0x00ff00ff
    buffer_store_dwordx2 v[10:11], v13, s[4:7], s25 offen
    s_mov_b64 exec, -1
    s_add_u32 s16, s16, 1
    s_mov_b32 s17, s18
    s_mov_b32 s18, s19
    s_mov_b32 s19, s20
    s_add_u32 s20, s20, 262144
    s_cmp_eq_u32 s20, 210763776
    s_cselect_b32 s20, 209715200, s20
    s_branch ploop_6
prm_9_gt:
gate_13:
    v_readfirstlane_b32 s25, v15
    s_cmp_ge_u32 s25, s59
    s_cbranch_scc1 gate_13_ok
    s_sleep 8
    buffer_load_dword v15, off, s[4:7], s58 sc1
    s_waitcnt vmcnt(0)
    s_sub_u32 s26, s26, 1
    s_cbranch_scc0 gate_13
    s_mov_b32 s26, 0
gate_13_ok:
    s_branch prm_9_gtb
prm_9_0:
    s_sub_u32 s26, s26, 1
    s_cbranch_scc1 prm_9_0_g
    buffer_load_dwordx4 v[16:19], v1, s[4:7], s21 offen offset:0 sc1
    buffer_load_dwordx4 v[20:23], v1, s[4:7], s21 offen offset:1024 sc1
    buffer_load_dwordx4 v[24:27], v1, s[4:7], s21 offen offset:2048 sc1
    buffer_load_dwordx4 v[28:31], v1, s[4:7], s21 offen offset:3072 sc1
    s_waitcnt vmcnt(3)
    v_max3_u32 v9, v16, v17, v18
    v_max_u32 v9, v9, v19
    v_cmp_eq_u32 vcc, -1, v9
    s_cbranch_vccnz prm_9_0
    s_branch prm_9_0ok
prm_9_0_g:
    s_mov_b32 s26, 0
    s_waitcnt vmcnt(0)
    s_branch prm_9_0ok
prm_9_1:
    s_sub_u32 s26, s26, 1
    s_cbranch_scc1 prm_9_1_g
    buffer_load_dwordx4 v[20:23], v1, s[4:7], s21 offen offset:1024 sc1
    buffer_load_dwordx4 v[24:27], v1, s[4:7], s21 offen offset:2048 sc1
    buffer_load_dwordx4 v[28:31], v1, s[4:7], s21 offen offset:3072 sc1
    s_waitcnt vmcnt(2)
    v_max3_u32 v9, v20, v21, v22
    v_max_u32 v9, v9, v23
    v_cmp_eq_u32 vcc, -1, v9
    s_cbranch_vccnz prm_9_1
    s_branch prm_9_1ok
prm_9_1_g:
    s_mov_b32 s26, 0
    s_waitcnt vmcnt(0)
    s_branch prm_9_1ok
prm_9_2:
    s_sub_u32 s26, s26, 1
    s_cbranch_scc1 prm_9_2_g
    buffer_load_dwordx4 v[24:27], v1, s[4:7], s21 offen offset:2048 sc1
    buffer_load_dwordx4 v[28:31], v1, s[4:7], s21 offen offset:3072 sc1
    s_waitcnt vmcnt(1)
    v_max3_u32 v9, v24, v25, v26
    v_max_u32 v9, v9, v27
    v_cmp_eq_u32 vcc, -1, v9
    s_cbranch_vccnz prm_9_2
    s_branch prm_9_2ok
prm_9_2_g:
    s_mov_b32 s26, 0
    s_waitcnt vmcnt(0)
    s_branch prm_9_2ok
prm_9_3:
    s_sub_u32 s26, s26, 1
    s_cbranch_scc1 prm_9_3_g
    buffer_load_dwordx4 v[28:31], v1, s[4:7], s21 offen offset:3072 sc1
    s_waitcnt vmcnt(0)
    v_max3_u32 v9, v28, v29, v30
    v_max_u32 v9, v9, v31
    v_cmp_eq_u32 vcc, -1, v9
    s_cbranch_vccnz prm_9_3
    s_branch prm_9_3ok
prm_9_3_g:
    s_mov_b32 s26, 0
    s_waitcnt vmcnt(0)
    s_branch prm_9_3ok
prm_9_d:
gate_14:
    v_readfirstlane_b32 s25, v15
    s_cmp_ge_u32 s25, s59
    s_cbranch_scc1 gate_14_ok
    s_sleep 8
    buffer_load_dword v15, off, s[4:7], s58 sc1
    s_waitcnt vmcnt(0)
    s_sub_u32 s26, s26, 1
    s_cbranch_scc0 gate_14
    s_mov_b32 s26, 0
gate_14_ok:
    ds_write_b32 v14, v60
    v_add_f32 v32, v32, v33
    v_add_f32 v34, v34, v35
    ds_write2_b32 v4, v32, v34 offset0:0 offset1:104
    v_add_f32 v36, v36, v37
    v_add_f32 v38, v38, v39
    ds_write2_b32 v4, v36, v38 offset0:16 offset1:120
    v_add_f32 v40, v40, v41
    v_add_f32 v42, v42, v43
    ds_write2_b32 v4, v40, v42 offset0:32 offset1:136
    v_add_f32 v44, v44, v45
    v_add_f32 v46, v46, v47
    ds_write2_b32 v4, v44, v46 offset0:48 offset1:152
    v_add_f32 v48, v48, v49
    v_add_f32 v50, v50, v51
    ds_write2_b32 v4, v48, v50 offset0:64 offset1:168
    v_add_f32 v52, v52, v53
    v_add_f32 v54, v54, v55
    ds_write2_b32 v4, v52, v54 offset0:80 offset1:184
    s_branch pnc_7_done
prp_10:
    s_sub_u32 s26, s26, 1
    s_nop 3
    s_cbranch_scc1 prp_10_g
    buffer_load_dwordx4 v[16:19], v12, s[4:7], s30 offen sc1
    buffer_load_dword v15, off, s[4:7], s58 sc1
    s_branch ploop_6_pagain
prp_10_g:
    s_mov_b32 s26, 0
    s_branch ploop_6_pgo
ploop_6_zr:
    s_sub_u32 s26, s26, 1
    s_cbranch_scc1 ploop_6_zg
    buffer_load_dwordx4 v[32:35], v1, s[4:7], s22 offen offset:0 sc1
    buffer_load_dwordx4 v[36:39], v1, s[4:7], s22 offen offset:1024 sc1
    buffer_load_dwordx4 v[40:43], v1, s[4:7], s22 offen offset:2048 sc1
    buffer_load_dwordx4 v[44:47], v1, s[4:7], s22 offen offset:3072 sc1
    s_branch ploop_6_za
ploop_6_zg:
    s_mov_b32 s26, 0
    s_branch ploop_6_zok
ptail_8:
    s_cmp_eq_u32 s15, 0
    s_cbranch_scc1 ptail_8_nd
    s_nop 0
ptail_8_nd:
    s_barrier
    v_add_u32 v55, s68, v61
    ds_read_b128 v[24:27], v55 offset:0
    ds_read_b128 v[28:31], v55 offset:1024
    ds_read_b128 v[32:35], v55 offset:18560
    ds_read_b128 v[36:39], v55 offset:19584
    ds_read_b128 v[40:43], v55 offset:37120
    ds_read_b128 v[44:47], v55 offset:38144
    ds_read_b128 v[48:51], v55 offset:55680
    ds_read_b128 v[52:55], v55 offset:56704
    s_waitcnt lgkmcnt(4)
    v_add_f32 v24, v24, v32
    v_add_f32 v25, v25, v33
    v_add_f32 v26, v26, v34
    v_add_f32 v27, v27, v35
    v_add_f32 v28, v28, v36
    v_add_f32 v29, v29, v37
    v_add_f32 v30, v30, v38
    v_add_f32 v31, v31, v39
    s_waitcnt lgkmcnt(0)
    v_add_f32 v40, v40, v48
    v_add_f32 v41, v41, v49
    v_add_f32 v42, v42, v50
    v_add_f32 v43, v43, v51
    v_add_f32 v44, v44, v52
    v_add_f32 v45, v45, v53
    v_add_f32 v46, v46, v54
    v_add_f32 v47, v47, v55
    v_add_f32 v24, v24, v40
    v_add_f32 v25, v25, v41
    v_add_f32 v26, v26, v42
    v_add_f32 v27, v27, v43
    v_add_f32 v28, v28, v44
    v_add_f32 v29, v29, v45
    v_add_f32 v30, v30, v46
    v_add_f32 v31, v31, v47
    v_cvt_pk_bf16_f32 v24, v24, v25
    v_cvt_pk_bf16_f32 v25, v26, v27
    v_cvt_pk_bf16_f32 v26, v28, v29
    v_cvt_pk_bf16_f32 v27, v30, v31
    v_min_u32 v24, -2, v24
    v_min_u32 v25, -2, v25
    v_min_u32 v26, -2, v26
    v_min_u32 v27, -2, v27
    buffer_store_dwordx4 v[24:27], v1, s[4:7], s37 offen sc1
    s_branch k_end
ch_p_slow:
    v_mov_b32 v32, 0
    v_mov_b32 v33, 0
    v_mov_b32 v34, 0
    v_mov_b32 v35, 0
    v_mov_b32 v36, 0
    v_mov_b32 v37, 0
    v_mov_b32 v38, 0
    v_mov_b32 v39, 0
    v_mov_b32 v40, 0
    v_mov_b32 v41, 0
    v_mov_b32 v42, 0
    v_mov_b32 v43, 0
    v_mov_b32 v44, 0
    v_mov_b32 v45, 0
    v_mov_b32 v46, 0
    v_mov_b32 v47, 0
    v_mov_b32 v48, 0
    v_mov_b32 v49, 0
    v_mov_b32 v50, 0
    v_mov_b32 v51, 0
    v_mov_b32 v52, 0
    v_mov_b32 v53, 0
    v_mov_b32 v54, 0
    v_mov_b32 v55, 0
    v_mov_b32 v0, 1.0
    s_mov_b32 exec_lo, 0xff00ff00
    s_mov_b32 exec_hi, 0xff00ff00
    v_mov_b32 v0, s47
    s_mov_b64 exec, -1
    v_mov_b32 v60, s16
    s_branch pnc_16
.p2align 6
ploop_15:
    s_add_u32 s21, s17, s33
    s_nop 15
    s_nop 5
    buffer_load_dwordx4 v[16:19], v1, s[4:7], s21 offen offset:0 sc1
    s_nop 7
    buffer_load_dwordx4 v[20:23], v1, s[4:7], s21 offen offset:1024 sc1
    s_nop 7
    buffer_load_dwordx4 v[24:27], v1, s[4:7], s21 offen offset:2048 sc1
    s_nop 7
    buffer_load_dwordx4 v[28:31], v1, s[4:7], s21 offen offset:3072 sc1
    s_waitcnt vmcnt(3)
    v_max3_u32 v9, v16, v17, v18
    v_max_u32 v9, v9, v19
    v_cmp_eq_u32 vcc, -1, v9
    s_cbranch_vccnz prm_18_0
prm_18_0ok:
    v_smfmac_f32_16x16x64_bf16 v[32:35], v[16:19], v[64:71], v62
    v_smfmac_f32_16x16x64_bf16 v[36:39], v[16:19], v[72:79], v62
    v_smfmac_f32_16x16x64_bf16 v[40:43], v[16:19], v[80:87], v62
    s_waitcnt vmcnt(2)
    v_max3_u32 v9, v20, v21, v22
    v_max_u32 v9, v9, v23
    v_cmp_eq_u32 vcc, -1, v9
    v_smfmac_f32_16x16x64_bf16 v[44:47], v[16:19], v[88:95], v62
    v_smfmac_f32_16x16x64_bf16 v[48:51], v[16:19], v[96:103], v62
    v_smfmac_f32_16x16x64_bf16 v[52:55], v[16:19], v[104:111], v62
    s_cbranch_vccnz prm_18_1
prm_18_1ok:
    v_smfmac_f32_16x16x64_bf16 v[32:35], v[20:23], v[112:119], v62
    v_readfirstlane_b32 s23, v15
    v_smfmac_f32_16x16x64_bf16 v[36:39], v[20:23], v[120:127], v62
    v_smfmac_f32_16x16x64_bf16 v[40:43], v[20:23], v[128:135], v62
    s_waitcnt vmcnt(1)
    v_max3_u32 v9, v24, v25, v26
    v_max_u32 v9, v9, v27
    v_cmp_eq_u32 vcc, -1, v9
    v_smfmac_f32_16x16x64_bf16 v[44:47], v[20:23], v[136:143], v62
    v_smfmac_f32_16x16x64_bf16 v[48:51], v[20:23], v[144:151], v62
    v_smfmac_f32_16x16x64_bf16 v[52:55], v[20:23], v[152:159], v62
    s_cbranch_vccnz prm_18_2
prm_18_2ok:
    v_smfmac_f32_16x16x64_bf16 v[32:35], v[24:27], v[160:167], v62
    v_smfmac_f32_16x16x64_bf16 v[36:39], v[24:27], v[168:175], v62
    v_smfmac_f32_16x16x64_bf16 v[40:43], v[24:27], v[176:183], v62
    s_waitcnt vmcnt(0)
    v_max3_u32 v9, v28, v29, v30
    v_max_u32 v9, v9, v31
    v_cmp_eq_u32 vcc, -1, v9
    v_smfmac_f32_16x16x64_bf16 v[44:47], v[24:27], v[184:191], v62
    v_smfmac_f32_16x16x64_bf16 v[48:51], v[24:27], v[192:199], v62
    v_smfmac_f32_16x16x64_bf16 v[52:55], v[24:27], v[200:207], v62
    s_cbranch_vccnz prm_18_3
prm_18_3ok:
    v_smfmac_f32_16x16x64_bf16 v[32:35], v[28:31], v[208:215], v62
    s_cmp_lt_u32 s23, s59
    s_cbranch_scc1 prm_18_gt
prm_18_gtb:
    ds_write_b32 v14, v60
    v_smfmac_f32_16x16x64_bf16 v[36:39], v[28:31], v[216:223], v62
    v_smfmac_f32_16x16x64_bf16 v[40:43], v[28:31], v[224:231], v62
    v_smfmac_f32_16x16x64_bf16 v[44:47], v[28:31], v[232:239], v62
    v_add_f32 v32, v32, v33
    v_add_f32 v34, v34, v35
    v_smfmac_f32_16x16x64_bf16 v[48:51], v[28:31], v[240:247], v62
    v_add_f32 v36, v36, v37
    v_add_f32 v38, v38, v39
    ds_write2_b32 v4, v32, v34 offset0:0 offset1:104
    v_smfmac_f32_16x16x64_bf16 v[52:55], v[28:31], v[248:255], v62
    v_add_f32 v40, v40, v41
    v_add_f32 v42, v42, v43
    ds_write2_b32 v4, v36, v38 offset0:16 offset1:120
    v_add_f32 v44, v44, v45
    v_add_f32 v46, v46, v47
    ds_write2_b32 v4, v40, v42 offset0:32 offset1:136
    v_add_f32 v48, v48, v49
    v_add_f32 v50, v50, v51
    ds_write2_b32 v4, v44, v46 offset0:48 offset1:152
    v_add_f32 v52, v52, v53
    v_add_f32 v54, v54, v55
    ds_write2_b32 v4, v48, v50 offset0:64 offset1:168
    ds_write2_b32 v4, v52, v54 offset0:80 offset1:184
    s_branch pnc_16_done
pnc_16:
    v_smfmac_f32_16x16x64_bf16 v[32:35], v[16:19], v[64:71], v62
    v_smfmac_f32_16x16x64_bf16 v[36:39], v[16:19], v[72:79], v62
    v_smfmac_f32_16x16x64_bf16 v[40:43], v[16:19], v[80:87], v62
    v_smfmac_f32_16x16x64_bf16 v[44:47], v[16:19], v[88:95], v62
    v_smfmac_f32_16x16x64_bf16 v[48:51], v[16:19], v[96:103], v62
    v_smfmac_f32_16x16x64_bf16 v[52:55], v[16:19], v[104:111], v62
    v_smfmac_f32_16x16x64_bf16 v[32:35], v[20:23], v[112:119], v62
    v_smfmac_f32_16x16x64_bf16 v[36:39], v[20:23], v[120:127], v62
    v_smfmac_f32_16x16x64_bf16 v[40:43], v[20:23], v[128:135], v62
    v_smfmac_f32_16x16x64_bf16 v[44:47], v[20:23], v[136:143], v62
    v_smfmac_f32_16x16x64_bf16 v[48:51], v[20:23], v[144:151], v62
    v_smfmac_f32_16x16x64_bf16 v[52:55], v[20:23], v[152:159], v62
    v_smfmac_f32_16x16x64_bf16 v[32:35], v[24:27], v[160:167], v62
    v_smfmac_f32_16x16x64_bf16 v[36:39], v[24:27], v[168:175], v62
    v_smfmac_f32_16x16x64_bf16 v[40:43], v[24:27], v[176:183], v62
    v_smfmac_f32_16x16x64_bf16 v[44:47], v[24:27], v[184:191], v62
    v_smfmac_f32_16x16x64_bf16 v[48:51], v[24:27], v[192:199], v62
    v_smfmac_f32_16x16x64_bf16 v[52:55], v[24:27], v[200:207], v62
    v_smfmac_f32_16x16x64_bf16 v[32:35], v[28:31], v[208:215], v62
    ds_write_b32 v14, v60
    v_smfmac_f32_16x16x64_bf16 v[36:39], v[28:31], v[216:223], v62
    v_smfmac_f32_16x16x64_bf16 v[40:43], v[28:31], v[224:231], v62
    v_smfmac_f32_16x16x64_bf16 v[44:47], v[28:31], v[232:239], v62
    v_add_f32 v32, v32, v33
    v_add_f32 v34, v34, v35
    v_smfmac_f32_16x16x64_bf16 v[48:51], v[28:31], v[240:247], v62
    v_add_f32 v36, v36, v37
    v_add_f32 v38, v38, v39
    ds_write2_b32 v4, v32, v34 offset0:0 offset1:104
    v_smfmac_f32_16x16x64_bf16 v[52:55], v[28:31], v[248:255], v62
    v_add_f32 v40, v40, v41
    v_add_f32 v42, v42, v43
    ds_write2_b32 v4, v36, v38 offset0:16 offset1:120
    v_add_f32 v44, v44, v45
    v_add_f32 v46, v46, v47
    ds_write2_b32 v4, v40, v42 offset0:32 offset1:136
    v_add_f32 v48, v48, v49
    v_add_f32 v50, v50, v51
    ds_write2_b32 v4, v44, v46 offset0:48 offset1:152
    v_add_f32 v52, v52, v53
    v_add_f32 v54, v54, v55
    ds_write2_b32 v4, v48, v50 offset0:64 offset1:168
    ds_write2_b32 v4, v52, v54 offset0:80 offset1:184
    s_waitcnt vmcnt(0)
pnc_16_done:
    s_add_u32 s21, s17, s32
    s_add_u32 s22, s19, s32
    s_add_u32 s24, s19, s35
    s_waitcnt lgkmcnt(0)
    s_barrier
    ds_read_b64 v[32:33], v5 offset:0
    ds_read_b64 v[34:35], v5 offset:3328
    ds_read_b64 v[36:37], v5 offset:6656
    ds_read_b64 v[38:39], v5 offset:9984
    ds_read_b64 v[40:41], v6 offset:0
    ds_read_b64 v[42:43], v6 offset:3328
    ds_read_b64 v[44:45], v6 offset:6656
    ds_read_b64 v[46:47], v6 offset:9984
    s_waitcnt lgkmcnt(6)
    v_add_f32 v32, v32, v34
    v_add_f32 v33, v33, v35
    s_waitcnt lgkmcnt(4)
    v_add_f32 v36, v36, v38
    v_add_f32 v37, v37, v39
    v_add_f32 v32, v32, v36
    v_add_f32 v33, v33, v37
    v_mul_f32 v32, v32, v0
    v_mul_f32 v33, v33, v0
    v_cvt_pk_bf16_f32 v32, v32, v33
    v_min_u32 v32, -2, v32
    buffer_store_dword v32, v2, s[4:7], s21 offen sc1
    s_waitcnt lgkmcnt(2)
    v_add_f32 v40, v40, v42
    v_add_f32 v41, v41, v43
    s_waitcnt lgkmcnt(0)
    v_add_f32 v44, v44, v46
    v_add_f32 v45, v45, v47
    v_add_f32 v40, v40, v44
    v_add_f32 v41, v41, v45
    v_cvt_pk_bf16_f32 v40, v40, v41
    v_min_u32 v40, -2, v40
    s_mov_b32 exec_hi, 0
    buffer_store_dword v40, v3, s[4:7], s21 offen sc1
    s_setprio 0
    s_mov_b64 exec, -1
    s_add_u32 s21, s17, s35
    s_add_u32 s30, s17, s34
    s_add_u32 s23, s18, s36
    s_cmp_lg_u32 s16, 0
    s_cbranch_scc1 ploop_15_n0
gate_20:
    v_readfirstlane_b32 s25, v15
    s_cmp_ge_u32 s25, s59
    s_cbranch_scc1 gate_20_ok
    s_sleep 8
    buffer_load_dword v15, off, s[4:7], s58 sc1
    s_waitcnt vmcnt(0)
    s_sub_u32 s26, s26, 1
    s_cbranch_scc0 gate_20
    s_mov_b32 s26, 0
gate_20_ok:
    s_cmp_eq_u32 s15, 0
    s_cbranch_scc1 ploop_15_st_nk
    s_add_u32 m0, s53, 0
    s_add_u32 s22, s52, 0
    buffer_load_dwordx4 v1, s[4:7], s22 offen offset:0 sc1 lds
    buffer_load_dwordx4 v1, s[4:7], s22 offen offset:1024 sc1 lds
    buffer_load_dwordx4 v1, s[4:7], s22 offen offset:2048 sc1 lds
    buffer_load_dwordx4 v1, s[4:7], s22 offen offset:3072 sc1 lds
    s_add_u32 m0, s53, 4096
    s_add_u32 s22, s52, 131072
    buffer_load_dwordx4 v1, s[4:7], s22 offen offset:0 sc1 lds
    buffer_load_dwordx4 v1, s[4:7], s22 offen offset:1024 sc1 lds
    buffer_load_dwordx4 v1, s[4:7], s22 offen offset:2048 sc1 lds
    buffer_load_dwordx4 v1, s[4:7], s22 offen offset:3072 sc1 lds
    s_add_u32 s52, s52, 262144
    s_sub_u32 s52, s52, 262144
ploop_15_st_nk:
    s_add_u32 s52, s52, 262144
    s_cmp_lg_u32 s3, 2
    s_cbranch_scc1 ploop_15_st_npf
    v_subrev_u32 v32, 786432, v63
    s_mov_b32 exec_hi, 0xffff
    s_mov_b32 s22, 262144
    buffer_load_dword v33, v32, s[4:7], s22 offen sc1
    s_mov_b32 s22, 524288
    buffer_load_dword v33, v32, s[4:7], s22 offen sc1
    s_mov_b32 exec_hi, -1
    s_waitcnt vmcnt(0)
ploop_15_st_npf:
    s_cmp_eq_u32 s15, 0
    s_cbranch_scc1 ploop_15_st_p_nd
    s_mov_b32 m0, 124928
    s_nop 0
    buffer_load_dwordx4 v1, s[4:7], s69 offen offset:0 sc1 lds
    buffer_load_dwordx4 v1, s[4:7], s69 offen offset:1024 sc1 lds
    buffer_load_dwordx4 v1, s[4:7], s69 offen offset:2048 sc1 lds
    buffer_load_dwordx4 v1, s[4:7], s69 offen offset:3072 sc1 lds
    s_add_u32 s69, s69, 262144
    s_waitcnt vmcnt(0)
ploop_15_st_p_nd:
ploop_15_n0:
    s_add_u32 s25, s16, 2
    s_min_u32 s25, s25, 63
    s_cmp_lt_u32 s25, 8
    s_cselect_b32 s59, 12, 24
    s_cselect_b32 s58, -4, -8
    s_and_b32 s25, s25, s58
    s_lshl_b32 s25, s25, 5
    s_add_u32 s58, s25, s60
    s_cmp_eq_u32 s15, 0
    s_cbranch_scc1 ploop_15_nd
    v_add_u32 v9, s53, v1
    v_add_u32 v0, 124928, v1
    ds_read_b128 v[16:19], v0 offset:0
    ds_read_b128 v[32:35], v9 offset:0
    ds_read_b128 v[20:23], v0 offset:1024
    ds_read_b128 v[36:39], v9 offset:1024
    ds_read_b128 v[24:27], v0 offset:2048
    ds_read_b128 v[40:43], v9 offset:2048
    ds_read_b128 v[28:31], v0 offset:3072
    ds_read_b128 v[44:47], v9 offset:3072
    s_add_u32 s22, s17, s61
    s_waitcnt lgkmcnt(6)
    v_mfma_f32_16x16x32_bf16 v[48:51], v[32:35], v[16:19], 0
    ds_read_b128 v[32:35], v9 offset:4096
    s_waitcnt lgkmcnt(5)
    v_mfma_f32_16x16x32_bf16 v[48:51], v[36:39], v[20:23], v[48:51]
    ds_read_b128 v[36:39], v9 offset:5120
    s_waitcnt lgkmcnt(4)
    v_mfma_f32_16x16x32_bf16 v[48:51], v[40:43], v[24:27], v[48:51]
    ds_read_b128 v[40:43], v9 offset:6144
    s_waitcnt lgkmcnt(3)
    v_mfma_f32_16x16x32_bf16 v[48:51], v[44:47], v[28:31], v[48:51]
    ds_read_b128 v[44:47], v9 offset:7168
    s_waitcnt lgkmcnt(3)
    v_mfma_f32_16x16x32_bf16 v[52:55], v[32:35], v[16:19], 0
    s_waitcnt lgkmcnt(2)
    v_mfma_f32_16x16x32_bf16 v[52:55], v[36:39], v[20:23], v[52:55]
    s_waitcnt lgkmcnt(1)
    v_mfma_f32_16x16x32_bf16 v[52:55], v[40:43], v[24:27], v[52:55]
    s_waitcnt lgkmcnt(0)
    v_mfma_f32_16x16x32_bf16 v[52:55], v[44:47], v[28:31], v[52:55]
    buffer_load_dwordx4 v[32:35], v1, s[4:7], s22 offen offset:0 sc1
    buffer_load_dwordx4 v[36:39], v1, s[4:7], s22 offen offset:1024 sc1
    buffer_load_dwordx4 v[40:43], v1, s[4:7], s22 offen offset:2048 sc1
    buffer_load_dwordx4 v[44:47], v1, s[4:7], s22 offen offset:3072 sc1
    v_mov_b32 v60, 0xff61b1e6
    s_nop 2
    v_cndmask_b32 v48, v48, v60, s[38:39]
    v_cndmask_b32 v49, v49, v60, s[40:41]
    v_cndmask_b32 v50, v50, v60, s[42:43]
    v_cndmask_b32 v51, v51, v60, s[44:45]
    v_cndmask_b32 v52, v52, v60, s[48:49]
    v_cndmask_b32 v53, v53, v60, s[50:51]
    v_cndmask_b32 v54, v54, v60, s[54:55]
    v_cndmask_b32 v55, v55, v60, s[56:57]
    v_max3_f32 v0, v48, v49, v50
    v_max3_f32 v9, v51, v52, v53
    v_max3_f32 v0, v0, v54, v55
    v_max_f32 v0, v0, v9
    v_mov_b32 v9, v0
    s_nop 1
    v_permlane16_swap_b32 v9, v0
    v_max_f32 v0, v0, v9
    v_mov_b32 v9, v0
    s_nop 1
    v_permlane32_swap_b32 v9, v0
    v_max_f32 v0, v0, v9
    v_mul_f32 v0, s47, v0
    v_fma_f32 v48, v48, s47, -v0
    v_fma_f32 v49, v49, s47, -v0
    v_fma_f32 v50, v50, s47, -v0
    v_fma_f32 v51, v51, s47, -v0
    v_fma_f32 v52, v52, s47, -v0
    v_fma_f32 v53, v53, s47, -v0
    v_fma_f32 v54, v54, s47, -v0
    v_fma_f32 v55, v55, s47, -v0
    v_exp_f32 v48, v48
    v_exp_f32 v49, v49
    v_exp_f32 v50, v50
    v_exp_f32 v51, v51
    v_exp_f32 v52, v52
    v_exp_f32 v53, v53
    v_exp_f32 v54, v54
    v_exp_f32 v55, v55
    v_add_f32 v15, v48, v49
    v_add_f32 v15, v15, v50
    v_add_f32 v15, v15, v51
    v_add_f32 v15, v15, v52
    v_add_f32 v15, v15, v53
    v_add_f32 v15, v15, v54
    v_add_f32 v15, v15, v55
ploop_15_za:
    s_waitcnt vmcnt(0)
    v_max3_u32 v9, v32, v33, v34
    v_max3_u32 v9, v9, v35, v36
    v_max3_u32 v9, v9, v37, v38
    v_max3_u32 v9, v9, v39, v40
    v_max3_u32 v9, v9, v41, v42
    v_max3_u32 v9, v9, v43, v44
    v_max3_u32 v9, v9, v45, v46
    v_max_u32 v9, v9, v47
    v_cmp_eq_u32 vcc, -1, v9
    s_cbranch_vccnz ploop_15_zr
ploop_15_zok:
    v_mfma_f32_16x16x32_bf16 v[56:59], v[32:35], v[16:19], 0
    v_mfma_f32_16x16x32_bf16 v[56:59], v[36:39], v[20:23], v[56:59]
    v_mfma_f32_16x16x32_bf16 v[56:59], v[40:43], v[24:27], v[56:59]
    v_mfma_f32_16x16x32_bf16 v[56:59], v[44:47], v[28:31], v[56:59]
    s_add_u32 s22, s17, s14
    s_nop 6
    v_max_f32 v60, v56, v57
    v_mov_b32 v9, v60
    s_nop 1
    v_permlane16_swap_b32 v9, v60
    v_max_f32 v60, v60, v9
    v_mov_b32 v9, v60
    s_nop 1
    v_permlane32_swap_b32 v9, v60
    v_max_f32 v60, v60, v9
    v_mul_f32 v60, s47, v60
    v_max_f32 v58, v60, v0
    v_sub_f32 v60, v0, v58
    v_fma_f32 v56, v56, s47, -v58
    v_fma_f32 v57, v57, s47, -v58
    v_exp_f32 v60, v60
    v_exp_f32 v56, v56
    v_exp_f32 v57, v57
    v_fma_f32 v15, v15, v60, v56
    v_add_f32 v15, v15, v57
    v_mov_b32 v9, v15
    s_nop 1
    v_permlane16_swap_b32 v9, v15
    v_add_f32 v15, v15, v9
    v_mov_b32 v9, v15
    s_nop 1
    v_permlane32_swap_b32 v9, v15
    v_add_f32 v15, v15, v9
    v_rcp_f32 v15, v15
    s_add_u32 s25, s19, s14
    v_mul_f32 v56, v56, v15
    v_mul_f32 v57, v57, v15
    v_mul_f32 v60, v60, v15
    v_mul_f32 v48, v48, v60
    v_mul_f32 v49, v49, v60
    v_mul_f32 v50, v50, v60
    v_mul_f32 v51, v51, v60
    v_mul_f32 v52, v52, v60
    v_mul_f32 v53, v53, v60
    v_mul_f32 v54, v54, v60
    v_mul_f32 v55, v55, v60
    v_cvt_pk_bf16_f32 v48, v48, v49
    v_cvt_pk_bf16_f32 v49, v50, v51
    v_cvt_pk_bf16_f32 v50, v52, v53
    v_cvt_pk_bf16_f32 v51, v54, v55
    v_min_u32 v48, -2, v48
    v_min_u32 v49, -2, v49
    v_min_u32 v50, -2, v50
    v_min_u32 v51, -2, v51
    v_lshlrev_b32 v54, 1, v8
    v_add_u32 v55, 14336, v1
    v_mov_b32 v53, 1.0
    v_cvt_pk_bf16_f32 v52, v56, v57
    v_min_u32 v53, -2, v53
    v_min_u32 v52, -2, v52
    buffer_store_dwordx4 v[48:51], v1, s[4:7], s22 offen sc1
    buffer_store_dwordx2 v[52:53], v54, s[4:7], s22 offen offset:1024 sc1
    ds_read_b128 v[56:59], v55
    s_branch ploop_15_nd2
ploop_15_nd:
    s_cmp_eq_u32 s16, 0
    s_cbranch_scc1 ploop_15_ns
    s_cmp_eq_u32 s31, 0
    s_cbranch_scc1 ploop_15_n2
    s_add_u32 s25, s68, s46
    v_add_u32 v55, s25, v61
    ds_read_b128 v[24:27], v55 offset:0
    ds_read_b128 v[28:31], v55 offset:1024
    ds_read_b128 v[32:35], v55 offset:18560
    ds_read_b128 v[36:39], v55 offset:19584
    ds_read_b128 v[40:43], v55 offset:37120
    ds_read_b128 v[44:47], v55 offset:38144
    ds_read_b128 v[48:51], v55 offset:55680
    ds_read_b128 v[52:55], v55 offset:56704
    s_waitcnt lgkmcnt(4)
    v_add_f32 v24, v24, v32
    v_add_f32 v25, v25, v33
    v_add_f32 v26, v26, v34
    v_add_f32 v27, v27, v35
    v_add_f32 v28, v28, v36
    v_add_f32 v29, v29, v37
    v_add_f32 v30, v30, v38
    v_add_f32 v31, v31, v39
    s_waitcnt lgkmcnt(0)
    v_add_f32 v40, v40, v48
    v_add_f32 v41, v41, v49
    v_add_f32 v42, v42, v50
    v_add_f32 v43, v43, v51
    v_add_f32 v44, v44, v52
    v_add_f32 v45, v45, v53
    v_add_f32 v46, v46, v54
    v_add_f32 v47, v47, v55
    v_add_f32 v24, v24, v40
    v_add_f32 v25, v25, v41
    v_add_f32 v26, v26, v42
    v_add_f32 v27, v27, v43
    v_add_f32 v28, v28, v44
    v_add_f32 v29, v29, v45
    v_add_f32 v30, v30, v46
    v_add_f32 v31, v31, v47
    v_cvt_pk_bf16_f32 v24, v24, v25
    v_cvt_pk_bf16_f32 v25, v26, v27
    v_cvt_pk_bf16_f32 v26, v28, v29
    v_cvt_pk_bf16_f32 v27, v30, v31
    v_min_u32 v24, -2, v24
    v_min_u32 v25, -2, v25
    v_min_u32 v26, -2, v26
    v_min_u32 v27, -2, v27
    v_mov_b32 v16, v24
    v_mov_b32 v17, v25
    v_mov_b32 v18, v26
    v_mov_b32 v19, v27
ploop_15_n2:
    v_add_u32 v55, s68, v61
    ds_read_b128 v[24:27], v55 offset:0
    ds_read_b128 v[28:31], v55 offset:1024
    ds_read_b128 v[32:35], v55 offset:18560
    ds_read_b128 v[36:39], v55 offset:19584
    ds_read_b128 v[40:43], v55 offset:37120
    ds_read_b128 v[44:47], v55 offset:38144
    ds_read_b128 v[48:51], v55 offset:55680
    ds_read_b128 v[52:55], v55 offset:56704
    s_waitcnt lgkmcnt(4)
    v_add_f32 v24, v24, v32
    v_add_f32 v25, v25, v33
    v_add_f32 v26, v26, v34
    v_add_f32 v27, v27, v35
    v_add_f32 v28, v28, v36
    v_add_f32 v29, v29, v37
    v_add_f32 v30, v30, v38
    v_add_f32 v31, v31, v39
    s_waitcnt lgkmcnt(0)
    v_add_f32 v40, v40, v48
    v_add_f32 v41, v41, v49
    v_add_f32 v42, v42, v50
    v_add_f32 v43, v43, v51
    v_add_f32 v44, v44, v52
    v_add_f32 v45, v45, v53
    v_add_f32 v46, v46, v54
    v_add_f32 v47, v47, v55
    v_add_f32 v24, v24, v40
    v_add_f32 v25, v25, v41
    v_add_f32 v26, v26, v42
    v_add_f32 v27, v27, v43
    v_add_f32 v28, v28, v44
    v_add_f32 v29, v29, v45
    v_add_f32 v30, v30, v46
    v_add_f32 v31, v31, v47
    v_cvt_pk_bf16_f32 v24, v24, v25
    v_cvt_pk_bf16_f32 v25, v26, v27
    v_cvt_pk_bf16_f32 v26, v28, v29
    v_cvt_pk_bf16_f32 v27, v30, v31
    v_min_u32 v24, -2, v24
    v_min_u32 v25, -2, v25
    v_min_u32 v26, -2, v26
    v_min_u32 v27, -2, v27
ploop_15_ns:
ploop_15_flag:
    ds_read_b32 v9, v14 offset:16
    s_waitcnt lgkmcnt(0)
    v_readfirstlane_b32 s25, v9
    s_cmp_eq_u32 s25, s16
    s_cbranch_scc0 ploop_15_flag
    s_add_u32 m0, s53, 0
    s_add_u32 s22, s52, 0
    buffer_load_dwordx4 v1, s[4:7], s22 offen offset:0 sc1 lds
    buffer_load_dwordx4 v1, s[4:7], s22 offen offset:1024 sc1 lds
    buffer_load_dwordx4 v1, s[4:7], s22 offen offset:2048 sc1 lds
    buffer_load_dwordx4 v1, s[4:7], s22 offen offset:3072 sc1 lds
    s_add_u32 m0, s53, 4096
    s_add_u32 s22, s52, 131072
    buffer_load_dwordx4 v1, s[4:7], s22 offen offset:0 sc1 lds
    buffer_load_dwordx4 v1, s[4:7], s22 offen offset:1024 sc1 lds
    buffer_load_dwordx4 v1, s[4:7], s22 offen offset:2048 sc1 lds
    buffer_load_dwordx4 v1, s[4:7], s22 offen offset:3072 sc1 lds
    s_add_u32 s52, s52, 262144
ploop_15_nk:
    s_cmp_eq_u32 s16, 0
    s_cbranch_scc1 ploop_15_nd2
    buffer_store_dwordx4 v[24:27], v1, s[4:7], s37 offen sc1
    s_cmp_eq_u32 s31, 0
    s_cbranch_scc1 ploop_15_nd2
    s_add_u32 s25, s37, s27
    buffer_store_dwordx4 v[16:19], v1, s[4:7], s25 offen sc1
ploop_15_nd2:
    s_cmp_eq_u32 s16, 0
    s_cbranch_scc1 ploop_15_nn
    s_add_u32 s37, s37, 65536
    s_xor_b32 s68, s68, 8192
ploop_15_nn:
    s_cmp_lg_u32 s3, 2
    s_cbranch_scc1 ppf_21
    s_lshl_b32 s22, s16, 18
    s_mov_b32 exec_hi, 0xffff
    buffer_load_dword v9, v63, s[4:7], s22 offen sc1
    s_mov_b32 exec_hi, -1
ppf_21:
    v_add_u32 v24, 18560, v7
    v_add_u32 v25, 37120, v7
    v_add_u32 v26, 55680, v7
    s_cmp_eq_u32 s16, 63
    s_setprio 3
    s_barrier
    s_cbranch_scc1 ptail_17
    ds_read2_b32 v[16:17], v7 offset0:0 offset1:2
    ds_read2_b32 v[18:19], v24 offset0:0 offset1:2
    ds_read2_b32 v[20:21], v25 offset0:0 offset1:2
    ds_read2_b32 v[22:23], v26 offset0:0 offset1:2
    s_waitcnt lgkmcnt(2)
    v_add_f32 v16, v16, v18
    v_add_f32 v17, v17, v19
    s_waitcnt lgkmcnt(0)
    v_add_f32 v20, v20, v22
    v_add_f32 v21, v21, v23
    v_add_f32 v16, v16, v20
    v_add_f32 v17, v17, v21
    v_cvt_pk_bf16_f32 v16, v16, v17
    v_min_u32 v16, -2, v16
    buffer_store_dword v16, v2, s[4:7], s21 offen sc1
    buffer_store_dword v10, v2, s[4:7], s24 offen sc1
    s_cmp_eq_u32 s15, 0
    s_cbranch_scc1 ploop_15_pnd
    s_sleep 6
    s_nop 8
    buffer_load_dwordx4 v[16:19], v12, s[4:7], s30 offen sc1
    buffer_load_dword v15, off, s[4:7], s58 sc1
    s_add_u32 s25, s19, s14
    v_mov_b32 v20, -1
    v_mov_b32 v21, -1
    v_mov_b32 v22, -1
    v_mov_b32 v23, -1
    buffer_store_dwordx4 v[20:23], v1, s[4:7], s25 offen sc1
    buffer_store_dwordx2 v[20:21], v54, s[4:7], s25 offen offset:1024 sc1
    s_mov_b32 m0, 124928
    s_nop 0
    buffer_load_dwordx4 v1, s[4:7], s69 offen offset:0 sc1 lds
    buffer_load_dwordx4 v1, s[4:7], s69 offen offset:1024 sc1 lds
    buffer_load_dwordx4 v1, s[4:7], s69 offen offset:2048 sc1 lds
    buffer_load_dwordx4 v1, s[4:7], s69 offen offset:3072 sc1 lds
    s_add_u32 s69, s69, 262144
    s_add_u32 m0, s53, 0
    s_add_u32 s22, s52, 0
    buffer_load_dwordx4 v1, s[4:7], s22 offen offset:0 sc1 lds
    buffer_load_dwordx4 v1, s[4:7], s22 offen offset:1024 sc1 lds
    buffer_load_dwordx4 v1, s[4:7], s22 offen offset:2048 sc1 lds
    buffer_load_dwordx4 v1, s[4:7], s22 offen offset:3072 sc1 lds
    s_add_u32 m0, s53, 4096
    s_add_u32 s22, s52, 131072
    buffer_load_dwordx4 v1, s[4:7], s22 offen offset:0 sc1 lds
    buffer_load_dwordx4 v1, s[4:7], s22 offen offset:1024 sc1 lds
    buffer_load_dwordx4 v1, s[4:7], s22 offen offset:2048 sc1 lds
    buffer_load_dwordx4 v1, s[4:7], s22 offen offset:3072 sc1 lds
    s_add_u32 s52, s52, 262144
    s_add_u32 s22, s16, 1
    v_mov_b32 v60, s22
    v_mov_b32 v32, 0
    v_mov_b32 v33, 0
    v_mov_b32 v34, 0
    v_mov_b32 v35, 0
    v_mov_b32 v36, 0
    v_mov_b32 v37, 0
    v_mov_b32 v38, 0
    v_mov_b32 v39, 0
    v_mov_b32 v40, 0
    v_mov_b32 v41, 0
    v_mov_b32 v42, 0
    v_mov_b32 v43, 0
    v_mov_b32 v44, 0
    v_mov_b32 v45, 0
    v_mov_b32 v46, 0
    v_mov_b32 v47, 0
    v_mov_b32 v48, 0
    v_mov_b32 v49, 0
    v_mov_b32 v50, 0
    v_mov_b32 v51, 0
    v_mov_b32 v52, 0
    v_mov_b32 v53, 0
    v_mov_b32 v54, 0
    v_mov_b32 v55, 0
    v_mov_b32 v0, 1.0
    s_mov_b32 exec_lo, 0xff00ff00
    s_mov_b32 exec_hi, 0xff00ff00
    v_mov_b32 v0, s47
    s_mov_b64 exec, -1
    s_waitcnt vmcnt(15) lgkmcnt(0)
    s_branch ploop_15_pchk
ploop_15_pnd:
    s_sleep 6
    s_nop 8
    buffer_load_dwordx4 v[16:19], v12, s[4:7], s30 offen sc1
    buffer_load_dword v15, off, s[4:7], s58 sc1
    s_add_u32 s22, s16, 1
    v_mov_b32 v60, s22
    v_mov_b32 v32, 0
    v_mov_b32 v33, 0
    v_mov_b32 v34, 0
    v_mov_b32 v35, 0
    v_mov_b32 v36, 0
    v_mov_b32 v37, 0
    v_mov_b32 v38, 0
    v_mov_b32 v39, 0
    v_mov_b32 v40, 0
    v_mov_b32 v41, 0
    v_mov_b32 v42, 0
    v_mov_b32 v43, 0
    v_mov_b32 v44, 0
    v_mov_b32 v45, 0
    v_mov_b32 v46, 0
    v_mov_b32 v47, 0
    v_mov_b32 v48, 0
    v_mov_b32 v49, 0
    v_mov_b32 v50, 0
    v_mov_b32 v51, 0
    v_mov_b32 v52, 0
    v_mov_b32 v53, 0
    v_mov_b32 v54, 0
    v_mov_b32 v55, 0
    v_mov_b32 v0, 1.0
    s_mov_b32 exec_lo, 0xff00ff00
    s_mov_b32 exec_hi, 0xff00ff00
    v_mov_b32 v0, s47
    s_mov_b64 exec, -1
    s_waitcnt vmcnt(1) lgkmcnt(0)
    s_branch ploop_15_pchk
ploop_15_pagain:
    s_waitcnt vmcnt(1) lgkmcnt(0)
ploop_15_pchk:
    v_mfma_f32_16x16x32_bf16 v[20:23], v[56:59], v[16:19], 0
    v_max3_u32 v9, v16, v17, v18
    v_max_u32 v9, v9, v19
    v_cmp_eq_u32 vcc, -1, v9
    s_cbranch_vccnz prp_19
ploop_15_pgo:
    s_nop 3
    v_add_f32_dpp v20, v20, v20 row_ror:8 row_mask:0xf bank_mask:0xf
    v_add_f32_dpp v21, v21, v21 row_ror:8 row_mask:0xf bank_mask:0xf
    v_add_f32_dpp v22, v22, v22 row_ror:8 row_mask:0xf bank_mask:0xf
    v_add_f32_dpp v23, v23, v23 row_ror:8 row_mask:0xf bank_mask:0xf
    v_cvt_pk_bf16_f32 v20, v20, v21
    v_cvt_pk_bf16_f32 v21, v22, v23
    s_mov_b32 exec_hi, 0
    v_min_u32 v20, -2, v20
    v_min_u32 v21, -2, v21
    s_mov_b32 exec_lo, 0x00ff00ff
    buffer_store_dwordx2 v[20:21], v13, s[4:7], s23 offen sc1
    s_mov_b64 exec, -1
    s_add_u32 s22, s19, s32
    s_add_u32 s25, s20, s36
    buffer_store_dword v10, v2, s[4:7], s22 offen sc1
    s_mov_b32 exec_hi, 0
    buffer_store_dword v10, v3, s[4:7], s22 offen sc1
    s_mov_b32 exec_lo, 0x00ff00ff
    buffer_store_dwordx2 v[10:11], v13, s[4:7], s25 offen sc1
    s_mov_b64 exec, -1
    s_add_u32 s16, s16, 1
    s_mov_b32 s17, s18
    s_mov_b32 s18, s19
    s_mov_b32 s19, s20
    s_add_u32 s20, s20, 262144
    s_cmp_eq_u32 s20, 210763776
    s_cselect_b32 s20, 209715200, s20
    s_branch ploop_15
prm_18_gt:
gate_22:
    v_readfirstlane_b32 s25, v15
    s_cmp_ge_u32 s25, s59
    s_cbranch_scc1 gate_22_ok
    s_sleep 8
    buffer_load_dword v15, off, s[4:7], s58 sc1
    s_waitcnt vmcnt(0)
    s_sub_u32 s26, s26, 1
    s_cbranch_scc0 gate_22
    s_mov_b32 s26, 0
gate_22_ok:
    s_branch prm_18_gtb
prm_18_0:
    s_sub_u32 s26, s26, 1
    s_cbranch_scc1 prm_18_0_g
    buffer_load_dwordx4 v[16:19], v1, s[4:7], s21 offen offset:0 sc1
    buffer_load_dwordx4 v[20:23], v1, s[4:7], s21 offen offset:1024 sc1
    buffer_load_dwordx4 v[24:27], v1, s[4:7], s21 offen offset:2048 sc1
    buffer_load_dwordx4 v[28:31], v1, s[4:7], s21 offen offset:3072 sc1
    s_waitcnt vmcnt(3)
    v_max3_u32 v9, v16, v17, v18
    v_max_u32 v9, v9, v19
    v_cmp_eq_u32 vcc, -1, v9
    s_cbranch_vccnz prm_18_0
    s_branch prm_18_0ok
prm_18_0_g:
    s_mov_b32 s26, 0
    s_waitcnt vmcnt(0)
    s_branch prm_18_0ok
prm_18_1:
    s_sub_u32 s26, s26, 1
    s_cbranch_scc1 prm_18_1_g
    buffer_load_dwordx4 v[20:23], v1, s[4:7], s21 offen offset:1024 sc1
    buffer_load_dwordx4 v[24:27], v1, s[4:7], s21 offen offset:2048 sc1
    buffer_load_dwordx4 v[28:31], v1, s[4:7], s21 offen offset:3072 sc1
    s_waitcnt vmcnt(2)
    v_max3_u32 v9, v20, v21, v22
    v_max_u32 v9, v9, v23
    v_cmp_eq_u32 vcc, -1, v9
    s_cbranch_vccnz prm_18_1
    s_branch prm_18_1ok
prm_18_1_g:
    s_mov_b32 s26, 0
    s_waitcnt vmcnt(0)
    s_branch prm_18_1ok
prm_18_2:
    s_sub_u32 s26, s26, 1
    s_cbranch_scc1 prm_18_2_g
    buffer_load_dwordx4 v[24:27], v1, s[4:7], s21 offen offset:2048 sc1
    buffer_load_dwordx4 v[28:31], v1, s[4:7], s21 offen offset:3072 sc1
    s_waitcnt vmcnt(1)
    v_max3_u32 v9, v24, v25, v26
    v_max_u32 v9, v9, v27
    v_cmp_eq_u32 vcc, -1, v9
    s_cbranch_vccnz prm_18_2
    s_branch prm_18_2ok
prm_18_2_g:
    s_mov_b32 s26, 0
    s_waitcnt vmcnt(0)
    s_branch prm_18_2ok
prm_18_3:
    s_sub_u32 s26, s26, 1
    s_cbranch_scc1 prm_18_3_g
    buffer_load_dwordx4 v[28:31], v1, s[4:7], s21 offen offset:3072 sc1
    s_waitcnt vmcnt(0)
    v_max3_u32 v9, v28, v29, v30
    v_max_u32 v9, v9, v31
    v_cmp_eq_u32 vcc, -1, v9
    s_cbranch_vccnz prm_18_3
    s_branch prm_18_3ok
prm_18_3_g:
    s_mov_b32 s26, 0
    s_waitcnt vmcnt(0)
    s_branch prm_18_3ok
prm_18_d:
gate_23:
    v_readfirstlane_b32 s25, v15
    s_cmp_ge_u32 s25, s59
    s_cbranch_scc1 gate_23_ok
    s_sleep 8
    buffer_load_dword v15, off, s[4:7], s58 sc1
    s_waitcnt vmcnt(0)
    s_sub_u32 s26, s26, 1
    s_cbranch_scc0 gate_23
    s_mov_b32 s26, 0
gate_23_ok:
    ds_write_b32 v14, v60
    v_add_f32 v32, v32, v33
    v_add_f32 v34, v34, v35
    ds_write2_b32 v4, v32, v34 offset0:0 offset1:104
    v_add_f32 v36, v36, v37
    v_add_f32 v38, v38, v39
    ds_write2_b32 v4, v36, v38 offset0:16 offset1:120
    v_add_f32 v40, v40, v41
    v_add_f32 v42, v42, v43
    ds_write2_b32 v4, v40, v42 offset0:32 offset1:136
    v_add_f32 v44, v44, v45
    v_add_f32 v46, v46, v47
    ds_write2_b32 v4, v44, v46 offset0:48 offset1:152
    v_add_f32 v48, v48, v49
    v_add_f32 v50, v50, v51
    ds_write2_b32 v4, v48, v50 offset0:64 offset1:168
    v_add_f32 v52, v52, v53
    v_add_f32 v54, v54, v55
    ds_write2_b32 v4, v52, v54 offset0:80 offset1:184
    s_branch pnc_16_done
prp_19:
    s_sub_u32 s26, s26, 1
    s_nop 3
    s_cbranch_scc1 prp_19_g
    buffer_load_dwordx4 v[16:19], v12, s[4:7], s30 offen sc1
    buffer_load_dword v15, off, s[4:7], s58 sc1
    s_branch ploop_15_pagain
prp_19_g:
    s_mov_b32 s26, 0
    s_branch ploop_15_pgo
ploop_15_zr:
    s_sub_u32 s26, s26, 1
    s_cbranch_scc1 ploop_15_zg
    buffer_load_dwordx4 v[32:35], v1, s[4:7], s22 offen offset:0 sc1
    buffer_load_dwordx4 v[36:39], v1, s[4:7], s22 offen offset:1024 sc1
    buffer_load_dwordx4 v[40:43], v1, s[4:7], s22 offen offset:2048 sc1
    buffer_load_dwordx4 v[44:47], v1, s[4:7], s22 offen offset:3072 sc1
    s_branch ploop_15_za
ploop_15_zg:
    s_mov_b32 s26, 0
    s_branch ploop_15_zok
ptail_17:
    s_cmp_eq_u32 s15, 0
    s_cbranch_scc1 ptail_17_nd
    s_nop 0
ptail_17_nd:
    s_barrier
    v_add_u32 v55, s68, v61
    ds_read_b128 v[24:27], v55 offset:0
    ds_read_b128 v[28:31], v55 offset:1024
    ds_read_b128 v[32:35], v55 offset:18560
    ds_read_b128 v[36:39], v55 offset:19584
    ds_read_b128 v[40:43], v55 offset:37120
    ds_read_b128 v[44:47], v55 offset:38144
    ds_read_b128 v[48:51], v55 offset:55680
    ds_read_b128 v[52:55], v55 offset:56704
    s_waitcnt lgkmcnt(4)
    v_add_f32 v24, v24, v32
    v_add_f32 v25, v25, v33
    v_add_f32 v26, v26, v34
    v_add_f32 v27, v27, v35
    v_add_f32 v28, v28, v36
    v_add_f32 v29, v29, v37
    v_add_f32 v30, v30, v38
    v_add_f32 v31, v31, v39
    s_waitcnt lgkmcnt(0)
    v_add_f32 v40, v40, v48
    v_add_f32 v41, v41, v49
    v_add_f32 v42, v42, v50
    v_add_f32 v43, v43, v51
    v_add_f32 v44, v44, v52
    v_add_f32 v45, v45, v53
    v_add_f32 v46, v46, v54
    v_add_f32 v47, v47, v55
    v_add_f32 v24, v24, v40
    v_add_f32 v25, v25, v41
    v_add_f32 v26, v26, v42
    v_add_f32 v27, v27, v43
    v_add_f32 v28, v28, v44
    v_add_f32 v29, v29, v45
    v_add_f32 v30, v30, v46
    v_add_f32 v31, v31, v47
    v_cvt_pk_bf16_f32 v24, v24, v25
    v_cvt_pk_bf16_f32 v25, v26, v27
    v_cvt_pk_bf16_f32 v26, v28, v29
    v_cvt_pk_bf16_f32 v27, v30, v31
    v_min_u32 v24, -2, v24
    v_min_u32 v25, -2, v25
    v_min_u32 v26, -2, v26
    v_min_u32 v27, -2, v27
    buffer_store_dwordx4 v[24:27], v1, s[4:7], s37 offen sc1
    s_branch k_end
ch_a_pro:
    s_mul_i32 s21, s2, 24576
    s_add_u32 s21, s21, 209711104
    v_lshlrev_b32 v1, 4, v0
    v_mov_b32 v4, -1
    v_mov_b32 v5, -1
    v_mov_b32 v6, -1
    v_mov_b32 v7, -1
    buffer_store_dwordx4 v[4:7], v1, s[4:7], s21 offen sc1
    s_add_u32 s21, s21, 4096
    buffer_store_dwordx4 v[4:7], v1, s[4:7], s21 offen sc1
    s_add_u32 s21, s21, 4096
    buffer_store_dwordx4 v[4:7], v1, s[4:7], s21 offen sc1
    s_add_u32 s21, s21, 4096
    buffer_store_dwordx4 v[4:7], v1, s[4:7], s21 offen sc1
    s_add_u32 s21, s21, 4096
    buffer_store_dwordx4 v[4:7], v1, s[4:7], s21 offen sc1
    s_add_u32 s21, s21, 4096
    buffer_store_dwordx4 v[4:7], v1, s[4:7], s21 offen sc1
    s_add_u32 s21, s21, 4096
    v_mov_b32 v2, s29
    s_waitcnt vmcnt(0)
    s_barrier
    s_cmp_lg_u32 s3, 4
    s_cbranch_scc1 ch_nox
    s_mov_b64 exec, 1
    buffer_atomic_add v2, off, s[64:67], s28 sc1
    s_mov_b64 exec, -1
ch_nox:
    v_and_b32 v20, 63, v0
    v_lshlrev_b32 v0, 4, v20
    s_sub_u32 s25, s3, 4
    s_lshl_b32 s46, s12, 2
    s_add_u32 s46, s46, s25
    s_lshl_b32 s21, s46, 18
    s_lshl_b32 s22, s13, 7
    s_add_u32 s21, s21, s22
    s_lshl_b32 s46, s46, 12
    s_lshl_b32 s23, s25, 13
    s_add_u32 s23, s23, 131072
    s_load_dwordx2 s[8:9], s[0:1], 40
    s_mov_b32 s10, 8388608
    s_mov_b32 s11, 131072
    v_lshrrev_b32 v21, 3, v20
    v_and_b32 v22, 7, v20
    v_lshlrev_b32 v21, 11, v21
    v_lshl_add_u32 v21, v22, 4, v21
    v_lshrrev_b32 v28, 4, v20
    v_and_b32 v29, 1, v28
    v_xor_b32 v29, 0, v29
    v_lshlrev_b32 v29, 2, v29
    v_lshl_add_u32 v29, v28, 3, v29
    v_bfe_u32 v28, v20, 2, 2
    v_add_u32 v29, v29, v28
    v_lshlrev_b32 v29, 7, v29
    v_and_b32 v28, 3, v20
    v_lshl_add_u32 v29, v28, 4, v29
    v_and_b32 v28, 1, v28
    v_xor_b32 v28, 0, v28
    v_lshl_add_u32 v24, v28, 3, v29
    v_add_u32 v24, s23, v24
    v_lshrrev_b32 v28, 4, v20
    v_and_b32 v29, 1, v28
    v_xor_b32 v29, 1, v29
    v_lshlrev_b32 v29, 2, v29
    v_lshl_add_u32 v29, v28, 3, v29
    v_bfe_u32 v28, v20, 2, 2
    v_add_u32 v29, v29, v28
    v_lshlrev_b32 v29, 7, v29
    v_and_b32 v28, 3, v20
    v_lshl_add_u32 v29, v28, 4, v29
    v_and_b32 v28, 1, v28
    v_xor_b32 v28, 0, v28
    v_lshl_add_u32 v25, v28, 3, v29
    v_add_u32 v25, s23, v25
    v_lshrrev_b32 v28, 4, v20
    v_and_b32 v29, 1, v28
    v_xor_b32 v29, 0, v29
    v_lshlrev_b32 v29, 2, v29
    v_lshl_add_u32 v29, v28, 3, v29
    v_bfe_u32 v28, v20, 2, 2
    v_add_u32 v29, v29, v28
    v_lshlrev_b32 v29, 7, v29
    v_and_b32 v28, 3, v20
    v_lshl_add_u32 v29, v28, 4, v29
    v_and_b32 v28, 1, v28
    v_xor_b32 v28, 1, v28
    v_lshl_add_u32 v26, v28, 3, v29
    v_add_u32 v26, s23, v26
    v_lshrrev_b32 v28, 4, v20
    v_and_b32 v29, 1, v28
    v_xor_b32 v29, 1, v29
    v_lshlrev_b32 v29, 2, v29
    v_lshl_add_u32 v29, v28, 3, v29
    v_bfe_u32 v28, v20, 2, 2
    v_add_u32 v29, v29, v28
    v_lshlrev_b32 v29, 7, v29
    v_and_b32 v28, 3, v20
    v_lshl_add_u32 v29, v28, 4, v29
    v_and_b32 v28, 1, v28
    v_xor_b32 v28, 1, v28
    v_lshl_add_u32 v27, v28, 3, v29
    v_add_u32 v27, s23, v27
    s_waitcnt lgkmcnt(0)
    s_add_u32 m0, s23, 0
    s_nop 0
    buffer_load_dwordx4 v21, s[8:11], s21 offen lds
    s_add_u32 s21, s21, 16384
    s_add_u32 m0, s23, 1024
    s_nop 0
    buffer_load_dwordx4 v21, s[8:11], s21 offen lds
    s_add_u32 s21, s21, 16384
    s_add_u32 m0, s23, 2048
    s_nop 0
    buffer_load_dwordx4 v21, s[8:11], s21 offen lds
    s_add_u32 s21, s21, 16384
    s_add_u32 m0, s23, 3072
    s_nop 0
    buffer_load_dwordx4 v21, s[8:11], s21 offen lds
    s_add_u32 s21, s21, 16384
    s_add_u32 m0, s23, 4096
    s_nop 0
    buffer_load_dwordx4 v21, s[8:11], s21 offen lds
    s_add_u32 s21, s21, 16384
    s_add_u32 m0, s23, 5120
    s_nop 0
    buffer_load_dwordx4 v21, s[8:11], s21 offen lds
    s_add_u32 s21, s21, 16384
    s_add_u32 m0, s23, 6144
    s_nop 0
    buffer_load_dwordx4 v21, s[8:11], s21 offen lds
    s_add_u32 s21, s21, 16384
    s_add_u32 m0, s23, 7168
    s_nop 0
    buffer_load_dwordx4 v21, s[8:11], s21 offen lds
    s_add_u32 s21, s21, 16384
    buffer_load_dwordx4 v[98:101], v21, s[8:11], s21 offen
    s_add_u32 s21, s21, 16384
    buffer_load_dwordx4 v[102:105], v21, s[8:11], s21 offen
    s_add_u32 s21, s21, 16384
    buffer_load_dwordx4 v[106:109], v21, s[8:11], s21 offen
    s_add_u32 s21, s21, 16384
    buffer_load_dwordx4 v[110:113], v21, s[8:11], s21 offen
    s_add_u32 s21, s21, 16384
    buffer_load_dwordx4 v[114:117], v21, s[8:11], s21 offen
    s_add_u32 s21, s21, 16384
    buffer_load_dwordx4 v[118:121], v21, s[8:11], s21 offen
    s_add_u32 s21, s21, 16384
    buffer_load_dwordx4 v[122:125], v21, s[8:11], s21 offen
    s_add_u32 s21, s21, 16384
    buffer_load_dwordx4 v[126:129], v21, s[8:11], s21 offen
    s_add_u32 s21, s21, 16384
    v_add_u32 v30, s23, v0
    s_waitcnt vmcnt(8)
    ds_read_b64_tr_b16 v[192:193], v24 offset:0
    ds_read_b64_tr_b16 v[194:195], v25 offset:0
    ds_read_b64_tr_b16 v[200:201], v26 offset:0
    ds_read_b64_tr_b16 v[202:203], v27 offset:0
    ds_read_b64_tr_b16 v[208:209], v24 offset:64
    ds_read_b64_tr_b16 v[210:211], v25 offset:64
    ds_read_b64_tr_b16 v[216:217], v26 offset:64
    ds_read_b64_tr_b16 v[218:219], v27 offset:64
    s_waitcnt lgkmcnt(0)
    ds_read_b64_tr_b16 v[196:197], v24 offset:4096
    ds_read_b64_tr_b16 v[198:199], v25 offset:4096
    ds_read_b64_tr_b16 v[204:205], v26 offset:4096
    ds_read_b64_tr_b16 v[206:207], v27 offset:4096
    ds_read_b64_tr_b16 v[212:213], v24 offset:4160
    ds_read_b64_tr_b16 v[214:215], v25 offset:4160
    ds_read_b64_tr_b16 v[220:221], v26 offset:4160
    ds_read_b64_tr_b16 v[222:223], v27 offset:4160
    s_waitcnt lgkmcnt(0)
    s_waitcnt vmcnt(0)
    ds_write_b128 v30, v[98:101] offset:0
    ds_write_b128 v30, v[102:105] offset:1024
    ds_write_b128 v30, v[106:109] offset:2048
    ds_write_b128 v30, v[110:113] offset:3072
    ds_write_b128 v30, v[114:117] offset:4096
    ds_write_b128 v30, v[118:121] offset:5120
    ds_write_b128 v30, v[122:125] offset:6144
    ds_write_b128 v30, v[126:129] offset:7168
    s_waitcnt lgkmcnt(0)
    ds_read_b64_tr_b16 v[224:225], v24 offset:0
    ds_read_b64_tr_b16 v[226:227], v25 offset:0
    ds_read_b64_tr_b16 v[232:233], v26 offset:0
    ds_read_b64_tr_b16 v[234:235], v27 offset:0
    ds_read_b64_tr_b16 v[240:241], v24 offset:64
    ds_read_b64_tr_b16 v[242:243], v25 offset:64
    ds_read_b64_tr_b16 v[248:249], v26 offset:64
    ds_read_b64_tr_b16 v[250:251], v27 offset:64
    s_waitcnt lgkmcnt(0)
    ds_read_b64_tr_b16 v[228:229], v24 offset:4096
    ds_read_b64_tr_b16 v[230:231], v25 offset:4096
    ds_read_b64_tr_b16 v[236:237], v26 offset:4096
    ds_read_b64_tr_b16 v[238:239], v27 offset:4096
    ds_read_b64_tr_b16 v[244:245], v24 offset:4160
    ds_read_b64_tr_b16 v[246:247], v25 offset:4160
    ds_read_b64_tr_b16 v[252:253], v26 offset:4160
    ds_read_b64_tr_b16 v[254:255], v27 offset:4160
    s_waitcnt lgkmcnt(0)
    v_lshrrev_b32 v21, 4, v20
    s_mul_i32 s21, s25, 18560
    s_add_u32 s21, s21, 16384
    v_add_u32 v1, s21, v0
    v_and_b32 v23, 15, v20
    v_mul_u32_u24 v21, 136, v21
    v_lshl_add_u32 v21, v23, 3, v21
    v_add_u32 v45, s21, v21
    s_lshl_b32 s53, s25, 13
    s_add_u32 s53, s53, 92160
    v_add_u32 v49, s53, v0
    v_mov_b32 v48, 0
    v_mov_b32 v4, 0x3f803f80
    v_mov_b32 v5, 0x3f803f80
    v_mov_b32 v6, 0x3f803f80
    v_mov_b32 v7, 0x3f803f80
    v_mov_b32 v8, 0
    v_mov_b32 v9, 0
    v_mov_b32 v10, 0
    v_mov_b32 v11, 0
    v_lshlrev_b32 v43, 2, v20
    v_mov_b32 v26, 0x44444444
    v_mov_b32 v27, 0xeeeeeeee
    v_and_b32 v28, 1, v20
    v_cmp_eq_u32 vcc, 0, v28
    s_mov_b32 s47, 0x3e0293ee
    s_lshl_b32 s32, s12, 15
    v_cndmask_b32 v41, v27, v26, vcc
    s_lshl_b32 s21, s25, 13
    s_add_u32 s32, s32, s21
    s_add_u32 s32, s32, 2097152
    s_lshl_b32 s21, s25, 2
    s_add_u32 s21, s21, 13312
    v_mov_b32 v47, s21
    s_lshl_b32 s27, s13, 2
    s_add_u32 s27, s27, s25
    s_lshl_b32 s62, s12, 7
    s_add_u32 s62, s62, 218112000
    s_lshl_b32 s33, s12, 14
    s_lshl_b32 s21, s25, 12
    s_add_u32 s33, s33, s21
    s_add_u32 s33, s33, 1179648
    v_mov_b32 v139, 0
    v_mov_b32 v140, 0
    v_mov_b32 v141, 0
    v_mov_b32 v143, 0
    v_mov_b32 v144, 0
    v_mov_b32 v145, 0
    v_mov_b32 v40, 0
    v_mov_b32 v42, 0
    v_mov_b32 v44, 0
    v_mov_b32 v46, 0
    v_mov_b32 v158, 0x7f800000
    s_mov_b32 exec_lo, 0xcccccccc
    s_mov_b32 exec_hi, 0xcccccccc
    v_mov_b32 v158, 0x42700000
    s_mov_b64 exec, -1
    s_cmp_lg_u32 s3, 4
    s_cbranch_scc1 ch_xcc_skip
    v_add_u32 v56, 128, v43
    s_movk_i32 s21, 192
    v_writelane_b32 v56, s21, 4
    v_mov_b32 v59, 63
    v_writelane_b32 v59, -1, 4
    v_mov_b32 v60, 32
    s_mov_b64 exec, 0x1f
ch_xcc:
    buffer_load_dword v57, v56, s[64:67], 0 offen sc1
    s_waitcnt vmcnt(0)
    v_and_b32 v62, v59, v57
    v_cmp_ne_u32 vcc, v62, v60
    s_cbranch_vccz ch_xcc_ok
    s_sleep 16
    s_sub_u32 s26, s26, 1
    s_cbranch_scc0 ch_xcc
    s_mov_b32 s26, 0
ch_xcc_ok:
    s_lshr_b32 s22, s12, 1
    v_readlane_b32 s23, v57, 0
    s_nop 2
    v_readlane_b32 s21, v57, s22
    s_mov_b64 exec, -1
    v_mov_b32 v58, 131072
    v_mov_b32 v57, s21
    ds_write_b32 v58, v57
    s_bfe_u32 s23, s23, 0x1000f
    v_and_b32 v60, 0x70, v0
    v_lshlrev_b32 v60, 3, v60
    s_mov_b32 s22, 218112000
ch_pgv:
    buffer_load_dword v61, v60, s[4:7], s22 offen offset:8 sc1
    s_waitcnt vmcnt(0) lgkmcnt(0)
    v_and_b32 v62, 1, v61
    v_cmp_eq_u32 vcc, 0, v62
    s_cbranch_vccz ch_pgvok
    s_sleep 8
    s_sub_u32 s26, s26, 1
    s_cbranch_scc0 ch_pgv
    s_mov_b32 s26, 0
ch_pgvok:
    v_bfe_u32 v62, v61, 1, 1
    v_ashrrev_i32 v61, 8, v61
    v_sub_u32 v59, 0, v61
    v_cmp_eq_u32 vcc, s23, v62
    s_mov_b32 s21, 0
    s_nop 1
    v_cndmask_b32 v61, v59, v61, vcc
    s_nop 1
    v_readlane_b32 s22, v61, 0
    s_add_i32 s21, s21, s22
    v_readlane_b32 s22, v61, 1
    s_add_i32 s21, s21, s22
    v_readlane_b32 s22, v61, 2
    s_add_i32 s21, s21, s22
    v_readlane_b32 s22, v61, 3
    s_add_i32 s21, s21, s22
    v_readlane_b32 s22, v61, 4
    s_add_i32 s21, s21, s22
    v_readlane_b32 s22, v61, 5
    s_add_i32 s21, s21, s22
    v_readlane_b32 s22, v61, 6
    s_add_i32 s21, s21, s22
    v_readlane_b32 s22, v61, 7
    s_add_i32 s21, s21, s22
    s_cmp_gt_i32 s21, 0
    s_cselect_b32 s21, 0x2000, 0
    v_mov_b32 v59, s21
    ds_write_b32 v58, v59 offset:4
    s_waitcnt lgkmcnt(0)
ch_xcc_skip:
    s_barrier
    s_barrier
    s_lshl_b32 s60, s12, 4
    s_add_u32 s60, s60, 218104320
    s_barrier
ch_g0:
    buffer_load_dword v57, off, s[4:7], s60 sc1
    s_waitcnt vmcnt(0)
    v_readfirstlane_b32 s21, v57
    s_cmp_ge_u32 s21, 12
    s_cbranch_scc1 ch_g0b
    s_sleep 8
    s_sub_u32 s26, s26, 1
    s_cbranch_scc0 ch_g0
    s_mov_b32 s26, 0
ch_g0b:
    s_add_u32 s21, s16, 0
    s_lshl_b32 s21, s21, 18
    s_add_u32 s21, s21, s46
    s_add_u32 s21, s21, 37748736
    s_add_u32 s22, s21, 131072
    buffer_load_dwordx4 v[160:163], v0, s[4:7], s21 offen offset:0 sc1
    buffer_load_dwordx4 v[164:167], v0, s[4:7], s21 offen offset:1024 sc1
    buffer_load_dwordx4 v[168:171], v0, s[4:7], s21 offen offset:2048 sc1
    buffer_load_dwordx4 v[172:175], v0, s[4:7], s21 offen offset:3072 sc1
    buffer_load_dwordx4 v[176:179], v0, s[4:7], s22 offen offset:0 sc1
    buffer_load_dwordx4 v[180:183], v0, s[4:7], s22 offen offset:1024 sc1
    buffer_load_dwordx4 v[184:187], v0, s[4:7], s22 offen offset:2048 sc1
    buffer_load_dwordx4 v[188:191], v0, s[4:7], s22 offen offset:3072 sc1
    s_add_u32 s21, s16, 0
    s_lshl_b32 s21, s21, 18
    s_add_u32 s21, s21, s46
    s_add_u32 s21, s21, 20971520
    s_add_u32 s22, s21, 131072
    buffer_load_dwordx4 v[98:101], v0, s[4:7], s21 offen offset:0 sc1
    buffer_load_dwordx4 v[102:105], v0, s[4:7], s21 offen offset:1024 sc1
    buffer_load_dwordx4 v[106:109], v0, s[4:7], s21 offen offset:2048 sc1
    buffer_load_dwordx4 v[110:113], v0, s[4:7], s21 offen offset:3072 sc1
    buffer_load_dwordx4 v[114:117], v0, s[4:7], s22 offen offset:0 sc1
    buffer_load_dwordx4 v[118:121], v0, s[4:7], s22 offen offset:1024 sc1
    buffer_load_dwordx4 v[122:125], v0, s[4:7], s22 offen offset:2048 sc1
    buffer_load_dwordx4 v[126:129], v0, s[4:7], s22 offen offset:3072 sc1
    s_waitcnt vmcnt(8)
    v_mfma_f32_16x16x32_bf16 v[50:53], v[160:163], v[192:195], 0
    v_mfma_f32_16x16x32_bf16 v[54:57], v[160:163], v[200:203], 0
    v_mfma_f32_16x16x32_bf16 v[58:61], v[160:163], v[208:211], 0
    v_mfma_f32_16x16x32_bf16 v[62:65], v[160:163], v[216:219], 0
    v_mfma_f32_16x16x32_bf16 v[66:69], v[176:179], v[192:195], 0
    v_mfma_f32_16x16x32_bf16 v[70:73], v[176:179], v[200:203], 0
    v_mfma_f32_16x16x32_bf16 v[74:77], v[176:179], v[208:211], 0
    v_mfma_f32_16x16x32_bf16 v[78:81], v[176:179], v[216:219], 0
    v_mfma_f32_16x16x32_bf16 v[50:53], v[164:167], v[196:199], v[50:53]
    v_mfma_f32_16x16x32_bf16 v[54:57], v[164:167], v[204:207], v[54:57]
    v_mfma_f32_16x16x32_bf16 v[58:61], v[164:167], v[212:215], v[58:61]
    v_mfma_f32_16x16x32_bf16 v[62:65], v[164:167], v[220:223], v[62:65]
    v_mfma_f32_16x16x32_bf16 v[66:69], v[180:183], v[196:199], v[66:69]
    v_mfma_f32_16x16x32_bf16 v[70:73], v[180:183], v[204:207], v[70:73]
    v_mfma_f32_16x16x32_bf16 v[74:77], v[180:183], v[212:215], v[74:77]
    v_mfma_f32_16x16x32_bf16 v[78:81], v[180:183], v[220:223], v[78:81]
    v_mfma_f32_16x16x32_bf16 v[50:53], v[168:171], v[224:227], v[50:53]
    v_mfma_f32_16x16x32_bf16 v[54:57], v[168:171], v[232:235], v[54:57]
    v_mfma_f32_16x16x32_bf16 v[58:61], v[168:171], v[240:243], v[58:61]
    v_mfma_f32_16x16x32_bf16 v[62:65], v[168:171], v[248:251], v[62:65]
    v_mfma_f32_16x16x32_bf16 v[66:69], v[184:187], v[224:227], v[66:69]
    v_mfma_f32_16x16x32_bf16 v[70:73], v[184:187], v[232:235], v[70:73]
    v_mfma_f32_16x16x32_bf16 v[74:77], v[184:187], v[240:243], v[74:77]
    v_mfma_f32_16x16x32_bf16 v[78:81], v[184:187], v[248:251], v[78:81]
    v_mfma_f32_16x16x32_bf16 v[50:53], v[172:175], v[228:231], v[50:53]
    v_mfma_f32_16x16x32_bf16 v[54:57], v[172:175], v[236:239], v[54:57]
    v_mfma_f32_16x16x32_bf16 v[58:61], v[172:175], v[244:247], v[58:61]
    v_mfma_f32_16x16x32_bf16 v[62:65], v[172:175], v[252:255], v[62:65]
    v_mfma_f32_16x16x32_bf16 v[66:69], v[188:191], v[228:231], v[66:69]
    v_mfma_f32_16x16x32_bf16 v[70:73], v[188:191], v[236:239], v[70:73]
    v_mfma_f32_16x16x32_bf16 v[74:77], v[188:191], v[244:247], v[74:77]
    v_mfma_f32_16x16x32_bf16 v[78:81], v[188:191], v[252:255], v[78:81]
    s_add_u32 s21, s16, 1
    s_lshl_b32 s21, s21, 18
    s_add_u32 s21, s21, s46
    s_add_u32 s21, s21, 37748736
    s_add_u32 s22, s21, 131072
    buffer_load_dwordx4 v[160:163], v0, s[4:7], s21 offen offset:0 sc1
    buffer_load_dwordx4 v[164:167], v0, s[4:7], s21 offen offset:1024 sc1
    buffer_load_dwordx4 v[168:171], v0, s[4:7], s21 offen offset:2048 sc1
    buffer_load_dwordx4 v[172:175], v0, s[4:7], s21 offen offset:3072 sc1
    buffer_load_dwordx4 v[176:179], v0, s[4:7], s22 offen offset:0 sc1
    buffer_load_dwordx4 v[180:183], v0, s[4:7], s22 offen offset:1024 sc1
    buffer_load_dwordx4 v[184:187], v0, s[4:7], s22 offen offset:2048 sc1
    buffer_load_dwordx4 v[188:191], v0, s[4:7], s22 offen offset:3072 sc1
    s_mov_b32 s34, 1
    s_nop 7
    v_cvt_pk_bf16_f32 v82, v50, v51
    v_cvt_pk_bf16_f32 v83, v52, v53
    v_cvt_pk_bf16_f32 v84, v66, v67
    v_cvt_pk_bf16_f32 v85, v68, v69
    v_cvt_pk_bf16_f32 v86, v54, v55
    v_cvt_pk_bf16_f32 v87, v56, v57
    v_cvt_pk_bf16_f32 v88, v70, v71
    v_cvt_pk_bf16_f32 v89, v72, v73
    v_cvt_pk_bf16_f32 v90, v58, v59
    v_cvt_pk_bf16_f32 v91, v60, v61
    v_cvt_pk_bf16_f32 v92, v74, v75
    v_cvt_pk_bf16_f32 v93, v76, v77
    v_cvt_pk_bf16_f32 v94, v62, v63
    v_cvt_pk_bf16_f32 v95, v64, v65
    v_cvt_pk_bf16_f32 v96, v78, v79
    v_cvt_pk_bf16_f32 v97, v80, v81
    v_mov_b32 v74, 0
    v_mov_b32 v75, 0
    v_mov_b32 v76, 0
    v_mov_b32 v77, 0
    v_mov_b32 v78, 0
    v_mov_b32 v79, 0
    v_mov_b32 v80, 0
    v_mov_b32 v81, 0
    v_mov_b32 v146, 0
    v_mov_b32 v147, 0
    v_mov_b32 v148, 0
    v_mov_b32 v149, 0
    v_mov_b32 v150, 0
    v_mov_b32 v151, 0
    v_mov_b32 v152, 0
    v_mov_b32 v153, 0
    v_mov_b32 v12, 0
    v_mov_b32 v13, 0
    v_mov_b32 v14, 0
    v_mov_b32 v15, 0
    v_mov_b32 v16, 0
    v_mov_b32 v17, 0
    v_mov_b32 v18, 0
    v_mov_b32 v19, 0
    v_mov_b32 v20, 0
    v_mov_b32 v21, 0
    v_mov_b32 v22, 0
    v_mov_b32 v23, 0
    v_mov_b32 v2, 0
    s_add_u32 s21, s17, s32
    s_add_u32 s22, s21, 4096
    s_setprio 2
    s_branch a_zl
.p2align 6
aloop_24:
    s_add_u32 s21, s17, s32
    s_add_u32 s22, s21, 4096
    v_mov_b32 v74, 0
    v_mov_b32 v75, 0
    v_mov_b32 v76, 0
    v_mov_b32 v77, 0
    v_mov_b32 v78, 0
    v_mov_b32 v79, 0
    v_mov_b32 v80, 0
    v_mov_b32 v81, 0
    v_mov_b32 v146, 0
    v_mov_b32 v147, 0
    v_mov_b32 v148, 0
    v_mov_b32 v149, 0
    v_mov_b32 v150, 0
    v_mov_b32 v151, 0
    v_mov_b32 v152, 0
    v_mov_b32 v153, 0
    s_add_u32 s30, s16, 1
    s_lshl_b32 s30, s30, 18
    s_add_u32 s30, s30, s46
    s_add_u32 s30, s30, 37748736
    s_add_u32 s31, s30, 131072
aloop_24_wm:
    ds_read_b32 v3, v47
    s_waitcnt lgkmcnt(0)
    v_readfirstlane_b32 s23, v3
    s_cmp_eq_u32 s23, s16
    s_cbranch_scc1 aloop_24_wmok
    s_sleep 1
    s_branch aloop_24_wm
aloop_24_wmok:
    buffer_load_dwordx4 v[160:163], v0, s[4:7], s30 offen offset:0 sc1
    buffer_load_dwordx4 v[164:167], v0, s[4:7], s30 offen offset:1024 sc1
    buffer_load_dwordx4 v[168:171], v0, s[4:7], s30 offen offset:2048 sc1
    buffer_load_dwordx4 v[172:175], v0, s[4:7], s30 offen offset:3072 sc1
    buffer_load_dwordx4 v[176:179], v0, s[4:7], s31 offen offset:0 sc1
    buffer_load_dwordx4 v[180:183], v0, s[4:7], s31 offen offset:1024 sc1
    buffer_load_dwordx4 v[184:187], v0, s[4:7], s31 offen offset:2048 sc1
    buffer_load_dwordx4 v[188:191], v0, s[4:7], s31 offen offset:3072 sc1
aloop_24_nv:
    s_setprio 2
    v_mov_b32 v2, s16
    s_barrier
    s_nop 15
    s_nop 13
    ds_read_b128 v[98:101], v49 offset:0
    ds_read_b128 v[102:105], v49 offset:1024
    ds_read_b128 v[106:109], v49 offset:2048
    ds_read_b128 v[110:113], v49 offset:3072
    ds_read_b128 v[114:117], v49 offset:4096
    ds_read_b128 v[118:121], v49 offset:5120
    ds_read_b128 v[122:125], v49 offset:6144
    ds_read_b128 v[126:129], v49 offset:7168
    v_mov_b32 v12, 0
    v_mov_b32 v13, 0
    v_mov_b32 v14, 0
    v_mov_b32 v15, 0
    v_mov_b32 v16, 0
    v_mov_b32 v17, 0
    v_mov_b32 v18, 0
    v_mov_b32 v19, 0
    v_mov_b32 v20, 0
    v_mov_b32 v21, 0
    v_mov_b32 v22, 0
    v_mov_b32 v23, 0
    s_sleep 3
    s_nop 13
a_zl:
    buffer_load_dwordx4 v[50:53], v0, s[4:7], s21 offen offset:0 sc1
    s_nop 7
    buffer_load_dwordx4 v[54:57], v0, s[4:7], s21 offen offset:1024 sc1
    s_nop 7
    buffer_load_dwordx4 v[58:61], v0, s[4:7], s21 offen offset:2048 sc1
    s_nop 7
    buffer_load_dwordx4 v[62:65], v0, s[4:7], s21 offen offset:3072 sc1
    s_nop 7
    buffer_load_dwordx4 v[66:69], v0, s[4:7], s22 offen offset:0 sc1
    s_nop 7
    buffer_load_dwordx4 v[70:73], v0, s[4:7], s22 offen offset:1024 sc1
    s_waitcnt lgkmcnt(0)
    s_waitcnt vmcnt(5)
    v_max3_u32 v3, v50, v51, v52
    v_max_u32 v3, v3, v53
    v_cmp_eq_u32 vcc, -1, v3
    s_cbranch_vccnz arq_25_0
arq_25_0ok:
    v_mfma_f32_16x16x32_bf16 v[12:15], v[98:101], v[50:53], v[12:15]
    v_mfma_f32_16x16x32_bf16 v[16:19], v[114:117], v[50:53], v[16:19]
    s_waitcnt vmcnt(4)
    v_max3_u32 v3, v54, v55, v56
    v_max_u32 v3, v3, v57
    v_cmp_eq_u32 vcc, -1, v3
    v_mfma_f32_16x16x32_bf16 v[20:23], v[50:53], v[50:53], v[20:23]
    s_cbranch_vccnz arq_25_1
arq_25_1ok:
    v_mfma_f32_16x16x32_bf16 v[12:15], v[102:105], v[54:57], v[12:15]
    v_mfma_f32_16x16x32_bf16 v[16:19], v[118:121], v[54:57], v[16:19]
    s_waitcnt vmcnt(3)
    v_max3_u32 v3, v58, v59, v60
    v_max_u32 v3, v3, v61
    v_cmp_eq_u32 vcc, -1, v3
    v_mfma_f32_16x16x32_bf16 v[20:23], v[54:57], v[54:57], v[20:23]
    s_cbranch_vccnz arq_25_2
arq_25_2ok:
    v_mfma_f32_16x16x32_bf16 v[12:15], v[106:109], v[58:61], v[12:15]
    v_mfma_f32_16x16x32_bf16 v[16:19], v[122:125], v[58:61], v[16:19]
    s_waitcnt vmcnt(2)
    v_max3_u32 v3, v62, v63, v64
    v_max_u32 v3, v3, v65
    v_cmp_eq_u32 vcc, -1, v3
    v_mfma_f32_16x16x32_bf16 v[20:23], v[58:61], v[58:61], v[20:23]
    s_cbranch_vccnz arq_25_3
arq_25_3ok:
    v_mfma_f32_16x16x32_bf16 v[12:15], v[110:113], v[62:65], v[12:15]
    ds_write_b32 v47, v2 offset:16
    v_mfma_f32_16x16x32_bf16 v[16:19], v[126:129], v[62:65], v[16:19]
    v_mfma_f32_16x16x32_bf16 v[20:23], v[62:65], v[62:65], v[20:23]
aloop_24_sdone:
    s_nop 0
    s_cmp_eq_u32 s16, 63
    s_cbranch_scc1 aloop_24_lsk
    s_nop 1
    v_exp_f32 v54, v12
    v_exp_f32 v55, v13
    s_waitcnt vmcnt(0)
    v_max3_u32 v24, v66, v67, v68
    v_max3_u32 v24, v24, v69, v70
    v_max3_u32 v24, v24, v71, v72
    v_max_u32 v24, v24, v73
    v_cmp_eq_u32 vcc, -1, v24
    s_cbranch_vccnz arq_25_v
    v_smfmac_f32_16x16x64_bf16 v[74:77], v[66:69], v[192:199], v41
    v_exp_f32 v56, v14
    v_smfmac_f32_16x16x64_bf16 v[78:81], v[66:69], v[200:207], v41
    v_exp_f32 v57, v15
    v_smfmac_f32_16x16x64_bf16 v[146:149], v[66:69], v[208:215], v41
    v_exp_f32 v58, v16
    v_smfmac_f32_16x16x64_bf16 v[150:153], v[66:69], v[216:223], v41
    v_exp_f32 v59, v17
    v_smfmac_f32_16x16x64_bf16 v[74:77], v[70:73], v[224:231], v41
    v_exp_f32 v60, v18
    v_smfmac_f32_16x16x64_bf16 v[78:81], v[70:73], v[232:239], v41
    v_exp_f32 v61, v19
    v_smfmac_f32_16x16x64_bf16 v[146:149], v[70:73], v[240:247], v41
    v_exp_f32 v62, v20
    v_smfmac_f32_16x16x64_bf16 v[150:153], v[70:73], v[248:255], v41
    v_exp_f32 v63, v21
    v_cvt_pk_bf16_f32 v154, v54, v55
    v_cvt_pk_bf16_f32 v155, v56, v57
    v_cvt_pk_bf16_f32 v156, v58, v59
    v_cvt_pk_bf16_f32 v157, v60, v61
    v_cvt_pk_bf16_f32 v8, v62, v63
    v_max3_f32 v2, |v12|, |v13|, |v14|
    v_mfma_f32_16x16x32_bf16 v[50:53], v[154:157], v[4:7], 0
    v_max3_f32 v3, |v15|, |v16|, |v17|
    v_add_f32 v74, v74, v75
    v_mfma_f32_16x16x32_bf16 v[50:53], v[8:11], v[4:7], v[50:53]
    v_add_f32 v76, v76, v77
    v_cvt_pk_bf16_f32 v40, v74, v76
    v_mfma_f32_16x16x32_bf16 v[24:27], v[154:157], v[82:85], 0
    v_add_f32 v78, v78, v79
    v_add_f32 v80, v80, v81
    v_mfma_f32_16x16x32_bf16 v[24:27], v[8:11], v[40:43], v[24:27]
    v_cvt_pk_bf16_f32 v42, v78, v80
    v_add_f32 v146, v146, v147
    v_mfma_f32_16x16x32_bf16 v[28:31], v[154:157], v[86:89], 0
    v_add_f32 v148, v148, v149
    v_cvt_pk_bf16_f32 v44, v146, v148
    v_mfma_f32_16x16x32_bf16 v[28:31], v[8:11], v[42:45], v[28:31]
    v_add_f32 v150, v150, v151
    v_add_f32 v152, v152, v153
    v_mfma_f32_16x16x32_bf16 v[32:35], v[154:157], v[90:93], 0
    v_cvt_pk_bf16_f32 v46, v150, v152
    v_rcp_f32 v52, v52
    v_mfma_f32_16x16x32_bf16 v[32:35], v[8:11], v[44:47], v[32:35]
    v_rcp_f32 v53, v53
    v_max3_f32 v2, v2, |v18|, |v19|
    v_mfma_f32_16x16x32_bf16 v[36:39], v[154:157], v[94:97], 0
    v_max3_f32 v3, v3, |v20|, |v21|
    v_max_f32 v2, v2, v3
    v_mfma_f32_16x16x32_bf16 v[36:39], v[8:11], v[46:49], v[36:39]
    v_cmp_nle_f32 vcc, v2, v158
    v_mul_f32 v26, v26, v52
    v_mul_f32 v27, v27, v53
    s_cbranch_vccnz aloop_24_tm
    v_mul_f32 v30, v30, v52
    v_mul_f32 v31, v31, v53
aloop_24_pvd:
    ds_write_b64 v45, v[26:27] offset:0
    v_mul_f32 v34, v34, v52
    v_mul_f32 v35, v35, v53
    ds_write_b64 v45, v[30:31] offset:544
    v_mul_f32 v38, v38, v52
    v_mul_f32 v39, v39, v53
    ds_write_b64 v45, v[34:35] offset:1088
    ds_write_b64 v45, v[38:39] offset:1632
aloop_24_lskb:
    s_waitcnt lgkmcnt(0)
    s_barrier
    s_setprio 0
    s_cmp_lg_u32 s27, 0
    s_cbranch_scc1 pg_26
    s_sub_u32 s25, s16, 1
    s_cbranch_scc1 pg_26
    v_mov_b32 v3, s25
    s_mov_b64 exec, 1
    buffer_store_dword v3, off, s[4:7], s62 sc1
    s_mov_b64 exec, -1
pg_26:
    s_add_u32 s21, s17, s33
    v_lshlrev_b32 v2, 1, v43
    s_cmp_eq_u32 s16, 63
    s_cbranch_scc1 aloop_24_nvw
    v_mfma_f32_16x16x32_bf16 v[50:53], v[160:163], v[192:195], 0
    v_mfma_f32_16x16x32_bf16 v[54:57], v[160:163], v[200:203], 0
    v_mfma_f32_16x16x32_bf16 v[58:61], v[160:163], v[208:211], 0
    v_mfma_f32_16x16x32_bf16 v[62:65], v[160:163], v[216:219], 0
    v_mfma_f32_16x16x32_bf16 v[66:69], v[176:179], v[192:195], 0
    v_mfma_f32_16x16x32_bf16 v[70:73], v[176:179], v[200:203], 0
    v_mfma_f32_16x16x32_bf16 v[74:77], v[176:179], v[208:211], 0
    v_mfma_f32_16x16x32_bf16 v[78:81], v[176:179], v[216:219], 0
    v_mfma_f32_16x16x32_bf16 v[50:53], v[164:167], v[196:199], v[50:53]
    v_mfma_f32_16x16x32_bf16 v[54:57], v[164:167], v[204:207], v[54:57]
    v_mfma_f32_16x16x32_bf16 v[58:61], v[164:167], v[212:215], v[58:61]
    v_mfma_f32_16x16x32_bf16 v[62:65], v[164:167], v[220:223], v[62:65]
    v_mfma_f32_16x16x32_bf16 v[66:69], v[180:183], v[196:199], v[66:69]
    v_mfma_f32_16x16x32_bf16 v[70:73], v[180:183], v[204:207], v[70:73]
    v_mfma_f32_16x16x32_bf16 v[74:77], v[180:183], v[212:215], v[74:77]
    v_mfma_f32_16x16x32_bf16 v[78:81], v[180:183], v[220:223], v[78:81]
    v_mfma_f32_16x16x32_bf16 v[50:53], v[168:171], v[224:227], v[50:53]
    v_mfma_f32_16x16x32_bf16 v[54:57], v[168:171], v[232:235], v[54:57]
    v_mfma_f32_16x16x32_bf16 v[58:61], v[168:171], v[240:243], v[58:61]
    v_mfma_f32_16x16x32_bf16 v[62:65], v[168:171], v[248:251], v[62:65]
    v_mfma_f32_16x16x32_bf16 v[66:69], v[184:187], v[224:227], v[66:69]
    v_mfma_f32_16x16x32_bf16 v[70:73], v[184:187], v[232:235], v[70:73]
    v_mfma_f32_16x16x32_bf16 v[74:77], v[184:187], v[240:243], v[74:77]
    v_mfma_f32_16x16x32_bf16 v[78:81], v[184:187], v[248:251], v[78:81]
    v_mfma_f32_16x16x32_bf16 v[50:53], v[172:175], v[228:231], v[50:53]
    v_mfma_f32_16x16x32_bf16 v[54:57], v[172:175], v[236:239], v[54:57]
    v_mfma_f32_16x16x32_bf16 v[58:61], v[172:175], v[244:247], v[58:61]
    v_mfma_f32_16x16x32_bf16 v[62:65], v[172:175], v[252:255], v[62:65]
    v_mfma_f32_16x16x32_bf16 v[66:69], v[188:191], v[228:231], v[66:69]
    v_mfma_f32_16x16x32_bf16 v[70:73], v[188:191], v[236:239], v[70:73]
    v_mfma_f32_16x16x32_bf16 v[74:77], v[188:191], v[244:247], v[74:77]
    v_mfma_f32_16x16x32_bf16 v[78:81], v[188:191], v[252:255], v[78:81]
    buffer_load_dwordx4 v[130:133], v0, s[4:7], s21 offen sc1
    buffer_load_dwordx2 v[146:147], v2, s[4:7], s21 offen offset:1024 sc1
    buffer_load_dwordx4 v[134:137], v0, s[4:7], s21 offen offset:2048 sc1
    buffer_load_dwordx2 v[148:149], v2, s[4:7], s21 offen offset:3072 sc1
    s_add_u32 s30, s16, 2
    s_lshl_b32 s30, s30, 18
    s_add_u32 s30, s30, s46
    s_add_u32 s30, s30, 37748736
    s_add_u32 s31, s30, 131072
    s_branch aloop_24_vwd
aloop_24_nvw:
    buffer_load_dwordx4 v[130:133], v0, s[4:7], s21 offen sc1
    buffer_load_dwordx2 v[146:147], v2, s[4:7], s21 offen offset:1024 sc1
    buffer_load_dwordx4 v[134:137], v0, s[4:7], s21 offen offset:2048 sc1
    buffer_load_dwordx2 v[148:149], v2, s[4:7], s21 offen offset:3072 sc1
aloop_24_vwd:
    v_add_u32 v48, s68, v1
    s_xor_b32 s68, s68, 8192
aloop_24_psa:
    s_waitcnt vmcnt(0)
    v_max3_u32 v3, v130, v131, v132
    v_max3_u32 v3, v3, v133, v134
    v_max3_u32 v3, v3, v135, v136
    v_max3_u32 v3, v3, v137, v146
    v_max3_u32 v3, v3, v147, v148
    v_max_u32 v3, v3, v149
    v_cmp_eq_u32 vcc, -1, v3
    s_cbranch_vccnz arq_25_ps
aloop_24_psok:
    v_mfma_f32_16x16x32_bf16 v[24:27], v[82:85], v[130:133], 0
    v_mfma_f32_16x16x32_bf16 v[28:31], v[86:89], v[130:133], 0
    v_mfma_f32_16x16x32_bf16 v[32:35], v[90:93], v[130:133], 0
    v_mfma_f32_16x16x32_bf16 v[36:39], v[94:97], v[130:133], 0
    v_mov_b32 v138, v146
    v_mfma_f32_16x16x32_bf16 v[12:15], v[82:85], v[134:137], 0
    v_mfma_f32_16x16x32_bf16 v[16:19], v[86:89], v[134:137], 0
    v_mfma_f32_16x16x32_bf16 v[20:23], v[90:93], v[134:137], 0
    v_mfma_f32_16x16x32_bf16 v[154:157], v[94:97], v[134:137], 0
    v_mov_b32 v142, v148
    v_mfma_f32_16x16x32_bf16 v[24:27], v[40:43], v[138:141], v[24:27]
    v_mfma_f32_16x16x32_bf16 v[28:31], v[42:45], v[138:141], v[28:31]
    v_mfma_f32_16x16x32_bf16 v[32:35], v[44:47], v[138:141], v[32:35]
    v_mfma_f32_16x16x32_bf16 v[36:39], v[46:49], v[138:141], v[36:39]
    v_mfma_f32_16x16x32_bf16 v[12:15], v[40:43], v[142:145], v[12:15]
    v_mfma_f32_16x16x32_bf16 v[16:19], v[42:45], v[142:145], v[16:19]
    v_mfma_f32_16x16x32_bf16 v[20:23], v[44:47], v[142:145], v[20:23]
    s_nop 1
    v_mfma_f32_16x16x32_bf16 v[154:157], v[46:49], v[142:145], v[154:157]
aloop_24_nev:
    ds_write_b128 v48, v[24:27] offset:2176
    v_cvt_pk_bf16_f32 v82, v50, v51
    v_cvt_pk_bf16_f32 v83, v52, v53
    ds_write_b128 v48, v[28:31] offset:3200
    v_cvt_pk_bf16_f32 v84, v66, v67
    v_cvt_pk_bf16_f32 v85, v68, v69
    ds_write_b128 v48, v[32:35] offset:4224
    v_cvt_pk_bf16_f32 v86, v54, v55
    v_cvt_pk_bf16_f32 v87, v56, v57
    ds_write_b128 v48, v[36:39] offset:5248
    v_cvt_pk_bf16_f32 v88, v70, v71
    v_cvt_pk_bf16_f32 v89, v72, v73
    ds_write_b128 v48, v[12:15] offset:6272
    v_cvt_pk_bf16_f32 v90, v58, v59
    v_cvt_pk_bf16_f32 v91, v60, v61
    ds_write_b128 v48, v[16:19] offset:7296
    v_cvt_pk_bf16_f32 v92, v74, v75
    v_cvt_pk_bf16_f32 v93, v76, v77
    ds_write_b128 v48, v[20:23] offset:8320
    v_cvt_pk_bf16_f32 v94, v62, v63
    v_cvt_pk_bf16_f32 v95, v64, v65
    ds_write_b128 v48, v[154:157] offset:9344
    v_cvt_pk_bf16_f32 v96, v78, v79
    v_cvt_pk_bf16_f32 v97, v80, v81
aloop_24_bgskip:
    s_waitcnt lgkmcnt(0)
    s_cmp_eq_u32 s16, 63
    s_cbranch_scc1 aloop_24_fin
    s_add_u32 s16, s16, 1
    s_mov_b32 s17, s18
    s_mov_b32 s18, s19
    s_mov_b32 s19, s20
    s_add_u32 s20, s20, 262144
    s_cmp_eq_u32 s20, 210763776
    s_cselect_b32 s20, 209715200, s20
    s_branch aloop_24
arq_25_0:
    s_sub_u32 s26, s26, 1
    s_cbranch_scc1 arq_25_0_g
    buffer_load_dwordx4 v[50:53], v0, s[4:7], s21 offen offset:0 sc1
    buffer_load_dwordx4 v[54:57], v0, s[4:7], s21 offen offset:1024 sc1
    buffer_load_dwordx4 v[58:61], v0, s[4:7], s21 offen offset:2048 sc1
    buffer_load_dwordx4 v[62:65], v0, s[4:7], s21 offen offset:3072 sc1
    buffer_load_dwordx4 v[66:69], v0, s[4:7], s22 offen offset:0 sc1
    buffer_load_dwordx4 v[70:73], v0, s[4:7], s22 offen offset:1024 sc1
    s_waitcnt vmcnt(5)
    v_max3_u32 v3, v50, v51, v52
    v_max_u32 v3, v3, v53
    v_cmp_eq_u32 vcc, -1, v3
    s_cbranch_vccnz arq_25_0
    s_branch arq_25_0ok
arq_25_0_g:
    s_mov_b32 s26, 0
    s_waitcnt vmcnt(0)
    s_branch arq_25_0ok
arq_25_1:
    s_sub_u32 s26, s26, 1
    s_cbranch_scc1 arq_25_1_g
    buffer_load_dwordx4 v[54:57], v0, s[4:7], s21 offen offset:1024 sc1
    buffer_load_dwordx4 v[58:61], v0, s[4:7], s21 offen offset:2048 sc1
    buffer_load_dwordx4 v[62:65], v0, s[4:7], s21 offen offset:3072 sc1
    buffer_load_dwordx4 v[66:69], v0, s[4:7], s22 offen offset:0 sc1
    buffer_load_dwordx4 v[70:73], v0, s[4:7], s22 offen offset:1024 sc1
    s_waitcnt vmcnt(4)
    v_max3_u32 v3, v54, v55, v56
    v_max_u32 v3, v3, v57
    v_cmp_eq_u32 vcc, -1, v3
    s_cbranch_vccnz arq_25_1
    s_branch arq_25_1ok
arq_25_1_g:
    s_mov_b32 s26, 0
    s_waitcnt vmcnt(0)
    s_branch arq_25_1ok
arq_25_2:
    s_sub_u32 s26, s26, 1
    s_cbranch_scc1 arq_25_2_g
    buffer_load_dwordx4 v[58:61], v0, s[4:7], s21 offen offset:2048 sc1
    buffer_load_dwordx4 v[62:65], v0, s[4:7], s21 offen offset:3072 sc1
    buffer_load_dwordx4 v[66:69], v0, s[4:7], s22 offen offset:0 sc1
    buffer_load_dwordx4 v[70:73], v0, s[4:7], s22 offen offset:1024 sc1
    s_waitcnt vmcnt(3)
    v_max3_u32 v3, v58, v59, v60
    v_max_u32 v3, v3, v61
    v_cmp_eq_u32 vcc, -1, v3
    s_cbranch_vccnz arq_25_2
    s_branch arq_25_2ok
arq_25_2_g:
    s_mov_b32 s26, 0
    s_waitcnt vmcnt(0)
    s_branch arq_25_2ok
arq_25_3:
    s_sub_u32 s26, s26, 1
    s_cbranch_scc1 arq_25_3_g
    buffer_load_dwordx4 v[62:65], v0, s[4:7], s21 offen offset:3072 sc1
    buffer_load_dwordx4 v[66:69], v0, s[4:7], s22 offen offset:0 sc1
    buffer_load_dwordx4 v[70:73], v0, s[4:7], s22 offen offset:1024 sc1
    s_waitcnt vmcnt(2)
    v_max3_u32 v3, v62, v63, v64
    v_max_u32 v3, v3, v65
    v_cmp_eq_u32 vcc, -1, v3
    s_cbranch_vccnz arq_25_3
    s_branch arq_25_3ok
arq_25_3_g:
    s_mov_b32 s26, 0
    s_waitcnt vmcnt(0)
    s_branch arq_25_3ok
arq_25_v:
    buffer_load_dwordx4 v[66:69], v0, s[4:7], s22 offen offset:0 sc1
    buffer_load_dwordx4 v[70:73], v0, s[4:7], s22 offen offset:1024 sc1
    v_max3_f32 v2, v12, v13, v14
    v_max3_f32 v3, v15, v16, v17
    v_max3_f32 v2, v2, v18, v19
    v_max3_f32 v3, v3, v20, v21
    v_max_f32 v2, v2, v3
    v_mov_b32 v3, v2
    s_nop 1
    v_permlane16_swap_b32 v3, v2
    v_max_f32 v2, v2, v3
    v_mov_b32 v3, v2
    s_nop 1
    v_permlane32_swap_b32 v3, v2
    v_max_f32 v2, v2, v3
    v_sub_f32 v12, v12, v2
    v_sub_f32 v13, v13, v2
    v_sub_f32 v14, v14, v2
    v_sub_f32 v15, v15, v2
    v_sub_f32 v16, v16, v2
    v_sub_f32 v17, v17, v2
    v_sub_f32 v18, v18, v2
    v_sub_f32 v19, v19, v2
    v_sub_f32 v20, v20, v2
    v_sub_f32 v21, v21, v2
    v_exp_f32 v54, v12
    v_exp_f32 v55, v13
    v_exp_f32 v56, v14
    v_exp_f32 v57, v15
    v_exp_f32 v58, v16
    v_exp_f32 v59, v17
    v_exp_f32 v60, v18
    v_exp_f32 v61, v19
    v_exp_f32 v62, v20
    v_exp_f32 v63, v21
    s_nop 0
    v_cvt_pk_bf16_f32 v154, v54, v55
    v_cvt_pk_bf16_f32 v155, v56, v57
    v_cvt_pk_bf16_f32 v156, v58, v59
    v_cvt_pk_bf16_f32 v157, v60, v61
    v_cvt_pk_bf16_f32 v8, v62, v63
    s_nop 0
    v_mfma_f32_16x16x32_bf16 v[50:53], v[154:157], v[4:7], 0
    v_mfma_f32_16x16x32_bf16 v[50:53], v[8:11], v[4:7], v[50:53]
    v_mfma_f32_16x16x32_bf16 v[24:27], v[154:157], v[82:85], 0
    v_mfma_f32_16x16x32_bf16 v[28:31], v[154:157], v[86:89], 0
    v_mfma_f32_16x16x32_bf16 v[32:35], v[154:157], v[90:93], 0
    v_mfma_f32_16x16x32_bf16 v[36:39], v[154:157], v[94:97], 0
arq_25_vs:
    s_waitcnt vmcnt(0)
    v_max3_u32 v3, v66, v67, v68
    v_max3_u32 v3, v3, v69, v70
    v_max3_u32 v3, v3, v71, v72
    v_max_u32 v3, v3, v73
    v_cmp_eq_u32 vcc, -1, v3
    s_cbranch_vccnz arq_25_vsr
    s_branch arq_25_vsok
arq_25_vsr:
    s_sub_u32 s26, s26, 1
    s_cbranch_scc1 arq_25_vsg
    buffer_load_dwordx4 v[66:69], v0, s[4:7], s22 offen offset:0 sc1
    buffer_load_dwordx4 v[70:73], v0, s[4:7], s22 offen offset:1024 sc1
    s_branch arq_25_vs
arq_25_vsg:
    s_mov_b32 s26, 0
arq_25_vsok:
    v_smfmac_f32_16x16x64_bf16 v[74:77], v[66:69], v[192:199], v41
    v_smfmac_f32_16x16x64_bf16 v[78:81], v[66:69], v[200:207], v41
    v_smfmac_f32_16x16x64_bf16 v[146:149], v[66:69], v[208:215], v41
    v_smfmac_f32_16x16x64_bf16 v[150:153], v[66:69], v[216:223], v41
    v_smfmac_f32_16x16x64_bf16 v[74:77], v[70:73], v[224:231], v41
    v_smfmac_f32_16x16x64_bf16 v[78:81], v[70:73], v[232:239], v41
    v_smfmac_f32_16x16x64_bf16 v[146:149], v[70:73], v[240:247], v41
    v_smfmac_f32_16x16x64_bf16 v[150:153], v[70:73], v[248:255], v41
    v_rcp_f32 v52, v52
    v_rcp_f32 v53, v53
    s_nop 2
    v_add_f32 v74, v74, v75
    v_add_f32 v76, v76, v77
    v_cvt_pk_bf16_f32 v40, v74, v76
    v_add_f32 v78, v78, v79
    v_add_f32 v80, v80, v81
    v_cvt_pk_bf16_f32 v42, v78, v80
    v_add_f32 v146, v146, v147
    v_add_f32 v148, v148, v149
    v_cvt_pk_bf16_f32 v44, v146, v148
    v_add_f32 v150, v150, v151
    v_add_f32 v152, v152, v153
    v_cvt_pk_bf16_f32 v46, v150, v152
    s_nop 1
    v_mfma_f32_16x16x32_bf16 v[24:27], v[8:11], v[40:43], v[24:27]
    v_mfma_f32_16x16x32_bf16 v[28:31], v[8:11], v[42:45], v[28:31]
    v_mfma_f32_16x16x32_bf16 v[32:35], v[8:11], v[44:47], v[32:35]
    v_mfma_f32_16x16x32_bf16 v[36:39], v[8:11], v[46:49], v[36:39]
    s_nop 4
    v_mul_f32 v26, v26, v52
    v_mul_f32 v27, v27, v53
    v_mul_f32 v30, v30, v52
    v_mul_f32 v31, v31, v53
    s_branch aloop_24_pvd
aloop_24_tm:
    s_nop 7
    v_max3_f32 v2, v12, v13, v14
    v_max3_f32 v3, v15, v16, v17
    v_max3_f32 v2, v2, v18, v19
    v_max3_f32 v3, v3, v20, v21
    v_max_f32 v2, v2, v3
    v_mov_b32 v3, v2
    s_nop 1
    v_permlane16_swap_b32 v3, v2
    v_max_f32 v2, v2, v3
    v_mov_b32 v3, v2
    s_nop 1
    v_permlane32_swap_b32 v3, v2
    v_max_f32 v2, v2, v3
    v_sub_f32 v12, v12, v2
    v_sub_f32 v13, v13, v2
    v_sub_f32 v14, v14, v2
    v_sub_f32 v15, v15, v2
    v_sub_f32 v16, v16, v2
    v_sub_f32 v17, v17, v2
    v_sub_f32 v18, v18, v2
    v_sub_f32 v19, v19, v2
    v_sub_f32 v20, v20, v2
    v_sub_f32 v21, v21, v2
    v_exp_f32 v54, v12
    v_exp_f32 v55, v13
    v_exp_f32 v56, v14
    v_exp_f32 v57, v15
    v_exp_f32 v58, v16
    v_exp_f32 v59, v17
    v_exp_f32 v60, v18
    v_exp_f32 v61, v19
    v_exp_f32 v62, v20
    v_exp_f32 v63, v21
    s_nop 0
    v_cvt_pk_bf16_f32 v154, v54, v55
    v_cvt_pk_bf16_f32 v155, v56, v57
    v_cvt_pk_bf16_f32 v156, v58, v59
    v_cvt_pk_bf16_f32 v157, v60, v61
    v_cvt_pk_bf16_f32 v8, v62, v63
    s_nop 0
    v_mfma_f32_16x16x32_bf16 v[50:53], v[154:157], v[4:7], 0
    v_mfma_f32_16x16x32_bf16 v[50:53], v[8:11], v[4:7], v[50:53]
    v_mfma_f32_16x16x32_bf16 v[24:27], v[154:157], v[82:85], 0
    v_mfma_f32_16x16x32_bf16 v[28:31], v[154:157], v[86:89], 0
    v_mfma_f32_16x16x32_bf16 v[32:35], v[154:157], v[90:93], 0
    v_mfma_f32_16x16x32_bf16 v[36:39], v[154:157], v[94:97], 0
    v_mfma_f32_16x16x32_bf16 v[24:27], v[8:11], v[40:43], v[24:27]
    v_mfma_f32_16x16x32_bf16 v[28:31], v[8:11], v[42:45], v[28:31]
    v_mfma_f32_16x16x32_bf16 v[32:35], v[8:11], v[44:47], v[32:35]
    v_mfma_f32_16x16x32_bf16 v[36:39], v[8:11], v[46:49], v[36:39]
    v_rcp_f32 v52, v52
    v_rcp_f32 v53, v53
    s_nop 4
    v_mul_f32 v26, v26, v52
    v_mul_f32 v27, v27, v53
    v_mul_f32 v30, v30, v52
    v_mul_f32 v31, v31, v53
    s_branch aloop_24_pvd
aloop_24_lz:
    buffer_load_dwordx4 v[66:69], v0, s[4:7], s22 offen offset:0 sc1
    buffer_load_dwordx4 v[70:73], v0, s[4:7], s22 offen offset:1024 sc1
    ds_write_b32 v47, v2 offset:16
aloop_24_lsk:
arq_25_vl:
    s_waitcnt vmcnt(0)
    v_max3_u32 v3, v66, v67, v68
    v_max3_u32 v3, v3, v69, v70
    v_max3_u32 v3, v3, v71, v72
    v_max_u32 v3, v3, v73
    v_cmp_eq_u32 vcc, -1, v3
    s_cbranch_vccnz arq_25_vlr
    s_branch arq_25_vlok
arq_25_vlr:
    s_sub_u32 s26, s26, 1
    s_cbranch_scc1 arq_25_vlg
    buffer_load_dwordx4 v[66:69], v0, s[4:7], s22 offen offset:0 sc1
    buffer_load_dwordx4 v[70:73], v0, s[4:7], s22 offen offset:1024 sc1
    s_branch arq_25_vl
arq_25_vlg:
    s_mov_b32 s26, 0
arq_25_vlok:
    v_smfmac_f32_16x16x64_bf16 v[74:77], v[66:69], v[192:199], v41
    v_smfmac_f32_16x16x64_bf16 v[78:81], v[66:69], v[200:207], v41
    v_smfmac_f32_16x16x64_bf16 v[146:149], v[66:69], v[208:215], v41
    v_smfmac_f32_16x16x64_bf16 v[150:153], v[66:69], v[216:223], v41
    v_smfmac_f32_16x16x64_bf16 v[74:77], v[70:73], v[224:231], v41
    v_smfmac_f32_16x16x64_bf16 v[78:81], v[70:73], v[232:239], v41
    v_smfmac_f32_16x16x64_bf16 v[146:149], v[70:73], v[240:247], v41
    v_smfmac_f32_16x16x64_bf16 v[150:153], v[70:73], v[248:255], v41
    s_nop 4
    v_add_f32 v74, v74, v75
    v_add_f32 v76, v76, v77
    v_cvt_pk_bf16_f32 v40, v74, v76
    v_add_f32 v78, v78, v79
    v_add_f32 v80, v80, v81
    v_cvt_pk_bf16_f32 v42, v78, v80
    v_add_f32 v146, v146, v147
    v_add_f32 v148, v148, v149
    v_cvt_pk_bf16_f32 v44, v146, v148
    v_add_f32 v150, v150, v151
    v_add_f32 v152, v152, v153
    v_cvt_pk_bf16_f32 v46, v150, v152
    s_branch aloop_24_lskb
arq_25_ps:
    s_sub_u32 s26, s26, 1
    s_cbranch_scc1 arq_25_psg
    s_sleep 2
    buffer_load_dwordx4 v[130:133], v0, s[4:7], s21 offen sc1
    buffer_load_dwordx2 v[146:147], v2, s[4:7], s21 offen offset:1024 sc1
    buffer_load_dwordx4 v[134:137], v0, s[4:7], s21 offen offset:2048 sc1
    buffer_load_dwordx2 v[148:149], v2, s[4:7], s21 offen offset:3072 sc1
    s_branch aloop_24_psa
arq_25_psg:
    s_mov_b32 s26, 0
    s_branch aloop_24_psok
aloop_24_fin:
    s_barrier
    s_branch k_end
k_end:
k_exit:
    s_endpgm
.section .rodata,"a"
.p2align 6
jobtab:
    .long 6, 24, 24, 8192, 0, 262144, 8388608, 0, 32768, 4, 20971520, 131072, 0, 0, 218104320, 1
    .long 4, 24, 24, 8192, 0, 262144, 8388608, 262144, 32768, 4, 22020096, 131072, 0, 0, 218104448, 1
    .long 1, 32, 32, 8192, 0, 256, 8388608, 1048576, 32768, 8, 41943040, 131072, 0, 0, 218104832, 4
    .long 1, 16, 16, 8192, 0, 256, 8388608, 2097152, 32768, 8, 12582912, 131072, 0, 0, 218105344, 4
    .long 1, 32, 32, 8192, 0, 256, 8388608, 3145728, 32768, 8, 50331648, 131072, 0, 0, 218105856, 4
    .long 1, 32, 32, 8192, 0, 256, 8388608, 3670016, 32768, 8, 52428800, 131072, 0, 0, 218106112, 4
    .long 1, 80, 80, 2048, 0, 256, 7340032, 54525952, 114688, 7, 167772160, 32768, 218103808, 7, 218106368, 1
    .long 0, 0, 0, 0, 0, 0, 0, 0, 0, 0, 0, 0, 0, 0, 0, 0
    .long 0, 0, 0, 0, 0, 0, 0, 0, 0, 0, 0, 0, 0, 0, 0, 0
    .long 0, 0, 0, 0, 0, 0, 0, 0, 0, 0, 0, 0, 0, 0, 0, 0
    .long 6, 24, 24, 8192, 2048, 264192, 8388608, 0, 32768, 4, 21004288, 131072, 0, 0, 218104352, 1
    .long 4, 24, 24, 8192, 2048, 264192, 8388608, 262144, 32768, 4, 22052864, 131072, 0, 0, 218104480, 1
    .long 1, 32, 32, 8192, 2048, 2304, 8388608, 1048576, 32768, 8, 41975808, 131072, 0, 0, 218104864, 4
    .long 1, 16, 16, 8192, 2048, 2304, 8388608, 2097152, 32768, 8, 12615680, 131072, 0, 0, 218105376, 4
    .long 1, 32, 32, 8192, 2048, 2304, 8388608, 3145728, 32768, 8, 50364416, 131072, 0, 0, 218105888, 4
    .long 1, 32, 32, 8192, 2048, 2304, 8388608, 3670016, 32768, 8, 52461568, 131072, 0, 0, 218106144, 4
    .long 1, 80, 80, 2048, 1835008, 1835264, 7340032, 54554624, 114688, 7, 171966464, 32768, 218103824, 7, 218106368, 1
    .long 0, 0, 0, 0, 0, 0, 0, 0, 0, 0, 0, 0, 0, 0, 0, 0
    .long 0, 0, 0, 0, 0, 0, 0, 0, 0, 0, 0, 0, 0, 0, 0, 0
    .long 0, 0, 0, 0, 0, 0, 0, 0, 0, 0, 0, 0, 0, 0, 0, 0
    .long 6, 24, 24, 8192, 4096, 266240, 8388608, 0, 32768, 4, 21037056, 131072, 0, 0, 218104384, 1
    .long 4, 24, 24, 8192, 4096, 266240, 8388608, 262144, 32768, 4, 22085632, 131072, 0, 0, 218104512, 1
    .long 1, 32, 32, 8192, 4096, 4352, 8388608, 1048576, 32768, 8, 42008576, 131072, 0, 0, 218104896, 4
    .long 1, 16, 16, 8192, 4096, 4352, 8388608, 2097152, 32768, 8, 12648448, 131072, 0, 0, 218105408, 4
    .long 1, 32, 32, 8192, 4096, 4352, 8388608, 3145728, 32768, 8, 50397184, 131072, 0, 0, 218105920, 4
    .long 1, 32, 32, 8192, 4096, 4352, 8388608, 3670016, 32768, 8, 52494336, 131072, 0, 0, 218106176, 4
    .long 1, 80, 80, 2048, 3670016, 3670272, 7340032, 54583296, 114688, 7, 176160768, 32768, 218103840, 7, 218106368, 1
    .long 0, 0, 0, 0, 0, 0, 0, 0, 0, 0, 0, 0, 0, 0, 0, 0
    .long 0, 0, 0, 0, 0, 0, 0, 0, 0, 0, 0, 0, 0, 0, 0, 0
    .long 0, 0, 0, 0, 0, 0, 0, 0, 0, 0, 0, 0, 0, 0, 0, 0
    .long 6, 24, 24, 8192, 6144, 268288, 8388608, 0, 32768, 4, 21069824, 131072, 0, 0, 218104416, 1
    .long 4, 24, 24, 8192, 6144, 268288, 8388608, 262144, 32768, 4, 22118400, 131072, 0, 0, 218104544, 1
    .long 1, 32, 32, 8192, 6144, 6400, 8388608, 1048576, 32768, 8, 42041344, 131072, 0, 0, 218104928, 4
    .long 1, 16, 16, 8192, 6144, 6400, 8388608, 2097152, 32768, 8, 12681216, 131072, 0, 0, 218105440, 4
    .long 1, 32, 32, 8192, 6144, 6400, 8388608, 3145728, 32768, 8, 50429952, 131072, 0, 0, 218105952, 4
    .long 1, 32, 32, 8192, 6144, 6400, 8388608, 3670016, 32768, 8, 52527104, 131072, 0, 0, 218106208, 4
    .long 1, 80, 80, 2048, 5505024, 5505280, 7340032, 54611968, 114688, 7, 180355072, 32768, 218103856, 7, 218106368, 1
    .long 0, 0, 0, 0, 0, 0, 0, 0, 0, 0, 0, 0, 0, 0, 0, 0
    .long 0, 0, 0, 0, 0, 0, 0, 0, 0, 0, 0, 0, 0, 0, 0, 0
    .long 0, 0, 0, 0, 0, 0, 0, 0, 0, 0, 0, 0, 0, 0, 0, 0
    .long 6, 24, 24, 8192, 256, 262400, 8388608, 0, 32768, 4, 20975616, 131072, 0, 0, 218104320, 1
    .long 4, 24, 24, 8192, 256, 262400, 8388608, 262144, 32768, 4, 22024192, 131072, 0, 0, 218104448, 1
    .long 1, 32, 32, 8192, 512, 768, 8388608, 1048576, 32768, 8, 41951232, 131072, 0, 0, 218104832, 4
    .long 1, 16, 16, 8192, 512, 768, 8388608, 2097152, 32768, 8, 12591104, 131072, 0, 0, 218105344, 4
    .long 1, 32, 32, 8192, 512, 768, 8388608, 3145728, 32768, 8, 50339840, 131072, 0, 0, 218105856, 4
    .long 1, 32, 32, 8192, 512, 768, 8388608, 3670016, 32768, 8, 52436992, 131072, 0, 0, 218106112, 4
    .long 1, 80, 80, 2048, 512, 768, 7340032, 54525952, 114688, 7, 167780352, 32768, 218103808, 7, 218106368, 1
    .long 0, 0, 0, 0, 0, 0, 0, 0, 0, 0, 0, 0, 0, 0, 0, 0
    .long 0, 0, 0, 0, 0, 0, 0, 0, 0, 0, 0, 0, 0, 0, 0, 0
    .long 0, 0, 0, 0, 0, 0, 0, 0, 0, 0, 0, 0, 0, 0, 0, 0
    .long 6, 24, 24, 8192, 2304, 264448, 8388608, 0, 32768, 4, 21008384, 131072, 0, 0, 218104352, 1
    .long 4, 24, 24, 8192, 2304, 264448, 8388608, 262144, 32768, 4, 22056960, 131072, 0, 0, 218104480, 1
    .long 1, 32, 32, 8192, 2560, 2816, 8388608, 1048576, 32768, 8, 41984000, 131072, 0, 0, 218104864, 4
    .long 1, 16, 16, 8192, 2560, 2816, 8388608, 2097152, 32768, 8, 12623872, 131072, 0, 0, 218105376, 4
    .long 1, 32, 32, 8192, 2560, 2816, 8388608, 3145728, 32768, 8, 50372608, 131072, 0, 0, 218105888, 4
    .long 1, 32, 32, 8192, 2560, 2816, 8388608, 3670016, 32768, 8, 52469760, 131072, 0, 0, 218106144, 4
    .long 1, 80, 80, 2048, 1835520, 1835776, 7340032, 54554624, 114688, 7, 171974656, 32768, 218103824, 7, 218106368, 1
    .long 0, 0, 0, 0, 0, 0, 0, 0, 0, 0, 0, 0, 0, 0, 0, 0
    .long 0, 0, 0, 0, 0, 0, 0, 0, 0, 0, 0, 0, 0, 0, 0, 0
    .long 0, 0, 0, 0, 0, 0, 0, 0, 0, 0, 0, 0, 0, 0, 0, 0
    .long 6, 24, 24, 8192, 4352, 266496, 8388608, 0, 32768, 4, 21041152, 131072, 0, 0, 218104384, 1
    .long 4, 24, 24, 8192, 4352, 266496, 8388608, 262144, 32768, 4, 22089728, 131072, 0, 0, 218104512, 1
    .long 1, 32, 32, 8192, 4608, 4864, 8388608, 1048576, 32768, 8, 42016768, 131072, 0, 0, 218104896, 4
    .long 1, 16, 16, 8192, 4608, 4864, 8388608, 2097152, 32768, 8, 12656640, 131072, 0, 0, 218105408, 4
    .long 1, 32, 32, 8192, 4608, 4864, 8388608, 3145728, 32768, 8, 50405376, 131072, 0, 0, 218105920, 4
    .long 1, 32, 32, 8192, 4608, 4864, 8388608, 3670016, 32768, 8, 52502528, 131072, 0, 0, 218106176, 4
    .long 1, 80, 80, 2048, 3670528, 3670784, 7340032, 54583296, 114688, 7, 176168960, 32768, 218103840, 7, 218106368, 1
    .long 0, 0, 0, 0, 0, 0, 0, 0, 0, 0, 0, 0, 0, 0, 0, 0
    .long 0, 0, 0, 0, 0, 0, 0, 0, 0, 0, 0, 0, 0, 0, 0, 0
    .long 0, 0, 0, 0, 0, 0, 0, 0, 0, 0, 0, 0, 0, 0, 0, 0
    .long 6, 24, 24, 8192, 6400, 268544, 8388608, 0, 32768, 4, 21073920, 131072, 0, 0, 218104416, 1
    .long 4, 24, 24, 8192, 6400, 268544, 8388608, 262144, 32768, 4, 22122496, 131072, 0, 0, 218104544, 1
    .long 1, 32, 32, 8192, 6656, 6912, 8388608, 1048576, 32768, 8, 42049536, 131072, 0, 0, 218104928, 4
    .long 1, 16, 16, 8192, 6656, 6912, 8388608, 2097152, 32768, 8, 12689408, 131072, 0, 0, 218105440, 4
    .long 1, 32, 32, 8192, 6656, 6912, 8388608, 3145728, 32768, 8, 50438144, 131072, 0, 0, 218105952, 4
    .long 1, 32, 32, 8192, 6656, 6912, 8388608, 3670016, 32768, 8, 52535296, 131072, 0, 0, 218106208, 4
    .long 1, 80, 80, 2048, 5505536, 5505792, 7340032, 54611968, 114688, 7, 180363264, 32768, 218103856, 7, 218106368, 1
    .long 0, 0, 0, 0, 0, 0, 0, 0, 0, 0, 0, 0, 0, 0, 0, 0
    .long 0, 0, 0, 0, 0, 0, 0, 0, 0, 0, 0, 0, 0, 0, 0, 0
    .long 0, 0, 0, 0, 0, 0, 0, 0, 0, 0, 0, 0, 0, 0, 0, 0
    .long 6, 24, 24, 8192, 512, 262656, 8388608, 0, 32768, 4, 20979712, 131072, 0, 0, 218104320, 1
    .long 4, 24, 24, 8192, 512, 262656, 8388608, 262144, 32768, 4, 22028288, 131072, 0, 0, 218104448, 1
    .long 1, 32, 32, 8192, 1024, 1280, 8388608, 1048576, 32768, 8, 41959424, 131072, 0, 0, 218104848, 4
    .long 1, 16, 16, 8192, 1024, 1280, 8388608, 2097152, 32768, 8, 12599296, 131072, 0, 0, 218105360, 4
    .long 1, 32, 32, 8192, 1024, 1280, 8388608, 3145728, 32768, 8, 50348032, 131072, 0, 0, 218105872, 4
    .long 1, 32, 32, 8192, 1024, 1280, 8388608, 3670016, 32768, 8, 52445184, 131072, 0, 0, 218106128, 4
    .long 1, 80, 80, 2048, 1024, 1280, 7340032, 54525952, 114688, 7, 167788544, 32768, 218103808, 7, 218106368, 1
    .long 0, 0, 0, 0, 0, 0, 0, 0, 0, 0, 0, 0, 0, 0, 0, 0
    .long 0, 0, 0, 0, 0, 0, 0, 0, 0, 0, 0, 0, 0, 0, 0, 0
    .long 0, 0, 0, 0, 0, 0, 0, 0, 0, 0, 0, 0, 0, 0, 0, 0
    .long 6, 24, 24, 8192, 2560, 264704, 8388608, 0, 32768, 4, 21012480, 131072, 0, 0, 218104352, 1
    .long 4, 24, 24, 8192, 2560, 264704, 8388608, 262144, 32768, 4, 22061056, 131072, 0, 0, 218104480, 1
    .long 1, 32, 32, 8192, 3072, 3328, 8388608, 1048576, 32768, 8, 41992192, 131072, 0, 0, 218104880, 4
    .long 1, 16, 16, 8192, 3072, 3328, 8388608, 2097152, 32768, 8, 12632064, 131072, 0, 0, 218105392, 4
    .long 1, 32, 32, 8192, 3072, 3328, 8388608, 3145728, 32768, 8, 50380800, 131072, 0, 0, 218105904, 4
    .long 1, 32, 32, 8192, 3072, 3328, 8388608, 3670016, 32768, 8, 52477952, 131072, 0, 0, 218106160, 4
    .long 1, 80, 80, 2048, 1836032, 1836288, 7340032, 54554624, 114688, 7, 171982848, 32768, 218103824, 7, 218106368, 1
    .long 0, 0, 0, 0, 0, 0, 0, 0, 0, 0, 0, 0, 0, 0, 0, 0
    .long 0, 0, 0, 0, 0, 0, 0, 0, 0, 0, 0, 0, 0, 0, 0, 0
    .long 0, 0, 0, 0, 0, 0, 0, 0, 0, 0, 0, 0, 0, 0, 0, 0
    .long 6, 24, 24, 8192, 4608, 266752, 8388608, 0, 32768, 4, 21045248, 131072, 0, 0, 218104384, 1
    .long 4, 24, 24, 8192, 4608, 266752, 8388608, 262144, 32768, 4, 22093824, 131072, 0, 0, 218104512, 1
    .long 1, 32, 32, 8192, 5120, 5376, 8388608, 1048576, 32768, 8, 42024960, 131072, 0, 0, 218104912, 4
    .long 1, 16, 16, 8192, 5120, 5376, 8388608, 2097152, 32768, 8, 12664832, 131072, 0, 0, 218105424, 4
    .long 1, 32, 32, 8192, 5120, 5376, 8388608, 3145728, 32768, 8, 50413568, 131072, 0, 0, 218105936, 4
    .long 1, 32, 32, 8192, 5120, 5376, 8388608, 3670016, 32768, 8, 52510720, 131072, 0, 0, 218106192, 4
    .long 1, 80, 80, 2048, 3671040, 3671296, 7340032, 54583296, 114688, 7, 176177152, 32768, 218103840, 7, 218106368, 1
    .long 0, 0, 0, 0, 0, 0, 0, 0, 0, 0, 0, 0, 0, 0, 0, 0
    .long 0, 0, 0, 0, 0, 0, 0, 0, 0, 0, 0, 0, 0, 0, 0, 0
    .long 0, 0, 0, 0, 0, 0, 0, 0, 0, 0, 0, 0, 0, 0, 0, 0
    .long 6, 24, 24, 8192, 6656, 268800, 8388608, 0, 32768, 4, 21078016, 131072, 0, 0, 218104416, 1
    .long 4, 24, 24, 8192, 6656, 268800, 8388608, 262144, 32768, 4, 22126592, 131072, 0, 0, 218104544, 1
    .long 1, 32, 32, 8192, 7168, 7424, 8388608, 1048576, 32768, 8, 42057728, 131072, 0, 0, 218104944, 4
    .long 1, 16, 16, 8192, 7168, 7424, 8388608, 2097152, 32768, 8, 12697600, 131072, 0, 0, 218105456, 4
    .long 1, 32, 32, 8192, 7168, 7424, 8388608, 3145728, 32768, 8, 50446336, 131072, 0, 0, 218105968, 4
    .long 1, 32, 32, 8192, 7168, 7424, 8388608, 3670016, 32768, 8, 52543488, 131072, 0, 0, 218106224, 4
    .long 1, 80, 80, 2048, 5506048, 5506304, 7340032, 54611968, 114688, 7, 180371456, 32768, 218103856, 7, 218106368, 1
    .long 0, 0, 0, 0, 0, 0, 0, 0, 0, 0, 0, 0, 0, 0, 0, 0
    .long 0, 0, 0, 0, 0, 0, 0, 0, 0, 0, 0, 0, 0, 0, 0, 0
    .long 0, 0, 0, 0, 0, 0, 0, 0, 0, 0, 0, 0, 0, 0, 0, 0
    .long 6, 24, 24, 8192, 768, 262912, 8388608, 0, 32768, 4, 20983808, 131072, 0, 0, 218104320, 1
    .long 4, 24, 24, 8192, 768, 262912, 8388608, 262144, 32768, 4, 22032384, 131072, 0, 0, 218104448, 1
    .long 1, 32, 32, 8192, 1536, 1792, 8388608, 1048576, 32768, 8, 41967616, 131072, 0, 0, 218104848, 4
    .long 1, 16, 16, 8192, 1536, 1792, 8388608, 2097152, 32768, 8, 12607488, 131072, 0, 0, 218105360, 4
    .long 1, 32, 32, 8192, 1536, 1792, 8388608, 3145728, 32768, 8, 50356224, 131072, 0, 0, 218105872, 4
    .long 1, 32, 32, 8192, 1536, 1792, 8388608, 3670016, 32768, 8, 52453376, 131072, 0, 0, 218106128, 4
    .long 1, 80, 80, 2048, 1536, 1792, 7340032, 54525952, 114688, 7, 167796736, 32768, 218103808, 7, 218106368, 1
    .long 0, 0, 0, 0, 0, 0, 0, 0, 0, 0, 0, 0, 0, 0, 0, 0
    .long 0, 0, 0, 0, 0, 0, 0, 0, 0, 0, 0, 0, 0, 0, 0, 0
    .long 0, 0, 0, 0, 0, 0, 0, 0, 0, 0, 0, 0, 0, 0, 0, 0
    .long 6, 24, 24, 8192, 2816, 264960, 8388608, 0, 32768, 4, 21016576, 131072, 0, 0, 218104352, 1
    .long 4, 24, 24, 8192, 2816, 264960, 8388608, 262144, 32768, 4, 22065152, 131072, 0, 0, 218104480, 1
    .long 1, 32, 32, 8192, 3584, 3840, 8388608, 1048576, 32768, 8, 42000384, 131072, 0, 0, 218104880, 4
    .long 1, 16, 16, 8192, 3584, 3840, 8388608, 2097152, 32768, 8, 12640256, 131072, 0, 0, 218105392, 4
    .long 1, 32, 32, 8192, 3584, 3840, 8388608, 3145728, 32768, 8, 50388992, 131072, 0, 0, 218105904, 4
    .long 1, 32, 32, 8192, 3584, 3840, 8388608, 3670016, 32768, 8, 52486144, 131072, 0, 0, 218106160, 4
    .long 1, 80, 80, 2048, 1836544, 1836800, 7340032, 54554624, 114688, 7, 171991040, 32768, 218103824, 7, 218106368, 1
    .long 0, 0, 0, 0, 0, 0, 0, 0, 0, 0, 0, 0, 0, 0, 0, 0
    .long 0, 0, 0, 0, 0, 0, 0, 0, 0, 0, 0, 0, 0, 0, 0, 0
    .long 0, 0, 0, 0, 0, 0, 0, 0, 0, 0, 0, 0, 0, 0, 0, 0
    .long 6, 24, 24, 8192, 4864, 267008, 8388608, 0, 32768, 4, 21049344, 131072, 0, 0, 218104384, 1
    .long 4, 24, 24, 8192, 4864, 267008, 8388608, 262144, 32768, 4, 22097920, 131072, 0, 0, 218104512, 1
    .long 1, 32, 32, 8192, 5632, 5888, 8388608, 1048576, 32768, 8, 42033152, 131072, 0, 0, 218104912, 4
    .long 1, 16, 16, 8192, 5632, 5888, 8388608, 2097152, 32768, 8, 12673024, 131072, 0, 0, 218105424, 4
    .long 1, 32, 32, 8192, 5632, 5888, 8388608, 3145728, 32768, 8, 50421760, 131072, 0, 0, 218105936, 4
    .long 1, 32, 32, 8192, 5632, 5888, 8388608, 3670016, 32768, 8, 52518912, 131072, 0, 0, 218106192, 4
    .long 1, 80, 80, 2048, 3671552, 3671808, 7340032, 54583296, 114688, 7, 176185344, 32768, 218103840, 7, 218106368, 1
    .long 0, 0, 0, 0, 0, 0, 0, 0, 0, 0, 0, 0, 0, 0, 0, 0
    .long 0, 0, 0, 0, 0, 0, 0, 0, 0, 0, 0, 0, 0, 0, 0, 0
    .long 0, 0, 0, 0, 0, 0, 0, 0, 0, 0, 0, 0, 0, 0, 0, 0
    .long 6, 24, 24, 8192, 6912, 269056, 8388608, 0, 32768, 4, 21082112, 131072, 0, 0, 218104416, 1
    .long 4, 24, 24, 8192, 6912, 269056, 8388608, 262144, 32768, 4, 22130688, 131072, 0, 0, 218104544, 1
    .long 1, 32, 32, 8192, 7680, 7936, 8388608, 1048576, 32768, 8, 42065920, 131072, 0, 0, 218104944, 4
    .long 1, 16, 16, 8192, 7680, 7936, 8388608, 2097152, 32768, 8, 12705792, 131072, 0, 0, 218105456, 4
    .long 1, 32, 32, 8192, 7680, 7936, 8388608, 3145728, 32768, 8, 50454528, 131072, 0, 0, 218105968, 4
    .long 1, 32, 32, 8192, 7680, 7936, 8388608, 3670016, 32768, 8, 52551680, 131072, 0, 0, 218106224, 4
    .long 1, 80, 80, 2048, 5506560, 5506816, 7340032, 54611968, 114688, 7, 180379648, 32768, 218103856, 7, 218106368, 1
    .long 0, 0, 0, 0, 0, 0, 0, 0, 0, 0, 0, 0, 0, 0, 0, 0
    .long 0, 0, 0, 0, 0, 0, 0, 0, 0, 0, 0, 0, 0, 0, 0, 0
    .long 0, 0, 0, 0, 0, 0, 0, 0, 0, 0, 0, 0, 0, 0, 0, 0
    .long 6, 24, 24, 8192, 1024, 263168, 8388608, 0, 32768, 4, 20987904, 131072, 0, 0, 218104336, 1
    .long 4, 24, 24, 8192, 1024, 263168, 8388608, 262144, 32768, 4, 22036480, 131072, 0, 0, 218104464, 1
    .long 1, 24, 24, 8192, 0, 256, 8388608, 1048576, 32768, 8, 25165824, 131072, 0, 0, 218104832, 4
    .long 1, 32, 32, 8192, 0, 256, 8388608, 2621440, 32768, 8, 48234496, 131072, 0, 0, 218105600, 4
    .long 1, 24, 24, 8192, 0, 256, 8388608, 3145728, 32768, 8, 33554432, 131072, 0, 0, 218105856, 4
    .long 1, 24, 24, 8192, 0, 256, 8388608, 3670016, 32768, 8, 35651584, 131072, 0, 0, 218106112, 4
    .long 1, 80, 80, 2048, 0, 256, 7340032, 56360960, 114688, 7, 168296448, 32768, 218103872, 7, 218106432, 1
    .long 0, 0, 0, 0, 0, 0, 0, 0, 0, 0, 0, 0, 0, 0, 0, 0
    .long 0, 0, 0, 0, 0, 0, 0, 0, 0, 0, 0, 0, 0, 0, 0, 0
    .long 0, 0, 0, 0, 0, 0, 0, 0, 0, 0, 0, 0, 0, 0, 0, 0
    .long 6, 24, 24, 8192, 3072, 265216, 8388608, 0, 32768, 4, 21020672, 131072, 0, 0, 218104368, 1
    .long 4, 24, 24, 8192, 3072, 265216, 8388608, 262144, 32768, 4, 22069248, 131072, 0, 0, 218104496, 1
    .long 1, 24, 24, 8192, 2048, 2304, 8388608, 1048576, 32768, 8, 25198592, 131072, 0, 0, 218104864, 4
    .long 1, 32, 32, 8192, 2048, 2304, 8388608, 2621440, 32768, 8, 48267264, 131072, 0, 0, 218105632, 4
    .long 1, 24, 24, 8192, 2048, 2304, 8388608, 3145728, 32768, 8, 33587200, 131072, 0, 0, 218105888, 4
    .long 1, 24, 24, 8192, 2048, 2304, 8388608, 3670016, 32768, 8, 35684352, 131072, 0, 0, 218106144, 4
    .long 1, 80, 80, 2048, 1835008, 1835264, 7340032, 56389632, 114688, 7, 172490752, 32768, 218103888, 7, 218106432, 1
    .long 0, 0, 0, 0, 0, 0, 0, 0, 0, 0, 0, 0, 0, 0, 0, 0
    .long 0, 0, 0, 0, 0, 0, 0, 0, 0, 0, 0, 0, 0, 0, 0, 0
    .long 0, 0, 0, 0, 0, 0, 0, 0, 0, 0, 0, 0, 0, 0, 0, 0
    .long 6, 24, 24, 8192, 5120, 267264, 8388608, 0, 32768, 4, 21053440, 131072, 0, 0, 218104400, 1
    .long 4, 24, 24, 8192, 5120, 267264, 8388608, 262144, 32768, 4, 22102016, 131072, 0, 0, 218104528, 1
    .long 1, 24, 24, 8192, 4096, 4352, 8388608, 1048576, 32768, 8, 25231360, 131072, 0, 0, 218104896, 4
    .long 1, 32, 32, 8192, 4096, 4352, 8388608, 2621440, 32768, 8, 48300032, 131072, 0, 0, 218105664, 4
    .long 1, 24, 24, 8192, 4096, 4352, 8388608, 3145728, 32768, 8, 33619968, 131072, 0, 0, 218105920, 4
    .long 1, 24, 24, 8192, 4096, 4352, 8388608, 3670016, 32768, 8, 35717120, 131072, 0, 0, 218106176, 4
    .long 1, 80, 80, 2048, 3670016, 3670272, 7340032, 56418304, 114688, 7, 176685056, 32768, 218103904, 7, 218106432, 1
    .long 0, 0, 0, 0, 0, 0, 0, 0, 0, 0, 0, 0, 0, 0, 0, 0
    .long 0, 0, 0, 0, 0, 0, 0, 0, 0, 0, 0, 0, 0, 0, 0, 0
    .long 0, 0, 0, 0, 0, 0, 0, 0, 0, 0, 0, 0, 0, 0, 0, 0
    .long 6, 24, 24, 8192, 7168, 269312, 8388608, 0, 32768, 4, 21086208, 131072, 0, 0, 218104432, 1
    .long 4, 24, 24, 8192, 7168, 269312, 8388608, 262144, 32768, 4, 22134784, 131072, 0, 0, 218104560, 1
    .long 1, 24, 24, 8192, 6144, 6400, 8388608, 1048576, 32768, 8, 25264128, 131072, 0, 0, 218104928, 4
    .long 1, 32, 32, 8192, 6144, 6400, 8388608, 2621440, 32768, 8, 48332800, 131072, 0, 0, 218105696, 4
    .long 1, 24, 24, 8192, 6144, 6400, 8388608, 3145728, 32768, 8, 33652736, 131072, 0, 0, 218105952, 4
    .long 1, 24, 24, 8192, 6144, 6400, 8388608, 3670016, 32768, 8, 35749888, 131072, 0, 0, 218106208, 4
    .long 1, 80, 80, 2048, 5505024, 5505280, 7340032, 56446976, 114688, 7, 180879360, 32768, 218103920, 7, 218106432, 1
    .long 0, 0, 0, 0, 0, 0, 0, 0, 0, 0, 0, 0, 0, 0, 0, 0
    .long 0, 0, 0, 0, 0, 0, 0, 0, 0, 0, 0, 0, 0, 0, 0, 0
    .long 0, 0, 0, 0, 0, 0, 0, 0, 0, 0, 0, 0, 0, 0, 0, 0
    .long 6, 24, 24, 8192, 1280, 263424, 8388608, 0, 32768, 4, 20992000, 131072, 0, 0, 218104336, 1
    .long 4, 24, 24, 8192, 1280, 263424, 8388608, 262144, 32768, 4, 22040576, 131072, 0, 0, 218104464, 1
    .long 1, 24, 24, 8192, 512, 768, 8388608, 1048576, 32768, 8, 25174016, 131072, 0, 0, 218104832, 4
    .long 1, 32, 32, 8192, 512, 768, 8388608, 2621440, 32768, 8, 48242688, 131072, 0, 0, 218105600, 4
    .long 1, 24, 24, 8192, 512, 768, 8388608, 3145728, 32768, 8, 33562624, 131072, 0, 0, 218105856, 4
    .long 1, 24, 24, 8192, 512, 768, 8388608, 3670016, 32768, 8, 35659776, 131072, 0, 0, 218106112, 4
    .long 1, 80, 80, 2048, 512, 768, 7340032, 56360960, 114688, 7, 168304640, 32768, 218103872, 7, 218106432, 1
    .long 0, 0, 0, 0, 0, 0, 0, 0, 0, 0, 0, 0, 0, 0, 0, 0
    .long 0, 0, 0, 0, 0, 0, 0, 0, 0, 0, 0, 0, 0, 0, 0, 0
    .long 0, 0, 0, 0, 0, 0, 0, 0, 0, 0, 0, 0, 0, 0, 0, 0
    .long 6, 24, 24, 8192, 3328, 265472, 8388608, 0, 32768, 4, 21024768, 131072, 0, 0, 218104368, 1
    .long 4, 24, 24, 8192, 3328, 265472, 8388608, 262144, 32768, 4, 22073344, 131072, 0, 0, 218104496, 1
    .long 1, 24, 24, 8192, 2560, 2816, 8388608, 1048576, 32768, 8, 25206784, 131072, 0, 0, 218104864, 4
    .long 1, 32, 32, 8192, 2560, 2816, 8388608, 2621440, 32768, 8, 48275456, 131072, 0, 0, 218105632, 4
    .long 1, 24, 24, 8192, 2560, 2816, 8388608, 3145728, 32768, 8, 33595392, 131072, 0, 0, 218105888, 4
    .long 1, 24, 24, 8192, 2560, 2816, 8388608, 3670016, 32768, 8, 35692544, 131072, 0, 0, 218106144, 4
    .long 1, 80, 80, 2048, 1835520, 1835776, 7340032, 56389632, 114688, 7, 172498944, 32768, 218103888, 7, 218106432, 1
    .long 0, 0, 0, 0, 0, 0, 0, 0, 0, 0, 0, 0, 0, 0, 0, 0
    .long 0, 0, 0, 0, 0, 0, 0, 0, 0, 0, 0, 0, 0, 0, 0, 0
    .long 0, 0, 0, 0, 0, 0, 0, 0, 0, 0, 0, 0, 0, 0, 0, 0
    .long 6, 24, 24, 8192, 5376, 267520, 8388608, 0, 32768, 4, 21057536, 131072, 0, 0, 218104400, 1
    .long 4, 24, 24, 8192, 5376, 267520, 8388608, 262144, 32768, 4, 22106112, 131072, 0, 0, 218104528, 1
    .long 1, 24, 24, 8192, 4608, 4864, 8388608, 1048576, 32768, 8, 25239552, 131072, 0, 0, 218104896, 4
    .long 1, 32, 32, 8192, 4608, 4864, 8388608, 2621440, 32768, 8, 48308224, 131072, 0, 0, 218105664, 4
    .long 1, 24, 24, 8192, 4608, 4864, 8388608, 3145728, 32768, 8, 33628160, 131072, 0, 0, 218105920, 4
    .long 1, 24, 24, 8192, 4608, 4864, 8388608, 3670016, 32768, 8, 35725312, 131072, 0, 0, 218106176, 4
    .long 1, 80, 80, 2048, 3670528, 3670784, 7340032, 56418304, 114688, 7, 176693248, 32768, 218103904, 7, 218106432, 1
    .long 0, 0, 0, 0, 0, 0, 0, 0, 0, 0, 0, 0, 0, 0, 0, 0
    .long 0, 0, 0, 0, 0, 0, 0, 0, 0, 0, 0, 0, 0, 0, 0, 0
    .long 0, 0, 0, 0, 0, 0, 0, 0, 0, 0, 0, 0, 0, 0, 0, 0
    .long 6, 24, 24, 8192, 7424, 269568, 8388608, 0, 32768, 4, 21090304, 131072, 0, 0, 218104432, 1
    .long 4, 24, 24, 8192, 7424, 269568, 8388608, 262144, 32768, 4, 22138880, 131072, 0, 0, 218104560, 1
    .long 1, 24, 24, 8192, 6656, 6912, 8388608, 1048576, 32768, 8, 25272320, 131072, 0, 0, 218104928, 4
    .long 1, 32, 32, 8192, 6656, 6912, 8388608, 2621440, 32768, 8, 48340992, 131072, 0, 0, 218105696, 4
    .long 1, 24, 24, 8192, 6656, 6912, 8388608, 3145728, 32768, 8, 33660928, 131072, 0, 0, 218105952, 4
    .long 1, 24, 24, 8192, 6656, 6912, 8388608, 3670016, 32768, 8, 35758080, 131072, 0, 0, 218106208, 4
    .long 1, 80, 80, 2048, 5505536, 5505792, 7340032, 56446976, 114688, 7, 180887552, 32768, 218103920, 7, 218106432, 1
    .long 0, 0, 0, 0, 0, 0, 0, 0, 0, 0, 0, 0, 0, 0, 0, 0
    .long 0, 0, 0, 0, 0, 0, 0, 0, 0, 0, 0, 0, 0, 0, 0, 0
    .long 0, 0, 0, 0, 0, 0, 0, 0, 0, 0, 0, 0, 0, 0, 0, 0
    .long 6, 24, 24, 8192, 1536, 263680, 8388608, 0, 32768, 4, 20996096, 131072, 0, 0, 218104336, 1
    .long 4, 24, 24, 8192, 1536, 263680, 8388608, 262144, 32768, 4, 22044672, 131072, 0, 0, 218104464, 1
    .long 1, 24, 24, 8192, 1024, 1280, 8388608, 1048576, 32768, 8, 25182208, 131072, 0, 0, 218104848, 4
    .long 1, 32, 32, 8192, 1024, 1280, 8388608, 2621440, 32768, 8, 48250880, 131072, 0, 0, 218105616, 4
    .long 1, 24, 24, 8192, 1024, 1280, 8388608, 3145728, 32768, 8, 33570816, 131072, 0, 0, 218105872, 4
    .long 1, 24, 24, 8192, 1024, 1280, 8388608, 3670016, 32768, 8, 35667968, 131072, 0, 0, 218106128, 4
    .long 1, 80, 80, 2048, 1024, 1280, 7340032, 56360960, 114688, 7, 168312832, 32768, 218103872, 7, 218106432, 1
    .long 0, 0, 0, 0, 0, 0, 0, 0, 0, 0, 0, 0, 0, 0, 0, 0
    .long 0, 0, 0, 0, 0, 0, 0, 0, 0, 0, 0, 0, 0, 0, 0, 0
    .long 0, 0, 0, 0, 0, 0, 0, 0, 0, 0, 0, 0, 0, 0, 0, 0
    .long 6, 24, 24, 8192, 3584, 265728, 8388608, 0, 32768, 4, 21028864, 131072, 0, 0, 218104368, 1
    .long 4, 24, 24, 8192, 3584, 265728, 8388608, 262144, 32768, 4, 22077440, 131072, 0, 0, 218104496, 1
    .long 1, 24, 24, 8192, 3072, 3328, 8388608, 1048576, 32768, 8, 25214976, 131072, 0, 0, 218104880, 4
    .long 1, 32, 32, 8192, 3072, 3328, 8388608, 2621440, 32768, 8, 48283648, 131072, 0, 0, 218105648, 4
    .long 1, 24, 24, 8192, 3072, 3328, 8388608, 3145728, 32768, 8, 33603584, 131072, 0, 0, 218105904, 4
    .long 1, 24, 24, 8192, 3072, 3328, 8388608, 3670016, 32768, 8, 35700736, 131072, 0, 0, 218106160, 4
    .long 1, 80, 80, 2048, 1836032, 1836288, 7340032, 56389632, 114688, 7, 172507136, 32768, 218103888, 7, 218106432, 1
    .long 0, 0, 0, 0, 0, 0, 0, 0, 0, 0, 0, 0, 0, 0, 0, 0
    .long 0, 0, 0, 0, 0, 0, 0, 0, 0, 0, 0, 0, 0, 0, 0, 0
    .long 0, 0, 0, 0, 0, 0, 0, 0, 0, 0, 0, 0, 0, 0, 0, 0
    .long 6, 24, 24, 8192, 5632, 267776, 8388608, 0, 32768, 4, 21061632, 131072, 0, 0, 218104400, 1
    .long 4, 24, 24, 8192, 5632, 267776, 8388608, 262144, 32768, 4, 22110208, 131072, 0, 0, 218104528, 1
    .long 1, 24, 24, 8192, 5120, 5376, 8388608, 1048576, 32768, 8, 25247744, 131072, 0, 0, 218104912, 4
    .long 1, 32, 32, 8192, 5120, 5376, 8388608, 2621440, 32768, 8, 48316416, 131072, 0, 0, 218105680, 4
    .long 1, 24, 24, 8192, 5120, 5376, 8388608, 3145728, 32768, 8, 33636352, 131072, 0, 0, 218105936, 4
    .long 1, 24, 24, 8192, 5120, 5376, 8388608, 3670016, 32768, 8, 35733504, 131072, 0, 0, 218106192, 4
    .long 1, 80, 80, 2048, 3671040, 3671296, 7340032, 56418304, 114688, 7, 176701440, 32768, 218103904, 7, 218106432, 1
    .long 0, 0, 0, 0, 0, 0, 0, 0, 0, 0, 0, 0, 0, 0, 0, 0
    .long 0, 0, 0, 0, 0, 0, 0, 0, 0, 0, 0, 0, 0, 0, 0, 0
    .long 0, 0, 0, 0, 0, 0, 0, 0, 0, 0, 0, 0, 0, 0, 0, 0
    .long 6, 24, 24, 8192, 7680, 269824, 8388608, 0, 32768, 4, 21094400, 131072, 0, 0, 218104432, 1
    .long 4, 24, 24, 8192, 7680, 269824, 8388608, 262144, 32768, 4, 22142976, 131072, 0, 0, 218104560, 1
    .long 1, 24, 24, 8192, 7168, 7424, 8388608, 1048576, 32768, 8, 25280512, 131072, 0, 0, 218104944, 4
    .long 1, 32, 32, 8192, 7168, 7424, 8388608, 2621440, 32768, 8, 48349184, 131072, 0, 0, 218105712, 4
    .long 1, 24, 24, 8192, 7168, 7424, 8388608, 3145728, 32768, 8, 33669120, 131072, 0, 0, 218105968, 4
    .long 1, 24, 24, 8192, 7168, 7424, 8388608, 3670016, 32768, 8, 35766272, 131072, 0, 0, 218106224, 4
    .long 1, 80, 80, 2048, 5506048, 5506304, 7340032, 56446976, 114688, 7, 180895744, 32768, 218103920, 7, 218106432, 1
    .long 0, 0, 0, 0, 0, 0, 0, 0, 0, 0, 0, 0, 0, 0, 0, 0
    .long 0, 0, 0, 0, 0, 0, 0, 0, 0, 0, 0, 0, 0, 0, 0, 0
    .long 0, 0, 0, 0, 0, 0, 0, 0, 0, 0, 0, 0, 0, 0, 0, 0
    .long 6, 24, 24, 8192, 1792, 263936, 8388608, 0, 32768, 4, 21000192, 131072, 0, 0, 218104336, 1
    .long 4, 24, 24, 8192, 1792, 263936, 8388608, 262144, 32768, 4, 22048768, 131072, 0, 0, 218104464, 1
    .long 1, 24, 24, 8192, 1536, 1792, 8388608, 1048576, 32768, 8, 25190400, 131072, 0, 0, 218104848, 4
    .long 1, 32, 32, 8192, 1536, 1792, 8388608, 2621440, 32768, 8, 48259072, 131072, 0, 0, 218105616, 4
    .long 1, 24, 24, 8192, 1536, 1792, 8388608, 3145728, 32768, 8, 33579008, 131072, 0, 0, 218105872, 4
    .long 1, 24, 24, 8192, 1536, 1792, 8388608, 3670016, 32768, 8, 35676160, 131072, 0, 0, 218106128, 4
    .long 1, 80, 80, 2048, 1536, 1792, 7340032, 56360960, 114688, 7, 168321024, 32768, 218103872, 7, 218106432, 1
    .long 0, 0, 0, 0, 0, 0, 0, 0, 0, 0, 0, 0, 0, 0, 0, 0
    .long 0, 0, 0, 0, 0, 0, 0, 0, 0, 0, 0, 0, 0, 0, 0, 0
    .long 0, 0, 0, 0, 0, 0, 0, 0, 0, 0, 0, 0, 0, 0, 0, 0
    .long 6, 24, 24, 8192, 3840, 265984, 8388608, 0, 32768, 4, 21032960, 131072, 0, 0, 218104368, 1
    .long 4, 24, 24, 8192, 3840, 265984, 8388608, 262144, 32768, 4, 22081536, 131072, 0, 0, 218104496, 1
    .long 1, 24, 24, 8192, 3584, 3840, 8388608, 1048576, 32768, 8, 25223168, 131072, 0, 0, 218104880, 4
    .long 1, 32, 32, 8192, 3584, 3840, 8388608, 2621440, 32768, 8, 48291840, 131072, 0, 0, 218105648, 4
    .long 1, 24, 24, 8192, 3584, 3840, 8388608, 3145728, 32768, 8, 33611776, 131072, 0, 0, 218105904, 4
    .long 1, 24, 24, 8192, 3584, 3840, 8388608, 3670016, 32768, 8, 35708928, 131072, 0, 0, 218106160, 4
    .long 1, 80, 80, 2048, 1836544, 1836800, 7340032, 56389632, 114688, 7, 172515328, 32768, 218103888, 7, 218106432, 1
    .long 0, 0, 0, 0, 0, 0, 0, 0, 0, 0, 0, 0, 0, 0, 0, 0
    .long 0, 0, 0, 0, 0, 0, 0, 0, 0, 0, 0, 0, 0, 0, 0, 0
    .long 0, 0, 0, 0, 0, 0, 0, 0, 0, 0, 0, 0, 0, 0, 0, 0
    .long 6, 24, 24, 8192, 5888, 268032, 8388608, 0, 32768, 4, 21065728, 131072, 0, 0, 218104400, 1
    .long 4, 24, 24, 8192, 5888, 268032, 8388608, 262144, 32768, 4, 22114304, 131072, 0, 0, 218104528, 1
    .long 1, 24, 24, 8192, 5632, 5888, 8388608, 1048576, 32768, 8, 25255936, 131072, 0, 0, 218104912, 4
    .long 1, 32, 32, 8192, 5632, 5888, 8388608, 2621440, 32768, 8, 48324608, 131072, 0, 0, 218105680, 4
    .long 1, 24, 24, 8192, 5632, 5888, 8388608, 3145728, 32768, 8, 33644544, 131072, 0, 0, 218105936, 4
    .long 1, 24, 24, 8192, 5632, 5888, 8388608, 3670016, 32768, 8, 35741696, 131072, 0, 0, 218106192, 4
    .long 1, 80, 80, 2048, 3671552, 3671808, 7340032, 56418304, 114688, 7, 176709632, 32768, 218103904, 7, 218106432, 1
    .long 0, 0, 0, 0, 0, 0, 0, 0, 0, 0, 0, 0, 0, 0, 0, 0
    .long 0, 0, 0, 0, 0, 0, 0, 0, 0, 0, 0, 0, 0, 0, 0, 0
    .long 0, 0, 0, 0, 0, 0, 0, 0, 0, 0, 0, 0, 0, 0, 0, 0
    .long 6, 24, 24, 8192, 7936, 270080, 8388608, 0, 32768, 4, 21098496, 131072, 0, 0, 218104432, 1
    .long 4, 24, 24, 8192, 7936, 270080, 8388608, 262144, 32768, 4, 22147072, 131072, 0, 0, 218104560, 1
    .long 1, 24, 24, 8192, 7680, 7936, 8388608, 1048576, 32768, 8, 25288704, 131072, 0, 0, 218104944, 4
    .long 1, 32, 32, 8192, 7680, 7936, 8388608, 2621440, 32768, 8, 48357376, 131072, 0, 0, 218105712, 4
    .long 1, 24, 24, 8192, 7680, 7936, 8388608, 3145728, 32768, 8, 33677312, 131072, 0, 0, 218105968, 4
    .long 1, 24, 24, 8192, 7680, 7936, 8388608, 3670016, 32768, 8, 35774464, 131072, 0, 0, 218106224, 4
    .long 1, 80, 80, 2048, 5506560, 5506816, 7340032, 56446976, 114688, 7, 180903936, 32768, 218103920, 7, 218106432, 1
    .long 0, 0, 0, 0, 0, 0, 0, 0, 0, 0, 0, 0, 0, 0, 0, 0
    .long 0, 0, 0, 0, 0, 0, 0, 0, 0, 0, 0, 0, 0, 0, 0, 0
    .long 0, 0, 0, 0, 0, 0, 0, 0, 0, 0, 0, 0, 0, 0, 0, 0
    .long 6, 32, 32, 8192, 0, 262144, 8388608, 0, 32768, 4, 37748736, 131072, 0, 0, 218104320, 1
    .long 4, 32, 32, 8192, 0, 262144, 8388608, 262144, 32768, 4, 38797312, 131072, 0, 0, 218104448, 1
    .long 4, 16, 16, 8192, 1792, 263936, 8388608, 786432, 32768, 4, 7368704, 131072, 0, 0, 218104592, 1
    .long 1, 32, 32, 8192, 1024, 1280, 8388608, 1572864, 32768, 8, 44056576, 131072, 0, 0, 218105104, 4
    .long 1, 16, 16, 8192, 1024, 1280, 8388608, 2621440, 32768, 8, 14696448, 131072, 0, 0, 218105616, 4
    .long 2, 64, 72, 7168, 4096, 4096, 7340032, 1048576, 32768, 8, 58261504, 114688, 0, 0, 218103968, 1
    .long 2, 64, 72, 7168, 3072, 3072, 7340032, 2621440, 32768, 8, 63750144, 114688, 0, 0, 218104144, 1
    .long 1, 80, 80, 2048, 1024, 1280, 7340032, 60030976, 114688, 7, 169361408, 32768, 218104000, 7, 218106560, 1
    .long 0, 0, 0, 0, 0, 0, 0, 0, 0, 0, 0, 0, 0, 0, 0, 0
    .long 0, 0, 0, 0, 0, 0, 0, 0, 0, 0, 0, 0, 0, 0, 0, 0
    .long 6, 32, 32, 8192, 2048, 264192, 8388608, 0, 32768, 4, 37781504, 131072, 0, 0, 218104352, 1
    .long 4, 32, 32, 8192, 2048, 264192, 8388608, 262144, 32768, 4, 38830080, 131072, 0, 0, 218104480, 1
    .long 4, 16, 16, 8192, 3840, 265984, 8388608, 786432, 32768, 4, 7401472, 131072, 0, 0, 218104624, 1
    .long 1, 32, 32, 8192, 3072, 3328, 8388608, 1572864, 32768, 8, 44089344, 131072, 0, 0, 218105136, 4
    .long 1, 16, 16, 8192, 3072, 3328, 8388608, 2621440, 32768, 8, 14729216, 131072, 0, 0, 218105648, 4
    .long 2, 64, 72, 7168, 4352, 4352, 7340032, 1048576, 32768, 8, 58265600, 114688, 0, 0, 218103968, 1
    .long 2, 64, 72, 7168, 3328, 3328, 7340032, 2621440, 32768, 8, 63754240, 114688, 0, 0, 218104144, 1
    .long 1, 80, 80, 2048, 1836032, 1836288, 7340032, 60059648, 114688, 7, 173555712, 32768, 218104016, 7, 218106560, 1
    .long 0, 0, 0, 0, 0, 0, 0, 0, 0, 0, 0, 0, 0, 0, 0, 0
    .long 0, 0, 0, 0, 0, 0, 0, 0, 0, 0, 0, 0, 0, 0, 0, 0
    .long 6, 32, 32, 8192, 4096, 266240, 8388608, 0, 32768, 4, 37814272, 131072, 0, 0, 218104384, 1
    .long 4, 32, 32, 8192, 4096, 266240, 8388608, 262144, 32768, 4, 38862848, 131072, 0, 0, 218104512, 1
    .long 4, 16, 16, 8192, 5888, 268032, 8388608, 786432, 32768, 4, 7434240, 131072, 0, 0, 218104656, 1
    .long 1, 32, 32, 8192, 5120, 5376, 8388608, 1572864, 32768, 8, 44122112, 131072, 0, 0, 218105168, 4
    .long 1, 16, 16, 8192, 5120, 5376, 8388608, 2621440, 32768, 8, 14761984, 131072, 0, 0, 218105680, 4
    .long 2, 64, 72, 7168, 4608, 4608, 7340032, 1048576, 32768, 8, 58269696, 114688, 0, 0, 218103968, 1
    .long 2, 64, 72, 7168, 3584, 3584, 7340032, 2621440, 32768, 8, 63758336, 114688, 0, 0, 218104160, 1
    .long 1, 80, 80, 2048, 3671040, 3671296, 7340032, 60088320, 114688, 7, 177750016, 32768, 218104032, 7, 218106560, 1
    .long 0, 0, 0, 0, 0, 0, 0, 0, 0, 0, 0, 0, 0, 0, 0, 0
    .long 0, 0, 0, 0, 0, 0, 0, 0, 0, 0, 0, 0, 0, 0, 0, 0
    .long 6, 32, 32, 8192, 6144, 268288, 8388608, 0, 32768, 4, 37847040, 131072, 0, 0, 218104416, 1
    .long 4, 32, 32, 8192, 6144, 268288, 8388608, 262144, 32768, 4, 38895616, 131072, 0, 0, 218104544, 1
    .long 4, 16, 16, 8192, 7936, 270080, 8388608, 786432, 32768, 4, 7467008, 131072, 0, 0, 218104688, 1
    .long 1, 32, 32, 8192, 7168, 7424, 8388608, 1572864, 32768, 8, 44154880, 131072, 0, 0, 218105200, 4
    .long 1, 16, 16, 8192, 7168, 7424, 8388608, 2621440, 32768, 8, 14794752, 131072, 0, 0, 218105712, 4
    .long 2, 64, 72, 7168, 4864, 4864, 7340032, 1048576, 32768, 8, 58273792, 114688, 0, 0, 218103968, 1
    .long 2, 64, 72, 7168, 3840, 3840, 7340032, 2621440, 32768, 8, 63762432, 114688, 0, 0, 218104160, 1
    .long 1, 80, 80, 2048, 5506048, 5506304, 7340032, 60116992, 114688, 7, 181944320, 32768, 218104048, 7, 218106560, 1
    .long 0, 0, 0, 0, 0, 0, 0, 0, 0, 0, 0, 0, 0, 0, 0, 0
    .long 0, 0, 0, 0, 0, 0, 0, 0, 0, 0, 0, 0, 0, 0, 0, 0
    .long 6, 32, 32, 8192, 256, 262400, 8388608, 0, 32768, 4, 37752832, 131072, 0, 0, 218104320, 1
    .long 4, 32, 32, 8192, 256, 262400, 8388608, 262144, 32768, 4, 38801408, 131072, 0, 0, 218104448, 1
    .long 4, 16, 16, 8192, 1792, 263936, 8388608, 524288, 32768, 4, 6320128, 131072, 0, 0, 218104592, 1
    .long 1, 32, 32, 8192, 1536, 1792, 8388608, 1572864, 32768, 8, 44064768, 131072, 0, 0, 218105104, 4
    .long 1, 16, 16, 8192, 1536, 1792, 8388608, 2621440, 32768, 8, 14704640, 131072, 0, 0, 218105616, 4
    .long 2, 64, 72, 7168, 5120, 5120, 7340032, 1048576, 32768, 8, 58277888, 114688, 0, 0, 218103968, 1
    .long 2, 64, 72, 7168, 4096, 4096, 7340032, 2621440, 32768, 8, 63766528, 114688, 0, 0, 218104160, 1
    .long 1, 80, 80, 2048, 1536, 1792, 7340032, 60030976, 114688, 7, 169369600, 32768, 218104000, 7, 218106560, 1
    .long 0, 0, 0, 0, 0, 0, 0, 0, 0, 0, 0, 0, 0, 0, 0, 0
    .long 0, 0, 0, 0, 0, 0, 0, 0, 0, 0, 0, 0, 0, 0, 0, 0
    .long 6, 32, 32, 8192, 2304, 264448, 8388608, 0, 32768, 4, 37785600, 131072, 0, 0, 218104352, 1
    .long 4, 32, 32, 8192, 2304, 264448, 8388608, 262144, 32768, 4, 38834176, 131072, 0, 0, 218104480, 1
    .long 4, 16, 16, 8192, 3840, 265984, 8388608, 524288, 32768, 4, 6352896, 131072, 0, 0, 218104624, 1
    .long 1, 32, 32, 8192, 3584, 3840, 8388608, 1572864, 32768, 8, 44097536, 131072, 0, 0, 218105136, 4
    .long 1, 16, 16, 8192, 3584, 3840, 8388608, 2621440, 32768, 8, 14737408, 131072, 0, 0, 218105648, 4
    .long 2, 64, 72, 7168, 5376, 5376, 7340032, 1048576, 32768, 8, 58281984, 114688, 0, 0, 218103984, 1
    .long 2, 64, 72, 7168, 4352, 4352, 7340032, 2621440, 32768, 8, 63770624, 114688, 0, 0, 218104160, 1
    .long 1, 80, 80, 2048, 1836544, 1836800, 7340032, 60059648, 114688, 7, 173563904, 32768, 218104016, 7, 218106560, 1
    .long 0, 0, 0, 0, 0, 0, 0, 0, 0, 0, 0, 0, 0, 0, 0, 0
    .long 0, 0, 0, 0, 0, 0, 0, 0, 0, 0, 0, 0, 0, 0, 0, 0
    .long 6, 32, 32, 8192, 4352, 266496, 8388608, 0, 32768, 4, 37818368, 131072, 0, 0, 218104384, 1
    .long 4, 32, 32, 8192, 4352, 266496, 8388608, 262144, 32768, 4, 38866944, 131072, 0, 0, 218104512, 1
    .long 4, 16, 16, 8192, 5888, 268032, 8388608, 524288, 32768, 4, 6385664, 131072, 0, 0, 218104656, 1
    .long 1, 32, 32, 8192, 5632, 5888, 8388608, 1572864, 32768, 8, 44130304, 131072, 0, 0, 218105168, 4
    .long 1, 16, 16, 8192, 5632, 5888, 8388608, 2621440, 32768, 8, 14770176, 131072, 0, 0, 218105680, 4
    .long 2, 64, 72, 7168, 5632, 5632, 7340032, 1048576, 32768, 8, 58286080, 114688, 0, 0, 218103984, 1
    .long 2, 64, 72, 7168, 4608, 4608, 7340032, 2621440, 32768, 8, 63774720, 114688, 0, 0, 218104160, 1
    .long 1, 80, 80, 2048, 3671552, 3671808, 7340032, 60088320, 114688, 7, 177758208, 32768, 218104032, 7, 218106560, 1
    .long 0, 0, 0, 0, 0, 0, 0, 0, 0, 0, 0, 0, 0, 0, 0, 0
    .long 0, 0, 0, 0, 0, 0, 0, 0, 0, 0, 0, 0, 0, 0, 0, 0
    .long 6, 32, 32, 8192, 6400, 268544, 8388608, 0, 32768, 4, 37851136, 131072, 0, 0, 218104416, 1
    .long 4, 32, 32, 8192, 6400, 268544, 8388608, 262144, 32768, 4, 38899712, 131072, 0, 0, 218104544, 1
    .long 4, 16, 16, 8192, 7936, 270080, 8388608, 524288, 32768, 4, 6418432, 131072, 0, 0, 218104688, 1
    .long 1, 32, 32, 8192, 7680, 7936, 8388608, 1572864, 32768, 8, 44163072, 131072, 0, 0, 218105200, 4
    .long 1, 16, 16, 8192, 7680, 7936, 8388608, 2621440, 32768, 8, 14802944, 131072, 0, 0, 218105712, 4
    .long 2, 64, 72, 7168, 5888, 5888, 7340032, 1048576, 32768, 8, 58290176, 114688, 0, 0, 218103984, 1
    .long 2, 64, 72, 7168, 4864, 4864, 7340032, 2621440, 32768, 8, 63778816, 114688, 0, 0, 218104160, 1
    .long 1, 80, 80, 2048, 5506560, 5506816, 7340032, 60116992, 114688, 7, 181952512, 32768, 218104048, 7, 218106560, 1
    .long 0, 0, 0, 0, 0, 0, 0, 0, 0, 0, 0, 0, 0, 0, 0, 0
    .long 0, 0, 0, 0, 0, 0, 0, 0, 0, 0, 0, 0, 0, 0, 0, 0
    .long 6, 32, 32, 8192, 512, 262656, 8388608, 0, 32768, 4, 37756928, 131072, 0, 0, 218104320, 1
    .long 4, 32, 32, 8192, 512, 262656, 8388608, 262144, 32768, 4, 38805504, 131072, 0, 0, 218104448, 1
    .long 4, 16, 16, 8192, 1536, 263680, 8388608, 786432, 32768, 4, 7364608, 131072, 0, 0, 218104592, 1
    .long 1, 24, 24, 8192, 0, 256, 8388608, 1572864, 32768, 8, 27262976, 131072, 0, 0, 218105088, 4
    .long 2, 64, 72, 7168, 0, 0, 7340032, 0, 32768, 8, 54525952, 114688, 0, 0, 218103808, 1
    .long 2, 64, 72, 7168, 6144, 6144, 7340032, 1048576, 32768, 8, 58294272, 114688, 0, 0, 218103984, 1
    .long 2, 64, 72, 7168, 5120, 5120, 7340032, 2621440, 32768, 8, 63782912, 114688, 0, 0, 218104160, 1
    .long 1, 80, 80, 2048, 0, 256, 7340032, 61865984, 114688, 7, 169869312, 32768, 218104064, 7, 218106624, 1
    .long 0, 0, 0, 0, 0, 0, 0, 0, 0, 0, 0, 0, 0, 0, 0, 0
    .long 0, 0, 0, 0, 0, 0, 0, 0, 0, 0, 0, 0, 0, 0, 0, 0
    .long 6, 32, 32, 8192, 2560, 264704, 8388608, 0, 32768, 4, 37789696, 131072, 0, 0, 218104352, 1
    .long 4, 32, 32, 8192, 2560, 264704, 8388608, 262144, 32768, 4, 38838272, 131072, 0, 0, 218104480, 1
    .long 4, 16, 16, 8192, 3584, 265728, 8388608, 786432, 32768, 4, 7397376, 131072, 0, 0, 218104624, 1
    .long 1, 24, 24, 8192, 2048, 2304, 8388608, 1572864, 32768, 8, 27295744, 131072, 0, 0, 218105120, 4
    .long 2, 64, 72, 7168, 256, 256, 7340032, 0, 32768, 8, 54530048, 114688, 0, 0, 218103808, 1
    .long 2, 64, 72, 7168, 6400, 6400, 7340032, 1048576, 32768, 8, 58298368, 114688, 0, 0, 218103984, 1
    .long 2, 64, 72, 7168, 5376, 5376, 7340032, 2621440, 32768, 8, 63787008, 114688, 0, 0, 218104176, 1
    .long 1, 80, 80, 2048, 1835008, 1835264, 7340032, 61894656, 114688, 7, 174063616, 32768, 218104080, 7, 218106624, 1
    .long 0, 0, 0, 0, 0, 0, 0, 0, 0, 0, 0, 0, 0, 0, 0, 0
    .long 0, 0, 0, 0, 0, 0, 0, 0, 0, 0, 0, 0, 0, 0, 0, 0
    .long 6, 32, 32, 8192, 4608, 266752, 8388608, 0, 32768, 4, 37822464, 131072, 0, 0, 218104384, 1
    .long 4, 32, 32, 8192, 4608, 266752, 8388608, 262144, 32768, 4, 38871040, 131072, 0, 0, 218104512, 1
    .long 4, 16, 16, 8192, 5632, 267776, 8388608, 786432, 32768, 4, 7430144, 131072, 0, 0, 218104656, 1
    .long 1, 24, 24, 8192, 4096, 4352, 8388608, 1572864, 32768, 8, 27328512, 131072, 0, 0, 218105152, 4
    .long 2, 64, 72, 7168, 512, 512, 7340032, 0, 32768, 8, 54534144, 114688, 0, 0, 218103808, 1
    .long 2, 64, 72, 7168, 6656, 6656, 7340032, 1048576, 32768, 8, 58302464, 114688, 0, 0, 218103984, 1
    .long 2, 64, 72, 7168, 5632, 5632, 7340032, 2621440, 32768, 8, 63791104, 114688, 0, 0, 218104176, 1
    .long 1, 80, 80, 2048, 3670016, 3670272, 7340032, 61923328, 114688, 7, 178257920, 32768, 218104096, 7, 218106624, 1
    .long 0, 0, 0, 0, 0, 0, 0, 0, 0, 0, 0, 0, 0, 0, 0, 0
    .long 0, 0, 0, 0, 0, 0, 0, 0, 0, 0, 0, 0, 0, 0, 0, 0
    .long 6, 32, 32, 8192, 6656, 268800, 8388608, 0, 32768, 4, 37855232, 131072, 0, 0, 218104416, 1
    .long 4, 32, 32, 8192, 6656, 268800, 8388608, 262144, 32768, 4, 38903808, 131072, 0, 0, 218104544, 1
    .long 4, 16, 16, 8192, 7680, 269824, 8388608, 786432, 32768, 4, 7462912, 131072, 0, 0, 218104688, 1
    .long 1, 24, 24, 8192, 6144, 6400, 8388608, 1572864, 32768, 8, 27361280, 131072, 0, 0, 218105184, 4
    .long 2, 64, 72, 7168, 768, 768, 7340032, 0, 32768, 8, 54538240, 114688, 0, 0, 218103808, 1
    .long 2, 64, 72, 7168, 6912, 6912, 7340032, 1048576, 32768, 8, 58306560, 114688, 0, 0, 218103984, 1
    .long 2, 64, 72, 7168, 5888, 5888, 7340032, 2621440, 32768, 8, 63795200, 114688, 0, 0, 218104176, 1
    .long 1, 80, 80, 2048, 5505024, 5505280, 7340032, 61952000, 114688, 7, 182452224, 32768, 218104112, 7, 218106624, 1
    .long 0, 0, 0, 0, 0, 0, 0, 0, 0, 0, 0, 0, 0, 0, 0, 0
    .long 0, 0, 0, 0, 0, 0, 0, 0, 0, 0, 0, 0, 0, 0, 0, 0
    .long 6, 32, 32, 8192, 768, 262912, 8388608, 0, 32768, 4, 37761024, 131072, 0, 0, 218104320, 1
    .long 4, 32, 32, 8192, 768, 262912, 8388608, 262144, 32768, 4, 38809600, 131072, 0, 0, 218104448, 1
    .long 4, 16, 16, 8192, 1536, 263680, 8388608, 524288, 32768, 4, 6316032, 131072, 0, 0, 218104592, 1
    .long 1, 24, 24, 8192, 512, 768, 8388608, 1572864, 32768, 8, 27271168, 131072, 0, 0, 218105088, 4
    .long 2, 64, 72, 7168, 1024, 1024, 7340032, 0, 32768, 8, 54542336, 114688, 0, 0, 218103808, 1
    .long 2, 64, 72, 7168, 0, 0, 7340032, 1572864, 32768, 8, 60030976, 114688, 0, 0, 218104000, 1
    .long 2, 64, 72, 7168, 6144, 6144, 7340032, 2621440, 32768, 8, 63799296, 114688, 0, 0, 218104176, 1
    .long 1, 80, 80, 2048, 512, 768, 7340032, 61865984, 114688, 7, 169877504, 32768, 218104064, 7, 218106624, 1
    .long 0, 0, 0, 0, 0, 0, 0, 0, 0, 0, 0, 0, 0, 0, 0, 0
    .long 0, 0, 0, 0, 0, 0, 0, 0, 0, 0, 0, 0, 0, 0, 0, 0
    .long 6, 32, 32, 8192, 2816, 264960, 8388608, 0, 32768, 4, 37793792, 131072, 0, 0, 218104352, 1
    .long 4, 32, 32, 8192, 2816, 264960, 8388608, 262144, 32768, 4, 38842368, 131072, 0, 0, 218104480, 1
    .long 4, 16, 16, 8192, 3584, 265728, 8388608, 524288, 32768, 4, 6348800, 131072, 0, 0, 218104624, 1
    .long 1, 24, 24, 8192, 2560, 2816, 8388608, 1572864, 32768, 8, 27303936, 131072, 0, 0, 218105120, 4
    .long 2, 64, 72, 7168, 1280, 1280, 7340032, 0, 32768, 8, 54546432, 114688, 0, 0, 218103808, 1
    .long 2, 64, 72, 7168, 256, 256, 7340032, 1572864, 32768, 8, 60035072, 114688, 0, 0, 218104000, 1
    .long 2, 64, 72, 7168, 6400, 6400, 7340032, 2621440, 32768, 8, 63803392, 114688, 0, 0, 218104176, 1
    .long 1, 80, 80, 2048, 1835520, 1835776, 7340032, 61894656, 114688, 7, 174071808, 32768, 218104080, 7, 218106624, 1
    .long 0, 0, 0, 0, 0, 0, 0, 0, 0, 0, 0, 0, 0, 0, 0, 0
    .long 0, 0, 0, 0, 0, 0, 0, 0, 0, 0, 0, 0, 0, 0, 0, 0
    .long 6, 32, 32, 8192, 4864, 267008, 8388608, 0, 32768, 4, 37826560, 131072, 0, 0, 218104384, 1
    .long 4, 32, 32, 8192, 4864, 267008, 8388608, 262144, 32768, 4, 38875136, 131072, 0, 0, 218104512, 1
    .long 4, 16, 16, 8192, 5632, 267776, 8388608, 524288, 32768, 4, 6381568, 131072, 0, 0, 218104656, 1
    .long 1, 24, 24, 8192, 4608, 4864, 8388608, 1572864, 32768, 8, 27336704, 131072, 0, 0, 218105152, 4
    .long 2, 64, 72, 7168, 1536, 1536, 7340032, 0, 32768, 8, 54550528, 114688, 0, 0, 218103808, 1
    .long 2, 64, 72, 7168, 512, 512, 7340032, 1572864, 32768, 8, 60039168, 114688, 0, 0, 218104000, 1
    .long 2, 64, 72, 7168, 6656, 6656, 7340032, 2621440, 32768, 8, 63807488, 114688, 0, 0, 218104176, 1
    .long 1, 80, 80, 2048, 3670528, 3670784, 7340032, 61923328, 114688, 7, 178266112, 32768, 218104096, 7, 218106624, 1
    .long 0, 0, 0, 0, 0, 0, 0, 0, 0, 0, 0, 0, 0, 0, 0, 0
    .long 0, 0, 0, 0, 0, 0, 0, 0, 0, 0, 0, 0, 0, 0, 0, 0
    .long 6, 32, 32, 8192, 6912, 269056, 8388608, 0, 32768, 4, 37859328, 131072, 0, 0, 218104416, 1
    .long 4, 32, 32, 8192, 6912, 269056, 8388608, 262144, 32768, 4, 38907904, 131072, 0, 0, 218104544, 1
    .long 4, 16, 16, 8192, 7680, 269824, 8388608, 524288, 32768, 4, 6414336, 131072, 0, 0, 218104688, 1
    .long 1, 24, 24, 8192, 6656, 6912, 8388608, 1572864, 32768, 8, 27369472, 131072, 0, 0, 218105184, 4
    .long 2, 64, 72, 7168, 1792, 1792, 7340032, 0, 32768, 8, 54554624, 114688, 0, 0, 218103824, 1
    .long 2, 64, 72, 7168, 768, 768, 7340032, 1572864, 32768, 8, 60043264, 114688, 0, 0, 218104000, 1
    .long 2, 64, 72, 7168, 6912, 6912, 7340032, 2621440, 32768, 8, 63811584, 114688, 0, 0, 218104176, 1
    .long 1, 80, 80, 2048, 5505536, 5505792, 7340032, 61952000, 114688, 7, 182460416, 32768, 218104112, 7, 218106624, 1
    .long 0, 0, 0, 0, 0, 0, 0, 0, 0, 0, 0, 0, 0, 0, 0, 0
    .long 0, 0, 0, 0, 0, 0, 0, 0, 0, 0, 0, 0, 0, 0, 0, 0
    .long 6, 32, 32, 8192, 1024, 263168, 8388608, 0, 32768, 4, 37765120, 131072, 0, 0, 218104336, 1
    .long 4, 32, 32, 8192, 1024, 263168, 8388608, 262144, 32768, 4, 38813696, 131072, 0, 0, 218104464, 1
    .long 4, 16, 16, 8192, 1280, 263424, 8388608, 786432, 32768, 4, 7360512, 131072, 0, 0, 218104592, 1
    .long 1, 24, 24, 8192, 1024, 1280, 8388608, 1572864, 32768, 8, 27279360, 131072, 0, 0, 218105104, 4
    .long 2, 64, 72, 7168, 2048, 2048, 7340032, 0, 32768, 8, 54558720, 114688, 0, 0, 218103824, 1
    .long 2, 64, 72, 7168, 1024, 1024, 7340032, 1572864, 32768, 8, 60047360, 114688, 0, 0, 218104000, 1
    .long 2, 64, 72, 7168, 0, 0, 7340032, 3145728, 32768, 8, 65536000, 114688, 0, 0, 218104192, 1
    .long 1, 80, 80, 2048, 1024, 1280, 7340032, 61865984, 114688, 7, 169885696, 32768, 218104064, 7, 218106624, 1
    .long 0, 0, 0, 0, 0, 0, 0, 0, 0, 0, 0, 0, 0, 0, 0, 0
    .long 0, 0, 0, 0, 0, 0, 0, 0, 0, 0, 0, 0, 0, 0, 0, 0
    .long 6, 32, 32, 8192, 3072, 265216, 8388608, 0, 32768, 4, 37797888, 131072, 0, 0, 218104368, 1
    .long 4, 32, 32, 8192, 3072, 265216, 8388608, 262144, 32768, 4, 38846464, 131072, 0, 0, 218104496, 1
    .long 4, 16, 16, 8192, 3328, 265472, 8388608, 786432, 32768, 4, 7393280, 131072, 0, 0, 218104624, 1
    .long 1, 24, 24, 8192, 3072, 3328, 8388608, 1572864, 32768, 8, 27312128, 131072, 0, 0, 218105136, 4
    .long 2, 64, 72, 7168, 2304, 2304, 7340032, 0, 32768, 8, 54562816, 114688, 0, 0, 218103824, 1
    .long 2, 64, 72, 7168, 1280, 1280, 7340032, 1572864, 32768, 8, 60051456, 114688, 0, 0, 218104000, 1
    .long 2, 64, 72, 7168, 256, 256, 7340032, 3145728, 32768, 8, 65540096, 114688, 0, 0, 218104192, 1
    .long 1, 80, 80, 2048, 1836032, 1836288, 7340032, 61894656, 114688, 7, 174080000, 32768, 218104080, 7, 218106624, 1
    .long 0, 0, 0, 0, 0, 0, 0, 0, 0, 0, 0, 0, 0, 0, 0, 0
    .long 0, 0, 0, 0, 0, 0, 0, 0, 0, 0, 0, 0, 0, 0, 0, 0
    .long 6, 32, 32, 8192, 5120, 267264, 8388608, 0, 32768, 4, 37830656, 131072, 0, 0, 218104400, 1
    .long 4, 32, 32, 8192, 5120, 267264, 8388608, 262144, 32768, 4, 38879232, 131072, 0, 0, 218104528, 1
    .long 4, 16, 16, 8192, 5376, 267520, 8388608, 786432, 32768, 4, 7426048, 131072, 0, 0, 218104656, 1
    .long 1, 24, 24, 8192, 5120, 5376, 8388608, 1572864, 32768, 8, 27344896, 131072, 0, 0, 218105168, 4
    .long 2, 64, 72, 7168, 2560, 2560, 7340032, 0, 32768, 8, 54566912, 114688, 0, 0, 218103824, 1
    .long 2, 64, 72, 7168, 1536, 1536, 7340032, 1572864, 32768, 8, 60055552, 114688, 0, 0, 218104000, 1
    .long 2, 64, 72, 7168, 512, 512, 7340032, 3145728, 32768, 8, 65544192, 114688, 0, 0, 218104192, 1
    .long 1, 80, 80, 2048, 3671040, 3671296, 7340032, 61923328, 114688, 7, 178274304, 32768, 218104096, 7, 218106624, 1
    .long 0, 0, 0, 0, 0, 0, 0, 0, 0, 0, 0, 0, 0, 0, 0, 0
    .long 0, 0, 0, 0, 0, 0, 0, 0, 0, 0, 0, 0, 0, 0, 0, 0
    .long 6, 32, 32, 8192, 7168, 269312, 8388608, 0, 32768, 4, 37863424, 131072, 0, 0, 218104432, 1
    .long 4, 32, 32, 8192, 7168, 269312, 8388608, 262144, 32768, 4, 38912000, 131072, 0, 0, 218104560, 1
    .long 4, 16, 16, 8192, 7424, 269568, 8388608, 786432, 32768, 4, 7458816, 131072, 0, 0, 218104688, 1
    .long 1, 24, 24, 8192, 7168, 7424, 8388608, 1572864, 32768, 8, 27377664, 131072, 0, 0, 218105200, 4
    .long 2, 64, 72, 7168, 2816, 2816, 7340032, 0, 32768, 8, 54571008, 114688, 0, 0, 218103824, 1
    .long 2, 64, 72, 7168, 1792, 1792, 7340032, 1572864, 32768, 8, 60059648, 114688, 0, 0, 218104016, 1
    .long 2, 64, 72, 7168, 768, 768, 7340032, 3145728, 32768, 8, 65548288, 114688, 0, 0, 218104192, 1
    .long 1, 80, 80, 2048, 5506048, 5506304, 7340032, 61952000, 114688, 7, 182468608, 32768, 218104112, 7, 218106624, 1
    .long 0, 0, 0, 0, 0, 0, 0, 0, 0, 0, 0, 0, 0, 0, 0, 0
    .long 0, 0, 0, 0, 0, 0, 0, 0, 0, 0, 0, 0, 0, 0, 0, 0
    .long 6, 32, 32, 8192, 1280, 263424, 8388608, 0, 32768, 4, 37769216, 131072, 0, 0, 218104336, 1
    .long 4, 32, 32, 8192, 1280, 263424, 8388608, 262144, 32768, 4, 38817792, 131072, 0, 0, 218104464, 1
    .long 4, 16, 16, 8192, 1280, 263424, 8388608, 524288, 32768, 4, 6311936, 131072, 0, 0, 218104592, 1
    .long 1, 24, 24, 8192, 1536, 1792, 8388608, 1572864, 32768, 8, 27287552, 131072, 0, 0, 218105104, 4
    .long 2, 64, 72, 7168, 3072, 3072, 7340032, 0, 32768, 8, 54575104, 114688, 0, 0, 218103824, 1
    .long 2, 64, 72, 7168, 2048, 2048, 7340032, 1572864, 32768, 8, 60063744, 114688, 0, 0, 218104016, 1
    .long 2, 64, 72, 7168, 1024, 1024, 7340032, 3145728, 32768, 8, 65552384, 114688, 0, 0, 218104192, 1
    .long 1, 80, 80, 2048, 1536, 1792, 7340032, 61865984, 114688, 7, 169893888, 32768, 218104064, 7, 218106624, 1
    .long 0, 0, 0, 0, 0, 0, 0, 0, 0, 0, 0, 0, 0, 0, 0, 0
    .long 0, 0, 0, 0, 0, 0, 0, 0, 0, 0, 0, 0, 0, 0, 0, 0
    .long 6, 32, 32, 8192, 3328, 265472, 8388608, 0, 32768, 4, 37801984, 131072, 0, 0, 218104368, 1
    .long 4, 32, 32, 8192, 3328, 265472, 8388608, 262144, 32768, 4, 38850560, 131072, 0, 0, 218104496, 1
    .long 4, 16, 16, 8192, 3328, 265472, 8388608, 524288, 32768, 4, 6344704, 131072, 0, 0, 218104624, 1
    .long 1, 24, 24, 8192, 3584, 3840, 8388608, 1572864, 32768, 8, 27320320, 131072, 0, 0, 218105136, 4
    .long 2, 64, 72, 7168, 3328, 3328, 7340032, 0, 32768, 8, 54579200, 114688, 0, 0, 218103824, 1
    .long 2, 64, 72, 7168, 2304, 2304, 7340032, 1572864, 32768, 8, 60067840, 114688, 0, 0, 218104016, 1
    .long 2, 64, 72, 7168, 1280, 1280, 7340032, 3145728, 32768, 8, 65556480, 114688, 0, 0, 218104192, 1
    .long 1, 80, 80, 2048, 1836544, 1836800, 7340032, 61894656, 114688, 7, 174088192, 32768, 218104080, 7, 218106624, 1
    .long 0, 0, 0, 0, 0, 0, 0, 0, 0, 0, 0, 0, 0, 0, 0, 0
    .long 0, 0, 0, 0, 0, 0, 0, 0, 0, 0, 0, 0, 0, 0, 0, 0
    .long 6, 32, 32, 8192, 5376, 267520, 8388608, 0, 32768, 4, 37834752, 131072, 0, 0, 218104400, 1
    .long 4, 32, 32, 8192, 5376, 267520, 8388608, 262144, 32768, 4, 38883328, 131072, 0, 0, 218104528, 1
    .long 4, 16, 16, 8192, 5376, 267520, 8388608, 524288, 32768, 4, 6377472, 131072, 0, 0, 218104656, 1
    .long 1, 24, 24, 8192, 5632, 5888, 8388608, 1572864, 32768, 8, 27353088, 131072, 0, 0, 218105168, 4
    .long 2, 64, 72, 7168, 3584, 3584, 7340032, 0, 32768, 8, 54583296, 114688, 0, 0, 218103840, 1
    .long 2, 64, 72, 7168, 2560, 2560, 7340032, 1572864, 32768, 8, 60071936, 114688, 0, 0, 218104016, 1
    .long 2, 64, 72, 7168, 1536, 1536, 7340032, 3145728, 32768, 8, 65560576, 114688, 0, 0, 218104192, 1
    .long 1, 80, 80, 2048, 3671552, 3671808, 7340032, 61923328, 114688, 7, 178282496, 32768, 218104096, 7, 218106624, 1
    .long 0, 0, 0, 0, 0, 0, 0, 0, 0, 0, 0, 0, 0, 0, 0, 0
    .long 0, 0, 0, 0, 0, 0, 0, 0, 0, 0, 0, 0, 0, 0, 0, 0
    .long 6, 32, 32, 8192, 7424, 269568, 8388608, 0, 32768, 4, 37867520, 131072, 0, 0, 218104432, 1
    .long 4, 32, 32, 8192, 7424, 269568, 8388608, 262144, 32768, 4, 38916096, 131072, 0, 0, 218104560, 1
    .long 4, 16, 16, 8192, 7424, 269568, 8388608, 524288, 32768, 4, 6410240, 131072, 0, 0, 218104688, 1
    .long 1, 24, 24, 8192, 7680, 7936, 8388608, 1572864, 32768, 8, 27385856, 131072, 0, 0, 218105200, 4
    .long 2, 64, 72, 7168, 3840, 3840, 7340032, 0, 32768, 8, 54587392, 114688, 0, 0, 218103840, 1
    .long 2, 64, 72, 7168, 2816, 2816, 7340032, 1572864, 32768, 8, 60076032, 114688, 0, 0, 218104016, 1
    .long 2, 64, 72, 7168, 1792, 1792, 7340032, 3145728, 32768, 8, 65564672, 114688, 0, 0, 218104208, 1
    .long 1, 80, 80, 2048, 5506560, 5506816, 7340032, 61952000, 114688, 7, 182476800, 32768, 218104112, 7, 218106624, 1
    .long 0, 0, 0, 0, 0, 0, 0, 0, 0, 0, 0, 0, 0, 0, 0, 0
    .long 0, 0, 0, 0, 0, 0, 0, 0, 0, 0, 0, 0, 0, 0, 0, 0
    .long 6, 32, 32, 8192, 1536, 263680, 8388608, 0, 32768, 4, 37773312, 131072, 0, 0, 218104336, 1
    .long 4, 32, 32, 8192, 1536, 263680, 8388608, 262144, 32768, 4, 38821888, 131072, 0, 0, 218104464, 1
    .long 4, 16, 16, 8192, 1024, 263168, 8388608, 786432, 32768, 4, 7356416, 131072, 0, 0, 218104592, 1
    .long 1, 16, 16, 8192, 0, 256, 8388608, 1572864, 32768, 8, 10485760, 131072, 0, 0, 218105088, 4
    .long 2, 64, 72, 7168, 4096, 4096, 7340032, 0, 32768, 8, 54591488, 114688, 0, 0, 218103840, 1
    .long 2, 64, 72, 7168, 3072, 3072, 7340032, 1572864, 32768, 8, 60080128, 114688, 0, 0, 218104016, 1
    .long 2, 64, 72, 7168, 2048, 2048, 7340032, 3145728, 32768, 8, 65568768, 114688, 0, 0, 218104208, 1
    .long 1, 80, 80, 2048, 0, 256, 7340032, 63700992, 114688, 7, 170393600, 32768, 218104128, 7, 218106688, 1
    .long 0, 0, 0, 0, 0, 0, 0, 0, 0, 0, 0, 0, 0, 0, 0, 0
    .long 0, 0, 0, 0, 0, 0, 0, 0, 0, 0, 0, 0, 0, 0, 0, 0
    .long 6, 32, 32, 8192, 3584, 265728, 8388608, 0, 32768, 4, 37806080, 131072, 0, 0, 218104368, 1
    .long 4, 32, 32, 8192, 3584, 265728, 8388608, 262144, 32768, 4, 38854656, 131072, 0, 0, 218104496, 1
    .long 4, 16, 16, 8192, 3072, 265216, 8388608, 786432, 32768, 4, 7389184, 131072, 0, 0, 218104624, 1
    .long 1, 16, 16, 8192, 2048, 2304, 8388608, 1572864, 32768, 8, 10518528, 131072, 0, 0, 218105120, 4
    .long 2, 64, 72, 7168, 4352, 4352, 7340032, 0, 32768, 8, 54595584, 114688, 0, 0, 218103840, 1
    .long 2, 64, 72, 7168, 3328, 3328, 7340032, 1572864, 32768, 8, 60084224, 114688, 0, 0, 218104016, 1
    .long 2, 64, 72, 7168, 2304, 2304, 7340032, 3145728, 32768, 8, 65572864, 114688, 0, 0, 218104208, 1
    .long 1, 80, 80, 2048, 1835008, 1835264, 7340032, 63729664, 114688, 7, 174587904, 32768, 218104144, 7, 218106688, 1
    .long 0, 0, 0, 0, 0, 0, 0, 0, 0, 0, 0, 0, 0, 0, 0, 0
    .long 0, 0, 0, 0, 0, 0, 0, 0, 0, 0, 0, 0, 0, 0, 0, 0
    .long 6, 32, 32, 8192, 5632, 267776, 8388608, 0, 32768, 4, 37838848, 131072, 0, 0, 218104400, 1
    .long 4, 32, 32, 8192, 5632, 267776, 8388608, 262144, 32768, 4, 38887424, 131072, 0, 0, 218104528, 1
    .long 4, 16, 16, 8192, 5120, 267264, 8388608, 786432, 32768, 4, 7421952, 131072, 0, 0, 218104656, 1
    .long 1, 16, 16, 8192, 4096, 4352, 8388608, 1572864, 32768, 8, 10551296, 131072, 0, 0, 218105152, 4
    .long 2, 64, 72, 7168, 4608, 4608, 7340032, 0, 32768, 8, 54599680, 114688, 0, 0, 218103840, 1
    .long 2, 64, 72, 7168, 3584, 3584, 7340032, 1572864, 32768, 8, 60088320, 114688, 0, 0, 218104032, 1
    .long 2, 64, 72, 7168, 2560, 2560, 7340032, 3145728, 32768, 8, 65576960, 114688, 0, 0, 218104208, 1
    .long 1, 80, 80, 2048, 3670016, 3670272, 7340032, 63758336, 114688, 7, 178782208, 32768, 218104160, 7, 218106688, 1
    .long 0, 0, 0, 0, 0, 0, 0, 0, 0, 0, 0, 0, 0, 0, 0, 0
    .long 0, 0, 0, 0, 0, 0, 0, 0, 0, 0, 0, 0, 0, 0, 0, 0
    .long 6, 32, 32, 8192, 7680, 269824, 8388608, 0, 32768, 4, 37871616, 131072, 0, 0, 218104432, 1
    .long 4, 32, 32, 8192, 7680, 269824, 8388608, 262144, 32768, 4, 38920192, 131072, 0, 0, 218104560, 1
    .long 4, 16, 16, 8192, 7168, 269312, 8388608, 786432, 32768, 4, 7454720, 131072, 0, 0, 218104688, 1
    .long 1, 16, 16, 8192, 6144, 6400, 8388608, 1572864, 32768, 8, 10584064, 131072, 0, 0, 218105184, 4
    .long 2, 64, 72, 7168, 4864, 4864, 7340032, 0, 32768, 8, 54603776, 114688, 0, 0, 218103840, 1
    .long 2, 64, 72, 7168, 3840, 3840, 7340032, 1572864, 32768, 8, 60092416, 114688, 0, 0, 218104032, 1
    .long 2, 64, 72, 7168, 2816, 2816, 7340032, 3145728, 32768, 8, 65581056, 114688, 0, 0, 218104208, 1
    .long 1, 80, 80, 2048, 5505024, 5505280, 7340032, 63787008, 114688, 7, 182976512, 32768, 218104176, 7, 218106688, 1
    .long 0, 0, 0, 0, 0, 0, 0, 0, 0, 0, 0, 0, 0, 0, 0, 0
    .long 0, 0, 0, 0, 0, 0, 0, 0, 0, 0, 0, 0, 0, 0, 0, 0
    .long 6, 32, 32, 8192, 1792, 263936, 8388608, 0, 32768, 4, 37777408, 131072, 0, 0, 218104336, 1
    .long 4, 32, 32, 8192, 1792, 263936, 8388608, 262144, 32768, 4, 38825984, 131072, 0, 0, 218104464, 1
    .long 4, 16, 16, 8192, 1024, 263168, 8388608, 524288, 32768, 4, 6307840, 131072, 0, 0, 218104592, 1
    .long 1, 16, 16, 8192, 512, 768, 8388608, 1572864, 32768, 8, 10493952, 131072, 0, 0, 218105088, 4
    .long 2, 64, 72, 7168, 5120, 5120, 7340032, 0, 32768, 8, 54607872, 114688, 0, 0, 218103840, 1
    .long 2, 64, 72, 7168, 4096, 4096, 7340032, 1572864, 32768, 8, 60096512, 114688, 0, 0, 218104032, 1
    .long 2, 64, 72, 7168, 3072, 3072, 7340032, 3145728, 32768, 8, 65585152, 114688, 0, 0, 218104208, 1
    .long 1, 80, 80, 2048, 512, 768, 7340032, 63700992, 114688, 7, 170401792, 32768, 218104128, 7, 218106688, 1
    .long 0, 0, 0, 0, 0, 0, 0, 0, 0, 0, 0, 0, 0, 0, 0, 0
    .long 0, 0, 0, 0, 0, 0, 0, 0, 0, 0, 0, 0, 0, 0, 0, 0
    .long 6, 32, 32, 8192, 3840, 265984, 8388608, 0, 32768, 4, 37810176, 131072, 0, 0, 218104368, 1
    .long 4, 32, 32, 8192, 3840, 265984, 8388608, 262144, 32768, 4, 38858752, 131072, 0, 0, 218104496, 1
    .long 4, 16, 16, 8192, 3072, 265216, 8388608, 524288, 32768, 4, 6340608, 131072, 0, 0, 218104624, 1
    .long 1, 16, 16, 8192, 2560, 2816, 8388608, 1572864, 32768, 8, 10526720, 131072, 0, 0, 218105120, 4
    .long 2, 64, 72, 7168, 5376, 5376, 7340032, 0, 32768, 8, 54611968, 114688, 0, 0, 218103856, 1
    .long 2, 64, 72, 7168, 4352, 4352, 7340032, 1572864, 32768, 8, 60100608, 114688, 0, 0, 218104032, 1
    .long 2, 64, 72, 7168, 3328, 3328, 7340032, 3145728, 32768, 8, 65589248, 114688, 0, 0, 218104208, 1
    .long 1, 80, 80, 2048, 1835520, 1835776, 7340032, 63729664, 114688, 7, 174596096, 32768, 218104144, 7, 218106688, 1
    .long 0, 0, 0, 0, 0, 0, 0, 0, 0, 0, 0, 0, 0, 0, 0, 0
    .long 0, 0, 0, 0, 0, 0, 0, 0, 0, 0, 0, 0, 0, 0, 0, 0
    .long 6, 32, 32, 8192, 5888, 268032, 8388608, 0, 32768, 4, 37842944, 131072, 0, 0, 218104400, 1
    .long 4, 32, 32, 8192, 5888, 268032, 8388608, 262144, 32768, 4, 38891520, 131072, 0, 0, 218104528, 1
    .long 4, 16, 16, 8192, 5120, 267264, 8388608, 524288, 32768, 4, 6373376, 131072, 0, 0, 218104656, 1
    .long 1, 16, 16, 8192, 4608, 4864, 8388608, 1572864, 32768, 8, 10559488, 131072, 0, 0, 218105152, 4
    .long 2, 64, 72, 7168, 5632, 5632, 7340032, 0, 32768, 8, 54616064, 114688, 0, 0, 218103856, 1
    .long 2, 64, 72, 7168, 4608, 4608, 7340032, 1572864, 32768, 8, 60104704, 114688, 0, 0, 218104032, 1
    .long 2, 64, 72, 7168, 3584, 3584, 7340032, 3145728, 32768, 8, 65593344, 114688, 0, 0, 218104224, 1
    .long 1, 80, 80, 2048, 3670528, 3670784, 7340032, 63758336, 114688, 7, 178790400, 32768, 218104160, 7, 218106688, 1
    .long 0, 0, 0, 0, 0, 0, 0, 0, 0, 0, 0, 0, 0, 0, 0, 0
    .long 0, 0, 0, 0, 0, 0, 0, 0, 0, 0, 0, 0, 0, 0, 0, 0
    .long 6, 32, 32, 8192, 7936, 270080, 8388608, 0, 32768, 4, 37875712, 131072, 0, 0, 218104432, 1
    .long 4, 32, 32, 8192, 7936, 270080, 8388608, 262144, 32768, 4, 38924288, 131072, 0, 0, 218104560, 1
    .long 4, 16, 16, 8192, 7168, 269312, 8388608, 524288, 32768, 4, 6406144, 131072, 0, 0, 218104688, 1
    .long 1, 16, 16, 8192, 6656, 6912, 8388608, 1572864, 32768, 8, 10592256, 131072, 0, 0, 218105184, 4
    .long 2, 64, 72, 7168, 5888, 5888, 7340032, 0, 32768, 8, 54620160, 114688, 0, 0, 218103856, 1
    .long 2, 64, 72, 7168, 4864, 4864, 7340032, 1572864, 32768, 8, 60108800, 114688, 0, 0, 218104032, 1
    .long 2, 64, 72, 7168, 3840, 3840, 7340032, 3145728, 32768, 8, 65597440, 114688, 0, 0, 218104224, 1
    .long 1, 80, 80, 2048, 5505536, 5505792, 7340032, 63787008, 114688, 7, 182984704, 32768, 218104176, 7, 218106688, 1
    .long 0, 0, 0, 0, 0, 0, 0, 0, 0, 0, 0, 0, 0, 0, 0, 0
    .long 0, 0, 0, 0, 0, 0, 0, 0, 0, 0, 0, 0, 0, 0, 0, 0
    .long 6, 16, 16, 8192, 0, 262144, 8388608, 0, 32768, 4, 4194304, 131072, 0, 0, 218104320, 1
    .long 4, 16, 16, 8192, 0, 262144, 8388608, 262144, 32768, 4, 5242880, 131072, 0, 0, 218104448, 1
    .long 4, 16, 16, 8192, 0, 262144, 8388608, 524288, 32768, 4, 6291456, 131072, 0, 0, 218104576, 1
    .long 1, 16, 16, 8192, 1024, 1280, 8388608, 1572864, 32768, 8, 10502144, 131072, 0, 0, 218105104, 4
    .long 2, 64, 72, 7168, 6144, 6144, 7340032, 0, 32768, 8, 54624256, 114688, 0, 0, 218103856, 1
    .long 2, 64, 72, 7168, 5120, 5120, 7340032, 1572864, 32768, 8, 60112896, 114688, 0, 0, 218104032, 1
    .long 2, 64, 72, 7168, 4096, 4096, 7340032, 3145728, 32768, 8, 65601536, 114688, 0, 0, 218104224, 1
    .long 1, 80, 80, 2048, 1024, 1280, 7340032, 63700992, 114688, 7, 170409984, 32768, 218104128, 7, 218106688, 1
    .long 0, 0, 0, 0, 0, 0, 0, 0, 0, 0, 0, 0, 0, 0, 0, 0
    .long 0, 0, 0, 0, 0, 0, 0, 0, 0, 0, 0, 0, 0, 0, 0, 0
    .long 6, 16, 16, 8192, 2048, 264192, 8388608, 0, 32768, 4, 4227072, 131072, 0, 0, 218104352, 1
    .long 4, 16, 16, 8192, 2048, 264192, 8388608, 262144, 32768, 4, 5275648, 131072, 0, 0, 218104480, 1
    .long 4, 16, 16, 8192, 2048, 264192, 8388608, 524288, 32768, 4, 6324224, 131072, 0, 0, 218104608, 1
    .long 1, 16, 16, 8192, 3072, 3328, 8388608, 1572864, 32768, 8, 10534912, 131072, 0, 0, 218105136, 4
    .long 2, 64, 72, 7168, 6400, 6400, 7340032, 0, 32768, 8, 54628352, 114688, 0, 0, 218103856, 1
    .long 2, 64, 72, 7168, 5376, 5376, 7340032, 1572864, 32768, 8, 60116992, 114688, 0, 0, 218104048, 1
    .long 2, 64, 72, 7168, 4352, 4352, 7340032, 3145728, 32768, 8, 65605632, 114688, 0, 0, 218104224, 1
    .long 1, 80, 80, 2048, 1836032, 1836288, 7340032, 63729664, 114688, 7, 174604288, 32768, 218104144, 7, 218106688, 1
    .long 0, 0, 0, 0, 0, 0, 0, 0, 0, 0, 0, 0, 0, 0, 0, 0
    .long 0, 0, 0, 0, 0, 0, 0, 0, 0, 0, 0, 0, 0, 0, 0, 0
    .long 6, 16, 16, 8192, 4096, 266240, 8388608, 0, 32768, 4, 4259840, 131072, 0, 0, 218104384, 1
    .long 4, 16, 16, 8192, 4096, 266240, 8388608, 262144, 32768, 4, 5308416, 131072, 0, 0, 218104512, 1
    .long 4, 16, 16, 8192, 4096, 266240, 8388608, 524288, 32768, 4, 6356992, 131072, 0, 0, 218104640, 1
    .long 1, 16, 16, 8192, 5120, 5376, 8388608, 1572864, 32768, 8, 10567680, 131072, 0, 0, 218105168, 4
    .long 2, 64, 72, 7168, 6656, 6656, 7340032, 0, 32768, 8, 54632448, 114688, 0, 0, 218103856, 1
    .long 2, 64, 72, 7168, 5632, 5632, 7340032, 1572864, 32768, 8, 60121088, 114688, 0, 0, 218104048, 1
    .long 2, 64, 72, 7168, 4608, 4608, 7340032, 3145728, 32768, 8, 65609728, 114688, 0, 0, 218104224, 1
    .long 1, 80, 80, 2048, 3671040, 3671296, 7340032, 63758336, 114688, 7, 178798592, 32768, 218104160, 7, 218106688, 1
    .long 0, 0, 0, 0, 0, 0, 0, 0, 0, 0, 0, 0, 0, 0, 0, 0
    .long 0, 0, 0, 0, 0, 0, 0, 0, 0, 0, 0, 0, 0, 0, 0, 0
    .long 6, 16, 16, 8192, 6144, 268288, 8388608, 0, 32768, 4, 4292608, 131072, 0, 0, 218104416, 1
    .long 4, 16, 16, 8192, 6144, 268288, 8388608, 262144, 32768, 4, 5341184, 131072, 0, 0, 218104544, 1
    .long 4, 16, 16, 8192, 6144, 268288, 8388608, 524288, 32768, 4, 6389760, 131072, 0, 0, 218104672, 1
    .long 1, 16, 16, 8192, 7168, 7424, 8388608, 1572864, 32768, 8, 10600448, 131072, 0, 0, 218105200, 4
    .long 2, 64, 72, 7168, 6912, 6912, 7340032, 0, 32768, 8, 54636544, 114688, 0, 0, 218103856, 1
    .long 2, 64, 72, 7168, 5888, 5888, 7340032, 1572864, 32768, 8, 60125184, 114688, 0, 0, 218104048, 1
    .long 2, 64, 72, 7168, 4864, 4864, 7340032, 3145728, 32768, 8, 65613824, 114688, 0, 0, 218104224, 1
    .long 1, 80, 80, 2048, 5506048, 5506304, 7340032, 63787008, 114688, 7, 182992896, 32768, 218104176, 7, 218106688, 1
    .long 0, 0, 0, 0, 0, 0, 0, 0, 0, 0, 0, 0, 0, 0, 0, 0
    .long 0, 0, 0, 0, 0, 0, 0, 0, 0, 0, 0, 0, 0, 0, 0, 0
    .long 6, 16, 16, 8192, 256, 262400, 8388608, 0, 32768, 4, 4198400, 131072, 0, 0, 218104320, 1
    .long 4, 16, 16, 8192, 256, 262400, 8388608, 262144, 32768, 4, 5246976, 131072, 0, 0, 218104448, 1
    .long 4, 16, 16, 8192, 256, 262400, 8388608, 524288, 32768, 4, 6295552, 131072, 0, 0, 218104576, 1
    .long 1, 16, 16, 8192, 1536, 1792, 8388608, 1572864, 32768, 8, 10510336, 131072, 0, 0, 218105104, 4
    .long 2, 64, 72, 7168, 0, 0, 7340032, 524288, 32768, 8, 56360960, 114688, 0, 0, 218103872, 1
    .long 2, 64, 72, 7168, 6144, 6144, 7340032, 1572864, 32768, 8, 60129280, 114688, 0, 0, 218104048, 1
    .long 2, 64, 72, 7168, 5120, 5120, 7340032, 3145728, 32768, 8, 65617920, 114688, 0, 0, 218104224, 1
    .long 1, 80, 80, 2048, 1536, 1792, 7340032, 63700992, 114688, 7, 170418176, 32768, 218104128, 7, 218106688, 1
    .long 0, 0, 0, 0, 0, 0, 0, 0, 0, 0, 0, 0, 0, 0, 0, 0
    .long 0, 0, 0, 0, 0, 0, 0, 0, 0, 0, 0, 0, 0, 0, 0, 0
    .long 6, 16, 16, 8192, 2304, 264448, 8388608, 0, 32768, 4, 4231168, 131072, 0, 0, 218104352, 1
    .long 4, 16, 16, 8192, 2304, 264448, 8388608, 262144, 32768, 4, 5279744, 131072, 0, 0, 218104480, 1
    .long 4, 16, 16, 8192, 2304, 264448, 8388608, 524288, 32768, 4, 6328320, 131072, 0, 0, 218104608, 1
    .long 1, 16, 16, 8192, 3584, 3840, 8388608, 1572864, 32768, 8, 10543104, 131072, 0, 0, 218105136, 4
    .long 2, 64, 72, 7168, 256, 256, 7340032, 524288, 32768, 8, 56365056, 114688, 0, 0, 218103872, 1
    .long 2, 64, 72, 7168, 6400, 6400, 7340032, 1572864, 32768, 8, 60133376, 114688, 0, 0, 218104048, 1
    .long 2, 64, 72, 7168, 5376, 5376, 7340032, 3145728, 32768, 8, 65622016, 114688, 0, 0, 218104240, 1
    .long 1, 80, 80, 2048, 1836544, 1836800, 7340032, 63729664, 114688, 7, 174612480, 32768, 218104144, 7, 218106688, 1
    .long 0, 0, 0, 0, 0, 0, 0, 0, 0, 0, 0, 0, 0, 0, 0, 0
    .long 0, 0, 0, 0, 0, 0, 0, 0, 0, 0, 0, 0, 0, 0, 0, 0
    .long 6, 16, 16, 8192, 4352, 266496, 8388608, 0, 32768, 4, 4263936, 131072, 0, 0, 218104384, 1
    .long 4, 16, 16, 8192, 4352, 266496, 8388608, 262144, 32768, 4, 5312512, 131072, 0, 0, 218104512, 1
    .long 4, 16, 16, 8192, 4352, 266496, 8388608, 524288, 32768, 4, 6361088, 131072, 0, 0, 218104640, 1
    .long 1, 16, 16, 8192, 5632, 5888, 8388608, 1572864, 32768, 8, 10575872, 131072, 0, 0, 218105168, 4
    .long 2, 64, 72, 7168, 512, 512, 7340032, 524288, 32768, 8, 56369152, 114688, 0, 0, 218103872, 1
    .long 2, 64, 72, 7168, 6656, 6656, 7340032, 1572864, 32768, 8, 60137472, 114688, 0, 0, 218104048, 1
    .long 2, 64, 72, 7168, 5632, 5632, 7340032, 3145728, 32768, 8, 65626112, 114688, 0, 0, 218104240, 1
    .long 1, 80, 80, 2048, 3671552, 3671808, 7340032, 63758336, 114688, 7, 178806784, 32768, 218104160, 7, 218106688, 1
    .long 0, 0, 0, 0, 0, 0, 0, 0, 0, 0, 0, 0, 0, 0, 0, 0
    .long 0, 0, 0, 0, 0, 0, 0, 0, 0, 0, 0, 0, 0, 0, 0, 0
    .long 6, 16, 16, 8192, 6400, 268544, 8388608, 0, 32768, 4, 4296704, 131072, 0, 0, 218104416, 1
    .long 4, 16, 16, 8192, 6400, 268544, 8388608, 262144, 32768, 4, 5345280, 131072, 0, 0, 218104544, 1
    .long 4, 16, 16, 8192, 6400, 268544, 8388608, 524288, 32768, 4, 6393856, 131072, 0, 0, 218104672, 1
    .long 1, 16, 16, 8192, 7680, 7936, 8388608, 1572864, 32768, 8, 10608640, 131072, 0, 0, 218105200, 4
    .long 2, 64, 72, 7168, 768, 768, 7340032, 524288, 32768, 8, 56373248, 114688, 0, 0, 218103872, 1
    .long 2, 64, 72, 7168, 6912, 6912, 7340032, 1572864, 32768, 8, 60141568, 114688, 0, 0, 218104048, 1
    .long 2, 64, 72, 7168, 5888, 5888, 7340032, 3145728, 32768, 8, 65630208, 114688, 0, 0, 218104240, 1
    .long 1, 80, 80, 2048, 5506560, 5506816, 7340032, 63787008, 114688, 7, 183001088, 32768, 218104176, 7, 218106688, 1
    .long 0, 0, 0, 0, 0, 0, 0, 0, 0, 0, 0, 0, 0, 0, 0, 0
    .long 0, 0, 0, 0, 0, 0, 0, 0, 0, 0, 0, 0, 0, 0, 0, 0
    .long 6, 16, 16, 8192, 512, 262656, 8388608, 0, 32768, 4, 4202496, 131072, 0, 0, 218104320, 1
    .long 4, 16, 16, 8192, 512, 262656, 8388608, 262144, 32768, 4, 5251072, 131072, 0, 0, 218104448, 1
    .long 4, 16, 16, 8192, 512, 262656, 8388608, 524288, 32768, 4, 6299648, 131072, 0, 0, 218104576, 1
    .long 1, 32, 32, 8192, 0, 256, 8388608, 2097152, 32768, 8, 46137344, 131072, 0, 0, 218105344, 4
    .long 2, 64, 72, 7168, 1024, 1024, 7340032, 524288, 32768, 8, 56377344, 114688, 0, 0, 218103872, 1
    .long 2, 64, 72, 7168, 0, 0, 7340032, 2097152, 32768, 8, 61865984, 114688, 0, 0, 218104064, 1
    .long 2, 64, 72, 7168, 6144, 6144, 7340032, 3145728, 32768, 8, 65634304, 114688, 0, 0, 218104240, 1
    .long 1, 80, 80, 2048, 0, 256, 7340032, 65536000, 114688, 7, 170917888, 32768, 218104192, 7, 218106752, 1
    .long 0, 0, 0, 0, 0, 0, 0, 0, 0, 0, 0, 0, 0, 0, 0, 0
    .long 0, 0, 0, 0, 0, 0, 0, 0, 0, 0, 0, 0, 0, 0, 0, 0
    .long 6, 16, 16, 8192, 2560, 264704, 8388608, 0, 32768, 4, 4235264, 131072, 0, 0, 218104352, 1
    .long 4, 16, 16, 8192, 2560, 264704, 8388608, 262144, 32768, 4, 5283840, 131072, 0, 0, 218104480, 1
    .long 4, 16, 16, 8192, 2560, 264704, 8388608, 524288, 32768, 4, 6332416, 131072, 0, 0, 218104608, 1
    .long 1, 32, 32, 8192, 2048, 2304, 8388608, 2097152, 32768, 8, 46170112, 131072, 0, 0, 218105376, 4
    .long 2, 64, 72, 7168, 1280, 1280, 7340032, 524288, 32768, 8, 56381440, 114688, 0, 0, 218103872, 1
    .long 2, 64, 72, 7168, 256, 256, 7340032, 2097152, 32768, 8, 61870080, 114688, 0, 0, 218104064, 1
    .long 2, 64, 72, 7168, 6400, 6400, 7340032, 3145728, 32768, 8, 65638400, 114688, 0, 0, 218104240, 1
    .long 1, 80, 80, 2048, 1835008, 1835264, 7340032, 65564672, 114688, 7, 175112192, 32768, 218104208, 7, 218106752, 1
    .long 0, 0, 0, 0, 0, 0, 0, 0, 0, 0, 0, 0, 0, 0, 0, 0
    .long 0, 0, 0, 0, 0, 0, 0, 0, 0, 0, 0, 0, 0, 0, 0, 0
    .long 6, 16, 16, 8192, 4608, 266752, 8388608, 0, 32768, 4, 4268032, 131072, 0, 0, 218104384, 1
    .long 4, 16, 16, 8192, 4608, 266752, 8388608, 262144, 32768, 4, 5316608, 131072, 0, 0, 218104512, 1
    .long 4, 16, 16, 8192, 4608, 266752, 8388608, 524288, 32768, 4, 6365184, 131072, 0, 0, 218104640, 1
    .long 1, 32, 32, 8192, 4096, 4352, 8388608, 2097152, 32768, 8, 46202880, 131072, 0, 0, 218105408, 4
    .long 2, 64, 72, 7168, 1536, 1536, 7340032, 524288, 32768, 8, 56385536, 114688, 0, 0, 218103872, 1
    .long 2, 64, 72, 7168, 512, 512, 7340032, 2097152, 32768, 8, 61874176, 114688, 0, 0, 218104064, 1
    .long 2, 64, 72, 7168, 6656, 6656, 7340032, 3145728, 32768, 8, 65642496, 114688, 0, 0, 218104240, 1
    .long 1, 80, 80, 2048, 3670016, 3670272, 7340032, 65593344, 114688, 7, 179306496, 32768, 218104224, 7, 218106752, 1
    .long 0, 0, 0, 0, 0, 0, 0, 0, 0, 0, 0, 0, 0, 0, 0, 0
    .long 0, 0, 0, 0, 0, 0, 0, 0, 0, 0, 0, 0, 0, 0, 0, 0
    .long 6, 16, 16, 8192, 6656, 268800, 8388608, 0, 32768, 4, 4300800, 131072, 0, 0, 218104416, 1
    .long 4, 16, 16, 8192, 6656, 268800, 8388608, 262144, 32768, 4, 5349376, 131072, 0, 0, 218104544, 1
    .long 4, 16, 16, 8192, 6656, 268800, 8388608, 524288, 32768, 4, 6397952, 131072, 0, 0, 218104672, 1
    .long 1, 32, 32, 8192, 6144, 6400, 8388608, 2097152, 32768, 8, 46235648, 131072, 0, 0, 218105440, 4
    .long 2, 64, 72, 7168, 1792, 1792, 7340032, 524288, 32768, 8, 56389632, 114688, 0, 0, 218103888, 1
    .long 2, 64, 72, 7168, 768, 768, 7340032, 2097152, 32768, 8, 61878272, 114688, 0, 0, 218104064, 1
    .long 2, 64, 72, 7168, 6912, 6912, 7340032, 3145728, 32768, 8, 65646592, 114688, 0, 0, 218104240, 1
    .long 1, 80, 80, 2048, 5505024, 5505280, 7340032, 65622016, 114688, 7, 183500800, 32768, 218104240, 7, 218106752, 1
    .long 0, 0, 0, 0, 0, 0, 0, 0, 0, 0, 0, 0, 0, 0, 0, 0
    .long 0, 0, 0, 0, 0, 0, 0, 0, 0, 0, 0, 0, 0, 0, 0, 0
    .long 6, 16, 16, 8192, 768, 262912, 8388608, 0, 32768, 4, 4206592, 131072, 0, 0, 218104320, 1
    .long 4, 16, 16, 8192, 768, 262912, 8388608, 262144, 32768, 4, 5255168, 131072, 0, 0, 218104448, 1
    .long 4, 16, 16, 8192, 768, 262912, 8388608, 524288, 32768, 4, 6303744, 131072, 0, 0, 218104576, 1
    .long 1, 32, 32, 8192, 512, 768, 8388608, 2097152, 32768, 8, 46145536, 131072, 0, 0, 218105344, 4
    .long 2, 64, 72, 7168, 2048, 2048, 7340032, 524288, 32768, 8, 56393728, 114688, 0, 0, 218103888, 1
    .long 2, 64, 72, 7168, 1024, 1024, 7340032, 2097152, 32768, 8, 61882368, 114688, 0, 0, 218104064, 1
    .long 2, 64, 72, 7168, 0, 0, 7340032, 3670016, 32768, 8, 67371008, 114688, 0, 0, 218104256, 1
    .long 1, 80, 80, 2048, 512, 768, 7340032, 65536000, 114688, 7, 170926080, 32768, 218104192, 7, 218106752, 1
    .long 0, 0, 0, 0, 0, 0, 0, 0, 0, 0, 0, 0, 0, 0, 0, 0
    .long 0, 0, 0, 0, 0, 0, 0, 0, 0, 0, 0, 0, 0, 0, 0, 0
    .long 6, 16, 16, 8192, 2816, 264960, 8388608, 0, 32768, 4, 4239360, 131072, 0, 0, 218104352, 1
    .long 4, 16, 16, 8192, 2816, 264960, 8388608, 262144, 32768, 4, 5287936, 131072, 0, 0, 218104480, 1
    .long 4, 16, 16, 8192, 2816, 264960, 8388608, 524288, 32768, 4, 6336512, 131072, 0, 0, 218104608, 1
    .long 1, 32, 32, 8192, 2560, 2816, 8388608, 2097152, 32768, 8, 46178304, 131072, 0, 0, 218105376, 4
    .long 2, 64, 72, 7168, 2304, 2304, 7340032, 524288, 32768, 8, 56397824, 114688, 0, 0, 218103888, 1
    .long 2, 64, 72, 7168, 1280, 1280, 7340032, 2097152, 32768, 8, 61886464, 114688, 0, 0, 218104064, 1
    .long 2, 64, 72, 7168, 256, 256, 7340032, 3670016, 32768, 8, 67375104, 114688, 0, 0, 218104256, 1
    .long 1, 80, 80, 2048, 1835520, 1835776, 7340032, 65564672, 114688, 7, 175120384, 32768, 218104208, 7, 218106752, 1
    .long 0, 0, 0, 0, 0, 0, 0, 0, 0, 0, 0, 0, 0, 0, 0, 0
    .long 0, 0, 0, 0, 0, 0, 0, 0, 0, 0, 0, 0, 0, 0, 0, 0
    .long 6, 16, 16, 8192, 4864, 267008, 8388608, 0, 32768, 4, 4272128, 131072, 0, 0, 218104384, 1
    .long 4, 16, 16, 8192, 4864, 267008, 8388608, 262144, 32768, 4, 5320704, 131072, 0, 0, 218104512, 1
    .long 4, 16, 16, 8192, 4864, 267008, 8388608, 524288, 32768, 4, 6369280, 131072, 0, 0, 218104640, 1
    .long 1, 32, 32, 8192, 4608, 4864, 8388608, 2097152, 32768, 8, 46211072, 131072, 0, 0, 218105408, 4
    .long 2, 64, 72, 7168, 2560, 2560, 7340032, 524288, 32768, 8, 56401920, 114688, 0, 0, 218103888, 1
    .long 2, 64, 72, 7168, 1536, 1536, 7340032, 2097152, 32768, 8, 61890560, 114688, 0, 0, 218104064, 1
    .long 2, 64, 72, 7168, 512, 512, 7340032, 3670016, 32768, 8, 67379200, 114688, 0, 0, 218104256, 1
    .long 1, 80, 80, 2048, 3670528, 3670784, 7340032, 65593344, 114688, 7, 179314688, 32768, 218104224, 7, 218106752, 1
    .long 0, 0, 0, 0, 0, 0, 0, 0, 0, 0, 0, 0, 0, 0, 0, 0
    .long 0, 0, 0, 0, 0, 0, 0, 0, 0, 0, 0, 0, 0, 0, 0, 0
    .long 6, 16, 16, 8192, 6912, 269056, 8388608, 0, 32768, 4, 4304896, 131072, 0, 0, 218104416, 1
    .long 4, 16, 16, 8192, 6912, 269056, 8388608, 262144, 32768, 4, 5353472, 131072, 0, 0, 218104544, 1
    .long 4, 16, 16, 8192, 6912, 269056, 8388608, 524288, 32768, 4, 6402048, 131072, 0, 0, 218104672, 1
    .long 1, 32, 32, 8192, 6656, 6912, 8388608, 2097152, 32768, 8, 46243840, 131072, 0, 0, 218105440, 4
    .long 2, 64, 72, 7168, 2816, 2816, 7340032, 524288, 32768, 8, 56406016, 114688, 0, 0, 218103888, 1
    .long 2, 64, 72, 7168, 1792, 1792, 7340032, 2097152, 32768, 8, 61894656, 114688, 0, 0, 218104080, 1
    .long 2, 64, 72, 7168, 768, 768, 7340032, 3670016, 32768, 8, 67383296, 114688, 0, 0, 218104256, 1
    .long 1, 80, 80, 2048, 5505536, 5505792, 7340032, 65622016, 114688, 7, 183508992, 32768, 218104240, 7, 218106752, 1
    .long 0, 0, 0, 0, 0, 0, 0, 0, 0, 0, 0, 0, 0, 0, 0, 0
    .long 0, 0, 0, 0, 0, 0, 0, 0, 0, 0, 0, 0, 0, 0, 0, 0
    .long 6, 16, 16, 8192, 1024, 263168, 8388608, 0, 32768, 4, 4210688, 131072, 0, 0, 218104336, 1
    .long 4, 16, 16, 8192, 1024, 263168, 8388608, 262144, 32768, 4, 5259264, 131072, 0, 0, 218104464, 1
    .long 4, 16, 16, 8192, 768, 262912, 8388608, 786432, 32768, 4, 7352320, 131072, 0, 0, 218104576, 1
    .long 1, 32, 32, 8192, 1024, 1280, 8388608, 2097152, 32768, 8, 46153728, 131072, 0, 0, 218105360, 4
    .long 2, 64, 72, 7168, 3072, 3072, 7340032, 524288, 32768, 8, 56410112, 114688, 0, 0, 218103888, 1
    .long 2, 64, 72, 7168, 2048, 2048, 7340032, 2097152, 32768, 8, 61898752, 114688, 0, 0, 218104080, 1
    .long 2, 64, 72, 7168, 1024, 1024, 7340032, 3670016, 32768, 8, 67387392, 114688, 0, 0, 218104256, 1
    .long 1, 80, 80, 2048, 1024, 1280, 7340032, 65536000, 114688, 7, 170934272, 32768, 218104192, 7, 218106752, 1
    .long 0, 0, 0, 0, 0, 0, 0, 0, 0, 0, 0, 0, 0, 0, 0, 0
    .long 0, 0, 0, 0, 0, 0, 0, 0, 0, 0, 0, 0, 0, 0, 0, 0
    .long 6, 16, 16, 8192, 3072, 265216, 8388608, 0, 32768, 4, 4243456, 131072, 0, 0, 218104368, 1
    .long 4, 16, 16, 8192, 3072, 265216, 8388608, 262144, 32768, 4, 5292032, 131072, 0, 0, 218104496, 1
    .long 4, 16, 16, 8192, 2816, 264960, 8388608, 786432, 32768, 4, 7385088, 131072, 0, 0, 218104608, 1
    .long 1, 32, 32, 8192, 3072, 3328, 8388608, 2097152, 32768, 8, 46186496, 131072, 0, 0, 218105392, 4
    .long 2, 64, 72, 7168, 3328, 3328, 7340032, 524288, 32768, 8, 56414208, 114688, 0, 0, 218103888, 1
    .long 2, 64, 72, 7168, 2304, 2304, 7340032, 2097152, 32768, 8, 61902848, 114688, 0, 0, 218104080, 1
    .long 2, 64, 72, 7168, 1280, 1280, 7340032, 3670016, 32768, 8, 67391488, 114688, 0, 0, 218104256, 1
    .long 1, 80, 80, 2048, 1836032, 1836288, 7340032, 65564672, 114688, 7, 175128576, 32768, 218104208, 7, 218106752, 1
    .long 0, 0, 0, 0, 0, 0, 0, 0, 0, 0, 0, 0, 0, 0, 0, 0
    .long 0, 0, 0, 0, 0, 0, 0, 0, 0, 0, 0, 0, 0, 0, 0, 0
    .long 6, 16, 16, 8192, 5120, 267264, 8388608, 0, 32768, 4, 4276224, 131072, 0, 0, 218104400, 1
    .long 4, 16, 16, 8192, 5120, 267264, 8388608, 262144, 32768, 4, 5324800, 131072, 0, 0, 218104528, 1
    .long 4, 16, 16, 8192, 4864, 267008, 8388608, 786432, 32768, 4, 7417856, 131072, 0, 0, 218104640, 1
    .long 1, 32, 32, 8192, 5120, 5376, 8388608, 2097152, 32768, 8, 46219264, 131072, 0, 0, 218105424, 4
    .long 2, 64, 72, 7168, 3584, 3584, 7340032, 524288, 32768, 8, 56418304, 114688, 0, 0, 218103904, 1
    .long 2, 64, 72, 7168, 2560, 2560, 7340032, 2097152, 32768, 8, 61906944, 114688, 0, 0, 218104080, 1
    .long 2, 64, 72, 7168, 1536, 1536, 7340032, 3670016, 32768, 8, 67395584, 114688, 0, 0, 218104256, 1
    .long 1, 80, 80, 2048, 3671040, 3671296, 7340032, 65593344, 114688, 7, 179322880, 32768, 218104224, 7, 218106752, 1
    .long 0, 0, 0, 0, 0, 0, 0, 0, 0, 0, 0, 0, 0, 0, 0, 0
    .long 0, 0, 0, 0, 0, 0, 0, 0, 0, 0, 0, 0, 0, 0, 0, 0
    .long 6, 16, 16, 8192, 7168, 269312, 8388608, 0, 32768, 4, 4308992, 131072, 0, 0, 218104432, 1
    .long 4, 16, 16, 8192, 7168, 269312, 8388608, 262144, 32768, 4, 5357568, 131072, 0, 0, 218104560, 1
    .long 4, 16, 16, 8192, 6912, 269056, 8388608, 786432, 32768, 4, 7450624, 131072, 0, 0, 218104672, 1
    .long 1, 32, 32, 8192, 7168, 7424, 8388608, 2097152, 32768, 8, 46252032, 131072, 0, 0, 218105456, 4
    .long 2, 64, 72, 7168, 3840, 3840, 7340032, 524288, 32768, 8, 56422400, 114688, 0, 0, 218103904, 1
    .long 2, 64, 72, 7168, 2816, 2816, 7340032, 2097152, 32768, 8, 61911040, 114688, 0, 0, 218104080, 1
    .long 2, 64, 72, 7168, 1792, 1792, 7340032, 3670016, 32768, 8, 67399680, 114688, 0, 0, 218104272, 1
    .long 1, 80, 80, 2048, 5506048, 5506304, 7340032, 65622016, 114688, 7, 183517184, 32768, 218104240, 7, 218106752, 1
    .long 0, 0, 0, 0, 0, 0, 0, 0, 0, 0, 0, 0, 0, 0, 0, 0
    .long 0, 0, 0, 0, 0, 0, 0, 0, 0, 0, 0, 0, 0, 0, 0, 0
    .long 6, 16, 16, 8192, 1280, 263424, 8388608, 0, 32768, 4, 4214784, 131072, 0, 0, 218104336, 1
    .long 4, 16, 16, 8192, 1280, 263424, 8388608, 262144, 32768, 4, 5263360, 131072, 0, 0, 218104464, 1
    .long 4, 16, 16, 8192, 512, 262656, 8388608, 786432, 32768, 4, 7348224, 131072, 0, 0, 218104576, 1
    .long 1, 32, 32, 8192, 1536, 1792, 8388608, 2097152, 32768, 8, 46161920, 131072, 0, 0, 218105360, 4
    .long 2, 64, 72, 7168, 4096, 4096, 7340032, 524288, 32768, 8, 56426496, 114688, 0, 0, 218103904, 1
    .long 2, 64, 72, 7168, 3072, 3072, 7340032, 2097152, 32768, 8, 61915136, 114688, 0, 0, 218104080, 1
    .long 2, 64, 72, 7168, 2048, 2048, 7340032, 3670016, 32768, 8, 67403776, 114688, 0, 0, 218104272, 1
    .long 1, 80, 80, 2048, 1536, 1792, 7340032, 65536000, 114688, 7, 170942464, 32768, 218104192, 7, 218106752, 1
    .long 0, 0, 0, 0, 0, 0, 0, 0, 0, 0, 0, 0, 0, 0, 0, 0
    .long 0, 0, 0, 0, 0, 0, 0, 0, 0, 0, 0, 0, 0, 0, 0, 0
    .long 6, 16, 16, 8192, 3328, 265472, 8388608, 0, 32768, 4, 4247552, 131072, 0, 0, 218104368, 1
    .long 4, 16, 16, 8192, 3328, 265472, 8388608, 262144, 32768, 4, 5296128, 131072, 0, 0, 218104496, 1
    .long 4, 16, 16, 8192, 2560, 264704, 8388608, 786432, 32768, 4, 7380992, 131072, 0, 0, 218104608, 1
    .long 1, 32, 32, 8192, 3584, 3840, 8388608, 2097152, 32768, 8, 46194688, 131072, 0, 0, 218105392, 4
    .long 2, 64, 72, 7168, 4352, 4352, 7340032, 524288, 32768, 8, 56430592, 114688, 0, 0, 218103904, 1
    .long 2, 64, 72, 7168, 3328, 3328, 7340032, 2097152, 32768, 8, 61919232, 114688, 0, 0, 218104080, 1
    .long 2, 64, 72, 7168, 2304, 2304, 7340032, 3670016, 32768, 8, 67407872, 114688, 0, 0, 218104272, 1
    .long 1, 80, 80, 2048, 1836544, 1836800, 7340032, 65564672, 114688, 7, 175136768, 32768, 218104208, 7, 218106752, 1
    .long 0, 0, 0, 0, 0, 0, 0, 0, 0, 0, 0, 0, 0, 0, 0, 0
    .long 0, 0, 0, 0, 0, 0, 0, 0, 0, 0, 0, 0, 0, 0, 0, 0
    .long 6, 16, 16, 8192, 5376, 267520, 8388608, 0, 32768, 4, 4280320, 131072, 0, 0, 218104400, 1
    .long 4, 16, 16, 8192, 5376, 267520, 8388608, 262144, 32768, 4, 5328896, 131072, 0, 0, 218104528, 1
    .long 4, 16, 16, 8192, 4608, 266752, 8388608, 786432, 32768, 4, 7413760, 131072, 0, 0, 218104640, 1
    .long 1, 32, 32, 8192, 5632, 5888, 8388608, 2097152, 32768, 8, 46227456, 131072, 0, 0, 218105424, 4
    .long 2, 64, 72, 7168, 4608, 4608, 7340032, 524288, 32768, 8, 56434688, 114688, 0, 0, 218103904, 1
    .long 2, 64, 72, 7168, 3584, 3584, 7340032, 2097152, 32768, 8, 61923328, 114688, 0, 0, 218104096, 1
    .long 2, 64, 72, 7168, 2560, 2560, 7340032, 3670016, 32768, 8, 67411968, 114688, 0, 0, 218104272, 1
    .long 1, 80, 80, 2048, 3671552, 3671808, 7340032, 65593344, 114688, 7, 179331072, 32768, 218104224, 7, 218106752, 1
    .long 0, 0, 0, 0, 0, 0, 0, 0, 0, 0, 0, 0, 0, 0, 0, 0
    .long 0, 0, 0, 0, 0, 0, 0, 0, 0, 0, 0, 0, 0, 0, 0, 0
    .long 6, 16, 16, 8192, 7424, 269568, 8388608, 0, 32768, 4, 4313088, 131072, 0, 0, 218104432, 1
    .long 4, 16, 16, 8192, 7424, 269568, 8388608, 262144, 32768, 4, 5361664, 131072, 0, 0, 218104560, 1
    .long 4, 16, 16, 8192, 6656, 268800, 8388608, 786432, 32768, 4, 7446528, 131072, 0, 0, 218104672, 1
    .long 1, 32, 32, 8192, 7680, 7936, 8388608, 2097152, 32768, 8, 46260224, 131072, 0, 0, 218105456, 4
    .long 2, 64, 72, 7168, 4864, 4864, 7340032, 524288, 32768, 8, 56438784, 114688, 0, 0, 218103904, 1
    .long 2, 64, 72, 7168, 3840, 3840, 7340032, 2097152, 32768, 8, 61927424, 114688, 0, 0, 218104096, 1
    .long 2, 64, 72, 7168, 2816, 2816, 7340032, 3670016, 32768, 8, 67416064, 114688, 0, 0, 218104272, 1
    .long 1, 80, 80, 2048, 5506560, 5506816, 7340032, 65622016, 114688, 7, 183525376, 32768, 218104240, 7, 218106752, 1
    .long 0, 0, 0, 0, 0, 0, 0, 0, 0, 0, 0, 0, 0, 0, 0, 0
    .long 0, 0, 0, 0, 0, 0, 0, 0, 0, 0, 0, 0, 0, 0, 0, 0
    .long 6, 16, 16, 8192, 1536, 263680, 8388608, 0, 32768, 4, 4218880, 131072, 0, 0, 218104336, 1
    .long 4, 16, 16, 8192, 1536, 263680, 8388608, 262144, 32768, 4, 5267456, 131072, 0, 0, 218104464, 1
    .long 4, 16, 16, 8192, 256, 262400, 8388608, 786432, 32768, 4, 7344128, 131072, 0, 0, 218104576, 1
    .long 1, 24, 24, 8192, 0, 256, 8388608, 2097152, 32768, 8, 29360128, 131072, 0, 0, 218105344, 4
    .long 2, 64, 72, 7168, 5120, 5120, 7340032, 524288, 32768, 8, 56442880, 114688, 0, 0, 218103904, 1
    .long 2, 64, 72, 7168, 4096, 4096, 7340032, 2097152, 32768, 8, 61931520, 114688, 0, 0, 218104096, 1
    .long 2, 64, 72, 7168, 3072, 3072, 7340032, 3670016, 32768, 8, 67420160, 114688, 0, 0, 218104272, 1
    .long 1, 80, 80, 2048, 0, 256, 7340032, 67371008, 114688, 7, 171442176, 32768, 218104256, 7, 218106816, 1
    .long 0, 0, 0, 0, 0, 0, 0, 0, 0, 0, 0, 0, 0, 0, 0, 0
    .long 0, 0, 0, 0, 0, 0, 0, 0, 0, 0, 0, 0, 0, 0, 0, 0
    .long 6, 16, 16, 8192, 3584, 265728, 8388608, 0, 32768, 4, 4251648, 131072, 0, 0, 218104368, 1
    .long 4, 16, 16, 8192, 3584, 265728, 8388608, 262144, 32768, 4, 5300224, 131072, 0, 0, 218104496, 1
    .long 4, 16, 16, 8192, 2304, 264448, 8388608, 786432, 32768, 4, 7376896, 131072, 0, 0, 218104608, 1
    .long 1, 24, 24, 8192, 2048, 2304, 8388608, 2097152, 32768, 8, 29392896, 131072, 0, 0, 218105376, 4
    .long 2, 64, 72, 7168, 5376, 5376, 7340032, 524288, 32768, 8, 56446976, 114688, 0, 0, 218103920, 1
    .long 2, 64, 72, 7168, 4352, 4352, 7340032, 2097152, 32768, 8, 61935616, 114688, 0, 0, 218104096, 1
    .long 2, 64, 72, 7168, 3328, 3328, 7340032, 3670016, 32768, 8, 67424256, 114688, 0, 0, 218104272, 1
    .long 1, 80, 80, 2048, 1835008, 1835264, 7340032, 67399680, 114688, 7, 175636480, 32768, 218104272, 7, 218106816, 1
    .long 0, 0, 0, 0, 0, 0, 0, 0, 0, 0, 0, 0, 0, 0, 0, 0
    .long 0, 0, 0, 0, 0, 0, 0, 0, 0, 0, 0, 0, 0, 0, 0, 0
    .long 6, 16, 16, 8192, 5632, 267776, 8388608, 0, 32768, 4, 4284416, 131072, 0, 0, 218104400, 1
    .long 4, 16, 16, 8192, 5632, 267776, 8388608, 262144, 32768, 4, 5332992, 131072, 0, 0, 218104528, 1
    .long 4, 16, 16, 8192, 4352, 266496, 8388608, 786432, 32768, 4, 7409664, 131072, 0, 0, 218104640, 1
    .long 1, 24, 24, 8192, 4096, 4352, 8388608, 2097152, 32768, 8, 29425664, 131072, 0, 0, 218105408, 4
    .long 2, 64, 72, 7168, 5632, 5632, 7340032, 524288, 32768, 8, 56451072, 114688, 0, 0, 218103920, 1
    .long 2, 64, 72, 7168, 4608, 4608, 7340032, 2097152, 32768, 8, 61939712, 114688, 0, 0, 218104096, 1
    .long 2, 64, 72, 7168, 3584, 3584, 7340032, 3670016, 32768, 8, 67428352, 114688, 0, 0, 218104288, 1
    .long 1, 80, 80, 2048, 512, 768, 7340032, 67371008, 114688, 7, 171450368, 32768, 218104256, 7, 218106816, 1
    .long 0, 0, 0, 0, 0, 0, 0, 0, 0, 0, 0, 0, 0, 0, 0, 0
    .long 0, 0, 0, 0, 0, 0, 0, 0, 0, 0, 0, 0, 0, 0, 0, 0
    .long 6, 16, 16, 8192, 7680, 269824, 8388608, 0, 32768, 4, 4317184, 131072, 0, 0, 218104432, 1
    .long 4, 16, 16, 8192, 7680, 269824, 8388608, 262144, 32768, 4, 5365760, 131072, 0, 0, 218104560, 1
    .long 4, 16, 16, 8192, 6400, 268544, 8388608, 786432, 32768, 4, 7442432, 131072, 0, 0, 218104672, 1
    .long 1, 24, 24, 8192, 6144, 6400, 8388608, 2097152, 32768, 8, 29458432, 131072, 0, 0, 218105440, 4
    .long 2, 64, 72, 7168, 5888, 5888, 7340032, 524288, 32768, 8, 56455168, 114688, 0, 0, 218103920, 1
    .long 2, 64, 72, 7168, 4864, 4864, 7340032, 2097152, 32768, 8, 61943808, 114688, 0, 0, 218104096, 1
    .long 2, 64, 72, 7168, 3840, 3840, 7340032, 3670016, 32768, 8, 67432448, 114688, 0, 0, 218104288, 1
    .long 1, 80, 80, 2048, 1024, 1280, 7340032, 67371008, 114688, 7, 171458560, 32768, 218104256, 7, 218106816, 1
    .long 0, 0, 0, 0, 0, 0, 0, 0, 0, 0, 0, 0, 0, 0, 0, 0
    .long 0, 0, 0, 0, 0, 0, 0, 0, 0, 0, 0, 0, 0, 0, 0, 0
    .long 6, 16, 16, 8192, 1792, 263936, 8388608, 0, 32768, 4, 4222976, 131072, 0, 0, 218104336, 1
    .long 4, 16, 16, 8192, 1792, 263936, 8388608, 262144, 32768, 4, 5271552, 131072, 0, 0, 218104464, 1
    .long 4, 16, 16, 8192, 0, 262144, 8388608, 786432, 32768, 4, 7340032, 131072, 0, 0, 218104576, 1
    .long 1, 24, 24, 8192, 512, 768, 8388608, 2097152, 32768, 8, 29368320, 131072, 0, 0, 218105344, 4
    .long 2, 64, 72, 7168, 6144, 6144, 7340032, 524288, 32768, 8, 56459264, 114688, 0, 0, 218103920, 1
    .long 2, 64, 72, 7168, 5120, 5120, 7340032, 2097152, 32768, 8, 61947904, 114688, 0, 0, 218104096, 1
    .long 2, 64, 72, 7168, 4096, 4096, 7340032, 3670016, 32768, 8, 67436544, 114688, 0, 0, 218104288, 1
    .long 1, 80, 80, 2048, 1536, 1792, 7340032, 67371008, 114688, 7, 171466752, 32768, 218104256, 7, 218106816, 1
    .long 0, 0, 0, 0, 0, 0, 0, 0, 0, 0, 0, 0, 0, 0, 0, 0
    .long 0, 0, 0, 0, 0, 0, 0, 0, 0, 0, 0, 0, 0, 0, 0, 0
    .long 6, 16, 16, 8192, 3840, 265984, 8388608, 0, 32768, 4, 4255744, 131072, 0, 0, 218104368, 1
    .long 4, 16, 16, 8192, 3840, 265984, 8388608, 262144, 32768, 4, 5304320, 131072, 0, 0, 218104496, 1
    .long 4, 16, 16, 8192, 2048, 264192, 8388608, 786432, 32768, 4, 7372800, 131072, 0, 0, 218104608, 1
    .long 1, 24, 24, 8192, 2560, 2816, 8388608, 2097152, 32768, 8, 29401088, 131072, 0, 0, 218105376, 4
    .long 2, 64, 72, 7168, 6400, 6400, 7340032, 524288, 32768, 8, 56463360, 114688, 0, 0, 218103920, 1
    .long 2, 64, 72, 7168, 5376, 5376, 7340032, 2097152, 32768, 8, 61952000, 114688, 0, 0, 218104112, 1
    .long 2, 64, 72, 7168, 4352, 4352, 7340032, 3670016, 32768, 8, 67440640, 114688, 0, 0, 218104288, 1
    .long 1, 80, 80, 2048, 1835520, 1835776, 7340032, 67399680, 114688, 7, 175644672, 32768, 218104272, 7, 218106816, 1
    .long 0, 0, 0, 0, 0, 0, 0, 0, 0, 0, 0, 0, 0, 0, 0, 0
    .long 0, 0, 0, 0, 0, 0, 0, 0, 0, 0, 0, 0, 0, 0, 0, 0
    .long 6, 16, 16, 8192, 5888, 268032, 8388608, 0, 32768, 4, 4288512, 131072, 0, 0, 218104400, 1
    .long 4, 16, 16, 8192, 5888, 268032, 8388608, 262144, 32768, 4, 5337088, 131072, 0, 0, 218104528, 1
    .long 4, 16, 16, 8192, 4096, 266240, 8388608, 786432, 32768, 4, 7405568, 131072, 0, 0, 218104640, 1
    .long 1, 24, 24, 8192, 4608, 4864, 8388608, 2097152, 32768, 8, 29433856, 131072, 0, 0, 218105408, 4
    .long 2, 64, 72, 7168, 6656, 6656, 7340032, 524288, 32768, 8, 56467456, 114688, 0, 0, 218103920, 1
    .long 2, 64, 72, 7168, 5632, 5632, 7340032, 2097152, 32768, 8, 61956096, 114688, 0, 0, 218104112, 1
    .long 2, 64, 72, 7168, 4608, 4608, 7340032, 3670016, 32768, 8, 67444736, 114688, 0, 0, 218104288, 1
    .long 1, 80, 80, 2048, 1836032, 1836288, 7340032, 67399680, 114688, 7, 175652864, 32768, 218104272, 7, 218106816, 1
    .long 0, 0, 0, 0, 0, 0, 0, 0, 0, 0, 0, 0, 0, 0, 0, 0
    .long 0, 0, 0, 0, 0, 0, 0, 0, 0, 0, 0, 0, 0, 0, 0, 0
    .long 6, 16, 16, 8192, 7936, 270080, 8388608, 0, 32768, 4, 4321280, 131072, 0, 0, 218104432, 1
    .long 4, 16, 16, 8192, 7936, 270080, 8388608, 262144, 32768, 4, 5369856, 131072, 0, 0, 218104560, 1
    .long 4, 16, 16, 8192, 6144, 268288, 8388608, 786432, 32768, 4, 7438336, 131072, 0, 0, 218104672, 1
    .long 1, 24, 24, 8192, 6656, 6912, 8388608, 2097152, 32768, 8, 29466624, 131072, 0, 0, 218105440, 4
    .long 2, 64, 72, 7168, 6912, 6912, 7340032, 524288, 32768, 8, 56471552, 114688, 0, 0, 218103920, 1
    .long 2, 64, 72, 7168, 5888, 5888, 7340032, 2097152, 32768, 8, 61960192, 114688, 0, 0, 218104112, 1
    .long 2, 64, 72, 7168, 4864, 4864, 7340032, 3670016, 32768, 8, 67448832, 114688, 0, 0, 218104288, 1
    .long 1, 80, 80, 2048, 1836544, 1836800, 7340032, 67399680, 114688, 7, 175661056, 32768, 218104272, 7, 218106816, 1
    .long 0, 0, 0, 0, 0, 0, 0, 0, 0, 0, 0, 0, 0, 0, 0, 0
    .long 0, 0, 0, 0, 0, 0, 0, 0, 0, 0, 0, 0, 0, 0, 0, 0
    .long 1, 32, 32, 8192, 0, 256, 8388608, 524288, 32768, 8, 39845888, 131072, 0, 0, 218104576, 4
    .long 1, 16, 16, 8192, 0, 256, 8388608, 1048576, 32768, 8, 8388608, 131072, 0, 0, 218104832, 4
    .long 1, 24, 24, 8192, 0, 256, 8388608, 2621440, 32768, 8, 31457280, 131072, 0, 0, 218105600, 4
    .long 1, 16, 16, 8192, 0, 256, 8388608, 3145728, 32768, 8, 16777216, 131072, 0, 0, 218105856, 4
    .long 1, 16, 16, 8192, 0, 256, 8388608, 3670016, 32768, 8, 18874368, 131072, 0, 0, 218106112, 4
    .long 1, 80, 80, 2048, 0, 256, 7340032, 58195968, 114688, 7, 168820736, 32768, 218103936, 7, 218106496, 1
    .long 0, 0, 0, 0, 0, 0, 0, 0, 0, 0, 0, 0, 0, 0, 0, 0
    .long 0, 0, 0, 0, 0, 0, 0, 0, 0, 0, 0, 0, 0, 0, 0, 0
    .long 0, 0, 0, 0, 0, 0, 0, 0, 0, 0, 0, 0, 0, 0, 0, 0
    .long 0, 0, 0, 0, 0, 0, 0, 0, 0, 0, 0, 0, 0, 0, 0, 0
    .long 1, 32, 32, 8192, 2048, 2304, 8388608, 524288, 32768, 8, 39878656, 131072, 0, 0, 218104608, 4
    .long 1, 16, 16, 8192, 2048, 2304, 8388608, 1048576, 32768, 8, 8421376, 131072, 0, 0, 218104864, 4
    .long 1, 24, 24, 8192, 2048, 2304, 8388608, 2621440, 32768, 8, 31490048, 131072, 0, 0, 218105632, 4
    .long 1, 16, 16, 8192, 2048, 2304, 8388608, 3145728, 32768, 8, 16809984, 131072, 0, 0, 218105888, 4
    .long 1, 16, 16, 8192, 2048, 2304, 8388608, 3670016, 32768, 8, 18907136, 131072, 0, 0, 218106144, 4
    .long 1, 80, 80, 2048, 1835008, 1835264, 7340032, 58224640, 114688, 7, 173015040, 32768, 218103952, 7, 218106496, 1
    .long 0, 0, 0, 0, 0, 0, 0, 0, 0, 0, 0, 0, 0, 0, 0, 0
    .long 0, 0, 0, 0, 0, 0, 0, 0, 0, 0, 0, 0, 0, 0, 0, 0
    .long 0, 0, 0, 0, 0, 0, 0, 0, 0, 0, 0, 0, 0, 0, 0, 0
    .long 0, 0, 0, 0, 0, 0, 0, 0, 0, 0, 0, 0, 0, 0, 0, 0
    .long 1, 32, 32, 8192, 4096, 4352, 8388608, 524288, 32768, 8, 39911424, 131072, 0, 0, 218104640, 4
    .long 1, 16, 16, 8192, 4096, 4352, 8388608, 1048576, 32768, 8, 8454144, 131072, 0, 0, 218104896, 4
    .long 1, 24, 24, 8192, 4096, 4352, 8388608, 2621440, 32768, 8, 31522816, 131072, 0, 0, 218105664, 4
    .long 1, 16, 16, 8192, 4096, 4352, 8388608, 3145728, 32768, 8, 16842752, 131072, 0, 0, 218105920, 4
    .long 1, 16, 16, 8192, 4096, 4352, 8388608, 3670016, 32768, 8, 18939904, 131072, 0, 0, 218106176, 4
    .long 1, 80, 80, 2048, 3670016, 3670272, 7340032, 58253312, 114688, 7, 177209344, 32768, 218103968, 7, 218106496, 1
    .long 0, 0, 0, 0, 0, 0, 0, 0, 0, 0, 0, 0, 0, 0, 0, 0
    .long 0, 0, 0, 0, 0, 0, 0, 0, 0, 0, 0, 0, 0, 0, 0, 0
    .long 0, 0, 0, 0, 0, 0, 0, 0, 0, 0, 0, 0, 0, 0, 0, 0
    .long 0, 0, 0, 0, 0, 0, 0, 0, 0, 0, 0, 0, 0, 0, 0, 0
    .long 1, 32, 32, 8192, 6144, 6400, 8388608, 524288, 32768, 8, 39944192, 131072, 0, 0, 218104672, 4
    .long 1, 16, 16, 8192, 6144, 6400, 8388608, 1048576, 32768, 8, 8486912, 131072, 0, 0, 218104928, 4
    .long 1, 24, 24, 8192, 6144, 6400, 8388608, 2621440, 32768, 8, 31555584, 131072, 0, 0, 218105696, 4
    .long 1, 16, 16, 8192, 6144, 6400, 8388608, 3145728, 32768, 8, 16875520, 131072, 0, 0, 218105952, 4
    .long 1, 16, 16, 8192, 6144, 6400, 8388608, 3670016, 32768, 8, 18972672, 131072, 0, 0, 218106208, 4
    .long 1, 80, 80, 2048, 5505024, 5505280, 7340032, 58281984, 114688, 7, 181403648, 32768, 218103984, 7, 218106496, 1
    .long 0, 0, 0, 0, 0, 0, 0, 0, 0, 0, 0, 0, 0, 0, 0, 0
    .long 0, 0, 0, 0, 0, 0, 0, 0, 0, 0, 0, 0, 0, 0, 0, 0
    .long 0, 0, 0, 0, 0, 0, 0, 0, 0, 0, 0, 0, 0, 0, 0, 0
    .long 0, 0, 0, 0, 0, 0, 0, 0, 0, 0, 0, 0, 0, 0, 0, 0
    .long 1, 32, 32, 8192, 512, 768, 8388608, 524288, 32768, 8, 39854080, 131072, 0, 0, 218104576, 4
    .long 1, 16, 16, 8192, 512, 768, 8388608, 1048576, 32768, 8, 8396800, 131072, 0, 0, 218104832, 4
    .long 1, 24, 24, 8192, 512, 768, 8388608, 2621440, 32768, 8, 31465472, 131072, 0, 0, 218105600, 4
    .long 1, 16, 16, 8192, 512, 768, 8388608, 3145728, 32768, 8, 16785408, 131072, 0, 0, 218105856, 4
    .long 1, 16, 16, 8192, 512, 768, 8388608, 3670016, 32768, 8, 18882560, 131072, 0, 0, 218106112, 4
    .long 1, 80, 80, 2048, 512, 768, 7340032, 58195968, 114688, 7, 168828928, 32768, 218103936, 7, 218106496, 1
    .long 0, 0, 0, 0, 0, 0, 0, 0, 0, 0, 0, 0, 0, 0, 0, 0
    .long 0, 0, 0, 0, 0, 0, 0, 0, 0, 0, 0, 0, 0, 0, 0, 0
    .long 0, 0, 0, 0, 0, 0, 0, 0, 0, 0, 0, 0, 0, 0, 0, 0
    .long 0, 0, 0, 0, 0, 0, 0, 0, 0, 0, 0, 0, 0, 0, 0, 0
    .long 1, 32, 32, 8192, 2560, 2816, 8388608, 524288, 32768, 8, 39886848, 131072, 0, 0, 218104608, 4
    .long 1, 16, 16, 8192, 2560, 2816, 8388608, 1048576, 32768, 8, 8429568, 131072, 0, 0, 218104864, 4
    .long 1, 24, 24, 8192, 2560, 2816, 8388608, 2621440, 32768, 8, 31498240, 131072, 0, 0, 218105632, 4
    .long 1, 16, 16, 8192, 2560, 2816, 8388608, 3145728, 32768, 8, 16818176, 131072, 0, 0, 218105888, 4
    .long 1, 16, 16, 8192, 2560, 2816, 8388608, 3670016, 32768, 8, 18915328, 131072, 0, 0, 218106144, 4
    .long 1, 80, 80, 2048, 1835520, 1835776, 7340032, 58224640, 114688, 7, 173023232, 32768, 218103952, 7, 218106496, 1
    .long 0, 0, 0, 0, 0, 0, 0, 0, 0, 0, 0, 0, 0, 0, 0, 0
    .long 0, 0, 0, 0, 0, 0, 0, 0, 0, 0, 0, 0, 0, 0, 0, 0
    .long 0, 0, 0, 0, 0, 0, 0, 0, 0, 0, 0, 0, 0, 0, 0, 0
    .long 0, 0, 0, 0, 0, 0, 0, 0, 0, 0, 0, 0, 0, 0, 0, 0
    .long 1, 32, 32, 8192, 4608, 4864, 8388608, 524288, 32768, 8, 39919616, 131072, 0, 0, 218104640, 4
    .long 1, 16, 16, 8192, 4608, 4864, 8388608, 1048576, 32768, 8, 8462336, 131072, 0, 0, 218104896, 4
    .long 1, 24, 24, 8192, 4608, 4864, 8388608, 2621440, 32768, 8, 31531008, 131072, 0, 0, 218105664, 4
    .long 1, 16, 16, 8192, 4608, 4864, 8388608, 3145728, 32768, 8, 16850944, 131072, 0, 0, 218105920, 4
    .long 1, 16, 16, 8192, 4608, 4864, 8388608, 3670016, 32768, 8, 18948096, 131072, 0, 0, 218106176, 4
    .long 1, 80, 80, 2048, 3670528, 3670784, 7340032, 58253312, 114688, 7, 177217536, 32768, 218103968, 7, 218106496, 1
    .long 0, 0, 0, 0, 0, 0, 0, 0, 0, 0, 0, 0, 0, 0, 0, 0
    .long 0, 0, 0, 0, 0, 0, 0, 0, 0, 0, 0, 0, 0, 0, 0, 0
    .long 0, 0, 0, 0, 0, 0, 0, 0, 0, 0, 0, 0, 0, 0, 0, 0
    .long 0, 0, 0, 0, 0, 0, 0, 0, 0, 0, 0, 0, 0, 0, 0, 0
    .long 1, 32, 32, 8192, 6656, 6912, 8388608, 524288, 32768, 8, 39952384, 131072, 0, 0, 218104672, 4
    .long 1, 16, 16, 8192, 6656, 6912, 8388608, 1048576, 32768, 8, 8495104, 131072, 0, 0, 218104928, 4
    .long 1, 24, 24, 8192, 6656, 6912, 8388608, 2621440, 32768, 8, 31563776, 131072, 0, 0, 218105696, 4
    .long 1, 16, 16, 8192, 6656, 6912, 8388608, 3145728, 32768, 8, 16883712, 131072, 0, 0, 218105952, 4
    .long 1, 16, 16, 8192, 6656, 6912, 8388608, 3670016, 32768, 8, 18980864, 131072, 0, 0, 218106208, 4
    .long 1, 80, 80, 2048, 5505536, 5505792, 7340032, 58281984, 114688, 7, 181411840, 32768, 218103984, 7, 218106496, 1
    .long 0, 0, 0, 0, 0, 0, 0, 0, 0, 0, 0, 0, 0, 0, 0, 0
    .long 0, 0, 0, 0, 0, 0, 0, 0, 0, 0, 0, 0, 0, 0, 0, 0
    .long 0, 0, 0, 0, 0, 0, 0, 0, 0, 0, 0, 0, 0, 0, 0, 0
    .long 0, 0, 0, 0, 0, 0, 0, 0, 0, 0, 0, 0, 0, 0, 0, 0
    .long 1, 32, 32, 8192, 1024, 1280, 8388608, 524288, 32768, 8, 39862272, 131072, 0, 0, 218104592, 4
    .long 1, 16, 16, 8192, 1024, 1280, 8388608, 1048576, 32768, 8, 8404992, 131072, 0, 0, 218104848, 4
    .long 1, 24, 24, 8192, 1024, 1280, 8388608, 2621440, 32768, 8, 31473664, 131072, 0, 0, 218105616, 4
    .long 1, 16, 16, 8192, 1024, 1280, 8388608, 3145728, 32768, 8, 16793600, 131072, 0, 0, 218105872, 4
    .long 1, 16, 16, 8192, 1024, 1280, 8388608, 3670016, 32768, 8, 18890752, 131072, 0, 0, 218106128, 4
    .long 1, 80, 80, 2048, 1024, 1280, 7340032, 58195968, 114688, 7, 168837120, 32768, 218103936, 7, 218106496, 1
    .long 0, 0, 0, 0, 0, 0, 0, 0, 0, 0, 0, 0, 0, 0, 0, 0
    .long 0, 0, 0, 0, 0, 0, 0, 0, 0, 0, 0, 0, 0, 0, 0, 0
    .long 0, 0, 0, 0, 0, 0, 0, 0, 0, 0, 0, 0, 0, 0, 0, 0
    .long 0, 0, 0, 0, 0, 0, 0, 0, 0, 0, 0, 0, 0, 0, 0, 0
    .long 1, 32, 32, 8192, 3072, 3328, 8388608, 524288, 32768, 8, 39895040, 131072, 0, 0, 218104624, 4
    .long 1, 16, 16, 8192, 3072, 3328, 8388608, 1048576, 32768, 8, 8437760, 131072, 0, 0, 218104880, 4
    .long 1, 24, 24, 8192, 3072, 3328, 8388608, 2621440, 32768, 8, 31506432, 131072, 0, 0, 218105648, 4
    .long 1, 16, 16, 8192, 3072, 3328, 8388608, 3145728, 32768, 8, 16826368, 131072, 0, 0, 218105904, 4
    .long 1, 16, 16, 8192, 3072, 3328, 8388608, 3670016, 32768, 8, 18923520, 131072, 0, 0, 218106160, 4
    .long 1, 80, 80, 2048, 1836032, 1836288, 7340032, 58224640, 114688, 7, 173031424, 32768, 218103952, 7, 218106496, 1
    .long 0, 0, 0, 0, 0, 0, 0, 0, 0, 0, 0, 0, 0, 0, 0, 0
    .long 0, 0, 0, 0, 0, 0, 0, 0, 0, 0, 0, 0, 0, 0, 0, 0
    .long 0, 0, 0, 0, 0, 0, 0, 0, 0, 0, 0, 0, 0, 0, 0, 0
    .long 0, 0, 0, 0, 0, 0, 0, 0, 0, 0, 0, 0, 0, 0, 0, 0
    .long 1, 32, 32, 8192, 5120, 5376, 8388608, 524288, 32768, 8, 39927808, 131072, 0, 0, 218104656, 4
    .long 1, 16, 16, 8192, 5120, 5376, 8388608, 1048576, 32768, 8, 8470528, 131072, 0, 0, 218104912, 4
    .long 1, 24, 24, 8192, 5120, 5376, 8388608, 2621440, 32768, 8, 31539200, 131072, 0, 0, 218105680, 4
    .long 1, 16, 16, 8192, 5120, 5376, 8388608, 3145728, 32768, 8, 16859136, 131072, 0, 0, 218105936, 4
    .long 1, 16, 16, 8192, 5120, 5376, 8388608, 3670016, 32768, 8, 18956288, 131072, 0, 0, 218106192, 4
    .long 1, 80, 80, 2048, 3671040, 3671296, 7340032, 58253312, 114688, 7, 177225728, 32768, 218103968, 7, 218106496, 1
    .long 0, 0, 0, 0, 0, 0, 0, 0, 0, 0, 0, 0, 0, 0, 0, 0
    .long 0, 0, 0, 0, 0, 0, 0, 0, 0, 0, 0, 0, 0, 0, 0, 0
    .long 0, 0, 0, 0, 0, 0, 0, 0, 0, 0, 0, 0, 0, 0, 0, 0
    .long 0, 0, 0, 0, 0, 0, 0, 0, 0, 0, 0, 0, 0, 0, 0, 0
    .long 1, 32, 32, 8192, 7168, 7424, 8388608, 524288, 32768, 8, 39960576, 131072, 0, 0, 218104688, 4
    .long 1, 16, 16, 8192, 7168, 7424, 8388608, 1048576, 32768, 8, 8503296, 131072, 0, 0, 218104944, 4
    .long 1, 24, 24, 8192, 7168, 7424, 8388608, 2621440, 32768, 8, 31571968, 131072, 0, 0, 218105712, 4
    .long 1, 16, 16, 8192, 7168, 7424, 8388608, 3145728, 32768, 8, 16891904, 131072, 0, 0, 218105968, 4
    .long 1, 16, 16, 8192, 7168, 7424, 8388608, 3670016, 32768, 8, 18989056, 131072, 0, 0, 218106224, 4
    .long 1, 80, 80, 2048, 5506048, 5506304, 7340032, 58281984, 114688, 7, 181420032, 32768, 218103984, 7, 218106496, 1
    .long 0, 0, 0, 0, 0, 0, 0, 0, 0, 0, 0, 0, 0, 0, 0, 0
    .long 0, 0, 0, 0, 0, 0, 0, 0, 0, 0, 0, 0, 0, 0, 0, 0
    .long 0, 0, 0, 0, 0, 0, 0, 0, 0, 0, 0, 0, 0, 0, 0, 0
    .long 0, 0, 0, 0, 0, 0, 0, 0, 0, 0, 0, 0, 0, 0, 0, 0
    .long 1, 32, 32, 8192, 1536, 1792, 8388608, 524288, 32768, 8, 39870464, 131072, 0, 0, 218104592, 4
    .long 1, 16, 16, 8192, 1536, 1792, 8388608, 1048576, 32768, 8, 8413184, 131072, 0, 0, 218104848, 4
    .long 1, 24, 24, 8192, 1536, 1792, 8388608, 2621440, 32768, 8, 31481856, 131072, 0, 0, 218105616, 4
    .long 1, 16, 16, 8192, 1536, 1792, 8388608, 3145728, 32768, 8, 16801792, 131072, 0, 0, 218105872, 4
    .long 1, 16, 16, 8192, 1536, 1792, 8388608, 3670016, 32768, 8, 18898944, 131072, 0, 0, 218106128, 4
    .long 1, 80, 80, 2048, 1536, 1792, 7340032, 58195968, 114688, 7, 168845312, 32768, 218103936, 7, 218106496, 1
    .long 0, 0, 0, 0, 0, 0, 0, 0, 0, 0, 0, 0, 0, 0, 0, 0
    .long 0, 0, 0, 0, 0, 0, 0, 0, 0, 0, 0, 0, 0, 0, 0, 0
    .long 0, 0, 0, 0, 0, 0, 0, 0, 0, 0, 0, 0, 0, 0, 0, 0
    .long 0, 0, 0, 0, 0, 0, 0, 0, 0, 0, 0, 0, 0, 0, 0, 0
    .long 1, 32, 32, 8192, 3584, 3840, 8388608, 524288, 32768, 8, 39903232, 131072, 0, 0, 218104624, 4
    .long 1, 16, 16, 8192, 3584, 3840, 8388608, 1048576, 32768, 8, 8445952, 131072, 0, 0, 218104880, 4
    .long 1, 24, 24, 8192, 3584, 3840, 8388608, 2621440, 32768, 8, 31514624, 131072, 0, 0, 218105648, 4
    .long 1, 16, 16, 8192, 3584, 3840, 8388608, 3145728, 32768, 8, 16834560, 131072, 0, 0, 218105904, 4
    .long 1, 16, 16, 8192, 3584, 3840, 8388608, 3670016, 32768, 8, 18931712, 131072, 0, 0, 218106160, 4
    .long 1, 80, 80, 2048, 1836544, 1836800, 7340032, 58224640, 114688, 7, 173039616, 32768, 218103952, 7, 218106496, 1
    .long 0, 0, 0, 0, 0, 0, 0, 0, 0, 0, 0, 0, 0, 0, 0, 0
    .long 0, 0, 0, 0, 0, 0, 0, 0, 0, 0, 0, 0, 0, 0, 0, 0
    .long 0, 0, 0, 0, 0, 0, 0, 0, 0, 0, 0, 0, 0, 0, 0, 0
    .long 0, 0, 0, 0, 0, 0, 0, 0, 0, 0, 0, 0, 0, 0, 0, 0
    .long 1, 32, 32, 8192, 5632, 5888, 8388608, 524288, 32768, 8, 39936000, 131072, 0, 0, 218104656, 4
    .long 1, 16, 16, 8192, 5632, 5888, 8388608, 1048576, 32768, 8, 8478720, 131072, 0, 0, 218104912, 4
    .long 1, 24, 24, 8192, 5632, 5888, 8388608, 2621440, 32768, 8, 31547392, 131072, 0, 0, 218105680, 4
    .long 1, 16, 16, 8192, 5632, 5888, 8388608, 3145728, 32768, 8, 16867328, 131072, 0, 0, 218105936, 4
    .long 1, 16, 16, 8192, 5632, 5888, 8388608, 3670016, 32768, 8, 18964480, 131072, 0, 0, 218106192, 4
    .long 1, 80, 80, 2048, 3671552, 3671808, 7340032, 58253312, 114688, 7, 177233920, 32768, 218103968, 7, 218106496, 1
    .long 0, 0, 0, 0, 0, 0, 0, 0, 0, 0, 0, 0, 0, 0, 0, 0
    .long 0, 0, 0, 0, 0, 0, 0, 0, 0, 0, 0, 0, 0, 0, 0, 0
    .long 0, 0, 0, 0, 0, 0, 0, 0, 0, 0, 0, 0, 0, 0, 0, 0
    .long 0, 0, 0, 0, 0, 0, 0, 0, 0, 0, 0, 0, 0, 0, 0, 0
    .long 1, 32, 32, 8192, 7680, 7936, 8388608, 524288, 32768, 8, 39968768, 131072, 0, 0, 218104688, 4
    .long 1, 16, 16, 8192, 7680, 7936, 8388608, 1048576, 32768, 8, 8511488, 131072, 0, 0, 218104944, 4
    .long 1, 24, 24, 8192, 7680, 7936, 8388608, 2621440, 32768, 8, 31580160, 131072, 0, 0, 218105712, 4
    .long 1, 16, 16, 8192, 7680, 7936, 8388608, 3145728, 32768, 8, 16900096, 131072, 0, 0, 218105968, 4
    .long 1, 16, 16, 8192, 7680, 7936, 8388608, 3670016, 32768, 8, 18997248, 131072, 0, 0, 218106224, 4
    .long 1, 80, 80, 2048, 5506560, 5506816, 7340032, 58281984, 114688, 7, 181428224, 32768, 218103984, 7, 218106496, 1
    .long 0, 0, 0, 0, 0, 0, 0, 0, 0, 0, 0, 0, 0, 0, 0, 0
    .long 0, 0, 0, 0, 0, 0, 0, 0, 0, 0, 0, 0, 0, 0, 0, 0
    .long 0, 0, 0, 0, 0, 0, 0, 0, 0, 0, 0, 0, 0, 0, 0, 0
    .long 0, 0, 0, 0, 0, 0, 0, 0, 0, 0, 0, 0, 0, 0, 0, 0
    .long 1, 24, 24, 8192, 0, 256, 8388608, 524288, 32768, 8, 23068672, 131072, 0, 0, 218104576, 4
    .long 1, 32, 32, 8192, 0, 256, 8388608, 1572864, 32768, 8, 44040192, 131072, 0, 0, 218105088, 4
    .long 1, 16, 16, 8192, 0, 256, 8388608, 2621440, 32768, 8, 14680064, 131072, 0, 0, 218105600, 4
    .long 2, 64, 72, 7168, 2048, 2048, 7340032, 1048576, 32768, 8, 58228736, 114688, 0, 0, 218103952, 1
    .long 2, 64, 72, 7168, 1024, 1024, 7340032, 2621440, 32768, 8, 63717376, 114688, 0, 0, 218104128, 1
    .long 1, 80, 80, 2048, 0, 256, 7340032, 60030976, 114688, 7, 169345024, 32768, 218104000, 7, 218106560, 1
    .long 0, 0, 0, 0, 0, 0, 0, 0, 0, 0, 0, 0, 0, 0, 0, 0
    .long 0, 0, 0, 0, 0, 0, 0, 0, 0, 0, 0, 0, 0, 0, 0, 0
    .long 0, 0, 0, 0, 0, 0, 0, 0, 0, 0, 0, 0, 0, 0, 0, 0
    .long 0, 0, 0, 0, 0, 0, 0, 0, 0, 0, 0, 0, 0, 0, 0, 0
    .long 1, 24, 24, 8192, 2048, 2304, 8388608, 524288, 32768, 8, 23101440, 131072, 0, 0, 218104608, 4
    .long 1, 32, 32, 8192, 2048, 2304, 8388608, 1572864, 32768, 8, 44072960, 131072, 0, 0, 218105120, 4
    .long 1, 16, 16, 8192, 2048, 2304, 8388608, 2621440, 32768, 8, 14712832, 131072, 0, 0, 218105632, 4
    .long 2, 64, 72, 7168, 2304, 2304, 7340032, 1048576, 32768, 8, 58232832, 114688, 0, 0, 218103952, 1
    .long 2, 64, 72, 7168, 1280, 1280, 7340032, 2621440, 32768, 8, 63721472, 114688, 0, 0, 218104128, 1
    .long 1, 80, 80, 2048, 1835008, 1835264, 7340032, 60059648, 114688, 7, 173539328, 32768, 218104016, 7, 218106560, 1
    .long 0, 0, 0, 0, 0, 0, 0, 0, 0, 0, 0, 0, 0, 0, 0, 0
    .long 0, 0, 0, 0, 0, 0, 0, 0, 0, 0, 0, 0, 0, 0, 0, 0
    .long 0, 0, 0, 0, 0, 0, 0, 0, 0, 0, 0, 0, 0, 0, 0, 0
    .long 0, 0, 0, 0, 0, 0, 0, 0, 0, 0, 0, 0, 0, 0, 0, 0
    .long 1, 24, 24, 8192, 4096, 4352, 8388608, 524288, 32768, 8, 23134208, 131072, 0, 0, 218104640, 4
    .long 1, 32, 32, 8192, 4096, 4352, 8388608, 1572864, 32768, 8, 44105728, 131072, 0, 0, 218105152, 4
    .long 1, 16, 16, 8192, 4096, 4352, 8388608, 2621440, 32768, 8, 14745600, 131072, 0, 0, 218105664, 4
    .long 2, 64, 72, 7168, 2560, 2560, 7340032, 1048576, 32768, 8, 58236928, 114688, 0, 0, 218103952, 1
    .long 2, 64, 72, 7168, 1536, 1536, 7340032, 2621440, 32768, 8, 63725568, 114688, 0, 0, 218104128, 1
    .long 1, 80, 80, 2048, 3670016, 3670272, 7340032, 60088320, 114688, 7, 177733632, 32768, 218104032, 7, 218106560, 1
    .long 0, 0, 0, 0, 0, 0, 0, 0, 0, 0, 0, 0, 0, 0, 0, 0
    .long 0, 0, 0, 0, 0, 0, 0, 0, 0, 0, 0, 0, 0, 0, 0, 0
    .long 0, 0, 0, 0, 0, 0, 0, 0, 0, 0, 0, 0, 0, 0, 0, 0
    .long 0, 0, 0, 0, 0, 0, 0, 0, 0, 0, 0, 0, 0, 0, 0, 0
    .long 1, 24, 24, 8192, 6144, 6400, 8388608, 524288, 32768, 8, 23166976, 131072, 0, 0, 218104672, 4
    .long 1, 32, 32, 8192, 6144, 6400, 8388608, 1572864, 32768, 8, 44138496, 131072, 0, 0, 218105184, 4
    .long 1, 16, 16, 8192, 6144, 6400, 8388608, 2621440, 32768, 8, 14778368, 131072, 0, 0, 218105696, 4
    .long 2, 64, 72, 7168, 2816, 2816, 7340032, 1048576, 32768, 8, 58241024, 114688, 0, 0, 218103952, 1
    .long 2, 64, 72, 7168, 1792, 1792, 7340032, 2621440, 32768, 8, 63729664, 114688, 0, 0, 218104144, 1
    .long 1, 80, 80, 2048, 5505024, 5505280, 7340032, 60116992, 114688, 7, 181927936, 32768, 218104048, 7, 218106560, 1
    .long 0, 0, 0, 0, 0, 0, 0, 0, 0, 0, 0, 0, 0, 0, 0, 0
    .long 0, 0, 0, 0, 0, 0, 0, 0, 0, 0, 0, 0, 0, 0, 0, 0
    .long 0, 0, 0, 0, 0, 0, 0, 0, 0, 0, 0, 0, 0, 0, 0, 0
    .long 0, 0, 0, 0, 0, 0, 0, 0, 0, 0, 0, 0, 0, 0, 0, 0
    .long 1, 24, 24, 8192, 512, 768, 8388608, 524288, 32768, 8, 23076864, 131072, 0, 0, 218104576, 4
    .long 1, 32, 32, 8192, 512, 768, 8388608, 1572864, 32768, 8, 44048384, 131072, 0, 0, 218105088, 4
    .long 1, 16, 16, 8192, 512, 768, 8388608, 2621440, 32768, 8, 14688256, 131072, 0, 0, 218105600, 4
    .long 2, 64, 72, 7168, 3072, 3072, 7340032, 1048576, 32768, 8, 58245120, 114688, 0, 0, 218103952, 1
    .long 2, 64, 72, 7168, 2048, 2048, 7340032, 2621440, 32768, 8, 63733760, 114688, 0, 0, 218104144, 1
    .long 1, 80, 80, 2048, 512, 768, 7340032, 60030976, 114688, 7, 169353216, 32768, 218104000, 7, 218106560, 1
    .long 0, 0, 0, 0, 0, 0, 0, 0, 0, 0, 0, 0, 0, 0, 0, 0
    .long 0, 0, 0, 0, 0, 0, 0, 0, 0, 0, 0, 0, 0, 0, 0, 0
    .long 0, 0, 0, 0, 0, 0, 0, 0, 0, 0, 0, 0, 0, 0, 0, 0
    .long 0, 0, 0, 0, 0, 0, 0, 0, 0, 0, 0, 0, 0, 0, 0, 0
    .long 1, 24, 24, 8192, 2560, 2816, 8388608, 524288, 32768, 8, 23109632, 131072, 0, 0, 218104608, 4
    .long 1, 32, 32, 8192, 2560, 2816, 8388608, 1572864, 32768, 8, 44081152, 131072, 0, 0, 218105120, 4
    .long 1, 16, 16, 8192, 2560, 2816, 8388608, 2621440, 32768, 8, 14721024, 131072, 0, 0, 218105632, 4
    .long 2, 64, 72, 7168, 3328, 3328, 7340032, 1048576, 32768, 8, 58249216, 114688, 0, 0, 218103952, 1
    .long 2, 64, 72, 7168, 2304, 2304, 7340032, 2621440, 32768, 8, 63737856, 114688, 0, 0, 218104144, 1
    .long 1, 80, 80, 2048, 1835520, 1835776, 7340032, 60059648, 114688, 7, 173547520, 32768, 218104016, 7, 218106560, 1
    .long 0, 0, 0, 0, 0, 0, 0, 0, 0, 0, 0, 0, 0, 0, 0, 0
    .long 0, 0, 0, 0, 0, 0, 0, 0, 0, 0, 0, 0, 0, 0, 0, 0
    .long 0, 0, 0, 0, 0, 0, 0, 0, 0, 0, 0, 0, 0, 0, 0, 0
    .long 0, 0, 0, 0, 0, 0, 0, 0, 0, 0, 0, 0, 0, 0, 0, 0
    .long 1, 24, 24, 8192, 4608, 4864, 8388608, 524288, 32768, 8, 23142400, 131072, 0, 0, 218104640, 4
    .long 1, 32, 32, 8192, 4608, 4864, 8388608, 1572864, 32768, 8, 44113920, 131072, 0, 0, 218105152, 4
    .long 1, 16, 16, 8192, 4608, 4864, 8388608, 2621440, 32768, 8, 14753792, 131072, 0, 0, 218105664, 4
    .long 2, 64, 72, 7168, 3584, 3584, 7340032, 1048576, 32768, 8, 58253312, 114688, 0, 0, 218103968, 1
    .long 2, 64, 72, 7168, 2560, 2560, 7340032, 2621440, 32768, 8, 63741952, 114688, 0, 0, 218104144, 1
    .long 1, 80, 80, 2048, 3670528, 3670784, 7340032, 60088320, 114688, 7, 177741824, 32768, 218104032, 7, 218106560, 1
    .long 0, 0, 0, 0, 0, 0, 0, 0, 0, 0, 0, 0, 0, 0, 0, 0
    .long 0, 0, 0, 0, 0, 0, 0, 0, 0, 0, 0, 0, 0, 0, 0, 0
    .long 0, 0, 0, 0, 0, 0, 0, 0, 0, 0, 0, 0, 0, 0, 0, 0
    .long 0, 0, 0, 0, 0, 0, 0, 0, 0, 0, 0, 0, 0, 0, 0, 0
    .long 1, 24, 24, 8192, 6656, 6912, 8388608, 524288, 32768, 8, 23175168, 131072, 0, 0, 218104672, 4
    .long 1, 32, 32, 8192, 6656, 6912, 8388608, 1572864, 32768, 8, 44146688, 131072, 0, 0, 218105184, 4
    .long 1, 16, 16, 8192, 6656, 6912, 8388608, 2621440, 32768, 8, 14786560, 131072, 0, 0, 218105696, 4
    .long 2, 64, 72, 7168, 3840, 3840, 7340032, 1048576, 32768, 8, 58257408, 114688, 0, 0, 218103968, 1
    .long 2, 64, 72, 7168, 2816, 2816, 7340032, 2621440, 32768, 8, 63746048, 114688, 0, 0, 218104144, 1
    .long 1, 80, 80, 2048, 5505536, 5505792, 7340032, 60116992, 114688, 7, 181936128, 32768, 218104048, 7, 218106560, 1
    .long 0, 0, 0, 0, 0, 0, 0, 0, 0, 0, 0, 0, 0, 0, 0, 0
    .long 0, 0, 0, 0, 0, 0, 0, 0, 0, 0, 0, 0, 0, 0, 0, 0
    .long 0, 0, 0, 0, 0, 0, 0, 0, 0, 0, 0, 0, 0, 0, 0, 0
    .long 0, 0, 0, 0, 0, 0, 0, 0, 0, 0, 0, 0, 0, 0, 0, 0
    .long 1, 24, 24, 8192, 1024, 1280, 8388608, 524288, 32768, 8, 23085056, 131072, 0, 0, 218104592, 4
    .long 1, 24, 24, 8192, 1024, 1280, 8388608, 2097152, 32768, 8, 29376512, 131072, 0, 0, 218105360, 4
    .long 2, 64, 72, 7168, 0, 0, 7340032, 1048576, 32768, 8, 58195968, 114688, 0, 0, 218103936, 1
    .long 2, 64, 72, 7168, 6144, 6144, 7340032, 2097152, 32768, 8, 61964288, 114688, 0, 0, 218104112, 1
    .long 2, 64, 72, 7168, 5120, 5120, 7340032, 3670016, 32768, 8, 67452928, 114688, 0, 0, 218104288, 1
    .long 1, 80, 80, 2048, 3670016, 3670272, 7340032, 67428352, 114688, 7, 179830784, 32768, 218104288, 7, 218106816, 1
    .long 0, 0, 0, 0, 0, 0, 0, 0, 0, 0, 0, 0, 0, 0, 0, 0
    .long 0, 0, 0, 0, 0, 0, 0, 0, 0, 0, 0, 0, 0, 0, 0, 0
    .long 0, 0, 0, 0, 0, 0, 0, 0, 0, 0, 0, 0, 0, 0, 0, 0
    .long 0, 0, 0, 0, 0, 0, 0, 0, 0, 0, 0, 0, 0, 0, 0, 0
    .long 1, 24, 24, 8192, 3072, 3328, 8388608, 524288, 32768, 8, 23117824, 131072, 0, 0, 218104624, 4
    .long 1, 24, 24, 8192, 3072, 3328, 8388608, 2097152, 32768, 8, 29409280, 131072, 0, 0, 218105392, 4
    .long 2, 64, 72, 7168, 256, 256, 7340032, 1048576, 32768, 8, 58200064, 114688, 0, 0, 218103936, 1
    .long 2, 64, 72, 7168, 6400, 6400, 7340032, 2097152, 32768, 8, 61968384, 114688, 0, 0, 218104112, 1
    .long 2, 64, 72, 7168, 5376, 5376, 7340032, 3670016, 32768, 8, 67457024, 114688, 0, 0, 218104304, 1
    .long 1, 80, 80, 2048, 3670528, 3670784, 7340032, 67428352, 114688, 7, 179838976, 32768, 218104288, 7, 218106816, 1
    .long 0, 0, 0, 0, 0, 0, 0, 0, 0, 0, 0, 0, 0, 0, 0, 0
    .long 0, 0, 0, 0, 0, 0, 0, 0, 0, 0, 0, 0, 0, 0, 0, 0
    .long 0, 0, 0, 0, 0, 0, 0, 0, 0, 0, 0, 0, 0, 0, 0, 0
    .long 0, 0, 0, 0, 0, 0, 0, 0, 0, 0, 0, 0, 0, 0, 0, 0
    .long 1, 24, 24, 8192, 5120, 5376, 8388608, 524288, 32768, 8, 23150592, 131072, 0, 0, 218104656, 4
    .long 1, 24, 24, 8192, 5120, 5376, 8388608, 2097152, 32768, 8, 29442048, 131072, 0, 0, 218105424, 4
    .long 2, 64, 72, 7168, 512, 512, 7340032, 1048576, 32768, 8, 58204160, 114688, 0, 0, 218103936, 1
    .long 2, 64, 72, 7168, 6656, 6656, 7340032, 2097152, 32768, 8, 61972480, 114688, 0, 0, 218104112, 1
    .long 2, 64, 72, 7168, 5632, 5632, 7340032, 3670016, 32768, 8, 67461120, 114688, 0, 0, 218104304, 1
    .long 1, 80, 80, 2048, 3671040, 3671296, 7340032, 67428352, 114688, 7, 179847168, 32768, 218104288, 7, 218106816, 1
    .long 0, 0, 0, 0, 0, 0, 0, 0, 0, 0, 0, 0, 0, 0, 0, 0
    .long 0, 0, 0, 0, 0, 0, 0, 0, 0, 0, 0, 0, 0, 0, 0, 0
    .long 0, 0, 0, 0, 0, 0, 0, 0, 0, 0, 0, 0, 0, 0, 0, 0
    .long 0, 0, 0, 0, 0, 0, 0, 0, 0, 0, 0, 0, 0, 0, 0, 0
    .long 1, 24, 24, 8192, 7168, 7424, 8388608, 524288, 32768, 8, 23183360, 131072, 0, 0, 218104688, 4
    .long 1, 24, 24, 8192, 7168, 7424, 8388608, 2097152, 32768, 8, 29474816, 131072, 0, 0, 218105456, 4
    .long 2, 64, 72, 7168, 768, 768, 7340032, 1048576, 32768, 8, 58208256, 114688, 0, 0, 218103936, 1
    .long 2, 64, 72, 7168, 6912, 6912, 7340032, 2097152, 32768, 8, 61976576, 114688, 0, 0, 218104112, 1
    .long 2, 64, 72, 7168, 5888, 5888, 7340032, 3670016, 32768, 8, 67465216, 114688, 0, 0, 218104304, 1
    .long 1, 80, 80, 2048, 5505024, 5505280, 7340032, 67457024, 114688, 7, 184025088, 32768, 218104304, 7, 218106816, 1
    .long 0, 0, 0, 0, 0, 0, 0, 0, 0, 0, 0, 0, 0, 0, 0, 0
    .long 0, 0, 0, 0, 0, 0, 0, 0, 0, 0, 0, 0, 0, 0, 0, 0
    .long 0, 0, 0, 0, 0, 0, 0, 0, 0, 0, 0, 0, 0, 0, 0, 0
    .long 0, 0, 0, 0, 0, 0, 0, 0, 0, 0, 0, 0, 0, 0, 0, 0
    .long 1, 24, 24, 8192, 1536, 1792, 8388608, 524288, 32768, 8, 23093248, 131072, 0, 0, 218104592, 4
    .long 1, 24, 24, 8192, 1536, 1792, 8388608, 2097152, 32768, 8, 29384704, 131072, 0, 0, 218105360, 4
    .long 2, 64, 72, 7168, 1024, 1024, 7340032, 1048576, 32768, 8, 58212352, 114688, 0, 0, 218103936, 1
    .long 2, 64, 72, 7168, 0, 0, 7340032, 2621440, 32768, 8, 63700992, 114688, 0, 0, 218104128, 1
    .long 2, 64, 72, 7168, 6144, 6144, 7340032, 3670016, 32768, 8, 67469312, 114688, 0, 0, 218104304, 1
    .long 1, 80, 80, 2048, 3671552, 3671808, 7340032, 67428352, 114688, 7, 179855360, 32768, 218104288, 7, 218106816, 1
    .long 0, 0, 0, 0, 0, 0, 0, 0, 0, 0, 0, 0, 0, 0, 0, 0
    .long 0, 0, 0, 0, 0, 0, 0, 0, 0, 0, 0, 0, 0, 0, 0, 0
    .long 0, 0, 0, 0, 0, 0, 0, 0, 0, 0, 0, 0, 0, 0, 0, 0
    .long 0, 0, 0, 0, 0, 0, 0, 0, 0, 0, 0, 0, 0, 0, 0, 0
    .long 1, 24, 24, 8192, 3584, 3840, 8388608, 524288, 32768, 8, 23126016, 131072, 0, 0, 218104624, 4
    .long 1, 24, 24, 8192, 3584, 3840, 8388608, 2097152, 32768, 8, 29417472, 131072, 0, 0, 218105392, 4
    .long 2, 64, 72, 7168, 1280, 1280, 7340032, 1048576, 32768, 8, 58216448, 114688, 0, 0, 218103936, 1
    .long 2, 64, 72, 7168, 256, 256, 7340032, 2621440, 32768, 8, 63705088, 114688, 0, 0, 218104128, 1
    .long 2, 64, 72, 7168, 6400, 6400, 7340032, 3670016, 32768, 8, 67473408, 114688, 0, 0, 218104304, 1
    .long 1, 80, 80, 2048, 5505536, 5505792, 7340032, 67457024, 114688, 7, 184033280, 32768, 218104304, 7, 218106816, 1
    .long 0, 0, 0, 0, 0, 0, 0, 0, 0, 0, 0, 0, 0, 0, 0, 0
    .long 0, 0, 0, 0, 0, 0, 0, 0, 0, 0, 0, 0, 0, 0, 0, 0
    .long 0, 0, 0, 0, 0, 0, 0, 0, 0, 0, 0, 0, 0, 0, 0, 0
    .long 0, 0, 0, 0, 0, 0, 0, 0, 0, 0, 0, 0, 0, 0, 0, 0
    .long 1, 24, 24, 8192, 5632, 5888, 8388608, 524288, 32768, 8, 23158784, 131072, 0, 0, 218104656, 4
    .long 1, 24, 24, 8192, 5632, 5888, 8388608, 2097152, 32768, 8, 29450240, 131072, 0, 0, 218105424, 4
    .long 2, 64, 72, 7168, 1536, 1536, 7340032, 1048576, 32768, 8, 58220544, 114688, 0, 0, 218103936, 1
    .long 2, 64, 72, 7168, 512, 512, 7340032, 2621440, 32768, 8, 63709184, 114688, 0, 0, 218104128, 1
    .long 2, 64, 72, 7168, 6656, 6656, 7340032, 3670016, 32768, 8, 67477504, 114688, 0, 0, 218104304, 1
    .long 1, 80, 80, 2048, 5506048, 5506304, 7340032, 67457024, 114688, 7, 184041472, 32768, 218104304, 7, 218106816, 1
    .long 0, 0, 0, 0, 0, 0, 0, 0, 0, 0, 0, 0, 0, 0, 0, 0
    .long 0, 0, 0, 0, 0, 0, 0, 0, 0, 0, 0, 0, 0, 0, 0, 0
    .long 0, 0, 0, 0, 0, 0, 0, 0, 0, 0, 0, 0, 0, 0, 0, 0
    .long 0, 0, 0, 0, 0, 0, 0, 0, 0, 0, 0, 0, 0, 0, 0, 0
    .long 1, 24, 24, 8192, 7680, 7936, 8388608, 524288, 32768, 8, 23191552, 131072, 0, 0, 218104688, 4
    .long 1, 24, 24, 8192, 7680, 7936, 8388608, 2097152, 32768, 8, 29483008, 131072, 0, 0, 218105456, 4
    .long 2, 64, 72, 7168, 1792, 1792, 7340032, 1048576, 32768, 8, 58224640, 114688, 0, 0, 218103952, 1
    .long 2, 64, 72, 7168, 768, 768, 7340032, 2621440, 32768, 8, 63713280, 114688, 0, 0, 218104128, 1
    .long 2, 64, 72, 7168, 6912, 6912, 7340032, 3670016, 32768, 8, 67481600, 114688, 0, 0, 218104304, 1
    .long 1, 80, 80, 2048, 5506560, 5506816, 7340032, 67457024, 114688, 7, 184049664, 32768, 218104304, 7, 218106816, 1
    .long 0, 0, 0, 0, 0, 0, 0, 0, 0, 0, 0, 0, 0, 0, 0, 0
    .long 0, 0, 0, 0, 0, 0, 0, 0, 0, 0, 0, 0, 0, 0, 0, 0
    .long 0, 0, 0, 0, 0, 0, 0, 0, 0, 0, 0, 0, 0, 0, 0, 0
    .long 0, 0, 0, 0, 0, 0, 0, 0, 0, 0, 0, 0, 0, 0, 0, 0
.p2align 6
.amdhsa_kernel recurrent_scan__memory_aug_recurrent_mem_tr__glu_gated_glu__prompt_kernel
  .amdhsa_next_free_vgpr 256
  .amdhsa_next_free_sgpr 102
  .amdhsa_accum_offset 256
  .amdhsa_group_segment_fixed_size 0
  .amdhsa_kernarg_size 112
  .amdhsa_user_sgpr_count 2
  .amdhsa_user_sgpr_kernarg_segment_ptr 1
  .amdhsa_system_sgpr_workgroup_id_x 1
  .amdhsa_float_denorm_mode_32 3
.end_amdhsa_kernel
```

```asm
; @launch grid=(256,1,1) block=(512,1,1) lds=163840
.amdgcn_target "amdgcn-amd-amdhsa--gfx950"
.text
.globl recurrent_scan__memory_aug_recurrent_mem_tr__glu_gated_glu__prompt_kernel
.p2align 8
.type recurrent_scan__memory_aug_recurrent_mem_tr__glu_gated_glu__prompt_kernel,@function
recurrent_scan__memory_aug_recurrent_mem_tr__glu_gated_glu__prompt_kernel:
    s_cmp_ge_u32 s2, 256
    s_cbranch_scc1 k_exit
    s_mov_b32 s99, s2
    s_load_dwordx2 s[4:5], s[0:1], 104
    s_load_dwordx2 s[64:65], s[0:1], 96
    v_lshrrev_b32 v2, 6, v0
    s_mov_b32 s6, 268435456
    s_mov_b32 s7, 131072
    s_mov_b32 s66, 256
    s_mov_b32 s67, 131072
    v_readfirstlane_b32 s3, v2
    s_lshr_b32 s12, s2, 3
    s_and_b32 s13, s2, 3
    s_waitcnt lgkmcnt(0)
    s_bitcmp0_b32 s2, 2
    s_cbranch_scc1 chain_map
    s_lshl_b32 s63, s12, 2
    s_add_u32 s63, s63, s13
    s_mov_b32 s29, s63
    v_and_b32 v20, 63, v0
    v_lshlrev_b32 v1, 4, v20
    v_add_u32 v19, 0x1000, v1
    v_lshrrev_b32 v4, 4, v20
    v_mov_b32 v17, 0
    v_mov_b32 v18, 1
    s_lshr_b32 s26, s3, 2
    s_and_b32 s27, s3, 3
    s_lshl_b32 s21, s3, 11
    s_lshl_b32 s22, s3, 10
    s_add_u32 s22, s22, 16384
    s_mov_b32 s11, 131072
    s_mov_b32 s15, 131072
    s_mov_b32 s28, 0
    v_and_b32 v21, 15, v20
    v_lshlrev_b32 v22, 2, v4
    v_xor_b32 v21, v21, v22
    s_lshr_b32 s30, s3, 1
    s_and_b32 s30, s30, 1
    v_xor_b32 v21, s30, v21
    v_lshlrev_b32 v3, 4, v21
    s_lshl_b32 s30, s26, 13
    v_add_u32 v5, s30, v1
    v_add_u32 v6, 0x10000, v5
    v_bfe_u32 v21, v20, 2, 2
    v_and_b32 v22, 3, v20
    v_and_b32 v23, 1, v4
    v_xor_b32 v24, s27, v21
    v_xor_b32 v25, v22, v23
    v_lshl_add_u32 v24, v24, 2, v25
    v_lshlrev_b32 v24, 4, v24
    v_lshl_add_u32 v25, v4, 3, v21
    v_lshl_add_u32 v24, v25, 8, v24
    v_and_b32 v22, 1, v22
    v_xor_b32 v25, 0, v23
    v_lshl_add_u32 v8, v25, 10, v24
    v_xor_b32 v25, 0, v22
    v_lshl_add_u32 v8, v25, 3, v8
    v_add_u32 v12, 0x10000, v8
    v_xor_b32 v25, 1, v23
    v_lshl_add_u32 v9, v25, 10, v24
    v_xor_b32 v25, 0, v22
    v_lshl_add_u32 v9, v25, 3, v9
    v_add_u32 v13, 0x10000, v9
    v_xor_b32 v25, 0, v23
    v_lshl_add_u32 v10, v25, 10, v24
    v_xor_b32 v25, 1, v22
    v_lshl_add_u32 v10, v25, 3, v10
    v_add_u32 v14, 0x10000, v10
    v_xor_b32 v25, 1, v23
    v_lshl_add_u32 v11, v25, 10, v24
    v_xor_b32 v25, 1, v22
    v_lshl_add_u32 v11, v25, 3, v11
    v_add_u32 v15, 0x10000, v11
    s_lshl_b32 s30, s3, 2
    s_add_u32 s30, s30, 131072
    v_mov_b32 v7, s30
    s_getpc_b64 s[24:25]
    s_add_u32 s24, s24, jobtab@rel32@lo+4
    s_addc_u32 s25, s25, jobtab@rel32@hi+12
    s_mul_i32 s30, s29, 640
    s_add_u32 s24, s24, s30
    s_addc_u32 s25, s25, 0
    s_load_dwordx16 s[32:47], s[24:25], 0
    s_add_u32 s24, s24, 64
    s_addc_u32 s25, s25, 0
    s_waitcnt lgkmcnt(0)
    s_mov_b32 s8, s4
    s_mov_b32 s9, s5
    s_mov_b32 s10, 0
    s_mov_b32 s12, s4
    s_mov_b32 s13, s5
    s_mov_b32 s14, 0
    s_load_dwordx2 s[88:89], s[0:1], 0
    s_mov_b32 s90, 4194304
    s_mov_b32 s91, 131072
    s_mov_b32 s98, 0
    v_mov_b32 v22, 0
    s_mov_b32 s70, 1
    v_and_b32 v245, 15, v0
    v_lshlrev_b32 v246, 11, v245
    v_lshl_add_u32 v246, v4, 4, v246
    s_add_u32 s71, s63, 32
    s_and_b32 s71, s71, 127
    s_lshl_b32 s72, s71, 15
    s_lshl_b32 s73, s3, 8
    s_add_u32 s72, s72, s73
    s_waitcnt lgkmcnt(0)
    buffer_load_dwordx4 v[228:231], v246, s[88:91], s72 offen offset:0
    buffer_load_dwordx4 v[232:235], v246, s[88:91], s72 offen offset:64
    buffer_load_dwordx4 v[236:239], v246, s[88:91], s72 offen offset:128
    buffer_load_dwordx4 v[240:243], v246, s[88:91], s72 offen offset:192
    s_cmp_lg_u32 s32, 6
    s_cbranch_scc1 ln_nx
    s_mov_b32 s98, 3
    s_cmp_lg_u32 s32, 6
    s_cbranch_scc1 xs_1
    s_load_dwordx2 s[8:9], s[0:1], s33
    s_load_dwordx2 s[12:13], s[0:1], s34
    s_mov_b32 s10, s38
    s_mov_b32 s14, s38
    s_cmp_ge_u32 s32, 4
    s_cselect_b32 s31, 0, 1
    s_lshl_b32 s30, s3, s31
    s_mul_i32 s30, s30, s40
    s_add_u32 s16, s39, s30
    s_cmp_eq_u32 s32, 4
    s_cselect_b32 s30, 1024, s40
    s_cselect_b32 s31, 6, 5
    s_lshl_b32 s62, 32, s31
    s_add_u32 s17, s16, s30
    s_lshl_b32 s30, s3, 2
    s_mul_i32 s30, s30, s35
    s_add_u32 s18, s36, s30
    s_add_u32 s19, s37, s30
    s_lshl_b32 s20, s35, s31
    v_mul_u32_u24 v2, s35, v4
    v_add_u32 v2, v2, v3
    s_waitcnt lgkmcnt(0)
    s_lshl_b32 s16, s3, 15
    s_add_u32 s16, s16, s39
    s_add_u32 s92, s16, 2048
    s_lshl_b32 s93, s35, 10
    s_lshr_b32 s94, s63, 2
    s_mul_i32 s94, s94, 1
    s_and_b32 s94, s94, 15
    s_lshl_b32 s95, s94, 7
    s_add_u32 s16, s16, s95
    s_lshl_b32 s95, s35, 6
    s_mul_i32 s94, s95, s94
    s_add_u32 s95, s18, s93
    s_add_u32 s18, s18, s94
    s_add_u32 s19, s19, s94
    s_add_u32 s17, s16, 16384
    s_mov_b32 s62, 128
    s_lshl_b32 s20, s35, 6
    v_lshrrev_b32 v21, 7, v1
    v_bfe_u32 v23, v1, 4, 3
    v_xor_b32 v23, v21, v23
    v_lshlrev_b32 v23, 4, v23
    v_lshl_add_u32 v23, v21, 11, v23
    s_add_u32 m0, s21, 0
    s_nop 0
    buffer_load_dwordx4 v23, s[88:91], s16 offen lds
    s_add_u32 s16, s16, s62
    s_add_u32 m0, s21, 1024
    s_nop 0
    buffer_load_dwordx4 v23, s[88:91], s17 offen lds
    s_add_u32 s17, s17, s62
    s_cmp_ge_u32 s16, s92
    s_cselect_b32 s94, 2048, 0
    s_sub_u32 s16, s16, s94
    s_sub_u32 s17, s17, s94
    s_add_u32 m0, s22, 0
    s_nop 0
    buffer_load_dwordx4 v2, s[8:11], s18 offen lds
    s_add_u32 s18, s18, s20
    s_add_u32 m0, s22, 8192
    s_nop 0
    buffer_load_dwordx4 v2, s[12:15], s19 offen lds
    s_add_u32 s19, s19, s20
    s_cmp_ge_u32 s18, s95
    s_cselect_b32 s94, s93, 0
    s_sub_u32 s18, s18, s94
    s_sub_u32 s19, s19, s94
    s_add_u32 m0, s21, 32768
    s_nop 0
    buffer_load_dwordx4 v23, s[88:91], s16 offen lds
    s_add_u32 s16, s16, s62
    s_add_u32 m0, s21, 33792
    s_nop 0
    buffer_load_dwordx4 v23, s[88:91], s17 offen lds
    s_add_u32 s17, s17, s62
    s_cmp_ge_u32 s16, s92
    s_cselect_b32 s94, 2048, 0
    s_sub_u32 s16, s16, s94
    s_sub_u32 s17, s17, s94
    s_add_u32 m0, s22, 32768
    s_nop 0
    buffer_load_dwordx4 v2, s[8:11], s18 offen lds
    s_add_u32 s18, s18, s20
    s_add_u32 m0, s22, 40960
    s_nop 0
    buffer_load_dwordx4 v2, s[12:15], s19 offen lds
    s_add_u32 s19, s19, s20
    s_cmp_ge_u32 s18, s95
    s_cselect_b32 s94, s93, 0
    s_sub_u32 s18, s18, s94
    s_sub_u32 s19, s19, s94
    s_add_u32 m0, s21, 65536
    s_nop 0
    buffer_load_dwordx4 v23, s[88:91], s16 offen lds
    s_add_u32 s16, s16, s62
    s_add_u32 m0, s21, 66560
    s_nop 0
    buffer_load_dwordx4 v23, s[88:91], s17 offen lds
    s_add_u32 s17, s17, s62
    s_cmp_ge_u32 s16, s92
    s_cselect_b32 s94, 2048, 0
    s_sub_u32 s16, s16, s94
    s_sub_u32 s17, s17, s94
    s_add_u32 m0, s22, 65536
    s_nop 0
    buffer_load_dwordx4 v2, s[8:11], s18 offen lds
    s_add_u32 s18, s18, s20
    s_add_u32 m0, s22, 73728
    s_nop 0
    buffer_load_dwordx4 v2, s[12:15], s19 offen lds
    s_add_u32 s19, s19, s20
    s_cmp_ge_u32 s18, s95
    s_cselect_b32 s94, s93, 0
    s_sub_u32 s18, s18, s94
    s_sub_u32 s19, s19, s94
    s_add_u32 m0, s21, 98304
    s_nop 0
    buffer_load_dwordx4 v23, s[88:91], s16 offen lds
    s_add_u32 s16, s16, s62
    s_add_u32 m0, s21, 99328
    s_nop 0
    buffer_load_dwordx4 v23, s[88:91], s17 offen lds
    s_add_u32 s17, s17, s62
    s_cmp_ge_u32 s16, s92
    s_cselect_b32 s94, 2048, 0
    s_sub_u32 s16, s16, s94
    s_sub_u32 s17, s17, s94
    s_add_u32 m0, s22, 98304
    s_nop 0
    buffer_load_dwordx4 v2, s[8:11], s18 offen lds
    s_add_u32 s18, s18, s20
    s_add_u32 m0, s22, 106496
    s_nop 0
    buffer_load_dwordx4 v2, s[12:15], s19 offen lds
    s_add_u32 s19, s19, s20
    s_cmp_ge_u32 s18, s95
    s_cselect_b32 s94, s93, 0
    s_sub_u32 s18, s18, s94
    s_sub_u32 s19, s19, s94
    v_and_b32 v21, 1, v4
    v_lshlrev_b32 v21, 10, v21
    v_xor_b32 v8, v21, v8
    v_xor_b32 v9, v21, v9
    v_xor_b32 v10, v21, v10
    v_xor_b32 v11, v21, v11
    v_xor_b32 v12, v21, v12
    v_xor_b32 v13, v21, v13
    v_xor_b32 v14, v21, v14
    v_xor_b32 v15, v21, v15
xs_1:
    s_branch w_adopt
ln_nx:
    s_lshl_b32 s73, s71, 9
    s_add_u32 s73, s73, 218103808
    v_lshlrev_b32 v252, 2, v0
    s_cmp_ge_u32 s71, 32
    s_cbranch_scc1 ln_nz
    s_cmp_ge_u32 s3, 2
    s_cbranch_scc1 ln_nz
    buffer_store_dword v17, v252, s[4:7], s73 offen sc1
ln_nz:
    s_waitcnt vmcnt(0)
ln_entry:
    v_lshlrev_b32 v247, 5, v245
    v_add_u32 v247, 135168, v247
    s_lshl_b32 s74, s3, 2
    v_add_u32 v248, s74, v247
    s_lshl_b32 s75, s71, 15
    s_lshl_b32 s76, s3, 12
    s_add_u32 s75, s75, s76
    v_and_b32 v249, 1, v4
    v_cmp_eq_u32 s[80:81], 1, v249
    v_lshlrev_b32 v56, 16, v228
    v_and_b32 v57, 0xffff0000, v228
    v_lshlrev_b32 v58, 16, v229
    v_and_b32 v59, 0xffff0000, v229
    v_lshlrev_b32 v60, 16, v230
    v_and_b32 v61, 0xffff0000, v230
    v_lshlrev_b32 v62, 16, v231
    v_and_b32 v63, 0xffff0000, v231
    v_lshlrev_b32 v64, 16, v232
    v_and_b32 v65, 0xffff0000, v232
    v_lshlrev_b32 v66, 16, v233
    v_and_b32 v67, 0xffff0000, v233
    v_lshlrev_b32 v68, 16, v234
    v_and_b32 v69, 0xffff0000, v234
    v_lshlrev_b32 v70, 16, v235
    v_and_b32 v71, 0xffff0000, v235
    v_lshlrev_b32 v72, 16, v236
    v_and_b32 v73, 0xffff0000, v236
    v_lshlrev_b32 v74, 16, v237
    v_and_b32 v75, 0xffff0000, v237
    v_lshlrev_b32 v76, 16, v238
    v_and_b32 v77, 0xffff0000, v238
    v_lshlrev_b32 v78, 16, v239
    v_and_b32 v79, 0xffff0000, v239
    v_lshlrev_b32 v80, 16, v240
    v_and_b32 v81, 0xffff0000, v240
    v_lshlrev_b32 v82, 16, v241
    v_and_b32 v83, 0xffff0000, v241
    v_lshlrev_b32 v84, 16, v242
    v_and_b32 v85, 0xffff0000, v242
    v_lshlrev_b32 v86, 16, v243
    v_and_b32 v87, 0xffff0000, v243
    v_add_f32 v120, v56, v72
    v_add_f32 v121, v57, v73
    v_add_f32 v122, v58, v74
    v_add_f32 v123, v59, v75
    v_add_f32 v124, v60, v76
    v_add_f32 v125, v61, v77
    v_add_f32 v126, v62, v78
    v_add_f32 v127, v63, v79
    v_add_f32 v128, v64, v80
    v_add_f32 v129, v65, v81
    v_add_f32 v130, v66, v82
    v_add_f32 v131, v67, v83
    v_add_f32 v132, v68, v84
    v_add_f32 v133, v69, v85
    v_add_f32 v134, v70, v86
    v_add_f32 v135, v71, v87
    v_add_f32 v120, v120, v128
    v_add_f32 v121, v121, v129
    v_add_f32 v122, v122, v130
    v_add_f32 v123, v123, v131
    v_add_f32 v124, v124, v132
    v_add_f32 v125, v125, v133
    v_add_f32 v126, v126, v134
    v_add_f32 v127, v127, v135
    v_add_f32 v120, v120, v124
    v_add_f32 v121, v121, v125
    v_add_f32 v122, v122, v126
    v_add_f32 v123, v123, v127
    v_add_f32 v120, v120, v122
    v_add_f32 v121, v121, v123
    v_add_f32 v120, v120, v121
    v_mov_b32 v121, v120
    s_nop 1
    v_permlane16_swap_b32 v121, v120
    v_add_f32 v120, v120, v121
    v_mov_b32 v121, v120
    s_nop 1
    v_permlane32_swap_b32 v121, v120
    v_add_f32 v120, v120, v121
    ds_write_b32 v248, v120 offset:0
    s_waitcnt lgkmcnt(0)
    s_barrier
    ds_read_b128 v[120:123], v247 offset:0
    ds_read_b128 v[124:127], v247 offset:16
    s_waitcnt lgkmcnt(0)
    v_add_f32 v120, v120, v124
    v_add_f32 v121, v121, v125
    v_add_f32 v122, v122, v126
    v_add_f32 v123, v123, v127
    v_add_f32 v120, v120, v122
    v_add_f32 v121, v121, v123
    v_add_f32 v120, v120, v121
    v_mul_f32 v250, 0x3a800000, v120
    v_sub_f32 v152, v56, v250
    v_sub_f32 v153, v57, v250
    v_sub_f32 v154, v58, v250
    v_sub_f32 v155, v59, v250
    v_sub_f32 v156, v60, v250
    v_sub_f32 v157, v61, v250
    v_sub_f32 v158, v62, v250
    v_sub_f32 v159, v63, v250
    v_sub_f32 v160, v64, v250
    v_sub_f32 v161, v65, v250
    v_sub_f32 v162, v66, v250
    v_sub_f32 v163, v67, v250
    v_sub_f32 v164, v68, v250
    v_sub_f32 v165, v69, v250
    v_sub_f32 v166, v70, v250
    v_sub_f32 v167, v71, v250
    v_sub_f32 v168, v72, v250
    v_sub_f32 v169, v73, v250
    v_sub_f32 v170, v74, v250
    v_sub_f32 v171, v75, v250
    v_sub_f32 v172, v76, v250
    v_sub_f32 v173, v77, v250
    v_sub_f32 v174, v78, v250
    v_sub_f32 v175, v79, v250
    v_sub_f32 v176, v80, v250
    v_sub_f32 v177, v81, v250
    v_sub_f32 v178, v82, v250
    v_sub_f32 v179, v83, v250
    v_sub_f32 v180, v84, v250
    v_sub_f32 v181, v85, v250
    v_sub_f32 v182, v86, v250
    v_sub_f32 v183, v87, v250
    v_mul_f32 v120, v152, v152
    v_fmac_f32 v120, v168, v168
    v_mul_f32 v121, v153, v153
    v_fmac_f32 v121, v169, v169
    v_mul_f32 v122, v154, v154
    v_fmac_f32 v122, v170, v170
    v_mul_f32 v123, v155, v155
    v_fmac_f32 v123, v171, v171
    v_mul_f32 v124, v156, v156
    v_fmac_f32 v124, v172, v172
    v_mul_f32 v125, v157, v157
    v_fmac_f32 v125, v173, v173
    v_mul_f32 v126, v158, v158
    v_fmac_f32 v126, v174, v174
    v_mul_f32 v127, v159, v159
    v_fmac_f32 v127, v175, v175
    v_mul_f32 v128, v160, v160
    v_fmac_f32 v128, v176, v176
    v_mul_f32 v129, v161, v161
    v_fmac_f32 v129, v177, v177
    v_mul_f32 v130, v162, v162
    v_fmac_f32 v130, v178, v178
    v_mul_f32 v131, v163, v163
    v_fmac_f32 v131, v179, v179
    v_mul_f32 v132, v164, v164
    v_fmac_f32 v132, v180, v180
    v_mul_f32 v133, v165, v165
    v_fmac_f32 v133, v181, v181
    v_mul_f32 v134, v166, v166
    v_fmac_f32 v134, v182, v182
    v_mul_f32 v135, v167, v167
    v_fmac_f32 v135, v183, v183
    v_add_f32 v120, v120, v128
    v_add_f32 v121, v121, v129
    v_add_f32 v122, v122, v130
    v_add_f32 v123, v123, v131
    v_add_f32 v124, v124, v132
    v_add_f32 v125, v125, v133
    v_add_f32 v126, v126, v134
    v_add_f32 v127, v127, v135
    v_add_f32 v120, v120, v124
    v_add_f32 v121, v121, v125
    v_add_f32 v122, v122, v126
    v_add_f32 v123, v123, v127
    v_add_f32 v120, v120, v122
    v_add_f32 v121, v121, v123
    v_add_f32 v120, v120, v121
    v_mov_b32 v121, v120
    s_nop 1
    v_permlane16_swap_b32 v121, v120
    v_add_f32 v120, v120, v121
    v_mov_b32 v121, v120
    s_nop 1
    v_permlane32_swap_b32 v121, v120
    v_add_f32 v120, v120, v121
    ds_write_b32 v248, v120 offset:512
    s_waitcnt lgkmcnt(0)
    s_barrier
    ds_read_b128 v[120:123], v247 offset:512
    ds_read_b128 v[124:127], v247 offset:528
    s_waitcnt lgkmcnt(0)
    v_add_f32 v120, v120, v124
    v_add_f32 v121, v121, v125
    v_add_f32 v122, v122, v126
    v_add_f32 v123, v123, v127
    v_add_f32 v120, v120, v122
    v_add_f32 v121, v121, v123
    v_add_f32 v120, v120, v121
    v_mul_f32 v251, 0x3a800000, v120
    v_cvt_pk_bf16_f32 v250, v250, v250
    v_lshlrev_b32 v250, 16, v250
    v_cvt_pk_bf16_f32 v251, v251, v251
    v_lshlrev_b32 v251, 16, v251
    v_add_f32 v251, 0x3727c5ac, v251
    v_cvt_pk_bf16_f32 v251, v251, v251
    v_lshlrev_b32 v251, 16, v251
    v_sqrt_f32 v251, v251
    s_nop 0
    v_cvt_pk_bf16_f32 v251, v251, v251
    v_lshlrev_b32 v251, 16, v251
    v_rcp_f32 v251, v251
    s_nop 0
    s_cmp_lg_u32 s3, 0
    s_cbranch_scc1 ln_nst
    s_lshl_b32 s77, s71, 7
    s_add_u32 s77, s77, 188743680
    v_lshlrev_b32 v249, 3, v245
    s_mov_b64 exec, 0xffff
    buffer_store_dwordx2 v[250:251], v249, s[4:7], s77 offen sc1
    s_mov_b64 exec, -1
ln_nst:
    v_sub_f32 v56, v56, v250
    v_sub_f32 v57, v57, v250
    v_cvt_pk_bf16_f32 v228, v56, v57
    v_lshlrev_b32 v56, 16, v228
    v_and_b32 v57, 0xffff0000, v228
    v_mul_f32 v56, v56, v251
    v_mul_f32 v57, v57, v251
    v_cvt_pk_bf16_f32 v228, v56, v57
    v_sub_f32 v58, v58, v250
    v_sub_f32 v59, v59, v250
    v_cvt_pk_bf16_f32 v229, v58, v59
    v_lshlrev_b32 v58, 16, v229
    v_and_b32 v59, 0xffff0000, v229
    v_mul_f32 v58, v58, v251
    v_mul_f32 v59, v59, v251
    v_cvt_pk_bf16_f32 v229, v58, v59
    v_sub_f32 v60, v60, v250
    v_sub_f32 v61, v61, v250
    v_cvt_pk_bf16_f32 v230, v60, v61
    v_lshlrev_b32 v60, 16, v230
    v_and_b32 v61, 0xffff0000, v230
    v_mul_f32 v60, v60, v251
    v_mul_f32 v61, v61, v251
    v_cvt_pk_bf16_f32 v230, v60, v61
    v_sub_f32 v62, v62, v250
    v_sub_f32 v63, v63, v250
    v_cvt_pk_bf16_f32 v231, v62, v63
    v_lshlrev_b32 v62, 16, v231
    v_and_b32 v63, 0xffff0000, v231
    v_mul_f32 v62, v62, v251
    v_mul_f32 v63, v63, v251
    v_cvt_pk_bf16_f32 v231, v62, v63
    v_cndmask_b32 v120, v228, v230, s[80:81]
    v_cndmask_b32 v121, v229, v231, s[80:81]
    v_cndmask_b32 v122, v230, v228, s[80:81]
    v_cndmask_b32 v123, v231, v229, s[80:81]
    buffer_store_dwordx4 v[120:123], v1, s[4:7], s75 offen offset:0 sc1
    v_sub_f32 v64, v64, v250
    v_sub_f32 v65, v65, v250
    v_cvt_pk_bf16_f32 v232, v64, v65
    v_lshlrev_b32 v64, 16, v232
    v_and_b32 v65, 0xffff0000, v232
    v_mul_f32 v64, v64, v251
    v_mul_f32 v65, v65, v251
    v_cvt_pk_bf16_f32 v232, v64, v65
    v_sub_f32 v66, v66, v250
    v_sub_f32 v67, v67, v250
    v_cvt_pk_bf16_f32 v233, v66, v67
    v_lshlrev_b32 v66, 16, v233
    v_and_b32 v67, 0xffff0000, v233
    v_mul_f32 v66, v66, v251
    v_mul_f32 v67, v67, v251
    v_cvt_pk_bf16_f32 v233, v66, v67
    v_sub_f32 v68, v68, v250
    v_sub_f32 v69, v69, v250
    v_cvt_pk_bf16_f32 v234, v68, v69
    v_lshlrev_b32 v68, 16, v234
    v_and_b32 v69, 0xffff0000, v234
    v_mul_f32 v68, v68, v251
    v_mul_f32 v69, v69, v251
    v_cvt_pk_bf16_f32 v234, v68, v69
    v_sub_f32 v70, v70, v250
    v_sub_f32 v71, v71, v250
    v_cvt_pk_bf16_f32 v235, v70, v71
    v_lshlrev_b32 v70, 16, v235
    v_and_b32 v71, 0xffff0000, v235
    v_mul_f32 v70, v70, v251
    v_mul_f32 v71, v71, v251
    v_cvt_pk_bf16_f32 v235, v70, v71
    v_cndmask_b32 v124, v232, v234, s[80:81]
    v_cndmask_b32 v125, v233, v235, s[80:81]
    v_cndmask_b32 v126, v234, v232, s[80:81]
    v_cndmask_b32 v127, v235, v233, s[80:81]
    buffer_store_dwordx4 v[124:127], v1, s[4:7], s75 offen offset:1024 sc1
    v_sub_f32 v72, v72, v250
    v_sub_f32 v73, v73, v250
    v_cvt_pk_bf16_f32 v236, v72, v73
    v_lshlrev_b32 v72, 16, v236
    v_and_b32 v73, 0xffff0000, v236
    v_mul_f32 v72, v72, v251
    v_mul_f32 v73, v73, v251
    v_cvt_pk_bf16_f32 v236, v72, v73
    v_sub_f32 v74, v74, v250
    v_sub_f32 v75, v75, v250
    v_cvt_pk_bf16_f32 v237, v74, v75
    v_lshlrev_b32 v74, 16, v237
    v_and_b32 v75, 0xffff0000, v237
    v_mul_f32 v74, v74, v251
    v_mul_f32 v75, v75, v251
    v_cvt_pk_bf16_f32 v237, v74, v75
    v_sub_f32 v76, v76, v250
    v_sub_f32 v77, v77, v250
    v_cvt_pk_bf16_f32 v238, v76, v77
    v_lshlrev_b32 v76, 16, v238
    v_and_b32 v77, 0xffff0000, v238
    v_mul_f32 v76, v76, v251
    v_mul_f32 v77, v77, v251
    v_cvt_pk_bf16_f32 v238, v76, v77
    v_sub_f32 v78, v78, v250
    v_sub_f32 v79, v79, v250
    v_cvt_pk_bf16_f32 v239, v78, v79
    v_lshlrev_b32 v78, 16, v239
    v_and_b32 v79, 0xffff0000, v239
    v_mul_f32 v78, v78, v251
    v_mul_f32 v79, v79, v251
    v_cvt_pk_bf16_f32 v239, v78, v79
    v_cndmask_b32 v128, v236, v238, s[80:81]
    v_cndmask_b32 v129, v237, v239, s[80:81]
    v_cndmask_b32 v130, v238, v236, s[80:81]
    v_cndmask_b32 v131, v239, v237, s[80:81]
    buffer_store_dwordx4 v[128:131], v1, s[4:7], s75 offen offset:2048 sc1
    v_sub_f32 v80, v80, v250
    v_sub_f32 v81, v81, v250
    v_cvt_pk_bf16_f32 v240, v80, v81
    v_lshlrev_b32 v80, 16, v240
    v_and_b32 v81, 0xffff0000, v240
    v_mul_f32 v80, v80, v251
    v_mul_f32 v81, v81, v251
    v_cvt_pk_bf16_f32 v240, v80, v81
    v_sub_f32 v82, v82, v250
    v_sub_f32 v83, v83, v250
    v_cvt_pk_bf16_f32 v241, v82, v83
    v_lshlrev_b32 v82, 16, v241
    v_and_b32 v83, 0xffff0000, v241
    v_mul_f32 v82, v82, v251
    v_mul_f32 v83, v83, v251
    v_cvt_pk_bf16_f32 v241, v82, v83
    v_sub_f32 v84, v84, v250
    v_sub_f32 v85, v85, v250
    v_cvt_pk_bf16_f32 v242, v84, v85
    v_lshlrev_b32 v84, 16, v242
    v_and_b32 v85, 0xffff0000, v242
    v_mul_f32 v84, v84, v251
    v_mul_f32 v85, v85, v251
    v_cvt_pk_bf16_f32 v242, v84, v85
    v_sub_f32 v86, v86, v250
    v_sub_f32 v87, v87, v250
    v_cvt_pk_bf16_f32 v243, v86, v87
    v_lshlrev_b32 v86, 16, v243
    v_and_b32 v87, 0xffff0000, v243
    v_mul_f32 v86, v86, v251
    v_mul_f32 v87, v87, v251
    v_cvt_pk_bf16_f32 v243, v86, v87
    v_cndmask_b32 v132, v240, v242, s[80:81]
    v_cndmask_b32 v133, v241, v243, s[80:81]
    v_cndmask_b32 v134, v242, v240, s[80:81]
    v_cndmask_b32 v135, v243, v241, s[80:81]
    buffer_store_dwordx4 v[132:135], v1, s[4:7], s75 offen offset:3072 sc1
    s_cmp_lg_u32 s98, 1
    s_cbranch_scc1 ln_now
    s_mov_b32 s98, 2
    s_branch w_adopt2
ln_now:
    v_mov_b32 v18, 1
    s_waitcnt vmcnt(0)
    s_barrier
    s_cmp_lg_u32 s3, 0
    s_cbranch_scc1 ln_sig
    s_mov_b64 exec, 1
    s_cmp_ge_u32 s71, 32
    s_cbranch_scc1 ln_sb
    buffer_atomic_add v18, off, s[64:67], 0 offset:192 sc1
ln_sb:
    buffer_atomic_add v18, off, s[64:67], 0 offset:0 sc1
    s_mov_b64 exec, -1
ln_sig:
    s_cmp_lt_u32 s63, 120
    s_cbranch_scc1 prb_done
    s_cmp_lg_u32 s3, 0
    s_cbranch_scc1 prb_bar
    s_sub_u32 s82, s63, 120
    s_lshl_b32 s83, s82, 7
    s_add_u32 s83, s83, 218112000
    s_lshl_b32 s84, s82, 10
    s_add_u32 s84, s84, 209715200
    s_mov_b32 s80, -1
    s_mov_b32 s81, -1
    s_mov_b64 exec, 1
    s_memtime s[74:75]
    s_add_u32 s87, s84, 0
    s_waitcnt lgkmcnt(0)
    buffer_load_dword v20, off, s[4:7], s87 sc1
    s_waitcnt vmcnt(0)
    s_memtime s[76:77]
    s_waitcnt lgkmcnt(0)
    s_sub_u32 s87, s76, s74
    s_min_u32 s80, s80, s87
    s_memtime s[74:75]
    s_add_u32 s87, s84, 8192
    s_waitcnt lgkmcnt(0)
    buffer_load_dword v20, off, s[4:7], s87 sc1
    s_waitcnt vmcnt(0)
    s_memtime s[76:77]
    s_waitcnt lgkmcnt(0)
    s_sub_u32 s87, s76, s74
    s_min_u32 s81, s81, s87
    s_memtime s[74:75]
    s_add_u32 s87, s84, 16384
    s_waitcnt lgkmcnt(0)
    buffer_load_dword v20, off, s[4:7], s87 sc1
    s_waitcnt vmcnt(0)
    s_memtime s[76:77]
    s_waitcnt lgkmcnt(0)
    s_sub_u32 s87, s76, s74
    s_min_u32 s80, s80, s87
    s_memtime s[74:75]
    s_add_u32 s87, s84, 24576
    s_waitcnt lgkmcnt(0)
    buffer_load_dword v20, off, s[4:7], s87 sc1
    s_waitcnt vmcnt(0)
    s_memtime s[76:77]
    s_waitcnt lgkmcnt(0)
    s_sub_u32 s87, s76, s74
    s_min_u32 s81, s81, s87
    s_memtime s[74:75]
    s_add_u32 s87, s84, 32768
    s_waitcnt lgkmcnt(0)
    buffer_load_dword v20, off, s[4:7], s87 sc1
    s_waitcnt vmcnt(0)
    s_memtime s[76:77]
    s_waitcnt lgkmcnt(0)
    s_sub_u32 s87, s76, s74
    s_min_u32 s80, s80, s87
    s_memtime s[74:75]
    s_add_u32 s87, s84, 40960
    s_waitcnt lgkmcnt(0)
    buffer_load_dword v20, off, s[4:7], s87 sc1
    s_waitcnt vmcnt(0)
    s_memtime s[76:77]
    s_waitcnt lgkmcnt(0)
    s_sub_u32 s87, s76, s74
    s_min_u32 s81, s81, s87
    s_memtime s[74:75]
    s_add_u32 s87, s84, 49152
    s_waitcnt lgkmcnt(0)
    buffer_load_dword v20, off, s[4:7], s87 sc1
    s_waitcnt vmcnt(0)
    s_memtime s[76:77]
    s_waitcnt lgkmcnt(0)
    s_sub_u32 s87, s76, s74
    s_min_u32 s80, s80, s87
    s_memtime s[74:75]
    s_add_u32 s87, s84, 57344
    s_waitcnt lgkmcnt(0)
    buffer_load_dword v20, off, s[4:7], s87 sc1
    s_waitcnt vmcnt(0)
    s_memtime s[76:77]
    s_waitcnt lgkmcnt(0)
    s_sub_u32 s87, s76, s74
    s_min_u32 s81, s81, s87
    s_memtime s[74:75]
    s_add_u32 s87, s84, 65536
    s_waitcnt lgkmcnt(0)
    buffer_load_dword v20, off, s[4:7], s87 sc1
    s_waitcnt vmcnt(0)
    s_memtime s[76:77]
    s_waitcnt lgkmcnt(0)
    s_sub_u32 s87, s76, s74
    s_min_u32 s80, s80, s87
    s_memtime s[74:75]
    s_add_u32 s87, s84, 73728
    s_waitcnt lgkmcnt(0)
    buffer_load_dword v20, off, s[4:7], s87 sc1
    s_waitcnt vmcnt(0)
    s_memtime s[76:77]
    s_waitcnt lgkmcnt(0)
    s_sub_u32 s87, s76, s74
    s_min_u32 s81, s81, s87
    s_memtime s[74:75]
    s_add_u32 s87, s84, 81920
    s_waitcnt lgkmcnt(0)
    buffer_load_dword v20, off, s[4:7], s87 sc1
    s_waitcnt vmcnt(0)
    s_memtime s[76:77]
    s_waitcnt lgkmcnt(0)
    s_sub_u32 s87, s76, s74
    s_min_u32 s80, s80, s87
    s_memtime s[74:75]
    s_add_u32 s87, s84, 90112
    s_waitcnt lgkmcnt(0)
    buffer_load_dword v20, off, s[4:7], s87 sc1
    s_waitcnt vmcnt(0)
    s_memtime s[76:77]
    s_waitcnt lgkmcnt(0)
    s_sub_u32 s87, s76, s74
    s_min_u32 s81, s81, s87
    s_sub_i32 s85, s80, s81
    s_min_i32 s85, s85, 400
    s_max_i32 s85, s85, -400
    s_lshl_b32 s85, s85, 8
    s_getreg_b32 s86, hwreg(HW_REG_XCC_ID)
    s_bfe_u32 s86, s86, 0x10002
    s_lshl_b32 s86, s86, 1
    s_or_b32 s85, s85, s86
    s_or_b32 s85, s85, 1
    s_mov_b32 s86, 65536
prb_i:
    buffer_load_dword v20, off, s[64:67], 0 offset:192 sc1
    s_waitcnt vmcnt(0)
    v_readfirstlane_b32 s84, v20
    s_cmp_ge_u32 s84, 32
    s_cbranch_scc1 prb_i_ok
    s_sleep 8
    s_sub_u32 s86, s86, 1
    s_cbranch_scc0 prb_i
prb_i_ok:
    v_mov_b32 v20, s85
    buffer_store_dword v20, off, s[4:7], s83 offset:8 sc1
    s_mov_b64 exec, -1
prb_bar:
    s_barrier
prb_done:
    s_cmp_lt_u32 s32, 4
    s_cbranch_scc1 w_nopre
    s_load_dwordx2 s[8:9], s[0:1], s33
    s_load_dwordx2 s[12:13], s[0:1], s34
    s_mov_b32 s10, s38
    s_mov_b32 s14, s38
    s_cmp_ge_u32 s32, 4
    s_cselect_b32 s31, 0, 1
    s_lshl_b32 s30, s3, s31
    s_mul_i32 s30, s30, s40
    s_add_u32 s16, s39, s30
    s_cmp_eq_u32 s32, 4
    s_cselect_b32 s30, 1024, s40
    s_cselect_b32 s31, 6, 5
    s_lshl_b32 s62, 32, s31
    s_add_u32 s17, s16, s30
    s_lshl_b32 s30, s3, 2
    s_mul_i32 s30, s30, s35
    s_add_u32 s18, s36, s30
    s_add_u32 s19, s37, s30
    s_lshl_b32 s20, s35, s31
    v_mul_u32_u24 v2, s35, v4
    v_add_u32 v2, v2, v3
    s_waitcnt lgkmcnt(0)
    s_add_u32 m0, s22, 0
    s_nop 0
    buffer_load_dwordx4 v2, s[8:11], s18 offen lds
    s_add_u32 s18, s18, s20
    s_add_u32 m0, s22, 8192
    s_nop 0
    buffer_load_dwordx4 v2, s[12:15], s19 offen lds
    s_add_u32 s19, s19, s20
    s_add_u32 m0, s22, 32768
    s_nop 0
    buffer_load_dwordx4 v2, s[8:11], s18 offen lds
    s_add_u32 s18, s18, s20
    s_add_u32 m0, s22, 40960
    s_nop 0
    buffer_load_dwordx4 v2, s[12:15], s19 offen lds
    s_add_u32 s19, s19, s20
    s_add_u32 m0, s22, 65536
    s_nop 0
    buffer_load_dwordx4 v2, s[8:11], s18 offen lds
    s_add_u32 s18, s18, s20
    s_add_u32 m0, s22, 73728
    s_nop 0
    buffer_load_dwordx4 v2, s[12:15], s19 offen lds
    s_add_u32 s19, s19, s20
    s_add_u32 m0, s22, 98304
    s_nop 0
    buffer_load_dwordx4 v2, s[8:11], s18 offen lds
    s_add_u32 s18, s18, s20
    s_add_u32 m0, s22, 106496
    s_nop 0
    buffer_load_dwordx4 v2, s[12:15], s19 offen lds
    s_add_u32 s19, s19, s20
    s_mov_b32 s70, 1
    s_cmp_lt_u32 s39, 1048576
    s_cselect_b32 s70, s70, 0
    s_cmp_lg_u32 s3, 0
    s_cbranch_scc1 lnwp_ok
    s_cmp_eq_u32 s70, 0
    s_cbranch_scc1 lnwp_full
    s_mov_b32 s69, 65536
lnwap:
    buffer_load_dword v20, off, s[64:67], 0 offset:192 sc1
    s_waitcnt vmcnt(0)
    v_readfirstlane_b32 s68, v20
    s_cmp_ge_u32 s68, 32
    s_cbranch_scc1 lnwap_ok
    s_sleep 8
    s_sub_u32 s69, s69, 1
    s_cbranch_scc0 lnwap
lnwap_ok:
    s_branch lnwp_ok
lnwp_full:
    s_mov_b32 s69, 65536
lnwp:
    buffer_load_dword v20, off, s[64:67], 0 offset:0 sc1
    s_waitcnt vmcnt(0)
    v_readfirstlane_b32 s68, v20
    s_cmp_ge_u32 s68, 128
    s_cbranch_scc1 lnwp_ok
    s_sleep 8
    s_sub_u32 s69, s69, 1
    s_cbranch_scc0 lnwp
lnwp_ok:
    s_barrier
    s_add_u32 m0, s21, 0
    s_nop 0
    buffer_load_dwordx4 v1, s[4:7], s16 offen sc1 lds
    s_add_u32 s16, s16, s62
    s_add_u32 m0, s21, 1024
    s_nop 0
    buffer_load_dwordx4 v1, s[4:7], s17 offen sc1 lds
    s_add_u32 s17, s17, s62
    s_add_u32 m0, s21, 32768
    s_nop 0
    buffer_load_dwordx4 v1, s[4:7], s16 offen sc1 lds
    s_add_u32 s16, s16, s62
    s_add_u32 m0, s21, 33792
    s_nop 0
    buffer_load_dwordx4 v1, s[4:7], s17 offen sc1 lds
    s_add_u32 s17, s17, s62
    s_add_u32 m0, s21, 65536
    s_nop 0
    buffer_load_dwordx4 v1, s[4:7], s16 offen sc1 lds
    s_add_u32 s16, s16, s62
    s_add_u32 m0, s21, 66560
    s_nop 0
    buffer_load_dwordx4 v1, s[4:7], s17 offen sc1 lds
    s_add_u32 s17, s17, s62
    s_add_u32 m0, s21, 98304
    s_nop 0
    buffer_load_dwordx4 v1, s[4:7], s16 offen sc1 lds
    s_add_u32 s16, s16, s62
    s_add_u32 m0, s21, 99328
    s_nop 0
    buffer_load_dwordx4 v1, s[4:7], s17 offen sc1 lds
    s_add_u32 s17, s17, s62
    s_branch w_adopt
w_nopre:
    s_mov_b32 s70, 1
    s_cmp_lt_u32 s39, 1048576
    s_cselect_b32 s70, s70, 0
    s_cmp_lg_u32 s3, 0
    s_cbranch_scc1 lnw_ok
    s_cmp_eq_u32 s70, 0
    s_cbranch_scc1 lnw_full
    s_mov_b32 s69, 65536
lnwa:
    buffer_load_dword v20, off, s[64:67], 0 offset:192 sc1
    s_waitcnt vmcnt(0)
    v_readfirstlane_b32 s68, v20
    s_cmp_ge_u32 s68, 32
    s_cbranch_scc1 lnwa_ok
    s_sleep 8
    s_sub_u32 s69, s69, 1
    s_cbranch_scc0 lnwa
lnwa_ok:
    s_branch lnw_ok
lnw_full:
    s_mov_b32 s69, 65536
lnw:
    buffer_load_dword v20, off, s[64:67], 0 offset:0 sc1
    s_waitcnt vmcnt(0)
    v_readfirstlane_b32 s68, v20
    s_cmp_ge_u32 s68, 128
    s_cbranch_scc1 lnw_ok
    s_sleep 8
    s_sub_u32 s69, s69, 1
    s_cbranch_scc0 lnw
lnw_ok:
    s_barrier
w_cold:
    s_cmp_eq_u32 s32, 0
    s_cbranch_scc1 fin_entry
    s_cmp_lg_u32 s3, 0
    s_cbranch_scc1 w_depok
    s_cmp_eq_u32 s45, 0
    s_cbranch_scc1 w_depok
    s_mov_b32 s31, 0x40000
w_waitdep:
    buffer_load_dword v16, v17, s[4:7], s44 offen sc1
    s_waitcnt vmcnt(0)
    v_readfirstlane_b32 s30, v16
    s_cmp_ge_u32 s30, s45
    s_cbranch_scc1 w_depok
    s_sleep 16
    s_sub_u32 s31, s31, 1
    s_cbranch_scc0 w_waitdep
w_depok:
    s_load_dwordx2 s[8:9], s[0:1], s33
    s_load_dwordx2 s[12:13], s[0:1], s34
    s_mov_b32 s10, s38
    s_mov_b32 s14, s38
    s_cmp_ge_u32 s32, 4
    s_cselect_b32 s31, 0, 1
    s_lshl_b32 s30, s3, s31
    s_mul_i32 s30, s30, s40
    s_add_u32 s16, s39, s30
    s_cmp_eq_u32 s32, 4
    s_cselect_b32 s30, 1024, s40
    s_cselect_b32 s31, 6, 5
    s_lshl_b32 s62, 32, s31
    s_add_u32 s17, s16, s30
    s_lshl_b32 s30, s3, 2
    s_mul_i32 s30, s30, s35
    s_add_u32 s18, s36, s30
    s_add_u32 s19, s37, s30
    s_lshl_b32 s20, s35, s31
    v_mul_u32_u24 v2, s35, v4
    v_add_u32 v2, v2, v3
    s_waitcnt lgkmcnt(0)
    s_barrier
    s_add_u32 m0, s21, 0
    s_nop 0
    buffer_load_dwordx4 v1, s[4:7], s16 offen sc1 lds
    s_add_u32 s16, s16, s62
    s_add_u32 m0, s21, 1024
    s_nop 0
    buffer_load_dwordx4 v1, s[4:7], s17 offen sc1 lds
    s_add_u32 s17, s17, s62
    s_add_u32 m0, s22, 0
    s_nop 0
    buffer_load_dwordx4 v2, s[8:11], s18 offen lds
    s_add_u32 s18, s18, s20
    s_add_u32 m0, s22, 8192
    s_nop 0
    buffer_load_dwordx4 v2, s[12:15], s19 offen lds
    s_add_u32 s19, s19, s20
    s_add_u32 m0, s21, 32768
    s_nop 0
    buffer_load_dwordx4 v1, s[4:7], s16 offen sc1 lds
    s_add_u32 s16, s16, s62
    s_add_u32 m0, s21, 33792
    s_nop 0
    buffer_load_dwordx4 v1, s[4:7], s17 offen sc1 lds
    s_add_u32 s17, s17, s62
    s_add_u32 m0, s22, 32768
    s_nop 0
    buffer_load_dwordx4 v2, s[8:11], s18 offen lds
    s_add_u32 s18, s18, s20
    s_add_u32 m0, s22, 40960
    s_nop 0
    buffer_load_dwordx4 v2, s[12:15], s19 offen lds
    s_add_u32 s19, s19, s20
    s_add_u32 m0, s21, 65536
    s_nop 0
    buffer_load_dwordx4 v1, s[4:7], s16 offen sc1 lds
    s_add_u32 s16, s16, s62
    s_add_u32 m0, s21, 66560
    s_nop 0
    buffer_load_dwordx4 v1, s[4:7], s17 offen sc1 lds
    s_add_u32 s17, s17, s62
    s_add_u32 m0, s22, 65536
    s_nop 0
    buffer_load_dwordx4 v2, s[8:11], s18 offen lds
    s_add_u32 s18, s18, s20
    s_add_u32 m0, s22, 73728
    s_nop 0
    buffer_load_dwordx4 v2, s[12:15], s19 offen lds
    s_add_u32 s19, s19, s20
    s_add_u32 m0, s21, 98304
    s_nop 0
    buffer_load_dwordx4 v1, s[4:7], s16 offen sc1 lds
    s_add_u32 s16, s16, s62
    s_add_u32 m0, s21, 99328
    s_nop 0
    buffer_load_dwordx4 v1, s[4:7], s17 offen sc1 lds
    s_add_u32 s17, s17, s62
    s_add_u32 m0, s22, 98304
    s_nop 0
    buffer_load_dwordx4 v2, s[8:11], s18 offen lds
    s_add_u32 s18, s18, s20
    s_add_u32 m0, s22, 106496
    s_nop 0
    buffer_load_dwordx4 v2, s[12:15], s19 offen lds
    s_add_u32 s19, s19, s20
w_adopt:
    s_cmp_eq_u32 s98, 1
    s_cbranch_scc1 ln_entry
w_adopt2:
    s_mov_b32 s48, s32
    s_cmp_ge_u32 s32, 4
    s_cselect_b32 s30, 2, 3
    s_lshl_b32 s30, s26, s30
    s_mul_i32 s30, s30, s43
    s_add_u32 s49, s42, s30
    s_mov_b32 s50, s43
    s_mov_b32 s51, s46
    s_mov_b32 s23, s41
    s_mov_b32 s53, s47
    s_nop 0
    s_load_dwordx16 s[32:47], s[24:25], 0
    s_add_u32 s24, s24, 64
    s_addc_u32 s25, s25, 0
    s_cmp_eq_u32 s48, 6
    s_cbranch_scc1 w_firstX
    s_waitcnt vmcnt(0)
    s_barrier
    s_cmp_lg_u32 s98, 2
    s_cbranch_scc1 lls_done
    s_mov_b32 s98, 0
    s_cmp_lg_u32 s3, 0
    s_cbranch_scc1 lls_done
    v_mov_b32 v20, 1
    s_mov_b64 exec, 1
    buffer_atomic_add v20, off, s[64:67], 0 offset:0 sc1
    s_mov_b64 exec, -1
lls_done:
    ds_read_b64_tr_b16 v[64:65], v8 offset:16384
    ds_read_b64_tr_b16 v[66:67], v9 offset:16384
    ds_read_b64_tr_b16 v[68:69], v10 offset:16384
    ds_read_b64_tr_b16 v[70:71], v11 offset:16384
    ds_read_b64_tr_b16 v[72:73], v8 offset:24576
    ds_read_b64_tr_b16 v[74:75], v9 offset:24576
    ds_read_b64_tr_b16 v[76:77], v10 offset:24576
    ds_read_b64_tr_b16 v[78:79], v11 offset:24576
    ds_read_b128 v[32:35], v5 offset:0
    ds_read_b128 v[36:39], v5 offset:1024
    ds_read_b128 v[40:43], v5 offset:2048
    ds_read_b128 v[44:47], v5 offset:3072
    ds_read_b128 v[48:51], v5 offset:4096
    ds_read_b128 v[52:55], v5 offset:5120
    ds_read_b128 v[56:59], v5 offset:6144
    ds_read_b128 v[60:63], v5 offset:7168
    s_waitcnt lgkmcnt(0)
    s_cmp_eq_u32 s48, 4
    s_cbranch_scc1 w_firstH
    s_cmp_eq_u32 s48, 5
    s_cbranch_scc1 w_firstM
    s_branch w_first16
w_first4:
    s_waitcnt vmcnt(12)
    s_barrier
    v_mfma_f32_16x16x32_bf16 v[128:131], v[64:67], v[32:35], 0
    ds_read_b64_tr_b16 v[112:113], v8 offset:49152
    v_mfma_f32_16x16x32_bf16 v[132:135], v[68:71], v[32:35], 0
    ds_read_b64_tr_b16 v[114:115], v9 offset:49152
    v_mfma_f32_16x16x32_bf16 v[136:139], v[72:75], v[32:35], 0
    ds_read_b64_tr_b16 v[116:117], v10 offset:49152
    v_mfma_f32_16x16x32_bf16 v[140:143], v[76:79], v[32:35], 0
    ds_read_b64_tr_b16 v[118:119], v11 offset:49152
    v_mfma_f32_16x16x32_bf16 v[144:147], v[64:67], v[36:39], 0
    ds_read_b64_tr_b16 v[120:121], v8 offset:57344
    v_mfma_f32_16x16x32_bf16 v[148:151], v[68:71], v[36:39], 0
    ds_read_b64_tr_b16 v[122:123], v9 offset:57344
    v_mfma_f32_16x16x32_bf16 v[152:155], v[72:75], v[36:39], 0
    ds_read_b64_tr_b16 v[124:125], v10 offset:57344
    v_mfma_f32_16x16x32_bf16 v[156:159], v[76:79], v[36:39], 0
    ds_read_b64_tr_b16 v[126:127], v11 offset:57344
    v_mfma_f32_16x16x32_bf16 v[160:163], v[64:67], v[40:43], 0
    ds_read_b128 v[80:83], v5 offset:32768
    v_mfma_f32_16x16x32_bf16 v[164:167], v[68:71], v[40:43], 0
    ds_read_b128 v[84:87], v5 offset:33792
    v_mfma_f32_16x16x32_bf16 v[168:171], v[72:75], v[40:43], 0
    ds_read_b128 v[88:91], v5 offset:34816
    v_mfma_f32_16x16x32_bf16 v[172:175], v[76:79], v[40:43], 0
    ds_read_b128 v[92:95], v5 offset:35840
    v_mfma_f32_16x16x32_bf16 v[176:179], v[64:67], v[44:47], 0
    ds_read_b128 v[96:99], v5 offset:36864
    v_mfma_f32_16x16x32_bf16 v[180:183], v[68:71], v[44:47], 0
    ds_read_b128 v[100:103], v5 offset:37888
    v_mfma_f32_16x16x32_bf16 v[184:187], v[72:75], v[44:47], 0
    ds_read_b128 v[104:107], v5 offset:38912
    v_mfma_f32_16x16x32_bf16 v[188:191], v[76:79], v[44:47], 0
    ds_read_b128 v[108:111], v5 offset:39936
    v_mfma_f32_16x16x32_bf16 v[192:195], v[64:67], v[48:51], 0
    v_mfma_f32_16x16x32_bf16 v[196:199], v[68:71], v[48:51], 0
    s_add_u32 m0, s21, 0
    s_nop 0
    buffer_load_dwordx4 v1, s[4:7], s16 offen sc1 lds
    s_add_u32 s16, s16, s62
    v_mfma_f32_16x16x32_bf16 v[200:203], v[72:75], v[48:51], 0
    v_mfma_f32_16x16x32_bf16 v[204:207], v[76:79], v[48:51], 0
    v_mfma_f32_16x16x32_bf16 v[208:211], v[64:67], v[52:55], 0
    s_add_u32 m0, s21, 1024
    s_nop 0
    buffer_load_dwordx4 v1, s[4:7], s17 offen sc1 lds
    s_add_u32 s17, s17, s62
    v_mfma_f32_16x16x32_bf16 v[212:215], v[68:71], v[52:55], 0
    v_mfma_f32_16x16x32_bf16 v[216:219], v[72:75], v[52:55], 0
    v_mfma_f32_16x16x32_bf16 v[220:223], v[76:79], v[52:55], 0
    s_add_u32 m0, s22, 0
    s_nop 0
    buffer_load_dwordx4 v2, s[8:11], s18 offen lds
    s_add_u32 s18, s18, s20
    v_mfma_f32_16x16x32_bf16 v[224:227], v[64:67], v[56:59], 0
    v_mfma_f32_16x16x32_bf16 v[228:231], v[68:71], v[56:59], 0
    v_mfma_f32_16x16x32_bf16 v[232:235], v[72:75], v[56:59], 0
    s_add_u32 m0, s22, 8192
    s_nop 0
    buffer_load_dwordx4 v2, s[12:15], s19 offen lds
    s_add_u32 s19, s19, s20
    v_mfma_f32_16x16x32_bf16 v[236:239], v[76:79], v[56:59], 0
    v_mfma_f32_16x16x32_bf16 v[240:243], v[64:67], v[60:63], 0
    v_mfma_f32_16x16x32_bf16 v[244:247], v[68:71], v[60:63], 0
    v_mfma_f32_16x16x32_bf16 v[248:251], v[72:75], v[60:63], 0
    v_mfma_f32_16x16x32_bf16 v[252:255], v[76:79], v[60:63], 0
    s_waitcnt lgkmcnt(0)
    s_waitcnt vmcnt(12)
    s_barrier
    v_mfma_f32_16x16x32_bf16 v[128:131], v[112:115], v[80:83], v[128:131]
    ds_read_b64_tr_b16 v[64:65], v12 offset:16384
    v_mfma_f32_16x16x32_bf16 v[132:135], v[116:119], v[80:83], v[132:135]
    ds_read_b64_tr_b16 v[66:67], v13 offset:16384
    v_mfma_f32_16x16x32_bf16 v[136:139], v[120:123], v[80:83], v[136:139]
    ds_read_b64_tr_b16 v[68:69], v14 offset:16384
    v_mfma_f32_16x16x32_bf16 v[140:143], v[124:127], v[80:83], v[140:143]
    ds_read_b64_tr_b16 v[70:71], v15 offset:16384
    v_mfma_f32_16x16x32_bf16 v[144:147], v[112:115], v[84:87], v[144:147]
    ds_read_b64_tr_b16 v[72:73], v12 offset:24576
    v_mfma_f32_16x16x32_bf16 v[148:151], v[116:119], v[84:87], v[148:151]
    ds_read_b64_tr_b16 v[74:75], v13 offset:24576
    v_mfma_f32_16x16x32_bf16 v[152:155], v[120:123], v[84:87], v[152:155]
    ds_read_b64_tr_b16 v[76:77], v14 offset:24576
    v_mfma_f32_16x16x32_bf16 v[156:159], v[124:127], v[84:87], v[156:159]
    ds_read_b64_tr_b16 v[78:79], v15 offset:24576
    v_mfma_f32_16x16x32_bf16 v[160:163], v[112:115], v[88:91], v[160:163]
    ds_read_b128 v[32:35], v6 offset:0
    v_mfma_f32_16x16x32_bf16 v[164:167], v[116:119], v[88:91], v[164:167]
    ds_read_b128 v[36:39], v6 offset:1024
    v_mfma_f32_16x16x32_bf16 v[168:171], v[120:123], v[88:91], v[168:171]
    ds_read_b128 v[40:43], v6 offset:2048
    v_mfma_f32_16x16x32_bf16 v[172:175], v[124:127], v[88:91], v[172:175]
    ds_read_b128 v[44:47], v6 offset:3072
    v_mfma_f32_16x16x32_bf16 v[176:179], v[112:115], v[92:95], v[176:179]
    ds_read_b128 v[48:51], v6 offset:4096
    v_mfma_f32_16x16x32_bf16 v[180:183], v[116:119], v[92:95], v[180:183]
    ds_read_b128 v[52:55], v6 offset:5120
    v_mfma_f32_16x16x32_bf16 v[184:187], v[120:123], v[92:95], v[184:187]
    ds_read_b128 v[56:59], v6 offset:6144
    v_mfma_f32_16x16x32_bf16 v[188:191], v[124:127], v[92:95], v[188:191]
    ds_read_b128 v[60:63], v6 offset:7168
    v_mfma_f32_16x16x32_bf16 v[192:195], v[112:115], v[96:99], v[192:195]
    v_mfma_f32_16x16x32_bf16 v[196:199], v[116:119], v[96:99], v[196:199]
    s_add_u32 m0, s21, 32768
    s_nop 0
    buffer_load_dwordx4 v1, s[4:7], s16 offen sc1 lds
    s_add_u32 s16, s16, s62
    v_mfma_f32_16x16x32_bf16 v[200:203], v[120:123], v[96:99], v[200:203]
    v_mfma_f32_16x16x32_bf16 v[204:207], v[124:127], v[96:99], v[204:207]
    v_mfma_f32_16x16x32_bf16 v[208:211], v[112:115], v[100:103], v[208:211]
    s_add_u32 m0, s21, 33792
    s_nop 0
    buffer_load_dwordx4 v1, s[4:7], s17 offen sc1 lds
    s_add_u32 s17, s17, s62
    v_mfma_f32_16x16x32_bf16 v[212:215], v[116:119], v[100:103], v[212:215]
    v_mfma_f32_16x16x32_bf16 v[216:219], v[120:123], v[100:103], v[216:219]
    v_mfma_f32_16x16x32_bf16 v[220:223], v[124:127], v[100:103], v[220:223]
    s_add_u32 m0, s22, 32768
    s_nop 0
    buffer_load_dwordx4 v2, s[8:11], s18 offen lds
    s_add_u32 s18, s18, s20
    v_mfma_f32_16x16x32_bf16 v[224:227], v[112:115], v[104:107], v[224:227]
    v_mfma_f32_16x16x32_bf16 v[228:231], v[116:119], v[104:107], v[228:231]
    v_mfma_f32_16x16x32_bf16 v[232:235], v[120:123], v[104:107], v[232:235]
    s_add_u32 m0, s22, 40960
    s_nop 0
    buffer_load_dwordx4 v2, s[12:15], s19 offen lds
    s_add_u32 s19, s19, s20
    v_mfma_f32_16x16x32_bf16 v[236:239], v[124:127], v[104:107], v[236:239]
    v_mfma_f32_16x16x32_bf16 v[240:243], v[112:115], v[108:111], v[240:243]
    v_mfma_f32_16x16x32_bf16 v[244:247], v[116:119], v[108:111], v[244:247]
    v_mfma_f32_16x16x32_bf16 v[248:251], v[120:123], v[108:111], v[248:251]
    v_mfma_f32_16x16x32_bf16 v[252:255], v[124:127], v[108:111], v[252:255]
    s_waitcnt lgkmcnt(0)
    s_waitcnt vmcnt(12)
    s_barrier
    v_mfma_f32_16x16x32_bf16 v[128:131], v[64:67], v[32:35], v[128:131]
    ds_read_b64_tr_b16 v[112:113], v12 offset:49152
    v_mfma_f32_16x16x32_bf16 v[132:135], v[68:71], v[32:35], v[132:135]
    ds_read_b64_tr_b16 v[114:115], v13 offset:49152
    v_mfma_f32_16x16x32_bf16 v[136:139], v[72:75], v[32:35], v[136:139]
    ds_read_b64_tr_b16 v[116:117], v14 offset:49152
    v_mfma_f32_16x16x32_bf16 v[140:143], v[76:79], v[32:35], v[140:143]
    ds_read_b64_tr_b16 v[118:119], v15 offset:49152
    v_mfma_f32_16x16x32_bf16 v[144:147], v[64:67], v[36:39], v[144:147]
    ds_read_b64_tr_b16 v[120:121], v12 offset:57344
    v_mfma_f32_16x16x32_bf16 v[148:151], v[68:71], v[36:39], v[148:151]
    ds_read_b64_tr_b16 v[122:123], v13 offset:57344
    v_mfma_f32_16x16x32_bf16 v[152:155], v[72:75], v[36:39], v[152:155]
    ds_read_b64_tr_b16 v[124:125], v14 offset:57344
    v_mfma_f32_16x16x32_bf16 v[156:159], v[76:79], v[36:39], v[156:159]
    ds_read_b64_tr_b16 v[126:127], v15 offset:57344
    v_mfma_f32_16x16x32_bf16 v[160:163], v[64:67], v[40:43], v[160:163]
    ds_read_b128 v[80:83], v6 offset:32768
    v_mfma_f32_16x16x32_bf16 v[164:167], v[68:71], v[40:43], v[164:167]
    ds_read_b128 v[84:87], v6 offset:33792
    v_mfma_f32_16x16x32_bf16 v[168:171], v[72:75], v[40:43], v[168:171]
    ds_read_b128 v[88:91], v6 offset:34816
    v_mfma_f32_16x16x32_bf16 v[172:175], v[76:79], v[40:43], v[172:175]
    ds_read_b128 v[92:95], v6 offset:35840
    v_mfma_f32_16x16x32_bf16 v[176:179], v[64:67], v[44:47], v[176:179]
    ds_read_b128 v[96:99], v6 offset:36864
    v_mfma_f32_16x16x32_bf16 v[180:183], v[68:71], v[44:47], v[180:183]
    ds_read_b128 v[100:103], v6 offset:37888
    v_mfma_f32_16x16x32_bf16 v[184:187], v[72:75], v[44:47], v[184:187]
    ds_read_b128 v[104:107], v6 offset:38912
    v_mfma_f32_16x16x32_bf16 v[188:191], v[76:79], v[44:47], v[188:191]
    ds_read_b128 v[108:111], v6 offset:39936
    v_mfma_f32_16x16x32_bf16 v[192:195], v[64:67], v[48:51], v[192:195]
    v_mfma_f32_16x16x32_bf16 v[196:199], v[68:71], v[48:51], v[196:199]
    s_add_u32 m0, s21, 65536
    s_nop 0
    buffer_load_dwordx4 v1, s[4:7], s16 offen sc1 lds
    s_add_u32 s16, s16, s62
    v_mfma_f32_16x16x32_bf16 v[200:203], v[72:75], v[48:51], v[200:203]
    v_mfma_f32_16x16x32_bf16 v[204:207], v[76:79], v[48:51], v[204:207]
    v_mfma_f32_16x16x32_bf16 v[208:211], v[64:67], v[52:55], v[208:211]
    s_add_u32 m0, s21, 66560
    s_nop 0
    buffer_load_dwordx4 v1, s[4:7], s17 offen sc1 lds
    s_add_u32 s17, s17, s62
    v_mfma_f32_16x16x32_bf16 v[212:215], v[68:71], v[52:55], v[212:215]
    v_mfma_f32_16x16x32_bf16 v[216:219], v[72:75], v[52:55], v[216:219]
    v_mfma_f32_16x16x32_bf16 v[220:223], v[76:79], v[52:55], v[220:223]
    s_add_u32 m0, s22, 65536
    s_nop 0
    buffer_load_dwordx4 v2, s[8:11], s18 offen lds
    s_add_u32 s18, s18, s20
    v_mfma_f32_16x16x32_bf16 v[224:227], v[64:67], v[56:59], v[224:227]
    v_mfma_f32_16x16x32_bf16 v[228:231], v[68:71], v[56:59], v[228:231]
    v_mfma_f32_16x16x32_bf16 v[232:235], v[72:75], v[56:59], v[232:235]
    s_add_u32 m0, s22, 73728
    s_nop 0
    buffer_load_dwordx4 v2, s[12:15], s19 offen lds
    s_add_u32 s19, s19, s20
    v_mfma_f32_16x16x32_bf16 v[236:239], v[76:79], v[56:59], v[236:239]
    v_mfma_f32_16x16x32_bf16 v[240:243], v[64:67], v[60:63], v[240:243]
    v_mfma_f32_16x16x32_bf16 v[244:247], v[68:71], v[60:63], v[244:247]
    v_mfma_f32_16x16x32_bf16 v[248:251], v[72:75], v[60:63], v[248:251]
    v_mfma_f32_16x16x32_bf16 v[252:255], v[76:79], v[60:63], v[252:255]
    s_waitcnt lgkmcnt(0)
    s_waitcnt vmcnt(8)
    s_barrier
    s_cmp_eq_u32 s28, 0
    s_cbranch_scc1 sig_2
    s_cmp_lg_u32 s3, 0
    s_cbranch_scc1 sig_2
    s_mov_b64 exec, 1
    v_mov_b32 v18, s57
    buffer_atomic_add v18, v17, s[4:7], s28 offen sc1
    s_mov_b64 exec, -1
sig_2:
    s_mov_b32 s28, 0
    v_mfma_f32_16x16x32_bf16 v[128:131], v[112:115], v[80:83], v[128:131]
    ds_read_b64_tr_b16 v[64:65], v8 offset:16384
    v_mfma_f32_16x16x32_bf16 v[132:135], v[116:119], v[80:83], v[132:135]
    ds_read_b64_tr_b16 v[66:67], v9 offset:16384
    v_mfma_f32_16x16x32_bf16 v[136:139], v[120:123], v[80:83], v[136:139]
    ds_read_b64_tr_b16 v[68:69], v10 offset:16384
    v_mfma_f32_16x16x32_bf16 v[140:143], v[124:127], v[80:83], v[140:143]
    ds_read_b64_tr_b16 v[70:71], v11 offset:16384
    v_mfma_f32_16x16x32_bf16 v[144:147], v[112:115], v[84:87], v[144:147]
    ds_read_b64_tr_b16 v[72:73], v8 offset:24576
    v_mfma_f32_16x16x32_bf16 v[148:151], v[116:119], v[84:87], v[148:151]
    ds_read_b64_tr_b16 v[74:75], v9 offset:24576
    v_mfma_f32_16x16x32_bf16 v[152:155], v[120:123], v[84:87], v[152:155]
    ds_read_b64_tr_b16 v[76:77], v10 offset:24576
    v_mfma_f32_16x16x32_bf16 v[156:159], v[124:127], v[84:87], v[156:159]
    ds_read_b64_tr_b16 v[78:79], v11 offset:24576
    v_mfma_f32_16x16x32_bf16 v[160:163], v[112:115], v[88:91], v[160:163]
    ds_read_b128 v[32:35], v5 offset:0
    v_mfma_f32_16x16x32_bf16 v[164:167], v[116:119], v[88:91], v[164:167]
    ds_read_b128 v[36:39], v5 offset:1024
    v_mfma_f32_16x16x32_bf16 v[168:171], v[120:123], v[88:91], v[168:171]
    ds_read_b128 v[40:43], v5 offset:2048
    v_mfma_f32_16x16x32_bf16 v[172:175], v[124:127], v[88:91], v[172:175]
    ds_read_b128 v[44:47], v5 offset:3072
    v_mfma_f32_16x16x32_bf16 v[176:179], v[112:115], v[92:95], v[176:179]
    ds_read_b128 v[48:51], v5 offset:4096
    v_mfma_f32_16x16x32_bf16 v[180:183], v[116:119], v[92:95], v[180:183]
    ds_read_b128 v[52:55], v5 offset:5120
    v_mfma_f32_16x16x32_bf16 v[184:187], v[120:123], v[92:95], v[184:187]
    ds_read_b128 v[56:59], v5 offset:6144
    v_mfma_f32_16x16x32_bf16 v[188:191], v[124:127], v[92:95], v[188:191]
    ds_read_b128 v[60:63], v5 offset:7168
    v_mfma_f32_16x16x32_bf16 v[192:195], v[112:115], v[96:99], v[192:195]
    v_mfma_f32_16x16x32_bf16 v[196:199], v[116:119], v[96:99], v[196:199]
    s_add_u32 m0, s21, 98304
    s_nop 0
    buffer_load_dwordx4 v1, s[4:7], s16 offen sc1 lds
    s_add_u32 s16, s16, s62
    v_mfma_f32_16x16x32_bf16 v[200:203], v[120:123], v[96:99], v[200:203]
    v_mfma_f32_16x16x32_bf16 v[204:207], v[124:127], v[96:99], v[204:207]
    v_mfma_f32_16x16x32_bf16 v[208:211], v[112:115], v[100:103], v[208:211]
    s_add_u32 m0, s21, 99328
    s_nop 0
    buffer_load_dwordx4 v1, s[4:7], s17 offen sc1 lds
    s_add_u32 s17, s17, s62
    v_mfma_f32_16x16x32_bf16 v[212:215], v[116:119], v[100:103], v[212:215]
    v_mfma_f32_16x16x32_bf16 v[216:219], v[120:123], v[100:103], v[216:219]
    v_mfma_f32_16x16x32_bf16 v[220:223], v[124:127], v[100:103], v[220:223]
    s_add_u32 m0, s22, 98304
    s_nop 0
    buffer_load_dwordx4 v2, s[8:11], s18 offen lds
    s_add_u32 s18, s18, s20
    v_mfma_f32_16x16x32_bf16 v[224:227], v[112:115], v[104:107], v[224:227]
    v_mfma_f32_16x16x32_bf16 v[228:231], v[116:119], v[104:107], v[228:231]
    v_mfma_f32_16x16x32_bf16 v[232:235], v[120:123], v[104:107], v[232:235]
    s_add_u32 m0, s22, 106496
    s_nop 0
    buffer_load_dwordx4 v2, s[12:15], s19 offen lds
    s_add_u32 s19, s19, s20
    v_mfma_f32_16x16x32_bf16 v[236:239], v[124:127], v[104:107], v[236:239]
    v_mfma_f32_16x16x32_bf16 v[240:243], v[112:115], v[108:111], v[240:243]
    v_mfma_f32_16x16x32_bf16 v[244:247], v[116:119], v[108:111], v[244:247]
    v_mfma_f32_16x16x32_bf16 v[248:251], v[120:123], v[108:111], v[248:251]
    v_mfma_f32_16x16x32_bf16 v[252:255], v[124:127], v[108:111], v[252:255]
    s_waitcnt lgkmcnt(0)
    s_branch w_loop_chk
w_first8:
    s_waitcnt vmcnt(16)
    s_barrier
    v_mfma_f32_16x16x32_bf16 v[128:131], v[64:67], v[32:35], 0
    ds_read_b64_tr_b16 v[112:113], v8 offset:49152
    v_mfma_f32_16x16x32_bf16 v[132:135], v[68:71], v[32:35], 0
    ds_read_b64_tr_b16 v[114:115], v9 offset:49152
    v_mfma_f32_16x16x32_bf16 v[136:139], v[72:75], v[32:35], 0
    ds_read_b64_tr_b16 v[116:117], v10 offset:49152
    v_mfma_f32_16x16x32_bf16 v[140:143], v[76:79], v[32:35], 0
    ds_read_b64_tr_b16 v[118:119], v11 offset:49152
    v_mfma_f32_16x16x32_bf16 v[144:147], v[64:67], v[36:39], 0
    ds_read_b64_tr_b16 v[120:121], v8 offset:57344
    v_mfma_f32_16x16x32_bf16 v[148:151], v[68:71], v[36:39], 0
    ds_read_b64_tr_b16 v[122:123], v9 offset:57344
    v_mfma_f32_16x16x32_bf16 v[152:155], v[72:75], v[36:39], 0
    ds_read_b64_tr_b16 v[124:125], v10 offset:57344
    v_mfma_f32_16x16x32_bf16 v[156:159], v[76:79], v[36:39], 0
    ds_read_b64_tr_b16 v[126:127], v11 offset:57344
    v_mfma_f32_16x16x32_bf16 v[160:163], v[64:67], v[40:43], 0
    ds_read_b128 v[80:83], v5 offset:32768
    v_mfma_f32_16x16x32_bf16 v[164:167], v[68:71], v[40:43], 0
    ds_read_b128 v[84:87], v5 offset:33792
    v_mfma_f32_16x16x32_bf16 v[168:171], v[72:75], v[40:43], 0
    ds_read_b128 v[88:91], v5 offset:34816
    v_mfma_f32_16x16x32_bf16 v[172:175], v[76:79], v[40:43], 0
    ds_read_b128 v[92:95], v5 offset:35840
    v_mfma_f32_16x16x32_bf16 v[176:179], v[64:67], v[44:47], 0
    ds_read_b128 v[96:99], v5 offset:36864
    v_mfma_f32_16x16x32_bf16 v[180:183], v[68:71], v[44:47], 0
    ds_read_b128 v[100:103], v5 offset:37888
    v_mfma_f32_16x16x32_bf16 v[184:187], v[72:75], v[44:47], 0
    ds_read_b128 v[104:107], v5 offset:38912
    v_mfma_f32_16x16x32_bf16 v[188:191], v[76:79], v[44:47], 0
    ds_read_b128 v[108:111], v5 offset:39936
    v_mfma_f32_16x16x32_bf16 v[192:195], v[64:67], v[48:51], 0
    v_mfma_f32_16x16x32_bf16 v[196:199], v[68:71], v[48:51], 0
    s_add_u32 m0, s21, 0
    s_nop 0
    buffer_load_dwordx4 v1, s[4:7], s16 offen sc1 lds
    s_add_u32 s16, s16, s62
    v_mfma_f32_16x16x32_bf16 v[200:203], v[72:75], v[48:51], 0
    v_mfma_f32_16x16x32_bf16 v[204:207], v[76:79], v[48:51], 0
    v_mfma_f32_16x16x32_bf16 v[208:211], v[64:67], v[52:55], 0
    s_add_u32 m0, s21, 1024
    s_nop 0
    buffer_load_dwordx4 v1, s[4:7], s17 offen sc1 lds
    s_add_u32 s17, s17, s62
    v_mfma_f32_16x16x32_bf16 v[212:215], v[68:71], v[52:55], 0
    v_mfma_f32_16x16x32_bf16 v[216:219], v[72:75], v[52:55], 0
    v_mfma_f32_16x16x32_bf16 v[220:223], v[76:79], v[52:55], 0
    s_add_u32 m0, s22, 0
    s_nop 0
    buffer_load_dwordx4 v2, s[8:11], s18 offen lds
    s_add_u32 s18, s18, s20
    v_mfma_f32_16x16x32_bf16 v[224:227], v[64:67], v[56:59], 0
    v_mfma_f32_16x16x32_bf16 v[228:231], v[68:71], v[56:59], 0
    v_mfma_f32_16x16x32_bf16 v[232:235], v[72:75], v[56:59], 0
    s_add_u32 m0, s22, 8192
    s_nop 0
    buffer_load_dwordx4 v2, s[12:15], s19 offen lds
    s_add_u32 s19, s19, s20
    v_mfma_f32_16x16x32_bf16 v[236:239], v[76:79], v[56:59], 0
    v_mfma_f32_16x16x32_bf16 v[240:243], v[64:67], v[60:63], 0
    v_mfma_f32_16x16x32_bf16 v[244:247], v[68:71], v[60:63], 0
    v_mfma_f32_16x16x32_bf16 v[248:251], v[72:75], v[60:63], 0
    v_mfma_f32_16x16x32_bf16 v[252:255], v[76:79], v[60:63], 0
    s_waitcnt lgkmcnt(0)
    s_waitcnt vmcnt(16)
    s_barrier
    v_mfma_f32_16x16x32_bf16 v[128:131], v[112:115], v[80:83], v[128:131]
    ds_read_b64_tr_b16 v[64:65], v12 offset:16384
    v_mfma_f32_16x16x32_bf16 v[132:135], v[116:119], v[80:83], v[132:135]
    ds_read_b64_tr_b16 v[66:67], v13 offset:16384
    v_mfma_f32_16x16x32_bf16 v[136:139], v[120:123], v[80:83], v[136:139]
    ds_read_b64_tr_b16 v[68:69], v14 offset:16384
    v_mfma_f32_16x16x32_bf16 v[140:143], v[124:127], v[80:83], v[140:143]
    ds_read_b64_tr_b16 v[70:71], v15 offset:16384
    v_mfma_f32_16x16x32_bf16 v[144:147], v[112:115], v[84:87], v[144:147]
    ds_read_b64_tr_b16 v[72:73], v12 offset:24576
    v_mfma_f32_16x16x32_bf16 v[148:151], v[116:119], v[84:87], v[148:151]
    ds_read_b64_tr_b16 v[74:75], v13 offset:24576
    v_mfma_f32_16x16x32_bf16 v[152:155], v[120:123], v[84:87], v[152:155]
    ds_read_b64_tr_b16 v[76:77], v14 offset:24576
    v_mfma_f32_16x16x32_bf16 v[156:159], v[124:127], v[84:87], v[156:159]
    ds_read_b64_tr_b16 v[78:79], v15 offset:24576
    v_mfma_f32_16x16x32_bf16 v[160:163], v[112:115], v[88:91], v[160:163]
    ds_read_b128 v[32:35], v6 offset:0
    v_mfma_f32_16x16x32_bf16 v[164:167], v[116:119], v[88:91], v[164:167]
    ds_read_b128 v[36:39], v6 offset:1024
    v_mfma_f32_16x16x32_bf16 v[168:171], v[120:123], v[88:91], v[168:171]
    ds_read_b128 v[40:43], v6 offset:2048
    v_mfma_f32_16x16x32_bf16 v[172:175], v[124:127], v[88:91], v[172:175]
    ds_read_b128 v[44:47], v6 offset:3072
    v_mfma_f32_16x16x32_bf16 v[176:179], v[112:115], v[92:95], v[176:179]
    ds_read_b128 v[48:51], v6 offset:4096
    v_mfma_f32_16x16x32_bf16 v[180:183], v[116:119], v[92:95], v[180:183]
    ds_read_b128 v[52:55], v6 offset:5120
    v_mfma_f32_16x16x32_bf16 v[184:187], v[120:123], v[92:95], v[184:187]
    ds_read_b128 v[56:59], v6 offset:6144
    v_mfma_f32_16x16x32_bf16 v[188:191], v[124:127], v[92:95], v[188:191]
    ds_read_b128 v[60:63], v6 offset:7168
    v_mfma_f32_16x16x32_bf16 v[192:195], v[112:115], v[96:99], v[192:195]
    v_mfma_f32_16x16x32_bf16 v[196:199], v[116:119], v[96:99], v[196:199]
    s_add_u32 m0, s21, 32768
    s_nop 0
    buffer_load_dwordx4 v1, s[4:7], s16 offen sc1 lds
    s_add_u32 s16, s16, s62
    v_mfma_f32_16x16x32_bf16 v[200:203], v[120:123], v[96:99], v[200:203]
    v_mfma_f32_16x16x32_bf16 v[204:207], v[124:127], v[96:99], v[204:207]
    v_mfma_f32_16x16x32_bf16 v[208:211], v[112:115], v[100:103], v[208:211]
    s_add_u32 m0, s21, 33792
    s_nop 0
    buffer_load_dwordx4 v1, s[4:7], s17 offen sc1 lds
    s_add_u32 s17, s17, s62
    v_mfma_f32_16x16x32_bf16 v[212:215], v[116:119], v[100:103], v[212:215]
    v_mfma_f32_16x16x32_bf16 v[216:219], v[120:123], v[100:103], v[216:219]
    v_mfma_f32_16x16x32_bf16 v[220:223], v[124:127], v[100:103], v[220:223]
    s_add_u32 m0, s22, 32768
    s_nop 0
    buffer_load_dwordx4 v2, s[8:11], s18 offen lds
    s_add_u32 s18, s18, s20
    v_mfma_f32_16x16x32_bf16 v[224:227], v[112:115], v[104:107], v[224:227]
    v_mfma_f32_16x16x32_bf16 v[228:231], v[116:119], v[104:107], v[228:231]
    v_mfma_f32_16x16x32_bf16 v[232:235], v[120:123], v[104:107], v[232:235]
    s_add_u32 m0, s22, 40960
    s_nop 0
    buffer_load_dwordx4 v2, s[12:15], s19 offen lds
    s_add_u32 s19, s19, s20
    v_mfma_f32_16x16x32_bf16 v[236:239], v[124:127], v[104:107], v[236:239]
    v_mfma_f32_16x16x32_bf16 v[240:243], v[112:115], v[108:111], v[240:243]
    v_mfma_f32_16x16x32_bf16 v[244:247], v[116:119], v[108:111], v[244:247]
    v_mfma_f32_16x16x32_bf16 v[248:251], v[120:123], v[108:111], v[248:251]
    v_mfma_f32_16x16x32_bf16 v[252:255], v[124:127], v[108:111], v[252:255]
    s_waitcnt lgkmcnt(0)
    s_waitcnt vmcnt(16)
    s_barrier
    v_mfma_f32_16x16x32_bf16 v[128:131], v[64:67], v[32:35], v[128:131]
    ds_read_b64_tr_b16 v[112:113], v12 offset:49152
    v_mfma_f32_16x16x32_bf16 v[132:135], v[68:71], v[32:35], v[132:135]
    ds_read_b64_tr_b16 v[114:115], v13 offset:49152
    v_mfma_f32_16x16x32_bf16 v[136:139], v[72:75], v[32:35], v[136:139]
    ds_read_b64_tr_b16 v[116:117], v14 offset:49152
    v_mfma_f32_16x16x32_bf16 v[140:143], v[76:79], v[32:35], v[140:143]
    ds_read_b64_tr_b16 v[118:119], v15 offset:49152
    v_mfma_f32_16x16x32_bf16 v[144:147], v[64:67], v[36:39], v[144:147]
    ds_read_b64_tr_b16 v[120:121], v12 offset:57344
    v_mfma_f32_16x16x32_bf16 v[148:151], v[68:71], v[36:39], v[148:151]
    ds_read_b64_tr_b16 v[122:123], v13 offset:57344
    v_mfma_f32_16x16x32_bf16 v[152:155], v[72:75], v[36:39], v[152:155]
    ds_read_b64_tr_b16 v[124:125], v14 offset:57344
    v_mfma_f32_16x16x32_bf16 v[156:159], v[76:79], v[36:39], v[156:159]
    ds_read_b64_tr_b16 v[126:127], v15 offset:57344
    v_mfma_f32_16x16x32_bf16 v[160:163], v[64:67], v[40:43], v[160:163]
    ds_read_b128 v[80:83], v6 offset:32768
    v_mfma_f32_16x16x32_bf16 v[164:167], v[68:71], v[40:43], v[164:167]
    ds_read_b128 v[84:87], v6 offset:33792
    v_mfma_f32_16x16x32_bf16 v[168:171], v[72:75], v[40:43], v[168:171]
    ds_read_b128 v[88:91], v6 offset:34816
    v_mfma_f32_16x16x32_bf16 v[172:175], v[76:79], v[40:43], v[172:175]
    ds_read_b128 v[92:95], v6 offset:35840
    v_mfma_f32_16x16x32_bf16 v[176:179], v[64:67], v[44:47], v[176:179]
    ds_read_b128 v[96:99], v6 offset:36864
    v_mfma_f32_16x16x32_bf16 v[180:183], v[68:71], v[44:47], v[180:183]
    ds_read_b128 v[100:103], v6 offset:37888
    v_mfma_f32_16x16x32_bf16 v[184:187], v[72:75], v[44:47], v[184:187]
    ds_read_b128 v[104:107], v6 offset:38912
    v_mfma_f32_16x16x32_bf16 v[188:191], v[76:79], v[44:47], v[188:191]
    ds_read_b128 v[108:111], v6 offset:39936
    v_mfma_f32_16x16x32_bf16 v[192:195], v[64:67], v[48:51], v[192:195]
    v_mfma_f32_16x16x32_bf16 v[196:199], v[68:71], v[48:51], v[196:199]
    s_add_u32 m0, s21, 65536
    s_nop 0
    buffer_load_dwordx4 v1, s[4:7], s16 offen sc1 lds
    s_add_u32 s16, s16, s62
    v_mfma_f32_16x16x32_bf16 v[200:203], v[72:75], v[48:51], v[200:203]
    v_mfma_f32_16x16x32_bf16 v[204:207], v[76:79], v[48:51], v[204:207]
    v_mfma_f32_16x16x32_bf16 v[208:211], v[64:67], v[52:55], v[208:211]
    s_add_u32 m0, s21, 66560
    s_nop 0
    buffer_load_dwordx4 v1, s[4:7], s17 offen sc1 lds
    s_add_u32 s17, s17, s62
    v_mfma_f32_16x16x32_bf16 v[212:215], v[68:71], v[52:55], v[212:215]
    v_mfma_f32_16x16x32_bf16 v[216:219], v[72:75], v[52:55], v[216:219]
    v_mfma_f32_16x16x32_bf16 v[220:223], v[76:79], v[52:55], v[220:223]
    s_add_u32 m0, s22, 65536
    s_nop 0
    buffer_load_dwordx4 v2, s[8:11], s18 offen lds
    s_add_u32 s18, s18, s20
    v_mfma_f32_16x16x32_bf16 v[224:227], v[64:67], v[56:59], v[224:227]
    v_mfma_f32_16x16x32_bf16 v[228:231], v[68:71], v[56:59], v[228:231]
    v_mfma_f32_16x16x32_bf16 v[232:235], v[72:75], v[56:59], v[232:235]
    s_add_u32 m0, s22, 73728
    s_nop 0
    buffer_load_dwordx4 v2, s[12:15], s19 offen lds
    s_add_u32 s19, s19, s20
    v_mfma_f32_16x16x32_bf16 v[236:239], v[76:79], v[56:59], v[236:239]
    v_mfma_f32_16x16x32_bf16 v[240:243], v[64:67], v[60:63], v[240:243]
    v_mfma_f32_16x16x32_bf16 v[244:247], v[68:71], v[60:63], v[244:247]
    v_mfma_f32_16x16x32_bf16 v[248:251], v[72:75], v[60:63], v[248:251]
    v_mfma_f32_16x16x32_bf16 v[252:255], v[76:79], v[60:63], v[252:255]
    s_waitcnt lgkmcnt(0)
    s_waitcnt vmcnt(8)
    s_barrier
    s_cmp_eq_u32 s28, 0
    s_cbranch_scc1 sig_3
    s_cmp_lg_u32 s3, 0
    s_cbranch_scc1 sig_3
    s_mov_b64 exec, 1
    v_mov_b32 v18, s57
    buffer_atomic_add v18, v17, s[4:7], s28 offen sc1
    s_mov_b64 exec, -1
sig_3:
    s_mov_b32 s28, 0
    v_mfma_f32_16x16x32_bf16 v[128:131], v[112:115], v[80:83], v[128:131]
    ds_read_b64_tr_b16 v[64:65], v8 offset:16384
    v_mfma_f32_16x16x32_bf16 v[132:135], v[116:119], v[80:83], v[132:135]
    ds_read_b64_tr_b16 v[66:67], v9 offset:16384
    v_mfma_f32_16x16x32_bf16 v[136:139], v[120:123], v[80:83], v[136:139]
    ds_read_b64_tr_b16 v[68:69], v10 offset:16384
    v_mfma_f32_16x16x32_bf16 v[140:143], v[124:127], v[80:83], v[140:143]
    ds_read_b64_tr_b16 v[70:71], v11 offset:16384
    v_mfma_f32_16x16x32_bf16 v[144:147], v[112:115], v[84:87], v[144:147]
    ds_read_b64_tr_b16 v[72:73], v8 offset:24576
    v_mfma_f32_16x16x32_bf16 v[148:151], v[116:119], v[84:87], v[148:151]
    ds_read_b64_tr_b16 v[74:75], v9 offset:24576
    v_mfma_f32_16x16x32_bf16 v[152:155], v[120:123], v[84:87], v[152:155]
    ds_read_b64_tr_b16 v[76:77], v10 offset:24576
    v_mfma_f32_16x16x32_bf16 v[156:159], v[124:127], v[84:87], v[156:159]
    ds_read_b64_tr_b16 v[78:79], v11 offset:24576
    v_mfma_f32_16x16x32_bf16 v[160:163], v[112:115], v[88:91], v[160:163]
    ds_read_b128 v[32:35], v5 offset:0
    v_mfma_f32_16x16x32_bf16 v[164:167], v[116:119], v[88:91], v[164:167]
    ds_read_b128 v[36:39], v5 offset:1024
    v_mfma_f32_16x16x32_bf16 v[168:171], v[120:123], v[88:91], v[168:171]
    ds_read_b128 v[40:43], v5 offset:2048
    v_mfma_f32_16x16x32_bf16 v[172:175], v[124:127], v[88:91], v[172:175]
    ds_read_b128 v[44:47], v5 offset:3072
    v_mfma_f32_16x16x32_bf16 v[176:179], v[112:115], v[92:95], v[176:179]
    ds_read_b128 v[48:51], v5 offset:4096
    v_mfma_f32_16x16x32_bf16 v[180:183], v[116:119], v[92:95], v[180:183]
    ds_read_b128 v[52:55], v5 offset:5120
    v_mfma_f32_16x16x32_bf16 v[184:187], v[120:123], v[92:95], v[184:187]
    ds_read_b128 v[56:59], v5 offset:6144
    v_mfma_f32_16x16x32_bf16 v[188:191], v[124:127], v[92:95], v[188:191]
    ds_read_b128 v[60:63], v5 offset:7168
    v_mfma_f32_16x16x32_bf16 v[192:195], v[112:115], v[96:99], v[192:195]
    v_mfma_f32_16x16x32_bf16 v[196:199], v[116:119], v[96:99], v[196:199]
    s_add_u32 m0, s21, 98304
    s_nop 0
    buffer_load_dwordx4 v1, s[4:7], s16 offen sc1 lds
    s_add_u32 s16, s16, s62
    v_mfma_f32_16x16x32_bf16 v[200:203], v[120:123], v[96:99], v[200:203]
    v_mfma_f32_16x16x32_bf16 v[204:207], v[124:127], v[96:99], v[204:207]
    v_mfma_f32_16x16x32_bf16 v[208:211], v[112:115], v[100:103], v[208:211]
    s_add_u32 m0, s21, 99328
    s_nop 0
    buffer_load_dwordx4 v1, s[4:7], s17 offen sc1 lds
    s_add_u32 s17, s17, s62
    v_mfma_f32_16x16x32_bf16 v[212:215], v[116:119], v[100:103], v[212:215]
    v_mfma_f32_16x16x32_bf16 v[216:219], v[120:123], v[100:103], v[216:219]
    v_mfma_f32_16x16x32_bf16 v[220:223], v[124:127], v[100:103], v[220:223]
    s_add_u32 m0, s22, 98304
    s_nop 0
    buffer_load_dwordx4 v2, s[8:11], s18 offen lds
    s_add_u32 s18, s18, s20
    v_mfma_f32_16x16x32_bf16 v[224:227], v[112:115], v[104:107], v[224:227]
    v_mfma_f32_16x16x32_bf16 v[228:231], v[116:119], v[104:107], v[228:231]
    v_mfma_f32_16x16x32_bf16 v[232:235], v[120:123], v[104:107], v[232:235]
    s_add_u32 m0, s22, 106496
    s_nop 0
    buffer_load_dwordx4 v2, s[12:15], s19 offen lds
    s_add_u32 s19, s19, s20
    v_mfma_f32_16x16x32_bf16 v[236:239], v[124:127], v[104:107], v[236:239]
    v_mfma_f32_16x16x32_bf16 v[240:243], v[112:115], v[108:111], v[240:243]
    v_mfma_f32_16x16x32_bf16 v[244:247], v[116:119], v[108:111], v[244:247]
    v_mfma_f32_16x16x32_bf16 v[248:251], v[120:123], v[108:111], v[248:251]
    v_mfma_f32_16x16x32_bf16 v[252:255], v[124:127], v[108:111], v[252:255]
    s_waitcnt lgkmcnt(0)
    s_branch w_loop_chk
w_first16:
    s_waitcnt vmcnt(24)
    s_barrier
    v_mfma_f32_16x16x32_bf16 v[128:131], v[64:67], v[32:35], 0
    ds_read_b64_tr_b16 v[112:113], v8 offset:49152
    v_mfma_f32_16x16x32_bf16 v[132:135], v[68:71], v[32:35], 0
    ds_read_b64_tr_b16 v[114:115], v9 offset:49152
    v_mfma_f32_16x16x32_bf16 v[136:139], v[72:75], v[32:35], 0
    ds_read_b64_tr_b16 v[116:117], v10 offset:49152
    v_mfma_f32_16x16x32_bf16 v[140:143], v[76:79], v[32:35], 0
    ds_read_b64_tr_b16 v[118:119], v11 offset:49152
    v_mfma_f32_16x16x32_bf16 v[144:147], v[64:67], v[36:39], 0
    ds_read_b64_tr_b16 v[120:121], v8 offset:57344
    v_mfma_f32_16x16x32_bf16 v[148:151], v[68:71], v[36:39], 0
    ds_read_b64_tr_b16 v[122:123], v9 offset:57344
    v_mfma_f32_16x16x32_bf16 v[152:155], v[72:75], v[36:39], 0
    ds_read_b64_tr_b16 v[124:125], v10 offset:57344
    v_mfma_f32_16x16x32_bf16 v[156:159], v[76:79], v[36:39], 0
    ds_read_b64_tr_b16 v[126:127], v11 offset:57344
    v_mfma_f32_16x16x32_bf16 v[160:163], v[64:67], v[40:43], 0
    ds_read_b128 v[80:83], v5 offset:32768
    v_mfma_f32_16x16x32_bf16 v[164:167], v[68:71], v[40:43], 0
    ds_read_b128 v[84:87], v5 offset:33792
    v_mfma_f32_16x16x32_bf16 v[168:171], v[72:75], v[40:43], 0
    ds_read_b128 v[88:91], v5 offset:34816
    v_mfma_f32_16x16x32_bf16 v[172:175], v[76:79], v[40:43], 0
    ds_read_b128 v[92:95], v5 offset:35840
    v_mfma_f32_16x16x32_bf16 v[176:179], v[64:67], v[44:47], 0
    ds_read_b128 v[96:99], v5 offset:36864
    v_mfma_f32_16x16x32_bf16 v[180:183], v[68:71], v[44:47], 0
    ds_read_b128 v[100:103], v5 offset:37888
    v_mfma_f32_16x16x32_bf16 v[184:187], v[72:75], v[44:47], 0
    ds_read_b128 v[104:107], v5 offset:38912
    v_mfma_f32_16x16x32_bf16 v[188:191], v[76:79], v[44:47], 0
    ds_read_b128 v[108:111], v5 offset:39936
    v_mfma_f32_16x16x32_bf16 v[192:195], v[64:67], v[48:51], 0
    v_mfma_f32_16x16x32_bf16 v[196:199], v[68:71], v[48:51], 0
    s_add_u32 m0, s21, 0
    s_nop 0
    buffer_load_dwordx4 v1, s[4:7], s16 offen sc1 lds
    s_add_u32 s16, s16, s62
    v_mfma_f32_16x16x32_bf16 v[200:203], v[72:75], v[48:51], 0
    v_mfma_f32_16x16x32_bf16 v[204:207], v[76:79], v[48:51], 0
    v_mfma_f32_16x16x32_bf16 v[208:211], v[64:67], v[52:55], 0
    s_add_u32 m0, s21, 1024
    s_nop 0
    buffer_load_dwordx4 v1, s[4:7], s17 offen sc1 lds
    s_add_u32 s17, s17, s62
    v_mfma_f32_16x16x32_bf16 v[212:215], v[68:71], v[52:55], 0
    v_mfma_f32_16x16x32_bf16 v[216:219], v[72:75], v[52:55], 0
    v_mfma_f32_16x16x32_bf16 v[220:223], v[76:79], v[52:55], 0
    s_add_u32 m0, s22, 0
    s_nop 0
    buffer_load_dwordx4 v2, s[8:11], s18 offen lds
    s_add_u32 s18, s18, s20
    v_mfma_f32_16x16x32_bf16 v[224:227], v[64:67], v[56:59], 0
    v_mfma_f32_16x16x32_bf16 v[228:231], v[68:71], v[56:59], 0
    v_mfma_f32_16x16x32_bf16 v[232:235], v[72:75], v[56:59], 0
    s_add_u32 m0, s22, 8192
    s_nop 0
    buffer_load_dwordx4 v2, s[12:15], s19 offen lds
    s_add_u32 s19, s19, s20
    v_mfma_f32_16x16x32_bf16 v[236:239], v[76:79], v[56:59], 0
    v_mfma_f32_16x16x32_bf16 v[240:243], v[64:67], v[60:63], 0
    v_mfma_f32_16x16x32_bf16 v[244:247], v[68:71], v[60:63], 0
    v_mfma_f32_16x16x32_bf16 v[248:251], v[72:75], v[60:63], 0
    v_mfma_f32_16x16x32_bf16 v[252:255], v[76:79], v[60:63], 0
    s_waitcnt lgkmcnt(0)
    s_waitcnt vmcnt(24)
    s_barrier
    v_mfma_f32_16x16x32_bf16 v[128:131], v[112:115], v[80:83], v[128:131]
    ds_read_b64_tr_b16 v[64:65], v12 offset:16384
    v_mfma_f32_16x16x32_bf16 v[132:135], v[116:119], v[80:83], v[132:135]
    ds_read_b64_tr_b16 v[66:67], v13 offset:16384
    v_mfma_f32_16x16x32_bf16 v[136:139], v[120:123], v[80:83], v[136:139]
    ds_read_b64_tr_b16 v[68:69], v14 offset:16384
    v_mfma_f32_16x16x32_bf16 v[140:143], v[124:127], v[80:83], v[140:143]
    ds_read_b64_tr_b16 v[70:71], v15 offset:16384
    v_mfma_f32_16x16x32_bf16 v[144:147], v[112:115], v[84:87], v[144:147]
    ds_read_b64_tr_b16 v[72:73], v12 offset:24576
    v_mfma_f32_16x16x32_bf16 v[148:151], v[116:119], v[84:87], v[148:151]
    ds_read_b64_tr_b16 v[74:75], v13 offset:24576
    v_mfma_f32_16x16x32_bf16 v[152:155], v[120:123], v[84:87], v[152:155]
    ds_read_b64_tr_b16 v[76:77], v14 offset:24576
    v_mfma_f32_16x16x32_bf16 v[156:159], v[124:127], v[84:87], v[156:159]
    ds_read_b64_tr_b16 v[78:79], v15 offset:24576
    v_mfma_f32_16x16x32_bf16 v[160:163], v[112:115], v[88:91], v[160:163]
    ds_read_b128 v[32:35], v6 offset:0
    v_mfma_f32_16x16x32_bf16 v[164:167], v[116:119], v[88:91], v[164:167]
    ds_read_b128 v[36:39], v6 offset:1024
    v_mfma_f32_16x16x32_bf16 v[168:171], v[120:123], v[88:91], v[168:171]
    ds_read_b128 v[40:43], v6 offset:2048
    v_mfma_f32_16x16x32_bf16 v[172:175], v[124:127], v[88:91], v[172:175]
    ds_read_b128 v[44:47], v6 offset:3072
    v_mfma_f32_16x16x32_bf16 v[176:179], v[112:115], v[92:95], v[176:179]
    ds_read_b128 v[48:51], v6 offset:4096
    v_mfma_f32_16x16x32_bf16 v[180:183], v[116:119], v[92:95], v[180:183]
    ds_read_b128 v[52:55], v6 offset:5120
    v_mfma_f32_16x16x32_bf16 v[184:187], v[120:123], v[92:95], v[184:187]
    ds_read_b128 v[56:59], v6 offset:6144
    v_mfma_f32_16x16x32_bf16 v[188:191], v[124:127], v[92:95], v[188:191]
    ds_read_b128 v[60:63], v6 offset:7168
    v_mfma_f32_16x16x32_bf16 v[192:195], v[112:115], v[96:99], v[192:195]
    v_mfma_f32_16x16x32_bf16 v[196:199], v[116:119], v[96:99], v[196:199]
    s_add_u32 m0, s21, 32768
    s_nop 0
    buffer_load_dwordx4 v1, s[4:7], s16 offen sc1 lds
    s_add_u32 s16, s16, s62
    v_mfma_f32_16x16x32_bf16 v[200:203], v[120:123], v[96:99], v[200:203]
    v_mfma_f32_16x16x32_bf16 v[204:207], v[124:127], v[96:99], v[204:207]
    v_mfma_f32_16x16x32_bf16 v[208:211], v[112:115], v[100:103], v[208:211]
    s_add_u32 m0, s21, 33792
    s_nop 0
    buffer_load_dwordx4 v1, s[4:7], s17 offen sc1 lds
    s_add_u32 s17, s17, s62
    v_mfma_f32_16x16x32_bf16 v[212:215], v[116:119], v[100:103], v[212:215]
    v_mfma_f32_16x16x32_bf16 v[216:219], v[120:123], v[100:103], v[216:219]
    v_mfma_f32_16x16x32_bf16 v[220:223], v[124:127], v[100:103], v[220:223]
    s_add_u32 m0, s22, 32768
    s_nop 0
    buffer_load_dwordx4 v2, s[8:11], s18 offen lds
    s_add_u32 s18, s18, s20
    v_mfma_f32_16x16x32_bf16 v[224:227], v[112:115], v[104:107], v[224:227]
    v_mfma_f32_16x16x32_bf16 v[228:231], v[116:119], v[104:107], v[228:231]
    v_mfma_f32_16x16x32_bf16 v[232:235], v[120:123], v[104:107], v[232:235]
    s_add_u32 m0, s22, 40960
    s_nop 0
    buffer_load_dwordx4 v2, s[12:15], s19 offen lds
    s_add_u32 s19, s19, s20
    v_mfma_f32_16x16x32_bf16 v[236:239], v[124:127], v[104:107], v[236:239]
    v_mfma_f32_16x16x32_bf16 v[240:243], v[112:115], v[108:111], v[240:243]
    v_mfma_f32_16x16x32_bf16 v[244:247], v[116:119], v[108:111], v[244:247]
    v_mfma_f32_16x16x32_bf16 v[248:251], v[120:123], v[108:111], v[248:251]
    v_mfma_f32_16x16x32_bf16 v[252:255], v[124:127], v[108:111], v[252:255]
    s_waitcnt lgkmcnt(0)
    s_waitcnt vmcnt(24)
    s_barrier
    v_mfma_f32_16x16x32_bf16 v[128:131], v[64:67], v[32:35], v[128:131]
    ds_read_b64_tr_b16 v[112:113], v12 offset:49152
    v_mfma_f32_16x16x32_bf16 v[132:135], v[68:71], v[32:35], v[132:135]
    ds_read_b64_tr_b16 v[114:115], v13 offset:49152
    v_mfma_f32_16x16x32_bf16 v[136:139], v[72:75], v[32:35], v[136:139]
    ds_read_b64_tr_b16 v[116:117], v14 offset:49152
    v_mfma_f32_16x16x32_bf16 v[140:143], v[76:79], v[32:35], v[140:143]
    ds_read_b64_tr_b16 v[118:119], v15 offset:49152
    v_mfma_f32_16x16x32_bf16 v[144:147], v[64:67], v[36:39], v[144:147]
    ds_read_b64_tr_b16 v[120:121], v12 offset:57344
    v_mfma_f32_16x16x32_bf16 v[148:151], v[68:71], v[36:39], v[148:151]
    ds_read_b64_tr_b16 v[122:123], v13 offset:57344
    v_mfma_f32_16x16x32_bf16 v[152:155], v[72:75], v[36:39], v[152:155]
    ds_read_b64_tr_b16 v[124:125], v14 offset:57344
    v_mfma_f32_16x16x32_bf16 v[156:159], v[76:79], v[36:39], v[156:159]
    ds_read_b64_tr_b16 v[126:127], v15 offset:57344
    v_mfma_f32_16x16x32_bf16 v[160:163], v[64:67], v[40:43], v[160:163]
    ds_read_b128 v[80:83], v6 offset:32768
    v_mfma_f32_16x16x32_bf16 v[164:167], v[68:71], v[40:43], v[164:167]
    ds_read_b128 v[84:87], v6 offset:33792
    v_mfma_f32_16x16x32_bf16 v[168:171], v[72:75], v[40:43], v[168:171]
    ds_read_b128 v[88:91], v6 offset:34816
    v_mfma_f32_16x16x32_bf16 v[172:175], v[76:79], v[40:43], v[172:175]
    ds_read_b128 v[92:95], v6 offset:35840
    v_mfma_f32_16x16x32_bf16 v[176:179], v[64:67], v[44:47], v[176:179]
    ds_read_b128 v[96:99], v6 offset:36864
    v_mfma_f32_16x16x32_bf16 v[180:183], v[68:71], v[44:47], v[180:183]
    ds_read_b128 v[100:103], v6 offset:37888
    v_mfma_f32_16x16x32_bf16 v[184:187], v[72:75], v[44:47], v[184:187]
    ds_read_b128 v[104:107], v6 offset:38912
    v_mfma_f32_16x16x32_bf16 v[188:191], v[76:79], v[44:47], v[188:191]
    ds_read_b128 v[108:111], v6 offset:39936
    v_mfma_f32_16x16x32_bf16 v[192:195], v[64:67], v[48:51], v[192:195]
    v_mfma_f32_16x16x32_bf16 v[196:199], v[68:71], v[48:51], v[196:199]
    s_add_u32 m0, s21, 65536
    s_nop 0
    buffer_load_dwordx4 v1, s[4:7], s16 offen sc1 lds
    s_add_u32 s16, s16, s62
    v_mfma_f32_16x16x32_bf16 v[200:203], v[72:75], v[48:51], v[200:203]
    v_mfma_f32_16x16x32_bf16 v[204:207], v[76:79], v[48:51], v[204:207]
    v_mfma_f32_16x16x32_bf16 v[208:211], v[64:67], v[52:55], v[208:211]
    s_add_u32 m0, s21, 66560
    s_nop 0
    buffer_load_dwordx4 v1, s[4:7], s17 offen sc1 lds
    s_add_u32 s17, s17, s62
    v_mfma_f32_16x16x32_bf16 v[212:215], v[68:71], v[52:55], v[212:215]
    v_mfma_f32_16x16x32_bf16 v[216:219], v[72:75], v[52:55], v[216:219]
    v_mfma_f32_16x16x32_bf16 v[220:223], v[76:79], v[52:55], v[220:223]
    s_add_u32 m0, s22, 65536
    s_nop 0
    buffer_load_dwordx4 v2, s[8:11], s18 offen lds
    s_add_u32 s18, s18, s20
    v_mfma_f32_16x16x32_bf16 v[224:227], v[64:67], v[56:59], v[224:227]
    v_mfma_f32_16x16x32_bf16 v[228:231], v[68:71], v[56:59], v[228:231]
    v_mfma_f32_16x16x32_bf16 v[232:235], v[72:75], v[56:59], v[232:235]
    s_add_u32 m0, s22, 73728
    s_nop 0
    buffer_load_dwordx4 v2, s[12:15], s19 offen lds
    s_add_u32 s19, s19, s20
    v_mfma_f32_16x16x32_bf16 v[236:239], v[76:79], v[56:59], v[236:239]
    v_mfma_f32_16x16x32_bf16 v[240:243], v[64:67], v[60:63], v[240:243]
    v_mfma_f32_16x16x32_bf16 v[244:247], v[68:71], v[60:63], v[244:247]
    v_mfma_f32_16x16x32_bf16 v[248:251], v[72:75], v[60:63], v[248:251]
    v_mfma_f32_16x16x32_bf16 v[252:255], v[76:79], v[60:63], v[252:255]
    s_waitcnt lgkmcnt(0)
    s_waitcnt vmcnt(8)
    s_barrier
    s_cmp_eq_u32 s28, 0
    s_cbranch_scc1 sig_4
    s_cmp_lg_u32 s3, 0
    s_cbranch_scc1 sig_4
    s_mov_b64 exec, 1
    v_mov_b32 v18, s57
    buffer_atomic_add v18, v17, s[4:7], s28 offen sc1
    s_mov_b64 exec, -1
sig_4:
    s_mov_b32 s28, 0
    v_mfma_f32_16x16x32_bf16 v[128:131], v[112:115], v[80:83], v[128:131]
    ds_read_b64_tr_b16 v[64:65], v8 offset:16384
    v_mfma_f32_16x16x32_bf16 v[132:135], v[116:119], v[80:83], v[132:135]
    ds_read_b64_tr_b16 v[66:67], v9 offset:16384
    v_mfma_f32_16x16x32_bf16 v[136:139], v[120:123], v[80:83], v[136:139]
    ds_read_b64_tr_b16 v[68:69], v10 offset:16384
    v_mfma_f32_16x16x32_bf16 v[140:143], v[124:127], v[80:83], v[140:143]
    ds_read_b64_tr_b16 v[70:71], v11 offset:16384
    v_mfma_f32_16x16x32_bf16 v[144:147], v[112:115], v[84:87], v[144:147]
    ds_read_b64_tr_b16 v[72:73], v8 offset:24576
    v_mfma_f32_16x16x32_bf16 v[148:151], v[116:119], v[84:87], v[148:151]
    ds_read_b64_tr_b16 v[74:75], v9 offset:24576
    v_mfma_f32_16x16x32_bf16 v[152:155], v[120:123], v[84:87], v[152:155]
    ds_read_b64_tr_b16 v[76:77], v10 offset:24576
    v_mfma_f32_16x16x32_bf16 v[156:159], v[124:127], v[84:87], v[156:159]
    ds_read_b64_tr_b16 v[78:79], v11 offset:24576
    v_mfma_f32_16x16x32_bf16 v[160:163], v[112:115], v[88:91], v[160:163]
    ds_read_b128 v[32:35], v5 offset:0
    v_mfma_f32_16x16x32_bf16 v[164:167], v[116:119], v[88:91], v[164:167]
    ds_read_b128 v[36:39], v5 offset:1024
    v_mfma_f32_16x16x32_bf16 v[168:171], v[120:123], v[88:91], v[168:171]
    ds_read_b128 v[40:43], v5 offset:2048
    v_mfma_f32_16x16x32_bf16 v[172:175], v[124:127], v[88:91], v[172:175]
    ds_read_b128 v[44:47], v5 offset:3072
    v_mfma_f32_16x16x32_bf16 v[176:179], v[112:115], v[92:95], v[176:179]
    ds_read_b128 v[48:51], v5 offset:4096
    v_mfma_f32_16x16x32_bf16 v[180:183], v[116:119], v[92:95], v[180:183]
    ds_read_b128 v[52:55], v5 offset:5120
    v_mfma_f32_16x16x32_bf16 v[184:187], v[120:123], v[92:95], v[184:187]
    ds_read_b128 v[56:59], v5 offset:6144
    v_mfma_f32_16x16x32_bf16 v[188:191], v[124:127], v[92:95], v[188:191]
    ds_read_b128 v[60:63], v5 offset:7168
    v_mfma_f32_16x16x32_bf16 v[192:195], v[112:115], v[96:99], v[192:195]
    v_mfma_f32_16x16x32_bf16 v[196:199], v[116:119], v[96:99], v[196:199]
    s_add_u32 m0, s21, 98304
    s_nop 0
    buffer_load_dwordx4 v1, s[4:7], s16 offen sc1 lds
    s_add_u32 s16, s16, s62
    v_mfma_f32_16x16x32_bf16 v[200:203], v[120:123], v[96:99], v[200:203]
    v_mfma_f32_16x16x32_bf16 v[204:207], v[124:127], v[96:99], v[204:207]
    v_mfma_f32_16x16x32_bf16 v[208:211], v[112:115], v[100:103], v[208:211]
    s_add_u32 m0, s21, 99328
    s_nop 0
    buffer_load_dwordx4 v1, s[4:7], s17 offen sc1 lds
    s_add_u32 s17, s17, s62
    v_mfma_f32_16x16x32_bf16 v[212:215], v[116:119], v[100:103], v[212:215]
    v_mfma_f32_16x16x32_bf16 v[216:219], v[120:123], v[100:103], v[216:219]
    v_mfma_f32_16x16x32_bf16 v[220:223], v[124:127], v[100:103], v[220:223]
    s_add_u32 m0, s22, 98304
    s_nop 0
    buffer_load_dwordx4 v2, s[8:11], s18 offen lds
    s_add_u32 s18, s18, s20
    v_mfma_f32_16x16x32_bf16 v[224:227], v[112:115], v[104:107], v[224:227]
    v_mfma_f32_16x16x32_bf16 v[228:231], v[116:119], v[104:107], v[228:231]
    v_mfma_f32_16x16x32_bf16 v[232:235], v[120:123], v[104:107], v[232:235]
    s_add_u32 m0, s22, 106496
    s_nop 0
    buffer_load_dwordx4 v2, s[12:15], s19 offen lds
    s_add_u32 s19, s19, s20
    v_mfma_f32_16x16x32_bf16 v[236:239], v[124:127], v[104:107], v[236:239]
    v_mfma_f32_16x16x32_bf16 v[240:243], v[112:115], v[108:111], v[240:243]
    v_mfma_f32_16x16x32_bf16 v[244:247], v[116:119], v[108:111], v[244:247]
    v_mfma_f32_16x16x32_bf16 v[248:251], v[120:123], v[108:111], v[248:251]
    v_mfma_f32_16x16x32_bf16 v[252:255], v[124:127], v[108:111], v[252:255]
    s_waitcnt lgkmcnt(0)
w_loop_chk:
    s_sub_u32 s23, s23, 1
w_loop:
    s_cmp_lg_u32 s23, 1
    s_cbranch_scc1 w_body
    v_readfirstlane_b32 s30, v16
    s_cmp_ge_u32 s30, s45
    s_cselect_b32 s30, 0, 1
    s_or_b32 s30, s30, s70
    s_cmp_ge_u32 s32, 4
    s_cselect_b32 s30, 1, s30
    s_cmp_eq_u32 s32, 0
    s_cselect_b32 s30, 1, s30
    v_mov_b32 v20, s30
    ds_write_b32 v7, v20
    s_cbranch_scc1 w_nd
    s_cmp_ge_u32 s32, 4
    s_cbranch_scc1 w_nd
    s_cmp_lg_u32 s70, 0
    s_cbranch_scc1 w_nd
    s_load_dwordx2 s[8:9], s[0:1], s33
    s_load_dwordx2 s[12:13], s[0:1], s34
    s_mov_b32 s10, s38
    s_mov_b32 s14, s38
    s_cmp_ge_u32 s32, 4
    s_cselect_b32 s31, 0, 1
    s_lshl_b32 s30, s3, s31
    s_mul_i32 s30, s30, s40
    s_add_u32 s16, s39, s30
    s_cmp_eq_u32 s32, 4
    s_cselect_b32 s30, 1024, s40
    s_cselect_b32 s31, 6, 5
    s_lshl_b32 s62, 32, s31
    s_add_u32 s17, s16, s30
    s_lshl_b32 s30, s3, 2
    s_mul_i32 s30, s30, s35
    s_add_u32 s18, s36, s30
    s_add_u32 s19, s37, s30
    s_lshl_b32 s20, s35, s31
    v_mul_u32_u24 v2, s35, v4
    v_add_u32 v2, v2, v3
    s_waitcnt lgkmcnt(0)
w_body:
    s_waitcnt vmcnt(8)
    s_barrier
    v_mfma_f32_16x16x32_bf16 v[128:131], v[64:67], v[32:35], v[128:131]
    ds_read_b64_tr_b16 v[112:113], v8 offset:49152
    v_mfma_f32_16x16x32_bf16 v[132:135], v[68:71], v[32:35], v[132:135]
    ds_read_b64_tr_b16 v[114:115], v9 offset:49152
    v_mfma_f32_16x16x32_bf16 v[136:139], v[72:75], v[32:35], v[136:139]
    ds_read_b64_tr_b16 v[116:117], v10 offset:49152
    v_mfma_f32_16x16x32_bf16 v[140:143], v[76:79], v[32:35], v[140:143]
    ds_read_b64_tr_b16 v[118:119], v11 offset:49152
    v_mfma_f32_16x16x32_bf16 v[144:147], v[64:67], v[36:39], v[144:147]
    ds_read_b64_tr_b16 v[120:121], v8 offset:57344
    v_mfma_f32_16x16x32_bf16 v[148:151], v[68:71], v[36:39], v[148:151]
    ds_read_b64_tr_b16 v[122:123], v9 offset:57344
    v_mfma_f32_16x16x32_bf16 v[152:155], v[72:75], v[36:39], v[152:155]
    ds_read_b64_tr_b16 v[124:125], v10 offset:57344
    v_mfma_f32_16x16x32_bf16 v[156:159], v[76:79], v[36:39], v[156:159]
    ds_read_b64_tr_b16 v[126:127], v11 offset:57344
    v_mfma_f32_16x16x32_bf16 v[160:163], v[64:67], v[40:43], v[160:163]
    ds_read_b128 v[80:83], v5 offset:32768
    v_mfma_f32_16x16x32_bf16 v[164:167], v[68:71], v[40:43], v[164:167]
    ds_read_b128 v[84:87], v5 offset:33792
    v_mfma_f32_16x16x32_bf16 v[168:171], v[72:75], v[40:43], v[168:171]
    ds_read_b128 v[88:91], v5 offset:34816
    v_mfma_f32_16x16x32_bf16 v[172:175], v[76:79], v[40:43], v[172:175]
    ds_read_b128 v[92:95], v5 offset:35840
    v_mfma_f32_16x16x32_bf16 v[176:179], v[64:67], v[44:47], v[176:179]
    ds_read_b128 v[96:99], v5 offset:36864
    v_mfma_f32_16x16x32_bf16 v[180:183], v[68:71], v[44:47], v[180:183]
    ds_read_b128 v[100:103], v5 offset:37888
    v_mfma_f32_16x16x32_bf16 v[184:187], v[72:75], v[44:47], v[184:187]
    ds_read_b128 v[104:107], v5 offset:38912
    v_mfma_f32_16x16x32_bf16 v[188:191], v[76:79], v[44:47], v[188:191]
    ds_read_b128 v[108:111], v5 offset:39936
    v_mfma_f32_16x16x32_bf16 v[192:195], v[64:67], v[48:51], v[192:195]
    v_mfma_f32_16x16x32_bf16 v[196:199], v[68:71], v[48:51], v[196:199]
    s_add_u32 m0, s21, 0
    s_nop 0
    buffer_load_dwordx4 v1, s[4:7], s16 offen sc1 lds
    s_add_u32 s16, s16, s62
    v_mfma_f32_16x16x32_bf16 v[200:203], v[72:75], v[48:51], v[200:203]
    v_mfma_f32_16x16x32_bf16 v[204:207], v[76:79], v[48:51], v[204:207]
    v_mfma_f32_16x16x32_bf16 v[208:211], v[64:67], v[52:55], v[208:211]
    s_add_u32 m0, s21, 1024
    s_nop 0
    buffer_load_dwordx4 v1, s[4:7], s17 offen sc1 lds
    s_add_u32 s17, s17, s62
    v_mfma_f32_16x16x32_bf16 v[212:215], v[68:71], v[52:55], v[212:215]
    v_mfma_f32_16x16x32_bf16 v[216:219], v[72:75], v[52:55], v[216:219]
    v_mfma_f32_16x16x32_bf16 v[220:223], v[76:79], v[52:55], v[220:223]
    s_add_u32 m0, s22, 0
    s_nop 0
    buffer_load_dwordx4 v2, s[8:11], s18 offen lds
    s_add_u32 s18, s18, s20
    v_mfma_f32_16x16x32_bf16 v[224:227], v[64:67], v[56:59], v[224:227]
    v_mfma_f32_16x16x32_bf16 v[228:231], v[68:71], v[56:59], v[228:231]
    v_mfma_f32_16x16x32_bf16 v[232:235], v[72:75], v[56:59], v[232:235]
    s_add_u32 m0, s22, 8192
    s_nop 0
    buffer_load_dwordx4 v2, s[12:15], s19 offen lds
    s_add_u32 s19, s19, s20
    v_mfma_f32_16x16x32_bf16 v[236:239], v[76:79], v[56:59], v[236:239]
    v_mfma_f32_16x16x32_bf16 v[240:243], v[64:67], v[60:63], v[240:243]
    v_mfma_f32_16x16x32_bf16 v[244:247], v[68:71], v[60:63], v[244:247]
    buffer_load_dword v16, v17, s[4:7], s44 offen sc1
    v_mfma_f32_16x16x32_bf16 v[248:251], v[72:75], v[60:63], v[248:251]
    v_mfma_f32_16x16x32_bf16 v[252:255], v[76:79], v[60:63], v[252:255]
    s_waitcnt lgkmcnt(0)
    s_waitcnt vmcnt(8)
    s_barrier
    v_mfma_f32_16x16x32_bf16 v[128:131], v[112:115], v[80:83], v[128:131]
    ds_read_b64_tr_b16 v[64:65], v12 offset:16384
    v_mfma_f32_16x16x32_bf16 v[132:135], v[116:119], v[80:83], v[132:135]
    ds_read_b64_tr_b16 v[66:67], v13 offset:16384
    v_mfma_f32_16x16x32_bf16 v[136:139], v[120:123], v[80:83], v[136:139]
    ds_read_b64_tr_b16 v[68:69], v14 offset:16384
    v_mfma_f32_16x16x32_bf16 v[140:143], v[124:127], v[80:83], v[140:143]
    ds_read_b64_tr_b16 v[70:71], v15 offset:16384
    v_mfma_f32_16x16x32_bf16 v[144:147], v[112:115], v[84:87], v[144:147]
    ds_read_b64_tr_b16 v[72:73], v12 offset:24576
    v_mfma_f32_16x16x32_bf16 v[148:151], v[116:119], v[84:87], v[148:151]
    ds_read_b64_tr_b16 v[74:75], v13 offset:24576
    v_mfma_f32_16x16x32_bf16 v[152:155], v[120:123], v[84:87], v[152:155]
    ds_read_b64_tr_b16 v[76:77], v14 offset:24576
    v_mfma_f32_16x16x32_bf16 v[156:159], v[124:127], v[84:87], v[156:159]
    ds_read_b64_tr_b16 v[78:79], v15 offset:24576
    v_mfma_f32_16x16x32_bf16 v[160:163], v[112:115], v[88:91], v[160:163]
    ds_read_b128 v[32:35], v6 offset:0
    v_mfma_f32_16x16x32_bf16 v[164:167], v[116:119], v[88:91], v[164:167]
    ds_read_b128 v[36:39], v6 offset:1024
    v_mfma_f32_16x16x32_bf16 v[168:171], v[120:123], v[88:91], v[168:171]
    ds_read_b128 v[40:43], v6 offset:2048
    v_mfma_f32_16x16x32_bf16 v[172:175], v[124:127], v[88:91], v[172:175]
    ds_read_b128 v[44:47], v6 offset:3072
    v_mfma_f32_16x16x32_bf16 v[176:179], v[112:115], v[92:95], v[176:179]
    ds_read_b128 v[48:51], v6 offset:4096
    v_mfma_f32_16x16x32_bf16 v[180:183], v[116:119], v[92:95], v[180:183]
    ds_read_b128 v[52:55], v6 offset:5120
    v_mfma_f32_16x16x32_bf16 v[184:187], v[120:123], v[92:95], v[184:187]
    ds_read_b128 v[56:59], v6 offset:6144
    v_mfma_f32_16x16x32_bf16 v[188:191], v[124:127], v[92:95], v[188:191]
    ds_read_b128 v[60:63], v6 offset:7168
    v_mfma_f32_16x16x32_bf16 v[192:195], v[112:115], v[96:99], v[192:195]
    v_mfma_f32_16x16x32_bf16 v[196:199], v[116:119], v[96:99], v[196:199]
    s_add_u32 m0, s21, 32768
    s_nop 0
    buffer_load_dwordx4 v1, s[4:7], s16 offen sc1 lds
    s_add_u32 s16, s16, s62
    v_mfma_f32_16x16x32_bf16 v[200:203], v[120:123], v[96:99], v[200:203]
    v_mfma_f32_16x16x32_bf16 v[204:207], v[124:127], v[96:99], v[204:207]
    v_mfma_f32_16x16x32_bf16 v[208:211], v[112:115], v[100:103], v[208:211]
    s_add_u32 m0, s21, 33792
    s_nop 0
    buffer_load_dwordx4 v1, s[4:7], s17 offen sc1 lds
    s_add_u32 s17, s17, s62
    v_mfma_f32_16x16x32_bf16 v[212:215], v[116:119], v[100:103], v[212:215]
    v_mfma_f32_16x16x32_bf16 v[216:219], v[120:123], v[100:103], v[216:219]
    v_mfma_f32_16x16x32_bf16 v[220:223], v[124:127], v[100:103], v[220:223]
    s_add_u32 m0, s22, 32768
    s_nop 0
    buffer_load_dwordx4 v2, s[8:11], s18 offen lds
    s_add_u32 s18, s18, s20
    v_mfma_f32_16x16x32_bf16 v[224:227], v[112:115], v[104:107], v[224:227]
    v_mfma_f32_16x16x32_bf16 v[228:231], v[116:119], v[104:107], v[228:231]
    v_mfma_f32_16x16x32_bf16 v[232:235], v[120:123], v[104:107], v[232:235]
    s_add_u32 m0, s22, 40960
    s_nop 0
    buffer_load_dwordx4 v2, s[12:15], s19 offen lds
    s_add_u32 s19, s19, s20
    v_mfma_f32_16x16x32_bf16 v[236:239], v[124:127], v[104:107], v[236:239]
    v_mfma_f32_16x16x32_bf16 v[240:243], v[112:115], v[108:111], v[240:243]
    v_mfma_f32_16x16x32_bf16 v[244:247], v[116:119], v[108:111], v[244:247]
    v_mfma_f32_16x16x32_bf16 v[248:251], v[120:123], v[108:111], v[248:251]
    v_mfma_f32_16x16x32_bf16 v[252:255], v[124:127], v[108:111], v[252:255]
    s_waitcnt lgkmcnt(0)
    s_waitcnt vmcnt(8)
    s_barrier
    v_mfma_f32_16x16x32_bf16 v[128:131], v[64:67], v[32:35], v[128:131]
    ds_read_b64_tr_b16 v[112:113], v12 offset:49152
    v_mfma_f32_16x16x32_bf16 v[132:135], v[68:71], v[32:35], v[132:135]
    ds_read_b64_tr_b16 v[114:115], v13 offset:49152
    v_mfma_f32_16x16x32_bf16 v[136:139], v[72:75], v[32:35], v[136:139]
    ds_read_b64_tr_b16 v[116:117], v14 offset:49152
    v_mfma_f32_16x16x32_bf16 v[140:143], v[76:79], v[32:35], v[140:143]
    ds_read_b64_tr_b16 v[118:119], v15 offset:49152
    v_mfma_f32_16x16x32_bf16 v[144:147], v[64:67], v[36:39], v[144:147]
    ds_read_b64_tr_b16 v[120:121], v12 offset:57344
    v_mfma_f32_16x16x32_bf16 v[148:151], v[68:71], v[36:39], v[148:151]
    ds_read_b64_tr_b16 v[122:123], v13 offset:57344
    v_mfma_f32_16x16x32_bf16 v[152:155], v[72:75], v[36:39], v[152:155]
    ds_read_b64_tr_b16 v[124:125], v14 offset:57344
    v_mfma_f32_16x16x32_bf16 v[156:159], v[76:79], v[36:39], v[156:159]
    ds_read_b64_tr_b16 v[126:127], v15 offset:57344
    v_mfma_f32_16x16x32_bf16 v[160:163], v[64:67], v[40:43], v[160:163]
    ds_read_b128 v[80:83], v6 offset:32768
    v_mfma_f32_16x16x32_bf16 v[164:167], v[68:71], v[40:43], v[164:167]
    ds_read_b128 v[84:87], v6 offset:33792
    v_mfma_f32_16x16x32_bf16 v[168:171], v[72:75], v[40:43], v[168:171]
    ds_read_b128 v[88:91], v6 offset:34816
    v_mfma_f32_16x16x32_bf16 v[172:175], v[76:79], v[40:43], v[172:175]
    ds_read_b128 v[92:95], v6 offset:35840
    v_mfma_f32_16x16x32_bf16 v[176:179], v[64:67], v[44:47], v[176:179]
    ds_read_b128 v[96:99], v6 offset:36864
    v_mfma_f32_16x16x32_bf16 v[180:183], v[68:71], v[44:47], v[180:183]
    ds_read_b128 v[100:103], v6 offset:37888
    v_mfma_f32_16x16x32_bf16 v[184:187], v[72:75], v[44:47], v[184:187]
    ds_read_b128 v[104:107], v6 offset:38912
    v_mfma_f32_16x16x32_bf16 v[188:191], v[76:79], v[44:47], v[188:191]
    ds_read_b128 v[108:111], v6 offset:39936
    v_mfma_f32_16x16x32_bf16 v[192:195], v[64:67], v[48:51], v[192:195]
    v_mfma_f32_16x16x32_bf16 v[196:199], v[68:71], v[48:51], v[196:199]
    s_add_u32 m0, s21, 65536
    s_nop 0
    buffer_load_dwordx4 v1, s[4:7], s16 offen sc1 lds
    s_add_u32 s16, s16, s62
    v_mfma_f32_16x16x32_bf16 v[200:203], v[72:75], v[48:51], v[200:203]
    v_mfma_f32_16x16x32_bf16 v[204:207], v[76:79], v[48:51], v[204:207]
    v_mfma_f32_16x16x32_bf16 v[208:211], v[64:67], v[52:55], v[208:211]
    s_add_u32 m0, s21, 66560
    s_nop 0
    buffer_load_dwordx4 v1, s[4:7], s17 offen sc1 lds
    s_add_u32 s17, s17, s62
    v_mfma_f32_16x16x32_bf16 v[212:215], v[68:71], v[52:55], v[212:215]
    v_mfma_f32_16x16x32_bf16 v[216:219], v[72:75], v[52:55], v[216:219]
    v_mfma_f32_16x16x32_bf16 v[220:223], v[76:79], v[52:55], v[220:223]
    s_add_u32 m0, s22, 65536
    s_nop 0
    buffer_load_dwordx4 v2, s[8:11], s18 offen lds
    s_add_u32 s18, s18, s20
    v_mfma_f32_16x16x32_bf16 v[224:227], v[64:67], v[56:59], v[224:227]
    v_mfma_f32_16x16x32_bf16 v[228:231], v[68:71], v[56:59], v[228:231]
    v_mfma_f32_16x16x32_bf16 v[232:235], v[72:75], v[56:59], v[232:235]
    s_add_u32 m0, s22, 73728
    s_nop 0
    buffer_load_dwordx4 v2, s[12:15], s19 offen lds
    s_add_u32 s19, s19, s20
    v_mfma_f32_16x16x32_bf16 v[236:239], v[76:79], v[56:59], v[236:239]
    v_mfma_f32_16x16x32_bf16 v[240:243], v[64:67], v[60:63], v[240:243]
    v_mfma_f32_16x16x32_bf16 v[244:247], v[68:71], v[60:63], v[244:247]
    v_mfma_f32_16x16x32_bf16 v[248:251], v[72:75], v[60:63], v[248:251]
    v_mfma_f32_16x16x32_bf16 v[252:255], v[76:79], v[60:63], v[252:255]
    s_waitcnt lgkmcnt(0)
    s_waitcnt vmcnt(8)
    s_barrier
    v_mfma_f32_16x16x32_bf16 v[128:131], v[112:115], v[80:83], v[128:131]
    ds_read_b64_tr_b16 v[64:65], v8 offset:16384
    v_mfma_f32_16x16x32_bf16 v[132:135], v[116:119], v[80:83], v[132:135]
    ds_read_b64_tr_b16 v[66:67], v9 offset:16384
    v_mfma_f32_16x16x32_bf16 v[136:139], v[120:123], v[80:83], v[136:139]
    ds_read_b64_tr_b16 v[68:69], v10 offset:16384
    v_mfma_f32_16x16x32_bf16 v[140:143], v[124:127], v[80:83], v[140:143]
    ds_read_b64_tr_b16 v[70:71], v11 offset:16384
    v_mfma_f32_16x16x32_bf16 v[144:147], v[112:115], v[84:87], v[144:147]
    ds_read_b64_tr_b16 v[72:73], v8 offset:24576
    v_mfma_f32_16x16x32_bf16 v[148:151], v[116:119], v[84:87], v[148:151]
    ds_read_b64_tr_b16 v[74:75], v9 offset:24576
    v_mfma_f32_16x16x32_bf16 v[152:155], v[120:123], v[84:87], v[152:155]
    ds_read_b64_tr_b16 v[76:77], v10 offset:24576
    v_mfma_f32_16x16x32_bf16 v[156:159], v[124:127], v[84:87], v[156:159]
    ds_read_b64_tr_b16 v[78:79], v11 offset:24576
    v_mfma_f32_16x16x32_bf16 v[160:163], v[112:115], v[88:91], v[160:163]
    ds_read_b128 v[32:35], v5 offset:0
    v_mfma_f32_16x16x32_bf16 v[164:167], v[116:119], v[88:91], v[164:167]
    ds_read_b128 v[36:39], v5 offset:1024
    v_mfma_f32_16x16x32_bf16 v[168:171], v[120:123], v[88:91], v[168:171]
    ds_read_b128 v[40:43], v5 offset:2048
    v_mfma_f32_16x16x32_bf16 v[172:175], v[124:127], v[88:91], v[172:175]
    ds_read_b128 v[44:47], v5 offset:3072
    v_mfma_f32_16x16x32_bf16 v[176:179], v[112:115], v[92:95], v[176:179]
    ds_read_b128 v[48:51], v5 offset:4096
    v_mfma_f32_16x16x32_bf16 v[180:183], v[116:119], v[92:95], v[180:183]
    ds_read_b128 v[52:55], v5 offset:5120
    v_mfma_f32_16x16x32_bf16 v[184:187], v[120:123], v[92:95], v[184:187]
    ds_read_b128 v[56:59], v5 offset:6144
    v_mfma_f32_16x16x32_bf16 v[188:191], v[124:127], v[92:95], v[188:191]
    ds_read_b128 v[60:63], v5 offset:7168
    v_mfma_f32_16x16x32_bf16 v[192:195], v[112:115], v[96:99], v[192:195]
    v_mfma_f32_16x16x32_bf16 v[196:199], v[116:119], v[96:99], v[196:199]
    s_add_u32 m0, s21, 98304
    s_nop 0
    buffer_load_dwordx4 v1, s[4:7], s16 offen sc1 lds
    s_add_u32 s16, s16, s62
    v_mfma_f32_16x16x32_bf16 v[200:203], v[120:123], v[96:99], v[200:203]
    v_mfma_f32_16x16x32_bf16 v[204:207], v[124:127], v[96:99], v[204:207]
    v_mfma_f32_16x16x32_bf16 v[208:211], v[112:115], v[100:103], v[208:211]
    s_add_u32 m0, s21, 99328
    s_nop 0
    buffer_load_dwordx4 v1, s[4:7], s17 offen sc1 lds
    s_add_u32 s17, s17, s62
    v_mfma_f32_16x16x32_bf16 v[212:215], v[116:119], v[100:103], v[212:215]
    v_mfma_f32_16x16x32_bf16 v[216:219], v[120:123], v[100:103], v[216:219]
    v_mfma_f32_16x16x32_bf16 v[220:223], v[124:127], v[100:103], v[220:223]
    s_add_u32 m0, s22, 98304
    s_nop 0
    buffer_load_dwordx4 v2, s[8:11], s18 offen lds
    s_add_u32 s18, s18, s20
    v_mfma_f32_16x16x32_bf16 v[224:227], v[112:115], v[104:107], v[224:227]
    v_mfma_f32_16x16x32_bf16 v[228:231], v[116:119], v[104:107], v[228:231]
    v_mfma_f32_16x16x32_bf16 v[232:235], v[120:123], v[104:107], v[232:235]
    s_add_u32 m0, s22, 106496
    s_nop 0
    buffer_load_dwordx4 v2, s[12:15], s19 offen lds
    s_add_u32 s19, s19, s20
    v_mfma_f32_16x16x32_bf16 v[236:239], v[124:127], v[104:107], v[236:239]
    v_mfma_f32_16x16x32_bf16 v[240:243], v[112:115], v[108:111], v[240:243]
    v_mfma_f32_16x16x32_bf16 v[244:247], v[116:119], v[108:111], v[244:247]
    v_mfma_f32_16x16x32_bf16 v[248:251], v[120:123], v[108:111], v[248:251]
    v_mfma_f32_16x16x32_bf16 v[252:255], v[124:127], v[108:111], v[252:255]
    s_waitcnt lgkmcnt(0)
    s_sub_u32 s23, s23, 1
    s_cmp_lg_u32 s23, 0
    s_cbranch_scc1 w_loop
    s_branch w_end
w_nd:
    s_waitcnt vmcnt(8)
    s_barrier
    v_mfma_f32_16x16x32_bf16 v[128:131], v[64:67], v[32:35], v[128:131]
    ds_read_b64_tr_b16 v[112:113], v8 offset:49152
    v_mfma_f32_16x16x32_bf16 v[132:135], v[68:71], v[32:35], v[132:135]
    ds_read_b64_tr_b16 v[114:115], v9 offset:49152
    v_mfma_f32_16x16x32_bf16 v[136:139], v[72:75], v[32:35], v[136:139]
    ds_read_b64_tr_b16 v[116:117], v10 offset:49152
    v_mfma_f32_16x16x32_bf16 v[140:143], v[76:79], v[32:35], v[140:143]
    ds_read_b64_tr_b16 v[118:119], v11 offset:49152
    v_mfma_f32_16x16x32_bf16 v[144:147], v[64:67], v[36:39], v[144:147]
    ds_read_b64_tr_b16 v[120:121], v8 offset:57344
    v_mfma_f32_16x16x32_bf16 v[148:151], v[68:71], v[36:39], v[148:151]
    ds_read_b64_tr_b16 v[122:123], v9 offset:57344
    v_mfma_f32_16x16x32_bf16 v[152:155], v[72:75], v[36:39], v[152:155]
    ds_read_b64_tr_b16 v[124:125], v10 offset:57344
    v_mfma_f32_16x16x32_bf16 v[156:159], v[76:79], v[36:39], v[156:159]
    ds_read_b64_tr_b16 v[126:127], v11 offset:57344
    v_mfma_f32_16x16x32_bf16 v[160:163], v[64:67], v[40:43], v[160:163]
    ds_read_b128 v[80:83], v5 offset:32768
    v_mfma_f32_16x16x32_bf16 v[164:167], v[68:71], v[40:43], v[164:167]
    ds_read_b128 v[84:87], v5 offset:33792
    v_mfma_f32_16x16x32_bf16 v[168:171], v[72:75], v[40:43], v[168:171]
    ds_read_b128 v[88:91], v5 offset:34816
    v_mfma_f32_16x16x32_bf16 v[172:175], v[76:79], v[40:43], v[172:175]
    ds_read_b128 v[92:95], v5 offset:35840
    v_mfma_f32_16x16x32_bf16 v[176:179], v[64:67], v[44:47], v[176:179]
    ds_read_b128 v[96:99], v5 offset:36864
    v_mfma_f32_16x16x32_bf16 v[180:183], v[68:71], v[44:47], v[180:183]
    ds_read_b128 v[100:103], v5 offset:37888
    v_mfma_f32_16x16x32_bf16 v[184:187], v[72:75], v[44:47], v[184:187]
    ds_read_b128 v[104:107], v5 offset:38912
    v_mfma_f32_16x16x32_bf16 v[188:191], v[76:79], v[44:47], v[188:191]
    ds_read_b128 v[108:111], v5 offset:39936
    v_mfma_f32_16x16x32_bf16 v[192:195], v[64:67], v[48:51], v[192:195]
    v_mfma_f32_16x16x32_bf16 v[196:199], v[68:71], v[48:51], v[196:199]
    v_mfma_f32_16x16x32_bf16 v[200:203], v[72:75], v[48:51], v[200:203]
    v_mfma_f32_16x16x32_bf16 v[204:207], v[76:79], v[48:51], v[204:207]
    v_mfma_f32_16x16x32_bf16 v[208:211], v[64:67], v[52:55], v[208:211]
    v_mfma_f32_16x16x32_bf16 v[212:215], v[68:71], v[52:55], v[212:215]
    v_mfma_f32_16x16x32_bf16 v[216:219], v[72:75], v[52:55], v[216:219]
    v_mfma_f32_16x16x32_bf16 v[220:223], v[76:79], v[52:55], v[220:223]
    v_mfma_f32_16x16x32_bf16 v[224:227], v[64:67], v[56:59], v[224:227]
    v_mfma_f32_16x16x32_bf16 v[228:231], v[68:71], v[56:59], v[228:231]
    v_mfma_f32_16x16x32_bf16 v[232:235], v[72:75], v[56:59], v[232:235]
    v_mfma_f32_16x16x32_bf16 v[236:239], v[76:79], v[56:59], v[236:239]
    v_mfma_f32_16x16x32_bf16 v[240:243], v[64:67], v[60:63], v[240:243]
    v_mfma_f32_16x16x32_bf16 v[244:247], v[68:71], v[60:63], v[244:247]
    v_mfma_f32_16x16x32_bf16 v[248:251], v[72:75], v[60:63], v[248:251]
    v_mfma_f32_16x16x32_bf16 v[252:255], v[76:79], v[60:63], v[252:255]
    s_waitcnt lgkmcnt(0)
    s_waitcnt vmcnt(4)
    s_barrier
    v_mfma_f32_16x16x32_bf16 v[128:131], v[112:115], v[80:83], v[128:131]
    ds_read_b64_tr_b16 v[64:65], v12 offset:16384
    v_mfma_f32_16x16x32_bf16 v[132:135], v[116:119], v[80:83], v[132:135]
    ds_read_b64_tr_b16 v[66:67], v13 offset:16384
    v_mfma_f32_16x16x32_bf16 v[136:139], v[120:123], v[80:83], v[136:139]
    ds_read_b64_tr_b16 v[68:69], v14 offset:16384
    v_mfma_f32_16x16x32_bf16 v[140:143], v[124:127], v[80:83], v[140:143]
    ds_read_b64_tr_b16 v[70:71], v15 offset:16384
    v_mfma_f32_16x16x32_bf16 v[144:147], v[112:115], v[84:87], v[144:147]
    ds_read_b64_tr_b16 v[72:73], v12 offset:24576
    v_mfma_f32_16x16x32_bf16 v[148:151], v[116:119], v[84:87], v[148:151]
    ds_read_b64_tr_b16 v[74:75], v13 offset:24576
    v_mfma_f32_16x16x32_bf16 v[152:155], v[120:123], v[84:87], v[152:155]
    ds_read_b64_tr_b16 v[76:77], v14 offset:24576
    v_mfma_f32_16x16x32_bf16 v[156:159], v[124:127], v[84:87], v[156:159]
    ds_read_b64_tr_b16 v[78:79], v15 offset:24576
    v_mfma_f32_16x16x32_bf16 v[160:163], v[112:115], v[88:91], v[160:163]
    ds_read_b128 v[32:35], v6 offset:0
    v_mfma_f32_16x16x32_bf16 v[164:167], v[116:119], v[88:91], v[164:167]
    ds_read_b128 v[36:39], v6 offset:1024
    v_mfma_f32_16x16x32_bf16 v[168:171], v[120:123], v[88:91], v[168:171]
    ds_read_b128 v[40:43], v6 offset:2048
    v_mfma_f32_16x16x32_bf16 v[172:175], v[124:127], v[88:91], v[172:175]
    ds_read_b128 v[44:47], v6 offset:3072
    v_mfma_f32_16x16x32_bf16 v[176:179], v[112:115], v[92:95], v[176:179]
    ds_read_b128 v[48:51], v6 offset:4096
    v_mfma_f32_16x16x32_bf16 v[180:183], v[116:119], v[92:95], v[180:183]
    ds_read_b128 v[52:55], v6 offset:5120
    v_mfma_f32_16x16x32_bf16 v[184:187], v[120:123], v[92:95], v[184:187]
    ds_read_b128 v[56:59], v6 offset:6144
    v_mfma_f32_16x16x32_bf16 v[188:191], v[124:127], v[92:95], v[188:191]
    ds_read_b128 v[60:63], v6 offset:7168
    v_mfma_f32_16x16x32_bf16 v[192:195], v[112:115], v[96:99], v[192:195]
    v_mfma_f32_16x16x32_bf16 v[196:199], v[116:119], v[96:99], v[196:199]
    v_mfma_f32_16x16x32_bf16 v[200:203], v[120:123], v[96:99], v[200:203]
    v_mfma_f32_16x16x32_bf16 v[204:207], v[124:127], v[96:99], v[204:207]
    v_mfma_f32_16x16x32_bf16 v[208:211], v[112:115], v[100:103], v[208:211]
    v_mfma_f32_16x16x32_bf16 v[212:215], v[116:119], v[100:103], v[212:215]
    v_mfma_f32_16x16x32_bf16 v[216:219], v[120:123], v[100:103], v[216:219]
    v_mfma_f32_16x16x32_bf16 v[220:223], v[124:127], v[100:103], v[220:223]
    v_mfma_f32_16x16x32_bf16 v[224:227], v[112:115], v[104:107], v[224:227]
    v_mfma_f32_16x16x32_bf16 v[228:231], v[116:119], v[104:107], v[228:231]
    v_mfma_f32_16x16x32_bf16 v[232:235], v[120:123], v[104:107], v[232:235]
    v_mfma_f32_16x16x32_bf16 v[236:239], v[124:127], v[104:107], v[236:239]
    v_mfma_f32_16x16x32_bf16 v[240:243], v[112:115], v[108:111], v[240:243]
    v_mfma_f32_16x16x32_bf16 v[244:247], v[116:119], v[108:111], v[244:247]
    v_mfma_f32_16x16x32_bf16 v[248:251], v[120:123], v[108:111], v[248:251]
    v_mfma_f32_16x16x32_bf16 v[252:255], v[124:127], v[108:111], v[252:255]
    s_waitcnt lgkmcnt(0)
    s_waitcnt vmcnt(0)
    s_barrier
    v_mfma_f32_16x16x32_bf16 v[128:131], v[64:67], v[32:35], v[128:131]
    ds_read_b64_tr_b16 v[112:113], v12 offset:49152
    v_mfma_f32_16x16x32_bf16 v[132:135], v[68:71], v[32:35], v[132:135]
    ds_read_b64_tr_b16 v[114:115], v13 offset:49152
    v_mfma_f32_16x16x32_bf16 v[136:139], v[72:75], v[32:35], v[136:139]
    ds_read_b64_tr_b16 v[116:117], v14 offset:49152
    v_mfma_f32_16x16x32_bf16 v[140:143], v[76:79], v[32:35], v[140:143]
    ds_read_b64_tr_b16 v[118:119], v15 offset:49152
    v_mfma_f32_16x16x32_bf16 v[144:147], v[64:67], v[36:39], v[144:147]
    ds_read_b64_tr_b16 v[120:121], v12 offset:57344
    v_mfma_f32_16x16x32_bf16 v[148:151], v[68:71], v[36:39], v[148:151]
    ds_read_b64_tr_b16 v[122:123], v13 offset:57344
    v_mfma_f32_16x16x32_bf16 v[152:155], v[72:75], v[36:39], v[152:155]
    ds_read_b64_tr_b16 v[124:125], v14 offset:57344
    v_mfma_f32_16x16x32_bf16 v[156:159], v[76:79], v[36:39], v[156:159]
    ds_read_b64_tr_b16 v[126:127], v15 offset:57344
    v_mfma_f32_16x16x32_bf16 v[160:163], v[64:67], v[40:43], v[160:163]
    ds_read_b128 v[80:83], v6 offset:32768
    v_mfma_f32_16x16x32_bf16 v[164:167], v[68:71], v[40:43], v[164:167]
    ds_read_b128 v[84:87], v6 offset:33792
    v_mfma_f32_16x16x32_bf16 v[168:171], v[72:75], v[40:43], v[168:171]
    ds_read_b128 v[88:91], v6 offset:34816
    v_mfma_f32_16x16x32_bf16 v[172:175], v[76:79], v[40:43], v[172:175]
    ds_read_b128 v[92:95], v6 offset:35840
    v_mfma_f32_16x16x32_bf16 v[176:179], v[64:67], v[44:47], v[176:179]
    ds_read_b128 v[96:99], v6 offset:36864
    v_mfma_f32_16x16x32_bf16 v[180:183], v[68:71], v[44:47], v[180:183]
    ds_read_b128 v[100:103], v6 offset:37888
    v_mfma_f32_16x16x32_bf16 v[184:187], v[72:75], v[44:47], v[184:187]
    ds_read_b128 v[104:107], v6 offset:38912
    v_mfma_f32_16x16x32_bf16 v[188:191], v[76:79], v[44:47], v[188:191]
    ds_read_b128 v[108:111], v6 offset:39936
    v_mfma_f32_16x16x32_bf16 v[192:195], v[64:67], v[48:51], v[192:195]
    v_mfma_f32_16x16x32_bf16 v[196:199], v[68:71], v[48:51], v[196:199]
    v_mfma_f32_16x16x32_bf16 v[200:203], v[72:75], v[48:51], v[200:203]
    v_mfma_f32_16x16x32_bf16 v[204:207], v[76:79], v[48:51], v[204:207]
    v_mfma_f32_16x16x32_bf16 v[208:211], v[64:67], v[52:55], v[208:211]
    v_mfma_f32_16x16x32_bf16 v[212:215], v[68:71], v[52:55], v[212:215]
    v_mfma_f32_16x16x32_bf16 v[216:219], v[72:75], v[52:55], v[216:219]
    v_mfma_f32_16x16x32_bf16 v[220:223], v[76:79], v[52:55], v[220:223]
    v_mfma_f32_16x16x32_bf16 v[224:227], v[64:67], v[56:59], v[224:227]
    v_mfma_f32_16x16x32_bf16 v[228:231], v[68:71], v[56:59], v[228:231]
    v_mfma_f32_16x16x32_bf16 v[232:235], v[72:75], v[56:59], v[232:235]
    v_mfma_f32_16x16x32_bf16 v[236:239], v[76:79], v[56:59], v[236:239]
    v_mfma_f32_16x16x32_bf16 v[240:243], v[64:67], v[60:63], v[240:243]
    v_mfma_f32_16x16x32_bf16 v[244:247], v[68:71], v[60:63], v[244:247]
    v_mfma_f32_16x16x32_bf16 v[248:251], v[72:75], v[60:63], v[248:251]
    v_mfma_f32_16x16x32_bf16 v[252:255], v[76:79], v[60:63], v[252:255]
    s_waitcnt lgkmcnt(0)
    s_waitcnt vmcnt(0)
    s_barrier
    v_mfma_f32_16x16x32_bf16 v[128:131], v[112:115], v[80:83], v[128:131]
    ds_read_b64_tr_b16 v[64:65], v8 offset:16384
    v_mfma_f32_16x16x32_bf16 v[132:135], v[116:119], v[80:83], v[132:135]
    ds_read_b64_tr_b16 v[66:67], v9 offset:16384
    v_mfma_f32_16x16x32_bf16 v[136:139], v[120:123], v[80:83], v[136:139]
    ds_read_b64_tr_b16 v[68:69], v10 offset:16384
    v_mfma_f32_16x16x32_bf16 v[140:143], v[124:127], v[80:83], v[140:143]
    ds_read_b64_tr_b16 v[70:71], v11 offset:16384
    v_mfma_f32_16x16x32_bf16 v[144:147], v[112:115], v[84:87], v[144:147]
    ds_read_b64_tr_b16 v[72:73], v8 offset:24576
    v_mfma_f32_16x16x32_bf16 v[148:151], v[116:119], v[84:87], v[148:151]
    ds_read_b64_tr_b16 v[74:75], v9 offset:24576
    v_mfma_f32_16x16x32_bf16 v[152:155], v[120:123], v[84:87], v[152:155]
    ds_read_b64_tr_b16 v[76:77], v10 offset:24576
    v_mfma_f32_16x16x32_bf16 v[156:159], v[124:127], v[84:87], v[156:159]
    ds_read_b64_tr_b16 v[78:79], v11 offset:24576
    v_mfma_f32_16x16x32_bf16 v[160:163], v[112:115], v[88:91], v[160:163]
    ds_read_b128 v[32:35], v5 offset:0
    v_mfma_f32_16x16x32_bf16 v[164:167], v[116:119], v[88:91], v[164:167]
    ds_read_b128 v[36:39], v5 offset:1024
    v_mfma_f32_16x16x32_bf16 v[168:171], v[120:123], v[88:91], v[168:171]
    ds_read_b128 v[40:43], v5 offset:2048
    v_mfma_f32_16x16x32_bf16 v[172:175], v[124:127], v[88:91], v[172:175]
    ds_read_b128 v[44:47], v5 offset:3072
    v_mfma_f32_16x16x32_bf16 v[176:179], v[112:115], v[92:95], v[176:179]
    ds_read_b128 v[48:51], v5 offset:4096
    v_mfma_f32_16x16x32_bf16 v[180:183], v[116:119], v[92:95], v[180:183]
    ds_read_b128 v[52:55], v5 offset:5120
    v_mfma_f32_16x16x32_bf16 v[184:187], v[120:123], v[92:95], v[184:187]
    ds_read_b128 v[56:59], v5 offset:6144
    v_mfma_f32_16x16x32_bf16 v[188:191], v[124:127], v[92:95], v[188:191]
    ds_read_b128 v[60:63], v5 offset:7168
    v_mfma_f32_16x16x32_bf16 v[192:195], v[112:115], v[96:99], v[192:195]
    v_mfma_f32_16x16x32_bf16 v[196:199], v[116:119], v[96:99], v[196:199]
    v_mfma_f32_16x16x32_bf16 v[200:203], v[120:123], v[96:99], v[200:203]
    v_mfma_f32_16x16x32_bf16 v[204:207], v[124:127], v[96:99], v[204:207]
    v_mfma_f32_16x16x32_bf16 v[208:211], v[112:115], v[100:103], v[208:211]
    v_mfma_f32_16x16x32_bf16 v[212:215], v[116:119], v[100:103], v[212:215]
    v_mfma_f32_16x16x32_bf16 v[216:219], v[120:123], v[100:103], v[216:219]
    v_mfma_f32_16x16x32_bf16 v[220:223], v[124:127], v[100:103], v[220:223]
    v_mfma_f32_16x16x32_bf16 v[224:227], v[112:115], v[104:107], v[224:227]
    v_mfma_f32_16x16x32_bf16 v[228:231], v[116:119], v[104:107], v[228:231]
    v_mfma_f32_16x16x32_bf16 v[232:235], v[120:123], v[104:107], v[232:235]
    v_mfma_f32_16x16x32_bf16 v[236:239], v[124:127], v[104:107], v[236:239]
    v_mfma_f32_16x16x32_bf16 v[240:243], v[112:115], v[108:111], v[240:243]
    v_mfma_f32_16x16x32_bf16 v[244:247], v[116:119], v[108:111], v[244:247]
    v_mfma_f32_16x16x32_bf16 v[248:251], v[120:123], v[108:111], v[248:251]
    v_mfma_f32_16x16x32_bf16 v[252:255], v[124:127], v[108:111], v[252:255]
    s_waitcnt lgkmcnt(0)
w_end:
    v_mov_b32 v20, 131072
    ds_read_b128 v[24:27], v20
    ds_read_b128 v[28:31], v20 offset:16
    s_cmp_eq_u32 s48, 2
    s_cbranch_scc1 w_epi_glu
    s_cmp_eq_u32 s48, 3
    s_cbranch_scc1 w_epi_silu
    s_lshl_b32 s30, s27, 10
    s_add_u32 s30, s30, s49
    s_nop 7
    v_cvt_pk_bf16_f32 v80, v128, v129
    v_cvt_pk_bf16_f32 v81, v130, v131
    v_cvt_pk_bf16_f32 v82, v132, v133
    v_cvt_pk_bf16_f32 v83, v134, v135
    buffer_store_dwordx4 v[80:83], v1, s[4:7], s30 offen sc1
    v_cvt_pk_bf16_f32 v84, v136, v137
    v_cvt_pk_bf16_f32 v85, v138, v139
    v_cvt_pk_bf16_f32 v86, v140, v141
    v_cvt_pk_bf16_f32 v87, v142, v143
    buffer_store_dwordx4 v[84:87], v19, s[4:7], s30 offen sc1
    s_add_u32 s30, s30, s50
    v_cvt_pk_bf16_f32 v88, v144, v145
    v_cvt_pk_bf16_f32 v89, v146, v147
    v_cvt_pk_bf16_f32 v90, v148, v149
    v_cvt_pk_bf16_f32 v91, v150, v151
    buffer_store_dwordx4 v[88:91], v1, s[4:7], s30 offen sc1
    v_cvt_pk_bf16_f32 v92, v152, v153
    v_cvt_pk_bf16_f32 v93, v154, v155
    v_cvt_pk_bf16_f32 v94, v156, v157
    v_cvt_pk_bf16_f32 v95, v158, v159
    buffer_store_dwordx4 v[92:95], v19, s[4:7], s30 offen sc1
    s_add_u32 s30, s30, s50
    v_cvt_pk_bf16_f32 v80, v160, v161
    v_cvt_pk_bf16_f32 v81, v162, v163
    v_cvt_pk_bf16_f32 v82, v164, v165
    v_cvt_pk_bf16_f32 v83, v166, v167
    buffer_store_dwordx4 v[80:83], v1, s[4:7], s30 offen sc1
    v_cvt_pk_bf16_f32 v84, v168, v169
    v_cvt_pk_bf16_f32 v85, v170, v171
    v_cvt_pk_bf16_f32 v86, v172, v173
    v_cvt_pk_bf16_f32 v87, v174, v175
    buffer_store_dwordx4 v[84:87], v19, s[4:7], s30 offen sc1
    s_add_u32 s30, s30, s50
    v_cvt_pk_bf16_f32 v88, v176, v177
    v_cvt_pk_bf16_f32 v89, v178, v179
    v_cvt_pk_bf16_f32 v90, v180, v181
    v_cvt_pk_bf16_f32 v91, v182, v183
    buffer_store_dwordx4 v[88:91], v1, s[4:7], s30 offen sc1
    v_cvt_pk_bf16_f32 v92, v184, v185
    v_cvt_pk_bf16_f32 v93, v186, v187
    v_cvt_pk_bf16_f32 v94, v188, v189
    v_cvt_pk_bf16_f32 v95, v190, v191
    buffer_store_dwordx4 v[92:95], v19, s[4:7], s30 offen sc1
    s_add_u32 s30, s30, s50
    v_cvt_pk_bf16_f32 v80, v192, v193
    v_cvt_pk_bf16_f32 v81, v194, v195
    v_cvt_pk_bf16_f32 v82, v196, v197
    v_cvt_pk_bf16_f32 v83, v198, v199
    buffer_store_dwordx4 v[80:83], v1, s[4:7], s30 offen sc1
    v_cvt_pk_bf16_f32 v84, v200, v201
    v_cvt_pk_bf16_f32 v85, v202, v203
    v_cvt_pk_bf16_f32 v86, v204, v205
    v_cvt_pk_bf16_f32 v87, v206, v207
    buffer_store_dwordx4 v[84:87], v19, s[4:7], s30 offen sc1
    s_add_u32 s30, s30, s50
    v_cvt_pk_bf16_f32 v88, v208, v209
    v_cvt_pk_bf16_f32 v89, v210, v211
    v_cvt_pk_bf16_f32 v90, v212, v213
    v_cvt_pk_bf16_f32 v91, v214, v215
    buffer_store_dwordx4 v[88:91], v1, s[4:7], s30 offen sc1
    v_cvt_pk_bf16_f32 v92, v216, v217
    v_cvt_pk_bf16_f32 v93, v218, v219
    v_cvt_pk_bf16_f32 v94, v220, v221
    v_cvt_pk_bf16_f32 v95, v222, v223
    buffer_store_dwordx4 v[92:95], v19, s[4:7], s30 offen sc1
    s_add_u32 s30, s30, s50
    v_cvt_pk_bf16_f32 v80, v224, v225
    v_cvt_pk_bf16_f32 v81, v226, v227
    v_cvt_pk_bf16_f32 v82, v228, v229
    v_cvt_pk_bf16_f32 v83, v230, v231
    buffer_store_dwordx4 v[80:83], v1, s[4:7], s30 offen sc1
    v_cvt_pk_bf16_f32 v84, v232, v233
    v_cvt_pk_bf16_f32 v85, v234, v235
    v_cvt_pk_bf16_f32 v86, v236, v237
    v_cvt_pk_bf16_f32 v87, v238, v239
    buffer_store_dwordx4 v[84:87], v19, s[4:7], s30 offen sc1
    s_add_u32 s30, s30, s50
    v_cvt_pk_bf16_f32 v88, v240, v241
    v_cvt_pk_bf16_f32 v89, v242, v243
    v_cvt_pk_bf16_f32 v90, v244, v245
    v_cvt_pk_bf16_f32 v91, v246, v247
    buffer_store_dwordx4 v[88:91], v1, s[4:7], s30 offen sc1
    v_cvt_pk_bf16_f32 v92, v248, v249
    v_cvt_pk_bf16_f32 v93, v250, v251
    v_cvt_pk_bf16_f32 v94, v252, v253
    v_cvt_pk_bf16_f32 v95, v254, v255
    buffer_store_dwordx4 v[92:95], v19, s[4:7], s30 offen sc1
    s_waitcnt lgkmcnt(0)
    v_or3_b32 v24, v24, v25, v26
    v_or3_b32 v28, v28, v29, v30
    v_or3_b32 v24, v24, v27, v31
    v_or_b32 v24, v24, v28
    s_mov_b32 s28, s51
    s_mov_b32 s57, s53
    v_readfirstlane_b32 s30, v24
    s_cmp_lg_u32 s30, 0
    s_cbranch_scc1 w_drain
    s_mov_b32 s48, s32
    s_cmp_ge_u32 s32, 4
    s_cselect_b32 s30, 2, 3
    s_lshl_b32 s30, s26, s30
    s_mul_i32 s30, s30, s43
    s_add_u32 s49, s42, s30
    s_mov_b32 s50, s43
    s_mov_b32 s51, s46
    s_mov_b32 s23, s41
    s_mov_b32 s53, s47
    s_nop 0
    s_load_dwordx16 s[32:47], s[24:25], 0
    s_add_u32 s24, s24, 64
    s_addc_u32 s25, s25, 0
    s_branch w_first16
w_epi_glu:
    s_lshl_b32 s30, s27, 10
    s_add_u32 s30, s30, s49
    s_mov_b32 s54, 0xbfb8aa3b
    s_nop 7
    v_cvt_pk_bf16_f32 v80, v128, v129
    v_cvt_pk_bf16_f32 v81, v130, v131
    v_cvt_pk_bf16_f32 v82, v132, v133
    v_cvt_pk_bf16_f32 v83, v134, v135
    v_lshlrev_b32 v96, 16, v80
    v_and_b32 v97, 0xffff0000, v80
    v_lshlrev_b32 v98, 16, v81
    v_and_b32 v99, 0xffff0000, v81
    v_lshlrev_b32 v100, 16, v82
    v_and_b32 v101, 0xffff0000, v82
    v_lshlrev_b32 v102, 16, v83
    v_and_b32 v103, 0xffff0000, v83
    v_mul_f32 v96, s54, v96
    v_mul_f32 v97, s54, v97
    v_mul_f32 v98, s54, v98
    v_mul_f32 v99, s54, v99
    v_mul_f32 v100, s54, v100
    v_mul_f32 v101, s54, v101
    v_mul_f32 v102, s54, v102
    v_mul_f32 v103, s54, v103
    v_exp_f32 v96, v96
    v_exp_f32 v97, v97
    v_exp_f32 v98, v98
    v_exp_f32 v99, v99
    v_exp_f32 v100, v100
    v_exp_f32 v101, v101
    v_exp_f32 v102, v102
    v_exp_f32 v103, v103
    v_add_f32 v96, 1.0, v96
    v_add_f32 v97, 1.0, v97
    v_add_f32 v98, 1.0, v98
    v_add_f32 v99, 1.0, v99
    v_add_f32 v100, 1.0, v100
    v_add_f32 v101, 1.0, v101
    v_add_f32 v102, 1.0, v102
    v_add_f32 v103, 1.0, v103
    v_rcp_f32 v96, v96
    v_rcp_f32 v97, v97
    v_rcp_f32 v98, v98
    v_rcp_f32 v99, v99
    v_rcp_f32 v100, v100
    v_rcp_f32 v101, v101
    v_rcp_f32 v102, v102
    v_rcp_f32 v103, v103
    v_mul_f32 v96, v96, v136
    v_mul_f32 v97, v97, v137
    v_mul_f32 v98, v98, v138
    v_mul_f32 v99, v99, v139
    v_mul_f32 v100, v100, v140
    v_mul_f32 v101, v101, v141
    v_mul_f32 v102, v102, v142
    v_mul_f32 v103, v103, v143
    v_cvt_pk_bf16_f32 v80, v96, v97
    v_cvt_pk_bf16_f32 v81, v98, v99
    v_cvt_pk_bf16_f32 v82, v100, v101
    v_cvt_pk_bf16_f32 v83, v102, v103
    buffer_store_dwordx4 v[80:83], v1, s[4:7], s30 offen sc1
    s_add_u32 s30, s30, s50
    v_cvt_pk_bf16_f32 v84, v144, v145
    v_cvt_pk_bf16_f32 v85, v146, v147
    v_cvt_pk_bf16_f32 v86, v148, v149
    v_cvt_pk_bf16_f32 v87, v150, v151
    v_lshlrev_b32 v104, 16, v84
    v_and_b32 v105, 0xffff0000, v84
    v_lshlrev_b32 v106, 16, v85
    v_and_b32 v107, 0xffff0000, v85
    v_lshlrev_b32 v108, 16, v86
    v_and_b32 v109, 0xffff0000, v86
    v_lshlrev_b32 v110, 16, v87
    v_and_b32 v111, 0xffff0000, v87
    v_mul_f32 v104, s54, v104
    v_mul_f32 v105, s54, v105
    v_mul_f32 v106, s54, v106
    v_mul_f32 v107, s54, v107
    v_mul_f32 v108, s54, v108
    v_mul_f32 v109, s54, v109
    v_mul_f32 v110, s54, v110
    v_mul_f32 v111, s54, v111
    v_exp_f32 v104, v104
    v_exp_f32 v105, v105
    v_exp_f32 v106, v106
    v_exp_f32 v107, v107
    v_exp_f32 v108, v108
    v_exp_f32 v109, v109
    v_exp_f32 v110, v110
    v_exp_f32 v111, v111
    v_add_f32 v104, 1.0, v104
    v_add_f32 v105, 1.0, v105
    v_add_f32 v106, 1.0, v106
    v_add_f32 v107, 1.0, v107
    v_add_f32 v108, 1.0, v108
    v_add_f32 v109, 1.0, v109
    v_add_f32 v110, 1.0, v110
    v_add_f32 v111, 1.0, v111
    v_rcp_f32 v104, v104
    v_rcp_f32 v105, v105
    v_rcp_f32 v106, v106
    v_rcp_f32 v107, v107
    v_rcp_f32 v108, v108
    v_rcp_f32 v109, v109
    v_rcp_f32 v110, v110
    v_rcp_f32 v111, v111
    v_mul_f32 v104, v104, v152
    v_mul_f32 v105, v105, v153
    v_mul_f32 v106, v106, v154
    v_mul_f32 v107, v107, v155
    v_mul_f32 v108, v108, v156
    v_mul_f32 v109, v109, v157
    v_mul_f32 v110, v110, v158
    v_mul_f32 v111, v111, v159
    v_cvt_pk_bf16_f32 v84, v104, v105
    v_cvt_pk_bf16_f32 v85, v106, v107
    v_cvt_pk_bf16_f32 v86, v108, v109
    v_cvt_pk_bf16_f32 v87, v110, v111
    buffer_store_dwordx4 v[84:87], v1, s[4:7], s30 offen sc1
    s_add_u32 s30, s30, s50
    v_cvt_pk_bf16_f32 v88, v160, v161
    v_cvt_pk_bf16_f32 v89, v162, v163
    v_cvt_pk_bf16_f32 v90, v164, v165
    v_cvt_pk_bf16_f32 v91, v166, v167
    v_lshlrev_b32 v96, 16, v88
    v_and_b32 v97, 0xffff0000, v88
    v_lshlrev_b32 v98, 16, v89
    v_and_b32 v99, 0xffff0000, v89
    v_lshlrev_b32 v100, 16, v90
    v_and_b32 v101, 0xffff0000, v90
    v_lshlrev_b32 v102, 16, v91
    v_and_b32 v103, 0xffff0000, v91
    v_mul_f32 v96, s54, v96
    v_mul_f32 v97, s54, v97
    v_mul_f32 v98, s54, v98
    v_mul_f32 v99, s54, v99
    v_mul_f32 v100, s54, v100
    v_mul_f32 v101, s54, v101
    v_mul_f32 v102, s54, v102
    v_mul_f32 v103, s54, v103
    v_exp_f32 v96, v96
    v_exp_f32 v97, v97
    v_exp_f32 v98, v98
    v_exp_f32 v99, v99
    v_exp_f32 v100, v100
    v_exp_f32 v101, v101
    v_exp_f32 v102, v102
    v_exp_f32 v103, v103
    v_add_f32 v96, 1.0, v96
    v_add_f32 v97, 1.0, v97
    v_add_f32 v98, 1.0, v98
    v_add_f32 v99, 1.0, v99
    v_add_f32 v100, 1.0, v100
    v_add_f32 v101, 1.0, v101
    v_add_f32 v102, 1.0, v102
    v_add_f32 v103, 1.0, v103
    v_rcp_f32 v96, v96
    v_rcp_f32 v97, v97
    v_rcp_f32 v98, v98
    v_rcp_f32 v99, v99
    v_rcp_f32 v100, v100
    v_rcp_f32 v101, v101
    v_rcp_f32 v102, v102
    v_rcp_f32 v103, v103
    v_mul_f32 v96, v96, v168
    v_mul_f32 v97, v97, v169
    v_mul_f32 v98, v98, v170
    v_mul_f32 v99, v99, v171
    v_mul_f32 v100, v100, v172
    v_mul_f32 v101, v101, v173
    v_mul_f32 v102, v102, v174
    v_mul_f32 v103, v103, v175
    v_cvt_pk_bf16_f32 v88, v96, v97
    v_cvt_pk_bf16_f32 v89, v98, v99
    v_cvt_pk_bf16_f32 v90, v100, v101
    v_cvt_pk_bf16_f32 v91, v102, v103
    buffer_store_dwordx4 v[88:91], v1, s[4:7], s30 offen sc1
    s_add_u32 s30, s30, s50
    v_cvt_pk_bf16_f32 v92, v176, v177
    v_cvt_pk_bf16_f32 v93, v178, v179
    v_cvt_pk_bf16_f32 v94, v180, v181
    v_cvt_pk_bf16_f32 v95, v182, v183
    v_lshlrev_b32 v104, 16, v92
    v_and_b32 v105, 0xffff0000, v92
    v_lshlrev_b32 v106, 16, v93
    v_and_b32 v107, 0xffff0000, v93
    v_lshlrev_b32 v108, 16, v94
    v_and_b32 v109, 0xffff0000, v94
    v_lshlrev_b32 v110, 16, v95
    v_and_b32 v111, 0xffff0000, v95
    v_mul_f32 v104, s54, v104
    v_mul_f32 v105, s54, v105
    v_mul_f32 v106, s54, v106
    v_mul_f32 v107, s54, v107
    v_mul_f32 v108, s54, v108
    v_mul_f32 v109, s54, v109
    v_mul_f32 v110, s54, v110
    v_mul_f32 v111, s54, v111
    v_exp_f32 v104, v104
    v_exp_f32 v105, v105
    v_exp_f32 v106, v106
    v_exp_f32 v107, v107
    v_exp_f32 v108, v108
    v_exp_f32 v109, v109
    v_exp_f32 v110, v110
    v_exp_f32 v111, v111
    v_add_f32 v104, 1.0, v104
    v_add_f32 v105, 1.0, v105
    v_add_f32 v106, 1.0, v106
    v_add_f32 v107, 1.0, v107
    v_add_f32 v108, 1.0, v108
    v_add_f32 v109, 1.0, v109
    v_add_f32 v110, 1.0, v110
    v_add_f32 v111, 1.0, v111
    v_rcp_f32 v104, v104
    v_rcp_f32 v105, v105
    v_rcp_f32 v106, v106
    v_rcp_f32 v107, v107
    v_rcp_f32 v108, v108
    v_rcp_f32 v109, v109
    v_rcp_f32 v110, v110
    v_rcp_f32 v111, v111
    v_mul_f32 v104, v104, v184
    v_mul_f32 v105, v105, v185
    v_mul_f32 v106, v106, v186
    v_mul_f32 v107, v107, v187
    v_mul_f32 v108, v108, v188
    v_mul_f32 v109, v109, v189
    v_mul_f32 v110, v110, v190
    v_mul_f32 v111, v111, v191
    v_cvt_pk_bf16_f32 v92, v104, v105
    v_cvt_pk_bf16_f32 v93, v106, v107
    v_cvt_pk_bf16_f32 v94, v108, v109
    v_cvt_pk_bf16_f32 v95, v110, v111
    buffer_store_dwordx4 v[92:95], v1, s[4:7], s30 offen sc1
    s_add_u32 s30, s30, s50
    v_cvt_pk_bf16_f32 v80, v192, v193
    v_cvt_pk_bf16_f32 v81, v194, v195
    v_cvt_pk_bf16_f32 v82, v196, v197
    v_cvt_pk_bf16_f32 v83, v198, v199
    v_lshlrev_b32 v96, 16, v80
    v_and_b32 v97, 0xffff0000, v80
    v_lshlrev_b32 v98, 16, v81
    v_and_b32 v99, 0xffff0000, v81
    v_lshlrev_b32 v100, 16, v82
    v_and_b32 v101, 0xffff0000, v82
    v_lshlrev_b32 v102, 16, v83
    v_and_b32 v103, 0xffff0000, v83
    v_mul_f32 v96, s54, v96
    v_mul_f32 v97, s54, v97
    v_mul_f32 v98, s54, v98
    v_mul_f32 v99, s54, v99
    v_mul_f32 v100, s54, v100
    v_mul_f32 v101, s54, v101
    v_mul_f32 v102, s54, v102
    v_mul_f32 v103, s54, v103
    v_exp_f32 v96, v96
    v_exp_f32 v97, v97
    v_exp_f32 v98, v98
    v_exp_f32 v99, v99
    v_exp_f32 v100, v100
    v_exp_f32 v101, v101
    v_exp_f32 v102, v102
    v_exp_f32 v103, v103
    v_add_f32 v96, 1.0, v96
    v_add_f32 v97, 1.0, v97
    v_add_f32 v98, 1.0, v98
    v_add_f32 v99, 1.0, v99
    v_add_f32 v100, 1.0, v100
    v_add_f32 v101, 1.0, v101
    v_add_f32 v102, 1.0, v102
    v_add_f32 v103, 1.0, v103
    v_rcp_f32 v96, v96
    v_rcp_f32 v97, v97
    v_rcp_f32 v98, v98
    v_rcp_f32 v99, v99
    v_rcp_f32 v100, v100
    v_rcp_f32 v101, v101
    v_rcp_f32 v102, v102
    v_rcp_f32 v103, v103
    v_mul_f32 v96, v96, v200
    v_mul_f32 v97, v97, v201
    v_mul_f32 v98, v98, v202
    v_mul_f32 v99, v99, v203
    v_mul_f32 v100, v100, v204
    v_mul_f32 v101, v101, v205
    v_mul_f32 v102, v102, v206
    v_mul_f32 v103, v103, v207
    v_cvt_pk_bf16_f32 v80, v96, v97
    v_cvt_pk_bf16_f32 v81, v98, v99
    v_cvt_pk_bf16_f32 v82, v100, v101
    v_cvt_pk_bf16_f32 v83, v102, v103
    buffer_store_dwordx4 v[80:83], v1, s[4:7], s30 offen sc1
    s_add_u32 s30, s30, s50
    v_cvt_pk_bf16_f32 v84, v208, v209
    v_cvt_pk_bf16_f32 v85, v210, v211
    v_cvt_pk_bf16_f32 v86, v212, v213
    v_cvt_pk_bf16_f32 v87, v214, v215
    v_lshlrev_b32 v104, 16, v84
    v_and_b32 v105, 0xffff0000, v84
    v_lshlrev_b32 v106, 16, v85
    v_and_b32 v107, 0xffff0000, v85
    v_lshlrev_b32 v108, 16, v86
    v_and_b32 v109, 0xffff0000, v86
    v_lshlrev_b32 v110, 16, v87
    v_and_b32 v111, 0xffff0000, v87
    v_mul_f32 v104, s54, v104
    v_mul_f32 v105, s54, v105
    v_mul_f32 v106, s54, v106
    v_mul_f32 v107, s54, v107
    v_mul_f32 v108, s54, v108
    v_mul_f32 v109, s54, v109
    v_mul_f32 v110, s54, v110
    v_mul_f32 v111, s54, v111
    v_exp_f32 v104, v104
    v_exp_f32 v105, v105
    v_exp_f32 v106, v106
    v_exp_f32 v107, v107
    v_exp_f32 v108, v108
    v_exp_f32 v109, v109
    v_exp_f32 v110, v110
    v_exp_f32 v111, v111
    v_add_f32 v104, 1.0, v104
    v_add_f32 v105, 1.0, v105
    v_add_f32 v106, 1.0, v106
    v_add_f32 v107, 1.0, v107
    v_add_f32 v108, 1.0, v108
    v_add_f32 v109, 1.0, v109
    v_add_f32 v110, 1.0, v110
    v_add_f32 v111, 1.0, v111
    v_rcp_f32 v104, v104
    v_rcp_f32 v105, v105
    v_rcp_f32 v106, v106
    v_rcp_f32 v107, v107
    v_rcp_f32 v108, v108
    v_rcp_f32 v109, v109
    v_rcp_f32 v110, v110
    v_rcp_f32 v111, v111
    v_mul_f32 v104, v104, v216
    v_mul_f32 v105, v105, v217
    v_mul_f32 v106, v106, v218
    v_mul_f32 v107, v107, v219
    v_mul_f32 v108, v108, v220
    v_mul_f32 v109, v109, v221
    v_mul_f32 v110, v110, v222
    v_mul_f32 v111, v111, v223
    v_cvt_pk_bf16_f32 v84, v104, v105
    v_cvt_pk_bf16_f32 v85, v106, v107
    v_cvt_pk_bf16_f32 v86, v108, v109
    v_cvt_pk_bf16_f32 v87, v110, v111
    buffer_store_dwordx4 v[84:87], v1, s[4:7], s30 offen sc1
    s_add_u32 s30, s30, s50
    v_cvt_pk_bf16_f32 v88, v224, v225
    v_cvt_pk_bf16_f32 v89, v226, v227
    v_cvt_pk_bf16_f32 v90, v228, v229
    v_cvt_pk_bf16_f32 v91, v230, v231
    v_lshlrev_b32 v96, 16, v88
    v_and_b32 v97, 0xffff0000, v88
    v_lshlrev_b32 v98, 16, v89
    v_and_b32 v99, 0xffff0000, v89
    v_lshlrev_b32 v100, 16, v90
    v_and_b32 v101, 0xffff0000, v90
    v_lshlrev_b32 v102, 16, v91
    v_and_b32 v103, 0xffff0000, v91
    v_mul_f32 v96, s54, v96
    v_mul_f32 v97, s54, v97
    v_mul_f32 v98, s54, v98
    v_mul_f32 v99, s54, v99
    v_mul_f32 v100, s54, v100
    v_mul_f32 v101, s54, v101
    v_mul_f32 v102, s54, v102
    v_mul_f32 v103, s54, v103
    v_exp_f32 v96, v96
    v_exp_f32 v97, v97
    v_exp_f32 v98, v98
    v_exp_f32 v99, v99
    v_exp_f32 v100, v100
    v_exp_f32 v101, v101
    v_exp_f32 v102, v102
    v_exp_f32 v103, v103
    v_add_f32 v96, 1.0, v96
    v_add_f32 v97, 1.0, v97
    v_add_f32 v98, 1.0, v98
    v_add_f32 v99, 1.0, v99
    v_add_f32 v100, 1.0, v100
    v_add_f32 v101, 1.0, v101
    v_add_f32 v102, 1.0, v102
    v_add_f32 v103, 1.0, v103
    v_rcp_f32 v96, v96
    v_rcp_f32 v97, v97
    v_rcp_f32 v98, v98
    v_rcp_f32 v99, v99
    v_rcp_f32 v100, v100
    v_rcp_f32 v101, v101
    v_rcp_f32 v102, v102
    v_rcp_f32 v103, v103
    v_mul_f32 v96, v96, v232
    v_mul_f32 v97, v97, v233
    v_mul_f32 v98, v98, v234
    v_mul_f32 v99, v99, v235
    v_mul_f32 v100, v100, v236
    v_mul_f32 v101, v101, v237
    v_mul_f32 v102, v102, v238
    v_mul_f32 v103, v103, v239
    v_cvt_pk_bf16_f32 v88, v96, v97
    v_cvt_pk_bf16_f32 v89, v98, v99
    v_cvt_pk_bf16_f32 v90, v100, v101
    v_cvt_pk_bf16_f32 v91, v102, v103
    buffer_store_dwordx4 v[88:91], v1, s[4:7], s30 offen sc1
    s_add_u32 s30, s30, s50
    v_cvt_pk_bf16_f32 v92, v240, v241
    v_cvt_pk_bf16_f32 v93, v242, v243
    v_cvt_pk_bf16_f32 v94, v244, v245
    v_cvt_pk_bf16_f32 v95, v246, v247
    v_lshlrev_b32 v104, 16, v92
    v_and_b32 v105, 0xffff0000, v92
    v_lshlrev_b32 v106, 16, v93
    v_and_b32 v107, 0xffff0000, v93
    v_lshlrev_b32 v108, 16, v94
    v_and_b32 v109, 0xffff0000, v94
    v_lshlrev_b32 v110, 16, v95
    v_and_b32 v111, 0xffff0000, v95
    v_mul_f32 v104, s54, v104
    v_mul_f32 v105, s54, v105
    v_mul_f32 v106, s54, v106
    v_mul_f32 v107, s54, v107
    v_mul_f32 v108, s54, v108
    v_mul_f32 v109, s54, v109
    v_mul_f32 v110, s54, v110
    v_mul_f32 v111, s54, v111
    v_exp_f32 v104, v104
    v_exp_f32 v105, v105
    v_exp_f32 v106, v106
    v_exp_f32 v107, v107
    v_exp_f32 v108, v108
    v_exp_f32 v109, v109
    v_exp_f32 v110, v110
    v_exp_f32 v111, v111
    v_add_f32 v104, 1.0, v104
    v_add_f32 v105, 1.0, v105
    v_add_f32 v106, 1.0, v106
    v_add_f32 v107, 1.0, v107
    v_add_f32 v108, 1.0, v108
    v_add_f32 v109, 1.0, v109
    v_add_f32 v110, 1.0, v110
    v_add_f32 v111, 1.0, v111
    v_rcp_f32 v104, v104
    v_rcp_f32 v105, v105
    v_rcp_f32 v106, v106
    v_rcp_f32 v107, v107
    v_rcp_f32 v108, v108
    v_rcp_f32 v109, v109
    v_rcp_f32 v110, v110
    v_rcp_f32 v111, v111
    v_mul_f32 v104, v104, v248
    v_mul_f32 v105, v105, v249
    v_mul_f32 v106, v106, v250
    v_mul_f32 v107, v107, v251
    v_mul_f32 v108, v108, v252
    v_mul_f32 v109, v109, v253
    v_mul_f32 v110, v110, v254
    v_mul_f32 v111, v111, v255
    v_cvt_pk_bf16_f32 v92, v104, v105
    v_cvt_pk_bf16_f32 v93, v106, v107
    v_cvt_pk_bf16_f32 v94, v108, v109
    v_cvt_pk_bf16_f32 v95, v110, v111
    buffer_store_dwordx4 v[92:95], v1, s[4:7], s30 offen sc1
    s_waitcnt lgkmcnt(0)
    v_or3_b32 v24, v24, v25, v26
    v_or3_b32 v28, v28, v29, v30
    v_or3_b32 v24, v24, v27, v31
    v_or_b32 v24, v24, v28
    s_mov_b32 s28, s51
    s_mov_b32 s57, s53
    v_readfirstlane_b32 s30, v24
    s_cmp_lg_u32 s30, 0
    s_cbranch_scc1 w_drain
    s_mov_b32 s48, s32
    s_cmp_ge_u32 s32, 4
    s_cselect_b32 s30, 2, 3
    s_lshl_b32 s30, s26, s30
    s_mul_i32 s30, s30, s43
    s_add_u32 s49, s42, s30
    s_mov_b32 s50, s43
    s_mov_b32 s51, s46
    s_mov_b32 s23, s41
    s_mov_b32 s53, s47
    s_nop 0
    s_load_dwordx16 s[32:47], s[24:25], 0
    s_add_u32 s24, s24, 64
    s_addc_u32 s25, s25, 0
    s_branch w_first8
w_epi_silu:
    s_lshl_b32 s30, s27, 10
    s_add_u32 s30, s30, s49
    s_mov_b32 s54, 0xbfb8aa3b
    s_nop 7
    v_cvt_pk_bf16_f32 v80, v128, v129
    v_cvt_pk_bf16_f32 v81, v130, v131
    v_cvt_pk_bf16_f32 v82, v132, v133
    v_cvt_pk_bf16_f32 v83, v134, v135
    v_lshlrev_b32 v128, 16, v80
    v_and_b32 v129, 0xffff0000, v80
    v_lshlrev_b32 v130, 16, v81
    v_and_b32 v131, 0xffff0000, v81
    v_lshlrev_b32 v132, 16, v82
    v_and_b32 v133, 0xffff0000, v82
    v_lshlrev_b32 v134, 16, v83
    v_and_b32 v135, 0xffff0000, v83
    v_mul_f32 v104, s54, v128
    v_mul_f32 v105, s54, v129
    v_mul_f32 v106, s54, v130
    v_mul_f32 v107, s54, v131
    v_mul_f32 v108, s54, v132
    v_mul_f32 v109, s54, v133
    v_mul_f32 v110, s54, v134
    v_mul_f32 v111, s54, v135
    v_exp_f32 v104, v104
    v_exp_f32 v105, v105
    v_exp_f32 v106, v106
    v_exp_f32 v107, v107
    v_exp_f32 v108, v108
    v_exp_f32 v109, v109
    v_exp_f32 v110, v110
    v_exp_f32 v111, v111
    v_add_f32 v104, 1.0, v104
    v_add_f32 v105, 1.0, v105
    v_add_f32 v106, 1.0, v106
    v_add_f32 v107, 1.0, v107
    v_add_f32 v108, 1.0, v108
    v_add_f32 v109, 1.0, v109
    v_add_f32 v110, 1.0, v110
    v_add_f32 v111, 1.0, v111
    v_rcp_f32 v104, v104
    v_rcp_f32 v105, v105
    v_rcp_f32 v106, v106
    v_rcp_f32 v107, v107
    v_rcp_f32 v108, v108
    v_rcp_f32 v109, v109
    v_rcp_f32 v110, v110
    v_rcp_f32 v111, v111
    v_mul_f32 v128, v128, v104
    v_mul_f32 v129, v129, v105
    v_mul_f32 v130, v130, v106
    v_mul_f32 v131, v131, v107
    v_mul_f32 v132, v132, v108
    v_mul_f32 v133, v133, v109
    v_mul_f32 v134, v134, v110
    v_mul_f32 v135, v135, v111
    v_cvt_pk_bf16_f32 v80, v128, v129
    v_cvt_pk_bf16_f32 v81, v130, v131
    v_cvt_pk_bf16_f32 v82, v132, v133
    v_cvt_pk_bf16_f32 v83, v134, v135
    buffer_store_dwordx4 v[80:83], v1, s[4:7], s30 offen sc1
    v_cvt_pk_bf16_f32 v84, v136, v137
    v_cvt_pk_bf16_f32 v85, v138, v139
    v_cvt_pk_bf16_f32 v86, v140, v141
    v_cvt_pk_bf16_f32 v87, v142, v143
    v_lshlrev_b32 v136, 16, v84
    v_and_b32 v137, 0xffff0000, v84
    v_lshlrev_b32 v138, 16, v85
    v_and_b32 v139, 0xffff0000, v85
    v_lshlrev_b32 v140, 16, v86
    v_and_b32 v141, 0xffff0000, v86
    v_lshlrev_b32 v142, 16, v87
    v_and_b32 v143, 0xffff0000, v87
    v_mul_f32 v96, s54, v136
    v_mul_f32 v97, s54, v137
    v_mul_f32 v98, s54, v138
    v_mul_f32 v99, s54, v139
    v_mul_f32 v100, s54, v140
    v_mul_f32 v101, s54, v141
    v_mul_f32 v102, s54, v142
    v_mul_f32 v103, s54, v143
    v_exp_f32 v96, v96
    v_exp_f32 v97, v97
    v_exp_f32 v98, v98
    v_exp_f32 v99, v99
    v_exp_f32 v100, v100
    v_exp_f32 v101, v101
    v_exp_f32 v102, v102
    v_exp_f32 v103, v103
    v_add_f32 v96, 1.0, v96
    v_add_f32 v97, 1.0, v97
    v_add_f32 v98, 1.0, v98
    v_add_f32 v99, 1.0, v99
    v_add_f32 v100, 1.0, v100
    v_add_f32 v101, 1.0, v101
    v_add_f32 v102, 1.0, v102
    v_add_f32 v103, 1.0, v103
    v_rcp_f32 v96, v96
    v_rcp_f32 v97, v97
    v_rcp_f32 v98, v98
    v_rcp_f32 v99, v99
    v_rcp_f32 v100, v100
    v_rcp_f32 v101, v101
    v_rcp_f32 v102, v102
    v_rcp_f32 v103, v103
    v_mul_f32 v136, v136, v96
    v_mul_f32 v137, v137, v97
    v_mul_f32 v138, v138, v98
    v_mul_f32 v139, v139, v99
    v_mul_f32 v140, v140, v100
    v_mul_f32 v141, v141, v101
    v_mul_f32 v142, v142, v102
    v_mul_f32 v143, v143, v103
    v_cvt_pk_bf16_f32 v84, v136, v137
    v_cvt_pk_bf16_f32 v85, v138, v139
    v_cvt_pk_bf16_f32 v86, v140, v141
    v_cvt_pk_bf16_f32 v87, v142, v143
    buffer_store_dwordx4 v[84:87], v19, s[4:7], s30 offen sc1
    s_add_u32 s30, s30, s50
    v_cvt_pk_bf16_f32 v88, v144, v145
    v_cvt_pk_bf16_f32 v89, v146, v147
    v_cvt_pk_bf16_f32 v90, v148, v149
    v_cvt_pk_bf16_f32 v91, v150, v151
    v_lshlrev_b32 v144, 16, v88
    v_and_b32 v145, 0xffff0000, v88
    v_lshlrev_b32 v146, 16, v89
    v_and_b32 v147, 0xffff0000, v89
    v_lshlrev_b32 v148, 16, v90
    v_and_b32 v149, 0xffff0000, v90
    v_lshlrev_b32 v150, 16, v91
    v_and_b32 v151, 0xffff0000, v91
    v_mul_f32 v104, s54, v144
    v_mul_f32 v105, s54, v145
    v_mul_f32 v106, s54, v146
    v_mul_f32 v107, s54, v147
    v_mul_f32 v108, s54, v148
    v_mul_f32 v109, s54, v149
    v_mul_f32 v110, s54, v150
    v_mul_f32 v111, s54, v151
    v_exp_f32 v104, v104
    v_exp_f32 v105, v105
    v_exp_f32 v106, v106
    v_exp_f32 v107, v107
    v_exp_f32 v108, v108
    v_exp_f32 v109, v109
    v_exp_f32 v110, v110
    v_exp_f32 v111, v111
    v_add_f32 v104, 1.0, v104
    v_add_f32 v105, 1.0, v105
    v_add_f32 v106, 1.0, v106
    v_add_f32 v107, 1.0, v107
    v_add_f32 v108, 1.0, v108
    v_add_f32 v109, 1.0, v109
    v_add_f32 v110, 1.0, v110
    v_add_f32 v111, 1.0, v111
    v_rcp_f32 v104, v104
    v_rcp_f32 v105, v105
    v_rcp_f32 v106, v106
    v_rcp_f32 v107, v107
    v_rcp_f32 v108, v108
    v_rcp_f32 v109, v109
    v_rcp_f32 v110, v110
    v_rcp_f32 v111, v111
    v_mul_f32 v144, v144, v104
    v_mul_f32 v145, v145, v105
    v_mul_f32 v146, v146, v106
    v_mul_f32 v147, v147, v107
    v_mul_f32 v148, v148, v108
    v_mul_f32 v149, v149, v109
    v_mul_f32 v150, v150, v110
    v_mul_f32 v151, v151, v111
    v_cvt_pk_bf16_f32 v88, v144, v145
    v_cvt_pk_bf16_f32 v89, v146, v147
    v_cvt_pk_bf16_f32 v90, v148, v149
    v_cvt_pk_bf16_f32 v91, v150, v151
    buffer_store_dwordx4 v[88:91], v1, s[4:7], s30 offen sc1
    v_cvt_pk_bf16_f32 v92, v152, v153
    v_cvt_pk_bf16_f32 v93, v154, v155
    v_cvt_pk_bf16_f32 v94, v156, v157
    v_cvt_pk_bf16_f32 v95, v158, v159
    v_lshlrev_b32 v152, 16, v92
    v_and_b32 v153, 0xffff0000, v92
    v_lshlrev_b32 v154, 16, v93
    v_and_b32 v155, 0xffff0000, v93
    v_lshlrev_b32 v156, 16, v94
    v_and_b32 v157, 0xffff0000, v94
    v_lshlrev_b32 v158, 16, v95
    v_and_b32 v159, 0xffff0000, v95
    v_mul_f32 v96, s54, v152
    v_mul_f32 v97, s54, v153
    v_mul_f32 v98, s54, v154
    v_mul_f32 v99, s54, v155
    v_mul_f32 v100, s54, v156
    v_mul_f32 v101, s54, v157
    v_mul_f32 v102, s54, v158
    v_mul_f32 v103, s54, v159
    v_exp_f32 v96, v96
    v_exp_f32 v97, v97
    v_exp_f32 v98, v98
    v_exp_f32 v99, v99
    v_exp_f32 v100, v100
    v_exp_f32 v101, v101
    v_exp_f32 v102, v102
    v_exp_f32 v103, v103
    v_add_f32 v96, 1.0, v96
    v_add_f32 v97, 1.0, v97
    v_add_f32 v98, 1.0, v98
    v_add_f32 v99, 1.0, v99
    v_add_f32 v100, 1.0, v100
    v_add_f32 v101, 1.0, v101
    v_add_f32 v102, 1.0, v102
    v_add_f32 v103, 1.0, v103
    v_rcp_f32 v96, v96
    v_rcp_f32 v97, v97
    v_rcp_f32 v98, v98
    v_rcp_f32 v99, v99
    v_rcp_f32 v100, v100
    v_rcp_f32 v101, v101
    v_rcp_f32 v102, v102
    v_rcp_f32 v103, v103
    v_mul_f32 v152, v152, v96
    v_mul_f32 v153, v153, v97
    v_mul_f32 v154, v154, v98
    v_mul_f32 v155, v155, v99
    v_mul_f32 v156, v156, v100
    v_mul_f32 v157, v157, v101
    v_mul_f32 v158, v158, v102
    v_mul_f32 v159, v159, v103
    v_cvt_pk_bf16_f32 v92, v152, v153
    v_cvt_pk_bf16_f32 v93, v154, v155
    v_cvt_pk_bf16_f32 v94, v156, v157
    v_cvt_pk_bf16_f32 v95, v158, v159
    buffer_store_dwordx4 v[92:95], v19, s[4:7], s30 offen sc1
    s_add_u32 s30, s30, s50
    v_cvt_pk_bf16_f32 v80, v160, v161
    v_cvt_pk_bf16_f32 v81, v162, v163
    v_cvt_pk_bf16_f32 v82, v164, v165
    v_cvt_pk_bf16_f32 v83, v166, v167
    v_lshlrev_b32 v160, 16, v80
    v_and_b32 v161, 0xffff0000, v80
    v_lshlrev_b32 v162, 16, v81
    v_and_b32 v163, 0xffff0000, v81
    v_lshlrev_b32 v164, 16, v82
    v_and_b32 v165, 0xffff0000, v82
    v_lshlrev_b32 v166, 16, v83
    v_and_b32 v167, 0xffff0000, v83
    v_mul_f32 v104, s54, v160
    v_mul_f32 v105, s54, v161
    v_mul_f32 v106, s54, v162
    v_mul_f32 v107, s54, v163
    v_mul_f32 v108, s54, v164
    v_mul_f32 v109, s54, v165
    v_mul_f32 v110, s54, v166
    v_mul_f32 v111, s54, v167
    v_exp_f32 v104, v104
    v_exp_f32 v105, v105
    v_exp_f32 v106, v106
    v_exp_f32 v107, v107
    v_exp_f32 v108, v108
    v_exp_f32 v109, v109
    v_exp_f32 v110, v110
    v_exp_f32 v111, v111
    v_add_f32 v104, 1.0, v104
    v_add_f32 v105, 1.0, v105
    v_add_f32 v106, 1.0, v106
    v_add_f32 v107, 1.0, v107
    v_add_f32 v108, 1.0, v108
    v_add_f32 v109, 1.0, v109
    v_add_f32 v110, 1.0, v110
    v_add_f32 v111, 1.0, v111
    v_rcp_f32 v104, v104
    v_rcp_f32 v105, v105
    v_rcp_f32 v106, v106
    v_rcp_f32 v107, v107
    v_rcp_f32 v108, v108
    v_rcp_f32 v109, v109
    v_rcp_f32 v110, v110
    v_rcp_f32 v111, v111
    v_mul_f32 v160, v160, v104
    v_mul_f32 v161, v161, v105
    v_mul_f32 v162, v162, v106
    v_mul_f32 v163, v163, v107
    v_mul_f32 v164, v164, v108
    v_mul_f32 v165, v165, v109
    v_mul_f32 v166, v166, v110
    v_mul_f32 v167, v167, v111
    v_cvt_pk_bf16_f32 v80, v160, v161
    v_cvt_pk_bf16_f32 v81, v162, v163
    v_cvt_pk_bf16_f32 v82, v164, v165
    v_cvt_pk_bf16_f32 v83, v166, v167
    buffer_store_dwordx4 v[80:83], v1, s[4:7], s30 offen sc1
    v_cvt_pk_bf16_f32 v84, v168, v169
    v_cvt_pk_bf16_f32 v85, v170, v171
    v_cvt_pk_bf16_f32 v86, v172, v173
    v_cvt_pk_bf16_f32 v87, v174, v175
    v_lshlrev_b32 v168, 16, v84
    v_and_b32 v169, 0xffff0000, v84
    v_lshlrev_b32 v170, 16, v85
    v_and_b32 v171, 0xffff0000, v85
    v_lshlrev_b32 v172, 16, v86
    v_and_b32 v173, 0xffff0000, v86
    v_lshlrev_b32 v174, 16, v87
    v_and_b32 v175, 0xffff0000, v87
    v_mul_f32 v96, s54, v168
    v_mul_f32 v97, s54, v169
    v_mul_f32 v98, s54, v170
    v_mul_f32 v99, s54, v171
    v_mul_f32 v100, s54, v172
    v_mul_f32 v101, s54, v173
    v_mul_f32 v102, s54, v174
    v_mul_f32 v103, s54, v175
    v_exp_f32 v96, v96
    v_exp_f32 v97, v97
    v_exp_f32 v98, v98
    v_exp_f32 v99, v99
    v_exp_f32 v100, v100
    v_exp_f32 v101, v101
    v_exp_f32 v102, v102
    v_exp_f32 v103, v103
    v_add_f32 v96, 1.0, v96
    v_add_f32 v97, 1.0, v97
    v_add_f32 v98, 1.0, v98
    v_add_f32 v99, 1.0, v99
    v_add_f32 v100, 1.0, v100
    v_add_f32 v101, 1.0, v101
    v_add_f32 v102, 1.0, v102
    v_add_f32 v103, 1.0, v103
    v_rcp_f32 v96, v96
    v_rcp_f32 v97, v97
    v_rcp_f32 v98, v98
    v_rcp_f32 v99, v99
    v_rcp_f32 v100, v100
    v_rcp_f32 v101, v101
    v_rcp_f32 v102, v102
    v_rcp_f32 v103, v103
    v_mul_f32 v168, v168, v96
    v_mul_f32 v169, v169, v97
    v_mul_f32 v170, v170, v98
    v_mul_f32 v171, v171, v99
    v_mul_f32 v172, v172, v100
    v_mul_f32 v173, v173, v101
    v_mul_f32 v174, v174, v102
    v_mul_f32 v175, v175, v103
    v_cvt_pk_bf16_f32 v84, v168, v169
    v_cvt_pk_bf16_f32 v85, v170, v171
    v_cvt_pk_bf16_f32 v86, v172, v173
    v_cvt_pk_bf16_f32 v87, v174, v175
    buffer_store_dwordx4 v[84:87], v19, s[4:7], s30 offen sc1
    s_add_u32 s30, s30, s50
    v_cvt_pk_bf16_f32 v88, v176, v177
    v_cvt_pk_bf16_f32 v89, v178, v179
    v_cvt_pk_bf16_f32 v90, v180, v181
    v_cvt_pk_bf16_f32 v91, v182, v183
    v_lshlrev_b32 v176, 16, v88
    v_and_b32 v177, 0xffff0000, v88
    v_lshlrev_b32 v178, 16, v89
    v_and_b32 v179, 0xffff0000, v89
    v_lshlrev_b32 v180, 16, v90
    v_and_b32 v181, 0xffff0000, v90
    v_lshlrev_b32 v182, 16, v91
    v_and_b32 v183, 0xffff0000, v91
    v_mul_f32 v104, s54, v176
    v_mul_f32 v105, s54, v177
    v_mul_f32 v106, s54, v178
    v_mul_f32 v107, s54, v179
    v_mul_f32 v108, s54, v180
    v_mul_f32 v109, s54, v181
    v_mul_f32 v110, s54, v182
    v_mul_f32 v111, s54, v183
    v_exp_f32 v104, v104
    v_exp_f32 v105, v105
    v_exp_f32 v106, v106
    v_exp_f32 v107, v107
    v_exp_f32 v108, v108
    v_exp_f32 v109, v109
    v_exp_f32 v110, v110
    v_exp_f32 v111, v111
    v_add_f32 v104, 1.0, v104
    v_add_f32 v105, 1.0, v105
    v_add_f32 v106, 1.0, v106
    v_add_f32 v107, 1.0, v107
    v_add_f32 v108, 1.0, v108
    v_add_f32 v109, 1.0, v109
    v_add_f32 v110, 1.0, v110
    v_add_f32 v111, 1.0, v111
    v_rcp_f32 v104, v104
    v_rcp_f32 v105, v105
    v_rcp_f32 v106, v106
    v_rcp_f32 v107, v107
    v_rcp_f32 v108, v108
    v_rcp_f32 v109, v109
    v_rcp_f32 v110, v110
    v_rcp_f32 v111, v111
    v_mul_f32 v176, v176, v104
    v_mul_f32 v177, v177, v105
    v_mul_f32 v178, v178, v106
    v_mul_f32 v179, v179, v107
    v_mul_f32 v180, v180, v108
    v_mul_f32 v181, v181, v109
    v_mul_f32 v182, v182, v110
    v_mul_f32 v183, v183, v111
    v_cvt_pk_bf16_f32 v88, v176, v177
    v_cvt_pk_bf16_f32 v89, v178, v179
    v_cvt_pk_bf16_f32 v90, v180, v181
    v_cvt_pk_bf16_f32 v91, v182, v183
    buffer_store_dwordx4 v[88:91], v1, s[4:7], s30 offen sc1
    v_cvt_pk_bf16_f32 v92, v184, v185
    v_cvt_pk_bf16_f32 v93, v186, v187
    v_cvt_pk_bf16_f32 v94, v188, v189
    v_cvt_pk_bf16_f32 v95, v190, v191
    v_lshlrev_b32 v184, 16, v92
    v_and_b32 v185, 0xffff0000, v92
    v_lshlrev_b32 v186, 16, v93
    v_and_b32 v187, 0xffff0000, v93
    v_lshlrev_b32 v188, 16, v94
    v_and_b32 v189, 0xffff0000, v94
    v_lshlrev_b32 v190, 16, v95
    v_and_b32 v191, 0xffff0000, v95
    v_mul_f32 v96, s54, v184
    v_mul_f32 v97, s54, v185
    v_mul_f32 v98, s54, v186
    v_mul_f32 v99, s54, v187
    v_mul_f32 v100, s54, v188
    v_mul_f32 v101, s54, v189
    v_mul_f32 v102, s54, v190
    v_mul_f32 v103, s54, v191
    v_exp_f32 v96, v96
    v_exp_f32 v97, v97
    v_exp_f32 v98, v98
    v_exp_f32 v99, v99
    v_exp_f32 v100, v100
    v_exp_f32 v101, v101
    v_exp_f32 v102, v102
    v_exp_f32 v103, v103
    v_add_f32 v96, 1.0, v96
    v_add_f32 v97, 1.0, v97
    v_add_f32 v98, 1.0, v98
    v_add_f32 v99, 1.0, v99
    v_add_f32 v100, 1.0, v100
    v_add_f32 v101, 1.0, v101
    v_add_f32 v102, 1.0, v102
    v_add_f32 v103, 1.0, v103
    v_rcp_f32 v96, v96
    v_rcp_f32 v97, v97
    v_rcp_f32 v98, v98
    v_rcp_f32 v99, v99
    v_rcp_f32 v100, v100
    v_rcp_f32 v101, v101
    v_rcp_f32 v102, v102
    v_rcp_f32 v103, v103
    v_mul_f32 v184, v184, v96
    v_mul_f32 v185, v185, v97
    v_mul_f32 v186, v186, v98
    v_mul_f32 v187, v187, v99
    v_mul_f32 v188, v188, v100
    v_mul_f32 v189, v189, v101
    v_mul_f32 v190, v190, v102
    v_mul_f32 v191, v191, v103
    v_cvt_pk_bf16_f32 v92, v184, v185
    v_cvt_pk_bf16_f32 v93, v186, v187
    v_cvt_pk_bf16_f32 v94, v188, v189
    v_cvt_pk_bf16_f32 v95, v190, v191
    buffer_store_dwordx4 v[92:95], v19, s[4:7], s30 offen sc1
    s_add_u32 s30, s30, s50
    v_cvt_pk_bf16_f32 v80, v192, v193
    v_cvt_pk_bf16_f32 v81, v194, v195
    v_cvt_pk_bf16_f32 v82, v196, v197
    v_cvt_pk_bf16_f32 v83, v198, v199
    v_lshlrev_b32 v192, 16, v80
    v_and_b32 v193, 0xffff0000, v80
    v_lshlrev_b32 v194, 16, v81
    v_and_b32 v195, 0xffff0000, v81
    v_lshlrev_b32 v196, 16, v82
    v_and_b32 v197, 0xffff0000, v82
    v_lshlrev_b32 v198, 16, v83
    v_and_b32 v199, 0xffff0000, v83
    v_mul_f32 v104, s54, v192
    v_mul_f32 v105, s54, v193
    v_mul_f32 v106, s54, v194
    v_mul_f32 v107, s54, v195
    v_mul_f32 v108, s54, v196
    v_mul_f32 v109, s54, v197
    v_mul_f32 v110, s54, v198
    v_mul_f32 v111, s54, v199
    v_exp_f32 v104, v104
    v_exp_f32 v105, v105
    v_exp_f32 v106, v106
    v_exp_f32 v107, v107
    v_exp_f32 v108, v108
    v_exp_f32 v109, v109
    v_exp_f32 v110, v110
    v_exp_f32 v111, v111
    v_add_f32 v104, 1.0, v104
    v_add_f32 v105, 1.0, v105
    v_add_f32 v106, 1.0, v106
    v_add_f32 v107, 1.0, v107
    v_add_f32 v108, 1.0, v108
    v_add_f32 v109, 1.0, v109
    v_add_f32 v110, 1.0, v110
    v_add_f32 v111, 1.0, v111
    v_rcp_f32 v104, v104
    v_rcp_f32 v105, v105
    v_rcp_f32 v106, v106
    v_rcp_f32 v107, v107
    v_rcp_f32 v108, v108
    v_rcp_f32 v109, v109
    v_rcp_f32 v110, v110
    v_rcp_f32 v111, v111
    v_mul_f32 v192, v192, v104
    v_mul_f32 v193, v193, v105
    v_mul_f32 v194, v194, v106
    v_mul_f32 v195, v195, v107
    v_mul_f32 v196, v196, v108
    v_mul_f32 v197, v197, v109
    v_mul_f32 v198, v198, v110
    v_mul_f32 v199, v199, v111
    v_cvt_pk_bf16_f32 v80, v192, v193
    v_cvt_pk_bf16_f32 v81, v194, v195
    v_cvt_pk_bf16_f32 v82, v196, v197
    v_cvt_pk_bf16_f32 v83, v198, v199
    buffer_store_dwordx4 v[80:83], v1, s[4:7], s30 offen sc1
    v_cvt_pk_bf16_f32 v84, v200, v201
    v_cvt_pk_bf16_f32 v85, v202, v203
    v_cvt_pk_bf16_f32 v86, v204, v205
    v_cvt_pk_bf16_f32 v87, v206, v207
    v_lshlrev_b32 v200, 16, v84
    v_and_b32 v201, 0xffff0000, v84
    v_lshlrev_b32 v202, 16, v85
    v_and_b32 v203, 0xffff0000, v85
    v_lshlrev_b32 v204, 16, v86
    v_and_b32 v205, 0xffff0000, v86
    v_lshlrev_b32 v206, 16, v87
    v_and_b32 v207, 0xffff0000, v87
    v_mul_f32 v96, s54, v200
    v_mul_f32 v97, s54, v201
    v_mul_f32 v98, s54, v202
    v_mul_f32 v99, s54, v203
    v_mul_f32 v100, s54, v204
    v_mul_f32 v101, s54, v205
    v_mul_f32 v102, s54, v206
    v_mul_f32 v103, s54, v207
    v_exp_f32 v96, v96
    v_exp_f32 v97, v97
    v_exp_f32 v98, v98
    v_exp_f32 v99, v99
    v_exp_f32 v100, v100
    v_exp_f32 v101, v101
    v_exp_f32 v102, v102
    v_exp_f32 v103, v103
    v_add_f32 v96, 1.0, v96
    v_add_f32 v97, 1.0, v97
    v_add_f32 v98, 1.0, v98
    v_add_f32 v99, 1.0, v99
    v_add_f32 v100, 1.0, v100
    v_add_f32 v101, 1.0, v101
    v_add_f32 v102, 1.0, v102
    v_add_f32 v103, 1.0, v103
    v_rcp_f32 v96, v96
    v_rcp_f32 v97, v97
    v_rcp_f32 v98, v98
    v_rcp_f32 v99, v99
    v_rcp_f32 v100, v100
    v_rcp_f32 v101, v101
    v_rcp_f32 v102, v102
    v_rcp_f32 v103, v103
    v_mul_f32 v200, v200, v96
    v_mul_f32 v201, v201, v97
    v_mul_f32 v202, v202, v98
    v_mul_f32 v203, v203, v99
    v_mul_f32 v204, v204, v100
    v_mul_f32 v205, v205, v101
    v_mul_f32 v206, v206, v102
    v_mul_f32 v207, v207, v103
    v_cvt_pk_bf16_f32 v84, v200, v201
    v_cvt_pk_bf16_f32 v85, v202, v203
    v_cvt_pk_bf16_f32 v86, v204, v205
    v_cvt_pk_bf16_f32 v87, v206, v207
    buffer_store_dwordx4 v[84:87], v19, s[4:7], s30 offen sc1
    s_add_u32 s30, s30, s50
    v_cvt_pk_bf16_f32 v88, v208, v209
    v_cvt_pk_bf16_f32 v89, v210, v211
    v_cvt_pk_bf16_f32 v90, v212, v213
    v_cvt_pk_bf16_f32 v91, v214, v215
    v_lshlrev_b32 v208, 16, v88
    v_and_b32 v209, 0xffff0000, v88
    v_lshlrev_b32 v210, 16, v89
    v_and_b32 v211, 0xffff0000, v89
    v_lshlrev_b32 v212, 16, v90
    v_and_b32 v213, 0xffff0000, v90
    v_lshlrev_b32 v214, 16, v91
    v_and_b32 v215, 0xffff0000, v91
    v_mul_f32 v104, s54, v208
    v_mul_f32 v105, s54, v209
    v_mul_f32 v106, s54, v210
    v_mul_f32 v107, s54, v211
    v_mul_f32 v108, s54, v212
    v_mul_f32 v109, s54, v213
    v_mul_f32 v110, s54, v214
    v_mul_f32 v111, s54, v215
    v_exp_f32 v104, v104
    v_exp_f32 v105, v105
    v_exp_f32 v106, v106
    v_exp_f32 v107, v107
    v_exp_f32 v108, v108
    v_exp_f32 v109, v109
    v_exp_f32 v110, v110
    v_exp_f32 v111, v111
    v_add_f32 v104, 1.0, v104
    v_add_f32 v105, 1.0, v105
    v_add_f32 v106, 1.0, v106
    v_add_f32 v107, 1.0, v107
    v_add_f32 v108, 1.0, v108
    v_add_f32 v109, 1.0, v109
    v_add_f32 v110, 1.0, v110
    v_add_f32 v111, 1.0, v111
    v_rcp_f32 v104, v104
    v_rcp_f32 v105, v105
    v_rcp_f32 v106, v106
    v_rcp_f32 v107, v107
    v_rcp_f32 v108, v108
    v_rcp_f32 v109, v109
    v_rcp_f32 v110, v110
    v_rcp_f32 v111, v111
    v_mul_f32 v208, v208, v104
    v_mul_f32 v209, v209, v105
    v_mul_f32 v210, v210, v106
    v_mul_f32 v211, v211, v107
    v_mul_f32 v212, v212, v108
    v_mul_f32 v213, v213, v109
    v_mul_f32 v214, v214, v110
    v_mul_f32 v215, v215, v111
    v_cvt_pk_bf16_f32 v88, v208, v209
    v_cvt_pk_bf16_f32 v89, v210, v211
    v_cvt_pk_bf16_f32 v90, v212, v213
    v_cvt_pk_bf16_f32 v91, v214, v215
    buffer_store_dwordx4 v[88:91], v1, s[4:7], s30 offen sc1
    v_cvt_pk_bf16_f32 v92, v216, v217
    v_cvt_pk_bf16_f32 v93, v218, v219
    v_cvt_pk_bf16_f32 v94, v220, v221
    v_cvt_pk_bf16_f32 v95, v222, v223
    v_lshlrev_b32 v216, 16, v92
    v_and_b32 v217, 0xffff0000, v92
    v_lshlrev_b32 v218, 16, v93
    v_and_b32 v219, 0xffff0000, v93
    v_lshlrev_b32 v220, 16, v94
    v_and_b32 v221, 0xffff0000, v94
    v_lshlrev_b32 v222, 16, v95
    v_and_b32 v223, 0xffff0000, v95
    v_mul_f32 v96, s54, v216
    v_mul_f32 v97, s54, v217
    v_mul_f32 v98, s54, v218
    v_mul_f32 v99, s54, v219
    v_mul_f32 v100, s54, v220
    v_mul_f32 v101, s54, v221
    v_mul_f32 v102, s54, v222
    v_mul_f32 v103, s54, v223
    v_exp_f32 v96, v96
    v_exp_f32 v97, v97
    v_exp_f32 v98, v98
    v_exp_f32 v99, v99
    v_exp_f32 v100, v100
    v_exp_f32 v101, v101
    v_exp_f32 v102, v102
    v_exp_f32 v103, v103
    v_add_f32 v96, 1.0, v96
    v_add_f32 v97, 1.0, v97
    v_add_f32 v98, 1.0, v98
    v_add_f32 v99, 1.0, v99
    v_add_f32 v100, 1.0, v100
    v_add_f32 v101, 1.0, v101
    v_add_f32 v102, 1.0, v102
    v_add_f32 v103, 1.0, v103
    v_rcp_f32 v96, v96
    v_rcp_f32 v97, v97
    v_rcp_f32 v98, v98
    v_rcp_f32 v99, v99
    v_rcp_f32 v100, v100
    v_rcp_f32 v101, v101
    v_rcp_f32 v102, v102
    v_rcp_f32 v103, v103
    v_mul_f32 v216, v216, v96
    v_mul_f32 v217, v217, v97
    v_mul_f32 v218, v218, v98
    v_mul_f32 v219, v219, v99
    v_mul_f32 v220, v220, v100
    v_mul_f32 v221, v221, v101
    v_mul_f32 v222, v222, v102
    v_mul_f32 v223, v223, v103
    v_cvt_pk_bf16_f32 v92, v216, v217
    v_cvt_pk_bf16_f32 v93, v218, v219
    v_cvt_pk_bf16_f32 v94, v220, v221
    v_cvt_pk_bf16_f32 v95, v222, v223
    buffer_store_dwordx4 v[92:95], v19, s[4:7], s30 offen sc1
    s_add_u32 s30, s30, s50
    v_cvt_pk_bf16_f32 v80, v224, v225
    v_cvt_pk_bf16_f32 v81, v226, v227
    v_cvt_pk_bf16_f32 v82, v228, v229
    v_cvt_pk_bf16_f32 v83, v230, v231
    v_lshlrev_b32 v224, 16, v80
    v_and_b32 v225, 0xffff0000, v80
    v_lshlrev_b32 v226, 16, v81
    v_and_b32 v227, 0xffff0000, v81
    v_lshlrev_b32 v228, 16, v82
    v_and_b32 v229, 0xffff0000, v82
    v_lshlrev_b32 v230, 16, v83
    v_and_b32 v231, 0xffff0000, v83
    v_mul_f32 v104, s54, v224
    v_mul_f32 v105, s54, v225
    v_mul_f32 v106, s54, v226
    v_mul_f32 v107, s54, v227
    v_mul_f32 v108, s54, v228
    v_mul_f32 v109, s54, v229
    v_mul_f32 v110, s54, v230
    v_mul_f32 v111, s54, v231
    v_exp_f32 v104, v104
    v_exp_f32 v105, v105
    v_exp_f32 v106, v106
    v_exp_f32 v107, v107
    v_exp_f32 v108, v108
    v_exp_f32 v109, v109
    v_exp_f32 v110, v110
    v_exp_f32 v111, v111
    v_add_f32 v104, 1.0, v104
    v_add_f32 v105, 1.0, v105
    v_add_f32 v106, 1.0, v106
    v_add_f32 v107, 1.0, v107
    v_add_f32 v108, 1.0, v108
    v_add_f32 v109, 1.0, v109
    v_add_f32 v110, 1.0, v110
    v_add_f32 v111, 1.0, v111
    v_rcp_f32 v104, v104
    v_rcp_f32 v105, v105
    v_rcp_f32 v106, v106
    v_rcp_f32 v107, v107
    v_rcp_f32 v108, v108
    v_rcp_f32 v109, v109
    v_rcp_f32 v110, v110
    v_rcp_f32 v111, v111
    v_mul_f32 v224, v224, v104
    v_mul_f32 v225, v225, v105
    v_mul_f32 v226, v226, v106
    v_mul_f32 v227, v227, v107
    v_mul_f32 v228, v228, v108
    v_mul_f32 v229, v229, v109
    v_mul_f32 v230, v230, v110
    v_mul_f32 v231, v231, v111
    v_cvt_pk_bf16_f32 v80, v224, v225
    v_cvt_pk_bf16_f32 v81, v226, v227
    v_cvt_pk_bf16_f32 v82, v228, v229
    v_cvt_pk_bf16_f32 v83, v230, v231
    buffer_store_dwordx4 v[80:83], v1, s[4:7], s30 offen sc1
    v_cvt_pk_bf16_f32 v84, v232, v233
    v_cvt_pk_bf16_f32 v85, v234, v235
    v_cvt_pk_bf16_f32 v86, v236, v237
    v_cvt_pk_bf16_f32 v87, v238, v239
    v_lshlrev_b32 v232, 16, v84
    v_and_b32 v233, 0xffff0000, v84
    v_lshlrev_b32 v234, 16, v85
    v_and_b32 v235, 0xffff0000, v85
    v_lshlrev_b32 v236, 16, v86
    v_and_b32 v237, 0xffff0000, v86
    v_lshlrev_b32 v238, 16, v87
    v_and_b32 v239, 0xffff0000, v87
    v_mul_f32 v96, s54, v232
    v_mul_f32 v97, s54, v233
    v_mul_f32 v98, s54, v234
    v_mul_f32 v99, s54, v235
    v_mul_f32 v100, s54, v236
    v_mul_f32 v101, s54, v237
    v_mul_f32 v102, s54, v238
    v_mul_f32 v103, s54, v239
    v_exp_f32 v96, v96
    v_exp_f32 v97, v97
    v_exp_f32 v98, v98
    v_exp_f32 v99, v99
    v_exp_f32 v100, v100
    v_exp_f32 v101, v101
    v_exp_f32 v102, v102
    v_exp_f32 v103, v103
    v_add_f32 v96, 1.0, v96
    v_add_f32 v97, 1.0, v97
    v_add_f32 v98, 1.0, v98
    v_add_f32 v99, 1.0, v99
    v_add_f32 v100, 1.0, v100
    v_add_f32 v101, 1.0, v101
    v_add_f32 v102, 1.0, v102
    v_add_f32 v103, 1.0, v103
    v_rcp_f32 v96, v96
    v_rcp_f32 v97, v97
    v_rcp_f32 v98, v98
    v_rcp_f32 v99, v99
    v_rcp_f32 v100, v100
    v_rcp_f32 v101, v101
    v_rcp_f32 v102, v102
    v_rcp_f32 v103, v103
    v_mul_f32 v232, v232, v96
    v_mul_f32 v233, v233, v97
    v_mul_f32 v234, v234, v98
    v_mul_f32 v235, v235, v99
    v_mul_f32 v236, v236, v100
    v_mul_f32 v237, v237, v101
    v_mul_f32 v238, v238, v102
    v_mul_f32 v239, v239, v103
    v_cvt_pk_bf16_f32 v84, v232, v233
    v_cvt_pk_bf16_f32 v85, v234, v235
    v_cvt_pk_bf16_f32 v86, v236, v237
    v_cvt_pk_bf16_f32 v87, v238, v239
    buffer_store_dwordx4 v[84:87], v19, s[4:7], s30 offen sc1
    s_add_u32 s30, s30, s50
    v_cvt_pk_bf16_f32 v88, v240, v241
    v_cvt_pk_bf16_f32 v89, v242, v243
    v_cvt_pk_bf16_f32 v90, v244, v245
    v_cvt_pk_bf16_f32 v91, v246, v247
    v_lshlrev_b32 v240, 16, v88
    v_and_b32 v241, 0xffff0000, v88
    v_lshlrev_b32 v242, 16, v89
    v_and_b32 v243, 0xffff0000, v89
    v_lshlrev_b32 v244, 16, v90
    v_and_b32 v245, 0xffff0000, v90
    v_lshlrev_b32 v246, 16, v91
    v_and_b32 v247, 0xffff0000, v91
    v_mul_f32 v104, s54, v240
    v_mul_f32 v105, s54, v241
    v_mul_f32 v106, s54, v242
    v_mul_f32 v107, s54, v243
    v_mul_f32 v108, s54, v244
    v_mul_f32 v109, s54, v245
    v_mul_f32 v110, s54, v246
    v_mul_f32 v111, s54, v247
    v_exp_f32 v104, v104
    v_exp_f32 v105, v105
    v_exp_f32 v106, v106
    v_exp_f32 v107, v107
    v_exp_f32 v108, v108
    v_exp_f32 v109, v109
    v_exp_f32 v110, v110
    v_exp_f32 v111, v111
    v_add_f32 v104, 1.0, v104
    v_add_f32 v105, 1.0, v105
    v_add_f32 v106, 1.0, v106
    v_add_f32 v107, 1.0, v107
    v_add_f32 v108, 1.0, v108
    v_add_f32 v109, 1.0, v109
    v_add_f32 v110, 1.0, v110
    v_add_f32 v111, 1.0, v111
    v_rcp_f32 v104, v104
    v_rcp_f32 v105, v105
    v_rcp_f32 v106, v106
    v_rcp_f32 v107, v107
    v_rcp_f32 v108, v108
    v_rcp_f32 v109, v109
    v_rcp_f32 v110, v110
    v_rcp_f32 v111, v111
    v_mul_f32 v240, v240, v104
    v_mul_f32 v241, v241, v105
    v_mul_f32 v242, v242, v106
    v_mul_f32 v243, v243, v107
    v_mul_f32 v244, v244, v108
    v_mul_f32 v245, v245, v109
    v_mul_f32 v246, v246, v110
    v_mul_f32 v247, v247, v111
    v_cvt_pk_bf16_f32 v88, v240, v241
    v_cvt_pk_bf16_f32 v89, v242, v243
    v_cvt_pk_bf16_f32 v90, v244, v245
    v_cvt_pk_bf16_f32 v91, v246, v247
    buffer_store_dwordx4 v[88:91], v1, s[4:7], s30 offen sc1
    v_cvt_pk_bf16_f32 v92, v248, v249
    v_cvt_pk_bf16_f32 v93, v250, v251
    v_cvt_pk_bf16_f32 v94, v252, v253
    v_cvt_pk_bf16_f32 v95, v254, v255
    v_lshlrev_b32 v248, 16, v92
    v_and_b32 v249, 0xffff0000, v92
    v_lshlrev_b32 v250, 16, v93
    v_and_b32 v251, 0xffff0000, v93
    v_lshlrev_b32 v252, 16, v94
    v_and_b32 v253, 0xffff0000, v94
    v_lshlrev_b32 v254, 16, v95
    v_and_b32 v255, 0xffff0000, v95
    v_mul_f32 v96, s54, v248
    v_mul_f32 v97, s54, v249
    v_mul_f32 v98, s54, v250
    v_mul_f32 v99, s54, v251
    v_mul_f32 v100, s54, v252
    v_mul_f32 v101, s54, v253
    v_mul_f32 v102, s54, v254
    v_mul_f32 v103, s54, v255
    v_exp_f32 v96, v96
    v_exp_f32 v97, v97
    v_exp_f32 v98, v98
    v_exp_f32 v99, v99
    v_exp_f32 v100, v100
    v_exp_f32 v101, v101
    v_exp_f32 v102, v102
    v_exp_f32 v103, v103
    v_add_f32 v96, 1.0, v96
    v_add_f32 v97, 1.0, v97
    v_add_f32 v98, 1.0, v98
    v_add_f32 v99, 1.0, v99
    v_add_f32 v100, 1.0, v100
    v_add_f32 v101, 1.0, v101
    v_add_f32 v102, 1.0, v102
    v_add_f32 v103, 1.0, v103
    v_rcp_f32 v96, v96
    v_rcp_f32 v97, v97
    v_rcp_f32 v98, v98
    v_rcp_f32 v99, v99
    v_rcp_f32 v100, v100
    v_rcp_f32 v101, v101
    v_rcp_f32 v102, v102
    v_rcp_f32 v103, v103
    v_mul_f32 v248, v248, v96
    v_mul_f32 v249, v249, v97
    v_mul_f32 v250, v250, v98
    v_mul_f32 v251, v251, v99
    v_mul_f32 v252, v252, v100
    v_mul_f32 v253, v253, v101
    v_mul_f32 v254, v254, v102
    v_mul_f32 v255, v255, v103
    v_cvt_pk_bf16_f32 v92, v248, v249
    v_cvt_pk_bf16_f32 v93, v250, v251
    v_cvt_pk_bf16_f32 v94, v252, v253
    v_cvt_pk_bf16_f32 v95, v254, v255
    buffer_store_dwordx4 v[92:95], v19, s[4:7], s30 offen sc1
    s_waitcnt lgkmcnt(0)
    v_or3_b32 v24, v24, v25, v26
    v_or3_b32 v28, v28, v29, v30
    v_or3_b32 v24, v24, v27, v31
    v_or_b32 v24, v24, v28
    s_mov_b32 s28, s51
    s_mov_b32 s57, s53
    v_readfirstlane_b32 s30, v24
    s_cmp_lg_u32 s30, 0
    s_cbranch_scc1 w_drain
    s_mov_b32 s48, s32
    s_cmp_ge_u32 s32, 4
    s_cselect_b32 s30, 2, 3
    s_lshl_b32 s30, s26, s30
    s_mul_i32 s30, s30, s43
    s_add_u32 s49, s42, s30
    s_mov_b32 s50, s43
    s_mov_b32 s51, s46
    s_mov_b32 s23, s41
    s_mov_b32 s53, s47
    s_nop 0
    s_load_dwordx16 s[32:47], s[24:25], 0
    s_add_u32 s24, s24, 64
    s_addc_u32 s25, s25, 0
    s_branch w_first16
w_firstH:
    s_waitcnt vmcnt(8)
    s_barrier
    s_add_u32 m0, s21, 0
    s_nop 0
    buffer_load_dwordx4 v1, s[4:7], s16 offen sc1 lds
    s_add_u32 s16, s16, s62
    s_add_u32 m0, s21, 1024
    s_nop 0
    buffer_load_dwordx4 v1, s[4:7], s17 offen sc1 lds
    s_add_u32 s17, s17, s62
    s_add_u32 m0, s22, 0
    s_nop 0
    buffer_load_dwordx4 v2, s[8:11], s18 offen lds
    s_add_u32 s18, s18, s20
    s_add_u32 m0, s22, 8192
    s_nop 0
    buffer_load_dwordx4 v2, s[12:15], s19 offen lds
    s_add_u32 s19, s19, s20
    v_mfma_f32_16x16x32_bf16 v[128:131], v[64:67], v[32:35], 0
    ds_read_b64_tr_b16 v[112:113], v8 offset:49152
    v_mfma_f32_16x16x32_bf16 v[132:135], v[68:71], v[32:35], 0
    ds_read_b64_tr_b16 v[114:115], v9 offset:49152
    v_mfma_f32_16x16x32_bf16 v[144:147], v[64:67], v[40:43], 0
    ds_read_b64_tr_b16 v[116:117], v10 offset:49152
    v_mfma_f32_16x16x32_bf16 v[148:151], v[68:71], v[40:43], 0
    ds_read_b64_tr_b16 v[118:119], v11 offset:49152
    v_mfma_f32_16x16x32_bf16 v[160:163], v[64:67], v[48:51], 0
    ds_read_b64_tr_b16 v[120:121], v8 offset:57344
    v_mfma_f32_16x16x32_bf16 v[164:167], v[68:71], v[48:51], 0
    ds_read_b64_tr_b16 v[122:123], v9 offset:57344
    v_mfma_f32_16x16x32_bf16 v[176:179], v[64:67], v[56:59], 0
    ds_read_b64_tr_b16 v[124:125], v10 offset:57344
    v_mfma_f32_16x16x32_bf16 v[180:183], v[68:71], v[56:59], 0
    ds_read_b64_tr_b16 v[126:127], v11 offset:57344
    v_mfma_f32_16x16x32_bf16 v[128:131], v[72:75], v[36:39], v[128:131]
    ds_read_b128 v[80:83], v5 offset:32768
    v_mfma_f32_16x16x32_bf16 v[132:135], v[76:79], v[36:39], v[132:135]
    ds_read_b128 v[84:87], v5 offset:33792
    v_mfma_f32_16x16x32_bf16 v[144:147], v[72:75], v[44:47], v[144:147]
    ds_read_b128 v[88:91], v5 offset:34816
    v_mfma_f32_16x16x32_bf16 v[148:151], v[76:79], v[44:47], v[148:151]
    ds_read_b128 v[92:95], v5 offset:35840
    v_mfma_f32_16x16x32_bf16 v[160:163], v[72:75], v[52:55], v[160:163]
    ds_read_b128 v[96:99], v5 offset:36864
    v_mfma_f32_16x16x32_bf16 v[164:167], v[76:79], v[52:55], v[164:167]
    ds_read_b128 v[100:103], v5 offset:37888
    v_mfma_f32_16x16x32_bf16 v[176:179], v[72:75], v[60:63], v[176:179]
    ds_read_b128 v[104:107], v5 offset:38912
    v_mfma_f32_16x16x32_bf16 v[180:183], v[76:79], v[60:63], v[180:183]
    ds_read_b128 v[108:111], v5 offset:39936
    s_waitcnt lgkmcnt(0)
    s_waitcnt vmcnt(8)
    s_barrier
    s_add_u32 m0, s21, 32768
    s_nop 0
    buffer_load_dwordx4 v1, s[4:7], s16 offen sc1 lds
    s_add_u32 s16, s16, s62
    s_add_u32 m0, s21, 33792
    s_nop 0
    buffer_load_dwordx4 v1, s[4:7], s17 offen sc1 lds
    s_add_u32 s17, s17, s62
    s_add_u32 m0, s22, 32768
    s_nop 0
    buffer_load_dwordx4 v2, s[8:11], s18 offen lds
    s_add_u32 s18, s18, s20
    s_add_u32 m0, s22, 40960
    s_nop 0
    buffer_load_dwordx4 v2, s[12:15], s19 offen lds
    s_add_u32 s19, s19, s20
    v_mfma_f32_16x16x32_bf16 v[128:131], v[112:115], v[80:83], v[128:131]
    ds_read_b64_tr_b16 v[64:65], v12 offset:16384
    v_mfma_f32_16x16x32_bf16 v[132:135], v[116:119], v[80:83], v[132:135]
    ds_read_b64_tr_b16 v[66:67], v13 offset:16384
    v_mfma_f32_16x16x32_bf16 v[144:147], v[112:115], v[88:91], v[144:147]
    ds_read_b64_tr_b16 v[68:69], v14 offset:16384
    v_mfma_f32_16x16x32_bf16 v[148:151], v[116:119], v[88:91], v[148:151]
    ds_read_b64_tr_b16 v[70:71], v15 offset:16384
    v_mfma_f32_16x16x32_bf16 v[160:163], v[112:115], v[96:99], v[160:163]
    ds_read_b64_tr_b16 v[72:73], v12 offset:24576
    v_mfma_f32_16x16x32_bf16 v[164:167], v[116:119], v[96:99], v[164:167]
    ds_read_b64_tr_b16 v[74:75], v13 offset:24576
    v_mfma_f32_16x16x32_bf16 v[176:179], v[112:115], v[104:107], v[176:179]
    ds_read_b64_tr_b16 v[76:77], v14 offset:24576
    v_mfma_f32_16x16x32_bf16 v[180:183], v[116:119], v[104:107], v[180:183]
    ds_read_b64_tr_b16 v[78:79], v15 offset:24576
    v_mfma_f32_16x16x32_bf16 v[128:131], v[120:123], v[84:87], v[128:131]
    ds_read_b128 v[32:35], v6 offset:0
    v_mfma_f32_16x16x32_bf16 v[132:135], v[124:127], v[84:87], v[132:135]
    ds_read_b128 v[36:39], v6 offset:1024
    v_mfma_f32_16x16x32_bf16 v[144:147], v[120:123], v[92:95], v[144:147]
    ds_read_b128 v[40:43], v6 offset:2048
    v_mfma_f32_16x16x32_bf16 v[148:151], v[124:127], v[92:95], v[148:151]
    ds_read_b128 v[44:47], v6 offset:3072
    v_mfma_f32_16x16x32_bf16 v[160:163], v[120:123], v[100:103], v[160:163]
    ds_read_b128 v[48:51], v6 offset:4096
    v_mfma_f32_16x16x32_bf16 v[164:167], v[124:127], v[100:103], v[164:167]
    ds_read_b128 v[52:55], v6 offset:5120
    v_mfma_f32_16x16x32_bf16 v[176:179], v[120:123], v[108:111], v[176:179]
    ds_read_b128 v[56:59], v6 offset:6144
    v_mfma_f32_16x16x32_bf16 v[180:183], v[124:127], v[108:111], v[180:183]
    ds_read_b128 v[60:63], v6 offset:7168
    s_waitcnt lgkmcnt(0)
    s_waitcnt vmcnt(8)
    s_barrier
    s_add_u32 m0, s21, 65536
    s_nop 0
    buffer_load_dwordx4 v1, s[4:7], s16 offen sc1 lds
    s_add_u32 s16, s16, s62
    s_add_u32 m0, s21, 66560
    s_nop 0
    buffer_load_dwordx4 v1, s[4:7], s17 offen sc1 lds
    s_add_u32 s17, s17, s62
    s_add_u32 m0, s22, 65536
    s_nop 0
    buffer_load_dwordx4 v2, s[8:11], s18 offen lds
    s_add_u32 s18, s18, s20
    s_add_u32 m0, s22, 73728
    s_nop 0
    buffer_load_dwordx4 v2, s[12:15], s19 offen lds
    s_add_u32 s19, s19, s20
    v_mfma_f32_16x16x32_bf16 v[128:131], v[64:67], v[32:35], v[128:131]
    ds_read_b64_tr_b16 v[112:113], v12 offset:49152
    v_mfma_f32_16x16x32_bf16 v[132:135], v[68:71], v[32:35], v[132:135]
    ds_read_b64_tr_b16 v[114:115], v13 offset:49152
    v_mfma_f32_16x16x32_bf16 v[144:147], v[64:67], v[40:43], v[144:147]
    ds_read_b64_tr_b16 v[116:117], v14 offset:49152
    v_mfma_f32_16x16x32_bf16 v[148:151], v[68:71], v[40:43], v[148:151]
    ds_read_b64_tr_b16 v[118:119], v15 offset:49152
    v_mfma_f32_16x16x32_bf16 v[160:163], v[64:67], v[48:51], v[160:163]
    ds_read_b64_tr_b16 v[120:121], v12 offset:57344
    v_mfma_f32_16x16x32_bf16 v[164:167], v[68:71], v[48:51], v[164:167]
    ds_read_b64_tr_b16 v[122:123], v13 offset:57344
    v_mfma_f32_16x16x32_bf16 v[176:179], v[64:67], v[56:59], v[176:179]
    ds_read_b64_tr_b16 v[124:125], v14 offset:57344
    v_mfma_f32_16x16x32_bf16 v[180:183], v[68:71], v[56:59], v[180:183]
    ds_read_b64_tr_b16 v[126:127], v15 offset:57344
    v_mfma_f32_16x16x32_bf16 v[128:131], v[72:75], v[36:39], v[128:131]
    ds_read_b128 v[80:83], v6 offset:32768
    v_mfma_f32_16x16x32_bf16 v[132:135], v[76:79], v[36:39], v[132:135]
    ds_read_b128 v[84:87], v6 offset:33792
    v_mfma_f32_16x16x32_bf16 v[144:147], v[72:75], v[44:47], v[144:147]
    ds_read_b128 v[88:91], v6 offset:34816
    v_mfma_f32_16x16x32_bf16 v[148:151], v[76:79], v[44:47], v[148:151]
    ds_read_b128 v[92:95], v6 offset:35840
    v_mfma_f32_16x16x32_bf16 v[160:163], v[72:75], v[52:55], v[160:163]
    ds_read_b128 v[96:99], v6 offset:36864
    v_mfma_f32_16x16x32_bf16 v[164:167], v[76:79], v[52:55], v[164:167]
    ds_read_b128 v[100:103], v6 offset:37888
    v_mfma_f32_16x16x32_bf16 v[176:179], v[72:75], v[60:63], v[176:179]
    ds_read_b128 v[104:107], v6 offset:38912
    v_mfma_f32_16x16x32_bf16 v[180:183], v[76:79], v[60:63], v[180:183]
    ds_read_b128 v[108:111], v6 offset:39936
    s_waitcnt lgkmcnt(0)
    s_waitcnt vmcnt(8)
    s_barrier
    s_add_u32 m0, s21, 98304
    s_nop 0
    buffer_load_dwordx4 v1, s[4:7], s16 offen sc1 lds
    s_add_u32 s16, s16, s62
    s_add_u32 m0, s21, 99328
    s_nop 0
    buffer_load_dwordx4 v1, s[4:7], s17 offen sc1 lds
    s_add_u32 s17, s17, s62
    s_add_u32 m0, s22, 98304
    s_nop 0
    buffer_load_dwordx4 v2, s[8:11], s18 offen lds
    s_add_u32 s18, s18, s20
    s_add_u32 m0, s22, 106496
    s_nop 0
    buffer_load_dwordx4 v2, s[12:15], s19 offen lds
    s_add_u32 s19, s19, s20
    v_mfma_f32_16x16x32_bf16 v[128:131], v[112:115], v[80:83], v[128:131]
    ds_read_b64_tr_b16 v[64:65], v8 offset:16384
    v_mfma_f32_16x16x32_bf16 v[132:135], v[116:119], v[80:83], v[132:135]
    ds_read_b64_tr_b16 v[66:67], v9 offset:16384
    v_mfma_f32_16x16x32_bf16 v[144:147], v[112:115], v[88:91], v[144:147]
    ds_read_b64_tr_b16 v[68:69], v10 offset:16384
    v_mfma_f32_16x16x32_bf16 v[148:151], v[116:119], v[88:91], v[148:151]
    ds_read_b64_tr_b16 v[70:71], v11 offset:16384
    v_mfma_f32_16x16x32_bf16 v[160:163], v[112:115], v[96:99], v[160:163]
    ds_read_b64_tr_b16 v[72:73], v8 offset:24576
    v_mfma_f32_16x16x32_bf16 v[164:167], v[116:119], v[96:99], v[164:167]
    ds_read_b64_tr_b16 v[74:75], v9 offset:24576
    v_mfma_f32_16x16x32_bf16 v[176:179], v[112:115], v[104:107], v[176:179]
    ds_read_b64_tr_b16 v[76:77], v10 offset:24576
    v_mfma_f32_16x16x32_bf16 v[180:183], v[116:119], v[104:107], v[180:183]
    ds_read_b64_tr_b16 v[78:79], v11 offset:24576
    v_mfma_f32_16x16x32_bf16 v[128:131], v[120:123], v[84:87], v[128:131]
    ds_read_b128 v[32:35], v5 offset:0
    v_mfma_f32_16x16x32_bf16 v[132:135], v[124:127], v[84:87], v[132:135]
    ds_read_b128 v[36:39], v5 offset:1024
    v_mfma_f32_16x16x32_bf16 v[144:147], v[120:123], v[92:95], v[144:147]
    ds_read_b128 v[40:43], v5 offset:2048
    v_mfma_f32_16x16x32_bf16 v[148:151], v[124:127], v[92:95], v[148:151]
    ds_read_b128 v[44:47], v5 offset:3072
    v_mfma_f32_16x16x32_bf16 v[160:163], v[120:123], v[100:103], v[160:163]
    ds_read_b128 v[48:51], v5 offset:4096
    v_mfma_f32_16x16x32_bf16 v[164:167], v[124:127], v[100:103], v[164:167]
    ds_read_b128 v[52:55], v5 offset:5120
    v_mfma_f32_16x16x32_bf16 v[176:179], v[120:123], v[108:111], v[176:179]
    ds_read_b128 v[56:59], v5 offset:6144
    v_mfma_f32_16x16x32_bf16 v[180:183], v[124:127], v[108:111], v[180:183]
    ds_read_b128 v[60:63], v5 offset:7168
    s_waitcnt lgkmcnt(0)
w_loop_chkH:
    s_sub_u32 s23, s23, 1
w_loopH:
    s_cmp_lg_u32 s23, 1
    s_cbranch_scc1 w_bodyH
    buffer_load_dword v22, off, s[64:67], 0 sc1
    v_readfirstlane_b32 s30, v16
    s_cmp_ge_u32 s30, s45
    s_cselect_b32 s30, 0, 1
    s_or_b32 s30, s30, s70
    s_cmp_ge_u32 s32, 4
    s_cselect_b32 s30, 1, s30
    s_cmp_eq_u32 s32, 0
    s_cselect_b32 s30, 1, s30
    v_mov_b32 v20, s30
    ds_write_b32 v7, v20
    s_cbranch_scc1 w_ndH
    s_cmp_ge_u32 s32, 4
    s_cbranch_scc1 w_ndH
    s_cmp_lg_u32 s70, 0
    s_cbranch_scc1 w_ndH
    s_load_dwordx2 s[8:9], s[0:1], s33
    s_load_dwordx2 s[12:13], s[0:1], s34
    s_mov_b32 s10, s38
    s_mov_b32 s14, s38
    s_cmp_ge_u32 s32, 4
    s_cselect_b32 s31, 0, 1
    s_lshl_b32 s30, s3, s31
    s_mul_i32 s30, s30, s40
    s_add_u32 s16, s39, s30
    s_cmp_eq_u32 s32, 4
    s_cselect_b32 s30, 1024, s40
    s_cselect_b32 s31, 6, 5
    s_lshl_b32 s62, 32, s31
    s_add_u32 s17, s16, s30
    s_lshl_b32 s30, s3, 2
    s_mul_i32 s30, s30, s35
    s_add_u32 s18, s36, s30
    s_add_u32 s19, s37, s30
    s_lshl_b32 s20, s35, s31
    v_mul_u32_u24 v2, s35, v4
    v_add_u32 v2, v2, v3
    s_waitcnt lgkmcnt(0)
w_bodyH:
    s_waitcnt vmcnt(8)
    s_barrier
    s_add_u32 m0, s21, 0
    s_nop 0
    buffer_load_dwordx4 v1, s[4:7], s16 offen sc1 lds
    s_add_u32 s16, s16, s62
    s_add_u32 m0, s21, 1024
    s_nop 0
    buffer_load_dwordx4 v1, s[4:7], s17 offen sc1 lds
    s_add_u32 s17, s17, s62
    s_add_u32 m0, s22, 0
    s_nop 0
    buffer_load_dwordx4 v2, s[8:11], s18 offen lds
    s_add_u32 s18, s18, s20
    s_add_u32 m0, s22, 8192
    s_nop 0
    buffer_load_dwordx4 v2, s[12:15], s19 offen lds
    s_add_u32 s19, s19, s20
    v_mfma_f32_16x16x32_bf16 v[128:131], v[64:67], v[32:35], v[128:131]
    ds_read_b64_tr_b16 v[112:113], v8 offset:49152
    v_mfma_f32_16x16x32_bf16 v[132:135], v[68:71], v[32:35], v[132:135]
    ds_read_b64_tr_b16 v[114:115], v9 offset:49152
    v_mfma_f32_16x16x32_bf16 v[144:147], v[64:67], v[40:43], v[144:147]
    ds_read_b64_tr_b16 v[116:117], v10 offset:49152
    v_mfma_f32_16x16x32_bf16 v[148:151], v[68:71], v[40:43], v[148:151]
    ds_read_b64_tr_b16 v[118:119], v11 offset:49152
    v_mfma_f32_16x16x32_bf16 v[160:163], v[64:67], v[48:51], v[160:163]
    ds_read_b64_tr_b16 v[120:121], v8 offset:57344
    v_mfma_f32_16x16x32_bf16 v[164:167], v[68:71], v[48:51], v[164:167]
    ds_read_b64_tr_b16 v[122:123], v9 offset:57344
    v_mfma_f32_16x16x32_bf16 v[176:179], v[64:67], v[56:59], v[176:179]
    ds_read_b64_tr_b16 v[124:125], v10 offset:57344
    v_mfma_f32_16x16x32_bf16 v[180:183], v[68:71], v[56:59], v[180:183]
    ds_read_b64_tr_b16 v[126:127], v11 offset:57344
    v_mfma_f32_16x16x32_bf16 v[128:131], v[72:75], v[36:39], v[128:131]
    ds_read_b128 v[80:83], v5 offset:32768
    v_mfma_f32_16x16x32_bf16 v[132:135], v[76:79], v[36:39], v[132:135]
    ds_read_b128 v[84:87], v5 offset:33792
    v_mfma_f32_16x16x32_bf16 v[144:147], v[72:75], v[44:47], v[144:147]
    ds_read_b128 v[88:91], v5 offset:34816
    v_mfma_f32_16x16x32_bf16 v[148:151], v[76:79], v[44:47], v[148:151]
    ds_read_b128 v[92:95], v5 offset:35840
    v_mfma_f32_16x16x32_bf16 v[160:163], v[72:75], v[52:55], v[160:163]
    ds_read_b128 v[96:99], v5 offset:36864
    v_mfma_f32_16x16x32_bf16 v[164:167], v[76:79], v[52:55], v[164:167]
    ds_read_b128 v[100:103], v5 offset:37888
    v_mfma_f32_16x16x32_bf16 v[176:179], v[72:75], v[60:63], v[176:179]
    ds_read_b128 v[104:107], v5 offset:38912
    v_mfma_f32_16x16x32_bf16 v[180:183], v[76:79], v[60:63], v[180:183]
    ds_read_b128 v[108:111], v5 offset:39936
    buffer_load_dword v16, v17, s[4:7], s44 offen sc1
    s_waitcnt lgkmcnt(0)
    s_waitcnt vmcnt(8)
    s_barrier
    s_add_u32 m0, s21, 32768
    s_nop 0
    buffer_load_dwordx4 v1, s[4:7], s16 offen sc1 lds
    s_add_u32 s16, s16, s62
    s_add_u32 m0, s21, 33792
    s_nop 0
    buffer_load_dwordx4 v1, s[4:7], s17 offen sc1 lds
    s_add_u32 s17, s17, s62
    s_add_u32 m0, s22, 32768
    s_nop 0
    buffer_load_dwordx4 v2, s[8:11], s18 offen lds
    s_add_u32 s18, s18, s20
    s_add_u32 m0, s22, 40960
    s_nop 0
    buffer_load_dwordx4 v2, s[12:15], s19 offen lds
    s_add_u32 s19, s19, s20
    v_mfma_f32_16x16x32_bf16 v[128:131], v[112:115], v[80:83], v[128:131]
    ds_read_b64_tr_b16 v[64:65], v12 offset:16384
    v_mfma_f32_16x16x32_bf16 v[132:135], v[116:119], v[80:83], v[132:135]
    ds_read_b64_tr_b16 v[66:67], v13 offset:16384
    v_mfma_f32_16x16x32_bf16 v[144:147], v[112:115], v[88:91], v[144:147]
    ds_read_b64_tr_b16 v[68:69], v14 offset:16384
    v_mfma_f32_16x16x32_bf16 v[148:151], v[116:119], v[88:91], v[148:151]
    ds_read_b64_tr_b16 v[70:71], v15 offset:16384
    v_mfma_f32_16x16x32_bf16 v[160:163], v[112:115], v[96:99], v[160:163]
    ds_read_b64_tr_b16 v[72:73], v12 offset:24576
    v_mfma_f32_16x16x32_bf16 v[164:167], v[116:119], v[96:99], v[164:167]
    ds_read_b64_tr_b16 v[74:75], v13 offset:24576
    v_mfma_f32_16x16x32_bf16 v[176:179], v[112:115], v[104:107], v[176:179]
    ds_read_b64_tr_b16 v[76:77], v14 offset:24576
    v_mfma_f32_16x16x32_bf16 v[180:183], v[116:119], v[104:107], v[180:183]
    ds_read_b64_tr_b16 v[78:79], v15 offset:24576
    v_mfma_f32_16x16x32_bf16 v[128:131], v[120:123], v[84:87], v[128:131]
    ds_read_b128 v[32:35], v6 offset:0
    v_mfma_f32_16x16x32_bf16 v[132:135], v[124:127], v[84:87], v[132:135]
    ds_read_b128 v[36:39], v6 offset:1024
    v_mfma_f32_16x16x32_bf16 v[144:147], v[120:123], v[92:95], v[144:147]
    ds_read_b128 v[40:43], v6 offset:2048
    v_mfma_f32_16x16x32_bf16 v[148:151], v[124:127], v[92:95], v[148:151]
    ds_read_b128 v[44:47], v6 offset:3072
    v_mfma_f32_16x16x32_bf16 v[160:163], v[120:123], v[100:103], v[160:163]
    ds_read_b128 v[48:51], v6 offset:4096
    v_mfma_f32_16x16x32_bf16 v[164:167], v[124:127], v[100:103], v[164:167]
    ds_read_b128 v[52:55], v6 offset:5120
    v_mfma_f32_16x16x32_bf16 v[176:179], v[120:123], v[108:111], v[176:179]
    ds_read_b128 v[56:59], v6 offset:6144
    v_mfma_f32_16x16x32_bf16 v[180:183], v[124:127], v[108:111], v[180:183]
    ds_read_b128 v[60:63], v6 offset:7168
    s_waitcnt lgkmcnt(0)
    s_waitcnt vmcnt(8)
    s_barrier
    s_add_u32 m0, s21, 65536
    s_nop 0
    buffer_load_dwordx4 v1, s[4:7], s16 offen sc1 lds
    s_add_u32 s16, s16, s62
    s_add_u32 m0, s21, 66560
    s_nop 0
    buffer_load_dwordx4 v1, s[4:7], s17 offen sc1 lds
    s_add_u32 s17, s17, s62
    s_add_u32 m0, s22, 65536
    s_nop 0
    buffer_load_dwordx4 v2, s[8:11], s18 offen lds
    s_add_u32 s18, s18, s20
    s_add_u32 m0, s22, 73728
    s_nop 0
    buffer_load_dwordx4 v2, s[12:15], s19 offen lds
    s_add_u32 s19, s19, s20
    v_mfma_f32_16x16x32_bf16 v[128:131], v[64:67], v[32:35], v[128:131]
    ds_read_b64_tr_b16 v[112:113], v12 offset:49152
    v_mfma_f32_16x16x32_bf16 v[132:135], v[68:71], v[32:35], v[132:135]
    ds_read_b64_tr_b16 v[114:115], v13 offset:49152
    v_mfma_f32_16x16x32_bf16 v[144:147], v[64:67], v[40:43], v[144:147]
    ds_read_b64_tr_b16 v[116:117], v14 offset:49152
    v_mfma_f32_16x16x32_bf16 v[148:151], v[68:71], v[40:43], v[148:151]
    ds_read_b64_tr_b16 v[118:119], v15 offset:49152
    v_mfma_f32_16x16x32_bf16 v[160:163], v[64:67], v[48:51], v[160:163]
    ds_read_b64_tr_b16 v[120:121], v12 offset:57344
    v_mfma_f32_16x16x32_bf16 v[164:167], v[68:71], v[48:51], v[164:167]
    ds_read_b64_tr_b16 v[122:123], v13 offset:57344
    v_mfma_f32_16x16x32_bf16 v[176:179], v[64:67], v[56:59], v[176:179]
    ds_read_b64_tr_b16 v[124:125], v14 offset:57344
    v_mfma_f32_16x16x32_bf16 v[180:183], v[68:71], v[56:59], v[180:183]
    ds_read_b64_tr_b16 v[126:127], v15 offset:57344
    v_mfma_f32_16x16x32_bf16 v[128:131], v[72:75], v[36:39], v[128:131]
    ds_read_b128 v[80:83], v6 offset:32768
    v_mfma_f32_16x16x32_bf16 v[132:135], v[76:79], v[36:39], v[132:135]
    ds_read_b128 v[84:87], v6 offset:33792
    v_mfma_f32_16x16x32_bf16 v[144:147], v[72:75], v[44:47], v[144:147]
    ds_read_b128 v[88:91], v6 offset:34816
    v_mfma_f32_16x16x32_bf16 v[148:151], v[76:79], v[44:47], v[148:151]
    ds_read_b128 v[92:95], v6 offset:35840
    v_mfma_f32_16x16x32_bf16 v[160:163], v[72:75], v[52:55], v[160:163]
    ds_read_b128 v[96:99], v6 offset:36864
    v_mfma_f32_16x16x32_bf16 v[164:167], v[76:79], v[52:55], v[164:167]
    ds_read_b128 v[100:103], v6 offset:37888
    v_mfma_f32_16x16x32_bf16 v[176:179], v[72:75], v[60:63], v[176:179]
    ds_read_b128 v[104:107], v6 offset:38912
    v_mfma_f32_16x16x32_bf16 v[180:183], v[76:79], v[60:63], v[180:183]
    ds_read_b128 v[108:111], v6 offset:39936
    s_waitcnt lgkmcnt(0)
    s_waitcnt vmcnt(8)
    s_barrier
    s_add_u32 m0, s21, 98304
    s_nop 0
    buffer_load_dwordx4 v1, s[4:7], s16 offen sc1 lds
    s_add_u32 s16, s16, s62
    s_add_u32 m0, s21, 99328
    s_nop 0
    buffer_load_dwordx4 v1, s[4:7], s17 offen sc1 lds
    s_add_u32 s17, s17, s62
    s_add_u32 m0, s22, 98304
    s_nop 0
    buffer_load_dwordx4 v2, s[8:11], s18 offen lds
    s_add_u32 s18, s18, s20
    s_add_u32 m0, s22, 106496
    s_nop 0
    buffer_load_dwordx4 v2, s[12:15], s19 offen lds
    s_add_u32 s19, s19, s20
    v_mfma_f32_16x16x32_bf16 v[128:131], v[112:115], v[80:83], v[128:131]
    ds_read_b64_tr_b16 v[64:65], v8 offset:16384
    v_mfma_f32_16x16x32_bf16 v[132:135], v[116:119], v[80:83], v[132:135]
    ds_read_b64_tr_b16 v[66:67], v9 offset:16384
    v_mfma_f32_16x16x32_bf16 v[144:147], v[112:115], v[88:91], v[144:147]
    ds_read_b64_tr_b16 v[68:69], v10 offset:16384
    v_mfma_f32_16x16x32_bf16 v[148:151], v[116:119], v[88:91], v[148:151]
    ds_read_b64_tr_b16 v[70:71], v11 offset:16384
    v_mfma_f32_16x16x32_bf16 v[160:163], v[112:115], v[96:99], v[160:163]
    ds_read_b64_tr_b16 v[72:73], v8 offset:24576
    v_mfma_f32_16x16x32_bf16 v[164:167], v[116:119], v[96:99], v[164:167]
    ds_read_b64_tr_b16 v[74:75], v9 offset:24576
    v_mfma_f32_16x16x32_bf16 v[176:179], v[112:115], v[104:107], v[176:179]
    ds_read_b64_tr_b16 v[76:77], v10 offset:24576
    v_mfma_f32_16x16x32_bf16 v[180:183], v[116:119], v[104:107], v[180:183]
    ds_read_b64_tr_b16 v[78:79], v11 offset:24576
    v_mfma_f32_16x16x32_bf16 v[128:131], v[120:123], v[84:87], v[128:131]
    ds_read_b128 v[32:35], v5 offset:0
    v_mfma_f32_16x16x32_bf16 v[132:135], v[124:127], v[84:87], v[132:135]
    ds_read_b128 v[36:39], v5 offset:1024
    v_mfma_f32_16x16x32_bf16 v[144:147], v[120:123], v[92:95], v[144:147]
    ds_read_b128 v[40:43], v5 offset:2048
    v_mfma_f32_16x16x32_bf16 v[148:151], v[124:127], v[92:95], v[148:151]
    ds_read_b128 v[44:47], v5 offset:3072
    v_mfma_f32_16x16x32_bf16 v[160:163], v[120:123], v[100:103], v[160:163]
    ds_read_b128 v[48:51], v5 offset:4096
    v_mfma_f32_16x16x32_bf16 v[164:167], v[124:127], v[100:103], v[164:167]
    ds_read_b128 v[52:55], v5 offset:5120
    v_mfma_f32_16x16x32_bf16 v[176:179], v[120:123], v[108:111], v[176:179]
    ds_read_b128 v[56:59], v5 offset:6144
    v_mfma_f32_16x16x32_bf16 v[180:183], v[124:127], v[108:111], v[180:183]
    ds_read_b128 v[60:63], v5 offset:7168
    s_waitcnt lgkmcnt(0)
    s_sub_u32 s23, s23, 1
    s_cmp_lg_u32 s23, 0
    s_cbranch_scc1 w_loopH
    s_branch w_endH
w_ndH:
    s_waitcnt vmcnt(8)
    s_barrier
    v_mfma_f32_16x16x32_bf16 v[128:131], v[64:67], v[32:35], v[128:131]
    ds_read_b64_tr_b16 v[112:113], v8 offset:49152
    v_mfma_f32_16x16x32_bf16 v[132:135], v[68:71], v[32:35], v[132:135]
    ds_read_b64_tr_b16 v[114:115], v9 offset:49152
    v_mfma_f32_16x16x32_bf16 v[144:147], v[64:67], v[40:43], v[144:147]
    ds_read_b64_tr_b16 v[116:117], v10 offset:49152
    v_mfma_f32_16x16x32_bf16 v[148:151], v[68:71], v[40:43], v[148:151]
    ds_read_b64_tr_b16 v[118:119], v11 offset:49152
    v_mfma_f32_16x16x32_bf16 v[160:163], v[64:67], v[48:51], v[160:163]
    ds_read_b64_tr_b16 v[120:121], v8 offset:57344
    v_mfma_f32_16x16x32_bf16 v[164:167], v[68:71], v[48:51], v[164:167]
    ds_read_b64_tr_b16 v[122:123], v9 offset:57344
    v_mfma_f32_16x16x32_bf16 v[176:179], v[64:67], v[56:59], v[176:179]
    ds_read_b64_tr_b16 v[124:125], v10 offset:57344
    v_mfma_f32_16x16x32_bf16 v[180:183], v[68:71], v[56:59], v[180:183]
    ds_read_b64_tr_b16 v[126:127], v11 offset:57344
    v_mfma_f32_16x16x32_bf16 v[128:131], v[72:75], v[36:39], v[128:131]
    ds_read_b128 v[80:83], v5 offset:32768
    v_mfma_f32_16x16x32_bf16 v[132:135], v[76:79], v[36:39], v[132:135]
    ds_read_b128 v[84:87], v5 offset:33792
    v_mfma_f32_16x16x32_bf16 v[144:147], v[72:75], v[44:47], v[144:147]
    ds_read_b128 v[88:91], v5 offset:34816
    v_mfma_f32_16x16x32_bf16 v[148:151], v[76:79], v[44:47], v[148:151]
    ds_read_b128 v[92:95], v5 offset:35840
    v_mfma_f32_16x16x32_bf16 v[160:163], v[72:75], v[52:55], v[160:163]
    ds_read_b128 v[96:99], v5 offset:36864
    v_mfma_f32_16x16x32_bf16 v[164:167], v[76:79], v[52:55], v[164:167]
    ds_read_b128 v[100:103], v5 offset:37888
    v_mfma_f32_16x16x32_bf16 v[176:179], v[72:75], v[60:63], v[176:179]
    ds_read_b128 v[104:107], v5 offset:38912
    v_mfma_f32_16x16x32_bf16 v[180:183], v[76:79], v[60:63], v[180:183]
    ds_read_b128 v[108:111], v5 offset:39936
    s_waitcnt lgkmcnt(0)
    s_waitcnt vmcnt(4)
    s_barrier
    v_mfma_f32_16x16x32_bf16 v[128:131], v[112:115], v[80:83], v[128:131]
    ds_read_b64_tr_b16 v[64:65], v12 offset:16384
    v_mfma_f32_16x16x32_bf16 v[132:135], v[116:119], v[80:83], v[132:135]
    ds_read_b64_tr_b16 v[66:67], v13 offset:16384
    v_mfma_f32_16x16x32_bf16 v[144:147], v[112:115], v[88:91], v[144:147]
    ds_read_b64_tr_b16 v[68:69], v14 offset:16384
    v_mfma_f32_16x16x32_bf16 v[148:151], v[116:119], v[88:91], v[148:151]
    ds_read_b64_tr_b16 v[70:71], v15 offset:16384
    v_mfma_f32_16x16x32_bf16 v[160:163], v[112:115], v[96:99], v[160:163]
    ds_read_b64_tr_b16 v[72:73], v12 offset:24576
    v_mfma_f32_16x16x32_bf16 v[164:167], v[116:119], v[96:99], v[164:167]
    ds_read_b64_tr_b16 v[74:75], v13 offset:24576
    v_mfma_f32_16x16x32_bf16 v[176:179], v[112:115], v[104:107], v[176:179]
    ds_read_b64_tr_b16 v[76:77], v14 offset:24576
    v_mfma_f32_16x16x32_bf16 v[180:183], v[116:119], v[104:107], v[180:183]
    ds_read_b64_tr_b16 v[78:79], v15 offset:24576
    v_mfma_f32_16x16x32_bf16 v[128:131], v[120:123], v[84:87], v[128:131]
    ds_read_b128 v[32:35], v6 offset:0
    v_mfma_f32_16x16x32_bf16 v[132:135], v[124:127], v[84:87], v[132:135]
    ds_read_b128 v[36:39], v6 offset:1024
    v_mfma_f32_16x16x32_bf16 v[144:147], v[120:123], v[92:95], v[144:147]
    ds_read_b128 v[40:43], v6 offset:2048
    v_mfma_f32_16x16x32_bf16 v[148:151], v[124:127], v[92:95], v[148:151]
    ds_read_b128 v[44:47], v6 offset:3072
    v_mfma_f32_16x16x32_bf16 v[160:163], v[120:123], v[100:103], v[160:163]
    ds_read_b128 v[48:51], v6 offset:4096
    v_mfma_f32_16x16x32_bf16 v[164:167], v[124:127], v[100:103], v[164:167]
    ds_read_b128 v[52:55], v6 offset:5120
    v_mfma_f32_16x16x32_bf16 v[176:179], v[120:123], v[108:111], v[176:179]
    ds_read_b128 v[56:59], v6 offset:6144
    v_mfma_f32_16x16x32_bf16 v[180:183], v[124:127], v[108:111], v[180:183]
    ds_read_b128 v[60:63], v6 offset:7168
    s_waitcnt lgkmcnt(0)
    s_waitcnt vmcnt(0)
    s_barrier
    v_mfma_f32_16x16x32_bf16 v[128:131], v[64:67], v[32:35], v[128:131]
    ds_read_b64_tr_b16 v[112:113], v12 offset:49152
    v_mfma_f32_16x16x32_bf16 v[132:135], v[68:71], v[32:35], v[132:135]
    ds_read_b64_tr_b16 v[114:115], v13 offset:49152
    v_mfma_f32_16x16x32_bf16 v[144:147], v[64:67], v[40:43], v[144:147]
    ds_read_b64_tr_b16 v[116:117], v14 offset:49152
    v_mfma_f32_16x16x32_bf16 v[148:151], v[68:71], v[40:43], v[148:151]
    ds_read_b64_tr_b16 v[118:119], v15 offset:49152
    v_mfma_f32_16x16x32_bf16 v[160:163], v[64:67], v[48:51], v[160:163]
    ds_read_b64_tr_b16 v[120:121], v12 offset:57344
    v_mfma_f32_16x16x32_bf16 v[164:167], v[68:71], v[48:51], v[164:167]
    ds_read_b64_tr_b16 v[122:123], v13 offset:57344
    v_mfma_f32_16x16x32_bf16 v[176:179], v[64:67], v[56:59], v[176:179]
    ds_read_b64_tr_b16 v[124:125], v14 offset:57344
    v_mfma_f32_16x16x32_bf16 v[180:183], v[68:71], v[56:59], v[180:183]
    ds_read_b64_tr_b16 v[126:127], v15 offset:57344
    v_mfma_f32_16x16x32_bf16 v[128:131], v[72:75], v[36:39], v[128:131]
    ds_read_b128 v[80:83], v6 offset:32768
    v_mfma_f32_16x16x32_bf16 v[132:135], v[76:79], v[36:39], v[132:135]
    ds_read_b128 v[84:87], v6 offset:33792
    v_mfma_f32_16x16x32_bf16 v[144:147], v[72:75], v[44:47], v[144:147]
    ds_read_b128 v[88:91], v6 offset:34816
    v_mfma_f32_16x16x32_bf16 v[148:151], v[76:79], v[44:47], v[148:151]
    ds_read_b128 v[92:95], v6 offset:35840
    v_mfma_f32_16x16x32_bf16 v[160:163], v[72:75], v[52:55], v[160:163]
    ds_read_b128 v[96:99], v6 offset:36864
    v_mfma_f32_16x16x32_bf16 v[164:167], v[76:79], v[52:55], v[164:167]
    ds_read_b128 v[100:103], v6 offset:37888
    v_mfma_f32_16x16x32_bf16 v[176:179], v[72:75], v[60:63], v[176:179]
    ds_read_b128 v[104:107], v6 offset:38912
    v_mfma_f32_16x16x32_bf16 v[180:183], v[76:79], v[60:63], v[180:183]
    ds_read_b128 v[108:111], v6 offset:39936
    s_waitcnt lgkmcnt(0)
    s_waitcnt vmcnt(0)
    s_barrier
    v_mfma_f32_16x16x32_bf16 v[128:131], v[112:115], v[80:83], v[128:131]
    ds_read_b64_tr_b16 v[64:65], v8 offset:16384
    v_mfma_f32_16x16x32_bf16 v[132:135], v[116:119], v[80:83], v[132:135]
    ds_read_b64_tr_b16 v[66:67], v9 offset:16384
    v_mfma_f32_16x16x32_bf16 v[144:147], v[112:115], v[88:91], v[144:147]
    ds_read_b64_tr_b16 v[68:69], v10 offset:16384
    v_mfma_f32_16x16x32_bf16 v[148:151], v[116:119], v[88:91], v[148:151]
    ds_read_b64_tr_b16 v[70:71], v11 offset:16384
    v_mfma_f32_16x16x32_bf16 v[160:163], v[112:115], v[96:99], v[160:163]
    ds_read_b64_tr_b16 v[72:73], v8 offset:24576
    v_mfma_f32_16x16x32_bf16 v[164:167], v[116:119], v[96:99], v[164:167]
    ds_read_b64_tr_b16 v[74:75], v9 offset:24576
    v_mfma_f32_16x16x32_bf16 v[176:179], v[112:115], v[104:107], v[176:179]
    ds_read_b64_tr_b16 v[76:77], v10 offset:24576
    v_mfma_f32_16x16x32_bf16 v[180:183], v[116:119], v[104:107], v[180:183]
    ds_read_b64_tr_b16 v[78:79], v11 offset:24576
    v_mfma_f32_16x16x32_bf16 v[128:131], v[120:123], v[84:87], v[128:131]
    ds_read_b128 v[32:35], v5 offset:0
    v_mfma_f32_16x16x32_bf16 v[132:135], v[124:127], v[84:87], v[132:135]
    ds_read_b128 v[36:39], v5 offset:1024
    v_mfma_f32_16x16x32_bf16 v[144:147], v[120:123], v[92:95], v[144:147]
    ds_read_b128 v[40:43], v5 offset:2048
    v_mfma_f32_16x16x32_bf16 v[148:151], v[124:127], v[92:95], v[148:151]
    ds_read_b128 v[44:47], v5 offset:3072
    v_mfma_f32_16x16x32_bf16 v[160:163], v[120:123], v[100:103], v[160:163]
    ds_read_b128 v[48:51], v5 offset:4096
    v_mfma_f32_16x16x32_bf16 v[164:167], v[124:127], v[100:103], v[164:167]
    ds_read_b128 v[52:55], v5 offset:5120
    v_mfma_f32_16x16x32_bf16 v[176:179], v[120:123], v[108:111], v[176:179]
    ds_read_b128 v[56:59], v5 offset:6144
    v_mfma_f32_16x16x32_bf16 v[180:183], v[124:127], v[108:111], v[180:183]
    ds_read_b128 v[60:63], v5 offset:7168
    s_waitcnt lgkmcnt(0)
w_endH:
    v_mov_b32 v20, 131072
    ds_read_b128 v[24:27], v20
    ds_read_b128 v[28:31], v20 offset:16
    s_cmp_lg_u32 s53, s53
    s_cbranch_scc1 w_epi_siluH
    s_lshl_b32 s30, s27, 10
    s_add_u32 s30, s30, s49
    s_nop 7
    v_cvt_pk_bf16_f32 v80, v128, v129
    v_cvt_pk_bf16_f32 v81, v130, v131
    v_cvt_pk_bf16_f32 v82, v132, v133
    v_cvt_pk_bf16_f32 v83, v134, v135
    buffer_store_dwordx4 v[80:83], v1, s[4:7], s30 offen sc1
    s_add_u32 s30, s30, s50
    v_cvt_pk_bf16_f32 v84, v144, v145
    v_cvt_pk_bf16_f32 v85, v146, v147
    v_cvt_pk_bf16_f32 v86, v148, v149
    v_cvt_pk_bf16_f32 v87, v150, v151
    buffer_store_dwordx4 v[84:87], v1, s[4:7], s30 offen sc1
    s_add_u32 s30, s30, s50
    v_cvt_pk_bf16_f32 v88, v160, v161
    v_cvt_pk_bf16_f32 v89, v162, v163
    v_cvt_pk_bf16_f32 v90, v164, v165
    v_cvt_pk_bf16_f32 v91, v166, v167
    buffer_store_dwordx4 v[88:91], v1, s[4:7], s30 offen sc1
    s_add_u32 s30, s30, s50
    v_cvt_pk_bf16_f32 v92, v176, v177
    v_cvt_pk_bf16_f32 v93, v178, v179
    v_cvt_pk_bf16_f32 v94, v180, v181
    v_cvt_pk_bf16_f32 v95, v182, v183
    buffer_store_dwordx4 v[92:95], v1, s[4:7], s30 offen sc1
    s_add_u32 s30, s30, s50
    s_waitcnt lgkmcnt(0)
    v_or3_b32 v24, v24, v25, v26
    v_or3_b32 v28, v28, v29, v30
    v_or3_b32 v24, v24, v27, v31
    v_or_b32 v24, v24, v28
    s_mov_b32 s28, s51
    s_mov_b32 s57, s53
    v_readfirstlane_b32 s30, v24
    s_cmp_lg_u32 s30, 0
    s_cbranch_scc1 w_drain
    s_mov_b32 s48, s32
    s_cmp_ge_u32 s32, 4
    s_cselect_b32 s30, 2, 3
    s_lshl_b32 s30, s26, s30
    s_mul_i32 s30, s30, s43
    s_add_u32 s49, s42, s30
    s_mov_b32 s50, s43
    s_mov_b32 s51, s46
    s_mov_b32 s23, s41
    s_mov_b32 s53, s47
    s_nop 0
    s_load_dwordx16 s[32:47], s[24:25], 0
    s_add_u32 s24, s24, 64
    s_addc_u32 s25, s25, 0
    s_branch w_first4
w_epi_siluH:
    s_lshl_b32 s30, s27, 10
    s_add_u32 s30, s30, s49
    s_mov_b32 s54, 0xbfb8aa3b
    s_nop 7
    v_cvt_pk_bf16_f32 v80, v128, v129
    v_cvt_pk_bf16_f32 v81, v130, v131
    v_cvt_pk_bf16_f32 v82, v132, v133
    v_cvt_pk_bf16_f32 v83, v134, v135
    v_lshlrev_b32 v128, 16, v80
    v_and_b32 v129, 0xffff0000, v80
    v_lshlrev_b32 v130, 16, v81
    v_and_b32 v131, 0xffff0000, v81
    v_lshlrev_b32 v132, 16, v82
    v_and_b32 v133, 0xffff0000, v82
    v_lshlrev_b32 v134, 16, v83
    v_and_b32 v135, 0xffff0000, v83
    v_mul_f32 v104, s54, v128
    v_mul_f32 v105, s54, v129
    v_mul_f32 v106, s54, v130
    v_mul_f32 v107, s54, v131
    v_mul_f32 v108, s54, v132
    v_mul_f32 v109, s54, v133
    v_mul_f32 v110, s54, v134
    v_mul_f32 v111, s54, v135
    v_exp_f32 v104, v104
    v_exp_f32 v105, v105
    v_exp_f32 v106, v106
    v_exp_f32 v107, v107
    v_exp_f32 v108, v108
    v_exp_f32 v109, v109
    v_exp_f32 v110, v110
    v_exp_f32 v111, v111
    v_add_f32 v104, 1.0, v104
    v_add_f32 v105, 1.0, v105
    v_add_f32 v106, 1.0, v106
    v_add_f32 v107, 1.0, v107
    v_add_f32 v108, 1.0, v108
    v_add_f32 v109, 1.0, v109
    v_add_f32 v110, 1.0, v110
    v_add_f32 v111, 1.0, v111
    v_rcp_f32 v104, v104
    v_rcp_f32 v105, v105
    v_rcp_f32 v106, v106
    v_rcp_f32 v107, v107
    v_rcp_f32 v108, v108
    v_rcp_f32 v109, v109
    v_rcp_f32 v110, v110
    v_rcp_f32 v111, v111
    v_mul_f32 v128, v128, v104
    v_mul_f32 v129, v129, v105
    v_mul_f32 v130, v130, v106
    v_mul_f32 v131, v131, v107
    v_mul_f32 v132, v132, v108
    v_mul_f32 v133, v133, v109
    v_mul_f32 v134, v134, v110
    v_mul_f32 v135, v135, v111
    v_cvt_pk_bf16_f32 v80, v128, v129
    v_cvt_pk_bf16_f32 v81, v130, v131
    v_cvt_pk_bf16_f32 v82, v132, v133
    v_cvt_pk_bf16_f32 v83, v134, v135
    buffer_store_dwordx4 v[80:83], v1, s[4:7], s30 offen sc1
    s_add_u32 s30, s30, s50
    v_cvt_pk_bf16_f32 v84, v144, v145
    v_cvt_pk_bf16_f32 v85, v146, v147
    v_cvt_pk_bf16_f32 v86, v148, v149
    v_cvt_pk_bf16_f32 v87, v150, v151
    v_lshlrev_b32 v144, 16, v84
    v_and_b32 v145, 0xffff0000, v84
    v_lshlrev_b32 v146, 16, v85
    v_and_b32 v147, 0xffff0000, v85
    v_lshlrev_b32 v148, 16, v86
    v_and_b32 v149, 0xffff0000, v86
    v_lshlrev_b32 v150, 16, v87
    v_and_b32 v151, 0xffff0000, v87
    v_mul_f32 v96, s54, v144
    v_mul_f32 v97, s54, v145
    v_mul_f32 v98, s54, v146
    v_mul_f32 v99, s54, v147
    v_mul_f32 v100, s54, v148
    v_mul_f32 v101, s54, v149
    v_mul_f32 v102, s54, v150
    v_mul_f32 v103, s54, v151
    v_exp_f32 v96, v96
    v_exp_f32 v97, v97
    v_exp_f32 v98, v98
    v_exp_f32 v99, v99
    v_exp_f32 v100, v100
    v_exp_f32 v101, v101
    v_exp_f32 v102, v102
    v_exp_f32 v103, v103
    v_add_f32 v96, 1.0, v96
    v_add_f32 v97, 1.0, v97
    v_add_f32 v98, 1.0, v98
    v_add_f32 v99, 1.0, v99
    v_add_f32 v100, 1.0, v100
    v_add_f32 v101, 1.0, v101
    v_add_f32 v102, 1.0, v102
    v_add_f32 v103, 1.0, v103
    v_rcp_f32 v96, v96
    v_rcp_f32 v97, v97
    v_rcp_f32 v98, v98
    v_rcp_f32 v99, v99
    v_rcp_f32 v100, v100
    v_rcp_f32 v101, v101
    v_rcp_f32 v102, v102
    v_rcp_f32 v103, v103
    v_mul_f32 v144, v144, v96
    v_mul_f32 v145, v145, v97
    v_mul_f32 v146, v146, v98
    v_mul_f32 v147, v147, v99
    v_mul_f32 v148, v148, v100
    v_mul_f32 v149, v149, v101
    v_mul_f32 v150, v150, v102
    v_mul_f32 v151, v151, v103
    v_cvt_pk_bf16_f32 v84, v144, v145
    v_cvt_pk_bf16_f32 v85, v146, v147
    v_cvt_pk_bf16_f32 v86, v148, v149
    v_cvt_pk_bf16_f32 v87, v150, v151
    buffer_store_dwordx4 v[84:87], v1, s[4:7], s30 offen sc1
    s_add_u32 s30, s30, s50
    v_cvt_pk_bf16_f32 v88, v160, v161
    v_cvt_pk_bf16_f32 v89, v162, v163
    v_cvt_pk_bf16_f32 v90, v164, v165
    v_cvt_pk_bf16_f32 v91, v166, v167
    v_lshlrev_b32 v160, 16, v88
    v_and_b32 v161, 0xffff0000, v88
    v_lshlrev_b32 v162, 16, v89
    v_and_b32 v163, 0xffff0000, v89
    v_lshlrev_b32 v164, 16, v90
    v_and_b32 v165, 0xffff0000, v90
    v_lshlrev_b32 v166, 16, v91
    v_and_b32 v167, 0xffff0000, v91
    v_mul_f32 v104, s54, v160
    v_mul_f32 v105, s54, v161
    v_mul_f32 v106, s54, v162
    v_mul_f32 v107, s54, v163
    v_mul_f32 v108, s54, v164
    v_mul_f32 v109, s54, v165
    v_mul_f32 v110, s54, v166
    v_mul_f32 v111, s54, v167
    v_exp_f32 v104, v104
    v_exp_f32 v105, v105
    v_exp_f32 v106, v106
    v_exp_f32 v107, v107
    v_exp_f32 v108, v108
    v_exp_f32 v109, v109
    v_exp_f32 v110, v110
    v_exp_f32 v111, v111
    v_add_f32 v104, 1.0, v104
    v_add_f32 v105, 1.0, v105
    v_add_f32 v106, 1.0, v106
    v_add_f32 v107, 1.0, v107
    v_add_f32 v108, 1.0, v108
    v_add_f32 v109, 1.0, v109
    v_add_f32 v110, 1.0, v110
    v_add_f32 v111, 1.0, v111
    v_rcp_f32 v104, v104
    v_rcp_f32 v105, v105
    v_rcp_f32 v106, v106
    v_rcp_f32 v107, v107
    v_rcp_f32 v108, v108
    v_rcp_f32 v109, v109
    v_rcp_f32 v110, v110
    v_rcp_f32 v111, v111
    v_mul_f32 v160, v160, v104
    v_mul_f32 v161, v161, v105
    v_mul_f32 v162, v162, v106
    v_mul_f32 v163, v163, v107
    v_mul_f32 v164, v164, v108
    v_mul_f32 v165, v165, v109
    v_mul_f32 v166, v166, v110
    v_mul_f32 v167, v167, v111
    v_cvt_pk_bf16_f32 v88, v160, v161
    v_cvt_pk_bf16_f32 v89, v162, v163
    v_cvt_pk_bf16_f32 v90, v164, v165
    v_cvt_pk_bf16_f32 v91, v166, v167
    buffer_store_dwordx4 v[88:91], v1, s[4:7], s30 offen sc1
    s_add_u32 s30, s30, s50
    v_cvt_pk_bf16_f32 v92, v176, v177
    v_cvt_pk_bf16_f32 v93, v178, v179
    v_cvt_pk_bf16_f32 v94, v180, v181
    v_cvt_pk_bf16_f32 v95, v182, v183
    v_lshlrev_b32 v176, 16, v92
    v_and_b32 v177, 0xffff0000, v92
    v_lshlrev_b32 v178, 16, v93
    v_and_b32 v179, 0xffff0000, v93
    v_lshlrev_b32 v180, 16, v94
    v_and_b32 v181, 0xffff0000, v94
    v_lshlrev_b32 v182, 16, v95
    v_and_b32 v183, 0xffff0000, v95
    v_mul_f32 v96, s54, v176
    v_mul_f32 v97, s54, v177
    v_mul_f32 v98, s54, v178
    v_mul_f32 v99, s54, v179
    v_mul_f32 v100, s54, v180
    v_mul_f32 v101, s54, v181
    v_mul_f32 v102, s54, v182
    v_mul_f32 v103, s54, v183
    v_exp_f32 v96, v96
    v_exp_f32 v97, v97
    v_exp_f32 v98, v98
    v_exp_f32 v99, v99
    v_exp_f32 v100, v100
    v_exp_f32 v101, v101
    v_exp_f32 v102, v102
    v_exp_f32 v103, v103
    v_add_f32 v96, 1.0, v96
    v_add_f32 v97, 1.0, v97
    v_add_f32 v98, 1.0, v98
    v_add_f32 v99, 1.0, v99
    v_add_f32 v100, 1.0, v100
    v_add_f32 v101, 1.0, v101
    v_add_f32 v102, 1.0, v102
    v_add_f32 v103, 1.0, v103
    v_rcp_f32 v96, v96
    v_rcp_f32 v97, v97
    v_rcp_f32 v98, v98
    v_rcp_f32 v99, v99
    v_rcp_f32 v100, v100
    v_rcp_f32 v101, v101
    v_rcp_f32 v102, v102
    v_rcp_f32 v103, v103
    v_mul_f32 v176, v176, v96
    v_mul_f32 v177, v177, v97
    v_mul_f32 v178, v178, v98
    v_mul_f32 v179, v179, v99
    v_mul_f32 v180, v180, v100
    v_mul_f32 v181, v181, v101
    v_mul_f32 v182, v182, v102
    v_mul_f32 v183, v183, v103
    v_cvt_pk_bf16_f32 v92, v176, v177
    v_cvt_pk_bf16_f32 v93, v178, v179
    v_cvt_pk_bf16_f32 v94, v180, v181
    v_cvt_pk_bf16_f32 v95, v182, v183
    buffer_store_dwordx4 v[92:95], v1, s[4:7], s30 offen sc1
    s_add_u32 s30, s30, s50
    s_waitcnt lgkmcnt(0)
    v_or3_b32 v24, v24, v25, v26
    v_or3_b32 v28, v28, v29, v30
    v_or3_b32 v24, v24, v27, v31
    v_or_b32 v24, v24, v28
    s_mov_b32 s28, s51
    s_mov_b32 s57, s53
    v_readfirstlane_b32 s30, v24
    s_cmp_lg_u32 s30, 0
    s_cbranch_scc1 w_drain
    s_mov_b32 s48, s32
    s_cmp_ge_u32 s32, 4
    s_cselect_b32 s30, 2, 3
    s_lshl_b32 s30, s26, s30
    s_mul_i32 s30, s30, s43
    s_add_u32 s49, s42, s30
    s_mov_b32 s50, s43
    s_mov_b32 s51, s46
    s_mov_b32 s23, s41
    s_mov_b32 s53, s47
    s_nop 0
    s_load_dwordx16 s[32:47], s[24:25], 0
    s_add_u32 s24, s24, 64
    s_addc_u32 s25, s25, 0
    s_branch w_first4
w_firstX:
    s_waitcnt vmcnt(0)
    s_barrier
    v_bfe_u32 v20, v1, 4, 3
    v_xor_b32 v21, v4, v20
    v_lshlrev_b32 v21, 4, v21
    v_lshl_add_u32 v21, v20, 7, v21
    v_bfe_u32 v20, v1, 7, 1
    v_lshl_add_u32 v21, v20, 10, v21
    s_lshl_b32 s30, s26, 13
    v_add_u32 v24, s30, v21
    v_xor_b32 v25, 64, v24
    v_add_u32 v26, 0x10000, v24
    v_add_u32 v27, 0x10000, v25
    v_add_u32 v28, s22, v1
    v_add_u32 v29, 0x10000, v28
    ds_read_b64_tr_b16 v[64:65], v8 offset:16384
    ds_read_b64_tr_b16 v[66:67], v9 offset:16384
    ds_read_b64_tr_b16 v[68:69], v10 offset:16384
    ds_read_b64_tr_b16 v[70:71], v11 offset:16384
    ds_read_b64_tr_b16 v[72:73], v8 offset:24576
    ds_read_b64_tr_b16 v[74:75], v9 offset:24576
    ds_read_b64_tr_b16 v[76:77], v10 offset:24576
    ds_read_b64_tr_b16 v[78:79], v11 offset:24576
    ds_read_b128 v[32:35], v24 offset:0
    ds_read_b128 v[36:39], v25 offset:0
    ds_read_b128 v[40:43], v24 offset:2048
    ds_read_b128 v[44:47], v25 offset:2048
    ds_read_b128 v[48:51], v24 offset:4096
    ds_read_b128 v[52:55], v25 offset:4096
    ds_read_b128 v[56:59], v24 offset:6144
    ds_read_b128 v[60:63], v25 offset:6144
    v_mov_b32 v208, 0x3f803f80
    v_mov_b32 v209, 0x3f803f80
    v_mov_b32 v210, 0x3f803f80
    v_mov_b32 v211, 0x3f803f80
    s_waitcnt lgkmcnt(0)
    s_waitcnt vmcnt(8)
    s_barrier
    s_add_u32 m0, s21, 0
    s_nop 0
    buffer_load_dwordx4 v23, s[88:91], s16 offen lds
    s_add_u32 s16, s16, s62
    s_add_u32 m0, s21, 1024
    s_nop 0
    buffer_load_dwordx4 v23, s[88:91], s17 offen lds
    s_add_u32 s17, s17, s62
    s_cmp_ge_u32 s16, s92
    s_cselect_b32 s94, 2048, 0
    s_sub_u32 s16, s16, s94
    s_sub_u32 s17, s17, s94
    s_add_u32 m0, s22, 0
    s_nop 0
    buffer_load_dwordx4 v2, s[8:11], s18 offen lds
    s_add_u32 s18, s18, s20
    s_add_u32 m0, s22, 8192
    s_nop 0
    buffer_load_dwordx4 v2, s[12:15], s19 offen lds
    s_add_u32 s19, s19, s20
    s_cmp_ge_u32 s18, s95
    s_cselect_b32 s94, s93, 0
    s_sub_u32 s18, s18, s94
    s_sub_u32 s19, s19, s94
    v_mfma_f32_16x16x32_bf16 v[128:131], v[64:67], v[32:35], 0
    ds_read_b64_tr_b16 v[112:113], v8 offset:49152
    v_mfma_f32_16x16x32_bf16 v[132:135], v[68:71], v[32:35], 0
    ds_read_b64_tr_b16 v[114:115], v9 offset:49152
    v_mfma_f32_16x16x32_bf16 v[144:147], v[64:67], v[40:43], 0
    ds_read_b64_tr_b16 v[116:117], v10 offset:49152
    v_mfma_f32_16x16x32_bf16 v[148:151], v[68:71], v[40:43], 0
    ds_read_b64_tr_b16 v[118:119], v11 offset:49152
    v_mfma_f32_16x16x32_bf16 v[160:163], v[64:67], v[48:51], 0
    ds_read_b64_tr_b16 v[120:121], v8 offset:57344
    v_mfma_f32_16x16x32_bf16 v[164:167], v[68:71], v[48:51], 0
    ds_read_b64_tr_b16 v[122:123], v9 offset:57344
    v_mfma_f32_16x16x32_bf16 v[176:179], v[64:67], v[56:59], 0
    ds_read_b64_tr_b16 v[124:125], v10 offset:57344
    v_mfma_f32_16x16x32_bf16 v[180:183], v[68:71], v[56:59], 0
    ds_read_b64_tr_b16 v[126:127], v11 offset:57344
    v_mfma_f32_16x16x32_bf16 v[192:195], v[64:67], v[208:211], 0
    ds_read_b128 v[80:83], v24 offset:32768
    v_mfma_f32_16x16x32_bf16 v[196:199], v[68:71], v[208:211], 0
    ds_read_b128 v[84:87], v25 offset:32768
    v_mfma_f32_16x16x32_bf16 v[128:131], v[72:75], v[36:39], v[128:131]
    ds_read_b128 v[88:91], v24 offset:34816
    v_mfma_f32_16x16x32_bf16 v[132:135], v[76:79], v[36:39], v[132:135]
    ds_read_b128 v[92:95], v25 offset:34816
    v_mfma_f32_16x16x32_bf16 v[144:147], v[72:75], v[44:47], v[144:147]
    ds_read_b128 v[96:99], v24 offset:36864
    v_mfma_f32_16x16x32_bf16 v[148:151], v[76:79], v[44:47], v[148:151]
    ds_read_b128 v[100:103], v25 offset:36864
    v_mfma_f32_16x16x32_bf16 v[160:163], v[72:75], v[52:55], v[160:163]
    ds_read_b128 v[104:107], v24 offset:38912
    v_mfma_f32_16x16x32_bf16 v[164:167], v[76:79], v[52:55], v[164:167]
    ds_read_b128 v[108:111], v25 offset:38912
    v_mfma_f32_16x16x32_bf16 v[176:179], v[72:75], v[60:63], v[176:179]
    v_mfma_f32_16x16x32_bf16 v[180:183], v[76:79], v[60:63], v[180:183]
    v_mfma_f32_16x16x32_bf16 v[192:195], v[72:75], v[208:211], v[192:195]
    v_mfma_f32_16x16x32_bf16 v[196:199], v[76:79], v[208:211], v[196:199]
    s_waitcnt lgkmcnt(0)
    s_waitcnt vmcnt(8)
    s_barrier
    s_add_u32 m0, s21, 32768
    s_nop 0
    buffer_load_dwordx4 v23, s[88:91], s16 offen lds
    s_add_u32 s16, s16, s62
    s_add_u32 m0, s21, 33792
    s_nop 0
    buffer_load_dwordx4 v23, s[88:91], s17 offen lds
    s_add_u32 s17, s17, s62
    s_cmp_ge_u32 s16, s92
    s_cselect_b32 s94, 2048, 0
    s_sub_u32 s16, s16, s94
    s_sub_u32 s17, s17, s94
    s_add_u32 m0, s22, 32768
    s_nop 0
    buffer_load_dwordx4 v2, s[8:11], s18 offen lds
    s_add_u32 s18, s18, s20
    s_add_u32 m0, s22, 40960
    s_nop 0
    buffer_load_dwordx4 v2, s[12:15], s19 offen lds
    s_add_u32 s19, s19, s20
    s_cmp_ge_u32 s18, s95
    s_cselect_b32 s94, s93, 0
    s_sub_u32 s18, s18, s94
    s_sub_u32 s19, s19, s94
    v_mfma_f32_16x16x32_bf16 v[128:131], v[112:115], v[80:83], v[128:131]
    ds_read_b64_tr_b16 v[64:65], v12 offset:16384
    v_mfma_f32_16x16x32_bf16 v[132:135], v[116:119], v[80:83], v[132:135]
    ds_read_b64_tr_b16 v[66:67], v13 offset:16384
    v_mfma_f32_16x16x32_bf16 v[144:147], v[112:115], v[88:91], v[144:147]
    ds_read_b64_tr_b16 v[68:69], v14 offset:16384
    v_mfma_f32_16x16x32_bf16 v[148:151], v[116:119], v[88:91], v[148:151]
    ds_read_b64_tr_b16 v[70:71], v15 offset:16384
    v_mfma_f32_16x16x32_bf16 v[160:163], v[112:115], v[96:99], v[160:163]
    ds_read_b64_tr_b16 v[72:73], v12 offset:24576
    v_mfma_f32_16x16x32_bf16 v[164:167], v[116:119], v[96:99], v[164:167]
    ds_read_b64_tr_b16 v[74:75], v13 offset:24576
    v_mfma_f32_16x16x32_bf16 v[176:179], v[112:115], v[104:107], v[176:179]
    ds_read_b64_tr_b16 v[76:77], v14 offset:24576
    v_mfma_f32_16x16x32_bf16 v[180:183], v[116:119], v[104:107], v[180:183]
    ds_read_b64_tr_b16 v[78:79], v15 offset:24576
    v_mfma_f32_16x16x32_bf16 v[192:195], v[112:115], v[208:211], v[192:195]
    ds_read_b128 v[32:35], v26 offset:0
    v_mfma_f32_16x16x32_bf16 v[196:199], v[116:119], v[208:211], v[196:199]
    ds_read_b128 v[36:39], v27 offset:0
    v_mfma_f32_16x16x32_bf16 v[128:131], v[120:123], v[84:87], v[128:131]
    ds_read_b128 v[40:43], v26 offset:2048
    v_mfma_f32_16x16x32_bf16 v[132:135], v[124:127], v[84:87], v[132:135]
    ds_read_b128 v[44:47], v27 offset:2048
    v_mfma_f32_16x16x32_bf16 v[144:147], v[120:123], v[92:95], v[144:147]
    ds_read_b128 v[48:51], v26 offset:4096
    v_mfma_f32_16x16x32_bf16 v[148:151], v[124:127], v[92:95], v[148:151]
    ds_read_b128 v[52:55], v27 offset:4096
    v_mfma_f32_16x16x32_bf16 v[160:163], v[120:123], v[100:103], v[160:163]
    ds_read_b128 v[56:59], v26 offset:6144
    v_mfma_f32_16x16x32_bf16 v[164:167], v[124:127], v[100:103], v[164:167]
    ds_read_b128 v[60:63], v27 offset:6144
    v_mfma_f32_16x16x32_bf16 v[176:179], v[120:123], v[108:111], v[176:179]
    v_mfma_f32_16x16x32_bf16 v[180:183], v[124:127], v[108:111], v[180:183]
    v_mfma_f32_16x16x32_bf16 v[192:195], v[120:123], v[208:211], v[192:195]
    v_mfma_f32_16x16x32_bf16 v[196:199], v[124:127], v[208:211], v[196:199]
    s_waitcnt lgkmcnt(0)
    s_waitcnt vmcnt(8)
    s_barrier
    s_add_u32 m0, s21, 65536
    s_nop 0
    buffer_load_dwordx4 v23, s[88:91], s16 offen lds
    s_add_u32 s16, s16, s62
    s_add_u32 m0, s21, 66560
    s_nop 0
    buffer_load_dwordx4 v23, s[88:91], s17 offen lds
    s_add_u32 s17, s17, s62
    s_cmp_ge_u32 s16, s92
    s_cselect_b32 s94, 2048, 0
    s_sub_u32 s16, s16, s94
    s_sub_u32 s17, s17, s94
    s_add_u32 m0, s22, 65536
    s_nop 0
    buffer_load_dwordx4 v2, s[8:11], s18 offen lds
    s_add_u32 s18, s18, s20
    s_add_u32 m0, s22, 73728
    s_nop 0
    buffer_load_dwordx4 v2, s[12:15], s19 offen lds
    s_add_u32 s19, s19, s20
    s_cmp_ge_u32 s18, s95
    s_cselect_b32 s94, s93, 0
    s_sub_u32 s18, s18, s94
    s_sub_u32 s19, s19, s94
    v_mfma_f32_16x16x32_bf16 v[128:131], v[64:67], v[32:35], v[128:131]
    ds_read_b64_tr_b16 v[112:113], v12 offset:49152
    v_mfma_f32_16x16x32_bf16 v[132:135], v[68:71], v[32:35], v[132:135]
    ds_read_b64_tr_b16 v[114:115], v13 offset:49152
    v_mfma_f32_16x16x32_bf16 v[144:147], v[64:67], v[40:43], v[144:147]
    ds_read_b64_tr_b16 v[116:117], v14 offset:49152
    v_mfma_f32_16x16x32_bf16 v[148:151], v[68:71], v[40:43], v[148:151]
    ds_read_b64_tr_b16 v[118:119], v15 offset:49152
    v_mfma_f32_16x16x32_bf16 v[160:163], v[64:67], v[48:51], v[160:163]
    ds_read_b64_tr_b16 v[120:121], v12 offset:57344
    v_mfma_f32_16x16x32_bf16 v[164:167], v[68:71], v[48:51], v[164:167]
    ds_read_b64_tr_b16 v[122:123], v13 offset:57344
    v_mfma_f32_16x16x32_bf16 v[176:179], v[64:67], v[56:59], v[176:179]
    ds_read_b64_tr_b16 v[124:125], v14 offset:57344
    v_mfma_f32_16x16x32_bf16 v[180:183], v[68:71], v[56:59], v[180:183]
    ds_read_b64_tr_b16 v[126:127], v15 offset:57344
    v_mfma_f32_16x16x32_bf16 v[192:195], v[64:67], v[208:211], v[192:195]
    ds_read_b128 v[80:83], v26 offset:32768
    v_mfma_f32_16x16x32_bf16 v[196:199], v[68:71], v[208:211], v[196:199]
    ds_read_b128 v[84:87], v27 offset:32768
    v_mfma_f32_16x16x32_bf16 v[128:131], v[72:75], v[36:39], v[128:131]
    ds_read_b128 v[88:91], v26 offset:34816
    v_mfma_f32_16x16x32_bf16 v[132:135], v[76:79], v[36:39], v[132:135]
    ds_read_b128 v[92:95], v27 offset:34816
    v_mfma_f32_16x16x32_bf16 v[144:147], v[72:75], v[44:47], v[144:147]
    ds_read_b128 v[96:99], v26 offset:36864
    v_mfma_f32_16x16x32_bf16 v[148:151], v[76:79], v[44:47], v[148:151]
    ds_read_b128 v[100:103], v27 offset:36864
    v_mfma_f32_16x16x32_bf16 v[160:163], v[72:75], v[52:55], v[160:163]
    ds_read_b128 v[104:107], v26 offset:38912
    v_mfma_f32_16x16x32_bf16 v[164:167], v[76:79], v[52:55], v[164:167]
    ds_read_b128 v[108:111], v27 offset:38912
    v_mfma_f32_16x16x32_bf16 v[176:179], v[72:75], v[60:63], v[176:179]
    v_mfma_f32_16x16x32_bf16 v[180:183], v[76:79], v[60:63], v[180:183]
    v_mfma_f32_16x16x32_bf16 v[192:195], v[72:75], v[208:211], v[192:195]
    v_mfma_f32_16x16x32_bf16 v[196:199], v[76:79], v[208:211], v[196:199]
    s_waitcnt lgkmcnt(0)
    s_waitcnt vmcnt(8)
    s_barrier
    s_add_u32 m0, s21, 98304
    s_nop 0
    buffer_load_dwordx4 v23, s[88:91], s16 offen lds
    s_add_u32 s16, s16, s62
    s_add_u32 m0, s21, 99328
    s_nop 0
    buffer_load_dwordx4 v23, s[88:91], s17 offen lds
    s_add_u32 s17, s17, s62
    s_cmp_ge_u32 s16, s92
    s_cselect_b32 s94, 2048, 0
    s_sub_u32 s16, s16, s94
    s_sub_u32 s17, s17, s94
    s_add_u32 m0, s22, 98304
    s_nop 0
    buffer_load_dwordx4 v2, s[8:11], s18 offen lds
    s_add_u32 s18, s18, s20
    s_add_u32 m0, s22, 106496
    s_nop 0
    buffer_load_dwordx4 v2, s[12:15], s19 offen lds
    s_add_u32 s19, s19, s20
    s_cmp_ge_u32 s18, s95
    s_cselect_b32 s94, s93, 0
    s_sub_u32 s18, s18, s94
    s_sub_u32 s19, s19, s94
    v_mfma_f32_16x16x32_bf16 v[128:131], v[112:115], v[80:83], v[128:131]
    ds_read_b64_tr_b16 v[64:65], v8 offset:16384
    v_mfma_f32_16x16x32_bf16 v[132:135], v[116:119], v[80:83], v[132:135]
    ds_read_b64_tr_b16 v[66:67], v9 offset:16384
    v_mfma_f32_16x16x32_bf16 v[144:147], v[112:115], v[88:91], v[144:147]
    ds_read_b64_tr_b16 v[68:69], v10 offset:16384
    v_mfma_f32_16x16x32_bf16 v[148:151], v[116:119], v[88:91], v[148:151]
    ds_read_b64_tr_b16 v[70:71], v11 offset:16384
    v_mfma_f32_16x16x32_bf16 v[160:163], v[112:115], v[96:99], v[160:163]
    ds_read_b64_tr_b16 v[72:73], v8 offset:24576
    v_mfma_f32_16x16x32_bf16 v[164:167], v[116:119], v[96:99], v[164:167]
    ds_read_b64_tr_b16 v[74:75], v9 offset:24576
    v_mfma_f32_16x16x32_bf16 v[176:179], v[112:115], v[104:107], v[176:179]
    ds_read_b64_tr_b16 v[76:77], v10 offset:24576
    v_mfma_f32_16x16x32_bf16 v[180:183], v[116:119], v[104:107], v[180:183]
    ds_read_b64_tr_b16 v[78:79], v11 offset:24576
    v_mfma_f32_16x16x32_bf16 v[192:195], v[112:115], v[208:211], v[192:195]
    ds_read_b128 v[32:35], v24 offset:0
    v_mfma_f32_16x16x32_bf16 v[196:199], v[116:119], v[208:211], v[196:199]
    ds_read_b128 v[36:39], v25 offset:0
    v_mfma_f32_16x16x32_bf16 v[128:131], v[120:123], v[84:87], v[128:131]
    ds_read_b128 v[40:43], v24 offset:2048
    v_mfma_f32_16x16x32_bf16 v[132:135], v[124:127], v[84:87], v[132:135]
    ds_read_b128 v[44:47], v25 offset:2048
    v_mfma_f32_16x16x32_bf16 v[144:147], v[120:123], v[92:95], v[144:147]
    ds_read_b128 v[48:51], v24 offset:4096
    v_mfma_f32_16x16x32_bf16 v[148:151], v[124:127], v[92:95], v[148:151]
    ds_read_b128 v[52:55], v25 offset:4096
    v_mfma_f32_16x16x32_bf16 v[160:163], v[120:123], v[100:103], v[160:163]
    ds_read_b128 v[56:59], v24 offset:6144
    v_mfma_f32_16x16x32_bf16 v[164:167], v[124:127], v[100:103], v[164:167]
    ds_read_b128 v[60:63], v25 offset:6144
    v_mfma_f32_16x16x32_bf16 v[176:179], v[120:123], v[108:111], v[176:179]
    v_mfma_f32_16x16x32_bf16 v[180:183], v[124:127], v[108:111], v[180:183]
    v_mfma_f32_16x16x32_bf16 v[192:195], v[120:123], v[208:211], v[192:195]
    v_mfma_f32_16x16x32_bf16 v[196:199], v[124:127], v[208:211], v[196:199]
    s_waitcnt lgkmcnt(0)
    s_waitcnt vmcnt(8)
    s_barrier
    s_add_u32 m0, s21, 0
    s_nop 0
    buffer_load_dwordx4 v23, s[88:91], s16 offen lds
    s_add_u32 s16, s16, s62
    s_add_u32 m0, s21, 1024
    s_nop 0
    buffer_load_dwordx4 v23, s[88:91], s17 offen lds
    s_add_u32 s17, s17, s62
    s_cmp_ge_u32 s16, s92
    s_cselect_b32 s94, 2048, 0
    s_sub_u32 s16, s16, s94
    s_sub_u32 s17, s17, s94
    s_add_u32 m0, s22, 0
    s_nop 0
    buffer_load_dwordx4 v2, s[8:11], s18 offen lds
    s_add_u32 s18, s18, s20
    s_add_u32 m0, s22, 8192
    s_nop 0
    buffer_load_dwordx4 v2, s[12:15], s19 offen lds
    s_add_u32 s19, s19, s20
    s_cmp_ge_u32 s18, s95
    s_cselect_b32 s94, s93, 0
    s_sub_u32 s18, s18, s94
    s_sub_u32 s19, s19, s94
    v_mfma_f32_16x16x32_bf16 v[128:131], v[64:67], v[32:35], v[128:131]
    ds_read_b64_tr_b16 v[112:113], v8 offset:49152
    v_mfma_f32_16x16x32_bf16 v[132:135], v[68:71], v[32:35], v[132:135]
    ds_read_b64_tr_b16 v[114:115], v9 offset:49152
    v_mfma_f32_16x16x32_bf16 v[144:147], v[64:67], v[40:43], v[144:147]
    ds_read_b64_tr_b16 v[116:117], v10 offset:49152
    v_mfma_f32_16x16x32_bf16 v[148:151], v[68:71], v[40:43], v[148:151]
    ds_read_b64_tr_b16 v[118:119], v11 offset:49152
    v_mfma_f32_16x16x32_bf16 v[160:163], v[64:67], v[48:51], v[160:163]
    ds_read_b64_tr_b16 v[120:121], v8 offset:57344
    v_mfma_f32_16x16x32_bf16 v[164:167], v[68:71], v[48:51], v[164:167]
    ds_read_b64_tr_b16 v[122:123], v9 offset:57344
    v_mfma_f32_16x16x32_bf16 v[176:179], v[64:67], v[56:59], v[176:179]
    ds_read_b64_tr_b16 v[124:125], v10 offset:57344
    v_mfma_f32_16x16x32_bf16 v[180:183], v[68:71], v[56:59], v[180:183]
    ds_read_b64_tr_b16 v[126:127], v11 offset:57344
    v_mfma_f32_16x16x32_bf16 v[192:195], v[64:67], v[208:211], v[192:195]
    ds_read_b128 v[80:83], v24 offset:32768
    v_mfma_f32_16x16x32_bf16 v[196:199], v[68:71], v[208:211], v[196:199]
    ds_read_b128 v[84:87], v25 offset:32768
    v_mfma_f32_16x16x32_bf16 v[128:131], v[72:75], v[36:39], v[128:131]
    ds_read_b128 v[88:91], v24 offset:34816
    v_mfma_f32_16x16x32_bf16 v[132:135], v[76:79], v[36:39], v[132:135]
    ds_read_b128 v[92:95], v25 offset:34816
    v_mfma_f32_16x16x32_bf16 v[144:147], v[72:75], v[44:47], v[144:147]
    ds_read_b128 v[96:99], v24 offset:36864
    v_mfma_f32_16x16x32_bf16 v[148:151], v[76:79], v[44:47], v[148:151]
    ds_read_b128 v[100:103], v25 offset:36864
    v_mfma_f32_16x16x32_bf16 v[160:163], v[72:75], v[52:55], v[160:163]
    ds_read_b128 v[104:107], v24 offset:38912
    v_mfma_f32_16x16x32_bf16 v[164:167], v[76:79], v[52:55], v[164:167]
    ds_read_b128 v[108:111], v25 offset:38912
    v_mfma_f32_16x16x32_bf16 v[176:179], v[72:75], v[60:63], v[176:179]
    v_mfma_f32_16x16x32_bf16 v[180:183], v[76:79], v[60:63], v[180:183]
    v_mfma_f32_16x16x32_bf16 v[192:195], v[72:75], v[208:211], v[192:195]
    v_mfma_f32_16x16x32_bf16 v[196:199], v[76:79], v[208:211], v[196:199]
    s_waitcnt lgkmcnt(0)
    s_waitcnt vmcnt(8)
    s_barrier
    s_add_u32 m0, s21, 32768
    s_nop 0
    buffer_load_dwordx4 v23, s[88:91], s16 offen lds
    s_add_u32 s16, s16, s62
    s_add_u32 m0, s21, 33792
    s_nop 0
    buffer_load_dwordx4 v23, s[88:91], s17 offen lds
    s_add_u32 s17, s17, s62
    s_cmp_ge_u32 s16, s92
    s_cselect_b32 s94, 2048, 0
    s_sub_u32 s16, s16, s94
    s_sub_u32 s17, s17, s94
    s_add_u32 m0, s22, 32768
    s_nop 0
    buffer_load_dwordx4 v2, s[8:11], s18 offen lds
    s_add_u32 s18, s18, s20
    s_add_u32 m0, s22, 40960
    s_nop 0
    buffer_load_dwordx4 v2, s[12:15], s19 offen lds
    s_add_u32 s19, s19, s20
    s_cmp_ge_u32 s18, s95
    s_cselect_b32 s94, s93, 0
    s_sub_u32 s18, s18, s94
    s_sub_u32 s19, s19, s94
    v_mfma_f32_16x16x32_bf16 v[128:131], v[112:115], v[80:83], v[128:131]
    ds_read_b64_tr_b16 v[64:65], v12 offset:16384
    v_mfma_f32_16x16x32_bf16 v[132:135], v[116:119], v[80:83], v[132:135]
    ds_read_b64_tr_b16 v[66:67], v13 offset:16384
    v_mfma_f32_16x16x32_bf16 v[144:147], v[112:115], v[88:91], v[144:147]
    ds_read_b64_tr_b16 v[68:69], v14 offset:16384
    v_mfma_f32_16x16x32_bf16 v[148:151], v[116:119], v[88:91], v[148:151]
    ds_read_b64_tr_b16 v[70:71], v15 offset:16384
    v_mfma_f32_16x16x32_bf16 v[160:163], v[112:115], v[96:99], v[160:163]
    ds_read_b64_tr_b16 v[72:73], v12 offset:24576
    v_mfma_f32_16x16x32_bf16 v[164:167], v[116:119], v[96:99], v[164:167]
    ds_read_b64_tr_b16 v[74:75], v13 offset:24576
    v_mfma_f32_16x16x32_bf16 v[176:179], v[112:115], v[104:107], v[176:179]
    ds_read_b64_tr_b16 v[76:77], v14 offset:24576
    v_mfma_f32_16x16x32_bf16 v[180:183], v[116:119], v[104:107], v[180:183]
    ds_read_b64_tr_b16 v[78:79], v15 offset:24576
    v_mfma_f32_16x16x32_bf16 v[192:195], v[112:115], v[208:211], v[192:195]
    ds_read_b128 v[32:35], v26 offset:0
    v_mfma_f32_16x16x32_bf16 v[196:199], v[116:119], v[208:211], v[196:199]
    ds_read_b128 v[36:39], v27 offset:0
    v_mfma_f32_16x16x32_bf16 v[128:131], v[120:123], v[84:87], v[128:131]
    ds_read_b128 v[40:43], v26 offset:2048
    v_mfma_f32_16x16x32_bf16 v[132:135], v[124:127], v[84:87], v[132:135]
    ds_read_b128 v[44:47], v27 offset:2048
    v_mfma_f32_16x16x32_bf16 v[144:147], v[120:123], v[92:95], v[144:147]
    ds_read_b128 v[48:51], v26 offset:4096
    v_mfma_f32_16x16x32_bf16 v[148:151], v[124:127], v[92:95], v[148:151]
    ds_read_b128 v[52:55], v27 offset:4096
    v_mfma_f32_16x16x32_bf16 v[160:163], v[120:123], v[100:103], v[160:163]
    ds_read_b128 v[56:59], v26 offset:6144
    v_mfma_f32_16x16x32_bf16 v[164:167], v[124:127], v[100:103], v[164:167]
    ds_read_b128 v[60:63], v27 offset:6144
    v_mfma_f32_16x16x32_bf16 v[176:179], v[120:123], v[108:111], v[176:179]
    v_mfma_f32_16x16x32_bf16 v[180:183], v[124:127], v[108:111], v[180:183]
    v_mfma_f32_16x16x32_bf16 v[192:195], v[120:123], v[208:211], v[192:195]
    v_mfma_f32_16x16x32_bf16 v[196:199], v[124:127], v[208:211], v[196:199]
    s_waitcnt lgkmcnt(0)
    s_waitcnt vmcnt(8)
    s_barrier
    s_add_u32 m0, s21, 65536
    s_nop 0
    buffer_load_dwordx4 v23, s[88:91], s16 offen lds
    s_add_u32 s16, s16, s62
    s_add_u32 m0, s21, 66560
    s_nop 0
    buffer_load_dwordx4 v23, s[88:91], s17 offen lds
    s_add_u32 s17, s17, s62
    s_cmp_ge_u32 s16, s92
    s_cselect_b32 s94, 2048, 0
    s_sub_u32 s16, s16, s94
    s_sub_u32 s17, s17, s94
    s_add_u32 m0, s22, 65536
    s_nop 0
    buffer_load_dwordx4 v2, s[8:11], s18 offen lds
    s_add_u32 s18, s18, s20
    s_add_u32 m0, s22, 73728
    s_nop 0
    buffer_load_dwordx4 v2, s[12:15], s19 offen lds
    s_add_u32 s19, s19, s20
    s_cmp_ge_u32 s18, s95
    s_cselect_b32 s94, s93, 0
    s_sub_u32 s18, s18, s94
    s_sub_u32 s19, s19, s94
    v_mfma_f32_16x16x32_bf16 v[128:131], v[64:67], v[32:35], v[128:131]
    ds_read_b64_tr_b16 v[112:113], v12 offset:49152
    v_mfma_f32_16x16x32_bf16 v[132:135], v[68:71], v[32:35], v[132:135]
    ds_read_b64_tr_b16 v[114:115], v13 offset:49152
    v_mfma_f32_16x16x32_bf16 v[144:147], v[64:67], v[40:43], v[144:147]
    ds_read_b64_tr_b16 v[116:117], v14 offset:49152
    v_mfma_f32_16x16x32_bf16 v[148:151], v[68:71], v[40:43], v[148:151]
    ds_read_b64_tr_b16 v[118:119], v15 offset:49152
    v_mfma_f32_16x16x32_bf16 v[160:163], v[64:67], v[48:51], v[160:163]
    ds_read_b64_tr_b16 v[120:121], v12 offset:57344
    v_mfma_f32_16x16x32_bf16 v[164:167], v[68:71], v[48:51], v[164:167]
    ds_read_b64_tr_b16 v[122:123], v13 offset:57344
    v_mfma_f32_16x16x32_bf16 v[176:179], v[64:67], v[56:59], v[176:179]
    ds_read_b64_tr_b16 v[124:125], v14 offset:57344
    v_mfma_f32_16x16x32_bf16 v[180:183], v[68:71], v[56:59], v[180:183]
    ds_read_b64_tr_b16 v[126:127], v15 offset:57344
    v_mfma_f32_16x16x32_bf16 v[192:195], v[64:67], v[208:211], v[192:195]
    ds_read_b128 v[80:83], v26 offset:32768
    v_mfma_f32_16x16x32_bf16 v[196:199], v[68:71], v[208:211], v[196:199]
    ds_read_b128 v[84:87], v27 offset:32768
    v_mfma_f32_16x16x32_bf16 v[128:131], v[72:75], v[36:39], v[128:131]
    ds_read_b128 v[88:91], v26 offset:34816
    v_mfma_f32_16x16x32_bf16 v[132:135], v[76:79], v[36:39], v[132:135]
    ds_read_b128 v[92:95], v27 offset:34816
    v_mfma_f32_16x16x32_bf16 v[144:147], v[72:75], v[44:47], v[144:147]
    ds_read_b128 v[96:99], v26 offset:36864
    v_mfma_f32_16x16x32_bf16 v[148:151], v[76:79], v[44:47], v[148:151]
    ds_read_b128 v[100:103], v27 offset:36864
    v_mfma_f32_16x16x32_bf16 v[160:163], v[72:75], v[52:55], v[160:163]
    ds_read_b128 v[104:107], v26 offset:38912
    v_mfma_f32_16x16x32_bf16 v[164:167], v[76:79], v[52:55], v[164:167]
    ds_read_b128 v[108:111], v27 offset:38912
    v_mfma_f32_16x16x32_bf16 v[176:179], v[72:75], v[60:63], v[176:179]
    v_mfma_f32_16x16x32_bf16 v[180:183], v[76:79], v[60:63], v[180:183]
    v_mfma_f32_16x16x32_bf16 v[192:195], v[72:75], v[208:211], v[192:195]
    v_mfma_f32_16x16x32_bf16 v[196:199], v[76:79], v[208:211], v[196:199]
    s_waitcnt lgkmcnt(0)
    s_waitcnt vmcnt(8)
    s_barrier
    s_add_u32 m0, s21, 98304
    s_nop 0
    buffer_load_dwordx4 v23, s[88:91], s16 offen lds
    s_add_u32 s16, s16, s62
    s_add_u32 m0, s21, 99328
    s_nop 0
    buffer_load_dwordx4 v23, s[88:91], s17 offen lds
    s_add_u32 s17, s17, s62
    s_cmp_ge_u32 s16, s92
    s_cselect_b32 s94, 2048, 0
    s_sub_u32 s16, s16, s94
    s_sub_u32 s17, s17, s94
    s_add_u32 m0, s22, 98304
    s_nop 0
    buffer_load_dwordx4 v2, s[8:11], s18 offen lds
    s_add_u32 s18, s18, s20
    s_add_u32 m0, s22, 106496
    s_nop 0
    buffer_load_dwordx4 v2, s[12:15], s19 offen lds
    s_add_u32 s19, s19, s20
    s_cmp_ge_u32 s18, s95
    s_cselect_b32 s94, s93, 0
    s_sub_u32 s18, s18, s94
    s_sub_u32 s19, s19, s94
    v_mfma_f32_16x16x32_bf16 v[128:131], v[112:115], v[80:83], v[128:131]
    ds_read_b64_tr_b16 v[64:65], v8 offset:16384
    v_mfma_f32_16x16x32_bf16 v[132:135], v[116:119], v[80:83], v[132:135]
    ds_read_b64_tr_b16 v[66:67], v9 offset:16384
    v_mfma_f32_16x16x32_bf16 v[144:147], v[112:115], v[88:91], v[144:147]
    ds_read_b64_tr_b16 v[68:69], v10 offset:16384
    v_mfma_f32_16x16x32_bf16 v[148:151], v[116:119], v[88:91], v[148:151]
    ds_read_b64_tr_b16 v[70:71], v11 offset:16384
    v_mfma_f32_16x16x32_bf16 v[160:163], v[112:115], v[96:99], v[160:163]
    ds_read_b64_tr_b16 v[72:73], v8 offset:24576
    v_mfma_f32_16x16x32_bf16 v[164:167], v[116:119], v[96:99], v[164:167]
    ds_read_b64_tr_b16 v[74:75], v9 offset:24576
    v_mfma_f32_16x16x32_bf16 v[176:179], v[112:115], v[104:107], v[176:179]
    ds_read_b64_tr_b16 v[76:77], v10 offset:24576
    v_mfma_f32_16x16x32_bf16 v[180:183], v[116:119], v[104:107], v[180:183]
    ds_read_b64_tr_b16 v[78:79], v11 offset:24576
    v_mfma_f32_16x16x32_bf16 v[192:195], v[112:115], v[208:211], v[192:195]
    ds_read_b128 v[32:35], v24 offset:0
    v_mfma_f32_16x16x32_bf16 v[196:199], v[116:119], v[208:211], v[196:199]
    ds_read_b128 v[36:39], v25 offset:0
    v_mfma_f32_16x16x32_bf16 v[128:131], v[120:123], v[84:87], v[128:131]
    ds_read_b128 v[40:43], v24 offset:2048
    v_mfma_f32_16x16x32_bf16 v[132:135], v[124:127], v[84:87], v[132:135]
    ds_read_b128 v[44:47], v25 offset:2048
    v_mfma_f32_16x16x32_bf16 v[144:147], v[120:123], v[92:95], v[144:147]
    ds_read_b128 v[48:51], v24 offset:4096
    v_mfma_f32_16x16x32_bf16 v[148:151], v[124:127], v[92:95], v[148:151]
    ds_read_b128 v[52:55], v25 offset:4096
    v_mfma_f32_16x16x32_bf16 v[160:163], v[120:123], v[100:103], v[160:163]
    ds_read_b128 v[56:59], v24 offset:6144
    v_mfma_f32_16x16x32_bf16 v[164:167], v[124:127], v[100:103], v[164:167]
    ds_read_b128 v[60:63], v25 offset:6144
    v_mfma_f32_16x16x32_bf16 v[176:179], v[120:123], v[108:111], v[176:179]
    v_mfma_f32_16x16x32_bf16 v[180:183], v[124:127], v[108:111], v[180:183]
    v_mfma_f32_16x16x32_bf16 v[192:195], v[120:123], v[208:211], v[192:195]
    v_mfma_f32_16x16x32_bf16 v[196:199], v[124:127], v[208:211], v[196:199]
    s_waitcnt lgkmcnt(0)
    s_waitcnt vmcnt(8)
    s_barrier
    s_add_u32 m0, s21, 0
    s_nop 0
    buffer_load_dwordx4 v23, s[88:91], s16 offen lds
    s_add_u32 s16, s16, s62
    s_add_u32 m0, s21, 1024
    s_nop 0
    buffer_load_dwordx4 v23, s[88:91], s17 offen lds
    s_add_u32 s17, s17, s62
    s_cmp_ge_u32 s16, s92
    s_cselect_b32 s94, 2048, 0
    s_sub_u32 s16, s16, s94
    s_sub_u32 s17, s17, s94
    s_add_u32 m0, s22, 0
    s_nop 0
    buffer_load_dwordx4 v2, s[8:11], s18 offen lds
    s_add_u32 s18, s18, s20
    s_add_u32 m0, s22, 8192
    s_nop 0
    buffer_load_dwordx4 v2, s[12:15], s19 offen lds
    s_add_u32 s19, s19, s20
    s_cmp_ge_u32 s18, s95
    s_cselect_b32 s94, s93, 0
    s_sub_u32 s18, s18, s94
    s_sub_u32 s19, s19, s94
    v_mfma_f32_16x16x32_bf16 v[128:131], v[64:67], v[32:35], v[128:131]
    ds_read_b64_tr_b16 v[112:113], v8 offset:49152
    v_mfma_f32_16x16x32_bf16 v[132:135], v[68:71], v[32:35], v[132:135]
    ds_read_b64_tr_b16 v[114:115], v9 offset:49152
    v_mfma_f32_16x16x32_bf16 v[144:147], v[64:67], v[40:43], v[144:147]
    ds_read_b64_tr_b16 v[116:117], v10 offset:49152
    v_mfma_f32_16x16x32_bf16 v[148:151], v[68:71], v[40:43], v[148:151]
    ds_read_b64_tr_b16 v[118:119], v11 offset:49152
    v_mfma_f32_16x16x32_bf16 v[160:163], v[64:67], v[48:51], v[160:163]
    ds_read_b64_tr_b16 v[120:121], v8 offset:57344
    v_mfma_f32_16x16x32_bf16 v[164:167], v[68:71], v[48:51], v[164:167]
    ds_read_b64_tr_b16 v[122:123], v9 offset:57344
    v_mfma_f32_16x16x32_bf16 v[176:179], v[64:67], v[56:59], v[176:179]
    ds_read_b64_tr_b16 v[124:125], v10 offset:57344
    v_mfma_f32_16x16x32_bf16 v[180:183], v[68:71], v[56:59], v[180:183]
    ds_read_b64_tr_b16 v[126:127], v11 offset:57344
    v_mfma_f32_16x16x32_bf16 v[192:195], v[64:67], v[208:211], v[192:195]
    ds_read_b128 v[80:83], v24 offset:32768
    v_mfma_f32_16x16x32_bf16 v[196:199], v[68:71], v[208:211], v[196:199]
    ds_read_b128 v[84:87], v25 offset:32768
    v_mfma_f32_16x16x32_bf16 v[128:131], v[72:75], v[36:39], v[128:131]
    ds_read_b128 v[88:91], v24 offset:34816
    v_mfma_f32_16x16x32_bf16 v[132:135], v[76:79], v[36:39], v[132:135]
    ds_read_b128 v[92:95], v25 offset:34816
    v_mfma_f32_16x16x32_bf16 v[144:147], v[72:75], v[44:47], v[144:147]
    ds_read_b128 v[96:99], v24 offset:36864
    v_mfma_f32_16x16x32_bf16 v[148:151], v[76:79], v[44:47], v[148:151]
    ds_read_b128 v[100:103], v25 offset:36864
    v_mfma_f32_16x16x32_bf16 v[160:163], v[72:75], v[52:55], v[160:163]
    ds_read_b128 v[104:107], v24 offset:38912
    v_mfma_f32_16x16x32_bf16 v[164:167], v[76:79], v[52:55], v[164:167]
    ds_read_b128 v[108:111], v25 offset:38912
    v_mfma_f32_16x16x32_bf16 v[176:179], v[72:75], v[60:63], v[176:179]
    v_mfma_f32_16x16x32_bf16 v[180:183], v[76:79], v[60:63], v[180:183]
    v_mfma_f32_16x16x32_bf16 v[192:195], v[72:75], v[208:211], v[192:195]
    v_mfma_f32_16x16x32_bf16 v[196:199], v[76:79], v[208:211], v[196:199]
    s_waitcnt lgkmcnt(0)
    s_waitcnt vmcnt(8)
    s_barrier
    s_add_u32 m0, s21, 32768
    s_nop 0
    buffer_load_dwordx4 v23, s[88:91], s16 offen lds
    s_add_u32 s16, s16, s62
    s_add_u32 m0, s21, 33792
    s_nop 0
    buffer_load_dwordx4 v23, s[88:91], s17 offen lds
    s_add_u32 s17, s17, s62
    s_cmp_ge_u32 s16, s92
    s_cselect_b32 s94, 2048, 0
    s_sub_u32 s16, s16, s94
    s_sub_u32 s17, s17, s94
    s_add_u32 m0, s22, 32768
    s_nop 0
    buffer_load_dwordx4 v2, s[8:11], s18 offen lds
    s_add_u32 s18, s18, s20
    s_add_u32 m0, s22, 40960
    s_nop 0
    buffer_load_dwordx4 v2, s[12:15], s19 offen lds
    s_add_u32 s19, s19, s20
    s_cmp_ge_u32 s18, s95
    s_cselect_b32 s94, s93, 0
    s_sub_u32 s18, s18, s94
    s_sub_u32 s19, s19, s94
    v_mfma_f32_16x16x32_bf16 v[128:131], v[112:115], v[80:83], v[128:131]
    ds_read_b64_tr_b16 v[64:65], v12 offset:16384
    v_mfma_f32_16x16x32_bf16 v[132:135], v[116:119], v[80:83], v[132:135]
    ds_read_b64_tr_b16 v[66:67], v13 offset:16384
    v_mfma_f32_16x16x32_bf16 v[144:147], v[112:115], v[88:91], v[144:147]
    ds_read_b64_tr_b16 v[68:69], v14 offset:16384
    v_mfma_f32_16x16x32_bf16 v[148:151], v[116:119], v[88:91], v[148:151]
    ds_read_b64_tr_b16 v[70:71], v15 offset:16384
    v_mfma_f32_16x16x32_bf16 v[160:163], v[112:115], v[96:99], v[160:163]
    ds_read_b64_tr_b16 v[72:73], v12 offset:24576
    v_mfma_f32_16x16x32_bf16 v[164:167], v[116:119], v[96:99], v[164:167]
    ds_read_b64_tr_b16 v[74:75], v13 offset:24576
    v_mfma_f32_16x16x32_bf16 v[176:179], v[112:115], v[104:107], v[176:179]
    ds_read_b64_tr_b16 v[76:77], v14 offset:24576
    v_mfma_f32_16x16x32_bf16 v[180:183], v[116:119], v[104:107], v[180:183]
    ds_read_b64_tr_b16 v[78:79], v15 offset:24576
    v_mfma_f32_16x16x32_bf16 v[192:195], v[112:115], v[208:211], v[192:195]
    ds_read_b128 v[32:35], v26 offset:0
    v_mfma_f32_16x16x32_bf16 v[196:199], v[116:119], v[208:211], v[196:199]
    ds_read_b128 v[36:39], v27 offset:0
    v_mfma_f32_16x16x32_bf16 v[128:131], v[120:123], v[84:87], v[128:131]
    ds_read_b128 v[40:43], v26 offset:2048
    v_mfma_f32_16x16x32_bf16 v[132:135], v[124:127], v[84:87], v[132:135]
    ds_read_b128 v[44:47], v27 offset:2048
    v_mfma_f32_16x16x32_bf16 v[144:147], v[120:123], v[92:95], v[144:147]
    ds_read_b128 v[48:51], v26 offset:4096
    v_mfma_f32_16x16x32_bf16 v[148:151], v[124:127], v[92:95], v[148:151]
    ds_read_b128 v[52:55], v27 offset:4096
    v_mfma_f32_16x16x32_bf16 v[160:163], v[120:123], v[100:103], v[160:163]
    ds_read_b128 v[56:59], v26 offset:6144
    v_mfma_f32_16x16x32_bf16 v[164:167], v[124:127], v[100:103], v[164:167]
    ds_read_b128 v[60:63], v27 offset:6144
    v_mfma_f32_16x16x32_bf16 v[176:179], v[120:123], v[108:111], v[176:179]
    v_mfma_f32_16x16x32_bf16 v[180:183], v[124:127], v[108:111], v[180:183]
    v_mfma_f32_16x16x32_bf16 v[192:195], v[120:123], v[208:211], v[192:195]
    v_mfma_f32_16x16x32_bf16 v[196:199], v[124:127], v[208:211], v[196:199]
    s_waitcnt lgkmcnt(0)
    s_waitcnt vmcnt(8)
    s_barrier
    s_add_u32 m0, s21, 65536
    s_nop 0
    buffer_load_dwordx4 v23, s[88:91], s16 offen lds
    s_add_u32 s16, s16, s62
    s_add_u32 m0, s21, 66560
    s_nop 0
    buffer_load_dwordx4 v23, s[88:91], s17 offen lds
    s_add_u32 s17, s17, s62
    s_cmp_ge_u32 s16, s92
    s_cselect_b32 s94, 2048, 0
    s_sub_u32 s16, s16, s94
    s_sub_u32 s17, s17, s94
    s_add_u32 m0, s22, 65536
    s_nop 0
    buffer_load_dwordx4 v2, s[8:11], s18 offen lds
    s_add_u32 s18, s18, s20
    s_add_u32 m0, s22, 73728
    s_nop 0
    buffer_load_dwordx4 v2, s[12:15], s19 offen lds
    s_add_u32 s19, s19, s20
    s_cmp_ge_u32 s18, s95
    s_cselect_b32 s94, s93, 0
    s_sub_u32 s18, s18, s94
    s_sub_u32 s19, s19, s94
    v_mfma_f32_16x16x32_bf16 v[128:131], v[64:67], v[32:35], v[128:131]
    ds_read_b64_tr_b16 v[112:113], v12 offset:49152
    v_mfma_f32_16x16x32_bf16 v[132:135], v[68:71], v[32:35], v[132:135]
    ds_read_b64_tr_b16 v[114:115], v13 offset:49152
    v_mfma_f32_16x16x32_bf16 v[144:147], v[64:67], v[40:43], v[144:147]
    ds_read_b64_tr_b16 v[116:117], v14 offset:49152
    v_mfma_f32_16x16x32_bf16 v[148:151], v[68:71], v[40:43], v[148:151]
    ds_read_b64_tr_b16 v[118:119], v15 offset:49152
    v_mfma_f32_16x16x32_bf16 v[160:163], v[64:67], v[48:51], v[160:163]
    ds_read_b64_tr_b16 v[120:121], v12 offset:57344
    v_mfma_f32_16x16x32_bf16 v[164:167], v[68:71], v[48:51], v[164:167]
    ds_read_b64_tr_b16 v[122:123], v13 offset:57344
    v_mfma_f32_16x16x32_bf16 v[176:179], v[64:67], v[56:59], v[176:179]
    ds_read_b64_tr_b16 v[124:125], v14 offset:57344
    v_mfma_f32_16x16x32_bf16 v[180:183], v[68:71], v[56:59], v[180:183]
    ds_read_b64_tr_b16 v[126:127], v15 offset:57344
    v_mfma_f32_16x16x32_bf16 v[192:195], v[64:67], v[208:211], v[192:195]
    ds_read_b128 v[80:83], v26 offset:32768
    v_mfma_f32_16x16x32_bf16 v[196:199], v[68:71], v[208:211], v[196:199]
    ds_read_b128 v[84:87], v27 offset:32768
    v_mfma_f32_16x16x32_bf16 v[128:131], v[72:75], v[36:39], v[128:131]
    ds_read_b128 v[88:91], v26 offset:34816
    v_mfma_f32_16x16x32_bf16 v[132:135], v[76:79], v[36:39], v[132:135]
    ds_read_b128 v[92:95], v27 offset:34816
    v_mfma_f32_16x16x32_bf16 v[144:147], v[72:75], v[44:47], v[144:147]
    ds_read_b128 v[96:99], v26 offset:36864
    v_mfma_f32_16x16x32_bf16 v[148:151], v[76:79], v[44:47], v[148:151]
    ds_read_b128 v[100:103], v27 offset:36864
    v_mfma_f32_16x16x32_bf16 v[160:163], v[72:75], v[52:55], v[160:163]
    ds_read_b128 v[104:107], v26 offset:38912
    v_mfma_f32_16x16x32_bf16 v[164:167], v[76:79], v[52:55], v[164:167]
    ds_read_b128 v[108:111], v27 offset:38912
    v_mfma_f32_16x16x32_bf16 v[176:179], v[72:75], v[60:63], v[176:179]
    v_mfma_f32_16x16x32_bf16 v[180:183], v[76:79], v[60:63], v[180:183]
    v_mfma_f32_16x16x32_bf16 v[192:195], v[72:75], v[208:211], v[192:195]
    v_mfma_f32_16x16x32_bf16 v[196:199], v[76:79], v[208:211], v[196:199]
    s_waitcnt lgkmcnt(0)
    s_waitcnt vmcnt(8)
    s_barrier
    s_add_u32 m0, s21, 98304
    s_nop 0
    buffer_load_dwordx4 v23, s[88:91], s16 offen lds
    s_add_u32 s16, s16, s62
    s_add_u32 m0, s21, 99328
    s_nop 0
    buffer_load_dwordx4 v23, s[88:91], s17 offen lds
    s_add_u32 s17, s17, s62
    s_cmp_ge_u32 s16, s92
    s_cselect_b32 s94, 2048, 0
    s_sub_u32 s16, s16, s94
    s_sub_u32 s17, s17, s94
    s_add_u32 m0, s22, 98304
    s_nop 0
    buffer_load_dwordx4 v2, s[8:11], s18 offen lds
    s_add_u32 s18, s18, s20
    s_add_u32 m0, s22, 106496
    s_nop 0
    buffer_load_dwordx4 v2, s[12:15], s19 offen lds
    s_add_u32 s19, s19, s20
    s_cmp_ge_u32 s18, s95
    s_cselect_b32 s94, s93, 0
    s_sub_u32 s18, s18, s94
    s_sub_u32 s19, s19, s94
    v_mfma_f32_16x16x32_bf16 v[128:131], v[112:115], v[80:83], v[128:131]
    ds_read_b64_tr_b16 v[64:65], v8 offset:16384
    v_mfma_f32_16x16x32_bf16 v[132:135], v[116:119], v[80:83], v[132:135]
    ds_read_b64_tr_b16 v[66:67], v9 offset:16384
    v_mfma_f32_16x16x32_bf16 v[144:147], v[112:115], v[88:91], v[144:147]
    ds_read_b64_tr_b16 v[68:69], v10 offset:16384
    v_mfma_f32_16x16x32_bf16 v[148:151], v[116:119], v[88:91], v[148:151]
    ds_read_b64_tr_b16 v[70:71], v11 offset:16384
    v_mfma_f32_16x16x32_bf16 v[160:163], v[112:115], v[96:99], v[160:163]
    ds_read_b64_tr_b16 v[72:73], v8 offset:24576
    v_mfma_f32_16x16x32_bf16 v[164:167], v[116:119], v[96:99], v[164:167]
    ds_read_b64_tr_b16 v[74:75], v9 offset:24576
    v_mfma_f32_16x16x32_bf16 v[176:179], v[112:115], v[104:107], v[176:179]
    ds_read_b64_tr_b16 v[76:77], v10 offset:24576
    v_mfma_f32_16x16x32_bf16 v[180:183], v[116:119], v[104:107], v[180:183]
    ds_read_b64_tr_b16 v[78:79], v11 offset:24576
    v_mfma_f32_16x16x32_bf16 v[192:195], v[112:115], v[208:211], v[192:195]
    ds_read_b128 v[32:35], v24 offset:0
    v_mfma_f32_16x16x32_bf16 v[196:199], v[116:119], v[208:211], v[196:199]
    ds_read_b128 v[36:39], v25 offset:0
    v_mfma_f32_16x16x32_bf16 v[128:131], v[120:123], v[84:87], v[128:131]
    ds_read_b128 v[40:43], v24 offset:2048
    v_mfma_f32_16x16x32_bf16 v[132:135], v[124:127], v[84:87], v[132:135]
    ds_read_b128 v[44:47], v25 offset:2048
    v_mfma_f32_16x16x32_bf16 v[144:147], v[120:123], v[92:95], v[144:147]
    ds_read_b128 v[48:51], v24 offset:4096
    v_mfma_f32_16x16x32_bf16 v[148:151], v[124:127], v[92:95], v[148:151]
    ds_read_b128 v[52:55], v25 offset:4096
    v_mfma_f32_16x16x32_bf16 v[160:163], v[120:123], v[100:103], v[160:163]
    ds_read_b128 v[56:59], v24 offset:6144
    v_mfma_f32_16x16x32_bf16 v[164:167], v[124:127], v[100:103], v[164:167]
    ds_read_b128 v[60:63], v25 offset:6144
    v_mfma_f32_16x16x32_bf16 v[176:179], v[120:123], v[108:111], v[176:179]
    v_mfma_f32_16x16x32_bf16 v[180:183], v[124:127], v[108:111], v[180:183]
    v_mfma_f32_16x16x32_bf16 v[192:195], v[120:123], v[208:211], v[192:195]
    v_mfma_f32_16x16x32_bf16 v[196:199], v[124:127], v[208:211], v[196:199]
    s_waitcnt lgkmcnt(0)
    s_waitcnt vmcnt(8)
    s_barrier
    v_mfma_f32_16x16x32_bf16 v[128:131], v[64:67], v[32:35], v[128:131]
    ds_read_b64_tr_b16 v[112:113], v8 offset:49152
    v_mfma_f32_16x16x32_bf16 v[132:135], v[68:71], v[32:35], v[132:135]
    ds_read_b64_tr_b16 v[114:115], v9 offset:49152
    v_mfma_f32_16x16x32_bf16 v[144:147], v[64:67], v[40:43], v[144:147]
    ds_read_b64_tr_b16 v[116:117], v10 offset:49152
    v_mfma_f32_16x16x32_bf16 v[148:151], v[68:71], v[40:43], v[148:151]
    ds_read_b64_tr_b16 v[118:119], v11 offset:49152
    v_mfma_f32_16x16x32_bf16 v[160:163], v[64:67], v[48:51], v[160:163]
    ds_read_b64_tr_b16 v[120:121], v8 offset:57344
    v_mfma_f32_16x16x32_bf16 v[164:167], v[68:71], v[48:51], v[164:167]
    ds_read_b64_tr_b16 v[122:123], v9 offset:57344
    v_mfma_f32_16x16x32_bf16 v[176:179], v[64:67], v[56:59], v[176:179]
    ds_read_b64_tr_b16 v[124:125], v10 offset:57344
    v_mfma_f32_16x16x32_bf16 v[180:183], v[68:71], v[56:59], v[180:183]
    ds_read_b64_tr_b16 v[126:127], v11 offset:57344
    v_mfma_f32_16x16x32_bf16 v[192:195], v[64:67], v[208:211], v[192:195]
    ds_read_b128 v[80:83], v24 offset:32768
    v_mfma_f32_16x16x32_bf16 v[196:199], v[68:71], v[208:211], v[196:199]
    ds_read_b128 v[84:87], v25 offset:32768
    v_mfma_f32_16x16x32_bf16 v[128:131], v[72:75], v[36:39], v[128:131]
    ds_read_b128 v[88:91], v24 offset:34816
    v_mfma_f32_16x16x32_bf16 v[132:135], v[76:79], v[36:39], v[132:135]
    ds_read_b128 v[92:95], v25 offset:34816
    v_mfma_f32_16x16x32_bf16 v[144:147], v[72:75], v[44:47], v[144:147]
    ds_read_b128 v[96:99], v24 offset:36864
    v_mfma_f32_16x16x32_bf16 v[148:151], v[76:79], v[44:47], v[148:151]
    ds_read_b128 v[100:103], v25 offset:36864
    v_mfma_f32_16x16x32_bf16 v[160:163], v[72:75], v[52:55], v[160:163]
    ds_read_b128 v[104:107], v24 offset:38912
    v_mfma_f32_16x16x32_bf16 v[164:167], v[76:79], v[52:55], v[164:167]
    ds_read_b128 v[108:111], v25 offset:38912
    v_mfma_f32_16x16x32_bf16 v[176:179], v[72:75], v[60:63], v[176:179]
    v_mfma_f32_16x16x32_bf16 v[180:183], v[76:79], v[60:63], v[180:183]
    v_mfma_f32_16x16x32_bf16 v[192:195], v[72:75], v[208:211], v[192:195]
    v_mfma_f32_16x16x32_bf16 v[196:199], v[76:79], v[208:211], v[196:199]
    s_waitcnt lgkmcnt(0)
    s_waitcnt vmcnt(4)
    s_barrier
    v_mfma_f32_16x16x32_bf16 v[128:131], v[112:115], v[80:83], v[128:131]
    ds_read_b64_tr_b16 v[64:65], v12 offset:16384
    v_mfma_f32_16x16x32_bf16 v[132:135], v[116:119], v[80:83], v[132:135]
    ds_read_b64_tr_b16 v[66:67], v13 offset:16384
    v_mfma_f32_16x16x32_bf16 v[144:147], v[112:115], v[88:91], v[144:147]
    ds_read_b64_tr_b16 v[68:69], v14 offset:16384
    v_mfma_f32_16x16x32_bf16 v[148:151], v[116:119], v[88:91], v[148:151]
    ds_read_b64_tr_b16 v[70:71], v15 offset:16384
    v_mfma_f32_16x16x32_bf16 v[160:163], v[112:115], v[96:99], v[160:163]
    ds_read_b64_tr_b16 v[72:73], v12 offset:24576
    v_mfma_f32_16x16x32_bf16 v[164:167], v[116:119], v[96:99], v[164:167]
    ds_read_b64_tr_b16 v[74:75], v13 offset:24576
    v_mfma_f32_16x16x32_bf16 v[176:179], v[112:115], v[104:107], v[176:179]
    ds_read_b64_tr_b16 v[76:77], v14 offset:24576
    v_mfma_f32_16x16x32_bf16 v[180:183], v[116:119], v[104:107], v[180:183]
    ds_read_b64_tr_b16 v[78:79], v15 offset:24576
    v_mfma_f32_16x16x32_bf16 v[192:195], v[112:115], v[208:211], v[192:195]
    ds_read_b128 v[32:35], v26 offset:0
    v_mfma_f32_16x16x32_bf16 v[196:199], v[116:119], v[208:211], v[196:199]
    ds_read_b128 v[36:39], v27 offset:0
    v_mfma_f32_16x16x32_bf16 v[128:131], v[120:123], v[84:87], v[128:131]
    ds_read_b128 v[40:43], v26 offset:2048
    v_mfma_f32_16x16x32_bf16 v[132:135], v[124:127], v[84:87], v[132:135]
    ds_read_b128 v[44:47], v27 offset:2048
    v_mfma_f32_16x16x32_bf16 v[144:147], v[120:123], v[92:95], v[144:147]
    ds_read_b128 v[48:51], v26 offset:4096
    v_mfma_f32_16x16x32_bf16 v[148:151], v[124:127], v[92:95], v[148:151]
    ds_read_b128 v[52:55], v27 offset:4096
    v_mfma_f32_16x16x32_bf16 v[160:163], v[120:123], v[100:103], v[160:163]
    ds_read_b128 v[56:59], v26 offset:6144
    v_mfma_f32_16x16x32_bf16 v[164:167], v[124:127], v[100:103], v[164:167]
    ds_read_b128 v[60:63], v27 offset:6144
    v_mfma_f32_16x16x32_bf16 v[176:179], v[120:123], v[108:111], v[176:179]
    v_mfma_f32_16x16x32_bf16 v[180:183], v[124:127], v[108:111], v[180:183]
    v_mfma_f32_16x16x32_bf16 v[192:195], v[120:123], v[208:211], v[192:195]
    v_mfma_f32_16x16x32_bf16 v[196:199], v[124:127], v[208:211], v[196:199]
    s_waitcnt lgkmcnt(0)
    s_waitcnt vmcnt(0)
    s_barrier
    v_mfma_f32_16x16x32_bf16 v[128:131], v[64:67], v[32:35], v[128:131]
    ds_read_b64_tr_b16 v[112:113], v12 offset:49152
    v_mfma_f32_16x16x32_bf16 v[132:135], v[68:71], v[32:35], v[132:135]
    ds_read_b64_tr_b16 v[114:115], v13 offset:49152
    v_mfma_f32_16x16x32_bf16 v[144:147], v[64:67], v[40:43], v[144:147]
    ds_read_b64_tr_b16 v[116:117], v14 offset:49152
    v_mfma_f32_16x16x32_bf16 v[148:151], v[68:71], v[40:43], v[148:151]
    ds_read_b64_tr_b16 v[118:119], v15 offset:49152
    v_mfma_f32_16x16x32_bf16 v[160:163], v[64:67], v[48:51], v[160:163]
    ds_read_b64_tr_b16 v[120:121], v12 offset:57344
    v_mfma_f32_16x16x32_bf16 v[164:167], v[68:71], v[48:51], v[164:167]
    ds_read_b64_tr_b16 v[122:123], v13 offset:57344
    v_mfma_f32_16x16x32_bf16 v[176:179], v[64:67], v[56:59], v[176:179]
    ds_read_b64_tr_b16 v[124:125], v14 offset:57344
    v_mfma_f32_16x16x32_bf16 v[180:183], v[68:71], v[56:59], v[180:183]
    ds_read_b64_tr_b16 v[126:127], v15 offset:57344
    v_mfma_f32_16x16x32_bf16 v[192:195], v[64:67], v[208:211], v[192:195]
    ds_read_b128 v[80:83], v26 offset:32768
    v_mfma_f32_16x16x32_bf16 v[196:199], v[68:71], v[208:211], v[196:199]
    ds_read_b128 v[84:87], v27 offset:32768
    v_mfma_f32_16x16x32_bf16 v[128:131], v[72:75], v[36:39], v[128:131]
    ds_read_b128 v[88:91], v26 offset:34816
    v_mfma_f32_16x16x32_bf16 v[132:135], v[76:79], v[36:39], v[132:135]
    ds_read_b128 v[92:95], v27 offset:34816
    v_mfma_f32_16x16x32_bf16 v[144:147], v[72:75], v[44:47], v[144:147]
    ds_read_b128 v[96:99], v26 offset:36864
    v_mfma_f32_16x16x32_bf16 v[148:151], v[76:79], v[44:47], v[148:151]
    ds_read_b128 v[100:103], v27 offset:36864
    v_mfma_f32_16x16x32_bf16 v[160:163], v[72:75], v[52:55], v[160:163]
    ds_read_b128 v[104:107], v26 offset:38912
    v_mfma_f32_16x16x32_bf16 v[164:167], v[76:79], v[52:55], v[164:167]
    ds_read_b128 v[108:111], v27 offset:38912
    v_mfma_f32_16x16x32_bf16 v[176:179], v[72:75], v[60:63], v[176:179]
    v_mfma_f32_16x16x32_bf16 v[180:183], v[76:79], v[60:63], v[180:183]
    v_mfma_f32_16x16x32_bf16 v[192:195], v[72:75], v[208:211], v[192:195]
    v_mfma_f32_16x16x32_bf16 v[196:199], v[76:79], v[208:211], v[196:199]
    s_waitcnt lgkmcnt(0)
    s_waitcnt vmcnt(0)
    s_barrier
    v_mfma_f32_16x16x32_bf16 v[128:131], v[112:115], v[80:83], v[128:131]
    ds_read_b64_tr_b16 v[64:65], v8 offset:16384
    v_mfma_f32_16x16x32_bf16 v[132:135], v[116:119], v[80:83], v[132:135]
    ds_read_b64_tr_b16 v[66:67], v9 offset:16384
    v_mfma_f32_16x16x32_bf16 v[144:147], v[112:115], v[88:91], v[144:147]
    ds_read_b64_tr_b16 v[68:69], v10 offset:16384
    v_mfma_f32_16x16x32_bf16 v[148:151], v[116:119], v[88:91], v[148:151]
    ds_read_b64_tr_b16 v[70:71], v11 offset:16384
    v_mfma_f32_16x16x32_bf16 v[160:163], v[112:115], v[96:99], v[160:163]
    ds_read_b64_tr_b16 v[72:73], v8 offset:24576
    v_mfma_f32_16x16x32_bf16 v[164:167], v[116:119], v[96:99], v[164:167]
    ds_read_b64_tr_b16 v[74:75], v9 offset:24576
    v_mfma_f32_16x16x32_bf16 v[176:179], v[112:115], v[104:107], v[176:179]
    ds_read_b64_tr_b16 v[76:77], v10 offset:24576
    v_mfma_f32_16x16x32_bf16 v[180:183], v[116:119], v[104:107], v[180:183]
    ds_read_b64_tr_b16 v[78:79], v11 offset:24576
    v_mfma_f32_16x16x32_bf16 v[192:195], v[112:115], v[208:211], v[192:195]
    ds_read_b128 v[32:35], v24 offset:0
    v_mfma_f32_16x16x32_bf16 v[196:199], v[116:119], v[208:211], v[196:199]
    ds_read_b128 v[36:39], v25 offset:0
    v_mfma_f32_16x16x32_bf16 v[128:131], v[120:123], v[84:87], v[128:131]
    ds_read_b128 v[40:43], v24 offset:2048
    v_mfma_f32_16x16x32_bf16 v[132:135], v[124:127], v[84:87], v[132:135]
    ds_read_b128 v[44:47], v25 offset:2048
    v_mfma_f32_16x16x32_bf16 v[144:147], v[120:123], v[92:95], v[144:147]
    ds_read_b128 v[48:51], v24 offset:4096
    v_mfma_f32_16x16x32_bf16 v[148:151], v[124:127], v[92:95], v[148:151]
    ds_read_b128 v[52:55], v25 offset:4096
    v_mfma_f32_16x16x32_bf16 v[160:163], v[120:123], v[100:103], v[160:163]
    ds_read_b128 v[56:59], v24 offset:6144
    v_mfma_f32_16x16x32_bf16 v[164:167], v[124:127], v[100:103], v[164:167]
    ds_read_b128 v[60:63], v25 offset:6144
    v_mfma_f32_16x16x32_bf16 v[176:179], v[120:123], v[108:111], v[176:179]
    v_mfma_f32_16x16x32_bf16 v[180:183], v[124:127], v[108:111], v[180:183]
    v_mfma_f32_16x16x32_bf16 v[192:195], v[120:123], v[208:211], v[192:195]
    v_mfma_f32_16x16x32_bf16 v[196:199], v[124:127], v[208:211], v[196:199]
    s_waitcnt lgkmcnt(0)
    v_and_b32 v20, 0xf0, v1
    v_lshrrev_b32 v20, 1, v20
    s_lshl_b32 s30, s26, 9
    s_add_u32 s30, s30, 188743680
    s_mov_b32 s31, 0x40000
    v_and_b32 v21, 1, v4
    v_lshlrev_b32 v21, 10, v21
    v_xor_b32 v8, v21, v8
    v_xor_b32 v9, v21, v9
    v_xor_b32 v10, v21, v10
    v_xor_b32 v11, v21, v11
    v_xor_b32 v12, v21, v12
    v_xor_b32 v13, v21, v13
    v_xor_b32 v14, v21, v14
    v_xor_b32 v15, v21, v15
w_stX:
    buffer_load_dword v22, off, s[64:67], 0 offset:192 sc1
    buffer_load_dwordx2 v[24:25], v20, s[4:7], s30 offen offset:0 sc1
    buffer_load_dwordx2 v[26:27], v20, s[4:7], s30 offen offset:128 sc1
    buffer_load_dwordx2 v[28:29], v20, s[4:7], s30 offen offset:256 sc1
    buffer_load_dwordx2 v[30:31], v20, s[4:7], s30 offen offset:384 sc1
    s_waitcnt vmcnt(0)
    v_readfirstlane_b32 s29, v22
    s_cmp_ge_u32 s29, 32
    s_cbranch_scc1 w_stXok
    s_sleep 4
    s_sub_u32 s31, s31, 1
    s_cbranch_scc0 w_stX
w_stXok:
    buffer_load_dword v22, off, s[64:67], 0 sc1
    v_fma_f32 v128, -v24, v192, v128
    v_fma_f32 v129, -v24, v193, v129
    v_fma_f32 v130, -v24, v194, v130
    v_fma_f32 v131, -v24, v195, v131
    v_fma_f32 v132, -v24, v196, v132
    v_fma_f32 v133, -v24, v197, v133
    v_fma_f32 v134, -v24, v198, v134
    v_fma_f32 v135, -v24, v199, v135
    v_mul_f32 v128, v128, v25
    v_mul_f32 v129, v129, v25
    v_mul_f32 v130, v130, v25
    v_mul_f32 v131, v131, v25
    v_mul_f32 v132, v132, v25
    v_mul_f32 v133, v133, v25
    v_mul_f32 v134, v134, v25
    v_mul_f32 v135, v135, v25
    v_fma_f32 v144, -v26, v192, v144
    v_fma_f32 v145, -v26, v193, v145
    v_fma_f32 v146, -v26, v194, v146
    v_fma_f32 v147, -v26, v195, v147
    v_fma_f32 v148, -v26, v196, v148
    v_fma_f32 v149, -v26, v197, v149
    v_fma_f32 v150, -v26, v198, v150
    v_fma_f32 v151, -v26, v199, v151
    v_mul_f32 v144, v144, v27
    v_mul_f32 v145, v145, v27
    v_mul_f32 v146, v146, v27
    v_mul_f32 v147, v147, v27
    v_mul_f32 v148, v148, v27
    v_mul_f32 v149, v149, v27
    v_mul_f32 v150, v150, v27
    v_mul_f32 v151, v151, v27
    v_fma_f32 v160, -v28, v192, v160
    v_fma_f32 v161, -v28, v193, v161
    v_fma_f32 v162, -v28, v194, v162
    v_fma_f32 v163, -v28, v195, v163
    v_fma_f32 v164, -v28, v196, v164
    v_fma_f32 v165, -v28, v197, v165
    v_fma_f32 v166, -v28, v198, v166
    v_fma_f32 v167, -v28, v199, v167
    v_mul_f32 v160, v160, v29
    v_mul_f32 v161, v161, v29
    v_mul_f32 v162, v162, v29
    v_mul_f32 v163, v163, v29
    v_mul_f32 v164, v164, v29
    v_mul_f32 v165, v165, v29
    v_mul_f32 v166, v166, v29
    v_mul_f32 v167, v167, v29
    v_fma_f32 v176, -v30, v192, v176
    v_fma_f32 v177, -v30, v193, v177
    v_fma_f32 v178, -v30, v194, v178
    v_fma_f32 v179, -v30, v195, v179
    v_fma_f32 v180, -v30, v196, v180
    v_fma_f32 v181, -v30, v197, v181
    v_fma_f32 v182, -v30, v198, v182
    v_fma_f32 v183, -v30, v199, v183
    v_mul_f32 v176, v176, v31
    v_mul_f32 v177, v177, v31
    v_mul_f32 v178, v178, v31
    v_mul_f32 v179, v179, v31
    v_mul_f32 v180, v180, v31
    v_mul_f32 v181, v181, v31
    v_mul_f32 v182, v182, v31
    v_mul_f32 v183, v183, v31
    s_lshl_b32 s30, s27, 10
    s_add_u32 s30, s30, s49
    s_nop 7
    v_cvt_pk_bf16_f32 v80, v128, v129
    v_cvt_pk_bf16_f32 v81, v130, v131
    v_cvt_pk_bf16_f32 v82, v132, v133
    v_cvt_pk_bf16_f32 v83, v134, v135
    buffer_store_dwordx4 v[80:83], v1, s[4:7], s30 offen sc1
    s_add_u32 s30, s30, s50
    v_cvt_pk_bf16_f32 v84, v144, v145
    v_cvt_pk_bf16_f32 v85, v146, v147
    v_cvt_pk_bf16_f32 v86, v148, v149
    v_cvt_pk_bf16_f32 v87, v150, v151
    buffer_store_dwordx4 v[84:87], v1, s[4:7], s30 offen sc1
    s_add_u32 s30, s30, s50
    v_cvt_pk_bf16_f32 v88, v160, v161
    v_cvt_pk_bf16_f32 v89, v162, v163
    v_cvt_pk_bf16_f32 v90, v164, v165
    v_cvt_pk_bf16_f32 v91, v166, v167
    buffer_store_dwordx4 v[88:91], v1, s[4:7], s30 offen sc1
    s_add_u32 s30, s30, s50
    v_cvt_pk_bf16_f32 v92, v176, v177
    v_cvt_pk_bf16_f32 v93, v178, v179
    v_cvt_pk_bf16_f32 v94, v180, v181
    v_cvt_pk_bf16_f32 v95, v182, v183
    buffer_store_dwordx4 v[92:95], v1, s[4:7], s30 offen sc1
    s_add_u32 s30, s30, s50
    s_mov_b32 s28, s51
    s_mov_b32 s57, s53
    s_branch w_drain
w_firstM:
    s_waitcnt vmcnt(6)
    s_barrier
    s_add_u32 m0, s21, 0
    s_nop 0
    buffer_load_dwordx4 v1, s[4:7], s16 offen sc1 lds
    s_add_u32 s16, s16, s62
    s_add_u32 m0, s22, 0
    s_nop 0
    buffer_load_dwordx4 v2, s[8:11], s18 offen lds
    s_add_u32 s18, s18, s20
    s_add_u32 m0, s22, 8192
    s_nop 0
    buffer_load_dwordx4 v2, s[12:15], s19 offen lds
    s_add_u32 s19, s19, s20
    v_mfma_f32_16x16x32_bf16 v[128:131], v[64:67], v[32:35], 0
    ds_read_b64_tr_b16 v[112:113], v8 offset:49152
    v_mfma_f32_16x16x32_bf16 v[132:135], v[68:71], v[32:35], 0
    ds_read_b64_tr_b16 v[114:115], v9 offset:49152
    v_mfma_f32_16x16x32_bf16 v[136:139], v[72:75], v[32:35], 0
    ds_read_b64_tr_b16 v[116:117], v10 offset:49152
    v_mfma_f32_16x16x32_bf16 v[140:143], v[76:79], v[32:35], 0
    ds_read_b64_tr_b16 v[118:119], v11 offset:49152
    v_mfma_f32_16x16x32_bf16 v[144:147], v[64:67], v[40:43], 0
    ds_read_b64_tr_b16 v[120:121], v8 offset:57344
    v_mfma_f32_16x16x32_bf16 v[148:151], v[68:71], v[40:43], 0
    ds_read_b64_tr_b16 v[122:123], v9 offset:57344
    v_mfma_f32_16x16x32_bf16 v[152:155], v[72:75], v[40:43], 0
    ds_read_b64_tr_b16 v[124:125], v10 offset:57344
    v_mfma_f32_16x16x32_bf16 v[156:159], v[76:79], v[40:43], 0
    ds_read_b64_tr_b16 v[126:127], v11 offset:57344
    v_mfma_f32_16x16x32_bf16 v[160:163], v[64:67], v[48:51], 0
    ds_read_b128 v[80:83], v5 offset:32768
    v_mfma_f32_16x16x32_bf16 v[164:167], v[68:71], v[48:51], 0
    ds_read_b128 v[88:91], v5 offset:34816
    v_mfma_f32_16x16x32_bf16 v[168:171], v[72:75], v[48:51], 0
    ds_read_b128 v[96:99], v5 offset:36864
    v_mfma_f32_16x16x32_bf16 v[172:175], v[76:79], v[48:51], 0
    ds_read_b128 v[104:107], v5 offset:38912
    v_mfma_f32_16x16x32_bf16 v[176:179], v[64:67], v[56:59], 0
    v_mfma_f32_16x16x32_bf16 v[180:183], v[68:71], v[56:59], 0
    v_mfma_f32_16x16x32_bf16 v[184:187], v[72:75], v[56:59], 0
    v_mfma_f32_16x16x32_bf16 v[188:191], v[76:79], v[56:59], 0
    s_waitcnt lgkmcnt(0)
    s_waitcnt vmcnt(6)
    s_barrier
    s_add_u32 m0, s21, 32768
    s_nop 0
    buffer_load_dwordx4 v1, s[4:7], s16 offen sc1 lds
    s_add_u32 s16, s16, s62
    s_add_u32 m0, s22, 32768
    s_nop 0
    buffer_load_dwordx4 v2, s[8:11], s18 offen lds
    s_add_u32 s18, s18, s20
    s_add_u32 m0, s22, 40960
    s_nop 0
    buffer_load_dwordx4 v2, s[12:15], s19 offen lds
    s_add_u32 s19, s19, s20
    v_mfma_f32_16x16x32_bf16 v[128:131], v[112:115], v[80:83], v[128:131]
    ds_read_b64_tr_b16 v[64:65], v12 offset:16384
    v_mfma_f32_16x16x32_bf16 v[132:135], v[116:119], v[80:83], v[132:135]
    ds_read_b64_tr_b16 v[66:67], v13 offset:16384
    v_mfma_f32_16x16x32_bf16 v[136:139], v[120:123], v[80:83], v[136:139]
    ds_read_b64_tr_b16 v[68:69], v14 offset:16384
    v_mfma_f32_16x16x32_bf16 v[140:143], v[124:127], v[80:83], v[140:143]
    ds_read_b64_tr_b16 v[70:71], v15 offset:16384
    v_mfma_f32_16x16x32_bf16 v[144:147], v[112:115], v[88:91], v[144:147]
    ds_read_b64_tr_b16 v[72:73], v12 offset:24576
    v_mfma_f32_16x16x32_bf16 v[148:151], v[116:119], v[88:91], v[148:151]
    ds_read_b64_tr_b16 v[74:75], v13 offset:24576
    v_mfma_f32_16x16x32_bf16 v[152:155], v[120:123], v[88:91], v[152:155]
    ds_read_b64_tr_b16 v[76:77], v14 offset:24576
    v_mfma_f32_16x16x32_bf16 v[156:159], v[124:127], v[88:91], v[156:159]
    ds_read_b64_tr_b16 v[78:79], v15 offset:24576
    v_mfma_f32_16x16x32_bf16 v[160:163], v[112:115], v[96:99], v[160:163]
    ds_read_b128 v[32:35], v6 offset:0
    v_mfma_f32_16x16x32_bf16 v[164:167], v[116:119], v[96:99], v[164:167]
    ds_read_b128 v[40:43], v6 offset:2048
    v_mfma_f32_16x16x32_bf16 v[168:171], v[120:123], v[96:99], v[168:171]
    ds_read_b128 v[48:51], v6 offset:4096
    v_mfma_f32_16x16x32_bf16 v[172:175], v[124:127], v[96:99], v[172:175]
    ds_read_b128 v[56:59], v6 offset:6144
    v_mfma_f32_16x16x32_bf16 v[176:179], v[112:115], v[104:107], v[176:179]
    v_mfma_f32_16x16x32_bf16 v[180:183], v[116:119], v[104:107], v[180:183]
    v_mfma_f32_16x16x32_bf16 v[184:187], v[120:123], v[104:107], v[184:187]
    v_mfma_f32_16x16x32_bf16 v[188:191], v[124:127], v[104:107], v[188:191]
    s_waitcnt lgkmcnt(0)
    s_waitcnt vmcnt(6)
    s_barrier
    s_add_u32 m0, s21, 65536
    s_nop 0
    buffer_load_dwordx4 v1, s[4:7], s16 offen sc1 lds
    s_add_u32 s16, s16, s62
    s_add_u32 m0, s22, 65536
    s_nop 0
    buffer_load_dwordx4 v2, s[8:11], s18 offen lds
    s_add_u32 s18, s18, s20
    s_add_u32 m0, s22, 73728
    s_nop 0
    buffer_load_dwordx4 v2, s[12:15], s19 offen lds
    s_add_u32 s19, s19, s20
    v_mfma_f32_16x16x32_bf16 v[128:131], v[64:67], v[32:35], v[128:131]
    ds_read_b64_tr_b16 v[112:113], v12 offset:49152
    v_mfma_f32_16x16x32_bf16 v[132:135], v[68:71], v[32:35], v[132:135]
    ds_read_b64_tr_b16 v[114:115], v13 offset:49152
    v_mfma_f32_16x16x32_bf16 v[136:139], v[72:75], v[32:35], v[136:139]
    ds_read_b64_tr_b16 v[116:117], v14 offset:49152
    v_mfma_f32_16x16x32_bf16 v[140:143], v[76:79], v[32:35], v[140:143]
    ds_read_b64_tr_b16 v[118:119], v15 offset:49152
    v_mfma_f32_16x16x32_bf16 v[144:147], v[64:67], v[40:43], v[144:147]
    ds_read_b64_tr_b16 v[120:121], v12 offset:57344
    v_mfma_f32_16x16x32_bf16 v[148:151], v[68:71], v[40:43], v[148:151]
    ds_read_b64_tr_b16 v[122:123], v13 offset:57344
    v_mfma_f32_16x16x32_bf16 v[152:155], v[72:75], v[40:43], v[152:155]
    ds_read_b64_tr_b16 v[124:125], v14 offset:57344
    v_mfma_f32_16x16x32_bf16 v[156:159], v[76:79], v[40:43], v[156:159]
    ds_read_b64_tr_b16 v[126:127], v15 offset:57344
    v_mfma_f32_16x16x32_bf16 v[160:163], v[64:67], v[48:51], v[160:163]
    ds_read_b128 v[80:83], v6 offset:32768
    v_mfma_f32_16x16x32_bf16 v[164:167], v[68:71], v[48:51], v[164:167]
    ds_read_b128 v[88:91], v6 offset:34816
    v_mfma_f32_16x16x32_bf16 v[168:171], v[72:75], v[48:51], v[168:171]
    ds_read_b128 v[96:99], v6 offset:36864
    v_mfma_f32_16x16x32_bf16 v[172:175], v[76:79], v[48:51], v[172:175]
    ds_read_b128 v[104:107], v6 offset:38912
    v_mfma_f32_16x16x32_bf16 v[176:179], v[64:67], v[56:59], v[176:179]
    v_mfma_f32_16x16x32_bf16 v[180:183], v[68:71], v[56:59], v[180:183]
    v_mfma_f32_16x16x32_bf16 v[184:187], v[72:75], v[56:59], v[184:187]
    v_mfma_f32_16x16x32_bf16 v[188:191], v[76:79], v[56:59], v[188:191]
    s_waitcnt lgkmcnt(0)
    s_waitcnt vmcnt(6)
    s_barrier
    s_add_u32 m0, s21, 98304
    s_nop 0
    buffer_load_dwordx4 v1, s[4:7], s16 offen sc1 lds
    s_add_u32 s16, s16, s62
    s_add_u32 m0, s22, 98304
    s_nop 0
    buffer_load_dwordx4 v2, s[8:11], s18 offen lds
    s_add_u32 s18, s18, s20
    s_add_u32 m0, s22, 106496
    s_nop 0
    buffer_load_dwordx4 v2, s[12:15], s19 offen lds
    s_add_u32 s19, s19, s20
    v_mfma_f32_16x16x32_bf16 v[128:131], v[112:115], v[80:83], v[128:131]
    ds_read_b64_tr_b16 v[64:65], v8 offset:16384
    v_mfma_f32_16x16x32_bf16 v[132:135], v[116:119], v[80:83], v[132:135]
    ds_read_b64_tr_b16 v[66:67], v9 offset:16384
    v_mfma_f32_16x16x32_bf16 v[136:139], v[120:123], v[80:83], v[136:139]
    ds_read_b64_tr_b16 v[68:69], v10 offset:16384
    v_mfma_f32_16x16x32_bf16 v[140:143], v[124:127], v[80:83], v[140:143]
    ds_read_b64_tr_b16 v[70:71], v11 offset:16384
    v_mfma_f32_16x16x32_bf16 v[144:147], v[112:115], v[88:91], v[144:147]
    ds_read_b64_tr_b16 v[72:73], v8 offset:24576
    v_mfma_f32_16x16x32_bf16 v[148:151], v[116:119], v[88:91], v[148:151]
    ds_read_b64_tr_b16 v[74:75], v9 offset:24576
    v_mfma_f32_16x16x32_bf16 v[152:155], v[120:123], v[88:91], v[152:155]
    ds_read_b64_tr_b16 v[76:77], v10 offset:24576
    v_mfma_f32_16x16x32_bf16 v[156:159], v[124:127], v[88:91], v[156:159]
    ds_read_b64_tr_b16 v[78:79], v11 offset:24576
    v_mfma_f32_16x16x32_bf16 v[160:163], v[112:115], v[96:99], v[160:163]
    ds_read_b128 v[32:35], v5 offset:0
    v_mfma_f32_16x16x32_bf16 v[164:167], v[116:119], v[96:99], v[164:167]
    ds_read_b128 v[40:43], v5 offset:2048
    v_mfma_f32_16x16x32_bf16 v[168:171], v[120:123], v[96:99], v[168:171]
    ds_read_b128 v[48:51], v5 offset:4096
    v_mfma_f32_16x16x32_bf16 v[172:175], v[124:127], v[96:99], v[172:175]
    ds_read_b128 v[56:59], v5 offset:6144
    v_mfma_f32_16x16x32_bf16 v[176:179], v[112:115], v[104:107], v[176:179]
    v_mfma_f32_16x16x32_bf16 v[180:183], v[116:119], v[104:107], v[180:183]
    v_mfma_f32_16x16x32_bf16 v[184:187], v[120:123], v[104:107], v[184:187]
    v_mfma_f32_16x16x32_bf16 v[188:191], v[124:127], v[104:107], v[188:191]
    s_waitcnt lgkmcnt(0)
w_loop_chkM:
    s_sub_u32 s23, s23, 1
w_loopM:
    s_cmp_lg_u32 s23, 1
    s_cbranch_scc1 w_bodyM
    v_readfirstlane_b32 s68, v22
    s_cmp_ge_u32 s68, 128
    s_cselect_b32 s70, 0, s70
    v_readfirstlane_b32 s30, v16
    s_cmp_ge_u32 s30, s45
    s_cselect_b32 s30, 0, 1
    s_or_b32 s30, s30, s70
    s_cmp_ge_u32 s32, 4
    s_cselect_b32 s30, 1, s30
    s_cmp_eq_u32 s32, 0
    s_cselect_b32 s30, 1, s30
    v_mov_b32 v20, s30
    ds_write_b32 v7, v20
    s_cbranch_scc1 w_bodyM
    s_load_dwordx2 s[8:9], s[0:1], s33
    s_load_dwordx2 s[12:13], s[0:1], s34
    s_mov_b32 s10, s38
    s_mov_b32 s14, s38
    s_cmp_ge_u32 s32, 4
    s_cselect_b32 s31, 0, 1
    s_lshl_b32 s30, s3, s31
    s_mul_i32 s30, s30, s40
    s_add_u32 s16, s39, s30
    s_cmp_eq_u32 s32, 4
    s_cselect_b32 s30, 1024, s40
    s_cselect_b32 s31, 6, 5
    s_lshl_b32 s62, 32, s31
    s_add_u32 s17, s16, s30
    s_lshl_b32 s30, s3, 2
    s_mul_i32 s30, s30, s35
    s_add_u32 s18, s36, s30
    s_add_u32 s19, s37, s30
    s_lshl_b32 s20, s35, s31
    v_mul_u32_u24 v2, s35, v4
    v_add_u32 v2, v2, v3
    s_waitcnt lgkmcnt(0)
    s_waitcnt vmcnt(6)
    s_barrier
    s_add_u32 m0, s21, 0
    s_nop 0
    buffer_load_dwordx4 v1, s[4:7], s16 offen sc1 lds
    s_add_u32 s16, s16, s62
    s_add_u32 m0, s21, 1024
    s_nop 0
    buffer_load_dwordx4 v1, s[4:7], s17 offen sc1 lds
    s_add_u32 s17, s17, s62
    s_add_u32 m0, s22, 0
    s_nop 0
    buffer_load_dwordx4 v2, s[8:11], s18 offen lds
    s_add_u32 s18, s18, s20
    s_add_u32 m0, s22, 8192
    s_nop 0
    buffer_load_dwordx4 v2, s[12:15], s19 offen lds
    s_add_u32 s19, s19, s20
    v_mfma_f32_16x16x32_bf16 v[128:131], v[64:67], v[32:35], v[128:131]
    ds_read_b64_tr_b16 v[112:113], v8 offset:49152
    v_mfma_f32_16x16x32_bf16 v[132:135], v[68:71], v[32:35], v[132:135]
    ds_read_b64_tr_b16 v[114:115], v9 offset:49152
    v_mfma_f32_16x16x32_bf16 v[136:139], v[72:75], v[32:35], v[136:139]
    ds_read_b64_tr_b16 v[116:117], v10 offset:49152
    v_mfma_f32_16x16x32_bf16 v[140:143], v[76:79], v[32:35], v[140:143]
    ds_read_b64_tr_b16 v[118:119], v11 offset:49152
    v_mfma_f32_16x16x32_bf16 v[144:147], v[64:67], v[40:43], v[144:147]
    ds_read_b64_tr_b16 v[120:121], v8 offset:57344
    v_mfma_f32_16x16x32_bf16 v[148:151], v[68:71], v[40:43], v[148:151]
    ds_read_b64_tr_b16 v[122:123], v9 offset:57344
    v_mfma_f32_16x16x32_bf16 v[152:155], v[72:75], v[40:43], v[152:155]
    ds_read_b64_tr_b16 v[124:125], v10 offset:57344
    v_mfma_f32_16x16x32_bf16 v[156:159], v[76:79], v[40:43], v[156:159]
    ds_read_b64_tr_b16 v[126:127], v11 offset:57344
    v_mfma_f32_16x16x32_bf16 v[160:163], v[64:67], v[48:51], v[160:163]
    ds_read_b128 v[80:83], v5 offset:32768
    v_mfma_f32_16x16x32_bf16 v[164:167], v[68:71], v[48:51], v[164:167]
    ds_read_b128 v[88:91], v5 offset:34816
    v_mfma_f32_16x16x32_bf16 v[168:171], v[72:75], v[48:51], v[168:171]
    ds_read_b128 v[96:99], v5 offset:36864
    v_mfma_f32_16x16x32_bf16 v[172:175], v[76:79], v[48:51], v[172:175]
    ds_read_b128 v[104:107], v5 offset:38912
    v_mfma_f32_16x16x32_bf16 v[176:179], v[64:67], v[56:59], v[176:179]
    v_mfma_f32_16x16x32_bf16 v[180:183], v[68:71], v[56:59], v[180:183]
    v_mfma_f32_16x16x32_bf16 v[184:187], v[72:75], v[56:59], v[184:187]
    v_mfma_f32_16x16x32_bf16 v[188:191], v[76:79], v[56:59], v[188:191]
    s_waitcnt lgkmcnt(0)
    s_waitcnt vmcnt(7)
    s_barrier
    s_add_u32 m0, s21, 32768
    s_nop 0
    buffer_load_dwordx4 v1, s[4:7], s16 offen sc1 lds
    s_add_u32 s16, s16, s62
    s_add_u32 m0, s21, 33792
    s_nop 0
    buffer_load_dwordx4 v1, s[4:7], s17 offen sc1 lds
    s_add_u32 s17, s17, s62
    s_add_u32 m0, s22, 32768
    s_nop 0
    buffer_load_dwordx4 v2, s[8:11], s18 offen lds
    s_add_u32 s18, s18, s20
    s_add_u32 m0, s22, 40960
    s_nop 0
    buffer_load_dwordx4 v2, s[12:15], s19 offen lds
    s_add_u32 s19, s19, s20
    v_mfma_f32_16x16x32_bf16 v[128:131], v[112:115], v[80:83], v[128:131]
    ds_read_b64_tr_b16 v[64:65], v12 offset:16384
    v_mfma_f32_16x16x32_bf16 v[132:135], v[116:119], v[80:83], v[132:135]
    ds_read_b64_tr_b16 v[66:67], v13 offset:16384
    v_mfma_f32_16x16x32_bf16 v[136:139], v[120:123], v[80:83], v[136:139]
    ds_read_b64_tr_b16 v[68:69], v14 offset:16384
    v_mfma_f32_16x16x32_bf16 v[140:143], v[124:127], v[80:83], v[140:143]
    ds_read_b64_tr_b16 v[70:71], v15 offset:16384
    v_mfma_f32_16x16x32_bf16 v[144:147], v[112:115], v[88:91], v[144:147]
    ds_read_b64_tr_b16 v[72:73], v12 offset:24576
    v_mfma_f32_16x16x32_bf16 v[148:151], v[116:119], v[88:91], v[148:151]
    ds_read_b64_tr_b16 v[74:75], v13 offset:24576
    v_mfma_f32_16x16x32_bf16 v[152:155], v[120:123], v[88:91], v[152:155]
    ds_read_b64_tr_b16 v[76:77], v14 offset:24576
    v_mfma_f32_16x16x32_bf16 v[156:159], v[124:127], v[88:91], v[156:159]
    ds_read_b64_tr_b16 v[78:79], v15 offset:24576
    v_mfma_f32_16x16x32_bf16 v[160:163], v[112:115], v[96:99], v[160:163]
    ds_read_b128 v[32:35], v6 offset:0
    v_mfma_f32_16x16x32_bf16 v[164:167], v[116:119], v[96:99], v[164:167]
    ds_read_b128 v[40:43], v6 offset:2048
    v_mfma_f32_16x16x32_bf16 v[168:171], v[120:123], v[96:99], v[168:171]
    ds_read_b128 v[48:51], v6 offset:4096
    v_mfma_f32_16x16x32_bf16 v[172:175], v[124:127], v[96:99], v[172:175]
    ds_read_b128 v[56:59], v6 offset:6144
    v_mfma_f32_16x16x32_bf16 v[176:179], v[112:115], v[104:107], v[176:179]
    v_mfma_f32_16x16x32_bf16 v[180:183], v[116:119], v[104:107], v[180:183]
    v_mfma_f32_16x16x32_bf16 v[184:187], v[120:123], v[104:107], v[184:187]
    v_mfma_f32_16x16x32_bf16 v[188:191], v[124:127], v[104:107], v[188:191]
    s_waitcnt lgkmcnt(0)
    s_waitcnt vmcnt(8)
    s_barrier
    s_add_u32 m0, s21, 65536
    s_nop 0
    buffer_load_dwordx4 v1, s[4:7], s16 offen sc1 lds
    s_add_u32 s16, s16, s62
    s_add_u32 m0, s21, 66560
    s_nop 0
    buffer_load_dwordx4 v1, s[4:7], s17 offen sc1 lds
    s_add_u32 s17, s17, s62
    s_add_u32 m0, s22, 65536
    s_nop 0
    buffer_load_dwordx4 v2, s[8:11], s18 offen lds
    s_add_u32 s18, s18, s20
    s_add_u32 m0, s22, 73728
    s_nop 0
    buffer_load_dwordx4 v2, s[12:15], s19 offen lds
    s_add_u32 s19, s19, s20
    v_mfma_f32_16x16x32_bf16 v[128:131], v[64:67], v[32:35], v[128:131]
    ds_read_b64_tr_b16 v[112:113], v12 offset:49152
    v_mfma_f32_16x16x32_bf16 v[132:135], v[68:71], v[32:35], v[132:135]
    ds_read_b64_tr_b16 v[114:115], v13 offset:49152
    v_mfma_f32_16x16x32_bf16 v[136:139], v[72:75], v[32:35], v[136:139]
    ds_read_b64_tr_b16 v[116:117], v14 offset:49152
    v_mfma_f32_16x16x32_bf16 v[140:143], v[76:79], v[32:35], v[140:143]
    ds_read_b64_tr_b16 v[118:119], v15 offset:49152
    v_mfma_f32_16x16x32_bf16 v[144:147], v[64:67], v[40:43], v[144:147]
    ds_read_b64_tr_b16 v[120:121], v12 offset:57344
    v_mfma_f32_16x16x32_bf16 v[148:151], v[68:71], v[40:43], v[148:151]
    ds_read_b64_tr_b16 v[122:123], v13 offset:57344
    v_mfma_f32_16x16x32_bf16 v[152:155], v[72:75], v[40:43], v[152:155]
    ds_read_b64_tr_b16 v[124:125], v14 offset:57344
    v_mfma_f32_16x16x32_bf16 v[156:159], v[76:79], v[40:43], v[156:159]
    ds_read_b64_tr_b16 v[126:127], v15 offset:57344
    v_mfma_f32_16x16x32_bf16 v[160:163], v[64:67], v[48:51], v[160:163]
    ds_read_b128 v[80:83], v6 offset:32768
    v_mfma_f32_16x16x32_bf16 v[164:167], v[68:71], v[48:51], v[164:167]
    ds_read_b128 v[88:91], v6 offset:34816
    v_mfma_f32_16x16x32_bf16 v[168:171], v[72:75], v[48:51], v[168:171]
    ds_read_b128 v[96:99], v6 offset:36864
    v_mfma_f32_16x16x32_bf16 v[172:175], v[76:79], v[48:51], v[172:175]
    ds_read_b128 v[104:107], v6 offset:38912
    v_mfma_f32_16x16x32_bf16 v[176:179], v[64:67], v[56:59], v[176:179]
    v_mfma_f32_16x16x32_bf16 v[180:183], v[68:71], v[56:59], v[180:183]
    v_mfma_f32_16x16x32_bf16 v[184:187], v[72:75], v[56:59], v[184:187]
    v_mfma_f32_16x16x32_bf16 v[188:191], v[76:79], v[56:59], v[188:191]
    s_waitcnt lgkmcnt(0)
    s_waitcnt vmcnt(8)
    s_barrier
    s_add_u32 m0, s21, 98304
    s_nop 0
    buffer_load_dwordx4 v1, s[4:7], s16 offen sc1 lds
    s_add_u32 s16, s16, s62
    s_add_u32 m0, s21, 99328
    s_nop 0
    buffer_load_dwordx4 v1, s[4:7], s17 offen sc1 lds
    s_add_u32 s17, s17, s62
    s_add_u32 m0, s22, 98304
    s_nop 0
    buffer_load_dwordx4 v2, s[8:11], s18 offen lds
    s_add_u32 s18, s18, s20
    s_add_u32 m0, s22, 106496
    s_nop 0
    buffer_load_dwordx4 v2, s[12:15], s19 offen lds
    s_add_u32 s19, s19, s20
    v_mfma_f32_16x16x32_bf16 v[128:131], v[112:115], v[80:83], v[128:131]
    ds_read_b64_tr_b16 v[64:65], v8 offset:16384
    v_mfma_f32_16x16x32_bf16 v[132:135], v[116:119], v[80:83], v[132:135]
    ds_read_b64_tr_b16 v[66:67], v9 offset:16384
    v_mfma_f32_16x16x32_bf16 v[136:139], v[120:123], v[80:83], v[136:139]
    ds_read_b64_tr_b16 v[68:69], v10 offset:16384
    v_mfma_f32_16x16x32_bf16 v[140:143], v[124:127], v[80:83], v[140:143]
    ds_read_b64_tr_b16 v[70:71], v11 offset:16384
    v_mfma_f32_16x16x32_bf16 v[144:147], v[112:115], v[88:91], v[144:147]
    ds_read_b64_tr_b16 v[72:73], v8 offset:24576
    v_mfma_f32_16x16x32_bf16 v[148:151], v[116:119], v[88:91], v[148:151]
    ds_read_b64_tr_b16 v[74:75], v9 offset:24576
    v_mfma_f32_16x16x32_bf16 v[152:155], v[120:123], v[88:91], v[152:155]
    ds_read_b64_tr_b16 v[76:77], v10 offset:24576
    v_mfma_f32_16x16x32_bf16 v[156:159], v[124:127], v[88:91], v[156:159]
    ds_read_b64_tr_b16 v[78:79], v11 offset:24576
    v_mfma_f32_16x16x32_bf16 v[160:163], v[112:115], v[96:99], v[160:163]
    ds_read_b128 v[32:35], v5 offset:0
    v_mfma_f32_16x16x32_bf16 v[164:167], v[116:119], v[96:99], v[164:167]
    ds_read_b128 v[36:39], v5 offset:1024
    v_mfma_f32_16x16x32_bf16 v[168:171], v[120:123], v[96:99], v[168:171]
    ds_read_b128 v[40:43], v5 offset:2048
    v_mfma_f32_16x16x32_bf16 v[172:175], v[124:127], v[96:99], v[172:175]
    ds_read_b128 v[44:47], v5 offset:3072
    v_mfma_f32_16x16x32_bf16 v[176:179], v[112:115], v[104:107], v[176:179]
    ds_read_b128 v[48:51], v5 offset:4096
    v_mfma_f32_16x16x32_bf16 v[180:183], v[116:119], v[104:107], v[180:183]
    ds_read_b128 v[52:55], v5 offset:5120
    v_mfma_f32_16x16x32_bf16 v[184:187], v[120:123], v[104:107], v[184:187]
    ds_read_b128 v[56:59], v5 offset:6144
    v_mfma_f32_16x16x32_bf16 v[188:191], v[124:127], v[104:107], v[188:191]
    ds_read_b128 v[60:63], v5 offset:7168
    s_waitcnt lgkmcnt(0)
    s_branch w_doneM
w_bodyM:
    buffer_load_dword v22, off, s[64:67], 0 sc1
    s_waitcnt vmcnt(6)
    s_barrier
    s_add_u32 m0, s21, 0
    s_nop 0
    buffer_load_dwordx4 v1, s[4:7], s16 offen sc1 lds
    s_add_u32 s16, s16, s62
    s_add_u32 m0, s22, 0
    s_nop 0
    buffer_load_dwordx4 v2, s[8:11], s18 offen lds
    s_add_u32 s18, s18, s20
    s_add_u32 m0, s22, 8192
    s_nop 0
    buffer_load_dwordx4 v2, s[12:15], s19 offen lds
    s_add_u32 s19, s19, s20
    v_mfma_f32_16x16x32_bf16 v[128:131], v[64:67], v[32:35], v[128:131]
    ds_read_b64_tr_b16 v[112:113], v8 offset:49152
    v_mfma_f32_16x16x32_bf16 v[132:135], v[68:71], v[32:35], v[132:135]
    ds_read_b64_tr_b16 v[114:115], v9 offset:49152
    v_mfma_f32_16x16x32_bf16 v[136:139], v[72:75], v[32:35], v[136:139]
    ds_read_b64_tr_b16 v[116:117], v10 offset:49152
    v_mfma_f32_16x16x32_bf16 v[140:143], v[76:79], v[32:35], v[140:143]
    ds_read_b64_tr_b16 v[118:119], v11 offset:49152
    v_mfma_f32_16x16x32_bf16 v[144:147], v[64:67], v[40:43], v[144:147]
    ds_read_b64_tr_b16 v[120:121], v8 offset:57344
    v_mfma_f32_16x16x32_bf16 v[148:151], v[68:71], v[40:43], v[148:151]
    ds_read_b64_tr_b16 v[122:123], v9 offset:57344
    v_mfma_f32_16x16x32_bf16 v[152:155], v[72:75], v[40:43], v[152:155]
    ds_read_b64_tr_b16 v[124:125], v10 offset:57344
    v_mfma_f32_16x16x32_bf16 v[156:159], v[76:79], v[40:43], v[156:159]
    ds_read_b64_tr_b16 v[126:127], v11 offset:57344
    v_mfma_f32_16x16x32_bf16 v[160:163], v[64:67], v[48:51], v[160:163]
    ds_read_b128 v[80:83], v5 offset:32768
    v_mfma_f32_16x16x32_bf16 v[164:167], v[68:71], v[48:51], v[164:167]
    ds_read_b128 v[88:91], v5 offset:34816
    v_mfma_f32_16x16x32_bf16 v[168:171], v[72:75], v[48:51], v[168:171]
    ds_read_b128 v[96:99], v5 offset:36864
    v_mfma_f32_16x16x32_bf16 v[172:175], v[76:79], v[48:51], v[172:175]
    ds_read_b128 v[104:107], v5 offset:38912
    v_mfma_f32_16x16x32_bf16 v[176:179], v[64:67], v[56:59], v[176:179]
    v_mfma_f32_16x16x32_bf16 v[180:183], v[68:71], v[56:59], v[180:183]
    v_mfma_f32_16x16x32_bf16 v[184:187], v[72:75], v[56:59], v[184:187]
    v_mfma_f32_16x16x32_bf16 v[188:191], v[76:79], v[56:59], v[188:191]
    buffer_load_dword v16, v17, s[4:7], s44 offen sc1
    s_waitcnt lgkmcnt(0)
    s_waitcnt vmcnt(6)
    s_barrier
    s_add_u32 m0, s21, 32768
    s_nop 0
    buffer_load_dwordx4 v1, s[4:7], s16 offen sc1 lds
    s_add_u32 s16, s16, s62
    s_add_u32 m0, s22, 32768
    s_nop 0
    buffer_load_dwordx4 v2, s[8:11], s18 offen lds
    s_add_u32 s18, s18, s20
    s_add_u32 m0, s22, 40960
    s_nop 0
    buffer_load_dwordx4 v2, s[12:15], s19 offen lds
    s_add_u32 s19, s19, s20
    v_mfma_f32_16x16x32_bf16 v[128:131], v[112:115], v[80:83], v[128:131]
    ds_read_b64_tr_b16 v[64:65], v12 offset:16384
    v_mfma_f32_16x16x32_bf16 v[132:135], v[116:119], v[80:83], v[132:135]
    ds_read_b64_tr_b16 v[66:67], v13 offset:16384
    v_mfma_f32_16x16x32_bf16 v[136:139], v[120:123], v[80:83], v[136:139]
    ds_read_b64_tr_b16 v[68:69], v14 offset:16384
    v_mfma_f32_16x16x32_bf16 v[140:143], v[124:127], v[80:83], v[140:143]
    ds_read_b64_tr_b16 v[70:71], v15 offset:16384
    v_mfma_f32_16x16x32_bf16 v[144:147], v[112:115], v[88:91], v[144:147]
    ds_read_b64_tr_b16 v[72:73], v12 offset:24576
    v_mfma_f32_16x16x32_bf16 v[148:151], v[116:119], v[88:91], v[148:151]
    ds_read_b64_tr_b16 v[74:75], v13 offset:24576
    v_mfma_f32_16x16x32_bf16 v[152:155], v[120:123], v[88:91], v[152:155]
    ds_read_b64_tr_b16 v[76:77], v14 offset:24576
    v_mfma_f32_16x16x32_bf16 v[156:159], v[124:127], v[88:91], v[156:159]
    ds_read_b64_tr_b16 v[78:79], v15 offset:24576
    v_mfma_f32_16x16x32_bf16 v[160:163], v[112:115], v[96:99], v[160:163]
    ds_read_b128 v[32:35], v6 offset:0
    v_mfma_f32_16x16x32_bf16 v[164:167], v[116:119], v[96:99], v[164:167]
    ds_read_b128 v[40:43], v6 offset:2048
    v_mfma_f32_16x16x32_bf16 v[168:171], v[120:123], v[96:99], v[168:171]
    ds_read_b128 v[48:51], v6 offset:4096
    v_mfma_f32_16x16x32_bf16 v[172:175], v[124:127], v[96:99], v[172:175]
    ds_read_b128 v[56:59], v6 offset:6144
    v_mfma_f32_16x16x32_bf16 v[176:179], v[112:115], v[104:107], v[176:179]
    v_mfma_f32_16x16x32_bf16 v[180:183], v[116:119], v[104:107], v[180:183]
    v_mfma_f32_16x16x32_bf16 v[184:187], v[120:123], v[104:107], v[184:187]
    v_mfma_f32_16x16x32_bf16 v[188:191], v[124:127], v[104:107], v[188:191]
    s_waitcnt lgkmcnt(0)
    s_waitcnt vmcnt(6)
    s_barrier
    s_add_u32 m0, s21, 65536
    s_nop 0
    buffer_load_dwordx4 v1, s[4:7], s16 offen sc1 lds
    s_add_u32 s16, s16, s62
    s_add_u32 m0, s22, 65536
    s_nop 0
    buffer_load_dwordx4 v2, s[8:11], s18 offen lds
    s_add_u32 s18, s18, s20
    s_add_u32 m0, s22, 73728
    s_nop 0
    buffer_load_dwordx4 v2, s[12:15], s19 offen lds
    s_add_u32 s19, s19, s20
    v_mfma_f32_16x16x32_bf16 v[128:131], v[64:67], v[32:35], v[128:131]
    ds_read_b64_tr_b16 v[112:113], v12 offset:49152
    v_mfma_f32_16x16x32_bf16 v[132:135], v[68:71], v[32:35], v[132:135]
    ds_read_b64_tr_b16 v[114:115], v13 offset:49152
    v_mfma_f32_16x16x32_bf16 v[136:139], v[72:75], v[32:35], v[136:139]
    ds_read_b64_tr_b16 v[116:117], v14 offset:49152
    v_mfma_f32_16x16x32_bf16 v[140:143], v[76:79], v[32:35], v[140:143]
    ds_read_b64_tr_b16 v[118:119], v15 offset:49152
    v_mfma_f32_16x16x32_bf16 v[144:147], v[64:67], v[40:43], v[144:147]
    ds_read_b64_tr_b16 v[120:121], v12 offset:57344
    v_mfma_f32_16x16x32_bf16 v[148:151], v[68:71], v[40:43], v[148:151]
    ds_read_b64_tr_b16 v[122:123], v13 offset:57344
    v_mfma_f32_16x16x32_bf16 v[152:155], v[72:75], v[40:43], v[152:155]
    ds_read_b64_tr_b16 v[124:125], v14 offset:57344
    v_mfma_f32_16x16x32_bf16 v[156:159], v[76:79], v[40:43], v[156:159]
    ds_read_b64_tr_b16 v[126:127], v15 offset:57344
    v_mfma_f32_16x16x32_bf16 v[160:163], v[64:67], v[48:51], v[160:163]
    ds_read_b128 v[80:83], v6 offset:32768
    v_mfma_f32_16x16x32_bf16 v[164:167], v[68:71], v[48:51], v[164:167]
    ds_read_b128 v[88:91], v6 offset:34816
    v_mfma_f32_16x16x32_bf16 v[168:171], v[72:75], v[48:51], v[168:171]
    ds_read_b128 v[96:99], v6 offset:36864
    v_mfma_f32_16x16x32_bf16 v[172:175], v[76:79], v[48:51], v[172:175]
    ds_read_b128 v[104:107], v6 offset:38912
    v_mfma_f32_16x16x32_bf16 v[176:179], v[64:67], v[56:59], v[176:179]
    v_mfma_f32_16x16x32_bf16 v[180:183], v[68:71], v[56:59], v[180:183]
    v_mfma_f32_16x16x32_bf16 v[184:187], v[72:75], v[56:59], v[184:187]
    v_mfma_f32_16x16x32_bf16 v[188:191], v[76:79], v[56:59], v[188:191]
    s_waitcnt lgkmcnt(0)
    s_waitcnt vmcnt(6)
    s_barrier
    s_add_u32 m0, s21, 98304
    s_nop 0
    buffer_load_dwordx4 v1, s[4:7], s16 offen sc1 lds
    s_add_u32 s16, s16, s62
    s_add_u32 m0, s22, 98304
    s_nop 0
    buffer_load_dwordx4 v2, s[8:11], s18 offen lds
    s_add_u32 s18, s18, s20
    s_add_u32 m0, s22, 106496
    s_nop 0
    buffer_load_dwordx4 v2, s[12:15], s19 offen lds
    s_add_u32 s19, s19, s20
    v_mfma_f32_16x16x32_bf16 v[128:131], v[112:115], v[80:83], v[128:131]
    ds_read_b64_tr_b16 v[64:65], v8 offset:16384
    v_mfma_f32_16x16x32_bf16 v[132:135], v[116:119], v[80:83], v[132:135]
    ds_read_b64_tr_b16 v[66:67], v9 offset:16384
    v_mfma_f32_16x16x32_bf16 v[136:139], v[120:123], v[80:83], v[136:139]
    ds_read_b64_tr_b16 v[68:69], v10 offset:16384
    v_mfma_f32_16x16x32_bf16 v[140:143], v[124:127], v[80:83], v[140:143]
    ds_read_b64_tr_b16 v[70:71], v11 offset:16384
    v_mfma_f32_16x16x32_bf16 v[144:147], v[112:115], v[88:91], v[144:147]
    ds_read_b64_tr_b16 v[72:73], v8 offset:24576
    v_mfma_f32_16x16x32_bf16 v[148:151], v[116:119], v[88:91], v[148:151]
    ds_read_b64_tr_b16 v[74:75], v9 offset:24576
    v_mfma_f32_16x16x32_bf16 v[152:155], v[120:123], v[88:91], v[152:155]
    ds_read_b64_tr_b16 v[76:77], v10 offset:24576
    v_mfma_f32_16x16x32_bf16 v[156:159], v[124:127], v[88:91], v[156:159]
    ds_read_b64_tr_b16 v[78:79], v11 offset:24576
    v_mfma_f32_16x16x32_bf16 v[160:163], v[112:115], v[96:99], v[160:163]
    ds_read_b128 v[32:35], v5 offset:0
    v_mfma_f32_16x16x32_bf16 v[164:167], v[116:119], v[96:99], v[164:167]
    ds_read_b128 v[40:43], v5 offset:2048
    v_mfma_f32_16x16x32_bf16 v[168:171], v[120:123], v[96:99], v[168:171]
    ds_read_b128 v[48:51], v5 offset:4096
    v_mfma_f32_16x16x32_bf16 v[172:175], v[124:127], v[96:99], v[172:175]
    ds_read_b128 v[56:59], v5 offset:6144
    v_mfma_f32_16x16x32_bf16 v[176:179], v[112:115], v[104:107], v[176:179]
    v_mfma_f32_16x16x32_bf16 v[180:183], v[116:119], v[104:107], v[180:183]
    v_mfma_f32_16x16x32_bf16 v[184:187], v[120:123], v[104:107], v[184:187]
    v_mfma_f32_16x16x32_bf16 v[188:191], v[124:127], v[104:107], v[188:191]
    s_waitcnt lgkmcnt(0)
    s_sub_u32 s23, s23, 1
    s_cmp_lg_u32 s23, 0
    s_cbranch_scc1 w_loopM
w_doneM:
    v_mov_b32 v20, 131072
    ds_read_b128 v[24:27], v20
    ds_read_b128 v[28:31], v20 offset:16
    s_lshl_b32 s30, s27, 10
    s_add_u32 s30, s30, s49
    s_nop 7
    v_cvt_pk_bf16_f32 v80, v128, v129
    v_cvt_pk_bf16_f32 v81, v130, v131
    v_cvt_pk_bf16_f32 v82, v132, v133
    v_cvt_pk_bf16_f32 v83, v134, v135
    buffer_store_dwordx4 v[80:83], v1, s[4:7], s30 offen sc1
    v_cvt_pk_bf16_f32 v84, v136, v137
    v_cvt_pk_bf16_f32 v85, v138, v139
    v_cvt_pk_bf16_f32 v86, v140, v141
    v_cvt_pk_bf16_f32 v87, v142, v143
    buffer_store_dwordx4 v[84:87], v19, s[4:7], s30 offen sc1
    s_add_u32 s30, s30, s50
    v_cvt_pk_bf16_f32 v88, v144, v145
    v_cvt_pk_bf16_f32 v89, v146, v147
    v_cvt_pk_bf16_f32 v90, v148, v149
    v_cvt_pk_bf16_f32 v91, v150, v151
    buffer_store_dwordx4 v[88:91], v1, s[4:7], s30 offen sc1
    v_cvt_pk_bf16_f32 v92, v152, v153
    v_cvt_pk_bf16_f32 v93, v154, v155
    v_cvt_pk_bf16_f32 v94, v156, v157
    v_cvt_pk_bf16_f32 v95, v158, v159
    buffer_store_dwordx4 v[92:95], v19, s[4:7], s30 offen sc1
    s_add_u32 s30, s30, s50
    v_cvt_pk_bf16_f32 v80, v160, v161
    v_cvt_pk_bf16_f32 v81, v162, v163
    v_cvt_pk_bf16_f32 v82, v164, v165
    v_cvt_pk_bf16_f32 v83, v166, v167
    buffer_store_dwordx4 v[80:83], v1, s[4:7], s30 offen sc1
    v_cvt_pk_bf16_f32 v84, v168, v169
    v_cvt_pk_bf16_f32 v85, v170, v171
    v_cvt_pk_bf16_f32 v86, v172, v173
    v_cvt_pk_bf16_f32 v87, v174, v175
    buffer_store_dwordx4 v[84:87], v19, s[4:7], s30 offen sc1
    s_add_u32 s30, s30, s50
    v_cvt_pk_bf16_f32 v88, v176, v177
    v_cvt_pk_bf16_f32 v89, v178, v179
    v_cvt_pk_bf16_f32 v90, v180, v181
    v_cvt_pk_bf16_f32 v91, v182, v183
    buffer_store_dwordx4 v[88:91], v1, s[4:7], s30 offen sc1
    v_cvt_pk_bf16_f32 v92, v184, v185
    v_cvt_pk_bf16_f32 v93, v186, v187
    v_cvt_pk_bf16_f32 v94, v188, v189
    v_cvt_pk_bf16_f32 v95, v190, v191
    buffer_store_dwordx4 v[92:95], v19, s[4:7], s30 offen sc1
    s_add_u32 s30, s30, s50
    s_waitcnt lgkmcnt(0)
    v_or3_b32 v24, v24, v25, v26
    v_or3_b32 v28, v28, v29, v30
    v_or3_b32 v24, v24, v27, v31
    v_or_b32 v24, v24, v28
    s_mov_b32 s28, s51
    s_mov_b32 s57, s53
    v_readfirstlane_b32 s30, v24
    s_cmp_lg_u32 s30, 0
    s_cbranch_scc1 w_drain
    s_mov_b32 s48, s32
    s_cmp_ge_u32 s32, 4
    s_cselect_b32 s30, 2, 3
    s_lshl_b32 s30, s26, s30
    s_mul_i32 s30, s30, s43
    s_add_u32 s49, s42, s30
    s_mov_b32 s50, s43
    s_mov_b32 s51, s46
    s_mov_b32 s23, s41
    s_mov_b32 s53, s47
    s_nop 0
    s_load_dwordx16 s[32:47], s[24:25], 0
    s_add_u32 s24, s24, 64
    s_addc_u32 s25, s25, 0
    s_branch w_first8
w_drain:
    s_waitcnt vmcnt(0)
    s_barrier
    s_cmp_eq_u32 s28, 0
    s_cbranch_scc1 sig_5
    s_cmp_lg_u32 s3, 0
    s_cbranch_scc1 sig_5
    s_mov_b64 exec, 1
    v_mov_b32 v18, s57
    buffer_atomic_add v18, v17, s[4:7], s28 offen sc1
    s_mov_b64 exec, -1
sig_5:
    s_mov_b32 s28, 0
    s_cmp_eq_u32 s98, 3
    s_cselect_b32 s98, 1, s98
w_hook:
    s_cmp_eq_u32 s70, 0
    s_cbranch_scc1 drw_ok
    s_cmp_lt_u32 s39, 1048576
    s_cbranch_scc1 drw_ok
    s_mov_b32 s70, 0
    s_cmp_lg_u32 s3, 0
    s_cbranch_scc1 drw_ok
    v_readfirstlane_b32 s68, v22
    s_cmp_ge_u32 s68, 128
    s_cbranch_scc1 drw_ok
    s_mov_b32 s69, 65536
drw:
    buffer_load_dword v20, off, s[64:67], 0 offset:0 sc1
    s_waitcnt vmcnt(0)
    v_readfirstlane_b32 s68, v20
    s_cmp_ge_u32 s68, 128
    s_cbranch_scc1 drw_ok
    s_sleep 8
    s_sub_u32 s69, s69, 1
    s_cbranch_scc0 drw
drw_ok:
    s_branch w_cold
fin_entry:
    s_load_dwordx2 s[8:9], s[0:1], 0
    s_load_dwordx2 s[12:13], s[0:1], 88
    v_mbcnt_lo_u32_b32 v1, -1, 0
    v_mbcnt_hi_u32_b32 v1, -1, v1
    s_mov_b32 s10, 4194304
    s_mov_b32 s11, 131072
    s_mov_b32 s14, 4194304
    s_mov_b32 s15, 131072
    v_lshlrev_b32 v3, 4, v1
    v_and_b32 v4, 15, v1
    v_lshrrev_b32 v5, 4, v1
    v_lshlrev_b32 v4, 11, v4
    v_lshl_add_u32 v4, v5, 4, v4
    v_and_b32 v5, 1, v5
    v_cmp_eq_u32 s[20:21], 1, v5
    v_and_b32 v6, 7, v1
    v_lshlrev_b32 v6, 7, v6
    s_lshr_b32 s24, s63, 2
    s_and_b32 s25, s63, 3
    s_lshl_b32 s25, s25, 2
    s_and_b32 s26, s3, 3
    s_add_u32 s25, s25, s26
    s_lshr_b32 s26, s3, 2
    s_mov_b32 s28, 65536
    s_waitcnt lgkmcnt(0)
fin_job:
    s_lshl_b32 s16, s24, 1
    s_add_u32 s16, s16, s26
    s_lshl_b32 s18, s16, 15
    s_lshl_b32 s17, s25, 11
    s_add_u32 s17, s17, s18
    s_lshl_b32 s19, s25, 7
    s_add_u32 s18, s18, s19
    s_add_u32 s22, s17, 167772160
    s_add_u32 s23, s17, 75497472
    s_lshr_b32 s27, s24, 3
    s_lshl_b32 s27, s27, 6
    s_add_u32 s27, s27, 218106368
    s_cmp_ge_u32 s24, 64
    s_cselect_b32 s29, 16, 16
    s_mov_b32 s30, 218112000
    s_add_u32 s32, s24, 1
    s_mov_b32 s33, 0
    s_mov_b32 s34, 255
    s_cmp_lt_u32 s24, 62
    s_cbranch_scc1 fin_tg
    s_mov_b32 s32, 16
    s_add_u32 s30, s30, 4
    s_sub_u32 s33, s24, 62
    s_lshl_b32 s33, s33, 3
fin_tg:
    s_mul_i32 s35, s24, 3
    s_lshr_b32 s35, s35, 4
    s_add_u32 s35, s35, 49
    s_min_u32 s35, s35, 61
    s_max_u32 s32, s32, s35
    buffer_load_dwordx4 v[88:91], v4, s[8:11], s18 offen offset:0
    buffer_load_dwordx4 v[92:95], v4, s[8:11], s18 offen offset:64
    s_cmp_lg_u32 s3, 0
    s_cbranch_scc1 fin_ws_ok
fin_wd:
    buffer_load_dword v7, off, s[4:7], s27 sc1
    s_waitcnt vmcnt(0)
    v_readfirstlane_b32 s31, v7
    s_cmp_ge_u32 s31, s29
    s_cbranch_scc1 fin_wd_ok
    s_sleep 127
    s_sub_u32 s28, s28, 1
    s_cbranch_scc0 fin_wd
    s_mov_b32 s28, 0
fin_wd_ok:
fin_ws:
    buffer_load_dword v7, v6, s[4:7], s30 offen sc1
    s_waitcnt vmcnt(0)
    v_lshrrev_b32 v7, s33, v7
    v_and_b32 v7, s34, v7
    v_cmp_gt_u32 vcc, s32, v7
    s_cbranch_vccz fin_ws_ok
    s_sleep 12
    v_add_u32 v7, 1, v7
    v_cmp_gt_u32 vcc, s32, v7
    s_cbranch_vccz fin_ws_f
    s_sleep 48
    v_add_u32 v7, 3, v7
    v_cmp_gt_u32 vcc, s32, v7
    s_cbranch_vccz fin_ws_f
    s_sleep 127
    s_sleep 127
fin_ws_f:
    s_sub_u32 s28, s28, 1
    s_cbranch_scc0 fin_ws
    s_mov_b32 s28, 0
fin_ws_ok:
    s_barrier
    buffer_load_dwordx4 v[144:147], v3, s[4:7], s22 offen offset:0 sc1
    buffer_load_dwordx4 v[160:163], v3, s[4:7], s22 offen offset:1024 sc1
    s_add_u32 s22, s22, 4194304
    buffer_load_dwordx4 v[148:151], v3, s[4:7], s22 offen offset:0 sc1
    buffer_load_dwordx4 v[164:167], v3, s[4:7], s22 offen offset:1024 sc1
    s_add_u32 s22, s22, 4194304
    buffer_load_dwordx4 v[152:155], v3, s[4:7], s22 offen offset:0 sc1
    buffer_load_dwordx4 v[168:171], v3, s[4:7], s22 offen offset:1024 sc1
    s_add_u32 s22, s22, 4194304
    buffer_load_dwordx4 v[156:159], v3, s[4:7], s22 offen offset:0 sc1
    buffer_load_dwordx4 v[172:175], v3, s[4:7], s22 offen offset:1024 sc1
    buffer_load_dwordx4 v[16:19], v3, s[4:7], s23 offen offset:0 sc1
    buffer_load_dwordx4 v[48:51], v3, s[4:7], s23 offen offset:1024 sc1
    s_add_u32 s23, s23, 4194304
    buffer_load_dwordx4 v[20:23], v3, s[4:7], s23 offen offset:0 sc1
    buffer_load_dwordx4 v[52:55], v3, s[4:7], s23 offen offset:1024 sc1
    s_add_u32 s23, s23, 4194304
    buffer_load_dwordx4 v[24:27], v3, s[4:7], s23 offen offset:0 sc1
    buffer_load_dwordx4 v[56:59], v3, s[4:7], s23 offen offset:1024 sc1
    s_add_u32 s23, s23, 4194304
    buffer_load_dwordx4 v[28:31], v3, s[4:7], s23 offen offset:0 sc1
    buffer_load_dwordx4 v[60:63], v3, s[4:7], s23 offen offset:1024 sc1
    s_add_u32 s23, s23, 4194304
    buffer_load_dwordx4 v[32:35], v3, s[4:7], s23 offen offset:0 sc1
    buffer_load_dwordx4 v[64:67], v3, s[4:7], s23 offen offset:1024 sc1
    s_add_u32 s23, s23, 4194304
    buffer_load_dwordx4 v[36:39], v3, s[4:7], s23 offen offset:0 sc1
    buffer_load_dwordx4 v[68:71], v3, s[4:7], s23 offen offset:1024 sc1
    s_add_u32 s23, s23, 4194304
    buffer_load_dwordx4 v[40:43], v3, s[4:7], s23 offen offset:0 sc1
    buffer_load_dwordx4 v[72:75], v3, s[4:7], s23 offen offset:1024 sc1
    s_add_u32 s23, s23, 4194304
    buffer_load_dwordx4 v[44:47], v3, s[4:7], s23 offen offset:0 sc1
    buffer_load_dwordx4 v[76:79], v3, s[4:7], s23 offen offset:1024 sc1
    s_add_u32 s23, s23, 4194304
    s_waitcnt vmcnt(16)
    v_lshlrev_b32 v96, 16, v144
    v_and_b32 v97, 0xffff0000, v144
    v_lshlrev_b32 v98, 16, v145
    v_and_b32 v99, 0xffff0000, v145
    v_lshlrev_b32 v100, 16, v146
    v_and_b32 v101, 0xffff0000, v146
    v_lshlrev_b32 v102, 16, v147
    v_and_b32 v103, 0xffff0000, v147
    v_lshlrev_b32 v120, 16, v148
    v_and_b32 v121, 0xffff0000, v148
    v_lshlrev_b32 v122, 16, v149
    v_and_b32 v123, 0xffff0000, v149
    v_lshlrev_b32 v124, 16, v150
    v_and_b32 v125, 0xffff0000, v150
    v_lshlrev_b32 v126, 16, v151
    v_and_b32 v127, 0xffff0000, v151
    v_add_f32 v96, v96, v120
    v_add_f32 v97, v97, v121
    v_add_f32 v98, v98, v122
    v_add_f32 v99, v99, v123
    v_add_f32 v100, v100, v124
    v_add_f32 v101, v101, v125
    v_add_f32 v102, v102, v126
    v_add_f32 v103, v103, v127
    v_lshlrev_b32 v120, 16, v152
    v_and_b32 v121, 0xffff0000, v152
    v_lshlrev_b32 v122, 16, v153
    v_and_b32 v123, 0xffff0000, v153
    v_lshlrev_b32 v124, 16, v154
    v_and_b32 v125, 0xffff0000, v154
    v_lshlrev_b32 v126, 16, v155
    v_and_b32 v127, 0xffff0000, v155
    v_add_f32 v96, v96, v120
    v_add_f32 v97, v97, v121
    v_add_f32 v98, v98, v122
    v_add_f32 v99, v99, v123
    v_add_f32 v100, v100, v124
    v_add_f32 v101, v101, v125
    v_add_f32 v102, v102, v126
    v_add_f32 v103, v103, v127
    v_lshlrev_b32 v120, 16, v156
    v_and_b32 v121, 0xffff0000, v156
    v_lshlrev_b32 v122, 16, v157
    v_and_b32 v123, 0xffff0000, v157
    v_lshlrev_b32 v124, 16, v158
    v_and_b32 v125, 0xffff0000, v158
    v_lshlrev_b32 v126, 16, v159
    v_and_b32 v127, 0xffff0000, v159
    v_add_f32 v96, v96, v120
    v_add_f32 v97, v97, v121
    v_add_f32 v98, v98, v122
    v_add_f32 v99, v99, v123
    v_add_f32 v100, v100, v124
    v_add_f32 v101, v101, v125
    v_add_f32 v102, v102, v126
    v_add_f32 v103, v103, v127
    v_cvt_pk_bf16_f32 v120, v96, v97
    v_cvt_pk_bf16_f32 v121, v98, v99
    v_cvt_pk_bf16_f32 v122, v100, v101
    v_cvt_pk_bf16_f32 v123, v102, v103
    v_lshlrev_b32 v96, 16, v120
    v_and_b32 v97, 0xffff0000, v120
    v_lshlrev_b32 v98, 16, v121
    v_and_b32 v99, 0xffff0000, v121
    v_lshlrev_b32 v100, 16, v122
    v_and_b32 v101, 0xffff0000, v122
    v_lshlrev_b32 v102, 16, v123
    v_and_b32 v103, 0xffff0000, v123
    v_mul_f32 v104, 0xbfb8aa3b, v96
    v_mul_f32 v105, 0xbfb8aa3b, v97
    v_mul_f32 v106, 0xbfb8aa3b, v98
    v_mul_f32 v107, 0xbfb8aa3b, v99
    v_mul_f32 v108, 0xbfb8aa3b, v100
    v_mul_f32 v109, 0xbfb8aa3b, v101
    v_mul_f32 v110, 0xbfb8aa3b, v102
    v_mul_f32 v111, 0xbfb8aa3b, v103
    v_exp_f32 v104, v104
    v_exp_f32 v105, v105
    v_exp_f32 v106, v106
    v_exp_f32 v107, v107
    v_exp_f32 v108, v108
    v_exp_f32 v109, v109
    v_exp_f32 v110, v110
    v_exp_f32 v111, v111
    v_add_f32 v104, 1.0, v104
    v_add_f32 v105, 1.0, v105
    v_add_f32 v106, 1.0, v106
    v_add_f32 v107, 1.0, v107
    v_add_f32 v108, 1.0, v108
    v_add_f32 v109, 1.0, v109
    v_add_f32 v110, 1.0, v110
    v_add_f32 v111, 1.0, v111
    v_rcp_f32 v104, v104
    v_rcp_f32 v105, v105
    v_rcp_f32 v106, v106
    v_rcp_f32 v107, v107
    v_rcp_f32 v108, v108
    v_rcp_f32 v109, v109
    v_rcp_f32 v110, v110
    v_rcp_f32 v111, v111
    v_mul_f32 v96, v96, v104
    v_mul_f32 v97, v97, v105
    v_mul_f32 v98, v98, v106
    v_mul_f32 v99, v99, v107
    v_mul_f32 v100, v100, v108
    v_mul_f32 v101, v101, v109
    v_mul_f32 v102, v102, v110
    v_mul_f32 v103, v103, v111
    v_cvt_pk_bf16_f32 v80, v96, v97
    v_cvt_pk_bf16_f32 v81, v98, v99
    v_cvt_pk_bf16_f32 v82, v100, v101
    v_cvt_pk_bf16_f32 v83, v102, v103
    v_lshlrev_b32 v96, 16, v160
    v_and_b32 v97, 0xffff0000, v160
    v_lshlrev_b32 v98, 16, v161
    v_and_b32 v99, 0xffff0000, v161
    v_lshlrev_b32 v100, 16, v162
    v_and_b32 v101, 0xffff0000, v162
    v_lshlrev_b32 v102, 16, v163
    v_and_b32 v103, 0xffff0000, v163
    v_lshlrev_b32 v120, 16, v164
    v_and_b32 v121, 0xffff0000, v164
    v_lshlrev_b32 v122, 16, v165
    v_and_b32 v123, 0xffff0000, v165
    v_lshlrev_b32 v124, 16, v166
    v_and_b32 v125, 0xffff0000, v166
    v_lshlrev_b32 v126, 16, v167
    v_and_b32 v127, 0xffff0000, v167
    v_add_f32 v96, v96, v120
    v_add_f32 v97, v97, v121
    v_add_f32 v98, v98, v122
    v_add_f32 v99, v99, v123
    v_add_f32 v100, v100, v124
    v_add_f32 v101, v101, v125
    v_add_f32 v102, v102, v126
    v_add_f32 v103, v103, v127
    v_lshlrev_b32 v120, 16, v168
    v_and_b32 v121, 0xffff0000, v168
    v_lshlrev_b32 v122, 16, v169
    v_and_b32 v123, 0xffff0000, v169
    v_lshlrev_b32 v124, 16, v170
    v_and_b32 v125, 0xffff0000, v170
    v_lshlrev_b32 v126, 16, v171
    v_and_b32 v127, 0xffff0000, v171
    v_add_f32 v96, v96, v120
    v_add_f32 v97, v97, v121
    v_add_f32 v98, v98, v122
    v_add_f32 v99, v99, v123
    v_add_f32 v100, v100, v124
    v_add_f32 v101, v101, v125
    v_add_f32 v102, v102, v126
    v_add_f32 v103, v103, v127
    v_lshlrev_b32 v120, 16, v172
    v_and_b32 v121, 0xffff0000, v172
    v_lshlrev_b32 v122, 16, v173
    v_and_b32 v123, 0xffff0000, v173
    v_lshlrev_b32 v124, 16, v174
    v_and_b32 v125, 0xffff0000, v174
    v_lshlrev_b32 v126, 16, v175
    v_and_b32 v127, 0xffff0000, v175
    v_add_f32 v96, v96, v120
    v_add_f32 v97, v97, v121
    v_add_f32 v98, v98, v122
    v_add_f32 v99, v99, v123
    v_add_f32 v100, v100, v124
    v_add_f32 v101, v101, v125
    v_add_f32 v102, v102, v126
    v_add_f32 v103, v103, v127
    v_cvt_pk_bf16_f32 v120, v96, v97
    v_cvt_pk_bf16_f32 v121, v98, v99
    v_cvt_pk_bf16_f32 v122, v100, v101
    v_cvt_pk_bf16_f32 v123, v102, v103
    v_lshlrev_b32 v96, 16, v120
    v_and_b32 v97, 0xffff0000, v120
    v_lshlrev_b32 v98, 16, v121
    v_and_b32 v99, 0xffff0000, v121
    v_lshlrev_b32 v100, 16, v122
    v_and_b32 v101, 0xffff0000, v122
    v_lshlrev_b32 v102, 16, v123
    v_and_b32 v103, 0xffff0000, v123
    v_mul_f32 v104, 0xbfb8aa3b, v96
    v_mul_f32 v105, 0xbfb8aa3b, v97
    v_mul_f32 v106, 0xbfb8aa3b, v98
    v_mul_f32 v107, 0xbfb8aa3b, v99
    v_mul_f32 v108, 0xbfb8aa3b, v100
    v_mul_f32 v109, 0xbfb8aa3b, v101
    v_mul_f32 v110, 0xbfb8aa3b, v102
    v_mul_f32 v111, 0xbfb8aa3b, v103
    v_exp_f32 v104, v104
    v_exp_f32 v105, v105
    v_exp_f32 v106, v106
    v_exp_f32 v107, v107
    v_exp_f32 v108, v108
    v_exp_f32 v109, v109
    v_exp_f32 v110, v110
    v_exp_f32 v111, v111
    v_add_f32 v104, 1.0, v104
    v_add_f32 v105, 1.0, v105
    v_add_f32 v106, 1.0, v106
    v_add_f32 v107, 1.0, v107
    v_add_f32 v108, 1.0, v108
    v_add_f32 v109, 1.0, v109
    v_add_f32 v110, 1.0, v110
    v_add_f32 v111, 1.0, v111
    v_rcp_f32 v104, v104
    v_rcp_f32 v105, v105
    v_rcp_f32 v106, v106
    v_rcp_f32 v107, v107
    v_rcp_f32 v108, v108
    v_rcp_f32 v109, v109
    v_rcp_f32 v110, v110
    v_rcp_f32 v111, v111
    v_mul_f32 v96, v96, v104
    v_mul_f32 v97, v97, v105
    v_mul_f32 v98, v98, v106
    v_mul_f32 v99, v99, v107
    v_mul_f32 v100, v100, v108
    v_mul_f32 v101, v101, v109
    v_mul_f32 v102, v102, v110
    v_mul_f32 v103, v103, v111
    v_cvt_pk_bf16_f32 v84, v96, v97
    v_cvt_pk_bf16_f32 v85, v98, v99
    v_cvt_pk_bf16_f32 v86, v100, v101
    v_cvt_pk_bf16_f32 v87, v102, v103
    s_waitcnt vmcnt(0)
    v_lshlrev_b32 v96, 16, v16
    v_and_b32 v97, 0xffff0000, v16
    v_lshlrev_b32 v98, 16, v17
    v_and_b32 v99, 0xffff0000, v17
    v_lshlrev_b32 v100, 16, v18
    v_and_b32 v101, 0xffff0000, v18
    v_lshlrev_b32 v102, 16, v19
    v_and_b32 v103, 0xffff0000, v19
    v_lshlrev_b32 v120, 16, v20
    v_and_b32 v121, 0xffff0000, v20
    v_lshlrev_b32 v122, 16, v21
    v_and_b32 v123, 0xffff0000, v21
    v_lshlrev_b32 v124, 16, v22
    v_and_b32 v125, 0xffff0000, v22
    v_lshlrev_b32 v126, 16, v23
    v_and_b32 v127, 0xffff0000, v23
    v_add_f32 v96, v96, v120
    v_add_f32 v97, v97, v121
    v_add_f32 v98, v98, v122
    v_add_f32 v99, v99, v123
    v_add_f32 v100, v100, v124
    v_add_f32 v101, v101, v125
    v_add_f32 v102, v102, v126
    v_add_f32 v103, v103, v127
    v_lshlrev_b32 v120, 16, v24
    v_and_b32 v121, 0xffff0000, v24
    v_lshlrev_b32 v122, 16, v25
    v_and_b32 v123, 0xffff0000, v25
    v_lshlrev_b32 v124, 16, v26
    v_and_b32 v125, 0xffff0000, v26
    v_lshlrev_b32 v126, 16, v27
    v_and_b32 v127, 0xffff0000, v27
    v_add_f32 v96, v96, v120
    v_add_f32 v97, v97, v121
    v_add_f32 v98, v98, v122
    v_add_f32 v99, v99, v123
    v_add_f32 v100, v100, v124
    v_add_f32 v101, v101, v125
    v_add_f32 v102, v102, v126
    v_add_f32 v103, v103, v127
    v_lshlrev_b32 v120, 16, v28
    v_and_b32 v121, 0xffff0000, v28
    v_lshlrev_b32 v122, 16, v29
    v_and_b32 v123, 0xffff0000, v29
    v_lshlrev_b32 v124, 16, v30
    v_and_b32 v125, 0xffff0000, v30
    v_lshlrev_b32 v126, 16, v31
    v_and_b32 v127, 0xffff0000, v31
    v_add_f32 v96, v96, v120
    v_add_f32 v97, v97, v121
    v_add_f32 v98, v98, v122
    v_add_f32 v99, v99, v123
    v_add_f32 v100, v100, v124
    v_add_f32 v101, v101, v125
    v_add_f32 v102, v102, v126
    v_add_f32 v103, v103, v127
    v_lshlrev_b32 v120, 16, v32
    v_and_b32 v121, 0xffff0000, v32
    v_lshlrev_b32 v122, 16, v33
    v_and_b32 v123, 0xffff0000, v33
    v_lshlrev_b32 v124, 16, v34
    v_and_b32 v125, 0xffff0000, v34
    v_lshlrev_b32 v126, 16, v35
    v_and_b32 v127, 0xffff0000, v35
    v_add_f32 v96, v96, v120
    v_add_f32 v97, v97, v121
    v_add_f32 v98, v98, v122
    v_add_f32 v99, v99, v123
    v_add_f32 v100, v100, v124
    v_add_f32 v101, v101, v125
    v_add_f32 v102, v102, v126
    v_add_f32 v103, v103, v127
    v_lshlrev_b32 v120, 16, v36
    v_and_b32 v121, 0xffff0000, v36
    v_lshlrev_b32 v122, 16, v37
    v_and_b32 v123, 0xffff0000, v37
    v_lshlrev_b32 v124, 16, v38
    v_and_b32 v125, 0xffff0000, v38
    v_lshlrev_b32 v126, 16, v39
    v_and_b32 v127, 0xffff0000, v39
    v_add_f32 v96, v96, v120
    v_add_f32 v97, v97, v121
    v_add_f32 v98, v98, v122
    v_add_f32 v99, v99, v123
    v_add_f32 v100, v100, v124
    v_add_f32 v101, v101, v125
    v_add_f32 v102, v102, v126
    v_add_f32 v103, v103, v127
    v_lshlrev_b32 v120, 16, v40
    v_and_b32 v121, 0xffff0000, v40
    v_lshlrev_b32 v122, 16, v41
    v_and_b32 v123, 0xffff0000, v41
    v_lshlrev_b32 v124, 16, v42
    v_and_b32 v125, 0xffff0000, v42
    v_lshlrev_b32 v126, 16, v43
    v_and_b32 v127, 0xffff0000, v43
    v_add_f32 v96, v96, v120
    v_add_f32 v97, v97, v121
    v_add_f32 v98, v98, v122
    v_add_f32 v99, v99, v123
    v_add_f32 v100, v100, v124
    v_add_f32 v101, v101, v125
    v_add_f32 v102, v102, v126
    v_add_f32 v103, v103, v127
    v_lshlrev_b32 v120, 16, v44
    v_and_b32 v121, 0xffff0000, v44
    v_lshlrev_b32 v122, 16, v45
    v_and_b32 v123, 0xffff0000, v45
    v_lshlrev_b32 v124, 16, v46
    v_and_b32 v125, 0xffff0000, v46
    v_lshlrev_b32 v126, 16, v47
    v_and_b32 v127, 0xffff0000, v47
    v_add_f32 v96, v96, v120
    v_add_f32 v97, v97, v121
    v_add_f32 v98, v98, v122
    v_add_f32 v99, v99, v123
    v_add_f32 v100, v100, v124
    v_add_f32 v101, v101, v125
    v_add_f32 v102, v102, v126
    v_add_f32 v103, v103, v127
    v_cndmask_b32 v108, v88, v90, s[20:21]
    v_cndmask_b32 v109, v89, v91, s[20:21]
    v_cndmask_b32 v110, v90, v88, s[20:21]
    v_cndmask_b32 v111, v91, v89, s[20:21]
    v_cvt_pk_bf16_f32 v104, v96, v97
    v_lshlrev_b32 v96, 16, v104
    v_and_b32 v97, 0xffff0000, v104
    v_lshlrev_b32 v104, 16, v80
    v_and_b32 v105, 0xffff0000, v80
    v_mul_f32 v96, v96, v104
    v_mul_f32 v97, v97, v105
    v_cvt_pk_bf16_f32 v104, v96, v97
    v_lshlrev_b32 v96, 16, v104
    v_and_b32 v97, 0xffff0000, v104
    v_lshlrev_b32 v104, 16, v108
    v_and_b32 v105, 0xffff0000, v108
    v_add_f32 v96, v96, v104
    v_add_f32 v97, v97, v105
    v_cvt_pk_bf16_f32 v112, v96, v97
    v_cvt_pk_bf16_f32 v104, v98, v99
    v_lshlrev_b32 v98, 16, v104
    v_and_b32 v99, 0xffff0000, v104
    v_lshlrev_b32 v104, 16, v81
    v_and_b32 v105, 0xffff0000, v81
    v_mul_f32 v98, v98, v104
    v_mul_f32 v99, v99, v105
    v_cvt_pk_bf16_f32 v104, v98, v99
    v_lshlrev_b32 v98, 16, v104
    v_and_b32 v99, 0xffff0000, v104
    v_lshlrev_b32 v104, 16, v109
    v_and_b32 v105, 0xffff0000, v109
    v_add_f32 v98, v98, v104
    v_add_f32 v99, v99, v105
    v_cvt_pk_bf16_f32 v113, v98, v99
    v_cvt_pk_bf16_f32 v104, v100, v101
    v_lshlrev_b32 v100, 16, v104
    v_and_b32 v101, 0xffff0000, v104
    v_lshlrev_b32 v104, 16, v82
    v_and_b32 v105, 0xffff0000, v82
    v_mul_f32 v100, v100, v104
    v_mul_f32 v101, v101, v105
    v_cvt_pk_bf16_f32 v104, v100, v101
    v_lshlrev_b32 v100, 16, v104
    v_and_b32 v101, 0xffff0000, v104
    v_lshlrev_b32 v104, 16, v110
    v_and_b32 v105, 0xffff0000, v110
    v_add_f32 v100, v100, v104
    v_add_f32 v101, v101, v105
    v_cvt_pk_bf16_f32 v114, v100, v101
    v_cvt_pk_bf16_f32 v104, v102, v103
    v_lshlrev_b32 v102, 16, v104
    v_and_b32 v103, 0xffff0000, v104
    v_lshlrev_b32 v104, 16, v83
    v_and_b32 v105, 0xffff0000, v83
    v_mul_f32 v102, v102, v104
    v_mul_f32 v103, v103, v105
    v_cvt_pk_bf16_f32 v104, v102, v103
    v_lshlrev_b32 v102, 16, v104
    v_and_b32 v103, 0xffff0000, v104
    v_lshlrev_b32 v104, 16, v111
    v_and_b32 v105, 0xffff0000, v111
    v_add_f32 v102, v102, v104
    v_add_f32 v103, v103, v105
    v_cvt_pk_bf16_f32 v115, v102, v103
    v_cndmask_b32 v128, v112, v114, s[20:21]
    v_cndmask_b32 v129, v113, v115, s[20:21]
    v_cndmask_b32 v130, v114, v112, s[20:21]
    v_cndmask_b32 v131, v115, v113, s[20:21]
    buffer_store_dwordx4 v[128:131], v4, s[12:15], s18 offen offset:0
    v_lshlrev_b32 v96, 16, v48
    v_and_b32 v97, 0xffff0000, v48
    v_lshlrev_b32 v98, 16, v49
    v_and_b32 v99, 0xffff0000, v49
    v_lshlrev_b32 v100, 16, v50
    v_and_b32 v101, 0xffff0000, v50
    v_lshlrev_b32 v102, 16, v51
    v_and_b32 v103, 0xffff0000, v51
    v_lshlrev_b32 v120, 16, v52
    v_and_b32 v121, 0xffff0000, v52
    v_lshlrev_b32 v122, 16, v53
    v_and_b32 v123, 0xffff0000, v53
    v_lshlrev_b32 v124, 16, v54
    v_and_b32 v125, 0xffff0000, v54
    v_lshlrev_b32 v126, 16, v55
    v_and_b32 v127, 0xffff0000, v55
    v_add_f32 v96, v96, v120
    v_add_f32 v97, v97, v121
    v_add_f32 v98, v98, v122
    v_add_f32 v99, v99, v123
    v_add_f32 v100, v100, v124
    v_add_f32 v101, v101, v125
    v_add_f32 v102, v102, v126
    v_add_f32 v103, v103, v127
    v_lshlrev_b32 v120, 16, v56
    v_and_b32 v121, 0xffff0000, v56
    v_lshlrev_b32 v122, 16, v57
    v_and_b32 v123, 0xffff0000, v57
    v_lshlrev_b32 v124, 16, v58
    v_and_b32 v125, 0xffff0000, v58
    v_lshlrev_b32 v126, 16, v59
    v_and_b32 v127, 0xffff0000, v59
    v_add_f32 v96, v96, v120
    v_add_f32 v97, v97, v121
    v_add_f32 v98, v98, v122
    v_add_f32 v99, v99, v123
    v_add_f32 v100, v100, v124
    v_add_f32 v101, v101, v125
    v_add_f32 v102, v102, v126
    v_add_f32 v103, v103, v127
    v_lshlrev_b32 v120, 16, v60
    v_and_b32 v121, 0xffff0000, v60
    v_lshlrev_b32 v122, 16, v61
    v_and_b32 v123, 0xffff0000, v61
    v_lshlrev_b32 v124, 16, v62
    v_and_b32 v125, 0xffff0000, v62
    v_lshlrev_b32 v126, 16, v63
    v_and_b32 v127, 0xffff0000, v63
    v_add_f32 v96, v96, v120
    v_add_f32 v97, v97, v121
    v_add_f32 v98, v98, v122
    v_add_f32 v99, v99, v123
    v_add_f32 v100, v100, v124
    v_add_f32 v101, v101, v125
    v_add_f32 v102, v102, v126
    v_add_f32 v103, v103, v127
    v_lshlrev_b32 v120, 16, v64
    v_and_b32 v121, 0xffff0000, v64
    v_lshlrev_b32 v122, 16, v65
    v_and_b32 v123, 0xffff0000, v65
    v_lshlrev_b32 v124, 16, v66
    v_and_b32 v125, 0xffff0000, v66
    v_lshlrev_b32 v126, 16, v67
    v_and_b32 v127, 0xffff0000, v67
    v_add_f32 v96, v96, v120
    v_add_f32 v97, v97, v121
    v_add_f32 v98, v98, v122
    v_add_f32 v99, v99, v123
    v_add_f32 v100, v100, v124
    v_add_f32 v101, v101, v125
    v_add_f32 v102, v102, v126
    v_add_f32 v103, v103, v127
    v_lshlrev_b32 v120, 16, v68
    v_and_b32 v121, 0xffff0000, v68
    v_lshlrev_b32 v122, 16, v69
    v_and_b32 v123, 0xffff0000, v69
    v_lshlrev_b32 v124, 16, v70
    v_and_b32 v125, 0xffff0000, v70
    v_lshlrev_b32 v126, 16, v71
    v_and_b32 v127, 0xffff0000, v71
    v_add_f32 v96, v96, v120
    v_add_f32 v97, v97, v121
    v_add_f32 v98, v98, v122
    v_add_f32 v99, v99, v123
    v_add_f32 v100, v100, v124
    v_add_f32 v101, v101, v125
    v_add_f32 v102, v102, v126
    v_add_f32 v103, v103, v127
    v_lshlrev_b32 v120, 16, v72
    v_and_b32 v121, 0xffff0000, v72
    v_lshlrev_b32 v122, 16, v73
    v_and_b32 v123, 0xffff0000, v73
    v_lshlrev_b32 v124, 16, v74
    v_and_b32 v125, 0xffff0000, v74
    v_lshlrev_b32 v126, 16, v75
    v_and_b32 v127, 0xffff0000, v75
    v_add_f32 v96, v96, v120
    v_add_f32 v97, v97, v121
    v_add_f32 v98, v98, v122
    v_add_f32 v99, v99, v123
    v_add_f32 v100, v100, v124
    v_add_f32 v101, v101, v125
    v_add_f32 v102, v102, v126
    v_add_f32 v103, v103, v127
    v_lshlrev_b32 v120, 16, v76
    v_and_b32 v121, 0xffff0000, v76
    v_lshlrev_b32 v122, 16, v77
    v_and_b32 v123, 0xffff0000, v77
    v_lshlrev_b32 v124, 16, v78
    v_and_b32 v125, 0xffff0000, v78
    v_lshlrev_b32 v126, 16, v79
    v_and_b32 v127, 0xffff0000, v79
    v_add_f32 v96, v96, v120
    v_add_f32 v97, v97, v121
    v_add_f32 v98, v98, v122
    v_add_f32 v99, v99, v123
    v_add_f32 v100, v100, v124
    v_add_f32 v101, v101, v125
    v_add_f32 v102, v102, v126
    v_add_f32 v103, v103, v127
    v_cndmask_b32 v108, v92, v94, s[20:21]
    v_cndmask_b32 v109, v93, v95, s[20:21]
    v_cndmask_b32 v110, v94, v92, s[20:21]
    v_cndmask_b32 v111, v95, v93, s[20:21]
    v_cvt_pk_bf16_f32 v104, v96, v97
    v_lshlrev_b32 v96, 16, v104
    v_and_b32 v97, 0xffff0000, v104
    v_lshlrev_b32 v104, 16, v84
    v_and_b32 v105, 0xffff0000, v84
    v_mul_f32 v96, v96, v104
    v_mul_f32 v97, v97, v105
    v_cvt_pk_bf16_f32 v104, v96, v97
    v_lshlrev_b32 v96, 16, v104
    v_and_b32 v97, 0xffff0000, v104
    v_lshlrev_b32 v104, 16, v108
    v_and_b32 v105, 0xffff0000, v108
    v_add_f32 v96, v96, v104
    v_add_f32 v97, v97, v105
    v_cvt_pk_bf16_f32 v112, v96, v97
    v_cvt_pk_bf16_f32 v104, v98, v99
    v_lshlrev_b32 v98, 16, v104
    v_and_b32 v99, 0xffff0000, v104
    v_lshlrev_b32 v104, 16, v85
    v_and_b32 v105, 0xffff0000, v85
    v_mul_f32 v98, v98, v104
    v_mul_f32 v99, v99, v105
    v_cvt_pk_bf16_f32 v104, v98, v99
    v_lshlrev_b32 v98, 16, v104
    v_and_b32 v99, 0xffff0000, v104
    v_lshlrev_b32 v104, 16, v109
    v_and_b32 v105, 0xffff0000, v109
    v_add_f32 v98, v98, v104
    v_add_f32 v99, v99, v105
    v_cvt_pk_bf16_f32 v113, v98, v99
    v_cvt_pk_bf16_f32 v104, v100, v101
    v_lshlrev_b32 v100, 16, v104
    v_and_b32 v101, 0xffff0000, v104
    v_lshlrev_b32 v104, 16, v86
    v_and_b32 v105, 0xffff0000, v86
    v_mul_f32 v100, v100, v104
    v_mul_f32 v101, v101, v105
    v_cvt_pk_bf16_f32 v104, v100, v101
    v_lshlrev_b32 v100, 16, v104
    v_and_b32 v101, 0xffff0000, v104
    v_lshlrev_b32 v104, 16, v110
    v_and_b32 v105, 0xffff0000, v110
    v_add_f32 v100, v100, v104
    v_add_f32 v101, v101, v105
    v_cvt_pk_bf16_f32 v114, v100, v101
    v_cvt_pk_bf16_f32 v104, v102, v103
    v_lshlrev_b32 v102, 16, v104
    v_and_b32 v103, 0xffff0000, v104
    v_lshlrev_b32 v104, 16, v87
    v_and_b32 v105, 0xffff0000, v87
    v_mul_f32 v102, v102, v104
    v_mul_f32 v103, v103, v105
    v_cvt_pk_bf16_f32 v104, v102, v103
    v_lshlrev_b32 v102, 16, v104
    v_and_b32 v103, 0xffff0000, v104
    v_lshlrev_b32 v104, 16, v111
    v_and_b32 v105, 0xffff0000, v111
    v_add_f32 v102, v102, v104
    v_add_f32 v103, v103, v105
    v_cvt_pk_bf16_f32 v115, v102, v103
    v_cndmask_b32 v132, v112, v114, s[20:21]
    v_cndmask_b32 v133, v113, v115, s[20:21]
    v_cndmask_b32 v134, v114, v112, s[20:21]
    v_cndmask_b32 v135, v115, v113, s[20:21]
    buffer_store_dwordx4 v[132:135], v4, s[12:15], s18 offen offset:64
    s_add_u32 s24, s24, 32
    s_cmp_lt_u32 s24, 61
    s_cbranch_scc1 fin_job
    s_cmp_ge_u32 s63, 48
    s_cbranch_scc1 k_end
    s_lshr_b32 s24, s63, 4
    s_sub_u32 s24, 63, s24
    s_and_b32 s25, s63, 15
    s_lshl_b32 s25, s25, 2
    s_and_b32 s26, s3, 3
    s_add_u32 s25, s25, s26
    s_lshr_b32 s26, s25, 5
    s_and_b32 s25, s25, 31
    s_lshl_b32 s16, s24, 1
    s_add_u32 s16, s16, s26
    s_lshl_b32 s18, s16, 15
    s_lshl_b32 s17, s25, 10
    s_add_u32 s17, s17, s18
    s_lshl_b32 s19, s25, 6
    s_add_u32 s18, s18, s19
    s_add_u32 s22, s17, 167772160
    s_add_u32 s23, s17, 75497472
    s_mov_b32 s27, 218106816
    s_mov_b32 s30, 218112000
    s_mov_b32 s28, 65536
    v_and_b32 v8, 7, v1
    v_lshlrev_b32 v8, 22, v8
    s_cmp_lg_u32 s3, 0
    s_cbranch_scc1 ft_ok
ft_wd:
    buffer_load_dword v7, off, s[4:7], s27 sc1
    s_waitcnt vmcnt(0)
    v_readfirstlane_b32 s31, v7
    s_cmp_ge_u32 s31, 16
    s_cbranch_scc1 ft_ws
    s_sleep 127
    s_sub_u32 s28, s28, 1
    s_cbranch_scc0 ft_wd
    s_mov_b32 s28, 0
ft_ws:
    buffer_load_dword v7, v6, s[4:7], s30 offen sc1
    s_waitcnt vmcnt(0)
    v_cmp_gt_u32 vcc, 61, v7
    s_cbranch_vccz ft_ok
    s_sleep 12
    v_cmp_gt_u32 vcc, 59, v7
    s_cbranch_vccz ft_wsf
    s_sleep 64
    v_cmp_gt_u32 vcc, 56, v7
    s_cbranch_vccz ft_wsf
    s_sleep 127
    s_sleep 127
ft_wsf:
    s_sub_u32 s28, s28, 1
    s_cbranch_scc0 ft_ws
    s_mov_b32 s28, 0
ft_ok:
    s_barrier
    s_cmp_ge_u32 s3, 4
    s_cbranch_scc1 k_end
    buffer_load_dwordx4 v[88:91], v4, s[8:11], s18 offen
    buffer_load_dwordx4 v[144:147], v3, s[4:7], s22 offen offset:0 sc1
    s_add_u32 s22, s22, 4194304
    buffer_load_dwordx4 v[148:151], v3, s[4:7], s22 offen offset:0 sc1
    s_add_u32 s22, s22, 4194304
    buffer_load_dwordx4 v[152:155], v3, s[4:7], s22 offen offset:0 sc1
    s_add_u32 s22, s22, 4194304
    buffer_load_dwordx4 v[156:159], v3, s[4:7], s22 offen offset:0 sc1
    s_waitcnt vmcnt(0)
    v_lshlrev_b32 v96, 16, v144
    v_and_b32 v97, 0xffff0000, v144
    v_lshlrev_b32 v98, 16, v145
    v_and_b32 v99, 0xffff0000, v145
    v_lshlrev_b32 v100, 16, v146
    v_and_b32 v101, 0xffff0000, v146
    v_lshlrev_b32 v102, 16, v147
    v_and_b32 v103, 0xffff0000, v147
    v_lshlrev_b32 v120, 16, v148
    v_and_b32 v121, 0xffff0000, v148
    v_lshlrev_b32 v122, 16, v149
    v_and_b32 v123, 0xffff0000, v149
    v_lshlrev_b32 v124, 16, v150
    v_and_b32 v125, 0xffff0000, v150
    v_lshlrev_b32 v126, 16, v151
    v_and_b32 v127, 0xffff0000, v151
    v_add_f32 v96, v96, v120
    v_add_f32 v97, v97, v121
    v_add_f32 v98, v98, v122
    v_add_f32 v99, v99, v123
    v_add_f32 v100, v100, v124
    v_add_f32 v101, v101, v125
    v_add_f32 v102, v102, v126
    v_add_f32 v103, v103, v127
    v_lshlrev_b32 v120, 16, v152
    v_and_b32 v121, 0xffff0000, v152
    v_lshlrev_b32 v122, 16, v153
    v_and_b32 v123, 0xffff0000, v153
    v_lshlrev_b32 v124, 16, v154
    v_and_b32 v125, 0xffff0000, v154
    v_lshlrev_b32 v126, 16, v155
    v_and_b32 v127, 0xffff0000, v155
    v_add_f32 v96, v96, v120
    v_add_f32 v97, v97, v121
    v_add_f32 v98, v98, v122
    v_add_f32 v99, v99, v123
    v_add_f32 v100, v100, v124
    v_add_f32 v101, v101, v125
    v_add_f32 v102, v102, v126
    v_add_f32 v103, v103, v127
    v_lshlrev_b32 v120, 16, v156
    v_and_b32 v121, 0xffff0000, v156
    v_lshlrev_b32 v122, 16, v157
    v_and_b32 v123, 0xffff0000, v157
    v_lshlrev_b32 v124, 16, v158
    v_and_b32 v125, 0xffff0000, v158
    v_lshlrev_b32 v126, 16, v159
    v_and_b32 v127, 0xffff0000, v159
    v_add_f32 v96, v96, v120
    v_add_f32 v97, v97, v121
    v_add_f32 v98, v98, v122
    v_add_f32 v99, v99, v123
    v_add_f32 v100, v100, v124
    v_add_f32 v101, v101, v125
    v_add_f32 v102, v102, v126
    v_add_f32 v103, v103, v127
    v_cvt_pk_bf16_f32 v120, v96, v97
    v_cvt_pk_bf16_f32 v121, v98, v99
    v_cvt_pk_bf16_f32 v122, v100, v101
    v_cvt_pk_bf16_f32 v123, v102, v103
    v_lshlrev_b32 v96, 16, v120
    v_and_b32 v97, 0xffff0000, v120
    v_lshlrev_b32 v98, 16, v121
    v_and_b32 v99, 0xffff0000, v121
    v_lshlrev_b32 v100, 16, v122
    v_and_b32 v101, 0xffff0000, v122
    v_lshlrev_b32 v102, 16, v123
    v_and_b32 v103, 0xffff0000, v123
    v_mul_f32 v104, 0xbfb8aa3b, v96
    v_mul_f32 v105, 0xbfb8aa3b, v97
    v_mul_f32 v106, 0xbfb8aa3b, v98
    v_mul_f32 v107, 0xbfb8aa3b, v99
    v_mul_f32 v108, 0xbfb8aa3b, v100
    v_mul_f32 v109, 0xbfb8aa3b, v101
    v_mul_f32 v110, 0xbfb8aa3b, v102
    v_mul_f32 v111, 0xbfb8aa3b, v103
    v_exp_f32 v104, v104
    v_exp_f32 v105, v105
    v_exp_f32 v106, v106
    v_exp_f32 v107, v107
    v_exp_f32 v108, v108
    v_exp_f32 v109, v109
    v_exp_f32 v110, v110
    v_exp_f32 v111, v111
    v_add_f32 v104, 1.0, v104
    v_add_f32 v105, 1.0, v105
    v_add_f32 v106, 1.0, v106
    v_add_f32 v107, 1.0, v107
    v_add_f32 v108, 1.0, v108
    v_add_f32 v109, 1.0, v109
    v_add_f32 v110, 1.0, v110
    v_add_f32 v111, 1.0, v111
    v_rcp_f32 v104, v104
    v_rcp_f32 v105, v105
    v_rcp_f32 v106, v106
    v_rcp_f32 v107, v107
    v_rcp_f32 v108, v108
    v_rcp_f32 v109, v109
    v_rcp_f32 v110, v110
    v_rcp_f32 v111, v111
    v_mul_f32 v96, v96, v104
    v_mul_f32 v97, v97, v105
    v_mul_f32 v98, v98, v106
    v_mul_f32 v99, v99, v107
    v_mul_f32 v100, v100, v108
    v_mul_f32 v101, v101, v109
    v_mul_f32 v102, v102, v110
    v_mul_f32 v103, v103, v111
    v_cvt_pk_bf16_f32 v80, v96, v97
    v_cvt_pk_bf16_f32 v81, v98, v99
    v_cvt_pk_bf16_f32 v82, v100, v101
    v_cvt_pk_bf16_f32 v83, v102, v103
    s_cmp_eq_u32 s24, 63
    s_cbranch_scc1 ft_p63
ft_p:
    buffer_load_dword v7, v8, s[4:7], s23 offen offset:1020 sc1
    s_waitcnt vmcnt(0)
    v_cmp_eq_u32 vcc, -1, v7
    s_cbranch_vccz ft_l
    s_sleep 4
    s_sub_u32 s28, s28, 1
    s_cbranch_scc0 ft_p
    s_mov_b32 s28, 0
ft_l:
    s_mov_b32 s31, s23
    buffer_load_dwordx4 v[16:19], v3, s[4:7], s31 offen sc1
    s_add_u32 s31, s31, 4194304
    buffer_load_dwordx4 v[20:23], v3, s[4:7], s31 offen sc1
    s_add_u32 s31, s31, 4194304
    buffer_load_dwordx4 v[24:27], v3, s[4:7], s31 offen sc1
    s_add_u32 s31, s31, 4194304
    buffer_load_dwordx4 v[28:31], v3, s[4:7], s31 offen sc1
    s_add_u32 s31, s31, 4194304
    buffer_load_dwordx4 v[32:35], v3, s[4:7], s31 offen sc1
    s_add_u32 s31, s31, 4194304
    buffer_load_dwordx4 v[36:39], v3, s[4:7], s31 offen sc1
    s_add_u32 s31, s31, 4194304
    buffer_load_dwordx4 v[40:43], v3, s[4:7], s31 offen sc1
    s_add_u32 s31, s31, 4194304
    buffer_load_dwordx4 v[44:47], v3, s[4:7], s31 offen sc1
    s_waitcnt vmcnt(0)
    v_max3_u32 v7, v16, v17, v18
    v_max3_u32 v7, v7, v19, v20
    v_max3_u32 v7, v7, v21, v22
    v_max3_u32 v7, v7, v23, v24
    v_max3_u32 v7, v7, v25, v26
    v_max3_u32 v7, v7, v27, v28
    v_max3_u32 v7, v7, v29, v30
    v_max3_u32 v7, v7, v31, v32
    v_max3_u32 v7, v7, v33, v34
    v_max3_u32 v7, v7, v35, v36
    v_max3_u32 v7, v7, v37, v38
    v_max3_u32 v7, v7, v39, v40
    v_max3_u32 v7, v7, v41, v42
    v_max3_u32 v7, v7, v43, v44
    v_max3_u32 v7, v7, v45, v46
    v_max_u32 v7, v7, v47
    v_cmp_eq_u32 vcc, -1, v7
    s_cbranch_vccz ft_go
    s_sleep 2
    s_sub_u32 s28, s28, 1
    s_cbranch_scc0 ft_l
    s_branch ft_go
ft_p63:
    s_sub_u32 s31, s23, 65536
    buffer_load_dword v7, v8, s[4:7], s31 offen offset:1020 sc1
    s_waitcnt vmcnt(0)
    v_cmp_eq_u32 vcc, -1, v7
    s_cbranch_vccz ft_l
    s_sleep 4
    s_sub_u32 s28, s28, 1
    s_cbranch_scc0 ft_p63
    s_mov_b32 s28, 0
    s_branch ft_l
ft_go:
    v_lshlrev_b32 v96, 16, v16
    v_and_b32 v97, 0xffff0000, v16
    v_lshlrev_b32 v98, 16, v17
    v_and_b32 v99, 0xffff0000, v17
    v_lshlrev_b32 v100, 16, v18
    v_and_b32 v101, 0xffff0000, v18
    v_lshlrev_b32 v102, 16, v19
    v_and_b32 v103, 0xffff0000, v19
    v_lshlrev_b32 v120, 16, v20
    v_and_b32 v121, 0xffff0000, v20
    v_lshlrev_b32 v122, 16, v21
    v_and_b32 v123, 0xffff0000, v21
    v_lshlrev_b32 v124, 16, v22
    v_and_b32 v125, 0xffff0000, v22
    v_lshlrev_b32 v126, 16, v23
    v_and_b32 v127, 0xffff0000, v23
    v_add_f32 v96, v96, v120
    v_add_f32 v97, v97, v121
    v_add_f32 v98, v98, v122
    v_add_f32 v99, v99, v123
    v_add_f32 v100, v100, v124
    v_add_f32 v101, v101, v125
    v_add_f32 v102, v102, v126
    v_add_f32 v103, v103, v127
    v_lshlrev_b32 v120, 16, v24
    v_and_b32 v121, 0xffff0000, v24
    v_lshlrev_b32 v122, 16, v25
    v_and_b32 v123, 0xffff0000, v25
    v_lshlrev_b32 v124, 16, v26
    v_and_b32 v125, 0xffff0000, v26
    v_lshlrev_b32 v126, 16, v27
    v_and_b32 v127, 0xffff0000, v27
    v_add_f32 v96, v96, v120
    v_add_f32 v97, v97, v121
    v_add_f32 v98, v98, v122
    v_add_f32 v99, v99, v123
    v_add_f32 v100, v100, v124
    v_add_f32 v101, v101, v125
    v_add_f32 v102, v102, v126
    v_add_f32 v103, v103, v127
    v_lshlrev_b32 v120, 16, v28
    v_and_b32 v121, 0xffff0000, v28
    v_lshlrev_b32 v122, 16, v29
    v_and_b32 v123, 0xffff0000, v29
    v_lshlrev_b32 v124, 16, v30
    v_and_b32 v125, 0xffff0000, v30
    v_lshlrev_b32 v126, 16, v31
    v_and_b32 v127, 0xffff0000, v31
    v_add_f32 v96, v96, v120
    v_add_f32 v97, v97, v121
    v_add_f32 v98, v98, v122
    v_add_f32 v99, v99, v123
    v_add_f32 v100, v100, v124
    v_add_f32 v101, v101, v125
    v_add_f32 v102, v102, v126
    v_add_f32 v103, v103, v127
    v_lshlrev_b32 v120, 16, v32
    v_and_b32 v121, 0xffff0000, v32
    v_lshlrev_b32 v122, 16, v33
    v_and_b32 v123, 0xffff0000, v33
    v_lshlrev_b32 v124, 16, v34
    v_and_b32 v125, 0xffff0000, v34
    v_lshlrev_b32 v126, 16, v35
    v_and_b32 v127, 0xffff0000, v35
    v_add_f32 v96, v96, v120
    v_add_f32 v97, v97, v121
    v_add_f32 v98, v98, v122
    v_add_f32 v99, v99, v123
    v_add_f32 v100, v100, v124
    v_add_f32 v101, v101, v125
    v_add_f32 v102, v102, v126
    v_add_f32 v103, v103, v127
    v_lshlrev_b32 v120, 16, v36
    v_and_b32 v121, 0xffff0000, v36
    v_lshlrev_b32 v122, 16, v37
    v_and_b32 v123, 0xffff0000, v37
    v_lshlrev_b32 v124, 16, v38
    v_and_b32 v125, 0xffff0000, v38
    v_lshlrev_b32 v126, 16, v39
    v_and_b32 v127, 0xffff0000, v39
    v_add_f32 v96, v96, v120
    v_add_f32 v97, v97, v121
    v_add_f32 v98, v98, v122
    v_add_f32 v99, v99, v123
    v_add_f32 v100, v100, v124
    v_add_f32 v101, v101, v125
    v_add_f32 v102, v102, v126
    v_add_f32 v103, v103, v127
    v_lshlrev_b32 v120, 16, v40
    v_and_b32 v121, 0xffff0000, v40
    v_lshlrev_b32 v122, 16, v41
    v_and_b32 v123, 0xffff0000, v41
    v_lshlrev_b32 v124, 16, v42
    v_and_b32 v125, 0xffff0000, v42
    v_lshlrev_b32 v126, 16, v43
    v_and_b32 v127, 0xffff0000, v43
    v_add_f32 v96, v96, v120
    v_add_f32 v97, v97, v121
    v_add_f32 v98, v98, v122
    v_add_f32 v99, v99, v123
    v_add_f32 v100, v100, v124
    v_add_f32 v101, v101, v125
    v_add_f32 v102, v102, v126
    v_add_f32 v103, v103, v127
    v_lshlrev_b32 v120, 16, v44
    v_and_b32 v121, 0xffff0000, v44
    v_lshlrev_b32 v122, 16, v45
    v_and_b32 v123, 0xffff0000, v45
    v_lshlrev_b32 v124, 16, v46
    v_and_b32 v125, 0xffff0000, v46
    v_lshlrev_b32 v126, 16, v47
    v_and_b32 v127, 0xffff0000, v47
    v_add_f32 v96, v96, v120
    v_add_f32 v97, v97, v121
    v_add_f32 v98, v98, v122
    v_add_f32 v99, v99, v123
    v_add_f32 v100, v100, v124
    v_add_f32 v101, v101, v125
    v_add_f32 v102, v102, v126
    v_add_f32 v103, v103, v127
    v_cndmask_b32 v108, v88, v90, s[20:21]
    v_cndmask_b32 v109, v89, v91, s[20:21]
    v_cndmask_b32 v110, v90, v88, s[20:21]
    v_cndmask_b32 v111, v91, v89, s[20:21]
    v_cvt_pk_bf16_f32 v104, v96, v97
    v_lshlrev_b32 v96, 16, v104
    v_and_b32 v97, 0xffff0000, v104
    v_lshlrev_b32 v104, 16, v80
    v_and_b32 v105, 0xffff0000, v80
    v_mul_f32 v96, v96, v104
    v_mul_f32 v97, v97, v105
    v_cvt_pk_bf16_f32 v104, v96, v97
    v_lshlrev_b32 v96, 16, v104
    v_and_b32 v97, 0xffff0000, v104
    v_lshlrev_b32 v104, 16, v108
    v_and_b32 v105, 0xffff0000, v108
    v_add_f32 v96, v96, v104
    v_add_f32 v97, v97, v105
    v_cvt_pk_bf16_f32 v112, v96, v97
    v_cvt_pk_bf16_f32 v104, v98, v99
    v_lshlrev_b32 v98, 16, v104
    v_and_b32 v99, 0xffff0000, v104
    v_lshlrev_b32 v104, 16, v81
    v_and_b32 v105, 0xffff0000, v81
    v_mul_f32 v98, v98, v104
    v_mul_f32 v99, v99, v105
    v_cvt_pk_bf16_f32 v104, v98, v99
    v_lshlrev_b32 v98, 16, v104
    v_and_b32 v99, 0xffff0000, v104
    v_lshlrev_b32 v104, 16, v109
    v_and_b32 v105, 0xffff0000, v109
    v_add_f32 v98, v98, v104
    v_add_f32 v99, v99, v105
    v_cvt_pk_bf16_f32 v113, v98, v99
    v_cvt_pk_bf16_f32 v104, v100, v101
    v_lshlrev_b32 v100, 16, v104
    v_and_b32 v101, 0xffff0000, v104
    v_lshlrev_b32 v104, 16, v82
    v_and_b32 v105, 0xffff0000, v82
    v_mul_f32 v100, v100, v104
    v_mul_f32 v101, v101, v105
    v_cvt_pk_bf16_f32 v104, v100, v101
    v_lshlrev_b32 v100, 16, v104
    v_and_b32 v101, 0xffff0000, v104
    v_lshlrev_b32 v104, 16, v110
    v_and_b32 v105, 0xffff0000, v110
    v_add_f32 v100, v100, v104
    v_add_f32 v101, v101, v105
    v_cvt_pk_bf16_f32 v114, v100, v101
    v_cvt_pk_bf16_f32 v104, v102, v103
    v_lshlrev_b32 v102, 16, v104
    v_and_b32 v103, 0xffff0000, v104
    v_lshlrev_b32 v104, 16, v83
    v_and_b32 v105, 0xffff0000, v83
    v_mul_f32 v102, v102, v104
    v_mul_f32 v103, v103, v105
    v_cvt_pk_bf16_f32 v104, v102, v103
    v_lshlrev_b32 v102, 16, v104
    v_and_b32 v103, 0xffff0000, v104
    v_lshlrev_b32 v104, 16, v111
    v_and_b32 v105, 0xffff0000, v111
    v_add_f32 v102, v102, v104
    v_add_f32 v103, v103, v105
    v_cvt_pk_bf16_f32 v115, v102, v103
    v_cndmask_b32 v128, v112, v114, s[20:21]
    v_cndmask_b32 v129, v113, v115, s[20:21]
    v_cndmask_b32 v130, v114, v112, s[20:21]
    v_cndmask_b32 v131, v115, v113, s[20:21]
    buffer_store_dwordx4 v[128:131], v4, s[12:15], s18 offen offset:0
    s_branch k_end
chain_map:
    s_and_b32 s14, s12, 1
    s_lshl_b32 s13, s13, 1
    s_lshr_b32 s15, s12, 1
    s_add_u32 s12, s13, s14
    s_mov_b32 s13, s15
    s_lshl_b32 s2, s13, 3
    s_add_u32 s2, s2, s12
    s_lshr_b32 s14, s13, 2
    s_and_b32 s15, s13, 3
    s_mov_b32 s16, 0
    s_mov_b32 s17, 209715200
    s_mov_b32 s18, 209977344
    s_mov_b32 s19, 210239488
    s_mov_b32 s20, 210501632
    s_mov_b32 s26, 131072
    s_mov_b32 s68, 0
    s_getreg_b32 s29, hwreg(HW_REG_XCC_ID)
    s_and_b32 s29, s29, 15
    s_mul_i32 s23, s29, s29
    s_lshl_b32 s23, s23, 18
    s_lshl_b32 s29, s29, 8
    s_add_u32 s29, s29, s23
    s_add_u32 s29, s29, 1
    s_lshr_b32 s28, s12, 1
    s_lshl_b32 s28, s28, 2
    s_add_u32 s28, s28, 128
    s_cmp_ge_u32 s3, 4
    s_cbranch_scc1 ch_a_pro
    s_lshl_b32 s32, s12, 15
    s_lshl_b32 s21, s14, 13
    s_add_u32 s32, s32, s21
    s_lshl_b32 s21, s15, 10
    s_add_u32 s32, s32, s21
    s_add_u32 s32, s32, 2097152
    s_lshr_b32 s33, s12, 1
    s_lshl_b32 s33, s33, 14
    s_add_u32 s33, s33, 1048576
    s_lshl_b32 s21, s13, 10
    s_add_u32 s36, s33, s21
    s_lshl_b32 s21, s3, 12
    s_add_u32 s33, s33, s21
    s_lshl_b32 s34, s13, 14
    s_lshl_b32 s21, s12, 10
    s_add_u32 s35, s34, s21
    s_lshl_b32 s37, s12, 22
    s_lshl_b32 s21, s13, 11
    s_add_u32 s37, s37, s21
    s_and_b32 s21, s3, 1
    s_lshl_b32 s21, s21, 15
    s_add_u32 s37, s37, s21
    s_lshr_b32 s21, s3, 1
    s_lshl_b32 s21, s21, 10
    s_add_u32 s37, s37, s21
    s_add_u32 s37, s37, 75497472
    v_and_b32 v20, 63, v0
    v_lshlrev_b32 v1, 4, v20
    v_mov_b32 v10, -1
    v_mov_b32 v11, -1
    v_lshrrev_b32 v21, 2, v20
    v_and_b32 v22, 3, v20
    v_lshlrev_b32 v21, 13, v21
    v_lshl_add_u32 v21, v22, 4, v21
    s_lshl_b32 s21, s3, 21
    s_lshl_b32 s22, s12, 10
    s_add_u32 s21, s21, s22
    s_lshl_b32 s23, s3, 15
    s_mov_b32 s10, 8388608
    s_mov_b32 s11, 131072
    v_lshrrev_b32 v24, 4, v20
    v_bfe_u32 v25, v20, 2, 2
    v_lshl_add_u32 v24, v24, 4, v25
    v_lshlrev_b32 v24, 6, v24
    v_lshl_add_u32 v24, v22, 3, v24
    v_add_u32 v24, s23, v24
    s_and_b32 s70, s13, 1
    s_lshl_b32 s71, s12, 4
    s_add_u32 s71, s71, s13
    s_cmp_eq_u32 s71, 127
    s_cselect_b32 s70, 1, 0
    s_cmp_eq_u32 s13, 7
    s_cselect_b32 s70, 1, s70
    s_lshl_b32 s72, s70, 20
    s_lshl_b32 s73, s70, 21
    s_lshl_b32 s70, s70, 13
    s_sub_u32 s71, s23, s70
    s_add_u32 s70, s23, s70
    s_load_dwordx2 s[8:9], s[0:1], 16
    s_lshl_b32 s25, s13, 6
    s_add_u32 s24, s21, s25
    s_add_u32 s24, s24, s72
    s_waitcnt lgkmcnt(0)
    s_add_u32 m0, s70, 0
    s_nop 0
    buffer_load_dwordx4 v21, s[8:11], s24 offen lds
    s_add_u32 s24, s24, 131072
    s_add_u32 m0, s70, 1024
    s_nop 0
    buffer_load_dwordx4 v21, s[8:11], s24 offen lds
    s_add_u32 s24, s24, 131072
    s_add_u32 m0, s70, 2048
    s_nop 0
    buffer_load_dwordx4 v21, s[8:11], s24 offen lds
    s_add_u32 s24, s24, 131072
    s_add_u32 m0, s70, 3072
    s_nop 0
    buffer_load_dwordx4 v21, s[8:11], s24 offen lds
    s_add_u32 s24, s24, 131072
    s_add_u32 m0, s70, 4096
    s_nop 0
    buffer_load_dwordx4 v21, s[8:11], s24 offen lds
    s_add_u32 s24, s24, 131072
    s_add_u32 m0, s70, 5120
    s_nop 0
    buffer_load_dwordx4 v21, s[8:11], s24 offen lds
    s_add_u32 s24, s24, 131072
    s_add_u32 m0, s70, 6144
    s_nop 0
    buffer_load_dwordx4 v21, s[8:11], s24 offen lds
    s_add_u32 s24, s24, 131072
    s_add_u32 m0, s70, 7168
    s_nop 0
    buffer_load_dwordx4 v21, s[8:11], s24 offen lds
    s_add_u32 s24, s24, 131072
    s_sub_u32 s24, s24, s73
    s_add_u32 m0, s71, 8192
    s_nop 0
    buffer_load_dwordx4 v21, s[8:11], s24 offen lds
    s_add_u32 s24, s24, 131072
    s_add_u32 m0, s71, 9216
    s_nop 0
    buffer_load_dwordx4 v21, s[8:11], s24 offen lds
    s_add_u32 s24, s24, 131072
    s_add_u32 m0, s71, 10240
    s_nop 0
    buffer_load_dwordx4 v21, s[8:11], s24 offen lds
    s_add_u32 s24, s24, 131072
    s_add_u32 m0, s71, 11264
    s_nop 0
    buffer_load_dwordx4 v21, s[8:11], s24 offen lds
    s_add_u32 s24, s24, 131072
    s_add_u32 m0, s71, 12288
    s_nop 0
    buffer_load_dwordx4 v21, s[8:11], s24 offen lds
    s_add_u32 s24, s24, 131072
    s_add_u32 m0, s71, 13312
    s_nop 0
    buffer_load_dwordx4 v21, s[8:11], s24 offen lds
    s_add_u32 s24, s24, 131072
    s_add_u32 m0, s71, 14336
    s_nop 0
    buffer_load_dwordx4 v21, s[8:11], s24 offen lds
    s_add_u32 s24, s24, 131072
    s_add_u32 m0, s71, 15360
    s_nop 0
    buffer_load_dwordx4 v21, s[8:11], s24 offen lds
    s_add_u32 s24, s24, 131072
    s_load_dwordx2 s[8:9], s[0:1], 24
    s_lshl_b32 s25, s13, 6
    s_add_u32 s24, s21, s25
    s_add_u32 s24, s24, s72
    s_waitcnt lgkmcnt(0)
    s_add_u32 m0, s70, 16384
    s_nop 0
    buffer_load_dwordx4 v21, s[8:11], s24 offen lds
    s_add_u32 s24, s24, 131072
    s_add_u32 m0, s70, 17408
    s_nop 0
    buffer_load_dwordx4 v21, s[8:11], s24 offen lds
    s_add_u32 s24, s24, 131072
    s_add_u32 m0, s70, 18432
    s_nop 0
    buffer_load_dwordx4 v21, s[8:11], s24 offen lds
    s_add_u32 s24, s24, 131072
    s_add_u32 m0, s70, 19456
    s_nop 0
    buffer_load_dwordx4 v21, s[8:11], s24 offen lds
    s_add_u32 s24, s24, 131072
    s_add_u32 m0, s70, 20480
    s_nop 0
    buffer_load_dwordx4 v21, s[8:11], s24 offen lds
    s_add_u32 s24, s24, 131072
    s_add_u32 m0, s70, 21504
    s_nop 0
    buffer_load_dwordx4 v21, s[8:11], s24 offen lds
    s_add_u32 s24, s24, 131072
    s_add_u32 m0, s70, 22528
    s_nop 0
    buffer_load_dwordx4 v21, s[8:11], s24 offen lds
    s_add_u32 s24, s24, 131072
    s_add_u32 m0, s70, 23552
    s_nop 0
    buffer_load_dwordx4 v21, s[8:11], s24 offen lds
    s_add_u32 s24, s24, 131072
    s_sub_u32 s24, s24, s73
    s_add_u32 m0, s71, 24576
    s_nop 0
    buffer_load_dwordx4 v21, s[8:11], s24 offen lds
    s_add_u32 s24, s24, 131072
    s_add_u32 m0, s71, 25600
    s_nop 0
    buffer_load_dwordx4 v21, s[8:11], s24 offen lds
    s_add_u32 s24, s24, 131072
    s_add_u32 m0, s71, 26624
    s_nop 0
    buffer_load_dwordx4 v21, s[8:11], s24 offen lds
    s_add_u32 s24, s24, 131072
    s_add_u32 m0, s71, 27648
    s_nop 0
    buffer_load_dwordx4 v21, s[8:11], s24 offen lds
    s_add_u32 s24, s24, 131072
    s_add_u32 m0, s71, 28672
    s_nop 0
    buffer_load_dwordx4 v21, s[8:11], s24 offen lds
    s_add_u32 s24, s24, 131072
    s_add_u32 m0, s71, 29696
    s_nop 0
    buffer_load_dwordx4 v21, s[8:11], s24 offen lds
    s_add_u32 s24, s24, 131072
    s_add_u32 m0, s71, 30720
    s_nop 0
    buffer_load_dwordx4 v21, s[8:11], s24 offen lds
    s_add_u32 s24, s24, 131072
    s_add_u32 m0, s71, 31744
    s_nop 0
    buffer_load_dwordx4 v21, s[8:11], s24 offen lds
    s_add_u32 s24, s24, 131072
    s_load_dwordx2 s[8:9], s[0:1], 32
    s_lshl_b32 s25, s13, 6
    s_add_u32 s24, s21, s25
    s_add_u32 s24, s24, s72
    s_waitcnt lgkmcnt(0)
    buffer_load_dwordx4 v[96:99], v21, s[8:11], s24 offen
    s_add_u32 s24, s24, 131072
    buffer_load_dwordx4 v[100:103], v21, s[8:11], s24 offen
    s_add_u32 s24, s24, 131072
    buffer_load_dwordx4 v[104:107], v21, s[8:11], s24 offen
    s_add_u32 s24, s24, 131072
    buffer_load_dwordx4 v[108:111], v21, s[8:11], s24 offen
    s_add_u32 s24, s24, 131072
    buffer_load_dwordx4 v[144:147], v21, s[8:11], s24 offen
    s_add_u32 s24, s24, 131072
    buffer_load_dwordx4 v[148:151], v21, s[8:11], s24 offen
    s_add_u32 s24, s24, 131072
    buffer_load_dwordx4 v[152:155], v21, s[8:11], s24 offen
    s_add_u32 s24, s24, 131072
    buffer_load_dwordx4 v[156:159], v21, s[8:11], s24 offen
    s_add_u32 s24, s24, 131072
    s_sub_u32 s24, s24, s73
    buffer_load_dwordx4 v[192:195], v21, s[8:11], s24 offen
    s_add_u32 s24, s24, 131072
    buffer_load_dwordx4 v[196:199], v21, s[8:11], s24 offen
    s_add_u32 s24, s24, 131072
    buffer_load_dwordx4 v[200:203], v21, s[8:11], s24 offen
    s_add_u32 s24, s24, 131072
    buffer_load_dwordx4 v[204:207], v21, s[8:11], s24 offen
    s_add_u32 s24, s24, 131072
    buffer_load_dwordx4 v[240:243], v21, s[8:11], s24 offen
    s_add_u32 s24, s24, 131072
    buffer_load_dwordx4 v[244:247], v21, s[8:11], s24 offen
    s_add_u32 s24, s24, 131072
    buffer_load_dwordx4 v[248:251], v21, s[8:11], s24 offen
    s_add_u32 s24, s24, 131072
    buffer_load_dwordx4 v[252:255], v21, s[8:11], s24 offen
    s_add_u32 s24, s24, 131072
    s_load_dwordx2 s[8:9], s[0:1], 8
    s_mov_b32 s10, 16384
    v_bfe_u32 v57, v20, 4, 1
    v_lshrrev_b32 v58, 5, v20
    v_and_b32 v59, 1, v20
    v_bfe_u32 v60, v20, 1, 3
    v_lshlrev_b32 v60, 11, v60
    v_lshl_add_u32 v60, v57, 6, v60
    v_lshl_add_u32 v60, v58, 4, v60
    v_lshl_add_u32 v15, v59, 2, v60
    s_lshl_b32 s24, s3, 9
    s_waitcnt lgkmcnt(0)
    buffer_load_dword v32, v15, s[8:11], s24 offen offset:0
    buffer_load_dword v33, v15, s[8:11], s24 offen offset:8
    buffer_load_dword v34, v15, s[8:11], s24 offen offset:32
    buffer_load_dword v35, v15, s[8:11], s24 offen offset:40
    buffer_load_dword v36, v15, s[8:11], s24 offen offset:128
    buffer_load_dword v37, v15, s[8:11], s24 offen offset:136
    buffer_load_dword v38, v15, s[8:11], s24 offen offset:160
    buffer_load_dword v39, v15, s[8:11], s24 offen offset:168
    buffer_load_dword v40, v15, s[8:11], s24 offen offset:256
    buffer_load_dword v41, v15, s[8:11], s24 offen offset:264
    buffer_load_dword v42, v15, s[8:11], s24 offen offset:288
    buffer_load_dword v43, v15, s[8:11], s24 offen offset:296
    buffer_load_dword v44, v15, s[8:11], s24 offen offset:384
    buffer_load_dword v45, v15, s[8:11], s24 offen offset:392
    buffer_load_dword v46, v15, s[8:11], s24 offen offset:416
    buffer_load_dword v47, v15, s[8:11], s24 offen offset:424
    s_barrier
    v_add_u32 v56, s70, v1
    s_add_u32 s71, s71, 8192
    v_add_u32 v26, s71, v1
    s_waitcnt vmcnt(48)
    ds_read_b64_tr_b16 v[64:65], v24 offset:0
    ds_read_b64_tr_b16 v[66:67], v24 offset:256
    ds_read_b64_tr_b16 v[68:69], v24 offset:512
    ds_read_b64_tr_b16 v[70:71], v24 offset:768
    ds_read_b64_tr_b16 v[72:73], v24 offset:32
    ds_read_b64_tr_b16 v[74:75], v24 offset:288
    ds_read_b64_tr_b16 v[76:77], v24 offset:544
    ds_read_b64_tr_b16 v[78:79], v24 offset:800
    s_waitcnt lgkmcnt(0)
    ds_read_b64_tr_b16 v[112:113], v24 offset:4096
    ds_read_b64_tr_b16 v[114:115], v24 offset:4352
    ds_read_b64_tr_b16 v[116:117], v24 offset:4608
    ds_read_b64_tr_b16 v[118:119], v24 offset:4864
    ds_read_b64_tr_b16 v[120:121], v24 offset:4128
    ds_read_b64_tr_b16 v[122:123], v24 offset:4384
    ds_read_b64_tr_b16 v[124:125], v24 offset:4640
    ds_read_b64_tr_b16 v[126:127], v24 offset:4896
    s_waitcnt lgkmcnt(0)
    ds_read_b64_tr_b16 v[160:161], v24 offset:8192
    ds_read_b64_tr_b16 v[162:163], v24 offset:8448
    ds_read_b64_tr_b16 v[164:165], v24 offset:8704
    ds_read_b64_tr_b16 v[166:167], v24 offset:8960
    ds_read_b64_tr_b16 v[168:169], v24 offset:8224
    ds_read_b64_tr_b16 v[170:171], v24 offset:8480
    ds_read_b64_tr_b16 v[172:173], v24 offset:8736
    ds_read_b64_tr_b16 v[174:175], v24 offset:8992
    s_waitcnt lgkmcnt(0)
    ds_read_b64_tr_b16 v[208:209], v24 offset:12288
    ds_read_b64_tr_b16 v[210:211], v24 offset:12544
    ds_read_b64_tr_b16 v[212:213], v24 offset:12800
    ds_read_b64_tr_b16 v[214:215], v24 offset:13056
    ds_read_b64_tr_b16 v[216:217], v24 offset:12320
    ds_read_b64_tr_b16 v[218:219], v24 offset:12576
    ds_read_b64_tr_b16 v[220:221], v24 offset:12832
    ds_read_b64_tr_b16 v[222:223], v24 offset:13088
    s_waitcnt lgkmcnt(0)
    s_waitcnt vmcnt(32)
    ds_read_b64_tr_b16 v[80:81], v24 offset:16384
    ds_read_b64_tr_b16 v[82:83], v24 offset:16640
    ds_read_b64_tr_b16 v[84:85], v24 offset:16896
    ds_read_b64_tr_b16 v[86:87], v24 offset:17152
    ds_read_b64_tr_b16 v[88:89], v24 offset:16416
    ds_read_b64_tr_b16 v[90:91], v24 offset:16672
    ds_read_b64_tr_b16 v[92:93], v24 offset:16928
    ds_read_b64_tr_b16 v[94:95], v24 offset:17184
    s_waitcnt lgkmcnt(0)
    ds_read_b64_tr_b16 v[128:129], v24 offset:20480
    ds_read_b64_tr_b16 v[130:131], v24 offset:20736
    ds_read_b64_tr_b16 v[132:133], v24 offset:20992
    ds_read_b64_tr_b16 v[134:135], v24 offset:21248
    ds_read_b64_tr_b16 v[136:137], v24 offset:20512
    ds_read_b64_tr_b16 v[138:139], v24 offset:20768
    ds_read_b64_tr_b16 v[140:141], v24 offset:21024
    ds_read_b64_tr_b16 v[142:143], v24 offset:21280
    s_waitcnt lgkmcnt(0)
    ds_read_b64_tr_b16 v[176:177], v24 offset:24576
    ds_read_b64_tr_b16 v[178:179], v24 offset:24832
    ds_read_b64_tr_b16 v[180:181], v24 offset:25088
    ds_read_b64_tr_b16 v[182:183], v24 offset:25344
    ds_read_b64_tr_b16 v[184:185], v24 offset:24608
    ds_read_b64_tr_b16 v[186:187], v24 offset:24864
    ds_read_b64_tr_b16 v[188:189], v24 offset:25120
    ds_read_b64_tr_b16 v[190:191], v24 offset:25376
    s_waitcnt lgkmcnt(0)
    ds_read_b64_tr_b16 v[224:225], v24 offset:28672
    ds_read_b64_tr_b16 v[226:227], v24 offset:28928
    ds_read_b64_tr_b16 v[228:229], v24 offset:29184
    ds_read_b64_tr_b16 v[230:231], v24 offset:29440
    ds_read_b64_tr_b16 v[232:233], v24 offset:28704
    ds_read_b64_tr_b16 v[234:235], v24 offset:28960
    ds_read_b64_tr_b16 v[236:237], v24 offset:29216
    ds_read_b64_tr_b16 v[238:239], v24 offset:29472
    s_waitcnt lgkmcnt(0)
    s_waitcnt vmcnt(16)
    ds_write_b128 v56, v[96:99] offset:0
    ds_write_b128 v56, v[100:103] offset:1024
    ds_write_b128 v56, v[104:107] offset:2048
    ds_write_b128 v56, v[108:111] offset:3072
    ds_write_b128 v56, v[144:147] offset:4096
    ds_write_b128 v56, v[148:151] offset:5120
    ds_write_b128 v56, v[152:155] offset:6144
    ds_write_b128 v56, v[156:159] offset:7168
    ds_write_b128 v26, v[192:195] offset:0
    ds_write_b128 v26, v[196:199] offset:1024
    ds_write_b128 v26, v[200:203] offset:2048
    ds_write_b128 v26, v[204:207] offset:3072
    ds_write_b128 v26, v[240:243] offset:4096
    ds_write_b128 v26, v[244:247] offset:5120
    ds_write_b128 v26, v[248:251] offset:6144
    ds_write_b128 v26, v[252:255] offset:7168
    s_waitcnt lgkmcnt(0)
    ds_read_b64_tr_b16 v[96:97], v24 offset:0
    ds_read_b64_tr_b16 v[98:99], v24 offset:256
    ds_read_b64_tr_b16 v[100:101], v24 offset:512
    ds_read_b64_tr_b16 v[102:103], v24 offset:768
    ds_read_b64_tr_b16 v[104:105], v24 offset:32
    ds_read_b64_tr_b16 v[106:107], v24 offset:288
    ds_read_b64_tr_b16 v[108:109], v24 offset:544
    ds_read_b64_tr_b16 v[110:111], v24 offset:800
    s_waitcnt lgkmcnt(0)
    ds_read_b64_tr_b16 v[144:145], v24 offset:4096
    ds_read_b64_tr_b16 v[146:147], v24 offset:4352
    ds_read_b64_tr_b16 v[148:149], v24 offset:4608
    ds_read_b64_tr_b16 v[150:151], v24 offset:4864
    ds_read_b64_tr_b16 v[152:153], v24 offset:4128
    ds_read_b64_tr_b16 v[154:155], v24 offset:4384
    ds_read_b64_tr_b16 v[156:157], v24 offset:4640
    ds_read_b64_tr_b16 v[158:159], v24 offset:4896
    s_waitcnt lgkmcnt(0)
    ds_read_b64_tr_b16 v[192:193], v24 offset:8192
    ds_read_b64_tr_b16 v[194:195], v24 offset:8448
    ds_read_b64_tr_b16 v[196:197], v24 offset:8704
    ds_read_b64_tr_b16 v[198:199], v24 offset:8960
    ds_read_b64_tr_b16 v[200:201], v24 offset:8224
    ds_read_b64_tr_b16 v[202:203], v24 offset:8480
    ds_read_b64_tr_b16 v[204:205], v24 offset:8736
    ds_read_b64_tr_b16 v[206:207], v24 offset:8992
    s_waitcnt lgkmcnt(0)
    ds_read_b64_tr_b16 v[240:241], v24 offset:12288
    ds_read_b64_tr_b16 v[242:243], v24 offset:12544
    ds_read_b64_tr_b16 v[244:245], v24 offset:12800
    ds_read_b64_tr_b16 v[246:247], v24 offset:13056
    ds_read_b64_tr_b16 v[248:249], v24 offset:12320
    ds_read_b64_tr_b16 v[250:251], v24 offset:12576
    ds_read_b64_tr_b16 v[252:253], v24 offset:12832
    ds_read_b64_tr_b16 v[254:255], v24 offset:13088
    s_waitcnt lgkmcnt(0)
    v_mov_b32 v21, 0x44444444
    v_mov_b32 v22, 0xeeeeeeee
    v_and_b32 v23, 1, v20
    v_cmp_eq_u32 vcc, 0, v23
    v_and_b32 v27, 255, v0
    v_lshlrev_b32 v2, 2, v27
    v_cndmask_b32 v62, v22, v21, vcc
    s_lshr_b32 s21, s15, 1
    s_sub_u32 s21, s21, s15
    s_add_u32 s21, s21, 4
    s_lshl_b32 s21, s21, 10
    s_and_b32 s22, s15, 1
    s_lshl_b32 s22, s22, 9
    s_add_u32 s21, s21, s22
    s_lshl_b32 s22, s3, 7
    s_add_u32 s21, s21, s22
    v_and_b32 v21, 31, v20
    v_lshlrev_b32 v21, 2, v21
    v_add_u32 v3, s21, v21
    v_lshrrev_b32 v21, 4, v20
    v_and_b32 v22, 15, v20
    v_mul_u32_u24 v21, 208, v21
    v_add_lshl_u32 v21, v21, v22, 2
    s_mul_i32 s21, s3, 3328
    v_add_u32 v4, s21, v21
    v_lshrrev_b32 v21, 4, v20
    v_bfe_u32 v22, v20, 2, 1
    v_lshl_add_u32 v21, v21, 1, v22
    v_mul_u32_u24 v21, 104, v21
    v_bfe_u32 v22, v20, 3, 1
    v_xor_b32 v22, 1, v22
    v_lshl_add_u32 v21, v22, 5, v21
    v_and_b32 v22, 3, v20
    v_lshlrev_b32 v22, 1, v22
    s_and_b32 s21, s3, 1
    s_lshl_b32 s21, s21, 2
    v_xor_b32 v22, s21, v22
    v_add_u32 v21, v21, v22
    s_lshl_b32 s21, s3, 3
    v_add_u32 v21, s21, v21
    v_lshlrev_b32 v5, 2, v21
    s_and_b32 s21, s3, 1
    s_lshl_b32 s21, s21, 2
    v_bfe_u32 v21, v20, 3, 2
    v_add_u32 v21, s21, v21
    v_mul_u32_u24 v21, 104, v21
    v_bfe_u32 v22, v20, 1, 1
    v_lshl_add_u32 v21, v22, 3, v21
    v_and_b32 v23, 1, v20
    v_xor_b32 v22, v22, v23
    v_lshl_add_u32 v21, v22, 2, v21
    v_bfe_u32 v22, v20, 2, 1
    v_lshl_add_u32 v21, v22, 1, v21
    s_lshr_b32 s21, s3, 1
    s_lshl_b32 s21, s21, 4
    s_add_u32 s21, s21, 64
    v_add_u32 v21, s21, v21
    v_lshlrev_b32 v6, 2, v21
    v_lshrrev_b32 v21, 6, v27
    v_bfe_u32 v22, v27, 1, 1
    v_lshrrev_b32 v23, 1, v21
    v_lshl_add_u32 v22, v22, 1, v23
    v_xor_b32 v23, v27, v22
    v_and_b32 v23, 1, v23
    v_and_b32 v21, 1, v21
    v_lshl_add_u32 v21, v21, 1, v23
    v_mul_u32_u24 v21, 544, v21
    v_lshl_add_u32 v21, v22, 5, v21
    v_bfe_u32 v23, v27, 4, 2
    v_mul_u32_u24 v23, 136, v23
    v_add_u32 v21, v21, v23
    v_bfe_u32 v24, v27, 3, 1
    v_lshl_add_u32 v21, v24, 2, v21
    v_bfe_u32 v24, v27, 2, 1
    v_lshl_add_u32 v21, v24, 4, v21
    v_add_u32 v7, 16384, v21
    v_lshlrev_b32 v8, 2, v20
    s_and_b32 s21, s12, 1
    s_lshl_b32 s21, s21, 9
    s_lshl_b32 s22, s3, 7
    s_add_u32 s21, s21, s22
    v_and_b32 v21, 7, v20
    v_lshlrev_b32 v21, 4, v21
    v_add_u32 v21, s21, v21
    v_lshrrev_b32 v22, 3, v20
    v_lshl_add_u32 v12, v22, 10, v21
    v_bfe_u32 v22, v20, 4, 1
    v_lshl_add_u32 v13, v22, 3, v21
    s_and_b32 s21, s3, 1
    s_lshl_b32 s21, s21, 12
    s_lshr_b32 s22, s3, 1
    s_lshl_b32 s22, s22, 11
    s_add_u32 s21, s21, s22
    s_add_u32 s21, s21, 18560
    v_add_u32 v61, s21, v1
    s_lshl_b32 s21, s3, 2
    s_add_u32 s21, s21, 13312
    v_mov_b32 v14, s21
    v_and_b32 v21, 15, v20
    v_and_b32 v22, 1, v20
    v_lshlrev_b32 v22, 4, v22
    v_mov_b32 v23, 0x3f80
    v_lshlrev_b32 v22, v22, v23
    v_lshrrev_b32 v21, 1, v21
    v_cmp_eq_u32 vcc, 0, v21
    s_nop 1
    v_cndmask_b32 v56, 0, v22, vcc
    v_cmp_eq_u32 vcc, 1, v21
    s_nop 1
    v_cndmask_b32 v57, 0, v22, vcc
    v_cmp_eq_u32 vcc, 2, v21
    s_nop 1
    v_cndmask_b32 v58, 0, v22, vcc
    v_cmp_eq_u32 vcc, 3, v21
    s_nop 1
    v_cndmask_b32 v59, 0, v22, vcc
    v_and_b32 v21, 7, v20
    v_lshlrev_b32 v21, 7, v21
    v_bfe_u32 v22, v20, 3, 1
    v_lshl_add_u32 v21, v22, 17, v21
    s_lshl_b32 s21, s12, 14
    s_lshl_b32 s22, s13, 10
    s_add_u32 s21, s21, s22
    s_add_u32 s21, s21, 4980736
    v_lshrrev_b32 v22, 4, v20
    v_lshl_add_u32 v21, v22, 24, v21
    v_add_u32 v63, s21, v21
    s_mov_b32 s47, 0x3e0293ee
    s_lshl_b32 s14, s12, 2
    s_add_u32 s14, s14, s3
    s_lshl_b32 s61, s14, 13
    s_add_u32 s61, s61, 2097152
    s_lshl_b32 s14, s14, 12
    s_and_b32 s22, s13, 1
    s_lshl_b32 s69, s22, 17
    s_add_u32 s69, s69, s14
    s_add_u32 s69, s69, 4194304
    s_add_u32 s52, s14, 20971520
    s_lshl_b32 s21, s22, 11
    s_add_u32 s14, s14, s21
    s_add_u32 s14, s14, 1179648
    s_lshr_b32 s21, s13, 1
    s_sub_u32 s21, s21, 0
    s_cmp_eq_u32 s21, s3
    s_cselect_b32 s15, 1, 0
    s_add_u32 s23, s3, 3
    s_and_b32 s23, s23, 3
    s_cmp_eq_u32 s21, s23
    s_cselect_b32 s31, 1, 0
    s_and_b32 s24, s23, 1
    s_and_b32 s25, s3, 1
    s_sub_i32 s24, s24, s25
    s_lshr_b32 s23, s23, 1
    s_lshr_b32 s25, s3, 1
    s_sub_i32 s23, s23, s25
    s_mul_i32 s46, s24, 4096
    s_mul_i32 s25, s23, 2048
    s_add_i32 s46, s46, s25
    s_mul_i32 s27, s24, 32768
    s_mul_i32 s25, s23, 1024
    s_add_i32 s27, s27, s25
    v_lshrrev_b32 v21, 4, v20
    v_and_b32 v23, 15, v20
    v_lshlrev_b32 v21, 2, v21
    v_add_u32 v24, 0, v21
    v_cmp_gt_u32 vcc, v24, v23
    s_cmp_eq_u32 s22, 0
    s_cselect_b64 s[38:39], vcc, 0
    s_cselect_b64 s[48:49], -1, vcc
    v_add_u32 v24, 1, v21
    v_cmp_gt_u32 vcc, v24, v23
    s_cmp_eq_u32 s22, 0
    s_cselect_b64 s[40:41], vcc, 0
    s_cselect_b64 s[50:51], -1, vcc
    v_add_u32 v24, 2, v21
    v_cmp_gt_u32 vcc, v24, v23
    s_cmp_eq_u32 s22, 0
    s_cselect_b64 s[42:43], vcc, 0
    s_cselect_b64 s[54:55], -1, vcc
    v_add_u32 v24, 3, v21
    v_cmp_gt_u32 vcc, v24, v23
    s_cmp_eq_u32 s22, 0
    s_cselect_b64 s[44:45], vcc, 0
    s_cselect_b64 s[56:57], -1, vcc
    s_waitcnt vmcnt(0)
    v_mov_b32 v16, v32
    v_mov_b32 v17, v33
    v_mov_b32 v18, v34
    v_mov_b32 v19, v35
    v_mov_b32 v20, v36
    v_mov_b32 v21, v37
    v_mov_b32 v22, v38
    v_mov_b32 v23, v39
    v_mov_b32 v24, v40
    v_mov_b32 v25, v41
    v_mov_b32 v26, v42
    v_mov_b32 v27, v43
    v_mov_b32 v28, v44
    v_mov_b32 v29, v45
    v_mov_b32 v30, v46
    v_mov_b32 v31, v47
    v_mov_b32 v32, -1
    v_mov_b32 v33, -1
    v_mov_b32 v34, -1
    v_mov_b32 v35, -1
    s_add_u32 s21, s37, 3997696
    buffer_store_dwordx4 v[32:35], v1, s[4:7], s21 offen sc1
    s_add_u32 s21, s37, 4063232
    buffer_store_dwordx4 v[32:35], v1, s[4:7], s21 offen sc1
    s_add_u32 s21, s37, 4128768
    buffer_store_dwordx4 v[32:35], v1, s[4:7], s21 offen sc1
    s_lshl_b32 s29, s29, 5
    s_barrier
    ds_write_b32 v14, v10
    ds_write_b32 v14, v10 offset:16
    ds_write_b32 v14, v10 offset:32
    s_lshl_b32 s53, s3, 13
    s_add_u32 s53, s53, 92160
    v_add_u32 v32, 14336, v1
    ds_write_b128 v32, v[56:59]
    s_lshl_b32 s60, s12, 4
    s_add_u32 s60, s60, 218104320
    v_mov_b32 v15, 0
    s_add_u32 s25, s16, 0
    s_min_u32 s25, s25, 63
    s_cmp_lt_u32 s25, 8
    s_cselect_b32 s59, 12, 24
    s_cselect_b32 s58, -4, -8
    s_and_b32 s25, s25, s58
    s_lshl_b32 s25, s25, 5
    s_add_u32 s58, s25, s60
    v_mov_b32 v32, 131072
    s_waitcnt vmcnt(0) lgkmcnt(0)
    s_barrier
    ds_read_b64 v[32:33], v32
    s_waitcnt lgkmcnt(0)
    v_cmp_ne_u32 vcc, s29, v32
    s_setprio 3
    v_readfirstlane_b32 s63, v33
    s_add_u32 s34, s34, s63
    s_add_u32 s35, s35, s63
    s_cbranch_vccnz ch_p_slow
    v_mov_b32 v32, 0
    v_mov_b32 v33, 0
    v_mov_b32 v34, 0
    v_mov_b32 v35, 0
    v_mov_b32 v36, 0
    v_mov_b32 v37, 0
    v_mov_b32 v38, 0
    v_mov_b32 v39, 0
    v_mov_b32 v40, 0
    v_mov_b32 v41, 0
    v_mov_b32 v42, 0
    v_mov_b32 v43, 0
    v_mov_b32 v44, 0
    v_mov_b32 v45, 0
    v_mov_b32 v46, 0
    v_mov_b32 v47, 0
    v_mov_b32 v48, 0
    v_mov_b32 v49, 0
    v_mov_b32 v50, 0
    v_mov_b32 v51, 0
    v_mov_b32 v52, 0
    v_mov_b32 v53, 0
    v_mov_b32 v54, 0
    v_mov_b32 v55, 0
    v_mov_b32 v0, 1.0
    s_mov_b32 exec_lo, 0xff00ff00
    s_mov_b32 exec_hi, 0xff00ff00
    v_mov_b32 v0, s47
    s_mov_b64 exec, -1
    v_mov_b32 v60, s16
    v_smfmac_f32_16x16x64_bf16 v[32:35], v[16:19], v[64:71], v62
    v_smfmac_f32_16x16x64_bf16 v[36:39], v[16:19], v[72:79], v62
    v_smfmac_f32_16x16x64_bf16 v[40:43], v[16:19], v[80:87], v62
    v_smfmac_f32_16x16x64_bf16 v[44:47], v[16:19], v[88:95], v62
    v_smfmac_f32_16x16x64_bf16 v[48:51], v[16:19], v[96:103], v62
    v_smfmac_f32_16x16x64_bf16 v[52:55], v[16:19], v[104:111], v62
    v_smfmac_f32_16x16x64_bf16 v[32:35], v[20:23], v[112:119], v62
    v_smfmac_f32_16x16x64_bf16 v[36:39], v[20:23], v[120:127], v62
    v_smfmac_f32_16x16x64_bf16 v[40:43], v[20:23], v[128:135], v62
    v_smfmac_f32_16x16x64_bf16 v[44:47], v[20:23], v[136:143], v62
    v_smfmac_f32_16x16x64_bf16 v[48:51], v[20:23], v[144:151], v62
    v_smfmac_f32_16x16x64_bf16 v[52:55], v[20:23], v[152:159], v62
    v_smfmac_f32_16x16x64_bf16 v[32:35], v[24:27], v[160:167], v62
    v_smfmac_f32_16x16x64_bf16 v[36:39], v[24:27], v[168:175], v62
    v_smfmac_f32_16x16x64_bf16 v[40:43], v[24:27], v[176:183], v62
    v_smfmac_f32_16x16x64_bf16 v[44:47], v[24:27], v[184:191], v62
    v_smfmac_f32_16x16x64_bf16 v[48:51], v[24:27], v[192:199], v62
    v_smfmac_f32_16x16x64_bf16 v[52:55], v[24:27], v[200:207], v62
    v_smfmac_f32_16x16x64_bf16 v[32:35], v[28:31], v[208:215], v62
    ds_write_b32 v14, v60
    v_smfmac_f32_16x16x64_bf16 v[36:39], v[28:31], v[216:223], v62
    v_smfmac_f32_16x16x64_bf16 v[40:43], v[28:31], v[224:231], v62
    v_smfmac_f32_16x16x64_bf16 v[44:47], v[28:31], v[232:239], v62
    v_add_f32 v32, v32, v33
    v_add_f32 v34, v34, v35
    v_smfmac_f32_16x16x64_bf16 v[48:51], v[28:31], v[240:247], v62
    v_add_f32 v36, v36, v37
    v_add_f32 v38, v38, v39
    ds_write2_b32 v4, v32, v34 offset0:0 offset1:104
    v_smfmac_f32_16x16x64_bf16 v[52:55], v[28:31], v[248:255], v62
    v_add_f32 v40, v40, v41
    v_add_f32 v42, v42, v43
    ds_write2_b32 v4, v36, v38 offset0:16 offset1:120
    v_add_f32 v44, v44, v45
    v_add_f32 v46, v46, v47
    ds_write2_b32 v4, v40, v42 offset0:32 offset1:136
    v_add_f32 v48, v48, v49
    v_add_f32 v50, v50, v51
    ds_write2_b32 v4, v44, v46 offset0:48 offset1:152
    v_add_f32 v52, v52, v53
    v_add_f32 v54, v54, v55
    ds_write2_b32 v4, v48, v50 offset0:64 offset1:168
    ds_write2_b32 v4, v52, v54 offset0:80 offset1:184
    s_waitcnt vmcnt(0)
    s_branch pnc_7_done
.p2align 6
    s_nop 0
    s_nop 0
    s_nop 0
    s_nop 0
    s_nop 0
    s_nop 0
    s_nop 0
    s_nop 0
ploop_6:
    s_add_u32 s21, s17, s33
    s_nop 15
    s_nop 5
    buffer_load_dwordx4 v[16:19], v1, s[4:7], s21 offen offset:0 sc1
    s_nop 7
    buffer_load_dwordx4 v[20:23], v1, s[4:7], s21 offen offset:1024 sc1
    s_nop 7
    buffer_load_dwordx4 v[24:27], v1, s[4:7], s21 offen offset:2048 sc1
    s_nop 7
    buffer_load_dwordx4 v[28:31], v1, s[4:7], s21 offen offset:3072 sc1
    s_waitcnt vmcnt(3)
    v_max3_u32 v9, v16, v17, v18
    v_max_u32 v9, v9, v19
    v_cmp_eq_u32 vcc, -1, v9
    s_cbranch_vccnz prm_9_0
prm_9_0ok:
    v_smfmac_f32_16x16x64_bf16 v[32:35], v[16:19], v[64:71], v62
    v_smfmac_f32_16x16x64_bf16 v[36:39], v[16:19], v[72:79], v62
    v_smfmac_f32_16x16x64_bf16 v[40:43], v[16:19], v[80:87], v62
    s_waitcnt vmcnt(2)
    v_max3_u32 v9, v20, v21, v22
    v_max_u32 v9, v9, v23
    v_cmp_eq_u32 vcc, -1, v9
    v_smfmac_f32_16x16x64_bf16 v[44:47], v[16:19], v[88:95], v62
    v_smfmac_f32_16x16x64_bf16 v[48:51], v[16:19], v[96:103], v62
    v_smfmac_f32_16x16x64_bf16 v[52:55], v[16:19], v[104:111], v62
    s_cbranch_vccnz prm_9_1
prm_9_1ok:
    v_smfmac_f32_16x16x64_bf16 v[32:35], v[20:23], v[112:119], v62
    v_readfirstlane_b32 s23, v15
    v_smfmac_f32_16x16x64_bf16 v[36:39], v[20:23], v[120:127], v62
    v_smfmac_f32_16x16x64_bf16 v[40:43], v[20:23], v[128:135], v62
    s_waitcnt vmcnt(1)
    v_max3_u32 v9, v24, v25, v26
    v_max_u32 v9, v9, v27
    v_cmp_eq_u32 vcc, -1, v9
    v_smfmac_f32_16x16x64_bf16 v[44:47], v[20:23], v[136:143], v62
    v_smfmac_f32_16x16x64_bf16 v[48:51], v[20:23], v[144:151], v62
    v_smfmac_f32_16x16x64_bf16 v[52:55], v[20:23], v[152:159], v62
    s_cbranch_vccnz prm_9_2
prm_9_2ok:
    v_smfmac_f32_16x16x64_bf16 v[32:35], v[24:27], v[160:167], v62
    v_smfmac_f32_16x16x64_bf16 v[36:39], v[24:27], v[168:175], v62
    v_smfmac_f32_16x16x64_bf16 v[40:43], v[24:27], v[176:183], v62
    s_waitcnt vmcnt(0)
    v_max3_u32 v9, v28, v29, v30
    v_max_u32 v9, v9, v31
    v_cmp_eq_u32 vcc, -1, v9
    v_smfmac_f32_16x16x64_bf16 v[44:47], v[24:27], v[184:191], v62
    v_smfmac_f32_16x16x64_bf16 v[48:51], v[24:27], v[192:199], v62
    v_smfmac_f32_16x16x64_bf16 v[52:55], v[24:27], v[200:207], v62
    s_cbranch_vccnz prm_9_3
prm_9_3ok:
    v_smfmac_f32_16x16x64_bf16 v[32:35], v[28:31], v[208:215], v62
    s_cmp_lt_u32 s23, s59
    s_cbranch_scc1 prm_9_gt
prm_9_gtb:
    ds_write_b32 v14, v60
    v_smfmac_f32_16x16x64_bf16 v[36:39], v[28:31], v[216:223], v62
    v_smfmac_f32_16x16x64_bf16 v[40:43], v[28:31], v[224:231], v62
    v_smfmac_f32_16x16x64_bf16 v[44:47], v[28:31], v[232:239], v62
    v_add_f32 v32, v32, v33
    v_add_f32 v34, v34, v35
    v_smfmac_f32_16x16x64_bf16 v[48:51], v[28:31], v[240:247], v62
    v_add_f32 v36, v36, v37
    v_add_f32 v38, v38, v39
    ds_write2_b32 v4, v32, v34 offset0:0 offset1:104
    v_smfmac_f32_16x16x64_bf16 v[52:55], v[28:31], v[248:255], v62
    v_add_f32 v40, v40, v41
    v_add_f32 v42, v42, v43
    ds_write2_b32 v4, v36, v38 offset0:16 offset1:120
    v_add_f32 v44, v44, v45
    v_add_f32 v46, v46, v47
    ds_write2_b32 v4, v40, v42 offset0:32 offset1:136
    v_add_f32 v48, v48, v49
    v_add_f32 v50, v50, v51
    ds_write2_b32 v4, v44, v46 offset0:48 offset1:152
    v_add_f32 v52, v52, v53
    v_add_f32 v54, v54, v55
    ds_write2_b32 v4, v48, v50 offset0:64 offset1:168
    ds_write2_b32 v4, v52, v54 offset0:80 offset1:184
pnc_7_done:
    s_add_u32 s21, s17, s32
    s_add_u32 s22, s19, s32
    s_add_u32 s24, s19, s35
    s_waitcnt lgkmcnt(0)
    s_barrier
    ds_read_b64 v[32:33], v5 offset:0
    ds_read_b64 v[34:35], v5 offset:3328
    ds_read_b64 v[36:37], v5 offset:6656
    ds_read_b64 v[38:39], v5 offset:9984
    ds_read_b64 v[40:41], v6 offset:0
    ds_read_b64 v[42:43], v6 offset:3328
    ds_read_b64 v[44:45], v6 offset:6656
    ds_read_b64 v[46:47], v6 offset:9984
    s_waitcnt lgkmcnt(6)
    v_add_f32 v32, v32, v34
    v_add_f32 v33, v33, v35
    v_mul_f32 v32, v32, v0
    v_mul_f32 v33, v33, v0
    s_waitcnt lgkmcnt(4)
    v_add_f32 v36, v36, v38
    v_add_f32 v37, v37, v39
    v_fma_f32 v32, v36, v0, v32
    v_fma_f32 v33, v37, v0, v33
    v_cvt_pk_bf16_f32 v32, v32, v33
    v_min_u32 v32, -2, v32
    buffer_store_dword v32, v2, s[4:7], s21 offen
    s_waitcnt lgkmcnt(2)
    v_add_f32 v40, v40, v42
    v_add_f32 v41, v41, v43
    s_waitcnt lgkmcnt(0)
    v_add_f32 v44, v44, v46
    v_add_f32 v45, v45, v47
    v_add_f32 v40, v40, v44
    v_add_f32 v41, v41, v45
    v_cvt_pk_bf16_f32 v40, v40, v41
    v_min_u32 v40, -2, v40
    s_mov_b32 exec_hi, 0
    buffer_store_dword v40, v3, s[4:7], s21 offen
    s_setprio 0
    s_mov_b64 exec, -1
    s_add_u32 s21, s17, s35
    s_add_u32 s30, s17, s34
    s_add_u32 s23, s18, s36
    s_cmp_lg_u32 s16, 0
    s_cbranch_scc1 ploop_6_n0
gate_11:
    v_readfirstlane_b32 s25, v15
    s_cmp_ge_u32 s25, s59
    s_cbranch_scc1 gate_11_ok
    s_sleep 8
    buffer_load_dword v15, off, s[4:7], s58 sc1
    s_waitcnt vmcnt(0)
    s_sub_u32 s26, s26, 1
    s_cbranch_scc0 gate_11
    s_mov_b32 s26, 0
gate_11_ok:
    s_cmp_eq_u32 s15, 0
    s_cbranch_scc1 ploop_6_st_nk
    s_add_u32 m0, s53, 0
    s_add_u32 s22, s52, 0
    buffer_load_dwordx4 v1, s[4:7], s22 offen offset:0 sc1 lds
    buffer_load_dwordx4 v1, s[4:7], s22 offen offset:1024 sc1 lds
    buffer_load_dwordx4 v1, s[4:7], s22 offen offset:2048 sc1 lds
    buffer_load_dwordx4 v1, s[4:7], s22 offen offset:3072 sc1 lds
    s_add_u32 m0, s53, 4096
    s_add_u32 s22, s52, 131072
    buffer_load_dwordx4 v1, s[4:7], s22 offen offset:0 sc1 lds
    buffer_load_dwordx4 v1, s[4:7], s22 offen offset:1024 sc1 lds
    buffer_load_dwordx4 v1, s[4:7], s22 offen offset:2048 sc1 lds
    buffer_load_dwordx4 v1, s[4:7], s22 offen offset:3072 sc1 lds
    s_add_u32 s52, s52, 262144
    s_sub_u32 s52, s52, 262144
ploop_6_st_nk:
    s_add_u32 s52, s52, 262144
    s_cmp_lg_u32 s3, 2
    s_cbranch_scc1 ploop_6_st_npf
    v_subrev_u32 v32, 786432, v63
    s_mov_b32 exec_hi, 0xffff
    s_mov_b32 s22, 262144
    buffer_load_dword v33, v32, s[4:7], s22 offen sc1
    s_mov_b32 s22, 524288
    buffer_load_dword v33, v32, s[4:7], s22 offen sc1
    s_mov_b32 exec_hi, -1
    s_waitcnt vmcnt(0)
ploop_6_st_npf:
    s_cmp_eq_u32 s15, 0
    s_cbranch_scc1 ploop_6_st_p_nd
    s_mov_b32 m0, 124928
    s_nop 0
    buffer_load_dwordx4 v1, s[4:7], s69 offen offset:0 sc1 lds
    buffer_load_dwordx4 v1, s[4:7], s69 offen offset:1024 sc1 lds
    buffer_load_dwordx4 v1, s[4:7], s69 offen offset:2048 sc1 lds
    buffer_load_dwordx4 v1, s[4:7], s69 offen offset:3072 sc1 lds
    s_add_u32 s69, s69, 262144
    s_waitcnt vmcnt(0)
ploop_6_st_p_nd:
ploop_6_n0:
    s_add_u32 s25, s16, 2
    s_min_u32 s25, s25, 63
    s_cmp_lt_u32 s25, 8
    s_cselect_b32 s59, 12, 24
    s_cselect_b32 s58, -4, -8
    s_and_b32 s25, s25, s58
    s_lshl_b32 s25, s25, 5
    s_add_u32 s58, s25, s60
    s_cmp_eq_u32 s15, 0
    s_cbranch_scc1 ploop_6_nd
    v_add_u32 v9, s53, v1
    v_add_u32 v0, 124928, v1
    ds_read_b128 v[16:19], v0 offset:0
    ds_read_b128 v[32:35], v9 offset:0
    ds_read_b128 v[20:23], v0 offset:1024
    ds_read_b128 v[36:39], v9 offset:1024
    ds_read_b128 v[24:27], v0 offset:2048
    ds_read_b128 v[40:43], v9 offset:2048
    ds_read_b128 v[28:31], v0 offset:3072
    ds_read_b128 v[44:47], v9 offset:3072
    s_add_u32 s22, s17, s61
    s_waitcnt lgkmcnt(6)
    v_mfma_f32_16x16x32_bf16 v[48:51], v[32:35], v[16:19], 0
    ds_read_b128 v[32:35], v9 offset:4096
    s_waitcnt lgkmcnt(5)
    v_mfma_f32_16x16x32_bf16 v[48:51], v[36:39], v[20:23], v[48:51]
    ds_read_b128 v[36:39], v9 offset:5120
    s_waitcnt lgkmcnt(4)
    v_mfma_f32_16x16x32_bf16 v[48:51], v[40:43], v[24:27], v[48:51]
    ds_read_b128 v[40:43], v9 offset:6144
    s_waitcnt lgkmcnt(3)
    v_mfma_f32_16x16x32_bf16 v[48:51], v[44:47], v[28:31], v[48:51]
    ds_read_b128 v[44:47], v9 offset:7168
    s_waitcnt lgkmcnt(3)
    v_mfma_f32_16x16x32_bf16 v[52:55], v[32:35], v[16:19], 0
    s_waitcnt lgkmcnt(2)
    v_mfma_f32_16x16x32_bf16 v[52:55], v[36:39], v[20:23], v[52:55]
    s_waitcnt lgkmcnt(1)
    v_mfma_f32_16x16x32_bf16 v[52:55], v[40:43], v[24:27], v[52:55]
    s_waitcnt lgkmcnt(0)
    v_mfma_f32_16x16x32_bf16 v[52:55], v[44:47], v[28:31], v[52:55]
    buffer_load_dwordx4 v[32:35], v1, s[4:7], s22 offen offset:0 sc1
    buffer_load_dwordx4 v[36:39], v1, s[4:7], s22 offen offset:1024 sc1
    buffer_load_dwordx4 v[40:43], v1, s[4:7], s22 offen offset:2048 sc1
    buffer_load_dwordx4 v[44:47], v1, s[4:7], s22 offen offset:3072 sc1
    v_mov_b32 v60, 0xff61b1e6
    s_nop 2
    v_cndmask_b32 v48, v48, v60, s[38:39]
    v_cndmask_b32 v49, v49, v60, s[40:41]
    v_cndmask_b32 v50, v50, v60, s[42:43]
    v_cndmask_b32 v51, v51, v60, s[44:45]
    v_cndmask_b32 v52, v52, v60, s[48:49]
    v_cndmask_b32 v53, v53, v60, s[50:51]
    v_cndmask_b32 v54, v54, v60, s[54:55]
    v_cndmask_b32 v55, v55, v60, s[56:57]
    v_max3_f32 v0, v48, v49, v50
    v_max3_f32 v9, v51, v52, v53
    v_max3_f32 v0, v0, v54, v55
    v_max_f32 v0, v0, v9
    v_mov_b32 v9, v0
    s_nop 1
    v_permlane16_swap_b32 v9, v0
    v_max_f32 v0, v0, v9
    v_mov_b32 v9, v0
    s_nop 1
    v_permlane32_swap_b32 v9, v0
    v_max_f32 v0, v0, v9
    v_mul_f32 v0, s47, v0
    v_fma_f32 v48, v48, s47, -v0
    v_fma_f32 v49, v49, s47, -v0
    v_fma_f32 v50, v50, s47, -v0
    v_fma_f32 v51, v51, s47, -v0
    v_fma_f32 v52, v52, s47, -v0
    v_fma_f32 v53, v53, s47, -v0
    v_fma_f32 v54, v54, s47, -v0
    v_fma_f32 v55, v55, s47, -v0
    v_exp_f32 v48, v48
    v_exp_f32 v49, v49
    v_exp_f32 v50, v50
    v_exp_f32 v51, v51
    v_exp_f32 v52, v52
    v_exp_f32 v53, v53
    v_exp_f32 v54, v54
    v_exp_f32 v55, v55
    v_add_f32 v15, v48, v49
    v_add_f32 v15, v15, v50
    v_add_f32 v15, v15, v51
    v_add_f32 v15, v15, v52
    v_add_f32 v15, v15, v53
    v_add_f32 v15, v15, v54
    v_add_f32 v15, v15, v55
ploop_6_za:
    s_waitcnt vmcnt(0)
    v_max3_u32 v9, v32, v33, v34
    v_max3_u32 v9, v9, v35, v36
    v_max3_u32 v9, v9, v37, v38
    v_max3_u32 v9, v9, v39, v40
    v_max3_u32 v9, v9, v41, v42
    v_max3_u32 v9, v9, v43, v44
    v_max3_u32 v9, v9, v45, v46
    v_max_u32 v9, v9, v47
    v_cmp_eq_u32 vcc, -1, v9
    s_cbranch_vccnz ploop_6_zr
ploop_6_zok:
    v_mfma_f32_16x16x32_bf16 v[56:59], v[32:35], v[16:19], 0
    v_mfma_f32_16x16x32_bf16 v[56:59], v[36:39], v[20:23], v[56:59]
    v_mfma_f32_16x16x32_bf16 v[56:59], v[40:43], v[24:27], v[56:59]
    v_mfma_f32_16x16x32_bf16 v[56:59], v[44:47], v[28:31], v[56:59]
    s_add_u32 s22, s17, s14
    s_nop 6
    v_max_f32 v60, v56, v57
    v_mov_b32 v9, v60
    s_nop 1
    v_permlane16_swap_b32 v9, v60
    v_max_f32 v60, v60, v9
    v_mov_b32 v9, v60
    s_nop 1
    v_permlane32_swap_b32 v9, v60
    v_max_f32 v60, v60, v9
    v_mul_f32 v60, s47, v60
    v_max_f32 v58, v60, v0
    v_sub_f32 v60, v0, v58
    v_fma_f32 v56, v56, s47, -v58
    v_fma_f32 v57, v57, s47, -v58
    v_exp_f32 v60, v60
    v_exp_f32 v56, v56
    v_exp_f32 v57, v57
    v_fma_f32 v15, v15, v60, v56
    v_add_f32 v15, v15, v57
    v_mov_b32 v9, v15
    s_nop 1
    v_permlane16_swap_b32 v9, v15
    v_add_f32 v15, v15, v9
    v_mov_b32 v9, v15
    s_nop 1
    v_permlane32_swap_b32 v9, v15
    v_add_f32 v15, v15, v9
    v_rcp_f32 v15, v15
    s_add_u32 s25, s19, s14
    v_mul_f32 v56, v56, v15
    v_mul_f32 v57, v57, v15
    v_mul_f32 v60, v60, v15
    v_mul_f32 v48, v48, v60
    v_mul_f32 v49, v49, v60
    v_mul_f32 v50, v50, v60
    v_mul_f32 v51, v51, v60
    v_mul_f32 v52, v52, v60
    v_mul_f32 v53, v53, v60
    v_mul_f32 v54, v54, v60
    v_mul_f32 v55, v55, v60
    v_cvt_pk_bf16_f32 v48, v48, v49
    v_cvt_pk_bf16_f32 v49, v50, v51
    v_cvt_pk_bf16_f32 v50, v52, v53
    v_cvt_pk_bf16_f32 v51, v54, v55
    v_min_u32 v48, -2, v48
    v_min_u32 v49, -2, v49
    v_min_u32 v50, -2, v50
    v_min_u32 v51, -2, v51
    v_lshlrev_b32 v54, 1, v8
    v_add_u32 v55, 14336, v1
    v_mov_b32 v53, 1.0
    v_cvt_pk_bf16_f32 v52, v56, v57
    v_min_u32 v53, -2, v53
    v_min_u32 v52, -2, v52
    buffer_store_dwordx4 v[48:51], v1, s[4:7], s22 offen
    buffer_store_dwordx2 v[52:53], v54, s[4:7], s22 offen offset:1024
    ds_read_b128 v[56:59], v55
    s_branch ploop_6_nd2
ploop_6_nd:
    s_cmp_eq_u32 s16, 0
    s_cbranch_scc1 ploop_6_ns
    s_cmp_eq_u32 s31, 0
    s_cbranch_scc1 ploop_6_n2
    s_add_u32 s25, s68, s46
    v_add_u32 v55, s25, v61
    ds_read_b128 v[24:27], v55 offset:0
    ds_read_b128 v[28:31], v55 offset:1024
    ds_read_b128 v[32:35], v55 offset:18560
    ds_read_b128 v[36:39], v55 offset:19584
    ds_read_b128 v[40:43], v55 offset:37120
    ds_read_b128 v[44:47], v55 offset:38144
    ds_read_b128 v[48:51], v55 offset:55680
    ds_read_b128 v[52:55], v55 offset:56704
    s_waitcnt lgkmcnt(4)
    v_add_f32 v24, v24, v32
    v_add_f32 v25, v25, v33
    v_add_f32 v26, v26, v34
    v_add_f32 v27, v27, v35
    v_add_f32 v28, v28, v36
    v_add_f32 v29, v29, v37
    v_add_f32 v30, v30, v38
    v_add_f32 v31, v31, v39
    s_waitcnt lgkmcnt(0)
    v_add_f32 v40, v40, v48
    v_add_f32 v41, v41, v49
    v_add_f32 v42, v42, v50
    v_add_f32 v43, v43, v51
    v_add_f32 v44, v44, v52
    v_add_f32 v45, v45, v53
    v_add_f32 v46, v46, v54
    v_add_f32 v47, v47, v55
    v_add_f32 v24, v24, v40
    v_add_f32 v25, v25, v41
    v_add_f32 v26, v26, v42
    v_add_f32 v27, v27, v43
    v_add_f32 v28, v28, v44
    v_add_f32 v29, v29, v45
    v_add_f32 v30, v30, v46
    v_add_f32 v31, v31, v47
    v_cvt_pk_bf16_f32 v24, v24, v25
    v_cvt_pk_bf16_f32 v25, v26, v27
    v_cvt_pk_bf16_f32 v26, v28, v29
    v_cvt_pk_bf16_f32 v27, v30, v31
    v_min_u32 v24, -2, v24
    v_min_u32 v25, -2, v25
    v_min_u32 v26, -2, v26
    v_min_u32 v27, -2, v27
    v_mov_b32 v16, v24
    v_mov_b32 v17, v25
    v_mov_b32 v18, v26
    v_mov_b32 v19, v27
ploop_6_n2:
    v_add_u32 v55, s68, v61
    ds_read_b128 v[24:27], v55 offset:0
    ds_read_b128 v[28:31], v55 offset:1024
    ds_read_b128 v[32:35], v55 offset:18560
    ds_read_b128 v[36:39], v55 offset:19584
    ds_read_b128 v[40:43], v55 offset:37120
    ds_read_b128 v[44:47], v55 offset:38144
    ds_read_b128 v[48:51], v55 offset:55680
    ds_read_b128 v[52:55], v55 offset:56704
    s_waitcnt lgkmcnt(4)
    v_add_f32 v24, v24, v32
    v_add_f32 v25, v25, v33
    v_add_f32 v26, v26, v34
    v_add_f32 v27, v27, v35
    v_add_f32 v28, v28, v36
    v_add_f32 v29, v29, v37
    v_add_f32 v30, v30, v38
    v_add_f32 v31, v31, v39
    s_waitcnt lgkmcnt(0)
    v_add_f32 v40, v40, v48
    v_add_f32 v41, v41, v49
    v_add_f32 v42, v42, v50
    v_add_f32 v43, v43, v51
    v_add_f32 v44, v44, v52
    v_add_f32 v45, v45, v53
    v_add_f32 v46, v46, v54
    v_add_f32 v47, v47, v55
    v_add_f32 v24, v24, v40
    v_add_f32 v25, v25, v41
    v_add_f32 v26, v26, v42
    v_add_f32 v27, v27, v43
    v_add_f32 v28, v28, v44
    v_add_f32 v29, v29, v45
    v_add_f32 v30, v30, v46
    v_add_f32 v31, v31, v47
    v_cvt_pk_bf16_f32 v24, v24, v25
    v_cvt_pk_bf16_f32 v25, v26, v27
    v_cvt_pk_bf16_f32 v26, v28, v29
    v_cvt_pk_bf16_f32 v27, v30, v31
    v_min_u32 v24, -2, v24
    v_min_u32 v25, -2, v25
    v_min_u32 v26, -2, v26
    v_min_u32 v27, -2, v27
ploop_6_ns:
ploop_6_flag:
    ds_read_b32 v9, v14 offset:16
    s_waitcnt lgkmcnt(0)
    v_readfirstlane_b32 s25, v9
    s_cmp_eq_u32 s25, s16
    s_cbranch_scc0 ploop_6_flag
    s_add_u32 m0, s53, 0
    s_add_u32 s22, s52, 0
    buffer_load_dwordx4 v1, s[4:7], s22 offen offset:0 sc1 lds
    buffer_load_dwordx4 v1, s[4:7], s22 offen offset:1024 sc1 lds
    buffer_load_dwordx4 v1, s[4:7], s22 offen offset:2048 sc1 lds
    buffer_load_dwordx4 v1, s[4:7], s22 offen offset:3072 sc1 lds
    s_add_u32 m0, s53, 4096
    s_add_u32 s22, s52, 131072
    buffer_load_dwordx4 v1, s[4:7], s22 offen offset:0 sc1 lds
    buffer_load_dwordx4 v1, s[4:7], s22 offen offset:1024 sc1 lds
    buffer_load_dwordx4 v1, s[4:7], s22 offen offset:2048 sc1 lds
    buffer_load_dwordx4 v1, s[4:7], s22 offen offset:3072 sc1 lds
    s_add_u32 s52, s52, 262144
ploop_6_nk:
    s_cmp_eq_u32 s16, 0
    s_cbranch_scc1 ploop_6_nd2
    buffer_store_dwordx4 v[24:27], v1, s[4:7], s37 offen sc1
    s_cmp_eq_u32 s31, 0
    s_cbranch_scc1 ploop_6_nd2
    s_add_u32 s25, s37, s27
    buffer_store_dwordx4 v[16:19], v1, s[4:7], s25 offen sc1
ploop_6_nd2:
    s_cmp_eq_u32 s16, 0
    s_cbranch_scc1 ploop_6_nn
    s_add_u32 s37, s37, 65536
    s_xor_b32 s68, s68, 8192
ploop_6_nn:
    s_cmp_lg_u32 s3, 2
    s_cbranch_scc1 ppf_12
    s_lshl_b32 s22, s16, 18
    s_mov_b32 exec_hi, 0xffff
    buffer_load_dword v9, v63, s[4:7], s22 offen sc1
    s_mov_b32 exec_hi, -1
ppf_12:
    v_add_u32 v24, 18560, v7
    v_add_u32 v25, 37120, v7
    v_add_u32 v26, 55680, v7
    s_cmp_eq_u32 s16, 63
    s_setprio 3
    s_barrier
    s_cbranch_scc1 ptail_8
    ds_read2_b32 v[16:17], v7 offset0:0 offset1:2
    ds_read2_b32 v[18:19], v24 offset0:0 offset1:2
    ds_read2_b32 v[20:21], v25 offset0:0 offset1:2
    ds_read2_b32 v[22:23], v26 offset0:0 offset1:2
    s_waitcnt lgkmcnt(2)
    v_add_f32 v16, v16, v18
    v_add_f32 v17, v17, v19
    s_waitcnt lgkmcnt(0)
    v_add_f32 v20, v20, v22
    v_add_f32 v21, v21, v23
    v_add_f32 v16, v16, v20
    v_add_f32 v17, v17, v21
    v_cvt_pk_bf16_f32 v16, v16, v17
    v_min_u32 v16, -2, v16
    buffer_store_dword v16, v2, s[4:7], s21 offen sc1
    buffer_store_dword v10, v2, s[4:7], s24 offen sc1
    s_cmp_eq_u32 s15, 0
    s_cbranch_scc1 ploop_6_pnd
    s_sleep 6
    s_nop 8
    buffer_load_dwordx4 v[16:19], v12, s[4:7], s30 offen sc1
    buffer_load_dword v15, off, s[4:7], s58 sc1
    s_add_u32 s25, s19, s14
    v_mov_b32 v20, -1
    v_mov_b32 v21, -1
    v_mov_b32 v22, -1
    v_mov_b32 v23, -1
    buffer_store_dwordx4 v[20:23], v1, s[4:7], s25 offen
    buffer_store_dwordx2 v[20:21], v54, s[4:7], s25 offen offset:1024
    s_mov_b32 m0, 124928
    s_nop 0
    buffer_load_dwordx4 v1, s[4:7], s69 offen offset:0 sc1 lds
    buffer_load_dwordx4 v1, s[4:7], s69 offen offset:1024 sc1 lds
    buffer_load_dwordx4 v1, s[4:7], s69 offen offset:2048 sc1 lds
    buffer_load_dwordx4 v1, s[4:7], s69 offen offset:3072 sc1 lds
    s_add_u32 s69, s69, 262144
    s_add_u32 m0, s53, 0
    s_add_u32 s22, s52, 0
    buffer_load_dwordx4 v1, s[4:7], s22 offen offset:0 sc1 lds
    buffer_load_dwordx4 v1, s[4:7], s22 offen offset:1024 sc1 lds
    buffer_load_dwordx4 v1, s[4:7], s22 offen offset:2048 sc1 lds
    buffer_load_dwordx4 v1, s[4:7], s22 offen offset:3072 sc1 lds
    s_add_u32 m0, s53, 4096
    s_add_u32 s22, s52, 131072
    buffer_load_dwordx4 v1, s[4:7], s22 offen offset:0 sc1 lds
    buffer_load_dwordx4 v1, s[4:7], s22 offen offset:1024 sc1 lds
    buffer_load_dwordx4 v1, s[4:7], s22 offen offset:2048 sc1 lds
    buffer_load_dwordx4 v1, s[4:7], s22 offen offset:3072 sc1 lds
    s_add_u32 s52, s52, 262144
    s_add_u32 s22, s16, 1
    v_mov_b32 v60, s22
    v_mov_b32 v32, 0
    v_mov_b32 v33, 0
    v_mov_b32 v34, 0
    v_mov_b32 v35, 0
    v_mov_b32 v36, 0
    v_mov_b32 v37, 0
    v_mov_b32 v38, 0
    v_mov_b32 v39, 0
    v_mov_b32 v40, 0
    v_mov_b32 v41, 0
    v_mov_b32 v42, 0
    v_mov_b32 v43, 0
    v_mov_b32 v44, 0
    v_mov_b32 v45, 0
    v_mov_b32 v46, 0
    v_mov_b32 v47, 0
    v_mov_b32 v48, 0
    v_mov_b32 v49, 0
    v_mov_b32 v50, 0
    v_mov_b32 v51, 0
    v_mov_b32 v52, 0
    v_mov_b32 v53, 0
    v_mov_b32 v54, 0
    v_mov_b32 v55, 0
    v_mov_b32 v0, 1.0
    s_mov_b32 exec_lo, 0xff00ff00
    s_mov_b32 exec_hi, 0xff00ff00
    v_mov_b32 v0, s47
    s_mov_b64 exec, -1
    s_waitcnt vmcnt(15) lgkmcnt(0)
    v_mfma_f32_16x16x32_bf16 v[20:23], v[56:59], v[16:19], 0
    v_max3_u32 v9, v16, v17, v18
    v_max_u32 v9, v9, v19
    v_cmp_eq_u32 vcc, -1, v9
    s_cbranch_vccnz prp_10
    s_nop 3
    v_add_f32_dpp v20, v20, v20 row_ror:8 row_mask:0xf bank_mask:0xf
    v_add_f32_dpp v21, v21, v21 row_ror:8 row_mask:0xf bank_mask:0xf
    v_add_f32_dpp v22, v22, v22 row_ror:8 row_mask:0xf bank_mask:0xf
    v_add_f32_dpp v23, v23, v23 row_ror:8 row_mask:0xf bank_mask:0xf
    v_cvt_pk_bf16_f32 v20, v20, v21
    v_cvt_pk_bf16_f32 v21, v22, v23
    s_mov_b32 exec_hi, 0
    v_min_u32 v20, -2, v20
    v_min_u32 v21, -2, v21
    s_mov_b32 exec_lo, 0x00ff00ff
    buffer_store_dwordx2 v[20:21], v13, s[4:7], s23 offen
    s_mov_b64 exec, -1
    s_branch ploop_6_pst
ploop_6_pnd:
    s_sleep 6
    s_nop 8
    buffer_load_dwordx4 v[16:19], v12, s[4:7], s30 offen sc1
    buffer_load_dword v15, off, s[4:7], s58 sc1
    s_add_u32 s22, s16, 1
    v_mov_b32 v60, s22
    v_mov_b32 v32, 0
    v_mov_b32 v33, 0
    v_mov_b32 v34, 0
    v_mov_b32 v35, 0
    v_mov_b32 v36, 0
    v_mov_b32 v37, 0
    v_mov_b32 v38, 0
    v_mov_b32 v39, 0
    v_mov_b32 v40, 0
    v_mov_b32 v41, 0
    v_mov_b32 v42, 0
    v_mov_b32 v43, 0
    v_mov_b32 v44, 0
    v_mov_b32 v45, 0
    v_mov_b32 v46, 0
    v_mov_b32 v47, 0
    v_mov_b32 v48, 0
    v_mov_b32 v49, 0
    v_mov_b32 v50, 0
    v_mov_b32 v51, 0
    v_mov_b32 v52, 0
    v_mov_b32 v53, 0
    v_mov_b32 v54, 0
    v_mov_b32 v55, 0
    v_mov_b32 v0, 1.0
    s_mov_b32 exec_lo, 0xff00ff00
    s_mov_b32 exec_hi, 0xff00ff00
    v_mov_b32 v0, s47
    s_mov_b64 exec, -1
ploop_6_pagain:
    s_waitcnt vmcnt(1) lgkmcnt(0)
    v_mfma_f32_16x16x32_bf16 v[20:23], v[56:59], v[16:19], 0
    v_max3_u32 v9, v16, v17, v18
    v_max_u32 v9, v9, v19
    v_cmp_eq_u32 vcc, -1, v9
    s_cbranch_vccnz prp_10
ploop_6_pgo:
    s_nop 3
    v_add_f32_dpp v20, v20, v20 row_ror:8 row_mask:0xf bank_mask:0xf
    v_add_f32_dpp v21, v21, v21 row_ror:8 row_mask:0xf bank_mask:0xf
    v_add_f32_dpp v22, v22, v22 row_ror:8 row_mask:0xf bank_mask:0xf
    v_add_f32_dpp v23, v23, v23 row_ror:8 row_mask:0xf bank_mask:0xf
    v_cvt_pk_bf16_f32 v20, v20, v21
    v_cvt_pk_bf16_f32 v21, v22, v23
    s_mov_b32 exec_hi, 0
    v_min_u32 v20, -2, v20
    v_min_u32 v21, -2, v21
    s_mov_b32 exec_lo, 0x00ff00ff
    buffer_store_dwordx2 v[20:21], v13, s[4:7], s23 offen
    s_mov_b64 exec, -1
ploop_6_pst:
    s_add_u32 s22, s19, s32
    s_add_u32 s25, s20, s36
    buffer_store_dword v10, v2, s[4:7], s22 offen
    s_mov_b32 exec_hi, 0
    buffer_store_dword v10, v3, s[4:7], s22 offen
    s_mov_b32 exec_lo, 0x00ff00ff
    buffer_store_dwordx2 v[10:11], v13, s[4:7], s25 offen
    s_mov_b64 exec, -1
    s_add_u32 s16, s16, 1
    s_mov_b32 s17, s18
    s_mov_b32 s18, s19
    s_mov_b32 s19, s20
    s_add_u32 s20, s20, 262144
    s_cmp_eq_u32 s20, 210763776
    s_cselect_b32 s20, 209715200, s20
    s_branch ploop_6
prm_9_gt:
gate_13:
    v_readfirstlane_b32 s25, v15
    s_cmp_ge_u32 s25, s59
    s_cbranch_scc1 gate_13_ok
    s_sleep 8
    buffer_load_dword v15, off, s[4:7], s58 sc1
    s_waitcnt vmcnt(0)
    s_sub_u32 s26, s26, 1
    s_cbranch_scc0 gate_13
    s_mov_b32 s26, 0
gate_13_ok:
    s_branch prm_9_gtb
prm_9_0:
    s_sub_u32 s26, s26, 1
    s_cbranch_scc1 prm_9_0_g
    buffer_load_dwordx4 v[16:19], v1, s[4:7], s21 offen offset:0 sc1
    buffer_load_dwordx4 v[20:23], v1, s[4:7], s21 offen offset:1024 sc1
    buffer_load_dwordx4 v[24:27], v1, s[4:7], s21 offen offset:2048 sc1
    buffer_load_dwordx4 v[28:31], v1, s[4:7], s21 offen offset:3072 sc1
    s_waitcnt vmcnt(3)
    v_max3_u32 v9, v16, v17, v18
    v_max_u32 v9, v9, v19
    v_cmp_eq_u32 vcc, -1, v9
    s_cbranch_vccnz prm_9_0
    s_branch prm_9_0ok
prm_9_0_g:
    s_mov_b32 s26, 0
    s_waitcnt vmcnt(0)
    s_branch prm_9_0ok
prm_9_1:
    s_sub_u32 s26, s26, 1
    s_cbranch_scc1 prm_9_1_g
    buffer_load_dwordx4 v[20:23], v1, s[4:7], s21 offen offset:1024 sc1
    buffer_load_dwordx4 v[24:27], v1, s[4:7], s21 offen offset:2048 sc1
    buffer_load_dwordx4 v[28:31], v1, s[4:7], s21 offen offset:3072 sc1
    s_waitcnt vmcnt(2)
    v_max3_u32 v9, v20, v21, v22
    v_max_u32 v9, v9, v23
    v_cmp_eq_u32 vcc, -1, v9
    s_cbranch_vccnz prm_9_1
    s_branch prm_9_1ok
prm_9_1_g:
    s_mov_b32 s26, 0
    s_waitcnt vmcnt(0)
    s_branch prm_9_1ok
prm_9_2:
    s_sub_u32 s26, s26, 1
    s_cbranch_scc1 prm_9_2_g
    buffer_load_dwordx4 v[24:27], v1, s[4:7], s21 offen offset:2048 sc1
    buffer_load_dwordx4 v[28:31], v1, s[4:7], s21 offen offset:3072 sc1
    s_waitcnt vmcnt(1)
    v_max3_u32 v9, v24, v25, v26
    v_max_u32 v9, v9, v27
    v_cmp_eq_u32 vcc, -1, v9
    s_cbranch_vccnz prm_9_2
    s_branch prm_9_2ok
prm_9_2_g:
    s_mov_b32 s26, 0
    s_waitcnt vmcnt(0)
    s_branch prm_9_2ok
prm_9_3:
    s_sub_u32 s26, s26, 1
    s_cbranch_scc1 prm_9_3_g
    buffer_load_dwordx4 v[28:31], v1, s[4:7], s21 offen offset:3072 sc1
    s_waitcnt vmcnt(0)
    v_max3_u32 v9, v28, v29, v30
    v_max_u32 v9, v9, v31
    v_cmp_eq_u32 vcc, -1, v9
    s_cbranch_vccnz prm_9_3
    s_branch prm_9_3ok
prm_9_3_g:
    s_mov_b32 s26, 0
    s_waitcnt vmcnt(0)
    s_branch prm_9_3ok
prm_9_d:
gate_14:
    v_readfirstlane_b32 s25, v15
    s_cmp_ge_u32 s25, s59
    s_cbranch_scc1 gate_14_ok
    s_sleep 8
    buffer_load_dword v15, off, s[4:7], s58 sc1
    s_waitcnt vmcnt(0)
    s_sub_u32 s26, s26, 1
    s_cbranch_scc0 gate_14
    s_mov_b32 s26, 0
gate_14_ok:
    ds_write_b32 v14, v60
    v_add_f32 v32, v32, v33
    v_add_f32 v34, v34, v35
    ds_write2_b32 v4, v32, v34 offset0:0 offset1:104
    v_add_f32 v36, v36, v37
    v_add_f32 v38, v38, v39
    ds_write2_b32 v4, v36, v38 offset0:16 offset1:120
    v_add_f32 v40, v40, v41
    v_add_f32 v42, v42, v43
    ds_write2_b32 v4, v40, v42 offset0:32 offset1:136
    v_add_f32 v44, v44, v45
    v_add_f32 v46, v46, v47
    ds_write2_b32 v4, v44, v46 offset0:48 offset1:152
    v_add_f32 v48, v48, v49
    v_add_f32 v50, v50, v51
    ds_write2_b32 v4, v48, v50 offset0:64 offset1:168
    v_add_f32 v52, v52, v53
    v_add_f32 v54, v54, v55
    ds_write2_b32 v4, v52, v54 offset0:80 offset1:184
    s_branch pnc_7_done
prp_10:
    s_sub_u32 s26, s26, 1
    s_nop 3
    s_cbranch_scc1 prp_10_g
    buffer_load_dwordx4 v[16:19], v12, s[4:7], s30 offen sc1
    buffer_load_dword v15, off, s[4:7], s58 sc1
    s_branch ploop_6_pagain
prp_10_g:
    s_mov_b32 s26, 0
    s_branch ploop_6_pgo
ploop_6_zr:
    s_sub_u32 s26, s26, 1
    s_cbranch_scc1 ploop_6_zg
    buffer_load_dwordx4 v[32:35], v1, s[4:7], s22 offen offset:0 sc1
    buffer_load_dwordx4 v[36:39], v1, s[4:7], s22 offen offset:1024 sc1
    buffer_load_dwordx4 v[40:43], v1, s[4:7], s22 offen offset:2048 sc1
    buffer_load_dwordx4 v[44:47], v1, s[4:7], s22 offen offset:3072 sc1
    s_branch ploop_6_za
ploop_6_zg:
    s_mov_b32 s26, 0
    s_branch ploop_6_zok
ptail_8:
    s_cmp_eq_u32 s15, 0
    s_cbranch_scc1 ptail_8_nd
    s_nop 0
ptail_8_nd:
    s_barrier
    v_add_u32 v55, s68, v61
    ds_read_b128 v[24:27], v55 offset:0
    ds_read_b128 v[28:31], v55 offset:1024
    ds_read_b128 v[32:35], v55 offset:18560
    ds_read_b128 v[36:39], v55 offset:19584
    ds_read_b128 v[40:43], v55 offset:37120
    ds_read_b128 v[44:47], v55 offset:38144
    ds_read_b128 v[48:51], v55 offset:55680
    ds_read_b128 v[52:55], v55 offset:56704
    s_waitcnt lgkmcnt(4)
    v_add_f32 v24, v24, v32
    v_add_f32 v25, v25, v33
    v_add_f32 v26, v26, v34
    v_add_f32 v27, v27, v35
    v_add_f32 v28, v28, v36
    v_add_f32 v29, v29, v37
    v_add_f32 v30, v30, v38
    v_add_f32 v31, v31, v39
    s_waitcnt lgkmcnt(0)
    v_add_f32 v40, v40, v48
    v_add_f32 v41, v41, v49
    v_add_f32 v42, v42, v50
    v_add_f32 v43, v43, v51
    v_add_f32 v44, v44, v52
    v_add_f32 v45, v45, v53
    v_add_f32 v46, v46, v54
    v_add_f32 v47, v47, v55
    v_add_f32 v24, v24, v40
    v_add_f32 v25, v25, v41
    v_add_f32 v26, v26, v42
    v_add_f32 v27, v27, v43
    v_add_f32 v28, v28, v44
    v_add_f32 v29, v29, v45
    v_add_f32 v30, v30, v46
    v_add_f32 v31, v31, v47
    v_cvt_pk_bf16_f32 v24, v24, v25
    v_cvt_pk_bf16_f32 v25, v26, v27
    v_cvt_pk_bf16_f32 v26, v28, v29
    v_cvt_pk_bf16_f32 v27, v30, v31
    v_min_u32 v24, -2, v24
    v_min_u32 v25, -2, v25
    v_min_u32 v26, -2, v26
    v_min_u32 v27, -2, v27
    buffer_store_dwordx4 v[24:27], v1, s[4:7], s37 offen sc1
    s_branch k_end
ch_p_slow:
    v_mov_b32 v32, 0
    v_mov_b32 v33, 0
    v_mov_b32 v34, 0
    v_mov_b32 v35, 0
    v_mov_b32 v36, 0
    v_mov_b32 v37, 0
    v_mov_b32 v38, 0
    v_mov_b32 v39, 0
    v_mov_b32 v40, 0
    v_mov_b32 v41, 0
    v_mov_b32 v42, 0
    v_mov_b32 v43, 0
    v_mov_b32 v44, 0
    v_mov_b32 v45, 0
    v_mov_b32 v46, 0
    v_mov_b32 v47, 0
    v_mov_b32 v48, 0
    v_mov_b32 v49, 0
    v_mov_b32 v50, 0
    v_mov_b32 v51, 0
    v_mov_b32 v52, 0
    v_mov_b32 v53, 0
    v_mov_b32 v54, 0
    v_mov_b32 v55, 0
    v_mov_b32 v0, 1.0
    s_mov_b32 exec_lo, 0xff00ff00
    s_mov_b32 exec_hi, 0xff00ff00
    v_mov_b32 v0, s47
    s_mov_b64 exec, -1
    v_mov_b32 v60, s16
    v_smfmac_f32_16x16x64_bf16 v[32:35], v[16:19], v[64:71], v62
    v_smfmac_f32_16x16x64_bf16 v[36:39], v[16:19], v[72:79], v62
    v_smfmac_f32_16x16x64_bf16 v[40:43], v[16:19], v[80:87], v62
    v_smfmac_f32_16x16x64_bf16 v[44:47], v[16:19], v[88:95], v62
    v_smfmac_f32_16x16x64_bf16 v[48:51], v[16:19], v[96:103], v62
    v_smfmac_f32_16x16x64_bf16 v[52:55], v[16:19], v[104:111], v62
    v_smfmac_f32_16x16x64_bf16 v[32:35], v[20:23], v[112:119], v62
    v_smfmac_f32_16x16x64_bf16 v[36:39], v[20:23], v[120:127], v62
    v_smfmac_f32_16x16x64_bf16 v[40:43], v[20:23], v[128:135], v62
    v_smfmac_f32_16x16x64_bf16 v[44:47], v[20:23], v[136:143], v62
    v_smfmac_f32_16x16x64_bf16 v[48:51], v[20:23], v[144:151], v62
    v_smfmac_f32_16x16x64_bf16 v[52:55], v[20:23], v[152:159], v62
    v_smfmac_f32_16x16x64_bf16 v[32:35], v[24:27], v[160:167], v62
    v_smfmac_f32_16x16x64_bf16 v[36:39], v[24:27], v[168:175], v62
    v_smfmac_f32_16x16x64_bf16 v[40:43], v[24:27], v[176:183], v62
    v_smfmac_f32_16x16x64_bf16 v[44:47], v[24:27], v[184:191], v62
    v_smfmac_f32_16x16x64_bf16 v[48:51], v[24:27], v[192:199], v62
    v_smfmac_f32_16x16x64_bf16 v[52:55], v[24:27], v[200:207], v62
    v_smfmac_f32_16x16x64_bf16 v[32:35], v[28:31], v[208:215], v62
    ds_write_b32 v14, v60
    v_smfmac_f32_16x16x64_bf16 v[36:39], v[28:31], v[216:223], v62
    v_smfmac_f32_16x16x64_bf16 v[40:43], v[28:31], v[224:231], v62
    v_smfmac_f32_16x16x64_bf16 v[44:47], v[28:31], v[232:239], v62
    v_add_f32 v32, v32, v33
    v_add_f32 v34, v34, v35
    v_smfmac_f32_16x16x64_bf16 v[48:51], v[28:31], v[240:247], v62
    v_add_f32 v36, v36, v37
    v_add_f32 v38, v38, v39
    ds_write2_b32 v4, v32, v34 offset0:0 offset1:104
    v_smfmac_f32_16x16x64_bf16 v[52:55], v[28:31], v[248:255], v62
    v_add_f32 v40, v40, v41
    v_add_f32 v42, v42, v43
    ds_write2_b32 v4, v36, v38 offset0:16 offset1:120
    v_add_f32 v44, v44, v45
    v_add_f32 v46, v46, v47
    ds_write2_b32 v4, v40, v42 offset0:32 offset1:136
    v_add_f32 v48, v48, v49
    v_add_f32 v50, v50, v51
    ds_write2_b32 v4, v44, v46 offset0:48 offset1:152
    v_add_f32 v52, v52, v53
    v_add_f32 v54, v54, v55
    ds_write2_b32 v4, v48, v50 offset0:64 offset1:168
    ds_write2_b32 v4, v52, v54 offset0:80 offset1:184
    s_waitcnt vmcnt(0)
    s_branch pnc_16_done
.p2align 6
    s_nop 0
    s_nop 0
    s_nop 0
    s_nop 0
    s_nop 0
    s_nop 0
    s_nop 0
    s_nop 0
ploop_15:
    s_add_u32 s21, s17, s33
    s_nop 15
    s_nop 5
    buffer_load_dwordx4 v[16:19], v1, s[4:7], s21 offen offset:0 sc1
    s_nop 7
    buffer_load_dwordx4 v[20:23], v1, s[4:7], s21 offen offset:1024 sc1
    s_nop 7
    buffer_load_dwordx4 v[24:27], v1, s[4:7], s21 offen offset:2048 sc1
    s_nop 7
    buffer_load_dwordx4 v[28:31], v1, s[4:7], s21 offen offset:3072 sc1
    s_waitcnt vmcnt(3)
    v_max3_u32 v9, v16, v17, v18
    v_max_u32 v9, v9, v19
    v_cmp_eq_u32 vcc, -1, v9
    s_cbranch_vccnz prm_18_0
prm_18_0ok:
    v_smfmac_f32_16x16x64_bf16 v[32:35], v[16:19], v[64:71], v62
    v_smfmac_f32_16x16x64_bf16 v[36:39], v[16:19], v[72:79], v62
    v_smfmac_f32_16x16x64_bf16 v[40:43], v[16:19], v[80:87], v62
    s_waitcnt vmcnt(2)
    v_max3_u32 v9, v20, v21, v22
    v_max_u32 v9, v9, v23
    v_cmp_eq_u32 vcc, -1, v9
    v_smfmac_f32_16x16x64_bf16 v[44:47], v[16:19], v[88:95], v62
    v_smfmac_f32_16x16x64_bf16 v[48:51], v[16:19], v[96:103], v62
    v_smfmac_f32_16x16x64_bf16 v[52:55], v[16:19], v[104:111], v62
    s_cbranch_vccnz prm_18_1
prm_18_1ok:
    v_smfmac_f32_16x16x64_bf16 v[32:35], v[20:23], v[112:119], v62
    v_readfirstlane_b32 s23, v15
    v_smfmac_f32_16x16x64_bf16 v[36:39], v[20:23], v[120:127], v62
    v_smfmac_f32_16x16x64_bf16 v[40:43], v[20:23], v[128:135], v62
    s_waitcnt vmcnt(1)
    v_max3_u32 v9, v24, v25, v26
    v_max_u32 v9, v9, v27
    v_cmp_eq_u32 vcc, -1, v9
    v_smfmac_f32_16x16x64_bf16 v[44:47], v[20:23], v[136:143], v62
    v_smfmac_f32_16x16x64_bf16 v[48:51], v[20:23], v[144:151], v62
    v_smfmac_f32_16x16x64_bf16 v[52:55], v[20:23], v[152:159], v62
    s_cbranch_vccnz prm_18_2
prm_18_2ok:
    v_smfmac_f32_16x16x64_bf16 v[32:35], v[24:27], v[160:167], v62
    v_smfmac_f32_16x16x64_bf16 v[36:39], v[24:27], v[168:175], v62
    v_smfmac_f32_16x16x64_bf16 v[40:43], v[24:27], v[176:183], v62
    s_waitcnt vmcnt(0)
    v_max3_u32 v9, v28, v29, v30
    v_max_u32 v9, v9, v31
    v_cmp_eq_u32 vcc, -1, v9
    v_smfmac_f32_16x16x64_bf16 v[44:47], v[24:27], v[184:191], v62
    v_smfmac_f32_16x16x64_bf16 v[48:51], v[24:27], v[192:199], v62
    v_smfmac_f32_16x16x64_bf16 v[52:55], v[24:27], v[200:207], v62
    s_cbranch_vccnz prm_18_3
prm_18_3ok:
    v_smfmac_f32_16x16x64_bf16 v[32:35], v[28:31], v[208:215], v62
    s_cmp_lt_u32 s23, s59
    s_cbranch_scc1 prm_18_gt
prm_18_gtb:
    ds_write_b32 v14, v60
    v_smfmac_f32_16x16x64_bf16 v[36:39], v[28:31], v[216:223], v62
    v_smfmac_f32_16x16x64_bf16 v[40:43], v[28:31], v[224:231], v62
    v_smfmac_f32_16x16x64_bf16 v[44:47], v[28:31], v[232:239], v62
    v_add_f32 v32, v32, v33
    v_add_f32 v34, v34, v35
    v_smfmac_f32_16x16x64_bf16 v[48:51], v[28:31], v[240:247], v62
    v_add_f32 v36, v36, v37
    v_add_f32 v38, v38, v39
    ds_write2_b32 v4, v32, v34 offset0:0 offset1:104
    v_smfmac_f32_16x16x64_bf16 v[52:55], v[28:31], v[248:255], v62
    v_add_f32 v40, v40, v41
    v_add_f32 v42, v42, v43
    ds_write2_b32 v4, v36, v38 offset0:16 offset1:120
    v_add_f32 v44, v44, v45
    v_add_f32 v46, v46, v47
    ds_write2_b32 v4, v40, v42 offset0:32 offset1:136
    v_add_f32 v48, v48, v49
    v_add_f32 v50, v50, v51
    ds_write2_b32 v4, v44, v46 offset0:48 offset1:152
    v_add_f32 v52, v52, v53
    v_add_f32 v54, v54, v55
    ds_write2_b32 v4, v48, v50 offset0:64 offset1:168
    ds_write2_b32 v4, v52, v54 offset0:80 offset1:184
pnc_16_done:
    s_add_u32 s21, s17, s32
    s_add_u32 s22, s19, s32
    s_add_u32 s24, s19, s35
    s_waitcnt lgkmcnt(0)
    s_barrier
    ds_read_b64 v[32:33], v5 offset:0
    ds_read_b64 v[34:35], v5 offset:3328
    ds_read_b64 v[36:37], v5 offset:6656
    ds_read_b64 v[38:39], v5 offset:9984
    ds_read_b64 v[40:41], v6 offset:0
    ds_read_b64 v[42:43], v6 offset:3328
    ds_read_b64 v[44:45], v6 offset:6656
    ds_read_b64 v[46:47], v6 offset:9984
    s_waitcnt lgkmcnt(6)
    v_add_f32 v32, v32, v34
    v_add_f32 v33, v33, v35
    v_mul_f32 v32, v32, v0
    v_mul_f32 v33, v33, v0
    s_waitcnt lgkmcnt(4)
    v_add_f32 v36, v36, v38
    v_add_f32 v37, v37, v39
    v_fma_f32 v32, v36, v0, v32
    v_fma_f32 v33, v37, v0, v33
    v_cvt_pk_bf16_f32 v32, v32, v33
    v_min_u32 v32, -2, v32
    buffer_store_dword v32, v2, s[4:7], s21 offen sc1
    s_waitcnt lgkmcnt(2)
    v_add_f32 v40, v40, v42
    v_add_f32 v41, v41, v43
    s_waitcnt lgkmcnt(0)
    v_add_f32 v44, v44, v46
    v_add_f32 v45, v45, v47
    v_add_f32 v40, v40, v44
    v_add_f32 v41, v41, v45
    v_cvt_pk_bf16_f32 v40, v40, v41
    v_min_u32 v40, -2, v40
    s_mov_b32 exec_hi, 0
    buffer_store_dword v40, v3, s[4:7], s21 offen sc1
    s_setprio 0
    s_mov_b64 exec, -1
    s_add_u32 s21, s17, s35
    s_add_u32 s30, s17, s34
    s_add_u32 s23, s18, s36
    s_cmp_lg_u32 s16, 0
    s_cbranch_scc1 ploop_15_n0
gate_20:
    v_readfirstlane_b32 s25, v15
    s_cmp_ge_u32 s25, s59
    s_cbranch_scc1 gate_20_ok
    s_sleep 8
    buffer_load_dword v15, off, s[4:7], s58 sc1
    s_waitcnt vmcnt(0)
    s_sub_u32 s26, s26, 1
    s_cbranch_scc0 gate_20
    s_mov_b32 s26, 0
gate_20_ok:
    s_cmp_eq_u32 s15, 0
    s_cbranch_scc1 ploop_15_st_nk
    s_add_u32 m0, s53, 0
    s_add_u32 s22, s52, 0
    buffer_load_dwordx4 v1, s[4:7], s22 offen offset:0 sc1 lds
    buffer_load_dwordx4 v1, s[4:7], s22 offen offset:1024 sc1 lds
    buffer_load_dwordx4 v1, s[4:7], s22 offen offset:2048 sc1 lds
    buffer_load_dwordx4 v1, s[4:7], s22 offen offset:3072 sc1 lds
    s_add_u32 m0, s53, 4096
    s_add_u32 s22, s52, 131072
    buffer_load_dwordx4 v1, s[4:7], s22 offen offset:0 sc1 lds
    buffer_load_dwordx4 v1, s[4:7], s22 offen offset:1024 sc1 lds
    buffer_load_dwordx4 v1, s[4:7], s22 offen offset:2048 sc1 lds
    buffer_load_dwordx4 v1, s[4:7], s22 offen offset:3072 sc1 lds
    s_add_u32 s52, s52, 262144
    s_sub_u32 s52, s52, 262144
ploop_15_st_nk:
    s_add_u32 s52, s52, 262144
    s_cmp_lg_u32 s3, 2
    s_cbranch_scc1 ploop_15_st_npf
    v_subrev_u32 v32, 786432, v63
    s_mov_b32 exec_hi, 0xffff
    s_mov_b32 s22, 262144
    buffer_load_dword v33, v32, s[4:7], s22 offen sc1
    s_mov_b32 s22, 524288
    buffer_load_dword v33, v32, s[4:7], s22 offen sc1
    s_mov_b32 exec_hi, -1
    s_waitcnt vmcnt(0)
ploop_15_st_npf:
    s_cmp_eq_u32 s15, 0
    s_cbranch_scc1 ploop_15_st_p_nd
    s_mov_b32 m0, 124928
    s_nop 0
    buffer_load_dwordx4 v1, s[4:7], s69 offen offset:0 sc1 lds
    buffer_load_dwordx4 v1, s[4:7], s69 offen offset:1024 sc1 lds
    buffer_load_dwordx4 v1, s[4:7], s69 offen offset:2048 sc1 lds
    buffer_load_dwordx4 v1, s[4:7], s69 offen offset:3072 sc1 lds
    s_add_u32 s69, s69, 262144
    s_waitcnt vmcnt(0)
ploop_15_st_p_nd:
ploop_15_n0:
    s_add_u32 s25, s16, 2
    s_min_u32 s25, s25, 63
    s_cmp_lt_u32 s25, 8
    s_cselect_b32 s59, 12, 24
    s_cselect_b32 s58, -4, -8
    s_and_b32 s25, s25, s58
    s_lshl_b32 s25, s25, 5
    s_add_u32 s58, s25, s60
    s_cmp_eq_u32 s15, 0
    s_cbranch_scc1 ploop_15_nd
    v_add_u32 v9, s53, v1
    v_add_u32 v0, 124928, v1
    ds_read_b128 v[16:19], v0 offset:0
    ds_read_b128 v[32:35], v9 offset:0
    ds_read_b128 v[20:23], v0 offset:1024
    ds_read_b128 v[36:39], v9 offset:1024
    ds_read_b128 v[24:27], v0 offset:2048
    ds_read_b128 v[40:43], v9 offset:2048
    ds_read_b128 v[28:31], v0 offset:3072
    ds_read_b128 v[44:47], v9 offset:3072
    s_add_u32 s22, s17, s61
    s_waitcnt lgkmcnt(6)
    v_mfma_f32_16x16x32_bf16 v[48:51], v[32:35], v[16:19], 0
    ds_read_b128 v[32:35], v9 offset:4096
    s_waitcnt lgkmcnt(5)
    v_mfma_f32_16x16x32_bf16 v[48:51], v[36:39], v[20:23], v[48:51]
    ds_read_b128 v[36:39], v9 offset:5120
    s_waitcnt lgkmcnt(4)
    v_mfma_f32_16x16x32_bf16 v[48:51], v[40:43], v[24:27], v[48:51]
    ds_read_b128 v[40:43], v9 offset:6144
    s_waitcnt lgkmcnt(3)
    v_mfma_f32_16x16x32_bf16 v[48:51], v[44:47], v[28:31], v[48:51]
    ds_read_b128 v[44:47], v9 offset:7168
    s_waitcnt lgkmcnt(3)
    v_mfma_f32_16x16x32_bf16 v[52:55], v[32:35], v[16:19], 0
    s_waitcnt lgkmcnt(2)
    v_mfma_f32_16x16x32_bf16 v[52:55], v[36:39], v[20:23], v[52:55]
    s_waitcnt lgkmcnt(1)
    v_mfma_f32_16x16x32_bf16 v[52:55], v[40:43], v[24:27], v[52:55]
    s_waitcnt lgkmcnt(0)
    v_mfma_f32_16x16x32_bf16 v[52:55], v[44:47], v[28:31], v[52:55]
    buffer_load_dwordx4 v[32:35], v1, s[4:7], s22 offen offset:0 sc1
    buffer_load_dwordx4 v[36:39], v1, s[4:7], s22 offen offset:1024 sc1
    buffer_load_dwordx4 v[40:43], v1, s[4:7], s22 offen offset:2048 sc1
    buffer_load_dwordx4 v[44:47], v1, s[4:7], s22 offen offset:3072 sc1
    v_mov_b32 v60, 0xff61b1e6
    s_nop 2
    v_cndmask_b32 v48, v48, v60, s[38:39]
    v_cndmask_b32 v49, v49, v60, s[40:41]
    v_cndmask_b32 v50, v50, v60, s[42:43]
    v_cndmask_b32 v51, v51, v60, s[44:45]
    v_cndmask_b32 v52, v52, v60, s[48:49]
    v_cndmask_b32 v53, v53, v60, s[50:51]
    v_cndmask_b32 v54, v54, v60, s[54:55]
    v_cndmask_b32 v55, v55, v60, s[56:57]
    v_max3_f32 v0, v48, v49, v50
    v_max3_f32 v9, v51, v52, v53
    v_max3_f32 v0, v0, v54, v55
    v_max_f32 v0, v0, v9
    v_mov_b32 v9, v0
    s_nop 1
    v_permlane16_swap_b32 v9, v0
    v_max_f32 v0, v0, v9
    v_mov_b32 v9, v0
    s_nop 1
    v_permlane32_swap_b32 v9, v0
    v_max_f32 v0, v0, v9
    v_mul_f32 v0, s47, v0
    v_fma_f32 v48, v48, s47, -v0
    v_fma_f32 v49, v49, s47, -v0
    v_fma_f32 v50, v50, s47, -v0
    v_fma_f32 v51, v51, s47, -v0
    v_fma_f32 v52, v52, s47, -v0
    v_fma_f32 v53, v53, s47, -v0
    v_fma_f32 v54, v54, s47, -v0
    v_fma_f32 v55, v55, s47, -v0
    v_exp_f32 v48, v48
    v_exp_f32 v49, v49
    v_exp_f32 v50, v50
    v_exp_f32 v51, v51
    v_exp_f32 v52, v52
    v_exp_f32 v53, v53
    v_exp_f32 v54, v54
    v_exp_f32 v55, v55
    v_add_f32 v15, v48, v49
    v_add_f32 v15, v15, v50
    v_add_f32 v15, v15, v51
    v_add_f32 v15, v15, v52
    v_add_f32 v15, v15, v53
    v_add_f32 v15, v15, v54
    v_add_f32 v15, v15, v55
ploop_15_za:
    s_waitcnt vmcnt(0)
    v_max3_u32 v9, v32, v33, v34
    v_max3_u32 v9, v9, v35, v36
    v_max3_u32 v9, v9, v37, v38
    v_max3_u32 v9, v9, v39, v40
    v_max3_u32 v9, v9, v41, v42
    v_max3_u32 v9, v9, v43, v44
    v_max3_u32 v9, v9, v45, v46
    v_max_u32 v9, v9, v47
    v_cmp_eq_u32 vcc, -1, v9
    s_cbranch_vccnz ploop_15_zr
ploop_15_zok:
    v_mfma_f32_16x16x32_bf16 v[56:59], v[32:35], v[16:19], 0
    v_mfma_f32_16x16x32_bf16 v[56:59], v[36:39], v[20:23], v[56:59]
    v_mfma_f32_16x16x32_bf16 v[56:59], v[40:43], v[24:27], v[56:59]
    v_mfma_f32_16x16x32_bf16 v[56:59], v[44:47], v[28:31], v[56:59]
    s_add_u32 s22, s17, s14
    s_nop 6
    v_max_f32 v60, v56, v57
    v_mov_b32 v9, v60
    s_nop 1
    v_permlane16_swap_b32 v9, v60
    v_max_f32 v60, v60, v9
    v_mov_b32 v9, v60
    s_nop 1
    v_permlane32_swap_b32 v9, v60
    v_max_f32 v60, v60, v9
    v_mul_f32 v60, s47, v60
    v_max_f32 v58, v60, v0
    v_sub_f32 v60, v0, v58
    v_fma_f32 v56, v56, s47, -v58
    v_fma_f32 v57, v57, s47, -v58
    v_exp_f32 v60, v60
    v_exp_f32 v56, v56
    v_exp_f32 v57, v57
    v_fma_f32 v15, v15, v60, v56
    v_add_f32 v15, v15, v57
    v_mov_b32 v9, v15
    s_nop 1
    v_permlane16_swap_b32 v9, v15
    v_add_f32 v15, v15, v9
    v_mov_b32 v9, v15
    s_nop 1
    v_permlane32_swap_b32 v9, v15
    v_add_f32 v15, v15, v9
    v_rcp_f32 v15, v15
    s_add_u32 s25, s19, s14
    v_mul_f32 v56, v56, v15
    v_mul_f32 v57, v57, v15
    v_mul_f32 v60, v60, v15
    v_mul_f32 v48, v48, v60
    v_mul_f32 v49, v49, v60
    v_mul_f32 v50, v50, v60
    v_mul_f32 v51, v51, v60
    v_mul_f32 v52, v52, v60
    v_mul_f32 v53, v53, v60
    v_mul_f32 v54, v54, v60
    v_mul_f32 v55, v55, v60
    v_cvt_pk_bf16_f32 v48, v48, v49
    v_cvt_pk_bf16_f32 v49, v50, v51
    v_cvt_pk_bf16_f32 v50, v52, v53
    v_cvt_pk_bf16_f32 v51, v54, v55
    v_min_u32 v48, -2, v48
    v_min_u32 v49, -2, v49
    v_min_u32 v50, -2, v50
    v_min_u32 v51, -2, v51
    v_lshlrev_b32 v54, 1, v8
    v_add_u32 v55, 14336, v1
    v_mov_b32 v53, 1.0
    v_cvt_pk_bf16_f32 v52, v56, v57
    v_min_u32 v53, -2, v53
    v_min_u32 v52, -2, v52
    buffer_store_dwordx4 v[48:51], v1, s[4:7], s22 offen sc1
    buffer_store_dwordx2 v[52:53], v54, s[4:7], s22 offen offset:1024 sc1
    ds_read_b128 v[56:59], v55
    s_branch ploop_15_nd2
ploop_15_nd:
    s_cmp_eq_u32 s16, 0
    s_cbranch_scc1 ploop_15_ns
    s_cmp_eq_u32 s31, 0
    s_cbranch_scc1 ploop_15_n2
    s_add_u32 s25, s68, s46
    v_add_u32 v55, s25, v61
    ds_read_b128 v[24:27], v55 offset:0
    ds_read_b128 v[28:31], v55 offset:1024
    ds_read_b128 v[32:35], v55 offset:18560
    ds_read_b128 v[36:39], v55 offset:19584
    ds_read_b128 v[40:43], v55 offset:37120
    ds_read_b128 v[44:47], v55 offset:38144
    ds_read_b128 v[48:51], v55 offset:55680
    ds_read_b128 v[52:55], v55 offset:56704
    s_waitcnt lgkmcnt(4)
    v_add_f32 v24, v24, v32
    v_add_f32 v25, v25, v33
    v_add_f32 v26, v26, v34
    v_add_f32 v27, v27, v35
    v_add_f32 v28, v28, v36
    v_add_f32 v29, v29, v37
    v_add_f32 v30, v30, v38
    v_add_f32 v31, v31, v39
    s_waitcnt lgkmcnt(0)
    v_add_f32 v40, v40, v48
    v_add_f32 v41, v41, v49
    v_add_f32 v42, v42, v50
    v_add_f32 v43, v43, v51
    v_add_f32 v44, v44, v52
    v_add_f32 v45, v45, v53
    v_add_f32 v46, v46, v54
    v_add_f32 v47, v47, v55
    v_add_f32 v24, v24, v40
    v_add_f32 v25, v25, v41
    v_add_f32 v26, v26, v42
    v_add_f32 v27, v27, v43
    v_add_f32 v28, v28, v44
    v_add_f32 v29, v29, v45
    v_add_f32 v30, v30, v46
    v_add_f32 v31, v31, v47
    v_cvt_pk_bf16_f32 v24, v24, v25
    v_cvt_pk_bf16_f32 v25, v26, v27
    v_cvt_pk_bf16_f32 v26, v28, v29
    v_cvt_pk_bf16_f32 v27, v30, v31
    v_min_u32 v24, -2, v24
    v_min_u32 v25, -2, v25
    v_min_u32 v26, -2, v26
    v_min_u32 v27, -2, v27
    v_mov_b32 v16, v24
    v_mov_b32 v17, v25
    v_mov_b32 v18, v26
    v_mov_b32 v19, v27
ploop_15_n2:
    v_add_u32 v55, s68, v61
    ds_read_b128 v[24:27], v55 offset:0
    ds_read_b128 v[28:31], v55 offset:1024
    ds_read_b128 v[32:35], v55 offset:18560
    ds_read_b128 v[36:39], v55 offset:19584
    ds_read_b128 v[40:43], v55 offset:37120
    ds_read_b128 v[44:47], v55 offset:38144
    ds_read_b128 v[48:51], v55 offset:55680
    ds_read_b128 v[52:55], v55 offset:56704
    s_waitcnt lgkmcnt(4)
    v_add_f32 v24, v24, v32
    v_add_f32 v25, v25, v33
    v_add_f32 v26, v26, v34
    v_add_f32 v27, v27, v35
    v_add_f32 v28, v28, v36
    v_add_f32 v29, v29, v37
    v_add_f32 v30, v30, v38
    v_add_f32 v31, v31, v39
    s_waitcnt lgkmcnt(0)
    v_add_f32 v40, v40, v48
    v_add_f32 v41, v41, v49
    v_add_f32 v42, v42, v50
    v_add_f32 v43, v43, v51
    v_add_f32 v44, v44, v52
    v_add_f32 v45, v45, v53
    v_add_f32 v46, v46, v54
    v_add_f32 v47, v47, v55
    v_add_f32 v24, v24, v40
    v_add_f32 v25, v25, v41
    v_add_f32 v26, v26, v42
    v_add_f32 v27, v27, v43
    v_add_f32 v28, v28, v44
    v_add_f32 v29, v29, v45
    v_add_f32 v30, v30, v46
    v_add_f32 v31, v31, v47
    v_cvt_pk_bf16_f32 v24, v24, v25
    v_cvt_pk_bf16_f32 v25, v26, v27
    v_cvt_pk_bf16_f32 v26, v28, v29
    v_cvt_pk_bf16_f32 v27, v30, v31
    v_min_u32 v24, -2, v24
    v_min_u32 v25, -2, v25
    v_min_u32 v26, -2, v26
    v_min_u32 v27, -2, v27
ploop_15_ns:
ploop_15_flag:
    ds_read_b32 v9, v14 offset:16
    s_waitcnt lgkmcnt(0)
    v_readfirstlane_b32 s25, v9
    s_cmp_eq_u32 s25, s16
    s_cbranch_scc0 ploop_15_flag
    s_add_u32 m0, s53, 0
    s_add_u32 s22, s52, 0
    buffer_load_dwordx4 v1, s[4:7], s22 offen offset:0 sc1 lds
    buffer_load_dwordx4 v1, s[4:7], s22 offen offset:1024 sc1 lds
    buffer_load_dwordx4 v1, s[4:7], s22 offen offset:2048 sc1 lds
    buffer_load_dwordx4 v1, s[4:7], s22 offen offset:3072 sc1 lds
    s_add_u32 m0, s53, 4096
    s_add_u32 s22, s52, 131072
    buffer_load_dwordx4 v1, s[4:7], s22 offen offset:0 sc1 lds
    buffer_load_dwordx4 v1, s[4:7], s22 offen offset:1024 sc1 lds
    buffer_load_dwordx4 v1, s[4:7], s22 offen offset:2048 sc1 lds
    buffer_load_dwordx4 v1, s[4:7], s22 offen offset:3072 sc1 lds
    s_add_u32 s52, s52, 262144
ploop_15_nk:
    s_cmp_eq_u32 s16, 0
    s_cbranch_scc1 ploop_15_nd2
    buffer_store_dwordx4 v[24:27], v1, s[4:7], s37 offen sc1
    s_cmp_eq_u32 s31, 0
    s_cbranch_scc1 ploop_15_nd2
    s_add_u32 s25, s37, s27
    buffer_store_dwordx4 v[16:19], v1, s[4:7], s25 offen sc1
ploop_15_nd2:
    s_cmp_eq_u32 s16, 0
    s_cbranch_scc1 ploop_15_nn
    s_add_u32 s37, s37, 65536
    s_xor_b32 s68, s68, 8192
ploop_15_nn:
    s_cmp_lg_u32 s3, 2
    s_cbranch_scc1 ppf_21
    s_lshl_b32 s22, s16, 18
    s_mov_b32 exec_hi, 0xffff
    buffer_load_dword v9, v63, s[4:7], s22 offen sc1
    s_mov_b32 exec_hi, -1
ppf_21:
    v_add_u32 v24, 18560, v7
    v_add_u32 v25, 37120, v7
    v_add_u32 v26, 55680, v7
    s_cmp_eq_u32 s16, 63
    s_setprio 3
    s_barrier
    s_cbranch_scc1 ptail_17
    ds_read2_b32 v[16:17], v7 offset0:0 offset1:2
    ds_read2_b32 v[18:19], v24 offset0:0 offset1:2
    ds_read2_b32 v[20:21], v25 offset0:0 offset1:2
    ds_read2_b32 v[22:23], v26 offset0:0 offset1:2
    s_waitcnt lgkmcnt(2)
    v_add_f32 v16, v16, v18
    v_add_f32 v17, v17, v19
    s_waitcnt lgkmcnt(0)
    v_add_f32 v20, v20, v22
    v_add_f32 v21, v21, v23
    v_add_f32 v16, v16, v20
    v_add_f32 v17, v17, v21
    v_cvt_pk_bf16_f32 v16, v16, v17
    v_min_u32 v16, -2, v16
    buffer_store_dword v16, v2, s[4:7], s21 offen sc1
    buffer_store_dword v10, v2, s[4:7], s24 offen sc1
    s_cmp_eq_u32 s15, 0
    s_cbranch_scc1 ploop_15_pnd
    s_sleep 6
    s_nop 8
    buffer_load_dwordx4 v[16:19], v12, s[4:7], s30 offen sc1
    buffer_load_dword v15, off, s[4:7], s58 sc1
    s_add_u32 s25, s19, s14
    v_mov_b32 v20, -1
    v_mov_b32 v21, -1
    v_mov_b32 v22, -1
    v_mov_b32 v23, -1
    buffer_store_dwordx4 v[20:23], v1, s[4:7], s25 offen sc1
    buffer_store_dwordx2 v[20:21], v54, s[4:7], s25 offen offset:1024 sc1
    s_mov_b32 m0, 124928
    s_nop 0
    buffer_load_dwordx4 v1, s[4:7], s69 offen offset:0 sc1 lds
    buffer_load_dwordx4 v1, s[4:7], s69 offen offset:1024 sc1 lds
    buffer_load_dwordx4 v1, s[4:7], s69 offen offset:2048 sc1 lds
    buffer_load_dwordx4 v1, s[4:7], s69 offen offset:3072 sc1 lds
    s_add_u32 s69, s69, 262144
    s_add_u32 m0, s53, 0
    s_add_u32 s22, s52, 0
    buffer_load_dwordx4 v1, s[4:7], s22 offen offset:0 sc1 lds
    buffer_load_dwordx4 v1, s[4:7], s22 offen offset:1024 sc1 lds
    buffer_load_dwordx4 v1, s[4:7], s22 offen offset:2048 sc1 lds
    buffer_load_dwordx4 v1, s[4:7], s22 offen offset:3072 sc1 lds
    s_add_u32 m0, s53, 4096
    s_add_u32 s22, s52, 131072
    buffer_load_dwordx4 v1, s[4:7], s22 offen offset:0 sc1 lds
    buffer_load_dwordx4 v1, s[4:7], s22 offen offset:1024 sc1 lds
    buffer_load_dwordx4 v1, s[4:7], s22 offen offset:2048 sc1 lds
    buffer_load_dwordx4 v1, s[4:7], s22 offen offset:3072 sc1 lds
    s_add_u32 s52, s52, 262144
    s_add_u32 s22, s16, 1
    v_mov_b32 v60, s22
    v_mov_b32 v32, 0
    v_mov_b32 v33, 0
    v_mov_b32 v34, 0
    v_mov_b32 v35, 0
    v_mov_b32 v36, 0
    v_mov_b32 v37, 0
    v_mov_b32 v38, 0
    v_mov_b32 v39, 0
    v_mov_b32 v40, 0
    v_mov_b32 v41, 0
    v_mov_b32 v42, 0
    v_mov_b32 v43, 0
    v_mov_b32 v44, 0
    v_mov_b32 v45, 0
    v_mov_b32 v46, 0
    v_mov_b32 v47, 0
    v_mov_b32 v48, 0
    v_mov_b32 v49, 0
    v_mov_b32 v50, 0
    v_mov_b32 v51, 0
    v_mov_b32 v52, 0
    v_mov_b32 v53, 0
    v_mov_b32 v54, 0
    v_mov_b32 v55, 0
    v_mov_b32 v0, 1.0
    s_mov_b32 exec_lo, 0xff00ff00
    s_mov_b32 exec_hi, 0xff00ff00
    v_mov_b32 v0, s47
    s_mov_b64 exec, -1
    s_waitcnt vmcnt(15) lgkmcnt(0)
    v_mfma_f32_16x16x32_bf16 v[20:23], v[56:59], v[16:19], 0
    v_max3_u32 v9, v16, v17, v18
    v_max_u32 v9, v9, v19
    v_cmp_eq_u32 vcc, -1, v9
    s_cbranch_vccnz prp_19
    s_nop 3
    v_add_f32_dpp v20, v20, v20 row_ror:8 row_mask:0xf bank_mask:0xf
    v_add_f32_dpp v21, v21, v21 row_ror:8 row_mask:0xf bank_mask:0xf
    v_add_f32_dpp v22, v22, v22 row_ror:8 row_mask:0xf bank_mask:0xf
    v_add_f32_dpp v23, v23, v23 row_ror:8 row_mask:0xf bank_mask:0xf
    v_cvt_pk_bf16_f32 v20, v20, v21
    v_cvt_pk_bf16_f32 v21, v22, v23
    s_mov_b32 exec_hi, 0
    v_min_u32 v20, -2, v20
    v_min_u32 v21, -2, v21
    s_mov_b32 exec_lo, 0x00ff00ff
    buffer_store_dwordx2 v[20:21], v13, s[4:7], s23 offen sc1
    s_mov_b64 exec, -1
    s_branch ploop_15_pst
ploop_15_pnd:
    s_sleep 6
    s_nop 8
    buffer_load_dwordx4 v[16:19], v12, s[4:7], s30 offen sc1
    buffer_load_dword v15, off, s[4:7], s58 sc1
    s_add_u32 s22, s16, 1
    v_mov_b32 v60, s22
    v_mov_b32 v32, 0
    v_mov_b32 v33, 0
    v_mov_b32 v34, 0
    v_mov_b32 v35, 0
    v_mov_b32 v36, 0
    v_mov_b32 v37, 0
    v_mov_b32 v38, 0
    v_mov_b32 v39, 0
    v_mov_b32 v40, 0
    v_mov_b32 v41, 0
    v_mov_b32 v42, 0
    v_mov_b32 v43, 0
    v_mov_b32 v44, 0
    v_mov_b32 v45, 0
    v_mov_b32 v46, 0
    v_mov_b32 v47, 0
    v_mov_b32 v48, 0
    v_mov_b32 v49, 0
    v_mov_b32 v50, 0
    v_mov_b32 v51, 0
    v_mov_b32 v52, 0
    v_mov_b32 v53, 0
    v_mov_b32 v54, 0
    v_mov_b32 v55, 0
    v_mov_b32 v0, 1.0
    s_mov_b32 exec_lo, 0xff00ff00
    s_mov_b32 exec_hi, 0xff00ff00
    v_mov_b32 v0, s47
    s_mov_b64 exec, -1
ploop_15_pagain:
    s_waitcnt vmcnt(1) lgkmcnt(0)
    v_mfma_f32_16x16x32_bf16 v[20:23], v[56:59], v[16:19], 0
    v_max3_u32 v9, v16, v17, v18
    v_max_u32 v9, v9, v19
    v_cmp_eq_u32 vcc, -1, v9
    s_cbranch_vccnz prp_19
ploop_15_pgo:
    s_nop 3
    v_add_f32_dpp v20, v20, v20 row_ror:8 row_mask:0xf bank_mask:0xf
    v_add_f32_dpp v21, v21, v21 row_ror:8 row_mask:0xf bank_mask:0xf
    v_add_f32_dpp v22, v22, v22 row_ror:8 row_mask:0xf bank_mask:0xf
    v_add_f32_dpp v23, v23, v23 row_ror:8 row_mask:0xf bank_mask:0xf
    v_cvt_pk_bf16_f32 v20, v20, v21
    v_cvt_pk_bf16_f32 v21, v22, v23
    s_mov_b32 exec_hi, 0
    v_min_u32 v20, -2, v20
    v_min_u32 v21, -2, v21
    s_mov_b32 exec_lo, 0x00ff00ff
    buffer_store_dwordx2 v[20:21], v13, s[4:7], s23 offen sc1
    s_mov_b64 exec, -1
ploop_15_pst:
    s_add_u32 s22, s19, s32
    s_add_u32 s25, s20, s36
    buffer_store_dword v10, v2, s[4:7], s22 offen sc1
    s_mov_b32 exec_hi, 0
    buffer_store_dword v10, v3, s[4:7], s22 offen sc1
    s_mov_b32 exec_lo, 0x00ff00ff
    buffer_store_dwordx2 v[10:11], v13, s[4:7], s25 offen sc1
    s_mov_b64 exec, -1
    s_add_u32 s16, s16, 1
    s_mov_b32 s17, s18
    s_mov_b32 s18, s19
    s_mov_b32 s19, s20
    s_add_u32 s20, s20, 262144
    s_cmp_eq_u32 s20, 210763776
    s_cselect_b32 s20, 209715200, s20
    s_branch ploop_15
prm_18_gt:
gate_22:
    v_readfirstlane_b32 s25, v15
    s_cmp_ge_u32 s25, s59
    s_cbranch_scc1 gate_22_ok
    s_sleep 8
    buffer_load_dword v15, off, s[4:7], s58 sc1
    s_waitcnt vmcnt(0)
    s_sub_u32 s26, s26, 1
    s_cbranch_scc0 gate_22
    s_mov_b32 s26, 0
gate_22_ok:
    s_branch prm_18_gtb
prm_18_0:
    s_sub_u32 s26, s26, 1
    s_cbranch_scc1 prm_18_0_g
    buffer_load_dwordx4 v[16:19], v1, s[4:7], s21 offen offset:0 sc1
    buffer_load_dwordx4 v[20:23], v1, s[4:7], s21 offen offset:1024 sc1
    buffer_load_dwordx4 v[24:27], v1, s[4:7], s21 offen offset:2048 sc1
    buffer_load_dwordx4 v[28:31], v1, s[4:7], s21 offen offset:3072 sc1
    s_waitcnt vmcnt(3)
    v_max3_u32 v9, v16, v17, v18
    v_max_u32 v9, v9, v19
    v_cmp_eq_u32 vcc, -1, v9
    s_cbranch_vccnz prm_18_0
    s_branch prm_18_0ok
prm_18_0_g:
    s_mov_b32 s26, 0
    s_waitcnt vmcnt(0)
    s_branch prm_18_0ok
prm_18_1:
    s_sub_u32 s26, s26, 1
    s_cbranch_scc1 prm_18_1_g
    buffer_load_dwordx4 v[20:23], v1, s[4:7], s21 offen offset:1024 sc1
    buffer_load_dwordx4 v[24:27], v1, s[4:7], s21 offen offset:2048 sc1
    buffer_load_dwordx4 v[28:31], v1, s[4:7], s21 offen offset:3072 sc1
    s_waitcnt vmcnt(2)
    v_max3_u32 v9, v20, v21, v22
    v_max_u32 v9, v9, v23
    v_cmp_eq_u32 vcc, -1, v9
    s_cbranch_vccnz prm_18_1
    s_branch prm_18_1ok
prm_18_1_g:
    s_mov_b32 s26, 0
    s_waitcnt vmcnt(0)
    s_branch prm_18_1ok
prm_18_2:
    s_sub_u32 s26, s26, 1
    s_cbranch_scc1 prm_18_2_g
    buffer_load_dwordx4 v[24:27], v1, s[4:7], s21 offen offset:2048 sc1
    buffer_load_dwordx4 v[28:31], v1, s[4:7], s21 offen offset:3072 sc1
    s_waitcnt vmcnt(1)
    v_max3_u32 v9, v24, v25, v26
    v_max_u32 v9, v9, v27
    v_cmp_eq_u32 vcc, -1, v9
    s_cbranch_vccnz prm_18_2
    s_branch prm_18_2ok
prm_18_2_g:
    s_mov_b32 s26, 0
    s_waitcnt vmcnt(0)
    s_branch prm_18_2ok
prm_18_3:
    s_sub_u32 s26, s26, 1
    s_cbranch_scc1 prm_18_3_g
    buffer_load_dwordx4 v[28:31], v1, s[4:7], s21 offen offset:3072 sc1
    s_waitcnt vmcnt(0)
    v_max3_u32 v9, v28, v29, v30
    v_max_u32 v9, v9, v31
    v_cmp_eq_u32 vcc, -1, v9
    s_cbranch_vccnz prm_18_3
    s_branch prm_18_3ok
prm_18_3_g:
    s_mov_b32 s26, 0
    s_waitcnt vmcnt(0)
    s_branch prm_18_3ok
prm_18_d:
gate_23:
    v_readfirstlane_b32 s25, v15
    s_cmp_ge_u32 s25, s59
    s_cbranch_scc1 gate_23_ok
    s_sleep 8
    buffer_load_dword v15, off, s[4:7], s58 sc1
    s_waitcnt vmcnt(0)
    s_sub_u32 s26, s26, 1
    s_cbranch_scc0 gate_23
    s_mov_b32 s26, 0
gate_23_ok:
    ds_write_b32 v14, v60
    v_add_f32 v32, v32, v33
    v_add_f32 v34, v34, v35
    ds_write2_b32 v4, v32, v34 offset0:0 offset1:104
    v_add_f32 v36, v36, v37
    v_add_f32 v38, v38, v39
    ds_write2_b32 v4, v36, v38 offset0:16 offset1:120
    v_add_f32 v40, v40, v41
    v_add_f32 v42, v42, v43
    ds_write2_b32 v4, v40, v42 offset0:32 offset1:136
    v_add_f32 v44, v44, v45
    v_add_f32 v46, v46, v47
    ds_write2_b32 v4, v44, v46 offset0:48 offset1:152
    v_add_f32 v48, v48, v49
    v_add_f32 v50, v50, v51
    ds_write2_b32 v4, v48, v50 offset0:64 offset1:168
    v_add_f32 v52, v52, v53
    v_add_f32 v54, v54, v55
    ds_write2_b32 v4, v52, v54 offset0:80 offset1:184
    s_branch pnc_16_done
prp_19:
    s_sub_u32 s26, s26, 1
    s_nop 3
    s_cbranch_scc1 prp_19_g
    buffer_load_dwordx4 v[16:19], v12, s[4:7], s30 offen sc1
    buffer_load_dword v15, off, s[4:7], s58 sc1
    s_branch ploop_15_pagain
prp_19_g:
    s_mov_b32 s26, 0
    s_branch ploop_15_pgo
ploop_15_zr:
    s_sub_u32 s26, s26, 1
    s_cbranch_scc1 ploop_15_zg
    buffer_load_dwordx4 v[32:35], v1, s[4:7], s22 offen offset:0 sc1
    buffer_load_dwordx4 v[36:39], v1, s[4:7], s22 offen offset:1024 sc1
    buffer_load_dwordx4 v[40:43], v1, s[4:7], s22 offen offset:2048 sc1
    buffer_load_dwordx4 v[44:47], v1, s[4:7], s22 offen offset:3072 sc1
    s_branch ploop_15_za
ploop_15_zg:
    s_mov_b32 s26, 0
    s_branch ploop_15_zok
ptail_17:
    s_cmp_eq_u32 s15, 0
    s_cbranch_scc1 ptail_17_nd
    s_nop 0
ptail_17_nd:
    s_barrier
    v_add_u32 v55, s68, v61
    ds_read_b128 v[24:27], v55 offset:0
    ds_read_b128 v[28:31], v55 offset:1024
    ds_read_b128 v[32:35], v55 offset:18560
    ds_read_b128 v[36:39], v55 offset:19584
    ds_read_b128 v[40:43], v55 offset:37120
    ds_read_b128 v[44:47], v55 offset:38144
    ds_read_b128 v[48:51], v55 offset:55680
    ds_read_b128 v[52:55], v55 offset:56704
    s_waitcnt lgkmcnt(4)
    v_add_f32 v24, v24, v32
    v_add_f32 v25, v25, v33
    v_add_f32 v26, v26, v34
    v_add_f32 v27, v27, v35
    v_add_f32 v28, v28, v36
    v_add_f32 v29, v29, v37
    v_add_f32 v30, v30, v38
    v_add_f32 v31, v31, v39
    s_waitcnt lgkmcnt(0)
    v_add_f32 v40, v40, v48
    v_add_f32 v41, v41, v49
    v_add_f32 v42, v42, v50
    v_add_f32 v43, v43, v51
    v_add_f32 v44, v44, v52
    v_add_f32 v45, v45, v53
    v_add_f32 v46, v46, v54
    v_add_f32 v47, v47, v55
    v_add_f32 v24, v24, v40
    v_add_f32 v25, v25, v41
    v_add_f32 v26, v26, v42
    v_add_f32 v27, v27, v43
    v_add_f32 v28, v28, v44
    v_add_f32 v29, v29, v45
    v_add_f32 v30, v30, v46
    v_add_f32 v31, v31, v47
    v_cvt_pk_bf16_f32 v24, v24, v25
    v_cvt_pk_bf16_f32 v25, v26, v27
    v_cvt_pk_bf16_f32 v26, v28, v29
    v_cvt_pk_bf16_f32 v27, v30, v31
    v_min_u32 v24, -2, v24
    v_min_u32 v25, -2, v25
    v_min_u32 v26, -2, v26
    v_min_u32 v27, -2, v27
    buffer_store_dwordx4 v[24:27], v1, s[4:7], s37 offen sc1
    s_branch k_end
ch_a_pro:
    s_mul_i32 s21, s2, 24576
    s_add_u32 s21, s21, 209711104
    v_lshlrev_b32 v1, 4, v0
    v_mov_b32 v4, -1
    v_mov_b32 v5, -1
    v_mov_b32 v6, -1
    v_mov_b32 v7, -1
    buffer_store_dwordx4 v[4:7], v1, s[4:7], s21 offen sc1
    s_add_u32 s21, s21, 4096
    buffer_store_dwordx4 v[4:7], v1, s[4:7], s21 offen sc1
    s_add_u32 s21, s21, 4096
    buffer_store_dwordx4 v[4:7], v1, s[4:7], s21 offen sc1
    s_add_u32 s21, s21, 4096
    buffer_store_dwordx4 v[4:7], v1, s[4:7], s21 offen sc1
    s_add_u32 s21, s21, 4096
    buffer_store_dwordx4 v[4:7], v1, s[4:7], s21 offen sc1
    s_add_u32 s21, s21, 4096
    buffer_store_dwordx4 v[4:7], v1, s[4:7], s21 offen sc1
    s_add_u32 s21, s21, 4096
    v_mov_b32 v2, s29
    s_waitcnt vmcnt(0)
    s_barrier
    s_cmp_lg_u32 s3, 4
    s_cbranch_scc1 ch_nox
    s_mov_b64 exec, 1
    buffer_atomic_add v2, off, s[64:67], s28 sc1
    s_mov_b64 exec, -1
ch_nox:
    v_and_b32 v20, 63, v0
    v_lshlrev_b32 v0, 4, v20
    s_sub_u32 s25, s3, 4
    s_lshl_b32 s46, s12, 2
    s_add_u32 s46, s46, s25
    s_lshl_b32 s21, s46, 18
    s_lshl_b32 s22, s13, 7
    s_add_u32 s21, s21, s22
    s_lshl_b32 s46, s46, 12
    s_lshl_b32 s23, s25, 13
    s_add_u32 s23, s23, 131072
    s_load_dwordx2 s[8:9], s[0:1], 40
    s_mov_b32 s10, 8388608
    s_mov_b32 s11, 131072
    v_lshrrev_b32 v21, 3, v20
    v_and_b32 v22, 7, v20
    v_lshlrev_b32 v21, 11, v21
    v_lshl_add_u32 v21, v22, 4, v21
    v_lshrrev_b32 v28, 4, v20
    v_and_b32 v29, 1, v28
    v_xor_b32 v29, 0, v29
    v_lshlrev_b32 v29, 2, v29
    v_lshl_add_u32 v29, v28, 3, v29
    v_bfe_u32 v28, v20, 2, 2
    v_add_u32 v29, v29, v28
    v_lshlrev_b32 v29, 7, v29
    v_and_b32 v28, 3, v20
    v_lshl_add_u32 v29, v28, 4, v29
    v_and_b32 v28, 1, v28
    v_xor_b32 v28, 0, v28
    v_lshl_add_u32 v24, v28, 3, v29
    v_add_u32 v24, s23, v24
    v_lshrrev_b32 v28, 4, v20
    v_and_b32 v29, 1, v28
    v_xor_b32 v29, 1, v29
    v_lshlrev_b32 v29, 2, v29
    v_lshl_add_u32 v29, v28, 3, v29
    v_bfe_u32 v28, v20, 2, 2
    v_add_u32 v29, v29, v28
    v_lshlrev_b32 v29, 7, v29
    v_and_b32 v28, 3, v20
    v_lshl_add_u32 v29, v28, 4, v29
    v_and_b32 v28, 1, v28
    v_xor_b32 v28, 0, v28
    v_lshl_add_u32 v25, v28, 3, v29
    v_add_u32 v25, s23, v25
    v_lshrrev_b32 v28, 4, v20
    v_and_b32 v29, 1, v28
    v_xor_b32 v29, 0, v29
    v_lshlrev_b32 v29, 2, v29
    v_lshl_add_u32 v29, v28, 3, v29
    v_bfe_u32 v28, v20, 2, 2
    v_add_u32 v29, v29, v28
    v_lshlrev_b32 v29, 7, v29
    v_and_b32 v28, 3, v20
    v_lshl_add_u32 v29, v28, 4, v29
    v_and_b32 v28, 1, v28
    v_xor_b32 v28, 1, v28
    v_lshl_add_u32 v26, v28, 3, v29
    v_add_u32 v26, s23, v26
    v_lshrrev_b32 v28, 4, v20
    v_and_b32 v29, 1, v28
    v_xor_b32 v29, 1, v29
    v_lshlrev_b32 v29, 2, v29
    v_lshl_add_u32 v29, v28, 3, v29
    v_bfe_u32 v28, v20, 2, 2
    v_add_u32 v29, v29, v28
    v_lshlrev_b32 v29, 7, v29
    v_and_b32 v28, 3, v20
    v_lshl_add_u32 v29, v28, 4, v29
    v_and_b32 v28, 1, v28
    v_xor_b32 v28, 1, v28
    v_lshl_add_u32 v27, v28, 3, v29
    v_add_u32 v27, s23, v27
    s_waitcnt lgkmcnt(0)
    s_add_u32 m0, s23, 0
    s_nop 0
    buffer_load_dwordx4 v21, s[8:11], s21 offen lds
    s_add_u32 s21, s21, 16384
    s_add_u32 m0, s23, 1024
    s_nop 0
    buffer_load_dwordx4 v21, s[8:11], s21 offen lds
    s_add_u32 s21, s21, 16384
    s_add_u32 m0, s23, 2048
    s_nop 0
    buffer_load_dwordx4 v21, s[8:11], s21 offen lds
    s_add_u32 s21, s21, 16384
    s_add_u32 m0, s23, 3072
    s_nop 0
    buffer_load_dwordx4 v21, s[8:11], s21 offen lds
    s_add_u32 s21, s21, 16384
    s_add_u32 m0, s23, 4096
    s_nop 0
    buffer_load_dwordx4 v21, s[8:11], s21 offen lds
    s_add_u32 s21, s21, 16384
    s_add_u32 m0, s23, 5120
    s_nop 0
    buffer_load_dwordx4 v21, s[8:11], s21 offen lds
    s_add_u32 s21, s21, 16384
    s_add_u32 m0, s23, 6144
    s_nop 0
    buffer_load_dwordx4 v21, s[8:11], s21 offen lds
    s_add_u32 s21, s21, 16384
    s_add_u32 m0, s23, 7168
    s_nop 0
    buffer_load_dwordx4 v21, s[8:11], s21 offen lds
    s_add_u32 s21, s21, 16384
    buffer_load_dwordx4 v[98:101], v21, s[8:11], s21 offen
    s_add_u32 s21, s21, 16384
    buffer_load_dwordx4 v[102:105], v21, s[8:11], s21 offen
    s_add_u32 s21, s21, 16384
    buffer_load_dwordx4 v[106:109], v21, s[8:11], s21 offen
    s_add_u32 s21, s21, 16384
    buffer_load_dwordx4 v[110:113], v21, s[8:11], s21 offen
    s_add_u32 s21, s21, 16384
    buffer_load_dwordx4 v[114:117], v21, s[8:11], s21 offen
    s_add_u32 s21, s21, 16384
    buffer_load_dwordx4 v[118:121], v21, s[8:11], s21 offen
    s_add_u32 s21, s21, 16384
    buffer_load_dwordx4 v[122:125], v21, s[8:11], s21 offen
    s_add_u32 s21, s21, 16384
    buffer_load_dwordx4 v[126:129], v21, s[8:11], s21 offen
    s_add_u32 s21, s21, 16384
    v_add_u32 v30, s23, v0
    s_waitcnt vmcnt(8)
    ds_read_b64_tr_b16 v[192:193], v24 offset:0
    ds_read_b64_tr_b16 v[194:195], v25 offset:0
    ds_read_b64_tr_b16 v[200:201], v26 offset:0
    ds_read_b64_tr_b16 v[202:203], v27 offset:0
    ds_read_b64_tr_b16 v[208:209], v24 offset:64
    ds_read_b64_tr_b16 v[210:211], v25 offset:64
    ds_read_b64_tr_b16 v[216:217], v26 offset:64
    ds_read_b64_tr_b16 v[218:219], v27 offset:64
    s_waitcnt lgkmcnt(0)
    ds_read_b64_tr_b16 v[196:197], v24 offset:4096
    ds_read_b64_tr_b16 v[198:199], v25 offset:4096
    ds_read_b64_tr_b16 v[204:205], v26 offset:4096
    ds_read_b64_tr_b16 v[206:207], v27 offset:4096
    ds_read_b64_tr_b16 v[212:213], v24 offset:4160
    ds_read_b64_tr_b16 v[214:215], v25 offset:4160
    ds_read_b64_tr_b16 v[220:221], v26 offset:4160
    ds_read_b64_tr_b16 v[222:223], v27 offset:4160
    s_waitcnt lgkmcnt(0)
    s_waitcnt vmcnt(0)
    ds_write_b128 v30, v[98:101] offset:0
    ds_write_b128 v30, v[102:105] offset:1024
    ds_write_b128 v30, v[106:109] offset:2048
    ds_write_b128 v30, v[110:113] offset:3072
    ds_write_b128 v30, v[114:117] offset:4096
    ds_write_b128 v30, v[118:121] offset:5120
    ds_write_b128 v30, v[122:125] offset:6144
    ds_write_b128 v30, v[126:129] offset:7168
    s_waitcnt lgkmcnt(0)
    ds_read_b64_tr_b16 v[224:225], v24 offset:0
    ds_read_b64_tr_b16 v[226:227], v25 offset:0
    ds_read_b64_tr_b16 v[232:233], v26 offset:0
    ds_read_b64_tr_b16 v[234:235], v27 offset:0
    ds_read_b64_tr_b16 v[240:241], v24 offset:64
    ds_read_b64_tr_b16 v[242:243], v25 offset:64
    ds_read_b64_tr_b16 v[248:249], v26 offset:64
    ds_read_b64_tr_b16 v[250:251], v27 offset:64
    s_waitcnt lgkmcnt(0)
    ds_read_b64_tr_b16 v[228:229], v24 offset:4096
    ds_read_b64_tr_b16 v[230:231], v25 offset:4096
    ds_read_b64_tr_b16 v[236:237], v26 offset:4096
    ds_read_b64_tr_b16 v[238:239], v27 offset:4096
    ds_read_b64_tr_b16 v[244:245], v24 offset:4160
    ds_read_b64_tr_b16 v[246:247], v25 offset:4160
    ds_read_b64_tr_b16 v[252:253], v26 offset:4160
    ds_read_b64_tr_b16 v[254:255], v27 offset:4160
    s_waitcnt lgkmcnt(0)
    v_lshrrev_b32 v21, 4, v20
    s_mul_i32 s21, s25, 18560
    s_add_u32 s21, s21, 16384
    v_add_u32 v1, s21, v0
    v_and_b32 v23, 15, v20
    v_mul_u32_u24 v21, 136, v21
    v_lshl_add_u32 v21, v23, 3, v21
    v_add_u32 v45, s21, v21
    s_lshl_b32 s53, s25, 13
    s_add_u32 s53, s53, 92160
    v_add_u32 v49, s53, v0
    v_mov_b32 v48, 0
    v_mov_b32 v4, 0x3f803f80
    v_mov_b32 v5, 0x3f803f80
    v_mov_b32 v6, 0x3f803f80
    v_mov_b32 v7, 0x3f803f80
    v_mov_b32 v8, 0
    v_mov_b32 v9, 0
    v_mov_b32 v10, 0
    v_mov_b32 v11, 0
    v_lshlrev_b32 v43, 2, v20
    v_mov_b32 v26, 0x44444444
    v_mov_b32 v27, 0xeeeeeeee
    v_and_b32 v28, 1, v20
    v_cmp_eq_u32 vcc, 0, v28
    s_mov_b32 s47, 0x3e0293ee
    s_lshl_b32 s32, s12, 15
    v_cndmask_b32 v41, v27, v26, vcc
    s_lshl_b32 s21, s25, 13
    s_add_u32 s32, s32, s21
    s_add_u32 s32, s32, 2097152
    s_lshl_b32 s21, s25, 2
    s_add_u32 s21, s21, 13312
    v_mov_b32 v47, s21
    s_lshl_b32 s27, s13, 2
    s_add_u32 s27, s27, s25
    s_lshl_b32 s62, s12, 7
    s_add_u32 s62, s62, 218112000
    s_lshl_b32 s33, s12, 14
    s_lshl_b32 s21, s25, 12
    s_add_u32 s33, s33, s21
    s_add_u32 s33, s33, 1179648
    v_mov_b32 v139, 0
    v_mov_b32 v140, 0
    v_mov_b32 v141, 0
    v_mov_b32 v143, 0
    v_mov_b32 v144, 0
    v_mov_b32 v145, 0
    v_mov_b32 v40, 0
    v_mov_b32 v42, 0
    v_mov_b32 v44, 0
    v_mov_b32 v46, 0
    v_mov_b32 v158, 0x7f800000
    s_mov_b32 exec_lo, 0xcccccccc
    s_mov_b32 exec_hi, 0xcccccccc
    v_mov_b32 v158, 0x42700000
    s_mov_b64 exec, -1
    s_cmp_lg_u32 s3, 4
    s_cbranch_scc1 ch_xcc_skip
    v_add_u32 v56, 128, v43
    s_movk_i32 s21, 192
    v_writelane_b32 v56, s21, 4
    v_mov_b32 v59, 63
    v_writelane_b32 v59, -1, 4
    v_mov_b32 v60, 32
    s_mov_b64 exec, 0x1f
ch_xcc:
    buffer_load_dword v57, v56, s[64:67], 0 offen sc1
    s_waitcnt vmcnt(0)
    v_and_b32 v62, v59, v57
    v_cmp_ne_u32 vcc, v62, v60
    s_cbranch_vccz ch_xcc_ok
    s_sleep 16
    s_sub_u32 s26, s26, 1
    s_cbranch_scc0 ch_xcc
    s_mov_b32 s26, 0
ch_xcc_ok:
    s_lshr_b32 s22, s12, 1
    v_readlane_b32 s23, v57, 0
    s_nop 2
    v_readlane_b32 s21, v57, s22
    s_mov_b64 exec, -1
    v_mov_b32 v58, 131072
    v_mov_b32 v57, s21
    ds_write_b32 v58, v57
    s_bfe_u32 s23, s23, 0x1000f
    v_and_b32 v60, 0x70, v0
    v_lshlrev_b32 v60, 3, v60
    s_mov_b32 s22, 218112000
ch_pgv:
    buffer_load_dword v61, v60, s[4:7], s22 offen offset:8 sc1
    s_waitcnt vmcnt(0) lgkmcnt(0)
    v_and_b32 v62, 1, v61
    v_cmp_eq_u32 vcc, 0, v62
    s_cbranch_vccz ch_pgvok
    s_sleep 8
    s_sub_u32 s26, s26, 1
    s_cbranch_scc0 ch_pgv
    s_mov_b32 s26, 0
ch_pgvok:
    v_bfe_u32 v62, v61, 1, 1
    v_ashrrev_i32 v61, 8, v61
    v_sub_u32 v59, 0, v61
    v_cmp_eq_u32 vcc, s23, v62
    s_mov_b32 s21, 0
    s_nop 1
    v_cndmask_b32 v61, v59, v61, vcc
    s_nop 1
    v_readlane_b32 s22, v61, 0
    s_add_i32 s21, s21, s22
    v_readlane_b32 s22, v61, 1
    s_add_i32 s21, s21, s22
    v_readlane_b32 s22, v61, 2
    s_add_i32 s21, s21, s22
    v_readlane_b32 s22, v61, 3
    s_add_i32 s21, s21, s22
    v_readlane_b32 s22, v61, 4
    s_add_i32 s21, s21, s22
    v_readlane_b32 s22, v61, 5
    s_add_i32 s21, s21, s22
    v_readlane_b32 s22, v61, 6
    s_add_i32 s21, s21, s22
    v_readlane_b32 s22, v61, 7
    s_add_i32 s21, s21, s22
    s_cmp_gt_i32 s21, 0
    s_cselect_b32 s21, 0x2000, 0
    v_mov_b32 v59, s21
    ds_write_b32 v58, v59 offset:4
    s_waitcnt lgkmcnt(0)
ch_xcc_skip:
    s_barrier
    s_barrier
    s_lshl_b32 s60, s12, 4
    s_add_u32 s60, s60, 218104320
    s_barrier
ch_g0:
    buffer_load_dword v57, off, s[4:7], s60 sc1
    s_waitcnt vmcnt(0)
    v_readfirstlane_b32 s21, v57
    s_cmp_ge_u32 s21, 12
    s_cbranch_scc1 ch_g0b
    s_sleep 8
    s_sub_u32 s26, s26, 1
    s_cbranch_scc0 ch_g0
    s_mov_b32 s26, 0
ch_g0b:
    s_add_u32 s21, s16, 0
    s_lshl_b32 s21, s21, 18
    s_add_u32 s21, s21, s46
    s_add_u32 s21, s21, 37748736
    s_add_u32 s22, s21, 131072
    buffer_load_dwordx4 v[160:163], v0, s[4:7], s21 offen offset:0 sc1
    buffer_load_dwordx4 v[164:167], v0, s[4:7], s21 offen offset:1024 sc1
    buffer_load_dwordx4 v[168:171], v0, s[4:7], s21 offen offset:2048 sc1
    buffer_load_dwordx4 v[172:175], v0, s[4:7], s21 offen offset:3072 sc1
    buffer_load_dwordx4 v[176:179], v0, s[4:7], s22 offen offset:0 sc1
    buffer_load_dwordx4 v[180:183], v0, s[4:7], s22 offen offset:1024 sc1
    buffer_load_dwordx4 v[184:187], v0, s[4:7], s22 offen offset:2048 sc1
    buffer_load_dwordx4 v[188:191], v0, s[4:7], s22 offen offset:3072 sc1
    s_add_u32 s21, s16, 0
    s_lshl_b32 s21, s21, 18
    s_add_u32 s21, s21, s46
    s_add_u32 s21, s21, 20971520
    s_add_u32 s22, s21, 131072
    buffer_load_dwordx4 v[98:101], v0, s[4:7], s21 offen offset:0 sc1
    buffer_load_dwordx4 v[102:105], v0, s[4:7], s21 offen offset:1024 sc1
    buffer_load_dwordx4 v[106:109], v0, s[4:7], s21 offen offset:2048 sc1
    buffer_load_dwordx4 v[110:113], v0, s[4:7], s21 offen offset:3072 sc1
    buffer_load_dwordx4 v[114:117], v0, s[4:7], s22 offen offset:0 sc1
    buffer_load_dwordx4 v[118:121], v0, s[4:7], s22 offen offset:1024 sc1
    buffer_load_dwordx4 v[122:125], v0, s[4:7], s22 offen offset:2048 sc1
    buffer_load_dwordx4 v[126:129], v0, s[4:7], s22 offen offset:3072 sc1
    s_waitcnt vmcnt(8)
    v_mfma_f32_16x16x32_bf16 v[50:53], v[160:163], v[192:195], 0
    v_mfma_f32_16x16x32_bf16 v[54:57], v[160:163], v[200:203], 0
    v_mfma_f32_16x16x32_bf16 v[58:61], v[160:163], v[208:211], 0
    v_mfma_f32_16x16x32_bf16 v[62:65], v[160:163], v[216:219], 0
    v_mfma_f32_16x16x32_bf16 v[66:69], v[176:179], v[192:195], 0
    v_mfma_f32_16x16x32_bf16 v[70:73], v[176:179], v[200:203], 0
    v_mfma_f32_16x16x32_bf16 v[74:77], v[176:179], v[208:211], 0
    v_mfma_f32_16x16x32_bf16 v[78:81], v[176:179], v[216:219], 0
    v_mfma_f32_16x16x32_bf16 v[50:53], v[164:167], v[196:199], v[50:53]
    v_mfma_f32_16x16x32_bf16 v[54:57], v[164:167], v[204:207], v[54:57]
    v_mfma_f32_16x16x32_bf16 v[58:61], v[164:167], v[212:215], v[58:61]
    v_mfma_f32_16x16x32_bf16 v[62:65], v[164:167], v[220:223], v[62:65]
    v_mfma_f32_16x16x32_bf16 v[66:69], v[180:183], v[196:199], v[66:69]
    v_mfma_f32_16x16x32_bf16 v[70:73], v[180:183], v[204:207], v[70:73]
    v_mfma_f32_16x16x32_bf16 v[74:77], v[180:183], v[212:215], v[74:77]
    v_mfma_f32_16x16x32_bf16 v[78:81], v[180:183], v[220:223], v[78:81]
    v_mfma_f32_16x16x32_bf16 v[50:53], v[168:171], v[224:227], v[50:53]
    v_mfma_f32_16x16x32_bf16 v[54:57], v[168:171], v[232:235], v[54:57]
    v_mfma_f32_16x16x32_bf16 v[58:61], v[168:171], v[240:243], v[58:61]
    v_mfma_f32_16x16x32_bf16 v[62:65], v[168:171], v[248:251], v[62:65]
    v_mfma_f32_16x16x32_bf16 v[66:69], v[184:187], v[224:227], v[66:69]
    v_mfma_f32_16x16x32_bf16 v[70:73], v[184:187], v[232:235], v[70:73]
    v_mfma_f32_16x16x32_bf16 v[74:77], v[184:187], v[240:243], v[74:77]
    v_mfma_f32_16x16x32_bf16 v[78:81], v[184:187], v[248:251], v[78:81]
    v_mfma_f32_16x16x32_bf16 v[50:53], v[172:175], v[228:231], v[50:53]
    v_mfma_f32_16x16x32_bf16 v[54:57], v[172:175], v[236:239], v[54:57]
    v_mfma_f32_16x16x32_bf16 v[58:61], v[172:175], v[244:247], v[58:61]
    v_mfma_f32_16x16x32_bf16 v[62:65], v[172:175], v[252:255], v[62:65]
    v_mfma_f32_16x16x32_bf16 v[66:69], v[188:191], v[228:231], v[66:69]
    v_mfma_f32_16x16x32_bf16 v[70:73], v[188:191], v[236:239], v[70:73]
    v_mfma_f32_16x16x32_bf16 v[74:77], v[188:191], v[244:247], v[74:77]
    v_mfma_f32_16x16x32_bf16 v[78:81], v[188:191], v[252:255], v[78:81]
    s_add_u32 s21, s16, 1
    s_lshl_b32 s21, s21, 18
    s_add_u32 s21, s21, s46
    s_add_u32 s21, s21, 37748736
    s_add_u32 s22, s21, 131072
    buffer_load_dwordx4 v[160:163], v0, s[4:7], s21 offen offset:0 sc1
    buffer_load_dwordx4 v[164:167], v0, s[4:7], s21 offen offset:1024 sc1
    buffer_load_dwordx4 v[168:171], v0, s[4:7], s21 offen offset:2048 sc1
    buffer_load_dwordx4 v[172:175], v0, s[4:7], s21 offen offset:3072 sc1
    buffer_load_dwordx4 v[176:179], v0, s[4:7], s22 offen offset:0 sc1
    buffer_load_dwordx4 v[180:183], v0, s[4:7], s22 offen offset:1024 sc1
    buffer_load_dwordx4 v[184:187], v0, s[4:7], s22 offen offset:2048 sc1
    buffer_load_dwordx4 v[188:191], v0, s[4:7], s22 offen offset:3072 sc1
    s_mov_b32 s34, 1
    s_nop 7
    v_cvt_pk_bf16_f32 v82, v50, v51
    v_cvt_pk_bf16_f32 v83, v52, v53
    v_cvt_pk_bf16_f32 v84, v66, v67
    v_cvt_pk_bf16_f32 v85, v68, v69
    v_cvt_pk_bf16_f32 v86, v54, v55
    v_cvt_pk_bf16_f32 v87, v56, v57
    v_cvt_pk_bf16_f32 v88, v70, v71
    v_cvt_pk_bf16_f32 v89, v72, v73
    v_cvt_pk_bf16_f32 v90, v58, v59
    v_cvt_pk_bf16_f32 v91, v60, v61
    v_cvt_pk_bf16_f32 v92, v74, v75
    v_cvt_pk_bf16_f32 v93, v76, v77
    v_cvt_pk_bf16_f32 v94, v62, v63
    v_cvt_pk_bf16_f32 v95, v64, v65
    v_cvt_pk_bf16_f32 v96, v78, v79
    v_cvt_pk_bf16_f32 v97, v80, v81
    v_mov_b32 v74, 0
    v_mov_b32 v75, 0
    v_mov_b32 v76, 0
    v_mov_b32 v77, 0
    v_mov_b32 v78, 0
    v_mov_b32 v79, 0
    v_mov_b32 v80, 0
    v_mov_b32 v81, 0
    v_mov_b32 v146, 0
    v_mov_b32 v147, 0
    v_mov_b32 v148, 0
    v_mov_b32 v149, 0
    v_mov_b32 v150, 0
    v_mov_b32 v151, 0
    v_mov_b32 v152, 0
    v_mov_b32 v153, 0
    v_mov_b32 v12, 0
    v_mov_b32 v13, 0
    v_mov_b32 v14, 0
    v_mov_b32 v15, 0
    v_mov_b32 v16, 0
    v_mov_b32 v17, 0
    v_mov_b32 v18, 0
    v_mov_b32 v19, 0
    v_mov_b32 v20, 0
    v_mov_b32 v21, 0
    v_mov_b32 v22, 0
    v_mov_b32 v23, 0
    v_mov_b32 v2, 0
    s_add_u32 s21, s17, s32
    s_add_u32 s22, s21, 4096
    s_setprio 2
    s_branch a_zl
.p2align 6
    s_nop 0
    s_nop 0
    s_nop 0
    s_nop 0
    s_nop 0
    s_nop 0
    s_nop 0
    s_nop 0
aloop_24:
    s_add_u32 s21, s17, s32
    s_add_u32 s22, s21, 4096
    v_mov_b32 v74, 0
    v_mov_b32 v75, 0
    v_mov_b32 v76, 0
    v_mov_b32 v77, 0
    v_mov_b32 v78, 0
    v_mov_b32 v79, 0
    v_mov_b32 v80, 0
    v_mov_b32 v81, 0
    v_mov_b32 v146, 0
    v_mov_b32 v147, 0
    v_mov_b32 v148, 0
    v_mov_b32 v149, 0
    v_mov_b32 v150, 0
    v_mov_b32 v151, 0
    v_mov_b32 v152, 0
    v_mov_b32 v153, 0
    s_add_u32 s30, s16, 1
    s_lshl_b32 s30, s30, 18
    s_add_u32 s30, s30, s46
    s_add_u32 s30, s30, 37748736
    s_add_u32 s31, s30, 131072
aloop_24_wm:
    ds_read_b32 v3, v47
    s_waitcnt lgkmcnt(0)
    v_readfirstlane_b32 s23, v3
    s_cmp_eq_u32 s23, s16
    s_cbranch_scc1 aloop_24_wmok
    s_sleep 1
    s_branch aloop_24_wm
aloop_24_wmok:
    buffer_load_dwordx4 v[160:163], v0, s[4:7], s30 offen offset:0 sc1
    buffer_load_dwordx4 v[164:167], v0, s[4:7], s30 offen offset:1024 sc1
    buffer_load_dwordx4 v[168:171], v0, s[4:7], s30 offen offset:2048 sc1
    buffer_load_dwordx4 v[172:175], v0, s[4:7], s30 offen offset:3072 sc1
    buffer_load_dwordx4 v[176:179], v0, s[4:7], s31 offen offset:0 sc1
    buffer_load_dwordx4 v[180:183], v0, s[4:7], s31 offen offset:1024 sc1
    buffer_load_dwordx4 v[184:187], v0, s[4:7], s31 offen offset:2048 sc1
    buffer_load_dwordx4 v[188:191], v0, s[4:7], s31 offen offset:3072 sc1
aloop_24_nv:
    s_setprio 2
    v_mov_b32 v2, s16
    s_barrier
    s_nop 15
    s_nop 13
    ds_read_b128 v[98:101], v49 offset:0
    ds_read_b128 v[102:105], v49 offset:1024
    ds_read_b128 v[106:109], v49 offset:2048
    ds_read_b128 v[110:113], v49 offset:3072
    ds_read_b128 v[114:117], v49 offset:4096
    ds_read_b128 v[118:121], v49 offset:5120
    ds_read_b128 v[122:125], v49 offset:6144
    ds_read_b128 v[126:129], v49 offset:7168
    v_mov_b32 v12, 0
    v_mov_b32 v13, 0
    v_mov_b32 v14, 0
    v_mov_b32 v15, 0
    v_mov_b32 v16, 0
    v_mov_b32 v17, 0
    v_mov_b32 v18, 0
    v_mov_b32 v19, 0
    v_mov_b32 v20, 0
    v_mov_b32 v21, 0
    v_mov_b32 v22, 0
    v_mov_b32 v23, 0
    s_sleep 3
    s_nop 13
a_zl:
    buffer_load_dwordx4 v[50:53], v0, s[4:7], s21 offen offset:0 sc1
    s_nop 7
    buffer_load_dwordx4 v[54:57], v0, s[4:7], s21 offen offset:1024 sc1
    s_nop 7
    buffer_load_dwordx4 v[58:61], v0, s[4:7], s21 offen offset:2048 sc1
    s_nop 7
    buffer_load_dwordx4 v[62:65], v0, s[4:7], s21 offen offset:3072 sc1
    s_nop 7
    buffer_load_dwordx4 v[66:69], v0, s[4:7], s22 offen offset:0 sc1
    s_nop 7
    buffer_load_dwordx4 v[70:73], v0, s[4:7], s22 offen offset:1024 sc1
    s_waitcnt lgkmcnt(0)
    s_waitcnt vmcnt(5)
    v_max3_u32 v3, v50, v51, v52
    v_max_u32 v3, v3, v53
    v_cmp_eq_u32 vcc, -1, v3
    s_cbranch_vccnz arq_25_0
arq_25_0ok:
    v_mfma_f32_16x16x32_bf16 v[12:15], v[98:101], v[50:53], v[12:15]
    v_mfma_f32_16x16x32_bf16 v[16:19], v[114:117], v[50:53], v[16:19]
    s_waitcnt vmcnt(4)
    v_max3_u32 v3, v54, v55, v56
    v_max_u32 v3, v3, v57
    v_cmp_eq_u32 vcc, -1, v3
    v_mfma_f32_16x16x32_bf16 v[20:23], v[50:53], v[50:53], v[20:23]
    s_cbranch_vccnz arq_25_1
arq_25_1ok:
    v_mfma_f32_16x16x32_bf16 v[12:15], v[102:105], v[54:57], v[12:15]
    v_mfma_f32_16x16x32_bf16 v[16:19], v[118:121], v[54:57], v[16:19]
    s_waitcnt vmcnt(3)
    v_max3_u32 v3, v58, v59, v60
    v_max_u32 v3, v3, v61
    v_cmp_eq_u32 vcc, -1, v3
    v_mfma_f32_16x16x32_bf16 v[20:23], v[54:57], v[54:57], v[20:23]
    s_cbranch_vccnz arq_25_2
arq_25_2ok:
    v_mfma_f32_16x16x32_bf16 v[12:15], v[106:109], v[58:61], v[12:15]
    v_mfma_f32_16x16x32_bf16 v[16:19], v[122:125], v[58:61], v[16:19]
    s_waitcnt vmcnt(2)
    v_max3_u32 v3, v62, v63, v64
    v_max_u32 v3, v3, v65
    v_cmp_eq_u32 vcc, -1, v3
    v_mfma_f32_16x16x32_bf16 v[20:23], v[58:61], v[58:61], v[20:23]
    s_cbranch_vccnz arq_25_3
arq_25_3ok:
    v_mfma_f32_16x16x32_bf16 v[12:15], v[110:113], v[62:65], v[12:15]
    ds_write_b32 v47, v2 offset:16
    v_mfma_f32_16x16x32_bf16 v[16:19], v[126:129], v[62:65], v[16:19]
    v_mfma_f32_16x16x32_bf16 v[20:23], v[62:65], v[62:65], v[20:23]
aloop_24_sdone:
    s_nop 0
    s_cmp_eq_u32 s16, 63
    s_cbranch_scc1 aloop_24_lsk
    s_nop 1
    v_exp_f32 v54, v12
    v_exp_f32 v55, v13
    s_waitcnt vmcnt(0)
    v_max3_u32 v24, v66, v67, v68
    v_max3_u32 v24, v24, v69, v70
    v_max3_u32 v24, v24, v71, v72
    v_max_u32 v24, v24, v73
    v_cmp_eq_u32 vcc, -1, v24
    s_cbranch_vccnz arq_25_v
    v_smfmac_f32_16x16x64_bf16 v[74:77], v[66:69], v[192:199], v41
    v_exp_f32 v56, v14
    v_smfmac_f32_16x16x64_bf16 v[78:81], v[66:69], v[200:207], v41
    v_exp_f32 v57, v15
    v_smfmac_f32_16x16x64_bf16 v[146:149], v[66:69], v[208:215], v41
    v_exp_f32 v58, v16
    v_smfmac_f32_16x16x64_bf16 v[150:153], v[66:69], v[216:223], v41
    v_exp_f32 v59, v17
    v_smfmac_f32_16x16x64_bf16 v[74:77], v[70:73], v[224:231], v41
    v_exp_f32 v60, v18
    v_smfmac_f32_16x16x64_bf16 v[78:81], v[70:73], v[232:239], v41
    v_exp_f32 v61, v19
    v_smfmac_f32_16x16x64_bf16 v[146:149], v[70:73], v[240:247], v41
    v_exp_f32 v62, v20
    v_smfmac_f32_16x16x64_bf16 v[150:153], v[70:73], v[248:255], v41
    v_exp_f32 v63, v21
    v_cvt_pk_bf16_f32 v154, v54, v55
    v_cvt_pk_bf16_f32 v155, v56, v57
    v_cvt_pk_bf16_f32 v156, v58, v59
    v_cvt_pk_bf16_f32 v157, v60, v61
    v_cvt_pk_bf16_f32 v8, v62, v63
    v_max3_f32 v2, |v12|, |v13|, |v14|
    v_mfma_f32_16x16x32_bf16 v[50:53], v[154:157], v[4:7], 0
    v_max3_f32 v3, |v15|, |v16|, |v17|
    v_add_f32 v74, v74, v75
    v_mfma_f32_16x16x32_bf16 v[50:53], v[8:11], v[4:7], v[50:53]
    v_add_f32 v76, v76, v77
    v_cvt_pk_bf16_f32 v40, v74, v76
    v_mfma_f32_16x16x32_bf16 v[24:27], v[154:157], v[82:85], 0
    v_add_f32 v78, v78, v79
    v_add_f32 v80, v80, v81
    v_mfma_f32_16x16x32_bf16 v[24:27], v[8:11], v[40:43], v[24:27]
    v_cvt_pk_bf16_f32 v42, v78, v80
    v_add_f32 v146, v146, v147
    v_mfma_f32_16x16x32_bf16 v[28:31], v[154:157], v[86:89], 0
    v_add_f32 v148, v148, v149
    v_cvt_pk_bf16_f32 v44, v146, v148
    v_mfma_f32_16x16x32_bf16 v[28:31], v[8:11], v[42:45], v[28:31]
    v_add_f32 v150, v150, v151
    v_add_f32 v152, v152, v153
    v_mfma_f32_16x16x32_bf16 v[32:35], v[154:157], v[90:93], 0
    v_cvt_pk_bf16_f32 v46, v150, v152
    v_rcp_f32 v52, v52
    v_mfma_f32_16x16x32_bf16 v[32:35], v[8:11], v[44:47], v[32:35]
    v_rcp_f32 v53, v53
    v_max3_f32 v2, v2, |v18|, |v19|
    v_mfma_f32_16x16x32_bf16 v[36:39], v[154:157], v[94:97], 0
    v_max3_f32 v3, v3, |v20|, |v21|
    v_max_f32 v2, v2, v3
    v_mfma_f32_16x16x32_bf16 v[36:39], v[8:11], v[46:49], v[36:39]
    v_cmp_nle_f32 vcc, v2, v158
    v_mul_f32 v26, v26, v52
    v_mul_f32 v27, v27, v53
    s_cbranch_vccnz aloop_24_tm
    v_mul_f32 v30, v30, v52
    v_mul_f32 v31, v31, v53
aloop_24_pvd:
    ds_write_b64 v45, v[26:27] offset:0
    v_mul_f32 v34, v34, v52
    v_mul_f32 v35, v35, v53
    ds_write_b64 v45, v[30:31] offset:544
    v_mul_f32 v38, v38, v52
    v_mul_f32 v39, v39, v53
    ds_write_b64 v45, v[34:35] offset:1088
    ds_write_b64 v45, v[38:39] offset:1632
aloop_24_lskb:
    s_waitcnt lgkmcnt(0)
    s_barrier
    s_setprio 0
    s_cmp_lg_u32 s27, 0
    s_cbranch_scc1 pg_26
    s_sub_u32 s25, s16, 1
    s_cbranch_scc1 pg_26
    v_mov_b32 v3, s25
    s_mov_b64 exec, 1
    buffer_store_dword v3, off, s[4:7], s62 sc1
    s_mov_b64 exec, -1
pg_26:
    s_add_u32 s21, s17, s33
    v_lshlrev_b32 v2, 1, v43
    s_cmp_eq_u32 s16, 63
    s_cbranch_scc1 aloop_24_nvw
    v_mfma_f32_16x16x32_bf16 v[50:53], v[160:163], v[192:195], 0
    v_mfma_f32_16x16x32_bf16 v[54:57], v[160:163], v[200:203], 0
    v_mfma_f32_16x16x32_bf16 v[58:61], v[160:163], v[208:211], 0
    v_mfma_f32_16x16x32_bf16 v[62:65], v[160:163], v[216:219], 0
    v_mfma_f32_16x16x32_bf16 v[66:69], v[176:179], v[192:195], 0
    v_mfma_f32_16x16x32_bf16 v[70:73], v[176:179], v[200:203], 0
    v_mfma_f32_16x16x32_bf16 v[74:77], v[176:179], v[208:211], 0
    v_mfma_f32_16x16x32_bf16 v[78:81], v[176:179], v[216:219], 0
    v_mfma_f32_16x16x32_bf16 v[50:53], v[164:167], v[196:199], v[50:53]
    v_mfma_f32_16x16x32_bf16 v[54:57], v[164:167], v[204:207], v[54:57]
    v_mfma_f32_16x16x32_bf16 v[58:61], v[164:167], v[212:215], v[58:61]
    v_mfma_f32_16x16x32_bf16 v[62:65], v[164:167], v[220:223], v[62:65]
    v_mfma_f32_16x16x32_bf16 v[66:69], v[180:183], v[196:199], v[66:69]
    v_mfma_f32_16x16x32_bf16 v[70:73], v[180:183], v[204:207], v[70:73]
    v_mfma_f32_16x16x32_bf16 v[74:77], v[180:183], v[212:215], v[74:77]
    v_mfma_f32_16x16x32_bf16 v[78:81], v[180:183], v[220:223], v[78:81]
    v_mfma_f32_16x16x32_bf16 v[50:53], v[168:171], v[224:227], v[50:53]
    v_mfma_f32_16x16x32_bf16 v[54:57], v[168:171], v[232:235], v[54:57]
    v_mfma_f32_16x16x32_bf16 v[58:61], v[168:171], v[240:243], v[58:61]
    v_mfma_f32_16x16x32_bf16 v[62:65], v[168:171], v[248:251], v[62:65]
    v_mfma_f32_16x16x32_bf16 v[66:69], v[184:187], v[224:227], v[66:69]
    v_mfma_f32_16x16x32_bf16 v[70:73], v[184:187], v[232:235], v[70:73]
    v_mfma_f32_16x16x32_bf16 v[74:77], v[184:187], v[240:243], v[74:77]
    v_mfma_f32_16x16x32_bf16 v[78:81], v[184:187], v[248:251], v[78:81]
    v_mfma_f32_16x16x32_bf16 v[50:53], v[172:175], v[228:231], v[50:53]
    v_mfma_f32_16x16x32_bf16 v[54:57], v[172:175], v[236:239], v[54:57]
    v_mfma_f32_16x16x32_bf16 v[58:61], v[172:175], v[244:247], v[58:61]
    v_mfma_f32_16x16x32_bf16 v[62:65], v[172:175], v[252:255], v[62:65]
    v_mfma_f32_16x16x32_bf16 v[66:69], v[188:191], v[228:231], v[66:69]
    v_mfma_f32_16x16x32_bf16 v[70:73], v[188:191], v[236:239], v[70:73]
    v_mfma_f32_16x16x32_bf16 v[74:77], v[188:191], v[244:247], v[74:77]
    v_mfma_f32_16x16x32_bf16 v[78:81], v[188:191], v[252:255], v[78:81]
    buffer_load_dwordx4 v[130:133], v0, s[4:7], s21 offen sc1
    buffer_load_dwordx2 v[146:147], v2, s[4:7], s21 offen offset:1024 sc1
    buffer_load_dwordx4 v[134:137], v0, s[4:7], s21 offen offset:2048 sc1
    buffer_load_dwordx2 v[148:149], v2, s[4:7], s21 offen offset:3072 sc1
    s_add_u32 s30, s16, 2
    s_lshl_b32 s30, s30, 18
    s_add_u32 s30, s30, s46
    s_add_u32 s30, s30, 37748736
    s_add_u32 s31, s30, 131072
    s_branch aloop_24_vwd
aloop_24_nvw:
    buffer_load_dwordx4 v[130:133], v0, s[4:7], s21 offen sc1
    buffer_load_dwordx2 v[146:147], v2, s[4:7], s21 offen offset:1024 sc1
    buffer_load_dwordx4 v[134:137], v0, s[4:7], s21 offen offset:2048 sc1
    buffer_load_dwordx2 v[148:149], v2, s[4:7], s21 offen offset:3072 sc1
aloop_24_vwd:
    v_add_u32 v48, s68, v1
    s_xor_b32 s68, s68, 8192
aloop_24_psa:
    s_waitcnt vmcnt(0)
    v_max3_u32 v3, v130, v131, v132
    v_max3_u32 v3, v3, v133, v134
    v_max3_u32 v3, v3, v135, v136
    v_max3_u32 v3, v3, v137, v146
    v_max3_u32 v3, v3, v147, v148
    v_max_u32 v3, v3, v149
    v_cmp_eq_u32 vcc, -1, v3
    s_cbranch_vccnz arq_25_ps
aloop_24_psok:
    v_mfma_f32_16x16x32_bf16 v[24:27], v[82:85], v[130:133], 0
    v_mfma_f32_16x16x32_bf16 v[28:31], v[86:89], v[130:133], 0
    v_mfma_f32_16x16x32_bf16 v[32:35], v[90:93], v[130:133], 0
    v_mfma_f32_16x16x32_bf16 v[36:39], v[94:97], v[130:133], 0
    v_mov_b32 v138, v146
    v_mfma_f32_16x16x32_bf16 v[12:15], v[82:85], v[134:137], 0
    v_mfma_f32_16x16x32_bf16 v[16:19], v[86:89], v[134:137], 0
    v_mfma_f32_16x16x32_bf16 v[20:23], v[90:93], v[134:137], 0
    v_mfma_f32_16x16x32_bf16 v[154:157], v[94:97], v[134:137], 0
    v_mov_b32 v142, v148
    v_mfma_f32_16x16x32_bf16 v[24:27], v[40:43], v[138:141], v[24:27]
    v_mfma_f32_16x16x32_bf16 v[28:31], v[42:45], v[138:141], v[28:31]
    v_mfma_f32_16x16x32_bf16 v[32:35], v[44:47], v[138:141], v[32:35]
    v_mfma_f32_16x16x32_bf16 v[36:39], v[46:49], v[138:141], v[36:39]
    v_mfma_f32_16x16x32_bf16 v[12:15], v[40:43], v[142:145], v[12:15]
    v_mfma_f32_16x16x32_bf16 v[16:19], v[42:45], v[142:145], v[16:19]
    v_mfma_f32_16x16x32_bf16 v[20:23], v[44:47], v[142:145], v[20:23]
    s_nop 1
    v_mfma_f32_16x16x32_bf16 v[154:157], v[46:49], v[142:145], v[154:157]
aloop_24_nev:
    ds_write_b128 v48, v[24:27] offset:2176
    v_cvt_pk_bf16_f32 v82, v50, v51
    v_cvt_pk_bf16_f32 v83, v52, v53
    ds_write_b128 v48, v[28:31] offset:3200
    v_cvt_pk_bf16_f32 v84, v66, v67
    v_cvt_pk_bf16_f32 v85, v68, v69
    ds_write_b128 v48, v[32:35] offset:4224
    v_cvt_pk_bf16_f32 v86, v54, v55
    v_cvt_pk_bf16_f32 v87, v56, v57
    ds_write_b128 v48, v[36:39] offset:5248
    v_cvt_pk_bf16_f32 v88, v70, v71
    v_cvt_pk_bf16_f32 v89, v72, v73
    ds_write_b128 v48, v[12:15] offset:6272
    v_cvt_pk_bf16_f32 v90, v58, v59
    v_cvt_pk_bf16_f32 v91, v60, v61
    ds_write_b128 v48, v[16:19] offset:7296
    v_cvt_pk_bf16_f32 v92, v74, v75
    v_cvt_pk_bf16_f32 v93, v76, v77
    ds_write_b128 v48, v[20:23] offset:8320
    v_cvt_pk_bf16_f32 v94, v62, v63
    v_cvt_pk_bf16_f32 v95, v64, v65
    ds_write_b128 v48, v[154:157] offset:9344
    v_cvt_pk_bf16_f32 v96, v78, v79
    v_cvt_pk_bf16_f32 v97, v80, v81
aloop_24_bgskip:
    s_waitcnt lgkmcnt(0)
    s_cmp_eq_u32 s16, 63
    s_cbranch_scc1 aloop_24_fin
    s_add_u32 s16, s16, 1
    s_mov_b32 s17, s18
    s_mov_b32 s18, s19
    s_mov_b32 s19, s20
    s_add_u32 s20, s20, 262144
    s_cmp_eq_u32 s20, 210763776
    s_cselect_b32 s20, 209715200, s20
    s_branch aloop_24
arq_25_0:
    s_sub_u32 s26, s26, 1
    s_cbranch_scc1 arq_25_0_g
    buffer_load_dwordx4 v[50:53], v0, s[4:7], s21 offen offset:0 sc1
    buffer_load_dwordx4 v[54:57], v0, s[4:7], s21 offen offset:1024 sc1
    buffer_load_dwordx4 v[58:61], v0, s[4:7], s21 offen offset:2048 sc1
    buffer_load_dwordx4 v[62:65], v0, s[4:7], s21 offen offset:3072 sc1
    buffer_load_dwordx4 v[66:69], v0, s[4:7], s22 offen offset:0 sc1
    buffer_load_dwordx4 v[70:73], v0, s[4:7], s22 offen offset:1024 sc1
    s_waitcnt vmcnt(5)
    v_max3_u32 v3, v50, v51, v52
    v_max_u32 v3, v3, v53
    v_cmp_eq_u32 vcc, -1, v3
    s_cbranch_vccnz arq_25_0
    s_branch arq_25_0ok
arq_25_0_g:
    s_mov_b32 s26, 0
    s_waitcnt vmcnt(0)
    s_branch arq_25_0ok
arq_25_1:
    s_sub_u32 s26, s26, 1
    s_cbranch_scc1 arq_25_1_g
    buffer_load_dwordx4 v[54:57], v0, s[4:7], s21 offen offset:1024 sc1
    buffer_load_dwordx4 v[58:61], v0, s[4:7], s21 offen offset:2048 sc1
    buffer_load_dwordx4 v[62:65], v0, s[4:7], s21 offen offset:3072 sc1
    buffer_load_dwordx4 v[66:69], v0, s[4:7], s22 offen offset:0 sc1
    buffer_load_dwordx4 v[70:73], v0, s[4:7], s22 offen offset:1024 sc1
    s_waitcnt vmcnt(4)
    v_max3_u32 v3, v54, v55, v56
    v_max_u32 v3, v3, v57
    v_cmp_eq_u32 vcc, -1, v3
    s_cbranch_vccnz arq_25_1
    s_branch arq_25_1ok
arq_25_1_g:
    s_mov_b32 s26, 0
    s_waitcnt vmcnt(0)
    s_branch arq_25_1ok
arq_25_2:
    s_sub_u32 s26, s26, 1
    s_cbranch_scc1 arq_25_2_g
    buffer_load_dwordx4 v[58:61], v0, s[4:7], s21 offen offset:2048 sc1
    buffer_load_dwordx4 v[62:65], v0, s[4:7], s21 offen offset:3072 sc1
    buffer_load_dwordx4 v[66:69], v0, s[4:7], s22 offen offset:0 sc1
    buffer_load_dwordx4 v[70:73], v0, s[4:7], s22 offen offset:1024 sc1
    s_waitcnt vmcnt(3)
    v_max3_u32 v3, v58, v59, v60
    v_max_u32 v3, v3, v61
    v_cmp_eq_u32 vcc, -1, v3
    s_cbranch_vccnz arq_25_2
    s_branch arq_25_2ok
arq_25_2_g:
    s_mov_b32 s26, 0
    s_waitcnt vmcnt(0)
    s_branch arq_25_2ok
arq_25_3:
    s_sub_u32 s26, s26, 1
    s_cbranch_scc1 arq_25_3_g
    buffer_load_dwordx4 v[62:65], v0, s[4:7], s21 offen offset:3072 sc1
    buffer_load_dwordx4 v[66:69], v0, s[4:7], s22 offen offset:0 sc1
    buffer_load_dwordx4 v[70:73], v0, s[4:7], s22 offen offset:1024 sc1
    s_waitcnt vmcnt(2)
    v_max3_u32 v3, v62, v63, v64
    v_max_u32 v3, v3, v65
    v_cmp_eq_u32 vcc, -1, v3
    s_cbranch_vccnz arq_25_3
    s_branch arq_25_3ok
arq_25_3_g:
    s_mov_b32 s26, 0
    s_waitcnt vmcnt(0)
    s_branch arq_25_3ok
arq_25_v:
    buffer_load_dwordx4 v[66:69], v0, s[4:7], s22 offen offset:0 sc1
    buffer_load_dwordx4 v[70:73], v0, s[4:7], s22 offen offset:1024 sc1
    v_max3_f32 v2, v12, v13, v14
    v_max3_f32 v3, v15, v16, v17
    v_max3_f32 v2, v2, v18, v19
    v_max3_f32 v3, v3, v20, v21
    v_max_f32 v2, v2, v3
    v_mov_b32 v3, v2
    s_nop 1
    v_permlane16_swap_b32 v3, v2
    v_max_f32 v2, v2, v3
    v_mov_b32 v3, v2
    s_nop 1
    v_permlane32_swap_b32 v3, v2
    v_max_f32 v2, v2, v3
    v_sub_f32 v12, v12, v2
    v_sub_f32 v13, v13, v2
    v_sub_f32 v14, v14, v2
    v_sub_f32 v15, v15, v2
    v_sub_f32 v16, v16, v2
    v_sub_f32 v17, v17, v2
    v_sub_f32 v18, v18, v2
    v_sub_f32 v19, v19, v2
    v_sub_f32 v20, v20, v2
    v_sub_f32 v21, v21, v2
    v_exp_f32 v54, v12
    v_exp_f32 v55, v13
    v_exp_f32 v56, v14
    v_exp_f32 v57, v15
    v_exp_f32 v58, v16
    v_exp_f32 v59, v17
    v_exp_f32 v60, v18
    v_exp_f32 v61, v19
    v_exp_f32 v62, v20
    v_exp_f32 v63, v21
    s_nop 0
    v_cvt_pk_bf16_f32 v154, v54, v55
    v_cvt_pk_bf16_f32 v155, v56, v57
    v_cvt_pk_bf16_f32 v156, v58, v59
    v_cvt_pk_bf16_f32 v157, v60, v61
    v_cvt_pk_bf16_f32 v8, v62, v63
    s_nop 0
    v_mfma_f32_16x16x32_bf16 v[50:53], v[154:157], v[4:7], 0
    v_mfma_f32_16x16x32_bf16 v[50:53], v[8:11], v[4:7], v[50:53]
    v_mfma_f32_16x16x32_bf16 v[24:27], v[154:157], v[82:85], 0
    v_mfma_f32_16x16x32_bf16 v[28:31], v[154:157], v[86:89], 0
    v_mfma_f32_16x16x32_bf16 v[32:35], v[154:157], v[90:93], 0
    v_mfma_f32_16x16x32_bf16 v[36:39], v[154:157], v[94:97], 0
arq_25_vs:
    s_waitcnt vmcnt(0)
    v_max3_u32 v3, v66, v67, v68
    v_max3_u32 v3, v3, v69, v70
    v_max3_u32 v3, v3, v71, v72
    v_max_u32 v3, v3, v73
    v_cmp_eq_u32 vcc, -1, v3
    s_cbranch_vccnz arq_25_vsr
    s_branch arq_25_vsok
arq_25_vsr:
    s_sub_u32 s26, s26, 1
    s_cbranch_scc1 arq_25_vsg
    buffer_load_dwordx4 v[66:69], v0, s[4:7], s22 offen offset:0 sc1
    buffer_load_dwordx4 v[70:73], v0, s[4:7], s22 offen offset:1024 sc1
    s_branch arq_25_vs
arq_25_vsg:
    s_mov_b32 s26, 0
arq_25_vsok:
    v_smfmac_f32_16x16x64_bf16 v[74:77], v[66:69], v[192:199], v41
    v_smfmac_f32_16x16x64_bf16 v[78:81], v[66:69], v[200:207], v41
    v_smfmac_f32_16x16x64_bf16 v[146:149], v[66:69], v[208:215], v41
    v_smfmac_f32_16x16x64_bf16 v[150:153], v[66:69], v[216:223], v41
    v_smfmac_f32_16x16x64_bf16 v[74:77], v[70:73], v[224:231], v41
    v_smfmac_f32_16x16x64_bf16 v[78:81], v[70:73], v[232:239], v41
    v_smfmac_f32_16x16x64_bf16 v[146:149], v[70:73], v[240:247], v41
    v_smfmac_f32_16x16x64_bf16 v[150:153], v[70:73], v[248:255], v41
    v_rcp_f32 v52, v52
    v_rcp_f32 v53, v53
    s_nop 2
    v_add_f32 v74, v74, v75
    v_add_f32 v76, v76, v77
    v_cvt_pk_bf16_f32 v40, v74, v76
    v_add_f32 v78, v78, v79
    v_add_f32 v80, v80, v81
    v_cvt_pk_bf16_f32 v42, v78, v80
    v_add_f32 v146, v146, v147
    v_add_f32 v148, v148, v149
    v_cvt_pk_bf16_f32 v44, v146, v148
    v_add_f32 v150, v150, v151
    v_add_f32 v152, v152, v153
    v_cvt_pk_bf16_f32 v46, v150, v152
    s_nop 1
    v_mfma_f32_16x16x32_bf16 v[24:27], v[8:11], v[40:43], v[24:27]
    v_mfma_f32_16x16x32_bf16 v[28:31], v[8:11], v[42:45], v[28:31]
    v_mfma_f32_16x16x32_bf16 v[32:35], v[8:11], v[44:47], v[32:35]
    v_mfma_f32_16x16x32_bf16 v[36:39], v[8:11], v[46:49], v[36:39]
    s_nop 4
    v_mul_f32 v26, v26, v52
    v_mul_f32 v27, v27, v53
    v_mul_f32 v30, v30, v52
    v_mul_f32 v31, v31, v53
    s_branch aloop_24_pvd
aloop_24_tm:
    s_nop 7
    v_max3_f32 v2, v12, v13, v14
    v_max3_f32 v3, v15, v16, v17
    v_max3_f32 v2, v2, v18, v19
    v_max3_f32 v3, v3, v20, v21
    v_max_f32 v2, v2, v3
    v_mov_b32 v3, v2
    s_nop 1
    v_permlane16_swap_b32 v3, v2
    v_max_f32 v2, v2, v3
    v_mov_b32 v3, v2
    s_nop 1
    v_permlane32_swap_b32 v3, v2
    v_max_f32 v2, v2, v3
    v_sub_f32 v12, v12, v2
    v_sub_f32 v13, v13, v2
    v_sub_f32 v14, v14, v2
    v_sub_f32 v15, v15, v2
    v_sub_f32 v16, v16, v2
    v_sub_f32 v17, v17, v2
    v_sub_f32 v18, v18, v2
    v_sub_f32 v19, v19, v2
    v_sub_f32 v20, v20, v2
    v_sub_f32 v21, v21, v2
    v_exp_f32 v54, v12
    v_exp_f32 v55, v13
    v_exp_f32 v56, v14
    v_exp_f32 v57, v15
    v_exp_f32 v58, v16
    v_exp_f32 v59, v17
    v_exp_f32 v60, v18
    v_exp_f32 v61, v19
    v_exp_f32 v62, v20
    v_exp_f32 v63, v21
    s_nop 0
    v_cvt_pk_bf16_f32 v154, v54, v55
    v_cvt_pk_bf16_f32 v155, v56, v57
    v_cvt_pk_bf16_f32 v156, v58, v59
    v_cvt_pk_bf16_f32 v157, v60, v61
    v_cvt_pk_bf16_f32 v8, v62, v63
    s_nop 0
    v_mfma_f32_16x16x32_bf16 v[50:53], v[154:157], v[4:7], 0
    v_mfma_f32_16x16x32_bf16 v[50:53], v[8:11], v[4:7], v[50:53]
    v_mfma_f32_16x16x32_bf16 v[24:27], v[154:157], v[82:85], 0
    v_mfma_f32_16x16x32_bf16 v[28:31], v[154:157], v[86:89], 0
    v_mfma_f32_16x16x32_bf16 v[32:35], v[154:157], v[90:93], 0
    v_mfma_f32_16x16x32_bf16 v[36:39], v[154:157], v[94:97], 0
    v_mfma_f32_16x16x32_bf16 v[24:27], v[8:11], v[40:43], v[24:27]
    v_mfma_f32_16x16x32_bf16 v[28:31], v[8:11], v[42:45], v[28:31]
    v_mfma_f32_16x16x32_bf16 v[32:35], v[8:11], v[44:47], v[32:35]
    v_mfma_f32_16x16x32_bf16 v[36:39], v[8:11], v[46:49], v[36:39]
    v_rcp_f32 v52, v52
    v_rcp_f32 v53, v53
    s_nop 4
    v_mul_f32 v26, v26, v52
    v_mul_f32 v27, v27, v53
    v_mul_f32 v30, v30, v52
    v_mul_f32 v31, v31, v53
    s_branch aloop_24_pvd
aloop_24_lz:
    buffer_load_dwordx4 v[66:69], v0, s[4:7], s22 offen offset:0 sc1
    buffer_load_dwordx4 v[70:73], v0, s[4:7], s22 offen offset:1024 sc1
    ds_write_b32 v47, v2 offset:16
aloop_24_lsk:
arq_25_vl:
    s_waitcnt vmcnt(0)
    v_max3_u32 v3, v66, v67, v68
    v_max3_u32 v3, v3, v69, v70
    v_max3_u32 v3, v3, v71, v72
    v_max_u32 v3, v3, v73
    v_cmp_eq_u32 vcc, -1, v3
    s_cbranch_vccnz arq_25_vlr
    s_branch arq_25_vlok
arq_25_vlr:
    s_sub_u32 s26, s26, 1
    s_cbranch_scc1 arq_25_vlg
    buffer_load_dwordx4 v[66:69], v0, s[4:7], s22 offen offset:0 sc1
    buffer_load_dwordx4 v[70:73], v0, s[4:7], s22 offen offset:1024 sc1
    s_branch arq_25_vl
arq_25_vlg:
    s_mov_b32 s26, 0
arq_25_vlok:
    v_smfmac_f32_16x16x64_bf16 v[74:77], v[66:69], v[192:199], v41
    v_smfmac_f32_16x16x64_bf16 v[78:81], v[66:69], v[200:207], v41
    v_smfmac_f32_16x16x64_bf16 v[146:149], v[66:69], v[208:215], v41
    v_smfmac_f32_16x16x64_bf16 v[150:153], v[66:69], v[216:223], v41
    v_smfmac_f32_16x16x64_bf16 v[74:77], v[70:73], v[224:231], v41
    v_smfmac_f32_16x16x64_bf16 v[78:81], v[70:73], v[232:239], v41
    v_smfmac_f32_16x16x64_bf16 v[146:149], v[70:73], v[240:247], v41
    v_smfmac_f32_16x16x64_bf16 v[150:153], v[70:73], v[248:255], v41
    s_nop 4
    v_add_f32 v74, v74, v75
    v_add_f32 v76, v76, v77
    v_cvt_pk_bf16_f32 v40, v74, v76
    v_add_f32 v78, v78, v79
    v_add_f32 v80, v80, v81
    v_cvt_pk_bf16_f32 v42, v78, v80
    v_add_f32 v146, v146, v147
    v_add_f32 v148, v148, v149
    v_cvt_pk_bf16_f32 v44, v146, v148
    v_add_f32 v150, v150, v151
    v_add_f32 v152, v152, v153
    v_cvt_pk_bf16_f32 v46, v150, v152
    s_branch aloop_24_lskb
arq_25_ps:
    s_sub_u32 s26, s26, 1
    s_cbranch_scc1 arq_25_psg
    s_sleep 2
    buffer_load_dwordx4 v[130:133], v0, s[4:7], s21 offen sc1
    buffer_load_dwordx2 v[146:147], v2, s[4:7], s21 offen offset:1024 sc1
    buffer_load_dwordx4 v[134:137], v0, s[4:7], s21 offen offset:2048 sc1
    buffer_load_dwordx2 v[148:149], v2, s[4:7], s21 offen offset:3072 sc1
    s_branch aloop_24_psa
arq_25_psg:
    s_mov_b32 s26, 0
    s_branch aloop_24_psok
aloop_24_fin:
    s_barrier
    s_branch k_end
k_end:
k_exit:
    s_endpgm
.section .rodata,"a"
.p2align 6
jobtab:
    .long 6, 24, 24, 8192, 0, 262144, 8388608, 0, 32768, 4, 20971520, 131072, 0, 0, 218104320, 1
    .long 4, 24, 24, 8192, 0, 262144, 8388608, 262144, 32768, 4, 22020096, 131072, 0, 0, 218104448, 1
    .long 1, 32, 32, 8192, 0, 256, 8388608, 1048576, 32768, 8, 41943040, 131072, 0, 0, 218104832, 4
    .long 1, 16, 16, 8192, 0, 256, 8388608, 2097152, 32768, 8, 12582912, 131072, 0, 0, 218105344, 4
    .long 1, 32, 32, 8192, 0, 256, 8388608, 3145728, 32768, 8, 50331648, 131072, 0, 0, 218105856, 4
    .long 1, 32, 32, 8192, 0, 256, 8388608, 3670016, 32768, 8, 52428800, 131072, 0, 0, 218106112, 4
    .long 1, 80, 80, 2048, 0, 256, 7340032, 54525952, 114688, 7, 167772160, 32768, 218103808, 7, 218106368, 1
    .long 0, 0, 0, 0, 0, 0, 0, 0, 0, 0, 0, 0, 0, 0, 0, 0
    .long 0, 0, 0, 0, 0, 0, 0, 0, 0, 0, 0, 0, 0, 0, 0, 0
    .long 0, 0, 0, 0, 0, 0, 0, 0, 0, 0, 0, 0, 0, 0, 0, 0
    .long 6, 24, 24, 8192, 2048, 264192, 8388608, 0, 32768, 4, 21004288, 131072, 0, 0, 218104352, 1
    .long 4, 24, 24, 8192, 2048, 264192, 8388608, 262144, 32768, 4, 22052864, 131072, 0, 0, 218104480, 1
    .long 1, 32, 32, 8192, 2048, 2304, 8388608, 1048576, 32768, 8, 41975808, 131072, 0, 0, 218104864, 4
    .long 1, 16, 16, 8192, 2048, 2304, 8388608, 2097152, 32768, 8, 12615680, 131072, 0, 0, 218105376, 4
    .long 1, 32, 32, 8192, 2048, 2304, 8388608, 3145728, 32768, 8, 50364416, 131072, 0, 0, 218105888, 4
    .long 1, 32, 32, 8192, 2048, 2304, 8388608, 3670016, 32768, 8, 52461568, 131072, 0, 0, 218106144, 4
    .long 1, 80, 80, 2048, 1835008, 1835264, 7340032, 54554624, 114688, 7, 171966464, 32768, 218103824, 7, 218106368, 1
    .long 0, 0, 0, 0, 0, 0, 0, 0, 0, 0, 0, 0, 0, 0, 0, 0
    .long 0, 0, 0, 0, 0, 0, 0, 0, 0, 0, 0, 0, 0, 0, 0, 0
    .long 0, 0, 0, 0, 0, 0, 0, 0, 0, 0, 0, 0, 0, 0, 0, 0
    .long 6, 24, 24, 8192, 4096, 266240, 8388608, 0, 32768, 4, 21037056, 131072, 0, 0, 218104384, 1
    .long 4, 24, 24, 8192, 4096, 266240, 8388608, 262144, 32768, 4, 22085632, 131072, 0, 0, 218104512, 1
    .long 1, 32, 32, 8192, 4096, 4352, 8388608, 1048576, 32768, 8, 42008576, 131072, 0, 0, 218104896, 4
    .long 1, 16, 16, 8192, 4096, 4352, 8388608, 2097152, 32768, 8, 12648448, 131072, 0, 0, 218105408, 4
    .long 1, 32, 32, 8192, 4096, 4352, 8388608, 3145728, 32768, 8, 50397184, 131072, 0, 0, 218105920, 4
    .long 1, 32, 32, 8192, 4096, 4352, 8388608, 3670016, 32768, 8, 52494336, 131072, 0, 0, 218106176, 4
    .long 1, 80, 80, 2048, 3670016, 3670272, 7340032, 54583296, 114688, 7, 176160768, 32768, 218103840, 7, 218106368, 1
    .long 0, 0, 0, 0, 0, 0, 0, 0, 0, 0, 0, 0, 0, 0, 0, 0
    .long 0, 0, 0, 0, 0, 0, 0, 0, 0, 0, 0, 0, 0, 0, 0, 0
    .long 0, 0, 0, 0, 0, 0, 0, 0, 0, 0, 0, 0, 0, 0, 0, 0
    .long 6, 24, 24, 8192, 6144, 268288, 8388608, 0, 32768, 4, 21069824, 131072, 0, 0, 218104416, 1
    .long 4, 24, 24, 8192, 6144, 268288, 8388608, 262144, 32768, 4, 22118400, 131072, 0, 0, 218104544, 1
    .long 1, 32, 32, 8192, 6144, 6400, 8388608, 1048576, 32768, 8, 42041344, 131072, 0, 0, 218104928, 4
    .long 1, 16, 16, 8192, 6144, 6400, 8388608, 2097152, 32768, 8, 12681216, 131072, 0, 0, 218105440, 4
    .long 1, 32, 32, 8192, 6144, 6400, 8388608, 3145728, 32768, 8, 50429952, 131072, 0, 0, 218105952, 4
    .long 1, 32, 32, 8192, 6144, 6400, 8388608, 3670016, 32768, 8, 52527104, 131072, 0, 0, 218106208, 4
    .long 1, 80, 80, 2048, 5505024, 5505280, 7340032, 54611968, 114688, 7, 180355072, 32768, 218103856, 7, 218106368, 1
    .long 0, 0, 0, 0, 0, 0, 0, 0, 0, 0, 0, 0, 0, 0, 0, 0
    .long 0, 0, 0, 0, 0, 0, 0, 0, 0, 0, 0, 0, 0, 0, 0, 0
    .long 0, 0, 0, 0, 0, 0, 0, 0, 0, 0, 0, 0, 0, 0, 0, 0
    .long 6, 24, 24, 8192, 256, 262400, 8388608, 0, 32768, 4, 20975616, 131072, 0, 0, 218104320, 1
    .long 4, 24, 24, 8192, 256, 262400, 8388608, 262144, 32768, 4, 22024192, 131072, 0, 0, 218104448, 1
    .long 1, 32, 32, 8192, 512, 768, 8388608, 1048576, 32768, 8, 41951232, 131072, 0, 0, 218104832, 4
    .long 1, 16, 16, 8192, 512, 768, 8388608, 2097152, 32768, 8, 12591104, 131072, 0, 0, 218105344, 4
    .long 1, 32, 32, 8192, 512, 768, 8388608, 3145728, 32768, 8, 50339840, 131072, 0, 0, 218105856, 4
    .long 1, 32, 32, 8192, 512, 768, 8388608, 3670016, 32768, 8, 52436992, 131072, 0, 0, 218106112, 4
    .long 1, 80, 80, 2048, 512, 768, 7340032, 54525952, 114688, 7, 167780352, 32768, 218103808, 7, 218106368, 1
    .long 0, 0, 0, 0, 0, 0, 0, 0, 0, 0, 0, 0, 0, 0, 0, 0
    .long 0, 0, 0, 0, 0, 0, 0, 0, 0, 0, 0, 0, 0, 0, 0, 0
    .long 0, 0, 0, 0, 0, 0, 0, 0, 0, 0, 0, 0, 0, 0, 0, 0
    .long 6, 24, 24, 8192, 2304, 264448, 8388608, 0, 32768, 4, 21008384, 131072, 0, 0, 218104352, 1
    .long 4, 24, 24, 8192, 2304, 264448, 8388608, 262144, 32768, 4, 22056960, 131072, 0, 0, 218104480, 1
    .long 1, 32, 32, 8192, 2560, 2816, 8388608, 1048576, 32768, 8, 41984000, 131072, 0, 0, 218104864, 4
    .long 1, 16, 16, 8192, 2560, 2816, 8388608, 2097152, 32768, 8, 12623872, 131072, 0, 0, 218105376, 4
    .long 1, 32, 32, 8192, 2560, 2816, 8388608, 3145728, 32768, 8, 50372608, 131072, 0, 0, 218105888, 4
    .long 1, 32, 32, 8192, 2560, 2816, 8388608, 3670016, 32768, 8, 52469760, 131072, 0, 0, 218106144, 4
    .long 1, 80, 80, 2048, 1835520, 1835776, 7340032, 54554624, 114688, 7, 171974656, 32768, 218103824, 7, 218106368, 1
    .long 0, 0, 0, 0, 0, 0, 0, 0, 0, 0, 0, 0, 0, 0, 0, 0
    .long 0, 0, 0, 0, 0, 0, 0, 0, 0, 0, 0, 0, 0, 0, 0, 0
    .long 0, 0, 0, 0, 0, 0, 0, 0, 0, 0, 0, 0, 0, 0, 0, 0
    .long 6, 24, 24, 8192, 4352, 266496, 8388608, 0, 32768, 4, 21041152, 131072, 0, 0, 218104384, 1
    .long 4, 24, 24, 8192, 4352, 266496, 8388608, 262144, 32768, 4, 22089728, 131072, 0, 0, 218104512, 1
    .long 1, 32, 32, 8192, 4608, 4864, 8388608, 1048576, 32768, 8, 42016768, 131072, 0, 0, 218104896, 4
    .long 1, 16, 16, 8192, 4608, 4864, 8388608, 2097152, 32768, 8, 12656640, 131072, 0, 0, 218105408, 4
    .long 1, 32, 32, 8192, 4608, 4864, 8388608, 3145728, 32768, 8, 50405376, 131072, 0, 0, 218105920, 4
    .long 1, 32, 32, 8192, 4608, 4864, 8388608, 3670016, 32768, 8, 52502528, 131072, 0, 0, 218106176, 4
    .long 1, 80, 80, 2048, 3670528, 3670784, 7340032, 54583296, 114688, 7, 176168960, 32768, 218103840, 7, 218106368, 1
    .long 0, 0, 0, 0, 0, 0, 0, 0, 0, 0, 0, 0, 0, 0, 0, 0
    .long 0, 0, 0, 0, 0, 0, 0, 0, 0, 0, 0, 0, 0, 0, 0, 0
    .long 0, 0, 0, 0, 0, 0, 0, 0, 0, 0, 0, 0, 0, 0, 0, 0
    .long 6, 24, 24, 8192, 6400, 268544, 8388608, 0, 32768, 4, 21073920, 131072, 0, 0, 218104416, 1
    .long 4, 24, 24, 8192, 6400, 268544, 8388608, 262144, 32768, 4, 22122496, 131072, 0, 0, 218104544, 1
    .long 1, 32, 32, 8192, 6656, 6912, 8388608, 1048576, 32768, 8, 42049536, 131072, 0, 0, 218104928, 4
    .long 1, 16, 16, 8192, 6656, 6912, 8388608, 2097152, 32768, 8, 12689408, 131072, 0, 0, 218105440, 4
    .long 1, 32, 32, 8192, 6656, 6912, 8388608, 3145728, 32768, 8, 50438144, 131072, 0, 0, 218105952, 4
    .long 1, 32, 32, 8192, 6656, 6912, 8388608, 3670016, 32768, 8, 52535296, 131072, 0, 0, 218106208, 4
    .long 1, 80, 80, 2048, 5505536, 5505792, 7340032, 54611968, 114688, 7, 180363264, 32768, 218103856, 7, 218106368, 1
    .long 0, 0, 0, 0, 0, 0, 0, 0, 0, 0, 0, 0, 0, 0, 0, 0
    .long 0, 0, 0, 0, 0, 0, 0, 0, 0, 0, 0, 0, 0, 0, 0, 0
    .long 0, 0, 0, 0, 0, 0, 0, 0, 0, 0, 0, 0, 0, 0, 0, 0
    .long 6, 24, 24, 8192, 512, 262656, 8388608, 0, 32768, 4, 20979712, 131072, 0, 0, 218104320, 1
    .long 4, 24, 24, 8192, 512, 262656, 8388608, 262144, 32768, 4, 22028288, 131072, 0, 0, 218104448, 1
    .long 1, 32, 32, 8192, 1024, 1280, 8388608, 1048576, 32768, 8, 41959424, 131072, 0, 0, 218104848, 4
    .long 1, 16, 16, 8192, 1024, 1280, 8388608, 2097152, 32768, 8, 12599296, 131072, 0, 0, 218105360, 4
    .long 1, 32, 32, 8192, 1024, 1280, 8388608, 3145728, 32768, 8, 50348032, 131072, 0, 0, 218105872, 4
    .long 1, 32, 32, 8192, 1024, 1280, 8388608, 3670016, 32768, 8, 52445184, 131072, 0, 0, 218106128, 4
    .long 1, 80, 80, 2048, 1024, 1280, 7340032, 54525952, 114688, 7, 167788544, 32768, 218103808, 7, 218106368, 1
    .long 0, 0, 0, 0, 0, 0, 0, 0, 0, 0, 0, 0, 0, 0, 0, 0
    .long 0, 0, 0, 0, 0, 0, 0, 0, 0, 0, 0, 0, 0, 0, 0, 0
    .long 0, 0, 0, 0, 0, 0, 0, 0, 0, 0, 0, 0, 0, 0, 0, 0
    .long 6, 24, 24, 8192, 2560, 264704, 8388608, 0, 32768, 4, 21012480, 131072, 0, 0, 218104352, 1
    .long 4, 24, 24, 8192, 2560, 264704, 8388608, 262144, 32768, 4, 22061056, 131072, 0, 0, 218104480, 1
    .long 1, 32, 32, 8192, 3072, 3328, 8388608, 1048576, 32768, 8, 41992192, 131072, 0, 0, 218104880, 4
    .long 1, 16, 16, 8192, 3072, 3328, 8388608, 2097152, 32768, 8, 12632064, 131072, 0, 0, 218105392, 4
    .long 1, 32, 32, 8192, 3072, 3328, 8388608, 3145728, 32768, 8, 50380800, 131072, 0, 0, 218105904, 4
    .long 1, 32, 32, 8192, 3072, 3328, 8388608, 3670016, 32768, 8, 52477952, 131072, 0, 0, 218106160, 4
    .long 1, 80, 80, 2048, 1836032, 1836288, 7340032, 54554624, 114688, 7, 171982848, 32768, 218103824, 7, 218106368, 1
    .long 0, 0, 0, 0, 0, 0, 0, 0, 0, 0, 0, 0, 0, 0, 0, 0
    .long 0, 0, 0, 0, 0, 0, 0, 0, 0, 0, 0, 0, 0, 0, 0, 0
    .long 0, 0, 0, 0, 0, 0, 0, 0, 0, 0, 0, 0, 0, 0, 0, 0
    .long 6, 24, 24, 8192, 4608, 266752, 8388608, 0, 32768, 4, 21045248, 131072, 0, 0, 218104384, 1
    .long 4, 24, 24, 8192, 4608, 266752, 8388608, 262144, 32768, 4, 22093824, 131072, 0, 0, 218104512, 1
    .long 1, 32, 32, 8192, 5120, 5376, 8388608, 1048576, 32768, 8, 42024960, 131072, 0, 0, 218104912, 4
    .long 1, 16, 16, 8192, 5120, 5376, 8388608, 2097152, 32768, 8, 12664832, 131072, 0, 0, 218105424, 4
    .long 1, 32, 32, 8192, 5120, 5376, 8388608, 3145728, 32768, 8, 50413568, 131072, 0, 0, 218105936, 4
    .long 1, 32, 32, 8192, 5120, 5376, 8388608, 3670016, 32768, 8, 52510720, 131072, 0, 0, 218106192, 4
    .long 1, 80, 80, 2048, 3671040, 3671296, 7340032, 54583296, 114688, 7, 176177152, 32768, 218103840, 7, 218106368, 1
    .long 0, 0, 0, 0, 0, 0, 0, 0, 0, 0, 0, 0, 0, 0, 0, 0
    .long 0, 0, 0, 0, 0, 0, 0, 0, 0, 0, 0, 0, 0, 0, 0, 0
    .long 0, 0, 0, 0, 0, 0, 0, 0, 0, 0, 0, 0, 0, 0, 0, 0
    .long 6, 24, 24, 8192, 6656, 268800, 8388608, 0, 32768, 4, 21078016, 131072, 0, 0, 218104416, 1
    .long 4, 24, 24, 8192, 6656, 268800, 8388608, 262144, 32768, 4, 22126592, 131072, 0, 0, 218104544, 1
    .long 1, 32, 32, 8192, 7168, 7424, 8388608, 1048576, 32768, 8, 42057728, 131072, 0, 0, 218104944, 4
    .long 1, 16, 16, 8192, 7168, 7424, 8388608, 2097152, 32768, 8, 12697600, 131072, 0, 0, 218105456, 4
    .long 1, 32, 32, 8192, 7168, 7424, 8388608, 3145728, 32768, 8, 50446336, 131072, 0, 0, 218105968, 4
    .long 1, 32, 32, 8192, 7168, 7424, 8388608, 3670016, 32768, 8, 52543488, 131072, 0, 0, 218106224, 4
    .long 1, 80, 80, 2048, 5506048, 5506304, 7340032, 54611968, 114688, 7, 180371456, 32768, 218103856, 7, 218106368, 1
    .long 0, 0, 0, 0, 0, 0, 0, 0, 0, 0, 0, 0, 0, 0, 0, 0
    .long 0, 0, 0, 0, 0, 0, 0, 0, 0, 0, 0, 0, 0, 0, 0, 0
    .long 0, 0, 0, 0, 0, 0, 0, 0, 0, 0, 0, 0, 0, 0, 0, 0
    .long 6, 24, 24, 8192, 768, 262912, 8388608, 0, 32768, 4, 20983808, 131072, 0, 0, 218104320, 1
    .long 4, 24, 24, 8192, 768, 262912, 8388608, 262144, 32768, 4, 22032384, 131072, 0, 0, 218104448, 1
    .long 1, 32, 32, 8192, 1536, 1792, 8388608, 1048576, 32768, 8, 41967616, 131072, 0, 0, 218104848, 4
    .long 1, 16, 16, 8192, 1536, 1792, 8388608, 2097152, 32768, 8, 12607488, 131072, 0, 0, 218105360, 4
    .long 1, 32, 32, 8192, 1536, 1792, 8388608, 3145728, 32768, 8, 50356224, 131072, 0, 0, 218105872, 4
    .long 1, 32, 32, 8192, 1536, 1792, 8388608, 3670016, 32768, 8, 52453376, 131072, 0, 0, 218106128, 4
    .long 1, 80, 80, 2048, 1536, 1792, 7340032, 54525952, 114688, 7, 167796736, 32768, 218103808, 7, 218106368, 1
    .long 0, 0, 0, 0, 0, 0, 0, 0, 0, 0, 0, 0, 0, 0, 0, 0
    .long 0, 0, 0, 0, 0, 0, 0, 0, 0, 0, 0, 0, 0, 0, 0, 0
    .long 0, 0, 0, 0, 0, 0, 0, 0, 0, 0, 0, 0, 0, 0, 0, 0
    .long 6, 24, 24, 8192, 2816, 264960, 8388608, 0, 32768, 4, 21016576, 131072, 0, 0, 218104352, 1
    .long 4, 24, 24, 8192, 2816, 264960, 8388608, 262144, 32768, 4, 22065152, 131072, 0, 0, 218104480, 1
    .long 1, 32, 32, 8192, 3584, 3840, 8388608, 1048576, 32768, 8, 42000384, 131072, 0, 0, 218104880, 4
    .long 1, 16, 16, 8192, 3584, 3840, 8388608, 2097152, 32768, 8, 12640256, 131072, 0, 0, 218105392, 4
    .long 1, 32, 32, 8192, 3584, 3840, 8388608, 3145728, 32768, 8, 50388992, 131072, 0, 0, 218105904, 4
    .long 1, 32, 32, 8192, 3584, 3840, 8388608, 3670016, 32768, 8, 52486144, 131072, 0, 0, 218106160, 4
    .long 1, 80, 80, 2048, 1836544, 1836800, 7340032, 54554624, 114688, 7, 171991040, 32768, 218103824, 7, 218106368, 1
    .long 0, 0, 0, 0, 0, 0, 0, 0, 0, 0, 0, 0, 0, 0, 0, 0
    .long 0, 0, 0, 0, 0, 0, 0, 0, 0, 0, 0, 0, 0, 0, 0, 0
    .long 0, 0, 0, 0, 0, 0, 0, 0, 0, 0, 0, 0, 0, 0, 0, 0
    .long 6, 24, 24, 8192, 4864, 267008, 8388608, 0, 32768, 4, 21049344, 131072, 0, 0, 218104384, 1
    .long 4, 24, 24, 8192, 4864, 267008, 8388608, 262144, 32768, 4, 22097920, 131072, 0, 0, 218104512, 1
    .long 1, 32, 32, 8192, 5632, 5888, 8388608, 1048576, 32768, 8, 42033152, 131072, 0, 0, 218104912, 4
    .long 1, 16, 16, 8192, 5632, 5888, 8388608, 2097152, 32768, 8, 12673024, 131072, 0, 0, 218105424, 4
    .long 1, 32, 32, 8192, 5632, 5888, 8388608, 3145728, 32768, 8, 50421760, 131072, 0, 0, 218105936, 4
    .long 1, 32, 32, 8192, 5632, 5888, 8388608, 3670016, 32768, 8, 52518912, 131072, 0, 0, 218106192, 4
    .long 1, 80, 80, 2048, 3671552, 3671808, 7340032, 54583296, 114688, 7, 176185344, 32768, 218103840, 7, 218106368, 1
    .long 0, 0, 0, 0, 0, 0, 0, 0, 0, 0, 0, 0, 0, 0, 0, 0
    .long 0, 0, 0, 0, 0, 0, 0, 0, 0, 0, 0, 0, 0, 0, 0, 0
    .long 0, 0, 0, 0, 0, 0, 0, 0, 0, 0, 0, 0, 0, 0, 0, 0
    .long 6, 24, 24, 8192, 6912, 269056, 8388608, 0, 32768, 4, 21082112, 131072, 0, 0, 218104416, 1
    .long 4, 24, 24, 8192, 6912, 269056, 8388608, 262144, 32768, 4, 22130688, 131072, 0, 0, 218104544, 1
    .long 1, 32, 32, 8192, 7680, 7936, 8388608, 1048576, 32768, 8, 42065920, 131072, 0, 0, 218104944, 4
    .long 1, 16, 16, 8192, 7680, 7936, 8388608, 2097152, 32768, 8, 12705792, 131072, 0, 0, 218105456, 4
    .long 1, 32, 32, 8192, 7680, 7936, 8388608, 3145728, 32768, 8, 50454528, 131072, 0, 0, 218105968, 4
    .long 1, 32, 32, 8192, 7680, 7936, 8388608, 3670016, 32768, 8, 52551680, 131072, 0, 0, 218106224, 4
    .long 1, 80, 80, 2048, 5506560, 5506816, 7340032, 54611968, 114688, 7, 180379648, 32768, 218103856, 7, 218106368, 1
    .long 0, 0, 0, 0, 0, 0, 0, 0, 0, 0, 0, 0, 0, 0, 0, 0
    .long 0, 0, 0, 0, 0, 0, 0, 0, 0, 0, 0, 0, 0, 0, 0, 0
    .long 0, 0, 0, 0, 0, 0, 0, 0, 0, 0, 0, 0, 0, 0, 0, 0
    .long 6, 24, 24, 8192, 1024, 263168, 8388608, 0, 32768, 4, 20987904, 131072, 0, 0, 218104336, 1
    .long 4, 24, 24, 8192, 1024, 263168, 8388608, 262144, 32768, 4, 22036480, 131072, 0, 0, 218104464, 1
    .long 1, 24, 24, 8192, 0, 256, 8388608, 1048576, 32768, 8, 25165824, 131072, 0, 0, 218104832, 4
    .long 1, 32, 32, 8192, 0, 256, 8388608, 2621440, 32768, 8, 48234496, 131072, 0, 0, 218105600, 4
    .long 1, 24, 24, 8192, 0, 256, 8388608, 3145728, 32768, 8, 33554432, 131072, 0, 0, 218105856, 4
    .long 1, 24, 24, 8192, 0, 256, 8388608, 3670016, 32768, 8, 35651584, 131072, 0, 0, 218106112, 4
    .long 1, 80, 80, 2048, 0, 256, 7340032, 56360960, 114688, 7, 168296448, 32768, 218103872, 7, 218106432, 1
    .long 0, 0, 0, 0, 0, 0, 0, 0, 0, 0, 0, 0, 0, 0, 0, 0
    .long 0, 0, 0, 0, 0, 0, 0, 0, 0, 0, 0, 0, 0, 0, 0, 0
    .long 0, 0, 0, 0, 0, 0, 0, 0, 0, 0, 0, 0, 0, 0, 0, 0
    .long 6, 24, 24, 8192, 3072, 265216, 8388608, 0, 32768, 4, 21020672, 131072, 0, 0, 218104368, 1
    .long 4, 24, 24, 8192, 3072, 265216, 8388608, 262144, 32768, 4, 22069248, 131072, 0, 0, 218104496, 1
    .long 1, 24, 24, 8192, 2048, 2304, 8388608, 1048576, 32768, 8, 25198592, 131072, 0, 0, 218104864, 4
    .long 1, 32, 32, 8192, 2048, 2304, 8388608, 2621440, 32768, 8, 48267264, 131072, 0, 0, 218105632, 4
    .long 1, 24, 24, 8192, 2048, 2304, 8388608, 3145728, 32768, 8, 33587200, 131072, 0, 0, 218105888, 4
    .long 1, 24, 24, 8192, 2048, 2304, 8388608, 3670016, 32768, 8, 35684352, 131072, 0, 0, 218106144, 4
    .long 1, 80, 80, 2048, 1835008, 1835264, 7340032, 56389632, 114688, 7, 172490752, 32768, 218103888, 7, 218106432, 1
    .long 0, 0, 0, 0, 0, 0, 0, 0, 0, 0, 0, 0, 0, 0, 0, 0
    .long 0, 0, 0, 0, 0, 0, 0, 0, 0, 0, 0, 0, 0, 0, 0, 0
    .long 0, 0, 0, 0, 0, 0, 0, 0, 0, 0, 0, 0, 0, 0, 0, 0
    .long 6, 24, 24, 8192, 5120, 267264, 8388608, 0, 32768, 4, 21053440, 131072, 0, 0, 218104400, 1
    .long 4, 24, 24, 8192, 5120, 267264, 8388608, 262144, 32768, 4, 22102016, 131072, 0, 0, 218104528, 1
    .long 1, 24, 24, 8192, 4096, 4352, 8388608, 1048576, 32768, 8, 25231360, 131072, 0, 0, 218104896, 4
    .long 1, 32, 32, 8192, 4096, 4352, 8388608, 2621440, 32768, 8, 48300032, 131072, 0, 0, 218105664, 4
    .long 1, 24, 24, 8192, 4096, 4352, 8388608, 3145728, 32768, 8, 33619968, 131072, 0, 0, 218105920, 4
    .long 1, 24, 24, 8192, 4096, 4352, 8388608, 3670016, 32768, 8, 35717120, 131072, 0, 0, 218106176, 4
    .long 1, 80, 80, 2048, 3670016, 3670272, 7340032, 56418304, 114688, 7, 176685056, 32768, 218103904, 7, 218106432, 1
    .long 0, 0, 0, 0, 0, 0, 0, 0, 0, 0, 0, 0, 0, 0, 0, 0
    .long 0, 0, 0, 0, 0, 0, 0, 0, 0, 0, 0, 0, 0, 0, 0, 0
    .long 0, 0, 0, 0, 0, 0, 0, 0, 0, 0, 0, 0, 0, 0, 0, 0
    .long 6, 24, 24, 8192, 7168, 269312, 8388608, 0, 32768, 4, 21086208, 131072, 0, 0, 218104432, 1
    .long 4, 24, 24, 8192, 7168, 269312, 8388608, 262144, 32768, 4, 22134784, 131072, 0, 0, 218104560, 1
    .long 1, 24, 24, 8192, 6144, 6400, 8388608, 1048576, 32768, 8, 25264128, 131072, 0, 0, 218104928, 4
    .long 1, 32, 32, 8192, 6144, 6400, 8388608, 2621440, 32768, 8, 48332800, 131072, 0, 0, 218105696, 4
    .long 1, 24, 24, 8192, 6144, 6400, 8388608, 3145728, 32768, 8, 33652736, 131072, 0, 0, 218105952, 4
    .long 1, 24, 24, 8192, 6144, 6400, 8388608, 3670016, 32768, 8, 35749888, 131072, 0, 0, 218106208, 4
    .long 1, 80, 80, 2048, 5505024, 5505280, 7340032, 56446976, 114688, 7, 180879360, 32768, 218103920, 7, 218106432, 1
    .long 0, 0, 0, 0, 0, 0, 0, 0, 0, 0, 0, 0, 0, 0, 0, 0
    .long 0, 0, 0, 0, 0, 0, 0, 0, 0, 0, 0, 0, 0, 0, 0, 0
    .long 0, 0, 0, 0, 0, 0, 0, 0, 0, 0, 0, 0, 0, 0, 0, 0
    .long 6, 24, 24, 8192, 1280, 263424, 8388608, 0, 32768, 4, 20992000, 131072, 0, 0, 218104336, 1
    .long 4, 24, 24, 8192, 1280, 263424, 8388608, 262144, 32768, 4, 22040576, 131072, 0, 0, 218104464, 1
    .long 1, 24, 24, 8192, 512, 768, 8388608, 1048576, 32768, 8, 25174016, 131072, 0, 0, 218104832, 4
    .long 1, 32, 32, 8192, 512, 768, 8388608, 2621440, 32768, 8, 48242688, 131072, 0, 0, 218105600, 4
    .long 1, 24, 24, 8192, 512, 768, 8388608, 3145728, 32768, 8, 33562624, 131072, 0, 0, 218105856, 4
    .long 1, 24, 24, 8192, 512, 768, 8388608, 3670016, 32768, 8, 35659776, 131072, 0, 0, 218106112, 4
    .long 1, 80, 80, 2048, 512, 768, 7340032, 56360960, 114688, 7, 168304640, 32768, 218103872, 7, 218106432, 1
    .long 0, 0, 0, 0, 0, 0, 0, 0, 0, 0, 0, 0, 0, 0, 0, 0
    .long 0, 0, 0, 0, 0, 0, 0, 0, 0, 0, 0, 0, 0, 0, 0, 0
    .long 0, 0, 0, 0, 0, 0, 0, 0, 0, 0, 0, 0, 0, 0, 0, 0
    .long 6, 24, 24, 8192, 3328, 265472, 8388608, 0, 32768, 4, 21024768, 131072, 0, 0, 218104368, 1
    .long 4, 24, 24, 8192, 3328, 265472, 8388608, 262144, 32768, 4, 22073344, 131072, 0, 0, 218104496, 1
    .long 1, 24, 24, 8192, 2560, 2816, 8388608, 1048576, 32768, 8, 25206784, 131072, 0, 0, 218104864, 4
    .long 1, 32, 32, 8192, 2560, 2816, 8388608, 2621440, 32768, 8, 48275456, 131072, 0, 0, 218105632, 4
    .long 1, 24, 24, 8192, 2560, 2816, 8388608, 3145728, 32768, 8, 33595392, 131072, 0, 0, 218105888, 4
    .long 1, 24, 24, 8192, 2560, 2816, 8388608, 3670016, 32768, 8, 35692544, 131072, 0, 0, 218106144, 4
    .long 1, 80, 80, 2048, 1835520, 1835776, 7340032, 56389632, 114688, 7, 172498944, 32768, 218103888, 7, 218106432, 1
    .long 0, 0, 0, 0, 0, 0, 0, 0, 0, 0, 0, 0, 0, 0, 0, 0
    .long 0, 0, 0, 0, 0, 0, 0, 0, 0, 0, 0, 0, 0, 0, 0, 0
    .long 0, 0, 0, 0, 0, 0, 0, 0, 0, 0, 0, 0, 0, 0, 0, 0
    .long 6, 24, 24, 8192, 5376, 267520, 8388608, 0, 32768, 4, 21057536, 131072, 0, 0, 218104400, 1
    .long 4, 24, 24, 8192, 5376, 267520, 8388608, 262144, 32768, 4, 22106112, 131072, 0, 0, 218104528, 1
    .long 1, 24, 24, 8192, 4608, 4864, 8388608, 1048576, 32768, 8, 25239552, 131072, 0, 0, 218104896, 4
    .long 1, 32, 32, 8192, 4608, 4864, 8388608, 2621440, 32768, 8, 48308224, 131072, 0, 0, 218105664, 4
    .long 1, 24, 24, 8192, 4608, 4864, 8388608, 3145728, 32768, 8, 33628160, 131072, 0, 0, 218105920, 4
    .long 1, 24, 24, 8192, 4608, 4864, 8388608, 3670016, 32768, 8, 35725312, 131072, 0, 0, 218106176, 4
    .long 1, 80, 80, 2048, 3670528, 3670784, 7340032, 56418304, 114688, 7, 176693248, 32768, 218103904, 7, 218106432, 1
    .long 0, 0, 0, 0, 0, 0, 0, 0, 0, 0, 0, 0, 0, 0, 0, 0
    .long 0, 0, 0, 0, 0, 0, 0, 0, 0, 0, 0, 0, 0, 0, 0, 0
    .long 0, 0, 0, 0, 0, 0, 0, 0, 0, 0, 0, 0, 0, 0, 0, 0
    .long 6, 24, 24, 8192, 7424, 269568, 8388608, 0, 32768, 4, 21090304, 131072, 0, 0, 218104432, 1
    .long 4, 24, 24, 8192, 7424, 269568, 8388608, 262144, 32768, 4, 22138880, 131072, 0, 0, 218104560, 1
    .long 1, 24, 24, 8192, 6656, 6912, 8388608, 1048576, 32768, 8, 25272320, 131072, 0, 0, 218104928, 4
    .long 1, 32, 32, 8192, 6656, 6912, 8388608, 2621440, 32768, 8, 48340992, 131072, 0, 0, 218105696, 4
    .long 1, 24, 24, 8192, 6656, 6912, 8388608, 3145728, 32768, 8, 33660928, 131072, 0, 0, 218105952, 4
    .long 1, 24, 24, 8192, 6656, 6912, 8388608, 3670016, 32768, 8, 35758080, 131072, 0, 0, 218106208, 4
    .long 1, 80, 80, 2048, 5505536, 5505792, 7340032, 56446976, 114688, 7, 180887552, 32768, 218103920, 7, 218106432, 1
    .long 0, 0, 0, 0, 0, 0, 0, 0, 0, 0, 0, 0, 0, 0, 0, 0
    .long 0, 0, 0, 0, 0, 0, 0, 0, 0, 0, 0, 0, 0, 0, 0, 0
    .long 0, 0, 0, 0, 0, 0, 0, 0, 0, 0, 0, 0, 0, 0, 0, 0
    .long 6, 24, 24, 8192, 1536, 263680, 8388608, 0, 32768, 4, 20996096, 131072, 0, 0, 218104336, 1
    .long 4, 24, 24, 8192, 1536, 263680, 8388608, 262144, 32768, 4, 22044672, 131072, 0, 0, 218104464, 1
    .long 1, 24, 24, 8192, 1024, 1280, 8388608, 1048576, 32768, 8, 25182208, 131072, 0, 0, 218104848, 4
    .long 1, 32, 32, 8192, 1024, 1280, 8388608, 2621440, 32768, 8, 48250880, 131072, 0, 0, 218105616, 4
    .long 1, 24, 24, 8192, 1024, 1280, 8388608, 3145728, 32768, 8, 33570816, 131072, 0, 0, 218105872, 4
    .long 1, 24, 24, 8192, 1024, 1280, 8388608, 3670016, 32768, 8, 35667968, 131072, 0, 0, 218106128, 4
    .long 1, 80, 80, 2048, 1024, 1280, 7340032, 56360960, 114688, 7, 168312832, 32768, 218103872, 7, 218106432, 1
    .long 0, 0, 0, 0, 0, 0, 0, 0, 0, 0, 0, 0, 0, 0, 0, 0
    .long 0, 0, 0, 0, 0, 0, 0, 0, 0, 0, 0, 0, 0, 0, 0, 0
    .long 0, 0, 0, 0, 0, 0, 0, 0, 0, 0, 0, 0, 0, 0, 0, 0
    .long 6, 24, 24, 8192, 3584, 265728, 8388608, 0, 32768, 4, 21028864, 131072, 0, 0, 218104368, 1
    .long 4, 24, 24, 8192, 3584, 265728, 8388608, 262144, 32768, 4, 22077440, 131072, 0, 0, 218104496, 1
    .long 1, 24, 24, 8192, 3072, 3328, 8388608, 1048576, 32768, 8, 25214976, 131072, 0, 0, 218104880, 4
    .long 1, 32, 32, 8192, 3072, 3328, 8388608, 2621440, 32768, 8, 48283648, 131072, 0, 0, 218105648, 4
    .long 1, 24, 24, 8192, 3072, 3328, 8388608, 3145728, 32768, 8, 33603584, 131072, 0, 0, 218105904, 4
    .long 1, 24, 24, 8192, 3072, 3328, 8388608, 3670016, 32768, 8, 35700736, 131072, 0, 0, 218106160, 4
    .long 1, 80, 80, 2048, 1836032, 1836288, 7340032, 56389632, 114688, 7, 172507136, 32768, 218103888, 7, 218106432, 1
    .long 0, 0, 0, 0, 0, 0, 0, 0, 0, 0, 0, 0, 0, 0, 0, 0
    .long 0, 0, 0, 0, 0, 0, 0, 0, 0, 0, 0, 0, 0, 0, 0, 0
    .long 0, 0, 0, 0, 0, 0, 0, 0, 0, 0, 0, 0, 0, 0, 0, 0
    .long 6, 24, 24, 8192, 5632, 267776, 8388608, 0, 32768, 4, 21061632, 131072, 0, 0, 218104400, 1
    .long 4, 24, 24, 8192, 5632, 267776, 8388608, 262144, 32768, 4, 22110208, 131072, 0, 0, 218104528, 1
    .long 1, 24, 24, 8192, 5120, 5376, 8388608, 1048576, 32768, 8, 25247744, 131072, 0, 0, 218104912, 4
    .long 1, 32, 32, 8192, 5120, 5376, 8388608, 2621440, 32768, 8, 48316416, 131072, 0, 0, 218105680, 4
    .long 1, 24, 24, 8192, 5120, 5376, 8388608, 3145728, 32768, 8, 33636352, 131072, 0, 0, 218105936, 4
    .long 1, 24, 24, 8192, 5120, 5376, 8388608, 3670016, 32768, 8, 35733504, 131072, 0, 0, 218106192, 4
    .long 1, 80, 80, 2048, 3671040, 3671296, 7340032, 56418304, 114688, 7, 176701440, 32768, 218103904, 7, 218106432, 1
    .long 0, 0, 0, 0, 0, 0, 0, 0, 0, 0, 0, 0, 0, 0, 0, 0
    .long 0, 0, 0, 0, 0, 0, 0, 0, 0, 0, 0, 0, 0, 0, 0, 0
    .long 0, 0, 0, 0, 0, 0, 0, 0, 0, 0, 0, 0, 0, 0, 0, 0
    .long 6, 24, 24, 8192, 7680, 269824, 8388608, 0, 32768, 4, 21094400, 131072, 0, 0, 218104432, 1
    .long 4, 24, 24, 8192, 7680, 269824, 8388608, 262144, 32768, 4, 22142976, 131072, 0, 0, 218104560, 1
    .long 1, 24, 24, 8192, 7168, 7424, 8388608, 1048576, 32768, 8, 25280512, 131072, 0, 0, 218104944, 4
    .long 1, 32, 32, 8192, 7168, 7424, 8388608, 2621440, 32768, 8, 48349184, 131072, 0, 0, 218105712, 4
    .long 1, 24, 24, 8192, 7168, 7424, 8388608, 3145728, 32768, 8, 33669120, 131072, 0, 0, 218105968, 4
    .long 1, 24, 24, 8192, 7168, 7424, 8388608, 3670016, 32768, 8, 35766272, 131072, 0, 0, 218106224, 4
    .long 1, 80, 80, 2048, 5506048, 5506304, 7340032, 56446976, 114688, 7, 180895744, 32768, 218103920, 7, 218106432, 1
    .long 0, 0, 0, 0, 0, 0, 0, 0, 0, 0, 0, 0, 0, 0, 0, 0
    .long 0, 0, 0, 0, 0, 0, 0, 0, 0, 0, 0, 0, 0, 0, 0, 0
    .long 0, 0, 0, 0, 0, 0, 0, 0, 0, 0, 0, 0, 0, 0, 0, 0
    .long 6, 24, 24, 8192, 1792, 263936, 8388608, 0, 32768, 4, 21000192, 131072, 0, 0, 218104336, 1
    .long 4, 24, 24, 8192, 1792, 263936, 8388608, 262144, 32768, 4, 22048768, 131072, 0, 0, 218104464, 1
    .long 1, 24, 24, 8192, 1536, 1792, 8388608, 1048576, 32768, 8, 25190400, 131072, 0, 0, 218104848, 4
    .long 1, 32, 32, 8192, 1536, 1792, 8388608, 2621440, 32768, 8, 48259072, 131072, 0, 0, 218105616, 4
    .long 1, 24, 24, 8192, 1536, 1792, 8388608, 3145728, 32768, 8, 33579008, 131072, 0, 0, 218105872, 4
    .long 1, 24, 24, 8192, 1536, 1792, 8388608, 3670016, 32768, 8, 35676160, 131072, 0, 0, 218106128, 4
    .long 1, 80, 80, 2048, 1536, 1792, 7340032, 56360960, 114688, 7, 168321024, 32768, 218103872, 7, 218106432, 1
    .long 0, 0, 0, 0, 0, 0, 0, 0, 0, 0, 0, 0, 0, 0, 0, 0
    .long 0, 0, 0, 0, 0, 0, 0, 0, 0, 0, 0, 0, 0, 0, 0, 0
    .long 0, 0, 0, 0, 0, 0, 0, 0, 0, 0, 0, 0, 0, 0, 0, 0
    .long 6, 24, 24, 8192, 3840, 265984, 8388608, 0, 32768, 4, 21032960, 131072, 0, 0, 218104368, 1
    .long 4, 24, 24, 8192, 3840, 265984, 8388608, 262144, 32768, 4, 22081536, 131072, 0, 0, 218104496, 1
    .long 1, 24, 24, 8192, 3584, 3840, 8388608, 1048576, 32768, 8, 25223168, 131072, 0, 0, 218104880, 4
    .long 1, 32, 32, 8192, 3584, 3840, 8388608, 2621440, 32768, 8, 48291840, 131072, 0, 0, 218105648, 4
    .long 1, 24, 24, 8192, 3584, 3840, 8388608, 3145728, 32768, 8, 33611776, 131072, 0, 0, 218105904, 4
    .long 1, 24, 24, 8192, 3584, 3840, 8388608, 3670016, 32768, 8, 35708928, 131072, 0, 0, 218106160, 4
    .long 1, 80, 80, 2048, 1836544, 1836800, 7340032, 56389632, 114688, 7, 172515328, 32768, 218103888, 7, 218106432, 1
    .long 0, 0, 0, 0, 0, 0, 0, 0, 0, 0, 0, 0, 0, 0, 0, 0
    .long 0, 0, 0, 0, 0, 0, 0, 0, 0, 0, 0, 0, 0, 0, 0, 0
    .long 0, 0, 0, 0, 0, 0, 0, 0, 0, 0, 0, 0, 0, 0, 0, 0
    .long 6, 24, 24, 8192, 5888, 268032, 8388608, 0, 32768, 4, 21065728, 131072, 0, 0, 218104400, 1
    .long 4, 24, 24, 8192, 5888, 268032, 8388608, 262144, 32768, 4, 22114304, 131072, 0, 0, 218104528, 1
    .long 1, 24, 24, 8192, 5632, 5888, 8388608, 1048576, 32768, 8, 25255936, 131072, 0, 0, 218104912, 4
    .long 1, 32, 32, 8192, 5632, 5888, 8388608, 2621440, 32768, 8, 48324608, 131072, 0, 0, 218105680, 4
    .long 1, 24, 24, 8192, 5632, 5888, 8388608, 3145728, 32768, 8, 33644544, 131072, 0, 0, 218105936, 4
    .long 1, 24, 24, 8192, 5632, 5888, 8388608, 3670016, 32768, 8, 35741696, 131072, 0, 0, 218106192, 4
    .long 1, 80, 80, 2048, 3671552, 3671808, 7340032, 56418304, 114688, 7, 176709632, 32768, 218103904, 7, 218106432, 1
    .long 0, 0, 0, 0, 0, 0, 0, 0, 0, 0, 0, 0, 0, 0, 0, 0
    .long 0, 0, 0, 0, 0, 0, 0, 0, 0, 0, 0, 0, 0, 0, 0, 0
    .long 0, 0, 0, 0, 0, 0, 0, 0, 0, 0, 0, 0, 0, 0, 0, 0
    .long 6, 24, 24, 8192, 7936, 270080, 8388608, 0, 32768, 4, 21098496, 131072, 0, 0, 218104432, 1
    .long 4, 24, 24, 8192, 7936, 270080, 8388608, 262144, 32768, 4, 22147072, 131072, 0, 0, 218104560, 1
    .long 1, 24, 24, 8192, 7680, 7936, 8388608, 1048576, 32768, 8, 25288704, 131072, 0, 0, 218104944, 4
    .long 1, 32, 32, 8192, 7680, 7936, 8388608, 2621440, 32768, 8, 48357376, 131072, 0, 0, 218105712, 4
    .long 1, 24, 24, 8192, 7680, 7936, 8388608, 3145728, 32768, 8, 33677312, 131072, 0, 0, 218105968, 4
    .long 1, 24, 24, 8192, 7680, 7936, 8388608, 3670016, 32768, 8, 35774464, 131072, 0, 0, 218106224, 4
    .long 1, 80, 80, 2048, 5506560, 5506816, 7340032, 56446976, 114688, 7, 180903936, 32768, 218103920, 7, 218106432, 1
    .long 0, 0, 0, 0, 0, 0, 0, 0, 0, 0, 0, 0, 0, 0, 0, 0
    .long 0, 0, 0, 0, 0, 0, 0, 0, 0, 0, 0, 0, 0, 0, 0, 0
    .long 0, 0, 0, 0, 0, 0, 0, 0, 0, 0, 0, 0, 0, 0, 0, 0
    .long 6, 32, 32, 8192, 0, 262144, 8388608, 0, 32768, 4, 37748736, 131072, 0, 0, 218104320, 1
    .long 4, 32, 32, 8192, 0, 262144, 8388608, 262144, 32768, 4, 38797312, 131072, 0, 0, 218104448, 1
    .long 4, 16, 16, 8192, 1792, 263936, 8388608, 786432, 32768, 4, 7368704, 131072, 0, 0, 218104592, 1
    .long 1, 24, 24, 8192, 0, 256, 8388608, 1572864, 32768, 8, 27262976, 131072, 0, 0, 218105088, 4
    .long 2, 64, 72, 7168, 0, 0, 7340032, 0, 32768, 8, 54525952, 114688, 0, 0, 218103808, 1
    .long 2, 64, 72, 7168, 6144, 6144, 7340032, 1048576, 32768, 8, 58294272, 114688, 0, 0, 218103984, 1
    .long 2, 64, 72, 7168, 5120, 5120, 7340032, 2621440, 32768, 8, 63782912, 114688, 0, 0, 218104160, 1
    .long 1, 80, 80, 2048, 0, 256, 7340032, 61865984, 114688, 7, 169869312, 32768, 218104064, 7, 218106624, 1
    .long 0, 0, 0, 0, 0, 0, 0, 0, 0, 0, 0, 0, 0, 0, 0, 0
    .long 0, 0, 0, 0, 0, 0, 0, 0, 0, 0, 0, 0, 0, 0, 0, 0
    .long 6, 32, 32, 8192, 2048, 264192, 8388608, 0, 32768, 4, 37781504, 131072, 0, 0, 218104352, 1
    .long 4, 32, 32, 8192, 2048, 264192, 8388608, 262144, 32768, 4, 38830080, 131072, 0, 0, 218104480, 1
    .long 4, 16, 16, 8192, 3840, 265984, 8388608, 786432, 32768, 4, 7401472, 131072, 0, 0, 218104624, 1
    .long 1, 24, 24, 8192, 2048, 2304, 8388608, 1572864, 32768, 8, 27295744, 131072, 0, 0, 218105120, 4
    .long 2, 64, 72, 7168, 256, 256, 7340032, 0, 32768, 8, 54530048, 114688, 0, 0, 218103808, 1
    .long 2, 64, 72, 7168, 6400, 6400, 7340032, 1048576, 32768, 8, 58298368, 114688, 0, 0, 218103984, 1
    .long 2, 64, 72, 7168, 5376, 5376, 7340032, 2621440, 32768, 8, 63787008, 114688, 0, 0, 218104176, 1
    .long 1, 80, 80, 2048, 1835008, 1835264, 7340032, 61894656, 114688, 7, 174063616, 32768, 218104080, 7, 218106624, 1
    .long 0, 0, 0, 0, 0, 0, 0, 0, 0, 0, 0, 0, 0, 0, 0, 0
    .long 0, 0, 0, 0, 0, 0, 0, 0, 0, 0, 0, 0, 0, 0, 0, 0
    .long 6, 32, 32, 8192, 4096, 266240, 8388608, 0, 32768, 4, 37814272, 131072, 0, 0, 218104384, 1
    .long 4, 32, 32, 8192, 4096, 266240, 8388608, 262144, 32768, 4, 38862848, 131072, 0, 0, 218104512, 1
    .long 4, 16, 16, 8192, 5888, 268032, 8388608, 786432, 32768, 4, 7434240, 131072, 0, 0, 218104656, 1
    .long 1, 24, 24, 8192, 4096, 4352, 8388608, 1572864, 32768, 8, 27328512, 131072, 0, 0, 218105152, 4
    .long 2, 64, 72, 7168, 512, 512, 7340032, 0, 32768, 8, 54534144, 114688, 0, 0, 218103808, 1
    .long 2, 64, 72, 7168, 6656, 6656, 7340032, 1048576, 32768, 8, 58302464, 114688, 0, 0, 218103984, 1
    .long 2, 64, 72, 7168, 5632, 5632, 7340032, 2621440, 32768, 8, 63791104, 114688, 0, 0, 218104176, 1
    .long 1, 80, 80, 2048, 3670016, 3670272, 7340032, 61923328, 114688, 7, 178257920, 32768, 218104096, 7, 218106624, 1
    .long 0, 0, 0, 0, 0, 0, 0, 0, 0, 0, 0, 0, 0, 0, 0, 0
    .long 0, 0, 0, 0, 0, 0, 0, 0, 0, 0, 0, 0, 0, 0, 0, 0
    .long 6, 32, 32, 8192, 6144, 268288, 8388608, 0, 32768, 4, 37847040, 131072, 0, 0, 218104416, 1
    .long 4, 32, 32, 8192, 6144, 268288, 8388608, 262144, 32768, 4, 38895616, 131072, 0, 0, 218104544, 1
    .long 4, 16, 16, 8192, 7936, 270080, 8388608, 786432, 32768, 4, 7467008, 131072, 0, 0, 218104688, 1
    .long 1, 24, 24, 8192, 6144, 6400, 8388608, 1572864, 32768, 8, 27361280, 131072, 0, 0, 218105184, 4
    .long 2, 64, 72, 7168, 768, 768, 7340032, 0, 32768, 8, 54538240, 114688, 0, 0, 218103808, 1
    .long 2, 64, 72, 7168, 6912, 6912, 7340032, 1048576, 32768, 8, 58306560, 114688, 0, 0, 218103984, 1
    .long 2, 64, 72, 7168, 5888, 5888, 7340032, 2621440, 32768, 8, 63795200, 114688, 0, 0, 218104176, 1
    .long 1, 80, 80, 2048, 5505024, 5505280, 7340032, 61952000, 114688, 7, 182452224, 32768, 218104112, 7, 218106624, 1
    .long 0, 0, 0, 0, 0, 0, 0, 0, 0, 0, 0, 0, 0, 0, 0, 0
    .long 0, 0, 0, 0, 0, 0, 0, 0, 0, 0, 0, 0, 0, 0, 0, 0
    .long 6, 32, 32, 8192, 256, 262400, 8388608, 0, 32768, 4, 37752832, 131072, 0, 0, 218104320, 1
    .long 4, 32, 32, 8192, 256, 262400, 8388608, 262144, 32768, 4, 38801408, 131072, 0, 0, 218104448, 1
    .long 4, 16, 16, 8192, 1792, 263936, 8388608, 524288, 32768, 4, 6320128, 131072, 0, 0, 218104592, 1
    .long 1, 24, 24, 8192, 512, 768, 8388608, 1572864, 32768, 8, 27271168, 131072, 0, 0, 218105088, 4
    .long 2, 64, 72, 7168, 1024, 1024, 7340032, 0, 32768, 8, 54542336, 114688, 0, 0, 218103808, 1
    .long 2, 64, 72, 7168, 0, 0, 7340032, 1572864, 32768, 8, 60030976, 114688, 0, 0, 218104000, 1
    .long 2, 64, 72, 7168, 6144, 6144, 7340032, 2621440, 32768, 8, 63799296, 114688, 0, 0, 218104176, 1
    .long 1, 80, 80, 2048, 512, 768, 7340032, 61865984, 114688, 7, 169877504, 32768, 218104064, 7, 218106624, 1
    .long 0, 0, 0, 0, 0, 0, 0, 0, 0, 0, 0, 0, 0, 0, 0, 0
    .long 0, 0, 0, 0, 0, 0, 0, 0, 0, 0, 0, 0, 0, 0, 0, 0
    .long 6, 32, 32, 8192, 2304, 264448, 8388608, 0, 32768, 4, 37785600, 131072, 0, 0, 218104352, 1
    .long 4, 32, 32, 8192, 2304, 264448, 8388608, 262144, 32768, 4, 38834176, 131072, 0, 0, 218104480, 1
    .long 4, 16, 16, 8192, 3840, 265984, 8388608, 524288, 32768, 4, 6352896, 131072, 0, 0, 218104624, 1
    .long 1, 24, 24, 8192, 2560, 2816, 8388608, 1572864, 32768, 8, 27303936, 131072, 0, 0, 218105120, 4
    .long 2, 64, 72, 7168, 1280, 1280, 7340032, 0, 32768, 8, 54546432, 114688, 0, 0, 218103808, 1
    .long 2, 64, 72, 7168, 256, 256, 7340032, 1572864, 32768, 8, 60035072, 114688, 0, 0, 218104000, 1
    .long 2, 64, 72, 7168, 6400, 6400, 7340032, 2621440, 32768, 8, 63803392, 114688, 0, 0, 218104176, 1
    .long 1, 80, 80, 2048, 1835520, 1835776, 7340032, 61894656, 114688, 7, 174071808, 32768, 218104080, 7, 218106624, 1
    .long 0, 0, 0, 0, 0, 0, 0, 0, 0, 0, 0, 0, 0, 0, 0, 0
    .long 0, 0, 0, 0, 0, 0, 0, 0, 0, 0, 0, 0, 0, 0, 0, 0
    .long 6, 32, 32, 8192, 4352, 266496, 8388608, 0, 32768, 4, 37818368, 131072, 0, 0, 218104384, 1
    .long 4, 32, 32, 8192, 4352, 266496, 8388608, 262144, 32768, 4, 38866944, 131072, 0, 0, 218104512, 1
    .long 4, 16, 16, 8192, 5888, 268032, 8388608, 524288, 32768, 4, 6385664, 131072, 0, 0, 218104656, 1
    .long 1, 24, 24, 8192, 4608, 4864, 8388608, 1572864, 32768, 8, 27336704, 131072, 0, 0, 218105152, 4
    .long 2, 64, 72, 7168, 1536, 1536, 7340032, 0, 32768, 8, 54550528, 114688, 0, 0, 218103808, 1
    .long 2, 64, 72, 7168, 512, 512, 7340032, 1572864, 32768, 8, 60039168, 114688, 0, 0, 218104000, 1
    .long 2, 64, 72, 7168, 6656, 6656, 7340032, 2621440, 32768, 8, 63807488, 114688, 0, 0, 218104176, 1
    .long 1, 80, 80, 2048, 3670528, 3670784, 7340032, 61923328, 114688, 7, 178266112, 32768, 218104096, 7, 218106624, 1
    .long 0, 0, 0, 0, 0, 0, 0, 0, 0, 0, 0, 0, 0, 0, 0, 0
    .long 0, 0, 0, 0, 0, 0, 0, 0, 0, 0, 0, 0, 0, 0, 0, 0
    .long 6, 32, 32, 8192, 6400, 268544, 8388608, 0, 32768, 4, 37851136, 131072, 0, 0, 218104416, 1
    .long 4, 32, 32, 8192, 6400, 268544, 8388608, 262144, 32768, 4, 38899712, 131072, 0, 0, 218104544, 1
    .long 4, 16, 16, 8192, 7936, 270080, 8388608, 524288, 32768, 4, 6418432, 131072, 0, 0, 218104688, 1
    .long 1, 24, 24, 8192, 6656, 6912, 8388608, 1572864, 32768, 8, 27369472, 131072, 0, 0, 218105184, 4
    .long 2, 64, 72, 7168, 1792, 1792, 7340032, 0, 32768, 8, 54554624, 114688, 0, 0, 218103824, 1
    .long 2, 64, 72, 7168, 768, 768, 7340032, 1572864, 32768, 8, 60043264, 114688, 0, 0, 218104000, 1
    .long 2, 64, 72, 7168, 6912, 6912, 7340032, 2621440, 32768, 8, 63811584, 114688, 0, 0, 218104176, 1
    .long 1, 80, 80, 2048, 5505536, 5505792, 7340032, 61952000, 114688, 7, 182460416, 32768, 218104112, 7, 218106624, 1
    .long 0, 0, 0, 0, 0, 0, 0, 0, 0, 0, 0, 0, 0, 0, 0, 0
    .long 0, 0, 0, 0, 0, 0, 0, 0, 0, 0, 0, 0, 0, 0, 0, 0
    .long 6, 32, 32, 8192, 512, 262656, 8388608, 0, 32768, 4, 37756928, 131072, 0, 0, 218104320, 1
    .long 4, 32, 32, 8192, 512, 262656, 8388608, 262144, 32768, 4, 38805504, 131072, 0, 0, 218104448, 1
    .long 4, 16, 16, 8192, 1536, 263680, 8388608, 786432, 32768, 4, 7364608, 131072, 0, 0, 218104592, 1
    .long 1, 24, 24, 8192, 1024, 1280, 8388608, 1572864, 32768, 8, 27279360, 131072, 0, 0, 218105104, 4
    .long 2, 64, 72, 7168, 2048, 2048, 7340032, 0, 32768, 8, 54558720, 114688, 0, 0, 218103824, 1
    .long 2, 64, 72, 7168, 1024, 1024, 7340032, 1572864, 32768, 8, 60047360, 114688, 0, 0, 218104000, 1
    .long 2, 64, 72, 7168, 0, 0, 7340032, 3145728, 32768, 8, 65536000, 114688, 0, 0, 218104192, 1
    .long 1, 80, 80, 2048, 1024, 1280, 7340032, 61865984, 114688, 7, 169885696, 32768, 218104064, 7, 218106624, 1
    .long 0, 0, 0, 0, 0, 0, 0, 0, 0, 0, 0, 0, 0, 0, 0, 0
    .long 0, 0, 0, 0, 0, 0, 0, 0, 0, 0, 0, 0, 0, 0, 0, 0
    .long 6, 32, 32, 8192, 2560, 264704, 8388608, 0, 32768, 4, 37789696, 131072, 0, 0, 218104352, 1
    .long 4, 32, 32, 8192, 2560, 264704, 8388608, 262144, 32768, 4, 38838272, 131072, 0, 0, 218104480, 1
    .long 4, 16, 16, 8192, 3584, 265728, 8388608, 786432, 32768, 4, 7397376, 131072, 0, 0, 218104624, 1
    .long 1, 24, 24, 8192, 3072, 3328, 8388608, 1572864, 32768, 8, 27312128, 131072, 0, 0, 218105136, 4
    .long 2, 64, 72, 7168, 2304, 2304, 7340032, 0, 32768, 8, 54562816, 114688, 0, 0, 218103824, 1
    .long 2, 64, 72, 7168, 1280, 1280, 7340032, 1572864, 32768, 8, 60051456, 114688, 0, 0, 218104000, 1
    .long 2, 64, 72, 7168, 256, 256, 7340032, 3145728, 32768, 8, 65540096, 114688, 0, 0, 218104192, 1
    .long 1, 80, 80, 2048, 1836032, 1836288, 7340032, 61894656, 114688, 7, 174080000, 32768, 218104080, 7, 218106624, 1
    .long 0, 0, 0, 0, 0, 0, 0, 0, 0, 0, 0, 0, 0, 0, 0, 0
    .long 0, 0, 0, 0, 0, 0, 0, 0, 0, 0, 0, 0, 0, 0, 0, 0
    .long 6, 32, 32, 8192, 4608, 266752, 8388608, 0, 32768, 4, 37822464, 131072, 0, 0, 218104384, 1
    .long 4, 32, 32, 8192, 4608, 266752, 8388608, 262144, 32768, 4, 38871040, 131072, 0, 0, 218104512, 1
    .long 4, 16, 16, 8192, 5632, 267776, 8388608, 786432, 32768, 4, 7430144, 131072, 0, 0, 218104656, 1
    .long 1, 24, 24, 8192, 5120, 5376, 8388608, 1572864, 32768, 8, 27344896, 131072, 0, 0, 218105168, 4
    .long 2, 64, 72, 7168, 2560, 2560, 7340032, 0, 32768, 8, 54566912, 114688, 0, 0, 218103824, 1
    .long 2, 64, 72, 7168, 1536, 1536, 7340032, 1572864, 32768, 8, 60055552, 114688, 0, 0, 218104000, 1
    .long 2, 64, 72, 7168, 512, 512, 7340032, 3145728, 32768, 8, 65544192, 114688, 0, 0, 218104192, 1
    .long 1, 80, 80, 2048, 3671040, 3671296, 7340032, 61923328, 114688, 7, 178274304, 32768, 218104096, 7, 218106624, 1
    .long 0, 0, 0, 0, 0, 0, 0, 0, 0, 0, 0, 0, 0, 0, 0, 0
    .long 0, 0, 0, 0, 0, 0, 0, 0, 0, 0, 0, 0, 0, 0, 0, 0
    .long 6, 32, 32, 8192, 6656, 268800, 8388608, 0, 32768, 4, 37855232, 131072, 0, 0, 218104416, 1
    .long 4, 32, 32, 8192, 6656, 268800, 8388608, 262144, 32768, 4, 38903808, 131072, 0, 0, 218104544, 1
    .long 4, 16, 16, 8192, 7680, 269824, 8388608, 786432, 32768, 4, 7462912, 131072, 0, 0, 218104688, 1
    .long 1, 24, 24, 8192, 7168, 7424, 8388608, 1572864, 32768, 8, 27377664, 131072, 0, 0, 218105200, 4
    .long 2, 64, 72, 7168, 2816, 2816, 7340032, 0, 32768, 8, 54571008, 114688, 0, 0, 218103824, 1
    .long 2, 64, 72, 7168, 1792, 1792, 7340032, 1572864, 32768, 8, 60059648, 114688, 0, 0, 218104016, 1
    .long 2, 64, 72, 7168, 768, 768, 7340032, 3145728, 32768, 8, 65548288, 114688, 0, 0, 218104192, 1
    .long 1, 80, 80, 2048, 5506048, 5506304, 7340032, 61952000, 114688, 7, 182468608, 32768, 218104112, 7, 218106624, 1
    .long 0, 0, 0, 0, 0, 0, 0, 0, 0, 0, 0, 0, 0, 0, 0, 0
    .long 0, 0, 0, 0, 0, 0, 0, 0, 0, 0, 0, 0, 0, 0, 0, 0
    .long 6, 32, 32, 8192, 768, 262912, 8388608, 0, 32768, 4, 37761024, 131072, 0, 0, 218104320, 1
    .long 4, 32, 32, 8192, 768, 262912, 8388608, 262144, 32768, 4, 38809600, 131072, 0, 0, 218104448, 1
    .long 4, 16, 16, 8192, 1536, 263680, 8388608, 524288, 32768, 4, 6316032, 131072, 0, 0, 218104592, 1
    .long 1, 24, 24, 8192, 1536, 1792, 8388608, 1572864, 32768, 8, 27287552, 131072, 0, 0, 218105104, 4
    .long 2, 64, 72, 7168, 3072, 3072, 7340032, 0, 32768, 8, 54575104, 114688, 0, 0, 218103824, 1
    .long 2, 64, 72, 7168, 2048, 2048, 7340032, 1572864, 32768, 8, 60063744, 114688, 0, 0, 218104016, 1
    .long 2, 64, 72, 7168, 1024, 1024, 7340032, 3145728, 32768, 8, 65552384, 114688, 0, 0, 218104192, 1
    .long 1, 80, 80, 2048, 1536, 1792, 7340032, 61865984, 114688, 7, 169893888, 32768, 218104064, 7, 218106624, 1
    .long 0, 0, 0, 0, 0, 0, 0, 0, 0, 0, 0, 0, 0, 0, 0, 0
    .long 0, 0, 0, 0, 0, 0, 0, 0, 0, 0, 0, 0, 0, 0, 0, 0
    .long 6, 32, 32, 8192, 2816, 264960, 8388608, 0, 32768, 4, 37793792, 131072, 0, 0, 218104352, 1
    .long 4, 32, 32, 8192, 2816, 264960, 8388608, 262144, 32768, 4, 38842368, 131072, 0, 0, 218104480, 1
    .long 4, 16, 16, 8192, 3584, 265728, 8388608, 524288, 32768, 4, 6348800, 131072, 0, 0, 218104624, 1
    .long 1, 24, 24, 8192, 3584, 3840, 8388608, 1572864, 32768, 8, 27320320, 131072, 0, 0, 218105136, 4
    .long 2, 64, 72, 7168, 3328, 3328, 7340032, 0, 32768, 8, 54579200, 114688, 0, 0, 218103824, 1
    .long 2, 64, 72, 7168, 2304, 2304, 7340032, 1572864, 32768, 8, 60067840, 114688, 0, 0, 218104016, 1
    .long 2, 64, 72, 7168, 1280, 1280, 7340032, 3145728, 32768, 8, 65556480, 114688, 0, 0, 218104192, 1
    .long 1, 80, 80, 2048, 1836544, 1836800, 7340032, 61894656, 114688, 7, 174088192, 32768, 218104080, 7, 218106624, 1
    .long 0, 0, 0, 0, 0, 0, 0, 0, 0, 0, 0, 0, 0, 0, 0, 0
    .long 0, 0, 0, 0, 0, 0, 0, 0, 0, 0, 0, 0, 0, 0, 0, 0
    .long 6, 32, 32, 8192, 4864, 267008, 8388608, 0, 32768, 4, 37826560, 131072, 0, 0, 218104384, 1
    .long 4, 32, 32, 8192, 4864, 267008, 8388608, 262144, 32768, 4, 38875136, 131072, 0, 0, 218104512, 1
    .long 4, 16, 16, 8192, 5632, 267776, 8388608, 524288, 32768, 4, 6381568, 131072, 0, 0, 218104656, 1
    .long 1, 24, 24, 8192, 5632, 5888, 8388608, 1572864, 32768, 8, 27353088, 131072, 0, 0, 218105168, 4
    .long 2, 64, 72, 7168, 3584, 3584, 7340032, 0, 32768, 8, 54583296, 114688, 0, 0, 218103840, 1
    .long 2, 64, 72, 7168, 2560, 2560, 7340032, 1572864, 32768, 8, 60071936, 114688, 0, 0, 218104016, 1
    .long 2, 64, 72, 7168, 1536, 1536, 7340032, 3145728, 32768, 8, 65560576, 114688, 0, 0, 218104192, 1
    .long 1, 80, 80, 2048, 3671552, 3671808, 7340032, 61923328, 114688, 7, 178282496, 32768, 218104096, 7, 218106624, 1
    .long 0, 0, 0, 0, 0, 0, 0, 0, 0, 0, 0, 0, 0, 0, 0, 0
    .long 0, 0, 0, 0, 0, 0, 0, 0, 0, 0, 0, 0, 0, 0, 0, 0
    .long 6, 32, 32, 8192, 6912, 269056, 8388608, 0, 32768, 4, 37859328, 131072, 0, 0, 218104416, 1
    .long 4, 32, 32, 8192, 6912, 269056, 8388608, 262144, 32768, 4, 38907904, 131072, 0, 0, 218104544, 1
    .long 4, 16, 16, 8192, 7680, 269824, 8388608, 524288, 32768, 4, 6414336, 131072, 0, 0, 218104688, 1
    .long 1, 24, 24, 8192, 7680, 7936, 8388608, 1572864, 32768, 8, 27385856, 131072, 0, 0, 218105200, 4
    .long 2, 64, 72, 7168, 3840, 3840, 7340032, 0, 32768, 8, 54587392, 114688, 0, 0, 218103840, 1
    .long 2, 64, 72, 7168, 2816, 2816, 7340032, 1572864, 32768, 8, 60076032, 114688, 0, 0, 218104016, 1
    .long 2, 64, 72, 7168, 1792, 1792, 7340032, 3145728, 32768, 8, 65564672, 114688, 0, 0, 218104208, 1
    .long 1, 80, 80, 2048, 5506560, 5506816, 7340032, 61952000, 114688, 7, 182476800, 32768, 218104112, 7, 218106624, 1
    .long 0, 0, 0, 0, 0, 0, 0, 0, 0, 0, 0, 0, 0, 0, 0, 0
    .long 0, 0, 0, 0, 0, 0, 0, 0, 0, 0, 0, 0, 0, 0, 0, 0
    .long 6, 32, 32, 8192, 1024, 263168, 8388608, 0, 32768, 4, 37765120, 131072, 0, 0, 218104336, 1
    .long 4, 32, 32, 8192, 1024, 263168, 8388608, 262144, 32768, 4, 38813696, 131072, 0, 0, 218104464, 1
    .long 4, 16, 16, 8192, 1280, 263424, 8388608, 786432, 32768, 4, 7360512, 131072, 0, 0, 218104592, 1
    .long 1, 16, 16, 8192, 0, 256, 8388608, 1572864, 32768, 8, 10485760, 131072, 0, 0, 218105088, 4
    .long 2, 64, 72, 7168, 4096, 4096, 7340032, 0, 32768, 8, 54591488, 114688, 0, 0, 218103840, 1
    .long 2, 64, 72, 7168, 3072, 3072, 7340032, 1572864, 32768, 8, 60080128, 114688, 0, 0, 218104016, 1
    .long 2, 64, 72, 7168, 2048, 2048, 7340032, 3145728, 32768, 8, 65568768, 114688, 0, 0, 218104208, 1
    .long 1, 80, 80, 2048, 0, 256, 7340032, 63700992, 114688, 7, 170393600, 32768, 218104128, 7, 218106688, 1
    .long 0, 0, 0, 0, 0, 0, 0, 0, 0, 0, 0, 0, 0, 0, 0, 0
    .long 0, 0, 0, 0, 0, 0, 0, 0, 0, 0, 0, 0, 0, 0, 0, 0
    .long 6, 32, 32, 8192, 3072, 265216, 8388608, 0, 32768, 4, 37797888, 131072, 0, 0, 218104368, 1
    .long 4, 32, 32, 8192, 3072, 265216, 8388608, 262144, 32768, 4, 38846464, 131072, 0, 0, 218104496, 1
    .long 4, 16, 16, 8192, 3328, 265472, 8388608, 786432, 32768, 4, 7393280, 131072, 0, 0, 218104624, 1
    .long 1, 16, 16, 8192, 2048, 2304, 8388608, 1572864, 32768, 8, 10518528, 131072, 0, 0, 218105120, 4
    .long 2, 64, 72, 7168, 4352, 4352, 7340032, 0, 32768, 8, 54595584, 114688, 0, 0, 218103840, 1
    .long 2, 64, 72, 7168, 3328, 3328, 7340032, 1572864, 32768, 8, 60084224, 114688, 0, 0, 218104016, 1
    .long 2, 64, 72, 7168, 2304, 2304, 7340032, 3145728, 32768, 8, 65572864, 114688, 0, 0, 218104208, 1
    .long 1, 80, 80, 2048, 1835008, 1835264, 7340032, 63729664, 114688, 7, 174587904, 32768, 218104144, 7, 218106688, 1
    .long 0, 0, 0, 0, 0, 0, 0, 0, 0, 0, 0, 0, 0, 0, 0, 0
    .long 0, 0, 0, 0, 0, 0, 0, 0, 0, 0, 0, 0, 0, 0, 0, 0
    .long 6, 32, 32, 8192, 5120, 267264, 8388608, 0, 32768, 4, 37830656, 131072, 0, 0, 218104400, 1
    .long 4, 32, 32, 8192, 5120, 267264, 8388608, 262144, 32768, 4, 38879232, 131072, 0, 0, 218104528, 1
    .long 4, 16, 16, 8192, 5376, 267520, 8388608, 786432, 32768, 4, 7426048, 131072, 0, 0, 218104656, 1
    .long 1, 16, 16, 8192, 4096, 4352, 8388608, 1572864, 32768, 8, 10551296, 131072, 0, 0, 218105152, 4
    .long 2, 64, 72, 7168, 4608, 4608, 7340032, 0, 32768, 8, 54599680, 114688, 0, 0, 218103840, 1
    .long 2, 64, 72, 7168, 3584, 3584, 7340032, 1572864, 32768, 8, 60088320, 114688, 0, 0, 218104032, 1
    .long 2, 64, 72, 7168, 2560, 2560, 7340032, 3145728, 32768, 8, 65576960, 114688, 0, 0, 218104208, 1
    .long 1, 80, 80, 2048, 3670016, 3670272, 7340032, 63758336, 114688, 7, 178782208, 32768, 218104160, 7, 218106688, 1
    .long 0, 0, 0, 0, 0, 0, 0, 0, 0, 0, 0, 0, 0, 0, 0, 0
    .long 0, 0, 0, 0, 0, 0, 0, 0, 0, 0, 0, 0, 0, 0, 0, 0
    .long 6, 32, 32, 8192, 7168, 269312, 8388608, 0, 32768, 4, 37863424, 131072, 0, 0, 218104432, 1
    .long 4, 32, 32, 8192, 7168, 269312, 8388608, 262144, 32768, 4, 38912000, 131072, 0, 0, 218104560, 1
    .long 4, 16, 16, 8192, 7424, 269568, 8388608, 786432, 32768, 4, 7458816, 131072, 0, 0, 218104688, 1
    .long 1, 16, 16, 8192, 6144, 6400, 8388608, 1572864, 32768, 8, 10584064, 131072, 0, 0, 218105184, 4
    .long 2, 64, 72, 7168, 4864, 4864, 7340032, 0, 32768, 8, 54603776, 114688, 0, 0, 218103840, 1
    .long 2, 64, 72, 7168, 3840, 3840, 7340032, 1572864, 32768, 8, 60092416, 114688, 0, 0, 218104032, 1
    .long 2, 64, 72, 7168, 2816, 2816, 7340032, 3145728, 32768, 8, 65581056, 114688, 0, 0, 218104208, 1
    .long 1, 80, 80, 2048, 5505024, 5505280, 7340032, 63787008, 114688, 7, 182976512, 32768, 218104176, 7, 218106688, 1
    .long 0, 0, 0, 0, 0, 0, 0, 0, 0, 0, 0, 0, 0, 0, 0, 0
    .long 0, 0, 0, 0, 0, 0, 0, 0, 0, 0, 0, 0, 0, 0, 0, 0
    .long 6, 32, 32, 8192, 1280, 263424, 8388608, 0, 32768, 4, 37769216, 131072, 0, 0, 218104336, 1
    .long 4, 32, 32, 8192, 1280, 263424, 8388608, 262144, 32768, 4, 38817792, 131072, 0, 0, 218104464, 1
    .long 4, 16, 16, 8192, 1280, 263424, 8388608, 524288, 32768, 4, 6311936, 131072, 0, 0, 218104592, 1
    .long 1, 16, 16, 8192, 512, 768, 8388608, 1572864, 32768, 8, 10493952, 131072, 0, 0, 218105088, 4
    .long 2, 64, 72, 7168, 5120, 5120, 7340032, 0, 32768, 8, 54607872, 114688, 0, 0, 218103840, 1
    .long 2, 64, 72, 7168, 4096, 4096, 7340032, 1572864, 32768, 8, 60096512, 114688, 0, 0, 218104032, 1
    .long 2, 64, 72, 7168, 3072, 3072, 7340032, 3145728, 32768, 8, 65585152, 114688, 0, 0, 218104208, 1
    .long 1, 80, 80, 2048, 512, 768, 7340032, 63700992, 114688, 7, 170401792, 32768, 218104128, 7, 218106688, 1
    .long 0, 0, 0, 0, 0, 0, 0, 0, 0, 0, 0, 0, 0, 0, 0, 0
    .long 0, 0, 0, 0, 0, 0, 0, 0, 0, 0, 0, 0, 0, 0, 0, 0
    .long 6, 32, 32, 8192, 3328, 265472, 8388608, 0, 32768, 4, 37801984, 131072, 0, 0, 218104368, 1
    .long 4, 32, 32, 8192, 3328, 265472, 8388608, 262144, 32768, 4, 38850560, 131072, 0, 0, 218104496, 1
    .long 4, 16, 16, 8192, 3328, 265472, 8388608, 524288, 32768, 4, 6344704, 131072, 0, 0, 218104624, 1
    .long 1, 16, 16, 8192, 2560, 2816, 8388608, 1572864, 32768, 8, 10526720, 131072, 0, 0, 218105120, 4
    .long 2, 64, 72, 7168, 5376, 5376, 7340032, 0, 32768, 8, 54611968, 114688, 0, 0, 218103856, 1
    .long 2, 64, 72, 7168, 4352, 4352, 7340032, 1572864, 32768, 8, 60100608, 114688, 0, 0, 218104032, 1
    .long 2, 64, 72, 7168, 3328, 3328, 7340032, 3145728, 32768, 8, 65589248, 114688, 0, 0, 218104208, 1
    .long 1, 80, 80, 2048, 1835520, 1835776, 7340032, 63729664, 114688, 7, 174596096, 32768, 218104144, 7, 218106688, 1
    .long 0, 0, 0, 0, 0, 0, 0, 0, 0, 0, 0, 0, 0, 0, 0, 0
    .long 0, 0, 0, 0, 0, 0, 0, 0, 0, 0, 0, 0, 0, 0, 0, 0
    .long 6, 32, 32, 8192, 5376, 267520, 8388608, 0, 32768, 4, 37834752, 131072, 0, 0, 218104400, 1
    .long 4, 32, 32, 8192, 5376, 267520, 8388608, 262144, 32768, 4, 38883328, 131072, 0, 0, 218104528, 1
    .long 4, 16, 16, 8192, 5376, 267520, 8388608, 524288, 32768, 4, 6377472, 131072, 0, 0, 218104656, 1
    .long 1, 16, 16, 8192, 4608, 4864, 8388608, 1572864, 32768, 8, 10559488, 131072, 0, 0, 218105152, 4
    .long 2, 64, 72, 7168, 5632, 5632, 7340032, 0, 32768, 8, 54616064, 114688, 0, 0, 218103856, 1
    .long 2, 64, 72, 7168, 4608, 4608, 7340032, 1572864, 32768, 8, 60104704, 114688, 0, 0, 218104032, 1
    .long 2, 64, 72, 7168, 3584, 3584, 7340032, 3145728, 32768, 8, 65593344, 114688, 0, 0, 218104224, 1
    .long 1, 80, 80, 2048, 3670528, 3670784, 7340032, 63758336, 114688, 7, 178790400, 32768, 218104160, 7, 218106688, 1
    .long 0, 0, 0, 0, 0, 0, 0, 0, 0, 0, 0, 0, 0, 0, 0, 0
    .long 0, 0, 0, 0, 0, 0, 0, 0, 0, 0, 0, 0, 0, 0, 0, 0
    .long 6, 32, 32, 8192, 7424, 269568, 8388608, 0, 32768, 4, 37867520, 131072, 0, 0, 218104432, 1
    .long 4, 32, 32, 8192, 7424, 269568, 8388608, 262144, 32768, 4, 38916096, 131072, 0, 0, 218104560, 1
    .long 4, 16, 16, 8192, 7424, 269568, 8388608, 524288, 32768, 4, 6410240, 131072, 0, 0, 218104688, 1
    .long 1, 16, 16, 8192, 6656, 6912, 8388608, 1572864, 32768, 8, 10592256, 131072, 0, 0, 218105184, 4
    .long 2, 64, 72, 7168, 5888, 5888, 7340032, 0, 32768, 8, 54620160, 114688, 0, 0, 218103856, 1
    .long 2, 64, 72, 7168, 4864, 4864, 7340032, 1572864, 32768, 8, 60108800, 114688, 0, 0, 218104032, 1
    .long 2, 64, 72, 7168, 3840, 3840, 7340032, 3145728, 32768, 8, 65597440, 114688, 0, 0, 218104224, 1
    .long 1, 80, 80, 2048, 5505536, 5505792, 7340032, 63787008, 114688, 7, 182984704, 32768, 218104176, 7, 218106688, 1
    .long 0, 0, 0, 0, 0, 0, 0, 0, 0, 0, 0, 0, 0, 0, 0, 0
    .long 0, 0, 0, 0, 0, 0, 0, 0, 0, 0, 0, 0, 0, 0, 0, 0
    .long 6, 32, 32, 8192, 1536, 263680, 8388608, 0, 32768, 4, 37773312, 131072, 0, 0, 218104336, 1
    .long 4, 32, 32, 8192, 1536, 263680, 8388608, 262144, 32768, 4, 38821888, 131072, 0, 0, 218104464, 1
    .long 4, 16, 16, 8192, 1024, 263168, 8388608, 786432, 32768, 4, 7356416, 131072, 0, 0, 218104592, 1
    .long 1, 16, 16, 8192, 1024, 1280, 8388608, 1572864, 32768, 8, 10502144, 131072, 0, 0, 218105104, 4
    .long 2, 64, 72, 7168, 6144, 6144, 7340032, 0, 32768, 8, 54624256, 114688, 0, 0, 218103856, 1
    .long 2, 64, 72, 7168, 5120, 5120, 7340032, 1572864, 32768, 8, 60112896, 114688, 0, 0, 218104032, 1
    .long 2, 64, 72, 7168, 4096, 4096, 7340032, 3145728, 32768, 8, 65601536, 114688, 0, 0, 218104224, 1
    .long 1, 80, 80, 2048, 1024, 1280, 7340032, 63700992, 114688, 7, 170409984, 32768, 218104128, 7, 218106688, 1
    .long 0, 0, 0, 0, 0, 0, 0, 0, 0, 0, 0, 0, 0, 0, 0, 0
    .long 0, 0, 0, 0, 0, 0, 0, 0, 0, 0, 0, 0, 0, 0, 0, 0
    .long 6, 32, 32, 8192, 3584, 265728, 8388608, 0, 32768, 4, 37806080, 131072, 0, 0, 218104368, 1
    .long 4, 32, 32, 8192, 3584, 265728, 8388608, 262144, 32768, 4, 38854656, 131072, 0, 0, 218104496, 1
    .long 4, 16, 16, 8192, 3072, 265216, 8388608, 786432, 32768, 4, 7389184, 131072, 0, 0, 218104624, 1
    .long 1, 16, 16, 8192, 3072, 3328, 8388608, 1572864, 32768, 8, 10534912, 131072, 0, 0, 218105136, 4
    .long 2, 64, 72, 7168, 6400, 6400, 7340032, 0, 32768, 8, 54628352, 114688, 0, 0, 218103856, 1
    .long 2, 64, 72, 7168, 5376, 5376, 7340032, 1572864, 32768, 8, 60116992, 114688, 0, 0, 218104048, 1
    .long 2, 64, 72, 7168, 4352, 4352, 7340032, 3145728, 32768, 8, 65605632, 114688, 0, 0, 218104224, 1
    .long 1, 80, 80, 2048, 1836032, 1836288, 7340032, 63729664, 114688, 7, 174604288, 32768, 218104144, 7, 218106688, 1
    .long 0, 0, 0, 0, 0, 0, 0, 0, 0, 0, 0, 0, 0, 0, 0, 0
    .long 0, 0, 0, 0, 0, 0, 0, 0, 0, 0, 0, 0, 0, 0, 0, 0
    .long 6, 32, 32, 8192, 5632, 267776, 8388608, 0, 32768, 4, 37838848, 131072, 0, 0, 218104400, 1
    .long 4, 32, 32, 8192, 5632, 267776, 8388608, 262144, 32768, 4, 38887424, 131072, 0, 0, 218104528, 1
    .long 4, 16, 16, 8192, 5120, 267264, 8388608, 786432, 32768, 4, 7421952, 131072, 0, 0, 218104656, 1
    .long 1, 16, 16, 8192, 5120, 5376, 8388608, 1572864, 32768, 8, 10567680, 131072, 0, 0, 218105168, 4
    .long 2, 64, 72, 7168, 6656, 6656, 7340032, 0, 32768, 8, 54632448, 114688, 0, 0, 218103856, 1
    .long 2, 64, 72, 7168, 5632, 5632, 7340032, 1572864, 32768, 8, 60121088, 114688, 0, 0, 218104048, 1
    .long 2, 64, 72, 7168, 4608, 4608, 7340032, 3145728, 32768, 8, 65609728, 114688, 0, 0, 218104224, 1
    .long 1, 80, 80, 2048, 3671040, 3671296, 7340032, 63758336, 114688, 7, 178798592, 32768, 218104160, 7, 218106688, 1
    .long 0, 0, 0, 0, 0, 0, 0, 0, 0, 0, 0, 0, 0, 0, 0, 0
    .long 0, 0, 0, 0, 0, 0, 0, 0, 0, 0, 0, 0, 0, 0, 0, 0
    .long 6, 32, 32, 8192, 7680, 269824, 8388608, 0, 32768, 4, 37871616, 131072, 0, 0, 218104432, 1
    .long 4, 32, 32, 8192, 7680, 269824, 8388608, 262144, 32768, 4, 38920192, 131072, 0, 0, 218104560, 1
    .long 4, 16, 16, 8192, 7168, 269312, 8388608, 786432, 32768, 4, 7454720, 131072, 0, 0, 218104688, 1
    .long 1, 16, 16, 8192, 7168, 7424, 8388608, 1572864, 32768, 8, 10600448, 131072, 0, 0, 218105200, 4
    .long 2, 64, 72, 7168, 6912, 6912, 7340032, 0, 32768, 8, 54636544, 114688, 0, 0, 218103856, 1
    .long 2, 64, 72, 7168, 5888, 5888, 7340032, 1572864, 32768, 8, 60125184, 114688, 0, 0, 218104048, 1
    .long 2, 64, 72, 7168, 4864, 4864, 7340032, 3145728, 32768, 8, 65613824, 114688, 0, 0, 218104224, 1
    .long 1, 80, 80, 2048, 5506048, 5506304, 7340032, 63787008, 114688, 7, 182992896, 32768, 218104176, 7, 218106688, 1
    .long 0, 0, 0, 0, 0, 0, 0, 0, 0, 0, 0, 0, 0, 0, 0, 0
    .long 0, 0, 0, 0, 0, 0, 0, 0, 0, 0, 0, 0, 0, 0, 0, 0
    .long 6, 32, 32, 8192, 1792, 263936, 8388608, 0, 32768, 4, 37777408, 131072, 0, 0, 218104336, 1
    .long 4, 32, 32, 8192, 1792, 263936, 8388608, 262144, 32768, 4, 38825984, 131072, 0, 0, 218104464, 1
    .long 4, 16, 16, 8192, 1024, 263168, 8388608, 524288, 32768, 4, 6307840, 131072, 0, 0, 218104592, 1
    .long 1, 16, 16, 8192, 1536, 1792, 8388608, 1572864, 32768, 8, 10510336, 131072, 0, 0, 218105104, 4
    .long 2, 64, 72, 7168, 0, 0, 7340032, 524288, 32768, 8, 56360960, 114688, 0, 0, 218103872, 1
    .long 2, 64, 72, 7168, 6144, 6144, 7340032, 1572864, 32768, 8, 60129280, 114688, 0, 0, 218104048, 1
    .long 2, 64, 72, 7168, 5120, 5120, 7340032, 3145728, 32768, 8, 65617920, 114688, 0, 0, 218104224, 1
    .long 1, 80, 80, 2048, 1536, 1792, 7340032, 63700992, 114688, 7, 170418176, 32768, 218104128, 7, 218106688, 1
    .long 0, 0, 0, 0, 0, 0, 0, 0, 0, 0, 0, 0, 0, 0, 0, 0
    .long 0, 0, 0, 0, 0, 0, 0, 0, 0, 0, 0, 0, 0, 0, 0, 0
    .long 6, 32, 32, 8192, 3840, 265984, 8388608, 0, 32768, 4, 37810176, 131072, 0, 0, 218104368, 1
    .long 4, 32, 32, 8192, 3840, 265984, 8388608, 262144, 32768, 4, 38858752, 131072, 0, 0, 218104496, 1
    .long 4, 16, 16, 8192, 3072, 265216, 8388608, 524288, 32768, 4, 6340608, 131072, 0, 0, 218104624, 1
    .long 1, 16, 16, 8192, 3584, 3840, 8388608, 1572864, 32768, 8, 10543104, 131072, 0, 0, 218105136, 4
    .long 2, 64, 72, 7168, 256, 256, 7340032, 524288, 32768, 8, 56365056, 114688, 0, 0, 218103872, 1
    .long 2, 64, 72, 7168, 6400, 6400, 7340032, 1572864, 32768, 8, 60133376, 114688, 0, 0, 218104048, 1
    .long 2, 64, 72, 7168, 5376, 5376, 7340032, 3145728, 32768, 8, 65622016, 114688, 0, 0, 218104240, 1
    .long 1, 80, 80, 2048, 1836544, 1836800, 7340032, 63729664, 114688, 7, 174612480, 32768, 218104144, 7, 218106688, 1
    .long 0, 0, 0, 0, 0, 0, 0, 0, 0, 0, 0, 0, 0, 0, 0, 0
    .long 0, 0, 0, 0, 0, 0, 0, 0, 0, 0, 0, 0, 0, 0, 0, 0
    .long 6, 32, 32, 8192, 5888, 268032, 8388608, 0, 32768, 4, 37842944, 131072, 0, 0, 218104400, 1
    .long 4, 32, 32, 8192, 5888, 268032, 8388608, 262144, 32768, 4, 38891520, 131072, 0, 0, 218104528, 1
    .long 4, 16, 16, 8192, 5120, 267264, 8388608, 524288, 32768, 4, 6373376, 131072, 0, 0, 218104656, 1
    .long 1, 16, 16, 8192, 5632, 5888, 8388608, 1572864, 32768, 8, 10575872, 131072, 0, 0, 218105168, 4
    .long 2, 64, 72, 7168, 512, 512, 7340032, 524288, 32768, 8, 56369152, 114688, 0, 0, 218103872, 1
    .long 2, 64, 72, 7168, 6656, 6656, 7340032, 1572864, 32768, 8, 60137472, 114688, 0, 0, 218104048, 1
    .long 2, 64, 72, 7168, 5632, 5632, 7340032, 3145728, 32768, 8, 65626112, 114688, 0, 0, 218104240, 1
    .long 1, 80, 80, 2048, 3671552, 3671808, 7340032, 63758336, 114688, 7, 178806784, 32768, 218104160, 7, 218106688, 1
    .long 0, 0, 0, 0, 0, 0, 0, 0, 0, 0, 0, 0, 0, 0, 0, 0
    .long 0, 0, 0, 0, 0, 0, 0, 0, 0, 0, 0, 0, 0, 0, 0, 0
    .long 6, 32, 32, 8192, 7936, 270080, 8388608, 0, 32768, 4, 37875712, 131072, 0, 0, 218104432, 1
    .long 4, 32, 32, 8192, 7936, 270080, 8388608, 262144, 32768, 4, 38924288, 131072, 0, 0, 218104560, 1
    .long 4, 16, 16, 8192, 7168, 269312, 8388608, 524288, 32768, 4, 6406144, 131072, 0, 0, 218104688, 1
    .long 1, 16, 16, 8192, 7680, 7936, 8388608, 1572864, 32768, 8, 10608640, 131072, 0, 0, 218105200, 4
    .long 2, 64, 72, 7168, 768, 768, 7340032, 524288, 32768, 8, 56373248, 114688, 0, 0, 218103872, 1
    .long 2, 64, 72, 7168, 6912, 6912, 7340032, 1572864, 32768, 8, 60141568, 114688, 0, 0, 218104048, 1
    .long 2, 64, 72, 7168, 5888, 5888, 7340032, 3145728, 32768, 8, 65630208, 114688, 0, 0, 218104240, 1
    .long 1, 80, 80, 2048, 5506560, 5506816, 7340032, 63787008, 114688, 7, 183001088, 32768, 218104176, 7, 218106688, 1
    .long 0, 0, 0, 0, 0, 0, 0, 0, 0, 0, 0, 0, 0, 0, 0, 0
    .long 0, 0, 0, 0, 0, 0, 0, 0, 0, 0, 0, 0, 0, 0, 0, 0
    .long 6, 16, 16, 8192, 0, 262144, 8388608, 0, 32768, 4, 4194304, 131072, 0, 0, 218104320, 1
    .long 4, 16, 16, 8192, 0, 262144, 8388608, 262144, 32768, 4, 5242880, 131072, 0, 0, 218104448, 1
    .long 4, 16, 16, 8192, 0, 262144, 8388608, 524288, 32768, 4, 6291456, 131072, 0, 0, 218104576, 1
    .long 1, 32, 32, 8192, 0, 256, 8388608, 2097152, 32768, 8, 46137344, 131072, 0, 0, 218105344, 4
    .long 2, 64, 72, 7168, 1024, 1024, 7340032, 524288, 32768, 8, 56377344, 114688, 0, 0, 218103872, 1
    .long 2, 64, 72, 7168, 0, 0, 7340032, 2097152, 32768, 8, 61865984, 114688, 0, 0, 218104064, 1
    .long 2, 64, 72, 7168, 6144, 6144, 7340032, 3145728, 32768, 8, 65634304, 114688, 0, 0, 218104240, 1
    .long 1, 80, 80, 2048, 0, 256, 7340032, 65536000, 114688, 7, 170917888, 32768, 218104192, 7, 218106752, 1
    .long 0, 0, 0, 0, 0, 0, 0, 0, 0, 0, 0, 0, 0, 0, 0, 0
    .long 0, 0, 0, 0, 0, 0, 0, 0, 0, 0, 0, 0, 0, 0, 0, 0
    .long 6, 16, 16, 8192, 2048, 264192, 8388608, 0, 32768, 4, 4227072, 131072, 0, 0, 218104352, 1
    .long 4, 16, 16, 8192, 2048, 264192, 8388608, 262144, 32768, 4, 5275648, 131072, 0, 0, 218104480, 1
    .long 4, 16, 16, 8192, 2048, 264192, 8388608, 524288, 32768, 4, 6324224, 131072, 0, 0, 218104608, 1
    .long 1, 32, 32, 8192, 2048, 2304, 8388608, 2097152, 32768, 8, 46170112, 131072, 0, 0, 218105376, 4
    .long 2, 64, 72, 7168, 1280, 1280, 7340032, 524288, 32768, 8, 56381440, 114688, 0, 0, 218103872, 1
    .long 2, 64, 72, 7168, 256, 256, 7340032, 2097152, 32768, 8, 61870080, 114688, 0, 0, 218104064, 1
    .long 2, 64, 72, 7168, 6400, 6400, 7340032, 3145728, 32768, 8, 65638400, 114688, 0, 0, 218104240, 1
    .long 1, 80, 80, 2048, 1835008, 1835264, 7340032, 65564672, 114688, 7, 175112192, 32768, 218104208, 7, 218106752, 1
    .long 0, 0, 0, 0, 0, 0, 0, 0, 0, 0, 0, 0, 0, 0, 0, 0
    .long 0, 0, 0, 0, 0, 0, 0, 0, 0, 0, 0, 0, 0, 0, 0, 0
    .long 6, 16, 16, 8192, 4096, 266240, 8388608, 0, 32768, 4, 4259840, 131072, 0, 0, 218104384, 1
    .long 4, 16, 16, 8192, 4096, 266240, 8388608, 262144, 32768, 4, 5308416, 131072, 0, 0, 218104512, 1
    .long 4, 16, 16, 8192, 4096, 266240, 8388608, 524288, 32768, 4, 6356992, 131072, 0, 0, 218104640, 1
    .long 1, 32, 32, 8192, 4096, 4352, 8388608, 2097152, 32768, 8, 46202880, 131072, 0, 0, 218105408, 4
    .long 2, 64, 72, 7168, 1536, 1536, 7340032, 524288, 32768, 8, 56385536, 114688, 0, 0, 218103872, 1
    .long 2, 64, 72, 7168, 512, 512, 7340032, 2097152, 32768, 8, 61874176, 114688, 0, 0, 218104064, 1
    .long 2, 64, 72, 7168, 6656, 6656, 7340032, 3145728, 32768, 8, 65642496, 114688, 0, 0, 218104240, 1
    .long 1, 80, 80, 2048, 3670016, 3670272, 7340032, 65593344, 114688, 7, 179306496, 32768, 218104224, 7, 218106752, 1
    .long 0, 0, 0, 0, 0, 0, 0, 0, 0, 0, 0, 0, 0, 0, 0, 0
    .long 0, 0, 0, 0, 0, 0, 0, 0, 0, 0, 0, 0, 0, 0, 0, 0
    .long 6, 16, 16, 8192, 6144, 268288, 8388608, 0, 32768, 4, 4292608, 131072, 0, 0, 218104416, 1
    .long 4, 16, 16, 8192, 6144, 268288, 8388608, 262144, 32768, 4, 5341184, 131072, 0, 0, 218104544, 1
    .long 4, 16, 16, 8192, 6144, 268288, 8388608, 524288, 32768, 4, 6389760, 131072, 0, 0, 218104672, 1
    .long 1, 32, 32, 8192, 6144, 6400, 8388608, 2097152, 32768, 8, 46235648, 131072, 0, 0, 218105440, 4
    .long 2, 64, 72, 7168, 1792, 1792, 7340032, 524288, 32768, 8, 56389632, 114688, 0, 0, 218103888, 1
    .long 2, 64, 72, 7168, 768, 768, 7340032, 2097152, 32768, 8, 61878272, 114688, 0, 0, 218104064, 1
    .long 2, 64, 72, 7168, 6912, 6912, 7340032, 3145728, 32768, 8, 65646592, 114688, 0, 0, 218104240, 1
    .long 1, 80, 80, 2048, 5505024, 5505280, 7340032, 65622016, 114688, 7, 183500800, 32768, 218104240, 7, 218106752, 1
    .long 0, 0, 0, 0, 0, 0, 0, 0, 0, 0, 0, 0, 0, 0, 0, 0
    .long 0, 0, 0, 0, 0, 0, 0, 0, 0, 0, 0, 0, 0, 0, 0, 0
    .long 6, 16, 16, 8192, 256, 262400, 8388608, 0, 32768, 4, 4198400, 131072, 0, 0, 218104320, 1
    .long 4, 16, 16, 8192, 256, 262400, 8388608, 262144, 32768, 4, 5246976, 131072, 0, 0, 218104448, 1
    .long 4, 16, 16, 8192, 256, 262400, 8388608, 524288, 32768, 4, 6295552, 131072, 0, 0, 218104576, 1
    .long 1, 32, 32, 8192, 512, 768, 8388608, 2097152, 32768, 8, 46145536, 131072, 0, 0, 218105344, 4
    .long 2, 64, 72, 7168, 2048, 2048, 7340032, 524288, 32768, 8, 56393728, 114688, 0, 0, 218103888, 1
    .long 2, 64, 72, 7168, 1024, 1024, 7340032, 2097152, 32768, 8, 61882368, 114688, 0, 0, 218104064, 1
    .long 2, 64, 72, 7168, 0, 0, 7340032, 3670016, 32768, 8, 67371008, 114688, 0, 0, 218104256, 1
    .long 1, 80, 80, 2048, 512, 768, 7340032, 65536000, 114688, 7, 170926080, 32768, 218104192, 7, 218106752, 1
    .long 0, 0, 0, 0, 0, 0, 0, 0, 0, 0, 0, 0, 0, 0, 0, 0
    .long 0, 0, 0, 0, 0, 0, 0, 0, 0, 0, 0, 0, 0, 0, 0, 0
    .long 6, 16, 16, 8192, 2304, 264448, 8388608, 0, 32768, 4, 4231168, 131072, 0, 0, 218104352, 1
    .long 4, 16, 16, 8192, 2304, 264448, 8388608, 262144, 32768, 4, 5279744, 131072, 0, 0, 218104480, 1
    .long 4, 16, 16, 8192, 2304, 264448, 8388608, 524288, 32768, 4, 6328320, 131072, 0, 0, 218104608, 1
    .long 1, 32, 32, 8192, 2560, 2816, 8388608, 2097152, 32768, 8, 46178304, 131072, 0, 0, 218105376, 4
    .long 2, 64, 72, 7168, 2304, 2304, 7340032, 524288, 32768, 8, 56397824, 114688, 0, 0, 218103888, 1
    .long 2, 64, 72, 7168, 1280, 1280, 7340032, 2097152, 32768, 8, 61886464, 114688, 0, 0, 218104064, 1
    .long 2, 64, 72, 7168, 256, 256, 7340032, 3670016, 32768, 8, 67375104, 114688, 0, 0, 218104256, 1
    .long 1, 80, 80, 2048, 1835520, 1835776, 7340032, 65564672, 114688, 7, 175120384, 32768, 218104208, 7, 218106752, 1
    .long 0, 0, 0, 0, 0, 0, 0, 0, 0, 0, 0, 0, 0, 0, 0, 0
    .long 0, 0, 0, 0, 0, 0, 0, 0, 0, 0, 0, 0, 0, 0, 0, 0
    .long 6, 16, 16, 8192, 4352, 266496, 8388608, 0, 32768, 4, 4263936, 131072, 0, 0, 218104384, 1
    .long 4, 16, 16, 8192, 4352, 266496, 8388608, 262144, 32768, 4, 5312512, 131072, 0, 0, 218104512, 1
    .long 4, 16, 16, 8192, 4352, 266496, 8388608, 524288, 32768, 4, 6361088, 131072, 0, 0, 218104640, 1
    .long 1, 32, 32, 8192, 4608, 4864, 8388608, 2097152, 32768, 8, 46211072, 131072, 0, 0, 218105408, 4
    .long 2, 64, 72, 7168, 2560, 2560, 7340032, 524288, 32768, 8, 56401920, 114688, 0, 0, 218103888, 1
    .long 2, 64, 72, 7168, 1536, 1536, 7340032, 2097152, 32768, 8, 61890560, 114688, 0, 0, 218104064, 1
    .long 2, 64, 72, 7168, 512, 512, 7340032, 3670016, 32768, 8, 67379200, 114688, 0, 0, 218104256, 1
    .long 1, 80, 80, 2048, 3670528, 3670784, 7340032, 65593344, 114688, 7, 179314688, 32768, 218104224, 7, 218106752, 1
    .long 0, 0, 0, 0, 0, 0, 0, 0, 0, 0, 0, 0, 0, 0, 0, 0
    .long 0, 0, 0, 0, 0, 0, 0, 0, 0, 0, 0, 0, 0, 0, 0, 0
    .long 6, 16, 16, 8192, 6400, 268544, 8388608, 0, 32768, 4, 4296704, 131072, 0, 0, 218104416, 1
    .long 4, 16, 16, 8192, 6400, 268544, 8388608, 262144, 32768, 4, 5345280, 131072, 0, 0, 218104544, 1
    .long 4, 16, 16, 8192, 6400, 268544, 8388608, 524288, 32768, 4, 6393856, 131072, 0, 0, 218104672, 1
    .long 1, 32, 32, 8192, 6656, 6912, 8388608, 2097152, 32768, 8, 46243840, 131072, 0, 0, 218105440, 4
    .long 2, 64, 72, 7168, 2816, 2816, 7340032, 524288, 32768, 8, 56406016, 114688, 0, 0, 218103888, 1
    .long 2, 64, 72, 7168, 1792, 1792, 7340032, 2097152, 32768, 8, 61894656, 114688, 0, 0, 218104080, 1
    .long 2, 64, 72, 7168, 768, 768, 7340032, 3670016, 32768, 8, 67383296, 114688, 0, 0, 218104256, 1
    .long 1, 80, 80, 2048, 5505536, 5505792, 7340032, 65622016, 114688, 7, 183508992, 32768, 218104240, 7, 218106752, 1
    .long 0, 0, 0, 0, 0, 0, 0, 0, 0, 0, 0, 0, 0, 0, 0, 0
    .long 0, 0, 0, 0, 0, 0, 0, 0, 0, 0, 0, 0, 0, 0, 0, 0
    .long 6, 16, 16, 8192, 512, 262656, 8388608, 0, 32768, 4, 4202496, 131072, 0, 0, 218104320, 1
    .long 4, 16, 16, 8192, 512, 262656, 8388608, 262144, 32768, 4, 5251072, 131072, 0, 0, 218104448, 1
    .long 4, 16, 16, 8192, 512, 262656, 8388608, 524288, 32768, 4, 6299648, 131072, 0, 0, 218104576, 1
    .long 1, 32, 32, 8192, 1024, 1280, 8388608, 2097152, 32768, 8, 46153728, 131072, 0, 0, 218105360, 4
    .long 2, 64, 72, 7168, 3072, 3072, 7340032, 524288, 32768, 8, 56410112, 114688, 0, 0, 218103888, 1
    .long 2, 64, 72, 7168, 2048, 2048, 7340032, 2097152, 32768, 8, 61898752, 114688, 0, 0, 218104080, 1
    .long 2, 64, 72, 7168, 1024, 1024, 7340032, 3670016, 32768, 8, 67387392, 114688, 0, 0, 218104256, 1
    .long 1, 80, 80, 2048, 1024, 1280, 7340032, 65536000, 114688, 7, 170934272, 32768, 218104192, 7, 218106752, 1
    .long 0, 0, 0, 0, 0, 0, 0, 0, 0, 0, 0, 0, 0, 0, 0, 0
    .long 0, 0, 0, 0, 0, 0, 0, 0, 0, 0, 0, 0, 0, 0, 0, 0
    .long 6, 16, 16, 8192, 2560, 264704, 8388608, 0, 32768, 4, 4235264, 131072, 0, 0, 218104352, 1
    .long 4, 16, 16, 8192, 2560, 264704, 8388608, 262144, 32768, 4, 5283840, 131072, 0, 0, 218104480, 1
    .long 4, 16, 16, 8192, 2560, 264704, 8388608, 524288, 32768, 4, 6332416, 131072, 0, 0, 218104608, 1
    .long 1, 32, 32, 8192, 3072, 3328, 8388608, 2097152, 32768, 8, 46186496, 131072, 0, 0, 218105392, 4
    .long 2, 64, 72, 7168, 3328, 3328, 7340032, 524288, 32768, 8, 56414208, 114688, 0, 0, 218103888, 1
    .long 2, 64, 72, 7168, 2304, 2304, 7340032, 2097152, 32768, 8, 61902848, 114688, 0, 0, 218104080, 1
    .long 2, 64, 72, 7168, 1280, 1280, 7340032, 3670016, 32768, 8, 67391488, 114688, 0, 0, 218104256, 1
    .long 1, 80, 80, 2048, 1836032, 1836288, 7340032, 65564672, 114688, 7, 175128576, 32768, 218104208, 7, 218106752, 1
    .long 0, 0, 0, 0, 0, 0, 0, 0, 0, 0, 0, 0, 0, 0, 0, 0
    .long 0, 0, 0, 0, 0, 0, 0, 0, 0, 0, 0, 0, 0, 0, 0, 0
    .long 6, 16, 16, 8192, 4608, 266752, 8388608, 0, 32768, 4, 4268032, 131072, 0, 0, 218104384, 1
    .long 4, 16, 16, 8192, 4608, 266752, 8388608, 262144, 32768, 4, 5316608, 131072, 0, 0, 218104512, 1
    .long 4, 16, 16, 8192, 4608, 266752, 8388608, 524288, 32768, 4, 6365184, 131072, 0, 0, 218104640, 1
    .long 1, 32, 32, 8192, 5120, 5376, 8388608, 2097152, 32768, 8, 46219264, 131072, 0, 0, 218105424, 4
    .long 2, 64, 72, 7168, 3584, 3584, 7340032, 524288, 32768, 8, 56418304, 114688, 0, 0, 218103904, 1
    .long 2, 64, 72, 7168, 2560, 2560, 7340032, 2097152, 32768, 8, 61906944, 114688, 0, 0, 218104080, 1
    .long 2, 64, 72, 7168, 1536, 1536, 7340032, 3670016, 32768, 8, 67395584, 114688, 0, 0, 218104256, 1
    .long 1, 80, 80, 2048, 3671040, 3671296, 7340032, 65593344, 114688, 7, 179322880, 32768, 218104224, 7, 218106752, 1
    .long 0, 0, 0, 0, 0, 0, 0, 0, 0, 0, 0, 0, 0, 0, 0, 0
    .long 0, 0, 0, 0, 0, 0, 0, 0, 0, 0, 0, 0, 0, 0, 0, 0
    .long 6, 16, 16, 8192, 6656, 268800, 8388608, 0, 32768, 4, 4300800, 131072, 0, 0, 218104416, 1
    .long 4, 16, 16, 8192, 6656, 268800, 8388608, 262144, 32768, 4, 5349376, 131072, 0, 0, 218104544, 1
    .long 4, 16, 16, 8192, 6656, 268800, 8388608, 524288, 32768, 4, 6397952, 131072, 0, 0, 218104672, 1
    .long 1, 32, 32, 8192, 7168, 7424, 8388608, 2097152, 32768, 8, 46252032, 131072, 0, 0, 218105456, 4
    .long 2, 64, 72, 7168, 3840, 3840, 7340032, 524288, 32768, 8, 56422400, 114688, 0, 0, 218103904, 1
    .long 2, 64, 72, 7168, 2816, 2816, 7340032, 2097152, 32768, 8, 61911040, 114688, 0, 0, 218104080, 1
    .long 2, 64, 72, 7168, 1792, 1792, 7340032, 3670016, 32768, 8, 67399680, 114688, 0, 0, 218104272, 1
    .long 1, 80, 80, 2048, 5506048, 5506304, 7340032, 65622016, 114688, 7, 183517184, 32768, 218104240, 7, 218106752, 1
    .long 0, 0, 0, 0, 0, 0, 0, 0, 0, 0, 0, 0, 0, 0, 0, 0
    .long 0, 0, 0, 0, 0, 0, 0, 0, 0, 0, 0, 0, 0, 0, 0, 0
    .long 6, 16, 16, 8192, 768, 262912, 8388608, 0, 32768, 4, 4206592, 131072, 0, 0, 218104320, 1
    .long 4, 16, 16, 8192, 768, 262912, 8388608, 262144, 32768, 4, 5255168, 131072, 0, 0, 218104448, 1
    .long 4, 16, 16, 8192, 768, 262912, 8388608, 524288, 32768, 4, 6303744, 131072, 0, 0, 218104576, 1
    .long 1, 32, 32, 8192, 1536, 1792, 8388608, 2097152, 32768, 8, 46161920, 131072, 0, 0, 218105360, 4
    .long 2, 64, 72, 7168, 4096, 4096, 7340032, 524288, 32768, 8, 56426496, 114688, 0, 0, 218103904, 1
    .long 2, 64, 72, 7168, 3072, 3072, 7340032, 2097152, 32768, 8, 61915136, 114688, 0, 0, 218104080, 1
    .long 2, 64, 72, 7168, 2048, 2048, 7340032, 3670016, 32768, 8, 67403776, 114688, 0, 0, 218104272, 1
    .long 1, 80, 80, 2048, 1536, 1792, 7340032, 65536000, 114688, 7, 170942464, 32768, 218104192, 7, 218106752, 1
    .long 0, 0, 0, 0, 0, 0, 0, 0, 0, 0, 0, 0, 0, 0, 0, 0
    .long 0, 0, 0, 0, 0, 0, 0, 0, 0, 0, 0, 0, 0, 0, 0, 0
    .long 6, 16, 16, 8192, 2816, 264960, 8388608, 0, 32768, 4, 4239360, 131072, 0, 0, 218104352, 1
    .long 4, 16, 16, 8192, 2816, 264960, 8388608, 262144, 32768, 4, 5287936, 131072, 0, 0, 218104480, 1
    .long 4, 16, 16, 8192, 2816, 264960, 8388608, 524288, 32768, 4, 6336512, 131072, 0, 0, 218104608, 1
    .long 1, 32, 32, 8192, 3584, 3840, 8388608, 2097152, 32768, 8, 46194688, 131072, 0, 0, 218105392, 4
    .long 2, 64, 72, 7168, 4352, 4352, 7340032, 524288, 32768, 8, 56430592, 114688, 0, 0, 218103904, 1
    .long 2, 64, 72, 7168, 3328, 3328, 7340032, 2097152, 32768, 8, 61919232, 114688, 0, 0, 218104080, 1
    .long 2, 64, 72, 7168, 2304, 2304, 7340032, 3670016, 32768, 8, 67407872, 114688, 0, 0, 218104272, 1
    .long 1, 80, 80, 2048, 1836544, 1836800, 7340032, 65564672, 114688, 7, 175136768, 32768, 218104208, 7, 218106752, 1
    .long 0, 0, 0, 0, 0, 0, 0, 0, 0, 0, 0, 0, 0, 0, 0, 0
    .long 0, 0, 0, 0, 0, 0, 0, 0, 0, 0, 0, 0, 0, 0, 0, 0
    .long 6, 16, 16, 8192, 4864, 267008, 8388608, 0, 32768, 4, 4272128, 131072, 0, 0, 218104384, 1
    .long 4, 16, 16, 8192, 4864, 267008, 8388608, 262144, 32768, 4, 5320704, 131072, 0, 0, 218104512, 1
    .long 4, 16, 16, 8192, 4864, 267008, 8388608, 524288, 32768, 4, 6369280, 131072, 0, 0, 218104640, 1
    .long 1, 32, 32, 8192, 5632, 5888, 8388608, 2097152, 32768, 8, 46227456, 131072, 0, 0, 218105424, 4
    .long 2, 64, 72, 7168, 4608, 4608, 7340032, 524288, 32768, 8, 56434688, 114688, 0, 0, 218103904, 1
    .long 2, 64, 72, 7168, 3584, 3584, 7340032, 2097152, 32768, 8, 61923328, 114688, 0, 0, 218104096, 1
    .long 2, 64, 72, 7168, 2560, 2560, 7340032, 3670016, 32768, 8, 67411968, 114688, 0, 0, 218104272, 1
    .long 1, 80, 80, 2048, 3671552, 3671808, 7340032, 65593344, 114688, 7, 179331072, 32768, 218104224, 7, 218106752, 1
    .long 0, 0, 0, 0, 0, 0, 0, 0, 0, 0, 0, 0, 0, 0, 0, 0
    .long 0, 0, 0, 0, 0, 0, 0, 0, 0, 0, 0, 0, 0, 0, 0, 0
    .long 6, 16, 16, 8192, 6912, 269056, 8388608, 0, 32768, 4, 4304896, 131072, 0, 0, 218104416, 1
    .long 4, 16, 16, 8192, 6912, 269056, 8388608, 262144, 32768, 4, 5353472, 131072, 0, 0, 218104544, 1
    .long 4, 16, 16, 8192, 6912, 269056, 8388608, 524288, 32768, 4, 6402048, 131072, 0, 0, 218104672, 1
    .long 1, 32, 32, 8192, 7680, 7936, 8388608, 2097152, 32768, 8, 46260224, 131072, 0, 0, 218105456, 4
    .long 2, 64, 72, 7168, 4864, 4864, 7340032, 524288, 32768, 8, 56438784, 114688, 0, 0, 218103904, 1
    .long 2, 64, 72, 7168, 3840, 3840, 7340032, 2097152, 32768, 8, 61927424, 114688, 0, 0, 218104096, 1
    .long 2, 64, 72, 7168, 2816, 2816, 7340032, 3670016, 32768, 8, 67416064, 114688, 0, 0, 218104272, 1
    .long 1, 80, 80, 2048, 5506560, 5506816, 7340032, 65622016, 114688, 7, 183525376, 32768, 218104240, 7, 218106752, 1
    .long 0, 0, 0, 0, 0, 0, 0, 0, 0, 0, 0, 0, 0, 0, 0, 0
    .long 0, 0, 0, 0, 0, 0, 0, 0, 0, 0, 0, 0, 0, 0, 0, 0
    .long 6, 16, 16, 8192, 1024, 263168, 8388608, 0, 32768, 4, 4210688, 131072, 0, 0, 218104336, 1
    .long 4, 16, 16, 8192, 1024, 263168, 8388608, 262144, 32768, 4, 5259264, 131072, 0, 0, 218104464, 1
    .long 4, 16, 16, 8192, 768, 262912, 8388608, 786432, 32768, 4, 7352320, 131072, 0, 0, 218104576, 1
    .long 1, 24, 24, 8192, 0, 256, 8388608, 2097152, 32768, 8, 29360128, 131072, 0, 0, 218105344, 4
    .long 2, 64, 72, 7168, 5120, 5120, 7340032, 524288, 32768, 8, 56442880, 114688, 0, 0, 218103904, 1
    .long 2, 64, 72, 7168, 4096, 4096, 7340032, 2097152, 32768, 8, 61931520, 114688, 0, 0, 218104096, 1
    .long 2, 64, 72, 7168, 3072, 3072, 7340032, 3670016, 32768, 8, 67420160, 114688, 0, 0, 218104272, 1
    .long 1, 80, 80, 2048, 0, 256, 7340032, 67371008, 114688, 7, 171442176, 32768, 218104256, 7, 218106816, 1
    .long 0, 0, 0, 0, 0, 0, 0, 0, 0, 0, 0, 0, 0, 0, 0, 0
    .long 0, 0, 0, 0, 0, 0, 0, 0, 0, 0, 0, 0, 0, 0, 0, 0
    .long 6, 16, 16, 8192, 3072, 265216, 8388608, 0, 32768, 4, 4243456, 131072, 0, 0, 218104368, 1
    .long 4, 16, 16, 8192, 3072, 265216, 8388608, 262144, 32768, 4, 5292032, 131072, 0, 0, 218104496, 1
    .long 4, 16, 16, 8192, 2816, 264960, 8388608, 786432, 32768, 4, 7385088, 131072, 0, 0, 218104608, 1
    .long 1, 24, 24, 8192, 2048, 2304, 8388608, 2097152, 32768, 8, 29392896, 131072, 0, 0, 218105376, 4
    .long 2, 64, 72, 7168, 5376, 5376, 7340032, 524288, 32768, 8, 56446976, 114688, 0, 0, 218103920, 1
    .long 2, 64, 72, 7168, 4352, 4352, 7340032, 2097152, 32768, 8, 61935616, 114688, 0, 0, 218104096, 1
    .long 2, 64, 72, 7168, 3328, 3328, 7340032, 3670016, 32768, 8, 67424256, 114688, 0, 0, 218104272, 1
    .long 1, 80, 80, 2048, 1835008, 1835264, 7340032, 67399680, 114688, 7, 175636480, 32768, 218104272, 7, 218106816, 1
    .long 0, 0, 0, 0, 0, 0, 0, 0, 0, 0, 0, 0, 0, 0, 0, 0
    .long 0, 0, 0, 0, 0, 0, 0, 0, 0, 0, 0, 0, 0, 0, 0, 0
    .long 6, 16, 16, 8192, 5120, 267264, 8388608, 0, 32768, 4, 4276224, 131072, 0, 0, 218104400, 1
    .long 4, 16, 16, 8192, 5120, 267264, 8388608, 262144, 32768, 4, 5324800, 131072, 0, 0, 218104528, 1
    .long 4, 16, 16, 8192, 4864, 267008, 8388608, 786432, 32768, 4, 7417856, 131072, 0, 0, 218104640, 1
    .long 1, 24, 24, 8192, 4096, 4352, 8388608, 2097152, 32768, 8, 29425664, 131072, 0, 0, 218105408, 4
    .long 2, 64, 72, 7168, 5632, 5632, 7340032, 524288, 32768, 8, 56451072, 114688, 0, 0, 218103920, 1
    .long 2, 64, 72, 7168, 4608, 4608, 7340032, 2097152, 32768, 8, 61939712, 114688, 0, 0, 218104096, 1
    .long 2, 64, 72, 7168, 3584, 3584, 7340032, 3670016, 32768, 8, 67428352, 114688, 0, 0, 218104288, 1
    .long 1, 80, 80, 2048, 3670016, 3670272, 7340032, 67428352, 114688, 7, 179830784, 32768, 218104288, 7, 218106816, 1
    .long 0, 0, 0, 0, 0, 0, 0, 0, 0, 0, 0, 0, 0, 0, 0, 0
    .long 0, 0, 0, 0, 0, 0, 0, 0, 0, 0, 0, 0, 0, 0, 0, 0
    .long 6, 16, 16, 8192, 7168, 269312, 8388608, 0, 32768, 4, 4308992, 131072, 0, 0, 218104432, 1
    .long 4, 16, 16, 8192, 7168, 269312, 8388608, 262144, 32768, 4, 5357568, 131072, 0, 0, 218104560, 1
    .long 4, 16, 16, 8192, 6912, 269056, 8388608, 786432, 32768, 4, 7450624, 131072, 0, 0, 218104672, 1
    .long 1, 24, 24, 8192, 6144, 6400, 8388608, 2097152, 32768, 8, 29458432, 131072, 0, 0, 218105440, 4
    .long 2, 64, 72, 7168, 5888, 5888, 7340032, 524288, 32768, 8, 56455168, 114688, 0, 0, 218103920, 1
    .long 2, 64, 72, 7168, 4864, 4864, 7340032, 2097152, 32768, 8, 61943808, 114688, 0, 0, 218104096, 1
    .long 2, 64, 72, 7168, 3840, 3840, 7340032, 3670016, 32768, 8, 67432448, 114688, 0, 0, 218104288, 1
    .long 1, 80, 80, 2048, 5505024, 5505280, 7340032, 67457024, 114688, 7, 184025088, 32768, 218104304, 7, 218106816, 1
    .long 0, 0, 0, 0, 0, 0, 0, 0, 0, 0, 0, 0, 0, 0, 0, 0
    .long 0, 0, 0, 0, 0, 0, 0, 0, 0, 0, 0, 0, 0, 0, 0, 0
    .long 6, 16, 16, 8192, 1280, 263424, 8388608, 0, 32768, 4, 4214784, 131072, 0, 0, 218104336, 1
    .long 4, 16, 16, 8192, 1280, 263424, 8388608, 262144, 32768, 4, 5263360, 131072, 0, 0, 218104464, 1
    .long 4, 16, 16, 8192, 512, 262656, 8388608, 786432, 32768, 4, 7348224, 131072, 0, 0, 218104576, 1
    .long 1, 24, 24, 8192, 512, 768, 8388608, 2097152, 32768, 8, 29368320, 131072, 0, 0, 218105344, 4
    .long 2, 64, 72, 7168, 6144, 6144, 7340032, 524288, 32768, 8, 56459264, 114688, 0, 0, 218103920, 1
    .long 2, 64, 72, 7168, 5120, 5120, 7340032, 2097152, 32768, 8, 61947904, 114688, 0, 0, 218104096, 1
    .long 2, 64, 72, 7168, 4096, 4096, 7340032, 3670016, 32768, 8, 67436544, 114688, 0, 0, 218104288, 1
    .long 1, 80, 80, 2048, 512, 768, 7340032, 67371008, 114688, 7, 171450368, 32768, 218104256, 7, 218106816, 1
    .long 0, 0, 0, 0, 0, 0, 0, 0, 0, 0, 0, 0, 0, 0, 0, 0
    .long 0, 0, 0, 0, 0, 0, 0, 0, 0, 0, 0, 0, 0, 0, 0, 0
    .long 6, 16, 16, 8192, 3328, 265472, 8388608, 0, 32768, 4, 4247552, 131072, 0, 0, 218104368, 1
    .long 4, 16, 16, 8192, 3328, 265472, 8388608, 262144, 32768, 4, 5296128, 131072, 0, 0, 218104496, 1
    .long 4, 16, 16, 8192, 2560, 264704, 8388608, 786432, 32768, 4, 7380992, 131072, 0, 0, 218104608, 1
    .long 1, 24, 24, 8192, 2560, 2816, 8388608, 2097152, 32768, 8, 29401088, 131072, 0, 0, 218105376, 4
    .long 2, 64, 72, 7168, 6400, 6400, 7340032, 524288, 32768, 8, 56463360, 114688, 0, 0, 218103920, 1
    .long 2, 64, 72, 7168, 5376, 5376, 7340032, 2097152, 32768, 8, 61952000, 114688, 0, 0, 218104112, 1
    .long 2, 64, 72, 7168, 4352, 4352, 7340032, 3670016, 32768, 8, 67440640, 114688, 0, 0, 218104288, 1
    .long 1, 80, 80, 2048, 1835520, 1835776, 7340032, 67399680, 114688, 7, 175644672, 32768, 218104272, 7, 218106816, 1
    .long 0, 0, 0, 0, 0, 0, 0, 0, 0, 0, 0, 0, 0, 0, 0, 0
    .long 0, 0, 0, 0, 0, 0, 0, 0, 0, 0, 0, 0, 0, 0, 0, 0
    .long 6, 16, 16, 8192, 5376, 267520, 8388608, 0, 32768, 4, 4280320, 131072, 0, 0, 218104400, 1
    .long 4, 16, 16, 8192, 5376, 267520, 8388608, 262144, 32768, 4, 5328896, 131072, 0, 0, 218104528, 1
    .long 4, 16, 16, 8192, 4608, 266752, 8388608, 786432, 32768, 4, 7413760, 131072, 0, 0, 218104640, 1
    .long 1, 24, 24, 8192, 4608, 4864, 8388608, 2097152, 32768, 8, 29433856, 131072, 0, 0, 218105408, 4
    .long 2, 64, 72, 7168, 6656, 6656, 7340032, 524288, 32768, 8, 56467456, 114688, 0, 0, 218103920, 1
    .long 2, 64, 72, 7168, 5632, 5632, 7340032, 2097152, 32768, 8, 61956096, 114688, 0, 0, 218104112, 1
    .long 2, 64, 72, 7168, 4608, 4608, 7340032, 3670016, 32768, 8, 67444736, 114688, 0, 0, 218104288, 1
    .long 1, 80, 80, 2048, 3670528, 3670784, 7340032, 67428352, 114688, 7, 179838976, 32768, 218104288, 7, 218106816, 1
    .long 0, 0, 0, 0, 0, 0, 0, 0, 0, 0, 0, 0, 0, 0, 0, 0
    .long 0, 0, 0, 0, 0, 0, 0, 0, 0, 0, 0, 0, 0, 0, 0, 0
    .long 6, 16, 16, 8192, 7424, 269568, 8388608, 0, 32768, 4, 4313088, 131072, 0, 0, 218104432, 1
    .long 4, 16, 16, 8192, 7424, 269568, 8388608, 262144, 32768, 4, 5361664, 131072, 0, 0, 218104560, 1
    .long 4, 16, 16, 8192, 6656, 268800, 8388608, 786432, 32768, 4, 7446528, 131072, 0, 0, 218104672, 1
    .long 1, 24, 24, 8192, 6656, 6912, 8388608, 2097152, 32768, 8, 29466624, 131072, 0, 0, 218105440, 4
    .long 2, 64, 72, 7168, 6912, 6912, 7340032, 524288, 32768, 8, 56471552, 114688, 0, 0, 218103920, 1
    .long 2, 64, 72, 7168, 5888, 5888, 7340032, 2097152, 32768, 8, 61960192, 114688, 0, 0, 218104112, 1
    .long 2, 64, 72, 7168, 4864, 4864, 7340032, 3670016, 32768, 8, 67448832, 114688, 0, 0, 218104288, 1
    .long 1, 80, 80, 2048, 5505536, 5505792, 7340032, 67457024, 114688, 7, 184033280, 32768, 218104304, 7, 218106816, 1
    .long 0, 0, 0, 0, 0, 0, 0, 0, 0, 0, 0, 0, 0, 0, 0, 0
    .long 0, 0, 0, 0, 0, 0, 0, 0, 0, 0, 0, 0, 0, 0, 0, 0
    .long 6, 16, 16, 8192, 1536, 263680, 8388608, 0, 32768, 4, 4218880, 131072, 0, 0, 218104336, 1
    .long 4, 16, 16, 8192, 1536, 263680, 8388608, 262144, 32768, 4, 5267456, 131072, 0, 0, 218104464, 1
    .long 4, 16, 16, 8192, 256, 262400, 8388608, 786432, 32768, 4, 7344128, 131072, 0, 0, 218104576, 1
    .long 1, 24, 24, 8192, 1024, 1280, 8388608, 2097152, 32768, 8, 29376512, 131072, 0, 0, 218105360, 4
    .long 2, 64, 72, 7168, 0, 0, 7340032, 1048576, 32768, 8, 58195968, 114688, 0, 0, 218103936, 1
    .long 2, 64, 72, 7168, 6144, 6144, 7340032, 2097152, 32768, 8, 61964288, 114688, 0, 0, 218104112, 1
    .long 2, 64, 72, 7168, 5120, 5120, 7340032, 3670016, 32768, 8, 67452928, 114688, 0, 0, 218104288, 1
    .long 1, 80, 80, 2048, 1024, 1280, 7340032, 67371008, 114688, 7, 171458560, 32768, 218104256, 7, 218106816, 1
    .long 0, 0, 0, 0, 0, 0, 0, 0, 0, 0, 0, 0, 0, 0, 0, 0
    .long 0, 0, 0, 0, 0, 0, 0, 0, 0, 0, 0, 0, 0, 0, 0, 0
    .long 6, 16, 16, 8192, 3584, 265728, 8388608, 0, 32768, 4, 4251648, 131072, 0, 0, 218104368, 1
    .long 4, 16, 16, 8192, 3584, 265728, 8388608, 262144, 32768, 4, 5300224, 131072, 0, 0, 218104496, 1
    .long 4, 16, 16, 8192, 2304, 264448, 8388608, 786432, 32768, 4, 7376896, 131072, 0, 0, 218104608, 1
    .long 1, 24, 24, 8192, 3072, 3328, 8388608, 2097152, 32768, 8, 29409280, 131072, 0, 0, 218105392, 4
    .long 2, 64, 72, 7168, 256, 256, 7340032, 1048576, 32768, 8, 58200064, 114688, 0, 0, 218103936, 1
    .long 2, 64, 72, 7168, 6400, 6400, 7340032, 2097152, 32768, 8, 61968384, 114688, 0, 0, 218104112, 1
    .long 2, 64, 72, 7168, 5376, 5376, 7340032, 3670016, 32768, 8, 67457024, 114688, 0, 0, 218104304, 1
    .long 1, 80, 80, 2048, 1836032, 1836288, 7340032, 67399680, 114688, 7, 175652864, 32768, 218104272, 7, 218106816, 1
    .long 0, 0, 0, 0, 0, 0, 0, 0, 0, 0, 0, 0, 0, 0, 0, 0
    .long 0, 0, 0, 0, 0, 0, 0, 0, 0, 0, 0, 0, 0, 0, 0, 0
    .long 6, 16, 16, 8192, 5632, 267776, 8388608, 0, 32768, 4, 4284416, 131072, 0, 0, 218104400, 1
    .long 4, 16, 16, 8192, 5632, 267776, 8388608, 262144, 32768, 4, 5332992, 131072, 0, 0, 218104528, 1
    .long 4, 16, 16, 8192, 4352, 266496, 8388608, 786432, 32768, 4, 7409664, 131072, 0, 0, 218104640, 1
    .long 1, 24, 24, 8192, 5120, 5376, 8388608, 2097152, 32768, 8, 29442048, 131072, 0, 0, 218105424, 4
    .long 2, 64, 72, 7168, 512, 512, 7340032, 1048576, 32768, 8, 58204160, 114688, 0, 0, 218103936, 1
    .long 2, 64, 72, 7168, 6656, 6656, 7340032, 2097152, 32768, 8, 61972480, 114688, 0, 0, 218104112, 1
    .long 2, 64, 72, 7168, 5632, 5632, 7340032, 3670016, 32768, 8, 67461120, 114688, 0, 0, 218104304, 1
    .long 1, 80, 80, 2048, 3671040, 3671296, 7340032, 67428352, 114688, 7, 179847168, 32768, 218104288, 7, 218106816, 1
    .long 0, 0, 0, 0, 0, 0, 0, 0, 0, 0, 0, 0, 0, 0, 0, 0
    .long 0, 0, 0, 0, 0, 0, 0, 0, 0, 0, 0, 0, 0, 0, 0, 0
    .long 6, 16, 16, 8192, 7680, 269824, 8388608, 0, 32768, 4, 4317184, 131072, 0, 0, 218104432, 1
    .long 4, 16, 16, 8192, 7680, 269824, 8388608, 262144, 32768, 4, 5365760, 131072, 0, 0, 218104560, 1
    .long 4, 16, 16, 8192, 6400, 268544, 8388608, 786432, 32768, 4, 7442432, 131072, 0, 0, 218104672, 1
    .long 1, 24, 24, 8192, 7168, 7424, 8388608, 2097152, 32768, 8, 29474816, 131072, 0, 0, 218105456, 4
    .long 2, 64, 72, 7168, 768, 768, 7340032, 1048576, 32768, 8, 58208256, 114688, 0, 0, 218103936, 1
    .long 2, 64, 72, 7168, 6912, 6912, 7340032, 2097152, 32768, 8, 61976576, 114688, 0, 0, 218104112, 1
    .long 2, 64, 72, 7168, 5888, 5888, 7340032, 3670016, 32768, 8, 67465216, 114688, 0, 0, 218104304, 1
    .long 1, 80, 80, 2048, 5506048, 5506304, 7340032, 67457024, 114688, 7, 184041472, 32768, 218104304, 7, 218106816, 1
    .long 0, 0, 0, 0, 0, 0, 0, 0, 0, 0, 0, 0, 0, 0, 0, 0
    .long 0, 0, 0, 0, 0, 0, 0, 0, 0, 0, 0, 0, 0, 0, 0, 0
    .long 6, 16, 16, 8192, 1792, 263936, 8388608, 0, 32768, 4, 4222976, 131072, 0, 0, 218104336, 1
    .long 4, 16, 16, 8192, 1792, 263936, 8388608, 262144, 32768, 4, 5271552, 131072, 0, 0, 218104464, 1
    .long 4, 16, 16, 8192, 0, 262144, 8388608, 786432, 32768, 4, 7340032, 131072, 0, 0, 218104576, 1
    .long 1, 24, 24, 8192, 1536, 1792, 8388608, 2097152, 32768, 8, 29384704, 131072, 0, 0, 218105360, 4
    .long 2, 64, 72, 7168, 1024, 1024, 7340032, 1048576, 32768, 8, 58212352, 114688, 0, 0, 218103936, 1
    .long 2, 64, 72, 7168, 0, 0, 7340032, 2621440, 32768, 8, 63700992, 114688, 0, 0, 218104128, 1
    .long 2, 64, 72, 7168, 6144, 6144, 7340032, 3670016, 32768, 8, 67469312, 114688, 0, 0, 218104304, 1
    .long 1, 80, 80, 2048, 1536, 1792, 7340032, 67371008, 114688, 7, 171466752, 32768, 218104256, 7, 218106816, 1
    .long 0, 0, 0, 0, 0, 0, 0, 0, 0, 0, 0, 0, 0, 0, 0, 0
    .long 0, 0, 0, 0, 0, 0, 0, 0, 0, 0, 0, 0, 0, 0, 0, 0
    .long 6, 16, 16, 8192, 3840, 265984, 8388608, 0, 32768, 4, 4255744, 131072, 0, 0, 218104368, 1
    .long 4, 16, 16, 8192, 3840, 265984, 8388608, 262144, 32768, 4, 5304320, 131072, 0, 0, 218104496, 1
    .long 4, 16, 16, 8192, 2048, 264192, 8388608, 786432, 32768, 4, 7372800, 131072, 0, 0, 218104608, 1
    .long 1, 24, 24, 8192, 3584, 3840, 8388608, 2097152, 32768, 8, 29417472, 131072, 0, 0, 218105392, 4
    .long 2, 64, 72, 7168, 1280, 1280, 7340032, 1048576, 32768, 8, 58216448, 114688, 0, 0, 218103936, 1
    .long 2, 64, 72, 7168, 256, 256, 7340032, 2621440, 32768, 8, 63705088, 114688, 0, 0, 218104128, 1
    .long 2, 64, 72, 7168, 6400, 6400, 7340032, 3670016, 32768, 8, 67473408, 114688, 0, 0, 218104304, 1
    .long 1, 80, 80, 2048, 1836544, 1836800, 7340032, 67399680, 114688, 7, 175661056, 32768, 218104272, 7, 218106816, 1
    .long 0, 0, 0, 0, 0, 0, 0, 0, 0, 0, 0, 0, 0, 0, 0, 0
    .long 0, 0, 0, 0, 0, 0, 0, 0, 0, 0, 0, 0, 0, 0, 0, 0
    .long 6, 16, 16, 8192, 5888, 268032, 8388608, 0, 32768, 4, 4288512, 131072, 0, 0, 218104400, 1
    .long 4, 16, 16, 8192, 5888, 268032, 8388608, 262144, 32768, 4, 5337088, 131072, 0, 0, 218104528, 1
    .long 4, 16, 16, 8192, 4096, 266240, 8388608, 786432, 32768, 4, 7405568, 131072, 0, 0, 218104640, 1
    .long 1, 24, 24, 8192, 5632, 5888, 8388608, 2097152, 32768, 8, 29450240, 131072, 0, 0, 218105424, 4
    .long 2, 64, 72, 7168, 1536, 1536, 7340032, 1048576, 32768, 8, 58220544, 114688, 0, 0, 218103936, 1
    .long 2, 64, 72, 7168, 512, 512, 7340032, 2621440, 32768, 8, 63709184, 114688, 0, 0, 218104128, 1
    .long 2, 64, 72, 7168, 6656, 6656, 7340032, 3670016, 32768, 8, 67477504, 114688, 0, 0, 218104304, 1
    .long 1, 80, 80, 2048, 3671552, 3671808, 7340032, 67428352, 114688, 7, 179855360, 32768, 218104288, 7, 218106816, 1
    .long 0, 0, 0, 0, 0, 0, 0, 0, 0, 0, 0, 0, 0, 0, 0, 0
    .long 0, 0, 0, 0, 0, 0, 0, 0, 0, 0, 0, 0, 0, 0, 0, 0
    .long 6, 16, 16, 8192, 7936, 270080, 8388608, 0, 32768, 4, 4321280, 131072, 0, 0, 218104432, 1
    .long 4, 16, 16, 8192, 7936, 270080, 8388608, 262144, 32768, 4, 5369856, 131072, 0, 0, 218104560, 1
    .long 4, 16, 16, 8192, 6144, 268288, 8388608, 786432, 32768, 4, 7438336, 131072, 0, 0, 218104672, 1
    .long 1, 24, 24, 8192, 7680, 7936, 8388608, 2097152, 32768, 8, 29483008, 131072, 0, 0, 218105456, 4
    .long 2, 64, 72, 7168, 1792, 1792, 7340032, 1048576, 32768, 8, 58224640, 114688, 0, 0, 218103952, 1
    .long 2, 64, 72, 7168, 768, 768, 7340032, 2621440, 32768, 8, 63713280, 114688, 0, 0, 218104128, 1
    .long 2, 64, 72, 7168, 6912, 6912, 7340032, 3670016, 32768, 8, 67481600, 114688, 0, 0, 218104304, 1
    .long 1, 80, 80, 2048, 5506560, 5506816, 7340032, 67457024, 114688, 7, 184049664, 32768, 218104304, 7, 218106816, 1
    .long 0, 0, 0, 0, 0, 0, 0, 0, 0, 0, 0, 0, 0, 0, 0, 0
    .long 0, 0, 0, 0, 0, 0, 0, 0, 0, 0, 0, 0, 0, 0, 0, 0
    .long 1, 32, 32, 8192, 0, 256, 8388608, 524288, 32768, 8, 39845888, 131072, 0, 0, 218104576, 4
    .long 1, 16, 16, 8192, 0, 256, 8388608, 1048576, 32768, 8, 8388608, 131072, 0, 0, 218104832, 4
    .long 1, 24, 24, 8192, 0, 256, 8388608, 2621440, 32768, 8, 31457280, 131072, 0, 0, 218105600, 4
    .long 1, 16, 16, 8192, 0, 256, 8388608, 3145728, 32768, 8, 16777216, 131072, 0, 0, 218105856, 4
    .long 1, 16, 16, 8192, 0, 256, 8388608, 3670016, 32768, 8, 18874368, 131072, 0, 0, 218106112, 4
    .long 1, 80, 80, 2048, 0, 256, 7340032, 58195968, 114688, 7, 168820736, 32768, 218103936, 7, 218106496, 1
    .long 0, 0, 0, 0, 0, 0, 0, 0, 0, 0, 0, 0, 0, 0, 0, 0
    .long 0, 0, 0, 0, 0, 0, 0, 0, 0, 0, 0, 0, 0, 0, 0, 0
    .long 0, 0, 0, 0, 0, 0, 0, 0, 0, 0, 0, 0, 0, 0, 0, 0
    .long 0, 0, 0, 0, 0, 0, 0, 0, 0, 0, 0, 0, 0, 0, 0, 0
    .long 1, 32, 32, 8192, 2048, 2304, 8388608, 524288, 32768, 8, 39878656, 131072, 0, 0, 218104608, 4
    .long 1, 16, 16, 8192, 2048, 2304, 8388608, 1048576, 32768, 8, 8421376, 131072, 0, 0, 218104864, 4
    .long 1, 24, 24, 8192, 2048, 2304, 8388608, 2621440, 32768, 8, 31490048, 131072, 0, 0, 218105632, 4
    .long 1, 16, 16, 8192, 2048, 2304, 8388608, 3145728, 32768, 8, 16809984, 131072, 0, 0, 218105888, 4
    .long 1, 16, 16, 8192, 2048, 2304, 8388608, 3670016, 32768, 8, 18907136, 131072, 0, 0, 218106144, 4
    .long 1, 80, 80, 2048, 1835008, 1835264, 7340032, 58224640, 114688, 7, 173015040, 32768, 218103952, 7, 218106496, 1
    .long 0, 0, 0, 0, 0, 0, 0, 0, 0, 0, 0, 0, 0, 0, 0, 0
    .long 0, 0, 0, 0, 0, 0, 0, 0, 0, 0, 0, 0, 0, 0, 0, 0
    .long 0, 0, 0, 0, 0, 0, 0, 0, 0, 0, 0, 0, 0, 0, 0, 0
    .long 0, 0, 0, 0, 0, 0, 0, 0, 0, 0, 0, 0, 0, 0, 0, 0
    .long 1, 32, 32, 8192, 4096, 4352, 8388608, 524288, 32768, 8, 39911424, 131072, 0, 0, 218104640, 4
    .long 1, 16, 16, 8192, 4096, 4352, 8388608, 1048576, 32768, 8, 8454144, 131072, 0, 0, 218104896, 4
    .long 1, 24, 24, 8192, 4096, 4352, 8388608, 2621440, 32768, 8, 31522816, 131072, 0, 0, 218105664, 4
    .long 1, 16, 16, 8192, 4096, 4352, 8388608, 3145728, 32768, 8, 16842752, 131072, 0, 0, 218105920, 4
    .long 1, 16, 16, 8192, 4096, 4352, 8388608, 3670016, 32768, 8, 18939904, 131072, 0, 0, 218106176, 4
    .long 1, 80, 80, 2048, 3670016, 3670272, 7340032, 58253312, 114688, 7, 177209344, 32768, 218103968, 7, 218106496, 1
    .long 0, 0, 0, 0, 0, 0, 0, 0, 0, 0, 0, 0, 0, 0, 0, 0
    .long 0, 0, 0, 0, 0, 0, 0, 0, 0, 0, 0, 0, 0, 0, 0, 0
    .long 0, 0, 0, 0, 0, 0, 0, 0, 0, 0, 0, 0, 0, 0, 0, 0
    .long 0, 0, 0, 0, 0, 0, 0, 0, 0, 0, 0, 0, 0, 0, 0, 0
    .long 1, 32, 32, 8192, 6144, 6400, 8388608, 524288, 32768, 8, 39944192, 131072, 0, 0, 218104672, 4
    .long 1, 16, 16, 8192, 6144, 6400, 8388608, 1048576, 32768, 8, 8486912, 131072, 0, 0, 218104928, 4
    .long 1, 24, 24, 8192, 6144, 6400, 8388608, 2621440, 32768, 8, 31555584, 131072, 0, 0, 218105696, 4
    .long 1, 16, 16, 8192, 6144, 6400, 8388608, 3145728, 32768, 8, 16875520, 131072, 0, 0, 218105952, 4
    .long 1, 16, 16, 8192, 6144, 6400, 8388608, 3670016, 32768, 8, 18972672, 131072, 0, 0, 218106208, 4
    .long 1, 80, 80, 2048, 5505024, 5505280, 7340032, 58281984, 114688, 7, 181403648, 32768, 218103984, 7, 218106496, 1
    .long 0, 0, 0, 0, 0, 0, 0, 0, 0, 0, 0, 0, 0, 0, 0, 0
    .long 0, 0, 0, 0, 0, 0, 0, 0, 0, 0, 0, 0, 0, 0, 0, 0
    .long 0, 0, 0, 0, 0, 0, 0, 0, 0, 0, 0, 0, 0, 0, 0, 0
    .long 0, 0, 0, 0, 0, 0, 0, 0, 0, 0, 0, 0, 0, 0, 0, 0
    .long 1, 32, 32, 8192, 512, 768, 8388608, 524288, 32768, 8, 39854080, 131072, 0, 0, 218104576, 4
    .long 1, 16, 16, 8192, 512, 768, 8388608, 1048576, 32768, 8, 8396800, 131072, 0, 0, 218104832, 4
    .long 1, 24, 24, 8192, 512, 768, 8388608, 2621440, 32768, 8, 31465472, 131072, 0, 0, 218105600, 4
    .long 1, 16, 16, 8192, 512, 768, 8388608, 3145728, 32768, 8, 16785408, 131072, 0, 0, 218105856, 4
    .long 1, 16, 16, 8192, 512, 768, 8388608, 3670016, 32768, 8, 18882560, 131072, 0, 0, 218106112, 4
    .long 1, 80, 80, 2048, 512, 768, 7340032, 58195968, 114688, 7, 168828928, 32768, 218103936, 7, 218106496, 1
    .long 0, 0, 0, 0, 0, 0, 0, 0, 0, 0, 0, 0, 0, 0, 0, 0
    .long 0, 0, 0, 0, 0, 0, 0, 0, 0, 0, 0, 0, 0, 0, 0, 0
    .long 0, 0, 0, 0, 0, 0, 0, 0, 0, 0, 0, 0, 0, 0, 0, 0
    .long 0, 0, 0, 0, 0, 0, 0, 0, 0, 0, 0, 0, 0, 0, 0, 0
    .long 1, 32, 32, 8192, 2560, 2816, 8388608, 524288, 32768, 8, 39886848, 131072, 0, 0, 218104608, 4
    .long 1, 16, 16, 8192, 2560, 2816, 8388608, 1048576, 32768, 8, 8429568, 131072, 0, 0, 218104864, 4
    .long 1, 24, 24, 8192, 2560, 2816, 8388608, 2621440, 32768, 8, 31498240, 131072, 0, 0, 218105632, 4
    .long 1, 16, 16, 8192, 2560, 2816, 8388608, 3145728, 32768, 8, 16818176, 131072, 0, 0, 218105888, 4
    .long 1, 16, 16, 8192, 2560, 2816, 8388608, 3670016, 32768, 8, 18915328, 131072, 0, 0, 218106144, 4
    .long 1, 80, 80, 2048, 1835520, 1835776, 7340032, 58224640, 114688, 7, 173023232, 32768, 218103952, 7, 218106496, 1
    .long 0, 0, 0, 0, 0, 0, 0, 0, 0, 0, 0, 0, 0, 0, 0, 0
    .long 0, 0, 0, 0, 0, 0, 0, 0, 0, 0, 0, 0, 0, 0, 0, 0
    .long 0, 0, 0, 0, 0, 0, 0, 0, 0, 0, 0, 0, 0, 0, 0, 0
    .long 0, 0, 0, 0, 0, 0, 0, 0, 0, 0, 0, 0, 0, 0, 0, 0
    .long 1, 32, 32, 8192, 4608, 4864, 8388608, 524288, 32768, 8, 39919616, 131072, 0, 0, 218104640, 4
    .long 1, 16, 16, 8192, 4608, 4864, 8388608, 1048576, 32768, 8, 8462336, 131072, 0, 0, 218104896, 4
    .long 1, 24, 24, 8192, 4608, 4864, 8388608, 2621440, 32768, 8, 31531008, 131072, 0, 0, 218105664, 4
    .long 1, 16, 16, 8192, 4608, 4864, 8388608, 3145728, 32768, 8, 16850944, 131072, 0, 0, 218105920, 4
    .long 1, 16, 16, 8192, 4608, 4864, 8388608, 3670016, 32768, 8, 18948096, 131072, 0, 0, 218106176, 4
    .long 1, 80, 80, 2048, 3670528, 3670784, 7340032, 58253312, 114688, 7, 177217536, 32768, 218103968, 7, 218106496, 1
    .long 0, 0, 0, 0, 0, 0, 0, 0, 0, 0, 0, 0, 0, 0, 0, 0
    .long 0, 0, 0, 0, 0, 0, 0, 0, 0, 0, 0, 0, 0, 0, 0, 0
    .long 0, 0, 0, 0, 0, 0, 0, 0, 0, 0, 0, 0, 0, 0, 0, 0
    .long 0, 0, 0, 0, 0, 0, 0, 0, 0, 0, 0, 0, 0, 0, 0, 0
    .long 1, 32, 32, 8192, 6656, 6912, 8388608, 524288, 32768, 8, 39952384, 131072, 0, 0, 218104672, 4
    .long 1, 16, 16, 8192, 6656, 6912, 8388608, 1048576, 32768, 8, 8495104, 131072, 0, 0, 218104928, 4
    .long 1, 24, 24, 8192, 6656, 6912, 8388608, 2621440, 32768, 8, 31563776, 131072, 0, 0, 218105696, 4
    .long 1, 16, 16, 8192, 6656, 6912, 8388608, 3145728, 32768, 8, 16883712, 131072, 0, 0, 218105952, 4
    .long 1, 16, 16, 8192, 6656, 6912, 8388608, 3670016, 32768, 8, 18980864, 131072, 0, 0, 218106208, 4
    .long 1, 80, 80, 2048, 5505536, 5505792, 7340032, 58281984, 114688, 7, 181411840, 32768, 218103984, 7, 218106496, 1
    .long 0, 0, 0, 0, 0, 0, 0, 0, 0, 0, 0, 0, 0, 0, 0, 0
    .long 0, 0, 0, 0, 0, 0, 0, 0, 0, 0, 0, 0, 0, 0, 0, 0
    .long 0, 0, 0, 0, 0, 0, 0, 0, 0, 0, 0, 0, 0, 0, 0, 0
    .long 0, 0, 0, 0, 0, 0, 0, 0, 0, 0, 0, 0, 0, 0, 0, 0
    .long 1, 32, 32, 8192, 1024, 1280, 8388608, 524288, 32768, 8, 39862272, 131072, 0, 0, 218104592, 4
    .long 1, 16, 16, 8192, 1024, 1280, 8388608, 1048576, 32768, 8, 8404992, 131072, 0, 0, 218104848, 4
    .long 1, 24, 24, 8192, 1024, 1280, 8388608, 2621440, 32768, 8, 31473664, 131072, 0, 0, 218105616, 4
    .long 1, 16, 16, 8192, 1024, 1280, 8388608, 3145728, 32768, 8, 16793600, 131072, 0, 0, 218105872, 4
    .long 1, 16, 16, 8192, 1024, 1280, 8388608, 3670016, 32768, 8, 18890752, 131072, 0, 0, 218106128, 4
    .long 1, 80, 80, 2048, 1024, 1280, 7340032, 58195968, 114688, 7, 168837120, 32768, 218103936, 7, 218106496, 1
    .long 0, 0, 0, 0, 0, 0, 0, 0, 0, 0, 0, 0, 0, 0, 0, 0
    .long 0, 0, 0, 0, 0, 0, 0, 0, 0, 0, 0, 0, 0, 0, 0, 0
    .long 0, 0, 0, 0, 0, 0, 0, 0, 0, 0, 0, 0, 0, 0, 0, 0
    .long 0, 0, 0, 0, 0, 0, 0, 0, 0, 0, 0, 0, 0, 0, 0, 0
    .long 1, 32, 32, 8192, 3072, 3328, 8388608, 524288, 32768, 8, 39895040, 131072, 0, 0, 218104624, 4
    .long 1, 16, 16, 8192, 3072, 3328, 8388608, 1048576, 32768, 8, 8437760, 131072, 0, 0, 218104880, 4
    .long 1, 24, 24, 8192, 3072, 3328, 8388608, 2621440, 32768, 8, 31506432, 131072, 0, 0, 218105648, 4
    .long 1, 16, 16, 8192, 3072, 3328, 8388608, 3145728, 32768, 8, 16826368, 131072, 0, 0, 218105904, 4
    .long 1, 16, 16, 8192, 3072, 3328, 8388608, 3670016, 32768, 8, 18923520, 131072, 0, 0, 218106160, 4
    .long 1, 80, 80, 2048, 1836032, 1836288, 7340032, 58224640, 114688, 7, 173031424, 32768, 218103952, 7, 218106496, 1
    .long 0, 0, 0, 0, 0, 0, 0, 0, 0, 0, 0, 0, 0, 0, 0, 0
    .long 0, 0, 0, 0, 0, 0, 0, 0, 0, 0, 0, 0, 0, 0, 0, 0
    .long 0, 0, 0, 0, 0, 0, 0, 0, 0, 0, 0, 0, 0, 0, 0, 0
    .long 0, 0, 0, 0, 0, 0, 0, 0, 0, 0, 0, 0, 0, 0, 0, 0
    .long 1, 32, 32, 8192, 5120, 5376, 8388608, 524288, 32768, 8, 39927808, 131072, 0, 0, 218104656, 4
    .long 1, 16, 16, 8192, 5120, 5376, 8388608, 1048576, 32768, 8, 8470528, 131072, 0, 0, 218104912, 4
    .long 1, 24, 24, 8192, 5120, 5376, 8388608, 2621440, 32768, 8, 31539200, 131072, 0, 0, 218105680, 4
    .long 1, 16, 16, 8192, 5120, 5376, 8388608, 3145728, 32768, 8, 16859136, 131072, 0, 0, 218105936, 4
    .long 1, 16, 16, 8192, 5120, 5376, 8388608, 3670016, 32768, 8, 18956288, 131072, 0, 0, 218106192, 4
    .long 1, 80, 80, 2048, 3671040, 3671296, 7340032, 58253312, 114688, 7, 177225728, 32768, 218103968, 7, 218106496, 1
    .long 0, 0, 0, 0, 0, 0, 0, 0, 0, 0, 0, 0, 0, 0, 0, 0
    .long 0, 0, 0, 0, 0, 0, 0, 0, 0, 0, 0, 0, 0, 0, 0, 0
    .long 0, 0, 0, 0, 0, 0, 0, 0, 0, 0, 0, 0, 0, 0, 0, 0
    .long 0, 0, 0, 0, 0, 0, 0, 0, 0, 0, 0, 0, 0, 0, 0, 0
    .long 1, 32, 32, 8192, 7168, 7424, 8388608, 524288, 32768, 8, 39960576, 131072, 0, 0, 218104688, 4
    .long 1, 16, 16, 8192, 7168, 7424, 8388608, 1048576, 32768, 8, 8503296, 131072, 0, 0, 218104944, 4
    .long 1, 24, 24, 8192, 7168, 7424, 8388608, 2621440, 32768, 8, 31571968, 131072, 0, 0, 218105712, 4
    .long 1, 16, 16, 8192, 7168, 7424, 8388608, 3145728, 32768, 8, 16891904, 131072, 0, 0, 218105968, 4
    .long 1, 16, 16, 8192, 7168, 7424, 8388608, 3670016, 32768, 8, 18989056, 131072, 0, 0, 218106224, 4
    .long 1, 80, 80, 2048, 5506048, 5506304, 7340032, 58281984, 114688, 7, 181420032, 32768, 218103984, 7, 218106496, 1
    .long 0, 0, 0, 0, 0, 0, 0, 0, 0, 0, 0, 0, 0, 0, 0, 0
    .long 0, 0, 0, 0, 0, 0, 0, 0, 0, 0, 0, 0, 0, 0, 0, 0
    .long 0, 0, 0, 0, 0, 0, 0, 0, 0, 0, 0, 0, 0, 0, 0, 0
    .long 0, 0, 0, 0, 0, 0, 0, 0, 0, 0, 0, 0, 0, 0, 0, 0
    .long 1, 32, 32, 8192, 1536, 1792, 8388608, 524288, 32768, 8, 39870464, 131072, 0, 0, 218104592, 4
    .long 1, 16, 16, 8192, 1536, 1792, 8388608, 1048576, 32768, 8, 8413184, 131072, 0, 0, 218104848, 4
    .long 1, 24, 24, 8192, 1536, 1792, 8388608, 2621440, 32768, 8, 31481856, 131072, 0, 0, 218105616, 4
    .long 1, 16, 16, 8192, 1536, 1792, 8388608, 3145728, 32768, 8, 16801792, 131072, 0, 0, 218105872, 4
    .long 1, 16, 16, 8192, 1536, 1792, 8388608, 3670016, 32768, 8, 18898944, 131072, 0, 0, 218106128, 4
    .long 1, 80, 80, 2048, 1536, 1792, 7340032, 58195968, 114688, 7, 168845312, 32768, 218103936, 7, 218106496, 1
    .long 0, 0, 0, 0, 0, 0, 0, 0, 0, 0, 0, 0, 0, 0, 0, 0
    .long 0, 0, 0, 0, 0, 0, 0, 0, 0, 0, 0, 0, 0, 0, 0, 0
    .long 0, 0, 0, 0, 0, 0, 0, 0, 0, 0, 0, 0, 0, 0, 0, 0
    .long 0, 0, 0, 0, 0, 0, 0, 0, 0, 0, 0, 0, 0, 0, 0, 0
    .long 1, 32, 32, 8192, 3584, 3840, 8388608, 524288, 32768, 8, 39903232, 131072, 0, 0, 218104624, 4
    .long 1, 16, 16, 8192, 3584, 3840, 8388608, 1048576, 32768, 8, 8445952, 131072, 0, 0, 218104880, 4
    .long 1, 24, 24, 8192, 3584, 3840, 8388608, 2621440, 32768, 8, 31514624, 131072, 0, 0, 218105648, 4
    .long 1, 16, 16, 8192, 3584, 3840, 8388608, 3145728, 32768, 8, 16834560, 131072, 0, 0, 218105904, 4
    .long 1, 16, 16, 8192, 3584, 3840, 8388608, 3670016, 32768, 8, 18931712, 131072, 0, 0, 218106160, 4
    .long 1, 80, 80, 2048, 1836544, 1836800, 7340032, 58224640, 114688, 7, 173039616, 32768, 218103952, 7, 218106496, 1
    .long 0, 0, 0, 0, 0, 0, 0, 0, 0, 0, 0, 0, 0, 0, 0, 0
    .long 0, 0, 0, 0, 0, 0, 0, 0, 0, 0, 0, 0, 0, 0, 0, 0
    .long 0, 0, 0, 0, 0, 0, 0, 0, 0, 0, 0, 0, 0, 0, 0, 0
    .long 0, 0, 0, 0, 0, 0, 0, 0, 0, 0, 0, 0, 0, 0, 0, 0
    .long 1, 32, 32, 8192, 5632, 5888, 8388608, 524288, 32768, 8, 39936000, 131072, 0, 0, 218104656, 4
    .long 1, 16, 16, 8192, 5632, 5888, 8388608, 1048576, 32768, 8, 8478720, 131072, 0, 0, 218104912, 4
    .long 1, 24, 24, 8192, 5632, 5888, 8388608, 2621440, 32768, 8, 31547392, 131072, 0, 0, 218105680, 4
    .long 1, 16, 16, 8192, 5632, 5888, 8388608, 3145728, 32768, 8, 16867328, 131072, 0, 0, 218105936, 4
    .long 1, 16, 16, 8192, 5632, 5888, 8388608, 3670016, 32768, 8, 18964480, 131072, 0, 0, 218106192, 4
    .long 1, 80, 80, 2048, 3671552, 3671808, 7340032, 58253312, 114688, 7, 177233920, 32768, 218103968, 7, 218106496, 1
    .long 0, 0, 0, 0, 0, 0, 0, 0, 0, 0, 0, 0, 0, 0, 0, 0
    .long 0, 0, 0, 0, 0, 0, 0, 0, 0, 0, 0, 0, 0, 0, 0, 0
    .long 0, 0, 0, 0, 0, 0, 0, 0, 0, 0, 0, 0, 0, 0, 0, 0
    .long 0, 0, 0, 0, 0, 0, 0, 0, 0, 0, 0, 0, 0, 0, 0, 0
    .long 1, 32, 32, 8192, 7680, 7936, 8388608, 524288, 32768, 8, 39968768, 131072, 0, 0, 218104688, 4
    .long 1, 16, 16, 8192, 7680, 7936, 8388608, 1048576, 32768, 8, 8511488, 131072, 0, 0, 218104944, 4
    .long 1, 24, 24, 8192, 7680, 7936, 8388608, 2621440, 32768, 8, 31580160, 131072, 0, 0, 218105712, 4
    .long 1, 16, 16, 8192, 7680, 7936, 8388608, 3145728, 32768, 8, 16900096, 131072, 0, 0, 218105968, 4
    .long 1, 16, 16, 8192, 7680, 7936, 8388608, 3670016, 32768, 8, 18997248, 131072, 0, 0, 218106224, 4
    .long 1, 80, 80, 2048, 5506560, 5506816, 7340032, 58281984, 114688, 7, 181428224, 32768, 218103984, 7, 218106496, 1
    .long 0, 0, 0, 0, 0, 0, 0, 0, 0, 0, 0, 0, 0, 0, 0, 0
    .long 0, 0, 0, 0, 0, 0, 0, 0, 0, 0, 0, 0, 0, 0, 0, 0
    .long 0, 0, 0, 0, 0, 0, 0, 0, 0, 0, 0, 0, 0, 0, 0, 0
    .long 0, 0, 0, 0, 0, 0, 0, 0, 0, 0, 0, 0, 0, 0, 0, 0
    .long 1, 24, 24, 8192, 0, 256, 8388608, 524288, 32768, 8, 23068672, 131072, 0, 0, 218104576, 4
    .long 1, 32, 32, 8192, 0, 256, 8388608, 1572864, 32768, 8, 44040192, 131072, 0, 0, 218105088, 4
    .long 1, 16, 16, 8192, 0, 256, 8388608, 2621440, 32768, 8, 14680064, 131072, 0, 0, 218105600, 4
    .long 2, 64, 72, 7168, 2048, 2048, 7340032, 1048576, 32768, 8, 58228736, 114688, 0, 0, 218103952, 1
    .long 2, 64, 72, 7168, 1024, 1024, 7340032, 2621440, 32768, 8, 63717376, 114688, 0, 0, 218104128, 1
    .long 1, 80, 80, 2048, 0, 256, 7340032, 60030976, 114688, 7, 169345024, 32768, 218104000, 7, 218106560, 1
    .long 0, 0, 0, 0, 0, 0, 0, 0, 0, 0, 0, 0, 0, 0, 0, 0
    .long 0, 0, 0, 0, 0, 0, 0, 0, 0, 0, 0, 0, 0, 0, 0, 0
    .long 0, 0, 0, 0, 0, 0, 0, 0, 0, 0, 0, 0, 0, 0, 0, 0
    .long 0, 0, 0, 0, 0, 0, 0, 0, 0, 0, 0, 0, 0, 0, 0, 0
    .long 1, 24, 24, 8192, 2048, 2304, 8388608, 524288, 32768, 8, 23101440, 131072, 0, 0, 218104608, 4
    .long 1, 32, 32, 8192, 2048, 2304, 8388608, 1572864, 32768, 8, 44072960, 131072, 0, 0, 218105120, 4
    .long 1, 16, 16, 8192, 2048, 2304, 8388608, 2621440, 32768, 8, 14712832, 131072, 0, 0, 218105632, 4
    .long 2, 64, 72, 7168, 2304, 2304, 7340032, 1048576, 32768, 8, 58232832, 114688, 0, 0, 218103952, 1
    .long 2, 64, 72, 7168, 1280, 1280, 7340032, 2621440, 32768, 8, 63721472, 114688, 0, 0, 218104128, 1
    .long 1, 80, 80, 2048, 1835008, 1835264, 7340032, 60059648, 114688, 7, 173539328, 32768, 218104016, 7, 218106560, 1
    .long 0, 0, 0, 0, 0, 0, 0, 0, 0, 0, 0, 0, 0, 0, 0, 0
    .long 0, 0, 0, 0, 0, 0, 0, 0, 0, 0, 0, 0, 0, 0, 0, 0
    .long 0, 0, 0, 0, 0, 0, 0, 0, 0, 0, 0, 0, 0, 0, 0, 0
    .long 0, 0, 0, 0, 0, 0, 0, 0, 0, 0, 0, 0, 0, 0, 0, 0
    .long 1, 24, 24, 8192, 4096, 4352, 8388608, 524288, 32768, 8, 23134208, 131072, 0, 0, 218104640, 4
    .long 1, 32, 32, 8192, 4096, 4352, 8388608, 1572864, 32768, 8, 44105728, 131072, 0, 0, 218105152, 4
    .long 1, 16, 16, 8192, 4096, 4352, 8388608, 2621440, 32768, 8, 14745600, 131072, 0, 0, 218105664, 4
    .long 2, 64, 72, 7168, 2560, 2560, 7340032, 1048576, 32768, 8, 58236928, 114688, 0, 0, 218103952, 1
    .long 2, 64, 72, 7168, 1536, 1536, 7340032, 2621440, 32768, 8, 63725568, 114688, 0, 0, 218104128, 1
    .long 1, 80, 80, 2048, 3670016, 3670272, 7340032, 60088320, 114688, 7, 177733632, 32768, 218104032, 7, 218106560, 1
    .long 0, 0, 0, 0, 0, 0, 0, 0, 0, 0, 0, 0, 0, 0, 0, 0
    .long 0, 0, 0, 0, 0, 0, 0, 0, 0, 0, 0, 0, 0, 0, 0, 0
    .long 0, 0, 0, 0, 0, 0, 0, 0, 0, 0, 0, 0, 0, 0, 0, 0
    .long 0, 0, 0, 0, 0, 0, 0, 0, 0, 0, 0, 0, 0, 0, 0, 0
    .long 1, 24, 24, 8192, 6144, 6400, 8388608, 524288, 32768, 8, 23166976, 131072, 0, 0, 218104672, 4
    .long 1, 32, 32, 8192, 6144, 6400, 8388608, 1572864, 32768, 8, 44138496, 131072, 0, 0, 218105184, 4
    .long 1, 16, 16, 8192, 6144, 6400, 8388608, 2621440, 32768, 8, 14778368, 131072, 0, 0, 218105696, 4
    .long 2, 64, 72, 7168, 2816, 2816, 7340032, 1048576, 32768, 8, 58241024, 114688, 0, 0, 218103952, 1
    .long 2, 64, 72, 7168, 1792, 1792, 7340032, 2621440, 32768, 8, 63729664, 114688, 0, 0, 218104144, 1
    .long 1, 80, 80, 2048, 5505024, 5505280, 7340032, 60116992, 114688, 7, 181927936, 32768, 218104048, 7, 218106560, 1
    .long 0, 0, 0, 0, 0, 0, 0, 0, 0, 0, 0, 0, 0, 0, 0, 0
    .long 0, 0, 0, 0, 0, 0, 0, 0, 0, 0, 0, 0, 0, 0, 0, 0
    .long 0, 0, 0, 0, 0, 0, 0, 0, 0, 0, 0, 0, 0, 0, 0, 0
    .long 0, 0, 0, 0, 0, 0, 0, 0, 0, 0, 0, 0, 0, 0, 0, 0
    .long 1, 24, 24, 8192, 512, 768, 8388608, 524288, 32768, 8, 23076864, 131072, 0, 0, 218104576, 4
    .long 1, 32, 32, 8192, 512, 768, 8388608, 1572864, 32768, 8, 44048384, 131072, 0, 0, 218105088, 4
    .long 1, 16, 16, 8192, 512, 768, 8388608, 2621440, 32768, 8, 14688256, 131072, 0, 0, 218105600, 4
    .long 2, 64, 72, 7168, 3072, 3072, 7340032, 1048576, 32768, 8, 58245120, 114688, 0, 0, 218103952, 1
    .long 2, 64, 72, 7168, 2048, 2048, 7340032, 2621440, 32768, 8, 63733760, 114688, 0, 0, 218104144, 1
    .long 1, 80, 80, 2048, 512, 768, 7340032, 60030976, 114688, 7, 169353216, 32768, 218104000, 7, 218106560, 1
    .long 0, 0, 0, 0, 0, 0, 0, 0, 0, 0, 0, 0, 0, 0, 0, 0
    .long 0, 0, 0, 0, 0, 0, 0, 0, 0, 0, 0, 0, 0, 0, 0, 0
    .long 0, 0, 0, 0, 0, 0, 0, 0, 0, 0, 0, 0, 0, 0, 0, 0
    .long 0, 0, 0, 0, 0, 0, 0, 0, 0, 0, 0, 0, 0, 0, 0, 0
    .long 1, 24, 24, 8192, 2560, 2816, 8388608, 524288, 32768, 8, 23109632, 131072, 0, 0, 218104608, 4
    .long 1, 32, 32, 8192, 2560, 2816, 8388608, 1572864, 32768, 8, 44081152, 131072, 0, 0, 218105120, 4
    .long 1, 16, 16, 8192, 2560, 2816, 8388608, 2621440, 32768, 8, 14721024, 131072, 0, 0, 218105632, 4
    .long 2, 64, 72, 7168, 3328, 3328, 7340032, 1048576, 32768, 8, 58249216, 114688, 0, 0, 218103952, 1
    .long 2, 64, 72, 7168, 2304, 2304, 7340032, 2621440, 32768, 8, 63737856, 114688, 0, 0, 218104144, 1
    .long 1, 80, 80, 2048, 1835520, 1835776, 7340032, 60059648, 114688, 7, 173547520, 32768, 218104016, 7, 218106560, 1
    .long 0, 0, 0, 0, 0, 0, 0, 0, 0, 0, 0, 0, 0, 0, 0, 0
    .long 0, 0, 0, 0, 0, 0, 0, 0, 0, 0, 0, 0, 0, 0, 0, 0
    .long 0, 0, 0, 0, 0, 0, 0, 0, 0, 0, 0, 0, 0, 0, 0, 0
    .long 0, 0, 0, 0, 0, 0, 0, 0, 0, 0, 0, 0, 0, 0, 0, 0
    .long 1, 24, 24, 8192, 4608, 4864, 8388608, 524288, 32768, 8, 23142400, 131072, 0, 0, 218104640, 4
    .long 1, 32, 32, 8192, 4608, 4864, 8388608, 1572864, 32768, 8, 44113920, 131072, 0, 0, 218105152, 4
    .long 1, 16, 16, 8192, 4608, 4864, 8388608, 2621440, 32768, 8, 14753792, 131072, 0, 0, 218105664, 4
    .long 2, 64, 72, 7168, 3584, 3584, 7340032, 1048576, 32768, 8, 58253312, 114688, 0, 0, 218103968, 1
    .long 2, 64, 72, 7168, 2560, 2560, 7340032, 2621440, 32768, 8, 63741952, 114688, 0, 0, 218104144, 1
    .long 1, 80, 80, 2048, 3670528, 3670784, 7340032, 60088320, 114688, 7, 177741824, 32768, 218104032, 7, 218106560, 1
    .long 0, 0, 0, 0, 0, 0, 0, 0, 0, 0, 0, 0, 0, 0, 0, 0
    .long 0, 0, 0, 0, 0, 0, 0, 0, 0, 0, 0, 0, 0, 0, 0, 0
    .long 0, 0, 0, 0, 0, 0, 0, 0, 0, 0, 0, 0, 0, 0, 0, 0
    .long 0, 0, 0, 0, 0, 0, 0, 0, 0, 0, 0, 0, 0, 0, 0, 0
    .long 1, 24, 24, 8192, 6656, 6912, 8388608, 524288, 32768, 8, 23175168, 131072, 0, 0, 218104672, 4
    .long 1, 32, 32, 8192, 6656, 6912, 8388608, 1572864, 32768, 8, 44146688, 131072, 0, 0, 218105184, 4
    .long 1, 16, 16, 8192, 6656, 6912, 8388608, 2621440, 32768, 8, 14786560, 131072, 0, 0, 218105696, 4
    .long 2, 64, 72, 7168, 3840, 3840, 7340032, 1048576, 32768, 8, 58257408, 114688, 0, 0, 218103968, 1
    .long 2, 64, 72, 7168, 2816, 2816, 7340032, 2621440, 32768, 8, 63746048, 114688, 0, 0, 218104144, 1
    .long 1, 80, 80, 2048, 5505536, 5505792, 7340032, 60116992, 114688, 7, 181936128, 32768, 218104048, 7, 218106560, 1
    .long 0, 0, 0, 0, 0, 0, 0, 0, 0, 0, 0, 0, 0, 0, 0, 0
    .long 0, 0, 0, 0, 0, 0, 0, 0, 0, 0, 0, 0, 0, 0, 0, 0
    .long 0, 0, 0, 0, 0, 0, 0, 0, 0, 0, 0, 0, 0, 0, 0, 0
    .long 0, 0, 0, 0, 0, 0, 0, 0, 0, 0, 0, 0, 0, 0, 0, 0
    .long 1, 24, 24, 8192, 1024, 1280, 8388608, 524288, 32768, 8, 23085056, 131072, 0, 0, 218104592, 4
    .long 1, 32, 32, 8192, 1024, 1280, 8388608, 1572864, 32768, 8, 44056576, 131072, 0, 0, 218105104, 4
    .long 1, 16, 16, 8192, 1024, 1280, 8388608, 2621440, 32768, 8, 14696448, 131072, 0, 0, 218105616, 4
    .long 2, 64, 72, 7168, 4096, 4096, 7340032, 1048576, 32768, 8, 58261504, 114688, 0, 0, 218103968, 1
    .long 2, 64, 72, 7168, 3072, 3072, 7340032, 2621440, 32768, 8, 63750144, 114688, 0, 0, 218104144, 1
    .long 1, 80, 80, 2048, 1024, 1280, 7340032, 60030976, 114688, 7, 169361408, 32768, 218104000, 7, 218106560, 1
    .long 0, 0, 0, 0, 0, 0, 0, 0, 0, 0, 0, 0, 0, 0, 0, 0
    .long 0, 0, 0, 0, 0, 0, 0, 0, 0, 0, 0, 0, 0, 0, 0, 0
    .long 0, 0, 0, 0, 0, 0, 0, 0, 0, 0, 0, 0, 0, 0, 0, 0
    .long 0, 0, 0, 0, 0, 0, 0, 0, 0, 0, 0, 0, 0, 0, 0, 0
    .long 1, 24, 24, 8192, 3072, 3328, 8388608, 524288, 32768, 8, 23117824, 131072, 0, 0, 218104624, 4
    .long 1, 32, 32, 8192, 3072, 3328, 8388608, 1572864, 32768, 8, 44089344, 131072, 0, 0, 218105136, 4
    .long 1, 16, 16, 8192, 3072, 3328, 8388608, 2621440, 32768, 8, 14729216, 131072, 0, 0, 218105648, 4
    .long 2, 64, 72, 7168, 4352, 4352, 7340032, 1048576, 32768, 8, 58265600, 114688, 0, 0, 218103968, 1
    .long 2, 64, 72, 7168, 3328, 3328, 7340032, 2621440, 32768, 8, 63754240, 114688, 0, 0, 218104144, 1
    .long 1, 80, 80, 2048, 1836032, 1836288, 7340032, 60059648, 114688, 7, 173555712, 32768, 218104016, 7, 218106560, 1
    .long 0, 0, 0, 0, 0, 0, 0, 0, 0, 0, 0, 0, 0, 0, 0, 0
    .long 0, 0, 0, 0, 0, 0, 0, 0, 0, 0, 0, 0, 0, 0, 0, 0
    .long 0, 0, 0, 0, 0, 0, 0, 0, 0, 0, 0, 0, 0, 0, 0, 0
    .long 0, 0, 0, 0, 0, 0, 0, 0, 0, 0, 0, 0, 0, 0, 0, 0
    .long 1, 24, 24, 8192, 5120, 5376, 8388608, 524288, 32768, 8, 23150592, 131072, 0, 0, 218104656, 4
    .long 1, 32, 32, 8192, 5120, 5376, 8388608, 1572864, 32768, 8, 44122112, 131072, 0, 0, 218105168, 4
    .long 1, 16, 16, 8192, 5120, 5376, 8388608, 2621440, 32768, 8, 14761984, 131072, 0, 0, 218105680, 4
    .long 2, 64, 72, 7168, 4608, 4608, 7340032, 1048576, 32768, 8, 58269696, 114688, 0, 0, 218103968, 1
    .long 2, 64, 72, 7168, 3584, 3584, 7340032, 2621440, 32768, 8, 63758336, 114688, 0, 0, 218104160, 1
    .long 1, 80, 80, 2048, 3671040, 3671296, 7340032, 60088320, 114688, 7, 177750016, 32768, 218104032, 7, 218106560, 1
    .long 0, 0, 0, 0, 0, 0, 0, 0, 0, 0, 0, 0, 0, 0, 0, 0
    .long 0, 0, 0, 0, 0, 0, 0, 0, 0, 0, 0, 0, 0, 0, 0, 0
    .long 0, 0, 0, 0, 0, 0, 0, 0, 0, 0, 0, 0, 0, 0, 0, 0
    .long 0, 0, 0, 0, 0, 0, 0, 0, 0, 0, 0, 0, 0, 0, 0, 0
    .long 1, 24, 24, 8192, 7168, 7424, 8388608, 524288, 32768, 8, 23183360, 131072, 0, 0, 218104688, 4
    .long 1, 32, 32, 8192, 7168, 7424, 8388608, 1572864, 32768, 8, 44154880, 131072, 0, 0, 218105200, 4
    .long 1, 16, 16, 8192, 7168, 7424, 8388608, 2621440, 32768, 8, 14794752, 131072, 0, 0, 218105712, 4
    .long 2, 64, 72, 7168, 4864, 4864, 7340032, 1048576, 32768, 8, 58273792, 114688, 0, 0, 218103968, 1
    .long 2, 64, 72, 7168, 3840, 3840, 7340032, 2621440, 32768, 8, 63762432, 114688, 0, 0, 218104160, 1
    .long 1, 80, 80, 2048, 5506048, 5506304, 7340032, 60116992, 114688, 7, 181944320, 32768, 218104048, 7, 218106560, 1
    .long 0, 0, 0, 0, 0, 0, 0, 0, 0, 0, 0, 0, 0, 0, 0, 0
    .long 0, 0, 0, 0, 0, 0, 0, 0, 0, 0, 0, 0, 0, 0, 0, 0
    .long 0, 0, 0, 0, 0, 0, 0, 0, 0, 0, 0, 0, 0, 0, 0, 0
    .long 0, 0, 0, 0, 0, 0, 0, 0, 0, 0, 0, 0, 0, 0, 0, 0
    .long 1, 24, 24, 8192, 1536, 1792, 8388608, 524288, 32768, 8, 23093248, 131072, 0, 0, 218104592, 4
    .long 1, 32, 32, 8192, 1536, 1792, 8388608, 1572864, 32768, 8, 44064768, 131072, 0, 0, 218105104, 4
    .long 1, 16, 16, 8192, 1536, 1792, 8388608, 2621440, 32768, 8, 14704640, 131072, 0, 0, 218105616, 4
    .long 2, 64, 72, 7168, 5120, 5120, 7340032, 1048576, 32768, 8, 58277888, 114688, 0, 0, 218103968, 1
    .long 2, 64, 72, 7168, 4096, 4096, 7340032, 2621440, 32768, 8, 63766528, 114688, 0, 0, 218104160, 1
    .long 1, 80, 80, 2048, 1536, 1792, 7340032, 60030976, 114688, 7, 169369600, 32768, 218104000, 7, 218106560, 1
    .long 0, 0, 0, 0, 0, 0, 0, 0, 0, 0, 0, 0, 0, 0, 0, 0
    .long 0, 0, 0, 0, 0, 0, 0, 0, 0, 0, 0, 0, 0, 0, 0, 0
    .long 0, 0, 0, 0, 0, 0, 0, 0, 0, 0, 0, 0, 0, 0, 0, 0
    .long 0, 0, 0, 0, 0, 0, 0, 0, 0, 0, 0, 0, 0, 0, 0, 0
    .long 1, 24, 24, 8192, 3584, 3840, 8388608, 524288, 32768, 8, 23126016, 131072, 0, 0, 218104624, 4
    .long 1, 32, 32, 8192, 3584, 3840, 8388608, 1572864, 32768, 8, 44097536, 131072, 0, 0, 218105136, 4
    .long 1, 16, 16, 8192, 3584, 3840, 8388608, 2621440, 32768, 8, 14737408, 131072, 0, 0, 218105648, 4
    .long 2, 64, 72, 7168, 5376, 5376, 7340032, 1048576, 32768, 8, 58281984, 114688, 0, 0, 218103984, 1
    .long 2, 64, 72, 7168, 4352, 4352, 7340032, 2621440, 32768, 8, 63770624, 114688, 0, 0, 218104160, 1
    .long 1, 80, 80, 2048, 1836544, 1836800, 7340032, 60059648, 114688, 7, 173563904, 32768, 218104016, 7, 218106560, 1
    .long 0, 0, 0, 0, 0, 0, 0, 0, 0, 0, 0, 0, 0, 0, 0, 0
    .long 0, 0, 0, 0, 0, 0, 0, 0, 0, 0, 0, 0, 0, 0, 0, 0
    .long 0, 0, 0, 0, 0, 0, 0, 0, 0, 0, 0, 0, 0, 0, 0, 0
    .long 0, 0, 0, 0, 0, 0, 0, 0, 0, 0, 0, 0, 0, 0, 0, 0
    .long 1, 24, 24, 8192, 5632, 5888, 8388608, 524288, 32768, 8, 23158784, 131072, 0, 0, 218104656, 4
    .long 1, 32, 32, 8192, 5632, 5888, 8388608, 1572864, 32768, 8, 44130304, 131072, 0, 0, 218105168, 4
    .long 1, 16, 16, 8192, 5632, 5888, 8388608, 2621440, 32768, 8, 14770176, 131072, 0, 0, 218105680, 4
    .long 2, 64, 72, 7168, 5632, 5632, 7340032, 1048576, 32768, 8, 58286080, 114688, 0, 0, 218103984, 1
    .long 2, 64, 72, 7168, 4608, 4608, 7340032, 2621440, 32768, 8, 63774720, 114688, 0, 0, 218104160, 1
    .long 1, 80, 80, 2048, 3671552, 3671808, 7340032, 60088320, 114688, 7, 177758208, 32768, 218104032, 7, 218106560, 1
    .long 0, 0, 0, 0, 0, 0, 0, 0, 0, 0, 0, 0, 0, 0, 0, 0
    .long 0, 0, 0, 0, 0, 0, 0, 0, 0, 0, 0, 0, 0, 0, 0, 0
    .long 0, 0, 0, 0, 0, 0, 0, 0, 0, 0, 0, 0, 0, 0, 0, 0
    .long 0, 0, 0, 0, 0, 0, 0, 0, 0, 0, 0, 0, 0, 0, 0, 0
    .long 1, 24, 24, 8192, 7680, 7936, 8388608, 524288, 32768, 8, 23191552, 131072, 0, 0, 218104688, 4
    .long 1, 32, 32, 8192, 7680, 7936, 8388608, 1572864, 32768, 8, 44163072, 131072, 0, 0, 218105200, 4
    .long 1, 16, 16, 8192, 7680, 7936, 8388608, 2621440, 32768, 8, 14802944, 131072, 0, 0, 218105712, 4
    .long 2, 64, 72, 7168, 5888, 5888, 7340032, 1048576, 32768, 8, 58290176, 114688, 0, 0, 218103984, 1
    .long 2, 64, 72, 7168, 4864, 4864, 7340032, 2621440, 32768, 8, 63778816, 114688, 0, 0, 218104160, 1
    .long 1, 80, 80, 2048, 5506560, 5506816, 7340032, 60116992, 114688, 7, 181952512, 32768, 218104048, 7, 218106560, 1
    .long 0, 0, 0, 0, 0, 0, 0, 0, 0, 0, 0, 0, 0, 0, 0, 0
    .long 0, 0, 0, 0, 0, 0, 0, 0, 0, 0, 0, 0, 0, 0, 0, 0
    .long 0, 0, 0, 0, 0, 0, 0, 0, 0, 0, 0, 0, 0, 0, 0, 0
    .long 0, 0, 0, 0, 0, 0, 0, 0, 0, 0, 0, 0, 0, 0, 0, 0
.p2align 6
.amdhsa_kernel recurrent_scan__memory_aug_recurrent_mem_tr__glu_gated_glu__prompt_kernel
  .amdhsa_next_free_vgpr 256
  .amdhsa_next_free_sgpr 102
  .amdhsa_accum_offset 256
  .amdhsa_group_segment_fixed_size 0
  .amdhsa_kernarg_size 112
  .amdhsa_user_sgpr_count 2
  .amdhsa_user_sgpr_kernarg_segment_ptr 1
  .amdhsa_system_sgpr_workgroup_id_x 1
  .amdhsa_float_denorm_mode_32 3
.end_amdhsa_kernel
```

```asm
; @launch grid=(256,1,1) block=(512,1,1) lds=163840
.amdgcn_target "amdgcn-amd-amdhsa--gfx950"
.text
.globl recurrent_scan__memory_aug_recurrent_mem_tr__glu_gated_glu__prompt_kernel
.p2align 8
.type recurrent_scan__memory_aug_recurrent_mem_tr__glu_gated_glu__prompt_kernel,@function
recurrent_scan__memory_aug_recurrent_mem_tr__glu_gated_glu__prompt_kernel:
    s_cmp_ge_u32 s2, 256
    s_cbranch_scc1 k_exit
    s_mov_b32 s99, s2
    s_load_dwordx2 s[4:5], s[0:1], 104
    s_load_dwordx2 s[64:65], s[0:1], 96
    v_lshrrev_b32 v2, 6, v0
    s_mov_b32 s6, 268435456
    s_mov_b32 s7, 131072
    s_mov_b32 s66, 256
    s_mov_b32 s67, 131072
    v_readfirstlane_b32 s3, v2
    s_lshr_b32 s12, s2, 3
    s_and_b32 s13, s2, 3
    s_waitcnt lgkmcnt(0)
    s_bitcmp0_b32 s2, 2
    s_cbranch_scc1 chain_map
    s_lshl_b32 s63, s12, 2
    s_add_u32 s63, s63, s13
    s_mov_b32 s29, s63
    v_and_b32 v20, 63, v0
    v_lshlrev_b32 v1, 4, v20
    v_add_u32 v19, 0x1000, v1
    v_lshrrev_b32 v4, 4, v20
    v_mov_b32 v17, 0
    v_mov_b32 v18, 1
    s_lshr_b32 s26, s3, 2
    s_and_b32 s27, s3, 3
    s_lshl_b32 s21, s3, 11
    s_lshl_b32 s22, s3, 10
    s_add_u32 s22, s22, 16384
    s_mov_b32 s11, 131072
    s_mov_b32 s15, 131072
    s_mov_b32 s28, 0
    v_and_b32 v21, 15, v20
    v_lshlrev_b32 v22, 2, v4
    v_xor_b32 v21, v21, v22
    s_lshr_b32 s30, s3, 1
    s_and_b32 s30, s30, 1
    v_xor_b32 v21, s30, v21
    v_lshlrev_b32 v3, 4, v21
    s_lshl_b32 s30, s26, 13
    v_add_u32 v5, s30, v1
    v_add_u32 v6, 0x10000, v5
    v_bfe_u32 v21, v20, 2, 2
    v_and_b32 v22, 3, v20
    v_and_b32 v23, 1, v4
    v_xor_b32 v24, s27, v21
    v_xor_b32 v25, v22, v23
    v_lshl_add_u32 v24, v24, 2, v25
    v_lshlrev_b32 v24, 4, v24
    v_lshl_add_u32 v25, v4, 3, v21
    v_lshl_add_u32 v24, v25, 8, v24
    v_and_b32 v22, 1, v22
    v_xor_b32 v25, 0, v23
    v_lshl_add_u32 v8, v25, 10, v24
    v_xor_b32 v25, 0, v22
    v_lshl_add_u32 v8, v25, 3, v8
    v_add_u32 v12, 0x10000, v8
    v_xor_b32 v25, 1, v23
    v_lshl_add_u32 v9, v25, 10, v24
    v_xor_b32 v25, 0, v22
    v_lshl_add_u32 v9, v25, 3, v9
    v_add_u32 v13, 0x10000, v9
    v_xor_b32 v25, 0, v23
    v_lshl_add_u32 v10, v25, 10, v24
    v_xor_b32 v25, 1, v22
    v_lshl_add_u32 v10, v25, 3, v10
    v_add_u32 v14, 0x10000, v10
    v_xor_b32 v25, 1, v23
    v_lshl_add_u32 v11, v25, 10, v24
    v_xor_b32 v25, 1, v22
    v_lshl_add_u32 v11, v25, 3, v11
    v_add_u32 v15, 0x10000, v11
    s_lshl_b32 s30, s3, 2
    s_add_u32 s30, s30, 131072
    v_mov_b32 v7, s30
    s_getpc_b64 s[24:25]
    s_add_u32 s24, s24, jobtab@rel32@lo+4
    s_addc_u32 s25, s25, jobtab@rel32@hi+12
    s_mul_i32 s30, s29, 640
    s_add_u32 s24, s24, s30
    s_addc_u32 s25, s25, 0
    s_load_dwordx16 s[32:47], s[24:25], 0
    s_add_u32 s24, s24, 64
    s_addc_u32 s25, s25, 0
    s_waitcnt lgkmcnt(0)
    s_mov_b32 s8, s4
    s_mov_b32 s9, s5
    s_mov_b32 s10, 0
    s_mov_b32 s12, s4
    s_mov_b32 s13, s5
    s_mov_b32 s14, 0
    s_load_dwordx2 s[88:89], s[0:1], 0
    s_mov_b32 s90, 4194304
    s_mov_b32 s91, 131072
    s_mov_b32 s98, 0
    v_mov_b32 v22, 0
    s_mov_b32 s70, 1
    v_and_b32 v245, 15, v0
    v_lshlrev_b32 v246, 11, v245
    v_lshl_add_u32 v246, v4, 4, v246
    s_add_u32 s71, s63, 32
    s_and_b32 s71, s71, 127
    s_lshl_b32 s72, s71, 15
    s_lshl_b32 s73, s3, 8
    s_add_u32 s72, s72, s73
    s_waitcnt lgkmcnt(0)
    buffer_load_dwordx4 v[228:231], v246, s[88:91], s72 offen offset:0
    buffer_load_dwordx4 v[232:235], v246, s[88:91], s72 offen offset:64
    buffer_load_dwordx4 v[236:239], v246, s[88:91], s72 offen offset:128
    buffer_load_dwordx4 v[240:243], v246, s[88:91], s72 offen offset:192
    s_cmp_lg_u32 s32, 6
    s_cbranch_scc1 ln_nx
    s_mov_b32 s98, 3
    s_cmp_lg_u32 s32, 6
    s_cbranch_scc1 xs_1
    s_load_dwordx2 s[8:9], s[0:1], s33
    s_load_dwordx2 s[12:13], s[0:1], s34
    s_mov_b32 s10, s38
    s_mov_b32 s14, s38
    s_cmp_ge_u32 s32, 4
    s_cselect_b32 s31, 0, 1
    s_lshl_b32 s30, s3, s31
    s_mul_i32 s30, s30, s40
    s_add_u32 s16, s39, s30
    s_cmp_eq_u32 s32, 4
    s_cselect_b32 s30, 1024, s40
    s_cselect_b32 s31, 6, 5
    s_lshl_b32 s62, 32, s31
    s_add_u32 s17, s16, s30
    s_lshl_b32 s30, s3, 2
    s_mul_i32 s30, s30, s35
    s_add_u32 s18, s36, s30
    s_add_u32 s19, s37, s30
    s_lshl_b32 s20, s35, s31
    v_mul_u32_u24 v2, s35, v4
    v_add_u32 v2, v2, v3
    s_waitcnt lgkmcnt(0)
    s_lshl_b32 s16, s3, 15
    s_add_u32 s16, s16, s39
    s_add_u32 s92, s16, 2048
    s_lshl_b32 s93, s35, 10
    s_lshr_b32 s94, s63, 2
    s_mul_i32 s94, s94, 1
    s_and_b32 s94, s94, 15
    s_lshl_b32 s95, s94, 7
    s_add_u32 s16, s16, s95
    s_lshl_b32 s95, s35, 6
    s_mul_i32 s94, s95, s94
    s_add_u32 s95, s18, s93
    s_add_u32 s18, s18, s94
    s_add_u32 s19, s19, s94
    s_add_u32 s17, s16, 16384
    s_mov_b32 s62, 128
    s_lshl_b32 s20, s35, 6
    v_lshrrev_b32 v21, 7, v1
    v_bfe_u32 v23, v1, 4, 3
    v_xor_b32 v23, v21, v23
    v_lshlrev_b32 v23, 4, v23
    v_lshl_add_u32 v23, v21, 11, v23
    s_add_u32 m0, s21, 0
    s_nop 0
    buffer_load_dwordx4 v23, s[88:91], s16 offen lds
    s_add_u32 s16, s16, s62
    s_add_u32 m0, s21, 1024
    s_nop 0
    buffer_load_dwordx4 v23, s[88:91], s17 offen lds
    s_add_u32 s17, s17, s62
    s_cmp_ge_u32 s16, s92
    s_cselect_b32 s94, 2048, 0
    s_sub_u32 s16, s16, s94
    s_sub_u32 s17, s17, s94
    s_add_u32 m0, s22, 0
    s_nop 0
    buffer_load_dwordx4 v2, s[8:11], s18 offen lds
    s_add_u32 s18, s18, s20
    s_add_u32 m0, s22, 8192
    s_nop 0
    buffer_load_dwordx4 v2, s[12:15], s19 offen lds
    s_add_u32 s19, s19, s20
    s_cmp_ge_u32 s18, s95
    s_cselect_b32 s94, s93, 0
    s_sub_u32 s18, s18, s94
    s_sub_u32 s19, s19, s94
    s_add_u32 m0, s21, 32768
    s_nop 0
    buffer_load_dwordx4 v23, s[88:91], s16 offen lds
    s_add_u32 s16, s16, s62
    s_add_u32 m0, s21, 33792
    s_nop 0
    buffer_load_dwordx4 v23, s[88:91], s17 offen lds
    s_add_u32 s17, s17, s62
    s_cmp_ge_u32 s16, s92
    s_cselect_b32 s94, 2048, 0
    s_sub_u32 s16, s16, s94
    s_sub_u32 s17, s17, s94
    s_add_u32 m0, s22, 32768
    s_nop 0
    buffer_load_dwordx4 v2, s[8:11], s18 offen lds
    s_add_u32 s18, s18, s20
    s_add_u32 m0, s22, 40960
    s_nop 0
    buffer_load_dwordx4 v2, s[12:15], s19 offen lds
    s_add_u32 s19, s19, s20
    s_cmp_ge_u32 s18, s95
    s_cselect_b32 s94, s93, 0
    s_sub_u32 s18, s18, s94
    s_sub_u32 s19, s19, s94
    s_add_u32 m0, s21, 65536
    s_nop 0
    buffer_load_dwordx4 v23, s[88:91], s16 offen lds
    s_add_u32 s16, s16, s62
    s_add_u32 m0, s21, 66560
    s_nop 0
    buffer_load_dwordx4 v23, s[88:91], s17 offen lds
    s_add_u32 s17, s17, s62
    s_cmp_ge_u32 s16, s92
    s_cselect_b32 s94, 2048, 0
    s_sub_u32 s16, s16, s94
    s_sub_u32 s17, s17, s94
    s_add_u32 m0, s22, 65536
    s_nop 0
    buffer_load_dwordx4 v2, s[8:11], s18 offen lds
    s_add_u32 s18, s18, s20
    s_add_u32 m0, s22, 73728
    s_nop 0
    buffer_load_dwordx4 v2, s[12:15], s19 offen lds
    s_add_u32 s19, s19, s20
    s_cmp_ge_u32 s18, s95
    s_cselect_b32 s94, s93, 0
    s_sub_u32 s18, s18, s94
    s_sub_u32 s19, s19, s94
    s_add_u32 m0, s21, 98304
    s_nop 0
    buffer_load_dwordx4 v23, s[88:91], s16 offen lds
    s_add_u32 s16, s16, s62
    s_add_u32 m0, s21, 99328
    s_nop 0
    buffer_load_dwordx4 v23, s[88:91], s17 offen lds
    s_add_u32 s17, s17, s62
    s_cmp_ge_u32 s16, s92
    s_cselect_b32 s94, 2048, 0
    s_sub_u32 s16, s16, s94
    s_sub_u32 s17, s17, s94
    s_add_u32 m0, s22, 98304
    s_nop 0
    buffer_load_dwordx4 v2, s[8:11], s18 offen lds
    s_add_u32 s18, s18, s20
    s_add_u32 m0, s22, 106496
    s_nop 0
    buffer_load_dwordx4 v2, s[12:15], s19 offen lds
    s_add_u32 s19, s19, s20
    s_cmp_ge_u32 s18, s95
    s_cselect_b32 s94, s93, 0
    s_sub_u32 s18, s18, s94
    s_sub_u32 s19, s19, s94
    v_and_b32 v21, 1, v4
    v_lshlrev_b32 v21, 10, v21
    v_xor_b32 v8, v21, v8
    v_xor_b32 v9, v21, v9
    v_xor_b32 v10, v21, v10
    v_xor_b32 v11, v21, v11
    v_xor_b32 v12, v21, v12
    v_xor_b32 v13, v21, v13
    v_xor_b32 v14, v21, v14
    v_xor_b32 v15, v21, v15
xs_1:
    s_branch w_adopt
ln_nx:
    s_lshl_b32 s73, s71, 9
    s_add_u32 s73, s73, 218103808
    v_lshlrev_b32 v252, 2, v0
    s_cmp_ge_u32 s71, 32
    s_cbranch_scc1 ln_nz
    s_cmp_ge_u32 s3, 2
    s_cbranch_scc1 ln_nz
    buffer_store_dword v17, v252, s[4:7], s73 offen sc1
ln_nz:
    s_waitcnt vmcnt(0)
ln_entry:
    v_lshlrev_b32 v247, 5, v245
    v_add_u32 v247, 135168, v247
    s_lshl_b32 s74, s3, 2
    v_add_u32 v248, s74, v247
    s_lshl_b32 s75, s71, 15
    s_lshl_b32 s76, s3, 12
    s_add_u32 s75, s75, s76
    v_and_b32 v249, 1, v4
    v_cmp_eq_u32 s[80:81], 1, v249
    v_lshlrev_b32 v56, 16, v228
    v_and_b32 v57, 0xffff0000, v228
    v_lshlrev_b32 v58, 16, v229
    v_and_b32 v59, 0xffff0000, v229
    v_lshlrev_b32 v60, 16, v230
    v_and_b32 v61, 0xffff0000, v230
    v_lshlrev_b32 v62, 16, v231
    v_and_b32 v63, 0xffff0000, v231
    v_lshlrev_b32 v64, 16, v232
    v_and_b32 v65, 0xffff0000, v232
    v_lshlrev_b32 v66, 16, v233
    v_and_b32 v67, 0xffff0000, v233
    v_lshlrev_b32 v68, 16, v234
    v_and_b32 v69, 0xffff0000, v234
    v_lshlrev_b32 v70, 16, v235
    v_and_b32 v71, 0xffff0000, v235
    v_lshlrev_b32 v72, 16, v236
    v_and_b32 v73, 0xffff0000, v236
    v_lshlrev_b32 v74, 16, v237
    v_and_b32 v75, 0xffff0000, v237
    v_lshlrev_b32 v76, 16, v238
    v_and_b32 v77, 0xffff0000, v238
    v_lshlrev_b32 v78, 16, v239
    v_and_b32 v79, 0xffff0000, v239
    v_lshlrev_b32 v80, 16, v240
    v_and_b32 v81, 0xffff0000, v240
    v_lshlrev_b32 v82, 16, v241
    v_and_b32 v83, 0xffff0000, v241
    v_lshlrev_b32 v84, 16, v242
    v_and_b32 v85, 0xffff0000, v242
    v_lshlrev_b32 v86, 16, v243
    v_and_b32 v87, 0xffff0000, v243
    v_add_f32 v120, v56, v72
    v_add_f32 v121, v57, v73
    v_add_f32 v122, v58, v74
    v_add_f32 v123, v59, v75
    v_add_f32 v124, v60, v76
    v_add_f32 v125, v61, v77
    v_add_f32 v126, v62, v78
    v_add_f32 v127, v63, v79
    v_add_f32 v128, v64, v80
    v_add_f32 v129, v65, v81
    v_add_f32 v130, v66, v82
    v_add_f32 v131, v67, v83
    v_add_f32 v132, v68, v84
    v_add_f32 v133, v69, v85
    v_add_f32 v134, v70, v86
    v_add_f32 v135, v71, v87
    v_add_f32 v120, v120, v128
    v_add_f32 v121, v121, v129
    v_add_f32 v122, v122, v130
    v_add_f32 v123, v123, v131
    v_add_f32 v124, v124, v132
    v_add_f32 v125, v125, v133
    v_add_f32 v126, v126, v134
    v_add_f32 v127, v127, v135
    v_add_f32 v120, v120, v124
    v_add_f32 v121, v121, v125
    v_add_f32 v122, v122, v126
    v_add_f32 v123, v123, v127
    v_add_f32 v120, v120, v122
    v_add_f32 v121, v121, v123
    v_add_f32 v120, v120, v121
    v_mov_b32 v121, v120
    s_nop 1
    v_permlane16_swap_b32 v121, v120
    v_add_f32 v120, v120, v121
    v_mov_b32 v121, v120
    s_nop 1
    v_permlane32_swap_b32 v121, v120
    v_add_f32 v120, v120, v121
    ds_write_b32 v248, v120 offset:0
    s_waitcnt lgkmcnt(0)
    s_barrier
    ds_read_b128 v[120:123], v247 offset:0
    ds_read_b128 v[124:127], v247 offset:16
    s_waitcnt lgkmcnt(0)
    v_add_f32 v120, v120, v124
    v_add_f32 v121, v121, v125
    v_add_f32 v122, v122, v126
    v_add_f32 v123, v123, v127
    v_add_f32 v120, v120, v122
    v_add_f32 v121, v121, v123
    v_add_f32 v120, v120, v121
    v_mul_f32 v250, 0x3a800000, v120
    v_sub_f32 v152, v56, v250
    v_sub_f32 v153, v57, v250
    v_sub_f32 v154, v58, v250
    v_sub_f32 v155, v59, v250
    v_sub_f32 v156, v60, v250
    v_sub_f32 v157, v61, v250
    v_sub_f32 v158, v62, v250
    v_sub_f32 v159, v63, v250
    v_sub_f32 v160, v64, v250
    v_sub_f32 v161, v65, v250
    v_sub_f32 v162, v66, v250
    v_sub_f32 v163, v67, v250
    v_sub_f32 v164, v68, v250
    v_sub_f32 v165, v69, v250
    v_sub_f32 v166, v70, v250
    v_sub_f32 v167, v71, v250
    v_sub_f32 v168, v72, v250
    v_sub_f32 v169, v73, v250
    v_sub_f32 v170, v74, v250
    v_sub_f32 v171, v75, v250
    v_sub_f32 v172, v76, v250
    v_sub_f32 v173, v77, v250
    v_sub_f32 v174, v78, v250
    v_sub_f32 v175, v79, v250
    v_sub_f32 v176, v80, v250
    v_sub_f32 v177, v81, v250
    v_sub_f32 v178, v82, v250
    v_sub_f32 v179, v83, v250
    v_sub_f32 v180, v84, v250
    v_sub_f32 v181, v85, v250
    v_sub_f32 v182, v86, v250
    v_sub_f32 v183, v87, v250
    v_mul_f32 v120, v152, v152
    v_fmac_f32 v120, v168, v168
    v_mul_f32 v121, v153, v153
    v_fmac_f32 v121, v169, v169
    v_mul_f32 v122, v154, v154
    v_fmac_f32 v122, v170, v170
    v_mul_f32 v123, v155, v155
    v_fmac_f32 v123, v171, v171
    v_mul_f32 v124, v156, v156
    v_fmac_f32 v124, v172, v172
    v_mul_f32 v125, v157, v157
    v_fmac_f32 v125, v173, v173
    v_mul_f32 v126, v158, v158
    v_fmac_f32 v126, v174, v174
    v_mul_f32 v127, v159, v159
    v_fmac_f32 v127, v175, v175
    v_mul_f32 v128, v160, v160
    v_fmac_f32 v128, v176, v176
    v_mul_f32 v129, v161, v161
    v_fmac_f32 v129, v177, v177
    v_mul_f32 v130, v162, v162
    v_fmac_f32 v130, v178, v178
    v_mul_f32 v131, v163, v163
    v_fmac_f32 v131, v179, v179
    v_mul_f32 v132, v164, v164
    v_fmac_f32 v132, v180, v180
    v_mul_f32 v133, v165, v165
    v_fmac_f32 v133, v181, v181
    v_mul_f32 v134, v166, v166
    v_fmac_f32 v134, v182, v182
    v_mul_f32 v135, v167, v167
    v_fmac_f32 v135, v183, v183
    v_add_f32 v120, v120, v128
    v_add_f32 v121, v121, v129
    v_add_f32 v122, v122, v130
    v_add_f32 v123, v123, v131
    v_add_f32 v124, v124, v132
    v_add_f32 v125, v125, v133
    v_add_f32 v126, v126, v134
    v_add_f32 v127, v127, v135
    v_add_f32 v120, v120, v124
    v_add_f32 v121, v121, v125
    v_add_f32 v122, v122, v126
    v_add_f32 v123, v123, v127
    v_add_f32 v120, v120, v122
    v_add_f32 v121, v121, v123
    v_add_f32 v120, v120, v121
    v_mov_b32 v121, v120
    s_nop 1
    v_permlane16_swap_b32 v121, v120
    v_add_f32 v120, v120, v121
    v_mov_b32 v121, v120
    s_nop 1
    v_permlane32_swap_b32 v121, v120
    v_add_f32 v120, v120, v121
    ds_write_b32 v248, v120 offset:512
    s_waitcnt lgkmcnt(0)
    s_barrier
    ds_read_b128 v[120:123], v247 offset:512
    ds_read_b128 v[124:127], v247 offset:528
    s_waitcnt lgkmcnt(0)
    v_add_f32 v120, v120, v124
    v_add_f32 v121, v121, v125
    v_add_f32 v122, v122, v126
    v_add_f32 v123, v123, v127
    v_add_f32 v120, v120, v122
    v_add_f32 v121, v121, v123
    v_add_f32 v120, v120, v121
    v_mul_f32 v251, 0x3a800000, v120
    v_cvt_pk_bf16_f32 v250, v250, v250
    v_lshlrev_b32 v250, 16, v250
    v_cvt_pk_bf16_f32 v251, v251, v251
    v_lshlrev_b32 v251, 16, v251
    v_add_f32 v251, 0x3727c5ac, v251
    v_cvt_pk_bf16_f32 v251, v251, v251
    v_lshlrev_b32 v251, 16, v251
    v_sqrt_f32 v251, v251
    s_nop 0
    v_cvt_pk_bf16_f32 v251, v251, v251
    v_lshlrev_b32 v251, 16, v251
    v_rcp_f32 v251, v251
    s_nop 0
    s_cmp_lg_u32 s3, 0
    s_cbranch_scc1 ln_nst
    s_lshl_b32 s77, s71, 7
    s_add_u32 s77, s77, 188743680
    v_lshlrev_b32 v249, 3, v245
    s_mov_b64 exec, 0xffff
    buffer_store_dwordx2 v[250:251], v249, s[4:7], s77 offen sc1
    s_mov_b64 exec, -1
ln_nst:
    v_sub_f32 v56, v56, v250
    v_sub_f32 v57, v57, v250
    v_cvt_pk_bf16_f32 v228, v56, v57
    v_lshlrev_b32 v56, 16, v228
    v_and_b32 v57, 0xffff0000, v228
    v_mul_f32 v56, v56, v251
    v_mul_f32 v57, v57, v251
    v_cvt_pk_bf16_f32 v228, v56, v57
    v_sub_f32 v58, v58, v250
    v_sub_f32 v59, v59, v250
    v_cvt_pk_bf16_f32 v229, v58, v59
    v_lshlrev_b32 v58, 16, v229
    v_and_b32 v59, 0xffff0000, v229
    v_mul_f32 v58, v58, v251
    v_mul_f32 v59, v59, v251
    v_cvt_pk_bf16_f32 v229, v58, v59
    v_sub_f32 v60, v60, v250
    v_sub_f32 v61, v61, v250
    v_cvt_pk_bf16_f32 v230, v60, v61
    v_lshlrev_b32 v60, 16, v230
    v_and_b32 v61, 0xffff0000, v230
    v_mul_f32 v60, v60, v251
    v_mul_f32 v61, v61, v251
    v_cvt_pk_bf16_f32 v230, v60, v61
    v_sub_f32 v62, v62, v250
    v_sub_f32 v63, v63, v250
    v_cvt_pk_bf16_f32 v231, v62, v63
    v_lshlrev_b32 v62, 16, v231
    v_and_b32 v63, 0xffff0000, v231
    v_mul_f32 v62, v62, v251
    v_mul_f32 v63, v63, v251
    v_cvt_pk_bf16_f32 v231, v62, v63
    v_cndmask_b32 v120, v228, v230, s[80:81]
    v_cndmask_b32 v121, v229, v231, s[80:81]
    v_cndmask_b32 v122, v230, v228, s[80:81]
    v_cndmask_b32 v123, v231, v229, s[80:81]
    buffer_store_dwordx4 v[120:123], v1, s[4:7], s75 offen offset:0 sc1
    v_sub_f32 v64, v64, v250
    v_sub_f32 v65, v65, v250
    v_cvt_pk_bf16_f32 v232, v64, v65
    v_lshlrev_b32 v64, 16, v232
    v_and_b32 v65, 0xffff0000, v232
    v_mul_f32 v64, v64, v251
    v_mul_f32 v65, v65, v251
    v_cvt_pk_bf16_f32 v232, v64, v65
    v_sub_f32 v66, v66, v250
    v_sub_f32 v67, v67, v250
    v_cvt_pk_bf16_f32 v233, v66, v67
    v_lshlrev_b32 v66, 16, v233
    v_and_b32 v67, 0xffff0000, v233
    v_mul_f32 v66, v66, v251
    v_mul_f32 v67, v67, v251
    v_cvt_pk_bf16_f32 v233, v66, v67
    v_sub_f32 v68, v68, v250
    v_sub_f32 v69, v69, v250
    v_cvt_pk_bf16_f32 v234, v68, v69
    v_lshlrev_b32 v68, 16, v234
    v_and_b32 v69, 0xffff0000, v234
    v_mul_f32 v68, v68, v251
    v_mul_f32 v69, v69, v251
    v_cvt_pk_bf16_f32 v234, v68, v69
    v_sub_f32 v70, v70, v250
    v_sub_f32 v71, v71, v250
    v_cvt_pk_bf16_f32 v235, v70, v71
    v_lshlrev_b32 v70, 16, v235
    v_and_b32 v71, 0xffff0000, v235
    v_mul_f32 v70, v70, v251
    v_mul_f32 v71, v71, v251
    v_cvt_pk_bf16_f32 v235, v70, v71
    v_cndmask_b32 v124, v232, v234, s[80:81]
    v_cndmask_b32 v125, v233, v235, s[80:81]
    v_cndmask_b32 v126, v234, v232, s[80:81]
    v_cndmask_b32 v127, v235, v233, s[80:81]
    buffer_store_dwordx4 v[124:127], v1, s[4:7], s75 offen offset:1024 sc1
    v_sub_f32 v72, v72, v250
    v_sub_f32 v73, v73, v250
    v_cvt_pk_bf16_f32 v236, v72, v73
    v_lshlrev_b32 v72, 16, v236
    v_and_b32 v73, 0xffff0000, v236
    v_mul_f32 v72, v72, v251
    v_mul_f32 v73, v73, v251
    v_cvt_pk_bf16_f32 v236, v72, v73
    v_sub_f32 v74, v74, v250
    v_sub_f32 v75, v75, v250
    v_cvt_pk_bf16_f32 v237, v74, v75
    v_lshlrev_b32 v74, 16, v237
    v_and_b32 v75, 0xffff0000, v237
    v_mul_f32 v74, v74, v251
    v_mul_f32 v75, v75, v251
    v_cvt_pk_bf16_f32 v237, v74, v75
    v_sub_f32 v76, v76, v250
    v_sub_f32 v77, v77, v250
    v_cvt_pk_bf16_f32 v238, v76, v77
    v_lshlrev_b32 v76, 16, v238
    v_and_b32 v77, 0xffff0000, v238
    v_mul_f32 v76, v76, v251
    v_mul_f32 v77, v77, v251
    v_cvt_pk_bf16_f32 v238, v76, v77
    v_sub_f32 v78, v78, v250
    v_sub_f32 v79, v79, v250
    v_cvt_pk_bf16_f32 v239, v78, v79
    v_lshlrev_b32 v78, 16, v239
    v_and_b32 v79, 0xffff0000, v239
    v_mul_f32 v78, v78, v251
    v_mul_f32 v79, v79, v251
    v_cvt_pk_bf16_f32 v239, v78, v79
    v_cndmask_b32 v128, v236, v238, s[80:81]
    v_cndmask_b32 v129, v237, v239, s[80:81]
    v_cndmask_b32 v130, v238, v236, s[80:81]
    v_cndmask_b32 v131, v239, v237, s[80:81]
    buffer_store_dwordx4 v[128:131], v1, s[4:7], s75 offen offset:2048 sc1
    v_sub_f32 v80, v80, v250
    v_sub_f32 v81, v81, v250
    v_cvt_pk_bf16_f32 v240, v80, v81
    v_lshlrev_b32 v80, 16, v240
    v_and_b32 v81, 0xffff0000, v240
    v_mul_f32 v80, v80, v251
    v_mul_f32 v81, v81, v251
    v_cvt_pk_bf16_f32 v240, v80, v81
    v_sub_f32 v82, v82, v250
    v_sub_f32 v83, v83, v250
    v_cvt_pk_bf16_f32 v241, v82, v83
    v_lshlrev_b32 v82, 16, v241
    v_and_b32 v83, 0xffff0000, v241
    v_mul_f32 v82, v82, v251
    v_mul_f32 v83, v83, v251
    v_cvt_pk_bf16_f32 v241, v82, v83
    v_sub_f32 v84, v84, v250
    v_sub_f32 v85, v85, v250
    v_cvt_pk_bf16_f32 v242, v84, v85
    v_lshlrev_b32 v84, 16, v242
    v_and_b32 v85, 0xffff0000, v242
    v_mul_f32 v84, v84, v251
    v_mul_f32 v85, v85, v251
    v_cvt_pk_bf16_f32 v242, v84, v85
    v_sub_f32 v86, v86, v250
    v_sub_f32 v87, v87, v250
    v_cvt_pk_bf16_f32 v243, v86, v87
    v_lshlrev_b32 v86, 16, v243
    v_and_b32 v87, 0xffff0000, v243
    v_mul_f32 v86, v86, v251
    v_mul_f32 v87, v87, v251
    v_cvt_pk_bf16_f32 v243, v86, v87
    v_cndmask_b32 v132, v240, v242, s[80:81]
    v_cndmask_b32 v133, v241, v243, s[80:81]
    v_cndmask_b32 v134, v242, v240, s[80:81]
    v_cndmask_b32 v135, v243, v241, s[80:81]
    buffer_store_dwordx4 v[132:135], v1, s[4:7], s75 offen offset:3072 sc1
    s_cmp_lg_u32 s98, 1
    s_cbranch_scc1 ln_now
    s_mov_b32 s98, 2
    s_branch w_adopt2
ln_now:
    v_mov_b32 v18, 1
    s_waitcnt vmcnt(0)
    s_barrier
    s_cmp_lg_u32 s3, 0
    s_cbranch_scc1 ln_sig
    s_mov_b64 exec, 1
    s_cmp_ge_u32 s71, 32
    s_cbranch_scc1 ln_sb
    buffer_atomic_add v18, off, s[64:67], 0 offset:192 sc1
ln_sb:
    buffer_atomic_add v18, off, s[64:67], 0 offset:0 sc1
    s_mov_b64 exec, -1
ln_sig:
    s_cmp_lt_u32 s63, 120
    s_cbranch_scc1 prb_done
    s_cmp_lg_u32 s3, 0
    s_cbranch_scc1 prb_bar
    s_sub_u32 s82, s63, 120
    s_lshl_b32 s83, s82, 7
    s_add_u32 s83, s83, 218112000
    s_lshl_b32 s84, s82, 10
    s_add_u32 s84, s84, 209715200
    s_mov_b32 s80, -1
    s_mov_b32 s81, -1
    s_mov_b64 exec, 1
    s_memtime s[74:75]
    s_add_u32 s87, s84, 0
    s_waitcnt lgkmcnt(0)
    buffer_load_dword v20, off, s[4:7], s87 sc1
    s_waitcnt vmcnt(0)
    s_memtime s[76:77]
    s_waitcnt lgkmcnt(0)
    s_sub_u32 s87, s76, s74
    s_min_u32 s80, s80, s87
    s_memtime s[74:75]
    s_add_u32 s87, s84, 8192
    s_waitcnt lgkmcnt(0)
    buffer_load_dword v20, off, s[4:7], s87 sc1
    s_waitcnt vmcnt(0)
    s_memtime s[76:77]
    s_waitcnt lgkmcnt(0)
    s_sub_u32 s87, s76, s74
    s_min_u32 s81, s81, s87
    s_memtime s[74:75]
    s_add_u32 s87, s84, 16384
    s_waitcnt lgkmcnt(0)
    buffer_load_dword v20, off, s[4:7], s87 sc1
    s_waitcnt vmcnt(0)
    s_memtime s[76:77]
    s_waitcnt lgkmcnt(0)
    s_sub_u32 s87, s76, s74
    s_min_u32 s80, s80, s87
    s_memtime s[74:75]
    s_add_u32 s87, s84, 24576
    s_waitcnt lgkmcnt(0)
    buffer_load_dword v20, off, s[4:7], s87 sc1
    s_waitcnt vmcnt(0)
    s_memtime s[76:77]
    s_waitcnt lgkmcnt(0)
    s_sub_u32 s87, s76, s74
    s_min_u32 s81, s81, s87
    s_memtime s[74:75]
    s_add_u32 s87, s84, 32768
    s_waitcnt lgkmcnt(0)
    buffer_load_dword v20, off, s[4:7], s87 sc1
    s_waitcnt vmcnt(0)
    s_memtime s[76:77]
    s_waitcnt lgkmcnt(0)
    s_sub_u32 s87, s76, s74
    s_min_u32 s80, s80, s87
    s_memtime s[74:75]
    s_add_u32 s87, s84, 40960
    s_waitcnt lgkmcnt(0)
    buffer_load_dword v20, off, s[4:7], s87 sc1
    s_waitcnt vmcnt(0)
    s_memtime s[76:77]
    s_waitcnt lgkmcnt(0)
    s_sub_u32 s87, s76, s74
    s_min_u32 s81, s81, s87
    s_memtime s[74:75]
    s_add_u32 s87, s84, 49152
    s_waitcnt lgkmcnt(0)
    buffer_load_dword v20, off, s[4:7], s87 sc1
    s_waitcnt vmcnt(0)
    s_memtime s[76:77]
    s_waitcnt lgkmcnt(0)
    s_sub_u32 s87, s76, s74
    s_min_u32 s80, s80, s87
    s_memtime s[74:75]
    s_add_u32 s87, s84, 57344
    s_waitcnt lgkmcnt(0)
    buffer_load_dword v20, off, s[4:7], s87 sc1
    s_waitcnt vmcnt(0)
    s_memtime s[76:77]
    s_waitcnt lgkmcnt(0)
    s_sub_u32 s87, s76, s74
    s_min_u32 s81, s81, s87
    s_memtime s[74:75]
    s_add_u32 s87, s84, 65536
    s_waitcnt lgkmcnt(0)
    buffer_load_dword v20, off, s[4:7], s87 sc1
    s_waitcnt vmcnt(0)
    s_memtime s[76:77]
    s_waitcnt lgkmcnt(0)
    s_sub_u32 s87, s76, s74
    s_min_u32 s80, s80, s87
    s_memtime s[74:75]
    s_add_u32 s87, s84, 73728
    s_waitcnt lgkmcnt(0)
    buffer_load_dword v20, off, s[4:7], s87 sc1
    s_waitcnt vmcnt(0)
    s_memtime s[76:77]
    s_waitcnt lgkmcnt(0)
    s_sub_u32 s87, s76, s74
    s_min_u32 s81, s81, s87
    s_memtime s[74:75]
    s_add_u32 s87, s84, 81920
    s_waitcnt lgkmcnt(0)
    buffer_load_dword v20, off, s[4:7], s87 sc1
    s_waitcnt vmcnt(0)
    s_memtime s[76:77]
    s_waitcnt lgkmcnt(0)
    s_sub_u32 s87, s76, s74
    s_min_u32 s80, s80, s87
    s_memtime s[74:75]
    s_add_u32 s87, s84, 90112
    s_waitcnt lgkmcnt(0)
    buffer_load_dword v20, off, s[4:7], s87 sc1
    s_waitcnt vmcnt(0)
    s_memtime s[76:77]
    s_waitcnt lgkmcnt(0)
    s_sub_u32 s87, s76, s74
    s_min_u32 s81, s81, s87
    s_sub_i32 s85, s80, s81
    s_min_i32 s85, s85, 400
    s_max_i32 s85, s85, -400
    s_lshl_b32 s85, s85, 8
    s_getreg_b32 s86, hwreg(HW_REG_XCC_ID)
    s_bfe_u32 s86, s86, 0x10002
    s_lshl_b32 s86, s86, 1
    s_or_b32 s85, s85, s86
    s_or_b32 s85, s85, 1
    s_mov_b32 s86, 65536
prb_i:
    buffer_load_dword v20, off, s[64:67], 0 offset:192 sc1
    s_waitcnt vmcnt(0)
    v_readfirstlane_b32 s84, v20
    s_cmp_ge_u32 s84, 32
    s_cbranch_scc1 prb_i_ok
    s_sleep 8
    s_sub_u32 s86, s86, 1
    s_cbranch_scc0 prb_i
prb_i_ok:
    v_mov_b32 v20, s85
    buffer_store_dword v20, off, s[4:7], s83 offset:8 sc1
    s_mov_b64 exec, -1
prb_bar:
    s_barrier
prb_done:
    s_cmp_lt_u32 s32, 4
    s_cbranch_scc1 w_nopre
    s_load_dwordx2 s[8:9], s[0:1], s33
    s_load_dwordx2 s[12:13], s[0:1], s34
    s_mov_b32 s10, s38
    s_mov_b32 s14, s38
    s_cmp_ge_u32 s32, 4
    s_cselect_b32 s31, 0, 1
    s_lshl_b32 s30, s3, s31
    s_mul_i32 s30, s30, s40
    s_add_u32 s16, s39, s30
    s_cmp_eq_u32 s32, 4
    s_cselect_b32 s30, 1024, s40
    s_cselect_b32 s31, 6, 5
    s_lshl_b32 s62, 32, s31
    s_add_u32 s17, s16, s30
    s_lshl_b32 s30, s3, 2
    s_mul_i32 s30, s30, s35
    s_add_u32 s18, s36, s30
    s_add_u32 s19, s37, s30
    s_lshl_b32 s20, s35, s31
    v_mul_u32_u24 v2, s35, v4
    v_add_u32 v2, v2, v3
    s_waitcnt lgkmcnt(0)
    s_add_u32 m0, s22, 0
    s_nop 0
    buffer_load_dwordx4 v2, s[8:11], s18 offen lds
    s_add_u32 s18, s18, s20
    s_add_u32 m0, s22, 8192
    s_nop 0
    buffer_load_dwordx4 v2, s[12:15], s19 offen lds
    s_add_u32 s19, s19, s20
    s_add_u32 m0, s22, 32768
    s_nop 0
    buffer_load_dwordx4 v2, s[8:11], s18 offen lds
    s_add_u32 s18, s18, s20
    s_add_u32 m0, s22, 40960
    s_nop 0
    buffer_load_dwordx4 v2, s[12:15], s19 offen lds
    s_add_u32 s19, s19, s20
    s_add_u32 m0, s22, 65536
    s_nop 0
    buffer_load_dwordx4 v2, s[8:11], s18 offen lds
    s_add_u32 s18, s18, s20
    s_add_u32 m0, s22, 73728
    s_nop 0
    buffer_load_dwordx4 v2, s[12:15], s19 offen lds
    s_add_u32 s19, s19, s20
    s_add_u32 m0, s22, 98304
    s_nop 0
    buffer_load_dwordx4 v2, s[8:11], s18 offen lds
    s_add_u32 s18, s18, s20
    s_add_u32 m0, s22, 106496
    s_nop 0
    buffer_load_dwordx4 v2, s[12:15], s19 offen lds
    s_add_u32 s19, s19, s20
    s_mov_b32 s70, 1
    s_cmp_lt_u32 s39, 1048576
    s_cselect_b32 s70, s70, 0
    s_cmp_lg_u32 s3, 0
    s_cbranch_scc1 lnwp_ok
    s_cmp_eq_u32 s70, 0
    s_cbranch_scc1 lnwp_full
    s_mov_b32 s69, 65536
lnwap:
    buffer_load_dword v20, off, s[64:67], 0 offset:192 sc1
    s_waitcnt vmcnt(0)
    v_readfirstlane_b32 s68, v20
    s_cmp_ge_u32 s68, 32
    s_cbranch_scc1 lnwap_ok
    s_sleep 8
    s_sub_u32 s69, s69, 1
    s_cbranch_scc0 lnwap
lnwap_ok:
    s_branch lnwp_ok
lnwp_full:
    s_mov_b32 s69, 65536
lnwp:
    buffer_load_dword v20, off, s[64:67], 0 offset:0 sc1
    s_waitcnt vmcnt(0)
    v_readfirstlane_b32 s68, v20
    s_cmp_ge_u32 s68, 128
    s_cbranch_scc1 lnwp_ok
    s_sleep 8
    s_sub_u32 s69, s69, 1
    s_cbranch_scc0 lnwp
lnwp_ok:
    s_barrier
    s_add_u32 m0, s21, 0
    s_nop 0
    buffer_load_dwordx4 v1, s[4:7], s16 offen sc1 lds
    s_add_u32 s16, s16, s62
    s_add_u32 m0, s21, 1024
    s_nop 0
    buffer_load_dwordx4 v1, s[4:7], s17 offen sc1 lds
    s_add_u32 s17, s17, s62
    s_add_u32 m0, s21, 32768
    s_nop 0
    buffer_load_dwordx4 v1, s[4:7], s16 offen sc1 lds
    s_add_u32 s16, s16, s62
    s_add_u32 m0, s21, 33792
    s_nop 0
    buffer_load_dwordx4 v1, s[4:7], s17 offen sc1 lds
    s_add_u32 s17, s17, s62
    s_add_u32 m0, s21, 65536
    s_nop 0
    buffer_load_dwordx4 v1, s[4:7], s16 offen sc1 lds
    s_add_u32 s16, s16, s62
    s_add_u32 m0, s21, 66560
    s_nop 0
    buffer_load_dwordx4 v1, s[4:7], s17 offen sc1 lds
    s_add_u32 s17, s17, s62
    s_add_u32 m0, s21, 98304
    s_nop 0
    buffer_load_dwordx4 v1, s[4:7], s16 offen sc1 lds
    s_add_u32 s16, s16, s62
    s_add_u32 m0, s21, 99328
    s_nop 0
    buffer_load_dwordx4 v1, s[4:7], s17 offen sc1 lds
    s_add_u32 s17, s17, s62
    s_branch w_adopt
w_nopre:
    s_mov_b32 s70, 1
    s_cmp_lt_u32 s39, 1048576
    s_cselect_b32 s70, s70, 0
    s_cmp_lg_u32 s3, 0
    s_cbranch_scc1 lnw_ok
    s_cmp_eq_u32 s70, 0
    s_cbranch_scc1 lnw_full
    s_mov_b32 s69, 65536
lnwa:
    buffer_load_dword v20, off, s[64:67], 0 offset:192 sc1
    s_waitcnt vmcnt(0)
    v_readfirstlane_b32 s68, v20
    s_cmp_ge_u32 s68, 32
    s_cbranch_scc1 lnwa_ok
    s_sleep 8
    s_sub_u32 s69, s69, 1
    s_cbranch_scc0 lnwa
lnwa_ok:
    s_branch lnw_ok
lnw_full:
    s_mov_b32 s69, 65536
lnw:
    buffer_load_dword v20, off, s[64:67], 0 offset:0 sc1
    s_waitcnt vmcnt(0)
    v_readfirstlane_b32 s68, v20
    s_cmp_ge_u32 s68, 128
    s_cbranch_scc1 lnw_ok
    s_sleep 8
    s_sub_u32 s69, s69, 1
    s_cbranch_scc0 lnw
lnw_ok:
    s_barrier
w_cold:
    s_cmp_eq_u32 s32, 0
    s_cbranch_scc1 fin_entry
    s_cmp_lg_u32 s3, 0
    s_cbranch_scc1 w_depok
    s_cmp_eq_u32 s45, 0
    s_cbranch_scc1 w_depok
    s_mov_b32 s31, 0x40000
w_waitdep:
    buffer_load_dword v16, v17, s[4:7], s44 offen sc1
    s_waitcnt vmcnt(0)
    v_readfirstlane_b32 s30, v16
    s_cmp_ge_u32 s30, s45
    s_cbranch_scc1 w_depok
    s_sleep 16
    s_sub_u32 s31, s31, 1
    s_cbranch_scc0 w_waitdep
w_depok:
    s_load_dwordx2 s[8:9], s[0:1], s33
    s_load_dwordx2 s[12:13], s[0:1], s34
    s_mov_b32 s10, s38
    s_mov_b32 s14, s38
    s_cmp_ge_u32 s32, 4
    s_cselect_b32 s31, 0, 1
    s_lshl_b32 s30, s3, s31
    s_mul_i32 s30, s30, s40
    s_add_u32 s16, s39, s30
    s_cmp_eq_u32 s32, 4
    s_cselect_b32 s30, 1024, s40
    s_cselect_b32 s31, 6, 5
    s_lshl_b32 s62, 32, s31
    s_add_u32 s17, s16, s30
    s_lshl_b32 s30, s3, 2
    s_mul_i32 s30, s30, s35
    s_add_u32 s18, s36, s30
    s_add_u32 s19, s37, s30
    s_lshl_b32 s20, s35, s31
    v_mul_u32_u24 v2, s35, v4
    v_add_u32 v2, v2, v3
    s_waitcnt lgkmcnt(0)
    s_barrier
    s_add_u32 m0, s21, 0
    s_nop 0
    buffer_load_dwordx4 v1, s[4:7], s16 offen sc1 lds
    s_add_u32 s16, s16, s62
    s_add_u32 m0, s21, 1024
    s_nop 0
    buffer_load_dwordx4 v1, s[4:7], s17 offen sc1 lds
    s_add_u32 s17, s17, s62
    s_add_u32 m0, s22, 0
    s_nop 0
    buffer_load_dwordx4 v2, s[8:11], s18 offen lds
    s_add_u32 s18, s18, s20
    s_add_u32 m0, s22, 8192
    s_nop 0
    buffer_load_dwordx4 v2, s[12:15], s19 offen lds
    s_add_u32 s19, s19, s20
    s_add_u32 m0, s21, 32768
    s_nop 0
    buffer_load_dwordx4 v1, s[4:7], s16 offen sc1 lds
    s_add_u32 s16, s16, s62
    s_add_u32 m0, s21, 33792
    s_nop 0
    buffer_load_dwordx4 v1, s[4:7], s17 offen sc1 lds
    s_add_u32 s17, s17, s62
    s_add_u32 m0, s22, 32768
    s_nop 0
    buffer_load_dwordx4 v2, s[8:11], s18 offen lds
    s_add_u32 s18, s18, s20
    s_add_u32 m0, s22, 40960
    s_nop 0
    buffer_load_dwordx4 v2, s[12:15], s19 offen lds
    s_add_u32 s19, s19, s20
    s_add_u32 m0, s21, 65536
    s_nop 0
    buffer_load_dwordx4 v1, s[4:7], s16 offen sc1 lds
    s_add_u32 s16, s16, s62
    s_add_u32 m0, s21, 66560
    s_nop 0
    buffer_load_dwordx4 v1, s[4:7], s17 offen sc1 lds
    s_add_u32 s17, s17, s62
    s_add_u32 m0, s22, 65536
    s_nop 0
    buffer_load_dwordx4 v2, s[8:11], s18 offen lds
    s_add_u32 s18, s18, s20
    s_add_u32 m0, s22, 73728
    s_nop 0
    buffer_load_dwordx4 v2, s[12:15], s19 offen lds
    s_add_u32 s19, s19, s20
    s_add_u32 m0, s21, 98304
    s_nop 0
    buffer_load_dwordx4 v1, s[4:7], s16 offen sc1 lds
    s_add_u32 s16, s16, s62
    s_add_u32 m0, s21, 99328
    s_nop 0
    buffer_load_dwordx4 v1, s[4:7], s17 offen sc1 lds
    s_add_u32 s17, s17, s62
    s_add_u32 m0, s22, 98304
    s_nop 0
    buffer_load_dwordx4 v2, s[8:11], s18 offen lds
    s_add_u32 s18, s18, s20
    s_add_u32 m0, s22, 106496
    s_nop 0
    buffer_load_dwordx4 v2, s[12:15], s19 offen lds
    s_add_u32 s19, s19, s20
w_adopt:
    s_cmp_eq_u32 s98, 1
    s_cbranch_scc1 ln_entry
w_adopt2:
    s_mov_b32 s48, s32
    s_cmp_ge_u32 s32, 4
    s_cselect_b32 s30, 2, 3
    s_lshl_b32 s30, s26, s30
    s_mul_i32 s30, s30, s43
    s_add_u32 s49, s42, s30
    s_mov_b32 s50, s43
    s_mov_b32 s51, s46
    s_mov_b32 s23, s41
    s_mov_b32 s53, s47
    s_nop 0
    s_load_dwordx16 s[32:47], s[24:25], 0
    s_add_u32 s24, s24, 64
    s_addc_u32 s25, s25, 0
    s_cmp_eq_u32 s48, 6
    s_cbranch_scc1 w_firstX
    s_waitcnt vmcnt(0)
    s_barrier
    s_cmp_lg_u32 s98, 2
    s_cbranch_scc1 lls_done
    s_mov_b32 s98, 0
    s_cmp_lg_u32 s3, 0
    s_cbranch_scc1 lls_done
    v_mov_b32 v20, 1
    s_mov_b64 exec, 1
    buffer_atomic_add v20, off, s[64:67], 0 offset:0 sc1
    s_mov_b64 exec, -1
lls_done:
    ds_read_b64_tr_b16 v[64:65], v8 offset:16384
    ds_read_b64_tr_b16 v[66:67], v9 offset:16384
    ds_read_b64_tr_b16 v[68:69], v10 offset:16384
    ds_read_b64_tr_b16 v[70:71], v11 offset:16384
    ds_read_b64_tr_b16 v[72:73], v8 offset:24576
    ds_read_b64_tr_b16 v[74:75], v9 offset:24576
    ds_read_b64_tr_b16 v[76:77], v10 offset:24576
    ds_read_b64_tr_b16 v[78:79], v11 offset:24576
    ds_read_b128 v[32:35], v5 offset:0
    ds_read_b128 v[36:39], v5 offset:1024
    ds_read_b128 v[40:43], v5 offset:2048
    ds_read_b128 v[44:47], v5 offset:3072
    ds_read_b128 v[48:51], v5 offset:4096
    ds_read_b128 v[52:55], v5 offset:5120
    ds_read_b128 v[56:59], v5 offset:6144
    ds_read_b128 v[60:63], v5 offset:7168
    s_waitcnt lgkmcnt(0)
    s_cmp_eq_u32 s48, 4
    s_cbranch_scc1 w_firstH
    s_cmp_eq_u32 s48, 5
    s_cbranch_scc1 w_firstM
    s_branch w_first16
w_first4:
    s_waitcnt vmcnt(12)
    s_barrier
    v_mfma_f32_16x16x32_bf16 v[128:131], v[64:67], v[32:35], 0
    ds_read_b64_tr_b16 v[112:113], v8 offset:49152
    v_mfma_f32_16x16x32_bf16 v[132:135], v[68:71], v[32:35], 0
    ds_read_b64_tr_b16 v[114:115], v9 offset:49152
    v_mfma_f32_16x16x32_bf16 v[136:139], v[72:75], v[32:35], 0
    ds_read_b64_tr_b16 v[116:117], v10 offset:49152
    v_mfma_f32_16x16x32_bf16 v[140:143], v[76:79], v[32:35], 0
    ds_read_b64_tr_b16 v[118:119], v11 offset:49152
    v_mfma_f32_16x16x32_bf16 v[144:147], v[64:67], v[36:39], 0
    ds_read_b64_tr_b16 v[120:121], v8 offset:57344
    v_mfma_f32_16x16x32_bf16 v[148:151], v[68:71], v[36:39], 0
    ds_read_b64_tr_b16 v[122:123], v9 offset:57344
    v_mfma_f32_16x16x32_bf16 v[152:155], v[72:75], v[36:39], 0
    ds_read_b64_tr_b16 v[124:125], v10 offset:57344
    v_mfma_f32_16x16x32_bf16 v[156:159], v[76:79], v[36:39], 0
    ds_read_b64_tr_b16 v[126:127], v11 offset:57344
    v_mfma_f32_16x16x32_bf16 v[160:163], v[64:67], v[40:43], 0
    ds_read_b128 v[80:83], v5 offset:32768
    v_mfma_f32_16x16x32_bf16 v[164:167], v[68:71], v[40:43], 0
    ds_read_b128 v[84:87], v5 offset:33792
    v_mfma_f32_16x16x32_bf16 v[168:171], v[72:75], v[40:43], 0
    ds_read_b128 v[88:91], v5 offset:34816
    v_mfma_f32_16x16x32_bf16 v[172:175], v[76:79], v[40:43], 0
    ds_read_b128 v[92:95], v5 offset:35840
    v_mfma_f32_16x16x32_bf16 v[176:179], v[64:67], v[44:47], 0
    ds_read_b128 v[96:99], v5 offset:36864
    v_mfma_f32_16x16x32_bf16 v[180:183], v[68:71], v[44:47], 0
    ds_read_b128 v[100:103], v5 offset:37888
    v_mfma_f32_16x16x32_bf16 v[184:187], v[72:75], v[44:47], 0
    ds_read_b128 v[104:107], v5 offset:38912
    v_mfma_f32_16x16x32_bf16 v[188:191], v[76:79], v[44:47], 0
    ds_read_b128 v[108:111], v5 offset:39936
    v_mfma_f32_16x16x32_bf16 v[192:195], v[64:67], v[48:51], 0
    v_mfma_f32_16x16x32_bf16 v[196:199], v[68:71], v[48:51], 0
    s_add_u32 m0, s21, 0
    s_nop 0
    buffer_load_dwordx4 v1, s[4:7], s16 offen sc1 lds
    s_add_u32 s16, s16, s62
    v_mfma_f32_16x16x32_bf16 v[200:203], v[72:75], v[48:51], 0
    v_mfma_f32_16x16x32_bf16 v[204:207], v[76:79], v[48:51], 0
    v_mfma_f32_16x16x32_bf16 v[208:211], v[64:67], v[52:55], 0
    s_add_u32 m0, s21, 1024
    s_nop 0
    buffer_load_dwordx4 v1, s[4:7], s17 offen sc1 lds
    s_add_u32 s17, s17, s62
    v_mfma_f32_16x16x32_bf16 v[212:215], v[68:71], v[52:55], 0
    v_mfma_f32_16x16x32_bf16 v[216:219], v[72:75], v[52:55], 0
    v_mfma_f32_16x16x32_bf16 v[220:223], v[76:79], v[52:55], 0
    s_add_u32 m0, s22, 0
    s_nop 0
    buffer_load_dwordx4 v2, s[8:11], s18 offen lds
    s_add_u32 s18, s18, s20
    v_mfma_f32_16x16x32_bf16 v[224:227], v[64:67], v[56:59], 0
    v_mfma_f32_16x16x32_bf16 v[228:231], v[68:71], v[56:59], 0
    v_mfma_f32_16x16x32_bf16 v[232:235], v[72:75], v[56:59], 0
    s_add_u32 m0, s22, 8192
    s_nop 0
    buffer_load_dwordx4 v2, s[12:15], s19 offen lds
    s_add_u32 s19, s19, s20
    v_mfma_f32_16x16x32_bf16 v[236:239], v[76:79], v[56:59], 0
    v_mfma_f32_16x16x32_bf16 v[240:243], v[64:67], v[60:63], 0
    v_mfma_f32_16x16x32_bf16 v[244:247], v[68:71], v[60:63], 0
    v_mfma_f32_16x16x32_bf16 v[248:251], v[72:75], v[60:63], 0
    v_mfma_f32_16x16x32_bf16 v[252:255], v[76:79], v[60:63], 0
    s_waitcnt lgkmcnt(0)
    s_waitcnt vmcnt(12)
    s_barrier
    v_mfma_f32_16x16x32_bf16 v[128:131], v[112:115], v[80:83], v[128:131]
    ds_read_b64_tr_b16 v[64:65], v12 offset:16384
    v_mfma_f32_16x16x32_bf16 v[132:135], v[116:119], v[80:83], v[132:135]
    ds_read_b64_tr_b16 v[66:67], v13 offset:16384
    v_mfma_f32_16x16x32_bf16 v[136:139], v[120:123], v[80:83], v[136:139]
    ds_read_b64_tr_b16 v[68:69], v14 offset:16384
    v_mfma_f32_16x16x32_bf16 v[140:143], v[124:127], v[80:83], v[140:143]
    ds_read_b64_tr_b16 v[70:71], v15 offset:16384
    v_mfma_f32_16x16x32_bf16 v[144:147], v[112:115], v[84:87], v[144:147]
    ds_read_b64_tr_b16 v[72:73], v12 offset:24576
    v_mfma_f32_16x16x32_bf16 v[148:151], v[116:119], v[84:87], v[148:151]
    ds_read_b64_tr_b16 v[74:75], v13 offset:24576
    v_mfma_f32_16x16x32_bf16 v[152:155], v[120:123], v[84:87], v[152:155]
    ds_read_b64_tr_b16 v[76:77], v14 offset:24576
    v_mfma_f32_16x16x32_bf16 v[156:159], v[124:127], v[84:87], v[156:159]
    ds_read_b64_tr_b16 v[78:79], v15 offset:24576
    v_mfma_f32_16x16x32_bf16 v[160:163], v[112:115], v[88:91], v[160:163]
    ds_read_b128 v[32:35], v6 offset:0
    v_mfma_f32_16x16x32_bf16 v[164:167], v[116:119], v[88:91], v[164:167]
    ds_read_b128 v[36:39], v6 offset:1024
    v_mfma_f32_16x16x32_bf16 v[168:171], v[120:123], v[88:91], v[168:171]
    ds_read_b128 v[40:43], v6 offset:2048
    v_mfma_f32_16x16x32_bf16 v[172:175], v[124:127], v[88:91], v[172:175]
    ds_read_b128 v[44:47], v6 offset:3072
    v_mfma_f32_16x16x32_bf16 v[176:179], v[112:115], v[92:95], v[176:179]
    ds_read_b128 v[48:51], v6 offset:4096
    v_mfma_f32_16x16x32_bf16 v[180:183], v[116:119], v[92:95], v[180:183]
    ds_read_b128 v[52:55], v6 offset:5120
    v_mfma_f32_16x16x32_bf16 v[184:187], v[120:123], v[92:95], v[184:187]
    ds_read_b128 v[56:59], v6 offset:6144
    v_mfma_f32_16x16x32_bf16 v[188:191], v[124:127], v[92:95], v[188:191]
    ds_read_b128 v[60:63], v6 offset:7168
    v_mfma_f32_16x16x32_bf16 v[192:195], v[112:115], v[96:99], v[192:195]
    v_mfma_f32_16x16x32_bf16 v[196:199], v[116:119], v[96:99], v[196:199]
    s_add_u32 m0, s21, 32768
    s_nop 0
    buffer_load_dwordx4 v1, s[4:7], s16 offen sc1 lds
    s_add_u32 s16, s16, s62
    v_mfma_f32_16x16x32_bf16 v[200:203], v[120:123], v[96:99], v[200:203]
    v_mfma_f32_16x16x32_bf16 v[204:207], v[124:127], v[96:99], v[204:207]
    v_mfma_f32_16x16x32_bf16 v[208:211], v[112:115], v[100:103], v[208:211]
    s_add_u32 m0, s21, 33792
    s_nop 0
    buffer_load_dwordx4 v1, s[4:7], s17 offen sc1 lds
    s_add_u32 s17, s17, s62
    v_mfma_f32_16x16x32_bf16 v[212:215], v[116:119], v[100:103], v[212:215]
    v_mfma_f32_16x16x32_bf16 v[216:219], v[120:123], v[100:103], v[216:219]
    v_mfma_f32_16x16x32_bf16 v[220:223], v[124:127], v[100:103], v[220:223]
    s_add_u32 m0, s22, 32768
    s_nop 0
    buffer_load_dwordx4 v2, s[8:11], s18 offen lds
    s_add_u32 s18, s18, s20
    v_mfma_f32_16x16x32_bf16 v[224:227], v[112:115], v[104:107], v[224:227]
    v_mfma_f32_16x16x32_bf16 v[228:231], v[116:119], v[104:107], v[228:231]
    v_mfma_f32_16x16x32_bf16 v[232:235], v[120:123], v[104:107], v[232:235]
    s_add_u32 m0, s22, 40960
    s_nop 0
    buffer_load_dwordx4 v2, s[12:15], s19 offen lds
    s_add_u32 s19, s19, s20
    v_mfma_f32_16x16x32_bf16 v[236:239], v[124:127], v[104:107], v[236:239]
    v_mfma_f32_16x16x32_bf16 v[240:243], v[112:115], v[108:111], v[240:243]
    v_mfma_f32_16x16x32_bf16 v[244:247], v[116:119], v[108:111], v[244:247]
    v_mfma_f32_16x16x32_bf16 v[248:251], v[120:123], v[108:111], v[248:251]
    v_mfma_f32_16x16x32_bf16 v[252:255], v[124:127], v[108:111], v[252:255]
    s_waitcnt lgkmcnt(0)
    s_waitcnt vmcnt(12)
    s_barrier
    v_mfma_f32_16x16x32_bf16 v[128:131], v[64:67], v[32:35], v[128:131]
    ds_read_b64_tr_b16 v[112:113], v12 offset:49152
    v_mfma_f32_16x16x32_bf16 v[132:135], v[68:71], v[32:35], v[132:135]
    ds_read_b64_tr_b16 v[114:115], v13 offset:49152
    v_mfma_f32_16x16x32_bf16 v[136:139], v[72:75], v[32:35], v[136:139]
    ds_read_b64_tr_b16 v[116:117], v14 offset:49152
    v_mfma_f32_16x16x32_bf16 v[140:143], v[76:79], v[32:35], v[140:143]
    ds_read_b64_tr_b16 v[118:119], v15 offset:49152
    v_mfma_f32_16x16x32_bf16 v[144:147], v[64:67], v[36:39], v[144:147]
    ds_read_b64_tr_b16 v[120:121], v12 offset:57344
    v_mfma_f32_16x16x32_bf16 v[148:151], v[68:71], v[36:39], v[148:151]
    ds_read_b64_tr_b16 v[122:123], v13 offset:57344
    v_mfma_f32_16x16x32_bf16 v[152:155], v[72:75], v[36:39], v[152:155]
    ds_read_b64_tr_b16 v[124:125], v14 offset:57344
    v_mfma_f32_16x16x32_bf16 v[156:159], v[76:79], v[36:39], v[156:159]
    ds_read_b64_tr_b16 v[126:127], v15 offset:57344
    v_mfma_f32_16x16x32_bf16 v[160:163], v[64:67], v[40:43], v[160:163]
    ds_read_b128 v[80:83], v6 offset:32768
    v_mfma_f32_16x16x32_bf16 v[164:167], v[68:71], v[40:43], v[164:167]
    ds_read_b128 v[84:87], v6 offset:33792
    v_mfma_f32_16x16x32_bf16 v[168:171], v[72:75], v[40:43], v[168:171]
    ds_read_b128 v[88:91], v6 offset:34816
    v_mfma_f32_16x16x32_bf16 v[172:175], v[76:79], v[40:43], v[172:175]
    ds_read_b128 v[92:95], v6 offset:35840
    v_mfma_f32_16x16x32_bf16 v[176:179], v[64:67], v[44:47], v[176:179]
    ds_read_b128 v[96:99], v6 offset:36864
    v_mfma_f32_16x16x32_bf16 v[180:183], v[68:71], v[44:47], v[180:183]
    ds_read_b128 v[100:103], v6 offset:37888
    v_mfma_f32_16x16x32_bf16 v[184:187], v[72:75], v[44:47], v[184:187]
    ds_read_b128 v[104:107], v6 offset:38912
    v_mfma_f32_16x16x32_bf16 v[188:191], v[76:79], v[44:47], v[188:191]
    ds_read_b128 v[108:111], v6 offset:39936
    v_mfma_f32_16x16x32_bf16 v[192:195], v[64:67], v[48:51], v[192:195]
    v_mfma_f32_16x16x32_bf16 v[196:199], v[68:71], v[48:51], v[196:199]
    s_add_u32 m0, s21, 65536
    s_nop 0
    buffer_load_dwordx4 v1, s[4:7], s16 offen sc1 lds
    s_add_u32 s16, s16, s62
    v_mfma_f32_16x16x32_bf16 v[200:203], v[72:75], v[48:51], v[200:203]
    v_mfma_f32_16x16x32_bf16 v[204:207], v[76:79], v[48:51], v[204:207]
    v_mfma_f32_16x16x32_bf16 v[208:211], v[64:67], v[52:55], v[208:211]
    s_add_u32 m0, s21, 66560
    s_nop 0
    buffer_load_dwordx4 v1, s[4:7], s17 offen sc1 lds
    s_add_u32 s17, s17, s62
    v_mfma_f32_16x16x32_bf16 v[212:215], v[68:71], v[52:55], v[212:215]
    v_mfma_f32_16x16x32_bf16 v[216:219], v[72:75], v[52:55], v[216:219]
    v_mfma_f32_16x16x32_bf16 v[220:223], v[76:79], v[52:55], v[220:223]
    s_add_u32 m0, s22, 65536
    s_nop 0
    buffer_load_dwordx4 v2, s[8:11], s18 offen lds
    s_add_u32 s18, s18, s20
    v_mfma_f32_16x16x32_bf16 v[224:227], v[64:67], v[56:59], v[224:227]
    v_mfma_f32_16x16x32_bf16 v[228:231], v[68:71], v[56:59], v[228:231]
    v_mfma_f32_16x16x32_bf16 v[232:235], v[72:75], v[56:59], v[232:235]
    s_add_u32 m0, s22, 73728
    s_nop 0
    buffer_load_dwordx4 v2, s[12:15], s19 offen lds
    s_add_u32 s19, s19, s20
    v_mfma_f32_16x16x32_bf16 v[236:239], v[76:79], v[56:59], v[236:239]
    v_mfma_f32_16x16x32_bf16 v[240:243], v[64:67], v[60:63], v[240:243]
    v_mfma_f32_16x16x32_bf16 v[244:247], v[68:71], v[60:63], v[244:247]
    v_mfma_f32_16x16x32_bf16 v[248:251], v[72:75], v[60:63], v[248:251]
    v_mfma_f32_16x16x32_bf16 v[252:255], v[76:79], v[60:63], v[252:255]
    s_waitcnt lgkmcnt(0)
    s_waitcnt vmcnt(8)
    s_barrier
    s_cmp_eq_u32 s28, 0
    s_cbranch_scc1 sig_2
    s_cmp_lg_u32 s3, 0
    s_cbranch_scc1 sig_2
    s_mov_b64 exec, 1
    v_mov_b32 v18, s57
    buffer_atomic_add v18, v17, s[4:7], s28 offen sc1
    s_mov_b64 exec, -1
sig_2:
    s_mov_b32 s28, 0
    v_mfma_f32_16x16x32_bf16 v[128:131], v[112:115], v[80:83], v[128:131]
    ds_read_b64_tr_b16 v[64:65], v8 offset:16384
    v_mfma_f32_16x16x32_bf16 v[132:135], v[116:119], v[80:83], v[132:135]
    ds_read_b64_tr_b16 v[66:67], v9 offset:16384
    v_mfma_f32_16x16x32_bf16 v[136:139], v[120:123], v[80:83], v[136:139]
    ds_read_b64_tr_b16 v[68:69], v10 offset:16384
    v_mfma_f32_16x16x32_bf16 v[140:143], v[124:127], v[80:83], v[140:143]
    ds_read_b64_tr_b16 v[70:71], v11 offset:16384
    v_mfma_f32_16x16x32_bf16 v[144:147], v[112:115], v[84:87], v[144:147]
    ds_read_b64_tr_b16 v[72:73], v8 offset:24576
    v_mfma_f32_16x16x32_bf16 v[148:151], v[116:119], v[84:87], v[148:151]
    ds_read_b64_tr_b16 v[74:75], v9 offset:24576
    v_mfma_f32_16x16x32_bf16 v[152:155], v[120:123], v[84:87], v[152:155]
    ds_read_b64_tr_b16 v[76:77], v10 offset:24576
    v_mfma_f32_16x16x32_bf16 v[156:159], v[124:127], v[84:87], v[156:159]
    ds_read_b64_tr_b16 v[78:79], v11 offset:24576
    v_mfma_f32_16x16x32_bf16 v[160:163], v[112:115], v[88:91], v[160:163]
    ds_read_b128 v[32:35], v5 offset:0
    v_mfma_f32_16x16x32_bf16 v[164:167], v[116:119], v[88:91], v[164:167]
    ds_read_b128 v[36:39], v5 offset:1024
    v_mfma_f32_16x16x32_bf16 v[168:171], v[120:123], v[88:91], v[168:171]
    ds_read_b128 v[40:43], v5 offset:2048
    v_mfma_f32_16x16x32_bf16 v[172:175], v[124:127], v[88:91], v[172:175]
    ds_read_b128 v[44:47], v5 offset:3072
    v_mfma_f32_16x16x32_bf16 v[176:179], v[112:115], v[92:95], v[176:179]
    ds_read_b128 v[48:51], v5 offset:4096
    v_mfma_f32_16x16x32_bf16 v[180:183], v[116:119], v[92:95], v[180:183]
    ds_read_b128 v[52:55], v5 offset:5120
    v_mfma_f32_16x16x32_bf16 v[184:187], v[120:123], v[92:95], v[184:187]
    ds_read_b128 v[56:59], v5 offset:6144
    v_mfma_f32_16x16x32_bf16 v[188:191], v[124:127], v[92:95], v[188:191]
    ds_read_b128 v[60:63], v5 offset:7168
    v_mfma_f32_16x16x32_bf16 v[192:195], v[112:115], v[96:99], v[192:195]
    v_mfma_f32_16x16x32_bf16 v[196:199], v[116:119], v[96:99], v[196:199]
    s_add_u32 m0, s21, 98304
    s_nop 0
    buffer_load_dwordx4 v1, s[4:7], s16 offen sc1 lds
    s_add_u32 s16, s16, s62
    v_mfma_f32_16x16x32_bf16 v[200:203], v[120:123], v[96:99], v[200:203]
    v_mfma_f32_16x16x32_bf16 v[204:207], v[124:127], v[96:99], v[204:207]
    v_mfma_f32_16x16x32_bf16 v[208:211], v[112:115], v[100:103], v[208:211]
    s_add_u32 m0, s21, 99328
    s_nop 0
    buffer_load_dwordx4 v1, s[4:7], s17 offen sc1 lds
    s_add_u32 s17, s17, s62
    v_mfma_f32_16x16x32_bf16 v[212:215], v[116:119], v[100:103], v[212:215]
    v_mfma_f32_16x16x32_bf16 v[216:219], v[120:123], v[100:103], v[216:219]
    v_mfma_f32_16x16x32_bf16 v[220:223], v[124:127], v[100:103], v[220:223]
    s_add_u32 m0, s22, 98304
    s_nop 0
    buffer_load_dwordx4 v2, s[8:11], s18 offen lds
    s_add_u32 s18, s18, s20
    v_mfma_f32_16x16x32_bf16 v[224:227], v[112:115], v[104:107], v[224:227]
    v_mfma_f32_16x16x32_bf16 v[228:231], v[116:119], v[104:107], v[228:231]
    v_mfma_f32_16x16x32_bf16 v[232:235], v[120:123], v[104:107], v[232:235]
    s_add_u32 m0, s22, 106496
    s_nop 0
    buffer_load_dwordx4 v2, s[12:15], s19 offen lds
    s_add_u32 s19, s19, s20
    v_mfma_f32_16x16x32_bf16 v[236:239], v[124:127], v[104:107], v[236:239]
    v_mfma_f32_16x16x32_bf16 v[240:243], v[112:115], v[108:111], v[240:243]
    v_mfma_f32_16x16x32_bf16 v[244:247], v[116:119], v[108:111], v[244:247]
    v_mfma_f32_16x16x32_bf16 v[248:251], v[120:123], v[108:111], v[248:251]
    v_mfma_f32_16x16x32_bf16 v[252:255], v[124:127], v[108:111], v[252:255]
    s_waitcnt lgkmcnt(0)
    s_branch w_loop_chk
w_first8:
    s_waitcnt vmcnt(16)
    s_barrier
    v_mfma_f32_16x16x32_bf16 v[128:131], v[64:67], v[32:35], 0
    ds_read_b64_tr_b16 v[112:113], v8 offset:49152
    v_mfma_f32_16x16x32_bf16 v[132:135], v[68:71], v[32:35], 0
    ds_read_b64_tr_b16 v[114:115], v9 offset:49152
    v_mfma_f32_16x16x32_bf16 v[136:139], v[72:75], v[32:35], 0
    ds_read_b64_tr_b16 v[116:117], v10 offset:49152
    v_mfma_f32_16x16x32_bf16 v[140:143], v[76:79], v[32:35], 0
    ds_read_b64_tr_b16 v[118:119], v11 offset:49152
    v_mfma_f32_16x16x32_bf16 v[144:147], v[64:67], v[36:39], 0
    ds_read_b64_tr_b16 v[120:121], v8 offset:57344
    v_mfma_f32_16x16x32_bf16 v[148:151], v[68:71], v[36:39], 0
    ds_read_b64_tr_b16 v[122:123], v9 offset:57344
    v_mfma_f32_16x16x32_bf16 v[152:155], v[72:75], v[36:39], 0
    ds_read_b64_tr_b16 v[124:125], v10 offset:57344
    v_mfma_f32_16x16x32_bf16 v[156:159], v[76:79], v[36:39], 0
    ds_read_b64_tr_b16 v[126:127], v11 offset:57344
    v_mfma_f32_16x16x32_bf16 v[160:163], v[64:67], v[40:43], 0
    ds_read_b128 v[80:83], v5 offset:32768
    v_mfma_f32_16x16x32_bf16 v[164:167], v[68:71], v[40:43], 0
    ds_read_b128 v[84:87], v5 offset:33792
    v_mfma_f32_16x16x32_bf16 v[168:171], v[72:75], v[40:43], 0
    ds_read_b128 v[88:91], v5 offset:34816
    v_mfma_f32_16x16x32_bf16 v[172:175], v[76:79], v[40:43], 0
    ds_read_b128 v[92:95], v5 offset:35840
    v_mfma_f32_16x16x32_bf16 v[176:179], v[64:67], v[44:47], 0
    ds_read_b128 v[96:99], v5 offset:36864
    v_mfma_f32_16x16x32_bf16 v[180:183], v[68:71], v[44:47], 0
    ds_read_b128 v[100:103], v5 offset:37888
    v_mfma_f32_16x16x32_bf16 v[184:187], v[72:75], v[44:47], 0
    ds_read_b128 v[104:107], v5 offset:38912
    v_mfma_f32_16x16x32_bf16 v[188:191], v[76:79], v[44:47], 0
    ds_read_b128 v[108:111], v5 offset:39936
    v_mfma_f32_16x16x32_bf16 v[192:195], v[64:67], v[48:51], 0
    v_mfma_f32_16x16x32_bf16 v[196:199], v[68:71], v[48:51], 0
    s_add_u32 m0, s21, 0
    s_nop 0
    buffer_load_dwordx4 v1, s[4:7], s16 offen sc1 lds
    s_add_u32 s16, s16, s62
    v_mfma_f32_16x16x32_bf16 v[200:203], v[72:75], v[48:51], 0
    v_mfma_f32_16x16x32_bf16 v[204:207], v[76:79], v[48:51], 0
    v_mfma_f32_16x16x32_bf16 v[208:211], v[64:67], v[52:55], 0
    s_add_u32 m0, s21, 1024
    s_nop 0
    buffer_load_dwordx4 v1, s[4:7], s17 offen sc1 lds
    s_add_u32 s17, s17, s62
    v_mfma_f32_16x16x32_bf16 v[212:215], v[68:71], v[52:55], 0
    v_mfma_f32_16x16x32_bf16 v[216:219], v[72:75], v[52:55], 0
    v_mfma_f32_16x16x32_bf16 v[220:223], v[76:79], v[52:55], 0
    s_add_u32 m0, s22, 0
    s_nop 0
    buffer_load_dwordx4 v2, s[8:11], s18 offen lds
    s_add_u32 s18, s18, s20
    v_mfma_f32_16x16x32_bf16 v[224:227], v[64:67], v[56:59], 0
    v_mfma_f32_16x16x32_bf16 v[228:231], v[68:71], v[56:59], 0
    v_mfma_f32_16x16x32_bf16 v[232:235], v[72:75], v[56:59], 0
    s_add_u32 m0, s22, 8192
    s_nop 0
    buffer_load_dwordx4 v2, s[12:15], s19 offen lds
    s_add_u32 s19, s19, s20
    v_mfma_f32_16x16x32_bf16 v[236:239], v[76:79], v[56:59], 0
    v_mfma_f32_16x16x32_bf16 v[240:243], v[64:67], v[60:63], 0
    v_mfma_f32_16x16x32_bf16 v[244:247], v[68:71], v[60:63], 0
    v_mfma_f32_16x16x32_bf16 v[248:251], v[72:75], v[60:63], 0
    v_mfma_f32_16x16x32_bf16 v[252:255], v[76:79], v[60:63], 0
    s_waitcnt lgkmcnt(0)
    s_waitcnt vmcnt(16)
    s_barrier
    v_mfma_f32_16x16x32_bf16 v[128:131], v[112:115], v[80:83], v[128:131]
    ds_read_b64_tr_b16 v[64:65], v12 offset:16384
    v_mfma_f32_16x16x32_bf16 v[132:135], v[116:119], v[80:83], v[132:135]
    ds_read_b64_tr_b16 v[66:67], v13 offset:16384
    v_mfma_f32_16x16x32_bf16 v[136:139], v[120:123], v[80:83], v[136:139]
    ds_read_b64_tr_b16 v[68:69], v14 offset:16384
    v_mfma_f32_16x16x32_bf16 v[140:143], v[124:127], v[80:83], v[140:143]
    ds_read_b64_tr_b16 v[70:71], v15 offset:16384
    v_mfma_f32_16x16x32_bf16 v[144:147], v[112:115], v[84:87], v[144:147]
    ds_read_b64_tr_b16 v[72:73], v12 offset:24576
    v_mfma_f32_16x16x32_bf16 v[148:151], v[116:119], v[84:87], v[148:151]
    ds_read_b64_tr_b16 v[74:75], v13 offset:24576
    v_mfma_f32_16x16x32_bf16 v[152:155], v[120:123], v[84:87], v[152:155]
    ds_read_b64_tr_b16 v[76:77], v14 offset:24576
    v_mfma_f32_16x16x32_bf16 v[156:159], v[124:127], v[84:87], v[156:159]
    ds_read_b64_tr_b16 v[78:79], v15 offset:24576
    v_mfma_f32_16x16x32_bf16 v[160:163], v[112:115], v[88:91], v[160:163]
    ds_read_b128 v[32:35], v6 offset:0
    v_mfma_f32_16x16x32_bf16 v[164:167], v[116:119], v[88:91], v[164:167]
    ds_read_b128 v[36:39], v6 offset:1024
    v_mfma_f32_16x16x32_bf16 v[168:171], v[120:123], v[88:91], v[168:171]
    ds_read_b128 v[40:43], v6 offset:2048
    v_mfma_f32_16x16x32_bf16 v[172:175], v[124:127], v[88:91], v[172:175]
    ds_read_b128 v[44:47], v6 offset:3072
    v_mfma_f32_16x16x32_bf16 v[176:179], v[112:115], v[92:95], v[176:179]
    ds_read_b128 v[48:51], v6 offset:4096
    v_mfma_f32_16x16x32_bf16 v[180:183], v[116:119], v[92:95], v[180:183]
    ds_read_b128 v[52:55], v6 offset:5120
    v_mfma_f32_16x16x32_bf16 v[184:187], v[120:123], v[92:95], v[184:187]
    ds_read_b128 v[56:59], v6 offset:6144
    v_mfma_f32_16x16x32_bf16 v[188:191], v[124:127], v[92:95], v[188:191]
    ds_read_b128 v[60:63], v6 offset:7168
    v_mfma_f32_16x16x32_bf16 v[192:195], v[112:115], v[96:99], v[192:195]
    v_mfma_f32_16x16x32_bf16 v[196:199], v[116:119], v[96:99], v[196:199]
    s_add_u32 m0, s21, 32768
    s_nop 0
    buffer_load_dwordx4 v1, s[4:7], s16 offen sc1 lds
    s_add_u32 s16, s16, s62
    v_mfma_f32_16x16x32_bf16 v[200:203], v[120:123], v[96:99], v[200:203]
    v_mfma_f32_16x16x32_bf16 v[204:207], v[124:127], v[96:99], v[204:207]
    v_mfma_f32_16x16x32_bf16 v[208:211], v[112:115], v[100:103], v[208:211]
    s_add_u32 m0, s21, 33792
    s_nop 0
    buffer_load_dwordx4 v1, s[4:7], s17 offen sc1 lds
    s_add_u32 s17, s17, s62
    v_mfma_f32_16x16x32_bf16 v[212:215], v[116:119], v[100:103], v[212:215]
    v_mfma_f32_16x16x32_bf16 v[216:219], v[120:123], v[100:103], v[216:219]
    v_mfma_f32_16x16x32_bf16 v[220:223], v[124:127], v[100:103], v[220:223]
    s_add_u32 m0, s22, 32768
    s_nop 0
    buffer_load_dwordx4 v2, s[8:11], s18 offen lds
    s_add_u32 s18, s18, s20
    v_mfma_f32_16x16x32_bf16 v[224:227], v[112:115], v[104:107], v[224:227]
    v_mfma_f32_16x16x32_bf16 v[228:231], v[116:119], v[104:107], v[228:231]
    v_mfma_f32_16x16x32_bf16 v[232:235], v[120:123], v[104:107], v[232:235]
    s_add_u32 m0, s22, 40960
    s_nop 0
    buffer_load_dwordx4 v2, s[12:15], s19 offen lds
    s_add_u32 s19, s19, s20
    v_mfma_f32_16x16x32_bf16 v[236:239], v[124:127], v[104:107], v[236:239]
    v_mfma_f32_16x16x32_bf16 v[240:243], v[112:115], v[108:111], v[240:243]
    v_mfma_f32_16x16x32_bf16 v[244:247], v[116:119], v[108:111], v[244:247]
    v_mfma_f32_16x16x32_bf16 v[248:251], v[120:123], v[108:111], v[248:251]
    v_mfma_f32_16x16x32_bf16 v[252:255], v[124:127], v[108:111], v[252:255]
    s_waitcnt lgkmcnt(0)
    s_waitcnt vmcnt(16)
    s_barrier
    v_mfma_f32_16x16x32_bf16 v[128:131], v[64:67], v[32:35], v[128:131]
    ds_read_b64_tr_b16 v[112:113], v12 offset:49152
    v_mfma_f32_16x16x32_bf16 v[132:135], v[68:71], v[32:35], v[132:135]
    ds_read_b64_tr_b16 v[114:115], v13 offset:49152
    v_mfma_f32_16x16x32_bf16 v[136:139], v[72:75], v[32:35], v[136:139]
    ds_read_b64_tr_b16 v[116:117], v14 offset:49152
    v_mfma_f32_16x16x32_bf16 v[140:143], v[76:79], v[32:35], v[140:143]
    ds_read_b64_tr_b16 v[118:119], v15 offset:49152
    v_mfma_f32_16x16x32_bf16 v[144:147], v[64:67], v[36:39], v[144:147]
    ds_read_b64_tr_b16 v[120:121], v12 offset:57344
    v_mfma_f32_16x16x32_bf16 v[148:151], v[68:71], v[36:39], v[148:151]
    ds_read_b64_tr_b16 v[122:123], v13 offset:57344
    v_mfma_f32_16x16x32_bf16 v[152:155], v[72:75], v[36:39], v[152:155]
    ds_read_b64_tr_b16 v[124:125], v14 offset:57344
    v_mfma_f32_16x16x32_bf16 v[156:159], v[76:79], v[36:39], v[156:159]
    ds_read_b64_tr_b16 v[126:127], v15 offset:57344
    v_mfma_f32_16x16x32_bf16 v[160:163], v[64:67], v[40:43], v[160:163]
    ds_read_b128 v[80:83], v6 offset:32768
    v_mfma_f32_16x16x32_bf16 v[164:167], v[68:71], v[40:43], v[164:167]
    ds_read_b128 v[84:87], v6 offset:33792
    v_mfma_f32_16x16x32_bf16 v[168:171], v[72:75], v[40:43], v[168:171]
    ds_read_b128 v[88:91], v6 offset:34816
    v_mfma_f32_16x16x32_bf16 v[172:175], v[76:79], v[40:43], v[172:175]
    ds_read_b128 v[92:95], v6 offset:35840
    v_mfma_f32_16x16x32_bf16 v[176:179], v[64:67], v[44:47], v[176:179]
    ds_read_b128 v[96:99], v6 offset:36864
    v_mfma_f32_16x16x32_bf16 v[180:183], v[68:71], v[44:47], v[180:183]
    ds_read_b128 v[100:103], v6 offset:37888
    v_mfma_f32_16x16x32_bf16 v[184:187], v[72:75], v[44:47], v[184:187]
    ds_read_b128 v[104:107], v6 offset:38912
    v_mfma_f32_16x16x32_bf16 v[188:191], v[76:79], v[44:47], v[188:191]
    ds_read_b128 v[108:111], v6 offset:39936
    v_mfma_f32_16x16x32_bf16 v[192:195], v[64:67], v[48:51], v[192:195]
    v_mfma_f32_16x16x32_bf16 v[196:199], v[68:71], v[48:51], v[196:199]
    s_add_u32 m0, s21, 65536
    s_nop 0
    buffer_load_dwordx4 v1, s[4:7], s16 offen sc1 lds
    s_add_u32 s16, s16, s62
    v_mfma_f32_16x16x32_bf16 v[200:203], v[72:75], v[48:51], v[200:203]
    v_mfma_f32_16x16x32_bf16 v[204:207], v[76:79], v[48:51], v[204:207]
    v_mfma_f32_16x16x32_bf16 v[208:211], v[64:67], v[52:55], v[208:211]
    s_add_u32 m0, s21, 66560
    s_nop 0
    buffer_load_dwordx4 v1, s[4:7], s17 offen sc1 lds
    s_add_u32 s17, s17, s62
    v_mfma_f32_16x16x32_bf16 v[212:215], v[68:71], v[52:55], v[212:215]
    v_mfma_f32_16x16x32_bf16 v[216:219], v[72:75], v[52:55], v[216:219]
    v_mfma_f32_16x16x32_bf16 v[220:223], v[76:79], v[52:55], v[220:223]
    s_add_u32 m0, s22, 65536
    s_nop 0
    buffer_load_dwordx4 v2, s[8:11], s18 offen lds
    s_add_u32 s18, s18, s20
    v_mfma_f32_16x16x32_bf16 v[224:227], v[64:67], v[56:59], v[224:227]
    v_mfma_f32_16x16x32_bf16 v[228:231], v[68:71], v[56:59], v[228:231]
    v_mfma_f32_16x16x32_bf16 v[232:235], v[72:75], v[56:59], v[232:235]
    s_add_u32 m0, s22, 73728
    s_nop 0
    buffer_load_dwordx4 v2, s[12:15], s19 offen lds
    s_add_u32 s19, s19, s20
    v_mfma_f32_16x16x32_bf16 v[236:239], v[76:79], v[56:59], v[236:239]
    v_mfma_f32_16x16x32_bf16 v[240:243], v[64:67], v[60:63], v[240:243]
    v_mfma_f32_16x16x32_bf16 v[244:247], v[68:71], v[60:63], v[244:247]
    v_mfma_f32_16x16x32_bf16 v[248:251], v[72:75], v[60:63], v[248:251]
    v_mfma_f32_16x16x32_bf16 v[252:255], v[76:79], v[60:63], v[252:255]
    s_waitcnt lgkmcnt(0)
    s_waitcnt vmcnt(8)
    s_barrier
    s_cmp_eq_u32 s28, 0
    s_cbranch_scc1 sig_3
    s_cmp_lg_u32 s3, 0
    s_cbranch_scc1 sig_3
    s_mov_b64 exec, 1
    v_mov_b32 v18, s57
    buffer_atomic_add v18, v17, s[4:7], s28 offen sc1
    s_mov_b64 exec, -1
sig_3:
    s_mov_b32 s28, 0
    v_mfma_f32_16x16x32_bf16 v[128:131], v[112:115], v[80:83], v[128:131]
    ds_read_b64_tr_b16 v[64:65], v8 offset:16384
    v_mfma_f32_16x16x32_bf16 v[132:135], v[116:119], v[80:83], v[132:135]
    ds_read_b64_tr_b16 v[66:67], v9 offset:16384
    v_mfma_f32_16x16x32_bf16 v[136:139], v[120:123], v[80:83], v[136:139]
    ds_read_b64_tr_b16 v[68:69], v10 offset:16384
    v_mfma_f32_16x16x32_bf16 v[140:143], v[124:127], v[80:83], v[140:143]
    ds_read_b64_tr_b16 v[70:71], v11 offset:16384
    v_mfma_f32_16x16x32_bf16 v[144:147], v[112:115], v[84:87], v[144:147]
    ds_read_b64_tr_b16 v[72:73], v8 offset:24576
    v_mfma_f32_16x16x32_bf16 v[148:151], v[116:119], v[84:87], v[148:151]
    ds_read_b64_tr_b16 v[74:75], v9 offset:24576
    v_mfma_f32_16x16x32_bf16 v[152:155], v[120:123], v[84:87], v[152:155]
    ds_read_b64_tr_b16 v[76:77], v10 offset:24576
    v_mfma_f32_16x16x32_bf16 v[156:159], v[124:127], v[84:87], v[156:159]
    ds_read_b64_tr_b16 v[78:79], v11 offset:24576
    v_mfma_f32_16x16x32_bf16 v[160:163], v[112:115], v[88:91], v[160:163]
    ds_read_b128 v[32:35], v5 offset:0
    v_mfma_f32_16x16x32_bf16 v[164:167], v[116:119], v[88:91], v[164:167]
    ds_read_b128 v[36:39], v5 offset:1024
    v_mfma_f32_16x16x32_bf16 v[168:171], v[120:123], v[88:91], v[168:171]
    ds_read_b128 v[40:43], v5 offset:2048
    v_mfma_f32_16x16x32_bf16 v[172:175], v[124:127], v[88:91], v[172:175]
    ds_read_b128 v[44:47], v5 offset:3072
    v_mfma_f32_16x16x32_bf16 v[176:179], v[112:115], v[92:95], v[176:179]
    ds_read_b128 v[48:51], v5 offset:4096
    v_mfma_f32_16x16x32_bf16 v[180:183], v[116:119], v[92:95], v[180:183]
    ds_read_b128 v[52:55], v5 offset:5120
    v_mfma_f32_16x16x32_bf16 v[184:187], v[120:123], v[92:95], v[184:187]
    ds_read_b128 v[56:59], v5 offset:6144
    v_mfma_f32_16x16x32_bf16 v[188:191], v[124:127], v[92:95], v[188:191]
    ds_read_b128 v[60:63], v5 offset:7168
    v_mfma_f32_16x16x32_bf16 v[192:195], v[112:115], v[96:99], v[192:195]
    v_mfma_f32_16x16x32_bf16 v[196:199], v[116:119], v[96:99], v[196:199]
    s_add_u32 m0, s21, 98304
    s_nop 0
    buffer_load_dwordx4 v1, s[4:7], s16 offen sc1 lds
    s_add_u32 s16, s16, s62
    v_mfma_f32_16x16x32_bf16 v[200:203], v[120:123], v[96:99], v[200:203]
    v_mfma_f32_16x16x32_bf16 v[204:207], v[124:127], v[96:99], v[204:207]
    v_mfma_f32_16x16x32_bf16 v[208:211], v[112:115], v[100:103], v[208:211]
    s_add_u32 m0, s21, 99328
    s_nop 0
    buffer_load_dwordx4 v1, s[4:7], s17 offen sc1 lds
    s_add_u32 s17, s17, s62
    v_mfma_f32_16x16x32_bf16 v[212:215], v[116:119], v[100:103], v[212:215]
    v_mfma_f32_16x16x32_bf16 v[216:219], v[120:123], v[100:103], v[216:219]
    v_mfma_f32_16x16x32_bf16 v[220:223], v[124:127], v[100:103], v[220:223]
    s_add_u32 m0, s22, 98304
    s_nop 0
    buffer_load_dwordx4 v2, s[8:11], s18 offen lds
    s_add_u32 s18, s18, s20
    v_mfma_f32_16x16x32_bf16 v[224:227], v[112:115], v[104:107], v[224:227]
    v_mfma_f32_16x16x32_bf16 v[228:231], v[116:119], v[104:107], v[228:231]
    v_mfma_f32_16x16x32_bf16 v[232:235], v[120:123], v[104:107], v[232:235]
    s_add_u32 m0, s22, 106496
    s_nop 0
    buffer_load_dwordx4 v2, s[12:15], s19 offen lds
    s_add_u32 s19, s19, s20
    v_mfma_f32_16x16x32_bf16 v[236:239], v[124:127], v[104:107], v[236:239]
    v_mfma_f32_16x16x32_bf16 v[240:243], v[112:115], v[108:111], v[240:243]
    v_mfma_f32_16x16x32_bf16 v[244:247], v[116:119], v[108:111], v[244:247]
    v_mfma_f32_16x16x32_bf16 v[248:251], v[120:123], v[108:111], v[248:251]
    v_mfma_f32_16x16x32_bf16 v[252:255], v[124:127], v[108:111], v[252:255]
    s_waitcnt lgkmcnt(0)
    s_branch w_loop_chk
w_first16:
    s_waitcnt vmcnt(24)
    s_barrier
    v_mfma_f32_16x16x32_bf16 v[128:131], v[64:67], v[32:35], 0
    ds_read_b64_tr_b16 v[112:113], v8 offset:49152
    v_mfma_f32_16x16x32_bf16 v[132:135], v[68:71], v[32:35], 0
    ds_read_b64_tr_b16 v[114:115], v9 offset:49152
    v_mfma_f32_16x16x32_bf16 v[136:139], v[72:75], v[32:35], 0
    ds_read_b64_tr_b16 v[116:117], v10 offset:49152
    v_mfma_f32_16x16x32_bf16 v[140:143], v[76:79], v[32:35], 0
    ds_read_b64_tr_b16 v[118:119], v11 offset:49152
    v_mfma_f32_16x16x32_bf16 v[144:147], v[64:67], v[36:39], 0
    ds_read_b64_tr_b16 v[120:121], v8 offset:57344
    v_mfma_f32_16x16x32_bf16 v[148:151], v[68:71], v[36:39], 0
    ds_read_b64_tr_b16 v[122:123], v9 offset:57344
    v_mfma_f32_16x16x32_bf16 v[152:155], v[72:75], v[36:39], 0
    ds_read_b64_tr_b16 v[124:125], v10 offset:57344
    v_mfma_f32_16x16x32_bf16 v[156:159], v[76:79], v[36:39], 0
    ds_read_b64_tr_b16 v[126:127], v11 offset:57344
    v_mfma_f32_16x16x32_bf16 v[160:163], v[64:67], v[40:43], 0
    ds_read_b128 v[80:83], v5 offset:32768
    v_mfma_f32_16x16x32_bf16 v[164:167], v[68:71], v[40:43], 0
    ds_read_b128 v[84:87], v5 offset:33792
    v_mfma_f32_16x16x32_bf16 v[168:171], v[72:75], v[40:43], 0
    ds_read_b128 v[88:91], v5 offset:34816
    v_mfma_f32_16x16x32_bf16 v[172:175], v[76:79], v[40:43], 0
    ds_read_b128 v[92:95], v5 offset:35840
    v_mfma_f32_16x16x32_bf16 v[176:179], v[64:67], v[44:47], 0
    ds_read_b128 v[96:99], v5 offset:36864
    v_mfma_f32_16x16x32_bf16 v[180:183], v[68:71], v[44:47], 0
    ds_read_b128 v[100:103], v5 offset:37888
    v_mfma_f32_16x16x32_bf16 v[184:187], v[72:75], v[44:47], 0
    ds_read_b128 v[104:107], v5 offset:38912
    v_mfma_f32_16x16x32_bf16 v[188:191], v[76:79], v[44:47], 0
    ds_read_b128 v[108:111], v5 offset:39936
    v_mfma_f32_16x16x32_bf16 v[192:195], v[64:67], v[48:51], 0
    v_mfma_f32_16x16x32_bf16 v[196:199], v[68:71], v[48:51], 0
    s_add_u32 m0, s21, 0
    s_nop 0
    buffer_load_dwordx4 v1, s[4:7], s16 offen sc1 lds
    s_add_u32 s16, s16, s62
    v_mfma_f32_16x16x32_bf16 v[200:203], v[72:75], v[48:51], 0
    v_mfma_f32_16x16x32_bf16 v[204:207], v[76:79], v[48:51], 0
    v_mfma_f32_16x16x32_bf16 v[208:211], v[64:67], v[52:55], 0
    s_add_u32 m0, s21, 1024
    s_nop 0
    buffer_load_dwordx4 v1, s[4:7], s17 offen sc1 lds
    s_add_u32 s17, s17, s62
    v_mfma_f32_16x16x32_bf16 v[212:215], v[68:71], v[52:55], 0
    v_mfma_f32_16x16x32_bf16 v[216:219], v[72:75], v[52:55], 0
    v_mfma_f32_16x16x32_bf16 v[220:223], v[76:79], v[52:55], 0
    s_add_u32 m0, s22, 0
    s_nop 0
    buffer_load_dwordx4 v2, s[8:11], s18 offen lds
    s_add_u32 s18, s18, s20
    v_mfma_f32_16x16x32_bf16 v[224:227], v[64:67], v[56:59], 0
    v_mfma_f32_16x16x32_bf16 v[228:231], v[68:71], v[56:59], 0
    v_mfma_f32_16x16x32_bf16 v[232:235], v[72:75], v[56:59], 0
    s_add_u32 m0, s22, 8192
    s_nop 0
    buffer_load_dwordx4 v2, s[12:15], s19 offen lds
    s_add_u32 s19, s19, s20
    v_mfma_f32_16x16x32_bf16 v[236:239], v[76:79], v[56:59], 0
    v_mfma_f32_16x16x32_bf16 v[240:243], v[64:67], v[60:63], 0
    v_mfma_f32_16x16x32_bf16 v[244:247], v[68:71], v[60:63], 0
    v_mfma_f32_16x16x32_bf16 v[248:251], v[72:75], v[60:63], 0
    v_mfma_f32_16x16x32_bf16 v[252:255], v[76:79], v[60:63], 0
    s_waitcnt lgkmcnt(0)
    s_waitcnt vmcnt(24)
    s_barrier
    v_mfma_f32_16x16x32_bf16 v[128:131], v[112:115], v[80:83], v[128:131]
    ds_read_b64_tr_b16 v[64:65], v12 offset:16384
    v_mfma_f32_16x16x32_bf16 v[132:135], v[116:119], v[80:83], v[132:135]
    ds_read_b64_tr_b16 v[66:67], v13 offset:16384
    v_mfma_f32_16x16x32_bf16 v[136:139], v[120:123], v[80:83], v[136:139]
    ds_read_b64_tr_b16 v[68:69], v14 offset:16384
    v_mfma_f32_16x16x32_bf16 v[140:143], v[124:127], v[80:83], v[140:143]
    ds_read_b64_tr_b16 v[70:71], v15 offset:16384
    v_mfma_f32_16x16x32_bf16 v[144:147], v[112:115], v[84:87], v[144:147]
    ds_read_b64_tr_b16 v[72:73], v12 offset:24576
    v_mfma_f32_16x16x32_bf16 v[148:151], v[116:119], v[84:87], v[148:151]
    ds_read_b64_tr_b16 v[74:75], v13 offset:24576
    v_mfma_f32_16x16x32_bf16 v[152:155], v[120:123], v[84:87], v[152:155]
    ds_read_b64_tr_b16 v[76:77], v14 offset:24576
    v_mfma_f32_16x16x32_bf16 v[156:159], v[124:127], v[84:87], v[156:159]
    ds_read_b64_tr_b16 v[78:79], v15 offset:24576
    v_mfma_f32_16x16x32_bf16 v[160:163], v[112:115], v[88:91], v[160:163]
    ds_read_b128 v[32:35], v6 offset:0
    v_mfma_f32_16x16x32_bf16 v[164:167], v[116:119], v[88:91], v[164:167]
    ds_read_b128 v[36:39], v6 offset:1024
    v_mfma_f32_16x16x32_bf16 v[168:171], v[120:123], v[88:91], v[168:171]
    ds_read_b128 v[40:43], v6 offset:2048
    v_mfma_f32_16x16x32_bf16 v[172:175], v[124:127], v[88:91], v[172:175]
    ds_read_b128 v[44:47], v6 offset:3072
    v_mfma_f32_16x16x32_bf16 v[176:179], v[112:115], v[92:95], v[176:179]
    ds_read_b128 v[48:51], v6 offset:4096
    v_mfma_f32_16x16x32_bf16 v[180:183], v[116:119], v[92:95], v[180:183]
    ds_read_b128 v[52:55], v6 offset:5120
    v_mfma_f32_16x16x32_bf16 v[184:187], v[120:123], v[92:95], v[184:187]
    ds_read_b128 v[56:59], v6 offset:6144
    v_mfma_f32_16x16x32_bf16 v[188:191], v[124:127], v[92:95], v[188:191]
    ds_read_b128 v[60:63], v6 offset:7168
    v_mfma_f32_16x16x32_bf16 v[192:195], v[112:115], v[96:99], v[192:195]
    v_mfma_f32_16x16x32_bf16 v[196:199], v[116:119], v[96:99], v[196:199]
    s_add_u32 m0, s21, 32768
    s_nop 0
    buffer_load_dwordx4 v1, s[4:7], s16 offen sc1 lds
    s_add_u32 s16, s16, s62
    v_mfma_f32_16x16x32_bf16 v[200:203], v[120:123], v[96:99], v[200:203]
    v_mfma_f32_16x16x32_bf16 v[204:207], v[124:127], v[96:99], v[204:207]
    v_mfma_f32_16x16x32_bf16 v[208:211], v[112:115], v[100:103], v[208:211]
    s_add_u32 m0, s21, 33792
    s_nop 0
    buffer_load_dwordx4 v1, s[4:7], s17 offen sc1 lds
    s_add_u32 s17, s17, s62
    v_mfma_f32_16x16x32_bf16 v[212:215], v[116:119], v[100:103], v[212:215]
    v_mfma_f32_16x16x32_bf16 v[216:219], v[120:123], v[100:103], v[216:219]
    v_mfma_f32_16x16x32_bf16 v[220:223], v[124:127], v[100:103], v[220:223]
    s_add_u32 m0, s22, 32768
    s_nop 0
    buffer_load_dwordx4 v2, s[8:11], s18 offen lds
    s_add_u32 s18, s18, s20
    v_mfma_f32_16x16x32_bf16 v[224:227], v[112:115], v[104:107], v[224:227]
    v_mfma_f32_16x16x32_bf16 v[228:231], v[116:119], v[104:107], v[228:231]
    v_mfma_f32_16x16x32_bf16 v[232:235], v[120:123], v[104:107], v[232:235]
    s_add_u32 m0, s22, 40960
    s_nop 0
    buffer_load_dwordx4 v2, s[12:15], s19 offen lds
    s_add_u32 s19, s19, s20
    v_mfma_f32_16x16x32_bf16 v[236:239], v[124:127], v[104:107], v[236:239]
    v_mfma_f32_16x16x32_bf16 v[240:243], v[112:115], v[108:111], v[240:243]
    v_mfma_f32_16x16x32_bf16 v[244:247], v[116:119], v[108:111], v[244:247]
    v_mfma_f32_16x16x32_bf16 v[248:251], v[120:123], v[108:111], v[248:251]
    v_mfma_f32_16x16x32_bf16 v[252:255], v[124:127], v[108:111], v[252:255]
    s_waitcnt lgkmcnt(0)
    s_waitcnt vmcnt(24)
    s_barrier
    v_mfma_f32_16x16x32_bf16 v[128:131], v[64:67], v[32:35], v[128:131]
    ds_read_b64_tr_b16 v[112:113], v12 offset:49152
    v_mfma_f32_16x16x32_bf16 v[132:135], v[68:71], v[32:35], v[132:135]
    ds_read_b64_tr_b16 v[114:115], v13 offset:49152
    v_mfma_f32_16x16x32_bf16 v[136:139], v[72:75], v[32:35], v[136:139]
    ds_read_b64_tr_b16 v[116:117], v14 offset:49152
    v_mfma_f32_16x16x32_bf16 v[140:143], v[76:79], v[32:35], v[140:143]
    ds_read_b64_tr_b16 v[118:119], v15 offset:49152
    v_mfma_f32_16x16x32_bf16 v[144:147], v[64:67], v[36:39], v[144:147]
    ds_read_b64_tr_b16 v[120:121], v12 offset:57344
    v_mfma_f32_16x16x32_bf16 v[148:151], v[68:71], v[36:39], v[148:151]
    ds_read_b64_tr_b16 v[122:123], v13 offset:57344
    v_mfma_f32_16x16x32_bf16 v[152:155], v[72:75], v[36:39], v[152:155]
    ds_read_b64_tr_b16 v[124:125], v14 offset:57344
    v_mfma_f32_16x16x32_bf16 v[156:159], v[76:79], v[36:39], v[156:159]
    ds_read_b64_tr_b16 v[126:127], v15 offset:57344
    v_mfma_f32_16x16x32_bf16 v[160:163], v[64:67], v[40:43], v[160:163]
    ds_read_b128 v[80:83], v6 offset:32768
    v_mfma_f32_16x16x32_bf16 v[164:167], v[68:71], v[40:43], v[164:167]
    ds_read_b128 v[84:87], v6 offset:33792
    v_mfma_f32_16x16x32_bf16 v[168:171], v[72:75], v[40:43], v[168:171]
    ds_read_b128 v[88:91], v6 offset:34816
    v_mfma_f32_16x16x32_bf16 v[172:175], v[76:79], v[40:43], v[172:175]
    ds_read_b128 v[92:95], v6 offset:35840
    v_mfma_f32_16x16x32_bf16 v[176:179], v[64:67], v[44:47], v[176:179]
    ds_read_b128 v[96:99], v6 offset:36864
    v_mfma_f32_16x16x32_bf16 v[180:183], v[68:71], v[44:47], v[180:183]
    ds_read_b128 v[100:103], v6 offset:37888
    v_mfma_f32_16x16x32_bf16 v[184:187], v[72:75], v[44:47], v[184:187]
    ds_read_b128 v[104:107], v6 offset:38912
    v_mfma_f32_16x16x32_bf16 v[188:191], v[76:79], v[44:47], v[188:191]
    ds_read_b128 v[108:111], v6 offset:39936
    v_mfma_f32_16x16x32_bf16 v[192:195], v[64:67], v[48:51], v[192:195]
    v_mfma_f32_16x16x32_bf16 v[196:199], v[68:71], v[48:51], v[196:199]
    s_add_u32 m0, s21, 65536
    s_nop 0
    buffer_load_dwordx4 v1, s[4:7], s16 offen sc1 lds
    s_add_u32 s16, s16, s62
    v_mfma_f32_16x16x32_bf16 v[200:203], v[72:75], v[48:51], v[200:203]
    v_mfma_f32_16x16x32_bf16 v[204:207], v[76:79], v[48:51], v[204:207]
    v_mfma_f32_16x16x32_bf16 v[208:211], v[64:67], v[52:55], v[208:211]
    s_add_u32 m0, s21, 66560
    s_nop 0
    buffer_load_dwordx4 v1, s[4:7], s17 offen sc1 lds
    s_add_u32 s17, s17, s62
    v_mfma_f32_16x16x32_bf16 v[212:215], v[68:71], v[52:55], v[212:215]
    v_mfma_f32_16x16x32_bf16 v[216:219], v[72:75], v[52:55], v[216:219]
    v_mfma_f32_16x16x32_bf16 v[220:223], v[76:79], v[52:55], v[220:223]
    s_add_u32 m0, s22, 65536
    s_nop 0
    buffer_load_dwordx4 v2, s[8:11], s18 offen lds
    s_add_u32 s18, s18, s20
    v_mfma_f32_16x16x32_bf16 v[224:227], v[64:67], v[56:59], v[224:227]
    v_mfma_f32_16x16x32_bf16 v[228:231], v[68:71], v[56:59], v[228:231]
    v_mfma_f32_16x16x32_bf16 v[232:235], v[72:75], v[56:59], v[232:235]
    s_add_u32 m0, s22, 73728
    s_nop 0
    buffer_load_dwordx4 v2, s[12:15], s19 offen lds
    s_add_u32 s19, s19, s20
    v_mfma_f32_16x16x32_bf16 v[236:239], v[76:79], v[56:59], v[236:239]
    v_mfma_f32_16x16x32_bf16 v[240:243], v[64:67], v[60:63], v[240:243]
    v_mfma_f32_16x16x32_bf16 v[244:247], v[68:71], v[60:63], v[244:247]
    v_mfma_f32_16x16x32_bf16 v[248:251], v[72:75], v[60:63], v[248:251]
    v_mfma_f32_16x16x32_bf16 v[252:255], v[76:79], v[60:63], v[252:255]
    s_waitcnt lgkmcnt(0)
    s_waitcnt vmcnt(8)
    s_barrier
    s_cmp_eq_u32 s28, 0
    s_cbranch_scc1 sig_4
    s_cmp_lg_u32 s3, 0
    s_cbranch_scc1 sig_4
    s_mov_b64 exec, 1
    v_mov_b32 v18, s57
    buffer_atomic_add v18, v17, s[4:7], s28 offen sc1
    s_mov_b64 exec, -1
sig_4:
    s_mov_b32 s28, 0
    v_mfma_f32_16x16x32_bf16 v[128:131], v[112:115], v[80:83], v[128:131]
    ds_read_b64_tr_b16 v[64:65], v8 offset:16384
    v_mfma_f32_16x16x32_bf16 v[132:135], v[116:119], v[80:83], v[132:135]
    ds_read_b64_tr_b16 v[66:67], v9 offset:16384
    v_mfma_f32_16x16x32_bf16 v[136:139], v[120:123], v[80:83], v[136:139]
    ds_read_b64_tr_b16 v[68:69], v10 offset:16384
    v_mfma_f32_16x16x32_bf16 v[140:143], v[124:127], v[80:83], v[140:143]
    ds_read_b64_tr_b16 v[70:71], v11 offset:16384
    v_mfma_f32_16x16x32_bf16 v[144:147], v[112:115], v[84:87], v[144:147]
    ds_read_b64_tr_b16 v[72:73], v8 offset:24576
    v_mfma_f32_16x16x32_bf16 v[148:151], v[116:119], v[84:87], v[148:151]
    ds_read_b64_tr_b16 v[74:75], v9 offset:24576
    v_mfma_f32_16x16x32_bf16 v[152:155], v[120:123], v[84:87], v[152:155]
    ds_read_b64_tr_b16 v[76:77], v10 offset:24576
    v_mfma_f32_16x16x32_bf16 v[156:159], v[124:127], v[84:87], v[156:159]
    ds_read_b64_tr_b16 v[78:79], v11 offset:24576
    v_mfma_f32_16x16x32_bf16 v[160:163], v[112:115], v[88:91], v[160:163]
    ds_read_b128 v[32:35], v5 offset:0
    v_mfma_f32_16x16x32_bf16 v[164:167], v[116:119], v[88:91], v[164:167]
    ds_read_b128 v[36:39], v5 offset:1024
    v_mfma_f32_16x16x32_bf16 v[168:171], v[120:123], v[88:91], v[168:171]
    ds_read_b128 v[40:43], v5 offset:2048
    v_mfma_f32_16x16x32_bf16 v[172:175], v[124:127], v[88:91], v[172:175]
    ds_read_b128 v[44:47], v5 offset:3072
    v_mfma_f32_16x16x32_bf16 v[176:179], v[112:115], v[92:95], v[176:179]
    ds_read_b128 v[48:51], v5 offset:4096
    v_mfma_f32_16x16x32_bf16 v[180:183], v[116:119], v[92:95], v[180:183]
    ds_read_b128 v[52:55], v5 offset:5120
    v_mfma_f32_16x16x32_bf16 v[184:187], v[120:123], v[92:95], v[184:187]
    ds_read_b128 v[56:59], v5 offset:6144
    v_mfma_f32_16x16x32_bf16 v[188:191], v[124:127], v[92:95], v[188:191]
    ds_read_b128 v[60:63], v5 offset:7168
    v_mfma_f32_16x16x32_bf16 v[192:195], v[112:115], v[96:99], v[192:195]
    v_mfma_f32_16x16x32_bf16 v[196:199], v[116:119], v[96:99], v[196:199]
    s_add_u32 m0, s21, 98304
    s_nop 0
    buffer_load_dwordx4 v1, s[4:7], s16 offen sc1 lds
    s_add_u32 s16, s16, s62
    v_mfma_f32_16x16x32_bf16 v[200:203], v[120:123], v[96:99], v[200:203]
    v_mfma_f32_16x16x32_bf16 v[204:207], v[124:127], v[96:99], v[204:207]
    v_mfma_f32_16x16x32_bf16 v[208:211], v[112:115], v[100:103], v[208:211]
    s_add_u32 m0, s21, 99328
    s_nop 0
    buffer_load_dwordx4 v1, s[4:7], s17 offen sc1 lds
    s_add_u32 s17, s17, s62
    v_mfma_f32_16x16x32_bf16 v[212:215], v[116:119], v[100:103], v[212:215]
    v_mfma_f32_16x16x32_bf16 v[216:219], v[120:123], v[100:103], v[216:219]
    v_mfma_f32_16x16x32_bf16 v[220:223], v[124:127], v[100:103], v[220:223]
    s_add_u32 m0, s22, 98304
    s_nop 0
    buffer_load_dwordx4 v2, s[8:11], s18 offen lds
    s_add_u32 s18, s18, s20
    v_mfma_f32_16x16x32_bf16 v[224:227], v[112:115], v[104:107], v[224:227]
    v_mfma_f32_16x16x32_bf16 v[228:231], v[116:119], v[104:107], v[228:231]
    v_mfma_f32_16x16x32_bf16 v[232:235], v[120:123], v[104:107], v[232:235]
    s_add_u32 m0, s22, 106496
    s_nop 0
    buffer_load_dwordx4 v2, s[12:15], s19 offen lds
    s_add_u32 s19, s19, s20
    v_mfma_f32_16x16x32_bf16 v[236:239], v[124:127], v[104:107], v[236:239]
    v_mfma_f32_16x16x32_bf16 v[240:243], v[112:115], v[108:111], v[240:243]
    v_mfma_f32_16x16x32_bf16 v[244:247], v[116:119], v[108:111], v[244:247]
    v_mfma_f32_16x16x32_bf16 v[248:251], v[120:123], v[108:111], v[248:251]
    v_mfma_f32_16x16x32_bf16 v[252:255], v[124:127], v[108:111], v[252:255]
    s_waitcnt lgkmcnt(0)
w_loop_chk:
    s_sub_u32 s23, s23, 1
w_loop:
    s_cmp_lg_u32 s23, 1
    s_cbranch_scc1 w_body
    v_readfirstlane_b32 s30, v16
    s_cmp_ge_u32 s30, s45
    s_cselect_b32 s30, 0, 1
    s_or_b32 s30, s30, s70
    s_cmp_ge_u32 s32, 4
    s_cselect_b32 s30, 1, s30
    s_cmp_eq_u32 s32, 0
    s_cselect_b32 s30, 1, s30
    v_mov_b32 v20, s30
    ds_write_b32 v7, v20
    s_cbranch_scc1 w_nd
    s_cmp_ge_u32 s32, 4
    s_cbranch_scc1 w_nd
    s_cmp_lg_u32 s70, 0
    s_cbranch_scc1 w_nd
    s_load_dwordx2 s[8:9], s[0:1], s33
    s_load_dwordx2 s[12:13], s[0:1], s34
    s_mov_b32 s10, s38
    s_mov_b32 s14, s38
    s_cmp_ge_u32 s32, 4
    s_cselect_b32 s31, 0, 1
    s_lshl_b32 s30, s3, s31
    s_mul_i32 s30, s30, s40
    s_add_u32 s16, s39, s30
    s_cmp_eq_u32 s32, 4
    s_cselect_b32 s30, 1024, s40
    s_cselect_b32 s31, 6, 5
    s_lshl_b32 s62, 32, s31
    s_add_u32 s17, s16, s30
    s_lshl_b32 s30, s3, 2
    s_mul_i32 s30, s30, s35
    s_add_u32 s18, s36, s30
    s_add_u32 s19, s37, s30
    s_lshl_b32 s20, s35, s31
    v_mul_u32_u24 v2, s35, v4
    v_add_u32 v2, v2, v3
    s_waitcnt lgkmcnt(0)
w_body:
    s_waitcnt vmcnt(8)
    s_barrier
    v_mfma_f32_16x16x32_bf16 v[128:131], v[64:67], v[32:35], v[128:131]
    ds_read_b64_tr_b16 v[112:113], v8 offset:49152
    v_mfma_f32_16x16x32_bf16 v[132:135], v[68:71], v[32:35], v[132:135]
    ds_read_b64_tr_b16 v[114:115], v9 offset:49152
    v_mfma_f32_16x16x32_bf16 v[136:139], v[72:75], v[32:35], v[136:139]
    ds_read_b64_tr_b16 v[116:117], v10 offset:49152
    v_mfma_f32_16x16x32_bf16 v[140:143], v[76:79], v[32:35], v[140:143]
    ds_read_b64_tr_b16 v[118:119], v11 offset:49152
    v_mfma_f32_16x16x32_bf16 v[144:147], v[64:67], v[36:39], v[144:147]
    ds_read_b64_tr_b16 v[120:121], v8 offset:57344
    v_mfma_f32_16x16x32_bf16 v[148:151], v[68:71], v[36:39], v[148:151]
    ds_read_b64_tr_b16 v[122:123], v9 offset:57344
    v_mfma_f32_16x16x32_bf16 v[152:155], v[72:75], v[36:39], v[152:155]
    ds_read_b64_tr_b16 v[124:125], v10 offset:57344
    v_mfma_f32_16x16x32_bf16 v[156:159], v[76:79], v[36:39], v[156:159]
    ds_read_b64_tr_b16 v[126:127], v11 offset:57344
    v_mfma_f32_16x16x32_bf16 v[160:163], v[64:67], v[40:43], v[160:163]
    ds_read_b128 v[80:83], v5 offset:32768
    v_mfma_f32_16x16x32_bf16 v[164:167], v[68:71], v[40:43], v[164:167]
    ds_read_b128 v[84:87], v5 offset:33792
    v_mfma_f32_16x16x32_bf16 v[168:171], v[72:75], v[40:43], v[168:171]
    ds_read_b128 v[88:91], v5 offset:34816
    v_mfma_f32_16x16x32_bf16 v[172:175], v[76:79], v[40:43], v[172:175]
    ds_read_b128 v[92:95], v5 offset:35840
    v_mfma_f32_16x16x32_bf16 v[176:179], v[64:67], v[44:47], v[176:179]
    ds_read_b128 v[96:99], v5 offset:36864
    v_mfma_f32_16x16x32_bf16 v[180:183], v[68:71], v[44:47], v[180:183]
    ds_read_b128 v[100:103], v5 offset:37888
    v_mfma_f32_16x16x32_bf16 v[184:187], v[72:75], v[44:47], v[184:187]
    ds_read_b128 v[104:107], v5 offset:38912
    v_mfma_f32_16x16x32_bf16 v[188:191], v[76:79], v[44:47], v[188:191]
    ds_read_b128 v[108:111], v5 offset:39936
    v_mfma_f32_16x16x32_bf16 v[192:195], v[64:67], v[48:51], v[192:195]
    v_mfma_f32_16x16x32_bf16 v[196:199], v[68:71], v[48:51], v[196:199]
    s_add_u32 m0, s21, 0
    s_nop 0
    buffer_load_dwordx4 v1, s[4:7], s16 offen sc1 lds
    s_add_u32 s16, s16, s62
    v_mfma_f32_16x16x32_bf16 v[200:203], v[72:75], v[48:51], v[200:203]
    v_mfma_f32_16x16x32_bf16 v[204:207], v[76:79], v[48:51], v[204:207]
    v_mfma_f32_16x16x32_bf16 v[208:211], v[64:67], v[52:55], v[208:211]
    s_add_u32 m0, s21, 1024
    s_nop 0
    buffer_load_dwordx4 v1, s[4:7], s17 offen sc1 lds
    s_add_u32 s17, s17, s62
    v_mfma_f32_16x16x32_bf16 v[212:215], v[68:71], v[52:55], v[212:215]
    v_mfma_f32_16x16x32_bf16 v[216:219], v[72:75], v[52:55], v[216:219]
    v_mfma_f32_16x16x32_bf16 v[220:223], v[76:79], v[52:55], v[220:223]
    s_add_u32 m0, s22, 0
    s_nop 0
    buffer_load_dwordx4 v2, s[8:11], s18 offen lds
    s_add_u32 s18, s18, s20
    v_mfma_f32_16x16x32_bf16 v[224:227], v[64:67], v[56:59], v[224:227]
    v_mfma_f32_16x16x32_bf16 v[228:231], v[68:71], v[56:59], v[228:231]
    v_mfma_f32_16x16x32_bf16 v[232:235], v[72:75], v[56:59], v[232:235]
    s_add_u32 m0, s22, 8192
    s_nop 0
    buffer_load_dwordx4 v2, s[12:15], s19 offen lds
    s_add_u32 s19, s19, s20
    v_mfma_f32_16x16x32_bf16 v[236:239], v[76:79], v[56:59], v[236:239]
    v_mfma_f32_16x16x32_bf16 v[240:243], v[64:67], v[60:63], v[240:243]
    v_mfma_f32_16x16x32_bf16 v[244:247], v[68:71], v[60:63], v[244:247]
    buffer_load_dword v16, v17, s[4:7], s44 offen sc1
    v_mfma_f32_16x16x32_bf16 v[248:251], v[72:75], v[60:63], v[248:251]
    v_mfma_f32_16x16x32_bf16 v[252:255], v[76:79], v[60:63], v[252:255]
    s_waitcnt lgkmcnt(0)
    s_waitcnt vmcnt(8)
    s_barrier
    v_mfma_f32_16x16x32_bf16 v[128:131], v[112:115], v[80:83], v[128:131]
    ds_read_b64_tr_b16 v[64:65], v12 offset:16384
    v_mfma_f32_16x16x32_bf16 v[132:135], v[116:119], v[80:83], v[132:135]
    ds_read_b64_tr_b16 v[66:67], v13 offset:16384
    v_mfma_f32_16x16x32_bf16 v[136:139], v[120:123], v[80:83], v[136:139]
    ds_read_b64_tr_b16 v[68:69], v14 offset:16384
    v_mfma_f32_16x16x32_bf16 v[140:143], v[124:127], v[80:83], v[140:143]
    ds_read_b64_tr_b16 v[70:71], v15 offset:16384
    v_mfma_f32_16x16x32_bf16 v[144:147], v[112:115], v[84:87], v[144:147]
    ds_read_b64_tr_b16 v[72:73], v12 offset:24576
    v_mfma_f32_16x16x32_bf16 v[148:151], v[116:119], v[84:87], v[148:151]
    ds_read_b64_tr_b16 v[74:75], v13 offset:24576
    v_mfma_f32_16x16x32_bf16 v[152:155], v[120:123], v[84:87], v[152:155]
    ds_read_b64_tr_b16 v[76:77], v14 offset:24576
    v_mfma_f32_16x16x32_bf16 v[156:159], v[124:127], v[84:87], v[156:159]
    ds_read_b64_tr_b16 v[78:79], v15 offset:24576
    v_mfma_f32_16x16x32_bf16 v[160:163], v[112:115], v[88:91], v[160:163]
    ds_read_b128 v[32:35], v6 offset:0
    v_mfma_f32_16x16x32_bf16 v[164:167], v[116:119], v[88:91], v[164:167]
    ds_read_b128 v[36:39], v6 offset:1024
    v_mfma_f32_16x16x32_bf16 v[168:171], v[120:123], v[88:91], v[168:171]
    ds_read_b128 v[40:43], v6 offset:2048
    v_mfma_f32_16x16x32_bf16 v[172:175], v[124:127], v[88:91], v[172:175]
    ds_read_b128 v[44:47], v6 offset:3072
    v_mfma_f32_16x16x32_bf16 v[176:179], v[112:115], v[92:95], v[176:179]
    ds_read_b128 v[48:51], v6 offset:4096
    v_mfma_f32_16x16x32_bf16 v[180:183], v[116:119], v[92:95], v[180:183]
    ds_read_b128 v[52:55], v6 offset:5120
    v_mfma_f32_16x16x32_bf16 v[184:187], v[120:123], v[92:95], v[184:187]
    ds_read_b128 v[56:59], v6 offset:6144
    v_mfma_f32_16x16x32_bf16 v[188:191], v[124:127], v[92:95], v[188:191]
    ds_read_b128 v[60:63], v6 offset:7168
    v_mfma_f32_16x16x32_bf16 v[192:195], v[112:115], v[96:99], v[192:195]
    v_mfma_f32_16x16x32_bf16 v[196:199], v[116:119], v[96:99], v[196:199]
    s_add_u32 m0, s21, 32768
    s_nop 0
    buffer_load_dwordx4 v1, s[4:7], s16 offen sc1 lds
    s_add_u32 s16, s16, s62
    v_mfma_f32_16x16x32_bf16 v[200:203], v[120:123], v[96:99], v[200:203]
    v_mfma_f32_16x16x32_bf16 v[204:207], v[124:127], v[96:99], v[204:207]
    v_mfma_f32_16x16x32_bf16 v[208:211], v[112:115], v[100:103], v[208:211]
    s_add_u32 m0, s21, 33792
    s_nop 0
    buffer_load_dwordx4 v1, s[4:7], s17 offen sc1 lds
    s_add_u32 s17, s17, s62
    v_mfma_f32_16x16x32_bf16 v[212:215], v[116:119], v[100:103], v[212:215]
    v_mfma_f32_16x16x32_bf16 v[216:219], v[120:123], v[100:103], v[216:219]
    v_mfma_f32_16x16x32_bf16 v[220:223], v[124:127], v[100:103], v[220:223]
    s_add_u32 m0, s22, 32768
    s_nop 0
    buffer_load_dwordx4 v2, s[8:11], s18 offen lds
    s_add_u32 s18, s18, s20
    v_mfma_f32_16x16x32_bf16 v[224:227], v[112:115], v[104:107], v[224:227]
    v_mfma_f32_16x16x32_bf16 v[228:231], v[116:119], v[104:107], v[228:231]
    v_mfma_f32_16x16x32_bf16 v[232:235], v[120:123], v[104:107], v[232:235]
    s_add_u32 m0, s22, 40960
    s_nop 0
    buffer_load_dwordx4 v2, s[12:15], s19 offen lds
    s_add_u32 s19, s19, s20
    v_mfma_f32_16x16x32_bf16 v[236:239], v[124:127], v[104:107], v[236:239]
    v_mfma_f32_16x16x32_bf16 v[240:243], v[112:115], v[108:111], v[240:243]
    v_mfma_f32_16x16x32_bf16 v[244:247], v[116:119], v[108:111], v[244:247]
    v_mfma_f32_16x16x32_bf16 v[248:251], v[120:123], v[108:111], v[248:251]
    v_mfma_f32_16x16x32_bf16 v[252:255], v[124:127], v[108:111], v[252:255]
    s_waitcnt lgkmcnt(0)
    s_waitcnt vmcnt(8)
    s_barrier
    v_mfma_f32_16x16x32_bf16 v[128:131], v[64:67], v[32:35], v[128:131]
    ds_read_b64_tr_b16 v[112:113], v12 offset:49152
    v_mfma_f32_16x16x32_bf16 v[132:135], v[68:71], v[32:35], v[132:135]
    ds_read_b64_tr_b16 v[114:115], v13 offset:49152
    v_mfma_f32_16x16x32_bf16 v[136:139], v[72:75], v[32:35], v[136:139]
    ds_read_b64_tr_b16 v[116:117], v14 offset:49152
    v_mfma_f32_16x16x32_bf16 v[140:143], v[76:79], v[32:35], v[140:143]
    ds_read_b64_tr_b16 v[118:119], v15 offset:49152
    v_mfma_f32_16x16x32_bf16 v[144:147], v[64:67], v[36:39], v[144:147]
    ds_read_b64_tr_b16 v[120:121], v12 offset:57344
    v_mfma_f32_16x16x32_bf16 v[148:151], v[68:71], v[36:39], v[148:151]
    ds_read_b64_tr_b16 v[122:123], v13 offset:57344
    v_mfma_f32_16x16x32_bf16 v[152:155], v[72:75], v[36:39], v[152:155]
    ds_read_b64_tr_b16 v[124:125], v14 offset:57344
    v_mfma_f32_16x16x32_bf16 v[156:159], v[76:79], v[36:39], v[156:159]
    ds_read_b64_tr_b16 v[126:127], v15 offset:57344
    v_mfma_f32_16x16x32_bf16 v[160:163], v[64:67], v[40:43], v[160:163]
    ds_read_b128 v[80:83], v6 offset:32768
    v_mfma_f32_16x16x32_bf16 v[164:167], v[68:71], v[40:43], v[164:167]
    ds_read_b128 v[84:87], v6 offset:33792
    v_mfma_f32_16x16x32_bf16 v[168:171], v[72:75], v[40:43], v[168:171]
    ds_read_b128 v[88:91], v6 offset:34816
    v_mfma_f32_16x16x32_bf16 v[172:175], v[76:79], v[40:43], v[172:175]
    ds_read_b128 v[92:95], v6 offset:35840
    v_mfma_f32_16x16x32_bf16 v[176:179], v[64:67], v[44:47], v[176:179]
    ds_read_b128 v[96:99], v6 offset:36864
    v_mfma_f32_16x16x32_bf16 v[180:183], v[68:71], v[44:47], v[180:183]
    ds_read_b128 v[100:103], v6 offset:37888
    v_mfma_f32_16x16x32_bf16 v[184:187], v[72:75], v[44:47], v[184:187]
    ds_read_b128 v[104:107], v6 offset:38912
    v_mfma_f32_16x16x32_bf16 v[188:191], v[76:79], v[44:47], v[188:191]
    ds_read_b128 v[108:111], v6 offset:39936
    v_mfma_f32_16x16x32_bf16 v[192:195], v[64:67], v[48:51], v[192:195]
    v_mfma_f32_16x16x32_bf16 v[196:199], v[68:71], v[48:51], v[196:199]
    s_add_u32 m0, s21, 65536
    s_nop 0
    buffer_load_dwordx4 v1, s[4:7], s16 offen sc1 lds
    s_add_u32 s16, s16, s62
    v_mfma_f32_16x16x32_bf16 v[200:203], v[72:75], v[48:51], v[200:203]
    v_mfma_f32_16x16x32_bf16 v[204:207], v[76:79], v[48:51], v[204:207]
    v_mfma_f32_16x16x32_bf16 v[208:211], v[64:67], v[52:55], v[208:211]
    s_add_u32 m0, s21, 66560
    s_nop 0
    buffer_load_dwordx4 v1, s[4:7], s17 offen sc1 lds
    s_add_u32 s17, s17, s62
    v_mfma_f32_16x16x32_bf16 v[212:215], v[68:71], v[52:55], v[212:215]
    v_mfma_f32_16x16x32_bf16 v[216:219], v[72:75], v[52:55], v[216:219]
    v_mfma_f32_16x16x32_bf16 v[220:223], v[76:79], v[52:55], v[220:223]
    s_add_u32 m0, s22, 65536
    s_nop 0
    buffer_load_dwordx4 v2, s[8:11], s18 offen lds
    s_add_u32 s18, s18, s20
    v_mfma_f32_16x16x32_bf16 v[224:227], v[64:67], v[56:59], v[224:227]
    v_mfma_f32_16x16x32_bf16 v[228:231], v[68:71], v[56:59], v[228:231]
    v_mfma_f32_16x16x32_bf16 v[232:235], v[72:75], v[56:59], v[232:235]
    s_add_u32 m0, s22, 73728
    s_nop 0
    buffer_load_dwordx4 v2, s[12:15], s19 offen lds
    s_add_u32 s19, s19, s20
    v_mfma_f32_16x16x32_bf16 v[236:239], v[76:79], v[56:59], v[236:239]
    v_mfma_f32_16x16x32_bf16 v[240:243], v[64:67], v[60:63], v[240:243]
    v_mfma_f32_16x16x32_bf16 v[244:247], v[68:71], v[60:63], v[244:247]
    v_mfma_f32_16x16x32_bf16 v[248:251], v[72:75], v[60:63], v[248:251]
    v_mfma_f32_16x16x32_bf16 v[252:255], v[76:79], v[60:63], v[252:255]
    s_waitcnt lgkmcnt(0)
    s_waitcnt vmcnt(8)
    s_barrier
    v_mfma_f32_16x16x32_bf16 v[128:131], v[112:115], v[80:83], v[128:131]
    ds_read_b64_tr_b16 v[64:65], v8 offset:16384
    v_mfma_f32_16x16x32_bf16 v[132:135], v[116:119], v[80:83], v[132:135]
    ds_read_b64_tr_b16 v[66:67], v9 offset:16384
    v_mfma_f32_16x16x32_bf16 v[136:139], v[120:123], v[80:83], v[136:139]
    ds_read_b64_tr_b16 v[68:69], v10 offset:16384
    v_mfma_f32_16x16x32_bf16 v[140:143], v[124:127], v[80:83], v[140:143]
    ds_read_b64_tr_b16 v[70:71], v11 offset:16384
    v_mfma_f32_16x16x32_bf16 v[144:147], v[112:115], v[84:87], v[144:147]
    ds_read_b64_tr_b16 v[72:73], v8 offset:24576
    v_mfma_f32_16x16x32_bf16 v[148:151], v[116:119], v[84:87], v[148:151]
    ds_read_b64_tr_b16 v[74:75], v9 offset:24576
    v_mfma_f32_16x16x32_bf16 v[152:155], v[120:123], v[84:87], v[152:155]
    ds_read_b64_tr_b16 v[76:77], v10 offset:24576
    v_mfma_f32_16x16x32_bf16 v[156:159], v[124:127], v[84:87], v[156:159]
    ds_read_b64_tr_b16 v[78:79], v11 offset:24576
    v_mfma_f32_16x16x32_bf16 v[160:163], v[112:115], v[88:91], v[160:163]
    ds_read_b128 v[32:35], v5 offset:0
    v_mfma_f32_16x16x32_bf16 v[164:167], v[116:119], v[88:91], v[164:167]
    ds_read_b128 v[36:39], v5 offset:1024
    v_mfma_f32_16x16x32_bf16 v[168:171], v[120:123], v[88:91], v[168:171]
    ds_read_b128 v[40:43], v5 offset:2048
    v_mfma_f32_16x16x32_bf16 v[172:175], v[124:127], v[88:91], v[172:175]
    ds_read_b128 v[44:47], v5 offset:3072
    v_mfma_f32_16x16x32_bf16 v[176:179], v[112:115], v[92:95], v[176:179]
    ds_read_b128 v[48:51], v5 offset:4096
    v_mfma_f32_16x16x32_bf16 v[180:183], v[116:119], v[92:95], v[180:183]
    ds_read_b128 v[52:55], v5 offset:5120
    v_mfma_f32_16x16x32_bf16 v[184:187], v[120:123], v[92:95], v[184:187]
    ds_read_b128 v[56:59], v5 offset:6144
    v_mfma_f32_16x16x32_bf16 v[188:191], v[124:127], v[92:95], v[188:191]
    ds_read_b128 v[60:63], v5 offset:7168
    v_mfma_f32_16x16x32_bf16 v[192:195], v[112:115], v[96:99], v[192:195]
    v_mfma_f32_16x16x32_bf16 v[196:199], v[116:119], v[96:99], v[196:199]
    s_add_u32 m0, s21, 98304
    s_nop 0
    buffer_load_dwordx4 v1, s[4:7], s16 offen sc1 lds
    s_add_u32 s16, s16, s62
    v_mfma_f32_16x16x32_bf16 v[200:203], v[120:123], v[96:99], v[200:203]
    v_mfma_f32_16x16x32_bf16 v[204:207], v[124:127], v[96:99], v[204:207]
    v_mfma_f32_16x16x32_bf16 v[208:211], v[112:115], v[100:103], v[208:211]
    s_add_u32 m0, s21, 99328
    s_nop 0
    buffer_load_dwordx4 v1, s[4:7], s17 offen sc1 lds
    s_add_u32 s17, s17, s62
    v_mfma_f32_16x16x32_bf16 v[212:215], v[116:119], v[100:103], v[212:215]
    v_mfma_f32_16x16x32_bf16 v[216:219], v[120:123], v[100:103], v[216:219]
    v_mfma_f32_16x16x32_bf16 v[220:223], v[124:127], v[100:103], v[220:223]
    s_add_u32 m0, s22, 98304
    s_nop 0
    buffer_load_dwordx4 v2, s[8:11], s18 offen lds
    s_add_u32 s18, s18, s20
    v_mfma_f32_16x16x32_bf16 v[224:227], v[112:115], v[104:107], v[224:227]
    v_mfma_f32_16x16x32_bf16 v[228:231], v[116:119], v[104:107], v[228:231]
    v_mfma_f32_16x16x32_bf16 v[232:235], v[120:123], v[104:107], v[232:235]
    s_add_u32 m0, s22, 106496
    s_nop 0
    buffer_load_dwordx4 v2, s[12:15], s19 offen lds
    s_add_u32 s19, s19, s20
    v_mfma_f32_16x16x32_bf16 v[236:239], v[124:127], v[104:107], v[236:239]
    v_mfma_f32_16x16x32_bf16 v[240:243], v[112:115], v[108:111], v[240:243]
    v_mfma_f32_16x16x32_bf16 v[244:247], v[116:119], v[108:111], v[244:247]
    v_mfma_f32_16x16x32_bf16 v[248:251], v[120:123], v[108:111], v[248:251]
    v_mfma_f32_16x16x32_bf16 v[252:255], v[124:127], v[108:111], v[252:255]
    s_waitcnt lgkmcnt(0)
    s_sub_u32 s23, s23, 1
    s_cmp_lg_u32 s23, 0
    s_cbranch_scc1 w_loop
    s_branch w_end
w_nd:
    s_waitcnt vmcnt(8)
    s_barrier
    v_mfma_f32_16x16x32_bf16 v[128:131], v[64:67], v[32:35], v[128:131]
    ds_read_b64_tr_b16 v[112:113], v8 offset:49152
    v_mfma_f32_16x16x32_bf16 v[132:135], v[68:71], v[32:35], v[132:135]
    ds_read_b64_tr_b16 v[114:115], v9 offset:49152
    v_mfma_f32_16x16x32_bf16 v[136:139], v[72:75], v[32:35], v[136:139]
    ds_read_b64_tr_b16 v[116:117], v10 offset:49152
    v_mfma_f32_16x16x32_bf16 v[140:143], v[76:79], v[32:35], v[140:143]
    ds_read_b64_tr_b16 v[118:119], v11 offset:49152
    v_mfma_f32_16x16x32_bf16 v[144:147], v[64:67], v[36:39], v[144:147]
    ds_read_b64_tr_b16 v[120:121], v8 offset:57344
    v_mfma_f32_16x16x32_bf16 v[148:151], v[68:71], v[36:39], v[148:151]
    ds_read_b64_tr_b16 v[122:123], v9 offset:57344
    v_mfma_f32_16x16x32_bf16 v[152:155], v[72:75], v[36:39], v[152:155]
    ds_read_b64_tr_b16 v[124:125], v10 offset:57344
    v_mfma_f32_16x16x32_bf16 v[156:159], v[76:79], v[36:39], v[156:159]
    ds_read_b64_tr_b16 v[126:127], v11 offset:57344
    v_mfma_f32_16x16x32_bf16 v[160:163], v[64:67], v[40:43], v[160:163]
    ds_read_b128 v[80:83], v5 offset:32768
    v_mfma_f32_16x16x32_bf16 v[164:167], v[68:71], v[40:43], v[164:167]
    ds_read_b128 v[84:87], v5 offset:33792
    v_mfma_f32_16x16x32_bf16 v[168:171], v[72:75], v[40:43], v[168:171]
    ds_read_b128 v[88:91], v5 offset:34816
    v_mfma_f32_16x16x32_bf16 v[172:175], v[76:79], v[40:43], v[172:175]
    ds_read_b128 v[92:95], v5 offset:35840
    v_mfma_f32_16x16x32_bf16 v[176:179], v[64:67], v[44:47], v[176:179]
    ds_read_b128 v[96:99], v5 offset:36864
    v_mfma_f32_16x16x32_bf16 v[180:183], v[68:71], v[44:47], v[180:183]
    ds_read_b128 v[100:103], v5 offset:37888
    v_mfma_f32_16x16x32_bf16 v[184:187], v[72:75], v[44:47], v[184:187]
    ds_read_b128 v[104:107], v5 offset:38912
    v_mfma_f32_16x16x32_bf16 v[188:191], v[76:79], v[44:47], v[188:191]
    ds_read_b128 v[108:111], v5 offset:39936
    v_mfma_f32_16x16x32_bf16 v[192:195], v[64:67], v[48:51], v[192:195]
    v_mfma_f32_16x16x32_bf16 v[196:199], v[68:71], v[48:51], v[196:199]
    v_mfma_f32_16x16x32_bf16 v[200:203], v[72:75], v[48:51], v[200:203]
    v_mfma_f32_16x16x32_bf16 v[204:207], v[76:79], v[48:51], v[204:207]
    v_mfma_f32_16x16x32_bf16 v[208:211], v[64:67], v[52:55], v[208:211]
    v_mfma_f32_16x16x32_bf16 v[212:215], v[68:71], v[52:55], v[212:215]
    v_mfma_f32_16x16x32_bf16 v[216:219], v[72:75], v[52:55], v[216:219]
    v_mfma_f32_16x16x32_bf16 v[220:223], v[76:79], v[52:55], v[220:223]
    v_mfma_f32_16x16x32_bf16 v[224:227], v[64:67], v[56:59], v[224:227]
    v_mfma_f32_16x16x32_bf16 v[228:231], v[68:71], v[56:59], v[228:231]
    v_mfma_f32_16x16x32_bf16 v[232:235], v[72:75], v[56:59], v[232:235]
    v_mfma_f32_16x16x32_bf16 v[236:239], v[76:79], v[56:59], v[236:239]
    v_mfma_f32_16x16x32_bf16 v[240:243], v[64:67], v[60:63], v[240:243]
    v_mfma_f32_16x16x32_bf16 v[244:247], v[68:71], v[60:63], v[244:247]
    v_mfma_f32_16x16x32_bf16 v[248:251], v[72:75], v[60:63], v[248:251]
    v_mfma_f32_16x16x32_bf16 v[252:255], v[76:79], v[60:63], v[252:255]
    s_waitcnt lgkmcnt(0)
    s_waitcnt vmcnt(4)
    s_barrier
    v_mfma_f32_16x16x32_bf16 v[128:131], v[112:115], v[80:83], v[128:131]
    ds_read_b64_tr_b16 v[64:65], v12 offset:16384
    v_mfma_f32_16x16x32_bf16 v[132:135], v[116:119], v[80:83], v[132:135]
    ds_read_b64_tr_b16 v[66:67], v13 offset:16384
    v_mfma_f32_16x16x32_bf16 v[136:139], v[120:123], v[80:83], v[136:139]
    ds_read_b64_tr_b16 v[68:69], v14 offset:16384
    v_mfma_f32_16x16x32_bf16 v[140:143], v[124:127], v[80:83], v[140:143]
    ds_read_b64_tr_b16 v[70:71], v15 offset:16384
    v_mfma_f32_16x16x32_bf16 v[144:147], v[112:115], v[84:87], v[144:147]
    ds_read_b64_tr_b16 v[72:73], v12 offset:24576
    v_mfma_f32_16x16x32_bf16 v[148:151], v[116:119], v[84:87], v[148:151]
    ds_read_b64_tr_b16 v[74:75], v13 offset:24576
    v_mfma_f32_16x16x32_bf16 v[152:155], v[120:123], v[84:87], v[152:155]
    ds_read_b64_tr_b16 v[76:77], v14 offset:24576
    v_mfma_f32_16x16x32_bf16 v[156:159], v[124:127], v[84:87], v[156:159]
    ds_read_b64_tr_b16 v[78:79], v15 offset:24576
    v_mfma_f32_16x16x32_bf16 v[160:163], v[112:115], v[88:91], v[160:163]
    ds_read_b128 v[32:35], v6 offset:0
    v_mfma_f32_16x16x32_bf16 v[164:167], v[116:119], v[88:91], v[164:167]
    ds_read_b128 v[36:39], v6 offset:1024
    v_mfma_f32_16x16x32_bf16 v[168:171], v[120:123], v[88:91], v[168:171]
    ds_read_b128 v[40:43], v6 offset:2048
    v_mfma_f32_16x16x32_bf16 v[172:175], v[124:127], v[88:91], v[172:175]
    ds_read_b128 v[44:47], v6 offset:3072
    v_mfma_f32_16x16x32_bf16 v[176:179], v[112:115], v[92:95], v[176:179]
    ds_read_b128 v[48:51], v6 offset:4096
    v_mfma_f32_16x16x32_bf16 v[180:183], v[116:119], v[92:95], v[180:183]
    ds_read_b128 v[52:55], v6 offset:5120
    v_mfma_f32_16x16x32_bf16 v[184:187], v[120:123], v[92:95], v[184:187]
    ds_read_b128 v[56:59], v6 offset:6144
    v_mfma_f32_16x16x32_bf16 v[188:191], v[124:127], v[92:95], v[188:191]
    ds_read_b128 v[60:63], v6 offset:7168
    v_mfma_f32_16x16x32_bf16 v[192:195], v[112:115], v[96:99], v[192:195]
    v_mfma_f32_16x16x32_bf16 v[196:199], v[116:119], v[96:99], v[196:199]
    v_mfma_f32_16x16x32_bf16 v[200:203], v[120:123], v[96:99], v[200:203]
    v_mfma_f32_16x16x32_bf16 v[204:207], v[124:127], v[96:99], v[204:207]
    v_mfma_f32_16x16x32_bf16 v[208:211], v[112:115], v[100:103], v[208:211]
    v_mfma_f32_16x16x32_bf16 v[212:215], v[116:119], v[100:103], v[212:215]
    v_mfma_f32_16x16x32_bf16 v[216:219], v[120:123], v[100:103], v[216:219]
    v_mfma_f32_16x16x32_bf16 v[220:223], v[124:127], v[100:103], v[220:223]
    v_mfma_f32_16x16x32_bf16 v[224:227], v[112:115], v[104:107], v[224:227]
    v_mfma_f32_16x16x32_bf16 v[228:231], v[116:119], v[104:107], v[228:231]
    v_mfma_f32_16x16x32_bf16 v[232:235], v[120:123], v[104:107], v[232:235]
    v_mfma_f32_16x16x32_bf16 v[236:239], v[124:127], v[104:107], v[236:239]
    v_mfma_f32_16x16x32_bf16 v[240:243], v[112:115], v[108:111], v[240:243]
    v_mfma_f32_16x16x32_bf16 v[244:247], v[116:119], v[108:111], v[244:247]
    v_mfma_f32_16x16x32_bf16 v[248:251], v[120:123], v[108:111], v[248:251]
    v_mfma_f32_16x16x32_bf16 v[252:255], v[124:127], v[108:111], v[252:255]
    s_waitcnt lgkmcnt(0)
    s_waitcnt vmcnt(0)
    s_barrier
    v_mfma_f32_16x16x32_bf16 v[128:131], v[64:67], v[32:35], v[128:131]
    ds_read_b64_tr_b16 v[112:113], v12 offset:49152
    v_mfma_f32_16x16x32_bf16 v[132:135], v[68:71], v[32:35], v[132:135]
    ds_read_b64_tr_b16 v[114:115], v13 offset:49152
    v_mfma_f32_16x16x32_bf16 v[136:139], v[72:75], v[32:35], v[136:139]
    ds_read_b64_tr_b16 v[116:117], v14 offset:49152
    v_mfma_f32_16x16x32_bf16 v[140:143], v[76:79], v[32:35], v[140:143]
    ds_read_b64_tr_b16 v[118:119], v15 offset:49152
    v_mfma_f32_16x16x32_bf16 v[144:147], v[64:67], v[36:39], v[144:147]
    ds_read_b64_tr_b16 v[120:121], v12 offset:57344
    v_mfma_f32_16x16x32_bf16 v[148:151], v[68:71], v[36:39], v[148:151]
    ds_read_b64_tr_b16 v[122:123], v13 offset:57344
    v_mfma_f32_16x16x32_bf16 v[152:155], v[72:75], v[36:39], v[152:155]
    ds_read_b64_tr_b16 v[124:125], v14 offset:57344
    v_mfma_f32_16x16x32_bf16 v[156:159], v[76:79], v[36:39], v[156:159]
    ds_read_b64_tr_b16 v[126:127], v15 offset:57344
    v_mfma_f32_16x16x32_bf16 v[160:163], v[64:67], v[40:43], v[160:163]
    ds_read_b128 v[80:83], v6 offset:32768
    v_mfma_f32_16x16x32_bf16 v[164:167], v[68:71], v[40:43], v[164:167]
    ds_read_b128 v[84:87], v6 offset:33792
    v_mfma_f32_16x16x32_bf16 v[168:171], v[72:75], v[40:43], v[168:171]
    ds_read_b128 v[88:91], v6 offset:34816
    v_mfma_f32_16x16x32_bf16 v[172:175], v[76:79], v[40:43], v[172:175]
    ds_read_b128 v[92:95], v6 offset:35840
    v_mfma_f32_16x16x32_bf16 v[176:179], v[64:67], v[44:47], v[176:179]
    ds_read_b128 v[96:99], v6 offset:36864
    v_mfma_f32_16x16x32_bf16 v[180:183], v[68:71], v[44:47], v[180:183]
    ds_read_b128 v[100:103], v6 offset:37888
    v_mfma_f32_16x16x32_bf16 v[184:187], v[72:75], v[44:47], v[184:187]
    ds_read_b128 v[104:107], v6 offset:38912
    v_mfma_f32_16x16x32_bf16 v[188:191], v[76:79], v[44:47], v[188:191]
    ds_read_b128 v[108:111], v6 offset:39936
    v_mfma_f32_16x16x32_bf16 v[192:195], v[64:67], v[48:51], v[192:195]
    v_mfma_f32_16x16x32_bf16 v[196:199], v[68:71], v[48:51], v[196:199]
    v_mfma_f32_16x16x32_bf16 v[200:203], v[72:75], v[48:51], v[200:203]
    v_mfma_f32_16x16x32_bf16 v[204:207], v[76:79], v[48:51], v[204:207]
    v_mfma_f32_16x16x32_bf16 v[208:211], v[64:67], v[52:55], v[208:211]
    v_mfma_f32_16x16x32_bf16 v[212:215], v[68:71], v[52:55], v[212:215]
    v_mfma_f32_16x16x32_bf16 v[216:219], v[72:75], v[52:55], v[216:219]
    v_mfma_f32_16x16x32_bf16 v[220:223], v[76:79], v[52:55], v[220:223]
    v_mfma_f32_16x16x32_bf16 v[224:227], v[64:67], v[56:59], v[224:227]
    v_mfma_f32_16x16x32_bf16 v[228:231], v[68:71], v[56:59], v[228:231]
    v_mfma_f32_16x16x32_bf16 v[232:235], v[72:75], v[56:59], v[232:235]
    v_mfma_f32_16x16x32_bf16 v[236:239], v[76:79], v[56:59], v[236:239]
    v_mfma_f32_16x16x32_bf16 v[240:243], v[64:67], v[60:63], v[240:243]
    v_mfma_f32_16x16x32_bf16 v[244:247], v[68:71], v[60:63], v[244:247]
    v_mfma_f32_16x16x32_bf16 v[248:251], v[72:75], v[60:63], v[248:251]
    v_mfma_f32_16x16x32_bf16 v[252:255], v[76:79], v[60:63], v[252:255]
    s_waitcnt lgkmcnt(0)
    s_waitcnt vmcnt(0)
    s_barrier
    v_mfma_f32_16x16x32_bf16 v[128:131], v[112:115], v[80:83], v[128:131]
    ds_read_b64_tr_b16 v[64:65], v8 offset:16384
    v_mfma_f32_16x16x32_bf16 v[132:135], v[116:119], v[80:83], v[132:135]
    ds_read_b64_tr_b16 v[66:67], v9 offset:16384
    v_mfma_f32_16x16x32_bf16 v[136:139], v[120:123], v[80:83], v[136:139]
    ds_read_b64_tr_b16 v[68:69], v10 offset:16384
    v_mfma_f32_16x16x32_bf16 v[140:143], v[124:127], v[80:83], v[140:143]
    ds_read_b64_tr_b16 v[70:71], v11 offset:16384
    v_mfma_f32_16x16x32_bf16 v[144:147], v[112:115], v[84:87], v[144:147]
    ds_read_b64_tr_b16 v[72:73], v8 offset:24576
    v_mfma_f32_16x16x32_bf16 v[148:151], v[116:119], v[84:87], v[148:151]
    ds_read_b64_tr_b16 v[74:75], v9 offset:24576
    v_mfma_f32_16x16x32_bf16 v[152:155], v[120:123], v[84:87], v[152:155]
    ds_read_b64_tr_b16 v[76:77], v10 offset:24576
    v_mfma_f32_16x16x32_bf16 v[156:159], v[124:127], v[84:87], v[156:159]
    ds_read_b64_tr_b16 v[78:79], v11 offset:24576
    v_mfma_f32_16x16x32_bf16 v[160:163], v[112:115], v[88:91], v[160:163]
    ds_read_b128 v[32:35], v5 offset:0
    v_mfma_f32_16x16x32_bf16 v[164:167], v[116:119], v[88:91], v[164:167]
    ds_read_b128 v[36:39], v5 offset:1024
    v_mfma_f32_16x16x32_bf16 v[168:171], v[120:123], v[88:91], v[168:171]
    ds_read_b128 v[40:43], v5 offset:2048
    v_mfma_f32_16x16x32_bf16 v[172:175], v[124:127], v[88:91], v[172:175]
    ds_read_b128 v[44:47], v5 offset:3072
    v_mfma_f32_16x16x32_bf16 v[176:179], v[112:115], v[92:95], v[176:179]
    ds_read_b128 v[48:51], v5 offset:4096
    v_mfma_f32_16x16x32_bf16 v[180:183], v[116:119], v[92:95], v[180:183]
    ds_read_b128 v[52:55], v5 offset:5120
    v_mfma_f32_16x16x32_bf16 v[184:187], v[120:123], v[92:95], v[184:187]
    ds_read_b128 v[56:59], v5 offset:6144
    v_mfma_f32_16x16x32_bf16 v[188:191], v[124:127], v[92:95], v[188:191]
    ds_read_b128 v[60:63], v5 offset:7168
    v_mfma_f32_16x16x32_bf16 v[192:195], v[112:115], v[96:99], v[192:195]
    v_mfma_f32_16x16x32_bf16 v[196:199], v[116:119], v[96:99], v[196:199]
    v_mfma_f32_16x16x32_bf16 v[200:203], v[120:123], v[96:99], v[200:203]
    v_mfma_f32_16x16x32_bf16 v[204:207], v[124:127], v[96:99], v[204:207]
    v_mfma_f32_16x16x32_bf16 v[208:211], v[112:115], v[100:103], v[208:211]
    v_mfma_f32_16x16x32_bf16 v[212:215], v[116:119], v[100:103], v[212:215]
    v_mfma_f32_16x16x32_bf16 v[216:219], v[120:123], v[100:103], v[216:219]
    v_mfma_f32_16x16x32_bf16 v[220:223], v[124:127], v[100:103], v[220:223]
    v_mfma_f32_16x16x32_bf16 v[224:227], v[112:115], v[104:107], v[224:227]
    v_mfma_f32_16x16x32_bf16 v[228:231], v[116:119], v[104:107], v[228:231]
    v_mfma_f32_16x16x32_bf16 v[232:235], v[120:123], v[104:107], v[232:235]
    v_mfma_f32_16x16x32_bf16 v[236:239], v[124:127], v[104:107], v[236:239]
    v_mfma_f32_16x16x32_bf16 v[240:243], v[112:115], v[108:111], v[240:243]
    v_mfma_f32_16x16x32_bf16 v[244:247], v[116:119], v[108:111], v[244:247]
    v_mfma_f32_16x16x32_bf16 v[248:251], v[120:123], v[108:111], v[248:251]
    v_mfma_f32_16x16x32_bf16 v[252:255], v[124:127], v[108:111], v[252:255]
    s_waitcnt lgkmcnt(0)
w_end:
    v_mov_b32 v20, 131072
    ds_read_b128 v[24:27], v20
    ds_read_b128 v[28:31], v20 offset:16
    s_cmp_eq_u32 s48, 2
    s_cbranch_scc1 w_epi_glu
    s_cmp_eq_u32 s48, 3
    s_cbranch_scc1 w_epi_silu
    s_lshl_b32 s30, s27, 10
    s_add_u32 s30, s30, s49
    s_nop 7
    v_cvt_pk_bf16_f32 v80, v128, v129
    v_cvt_pk_bf16_f32 v81, v130, v131
    v_cvt_pk_bf16_f32 v82, v132, v133
    v_cvt_pk_bf16_f32 v83, v134, v135
    buffer_store_dwordx4 v[80:83], v1, s[4:7], s30 offen sc1
    v_cvt_pk_bf16_f32 v84, v136, v137
    v_cvt_pk_bf16_f32 v85, v138, v139
    v_cvt_pk_bf16_f32 v86, v140, v141
    v_cvt_pk_bf16_f32 v87, v142, v143
    buffer_store_dwordx4 v[84:87], v19, s[4:7], s30 offen sc1
    s_add_u32 s30, s30, s50
    v_cvt_pk_bf16_f32 v88, v144, v145
    v_cvt_pk_bf16_f32 v89, v146, v147
    v_cvt_pk_bf16_f32 v90, v148, v149
    v_cvt_pk_bf16_f32 v91, v150, v151
    buffer_store_dwordx4 v[88:91], v1, s[4:7], s30 offen sc1
    v_cvt_pk_bf16_f32 v92, v152, v153
    v_cvt_pk_bf16_f32 v93, v154, v155
    v_cvt_pk_bf16_f32 v94, v156, v157
    v_cvt_pk_bf16_f32 v95, v158, v159
    buffer_store_dwordx4 v[92:95], v19, s[4:7], s30 offen sc1
    s_add_u32 s30, s30, s50
    v_cvt_pk_bf16_f32 v80, v160, v161
    v_cvt_pk_bf16_f32 v81, v162, v163
    v_cvt_pk_bf16_f32 v82, v164, v165
    v_cvt_pk_bf16_f32 v83, v166, v167
    buffer_store_dwordx4 v[80:83], v1, s[4:7], s30 offen sc1
    v_cvt_pk_bf16_f32 v84, v168, v169
    v_cvt_pk_bf16_f32 v85, v170, v171
    v_cvt_pk_bf16_f32 v86, v172, v173
    v_cvt_pk_bf16_f32 v87, v174, v175
    buffer_store_dwordx4 v[84:87], v19, s[4:7], s30 offen sc1
    s_add_u32 s30, s30, s50
    v_cvt_pk_bf16_f32 v88, v176, v177
    v_cvt_pk_bf16_f32 v89, v178, v179
    v_cvt_pk_bf16_f32 v90, v180, v181
    v_cvt_pk_bf16_f32 v91, v182, v183
    buffer_store_dwordx4 v[88:91], v1, s[4:7], s30 offen sc1
    v_cvt_pk_bf16_f32 v92, v184, v185
    v_cvt_pk_bf16_f32 v93, v186, v187
    v_cvt_pk_bf16_f32 v94, v188, v189
    v_cvt_pk_bf16_f32 v95, v190, v191
    buffer_store_dwordx4 v[92:95], v19, s[4:7], s30 offen sc1
    s_add_u32 s30, s30, s50
    v_cvt_pk_bf16_f32 v80, v192, v193
    v_cvt_pk_bf16_f32 v81, v194, v195
    v_cvt_pk_bf16_f32 v82, v196, v197
    v_cvt_pk_bf16_f32 v83, v198, v199
    buffer_store_dwordx4 v[80:83], v1, s[4:7], s30 offen sc1
    v_cvt_pk_bf16_f32 v84, v200, v201
    v_cvt_pk_bf16_f32 v85, v202, v203
    v_cvt_pk_bf16_f32 v86, v204, v205
    v_cvt_pk_bf16_f32 v87, v206, v207
    buffer_store_dwordx4 v[84:87], v19, s[4:7], s30 offen sc1
    s_add_u32 s30, s30, s50
    v_cvt_pk_bf16_f32 v88, v208, v209
    v_cvt_pk_bf16_f32 v89, v210, v211
    v_cvt_pk_bf16_f32 v90, v212, v213
    v_cvt_pk_bf16_f32 v91, v214, v215
    buffer_store_dwordx4 v[88:91], v1, s[4:7], s30 offen sc1
    v_cvt_pk_bf16_f32 v92, v216, v217
    v_cvt_pk_bf16_f32 v93, v218, v219
    v_cvt_pk_bf16_f32 v94, v220, v221
    v_cvt_pk_bf16_f32 v95, v222, v223
    buffer_store_dwordx4 v[92:95], v19, s[4:7], s30 offen sc1
    s_add_u32 s30, s30, s50
    v_cvt_pk_bf16_f32 v80, v224, v225
    v_cvt_pk_bf16_f32 v81, v226, v227
    v_cvt_pk_bf16_f32 v82, v228, v229
    v_cvt_pk_bf16_f32 v83, v230, v231
    buffer_store_dwordx4 v[80:83], v1, s[4:7], s30 offen sc1
    v_cvt_pk_bf16_f32 v84, v232, v233
    v_cvt_pk_bf16_f32 v85, v234, v235
    v_cvt_pk_bf16_f32 v86, v236, v237
    v_cvt_pk_bf16_f32 v87, v238, v239
    buffer_store_dwordx4 v[84:87], v19, s[4:7], s30 offen sc1
    s_add_u32 s30, s30, s50
    v_cvt_pk_bf16_f32 v88, v240, v241
    v_cvt_pk_bf16_f32 v89, v242, v243
    v_cvt_pk_bf16_f32 v90, v244, v245
    v_cvt_pk_bf16_f32 v91, v246, v247
    buffer_store_dwordx4 v[88:91], v1, s[4:7], s30 offen sc1
    v_cvt_pk_bf16_f32 v92, v248, v249
    v_cvt_pk_bf16_f32 v93, v250, v251
    v_cvt_pk_bf16_f32 v94, v252, v253
    v_cvt_pk_bf16_f32 v95, v254, v255
    buffer_store_dwordx4 v[92:95], v19, s[4:7], s30 offen sc1
    s_waitcnt lgkmcnt(0)
    v_or3_b32 v24, v24, v25, v26
    v_or3_b32 v28, v28, v29, v30
    v_or3_b32 v24, v24, v27, v31
    v_or_b32 v24, v24, v28
    s_mov_b32 s28, s51
    s_mov_b32 s57, s53
    v_readfirstlane_b32 s30, v24
    s_cmp_lg_u32 s30, 0
    s_cbranch_scc1 w_drain
    s_mov_b32 s48, s32
    s_cmp_ge_u32 s32, 4
    s_cselect_b32 s30, 2, 3
    s_lshl_b32 s30, s26, s30
    s_mul_i32 s30, s30, s43
    s_add_u32 s49, s42, s30
    s_mov_b32 s50, s43
    s_mov_b32 s51, s46
    s_mov_b32 s23, s41
    s_mov_b32 s53, s47
    s_nop 0
    s_load_dwordx16 s[32:47], s[24:25], 0
    s_add_u32 s24, s24, 64
    s_addc_u32 s25, s25, 0
    s_branch w_first16
w_epi_glu:
    s_lshl_b32 s30, s27, 10
    s_add_u32 s30, s30, s49
    s_mov_b32 s54, 0xbfb8aa3b
    s_nop 7
    v_cvt_pk_bf16_f32 v80, v128, v129
    v_cvt_pk_bf16_f32 v81, v130, v131
    v_cvt_pk_bf16_f32 v82, v132, v133
    v_cvt_pk_bf16_f32 v83, v134, v135
    v_lshlrev_b32 v96, 16, v80
    v_and_b32 v97, 0xffff0000, v80
    v_lshlrev_b32 v98, 16, v81
    v_and_b32 v99, 0xffff0000, v81
    v_lshlrev_b32 v100, 16, v82
    v_and_b32 v101, 0xffff0000, v82
    v_lshlrev_b32 v102, 16, v83
    v_and_b32 v103, 0xffff0000, v83
    v_mul_f32 v96, s54, v96
    v_mul_f32 v97, s54, v97
    v_mul_f32 v98, s54, v98
    v_mul_f32 v99, s54, v99
    v_mul_f32 v100, s54, v100
    v_mul_f32 v101, s54, v101
    v_mul_f32 v102, s54, v102
    v_mul_f32 v103, s54, v103
    v_exp_f32 v96, v96
    v_exp_f32 v97, v97
    v_exp_f32 v98, v98
    v_exp_f32 v99, v99
    v_exp_f32 v100, v100
    v_exp_f32 v101, v101
    v_exp_f32 v102, v102
    v_exp_f32 v103, v103
    v_add_f32 v96, 1.0, v96
    v_add_f32 v97, 1.0, v97
    v_add_f32 v98, 1.0, v98
    v_add_f32 v99, 1.0, v99
    v_add_f32 v100, 1.0, v100
    v_add_f32 v101, 1.0, v101
    v_add_f32 v102, 1.0, v102
    v_add_f32 v103, 1.0, v103
    v_rcp_f32 v96, v96
    v_rcp_f32 v97, v97
    v_rcp_f32 v98, v98
    v_rcp_f32 v99, v99
    v_rcp_f32 v100, v100
    v_rcp_f32 v101, v101
    v_rcp_f32 v102, v102
    v_rcp_f32 v103, v103
    v_mul_f32 v96, v96, v136
    v_mul_f32 v97, v97, v137
    v_mul_f32 v98, v98, v138
    v_mul_f32 v99, v99, v139
    v_mul_f32 v100, v100, v140
    v_mul_f32 v101, v101, v141
    v_mul_f32 v102, v102, v142
    v_mul_f32 v103, v103, v143
    v_cvt_pk_bf16_f32 v80, v96, v97
    v_cvt_pk_bf16_f32 v81, v98, v99
    v_cvt_pk_bf16_f32 v82, v100, v101
    v_cvt_pk_bf16_f32 v83, v102, v103
    buffer_store_dwordx4 v[80:83], v1, s[4:7], s30 offen sc1
    s_add_u32 s30, s30, s50
    v_cvt_pk_bf16_f32 v84, v144, v145
    v_cvt_pk_bf16_f32 v85, v146, v147
    v_cvt_pk_bf16_f32 v86, v148, v149
    v_cvt_pk_bf16_f32 v87, v150, v151
    v_lshlrev_b32 v104, 16, v84
    v_and_b32 v105, 0xffff0000, v84
    v_lshlrev_b32 v106, 16, v85
    v_and_b32 v107, 0xffff0000, v85
    v_lshlrev_b32 v108, 16, v86
    v_and_b32 v109, 0xffff0000, v86
    v_lshlrev_b32 v110, 16, v87
    v_and_b32 v111, 0xffff0000, v87
    v_mul_f32 v104, s54, v104
    v_mul_f32 v105, s54, v105
    v_mul_f32 v106, s54, v106
    v_mul_f32 v107, s54, v107
    v_mul_f32 v108, s54, v108
    v_mul_f32 v109, s54, v109
    v_mul_f32 v110, s54, v110
    v_mul_f32 v111, s54, v111
    v_exp_f32 v104, v104
    v_exp_f32 v105, v105
    v_exp_f32 v106, v106
    v_exp_f32 v107, v107
    v_exp_f32 v108, v108
    v_exp_f32 v109, v109
    v_exp_f32 v110, v110
    v_exp_f32 v111, v111
    v_add_f32 v104, 1.0, v104
    v_add_f32 v105, 1.0, v105
    v_add_f32 v106, 1.0, v106
    v_add_f32 v107, 1.0, v107
    v_add_f32 v108, 1.0, v108
    v_add_f32 v109, 1.0, v109
    v_add_f32 v110, 1.0, v110
    v_add_f32 v111, 1.0, v111
    v_rcp_f32 v104, v104
    v_rcp_f32 v105, v105
    v_rcp_f32 v106, v106
    v_rcp_f32 v107, v107
    v_rcp_f32 v108, v108
    v_rcp_f32 v109, v109
    v_rcp_f32 v110, v110
    v_rcp_f32 v111, v111
    v_mul_f32 v104, v104, v152
    v_mul_f32 v105, v105, v153
    v_mul_f32 v106, v106, v154
    v_mul_f32 v107, v107, v155
    v_mul_f32 v108, v108, v156
    v_mul_f32 v109, v109, v157
    v_mul_f32 v110, v110, v158
    v_mul_f32 v111, v111, v159
    v_cvt_pk_bf16_f32 v84, v104, v105
    v_cvt_pk_bf16_f32 v85, v106, v107
    v_cvt_pk_bf16_f32 v86, v108, v109
    v_cvt_pk_bf16_f32 v87, v110, v111
    buffer_store_dwordx4 v[84:87], v1, s[4:7], s30 offen sc1
    s_add_u32 s30, s30, s50
    v_cvt_pk_bf16_f32 v88, v160, v161
    v_cvt_pk_bf16_f32 v89, v162, v163
    v_cvt_pk_bf16_f32 v90, v164, v165
    v_cvt_pk_bf16_f32 v91, v166, v167
    v_lshlrev_b32 v96, 16, v88
    v_and_b32 v97, 0xffff0000, v88
    v_lshlrev_b32 v98, 16, v89
    v_and_b32 v99, 0xffff0000, v89
    v_lshlrev_b32 v100, 16, v90
    v_and_b32 v101, 0xffff0000, v90
    v_lshlrev_b32 v102, 16, v91
    v_and_b32 v103, 0xffff0000, v91
    v_mul_f32 v96, s54, v96
    v_mul_f32 v97, s54, v97
    v_mul_f32 v98, s54, v98
    v_mul_f32 v99, s54, v99
    v_mul_f32 v100, s54, v100
    v_mul_f32 v101, s54, v101
    v_mul_f32 v102, s54, v102
    v_mul_f32 v103, s54, v103
    v_exp_f32 v96, v96
    v_exp_f32 v97, v97
    v_exp_f32 v98, v98
    v_exp_f32 v99, v99
    v_exp_f32 v100, v100
    v_exp_f32 v101, v101
    v_exp_f32 v102, v102
    v_exp_f32 v103, v103
    v_add_f32 v96, 1.0, v96
    v_add_f32 v97, 1.0, v97
    v_add_f32 v98, 1.0, v98
    v_add_f32 v99, 1.0, v99
    v_add_f32 v100, 1.0, v100
    v_add_f32 v101, 1.0, v101
    v_add_f32 v102, 1.0, v102
    v_add_f32 v103, 1.0, v103
    v_rcp_f32 v96, v96
    v_rcp_f32 v97, v97
    v_rcp_f32 v98, v98
    v_rcp_f32 v99, v99
    v_rcp_f32 v100, v100
    v_rcp_f32 v101, v101
    v_rcp_f32 v102, v102
    v_rcp_f32 v103, v103
    v_mul_f32 v96, v96, v168
    v_mul_f32 v97, v97, v169
    v_mul_f32 v98, v98, v170
    v_mul_f32 v99, v99, v171
    v_mul_f32 v100, v100, v172
    v_mul_f32 v101, v101, v173
    v_mul_f32 v102, v102, v174
    v_mul_f32 v103, v103, v175
    v_cvt_pk_bf16_f32 v88, v96, v97
    v_cvt_pk_bf16_f32 v89, v98, v99
    v_cvt_pk_bf16_f32 v90, v100, v101
    v_cvt_pk_bf16_f32 v91, v102, v103
    buffer_store_dwordx4 v[88:91], v1, s[4:7], s30 offen sc1
    s_add_u32 s30, s30, s50
    v_cvt_pk_bf16_f32 v92, v176, v177
    v_cvt_pk_bf16_f32 v93, v178, v179
    v_cvt_pk_bf16_f32 v94, v180, v181
    v_cvt_pk_bf16_f32 v95, v182, v183
    v_lshlrev_b32 v104, 16, v92
    v_and_b32 v105, 0xffff0000, v92
    v_lshlrev_b32 v106, 16, v93
    v_and_b32 v107, 0xffff0000, v93
    v_lshlrev_b32 v108, 16, v94
    v_and_b32 v109, 0xffff0000, v94
    v_lshlrev_b32 v110, 16, v95
    v_and_b32 v111, 0xffff0000, v95
    v_mul_f32 v104, s54, v104
    v_mul_f32 v105, s54, v105
    v_mul_f32 v106, s54, v106
    v_mul_f32 v107, s54, v107
    v_mul_f32 v108, s54, v108
    v_mul_f32 v109, s54, v109
    v_mul_f32 v110, s54, v110
    v_mul_f32 v111, s54, v111
    v_exp_f32 v104, v104
    v_exp_f32 v105, v105
    v_exp_f32 v106, v106
    v_exp_f32 v107, v107
    v_exp_f32 v108, v108
    v_exp_f32 v109, v109
    v_exp_f32 v110, v110
    v_exp_f32 v111, v111
    v_add_f32 v104, 1.0, v104
    v_add_f32 v105, 1.0, v105
    v_add_f32 v106, 1.0, v106
    v_add_f32 v107, 1.0, v107
    v_add_f32 v108, 1.0, v108
    v_add_f32 v109, 1.0, v109
    v_add_f32 v110, 1.0, v110
    v_add_f32 v111, 1.0, v111
    v_rcp_f32 v104, v104
    v_rcp_f32 v105, v105
    v_rcp_f32 v106, v106
    v_rcp_f32 v107, v107
    v_rcp_f32 v108, v108
    v_rcp_f32 v109, v109
    v_rcp_f32 v110, v110
    v_rcp_f32 v111, v111
    v_mul_f32 v104, v104, v184
    v_mul_f32 v105, v105, v185
    v_mul_f32 v106, v106, v186
    v_mul_f32 v107, v107, v187
    v_mul_f32 v108, v108, v188
    v_mul_f32 v109, v109, v189
    v_mul_f32 v110, v110, v190
    v_mul_f32 v111, v111, v191
    v_cvt_pk_bf16_f32 v92, v104, v105
    v_cvt_pk_bf16_f32 v93, v106, v107
    v_cvt_pk_bf16_f32 v94, v108, v109
    v_cvt_pk_bf16_f32 v95, v110, v111
    buffer_store_dwordx4 v[92:95], v1, s[4:7], s30 offen sc1
    s_add_u32 s30, s30, s50
    v_cvt_pk_bf16_f32 v80, v192, v193
    v_cvt_pk_bf16_f32 v81, v194, v195
    v_cvt_pk_bf16_f32 v82, v196, v197
    v_cvt_pk_bf16_f32 v83, v198, v199
    v_lshlrev_b32 v96, 16, v80
    v_and_b32 v97, 0xffff0000, v80
    v_lshlrev_b32 v98, 16, v81
    v_and_b32 v99, 0xffff0000, v81
    v_lshlrev_b32 v100, 16, v82
    v_and_b32 v101, 0xffff0000, v82
    v_lshlrev_b32 v102, 16, v83
    v_and_b32 v103, 0xffff0000, v83
    v_mul_f32 v96, s54, v96
    v_mul_f32 v97, s54, v97
    v_mul_f32 v98, s54, v98
    v_mul_f32 v99, s54, v99
    v_mul_f32 v100, s54, v100
    v_mul_f32 v101, s54, v101
    v_mul_f32 v102, s54, v102
    v_mul_f32 v103, s54, v103
    v_exp_f32 v96, v96
    v_exp_f32 v97, v97
    v_exp_f32 v98, v98
    v_exp_f32 v99, v99
    v_exp_f32 v100, v100
    v_exp_f32 v101, v101
    v_exp_f32 v102, v102
    v_exp_f32 v103, v103
    v_add_f32 v96, 1.0, v96
    v_add_f32 v97, 1.0, v97
    v_add_f32 v98, 1.0, v98
    v_add_f32 v99, 1.0, v99
    v_add_f32 v100, 1.0, v100
    v_add_f32 v101, 1.0, v101
    v_add_f32 v102, 1.0, v102
    v_add_f32 v103, 1.0, v103
    v_rcp_f32 v96, v96
    v_rcp_f32 v97, v97
    v_rcp_f32 v98, v98
    v_rcp_f32 v99, v99
    v_rcp_f32 v100, v100
    v_rcp_f32 v101, v101
    v_rcp_f32 v102, v102
    v_rcp_f32 v103, v103
    v_mul_f32 v96, v96, v200
    v_mul_f32 v97, v97, v201
    v_mul_f32 v98, v98, v202
    v_mul_f32 v99, v99, v203
    v_mul_f32 v100, v100, v204
    v_mul_f32 v101, v101, v205
    v_mul_f32 v102, v102, v206
    v_mul_f32 v103, v103, v207
    v_cvt_pk_bf16_f32 v80, v96, v97
    v_cvt_pk_bf16_f32 v81, v98, v99
    v_cvt_pk_bf16_f32 v82, v100, v101
    v_cvt_pk_bf16_f32 v83, v102, v103
    buffer_store_dwordx4 v[80:83], v1, s[4:7], s30 offen sc1
    s_add_u32 s30, s30, s50
    v_cvt_pk_bf16_f32 v84, v208, v209
    v_cvt_pk_bf16_f32 v85, v210, v211
    v_cvt_pk_bf16_f32 v86, v212, v213
    v_cvt_pk_bf16_f32 v87, v214, v215
    v_lshlrev_b32 v104, 16, v84
    v_and_b32 v105, 0xffff0000, v84
    v_lshlrev_b32 v106, 16, v85
    v_and_b32 v107, 0xffff0000, v85
    v_lshlrev_b32 v108, 16, v86
    v_and_b32 v109, 0xffff0000, v86
    v_lshlrev_b32 v110, 16, v87
    v_and_b32 v111, 0xffff0000, v87
    v_mul_f32 v104, s54, v104
    v_mul_f32 v105, s54, v105
    v_mul_f32 v106, s54, v106
    v_mul_f32 v107, s54, v107
    v_mul_f32 v108, s54, v108
    v_mul_f32 v109, s54, v109
    v_mul_f32 v110, s54, v110
    v_mul_f32 v111, s54, v111
    v_exp_f32 v104, v104
    v_exp_f32 v105, v105
    v_exp_f32 v106, v106
    v_exp_f32 v107, v107
    v_exp_f32 v108, v108
    v_exp_f32 v109, v109
    v_exp_f32 v110, v110
    v_exp_f32 v111, v111
    v_add_f32 v104, 1.0, v104
    v_add_f32 v105, 1.0, v105
    v_add_f32 v106, 1.0, v106
    v_add_f32 v107, 1.0, v107
    v_add_f32 v108, 1.0, v108
    v_add_f32 v109, 1.0, v109
    v_add_f32 v110, 1.0, v110
    v_add_f32 v111, 1.0, v111
    v_rcp_f32 v104, v104
    v_rcp_f32 v105, v105
    v_rcp_f32 v106, v106
    v_rcp_f32 v107, v107
    v_rcp_f32 v108, v108
    v_rcp_f32 v109, v109
    v_rcp_f32 v110, v110
    v_rcp_f32 v111, v111
    v_mul_f32 v104, v104, v216
    v_mul_f32 v105, v105, v217
    v_mul_f32 v106, v106, v218
    v_mul_f32 v107, v107, v219
    v_mul_f32 v108, v108, v220
    v_mul_f32 v109, v109, v221
    v_mul_f32 v110, v110, v222
    v_mul_f32 v111, v111, v223
    v_cvt_pk_bf16_f32 v84, v104, v105
    v_cvt_pk_bf16_f32 v85, v106, v107
    v_cvt_pk_bf16_f32 v86, v108, v109
    v_cvt_pk_bf16_f32 v87, v110, v111
    buffer_store_dwordx4 v[84:87], v1, s[4:7], s30 offen sc1
    s_add_u32 s30, s30, s50
    v_cvt_pk_bf16_f32 v88, v224, v225
    v_cvt_pk_bf16_f32 v89, v226, v227
    v_cvt_pk_bf16_f32 v90, v228, v229
    v_cvt_pk_bf16_f32 v91, v230, v231
    v_lshlrev_b32 v96, 16, v88
    v_and_b32 v97, 0xffff0000, v88
    v_lshlrev_b32 v98, 16, v89
    v_and_b32 v99, 0xffff0000, v89
    v_lshlrev_b32 v100, 16, v90
    v_and_b32 v101, 0xffff0000, v90
    v_lshlrev_b32 v102, 16, v91
    v_and_b32 v103, 0xffff0000, v91
    v_mul_f32 v96, s54, v96
    v_mul_f32 v97, s54, v97
    v_mul_f32 v98, s54, v98
    v_mul_f32 v99, s54, v99
    v_mul_f32 v100, s54, v100
    v_mul_f32 v101, s54, v101
    v_mul_f32 v102, s54, v102
    v_mul_f32 v103, s54, v103
    v_exp_f32 v96, v96
    v_exp_f32 v97, v97
    v_exp_f32 v98, v98
    v_exp_f32 v99, v99
    v_exp_f32 v100, v100
    v_exp_f32 v101, v101
    v_exp_f32 v102, v102
    v_exp_f32 v103, v103
    v_add_f32 v96, 1.0, v96
    v_add_f32 v97, 1.0, v97
    v_add_f32 v98, 1.0, v98
    v_add_f32 v99, 1.0, v99
    v_add_f32 v100, 1.0, v100
    v_add_f32 v101, 1.0, v101
    v_add_f32 v102, 1.0, v102
    v_add_f32 v103, 1.0, v103
    v_rcp_f32 v96, v96
    v_rcp_f32 v97, v97
    v_rcp_f32 v98, v98
    v_rcp_f32 v99, v99
    v_rcp_f32 v100, v100
    v_rcp_f32 v101, v101
    v_rcp_f32 v102, v102
    v_rcp_f32 v103, v103
    v_mul_f32 v96, v96, v232
    v_mul_f32 v97, v97, v233
    v_mul_f32 v98, v98, v234
    v_mul_f32 v99, v99, v235
    v_mul_f32 v100, v100, v236
    v_mul_f32 v101, v101, v237
    v_mul_f32 v102, v102, v238
    v_mul_f32 v103, v103, v239
    v_cvt_pk_bf16_f32 v88, v96, v97
    v_cvt_pk_bf16_f32 v89, v98, v99
    v_cvt_pk_bf16_f32 v90, v100, v101
    v_cvt_pk_bf16_f32 v91, v102, v103
    buffer_store_dwordx4 v[88:91], v1, s[4:7], s30 offen sc1
    s_add_u32 s30, s30, s50
    v_cvt_pk_bf16_f32 v92, v240, v241
    v_cvt_pk_bf16_f32 v93, v242, v243
    v_cvt_pk_bf16_f32 v94, v244, v245
    v_cvt_pk_bf16_f32 v95, v246, v247
    v_lshlrev_b32 v104, 16, v92
    v_and_b32 v105, 0xffff0000, v92
    v_lshlrev_b32 v106, 16, v93
    v_and_b32 v107, 0xffff0000, v93
    v_lshlrev_b32 v108, 16, v94
    v_and_b32 v109, 0xffff0000, v94
    v_lshlrev_b32 v110, 16, v95
    v_and_b32 v111, 0xffff0000, v95
    v_mul_f32 v104, s54, v104
    v_mul_f32 v105, s54, v105
    v_mul_f32 v106, s54, v106
    v_mul_f32 v107, s54, v107
    v_mul_f32 v108, s54, v108
    v_mul_f32 v109, s54, v109
    v_mul_f32 v110, s54, v110
    v_mul_f32 v111, s54, v111
    v_exp_f32 v104, v104
    v_exp_f32 v105, v105
    v_exp_f32 v106, v106
    v_exp_f32 v107, v107
    v_exp_f32 v108, v108
    v_exp_f32 v109, v109
    v_exp_f32 v110, v110
    v_exp_f32 v111, v111
    v_add_f32 v104, 1.0, v104
    v_add_f32 v105, 1.0, v105
    v_add_f32 v106, 1.0, v106
    v_add_f32 v107, 1.0, v107
    v_add_f32 v108, 1.0, v108
    v_add_f32 v109, 1.0, v109
    v_add_f32 v110, 1.0, v110
    v_add_f32 v111, 1.0, v111
    v_rcp_f32 v104, v104
    v_rcp_f32 v105, v105
    v_rcp_f32 v106, v106
    v_rcp_f32 v107, v107
    v_rcp_f32 v108, v108
    v_rcp_f32 v109, v109
    v_rcp_f32 v110, v110
    v_rcp_f32 v111, v111
    v_mul_f32 v104, v104, v248
    v_mul_f32 v105, v105, v249
    v_mul_f32 v106, v106, v250
    v_mul_f32 v107, v107, v251
    v_mul_f32 v108, v108, v252
    v_mul_f32 v109, v109, v253
    v_mul_f32 v110, v110, v254
    v_mul_f32 v111, v111, v255
    v_cvt_pk_bf16_f32 v92, v104, v105
    v_cvt_pk_bf16_f32 v93, v106, v107
    v_cvt_pk_bf16_f32 v94, v108, v109
    v_cvt_pk_bf16_f32 v95, v110, v111
    buffer_store_dwordx4 v[92:95], v1, s[4:7], s30 offen sc1
    s_waitcnt lgkmcnt(0)
    v_or3_b32 v24, v24, v25, v26
    v_or3_b32 v28, v28, v29, v30
    v_or3_b32 v24, v24, v27, v31
    v_or_b32 v24, v24, v28
    s_mov_b32 s28, s51
    s_mov_b32 s57, s53
    v_readfirstlane_b32 s30, v24
    s_cmp_lg_u32 s30, 0
    s_cbranch_scc1 w_drain
    s_mov_b32 s48, s32
    s_cmp_ge_u32 s32, 4
    s_cselect_b32 s30, 2, 3
    s_lshl_b32 s30, s26, s30
    s_mul_i32 s30, s30, s43
    s_add_u32 s49, s42, s30
    s_mov_b32 s50, s43
    s_mov_b32 s51, s46
    s_mov_b32 s23, s41
    s_mov_b32 s53, s47
    s_nop 0
    s_load_dwordx16 s[32:47], s[24:25], 0
    s_add_u32 s24, s24, 64
    s_addc_u32 s25, s25, 0
    s_branch w_first8
w_epi_silu:
    s_lshl_b32 s30, s27, 10
    s_add_u32 s30, s30, s49
    s_mov_b32 s54, 0xbfb8aa3b
    s_nop 7
    v_cvt_pk_bf16_f32 v80, v128, v129
    v_cvt_pk_bf16_f32 v81, v130, v131
    v_cvt_pk_bf16_f32 v82, v132, v133
    v_cvt_pk_bf16_f32 v83, v134, v135
    v_lshlrev_b32 v128, 16, v80
    v_and_b32 v129, 0xffff0000, v80
    v_lshlrev_b32 v130, 16, v81
    v_and_b32 v131, 0xffff0000, v81
    v_lshlrev_b32 v132, 16, v82
    v_and_b32 v133, 0xffff0000, v82
    v_lshlrev_b32 v134, 16, v83
    v_and_b32 v135, 0xffff0000, v83
    v_mul_f32 v104, s54, v128
    v_mul_f32 v105, s54, v129
    v_mul_f32 v106, s54, v130
    v_mul_f32 v107, s54, v131
    v_mul_f32 v108, s54, v132
    v_mul_f32 v109, s54, v133
    v_mul_f32 v110, s54, v134
    v_mul_f32 v111, s54, v135
    v_exp_f32 v104, v104
    v_exp_f32 v105, v105
    v_exp_f32 v106, v106
    v_exp_f32 v107, v107
    v_exp_f32 v108, v108
    v_exp_f32 v109, v109
    v_exp_f32 v110, v110
    v_exp_f32 v111, v111
    v_add_f32 v104, 1.0, v104
    v_add_f32 v105, 1.0, v105
    v_add_f32 v106, 1.0, v106
    v_add_f32 v107, 1.0, v107
    v_add_f32 v108, 1.0, v108
    v_add_f32 v109, 1.0, v109
    v_add_f32 v110, 1.0, v110
    v_add_f32 v111, 1.0, v111
    v_rcp_f32 v104, v104
    v_rcp_f32 v105, v105
    v_rcp_f32 v106, v106
    v_rcp_f32 v107, v107
    v_rcp_f32 v108, v108
    v_rcp_f32 v109, v109
    v_rcp_f32 v110, v110
    v_rcp_f32 v111, v111
    v_mul_f32 v128, v128, v104
    v_mul_f32 v129, v129, v105
    v_mul_f32 v130, v130, v106
    v_mul_f32 v131, v131, v107
    v_mul_f32 v132, v132, v108
    v_mul_f32 v133, v133, v109
    v_mul_f32 v134, v134, v110
    v_mul_f32 v135, v135, v111
    v_cvt_pk_bf16_f32 v80, v128, v129
    v_cvt_pk_bf16_f32 v81, v130, v131
    v_cvt_pk_bf16_f32 v82, v132, v133
    v_cvt_pk_bf16_f32 v83, v134, v135
    buffer_store_dwordx4 v[80:83], v1, s[4:7], s30 offen sc1
    v_cvt_pk_bf16_f32 v84, v136, v137
    v_cvt_pk_bf16_f32 v85, v138, v139
    v_cvt_pk_bf16_f32 v86, v140, v141
    v_cvt_pk_bf16_f32 v87, v142, v143
    v_lshlrev_b32 v136, 16, v84
    v_and_b32 v137, 0xffff0000, v84
    v_lshlrev_b32 v138, 16, v85
    v_and_b32 v139, 0xffff0000, v85
    v_lshlrev_b32 v140, 16, v86
    v_and_b32 v141, 0xffff0000, v86
    v_lshlrev_b32 v142, 16, v87
    v_and_b32 v143, 0xffff0000, v87
    v_mul_f32 v96, s54, v136
    v_mul_f32 v97, s54, v137
    v_mul_f32 v98, s54, v138
    v_mul_f32 v99, s54, v139
    v_mul_f32 v100, s54, v140
    v_mul_f32 v101, s54, v141
    v_mul_f32 v102, s54, v142
    v_mul_f32 v103, s54, v143
    v_exp_f32 v96, v96
    v_exp_f32 v97, v97
    v_exp_f32 v98, v98
    v_exp_f32 v99, v99
    v_exp_f32 v100, v100
    v_exp_f32 v101, v101
    v_exp_f32 v102, v102
    v_exp_f32 v103, v103
    v_add_f32 v96, 1.0, v96
    v_add_f32 v97, 1.0, v97
    v_add_f32 v98, 1.0, v98
    v_add_f32 v99, 1.0, v99
    v_add_f32 v100, 1.0, v100
    v_add_f32 v101, 1.0, v101
    v_add_f32 v102, 1.0, v102
    v_add_f32 v103, 1.0, v103
    v_rcp_f32 v96, v96
    v_rcp_f32 v97, v97
    v_rcp_f32 v98, v98
    v_rcp_f32 v99, v99
    v_rcp_f32 v100, v100
    v_rcp_f32 v101, v101
    v_rcp_f32 v102, v102
    v_rcp_f32 v103, v103
    v_mul_f32 v136, v136, v96
    v_mul_f32 v137, v137, v97
    v_mul_f32 v138, v138, v98
    v_mul_f32 v139, v139, v99
    v_mul_f32 v140, v140, v100
    v_mul_f32 v141, v141, v101
    v_mul_f32 v142, v142, v102
    v_mul_f32 v143, v143, v103
    v_cvt_pk_bf16_f32 v84, v136, v137
    v_cvt_pk_bf16_f32 v85, v138, v139
    v_cvt_pk_bf16_f32 v86, v140, v141
    v_cvt_pk_bf16_f32 v87, v142, v143
    buffer_store_dwordx4 v[84:87], v19, s[4:7], s30 offen sc1
    s_add_u32 s30, s30, s50
    v_cvt_pk_bf16_f32 v88, v144, v145
    v_cvt_pk_bf16_f32 v89, v146, v147
    v_cvt_pk_bf16_f32 v90, v148, v149
    v_cvt_pk_bf16_f32 v91, v150, v151
    v_lshlrev_b32 v144, 16, v88
    v_and_b32 v145, 0xffff0000, v88
    v_lshlrev_b32 v146, 16, v89
    v_and_b32 v147, 0xffff0000, v89
    v_lshlrev_b32 v148, 16, v90
    v_and_b32 v149, 0xffff0000, v90
    v_lshlrev_b32 v150, 16, v91
    v_and_b32 v151, 0xffff0000, v91
    v_mul_f32 v104, s54, v144
    v_mul_f32 v105, s54, v145
    v_mul_f32 v106, s54, v146
    v_mul_f32 v107, s54, v147
    v_mul_f32 v108, s54, v148
    v_mul_f32 v109, s54, v149
    v_mul_f32 v110, s54, v150
    v_mul_f32 v111, s54, v151
    v_exp_f32 v104, v104
    v_exp_f32 v105, v105
    v_exp_f32 v106, v106
    v_exp_f32 v107, v107
    v_exp_f32 v108, v108
    v_exp_f32 v109, v109
    v_exp_f32 v110, v110
    v_exp_f32 v111, v111
    v_add_f32 v104, 1.0, v104
    v_add_f32 v105, 1.0, v105
    v_add_f32 v106, 1.0, v106
    v_add_f32 v107, 1.0, v107
    v_add_f32 v108, 1.0, v108
    v_add_f32 v109, 1.0, v109
    v_add_f32 v110, 1.0, v110
    v_add_f32 v111, 1.0, v111
    v_rcp_f32 v104, v104
    v_rcp_f32 v105, v105
    v_rcp_f32 v106, v106
    v_rcp_f32 v107, v107
    v_rcp_f32 v108, v108
    v_rcp_f32 v109, v109
    v_rcp_f32 v110, v110
    v_rcp_f32 v111, v111
    v_mul_f32 v144, v144, v104
    v_mul_f32 v145, v145, v105
    v_mul_f32 v146, v146, v106
    v_mul_f32 v147, v147, v107
    v_mul_f32 v148, v148, v108
    v_mul_f32 v149, v149, v109
    v_mul_f32 v150, v150, v110
    v_mul_f32 v151, v151, v111
    v_cvt_pk_bf16_f32 v88, v144, v145
    v_cvt_pk_bf16_f32 v89, v146, v147
    v_cvt_pk_bf16_f32 v90, v148, v149
    v_cvt_pk_bf16_f32 v91, v150, v151
    buffer_store_dwordx4 v[88:91], v1, s[4:7], s30 offen sc1
    v_cvt_pk_bf16_f32 v92, v152, v153
    v_cvt_pk_bf16_f32 v93, v154, v155
    v_cvt_pk_bf16_f32 v94, v156, v157
    v_cvt_pk_bf16_f32 v95, v158, v159
    v_lshlrev_b32 v152, 16, v92
    v_and_b32 v153, 0xffff0000, v92
    v_lshlrev_b32 v154, 16, v93
    v_and_b32 v155, 0xffff0000, v93
    v_lshlrev_b32 v156, 16, v94
    v_and_b32 v157, 0xffff0000, v94
    v_lshlrev_b32 v158, 16, v95
    v_and_b32 v159, 0xffff0000, v95
    v_mul_f32 v96, s54, v152
    v_mul_f32 v97, s54, v153
    v_mul_f32 v98, s54, v154
    v_mul_f32 v99, s54, v155
    v_mul_f32 v100, s54, v156
    v_mul_f32 v101, s54, v157
    v_mul_f32 v102, s54, v158
    v_mul_f32 v103, s54, v159
    v_exp_f32 v96, v96
    v_exp_f32 v97, v97
    v_exp_f32 v98, v98
    v_exp_f32 v99, v99
    v_exp_f32 v100, v100
    v_exp_f32 v101, v101
    v_exp_f32 v102, v102
    v_exp_f32 v103, v103
    v_add_f32 v96, 1.0, v96
    v_add_f32 v97, 1.0, v97
    v_add_f32 v98, 1.0, v98
    v_add_f32 v99, 1.0, v99
    v_add_f32 v100, 1.0, v100
    v_add_f32 v101, 1.0, v101
    v_add_f32 v102, 1.0, v102
    v_add_f32 v103, 1.0, v103
    v_rcp_f32 v96, v96
    v_rcp_f32 v97, v97
    v_rcp_f32 v98, v98
    v_rcp_f32 v99, v99
    v_rcp_f32 v100, v100
    v_rcp_f32 v101, v101
    v_rcp_f32 v102, v102
    v_rcp_f32 v103, v103
    v_mul_f32 v152, v152, v96
    v_mul_f32 v153, v153, v97
    v_mul_f32 v154, v154, v98
    v_mul_f32 v155, v155, v99
    v_mul_f32 v156, v156, v100
    v_mul_f32 v157, v157, v101
    v_mul_f32 v158, v158, v102
    v_mul_f32 v159, v159, v103
    v_cvt_pk_bf16_f32 v92, v152, v153
    v_cvt_pk_bf16_f32 v93, v154, v155
    v_cvt_pk_bf16_f32 v94, v156, v157
    v_cvt_pk_bf16_f32 v95, v158, v159
    buffer_store_dwordx4 v[92:95], v19, s[4:7], s30 offen sc1
    s_add_u32 s30, s30, s50
    v_cvt_pk_bf16_f32 v80, v160, v161
    v_cvt_pk_bf16_f32 v81, v162, v163
    v_cvt_pk_bf16_f32 v82, v164, v165
    v_cvt_pk_bf16_f32 v83, v166, v167
    v_lshlrev_b32 v160, 16, v80
    v_and_b32 v161, 0xffff0000, v80
    v_lshlrev_b32 v162, 16, v81
    v_and_b32 v163, 0xffff0000, v81
    v_lshlrev_b32 v164, 16, v82
    v_and_b32 v165, 0xffff0000, v82
    v_lshlrev_b32 v166, 16, v83
    v_and_b32 v167, 0xffff0000, v83
    v_mul_f32 v104, s54, v160
    v_mul_f32 v105, s54, v161
    v_mul_f32 v106, s54, v162
    v_mul_f32 v107, s54, v163
    v_mul_f32 v108, s54, v164
    v_mul_f32 v109, s54, v165
    v_mul_f32 v110, s54, v166
    v_mul_f32 v111, s54, v167
    v_exp_f32 v104, v104
    v_exp_f32 v105, v105
    v_exp_f32 v106, v106
    v_exp_f32 v107, v107
    v_exp_f32 v108, v108
    v_exp_f32 v109, v109
    v_exp_f32 v110, v110
    v_exp_f32 v111, v111
    v_add_f32 v104, 1.0, v104
    v_add_f32 v105, 1.0, v105
    v_add_f32 v106, 1.0, v106
    v_add_f32 v107, 1.0, v107
    v_add_f32 v108, 1.0, v108
    v_add_f32 v109, 1.0, v109
    v_add_f32 v110, 1.0, v110
    v_add_f32 v111, 1.0, v111
    v_rcp_f32 v104, v104
    v_rcp_f32 v105, v105
    v_rcp_f32 v106, v106
    v_rcp_f32 v107, v107
    v_rcp_f32 v108, v108
    v_rcp_f32 v109, v109
    v_rcp_f32 v110, v110
    v_rcp_f32 v111, v111
    v_mul_f32 v160, v160, v104
    v_mul_f32 v161, v161, v105
    v_mul_f32 v162, v162, v106
    v_mul_f32 v163, v163, v107
    v_mul_f32 v164, v164, v108
    v_mul_f32 v165, v165, v109
    v_mul_f32 v166, v166, v110
    v_mul_f32 v167, v167, v111
    v_cvt_pk_bf16_f32 v80, v160, v161
    v_cvt_pk_bf16_f32 v81, v162, v163
    v_cvt_pk_bf16_f32 v82, v164, v165
    v_cvt_pk_bf16_f32 v83, v166, v167
    buffer_store_dwordx4 v[80:83], v1, s[4:7], s30 offen sc1
    v_cvt_pk_bf16_f32 v84, v168, v169
    v_cvt_pk_bf16_f32 v85, v170, v171
    v_cvt_pk_bf16_f32 v86, v172, v173
    v_cvt_pk_bf16_f32 v87, v174, v175
    v_lshlrev_b32 v168, 16, v84
    v_and_b32 v169, 0xffff0000, v84
    v_lshlrev_b32 v170, 16, v85
    v_and_b32 v171, 0xffff0000, v85
    v_lshlrev_b32 v172, 16, v86
    v_and_b32 v173, 0xffff0000, v86
    v_lshlrev_b32 v174, 16, v87
    v_and_b32 v175, 0xffff0000, v87
    v_mul_f32 v96, s54, v168
    v_mul_f32 v97, s54, v169
    v_mul_f32 v98, s54, v170
    v_mul_f32 v99, s54, v171
    v_mul_f32 v100, s54, v172
    v_mul_f32 v101, s54, v173
    v_mul_f32 v102, s54, v174
    v_mul_f32 v103, s54, v175
    v_exp_f32 v96, v96
    v_exp_f32 v97, v97
    v_exp_f32 v98, v98
    v_exp_f32 v99, v99
    v_exp_f32 v100, v100
    v_exp_f32 v101, v101
    v_exp_f32 v102, v102
    v_exp_f32 v103, v103
    v_add_f32 v96, 1.0, v96
    v_add_f32 v97, 1.0, v97
    v_add_f32 v98, 1.0, v98
    v_add_f32 v99, 1.0, v99
    v_add_f32 v100, 1.0, v100
    v_add_f32 v101, 1.0, v101
    v_add_f32 v102, 1.0, v102
    v_add_f32 v103, 1.0, v103
    v_rcp_f32 v96, v96
    v_rcp_f32 v97, v97
    v_rcp_f32 v98, v98
    v_rcp_f32 v99, v99
    v_rcp_f32 v100, v100
    v_rcp_f32 v101, v101
    v_rcp_f32 v102, v102
    v_rcp_f32 v103, v103
    v_mul_f32 v168, v168, v96
    v_mul_f32 v169, v169, v97
    v_mul_f32 v170, v170, v98
    v_mul_f32 v171, v171, v99
    v_mul_f32 v172, v172, v100
    v_mul_f32 v173, v173, v101
    v_mul_f32 v174, v174, v102
    v_mul_f32 v175, v175, v103
    v_cvt_pk_bf16_f32 v84, v168, v169
    v_cvt_pk_bf16_f32 v85, v170, v171
    v_cvt_pk_bf16_f32 v86, v172, v173
    v_cvt_pk_bf16_f32 v87, v174, v175
    buffer_store_dwordx4 v[84:87], v19, s[4:7], s30 offen sc1
    s_add_u32 s30, s30, s50
    v_cvt_pk_bf16_f32 v88, v176, v177
    v_cvt_pk_bf16_f32 v89, v178, v179
    v_cvt_pk_bf16_f32 v90, v180, v181
    v_cvt_pk_bf16_f32 v91, v182, v183
    v_lshlrev_b32 v176, 16, v88
    v_and_b32 v177, 0xffff0000, v88
    v_lshlrev_b32 v178, 16, v89
    v_and_b32 v179, 0xffff0000, v89
    v_lshlrev_b32 v180, 16, v90
    v_and_b32 v181, 0xffff0000, v90
    v_lshlrev_b32 v182, 16, v91
    v_and_b32 v183, 0xffff0000, v91
    v_mul_f32 v104, s54, v176
    v_mul_f32 v105, s54, v177
    v_mul_f32 v106, s54, v178
    v_mul_f32 v107, s54, v179
    v_mul_f32 v108, s54, v180
    v_mul_f32 v109, s54, v181
    v_mul_f32 v110, s54, v182
    v_mul_f32 v111, s54, v183
    v_exp_f32 v104, v104
    v_exp_f32 v105, v105
    v_exp_f32 v106, v106
    v_exp_f32 v107, v107
    v_exp_f32 v108, v108
    v_exp_f32 v109, v109
    v_exp_f32 v110, v110
    v_exp_f32 v111, v111
    v_add_f32 v104, 1.0, v104
    v_add_f32 v105, 1.0, v105
    v_add_f32 v106, 1.0, v106
    v_add_f32 v107, 1.0, v107
    v_add_f32 v108, 1.0, v108
    v_add_f32 v109, 1.0, v109
    v_add_f32 v110, 1.0, v110
    v_add_f32 v111, 1.0, v111
    v_rcp_f32 v104, v104
    v_rcp_f32 v105, v105
    v_rcp_f32 v106, v106
    v_rcp_f32 v107, v107
    v_rcp_f32 v108, v108
    v_rcp_f32 v109, v109
    v_rcp_f32 v110, v110
    v_rcp_f32 v111, v111
    v_mul_f32 v176, v176, v104
    v_mul_f32 v177, v177, v105
    v_mul_f32 v178, v178, v106
    v_mul_f32 v179, v179, v107
    v_mul_f32 v180, v180, v108
    v_mul_f32 v181, v181, v109
    v_mul_f32 v182, v182, v110
    v_mul_f32 v183, v183, v111
    v_cvt_pk_bf16_f32 v88, v176, v177
    v_cvt_pk_bf16_f32 v89, v178, v179
    v_cvt_pk_bf16_f32 v90, v180, v181
    v_cvt_pk_bf16_f32 v91, v182, v183
    buffer_store_dwordx4 v[88:91], v1, s[4:7], s30 offen sc1
    v_cvt_pk_bf16_f32 v92, v184, v185
    v_cvt_pk_bf16_f32 v93, v186, v187
    v_cvt_pk_bf16_f32 v94, v188, v189
    v_cvt_pk_bf16_f32 v95, v190, v191
    v_lshlrev_b32 v184, 16, v92
    v_and_b32 v185, 0xffff0000, v92
    v_lshlrev_b32 v186, 16, v93
    v_and_b32 v187, 0xffff0000, v93
    v_lshlrev_b32 v188, 16, v94
    v_and_b32 v189, 0xffff0000, v94
    v_lshlrev_b32 v190, 16, v95
    v_and_b32 v191, 0xffff0000, v95
    v_mul_f32 v96, s54, v184
    v_mul_f32 v97, s54, v185
    v_mul_f32 v98, s54, v186
    v_mul_f32 v99, s54, v187
    v_mul_f32 v100, s54, v188
    v_mul_f32 v101, s54, v189
    v_mul_f32 v102, s54, v190
    v_mul_f32 v103, s54, v191
    v_exp_f32 v96, v96
    v_exp_f32 v97, v97
    v_exp_f32 v98, v98
    v_exp_f32 v99, v99
    v_exp_f32 v100, v100
    v_exp_f32 v101, v101
    v_exp_f32 v102, v102
    v_exp_f32 v103, v103
    v_add_f32 v96, 1.0, v96
    v_add_f32 v97, 1.0, v97
    v_add_f32 v98, 1.0, v98
    v_add_f32 v99, 1.0, v99
    v_add_f32 v100, 1.0, v100
    v_add_f32 v101, 1.0, v101
    v_add_f32 v102, 1.0, v102
    v_add_f32 v103, 1.0, v103
    v_rcp_f32 v96, v96
    v_rcp_f32 v97, v97
    v_rcp_f32 v98, v98
    v_rcp_f32 v99, v99
    v_rcp_f32 v100, v100
    v_rcp_f32 v101, v101
    v_rcp_f32 v102, v102
    v_rcp_f32 v103, v103
    v_mul_f32 v184, v184, v96
    v_mul_f32 v185, v185, v97
    v_mul_f32 v186, v186, v98
    v_mul_f32 v187, v187, v99
    v_mul_f32 v188, v188, v100
    v_mul_f32 v189, v189, v101
    v_mul_f32 v190, v190, v102
    v_mul_f32 v191, v191, v103
    v_cvt_pk_bf16_f32 v92, v184, v185
    v_cvt_pk_bf16_f32 v93, v186, v187
    v_cvt_pk_bf16_f32 v94, v188, v189
    v_cvt_pk_bf16_f32 v95, v190, v191
    buffer_store_dwordx4 v[92:95], v19, s[4:7], s30 offen sc1
    s_add_u32 s30, s30, s50
    v_cvt_pk_bf16_f32 v80, v192, v193
    v_cvt_pk_bf16_f32 v81, v194, v195
    v_cvt_pk_bf16_f32 v82, v196, v197
    v_cvt_pk_bf16_f32 v83, v198, v199
    v_lshlrev_b32 v192, 16, v80
    v_and_b32 v193, 0xffff0000, v80
    v_lshlrev_b32 v194, 16, v81
    v_and_b32 v195, 0xffff0000, v81
    v_lshlrev_b32 v196, 16, v82
    v_and_b32 v197, 0xffff0000, v82
    v_lshlrev_b32 v198, 16, v83
    v_and_b32 v199, 0xffff0000, v83
    v_mul_f32 v104, s54, v192
    v_mul_f32 v105, s54, v193
    v_mul_f32 v106, s54, v194
    v_mul_f32 v107, s54, v195
    v_mul_f32 v108, s54, v196
    v_mul_f32 v109, s54, v197
    v_mul_f32 v110, s54, v198
    v_mul_f32 v111, s54, v199
    v_exp_f32 v104, v104
    v_exp_f32 v105, v105
    v_exp_f32 v106, v106
    v_exp_f32 v107, v107
    v_exp_f32 v108, v108
    v_exp_f32 v109, v109
    v_exp_f32 v110, v110
    v_exp_f32 v111, v111
    v_add_f32 v104, 1.0, v104
    v_add_f32 v105, 1.0, v105
    v_add_f32 v106, 1.0, v106
    v_add_f32 v107, 1.0, v107
    v_add_f32 v108, 1.0, v108
    v_add_f32 v109, 1.0, v109
    v_add_f32 v110, 1.0, v110
    v_add_f32 v111, 1.0, v111
    v_rcp_f32 v104, v104
    v_rcp_f32 v105, v105
    v_rcp_f32 v106, v106
    v_rcp_f32 v107, v107
    v_rcp_f32 v108, v108
    v_rcp_f32 v109, v109
    v_rcp_f32 v110, v110
    v_rcp_f32 v111, v111
    v_mul_f32 v192, v192, v104
    v_mul_f32 v193, v193, v105
    v_mul_f32 v194, v194, v106
    v_mul_f32 v195, v195, v107
    v_mul_f32 v196, v196, v108
    v_mul_f32 v197, v197, v109
    v_mul_f32 v198, v198, v110
    v_mul_f32 v199, v199, v111
    v_cvt_pk_bf16_f32 v80, v192, v193
    v_cvt_pk_bf16_f32 v81, v194, v195
    v_cvt_pk_bf16_f32 v82, v196, v197
    v_cvt_pk_bf16_f32 v83, v198, v199
    buffer_store_dwordx4 v[80:83], v1, s[4:7], s30 offen sc1
    v_cvt_pk_bf16_f32 v84, v200, v201
    v_cvt_pk_bf16_f32 v85, v202, v203
    v_cvt_pk_bf16_f32 v86, v204, v205
    v_cvt_pk_bf16_f32 v87, v206, v207
    v_lshlrev_b32 v200, 16, v84
    v_and_b32 v201, 0xffff0000, v84
    v_lshlrev_b32 v202, 16, v85
    v_and_b32 v203, 0xffff0000, v85
    v_lshlrev_b32 v204, 16, v86
    v_and_b32 v205, 0xffff0000, v86
    v_lshlrev_b32 v206, 16, v87
    v_and_b32 v207, 0xffff0000, v87
    v_mul_f32 v96, s54, v200
    v_mul_f32 v97, s54, v201
    v_mul_f32 v98, s54, v202
    v_mul_f32 v99, s54, v203
    v_mul_f32 v100, s54, v204
    v_mul_f32 v101, s54, v205
    v_mul_f32 v102, s54, v206
    v_mul_f32 v103, s54, v207
    v_exp_f32 v96, v96
    v_exp_f32 v97, v97
    v_exp_f32 v98, v98
    v_exp_f32 v99, v99
    v_exp_f32 v100, v100
    v_exp_f32 v101, v101
    v_exp_f32 v102, v102
    v_exp_f32 v103, v103
    v_add_f32 v96, 1.0, v96
    v_add_f32 v97, 1.0, v97
    v_add_f32 v98, 1.0, v98
    v_add_f32 v99, 1.0, v99
    v_add_f32 v100, 1.0, v100
    v_add_f32 v101, 1.0, v101
    v_add_f32 v102, 1.0, v102
    v_add_f32 v103, 1.0, v103
    v_rcp_f32 v96, v96
    v_rcp_f32 v97, v97
    v_rcp_f32 v98, v98
    v_rcp_f32 v99, v99
    v_rcp_f32 v100, v100
    v_rcp_f32 v101, v101
    v_rcp_f32 v102, v102
    v_rcp_f32 v103, v103
    v_mul_f32 v200, v200, v96
    v_mul_f32 v201, v201, v97
    v_mul_f32 v202, v202, v98
    v_mul_f32 v203, v203, v99
    v_mul_f32 v204, v204, v100
    v_mul_f32 v205, v205, v101
    v_mul_f32 v206, v206, v102
    v_mul_f32 v207, v207, v103
    v_cvt_pk_bf16_f32 v84, v200, v201
    v_cvt_pk_bf16_f32 v85, v202, v203
    v_cvt_pk_bf16_f32 v86, v204, v205
    v_cvt_pk_bf16_f32 v87, v206, v207
    buffer_store_dwordx4 v[84:87], v19, s[4:7], s30 offen sc1
    s_add_u32 s30, s30, s50
    v_cvt_pk_bf16_f32 v88, v208, v209
    v_cvt_pk_bf16_f32 v89, v210, v211
    v_cvt_pk_bf16_f32 v90, v212, v213
    v_cvt_pk_bf16_f32 v91, v214, v215
    v_lshlrev_b32 v208, 16, v88
    v_and_b32 v209, 0xffff0000, v88
    v_lshlrev_b32 v210, 16, v89
    v_and_b32 v211, 0xffff0000, v89
    v_lshlrev_b32 v212, 16, v90
    v_and_b32 v213, 0xffff0000, v90
    v_lshlrev_b32 v214, 16, v91
    v_and_b32 v215, 0xffff0000, v91
    v_mul_f32 v104, s54, v208
    v_mul_f32 v105, s54, v209
    v_mul_f32 v106, s54, v210
    v_mul_f32 v107, s54, v211
    v_mul_f32 v108, s54, v212
    v_mul_f32 v109, s54, v213
    v_mul_f32 v110, s54, v214
    v_mul_f32 v111, s54, v215
    v_exp_f32 v104, v104
    v_exp_f32 v105, v105
    v_exp_f32 v106, v106
    v_exp_f32 v107, v107
    v_exp_f32 v108, v108
    v_exp_f32 v109, v109
    v_exp_f32 v110, v110
    v_exp_f32 v111, v111
    v_add_f32 v104, 1.0, v104
    v_add_f32 v105, 1.0, v105
    v_add_f32 v106, 1.0, v106
    v_add_f32 v107, 1.0, v107
    v_add_f32 v108, 1.0, v108
    v_add_f32 v109, 1.0, v109
    v_add_f32 v110, 1.0, v110
    v_add_f32 v111, 1.0, v111
    v_rcp_f32 v104, v104
    v_rcp_f32 v105, v105
    v_rcp_f32 v106, v106
    v_rcp_f32 v107, v107
    v_rcp_f32 v108, v108
    v_rcp_f32 v109, v109
    v_rcp_f32 v110, v110
    v_rcp_f32 v111, v111
    v_mul_f32 v208, v208, v104
    v_mul_f32 v209, v209, v105
    v_mul_f32 v210, v210, v106
    v_mul_f32 v211, v211, v107
    v_mul_f32 v212, v212, v108
    v_mul_f32 v213, v213, v109
    v_mul_f32 v214, v214, v110
    v_mul_f32 v215, v215, v111
    v_cvt_pk_bf16_f32 v88, v208, v209
    v_cvt_pk_bf16_f32 v89, v210, v211
    v_cvt_pk_bf16_f32 v90, v212, v213
    v_cvt_pk_bf16_f32 v91, v214, v215
    buffer_store_dwordx4 v[88:91], v1, s[4:7], s30 offen sc1
    v_cvt_pk_bf16_f32 v92, v216, v217
    v_cvt_pk_bf16_f32 v93, v218, v219
    v_cvt_pk_bf16_f32 v94, v220, v221
    v_cvt_pk_bf16_f32 v95, v222, v223
    v_lshlrev_b32 v216, 16, v92
    v_and_b32 v217, 0xffff0000, v92
    v_lshlrev_b32 v218, 16, v93
    v_and_b32 v219, 0xffff0000, v93
    v_lshlrev_b32 v220, 16, v94
    v_and_b32 v221, 0xffff0000, v94
    v_lshlrev_b32 v222, 16, v95
    v_and_b32 v223, 0xffff0000, v95
    v_mul_f32 v96, s54, v216
    v_mul_f32 v97, s54, v217
    v_mul_f32 v98, s54, v218
    v_mul_f32 v99, s54, v219
    v_mul_f32 v100, s54, v220
    v_mul_f32 v101, s54, v221
    v_mul_f32 v102, s54, v222
    v_mul_f32 v103, s54, v223
    v_exp_f32 v96, v96
    v_exp_f32 v97, v97
    v_exp_f32 v98, v98
    v_exp_f32 v99, v99
    v_exp_f32 v100, v100
    v_exp_f32 v101, v101
    v_exp_f32 v102, v102
    v_exp_f32 v103, v103
    v_add_f32 v96, 1.0, v96
    v_add_f32 v97, 1.0, v97
    v_add_f32 v98, 1.0, v98
    v_add_f32 v99, 1.0, v99
    v_add_f32 v100, 1.0, v100
    v_add_f32 v101, 1.0, v101
    v_add_f32 v102, 1.0, v102
    v_add_f32 v103, 1.0, v103
    v_rcp_f32 v96, v96
    v_rcp_f32 v97, v97
    v_rcp_f32 v98, v98
    v_rcp_f32 v99, v99
    v_rcp_f32 v100, v100
    v_rcp_f32 v101, v101
    v_rcp_f32 v102, v102
    v_rcp_f32 v103, v103
    v_mul_f32 v216, v216, v96
    v_mul_f32 v217, v217, v97
    v_mul_f32 v218, v218, v98
    v_mul_f32 v219, v219, v99
    v_mul_f32 v220, v220, v100
    v_mul_f32 v221, v221, v101
    v_mul_f32 v222, v222, v102
    v_mul_f32 v223, v223, v103
    v_cvt_pk_bf16_f32 v92, v216, v217
    v_cvt_pk_bf16_f32 v93, v218, v219
    v_cvt_pk_bf16_f32 v94, v220, v221
    v_cvt_pk_bf16_f32 v95, v222, v223
    buffer_store_dwordx4 v[92:95], v19, s[4:7], s30 offen sc1
    s_add_u32 s30, s30, s50
    v_cvt_pk_bf16_f32 v80, v224, v225
    v_cvt_pk_bf16_f32 v81, v226, v227
    v_cvt_pk_bf16_f32 v82, v228, v229
    v_cvt_pk_bf16_f32 v83, v230, v231
    v_lshlrev_b32 v224, 16, v80
    v_and_b32 v225, 0xffff0000, v80
    v_lshlrev_b32 v226, 16, v81
    v_and_b32 v227, 0xffff0000, v81
    v_lshlrev_b32 v228, 16, v82
    v_and_b32 v229, 0xffff0000, v82
    v_lshlrev_b32 v230, 16, v83
    v_and_b32 v231, 0xffff0000, v83
    v_mul_f32 v104, s54, v224
    v_mul_f32 v105, s54, v225
    v_mul_f32 v106, s54, v226
    v_mul_f32 v107, s54, v227
    v_mul_f32 v108, s54, v228
    v_mul_f32 v109, s54, v229
    v_mul_f32 v110, s54, v230
    v_mul_f32 v111, s54, v231
    v_exp_f32 v104, v104
    v_exp_f32 v105, v105
    v_exp_f32 v106, v106
    v_exp_f32 v107, v107
    v_exp_f32 v108, v108
    v_exp_f32 v109, v109
    v_exp_f32 v110, v110
    v_exp_f32 v111, v111
    v_add_f32 v104, 1.0, v104
    v_add_f32 v105, 1.0, v105
    v_add_f32 v106, 1.0, v106
    v_add_f32 v107, 1.0, v107
    v_add_f32 v108, 1.0, v108
    v_add_f32 v109, 1.0, v109
    v_add_f32 v110, 1.0, v110
    v_add_f32 v111, 1.0, v111
    v_rcp_f32 v104, v104
    v_rcp_f32 v105, v105
    v_rcp_f32 v106, v106
    v_rcp_f32 v107, v107
    v_rcp_f32 v108, v108
    v_rcp_f32 v109, v109
    v_rcp_f32 v110, v110
    v_rcp_f32 v111, v111
    v_mul_f32 v224, v224, v104
    v_mul_f32 v225, v225, v105
    v_mul_f32 v226, v226, v106
    v_mul_f32 v227, v227, v107
    v_mul_f32 v228, v228, v108
    v_mul_f32 v229, v229, v109
    v_mul_f32 v230, v230, v110
    v_mul_f32 v231, v231, v111
    v_cvt_pk_bf16_f32 v80, v224, v225
    v_cvt_pk_bf16_f32 v81, v226, v227
    v_cvt_pk_bf16_f32 v82, v228, v229
    v_cvt_pk_bf16_f32 v83, v230, v231
    buffer_store_dwordx4 v[80:83], v1, s[4:7], s30 offen sc1
    v_cvt_pk_bf16_f32 v84, v232, v233
    v_cvt_pk_bf16_f32 v85, v234, v235
    v_cvt_pk_bf16_f32 v86, v236, v237
    v_cvt_pk_bf16_f32 v87, v238, v239
    v_lshlrev_b32 v232, 16, v84
    v_and_b32 v233, 0xffff0000, v84
    v_lshlrev_b32 v234, 16, v85
    v_and_b32 v235, 0xffff0000, v85
    v_lshlrev_b32 v236, 16, v86
    v_and_b32 v237, 0xffff0000, v86
    v_lshlrev_b32 v238, 16, v87
    v_and_b32 v239, 0xffff0000, v87
    v_mul_f32 v96, s54, v232
    v_mul_f32 v97, s54, v233
    v_mul_f32 v98, s54, v234
    v_mul_f32 v99, s54, v235
    v_mul_f32 v100, s54, v236
    v_mul_f32 v101, s54, v237
    v_mul_f32 v102, s54, v238
    v_mul_f32 v103, s54, v239
    v_exp_f32 v96, v96
    v_exp_f32 v97, v97
    v_exp_f32 v98, v98
    v_exp_f32 v99, v99
    v_exp_f32 v100, v100
    v_exp_f32 v101, v101
    v_exp_f32 v102, v102
    v_exp_f32 v103, v103
    v_add_f32 v96, 1.0, v96
    v_add_f32 v97, 1.0, v97
    v_add_f32 v98, 1.0, v98
    v_add_f32 v99, 1.0, v99
    v_add_f32 v100, 1.0, v100
    v_add_f32 v101, 1.0, v101
    v_add_f32 v102, 1.0, v102
    v_add_f32 v103, 1.0, v103
    v_rcp_f32 v96, v96
    v_rcp_f32 v97, v97
    v_rcp_f32 v98, v98
    v_rcp_f32 v99, v99
    v_rcp_f32 v100, v100
    v_rcp_f32 v101, v101
    v_rcp_f32 v102, v102
    v_rcp_f32 v103, v103
    v_mul_f32 v232, v232, v96
    v_mul_f32 v233, v233, v97
    v_mul_f32 v234, v234, v98
    v_mul_f32 v235, v235, v99
    v_mul_f32 v236, v236, v100
    v_mul_f32 v237, v237, v101
    v_mul_f32 v238, v238, v102
    v_mul_f32 v239, v239, v103
    v_cvt_pk_bf16_f32 v84, v232, v233
    v_cvt_pk_bf16_f32 v85, v234, v235
    v_cvt_pk_bf16_f32 v86, v236, v237
    v_cvt_pk_bf16_f32 v87, v238, v239
    buffer_store_dwordx4 v[84:87], v19, s[4:7], s30 offen sc1
    s_add_u32 s30, s30, s50
    v_cvt_pk_bf16_f32 v88, v240, v241
    v_cvt_pk_bf16_f32 v89, v242, v243
    v_cvt_pk_bf16_f32 v90, v244, v245
    v_cvt_pk_bf16_f32 v91, v246, v247
    v_lshlrev_b32 v240, 16, v88
    v_and_b32 v241, 0xffff0000, v88
    v_lshlrev_b32 v242, 16, v89
    v_and_b32 v243, 0xffff0000, v89
    v_lshlrev_b32 v244, 16, v90
    v_and_b32 v245, 0xffff0000, v90
    v_lshlrev_b32 v246, 16, v91
    v_and_b32 v247, 0xffff0000, v91
    v_mul_f32 v104, s54, v240
    v_mul_f32 v105, s54, v241
    v_mul_f32 v106, s54, v242
    v_mul_f32 v107, s54, v243
    v_mul_f32 v108, s54, v244
    v_mul_f32 v109, s54, v245
    v_mul_f32 v110, s54, v246
    v_mul_f32 v111, s54, v247
    v_exp_f32 v104, v104
    v_exp_f32 v105, v105
    v_exp_f32 v106, v106
    v_exp_f32 v107, v107
    v_exp_f32 v108, v108
    v_exp_f32 v109, v109
    v_exp_f32 v110, v110
    v_exp_f32 v111, v111
    v_add_f32 v104, 1.0, v104
    v_add_f32 v105, 1.0, v105
    v_add_f32 v106, 1.0, v106
    v_add_f32 v107, 1.0, v107
    v_add_f32 v108, 1.0, v108
    v_add_f32 v109, 1.0, v109
    v_add_f32 v110, 1.0, v110
    v_add_f32 v111, 1.0, v111
    v_rcp_f32 v104, v104
    v_rcp_f32 v105, v105
    v_rcp_f32 v106, v106
    v_rcp_f32 v107, v107
    v_rcp_f32 v108, v108
    v_rcp_f32 v109, v109
    v_rcp_f32 v110, v110
    v_rcp_f32 v111, v111
    v_mul_f32 v240, v240, v104
    v_mul_f32 v241, v241, v105
    v_mul_f32 v242, v242, v106
    v_mul_f32 v243, v243, v107
    v_mul_f32 v244, v244, v108
    v_mul_f32 v245, v245, v109
    v_mul_f32 v246, v246, v110
    v_mul_f32 v247, v247, v111
    v_cvt_pk_bf16_f32 v88, v240, v241
    v_cvt_pk_bf16_f32 v89, v242, v243
    v_cvt_pk_bf16_f32 v90, v244, v245
    v_cvt_pk_bf16_f32 v91, v246, v247
    buffer_store_dwordx4 v[88:91], v1, s[4:7], s30 offen sc1
    v_cvt_pk_bf16_f32 v92, v248, v249
    v_cvt_pk_bf16_f32 v93, v250, v251
    v_cvt_pk_bf16_f32 v94, v252, v253
    v_cvt_pk_bf16_f32 v95, v254, v255
    v_lshlrev_b32 v248, 16, v92
    v_and_b32 v249, 0xffff0000, v92
    v_lshlrev_b32 v250, 16, v93
    v_and_b32 v251, 0xffff0000, v93
    v_lshlrev_b32 v252, 16, v94
    v_and_b32 v253, 0xffff0000, v94
    v_lshlrev_b32 v254, 16, v95
    v_and_b32 v255, 0xffff0000, v95
    v_mul_f32 v96, s54, v248
    v_mul_f32 v97, s54, v249
    v_mul_f32 v98, s54, v250
    v_mul_f32 v99, s54, v251
    v_mul_f32 v100, s54, v252
    v_mul_f32 v101, s54, v253
    v_mul_f32 v102, s54, v254
    v_mul_f32 v103, s54, v255
    v_exp_f32 v96, v96
    v_exp_f32 v97, v97
    v_exp_f32 v98, v98
    v_exp_f32 v99, v99
    v_exp_f32 v100, v100
    v_exp_f32 v101, v101
    v_exp_f32 v102, v102
    v_exp_f32 v103, v103
    v_add_f32 v96, 1.0, v96
    v_add_f32 v97, 1.0, v97
    v_add_f32 v98, 1.0, v98
    v_add_f32 v99, 1.0, v99
    v_add_f32 v100, 1.0, v100
    v_add_f32 v101, 1.0, v101
    v_add_f32 v102, 1.0, v102
    v_add_f32 v103, 1.0, v103
    v_rcp_f32 v96, v96
    v_rcp_f32 v97, v97
    v_rcp_f32 v98, v98
    v_rcp_f32 v99, v99
    v_rcp_f32 v100, v100
    v_rcp_f32 v101, v101
    v_rcp_f32 v102, v102
    v_rcp_f32 v103, v103
    v_mul_f32 v248, v248, v96
    v_mul_f32 v249, v249, v97
    v_mul_f32 v250, v250, v98
    v_mul_f32 v251, v251, v99
    v_mul_f32 v252, v252, v100
    v_mul_f32 v253, v253, v101
    v_mul_f32 v254, v254, v102
    v_mul_f32 v255, v255, v103
    v_cvt_pk_bf16_f32 v92, v248, v249
    v_cvt_pk_bf16_f32 v93, v250, v251
    v_cvt_pk_bf16_f32 v94, v252, v253
    v_cvt_pk_bf16_f32 v95, v254, v255
    buffer_store_dwordx4 v[92:95], v19, s[4:7], s30 offen sc1
    s_waitcnt lgkmcnt(0)
    v_or3_b32 v24, v24, v25, v26
    v_or3_b32 v28, v28, v29, v30
    v_or3_b32 v24, v24, v27, v31
    v_or_b32 v24, v24, v28
    s_mov_b32 s28, s51
    s_mov_b32 s57, s53
    v_readfirstlane_b32 s30, v24
    s_cmp_lg_u32 s30, 0
    s_cbranch_scc1 w_drain
    s_mov_b32 s48, s32
    s_cmp_ge_u32 s32, 4
    s_cselect_b32 s30, 2, 3
    s_lshl_b32 s30, s26, s30
    s_mul_i32 s30, s30, s43
    s_add_u32 s49, s42, s30
    s_mov_b32 s50, s43
    s_mov_b32 s51, s46
    s_mov_b32 s23, s41
    s_mov_b32 s53, s47
    s_nop 0
    s_load_dwordx16 s[32:47], s[24:25], 0
    s_add_u32 s24, s24, 64
    s_addc_u32 s25, s25, 0
    s_branch w_first16
w_firstH:
    s_waitcnt vmcnt(8)
    s_barrier
    s_add_u32 m0, s21, 0
    s_nop 0
    buffer_load_dwordx4 v1, s[4:7], s16 offen sc1 lds
    s_add_u32 s16, s16, s62
    s_add_u32 m0, s21, 1024
    s_nop 0
    buffer_load_dwordx4 v1, s[4:7], s17 offen sc1 lds
    s_add_u32 s17, s17, s62
    s_add_u32 m0, s22, 0
    s_nop 0
    buffer_load_dwordx4 v2, s[8:11], s18 offen lds
    s_add_u32 s18, s18, s20
    s_add_u32 m0, s22, 8192
    s_nop 0
    buffer_load_dwordx4 v2, s[12:15], s19 offen lds
    s_add_u32 s19, s19, s20
    v_mfma_f32_16x16x32_bf16 v[128:131], v[64:67], v[32:35], 0
    ds_read_b64_tr_b16 v[112:113], v8 offset:49152
    v_mfma_f32_16x16x32_bf16 v[132:135], v[68:71], v[32:35], 0
    ds_read_b64_tr_b16 v[114:115], v9 offset:49152
    v_mfma_f32_16x16x32_bf16 v[144:147], v[64:67], v[40:43], 0
    ds_read_b64_tr_b16 v[116:117], v10 offset:49152
    v_mfma_f32_16x16x32_bf16 v[148:151], v[68:71], v[40:43], 0
    ds_read_b64_tr_b16 v[118:119], v11 offset:49152
    v_mfma_f32_16x16x32_bf16 v[160:163], v[64:67], v[48:51], 0
    ds_read_b64_tr_b16 v[120:121], v8 offset:57344
    v_mfma_f32_16x16x32_bf16 v[164:167], v[68:71], v[48:51], 0
    ds_read_b64_tr_b16 v[122:123], v9 offset:57344
    v_mfma_f32_16x16x32_bf16 v[176:179], v[64:67], v[56:59], 0
    ds_read_b64_tr_b16 v[124:125], v10 offset:57344
    v_mfma_f32_16x16x32_bf16 v[180:183], v[68:71], v[56:59], 0
    ds_read_b64_tr_b16 v[126:127], v11 offset:57344
    v_mfma_f32_16x16x32_bf16 v[128:131], v[72:75], v[36:39], v[128:131]
    ds_read_b128 v[80:83], v5 offset:32768
    v_mfma_f32_16x16x32_bf16 v[132:135], v[76:79], v[36:39], v[132:135]
    ds_read_b128 v[84:87], v5 offset:33792
    v_mfma_f32_16x16x32_bf16 v[144:147], v[72:75], v[44:47], v[144:147]
    ds_read_b128 v[88:91], v5 offset:34816
    v_mfma_f32_16x16x32_bf16 v[148:151], v[76:79], v[44:47], v[148:151]
    ds_read_b128 v[92:95], v5 offset:35840
    v_mfma_f32_16x16x32_bf16 v[160:163], v[72:75], v[52:55], v[160:163]
    ds_read_b128 v[96:99], v5 offset:36864
    v_mfma_f32_16x16x32_bf16 v[164:167], v[76:79], v[52:55], v[164:167]
    ds_read_b128 v[100:103], v5 offset:37888
    v_mfma_f32_16x16x32_bf16 v[176:179], v[72:75], v[60:63], v[176:179]
    ds_read_b128 v[104:107], v5 offset:38912
    v_mfma_f32_16x16x32_bf16 v[180:183], v[76:79], v[60:63], v[180:183]
    ds_read_b128 v[108:111], v5 offset:39936
    s_waitcnt lgkmcnt(0)
    s_waitcnt vmcnt(8)
    s_barrier
    s_add_u32 m0, s21, 32768
    s_nop 0
    buffer_load_dwordx4 v1, s[4:7], s16 offen sc1 lds
    s_add_u32 s16, s16, s62
    s_add_u32 m0, s21, 33792
    s_nop 0
    buffer_load_dwordx4 v1, s[4:7], s17 offen sc1 lds
    s_add_u32 s17, s17, s62
    s_add_u32 m0, s22, 32768
    s_nop 0
    buffer_load_dwordx4 v2, s[8:11], s18 offen lds
    s_add_u32 s18, s18, s20
    s_add_u32 m0, s22, 40960
    s_nop 0
    buffer_load_dwordx4 v2, s[12:15], s19 offen lds
    s_add_u32 s19, s19, s20
    v_mfma_f32_16x16x32_bf16 v[128:131], v[112:115], v[80:83], v[128:131]
    ds_read_b64_tr_b16 v[64:65], v12 offset:16384
    v_mfma_f32_16x16x32_bf16 v[132:135], v[116:119], v[80:83], v[132:135]
    ds_read_b64_tr_b16 v[66:67], v13 offset:16384
    v_mfma_f32_16x16x32_bf16 v[144:147], v[112:115], v[88:91], v[144:147]
    ds_read_b64_tr_b16 v[68:69], v14 offset:16384
    v_mfma_f32_16x16x32_bf16 v[148:151], v[116:119], v[88:91], v[148:151]
    ds_read_b64_tr_b16 v[70:71], v15 offset:16384
    v_mfma_f32_16x16x32_bf16 v[160:163], v[112:115], v[96:99], v[160:163]
    ds_read_b64_tr_b16 v[72:73], v12 offset:24576
    v_mfma_f32_16x16x32_bf16 v[164:167], v[116:119], v[96:99], v[164:167]
    ds_read_b64_tr_b16 v[74:75], v13 offset:24576
    v_mfma_f32_16x16x32_bf16 v[176:179], v[112:115], v[104:107], v[176:179]
    ds_read_b64_tr_b16 v[76:77], v14 offset:24576
    v_mfma_f32_16x16x32_bf16 v[180:183], v[116:119], v[104:107], v[180:183]
    ds_read_b64_tr_b16 v[78:79], v15 offset:24576
    v_mfma_f32_16x16x32_bf16 v[128:131], v[120:123], v[84:87], v[128:131]
    ds_read_b128 v[32:35], v6 offset:0
    v_mfma_f32_16x16x32_bf16 v[132:135], v[124:127], v[84:87], v[132:135]
    ds_read_b128 v[36:39], v6 offset:1024
    v_mfma_f32_16x16x32_bf16 v[144:147], v[120:123], v[92:95], v[144:147]
    ds_read_b128 v[40:43], v6 offset:2048
    v_mfma_f32_16x16x32_bf16 v[148:151], v[124:127], v[92:95], v[148:151]
    ds_read_b128 v[44:47], v6 offset:3072
    v_mfma_f32_16x16x32_bf16 v[160:163], v[120:123], v[100:103], v[160:163]
    ds_read_b128 v[48:51], v6 offset:4096
    v_mfma_f32_16x16x32_bf16 v[164:167], v[124:127], v[100:103], v[164:167]
    ds_read_b128 v[52:55], v6 offset:5120
    v_mfma_f32_16x16x32_bf16 v[176:179], v[120:123], v[108:111], v[176:179]
    ds_read_b128 v[56:59], v6 offset:6144
    v_mfma_f32_16x16x32_bf16 v[180:183], v[124:127], v[108:111], v[180:183]
    ds_read_b128 v[60:63], v6 offset:7168
    s_waitcnt lgkmcnt(0)
    s_waitcnt vmcnt(8)
    s_barrier
    s_add_u32 m0, s21, 65536
    s_nop 0
    buffer_load_dwordx4 v1, s[4:7], s16 offen sc1 lds
    s_add_u32 s16, s16, s62
    s_add_u32 m0, s21, 66560
    s_nop 0
    buffer_load_dwordx4 v1, s[4:7], s17 offen sc1 lds
    s_add_u32 s17, s17, s62
    s_add_u32 m0, s22, 65536
    s_nop 0
    buffer_load_dwordx4 v2, s[8:11], s18 offen lds
    s_add_u32 s18, s18, s20
    s_add_u32 m0, s22, 73728
    s_nop 0
    buffer_load_dwordx4 v2, s[12:15], s19 offen lds
    s_add_u32 s19, s19, s20
    v_mfma_f32_16x16x32_bf16 v[128:131], v[64:67], v[32:35], v[128:131]
    ds_read_b64_tr_b16 v[112:113], v12 offset:49152
    v_mfma_f32_16x16x32_bf16 v[132:135], v[68:71], v[32:35], v[132:135]
    ds_read_b64_tr_b16 v[114:115], v13 offset:49152
    v_mfma_f32_16x16x32_bf16 v[144:147], v[64:67], v[40:43], v[144:147]
    ds_read_b64_tr_b16 v[116:117], v14 offset:49152
    v_mfma_f32_16x16x32_bf16 v[148:151], v[68:71], v[40:43], v[148:151]
    ds_read_b64_tr_b16 v[118:119], v15 offset:49152
    v_mfma_f32_16x16x32_bf16 v[160:163], v[64:67], v[48:51], v[160:163]
    ds_read_b64_tr_b16 v[120:121], v12 offset:57344
    v_mfma_f32_16x16x32_bf16 v[164:167], v[68:71], v[48:51], v[164:167]
    ds_read_b64_tr_b16 v[122:123], v13 offset:57344
    v_mfma_f32_16x16x32_bf16 v[176:179], v[64:67], v[56:59], v[176:179]
    ds_read_b64_tr_b16 v[124:125], v14 offset:57344
    v_mfma_f32_16x16x32_bf16 v[180:183], v[68:71], v[56:59], v[180:183]
    ds_read_b64_tr_b16 v[126:127], v15 offset:57344
    v_mfma_f32_16x16x32_bf16 v[128:131], v[72:75], v[36:39], v[128:131]
    ds_read_b128 v[80:83], v6 offset:32768
    v_mfma_f32_16x16x32_bf16 v[132:135], v[76:79], v[36:39], v[132:135]
    ds_read_b128 v[84:87], v6 offset:33792
    v_mfma_f32_16x16x32_bf16 v[144:147], v[72:75], v[44:47], v[144:147]
    ds_read_b128 v[88:91], v6 offset:34816
    v_mfma_f32_16x16x32_bf16 v[148:151], v[76:79], v[44:47], v[148:151]
    ds_read_b128 v[92:95], v6 offset:35840
    v_mfma_f32_16x16x32_bf16 v[160:163], v[72:75], v[52:55], v[160:163]
    ds_read_b128 v[96:99], v6 offset:36864
    v_mfma_f32_16x16x32_bf16 v[164:167], v[76:79], v[52:55], v[164:167]
    ds_read_b128 v[100:103], v6 offset:37888
    v_mfma_f32_16x16x32_bf16 v[176:179], v[72:75], v[60:63], v[176:179]
    ds_read_b128 v[104:107], v6 offset:38912
    v_mfma_f32_16x16x32_bf16 v[180:183], v[76:79], v[60:63], v[180:183]
    ds_read_b128 v[108:111], v6 offset:39936
    s_waitcnt lgkmcnt(0)
    s_waitcnt vmcnt(8)
    s_barrier
    s_add_u32 m0, s21, 98304
    s_nop 0
    buffer_load_dwordx4 v1, s[4:7], s16 offen sc1 lds
    s_add_u32 s16, s16, s62
    s_add_u32 m0, s21, 99328
    s_nop 0
    buffer_load_dwordx4 v1, s[4:7], s17 offen sc1 lds
    s_add_u32 s17, s17, s62
    s_add_u32 m0, s22, 98304
    s_nop 0
    buffer_load_dwordx4 v2, s[8:11], s18 offen lds
    s_add_u32 s18, s18, s20
    s_add_u32 m0, s22, 106496
    s_nop 0
    buffer_load_dwordx4 v2, s[12:15], s19 offen lds
    s_add_u32 s19, s19, s20
    v_mfma_f32_16x16x32_bf16 v[128:131], v[112:115], v[80:83], v[128:131]
    ds_read_b64_tr_b16 v[64:65], v8 offset:16384
    v_mfma_f32_16x16x32_bf16 v[132:135], v[116:119], v[80:83], v[132:135]
    ds_read_b64_tr_b16 v[66:67], v9 offset:16384
    v_mfma_f32_16x16x32_bf16 v[144:147], v[112:115], v[88:91], v[144:147]
    ds_read_b64_tr_b16 v[68:69], v10 offset:16384
    v_mfma_f32_16x16x32_bf16 v[148:151], v[116:119], v[88:91], v[148:151]
    ds_read_b64_tr_b16 v[70:71], v11 offset:16384
    v_mfma_f32_16x16x32_bf16 v[160:163], v[112:115], v[96:99], v[160:163]
    ds_read_b64_tr_b16 v[72:73], v8 offset:24576
    v_mfma_f32_16x16x32_bf16 v[164:167], v[116:119], v[96:99], v[164:167]
    ds_read_b64_tr_b16 v[74:75], v9 offset:24576
    v_mfma_f32_16x16x32_bf16 v[176:179], v[112:115], v[104:107], v[176:179]
    ds_read_b64_tr_b16 v[76:77], v10 offset:24576
    v_mfma_f32_16x16x32_bf16 v[180:183], v[116:119], v[104:107], v[180:183]
    ds_read_b64_tr_b16 v[78:79], v11 offset:24576
    v_mfma_f32_16x16x32_bf16 v[128:131], v[120:123], v[84:87], v[128:131]
    ds_read_b128 v[32:35], v5 offset:0
    v_mfma_f32_16x16x32_bf16 v[132:135], v[124:127], v[84:87], v[132:135]
    ds_read_b128 v[36:39], v5 offset:1024
    v_mfma_f32_16x16x32_bf16 v[144:147], v[120:123], v[92:95], v[144:147]
    ds_read_b128 v[40:43], v5 offset:2048
    v_mfma_f32_16x16x32_bf16 v[148:151], v[124:127], v[92:95], v[148:151]
    ds_read_b128 v[44:47], v5 offset:3072
    v_mfma_f32_16x16x32_bf16 v[160:163], v[120:123], v[100:103], v[160:163]
    ds_read_b128 v[48:51], v5 offset:4096
    v_mfma_f32_16x16x32_bf16 v[164:167], v[124:127], v[100:103], v[164:167]
    ds_read_b128 v[52:55], v5 offset:5120
    v_mfma_f32_16x16x32_bf16 v[176:179], v[120:123], v[108:111], v[176:179]
    ds_read_b128 v[56:59], v5 offset:6144
    v_mfma_f32_16x16x32_bf16 v[180:183], v[124:127], v[108:111], v[180:183]
    ds_read_b128 v[60:63], v5 offset:7168
    s_waitcnt lgkmcnt(0)
w_loop_chkH:
    s_sub_u32 s23, s23, 1
w_loopH:
    s_cmp_lg_u32 s23, 1
    s_cbranch_scc1 w_bodyH
    buffer_load_dword v22, off, s[64:67], 0 sc1
    v_readfirstlane_b32 s30, v16
    s_cmp_ge_u32 s30, s45
    s_cselect_b32 s30, 0, 1
    s_or_b32 s30, s30, s70
    s_cmp_ge_u32 s32, 4
    s_cselect_b32 s30, 1, s30
    s_cmp_eq_u32 s32, 0
    s_cselect_b32 s30, 1, s30
    v_mov_b32 v20, s30
    ds_write_b32 v7, v20
    s_cbranch_scc1 w_ndH
    s_cmp_ge_u32 s32, 4
    s_cbranch_scc1 w_ndH
    s_cmp_lg_u32 s70, 0
    s_cbranch_scc1 w_ndH
    s_load_dwordx2 s[8:9], s[0:1], s33
    s_load_dwordx2 s[12:13], s[0:1], s34
    s_mov_b32 s10, s38
    s_mov_b32 s14, s38
    s_cmp_ge_u32 s32, 4
    s_cselect_b32 s31, 0, 1
    s_lshl_b32 s30, s3, s31
    s_mul_i32 s30, s30, s40
    s_add_u32 s16, s39, s30
    s_cmp_eq_u32 s32, 4
    s_cselect_b32 s30, 1024, s40
    s_cselect_b32 s31, 6, 5
    s_lshl_b32 s62, 32, s31
    s_add_u32 s17, s16, s30
    s_lshl_b32 s30, s3, 2
    s_mul_i32 s30, s30, s35
    s_add_u32 s18, s36, s30
    s_add_u32 s19, s37, s30
    s_lshl_b32 s20, s35, s31
    v_mul_u32_u24 v2, s35, v4
    v_add_u32 v2, v2, v3
    s_waitcnt lgkmcnt(0)
w_bodyH:
    s_waitcnt vmcnt(8)
    s_barrier
    s_add_u32 m0, s21, 0
    s_nop 0
    buffer_load_dwordx4 v1, s[4:7], s16 offen sc1 lds
    s_add_u32 s16, s16, s62
    s_add_u32 m0, s21, 1024
    s_nop 0
    buffer_load_dwordx4 v1, s[4:7], s17 offen sc1 lds
    s_add_u32 s17, s17, s62
    s_add_u32 m0, s22, 0
    s_nop 0
    buffer_load_dwordx4 v2, s[8:11], s18 offen lds
    s_add_u32 s18, s18, s20
    s_add_u32 m0, s22, 8192
    s_nop 0
    buffer_load_dwordx4 v2, s[12:15], s19 offen lds
    s_add_u32 s19, s19, s20
    v_mfma_f32_16x16x32_bf16 v[128:131], v[64:67], v[32:35], v[128:131]
    ds_read_b64_tr_b16 v[112:113], v8 offset:49152
    v_mfma_f32_16x16x32_bf16 v[132:135], v[68:71], v[32:35], v[132:135]
    ds_read_b64_tr_b16 v[114:115], v9 offset:49152
    v_mfma_f32_16x16x32_bf16 v[144:147], v[64:67], v[40:43], v[144:147]
    ds_read_b64_tr_b16 v[116:117], v10 offset:49152
    v_mfma_f32_16x16x32_bf16 v[148:151], v[68:71], v[40:43], v[148:151]
    ds_read_b64_tr_b16 v[118:119], v11 offset:49152
    v_mfma_f32_16x16x32_bf16 v[160:163], v[64:67], v[48:51], v[160:163]
    ds_read_b64_tr_b16 v[120:121], v8 offset:57344
    v_mfma_f32_16x16x32_bf16 v[164:167], v[68:71], v[48:51], v[164:167]
    ds_read_b64_tr_b16 v[122:123], v9 offset:57344
    v_mfma_f32_16x16x32_bf16 v[176:179], v[64:67], v[56:59], v[176:179]
    ds_read_b64_tr_b16 v[124:125], v10 offset:57344
    v_mfma_f32_16x16x32_bf16 v[180:183], v[68:71], v[56:59], v[180:183]
    ds_read_b64_tr_b16 v[126:127], v11 offset:57344
    v_mfma_f32_16x16x32_bf16 v[128:131], v[72:75], v[36:39], v[128:131]
    ds_read_b128 v[80:83], v5 offset:32768
    v_mfma_f32_16x16x32_bf16 v[132:135], v[76:79], v[36:39], v[132:135]
    ds_read_b128 v[84:87], v5 offset:33792
    v_mfma_f32_16x16x32_bf16 v[144:147], v[72:75], v[44:47], v[144:147]
    ds_read_b128 v[88:91], v5 offset:34816
    v_mfma_f32_16x16x32_bf16 v[148:151], v[76:79], v[44:47], v[148:151]
    ds_read_b128 v[92:95], v5 offset:35840
    v_mfma_f32_16x16x32_bf16 v[160:163], v[72:75], v[52:55], v[160:163]
    ds_read_b128 v[96:99], v5 offset:36864
    v_mfma_f32_16x16x32_bf16 v[164:167], v[76:79], v[52:55], v[164:167]
    ds_read_b128 v[100:103], v5 offset:37888
    v_mfma_f32_16x16x32_bf16 v[176:179], v[72:75], v[60:63], v[176:179]
    ds_read_b128 v[104:107], v5 offset:38912
    v_mfma_f32_16x16x32_bf16 v[180:183], v[76:79], v[60:63], v[180:183]
    ds_read_b128 v[108:111], v5 offset:39936
    buffer_load_dword v16, v17, s[4:7], s44 offen sc1
    s_waitcnt lgkmcnt(0)
    s_waitcnt vmcnt(8)
    s_barrier
    s_add_u32 m0, s21, 32768
    s_nop 0
    buffer_load_dwordx4 v1, s[4:7], s16 offen sc1 lds
    s_add_u32 s16, s16, s62
    s_add_u32 m0, s21, 33792
    s_nop 0
    buffer_load_dwordx4 v1, s[4:7], s17 offen sc1 lds
    s_add_u32 s17, s17, s62
    s_add_u32 m0, s22, 32768
    s_nop 0
    buffer_load_dwordx4 v2, s[8:11], s18 offen lds
    s_add_u32 s18, s18, s20
    s_add_u32 m0, s22, 40960
    s_nop 0
    buffer_load_dwordx4 v2, s[12:15], s19 offen lds
    s_add_u32 s19, s19, s20
    v_mfma_f32_16x16x32_bf16 v[128:131], v[112:115], v[80:83], v[128:131]
    ds_read_b64_tr_b16 v[64:65], v12 offset:16384
    v_mfma_f32_16x16x32_bf16 v[132:135], v[116:119], v[80:83], v[132:135]
    ds_read_b64_tr_b16 v[66:67], v13 offset:16384
    v_mfma_f32_16x16x32_bf16 v[144:147], v[112:115], v[88:91], v[144:147]
    ds_read_b64_tr_b16 v[68:69], v14 offset:16384
    v_mfma_f32_16x16x32_bf16 v[148:151], v[116:119], v[88:91], v[148:151]
    ds_read_b64_tr_b16 v[70:71], v15 offset:16384
    v_mfma_f32_16x16x32_bf16 v[160:163], v[112:115], v[96:99], v[160:163]
    ds_read_b64_tr_b16 v[72:73], v12 offset:24576
    v_mfma_f32_16x16x32_bf16 v[164:167], v[116:119], v[96:99], v[164:167]
    ds_read_b64_tr_b16 v[74:75], v13 offset:24576
    v_mfma_f32_16x16x32_bf16 v[176:179], v[112:115], v[104:107], v[176:179]
    ds_read_b64_tr_b16 v[76:77], v14 offset:24576
    v_mfma_f32_16x16x32_bf16 v[180:183], v[116:119], v[104:107], v[180:183]
    ds_read_b64_tr_b16 v[78:79], v15 offset:24576
    v_mfma_f32_16x16x32_bf16 v[128:131], v[120:123], v[84:87], v[128:131]
    ds_read_b128 v[32:35], v6 offset:0
    v_mfma_f32_16x16x32_bf16 v[132:135], v[124:127], v[84:87], v[132:135]
    ds_read_b128 v[36:39], v6 offset:1024
    v_mfma_f32_16x16x32_bf16 v[144:147], v[120:123], v[92:95], v[144:147]
    ds_read_b128 v[40:43], v6 offset:2048
    v_mfma_f32_16x16x32_bf16 v[148:151], v[124:127], v[92:95], v[148:151]
    ds_read_b128 v[44:47], v6 offset:3072
    v_mfma_f32_16x16x32_bf16 v[160:163], v[120:123], v[100:103], v[160:163]
    ds_read_b128 v[48:51], v6 offset:4096
    v_mfma_f32_16x16x32_bf16 v[164:167], v[124:127], v[100:103], v[164:167]
    ds_read_b128 v[52:55], v6 offset:5120
    v_mfma_f32_16x16x32_bf16 v[176:179], v[120:123], v[108:111], v[176:179]
    ds_read_b128 v[56:59], v6 offset:6144
    v_mfma_f32_16x16x32_bf16 v[180:183], v[124:127], v[108:111], v[180:183]
    ds_read_b128 v[60:63], v6 offset:7168
    s_waitcnt lgkmcnt(0)
    s_waitcnt vmcnt(8)
    s_barrier
    s_add_u32 m0, s21, 65536
    s_nop 0
    buffer_load_dwordx4 v1, s[4:7], s16 offen sc1 lds
    s_add_u32 s16, s16, s62
    s_add_u32 m0, s21, 66560
    s_nop 0
    buffer_load_dwordx4 v1, s[4:7], s17 offen sc1 lds
    s_add_u32 s17, s17, s62
    s_add_u32 m0, s22, 65536
    s_nop 0
    buffer_load_dwordx4 v2, s[8:11], s18 offen lds
    s_add_u32 s18, s18, s20
    s_add_u32 m0, s22, 73728
    s_nop 0
    buffer_load_dwordx4 v2, s[12:15], s19 offen lds
    s_add_u32 s19, s19, s20
    v_mfma_f32_16x16x32_bf16 v[128:131], v[64:67], v[32:35], v[128:131]
    ds_read_b64_tr_b16 v[112:113], v12 offset:49152
    v_mfma_f32_16x16x32_bf16 v[132:135], v[68:71], v[32:35], v[132:135]
    ds_read_b64_tr_b16 v[114:115], v13 offset:49152
    v_mfma_f32_16x16x32_bf16 v[144:147], v[64:67], v[40:43], v[144:147]
    ds_read_b64_tr_b16 v[116:117], v14 offset:49152
    v_mfma_f32_16x16x32_bf16 v[148:151], v[68:71], v[40:43], v[148:151]
    ds_read_b64_tr_b16 v[118:119], v15 offset:49152
    v_mfma_f32_16x16x32_bf16 v[160:163], v[64:67], v[48:51], v[160:163]
    ds_read_b64_tr_b16 v[120:121], v12 offset:57344
    v_mfma_f32_16x16x32_bf16 v[164:167], v[68:71], v[48:51], v[164:167]
    ds_read_b64_tr_b16 v[122:123], v13 offset:57344
    v_mfma_f32_16x16x32_bf16 v[176:179], v[64:67], v[56:59], v[176:179]
    ds_read_b64_tr_b16 v[124:125], v14 offset:57344
    v_mfma_f32_16x16x32_bf16 v[180:183], v[68:71], v[56:59], v[180:183]
    ds_read_b64_tr_b16 v[126:127], v15 offset:57344
    v_mfma_f32_16x16x32_bf16 v[128:131], v[72:75], v[36:39], v[128:131]
    ds_read_b128 v[80:83], v6 offset:32768
    v_mfma_f32_16x16x32_bf16 v[132:135], v[76:79], v[36:39], v[132:135]
    ds_read_b128 v[84:87], v6 offset:33792
    v_mfma_f32_16x16x32_bf16 v[144:147], v[72:75], v[44:47], v[144:147]
    ds_read_b128 v[88:91], v6 offset:34816
    v_mfma_f32_16x16x32_bf16 v[148:151], v[76:79], v[44:47], v[148:151]
    ds_read_b128 v[92:95], v6 offset:35840
    v_mfma_f32_16x16x32_bf16 v[160:163], v[72:75], v[52:55], v[160:163]
    ds_read_b128 v[96:99], v6 offset:36864
    v_mfma_f32_16x16x32_bf16 v[164:167], v[76:79], v[52:55], v[164:167]
    ds_read_b128 v[100:103], v6 offset:37888
    v_mfma_f32_16x16x32_bf16 v[176:179], v[72:75], v[60:63], v[176:179]
    ds_read_b128 v[104:107], v6 offset:38912
    v_mfma_f32_16x16x32_bf16 v[180:183], v[76:79], v[60:63], v[180:183]
    ds_read_b128 v[108:111], v6 offset:39936
    s_waitcnt lgkmcnt(0)
    s_waitcnt vmcnt(8)
    s_barrier
    s_add_u32 m0, s21, 98304
    s_nop 0
    buffer_load_dwordx4 v1, s[4:7], s16 offen sc1 lds
    s_add_u32 s16, s16, s62
    s_add_u32 m0, s21, 99328
    s_nop 0
    buffer_load_dwordx4 v1, s[4:7], s17 offen sc1 lds
    s_add_u32 s17, s17, s62
    s_add_u32 m0, s22, 98304
    s_nop 0
    buffer_load_dwordx4 v2, s[8:11], s18 offen lds
    s_add_u32 s18, s18, s20
    s_add_u32 m0, s22, 106496
    s_nop 0
    buffer_load_dwordx4 v2, s[12:15], s19 offen lds
    s_add_u32 s19, s19, s20
    v_mfma_f32_16x16x32_bf16 v[128:131], v[112:115], v[80:83], v[128:131]
    ds_read_b64_tr_b16 v[64:65], v8 offset:16384
    v_mfma_f32_16x16x32_bf16 v[132:135], v[116:119], v[80:83], v[132:135]
    ds_read_b64_tr_b16 v[66:67], v9 offset:16384
    v_mfma_f32_16x16x32_bf16 v[144:147], v[112:115], v[88:91], v[144:147]
    ds_read_b64_tr_b16 v[68:69], v10 offset:16384
    v_mfma_f32_16x16x32_bf16 v[148:151], v[116:119], v[88:91], v[148:151]
    ds_read_b64_tr_b16 v[70:71], v11 offset:16384
    v_mfma_f32_16x16x32_bf16 v[160:163], v[112:115], v[96:99], v[160:163]
    ds_read_b64_tr_b16 v[72:73], v8 offset:24576
    v_mfma_f32_16x16x32_bf16 v[164:167], v[116:119], v[96:99], v[164:167]
    ds_read_b64_tr_b16 v[74:75], v9 offset:24576
    v_mfma_f32_16x16x32_bf16 v[176:179], v[112:115], v[104:107], v[176:179]
    ds_read_b64_tr_b16 v[76:77], v10 offset:24576
    v_mfma_f32_16x16x32_bf16 v[180:183], v[116:119], v[104:107], v[180:183]
    ds_read_b64_tr_b16 v[78:79], v11 offset:24576
    v_mfma_f32_16x16x32_bf16 v[128:131], v[120:123], v[84:87], v[128:131]
    ds_read_b128 v[32:35], v5 offset:0
    v_mfma_f32_16x16x32_bf16 v[132:135], v[124:127], v[84:87], v[132:135]
    ds_read_b128 v[36:39], v5 offset:1024
    v_mfma_f32_16x16x32_bf16 v[144:147], v[120:123], v[92:95], v[144:147]
    ds_read_b128 v[40:43], v5 offset:2048
    v_mfma_f32_16x16x32_bf16 v[148:151], v[124:127], v[92:95], v[148:151]
    ds_read_b128 v[44:47], v5 offset:3072
    v_mfma_f32_16x16x32_bf16 v[160:163], v[120:123], v[100:103], v[160:163]
    ds_read_b128 v[48:51], v5 offset:4096
    v_mfma_f32_16x16x32_bf16 v[164:167], v[124:127], v[100:103], v[164:167]
    ds_read_b128 v[52:55], v5 offset:5120
    v_mfma_f32_16x16x32_bf16 v[176:179], v[120:123], v[108:111], v[176:179]
    ds_read_b128 v[56:59], v5 offset:6144
    v_mfma_f32_16x16x32_bf16 v[180:183], v[124:127], v[108:111], v[180:183]
    ds_read_b128 v[60:63], v5 offset:7168
    s_waitcnt lgkmcnt(0)
    s_sub_u32 s23, s23, 1
    s_cmp_lg_u32 s23, 0
    s_cbranch_scc1 w_loopH
    s_branch w_endH
w_ndH:
    s_waitcnt vmcnt(8)
    s_barrier
    v_mfma_f32_16x16x32_bf16 v[128:131], v[64:67], v[32:35], v[128:131]
    ds_read_b64_tr_b16 v[112:113], v8 offset:49152
    v_mfma_f32_16x16x32_bf16 v[132:135], v[68:71], v[32:35], v[132:135]
    ds_read_b64_tr_b16 v[114:115], v9 offset:49152
    v_mfma_f32_16x16x32_bf16 v[144:147], v[64:67], v[40:43], v[144:147]
    ds_read_b64_tr_b16 v[116:117], v10 offset:49152
    v_mfma_f32_16x16x32_bf16 v[148:151], v[68:71], v[40:43], v[148:151]
    ds_read_b64_tr_b16 v[118:119], v11 offset:49152
    v_mfma_f32_16x16x32_bf16 v[160:163], v[64:67], v[48:51], v[160:163]
    ds_read_b64_tr_b16 v[120:121], v8 offset:57344
    v_mfma_f32_16x16x32_bf16 v[164:167], v[68:71], v[48:51], v[164:167]
    ds_read_b64_tr_b16 v[122:123], v9 offset:57344
    v_mfma_f32_16x16x32_bf16 v[176:179], v[64:67], v[56:59], v[176:179]
    ds_read_b64_tr_b16 v[124:125], v10 offset:57344
    v_mfma_f32_16x16x32_bf16 v[180:183], v[68:71], v[56:59], v[180:183]
    ds_read_b64_tr_b16 v[126:127], v11 offset:57344
    v_mfma_f32_16x16x32_bf16 v[128:131], v[72:75], v[36:39], v[128:131]
    ds_read_b128 v[80:83], v5 offset:32768
    v_mfma_f32_16x16x32_bf16 v[132:135], v[76:79], v[36:39], v[132:135]
    ds_read_b128 v[84:87], v5 offset:33792
    v_mfma_f32_16x16x32_bf16 v[144:147], v[72:75], v[44:47], v[144:147]
    ds_read_b128 v[88:91], v5 offset:34816
    v_mfma_f32_16x16x32_bf16 v[148:151], v[76:79], v[44:47], v[148:151]
    ds_read_b128 v[92:95], v5 offset:35840
    v_mfma_f32_16x16x32_bf16 v[160:163], v[72:75], v[52:55], v[160:163]
    ds_read_b128 v[96:99], v5 offset:36864
    v_mfma_f32_16x16x32_bf16 v[164:167], v[76:79], v[52:55], v[164:167]
    ds_read_b128 v[100:103], v5 offset:37888
    v_mfma_f32_16x16x32_bf16 v[176:179], v[72:75], v[60:63], v[176:179]
    ds_read_b128 v[104:107], v5 offset:38912
    v_mfma_f32_16x16x32_bf16 v[180:183], v[76:79], v[60:63], v[180:183]
    ds_read_b128 v[108:111], v5 offset:39936
    s_waitcnt lgkmcnt(0)
    s_waitcnt vmcnt(4)
    s_barrier
    v_mfma_f32_16x16x32_bf16 v[128:131], v[112:115], v[80:83], v[128:131]
    ds_read_b64_tr_b16 v[64:65], v12 offset:16384
    v_mfma_f32_16x16x32_bf16 v[132:135], v[116:119], v[80:83], v[132:135]
    ds_read_b64_tr_b16 v[66:67], v13 offset:16384
    v_mfma_f32_16x16x32_bf16 v[144:147], v[112:115], v[88:91], v[144:147]
    ds_read_b64_tr_b16 v[68:69], v14 offset:16384
    v_mfma_f32_16x16x32_bf16 v[148:151], v[116:119], v[88:91], v[148:151]
    ds_read_b64_tr_b16 v[70:71], v15 offset:16384
    v_mfma_f32_16x16x32_bf16 v[160:163], v[112:115], v[96:99], v[160:163]
    ds_read_b64_tr_b16 v[72:73], v12 offset:24576
    v_mfma_f32_16x16x32_bf16 v[164:167], v[116:119], v[96:99], v[164:167]
    ds_read_b64_tr_b16 v[74:75], v13 offset:24576
    v_mfma_f32_16x16x32_bf16 v[176:179], v[112:115], v[104:107], v[176:179]
    ds_read_b64_tr_b16 v[76:77], v14 offset:24576
    v_mfma_f32_16x16x32_bf16 v[180:183], v[116:119], v[104:107], v[180:183]
    ds_read_b64_tr_b16 v[78:79], v15 offset:24576
    v_mfma_f32_16x16x32_bf16 v[128:131], v[120:123], v[84:87], v[128:131]
    ds_read_b128 v[32:35], v6 offset:0
    v_mfma_f32_16x16x32_bf16 v[132:135], v[124:127], v[84:87], v[132:135]
    ds_read_b128 v[36:39], v6 offset:1024
    v_mfma_f32_16x16x32_bf16 v[144:147], v[120:123], v[92:95], v[144:147]
    ds_read_b128 v[40:43], v6 offset:2048
    v_mfma_f32_16x16x32_bf16 v[148:151], v[124:127], v[92:95], v[148:151]
    ds_read_b128 v[44:47], v6 offset:3072
    v_mfma_f32_16x16x32_bf16 v[160:163], v[120:123], v[100:103], v[160:163]
    ds_read_b128 v[48:51], v6 offset:4096
    v_mfma_f32_16x16x32_bf16 v[164:167], v[124:127], v[100:103], v[164:167]
    ds_read_b128 v[52:55], v6 offset:5120
    v_mfma_f32_16x16x32_bf16 v[176:179], v[120:123], v[108:111], v[176:179]
    ds_read_b128 v[56:59], v6 offset:6144
    v_mfma_f32_16x16x32_bf16 v[180:183], v[124:127], v[108:111], v[180:183]
    ds_read_b128 v[60:63], v6 offset:7168
    s_waitcnt lgkmcnt(0)
    s_waitcnt vmcnt(0)
    s_barrier
    v_mfma_f32_16x16x32_bf16 v[128:131], v[64:67], v[32:35], v[128:131]
    ds_read_b64_tr_b16 v[112:113], v12 offset:49152
    v_mfma_f32_16x16x32_bf16 v[132:135], v[68:71], v[32:35], v[132:135]
    ds_read_b64_tr_b16 v[114:115], v13 offset:49152
    v_mfma_f32_16x16x32_bf16 v[144:147], v[64:67], v[40:43], v[144:147]
    ds_read_b64_tr_b16 v[116:117], v14 offset:49152
    v_mfma_f32_16x16x32_bf16 v[148:151], v[68:71], v[40:43], v[148:151]
    ds_read_b64_tr_b16 v[118:119], v15 offset:49152
    v_mfma_f32_16x16x32_bf16 v[160:163], v[64:67], v[48:51], v[160:163]
    ds_read_b64_tr_b16 v[120:121], v12 offset:57344
    v_mfma_f32_16x16x32_bf16 v[164:167], v[68:71], v[48:51], v[164:167]
    ds_read_b64_tr_b16 v[122:123], v13 offset:57344
    v_mfma_f32_16x16x32_bf16 v[176:179], v[64:67], v[56:59], v[176:179]
    ds_read_b64_tr_b16 v[124:125], v14 offset:57344
    v_mfma_f32_16x16x32_bf16 v[180:183], v[68:71], v[56:59], v[180:183]
    ds_read_b64_tr_b16 v[126:127], v15 offset:57344
    v_mfma_f32_16x16x32_bf16 v[128:131], v[72:75], v[36:39], v[128:131]
    ds_read_b128 v[80:83], v6 offset:32768
    v_mfma_f32_16x16x32_bf16 v[132:135], v[76:79], v[36:39], v[132:135]
    ds_read_b128 v[84:87], v6 offset:33792
    v_mfma_f32_16x16x32_bf16 v[144:147], v[72:75], v[44:47], v[144:147]
    ds_read_b128 v[88:91], v6 offset:34816
    v_mfma_f32_16x16x32_bf16 v[148:151], v[76:79], v[44:47], v[148:151]
    ds_read_b128 v[92:95], v6 offset:35840
    v_mfma_f32_16x16x32_bf16 v[160:163], v[72:75], v[52:55], v[160:163]
    ds_read_b128 v[96:99], v6 offset:36864
    v_mfma_f32_16x16x32_bf16 v[164:167], v[76:79], v[52:55], v[164:167]
    ds_read_b128 v[100:103], v6 offset:37888
    v_mfma_f32_16x16x32_bf16 v[176:179], v[72:75], v[60:63], v[176:179]
    ds_read_b128 v[104:107], v6 offset:38912
    v_mfma_f32_16x16x32_bf16 v[180:183], v[76:79], v[60:63], v[180:183]
    ds_read_b128 v[108:111], v6 offset:39936
    s_waitcnt lgkmcnt(0)
    s_waitcnt vmcnt(0)
    s_barrier
    v_mfma_f32_16x16x32_bf16 v[128:131], v[112:115], v[80:83], v[128:131]
    ds_read_b64_tr_b16 v[64:65], v8 offset:16384
    v_mfma_f32_16x16x32_bf16 v[132:135], v[116:119], v[80:83], v[132:135]
    ds_read_b64_tr_b16 v[66:67], v9 offset:16384
    v_mfma_f32_16x16x32_bf16 v[144:147], v[112:115], v[88:91], v[144:147]
    ds_read_b64_tr_b16 v[68:69], v10 offset:16384
    v_mfma_f32_16x16x32_bf16 v[148:151], v[116:119], v[88:91], v[148:151]
    ds_read_b64_tr_b16 v[70:71], v11 offset:16384
    v_mfma_f32_16x16x32_bf16 v[160:163], v[112:115], v[96:99], v[160:163]
    ds_read_b64_tr_b16 v[72:73], v8 offset:24576
    v_mfma_f32_16x16x32_bf16 v[164:167], v[116:119], v[96:99], v[164:167]
    ds_read_b64_tr_b16 v[74:75], v9 offset:24576
    v_mfma_f32_16x16x32_bf16 v[176:179], v[112:115], v[104:107], v[176:179]
    ds_read_b64_tr_b16 v[76:77], v10 offset:24576
    v_mfma_f32_16x16x32_bf16 v[180:183], v[116:119], v[104:107], v[180:183]
    ds_read_b64_tr_b16 v[78:79], v11 offset:24576
    v_mfma_f32_16x16x32_bf16 v[128:131], v[120:123], v[84:87], v[128:131]
    ds_read_b128 v[32:35], v5 offset:0
    v_mfma_f32_16x16x32_bf16 v[132:135], v[124:127], v[84:87], v[132:135]
    ds_read_b128 v[36:39], v5 offset:1024
    v_mfma_f32_16x16x32_bf16 v[144:147], v[120:123], v[92:95], v[144:147]
    ds_read_b128 v[40:43], v5 offset:2048
    v_mfma_f32_16x16x32_bf16 v[148:151], v[124:127], v[92:95], v[148:151]
    ds_read_b128 v[44:47], v5 offset:3072
    v_mfma_f32_16x16x32_bf16 v[160:163], v[120:123], v[100:103], v[160:163]
    ds_read_b128 v[48:51], v5 offset:4096
    v_mfma_f32_16x16x32_bf16 v[164:167], v[124:127], v[100:103], v[164:167]
    ds_read_b128 v[52:55], v5 offset:5120
    v_mfma_f32_16x16x32_bf16 v[176:179], v[120:123], v[108:111], v[176:179]
    ds_read_b128 v[56:59], v5 offset:6144
    v_mfma_f32_16x16x32_bf16 v[180:183], v[124:127], v[108:111], v[180:183]
    ds_read_b128 v[60:63], v5 offset:7168
    s_waitcnt lgkmcnt(0)
w_endH:
    v_mov_b32 v20, 131072
    ds_read_b128 v[24:27], v20
    ds_read_b128 v[28:31], v20 offset:16
    s_cmp_lg_u32 s53, s53
    s_cbranch_scc1 w_epi_siluH
    s_lshl_b32 s30, s27, 10
    s_add_u32 s30, s30, s49
    s_nop 7
    v_cvt_pk_bf16_f32 v80, v128, v129
    v_cvt_pk_bf16_f32 v81, v130, v131
    v_cvt_pk_bf16_f32 v82, v132, v133
    v_cvt_pk_bf16_f32 v83, v134, v135
    buffer_store_dwordx4 v[80:83], v1, s[4:7], s30 offen sc1
    s_add_u32 s30, s30, s50
    v_cvt_pk_bf16_f32 v84, v144, v145
    v_cvt_pk_bf16_f32 v85, v146, v147
    v_cvt_pk_bf16_f32 v86, v148, v149
    v_cvt_pk_bf16_f32 v87, v150, v151
    buffer_store_dwordx4 v[84:87], v1, s[4:7], s30 offen sc1
    s_add_u32 s30, s30, s50
    v_cvt_pk_bf16_f32 v88, v160, v161
    v_cvt_pk_bf16_f32 v89, v162, v163
    v_cvt_pk_bf16_f32 v90, v164, v165
    v_cvt_pk_bf16_f32 v91, v166, v167
    buffer_store_dwordx4 v[88:91], v1, s[4:7], s30 offen sc1
    s_add_u32 s30, s30, s50
    v_cvt_pk_bf16_f32 v92, v176, v177
    v_cvt_pk_bf16_f32 v93, v178, v179
    v_cvt_pk_bf16_f32 v94, v180, v181
    v_cvt_pk_bf16_f32 v95, v182, v183
    buffer_store_dwordx4 v[92:95], v1, s[4:7], s30 offen sc1
    s_add_u32 s30, s30, s50
    s_waitcnt lgkmcnt(0)
    v_or3_b32 v24, v24, v25, v26
    v_or3_b32 v28, v28, v29, v30
    v_or3_b32 v24, v24, v27, v31
    v_or_b32 v24, v24, v28
    s_mov_b32 s28, s51
    s_mov_b32 s57, s53
    v_readfirstlane_b32 s30, v24
    s_cmp_lg_u32 s30, 0
    s_cbranch_scc1 w_drain
    s_mov_b32 s48, s32
    s_cmp_ge_u32 s32, 4
    s_cselect_b32 s30, 2, 3
    s_lshl_b32 s30, s26, s30
    s_mul_i32 s30, s30, s43
    s_add_u32 s49, s42, s30
    s_mov_b32 s50, s43
    s_mov_b32 s51, s46
    s_mov_b32 s23, s41
    s_mov_b32 s53, s47
    s_nop 0
    s_load_dwordx16 s[32:47], s[24:25], 0
    s_add_u32 s24, s24, 64
    s_addc_u32 s25, s25, 0
    s_branch w_first4
w_epi_siluH:
    s_lshl_b32 s30, s27, 10
    s_add_u32 s30, s30, s49
    s_mov_b32 s54, 0xbfb8aa3b
    s_nop 7
    v_cvt_pk_bf16_f32 v80, v128, v129
    v_cvt_pk_bf16_f32 v81, v130, v131
    v_cvt_pk_bf16_f32 v82, v132, v133
    v_cvt_pk_bf16_f32 v83, v134, v135
    v_lshlrev_b32 v128, 16, v80
    v_and_b32 v129, 0xffff0000, v80
    v_lshlrev_b32 v130, 16, v81
    v_and_b32 v131, 0xffff0000, v81
    v_lshlrev_b32 v132, 16, v82
    v_and_b32 v133, 0xffff0000, v82
    v_lshlrev_b32 v134, 16, v83
    v_and_b32 v135, 0xffff0000, v83
    v_mul_f32 v104, s54, v128
    v_mul_f32 v105, s54, v129
    v_mul_f32 v106, s54, v130
    v_mul_f32 v107, s54, v131
    v_mul_f32 v108, s54, v132
    v_mul_f32 v109, s54, v133
    v_mul_f32 v110, s54, v134
    v_mul_f32 v111, s54, v135
    v_exp_f32 v104, v104
    v_exp_f32 v105, v105
    v_exp_f32 v106, v106
    v_exp_f32 v107, v107
    v_exp_f32 v108, v108
    v_exp_f32 v109, v109
    v_exp_f32 v110, v110
    v_exp_f32 v111, v111
    v_add_f32 v104, 1.0, v104
    v_add_f32 v105, 1.0, v105
    v_add_f32 v106, 1.0, v106
    v_add_f32 v107, 1.0, v107
    v_add_f32 v108, 1.0, v108
    v_add_f32 v109, 1.0, v109
    v_add_f32 v110, 1.0, v110
    v_add_f32 v111, 1.0, v111
    v_rcp_f32 v104, v104
    v_rcp_f32 v105, v105
    v_rcp_f32 v106, v106
    v_rcp_f32 v107, v107
    v_rcp_f32 v108, v108
    v_rcp_f32 v109, v109
    v_rcp_f32 v110, v110
    v_rcp_f32 v111, v111
    v_mul_f32 v128, v128, v104
    v_mul_f32 v129, v129, v105
    v_mul_f32 v130, v130, v106
    v_mul_f32 v131, v131, v107
    v_mul_f32 v132, v132, v108
    v_mul_f32 v133, v133, v109
    v_mul_f32 v134, v134, v110
    v_mul_f32 v135, v135, v111
    v_cvt_pk_bf16_f32 v80, v128, v129
    v_cvt_pk_bf16_f32 v81, v130, v131
    v_cvt_pk_bf16_f32 v82, v132, v133
    v_cvt_pk_bf16_f32 v83, v134, v135
    buffer_store_dwordx4 v[80:83], v1, s[4:7], s30 offen sc1
    s_add_u32 s30, s30, s50
    v_cvt_pk_bf16_f32 v84, v144, v145
    v_cvt_pk_bf16_f32 v85, v146, v147
    v_cvt_pk_bf16_f32 v86, v148, v149
    v_cvt_pk_bf16_f32 v87, v150, v151
    v_lshlrev_b32 v144, 16, v84
    v_and_b32 v145, 0xffff0000, v84
    v_lshlrev_b32 v146, 16, v85
    v_and_b32 v147, 0xffff0000, v85
    v_lshlrev_b32 v148, 16, v86
    v_and_b32 v149, 0xffff0000, v86
    v_lshlrev_b32 v150, 16, v87
    v_and_b32 v151, 0xffff0000, v87
    v_mul_f32 v96, s54, v144
    v_mul_f32 v97, s54, v145
    v_mul_f32 v98, s54, v146
    v_mul_f32 v99, s54, v147
    v_mul_f32 v100, s54, v148
    v_mul_f32 v101, s54, v149
    v_mul_f32 v102, s54, v150
    v_mul_f32 v103, s54, v151
    v_exp_f32 v96, v96
    v_exp_f32 v97, v97
    v_exp_f32 v98, v98
    v_exp_f32 v99, v99
    v_exp_f32 v100, v100
    v_exp_f32 v101, v101
    v_exp_f32 v102, v102
    v_exp_f32 v103, v103
    v_add_f32 v96, 1.0, v96
    v_add_f32 v97, 1.0, v97
    v_add_f32 v98, 1.0, v98
    v_add_f32 v99, 1.0, v99
    v_add_f32 v100, 1.0, v100
    v_add_f32 v101, 1.0, v101
    v_add_f32 v102, 1.0, v102
    v_add_f32 v103, 1.0, v103
    v_rcp_f32 v96, v96
    v_rcp_f32 v97, v97
    v_rcp_f32 v98, v98
    v_rcp_f32 v99, v99
    v_rcp_f32 v100, v100
    v_rcp_f32 v101, v101
    v_rcp_f32 v102, v102
    v_rcp_f32 v103, v103
    v_mul_f32 v144, v144, v96
    v_mul_f32 v145, v145, v97
    v_mul_f32 v146, v146, v98
    v_mul_f32 v147, v147, v99
    v_mul_f32 v148, v148, v100
    v_mul_f32 v149, v149, v101
    v_mul_f32 v150, v150, v102
    v_mul_f32 v151, v151, v103
    v_cvt_pk_bf16_f32 v84, v144, v145
    v_cvt_pk_bf16_f32 v85, v146, v147
    v_cvt_pk_bf16_f32 v86, v148, v149
    v_cvt_pk_bf16_f32 v87, v150, v151
    buffer_store_dwordx4 v[84:87], v1, s[4:7], s30 offen sc1
    s_add_u32 s30, s30, s50
    v_cvt_pk_bf16_f32 v88, v160, v161
    v_cvt_pk_bf16_f32 v89, v162, v163
    v_cvt_pk_bf16_f32 v90, v164, v165
    v_cvt_pk_bf16_f32 v91, v166, v167
    v_lshlrev_b32 v160, 16, v88
    v_and_b32 v161, 0xffff0000, v88
    v_lshlrev_b32 v162, 16, v89
    v_and_b32 v163, 0xffff0000, v89
    v_lshlrev_b32 v164, 16, v90
    v_and_b32 v165, 0xffff0000, v90
    v_lshlrev_b32 v166, 16, v91
    v_and_b32 v167, 0xffff0000, v91
    v_mul_f32 v104, s54, v160
    v_mul_f32 v105, s54, v161
    v_mul_f32 v106, s54, v162
    v_mul_f32 v107, s54, v163
    v_mul_f32 v108, s54, v164
    v_mul_f32 v109, s54, v165
    v_mul_f32 v110, s54, v166
    v_mul_f32 v111, s54, v167
    v_exp_f32 v104, v104
    v_exp_f32 v105, v105
    v_exp_f32 v106, v106
    v_exp_f32 v107, v107
    v_exp_f32 v108, v108
    v_exp_f32 v109, v109
    v_exp_f32 v110, v110
    v_exp_f32 v111, v111
    v_add_f32 v104, 1.0, v104
    v_add_f32 v105, 1.0, v105
    v_add_f32 v106, 1.0, v106
    v_add_f32 v107, 1.0, v107
    v_add_f32 v108, 1.0, v108
    v_add_f32 v109, 1.0, v109
    v_add_f32 v110, 1.0, v110
    v_add_f32 v111, 1.0, v111
    v_rcp_f32 v104, v104
    v_rcp_f32 v105, v105
    v_rcp_f32 v106, v106
    v_rcp_f32 v107, v107
    v_rcp_f32 v108, v108
    v_rcp_f32 v109, v109
    v_rcp_f32 v110, v110
    v_rcp_f32 v111, v111
    v_mul_f32 v160, v160, v104
    v_mul_f32 v161, v161, v105
    v_mul_f32 v162, v162, v106
    v_mul_f32 v163, v163, v107
    v_mul_f32 v164, v164, v108
    v_mul_f32 v165, v165, v109
    v_mul_f32 v166, v166, v110
    v_mul_f32 v167, v167, v111
    v_cvt_pk_bf16_f32 v88, v160, v161
    v_cvt_pk_bf16_f32 v89, v162, v163
    v_cvt_pk_bf16_f32 v90, v164, v165
    v_cvt_pk_bf16_f32 v91, v166, v167
    buffer_store_dwordx4 v[88:91], v1, s[4:7], s30 offen sc1
    s_add_u32 s30, s30, s50
    v_cvt_pk_bf16_f32 v92, v176, v177
    v_cvt_pk_bf16_f32 v93, v178, v179
    v_cvt_pk_bf16_f32 v94, v180, v181
    v_cvt_pk_bf16_f32 v95, v182, v183
    v_lshlrev_b32 v176, 16, v92
    v_and_b32 v177, 0xffff0000, v92
    v_lshlrev_b32 v178, 16, v93
    v_and_b32 v179, 0xffff0000, v93
    v_lshlrev_b32 v180, 16, v94
    v_and_b32 v181, 0xffff0000, v94
    v_lshlrev_b32 v182, 16, v95
    v_and_b32 v183, 0xffff0000, v95
    v_mul_f32 v96, s54, v176
    v_mul_f32 v97, s54, v177
    v_mul_f32 v98, s54, v178
    v_mul_f32 v99, s54, v179
    v_mul_f32 v100, s54, v180
    v_mul_f32 v101, s54, v181
    v_mul_f32 v102, s54, v182
    v_mul_f32 v103, s54, v183
    v_exp_f32 v96, v96
    v_exp_f32 v97, v97
    v_exp_f32 v98, v98
    v_exp_f32 v99, v99
    v_exp_f32 v100, v100
    v_exp_f32 v101, v101
    v_exp_f32 v102, v102
    v_exp_f32 v103, v103
    v_add_f32 v96, 1.0, v96
    v_add_f32 v97, 1.0, v97
    v_add_f32 v98, 1.0, v98
    v_add_f32 v99, 1.0, v99
    v_add_f32 v100, 1.0, v100
    v_add_f32 v101, 1.0, v101
    v_add_f32 v102, 1.0, v102
    v_add_f32 v103, 1.0, v103
    v_rcp_f32 v96, v96
    v_rcp_f32 v97, v97
    v_rcp_f32 v98, v98
    v_rcp_f32 v99, v99
    v_rcp_f32 v100, v100
    v_rcp_f32 v101, v101
    v_rcp_f32 v102, v102
    v_rcp_f32 v103, v103
    v_mul_f32 v176, v176, v96
    v_mul_f32 v177, v177, v97
    v_mul_f32 v178, v178, v98
    v_mul_f32 v179, v179, v99
    v_mul_f32 v180, v180, v100
    v_mul_f32 v181, v181, v101
    v_mul_f32 v182, v182, v102
    v_mul_f32 v183, v183, v103
    v_cvt_pk_bf16_f32 v92, v176, v177
    v_cvt_pk_bf16_f32 v93, v178, v179
    v_cvt_pk_bf16_f32 v94, v180, v181
    v_cvt_pk_bf16_f32 v95, v182, v183
    buffer_store_dwordx4 v[92:95], v1, s[4:7], s30 offen sc1
    s_add_u32 s30, s30, s50
    s_waitcnt lgkmcnt(0)
    v_or3_b32 v24, v24, v25, v26
    v_or3_b32 v28, v28, v29, v30
    v_or3_b32 v24, v24, v27, v31
    v_or_b32 v24, v24, v28
    s_mov_b32 s28, s51
    s_mov_b32 s57, s53
    v_readfirstlane_b32 s30, v24
    s_cmp_lg_u32 s30, 0
    s_cbranch_scc1 w_drain
    s_mov_b32 s48, s32
    s_cmp_ge_u32 s32, 4
    s_cselect_b32 s30, 2, 3
    s_lshl_b32 s30, s26, s30
    s_mul_i32 s30, s30, s43
    s_add_u32 s49, s42, s30
    s_mov_b32 s50, s43
    s_mov_b32 s51, s46
    s_mov_b32 s23, s41
    s_mov_b32 s53, s47
    s_nop 0
    s_load_dwordx16 s[32:47], s[24:25], 0
    s_add_u32 s24, s24, 64
    s_addc_u32 s25, s25, 0
    s_branch w_first4
w_firstX:
    s_waitcnt vmcnt(0)
    s_barrier
    v_bfe_u32 v20, v1, 4, 3
    v_xor_b32 v21, v4, v20
    v_lshlrev_b32 v21, 4, v21
    v_lshl_add_u32 v21, v20, 7, v21
    v_bfe_u32 v20, v1, 7, 1
    v_lshl_add_u32 v21, v20, 10, v21
    s_lshl_b32 s30, s26, 13
    v_add_u32 v24, s30, v21
    v_xor_b32 v25, 64, v24
    v_add_u32 v26, 0x10000, v24
    v_add_u32 v27, 0x10000, v25
    v_add_u32 v28, s22, v1
    v_add_u32 v29, 0x10000, v28
    ds_read_b64_tr_b16 v[64:65], v8 offset:16384
    ds_read_b64_tr_b16 v[66:67], v9 offset:16384
    ds_read_b64_tr_b16 v[68:69], v10 offset:16384
    ds_read_b64_tr_b16 v[70:71], v11 offset:16384
    ds_read_b64_tr_b16 v[72:73], v8 offset:24576
    ds_read_b64_tr_b16 v[74:75], v9 offset:24576
    ds_read_b64_tr_b16 v[76:77], v10 offset:24576
    ds_read_b64_tr_b16 v[78:79], v11 offset:24576
    ds_read_b128 v[32:35], v24 offset:0
    ds_read_b128 v[36:39], v25 offset:0
    ds_read_b128 v[40:43], v24 offset:2048
    ds_read_b128 v[44:47], v25 offset:2048
    ds_read_b128 v[48:51], v24 offset:4096
    ds_read_b128 v[52:55], v25 offset:4096
    ds_read_b128 v[56:59], v24 offset:6144
    ds_read_b128 v[60:63], v25 offset:6144
    v_mov_b32 v208, 0x3f803f80
    v_mov_b32 v209, 0x3f803f80
    v_mov_b32 v210, 0x3f803f80
    v_mov_b32 v211, 0x3f803f80
    s_waitcnt lgkmcnt(0)
    s_waitcnt vmcnt(8)
    s_barrier
    s_add_u32 m0, s21, 0
    s_nop 0
    buffer_load_dwordx4 v23, s[88:91], s16 offen lds
    s_add_u32 s16, s16, s62
    s_add_u32 m0, s21, 1024
    s_nop 0
    buffer_load_dwordx4 v23, s[88:91], s17 offen lds
    s_add_u32 s17, s17, s62
    s_cmp_ge_u32 s16, s92
    s_cselect_b32 s94, 2048, 0
    s_sub_u32 s16, s16, s94
    s_sub_u32 s17, s17, s94
    s_add_u32 m0, s22, 0
    s_nop 0
    buffer_load_dwordx4 v2, s[8:11], s18 offen lds
    s_add_u32 s18, s18, s20
    s_add_u32 m0, s22, 8192
    s_nop 0
    buffer_load_dwordx4 v2, s[12:15], s19 offen lds
    s_add_u32 s19, s19, s20
    s_cmp_ge_u32 s18, s95
    s_cselect_b32 s94, s93, 0
    s_sub_u32 s18, s18, s94
    s_sub_u32 s19, s19, s94
    v_mfma_f32_16x16x32_bf16 v[128:131], v[64:67], v[32:35], 0
    ds_read_b64_tr_b16 v[112:113], v8 offset:49152
    v_mfma_f32_16x16x32_bf16 v[132:135], v[68:71], v[32:35], 0
    ds_read_b64_tr_b16 v[114:115], v9 offset:49152
    v_mfma_f32_16x16x32_bf16 v[144:147], v[64:67], v[40:43], 0
    ds_read_b64_tr_b16 v[116:117], v10 offset:49152
    v_mfma_f32_16x16x32_bf16 v[148:151], v[68:71], v[40:43], 0
    ds_read_b64_tr_b16 v[118:119], v11 offset:49152
    v_mfma_f32_16x16x32_bf16 v[160:163], v[64:67], v[48:51], 0
    ds_read_b64_tr_b16 v[120:121], v8 offset:57344
    v_mfma_f32_16x16x32_bf16 v[164:167], v[68:71], v[48:51], 0
    ds_read_b64_tr_b16 v[122:123], v9 offset:57344
    v_mfma_f32_16x16x32_bf16 v[176:179], v[64:67], v[56:59], 0
    ds_read_b64_tr_b16 v[124:125], v10 offset:57344
    v_mfma_f32_16x16x32_bf16 v[180:183], v[68:71], v[56:59], 0
    ds_read_b64_tr_b16 v[126:127], v11 offset:57344
    v_mfma_f32_16x16x32_bf16 v[192:195], v[64:67], v[208:211], 0
    ds_read_b128 v[80:83], v24 offset:32768
    v_mfma_f32_16x16x32_bf16 v[196:199], v[68:71], v[208:211], 0
    ds_read_b128 v[84:87], v25 offset:32768
    v_mfma_f32_16x16x32_bf16 v[128:131], v[72:75], v[36:39], v[128:131]
    ds_read_b128 v[88:91], v24 offset:34816
    v_mfma_f32_16x16x32_bf16 v[132:135], v[76:79], v[36:39], v[132:135]
    ds_read_b128 v[92:95], v25 offset:34816
    v_mfma_f32_16x16x32_bf16 v[144:147], v[72:75], v[44:47], v[144:147]
    ds_read_b128 v[96:99], v24 offset:36864
    v_mfma_f32_16x16x32_bf16 v[148:151], v[76:79], v[44:47], v[148:151]
    ds_read_b128 v[100:103], v25 offset:36864
    v_mfma_f32_16x16x32_bf16 v[160:163], v[72:75], v[52:55], v[160:163]
    ds_read_b128 v[104:107], v24 offset:38912
    v_mfma_f32_16x16x32_bf16 v[164:167], v[76:79], v[52:55], v[164:167]
    ds_read_b128 v[108:111], v25 offset:38912
    v_mfma_f32_16x16x32_bf16 v[176:179], v[72:75], v[60:63], v[176:179]
    v_mfma_f32_16x16x32_bf16 v[180:183], v[76:79], v[60:63], v[180:183]
    v_mfma_f32_16x16x32_bf16 v[192:195], v[72:75], v[208:211], v[192:195]
    v_mfma_f32_16x16x32_bf16 v[196:199], v[76:79], v[208:211], v[196:199]
    s_waitcnt lgkmcnt(0)
    s_waitcnt vmcnt(8)
    s_barrier
    s_add_u32 m0, s21, 32768
    s_nop 0
    buffer_load_dwordx4 v23, s[88:91], s16 offen lds
    s_add_u32 s16, s16, s62
    s_add_u32 m0, s21, 33792
    s_nop 0
    buffer_load_dwordx4 v23, s[88:91], s17 offen lds
    s_add_u32 s17, s17, s62
    s_cmp_ge_u32 s16, s92
    s_cselect_b32 s94, 2048, 0
    s_sub_u32 s16, s16, s94
    s_sub_u32 s17, s17, s94
    s_add_u32 m0, s22, 32768
    s_nop 0
    buffer_load_dwordx4 v2, s[8:11], s18 offen lds
    s_add_u32 s18, s18, s20
    s_add_u32 m0, s22, 40960
    s_nop 0
    buffer_load_dwordx4 v2, s[12:15], s19 offen lds
    s_add_u32 s19, s19, s20
    s_cmp_ge_u32 s18, s95
    s_cselect_b32 s94, s93, 0
    s_sub_u32 s18, s18, s94
    s_sub_u32 s19, s19, s94
    v_mfma_f32_16x16x32_bf16 v[128:131], v[112:115], v[80:83], v[128:131]
    ds_read_b64_tr_b16 v[64:65], v12 offset:16384
    v_mfma_f32_16x16x32_bf16 v[132:135], v[116:119], v[80:83], v[132:135]
    ds_read_b64_tr_b16 v[66:67], v13 offset:16384
    v_mfma_f32_16x16x32_bf16 v[144:147], v[112:115], v[88:91], v[144:147]
    ds_read_b64_tr_b16 v[68:69], v14 offset:16384
    v_mfma_f32_16x16x32_bf16 v[148:151], v[116:119], v[88:91], v[148:151]
    ds_read_b64_tr_b16 v[70:71], v15 offset:16384
    v_mfma_f32_16x16x32_bf16 v[160:163], v[112:115], v[96:99], v[160:163]
    ds_read_b64_tr_b16 v[72:73], v12 offset:24576
    v_mfma_f32_16x16x32_bf16 v[164:167], v[116:119], v[96:99], v[164:167]
    ds_read_b64_tr_b16 v[74:75], v13 offset:24576
    v_mfma_f32_16x16x32_bf16 v[176:179], v[112:115], v[104:107], v[176:179]
    ds_read_b64_tr_b16 v[76:77], v14 offset:24576
    v_mfma_f32_16x16x32_bf16 v[180:183], v[116:119], v[104:107], v[180:183]
    ds_read_b64_tr_b16 v[78:79], v15 offset:24576
    v_mfma_f32_16x16x32_bf16 v[192:195], v[112:115], v[208:211], v[192:195]
    ds_read_b128 v[32:35], v26 offset:0
    v_mfma_f32_16x16x32_bf16 v[196:199], v[116:119], v[208:211], v[196:199]
    ds_read_b128 v[36:39], v27 offset:0
    v_mfma_f32_16x16x32_bf16 v[128:131], v[120:123], v[84:87], v[128:131]
    ds_read_b128 v[40:43], v26 offset:2048
    v_mfma_f32_16x16x32_bf16 v[132:135], v[124:127], v[84:87], v[132:135]
    ds_read_b128 v[44:47], v27 offset:2048
    v_mfma_f32_16x16x32_bf16 v[144:147], v[120:123], v[92:95], v[144:147]
    ds_read_b128 v[48:51], v26 offset:4096
    v_mfma_f32_16x16x32_bf16 v[148:151], v[124:127], v[92:95], v[148:151]
    ds_read_b128 v[52:55], v27 offset:4096
    v_mfma_f32_16x16x32_bf16 v[160:163], v[120:123], v[100:103], v[160:163]
    ds_read_b128 v[56:59], v26 offset:6144
    v_mfma_f32_16x16x32_bf16 v[164:167], v[124:127], v[100:103], v[164:167]
    ds_read_b128 v[60:63], v27 offset:6144
    v_mfma_f32_16x16x32_bf16 v[176:179], v[120:123], v[108:111], v[176:179]
    v_mfma_f32_16x16x32_bf16 v[180:183], v[124:127], v[108:111], v[180:183]
    v_mfma_f32_16x16x32_bf16 v[192:195], v[120:123], v[208:211], v[192:195]
    v_mfma_f32_16x16x32_bf16 v[196:199], v[124:127], v[208:211], v[196:199]
    s_waitcnt lgkmcnt(0)
    s_waitcnt vmcnt(8)
    s_barrier
    s_add_u32 m0, s21, 65536
    s_nop 0
    buffer_load_dwordx4 v23, s[88:91], s16 offen lds
    s_add_u32 s16, s16, s62
    s_add_u32 m0, s21, 66560
    s_nop 0
    buffer_load_dwordx4 v23, s[88:91], s17 offen lds
    s_add_u32 s17, s17, s62
    s_cmp_ge_u32 s16, s92
    s_cselect_b32 s94, 2048, 0
    s_sub_u32 s16, s16, s94
    s_sub_u32 s17, s17, s94
    s_add_u32 m0, s22, 65536
    s_nop 0
    buffer_load_dwordx4 v2, s[8:11], s18 offen lds
    s_add_u32 s18, s18, s20
    s_add_u32 m0, s22, 73728
    s_nop 0
    buffer_load_dwordx4 v2, s[12:15], s19 offen lds
    s_add_u32 s19, s19, s20
    s_cmp_ge_u32 s18, s95
    s_cselect_b32 s94, s93, 0
    s_sub_u32 s18, s18, s94
    s_sub_u32 s19, s19, s94
    v_mfma_f32_16x16x32_bf16 v[128:131], v[64:67], v[32:35], v[128:131]
    ds_read_b64_tr_b16 v[112:113], v12 offset:49152
    v_mfma_f32_16x16x32_bf16 v[132:135], v[68:71], v[32:35], v[132:135]
    ds_read_b64_tr_b16 v[114:115], v13 offset:49152
    v_mfma_f32_16x16x32_bf16 v[144:147], v[64:67], v[40:43], v[144:147]
    ds_read_b64_tr_b16 v[116:117], v14 offset:49152
    v_mfma_f32_16x16x32_bf16 v[148:151], v[68:71], v[40:43], v[148:151]
    ds_read_b64_tr_b16 v[118:119], v15 offset:49152
    v_mfma_f32_16x16x32_bf16 v[160:163], v[64:67], v[48:51], v[160:163]
    ds_read_b64_tr_b16 v[120:121], v12 offset:57344
    v_mfma_f32_16x16x32_bf16 v[164:167], v[68:71], v[48:51], v[164:167]
    ds_read_b64_tr_b16 v[122:123], v13 offset:57344
    v_mfma_f32_16x16x32_bf16 v[176:179], v[64:67], v[56:59], v[176:179]
    ds_read_b64_tr_b16 v[124:125], v14 offset:57344
    v_mfma_f32_16x16x32_bf16 v[180:183], v[68:71], v[56:59], v[180:183]
    ds_read_b64_tr_b16 v[126:127], v15 offset:57344
    v_mfma_f32_16x16x32_bf16 v[192:195], v[64:67], v[208:211], v[192:195]
    ds_read_b128 v[80:83], v26 offset:32768
    v_mfma_f32_16x16x32_bf16 v[196:199], v[68:71], v[208:211], v[196:199]
    ds_read_b128 v[84:87], v27 offset:32768
    v_mfma_f32_16x16x32_bf16 v[128:131], v[72:75], v[36:39], v[128:131]
    ds_read_b128 v[88:91], v26 offset:34816
    v_mfma_f32_16x16x32_bf16 v[132:135], v[76:79], v[36:39], v[132:135]
    ds_read_b128 v[92:95], v27 offset:34816
    v_mfma_f32_16x16x32_bf16 v[144:147], v[72:75], v[44:47], v[144:147]
    ds_read_b128 v[96:99], v26 offset:36864
    v_mfma_f32_16x16x32_bf16 v[148:151], v[76:79], v[44:47], v[148:151]
    ds_read_b128 v[100:103], v27 offset:36864
    v_mfma_f32_16x16x32_bf16 v[160:163], v[72:75], v[52:55], v[160:163]
    ds_read_b128 v[104:107], v26 offset:38912
    v_mfma_f32_16x16x32_bf16 v[164:167], v[76:79], v[52:55], v[164:167]
    ds_read_b128 v[108:111], v27 offset:38912
    v_mfma_f32_16x16x32_bf16 v[176:179], v[72:75], v[60:63], v[176:179]
    v_mfma_f32_16x16x32_bf16 v[180:183], v[76:79], v[60:63], v[180:183]
    v_mfma_f32_16x16x32_bf16 v[192:195], v[72:75], v[208:211], v[192:195]
    v_mfma_f32_16x16x32_bf16 v[196:199], v[76:79], v[208:211], v[196:199]
    s_waitcnt lgkmcnt(0)
    s_waitcnt vmcnt(8)
    s_barrier
    s_add_u32 m0, s21, 98304
    s_nop 0
    buffer_load_dwordx4 v23, s[88:91], s16 offen lds
    s_add_u32 s16, s16, s62
    s_add_u32 m0, s21, 99328
    s_nop 0
    buffer_load_dwordx4 v23, s[88:91], s17 offen lds
    s_add_u32 s17, s17, s62
    s_cmp_ge_u32 s16, s92
    s_cselect_b32 s94, 2048, 0
    s_sub_u32 s16, s16, s94
    s_sub_u32 s17, s17, s94
    s_add_u32 m0, s22, 98304
    s_nop 0
    buffer_load_dwordx4 v2, s[8:11], s18 offen lds
    s_add_u32 s18, s18, s20
    s_add_u32 m0, s22, 106496
    s_nop 0
    buffer_load_dwordx4 v2, s[12:15], s19 offen lds
    s_add_u32 s19, s19, s20
    s_cmp_ge_u32 s18, s95
    s_cselect_b32 s94, s93, 0
    s_sub_u32 s18, s18, s94
    s_sub_u32 s19, s19, s94
    v_mfma_f32_16x16x32_bf16 v[128:131], v[112:115], v[80:83], v[128:131]
    ds_read_b64_tr_b16 v[64:65], v8 offset:16384
    v_mfma_f32_16x16x32_bf16 v[132:135], v[116:119], v[80:83], v[132:135]
    ds_read_b64_tr_b16 v[66:67], v9 offset:16384
    v_mfma_f32_16x16x32_bf16 v[144:147], v[112:115], v[88:91], v[144:147]
    ds_read_b64_tr_b16 v[68:69], v10 offset:16384
    v_mfma_f32_16x16x32_bf16 v[148:151], v[116:119], v[88:91], v[148:151]
    ds_read_b64_tr_b16 v[70:71], v11 offset:16384
    v_mfma_f32_16x16x32_bf16 v[160:163], v[112:115], v[96:99], v[160:163]
    ds_read_b64_tr_b16 v[72:73], v8 offset:24576
    v_mfma_f32_16x16x32_bf16 v[164:167], v[116:119], v[96:99], v[164:167]
    ds_read_b64_tr_b16 v[74:75], v9 offset:24576
    v_mfma_f32_16x16x32_bf16 v[176:179], v[112:115], v[104:107], v[176:179]
    ds_read_b64_tr_b16 v[76:77], v10 offset:24576
    v_mfma_f32_16x16x32_bf16 v[180:183], v[116:119], v[104:107], v[180:183]
    ds_read_b64_tr_b16 v[78:79], v11 offset:24576
    v_mfma_f32_16x16x32_bf16 v[192:195], v[112:115], v[208:211], v[192:195]
    ds_read_b128 v[32:35], v24 offset:0
    v_mfma_f32_16x16x32_bf16 v[196:199], v[116:119], v[208:211], v[196:199]
    ds_read_b128 v[36:39], v25 offset:0
    v_mfma_f32_16x16x32_bf16 v[128:131], v[120:123], v[84:87], v[128:131]
    ds_read_b128 v[40:43], v24 offset:2048
    v_mfma_f32_16x16x32_bf16 v[132:135], v[124:127], v[84:87], v[132:135]
    ds_read_b128 v[44:47], v25 offset:2048
    v_mfma_f32_16x16x32_bf16 v[144:147], v[120:123], v[92:95], v[144:147]
    ds_read_b128 v[48:51], v24 offset:4096
    v_mfma_f32_16x16x32_bf16 v[148:151], v[124:127], v[92:95], v[148:151]
    ds_read_b128 v[52:55], v25 offset:4096
    v_mfma_f32_16x16x32_bf16 v[160:163], v[120:123], v[100:103], v[160:163]
    ds_read_b128 v[56:59], v24 offset:6144
    v_mfma_f32_16x16x32_bf16 v[164:167], v[124:127], v[100:103], v[164:167]
    ds_read_b128 v[60:63], v25 offset:6144
    v_mfma_f32_16x16x32_bf16 v[176:179], v[120:123], v[108:111], v[176:179]
    v_mfma_f32_16x16x32_bf16 v[180:183], v[124:127], v[108:111], v[180:183]
    v_mfma_f32_16x16x32_bf16 v[192:195], v[120:123], v[208:211], v[192:195]
    v_mfma_f32_16x16x32_bf16 v[196:199], v[124:127], v[208:211], v[196:199]
    s_waitcnt lgkmcnt(0)
    s_waitcnt vmcnt(8)
    s_barrier
    s_add_u32 m0, s21, 0
    s_nop 0
    buffer_load_dwordx4 v23, s[88:91], s16 offen lds
    s_add_u32 s16, s16, s62
    s_add_u32 m0, s21, 1024
    s_nop 0
    buffer_load_dwordx4 v23, s[88:91], s17 offen lds
    s_add_u32 s17, s17, s62
    s_cmp_ge_u32 s16, s92
    s_cselect_b32 s94, 2048, 0
    s_sub_u32 s16, s16, s94
    s_sub_u32 s17, s17, s94
    s_add_u32 m0, s22, 0
    s_nop 0
    buffer_load_dwordx4 v2, s[8:11], s18 offen lds
    s_add_u32 s18, s18, s20
    s_add_u32 m0, s22, 8192
    s_nop 0
    buffer_load_dwordx4 v2, s[12:15], s19 offen lds
    s_add_u32 s19, s19, s20
    s_cmp_ge_u32 s18, s95
    s_cselect_b32 s94, s93, 0
    s_sub_u32 s18, s18, s94
    s_sub_u32 s19, s19, s94
    v_mfma_f32_16x16x32_bf16 v[128:131], v[64:67], v[32:35], v[128:131]
    ds_read_b64_tr_b16 v[112:113], v8 offset:49152
    v_mfma_f32_16x16x32_bf16 v[132:135], v[68:71], v[32:35], v[132:135]
    ds_read_b64_tr_b16 v[114:115], v9 offset:49152
    v_mfma_f32_16x16x32_bf16 v[144:147], v[64:67], v[40:43], v[144:147]
    ds_read_b64_tr_b16 v[116:117], v10 offset:49152
    v_mfma_f32_16x16x32_bf16 v[148:151], v[68:71], v[40:43], v[148:151]
    ds_read_b64_tr_b16 v[118:119], v11 offset:49152
    v_mfma_f32_16x16x32_bf16 v[160:163], v[64:67], v[48:51], v[160:163]
    ds_read_b64_tr_b16 v[120:121], v8 offset:57344
    v_mfma_f32_16x16x32_bf16 v[164:167], v[68:71], v[48:51], v[164:167]
    ds_read_b64_tr_b16 v[122:123], v9 offset:57344
    v_mfma_f32_16x16x32_bf16 v[176:179], v[64:67], v[56:59], v[176:179]
    ds_read_b64_tr_b16 v[124:125], v10 offset:57344
    v_mfma_f32_16x16x32_bf16 v[180:183], v[68:71], v[56:59], v[180:183]
    ds_read_b64_tr_b16 v[126:127], v11 offset:57344
    v_mfma_f32_16x16x32_bf16 v[192:195], v[64:67], v[208:211], v[192:195]
    ds_read_b128 v[80:83], v24 offset:32768
    v_mfma_f32_16x16x32_bf16 v[196:199], v[68:71], v[208:211], v[196:199]
    ds_read_b128 v[84:87], v25 offset:32768
    v_mfma_f32_16x16x32_bf16 v[128:131], v[72:75], v[36:39], v[128:131]
    ds_read_b128 v[88:91], v24 offset:34816
    v_mfma_f32_16x16x32_bf16 v[132:135], v[76:79], v[36:39], v[132:135]
    ds_read_b128 v[92:95], v25 offset:34816
    v_mfma_f32_16x16x32_bf16 v[144:147], v[72:75], v[44:47], v[144:147]
    ds_read_b128 v[96:99], v24 offset:36864
    v_mfma_f32_16x16x32_bf16 v[148:151], v[76:79], v[44:47], v[148:151]
    ds_read_b128 v[100:103], v25 offset:36864
    v_mfma_f32_16x16x32_bf16 v[160:163], v[72:75], v[52:55], v[160:163]
    ds_read_b128 v[104:107], v24 offset:38912
    v_mfma_f32_16x16x32_bf16 v[164:167], v[76:79], v[52:55], v[164:167]
    ds_read_b128 v[108:111], v25 offset:38912
    v_mfma_f32_16x16x32_bf16 v[176:179], v[72:75], v[60:63], v[176:179]
    v_mfma_f32_16x16x32_bf16 v[180:183], v[76:79], v[60:63], v[180:183]
    v_mfma_f32_16x16x32_bf16 v[192:195], v[72:75], v[208:211], v[192:195]
    v_mfma_f32_16x16x32_bf16 v[196:199], v[76:79], v[208:211], v[196:199]
    s_waitcnt lgkmcnt(0)
    s_waitcnt vmcnt(8)
    s_barrier
    s_add_u32 m0, s21, 32768
    s_nop 0
    buffer_load_dwordx4 v23, s[88:91], s16 offen lds
    s_add_u32 s16, s16, s62
    s_add_u32 m0, s21, 33792
    s_nop 0
    buffer_load_dwordx4 v23, s[88:91], s17 offen lds
    s_add_u32 s17, s17, s62
    s_cmp_ge_u32 s16, s92
    s_cselect_b32 s94, 2048, 0
    s_sub_u32 s16, s16, s94
    s_sub_u32 s17, s17, s94
    s_add_u32 m0, s22, 32768
    s_nop 0
    buffer_load_dwordx4 v2, s[8:11], s18 offen lds
    s_add_u32 s18, s18, s20
    s_add_u32 m0, s22, 40960
    s_nop 0
    buffer_load_dwordx4 v2, s[12:15], s19 offen lds
    s_add_u32 s19, s19, s20
    s_cmp_ge_u32 s18, s95
    s_cselect_b32 s94, s93, 0
    s_sub_u32 s18, s18, s94
    s_sub_u32 s19, s19, s94
    v_mfma_f32_16x16x32_bf16 v[128:131], v[112:115], v[80:83], v[128:131]
    ds_read_b64_tr_b16 v[64:65], v12 offset:16384
    v_mfma_f32_16x16x32_bf16 v[132:135], v[116:119], v[80:83], v[132:135]
    ds_read_b64_tr_b16 v[66:67], v13 offset:16384
    v_mfma_f32_16x16x32_bf16 v[144:147], v[112:115], v[88:91], v[144:147]
    ds_read_b64_tr_b16 v[68:69], v14 offset:16384
    v_mfma_f32_16x16x32_bf16 v[148:151], v[116:119], v[88:91], v[148:151]
    ds_read_b64_tr_b16 v[70:71], v15 offset:16384
    v_mfma_f32_16x16x32_bf16 v[160:163], v[112:115], v[96:99], v[160:163]
    ds_read_b64_tr_b16 v[72:73], v12 offset:24576
    v_mfma_f32_16x16x32_bf16 v[164:167], v[116:119], v[96:99], v[164:167]
    ds_read_b64_tr_b16 v[74:75], v13 offset:24576
    v_mfma_f32_16x16x32_bf16 v[176:179], v[112:115], v[104:107], v[176:179]
    ds_read_b64_tr_b16 v[76:77], v14 offset:24576
    v_mfma_f32_16x16x32_bf16 v[180:183], v[116:119], v[104:107], v[180:183]
    ds_read_b64_tr_b16 v[78:79], v15 offset:24576
    v_mfma_f32_16x16x32_bf16 v[192:195], v[112:115], v[208:211], v[192:195]
    ds_read_b128 v[32:35], v26 offset:0
    v_mfma_f32_16x16x32_bf16 v[196:199], v[116:119], v[208:211], v[196:199]
    ds_read_b128 v[36:39], v27 offset:0
    v_mfma_f32_16x16x32_bf16 v[128:131], v[120:123], v[84:87], v[128:131]
    ds_read_b128 v[40:43], v26 offset:2048
    v_mfma_f32_16x16x32_bf16 v[132:135], v[124:127], v[84:87], v[132:135]
    ds_read_b128 v[44:47], v27 offset:2048
    v_mfma_f32_16x16x32_bf16 v[144:147], v[120:123], v[92:95], v[144:147]
    ds_read_b128 v[48:51], v26 offset:4096
    v_mfma_f32_16x16x32_bf16 v[148:151], v[124:127], v[92:95], v[148:151]
    ds_read_b128 v[52:55], v27 offset:4096
    v_mfma_f32_16x16x32_bf16 v[160:163], v[120:123], v[100:103], v[160:163]
    ds_read_b128 v[56:59], v26 offset:6144
    v_mfma_f32_16x16x32_bf16 v[164:167], v[124:127], v[100:103], v[164:167]
    ds_read_b128 v[60:63], v27 offset:6144
    v_mfma_f32_16x16x32_bf16 v[176:179], v[120:123], v[108:111], v[176:179]
    v_mfma_f32_16x16x32_bf16 v[180:183], v[124:127], v[108:111], v[180:183]
    v_mfma_f32_16x16x32_bf16 v[192:195], v[120:123], v[208:211], v[192:195]
    v_mfma_f32_16x16x32_bf16 v[196:199], v[124:127], v[208:211], v[196:199]
    s_waitcnt lgkmcnt(0)
    s_waitcnt vmcnt(8)
    s_barrier
    s_add_u32 m0, s21, 65536
    s_nop 0
    buffer_load_dwordx4 v23, s[88:91], s16 offen lds
    s_add_u32 s16, s16, s62
    s_add_u32 m0, s21, 66560
    s_nop 0
    buffer_load_dwordx4 v23, s[88:91], s17 offen lds
    s_add_u32 s17, s17, s62
    s_cmp_ge_u32 s16, s92
    s_cselect_b32 s94, 2048, 0
    s_sub_u32 s16, s16, s94
    s_sub_u32 s17, s17, s94
    s_add_u32 m0, s22, 65536
    s_nop 0
    buffer_load_dwordx4 v2, s[8:11], s18 offen lds
    s_add_u32 s18, s18, s20
    s_add_u32 m0, s22, 73728
    s_nop 0
    buffer_load_dwordx4 v2, s[12:15], s19 offen lds
    s_add_u32 s19, s19, s20
    s_cmp_ge_u32 s18, s95
    s_cselect_b32 s94, s93, 0
    s_sub_u32 s18, s18, s94
    s_sub_u32 s19, s19, s94
    v_mfma_f32_16x16x32_bf16 v[128:131], v[64:67], v[32:35], v[128:131]
    ds_read_b64_tr_b16 v[112:113], v12 offset:49152
    v_mfma_f32_16x16x32_bf16 v[132:135], v[68:71], v[32:35], v[132:135]
    ds_read_b64_tr_b16 v[114:115], v13 offset:49152
    v_mfma_f32_16x16x32_bf16 v[144:147], v[64:67], v[40:43], v[144:147]
    ds_read_b64_tr_b16 v[116:117], v14 offset:49152
    v_mfma_f32_16x16x32_bf16 v[148:151], v[68:71], v[40:43], v[148:151]
    ds_read_b64_tr_b16 v[118:119], v15 offset:49152
    v_mfma_f32_16x16x32_bf16 v[160:163], v[64:67], v[48:51], v[160:163]
    ds_read_b64_tr_b16 v[120:121], v12 offset:57344
    v_mfma_f32_16x16x32_bf16 v[164:167], v[68:71], v[48:51], v[164:167]
    ds_read_b64_tr_b16 v[122:123], v13 offset:57344
    v_mfma_f32_16x16x32_bf16 v[176:179], v[64:67], v[56:59], v[176:179]
    ds_read_b64_tr_b16 v[124:125], v14 offset:57344
    v_mfma_f32_16x16x32_bf16 v[180:183], v[68:71], v[56:59], v[180:183]
    ds_read_b64_tr_b16 v[126:127], v15 offset:57344
    v_mfma_f32_16x16x32_bf16 v[192:195], v[64:67], v[208:211], v[192:195]
    ds_read_b128 v[80:83], v26 offset:32768
    v_mfma_f32_16x16x32_bf16 v[196:199], v[68:71], v[208:211], v[196:199]
    ds_read_b128 v[84:87], v27 offset:32768
    v_mfma_f32_16x16x32_bf16 v[128:131], v[72:75], v[36:39], v[128:131]
    ds_read_b128 v[88:91], v26 offset:34816
    v_mfma_f32_16x16x32_bf16 v[132:135], v[76:79], v[36:39], v[132:135]
    ds_read_b128 v[92:95], v27 offset:34816
    v_mfma_f32_16x16x32_bf16 v[144:147], v[72:75], v[44:47], v[144:147]
    ds_read_b128 v[96:99], v26 offset:36864
    v_mfma_f32_16x16x32_bf16 v[148:151], v[76:79], v[44:47], v[148:151]
    ds_read_b128 v[100:103], v27 offset:36864
    v_mfma_f32_16x16x32_bf16 v[160:163], v[72:75], v[52:55], v[160:163]
    ds_read_b128 v[104:107], v26 offset:38912
    v_mfma_f32_16x16x32_bf16 v[164:167], v[76:79], v[52:55], v[164:167]
    ds_read_b128 v[108:111], v27 offset:38912
    v_mfma_f32_16x16x32_bf16 v[176:179], v[72:75], v[60:63], v[176:179]
    v_mfma_f32_16x16x32_bf16 v[180:183], v[76:79], v[60:63], v[180:183]
    v_mfma_f32_16x16x32_bf16 v[192:195], v[72:75], v[208:211], v[192:195]
    v_mfma_f32_16x16x32_bf16 v[196:199], v[76:79], v[208:211], v[196:199]
    s_waitcnt lgkmcnt(0)
    s_waitcnt vmcnt(8)
    s_barrier
    s_add_u32 m0, s21, 98304
    s_nop 0
    buffer_load_dwordx4 v23, s[88:91], s16 offen lds
    s_add_u32 s16, s16, s62
    s_add_u32 m0, s21, 99328
    s_nop 0
    buffer_load_dwordx4 v23, s[88:91], s17 offen lds
    s_add_u32 s17, s17, s62
    s_cmp_ge_u32 s16, s92
    s_cselect_b32 s94, 2048, 0
    s_sub_u32 s16, s16, s94
    s_sub_u32 s17, s17, s94
    s_add_u32 m0, s22, 98304
    s_nop 0
    buffer_load_dwordx4 v2, s[8:11], s18 offen lds
    s_add_u32 s18, s18, s20
    s_add_u32 m0, s22, 106496
    s_nop 0
    buffer_load_dwordx4 v2, s[12:15], s19 offen lds
    s_add_u32 s19, s19, s20
    s_cmp_ge_u32 s18, s95
    s_cselect_b32 s94, s93, 0
    s_sub_u32 s18, s18, s94
    s_sub_u32 s19, s19, s94
    v_mfma_f32_16x16x32_bf16 v[128:131], v[112:115], v[80:83], v[128:131]
    ds_read_b64_tr_b16 v[64:65], v8 offset:16384
    v_mfma_f32_16x16x32_bf16 v[132:135], v[116:119], v[80:83], v[132:135]
    ds_read_b64_tr_b16 v[66:67], v9 offset:16384
    v_mfma_f32_16x16x32_bf16 v[144:147], v[112:115], v[88:91], v[144:147]
    ds_read_b64_tr_b16 v[68:69], v10 offset:16384
    v_mfma_f32_16x16x32_bf16 v[148:151], v[116:119], v[88:91], v[148:151]
    ds_read_b64_tr_b16 v[70:71], v11 offset:16384
    v_mfma_f32_16x16x32_bf16 v[160:163], v[112:115], v[96:99], v[160:163]
    ds_read_b64_tr_b16 v[72:73], v8 offset:24576
    v_mfma_f32_16x16x32_bf16 v[164:167], v[116:119], v[96:99], v[164:167]
    ds_read_b64_tr_b16 v[74:75], v9 offset:24576
    v_mfma_f32_16x16x32_bf16 v[176:179], v[112:115], v[104:107], v[176:179]
    ds_read_b64_tr_b16 v[76:77], v10 offset:24576
    v_mfma_f32_16x16x32_bf16 v[180:183], v[116:119], v[104:107], v[180:183]
    ds_read_b64_tr_b16 v[78:79], v11 offset:24576
    v_mfma_f32_16x16x32_bf16 v[192:195], v[112:115], v[208:211], v[192:195]
    ds_read_b128 v[32:35], v24 offset:0
    v_mfma_f32_16x16x32_bf16 v[196:199], v[116:119], v[208:211], v[196:199]
    ds_read_b128 v[36:39], v25 offset:0
    v_mfma_f32_16x16x32_bf16 v[128:131], v[120:123], v[84:87], v[128:131]
    ds_read_b128 v[40:43], v24 offset:2048
    v_mfma_f32_16x16x32_bf16 v[132:135], v[124:127], v[84:87], v[132:135]
    ds_read_b128 v[44:47], v25 offset:2048
    v_mfma_f32_16x16x32_bf16 v[144:147], v[120:123], v[92:95], v[144:147]
    ds_read_b128 v[48:51], v24 offset:4096
    v_mfma_f32_16x16x32_bf16 v[148:151], v[124:127], v[92:95], v[148:151]
    ds_read_b128 v[52:55], v25 offset:4096
    v_mfma_f32_16x16x32_bf16 v[160:163], v[120:123], v[100:103], v[160:163]
    ds_read_b128 v[56:59], v24 offset:6144
    v_mfma_f32_16x16x32_bf16 v[164:167], v[124:127], v[100:103], v[164:167]
    ds_read_b128 v[60:63], v25 offset:6144
    v_mfma_f32_16x16x32_bf16 v[176:179], v[120:123], v[108:111], v[176:179]
    v_mfma_f32_16x16x32_bf16 v[180:183], v[124:127], v[108:111], v[180:183]
    v_mfma_f32_16x16x32_bf16 v[192:195], v[120:123], v[208:211], v[192:195]
    v_mfma_f32_16x16x32_bf16 v[196:199], v[124:127], v[208:211], v[196:199]
    s_waitcnt lgkmcnt(0)
    s_waitcnt vmcnt(8)
    s_barrier
    s_add_u32 m0, s21, 0
    s_nop 0
    buffer_load_dwordx4 v23, s[88:91], s16 offen lds
    s_add_u32 s16, s16, s62
    s_add_u32 m0, s21, 1024
    s_nop 0
    buffer_load_dwordx4 v23, s[88:91], s17 offen lds
    s_add_u32 s17, s17, s62
    s_cmp_ge_u32 s16, s92
    s_cselect_b32 s94, 2048, 0
    s_sub_u32 s16, s16, s94
    s_sub_u32 s17, s17, s94
    s_add_u32 m0, s22, 0
    s_nop 0
    buffer_load_dwordx4 v2, s[8:11], s18 offen lds
    s_add_u32 s18, s18, s20
    s_add_u32 m0, s22, 8192
    s_nop 0
    buffer_load_dwordx4 v2, s[12:15], s19 offen lds
    s_add_u32 s19, s19, s20
    s_cmp_ge_u32 s18, s95
    s_cselect_b32 s94, s93, 0
    s_sub_u32 s18, s18, s94
    s_sub_u32 s19, s19, s94
    v_mfma_f32_16x16x32_bf16 v[128:131], v[64:67], v[32:35], v[128:131]
    ds_read_b64_tr_b16 v[112:113], v8 offset:49152
    v_mfma_f32_16x16x32_bf16 v[132:135], v[68:71], v[32:35], v[132:135]
    ds_read_b64_tr_b16 v[114:115], v9 offset:49152
    v_mfma_f32_16x16x32_bf16 v[144:147], v[64:67], v[40:43], v[144:147]
    ds_read_b64_tr_b16 v[116:117], v10 offset:49152
    v_mfma_f32_16x16x32_bf16 v[148:151], v[68:71], v[40:43], v[148:151]
    ds_read_b64_tr_b16 v[118:119], v11 offset:49152
    v_mfma_f32_16x16x32_bf16 v[160:163], v[64:67], v[48:51], v[160:163]
    ds_read_b64_tr_b16 v[120:121], v8 offset:57344
    v_mfma_f32_16x16x32_bf16 v[164:167], v[68:71], v[48:51], v[164:167]
    ds_read_b64_tr_b16 v[122:123], v9 offset:57344
    v_mfma_f32_16x16x32_bf16 v[176:179], v[64:67], v[56:59], v[176:179]
    ds_read_b64_tr_b16 v[124:125], v10 offset:57344
    v_mfma_f32_16x16x32_bf16 v[180:183], v[68:71], v[56:59], v[180:183]
    ds_read_b64_tr_b16 v[126:127], v11 offset:57344
    v_mfma_f32_16x16x32_bf16 v[192:195], v[64:67], v[208:211], v[192:195]
    ds_read_b128 v[80:83], v24 offset:32768
    v_mfma_f32_16x16x32_bf16 v[196:199], v[68:71], v[208:211], v[196:199]
    ds_read_b128 v[84:87], v25 offset:32768
    v_mfma_f32_16x16x32_bf16 v[128:131], v[72:75], v[36:39], v[128:131]
    ds_read_b128 v[88:91], v24 offset:34816
    v_mfma_f32_16x16x32_bf16 v[132:135], v[76:79], v[36:39], v[132:135]
    ds_read_b128 v[92:95], v25 offset:34816
    v_mfma_f32_16x16x32_bf16 v[144:147], v[72:75], v[44:47], v[144:147]
    ds_read_b128 v[96:99], v24 offset:36864
    v_mfma_f32_16x16x32_bf16 v[148:151], v[76:79], v[44:47], v[148:151]
    ds_read_b128 v[100:103], v25 offset:36864
    v_mfma_f32_16x16x32_bf16 v[160:163], v[72:75], v[52:55], v[160:163]
    ds_read_b128 v[104:107], v24 offset:38912
    v_mfma_f32_16x16x32_bf16 v[164:167], v[76:79], v[52:55], v[164:167]
    ds_read_b128 v[108:111], v25 offset:38912
    v_mfma_f32_16x16x32_bf16 v[176:179], v[72:75], v[60:63], v[176:179]
    v_mfma_f32_16x16x32_bf16 v[180:183], v[76:79], v[60:63], v[180:183]
    v_mfma_f32_16x16x32_bf16 v[192:195], v[72:75], v[208:211], v[192:195]
    v_mfma_f32_16x16x32_bf16 v[196:199], v[76:79], v[208:211], v[196:199]
    s_waitcnt lgkmcnt(0)
    s_waitcnt vmcnt(8)
    s_barrier
    s_add_u32 m0, s21, 32768
    s_nop 0
    buffer_load_dwordx4 v23, s[88:91], s16 offen lds
    s_add_u32 s16, s16, s62
    s_add_u32 m0, s21, 33792
    s_nop 0
    buffer_load_dwordx4 v23, s[88:91], s17 offen lds
    s_add_u32 s17, s17, s62
    s_cmp_ge_u32 s16, s92
    s_cselect_b32 s94, 2048, 0
    s_sub_u32 s16, s16, s94
    s_sub_u32 s17, s17, s94
    s_add_u32 m0, s22, 32768
    s_nop 0
    buffer_load_dwordx4 v2, s[8:11], s18 offen lds
    s_add_u32 s18, s18, s20
    s_add_u32 m0, s22, 40960
    s_nop 0
    buffer_load_dwordx4 v2, s[12:15], s19 offen lds
    s_add_u32 s19, s19, s20
    s_cmp_ge_u32 s18, s95
    s_cselect_b32 s94, s93, 0
    s_sub_u32 s18, s18, s94
    s_sub_u32 s19, s19, s94
    v_mfma_f32_16x16x32_bf16 v[128:131], v[112:115], v[80:83], v[128:131]
    ds_read_b64_tr_b16 v[64:65], v12 offset:16384
    v_mfma_f32_16x16x32_bf16 v[132:135], v[116:119], v[80:83], v[132:135]
    ds_read_b64_tr_b16 v[66:67], v13 offset:16384
    v_mfma_f32_16x16x32_bf16 v[144:147], v[112:115], v[88:91], v[144:147]
    ds_read_b64_tr_b16 v[68:69], v14 offset:16384
    v_mfma_f32_16x16x32_bf16 v[148:151], v[116:119], v[88:91], v[148:151]
    ds_read_b64_tr_b16 v[70:71], v15 offset:16384
    v_mfma_f32_16x16x32_bf16 v[160:163], v[112:115], v[96:99], v[160:163]
    ds_read_b64_tr_b16 v[72:73], v12 offset:24576
    v_mfma_f32_16x16x32_bf16 v[164:167], v[116:119], v[96:99], v[164:167]
    ds_read_b64_tr_b16 v[74:75], v13 offset:24576
    v_mfma_f32_16x16x32_bf16 v[176:179], v[112:115], v[104:107], v[176:179]
    ds_read_b64_tr_b16 v[76:77], v14 offset:24576
    v_mfma_f32_16x16x32_bf16 v[180:183], v[116:119], v[104:107], v[180:183]
    ds_read_b64_tr_b16 v[78:79], v15 offset:24576
    v_mfma_f32_16x16x32_bf16 v[192:195], v[112:115], v[208:211], v[192:195]
    ds_read_b128 v[32:35], v26 offset:0
    v_mfma_f32_16x16x32_bf16 v[196:199], v[116:119], v[208:211], v[196:199]
    ds_read_b128 v[36:39], v27 offset:0
    v_mfma_f32_16x16x32_bf16 v[128:131], v[120:123], v[84:87], v[128:131]
    ds_read_b128 v[40:43], v26 offset:2048
    v_mfma_f32_16x16x32_bf16 v[132:135], v[124:127], v[84:87], v[132:135]
    ds_read_b128 v[44:47], v27 offset:2048
    v_mfma_f32_16x16x32_bf16 v[144:147], v[120:123], v[92:95], v[144:147]
    ds_read_b128 v[48:51], v26 offset:4096
    v_mfma_f32_16x16x32_bf16 v[148:151], v[124:127], v[92:95], v[148:151]
    ds_read_b128 v[52:55], v27 offset:4096
    v_mfma_f32_16x16x32_bf16 v[160:163], v[120:123], v[100:103], v[160:163]
    ds_read_b128 v[56:59], v26 offset:6144
    v_mfma_f32_16x16x32_bf16 v[164:167], v[124:127], v[100:103], v[164:167]
    ds_read_b128 v[60:63], v27 offset:6144
    v_mfma_f32_16x16x32_bf16 v[176:179], v[120:123], v[108:111], v[176:179]
    v_mfma_f32_16x16x32_bf16 v[180:183], v[124:127], v[108:111], v[180:183]
    v_mfma_f32_16x16x32_bf16 v[192:195], v[120:123], v[208:211], v[192:195]
    v_mfma_f32_16x16x32_bf16 v[196:199], v[124:127], v[208:211], v[196:199]
    s_waitcnt lgkmcnt(0)
    s_waitcnt vmcnt(8)
    s_barrier
    s_add_u32 m0, s21, 65536
    s_nop 0
    buffer_load_dwordx4 v23, s[88:91], s16 offen lds
    s_add_u32 s16, s16, s62
    s_add_u32 m0, s21, 66560
    s_nop 0
    buffer_load_dwordx4 v23, s[88:91], s17 offen lds
    s_add_u32 s17, s17, s62
    s_cmp_ge_u32 s16, s92
    s_cselect_b32 s94, 2048, 0
    s_sub_u32 s16, s16, s94
    s_sub_u32 s17, s17, s94
    s_add_u32 m0, s22, 65536
    s_nop 0
    buffer_load_dwordx4 v2, s[8:11], s18 offen lds
    s_add_u32 s18, s18, s20
    s_add_u32 m0, s22, 73728
    s_nop 0
    buffer_load_dwordx4 v2, s[12:15], s19 offen lds
    s_add_u32 s19, s19, s20
    s_cmp_ge_u32 s18, s95
    s_cselect_b32 s94, s93, 0
    s_sub_u32 s18, s18, s94
    s_sub_u32 s19, s19, s94
    v_mfma_f32_16x16x32_bf16 v[128:131], v[64:67], v[32:35], v[128:131]
    ds_read_b64_tr_b16 v[112:113], v12 offset:49152
    v_mfma_f32_16x16x32_bf16 v[132:135], v[68:71], v[32:35], v[132:135]
    ds_read_b64_tr_b16 v[114:115], v13 offset:49152
    v_mfma_f32_16x16x32_bf16 v[144:147], v[64:67], v[40:43], v[144:147]
    ds_read_b64_tr_b16 v[116:117], v14 offset:49152
    v_mfma_f32_16x16x32_bf16 v[148:151], v[68:71], v[40:43], v[148:151]
    ds_read_b64_tr_b16 v[118:119], v15 offset:49152
    v_mfma_f32_16x16x32_bf16 v[160:163], v[64:67], v[48:51], v[160:163]
    ds_read_b64_tr_b16 v[120:121], v12 offset:57344
    v_mfma_f32_16x16x32_bf16 v[164:167], v[68:71], v[48:51], v[164:167]
    ds_read_b64_tr_b16 v[122:123], v13 offset:57344
    v_mfma_f32_16x16x32_bf16 v[176:179], v[64:67], v[56:59], v[176:179]
    ds_read_b64_tr_b16 v[124:125], v14 offset:57344
    v_mfma_f32_16x16x32_bf16 v[180:183], v[68:71], v[56:59], v[180:183]
    ds_read_b64_tr_b16 v[126:127], v15 offset:57344
    v_mfma_f32_16x16x32_bf16 v[192:195], v[64:67], v[208:211], v[192:195]
    ds_read_b128 v[80:83], v26 offset:32768
    v_mfma_f32_16x16x32_bf16 v[196:199], v[68:71], v[208:211], v[196:199]
    ds_read_b128 v[84:87], v27 offset:32768
    v_mfma_f32_16x16x32_bf16 v[128:131], v[72:75], v[36:39], v[128:131]
    ds_read_b128 v[88:91], v26 offset:34816
    v_mfma_f32_16x16x32_bf16 v[132:135], v[76:79], v[36:39], v[132:135]
    ds_read_b128 v[92:95], v27 offset:34816
    v_mfma_f32_16x16x32_bf16 v[144:147], v[72:75], v[44:47], v[144:147]
    ds_read_b128 v[96:99], v26 offset:36864
    v_mfma_f32_16x16x32_bf16 v[148:151], v[76:79], v[44:47], v[148:151]
    ds_read_b128 v[100:103], v27 offset:36864
    v_mfma_f32_16x16x32_bf16 v[160:163], v[72:75], v[52:55], v[160:163]
    ds_read_b128 v[104:107], v26 offset:38912
    v_mfma_f32_16x16x32_bf16 v[164:167], v[76:79], v[52:55], v[164:167]
    ds_read_b128 v[108:111], v27 offset:38912
    v_mfma_f32_16x16x32_bf16 v[176:179], v[72:75], v[60:63], v[176:179]
    v_mfma_f32_16x16x32_bf16 v[180:183], v[76:79], v[60:63], v[180:183]
    v_mfma_f32_16x16x32_bf16 v[192:195], v[72:75], v[208:211], v[192:195]
    v_mfma_f32_16x16x32_bf16 v[196:199], v[76:79], v[208:211], v[196:199]
    s_waitcnt lgkmcnt(0)
    s_waitcnt vmcnt(8)
    s_barrier
    s_add_u32 m0, s21, 98304
    s_nop 0
    buffer_load_dwordx4 v23, s[88:91], s16 offen lds
    s_add_u32 s16, s16, s62
    s_add_u32 m0, s21, 99328
    s_nop 0
    buffer_load_dwordx4 v23, s[88:91], s17 offen lds
    s_add_u32 s17, s17, s62
    s_cmp_ge_u32 s16, s92
    s_cselect_b32 s94, 2048, 0
    s_sub_u32 s16, s16, s94
    s_sub_u32 s17, s17, s94
    s_add_u32 m0, s22, 98304
    s_nop 0
    buffer_load_dwordx4 v2, s[8:11], s18 offen lds
    s_add_u32 s18, s18, s20
    s_add_u32 m0, s22, 106496
    s_nop 0
    buffer_load_dwordx4 v2, s[12:15], s19 offen lds
    s_add_u32 s19, s19, s20
    s_cmp_ge_u32 s18, s95
    s_cselect_b32 s94, s93, 0
    s_sub_u32 s18, s18, s94
    s_sub_u32 s19, s19, s94
    v_mfma_f32_16x16x32_bf16 v[128:131], v[112:115], v[80:83], v[128:131]
    ds_read_b64_tr_b16 v[64:65], v8 offset:16384
    v_mfma_f32_16x16x32_bf16 v[132:135], v[116:119], v[80:83], v[132:135]
    ds_read_b64_tr_b16 v[66:67], v9 offset:16384
    v_mfma_f32_16x16x32_bf16 v[144:147], v[112:115], v[88:91], v[144:147]
    ds_read_b64_tr_b16 v[68:69], v10 offset:16384
    v_mfma_f32_16x16x32_bf16 v[148:151], v[116:119], v[88:91], v[148:151]
    ds_read_b64_tr_b16 v[70:71], v11 offset:16384
    v_mfma_f32_16x16x32_bf16 v[160:163], v[112:115], v[96:99], v[160:163]
    ds_read_b64_tr_b16 v[72:73], v8 offset:24576
    v_mfma_f32_16x16x32_bf16 v[164:167], v[116:119], v[96:99], v[164:167]
    ds_read_b64_tr_b16 v[74:75], v9 offset:24576
    v_mfma_f32_16x16x32_bf16 v[176:179], v[112:115], v[104:107], v[176:179]
    ds_read_b64_tr_b16 v[76:77], v10 offset:24576
    v_mfma_f32_16x16x32_bf16 v[180:183], v[116:119], v[104:107], v[180:183]
    ds_read_b64_tr_b16 v[78:79], v11 offset:24576
    v_mfma_f32_16x16x32_bf16 v[192:195], v[112:115], v[208:211], v[192:195]
    ds_read_b128 v[32:35], v24 offset:0
    v_mfma_f32_16x16x32_bf16 v[196:199], v[116:119], v[208:211], v[196:199]
    ds_read_b128 v[36:39], v25 offset:0
    v_mfma_f32_16x16x32_bf16 v[128:131], v[120:123], v[84:87], v[128:131]
    ds_read_b128 v[40:43], v24 offset:2048
    v_mfma_f32_16x16x32_bf16 v[132:135], v[124:127], v[84:87], v[132:135]
    ds_read_b128 v[44:47], v25 offset:2048
    v_mfma_f32_16x16x32_bf16 v[144:147], v[120:123], v[92:95], v[144:147]
    ds_read_b128 v[48:51], v24 offset:4096
    v_mfma_f32_16x16x32_bf16 v[148:151], v[124:127], v[92:95], v[148:151]
    ds_read_b128 v[52:55], v25 offset:4096
    v_mfma_f32_16x16x32_bf16 v[160:163], v[120:123], v[100:103], v[160:163]
    ds_read_b128 v[56:59], v24 offset:6144
    v_mfma_f32_16x16x32_bf16 v[164:167], v[124:127], v[100:103], v[164:167]
    ds_read_b128 v[60:63], v25 offset:6144
    v_mfma_f32_16x16x32_bf16 v[176:179], v[120:123], v[108:111], v[176:179]
    v_mfma_f32_16x16x32_bf16 v[180:183], v[124:127], v[108:111], v[180:183]
    v_mfma_f32_16x16x32_bf16 v[192:195], v[120:123], v[208:211], v[192:195]
    v_mfma_f32_16x16x32_bf16 v[196:199], v[124:127], v[208:211], v[196:199]
    s_waitcnt lgkmcnt(0)
    s_waitcnt vmcnt(8)
    s_barrier
    v_mfma_f32_16x16x32_bf16 v[128:131], v[64:67], v[32:35], v[128:131]
    ds_read_b64_tr_b16 v[112:113], v8 offset:49152
    v_mfma_f32_16x16x32_bf16 v[132:135], v[68:71], v[32:35], v[132:135]
    ds_read_b64_tr_b16 v[114:115], v9 offset:49152
    v_mfma_f32_16x16x32_bf16 v[144:147], v[64:67], v[40:43], v[144:147]
    ds_read_b64_tr_b16 v[116:117], v10 offset:49152
    v_mfma_f32_16x16x32_bf16 v[148:151], v[68:71], v[40:43], v[148:151]
    ds_read_b64_tr_b16 v[118:119], v11 offset:49152
    v_mfma_f32_16x16x32_bf16 v[160:163], v[64:67], v[48:51], v[160:163]
    ds_read_b64_tr_b16 v[120:121], v8 offset:57344
    v_mfma_f32_16x16x32_bf16 v[164:167], v[68:71], v[48:51], v[164:167]
    ds_read_b64_tr_b16 v[122:123], v9 offset:57344
    v_mfma_f32_16x16x32_bf16 v[176:179], v[64:67], v[56:59], v[176:179]
    ds_read_b64_tr_b16 v[124:125], v10 offset:57344
    v_mfma_f32_16x16x32_bf16 v[180:183], v[68:71], v[56:59], v[180:183]
    ds_read_b64_tr_b16 v[126:127], v11 offset:57344
    v_mfma_f32_16x16x32_bf16 v[192:195], v[64:67], v[208:211], v[192:195]
    ds_read_b128 v[80:83], v24 offset:32768
    v_mfma_f32_16x16x32_bf16 v[196:199], v[68:71], v[208:211], v[196:199]
    ds_read_b128 v[84:87], v25 offset:32768
    v_mfma_f32_16x16x32_bf16 v[128:131], v[72:75], v[36:39], v[128:131]
    ds_read_b128 v[88:91], v24 offset:34816
    v_mfma_f32_16x16x32_bf16 v[132:135], v[76:79], v[36:39], v[132:135]
    ds_read_b128 v[92:95], v25 offset:34816
    v_mfma_f32_16x16x32_bf16 v[144:147], v[72:75], v[44:47], v[144:147]
    ds_read_b128 v[96:99], v24 offset:36864
    v_mfma_f32_16x16x32_bf16 v[148:151], v[76:79], v[44:47], v[148:151]
    ds_read_b128 v[100:103], v25 offset:36864
    v_mfma_f32_16x16x32_bf16 v[160:163], v[72:75], v[52:55], v[160:163]
    ds_read_b128 v[104:107], v24 offset:38912
    v_mfma_f32_16x16x32_bf16 v[164:167], v[76:79], v[52:55], v[164:167]
    ds_read_b128 v[108:111], v25 offset:38912
    v_mfma_f32_16x16x32_bf16 v[176:179], v[72:75], v[60:63], v[176:179]
    v_mfma_f32_16x16x32_bf16 v[180:183], v[76:79], v[60:63], v[180:183]
    v_mfma_f32_16x16x32_bf16 v[192:195], v[72:75], v[208:211], v[192:195]
    v_mfma_f32_16x16x32_bf16 v[196:199], v[76:79], v[208:211], v[196:199]
    s_waitcnt lgkmcnt(0)
    s_waitcnt vmcnt(4)
    s_barrier
    v_mfma_f32_16x16x32_bf16 v[128:131], v[112:115], v[80:83], v[128:131]
    ds_read_b64_tr_b16 v[64:65], v12 offset:16384
    v_mfma_f32_16x16x32_bf16 v[132:135], v[116:119], v[80:83], v[132:135]
    ds_read_b64_tr_b16 v[66:67], v13 offset:16384
    v_mfma_f32_16x16x32_bf16 v[144:147], v[112:115], v[88:91], v[144:147]
    ds_read_b64_tr_b16 v[68:69], v14 offset:16384
    v_mfma_f32_16x16x32_bf16 v[148:151], v[116:119], v[88:91], v[148:151]
    ds_read_b64_tr_b16 v[70:71], v15 offset:16384
    v_mfma_f32_16x16x32_bf16 v[160:163], v[112:115], v[96:99], v[160:163]
    ds_read_b64_tr_b16 v[72:73], v12 offset:24576
    v_mfma_f32_16x16x32_bf16 v[164:167], v[116:119], v[96:99], v[164:167]
    ds_read_b64_tr_b16 v[74:75], v13 offset:24576
    v_mfma_f32_16x16x32_bf16 v[176:179], v[112:115], v[104:107], v[176:179]
    ds_read_b64_tr_b16 v[76:77], v14 offset:24576
    v_mfma_f32_16x16x32_bf16 v[180:183], v[116:119], v[104:107], v[180:183]
    ds_read_b64_tr_b16 v[78:79], v15 offset:24576
    v_mfma_f32_16x16x32_bf16 v[192:195], v[112:115], v[208:211], v[192:195]
    ds_read_b128 v[32:35], v26 offset:0
    v_mfma_f32_16x16x32_bf16 v[196:199], v[116:119], v[208:211], v[196:199]
    ds_read_b128 v[36:39], v27 offset:0
    v_mfma_f32_16x16x32_bf16 v[128:131], v[120:123], v[84:87], v[128:131]
    ds_read_b128 v[40:43], v26 offset:2048
    v_mfma_f32_16x16x32_bf16 v[132:135], v[124:127], v[84:87], v[132:135]
    ds_read_b128 v[44:47], v27 offset:2048
    v_mfma_f32_16x16x32_bf16 v[144:147], v[120:123], v[92:95], v[144:147]
    ds_read_b128 v[48:51], v26 offset:4096
    v_mfma_f32_16x16x32_bf16 v[148:151], v[124:127], v[92:95], v[148:151]
    ds_read_b128 v[52:55], v27 offset:4096
    v_mfma_f32_16x16x32_bf16 v[160:163], v[120:123], v[100:103], v[160:163]
    ds_read_b128 v[56:59], v26 offset:6144
    v_mfma_f32_16x16x32_bf16 v[164:167], v[124:127], v[100:103], v[164:167]
    ds_read_b128 v[60:63], v27 offset:6144
    v_mfma_f32_16x16x32_bf16 v[176:179], v[120:123], v[108:111], v[176:179]
    v_mfma_f32_16x16x32_bf16 v[180:183], v[124:127], v[108:111], v[180:183]
    v_mfma_f32_16x16x32_bf16 v[192:195], v[120:123], v[208:211], v[192:195]
    v_mfma_f32_16x16x32_bf16 v[196:199], v[124:127], v[208:211], v[196:199]
    s_waitcnt lgkmcnt(0)
    s_waitcnt vmcnt(0)
    s_barrier
    v_mfma_f32_16x16x32_bf16 v[128:131], v[64:67], v[32:35], v[128:131]
    ds_read_b64_tr_b16 v[112:113], v12 offset:49152
    v_mfma_f32_16x16x32_bf16 v[132:135], v[68:71], v[32:35], v[132:135]
    ds_read_b64_tr_b16 v[114:115], v13 offset:49152
    v_mfma_f32_16x16x32_bf16 v[144:147], v[64:67], v[40:43], v[144:147]
    ds_read_b64_tr_b16 v[116:117], v14 offset:49152
    v_mfma_f32_16x16x32_bf16 v[148:151], v[68:71], v[40:43], v[148:151]
    ds_read_b64_tr_b16 v[118:119], v15 offset:49152
    v_mfma_f32_16x16x32_bf16 v[160:163], v[64:67], v[48:51], v[160:163]
    ds_read_b64_tr_b16 v[120:121], v12 offset:57344
    v_mfma_f32_16x16x32_bf16 v[164:167], v[68:71], v[48:51], v[164:167]
    ds_read_b64_tr_b16 v[122:123], v13 offset:57344
    v_mfma_f32_16x16x32_bf16 v[176:179], v[64:67], v[56:59], v[176:179]
    ds_read_b64_tr_b16 v[124:125], v14 offset:57344
    v_mfma_f32_16x16x32_bf16 v[180:183], v[68:71], v[56:59], v[180:183]
    ds_read_b64_tr_b16 v[126:127], v15 offset:57344
    v_mfma_f32_16x16x32_bf16 v[192:195], v[64:67], v[208:211], v[192:195]
    ds_read_b128 v[80:83], v26 offset:32768
    v_mfma_f32_16x16x32_bf16 v[196:199], v[68:71], v[208:211], v[196:199]
    ds_read_b128 v[84:87], v27 offset:32768
    v_mfma_f32_16x16x32_bf16 v[128:131], v[72:75], v[36:39], v[128:131]
    ds_read_b128 v[88:91], v26 offset:34816
    v_mfma_f32_16x16x32_bf16 v[132:135], v[76:79], v[36:39], v[132:135]
    ds_read_b128 v[92:95], v27 offset:34816
    v_mfma_f32_16x16x32_bf16 v[144:147], v[72:75], v[44:47], v[144:147]
    ds_read_b128 v[96:99], v26 offset:36864
    v_mfma_f32_16x16x32_bf16 v[148:151], v[76:79], v[44:47], v[148:151]
    ds_read_b128 v[100:103], v27 offset:36864
    v_mfma_f32_16x16x32_bf16 v[160:163], v[72:75], v[52:55], v[160:163]
    ds_read_b128 v[104:107], v26 offset:38912
    v_mfma_f32_16x16x32_bf16 v[164:167], v[76:79], v[52:55], v[164:167]
    ds_read_b128 v[108:111], v27 offset:38912
    v_mfma_f32_16x16x32_bf16 v[176:179], v[72:75], v[60:63], v[176:179]
    v_mfma_f32_16x16x32_bf16 v[180:183], v[76:79], v[60:63], v[180:183]
    v_mfma_f32_16x16x32_bf16 v[192:195], v[72:75], v[208:211], v[192:195]
    v_mfma_f32_16x16x32_bf16 v[196:199], v[76:79], v[208:211], v[196:199]
    s_waitcnt lgkmcnt(0)
    s_waitcnt vmcnt(0)
    s_barrier
    v_mfma_f32_16x16x32_bf16 v[128:131], v[112:115], v[80:83], v[128:131]
    ds_read_b64_tr_b16 v[64:65], v8 offset:16384
    v_mfma_f32_16x16x32_bf16 v[132:135], v[116:119], v[80:83], v[132:135]
    ds_read_b64_tr_b16 v[66:67], v9 offset:16384
    v_mfma_f32_16x16x32_bf16 v[144:147], v[112:115], v[88:91], v[144:147]
    ds_read_b64_tr_b16 v[68:69], v10 offset:16384
    v_mfma_f32_16x16x32_bf16 v[148:151], v[116:119], v[88:91], v[148:151]
    ds_read_b64_tr_b16 v[70:71], v11 offset:16384
    v_mfma_f32_16x16x32_bf16 v[160:163], v[112:115], v[96:99], v[160:163]
    ds_read_b64_tr_b16 v[72:73], v8 offset:24576
    v_mfma_f32_16x16x32_bf16 v[164:167], v[116:119], v[96:99], v[164:167]
    ds_read_b64_tr_b16 v[74:75], v9 offset:24576
    v_mfma_f32_16x16x32_bf16 v[176:179], v[112:115], v[104:107], v[176:179]
    ds_read_b64_tr_b16 v[76:77], v10 offset:24576
    v_mfma_f32_16x16x32_bf16 v[180:183], v[116:119], v[104:107], v[180:183]
    ds_read_b64_tr_b16 v[78:79], v11 offset:24576
    v_mfma_f32_16x16x32_bf16 v[192:195], v[112:115], v[208:211], v[192:195]
    ds_read_b128 v[32:35], v24 offset:0
    v_mfma_f32_16x16x32_bf16 v[196:199], v[116:119], v[208:211], v[196:199]
    ds_read_b128 v[36:39], v25 offset:0
    v_mfma_f32_16x16x32_bf16 v[128:131], v[120:123], v[84:87], v[128:131]
    ds_read_b128 v[40:43], v24 offset:2048
    v_mfma_f32_16x16x32_bf16 v[132:135], v[124:127], v[84:87], v[132:135]
    ds_read_b128 v[44:47], v25 offset:2048
    v_mfma_f32_16x16x32_bf16 v[144:147], v[120:123], v[92:95], v[144:147]
    ds_read_b128 v[48:51], v24 offset:4096
    v_mfma_f32_16x16x32_bf16 v[148:151], v[124:127], v[92:95], v[148:151]
    ds_read_b128 v[52:55], v25 offset:4096
    v_mfma_f32_16x16x32_bf16 v[160:163], v[120:123], v[100:103], v[160:163]
    ds_read_b128 v[56:59], v24 offset:6144
    v_mfma_f32_16x16x32_bf16 v[164:167], v[124:127], v[100:103], v[164:167]
    ds_read_b128 v[60:63], v25 offset:6144
    v_mfma_f32_16x16x32_bf16 v[176:179], v[120:123], v[108:111], v[176:179]
    v_mfma_f32_16x16x32_bf16 v[180:183], v[124:127], v[108:111], v[180:183]
    v_mfma_f32_16x16x32_bf16 v[192:195], v[120:123], v[208:211], v[192:195]
    v_mfma_f32_16x16x32_bf16 v[196:199], v[124:127], v[208:211], v[196:199]
    s_waitcnt lgkmcnt(0)
    v_and_b32 v20, 0xf0, v1
    v_lshrrev_b32 v20, 1, v20
    s_lshl_b32 s30, s26, 9
    s_add_u32 s30, s30, 188743680
    s_mov_b32 s31, 0x40000
    v_and_b32 v21, 1, v4
    v_lshlrev_b32 v21, 10, v21
    v_xor_b32 v8, v21, v8
    v_xor_b32 v9, v21, v9
    v_xor_b32 v10, v21, v10
    v_xor_b32 v11, v21, v11
    v_xor_b32 v12, v21, v12
    v_xor_b32 v13, v21, v13
    v_xor_b32 v14, v21, v14
    v_xor_b32 v15, v21, v15
w_stX:
    buffer_load_dword v22, off, s[64:67], 0 offset:192 sc1
    buffer_load_dwordx2 v[24:25], v20, s[4:7], s30 offen offset:0 sc1
    buffer_load_dwordx2 v[26:27], v20, s[4:7], s30 offen offset:128 sc1
    buffer_load_dwordx2 v[28:29], v20, s[4:7], s30 offen offset:256 sc1
    buffer_load_dwordx2 v[30:31], v20, s[4:7], s30 offen offset:384 sc1
    s_waitcnt vmcnt(0)
    v_readfirstlane_b32 s29, v22
    s_cmp_ge_u32 s29, 32
    s_cbranch_scc1 w_stXok
    s_sleep 4
    s_sub_u32 s31, s31, 1
    s_cbranch_scc0 w_stX
w_stXok:
    buffer_load_dword v22, off, s[64:67], 0 sc1
    v_fma_f32 v128, -v24, v192, v128
    v_fma_f32 v129, -v24, v193, v129
    v_fma_f32 v130, -v24, v194, v130
    v_fma_f32 v131, -v24, v195, v131
    v_fma_f32 v132, -v24, v196, v132
    v_fma_f32 v133, -v24, v197, v133
    v_fma_f32 v134, -v24, v198, v134
    v_fma_f32 v135, -v24, v199, v135
    v_mul_f32 v128, v128, v25
    v_mul_f32 v129, v129, v25
    v_mul_f32 v130, v130, v25
    v_mul_f32 v131, v131, v25
    v_mul_f32 v132, v132, v25
    v_mul_f32 v133, v133, v25
    v_mul_f32 v134, v134, v25
    v_mul_f32 v135, v135, v25
    v_fma_f32 v144, -v26, v192, v144
    v_fma_f32 v145, -v26, v193, v145
    v_fma_f32 v146, -v26, v194, v146
    v_fma_f32 v147, -v26, v195, v147
    v_fma_f32 v148, -v26, v196, v148
    v_fma_f32 v149, -v26, v197, v149
    v_fma_f32 v150, -v26, v198, v150
    v_fma_f32 v151, -v26, v199, v151
    v_mul_f32 v144, v144, v27
    v_mul_f32 v145, v145, v27
    v_mul_f32 v146, v146, v27
    v_mul_f32 v147, v147, v27
    v_mul_f32 v148, v148, v27
    v_mul_f32 v149, v149, v27
    v_mul_f32 v150, v150, v27
    v_mul_f32 v151, v151, v27
    v_fma_f32 v160, -v28, v192, v160
    v_fma_f32 v161, -v28, v193, v161
    v_fma_f32 v162, -v28, v194, v162
    v_fma_f32 v163, -v28, v195, v163
    v_fma_f32 v164, -v28, v196, v164
    v_fma_f32 v165, -v28, v197, v165
    v_fma_f32 v166, -v28, v198, v166
    v_fma_f32 v167, -v28, v199, v167
    v_mul_f32 v160, v160, v29
    v_mul_f32 v161, v161, v29
    v_mul_f32 v162, v162, v29
    v_mul_f32 v163, v163, v29
    v_mul_f32 v164, v164, v29
    v_mul_f32 v165, v165, v29
    v_mul_f32 v166, v166, v29
    v_mul_f32 v167, v167, v29
    v_fma_f32 v176, -v30, v192, v176
    v_fma_f32 v177, -v30, v193, v177
    v_fma_f32 v178, -v30, v194, v178
    v_fma_f32 v179, -v30, v195, v179
    v_fma_f32 v180, -v30, v196, v180
    v_fma_f32 v181, -v30, v197, v181
    v_fma_f32 v182, -v30, v198, v182
    v_fma_f32 v183, -v30, v199, v183
    v_mul_f32 v176, v176, v31
    v_mul_f32 v177, v177, v31
    v_mul_f32 v178, v178, v31
    v_mul_f32 v179, v179, v31
    v_mul_f32 v180, v180, v31
    v_mul_f32 v181, v181, v31
    v_mul_f32 v182, v182, v31
    v_mul_f32 v183, v183, v31
    s_lshl_b32 s30, s27, 10
    s_add_u32 s30, s30, s49
    s_nop 7
    v_cvt_pk_bf16_f32 v80, v128, v129
    v_cvt_pk_bf16_f32 v81, v130, v131
    v_cvt_pk_bf16_f32 v82, v132, v133
    v_cvt_pk_bf16_f32 v83, v134, v135
    buffer_store_dwordx4 v[80:83], v1, s[4:7], s30 offen sc1
    s_add_u32 s30, s30, s50
    v_cvt_pk_bf16_f32 v84, v144, v145
    v_cvt_pk_bf16_f32 v85, v146, v147
    v_cvt_pk_bf16_f32 v86, v148, v149
    v_cvt_pk_bf16_f32 v87, v150, v151
    buffer_store_dwordx4 v[84:87], v1, s[4:7], s30 offen sc1
    s_add_u32 s30, s30, s50
    v_cvt_pk_bf16_f32 v88, v160, v161
    v_cvt_pk_bf16_f32 v89, v162, v163
    v_cvt_pk_bf16_f32 v90, v164, v165
    v_cvt_pk_bf16_f32 v91, v166, v167
    buffer_store_dwordx4 v[88:91], v1, s[4:7], s30 offen sc1
    s_add_u32 s30, s30, s50
    v_cvt_pk_bf16_f32 v92, v176, v177
    v_cvt_pk_bf16_f32 v93, v178, v179
    v_cvt_pk_bf16_f32 v94, v180, v181
    v_cvt_pk_bf16_f32 v95, v182, v183
    buffer_store_dwordx4 v[92:95], v1, s[4:7], s30 offen sc1
    s_add_u32 s30, s30, s50
    s_mov_b32 s28, s51
    s_mov_b32 s57, s53
    s_branch w_drain
w_firstM:
    s_waitcnt vmcnt(6)
    s_barrier
    s_add_u32 m0, s21, 0
    s_nop 0
    buffer_load_dwordx4 v1, s[4:7], s16 offen sc1 lds
    s_add_u32 s16, s16, s62
    s_add_u32 m0, s22, 0
    s_nop 0
    buffer_load_dwordx4 v2, s[8:11], s18 offen lds
    s_add_u32 s18, s18, s20
    s_add_u32 m0, s22, 8192
    s_nop 0
    buffer_load_dwordx4 v2, s[12:15], s19 offen lds
    s_add_u32 s19, s19, s20
    v_mfma_f32_16x16x32_bf16 v[128:131], v[64:67], v[32:35], 0
    ds_read_b64_tr_b16 v[112:113], v8 offset:49152
    v_mfma_f32_16x16x32_bf16 v[132:135], v[68:71], v[32:35], 0
    ds_read_b64_tr_b16 v[114:115], v9 offset:49152
    v_mfma_f32_16x16x32_bf16 v[136:139], v[72:75], v[32:35], 0
    ds_read_b64_tr_b16 v[116:117], v10 offset:49152
    v_mfma_f32_16x16x32_bf16 v[140:143], v[76:79], v[32:35], 0
    ds_read_b64_tr_b16 v[118:119], v11 offset:49152
    v_mfma_f32_16x16x32_bf16 v[144:147], v[64:67], v[40:43], 0
    ds_read_b64_tr_b16 v[120:121], v8 offset:57344
    v_mfma_f32_16x16x32_bf16 v[148:151], v[68:71], v[40:43], 0
    ds_read_b64_tr_b16 v[122:123], v9 offset:57344
    v_mfma_f32_16x16x32_bf16 v[152:155], v[72:75], v[40:43], 0
    ds_read_b64_tr_b16 v[124:125], v10 offset:57344
    v_mfma_f32_16x16x32_bf16 v[156:159], v[76:79], v[40:43], 0
    ds_read_b64_tr_b16 v[126:127], v11 offset:57344
    v_mfma_f32_16x16x32_bf16 v[160:163], v[64:67], v[48:51], 0
    ds_read_b128 v[80:83], v5 offset:32768
    v_mfma_f32_16x16x32_bf16 v[164:167], v[68:71], v[48:51], 0
    ds_read_b128 v[88:91], v5 offset:34816
    v_mfma_f32_16x16x32_bf16 v[168:171], v[72:75], v[48:51], 0
    ds_read_b128 v[96:99], v5 offset:36864
    v_mfma_f32_16x16x32_bf16 v[172:175], v[76:79], v[48:51], 0
    ds_read_b128 v[104:107], v5 offset:38912
    v_mfma_f32_16x16x32_bf16 v[176:179], v[64:67], v[56:59], 0
    v_mfma_f32_16x16x32_bf16 v[180:183], v[68:71], v[56:59], 0
    v_mfma_f32_16x16x32_bf16 v[184:187], v[72:75], v[56:59], 0
    v_mfma_f32_16x16x32_bf16 v[188:191], v[76:79], v[56:59], 0
    s_waitcnt lgkmcnt(0)
    s_waitcnt vmcnt(6)
    s_barrier
    s_add_u32 m0, s21, 32768
    s_nop 0
    buffer_load_dwordx4 v1, s[4:7], s16 offen sc1 lds
    s_add_u32 s16, s16, s62
    s_add_u32 m0, s22, 32768
    s_nop 0
    buffer_load_dwordx4 v2, s[8:11], s18 offen lds
    s_add_u32 s18, s18, s20
    s_add_u32 m0, s22, 40960
    s_nop 0
    buffer_load_dwordx4 v2, s[12:15], s19 offen lds
    s_add_u32 s19, s19, s20
    v_mfma_f32_16x16x32_bf16 v[128:131], v[112:115], v[80:83], v[128:131]
    ds_read_b64_tr_b16 v[64:65], v12 offset:16384
    v_mfma_f32_16x16x32_bf16 v[132:135], v[116:119], v[80:83], v[132:135]
    ds_read_b64_tr_b16 v[66:67], v13 offset:16384
    v_mfma_f32_16x16x32_bf16 v[136:139], v[120:123], v[80:83], v[136:139]
    ds_read_b64_tr_b16 v[68:69], v14 offset:16384
    v_mfma_f32_16x16x32_bf16 v[140:143], v[124:127], v[80:83], v[140:143]
    ds_read_b64_tr_b16 v[70:71], v15 offset:16384
    v_mfma_f32_16x16x32_bf16 v[144:147], v[112:115], v[88:91], v[144:147]
    ds_read_b64_tr_b16 v[72:73], v12 offset:24576
    v_mfma_f32_16x16x32_bf16 v[148:151], v[116:119], v[88:91], v[148:151]
    ds_read_b64_tr_b16 v[74:75], v13 offset:24576
    v_mfma_f32_16x16x32_bf16 v[152:155], v[120:123], v[88:91], v[152:155]
    ds_read_b64_tr_b16 v[76:77], v14 offset:24576
    v_mfma_f32_16x16x32_bf16 v[156:159], v[124:127], v[88:91], v[156:159]
    ds_read_b64_tr_b16 v[78:79], v15 offset:24576
    v_mfma_f32_16x16x32_bf16 v[160:163], v[112:115], v[96:99], v[160:163]
    ds_read_b128 v[32:35], v6 offset:0
    v_mfma_f32_16x16x32_bf16 v[164:167], v[116:119], v[96:99], v[164:167]
    ds_read_b128 v[40:43], v6 offset:2048
    v_mfma_f32_16x16x32_bf16 v[168:171], v[120:123], v[96:99], v[168:171]
    ds_read_b128 v[48:51], v6 offset:4096
    v_mfma_f32_16x16x32_bf16 v[172:175], v[124:127], v[96:99], v[172:175]
    ds_read_b128 v[56:59], v6 offset:6144
    v_mfma_f32_16x16x32_bf16 v[176:179], v[112:115], v[104:107], v[176:179]
    v_mfma_f32_16x16x32_bf16 v[180:183], v[116:119], v[104:107], v[180:183]
    v_mfma_f32_16x16x32_bf16 v[184:187], v[120:123], v[104:107], v[184:187]
    v_mfma_f32_16x16x32_bf16 v[188:191], v[124:127], v[104:107], v[188:191]
    s_waitcnt lgkmcnt(0)
    s_waitcnt vmcnt(6)
    s_barrier
    s_add_u32 m0, s21, 65536
    s_nop 0
    buffer_load_dwordx4 v1, s[4:7], s16 offen sc1 lds
    s_add_u32 s16, s16, s62
    s_add_u32 m0, s22, 65536
    s_nop 0
    buffer_load_dwordx4 v2, s[8:11], s18 offen lds
    s_add_u32 s18, s18, s20
    s_add_u32 m0, s22, 73728
    s_nop 0
    buffer_load_dwordx4 v2, s[12:15], s19 offen lds
    s_add_u32 s19, s19, s20
    v_mfma_f32_16x16x32_bf16 v[128:131], v[64:67], v[32:35], v[128:131]
    ds_read_b64_tr_b16 v[112:113], v12 offset:49152
    v_mfma_f32_16x16x32_bf16 v[132:135], v[68:71], v[32:35], v[132:135]
    ds_read_b64_tr_b16 v[114:115], v13 offset:49152
    v_mfma_f32_16x16x32_bf16 v[136:139], v[72:75], v[32:35], v[136:139]
    ds_read_b64_tr_b16 v[116:117], v14 offset:49152
    v_mfma_f32_16x16x32_bf16 v[140:143], v[76:79], v[32:35], v[140:143]
    ds_read_b64_tr_b16 v[118:119], v15 offset:49152
    v_mfma_f32_16x16x32_bf16 v[144:147], v[64:67], v[40:43], v[144:147]
    ds_read_b64_tr_b16 v[120:121], v12 offset:57344
    v_mfma_f32_16x16x32_bf16 v[148:151], v[68:71], v[40:43], v[148:151]
    ds_read_b64_tr_b16 v[122:123], v13 offset:57344
    v_mfma_f32_16x16x32_bf16 v[152:155], v[72:75], v[40:43], v[152:155]
    ds_read_b64_tr_b16 v[124:125], v14 offset:57344
    v_mfma_f32_16x16x32_bf16 v[156:159], v[76:79], v[40:43], v[156:159]
    ds_read_b64_tr_b16 v[126:127], v15 offset:57344
    v_mfma_f32_16x16x32_bf16 v[160:163], v[64:67], v[48:51], v[160:163]
    ds_read_b128 v[80:83], v6 offset:32768
    v_mfma_f32_16x16x32_bf16 v[164:167], v[68:71], v[48:51], v[164:167]
    ds_read_b128 v[88:91], v6 offset:34816
    v_mfma_f32_16x16x32_bf16 v[168:171], v[72:75], v[48:51], v[168:171]
    ds_read_b128 v[96:99], v6 offset:36864
    v_mfma_f32_16x16x32_bf16 v[172:175], v[76:79], v[48:51], v[172:175]
    ds_read_b128 v[104:107], v6 offset:38912
    v_mfma_f32_16x16x32_bf16 v[176:179], v[64:67], v[56:59], v[176:179]
    v_mfma_f32_16x16x32_bf16 v[180:183], v[68:71], v[56:59], v[180:183]
    v_mfma_f32_16x16x32_bf16 v[184:187], v[72:75], v[56:59], v[184:187]
    v_mfma_f32_16x16x32_bf16 v[188:191], v[76:79], v[56:59], v[188:191]
    s_waitcnt lgkmcnt(0)
    s_waitcnt vmcnt(6)
    s_barrier
    s_add_u32 m0, s21, 98304
    s_nop 0
    buffer_load_dwordx4 v1, s[4:7], s16 offen sc1 lds
    s_add_u32 s16, s16, s62
    s_add_u32 m0, s22, 98304
    s_nop 0
    buffer_load_dwordx4 v2, s[8:11], s18 offen lds
    s_add_u32 s18, s18, s20
    s_add_u32 m0, s22, 106496
    s_nop 0
    buffer_load_dwordx4 v2, s[12:15], s19 offen lds
    s_add_u32 s19, s19, s20
    v_mfma_f32_16x16x32_bf16 v[128:131], v[112:115], v[80:83], v[128:131]
    ds_read_b64_tr_b16 v[64:65], v8 offset:16384
    v_mfma_f32_16x16x32_bf16 v[132:135], v[116:119], v[80:83], v[132:135]
    ds_read_b64_tr_b16 v[66:67], v9 offset:16384
    v_mfma_f32_16x16x32_bf16 v[136:139], v[120:123], v[80:83], v[136:139]
    ds_read_b64_tr_b16 v[68:69], v10 offset:16384
    v_mfma_f32_16x16x32_bf16 v[140:143], v[124:127], v[80:83], v[140:143]
    ds_read_b64_tr_b16 v[70:71], v11 offset:16384
    v_mfma_f32_16x16x32_bf16 v[144:147], v[112:115], v[88:91], v[144:147]
    ds_read_b64_tr_b16 v[72:73], v8 offset:24576
    v_mfma_f32_16x16x32_bf16 v[148:151], v[116:119], v[88:91], v[148:151]
    ds_read_b64_tr_b16 v[74:75], v9 offset:24576
    v_mfma_f32_16x16x32_bf16 v[152:155], v[120:123], v[88:91], v[152:155]
    ds_read_b64_tr_b16 v[76:77], v10 offset:24576
    v_mfma_f32_16x16x32_bf16 v[156:159], v[124:127], v[88:91], v[156:159]
    ds_read_b64_tr_b16 v[78:79], v11 offset:24576
    v_mfma_f32_16x16x32_bf16 v[160:163], v[112:115], v[96:99], v[160:163]
    ds_read_b128 v[32:35], v5 offset:0
    v_mfma_f32_16x16x32_bf16 v[164:167], v[116:119], v[96:99], v[164:167]
    ds_read_b128 v[40:43], v5 offset:2048
    v_mfma_f32_16x16x32_bf16 v[168:171], v[120:123], v[96:99], v[168:171]
    ds_read_b128 v[48:51], v5 offset:4096
    v_mfma_f32_16x16x32_bf16 v[172:175], v[124:127], v[96:99], v[172:175]
    ds_read_b128 v[56:59], v5 offset:6144
    v_mfma_f32_16x16x32_bf16 v[176:179], v[112:115], v[104:107], v[176:179]
    v_mfma_f32_16x16x32_bf16 v[180:183], v[116:119], v[104:107], v[180:183]
    v_mfma_f32_16x16x32_bf16 v[184:187], v[120:123], v[104:107], v[184:187]
    v_mfma_f32_16x16x32_bf16 v[188:191], v[124:127], v[104:107], v[188:191]
    s_waitcnt lgkmcnt(0)
w_loop_chkM:
    s_sub_u32 s23, s23, 1
w_loopM:
    s_cmp_lg_u32 s23, 1
    s_cbranch_scc1 w_bodyM
    v_readfirstlane_b32 s68, v22
    s_cmp_ge_u32 s68, 128
    s_cselect_b32 s70, 0, s70
    v_readfirstlane_b32 s30, v16
    s_cmp_ge_u32 s30, s45
    s_cselect_b32 s30, 0, 1
    s_or_b32 s30, s30, s70
    s_cmp_ge_u32 s32, 4
    s_cselect_b32 s30, 1, s30
    s_cmp_eq_u32 s32, 0
    s_cselect_b32 s30, 1, s30
    v_mov_b32 v20, s30
    ds_write_b32 v7, v20
    s_cbranch_scc1 w_bodyM
    s_load_dwordx2 s[8:9], s[0:1], s33
    s_load_dwordx2 s[12:13], s[0:1], s34
    s_mov_b32 s10, s38
    s_mov_b32 s14, s38
    s_cmp_ge_u32 s32, 4
    s_cselect_b32 s31, 0, 1
    s_lshl_b32 s30, s3, s31
    s_mul_i32 s30, s30, s40
    s_add_u32 s16, s39, s30
    s_cmp_eq_u32 s32, 4
    s_cselect_b32 s30, 1024, s40
    s_cselect_b32 s31, 6, 5
    s_lshl_b32 s62, 32, s31
    s_add_u32 s17, s16, s30
    s_lshl_b32 s30, s3, 2
    s_mul_i32 s30, s30, s35
    s_add_u32 s18, s36, s30
    s_add_u32 s19, s37, s30
    s_lshl_b32 s20, s35, s31
    v_mul_u32_u24 v2, s35, v4
    v_add_u32 v2, v2, v3
    s_waitcnt lgkmcnt(0)
    s_waitcnt vmcnt(6)
    s_barrier
    s_add_u32 m0, s21, 0
    s_nop 0
    buffer_load_dwordx4 v1, s[4:7], s16 offen sc1 lds
    s_add_u32 s16, s16, s62
    s_add_u32 m0, s21, 1024
    s_nop 0
    buffer_load_dwordx4 v1, s[4:7], s17 offen sc1 lds
    s_add_u32 s17, s17, s62
    s_add_u32 m0, s22, 0
    s_nop 0
    buffer_load_dwordx4 v2, s[8:11], s18 offen lds
    s_add_u32 s18, s18, s20
    s_add_u32 m0, s22, 8192
    s_nop 0
    buffer_load_dwordx4 v2, s[12:15], s19 offen lds
    s_add_u32 s19, s19, s20
    v_mfma_f32_16x16x32_bf16 v[128:131], v[64:67], v[32:35], v[128:131]
    ds_read_b64_tr_b16 v[112:113], v8 offset:49152
    v_mfma_f32_16x16x32_bf16 v[132:135], v[68:71], v[32:35], v[132:135]
    ds_read_b64_tr_b16 v[114:115], v9 offset:49152
    v_mfma_f32_16x16x32_bf16 v[136:139], v[72:75], v[32:35], v[136:139]
    ds_read_b64_tr_b16 v[116:117], v10 offset:49152
    v_mfma_f32_16x16x32_bf16 v[140:143], v[76:79], v[32:35], v[140:143]
    ds_read_b64_tr_b16 v[118:119], v11 offset:49152
    v_mfma_f32_16x16x32_bf16 v[144:147], v[64:67], v[40:43], v[144:147]
    ds_read_b64_tr_b16 v[120:121], v8 offset:57344
    v_mfma_f32_16x16x32_bf16 v[148:151], v[68:71], v[40:43], v[148:151]
    ds_read_b64_tr_b16 v[122:123], v9 offset:57344
    v_mfma_f32_16x16x32_bf16 v[152:155], v[72:75], v[40:43], v[152:155]
    ds_read_b64_tr_b16 v[124:125], v10 offset:57344
    v_mfma_f32_16x16x32_bf16 v[156:159], v[76:79], v[40:43], v[156:159]
    ds_read_b64_tr_b16 v[126:127], v11 offset:57344
    v_mfma_f32_16x16x32_bf16 v[160:163], v[64:67], v[48:51], v[160:163]
    ds_read_b128 v[80:83], v5 offset:32768
    v_mfma_f32_16x16x32_bf16 v[164:167], v[68:71], v[48:51], v[164:167]
    ds_read_b128 v[88:91], v5 offset:34816
    v_mfma_f32_16x16x32_bf16 v[168:171], v[72:75], v[48:51], v[168:171]
    ds_read_b128 v[96:99], v5 offset:36864
    v_mfma_f32_16x16x32_bf16 v[172:175], v[76:79], v[48:51], v[172:175]
    ds_read_b128 v[104:107], v5 offset:38912
    v_mfma_f32_16x16x32_bf16 v[176:179], v[64:67], v[56:59], v[176:179]
    v_mfma_f32_16x16x32_bf16 v[180:183], v[68:71], v[56:59], v[180:183]
    v_mfma_f32_16x16x32_bf16 v[184:187], v[72:75], v[56:59], v[184:187]
    v_mfma_f32_16x16x32_bf16 v[188:191], v[76:79], v[56:59], v[188:191]
    s_waitcnt lgkmcnt(0)
    s_waitcnt vmcnt(7)
    s_barrier
    s_add_u32 m0, s21, 32768
    s_nop 0
    buffer_load_dwordx4 v1, s[4:7], s16 offen sc1 lds
    s_add_u32 s16, s16, s62
    s_add_u32 m0, s21, 33792
    s_nop 0
    buffer_load_dwordx4 v1, s[4:7], s17 offen sc1 lds
    s_add_u32 s17, s17, s62
    s_add_u32 m0, s22, 32768
    s_nop 0
    buffer_load_dwordx4 v2, s[8:11], s18 offen lds
    s_add_u32 s18, s18, s20
    s_add_u32 m0, s22, 40960
    s_nop 0
    buffer_load_dwordx4 v2, s[12:15], s19 offen lds
    s_add_u32 s19, s19, s20
    v_mfma_f32_16x16x32_bf16 v[128:131], v[112:115], v[80:83], v[128:131]
    ds_read_b64_tr_b16 v[64:65], v12 offset:16384
    v_mfma_f32_16x16x32_bf16 v[132:135], v[116:119], v[80:83], v[132:135]
    ds_read_b64_tr_b16 v[66:67], v13 offset:16384
    v_mfma_f32_16x16x32_bf16 v[136:139], v[120:123], v[80:83], v[136:139]
    ds_read_b64_tr_b16 v[68:69], v14 offset:16384
    v_mfma_f32_16x16x32_bf16 v[140:143], v[124:127], v[80:83], v[140:143]
    ds_read_b64_tr_b16 v[70:71], v15 offset:16384
    v_mfma_f32_16x16x32_bf16 v[144:147], v[112:115], v[88:91], v[144:147]
    ds_read_b64_tr_b16 v[72:73], v12 offset:24576
    v_mfma_f32_16x16x32_bf16 v[148:151], v[116:119], v[88:91], v[148:151]
    ds_read_b64_tr_b16 v[74:75], v13 offset:24576
    v_mfma_f32_16x16x32_bf16 v[152:155], v[120:123], v[88:91], v[152:155]
    ds_read_b64_tr_b16 v[76:77], v14 offset:24576
    v_mfma_f32_16x16x32_bf16 v[156:159], v[124:127], v[88:91], v[156:159]
    ds_read_b64_tr_b16 v[78:79], v15 offset:24576
    v_mfma_f32_16x16x32_bf16 v[160:163], v[112:115], v[96:99], v[160:163]
    ds_read_b128 v[32:35], v6 offset:0
    v_mfma_f32_16x16x32_bf16 v[164:167], v[116:119], v[96:99], v[164:167]
    ds_read_b128 v[40:43], v6 offset:2048
    v_mfma_f32_16x16x32_bf16 v[168:171], v[120:123], v[96:99], v[168:171]
    ds_read_b128 v[48:51], v6 offset:4096
    v_mfma_f32_16x16x32_bf16 v[172:175], v[124:127], v[96:99], v[172:175]
    ds_read_b128 v[56:59], v6 offset:6144
    v_mfma_f32_16x16x32_bf16 v[176:179], v[112:115], v[104:107], v[176:179]
    v_mfma_f32_16x16x32_bf16 v[180:183], v[116:119], v[104:107], v[180:183]
    v_mfma_f32_16x16x32_bf16 v[184:187], v[120:123], v[104:107], v[184:187]
    v_mfma_f32_16x16x32_bf16 v[188:191], v[124:127], v[104:107], v[188:191]
    s_waitcnt lgkmcnt(0)
    s_waitcnt vmcnt(8)
    s_barrier
    s_add_u32 m0, s21, 65536
    s_nop 0
    buffer_load_dwordx4 v1, s[4:7], s16 offen sc1 lds
    s_add_u32 s16, s16, s62
    s_add_u32 m0, s21, 66560
    s_nop 0
    buffer_load_dwordx4 v1, s[4:7], s17 offen sc1 lds
    s_add_u32 s17, s17, s62
    s_add_u32 m0, s22, 65536
    s_nop 0
    buffer_load_dwordx4 v2, s[8:11], s18 offen lds
    s_add_u32 s18, s18, s20
    s_add_u32 m0, s22, 73728
    s_nop 0
    buffer_load_dwordx4 v2, s[12:15], s19 offen lds
    s_add_u32 s19, s19, s20
    v_mfma_f32_16x16x32_bf16 v[128:131], v[64:67], v[32:35], v[128:131]
    ds_read_b64_tr_b16 v[112:113], v12 offset:49152
    v_mfma_f32_16x16x32_bf16 v[132:135], v[68:71], v[32:35], v[132:135]
    ds_read_b64_tr_b16 v[114:115], v13 offset:49152
    v_mfma_f32_16x16x32_bf16 v[136:139], v[72:75], v[32:35], v[136:139]
    ds_read_b64_tr_b16 v[116:117], v14 offset:49152
    v_mfma_f32_16x16x32_bf16 v[140:143], v[76:79], v[32:35], v[140:143]
    ds_read_b64_tr_b16 v[118:119], v15 offset:49152
    v_mfma_f32_16x16x32_bf16 v[144:147], v[64:67], v[40:43], v[144:147]
    ds_read_b64_tr_b16 v[120:121], v12 offset:57344
    v_mfma_f32_16x16x32_bf16 v[148:151], v[68:71], v[40:43], v[148:151]
    ds_read_b64_tr_b16 v[122:123], v13 offset:57344
    v_mfma_f32_16x16x32_bf16 v[152:155], v[72:75], v[40:43], v[152:155]
    ds_read_b64_tr_b16 v[124:125], v14 offset:57344
    v_mfma_f32_16x16x32_bf16 v[156:159], v[76:79], v[40:43], v[156:159]
    ds_read_b64_tr_b16 v[126:127], v15 offset:57344
    v_mfma_f32_16x16x32_bf16 v[160:163], v[64:67], v[48:51], v[160:163]
    ds_read_b128 v[80:83], v6 offset:32768
    v_mfma_f32_16x16x32_bf16 v[164:167], v[68:71], v[48:51], v[164:167]
    ds_read_b128 v[88:91], v6 offset:34816
    v_mfma_f32_16x16x32_bf16 v[168:171], v[72:75], v[48:51], v[168:171]
    ds_read_b128 v[96:99], v6 offset:36864
    v_mfma_f32_16x16x32_bf16 v[172:175], v[76:79], v[48:51], v[172:175]
    ds_read_b128 v[104:107], v6 offset:38912
    v_mfma_f32_16x16x32_bf16 v[176:179], v[64:67], v[56:59], v[176:179]
    v_mfma_f32_16x16x32_bf16 v[180:183], v[68:71], v[56:59], v[180:183]
    v_mfma_f32_16x16x32_bf16 v[184:187], v[72:75], v[56:59], v[184:187]
    v_mfma_f32_16x16x32_bf16 v[188:191], v[76:79], v[56:59], v[188:191]
    s_waitcnt lgkmcnt(0)
    s_waitcnt vmcnt(8)
    s_barrier
    s_add_u32 m0, s21, 98304
    s_nop 0
    buffer_load_dwordx4 v1, s[4:7], s16 offen sc1 lds
    s_add_u32 s16, s16, s62
    s_add_u32 m0, s21, 99328
    s_nop 0
    buffer_load_dwordx4 v1, s[4:7], s17 offen sc1 lds
    s_add_u32 s17, s17, s62
    s_add_u32 m0, s22, 98304
    s_nop 0
    buffer_load_dwordx4 v2, s[8:11], s18 offen lds
    s_add_u32 s18, s18, s20
    s_add_u32 m0, s22, 106496
    s_nop 0
    buffer_load_dwordx4 v2, s[12:15], s19 offen lds
    s_add_u32 s19, s19, s20
    v_mfma_f32_16x16x32_bf16 v[128:131], v[112:115], v[80:83], v[128:131]
    ds_read_b64_tr_b16 v[64:65], v8 offset:16384
    v_mfma_f32_16x16x32_bf16 v[132:135], v[116:119], v[80:83], v[132:135]
    ds_read_b64_tr_b16 v[66:67], v9 offset:16384
    v_mfma_f32_16x16x32_bf16 v[136:139], v[120:123], v[80:83], v[136:139]
    ds_read_b64_tr_b16 v[68:69], v10 offset:16384
    v_mfma_f32_16x16x32_bf16 v[140:143], v[124:127], v[80:83], v[140:143]
    ds_read_b64_tr_b16 v[70:71], v11 offset:16384
    v_mfma_f32_16x16x32_bf16 v[144:147], v[112:115], v[88:91], v[144:147]
    ds_read_b64_tr_b16 v[72:73], v8 offset:24576
    v_mfma_f32_16x16x32_bf16 v[148:151], v[116:119], v[88:91], v[148:151]
    ds_read_b64_tr_b16 v[74:75], v9 offset:24576
    v_mfma_f32_16x16x32_bf16 v[152:155], v[120:123], v[88:91], v[152:155]
    ds_read_b64_tr_b16 v[76:77], v10 offset:24576
    v_mfma_f32_16x16x32_bf16 v[156:159], v[124:127], v[88:91], v[156:159]
    ds_read_b64_tr_b16 v[78:79], v11 offset:24576
    v_mfma_f32_16x16x32_bf16 v[160:163], v[112:115], v[96:99], v[160:163]
    ds_read_b128 v[32:35], v5 offset:0
    v_mfma_f32_16x16x32_bf16 v[164:167], v[116:119], v[96:99], v[164:167]
    ds_read_b128 v[36:39], v5 offset:1024
    v_mfma_f32_16x16x32_bf16 v[168:171], v[120:123], v[96:99], v[168:171]
    ds_read_b128 v[40:43], v5 offset:2048
    v_mfma_f32_16x16x32_bf16 v[172:175], v[124:127], v[96:99], v[172:175]
    ds_read_b128 v[44:47], v5 offset:3072
    v_mfma_f32_16x16x32_bf16 v[176:179], v[112:115], v[104:107], v[176:179]
    ds_read_b128 v[48:51], v5 offset:4096
    v_mfma_f32_16x16x32_bf16 v[180:183], v[116:119], v[104:107], v[180:183]
    ds_read_b128 v[52:55], v5 offset:5120
    v_mfma_f32_16x16x32_bf16 v[184:187], v[120:123], v[104:107], v[184:187]
    ds_read_b128 v[56:59], v5 offset:6144
    v_mfma_f32_16x16x32_bf16 v[188:191], v[124:127], v[104:107], v[188:191]
    ds_read_b128 v[60:63], v5 offset:7168
    s_waitcnt lgkmcnt(0)
    s_branch w_doneM
w_bodyM:
    buffer_load_dword v22, off, s[64:67], 0 sc1
    s_waitcnt vmcnt(6)
    s_barrier
    s_add_u32 m0, s21, 0
    s_nop 0
    buffer_load_dwordx4 v1, s[4:7], s16 offen sc1 lds
    s_add_u32 s16, s16, s62
    s_add_u32 m0, s22, 0
    s_nop 0
    buffer_load_dwordx4 v2, s[8:11], s18 offen lds
    s_add_u32 s18, s18, s20
    s_add_u32 m0, s22, 8192
    s_nop 0
    buffer_load_dwordx4 v2, s[12:15], s19 offen lds
    s_add_u32 s19, s19, s20
    v_mfma_f32_16x16x32_bf16 v[128:131], v[64:67], v[32:35], v[128:131]
    ds_read_b64_tr_b16 v[112:113], v8 offset:49152
    v_mfma_f32_16x16x32_bf16 v[132:135], v[68:71], v[32:35], v[132:135]
    ds_read_b64_tr_b16 v[114:115], v9 offset:49152
    v_mfma_f32_16x16x32_bf16 v[136:139], v[72:75], v[32:35], v[136:139]
    ds_read_b64_tr_b16 v[116:117], v10 offset:49152
    v_mfma_f32_16x16x32_bf16 v[140:143], v[76:79], v[32:35], v[140:143]
    ds_read_b64_tr_b16 v[118:119], v11 offset:49152
    v_mfma_f32_16x16x32_bf16 v[144:147], v[64:67], v[40:43], v[144:147]
    ds_read_b64_tr_b16 v[120:121], v8 offset:57344
    v_mfma_f32_16x16x32_bf16 v[148:151], v[68:71], v[40:43], v[148:151]
    ds_read_b64_tr_b16 v[122:123], v9 offset:57344
    v_mfma_f32_16x16x32_bf16 v[152:155], v[72:75], v[40:43], v[152:155]
    ds_read_b64_tr_b16 v[124:125], v10 offset:57344
    v_mfma_f32_16x16x32_bf16 v[156:159], v[76:79], v[40:43], v[156:159]
    ds_read_b64_tr_b16 v[126:127], v11 offset:57344
    v_mfma_f32_16x16x32_bf16 v[160:163], v[64:67], v[48:51], v[160:163]
    ds_read_b128 v[80:83], v5 offset:32768
    v_mfma_f32_16x16x32_bf16 v[164:167], v[68:71], v[48:51], v[164:167]
    ds_read_b128 v[88:91], v5 offset:34816
    v_mfma_f32_16x16x32_bf16 v[168:171], v[72:75], v[48:51], v[168:171]
    ds_read_b128 v[96:99], v5 offset:36864
    v_mfma_f32_16x16x32_bf16 v[172:175], v[76:79], v[48:51], v[172:175]
    ds_read_b128 v[104:107], v5 offset:38912
    v_mfma_f32_16x16x32_bf16 v[176:179], v[64:67], v[56:59], v[176:179]
    v_mfma_f32_16x16x32_bf16 v[180:183], v[68:71], v[56:59], v[180:183]
    v_mfma_f32_16x16x32_bf16 v[184:187], v[72:75], v[56:59], v[184:187]
    v_mfma_f32_16x16x32_bf16 v[188:191], v[76:79], v[56:59], v[188:191]
    buffer_load_dword v16, v17, s[4:7], s44 offen sc1
    s_waitcnt lgkmcnt(0)
    s_waitcnt vmcnt(6)
    s_barrier
    s_add_u32 m0, s21, 32768
    s_nop 0
    buffer_load_dwordx4 v1, s[4:7], s16 offen sc1 lds
    s_add_u32 s16, s16, s62
    s_add_u32 m0, s22, 32768
    s_nop 0
    buffer_load_dwordx4 v2, s[8:11], s18 offen lds
    s_add_u32 s18, s18, s20
    s_add_u32 m0, s22, 40960
    s_nop 0
    buffer_load_dwordx4 v2, s[12:15], s19 offen lds
    s_add_u32 s19, s19, s20
    v_mfma_f32_16x16x32_bf16 v[128:131], v[112:115], v[80:83], v[128:131]
    ds_read_b64_tr_b16 v[64:65], v12 offset:16384
    v_mfma_f32_16x16x32_bf16 v[132:135], v[116:119], v[80:83], v[132:135]
    ds_read_b64_tr_b16 v[66:67], v13 offset:16384
    v_mfma_f32_16x16x32_bf16 v[136:139], v[120:123], v[80:83], v[136:139]
    ds_read_b64_tr_b16 v[68:69], v14 offset:16384
    v_mfma_f32_16x16x32_bf16 v[140:143], v[124:127], v[80:83], v[140:143]
    ds_read_b64_tr_b16 v[70:71], v15 offset:16384
    v_mfma_f32_16x16x32_bf16 v[144:147], v[112:115], v[88:91], v[144:147]
    ds_read_b64_tr_b16 v[72:73], v12 offset:24576
    v_mfma_f32_16x16x32_bf16 v[148:151], v[116:119], v[88:91], v[148:151]
    ds_read_b64_tr_b16 v[74:75], v13 offset:24576
    v_mfma_f32_16x16x32_bf16 v[152:155], v[120:123], v[88:91], v[152:155]
    ds_read_b64_tr_b16 v[76:77], v14 offset:24576
    v_mfma_f32_16x16x32_bf16 v[156:159], v[124:127], v[88:91], v[156:159]
    ds_read_b64_tr_b16 v[78:79], v15 offset:24576
    v_mfma_f32_16x16x32_bf16 v[160:163], v[112:115], v[96:99], v[160:163]
    ds_read_b128 v[32:35], v6 offset:0
    v_mfma_f32_16x16x32_bf16 v[164:167], v[116:119], v[96:99], v[164:167]
    ds_read_b128 v[40:43], v6 offset:2048
    v_mfma_f32_16x16x32_bf16 v[168:171], v[120:123], v[96:99], v[168:171]
    ds_read_b128 v[48:51], v6 offset:4096
    v_mfma_f32_16x16x32_bf16 v[172:175], v[124:127], v[96:99], v[172:175]
    ds_read_b128 v[56:59], v6 offset:6144
    v_mfma_f32_16x16x32_bf16 v[176:179], v[112:115], v[104:107], v[176:179]
    v_mfma_f32_16x16x32_bf16 v[180:183], v[116:119], v[104:107], v[180:183]
    v_mfma_f32_16x16x32_bf16 v[184:187], v[120:123], v[104:107], v[184:187]
    v_mfma_f32_16x16x32_bf16 v[188:191], v[124:127], v[104:107], v[188:191]
    s_waitcnt lgkmcnt(0)
    s_waitcnt vmcnt(6)
    s_barrier
    s_add_u32 m0, s21, 65536
    s_nop 0
    buffer_load_dwordx4 v1, s[4:7], s16 offen sc1 lds
    s_add_u32 s16, s16, s62
    s_add_u32 m0, s22, 65536
    s_nop 0
    buffer_load_dwordx4 v2, s[8:11], s18 offen lds
    s_add_u32 s18, s18, s20
    s_add_u32 m0, s22, 73728
    s_nop 0
    buffer_load_dwordx4 v2, s[12:15], s19 offen lds
    s_add_u32 s19, s19, s20
    v_mfma_f32_16x16x32_bf16 v[128:131], v[64:67], v[32:35], v[128:131]
    ds_read_b64_tr_b16 v[112:113], v12 offset:49152
    v_mfma_f32_16x16x32_bf16 v[132:135], v[68:71], v[32:35], v[132:135]
    ds_read_b64_tr_b16 v[114:115], v13 offset:49152
    v_mfma_f32_16x16x32_bf16 v[136:139], v[72:75], v[32:35], v[136:139]
    ds_read_b64_tr_b16 v[116:117], v14 offset:49152
    v_mfma_f32_16x16x32_bf16 v[140:143], v[76:79], v[32:35], v[140:143]
    ds_read_b64_tr_b16 v[118:119], v15 offset:49152
    v_mfma_f32_16x16x32_bf16 v[144:147], v[64:67], v[40:43], v[144:147]
    ds_read_b64_tr_b16 v[120:121], v12 offset:57344
    v_mfma_f32_16x16x32_bf16 v[148:151], v[68:71], v[40:43], v[148:151]
    ds_read_b64_tr_b16 v[122:123], v13 offset:57344
    v_mfma_f32_16x16x32_bf16 v[152:155], v[72:75], v[40:43], v[152:155]
    ds_read_b64_tr_b16 v[124:125], v14 offset:57344
    v_mfma_f32_16x16x32_bf16 v[156:159], v[76:79], v[40:43], v[156:159]
    ds_read_b64_tr_b16 v[126:127], v15 offset:57344
    v_mfma_f32_16x16x32_bf16 v[160:163], v[64:67], v[48:51], v[160:163]
    ds_read_b128 v[80:83], v6 offset:32768
    v_mfma_f32_16x16x32_bf16 v[164:167], v[68:71], v[48:51], v[164:167]
    ds_read_b128 v[88:91], v6 offset:34816
    v_mfma_f32_16x16x32_bf16 v[168:171], v[72:75], v[48:51], v[168:171]
    ds_read_b128 v[96:99], v6 offset:36864
    v_mfma_f32_16x16x32_bf16 v[172:175], v[76:79], v[48:51], v[172:175]
    ds_read_b128 v[104:107], v6 offset:38912
    v_mfma_f32_16x16x32_bf16 v[176:179], v[64:67], v[56:59], v[176:179]
    v_mfma_f32_16x16x32_bf16 v[180:183], v[68:71], v[56:59], v[180:183]
    v_mfma_f32_16x16x32_bf16 v[184:187], v[72:75], v[56:59], v[184:187]
    v_mfma_f32_16x16x32_bf16 v[188:191], v[76:79], v[56:59], v[188:191]
    s_waitcnt lgkmcnt(0)
    s_waitcnt vmcnt(6)
    s_barrier
    s_add_u32 m0, s21, 98304
    s_nop 0
    buffer_load_dwordx4 v1, s[4:7], s16 offen sc1 lds
    s_add_u32 s16, s16, s62
    s_add_u32 m0, s22, 98304
    s_nop 0
    buffer_load_dwordx4 v2, s[8:11], s18 offen lds
    s_add_u32 s18, s18, s20
    s_add_u32 m0, s22, 106496
    s_nop 0
    buffer_load_dwordx4 v2, s[12:15], s19 offen lds
    s_add_u32 s19, s19, s20
    v_mfma_f32_16x16x32_bf16 v[128:131], v[112:115], v[80:83], v[128:131]
    ds_read_b64_tr_b16 v[64:65], v8 offset:16384
    v_mfma_f32_16x16x32_bf16 v[132:135], v[116:119], v[80:83], v[132:135]
    ds_read_b64_tr_b16 v[66:67], v9 offset:16384
    v_mfma_f32_16x16x32_bf16 v[136:139], v[120:123], v[80:83], v[136:139]
    ds_read_b64_tr_b16 v[68:69], v10 offset:16384
    v_mfma_f32_16x16x32_bf16 v[140:143], v[124:127], v[80:83], v[140:143]
    ds_read_b64_tr_b16 v[70:71], v11 offset:16384
    v_mfma_f32_16x16x32_bf16 v[144:147], v[112:115], v[88:91], v[144:147]
    ds_read_b64_tr_b16 v[72:73], v8 offset:24576
    v_mfma_f32_16x16x32_bf16 v[148:151], v[116:119], v[88:91], v[148:151]
    ds_read_b64_tr_b16 v[74:75], v9 offset:24576
    v_mfma_f32_16x16x32_bf16 v[152:155], v[120:123], v[88:91], v[152:155]
    ds_read_b64_tr_b16 v[76:77], v10 offset:24576
    v_mfma_f32_16x16x32_bf16 v[156:159], v[124:127], v[88:91], v[156:159]
    ds_read_b64_tr_b16 v[78:79], v11 offset:24576
    v_mfma_f32_16x16x32_bf16 v[160:163], v[112:115], v[96:99], v[160:163]
    ds_read_b128 v[32:35], v5 offset:0
    v_mfma_f32_16x16x32_bf16 v[164:167], v[116:119], v[96:99], v[164:167]
    ds_read_b128 v[40:43], v5 offset:2048
    v_mfma_f32_16x16x32_bf16 v[168:171], v[120:123], v[96:99], v[168:171]
    ds_read_b128 v[48:51], v5 offset:4096
    v_mfma_f32_16x16x32_bf16 v[172:175], v[124:127], v[96:99], v[172:175]
    ds_read_b128 v[56:59], v5 offset:6144
    v_mfma_f32_16x16x32_bf16 v[176:179], v[112:115], v[104:107], v[176:179]
    v_mfma_f32_16x16x32_bf16 v[180:183], v[116:119], v[104:107], v[180:183]
    v_mfma_f32_16x16x32_bf16 v[184:187], v[120:123], v[104:107], v[184:187]
    v_mfma_f32_16x16x32_bf16 v[188:191], v[124:127], v[104:107], v[188:191]
    s_waitcnt lgkmcnt(0)
    s_sub_u32 s23, s23, 1
    s_cmp_lg_u32 s23, 0
    s_cbranch_scc1 w_loopM
w_doneM:
    v_mov_b32 v20, 131072
    ds_read_b128 v[24:27], v20
    ds_read_b128 v[28:31], v20 offset:16
    s_lshl_b32 s30, s27, 10
    s_add_u32 s30, s30, s49
    s_nop 7
    v_cvt_pk_bf16_f32 v80, v128, v129
    v_cvt_pk_bf16_f32 v81, v130, v131
    v_cvt_pk_bf16_f32 v82, v132, v133
    v_cvt_pk_bf16_f32 v83, v134, v135
    buffer_store_dwordx4 v[80:83], v1, s[4:7], s30 offen sc1
    v_cvt_pk_bf16_f32 v84, v136, v137
    v_cvt_pk_bf16_f32 v85, v138, v139
    v_cvt_pk_bf16_f32 v86, v140, v141
    v_cvt_pk_bf16_f32 v87, v142, v143
    buffer_store_dwordx4 v[84:87], v19, s[4:7], s30 offen sc1
    s_add_u32 s30, s30, s50
    v_cvt_pk_bf16_f32 v88, v144, v145
    v_cvt_pk_bf16_f32 v89, v146, v147
    v_cvt_pk_bf16_f32 v90, v148, v149
    v_cvt_pk_bf16_f32 v91, v150, v151
    buffer_store_dwordx4 v[88:91], v1, s[4:7], s30 offen sc1
    v_cvt_pk_bf16_f32 v92, v152, v153
    v_cvt_pk_bf16_f32 v93, v154, v155
    v_cvt_pk_bf16_f32 v94, v156, v157
    v_cvt_pk_bf16_f32 v95, v158, v159
    buffer_store_dwordx4 v[92:95], v19, s[4:7], s30 offen sc1
    s_add_u32 s30, s30, s50
    v_cvt_pk_bf16_f32 v80, v160, v161
    v_cvt_pk_bf16_f32 v81, v162, v163
    v_cvt_pk_bf16_f32 v82, v164, v165
    v_cvt_pk_bf16_f32 v83, v166, v167
    buffer_store_dwordx4 v[80:83], v1, s[4:7], s30 offen sc1
    v_cvt_pk_bf16_f32 v84, v168, v169
    v_cvt_pk_bf16_f32 v85, v170, v171
    v_cvt_pk_bf16_f32 v86, v172, v173
    v_cvt_pk_bf16_f32 v87, v174, v175
    buffer_store_dwordx4 v[84:87], v19, s[4:7], s30 offen sc1
    s_add_u32 s30, s30, s50
    v_cvt_pk_bf16_f32 v88, v176, v177
    v_cvt_pk_bf16_f32 v89, v178, v179
    v_cvt_pk_bf16_f32 v90, v180, v181
    v_cvt_pk_bf16_f32 v91, v182, v183
    buffer_store_dwordx4 v[88:91], v1, s[4:7], s30 offen sc1
    v_cvt_pk_bf16_f32 v92, v184, v185
    v_cvt_pk_bf16_f32 v93, v186, v187
    v_cvt_pk_bf16_f32 v94, v188, v189
    v_cvt_pk_bf16_f32 v95, v190, v191
    buffer_store_dwordx4 v[92:95], v19, s[4:7], s30 offen sc1
    s_add_u32 s30, s30, s50
    s_waitcnt lgkmcnt(0)
    v_or3_b32 v24, v24, v25, v26
    v_or3_b32 v28, v28, v29, v30
    v_or3_b32 v24, v24, v27, v31
    v_or_b32 v24, v24, v28
    s_mov_b32 s28, s51
    s_mov_b32 s57, s53
    v_readfirstlane_b32 s30, v24
    s_cmp_lg_u32 s30, 0
    s_cbranch_scc1 w_drain
    s_mov_b32 s48, s32
    s_cmp_ge_u32 s32, 4
    s_cselect_b32 s30, 2, 3
    s_lshl_b32 s30, s26, s30
    s_mul_i32 s30, s30, s43
    s_add_u32 s49, s42, s30
    s_mov_b32 s50, s43
    s_mov_b32 s51, s46
    s_mov_b32 s23, s41
    s_mov_b32 s53, s47
    s_nop 0
    s_load_dwordx16 s[32:47], s[24:25], 0
    s_add_u32 s24, s24, 64
    s_addc_u32 s25, s25, 0
    s_branch w_first8
w_drain:
    s_waitcnt vmcnt(0)
    s_barrier
    s_cmp_eq_u32 s28, 0
    s_cbranch_scc1 sig_5
    s_cmp_lg_u32 s3, 0
    s_cbranch_scc1 sig_5
    s_mov_b64 exec, 1
    v_mov_b32 v18, s57
    buffer_atomic_add v18, v17, s[4:7], s28 offen sc1
    s_mov_b64 exec, -1
sig_5:
    s_mov_b32 s28, 0
    s_cmp_eq_u32 s98, 3
    s_cselect_b32 s98, 1, s98
w_hook:
    s_cmp_eq_u32 s70, 0
    s_cbranch_scc1 drw_ok
    s_cmp_lt_u32 s39, 1048576
    s_cbranch_scc1 drw_ok
    s_mov_b32 s70, 0
    s_cmp_lg_u32 s3, 0
    s_cbranch_scc1 drw_ok
    v_readfirstlane_b32 s68, v22
    s_cmp_ge_u32 s68, 128
    s_cbranch_scc1 drw_ok
    s_mov_b32 s69, 65536
drw:
    buffer_load_dword v20, off, s[64:67], 0 offset:0 sc1
    s_waitcnt vmcnt(0)
    v_readfirstlane_b32 s68, v20
    s_cmp_ge_u32 s68, 128
    s_cbranch_scc1 drw_ok
    s_sleep 8
    s_sub_u32 s69, s69, 1
    s_cbranch_scc0 drw
drw_ok:
    s_branch w_cold
fin_entry:
    s_load_dwordx2 s[8:9], s[0:1], 0
    s_load_dwordx2 s[12:13], s[0:1], 88
    v_mbcnt_lo_u32_b32 v1, -1, 0
    v_mbcnt_hi_u32_b32 v1, -1, v1
    s_mov_b32 s10, 4194304
    s_mov_b32 s11, 131072
    s_mov_b32 s14, 4194304
    s_mov_b32 s15, 131072
    v_lshlrev_b32 v3, 4, v1
    v_and_b32 v4, 15, v1
    v_lshrrev_b32 v5, 4, v1
    v_lshlrev_b32 v4, 11, v4
    v_lshl_add_u32 v4, v5, 4, v4
    v_and_b32 v5, 1, v5
    v_cmp_eq_u32 s[20:21], 1, v5
    v_and_b32 v6, 7, v1
    v_lshlrev_b32 v6, 7, v6
    s_lshr_b32 s24, s63, 2
    s_and_b32 s25, s63, 3
    s_lshl_b32 s25, s25, 2
    s_and_b32 s26, s3, 3
    s_add_u32 s25, s25, s26
    s_lshr_b32 s26, s3, 2
    s_mov_b32 s28, 65536
    s_waitcnt lgkmcnt(0)
fin_job:
    s_lshl_b32 s16, s24, 1
    s_add_u32 s16, s16, s26
    s_lshl_b32 s18, s16, 15
    s_lshl_b32 s17, s25, 11
    s_add_u32 s17, s17, s18
    s_lshl_b32 s19, s25, 7
    s_add_u32 s18, s18, s19
    s_add_u32 s22, s17, 167772160
    s_add_u32 s23, s17, 75497472
    s_lshr_b32 s27, s24, 3
    s_lshl_b32 s27, s27, 6
    s_add_u32 s27, s27, 218106368
    s_cmp_ge_u32 s24, 64
    s_cselect_b32 s29, 16, 16
    s_mov_b32 s30, 218112000
    s_add_u32 s32, s24, 1
    s_mov_b32 s33, 0
    s_mov_b32 s34, 255
    s_cmp_lt_u32 s24, 62
    s_cbranch_scc1 fin_tg
    s_mov_b32 s32, 16
    s_add_u32 s30, s30, 4
    s_sub_u32 s33, s24, 62
    s_lshl_b32 s33, s33, 3
fin_tg:
    s_mul_i32 s35, s24, 3
    s_lshr_b32 s35, s35, 4
    s_add_u32 s35, s35, 49
    s_min_u32 s35, s35, 61
    s_max_u32 s32, s32, s35
    buffer_load_dwordx4 v[88:91], v4, s[8:11], s18 offen offset:0
    buffer_load_dwordx4 v[92:95], v4, s[8:11], s18 offen offset:64
    s_cmp_lg_u32 s3, 0
    s_cbranch_scc1 fin_ws_ok
fin_wd:
    buffer_load_dword v7, off, s[4:7], s27 sc1
    s_waitcnt vmcnt(0)
    v_readfirstlane_b32 s31, v7
    s_cmp_ge_u32 s31, s29
    s_cbranch_scc1 fin_wd_ok
    s_sleep 127
    s_sub_u32 s28, s28, 1
    s_cbranch_scc0 fin_wd
    s_mov_b32 s28, 0
fin_wd_ok:
fin_ws:
    buffer_load_dword v7, v6, s[4:7], s30 offen sc1
    s_waitcnt vmcnt(0)
    v_lshrrev_b32 v7, s33, v7
    v_and_b32 v7, s34, v7
    v_cmp_gt_u32 vcc, s32, v7
    s_cbranch_vccz fin_ws_ok
    s_sleep 12
    v_add_u32 v7, 1, v7
    v_cmp_gt_u32 vcc, s32, v7
    s_cbranch_vccz fin_ws_f
    s_sleep 48
    v_add_u32 v7, 3, v7
    v_cmp_gt_u32 vcc, s32, v7
    s_cbranch_vccz fin_ws_f
    s_sleep 127
    s_sleep 127
fin_ws_f:
    s_sub_u32 s28, s28, 1
    s_cbranch_scc0 fin_ws
    s_mov_b32 s28, 0
fin_ws_ok:
    s_barrier
    buffer_load_dwordx4 v[144:147], v3, s[4:7], s22 offen offset:0 sc1
    buffer_load_dwordx4 v[160:163], v3, s[4:7], s22 offen offset:1024 sc1
    s_add_u32 s22, s22, 4194304
    buffer_load_dwordx4 v[148:151], v3, s[4:7], s22 offen offset:0 sc1
    buffer_load_dwordx4 v[164:167], v3, s[4:7], s22 offen offset:1024 sc1
    s_add_u32 s22, s22, 4194304
    buffer_load_dwordx4 v[152:155], v3, s[4:7], s22 offen offset:0 sc1
    buffer_load_dwordx4 v[168:171], v3, s[4:7], s22 offen offset:1024 sc1
    s_add_u32 s22, s22, 4194304
    buffer_load_dwordx4 v[156:159], v3, s[4:7], s22 offen offset:0 sc1
    buffer_load_dwordx4 v[172:175], v3, s[4:7], s22 offen offset:1024 sc1
    buffer_load_dwordx4 v[16:19], v3, s[4:7], s23 offen offset:0 sc1
    buffer_load_dwordx4 v[48:51], v3, s[4:7], s23 offen offset:1024 sc1
    s_add_u32 s23, s23, 4194304
    buffer_load_dwordx4 v[20:23], v3, s[4:7], s23 offen offset:0 sc1
    buffer_load_dwordx4 v[52:55], v3, s[4:7], s23 offen offset:1024 sc1
    s_add_u32 s23, s23, 4194304
    buffer_load_dwordx4 v[24:27], v3, s[4:7], s23 offen offset:0 sc1
    buffer_load_dwordx4 v[56:59], v3, s[4:7], s23 offen offset:1024 sc1
    s_add_u32 s23, s23, 4194304
    buffer_load_dwordx4 v[28:31], v3, s[4:7], s23 offen offset:0 sc1
    buffer_load_dwordx4 v[60:63], v3, s[4:7], s23 offen offset:1024 sc1
    s_add_u32 s23, s23, 4194304
    buffer_load_dwordx4 v[32:35], v3, s[4:7], s23 offen offset:0 sc1
    buffer_load_dwordx4 v[64:67], v3, s[4:7], s23 offen offset:1024 sc1
    s_add_u32 s23, s23, 4194304
    buffer_load_dwordx4 v[36:39], v3, s[4:7], s23 offen offset:0 sc1
    buffer_load_dwordx4 v[68:71], v3, s[4:7], s23 offen offset:1024 sc1
    s_add_u32 s23, s23, 4194304
    buffer_load_dwordx4 v[40:43], v3, s[4:7], s23 offen offset:0 sc1
    buffer_load_dwordx4 v[72:75], v3, s[4:7], s23 offen offset:1024 sc1
    s_add_u32 s23, s23, 4194304
    buffer_load_dwordx4 v[44:47], v3, s[4:7], s23 offen offset:0 sc1
    buffer_load_dwordx4 v[76:79], v3, s[4:7], s23 offen offset:1024 sc1
    s_add_u32 s23, s23, 4194304
    s_waitcnt vmcnt(16)
    v_lshlrev_b32 v96, 16, v144
    v_and_b32 v97, 0xffff0000, v144
    v_lshlrev_b32 v98, 16, v145
    v_and_b32 v99, 0xffff0000, v145
    v_lshlrev_b32 v100, 16, v146
    v_and_b32 v101, 0xffff0000, v146
    v_lshlrev_b32 v102, 16, v147
    v_and_b32 v103, 0xffff0000, v147
    v_lshlrev_b32 v120, 16, v148
    v_and_b32 v121, 0xffff0000, v148
    v_lshlrev_b32 v122, 16, v149
    v_and_b32 v123, 0xffff0000, v149
    v_lshlrev_b32 v124, 16, v150
    v_and_b32 v125, 0xffff0000, v150
    v_lshlrev_b32 v126, 16, v151
    v_and_b32 v127, 0xffff0000, v151
    v_add_f32 v96, v96, v120
    v_add_f32 v97, v97, v121
    v_add_f32 v98, v98, v122
    v_add_f32 v99, v99, v123
    v_add_f32 v100, v100, v124
    v_add_f32 v101, v101, v125
    v_add_f32 v102, v102, v126
    v_add_f32 v103, v103, v127
    v_lshlrev_b32 v120, 16, v152
    v_and_b32 v121, 0xffff0000, v152
    v_lshlrev_b32 v122, 16, v153
    v_and_b32 v123, 0xffff0000, v153
    v_lshlrev_b32 v124, 16, v154
    v_and_b32 v125, 0xffff0000, v154
    v_lshlrev_b32 v126, 16, v155
    v_and_b32 v127, 0xffff0000, v155
    v_add_f32 v96, v96, v120
    v_add_f32 v97, v97, v121
    v_add_f32 v98, v98, v122
    v_add_f32 v99, v99, v123
    v_add_f32 v100, v100, v124
    v_add_f32 v101, v101, v125
    v_add_f32 v102, v102, v126
    v_add_f32 v103, v103, v127
    v_lshlrev_b32 v120, 16, v156
    v_and_b32 v121, 0xffff0000, v156
    v_lshlrev_b32 v122, 16, v157
    v_and_b32 v123, 0xffff0000, v157
    v_lshlrev_b32 v124, 16, v158
    v_and_b32 v125, 0xffff0000, v158
    v_lshlrev_b32 v126, 16, v159
    v_and_b32 v127, 0xffff0000, v159
    v_add_f32 v96, v96, v120
    v_add_f32 v97, v97, v121
    v_add_f32 v98, v98, v122
    v_add_f32 v99, v99, v123
    v_add_f32 v100, v100, v124
    v_add_f32 v101, v101, v125
    v_add_f32 v102, v102, v126
    v_add_f32 v103, v103, v127
    v_cvt_pk_bf16_f32 v120, v96, v97
    v_cvt_pk_bf16_f32 v121, v98, v99
    v_cvt_pk_bf16_f32 v122, v100, v101
    v_cvt_pk_bf16_f32 v123, v102, v103
    v_lshlrev_b32 v96, 16, v120
    v_and_b32 v97, 0xffff0000, v120
    v_lshlrev_b32 v98, 16, v121
    v_and_b32 v99, 0xffff0000, v121
    v_lshlrev_b32 v100, 16, v122
    v_and_b32 v101, 0xffff0000, v122
    v_lshlrev_b32 v102, 16, v123
    v_and_b32 v103, 0xffff0000, v123
    v_mul_f32 v104, 0xbfb8aa3b, v96
    v_mul_f32 v105, 0xbfb8aa3b, v97
    v_mul_f32 v106, 0xbfb8aa3b, v98
    v_mul_f32 v107, 0xbfb8aa3b, v99
    v_mul_f32 v108, 0xbfb8aa3b, v100
    v_mul_f32 v109, 0xbfb8aa3b, v101
    v_mul_f32 v110, 0xbfb8aa3b, v102
    v_mul_f32 v111, 0xbfb8aa3b, v103
    v_exp_f32 v104, v104
    v_exp_f32 v105, v105
    v_exp_f32 v106, v106
    v_exp_f32 v107, v107
    v_exp_f32 v108, v108
    v_exp_f32 v109, v109
    v_exp_f32 v110, v110
    v_exp_f32 v111, v111
    v_add_f32 v104, 1.0, v104
    v_add_f32 v105, 1.0, v105
    v_add_f32 v106, 1.0, v106
    v_add_f32 v107, 1.0, v107
    v_add_f32 v108, 1.0, v108
    v_add_f32 v109, 1.0, v109
    v_add_f32 v110, 1.0, v110
    v_add_f32 v111, 1.0, v111
    v_rcp_f32 v104, v104
    v_rcp_f32 v105, v105
    v_rcp_f32 v106, v106
    v_rcp_f32 v107, v107
    v_rcp_f32 v108, v108
    v_rcp_f32 v109, v109
    v_rcp_f32 v110, v110
    v_rcp_f32 v111, v111
    v_mul_f32 v96, v96, v104
    v_mul_f32 v97, v97, v105
    v_mul_f32 v98, v98, v106
    v_mul_f32 v99, v99, v107
    v_mul_f32 v100, v100, v108
    v_mul_f32 v101, v101, v109
    v_mul_f32 v102, v102, v110
    v_mul_f32 v103, v103, v111
    v_cvt_pk_bf16_f32 v80, v96, v97
    v_cvt_pk_bf16_f32 v81, v98, v99
    v_cvt_pk_bf16_f32 v82, v100, v101
    v_cvt_pk_bf16_f32 v83, v102, v103
    v_lshlrev_b32 v96, 16, v160
    v_and_b32 v97, 0xffff0000, v160
    v_lshlrev_b32 v98, 16, v161
    v_and_b32 v99, 0xffff0000, v161
    v_lshlrev_b32 v100, 16, v162
    v_and_b32 v101, 0xffff0000, v162
    v_lshlrev_b32 v102, 16, v163
    v_and_b32 v103, 0xffff0000, v163
    v_lshlrev_b32 v120, 16, v164
    v_and_b32 v121, 0xffff0000, v164
    v_lshlrev_b32 v122, 16, v165
    v_and_b32 v123, 0xffff0000, v165
    v_lshlrev_b32 v124, 16, v166
    v_and_b32 v125, 0xffff0000, v166
    v_lshlrev_b32 v126, 16, v167
    v_and_b32 v127, 0xffff0000, v167
    v_add_f32 v96, v96, v120
    v_add_f32 v97, v97, v121
    v_add_f32 v98, v98, v122
    v_add_f32 v99, v99, v123
    v_add_f32 v100, v100, v124
    v_add_f32 v101, v101, v125
    v_add_f32 v102, v102, v126
    v_add_f32 v103, v103, v127
    v_lshlrev_b32 v120, 16, v168
    v_and_b32 v121, 0xffff0000, v168
    v_lshlrev_b32 v122, 16, v169
    v_and_b32 v123, 0xffff0000, v169
    v_lshlrev_b32 v124, 16, v170
    v_and_b32 v125, 0xffff0000, v170
    v_lshlrev_b32 v126, 16, v171
    v_and_b32 v127, 0xffff0000, v171
    v_add_f32 v96, v96, v120
    v_add_f32 v97, v97, v121
    v_add_f32 v98, v98, v122
    v_add_f32 v99, v99, v123
    v_add_f32 v100, v100, v124
    v_add_f32 v101, v101, v125
    v_add_f32 v102, v102, v126
    v_add_f32 v103, v103, v127
    v_lshlrev_b32 v120, 16, v172
    v_and_b32 v121, 0xffff0000, v172
    v_lshlrev_b32 v122, 16, v173
    v_and_b32 v123, 0xffff0000, v173
    v_lshlrev_b32 v124, 16, v174
    v_and_b32 v125, 0xffff0000, v174
    v_lshlrev_b32 v126, 16, v175
    v_and_b32 v127, 0xffff0000, v175
    v_add_f32 v96, v96, v120
    v_add_f32 v97, v97, v121
    v_add_f32 v98, v98, v122
    v_add_f32 v99, v99, v123
    v_add_f32 v100, v100, v124
    v_add_f32 v101, v101, v125
    v_add_f32 v102, v102, v126
    v_add_f32 v103, v103, v127
    v_cvt_pk_bf16_f32 v120, v96, v97
    v_cvt_pk_bf16_f32 v121, v98, v99
    v_cvt_pk_bf16_f32 v122, v100, v101
    v_cvt_pk_bf16_f32 v123, v102, v103
    v_lshlrev_b32 v96, 16, v120
    v_and_b32 v97, 0xffff0000, v120
    v_lshlrev_b32 v98, 16, v121
    v_and_b32 v99, 0xffff0000, v121
    v_lshlrev_b32 v100, 16, v122
    v_and_b32 v101, 0xffff0000, v122
    v_lshlrev_b32 v102, 16, v123
    v_and_b32 v103, 0xffff0000, v123
    v_mul_f32 v104, 0xbfb8aa3b, v96
    v_mul_f32 v105, 0xbfb8aa3b, v97
    v_mul_f32 v106, 0xbfb8aa3b, v98
    v_mul_f32 v107, 0xbfb8aa3b, v99
    v_mul_f32 v108, 0xbfb8aa3b, v100
    v_mul_f32 v109, 0xbfb8aa3b, v101
    v_mul_f32 v110, 0xbfb8aa3b, v102
    v_mul_f32 v111, 0xbfb8aa3b, v103
    v_exp_f32 v104, v104
    v_exp_f32 v105, v105
    v_exp_f32 v106, v106
    v_exp_f32 v107, v107
    v_exp_f32 v108, v108
    v_exp_f32 v109, v109
    v_exp_f32 v110, v110
    v_exp_f32 v111, v111
    v_add_f32 v104, 1.0, v104
    v_add_f32 v105, 1.0, v105
    v_add_f32 v106, 1.0, v106
    v_add_f32 v107, 1.0, v107
    v_add_f32 v108, 1.0, v108
    v_add_f32 v109, 1.0, v109
    v_add_f32 v110, 1.0, v110
    v_add_f32 v111, 1.0, v111
    v_rcp_f32 v104, v104
    v_rcp_f32 v105, v105
    v_rcp_f32 v106, v106
    v_rcp_f32 v107, v107
    v_rcp_f32 v108, v108
    v_rcp_f32 v109, v109
    v_rcp_f32 v110, v110
    v_rcp_f32 v111, v111
    v_mul_f32 v96, v96, v104
    v_mul_f32 v97, v97, v105
    v_mul_f32 v98, v98, v106
    v_mul_f32 v99, v99, v107
    v_mul_f32 v100, v100, v108
    v_mul_f32 v101, v101, v109
    v_mul_f32 v102, v102, v110
    v_mul_f32 v103, v103, v111
    v_cvt_pk_bf16_f32 v84, v96, v97
    v_cvt_pk_bf16_f32 v85, v98, v99
    v_cvt_pk_bf16_f32 v86, v100, v101
    v_cvt_pk_bf16_f32 v87, v102, v103
    s_waitcnt vmcnt(0)
    v_lshlrev_b32 v96, 16, v16
    v_and_b32 v97, 0xffff0000, v16
    v_lshlrev_b32 v98, 16, v17
    v_and_b32 v99, 0xffff0000, v17
    v_lshlrev_b32 v100, 16, v18
    v_and_b32 v101, 0xffff0000, v18
    v_lshlrev_b32 v102, 16, v19
    v_and_b32 v103, 0xffff0000, v19
    v_lshlrev_b32 v120, 16, v20
    v_and_b32 v121, 0xffff0000, v20
    v_lshlrev_b32 v122, 16, v21
    v_and_b32 v123, 0xffff0000, v21
    v_lshlrev_b32 v124, 16, v22
    v_and_b32 v125, 0xffff0000, v22
    v_lshlrev_b32 v126, 16, v23
    v_and_b32 v127, 0xffff0000, v23
    v_add_f32 v96, v96, v120
    v_add_f32 v97, v97, v121
    v_add_f32 v98, v98, v122
    v_add_f32 v99, v99, v123
    v_add_f32 v100, v100, v124
    v_add_f32 v101, v101, v125
    v_add_f32 v102, v102, v126
    v_add_f32 v103, v103, v127
    v_lshlrev_b32 v120, 16, v24
    v_and_b32 v121, 0xffff0000, v24
    v_lshlrev_b32 v122, 16, v25
    v_and_b32 v123, 0xffff0000, v25
    v_lshlrev_b32 v124, 16, v26
    v_and_b32 v125, 0xffff0000, v26
    v_lshlrev_b32 v126, 16, v27
    v_and_b32 v127, 0xffff0000, v27
    v_add_f32 v96, v96, v120
    v_add_f32 v97, v97, v121
    v_add_f32 v98, v98, v122
    v_add_f32 v99, v99, v123
    v_add_f32 v100, v100, v124
    v_add_f32 v101, v101, v125
    v_add_f32 v102, v102, v126
    v_add_f32 v103, v103, v127
    v_lshlrev_b32 v120, 16, v28
    v_and_b32 v121, 0xffff0000, v28
    v_lshlrev_b32 v122, 16, v29
    v_and_b32 v123, 0xffff0000, v29
    v_lshlrev_b32 v124, 16, v30
    v_and_b32 v125, 0xffff0000, v30
    v_lshlrev_b32 v126, 16, v31
    v_and_b32 v127, 0xffff0000, v31
    v_add_f32 v96, v96, v120
    v_add_f32 v97, v97, v121
    v_add_f32 v98, v98, v122
    v_add_f32 v99, v99, v123
    v_add_f32 v100, v100, v124
    v_add_f32 v101, v101, v125
    v_add_f32 v102, v102, v126
    v_add_f32 v103, v103, v127
    v_lshlrev_b32 v120, 16, v32
    v_and_b32 v121, 0xffff0000, v32
    v_lshlrev_b32 v122, 16, v33
    v_and_b32 v123, 0xffff0000, v33
    v_lshlrev_b32 v124, 16, v34
    v_and_b32 v125, 0xffff0000, v34
    v_lshlrev_b32 v126, 16, v35
    v_and_b32 v127, 0xffff0000, v35
    v_add_f32 v96, v96, v120
    v_add_f32 v97, v97, v121
    v_add_f32 v98, v98, v122
    v_add_f32 v99, v99, v123
    v_add_f32 v100, v100, v124
    v_add_f32 v101, v101, v125
    v_add_f32 v102, v102, v126
    v_add_f32 v103, v103, v127
    v_lshlrev_b32 v120, 16, v36
    v_and_b32 v121, 0xffff0000, v36
    v_lshlrev_b32 v122, 16, v37
    v_and_b32 v123, 0xffff0000, v37
    v_lshlrev_b32 v124, 16, v38
    v_and_b32 v125, 0xffff0000, v38
    v_lshlrev_b32 v126, 16, v39
    v_and_b32 v127, 0xffff0000, v39
    v_add_f32 v96, v96, v120
    v_add_f32 v97, v97, v121
    v_add_f32 v98, v98, v122
    v_add_f32 v99, v99, v123
    v_add_f32 v100, v100, v124
    v_add_f32 v101, v101, v125
    v_add_f32 v102, v102, v126
    v_add_f32 v103, v103, v127
    v_lshlrev_b32 v120, 16, v40
    v_and_b32 v121, 0xffff0000, v40
    v_lshlrev_b32 v122, 16, v41
    v_and_b32 v123, 0xffff0000, v41
    v_lshlrev_b32 v124, 16, v42
    v_and_b32 v125, 0xffff0000, v42
    v_lshlrev_b32 v126, 16, v43
    v_and_b32 v127, 0xffff0000, v43
    v_add_f32 v96, v96, v120
    v_add_f32 v97, v97, v121
    v_add_f32 v98, v98, v122
    v_add_f32 v99, v99, v123
    v_add_f32 v100, v100, v124
    v_add_f32 v101, v101, v125
    v_add_f32 v102, v102, v126
    v_add_f32 v103, v103, v127
    v_lshlrev_b32 v120, 16, v44
    v_and_b32 v121, 0xffff0000, v44
    v_lshlrev_b32 v122, 16, v45
    v_and_b32 v123, 0xffff0000, v45
    v_lshlrev_b32 v124, 16, v46
    v_and_b32 v125, 0xffff0000, v46
    v_lshlrev_b32 v126, 16, v47
    v_and_b32 v127, 0xffff0000, v47
    v_add_f32 v96, v96, v120
    v_add_f32 v97, v97, v121
    v_add_f32 v98, v98, v122
    v_add_f32 v99, v99, v123
    v_add_f32 v100, v100, v124
    v_add_f32 v101, v101, v125
    v_add_f32 v102, v102, v126
    v_add_f32 v103, v103, v127
    v_cndmask_b32 v108, v88, v90, s[20:21]
    v_cndmask_b32 v109, v89, v91, s[20:21]
    v_cndmask_b32 v110, v90, v88, s[20:21]
    v_cndmask_b32 v111, v91, v89, s[20:21]
    v_cvt_pk_bf16_f32 v104, v96, v97
    v_lshlrev_b32 v96, 16, v104
    v_and_b32 v97, 0xffff0000, v104
    v_lshlrev_b32 v104, 16, v80
    v_and_b32 v105, 0xffff0000, v80
    v_mul_f32 v96, v96, v104
    v_mul_f32 v97, v97, v105
    v_cvt_pk_bf16_f32 v104, v96, v97
    v_lshlrev_b32 v96, 16, v104
    v_and_b32 v97, 0xffff0000, v104
    v_lshlrev_b32 v104, 16, v108
    v_and_b32 v105, 0xffff0000, v108
    v_add_f32 v96, v96, v104
    v_add_f32 v97, v97, v105
    v_cvt_pk_bf16_f32 v112, v96, v97
    v_cvt_pk_bf16_f32 v104, v98, v99
    v_lshlrev_b32 v98, 16, v104
    v_and_b32 v99, 0xffff0000, v104
    v_lshlrev_b32 v104, 16, v81
    v_and_b32 v105, 0xffff0000, v81
    v_mul_f32 v98, v98, v104
    v_mul_f32 v99, v99, v105
    v_cvt_pk_bf16_f32 v104, v98, v99
    v_lshlrev_b32 v98, 16, v104
    v_and_b32 v99, 0xffff0000, v104
    v_lshlrev_b32 v104, 16, v109
    v_and_b32 v105, 0xffff0000, v109
    v_add_f32 v98, v98, v104
    v_add_f32 v99, v99, v105
    v_cvt_pk_bf16_f32 v113, v98, v99
    v_cvt_pk_bf16_f32 v104, v100, v101
    v_lshlrev_b32 v100, 16, v104
    v_and_b32 v101, 0xffff0000, v104
    v_lshlrev_b32 v104, 16, v82
    v_and_b32 v105, 0xffff0000, v82
    v_mul_f32 v100, v100, v104
    v_mul_f32 v101, v101, v105
    v_cvt_pk_bf16_f32 v104, v100, v101
    v_lshlrev_b32 v100, 16, v104
    v_and_b32 v101, 0xffff0000, v104
    v_lshlrev_b32 v104, 16, v110
    v_and_b32 v105, 0xffff0000, v110
    v_add_f32 v100, v100, v104
    v_add_f32 v101, v101, v105
    v_cvt_pk_bf16_f32 v114, v100, v101
    v_cvt_pk_bf16_f32 v104, v102, v103
    v_lshlrev_b32 v102, 16, v104
    v_and_b32 v103, 0xffff0000, v104
    v_lshlrev_b32 v104, 16, v83
    v_and_b32 v105, 0xffff0000, v83
    v_mul_f32 v102, v102, v104
    v_mul_f32 v103, v103, v105
    v_cvt_pk_bf16_f32 v104, v102, v103
    v_lshlrev_b32 v102, 16, v104
    v_and_b32 v103, 0xffff0000, v104
    v_lshlrev_b32 v104, 16, v111
    v_and_b32 v105, 0xffff0000, v111
    v_add_f32 v102, v102, v104
    v_add_f32 v103, v103, v105
    v_cvt_pk_bf16_f32 v115, v102, v103
    v_cndmask_b32 v128, v112, v114, s[20:21]
    v_cndmask_b32 v129, v113, v115, s[20:21]
    v_cndmask_b32 v130, v114, v112, s[20:21]
    v_cndmask_b32 v131, v115, v113, s[20:21]
    buffer_store_dwordx4 v[128:131], v4, s[12:15], s18 offen offset:0
    v_lshlrev_b32 v96, 16, v48
    v_and_b32 v97, 0xffff0000, v48
    v_lshlrev_b32 v98, 16, v49
    v_and_b32 v99, 0xffff0000, v49
    v_lshlrev_b32 v100, 16, v50
    v_and_b32 v101, 0xffff0000, v50
    v_lshlrev_b32 v102, 16, v51
    v_and_b32 v103, 0xffff0000, v51
    v_lshlrev_b32 v120, 16, v52
    v_and_b32 v121, 0xffff0000, v52
    v_lshlrev_b32 v122, 16, v53
    v_and_b32 v123, 0xffff0000, v53
    v_lshlrev_b32 v124, 16, v54
    v_and_b32 v125, 0xffff0000, v54
    v_lshlrev_b32 v126, 16, v55
    v_and_b32 v127, 0xffff0000, v55
    v_add_f32 v96, v96, v120
    v_add_f32 v97, v97, v121
    v_add_f32 v98, v98, v122
    v_add_f32 v99, v99, v123
    v_add_f32 v100, v100, v124
    v_add_f32 v101, v101, v125
    v_add_f32 v102, v102, v126
    v_add_f32 v103, v103, v127
    v_lshlrev_b32 v120, 16, v56
    v_and_b32 v121, 0xffff0000, v56
    v_lshlrev_b32 v122, 16, v57
    v_and_b32 v123, 0xffff0000, v57
    v_lshlrev_b32 v124, 16, v58
    v_and_b32 v125, 0xffff0000, v58
    v_lshlrev_b32 v126, 16, v59
    v_and_b32 v127, 0xffff0000, v59
    v_add_f32 v96, v96, v120
    v_add_f32 v97, v97, v121
    v_add_f32 v98, v98, v122
    v_add_f32 v99, v99, v123
    v_add_f32 v100, v100, v124
    v_add_f32 v101, v101, v125
    v_add_f32 v102, v102, v126
    v_add_f32 v103, v103, v127
    v_lshlrev_b32 v120, 16, v60
    v_and_b32 v121, 0xffff0000, v60
    v_lshlrev_b32 v122, 16, v61
    v_and_b32 v123, 0xffff0000, v61
    v_lshlrev_b32 v124, 16, v62
    v_and_b32 v125, 0xffff0000, v62
    v_lshlrev_b32 v126, 16, v63
    v_and_b32 v127, 0xffff0000, v63
    v_add_f32 v96, v96, v120
    v_add_f32 v97, v97, v121
    v_add_f32 v98, v98, v122
    v_add_f32 v99, v99, v123
    v_add_f32 v100, v100, v124
    v_add_f32 v101, v101, v125
    v_add_f32 v102, v102, v126
    v_add_f32 v103, v103, v127
    v_lshlrev_b32 v120, 16, v64
    v_and_b32 v121, 0xffff0000, v64
    v_lshlrev_b32 v122, 16, v65
    v_and_b32 v123, 0xffff0000, v65
    v_lshlrev_b32 v124, 16, v66
    v_and_b32 v125, 0xffff0000, v66
    v_lshlrev_b32 v126, 16, v67
    v_and_b32 v127, 0xffff0000, v67
    v_add_f32 v96, v96, v120
    v_add_f32 v97, v97, v121
    v_add_f32 v98, v98, v122
    v_add_f32 v99, v99, v123
    v_add_f32 v100, v100, v124
    v_add_f32 v101, v101, v125
    v_add_f32 v102, v102, v126
    v_add_f32 v103, v103, v127
    v_lshlrev_b32 v120, 16, v68
    v_and_b32 v121, 0xffff0000, v68
    v_lshlrev_b32 v122, 16, v69
    v_and_b32 v123, 0xffff0000, v69
    v_lshlrev_b32 v124, 16, v70
    v_and_b32 v125, 0xffff0000, v70
    v_lshlrev_b32 v126, 16, v71
    v_and_b32 v127, 0xffff0000, v71
    v_add_f32 v96, v96, v120
    v_add_f32 v97, v97, v121
    v_add_f32 v98, v98, v122
    v_add_f32 v99, v99, v123
    v_add_f32 v100, v100, v124
    v_add_f32 v101, v101, v125
    v_add_f32 v102, v102, v126
    v_add_f32 v103, v103, v127
    v_lshlrev_b32 v120, 16, v72
    v_and_b32 v121, 0xffff0000, v72
    v_lshlrev_b32 v122, 16, v73
    v_and_b32 v123, 0xffff0000, v73
    v_lshlrev_b32 v124, 16, v74
    v_and_b32 v125, 0xffff0000, v74
    v_lshlrev_b32 v126, 16, v75
    v_and_b32 v127, 0xffff0000, v75
    v_add_f32 v96, v96, v120
    v_add_f32 v97, v97, v121
    v_add_f32 v98, v98, v122
    v_add_f32 v99, v99, v123
    v_add_f32 v100, v100, v124
    v_add_f32 v101, v101, v125
    v_add_f32 v102, v102, v126
    v_add_f32 v103, v103, v127
    v_lshlrev_b32 v120, 16, v76
    v_and_b32 v121, 0xffff0000, v76
    v_lshlrev_b32 v122, 16, v77
    v_and_b32 v123, 0xffff0000, v77
    v_lshlrev_b32 v124, 16, v78
    v_and_b32 v125, 0xffff0000, v78
    v_lshlrev_b32 v126, 16, v79
    v_and_b32 v127, 0xffff0000, v79
    v_add_f32 v96, v96, v120
    v_add_f32 v97, v97, v121
    v_add_f32 v98, v98, v122
    v_add_f32 v99, v99, v123
    v_add_f32 v100, v100, v124
    v_add_f32 v101, v101, v125
    v_add_f32 v102, v102, v126
    v_add_f32 v103, v103, v127
    v_cndmask_b32 v108, v92, v94, s[20:21]
    v_cndmask_b32 v109, v93, v95, s[20:21]
    v_cndmask_b32 v110, v94, v92, s[20:21]
    v_cndmask_b32 v111, v95, v93, s[20:21]
    v_cvt_pk_bf16_f32 v104, v96, v97
    v_lshlrev_b32 v96, 16, v104
    v_and_b32 v97, 0xffff0000, v104
    v_lshlrev_b32 v104, 16, v84
    v_and_b32 v105, 0xffff0000, v84
    v_mul_f32 v96, v96, v104
    v_mul_f32 v97, v97, v105
    v_cvt_pk_bf16_f32 v104, v96, v97
    v_lshlrev_b32 v96, 16, v104
    v_and_b32 v97, 0xffff0000, v104
    v_lshlrev_b32 v104, 16, v108
    v_and_b32 v105, 0xffff0000, v108
    v_add_f32 v96, v96, v104
    v_add_f32 v97, v97, v105
    v_cvt_pk_bf16_f32 v112, v96, v97
    v_cvt_pk_bf16_f32 v104, v98, v99
    v_lshlrev_b32 v98, 16, v104
    v_and_b32 v99, 0xffff0000, v104
    v_lshlrev_b32 v104, 16, v85
    v_and_b32 v105, 0xffff0000, v85
    v_mul_f32 v98, v98, v104
    v_mul_f32 v99, v99, v105
    v_cvt_pk_bf16_f32 v104, v98, v99
    v_lshlrev_b32 v98, 16, v104
    v_and_b32 v99, 0xffff0000, v104
    v_lshlrev_b32 v104, 16, v109
    v_and_b32 v105, 0xffff0000, v109
    v_add_f32 v98, v98, v104
    v_add_f32 v99, v99, v105
    v_cvt_pk_bf16_f32 v113, v98, v99
    v_cvt_pk_bf16_f32 v104, v100, v101
    v_lshlrev_b32 v100, 16, v104
    v_and_b32 v101, 0xffff0000, v104
    v_lshlrev_b32 v104, 16, v86
    v_and_b32 v105, 0xffff0000, v86
    v_mul_f32 v100, v100, v104
    v_mul_f32 v101, v101, v105
    v_cvt_pk_bf16_f32 v104, v100, v101
    v_lshlrev_b32 v100, 16, v104
    v_and_b32 v101, 0xffff0000, v104
    v_lshlrev_b32 v104, 16, v110
    v_and_b32 v105, 0xffff0000, v110
    v_add_f32 v100, v100, v104
    v_add_f32 v101, v101, v105
    v_cvt_pk_bf16_f32 v114, v100, v101
    v_cvt_pk_bf16_f32 v104, v102, v103
    v_lshlrev_b32 v102, 16, v104
    v_and_b32 v103, 0xffff0000, v104
    v_lshlrev_b32 v104, 16, v87
    v_and_b32 v105, 0xffff0000, v87
    v_mul_f32 v102, v102, v104
    v_mul_f32 v103, v103, v105
    v_cvt_pk_bf16_f32 v104, v102, v103
    v_lshlrev_b32 v102, 16, v104
    v_and_b32 v103, 0xffff0000, v104
    v_lshlrev_b32 v104, 16, v111
    v_and_b32 v105, 0xffff0000, v111
    v_add_f32 v102, v102, v104
    v_add_f32 v103, v103, v105
    v_cvt_pk_bf16_f32 v115, v102, v103
    v_cndmask_b32 v132, v112, v114, s[20:21]
    v_cndmask_b32 v133, v113, v115, s[20:21]
    v_cndmask_b32 v134, v114, v112, s[20:21]
    v_cndmask_b32 v135, v115, v113, s[20:21]
    buffer_store_dwordx4 v[132:135], v4, s[12:15], s18 offen offset:64
    s_add_u32 s24, s24, 32
    s_cmp_lt_u32 s24, 61
    s_cbranch_scc1 fin_job
    s_cmp_ge_u32 s63, 48
    s_cbranch_scc1 k_end
    s_lshr_b32 s24, s63, 4
    s_sub_u32 s24, 63, s24
    s_and_b32 s25, s63, 15
    s_lshl_b32 s25, s25, 2
    s_and_b32 s26, s3, 3
    s_add_u32 s25, s25, s26
    s_lshr_b32 s26, s25, 5
    s_and_b32 s25, s25, 31
    s_lshl_b32 s16, s24, 1
    s_add_u32 s16, s16, s26
    s_lshl_b32 s18, s16, 15
    s_lshl_b32 s17, s25, 10
    s_add_u32 s17, s17, s18
    s_lshl_b32 s19, s25, 6
    s_add_u32 s18, s18, s19
    s_add_u32 s22, s17, 167772160
    s_add_u32 s23, s17, 75497472
    s_mov_b32 s27, 218106816
    s_mov_b32 s30, 218112000
    s_mov_b32 s28, 65536
    v_and_b32 v8, 7, v1
    v_lshlrev_b32 v8, 22, v8
    s_cmp_lg_u32 s3, 0
    s_cbranch_scc1 ft_ok
ft_wd:
    buffer_load_dword v7, off, s[4:7], s27 sc1
    s_waitcnt vmcnt(0)
    v_readfirstlane_b32 s31, v7
    s_cmp_ge_u32 s31, 16
    s_cbranch_scc1 ft_ws
    s_sleep 127
    s_sub_u32 s28, s28, 1
    s_cbranch_scc0 ft_wd
    s_mov_b32 s28, 0
ft_ws:
    buffer_load_dword v7, v6, s[4:7], s30 offen sc1
    s_waitcnt vmcnt(0)
    v_cmp_gt_u32 vcc, 61, v7
    s_cbranch_vccz ft_ok
    s_sleep 12
    v_cmp_gt_u32 vcc, 59, v7
    s_cbranch_vccz ft_wsf
    s_sleep 64
    v_cmp_gt_u32 vcc, 56, v7
    s_cbranch_vccz ft_wsf
    s_sleep 127
    s_sleep 127
ft_wsf:
    s_sub_u32 s28, s28, 1
    s_cbranch_scc0 ft_ws
    s_mov_b32 s28, 0
ft_ok:
    s_barrier
    s_cmp_ge_u32 s3, 4
    s_cbranch_scc1 k_end
    buffer_load_dwordx4 v[88:91], v4, s[8:11], s18 offen
    buffer_load_dwordx4 v[144:147], v3, s[4:7], s22 offen offset:0 sc1
    s_add_u32 s22, s22, 4194304
    buffer_load_dwordx4 v[148:151], v3, s[4:7], s22 offen offset:0 sc1
    s_add_u32 s22, s22, 4194304
    buffer_load_dwordx4 v[152:155], v3, s[4:7], s22 offen offset:0 sc1
    s_add_u32 s22, s22, 4194304
    buffer_load_dwordx4 v[156:159], v3, s[4:7], s22 offen offset:0 sc1
    s_waitcnt vmcnt(0)
    v_lshlrev_b32 v96, 16, v144
    v_and_b32 v97, 0xffff0000, v144
    v_lshlrev_b32 v98, 16, v145
    v_and_b32 v99, 0xffff0000, v145
    v_lshlrev_b32 v100, 16, v146
    v_and_b32 v101, 0xffff0000, v146
    v_lshlrev_b32 v102, 16, v147
    v_and_b32 v103, 0xffff0000, v147
    v_lshlrev_b32 v120, 16, v148
    v_and_b32 v121, 0xffff0000, v148
    v_lshlrev_b32 v122, 16, v149
    v_and_b32 v123, 0xffff0000, v149
    v_lshlrev_b32 v124, 16, v150
    v_and_b32 v125, 0xffff0000, v150
    v_lshlrev_b32 v126, 16, v151
    v_and_b32 v127, 0xffff0000, v151
    v_add_f32 v96, v96, v120
    v_add_f32 v97, v97, v121
    v_add_f32 v98, v98, v122
    v_add_f32 v99, v99, v123
    v_add_f32 v100, v100, v124
    v_add_f32 v101, v101, v125
    v_add_f32 v102, v102, v126
    v_add_f32 v103, v103, v127
    v_lshlrev_b32 v120, 16, v152
    v_and_b32 v121, 0xffff0000, v152
    v_lshlrev_b32 v122, 16, v153
    v_and_b32 v123, 0xffff0000, v153
    v_lshlrev_b32 v124, 16, v154
    v_and_b32 v125, 0xffff0000, v154
    v_lshlrev_b32 v126, 16, v155
    v_and_b32 v127, 0xffff0000, v155
    v_add_f32 v96, v96, v120
    v_add_f32 v97, v97, v121
    v_add_f32 v98, v98, v122
    v_add_f32 v99, v99, v123
    v_add_f32 v100, v100, v124
    v_add_f32 v101, v101, v125
    v_add_f32 v102, v102, v126
    v_add_f32 v103, v103, v127
    v_lshlrev_b32 v120, 16, v156
    v_and_b32 v121, 0xffff0000, v156
    v_lshlrev_b32 v122, 16, v157
    v_and_b32 v123, 0xffff0000, v157
    v_lshlrev_b32 v124, 16, v158
    v_and_b32 v125, 0xffff0000, v158
    v_lshlrev_b32 v126, 16, v159
    v_and_b32 v127, 0xffff0000, v159
    v_add_f32 v96, v96, v120
    v_add_f32 v97, v97, v121
    v_add_f32 v98, v98, v122
    v_add_f32 v99, v99, v123
    v_add_f32 v100, v100, v124
    v_add_f32 v101, v101, v125
    v_add_f32 v102, v102, v126
    v_add_f32 v103, v103, v127
    v_cvt_pk_bf16_f32 v120, v96, v97
    v_cvt_pk_bf16_f32 v121, v98, v99
    v_cvt_pk_bf16_f32 v122, v100, v101
    v_cvt_pk_bf16_f32 v123, v102, v103
    v_lshlrev_b32 v96, 16, v120
    v_and_b32 v97, 0xffff0000, v120
    v_lshlrev_b32 v98, 16, v121
    v_and_b32 v99, 0xffff0000, v121
    v_lshlrev_b32 v100, 16, v122
    v_and_b32 v101, 0xffff0000, v122
    v_lshlrev_b32 v102, 16, v123
    v_and_b32 v103, 0xffff0000, v123
    v_mul_f32 v104, 0xbfb8aa3b, v96
    v_mul_f32 v105, 0xbfb8aa3b, v97
    v_mul_f32 v106, 0xbfb8aa3b, v98
    v_mul_f32 v107, 0xbfb8aa3b, v99
    v_mul_f32 v108, 0xbfb8aa3b, v100
    v_mul_f32 v109, 0xbfb8aa3b, v101
    v_mul_f32 v110, 0xbfb8aa3b, v102
    v_mul_f32 v111, 0xbfb8aa3b, v103
    v_exp_f32 v104, v104
    v_exp_f32 v105, v105
    v_exp_f32 v106, v106
    v_exp_f32 v107, v107
    v_exp_f32 v108, v108
    v_exp_f32 v109, v109
    v_exp_f32 v110, v110
    v_exp_f32 v111, v111
    v_add_f32 v104, 1.0, v104
    v_add_f32 v105, 1.0, v105
    v_add_f32 v106, 1.0, v106
    v_add_f32 v107, 1.0, v107
    v_add_f32 v108, 1.0, v108
    v_add_f32 v109, 1.0, v109
    v_add_f32 v110, 1.0, v110
    v_add_f32 v111, 1.0, v111
    v_rcp_f32 v104, v104
    v_rcp_f32 v105, v105
    v_rcp_f32 v106, v106
    v_rcp_f32 v107, v107
    v_rcp_f32 v108, v108
    v_rcp_f32 v109, v109
    v_rcp_f32 v110, v110
    v_rcp_f32 v111, v111
    v_mul_f32 v96, v96, v104
    v_mul_f32 v97, v97, v105
    v_mul_f32 v98, v98, v106
    v_mul_f32 v99, v99, v107
    v_mul_f32 v100, v100, v108
    v_mul_f32 v101, v101, v109
    v_mul_f32 v102, v102, v110
    v_mul_f32 v103, v103, v111
    v_cvt_pk_bf16_f32 v80, v96, v97
    v_cvt_pk_bf16_f32 v81, v98, v99
    v_cvt_pk_bf16_f32 v82, v100, v101
    v_cvt_pk_bf16_f32 v83, v102, v103
    s_cmp_eq_u32 s24, 63
    s_cbranch_scc1 ft_p63
ft_p:
    buffer_load_dword v7, v8, s[4:7], s23 offen offset:1020 sc1
    s_waitcnt vmcnt(0)
    v_cmp_eq_u32 vcc, -1, v7
    s_cbranch_vccz ft_l
    s_sleep 4
    s_sub_u32 s28, s28, 1
    s_cbranch_scc0 ft_p
    s_mov_b32 s28, 0
ft_l:
    s_mov_b32 s31, s23
    buffer_load_dwordx4 v[16:19], v3, s[4:7], s31 offen sc1
    s_add_u32 s31, s31, 4194304
    buffer_load_dwordx4 v[20:23], v3, s[4:7], s31 offen sc1
    s_add_u32 s31, s31, 4194304
    buffer_load_dwordx4 v[24:27], v3, s[4:7], s31 offen sc1
    s_add_u32 s31, s31, 4194304
    buffer_load_dwordx4 v[28:31], v3, s[4:7], s31 offen sc1
    s_add_u32 s31, s31, 4194304
    buffer_load_dwordx4 v[32:35], v3, s[4:7], s31 offen sc1
    s_add_u32 s31, s31, 4194304
    buffer_load_dwordx4 v[36:39], v3, s[4:7], s31 offen sc1
    s_add_u32 s31, s31, 4194304
    buffer_load_dwordx4 v[40:43], v3, s[4:7], s31 offen sc1
    s_add_u32 s31, s31, 4194304
    buffer_load_dwordx4 v[44:47], v3, s[4:7], s31 offen sc1
    s_waitcnt vmcnt(0)
    v_max3_u32 v7, v16, v17, v18
    v_max3_u32 v7, v7, v19, v20
    v_max3_u32 v7, v7, v21, v22
    v_max3_u32 v7, v7, v23, v24
    v_max3_u32 v7, v7, v25, v26
    v_max3_u32 v7, v7, v27, v28
    v_max3_u32 v7, v7, v29, v30
    v_max3_u32 v7, v7, v31, v32
    v_max3_u32 v7, v7, v33, v34
    v_max3_u32 v7, v7, v35, v36
    v_max3_u32 v7, v7, v37, v38
    v_max3_u32 v7, v7, v39, v40
    v_max3_u32 v7, v7, v41, v42
    v_max3_u32 v7, v7, v43, v44
    v_max3_u32 v7, v7, v45, v46
    v_max_u32 v7, v7, v47
    v_cmp_eq_u32 vcc, -1, v7
    s_cbranch_vccz ft_go
    s_sleep 2
    s_sub_u32 s28, s28, 1
    s_cbranch_scc0 ft_l
    s_branch ft_go
ft_p63:
    s_sub_u32 s31, s23, 65536
    buffer_load_dword v7, v8, s[4:7], s31 offen offset:1020 sc1
    s_waitcnt vmcnt(0)
    v_cmp_eq_u32 vcc, -1, v7
    s_cbranch_vccz ft_l
    s_sleep 4
    s_sub_u32 s28, s28, 1
    s_cbranch_scc0 ft_p63
    s_mov_b32 s28, 0
    s_branch ft_l
ft_go:
    v_lshlrev_b32 v96, 16, v16
    v_and_b32 v97, 0xffff0000, v16
    v_lshlrev_b32 v98, 16, v17
    v_and_b32 v99, 0xffff0000, v17
    v_lshlrev_b32 v100, 16, v18
    v_and_b32 v101, 0xffff0000, v18
    v_lshlrev_b32 v102, 16, v19
    v_and_b32 v103, 0xffff0000, v19
    v_lshlrev_b32 v120, 16, v20
    v_and_b32 v121, 0xffff0000, v20
    v_lshlrev_b32 v122, 16, v21
    v_and_b32 v123, 0xffff0000, v21
    v_lshlrev_b32 v124, 16, v22
    v_and_b32 v125, 0xffff0000, v22
    v_lshlrev_b32 v126, 16, v23
    v_and_b32 v127, 0xffff0000, v23
    v_add_f32 v96, v96, v120
    v_add_f32 v97, v97, v121
    v_add_f32 v98, v98, v122
    v_add_f32 v99, v99, v123
    v_add_f32 v100, v100, v124
    v_add_f32 v101, v101, v125
    v_add_f32 v102, v102, v126
    v_add_f32 v103, v103, v127
    v_lshlrev_b32 v120, 16, v24
    v_and_b32 v121, 0xffff0000, v24
    v_lshlrev_b32 v122, 16, v25
    v_and_b32 v123, 0xffff0000, v25
    v_lshlrev_b32 v124, 16, v26
    v_and_b32 v125, 0xffff0000, v26
    v_lshlrev_b32 v126, 16, v27
    v_and_b32 v127, 0xffff0000, v27
    v_add_f32 v96, v96, v120
    v_add_f32 v97, v97, v121
    v_add_f32 v98, v98, v122
    v_add_f32 v99, v99, v123
    v_add_f32 v100, v100, v124
    v_add_f32 v101, v101, v125
    v_add_f32 v102, v102, v126
    v_add_f32 v103, v103, v127
    v_lshlrev_b32 v120, 16, v28
    v_and_b32 v121, 0xffff0000, v28
    v_lshlrev_b32 v122, 16, v29
    v_and_b32 v123, 0xffff0000, v29
    v_lshlrev_b32 v124, 16, v30
    v_and_b32 v125, 0xffff0000, v30
    v_lshlrev_b32 v126, 16, v31
    v_and_b32 v127, 0xffff0000, v31
    v_add_f32 v96, v96, v120
    v_add_f32 v97, v97, v121
    v_add_f32 v98, v98, v122
    v_add_f32 v99, v99, v123
    v_add_f32 v100, v100, v124
    v_add_f32 v101, v101, v125
    v_add_f32 v102, v102, v126
    v_add_f32 v103, v103, v127
    v_lshlrev_b32 v120, 16, v32
    v_and_b32 v121, 0xffff0000, v32
    v_lshlrev_b32 v122, 16, v33
    v_and_b32 v123, 0xffff0000, v33
    v_lshlrev_b32 v124, 16, v34
    v_and_b32 v125, 0xffff0000, v34
    v_lshlrev_b32 v126, 16, v35
    v_and_b32 v127, 0xffff0000, v35
    v_add_f32 v96, v96, v120
    v_add_f32 v97, v97, v121
    v_add_f32 v98, v98, v122
    v_add_f32 v99, v99, v123
    v_add_f32 v100, v100, v124
    v_add_f32 v101, v101, v125
    v_add_f32 v102, v102, v126
    v_add_f32 v103, v103, v127
    v_lshlrev_b32 v120, 16, v36
    v_and_b32 v121, 0xffff0000, v36
    v_lshlrev_b32 v122, 16, v37
    v_and_b32 v123, 0xffff0000, v37
    v_lshlrev_b32 v124, 16, v38
    v_and_b32 v125, 0xffff0000, v38
    v_lshlrev_b32 v126, 16, v39
    v_and_b32 v127, 0xffff0000, v39
    v_add_f32 v96, v96, v120
    v_add_f32 v97, v97, v121
    v_add_f32 v98, v98, v122
    v_add_f32 v99, v99, v123
    v_add_f32 v100, v100, v124
    v_add_f32 v101, v101, v125
    v_add_f32 v102, v102, v126
    v_add_f32 v103, v103, v127
    v_lshlrev_b32 v120, 16, v40
    v_and_b32 v121, 0xffff0000, v40
    v_lshlrev_b32 v122, 16, v41
    v_and_b32 v123, 0xffff0000, v41
    v_lshlrev_b32 v124, 16, v42
    v_and_b32 v125, 0xffff0000, v42
    v_lshlrev_b32 v126, 16, v43
    v_and_b32 v127, 0xffff0000, v43
    v_add_f32 v96, v96, v120
    v_add_f32 v97, v97, v121
    v_add_f32 v98, v98, v122
    v_add_f32 v99, v99, v123
    v_add_f32 v100, v100, v124
    v_add_f32 v101, v101, v125
    v_add_f32 v102, v102, v126
    v_add_f32 v103, v103, v127
    v_lshlrev_b32 v120, 16, v44
    v_and_b32 v121, 0xffff0000, v44
    v_lshlrev_b32 v122, 16, v45
    v_and_b32 v123, 0xffff0000, v45
    v_lshlrev_b32 v124, 16, v46
    v_and_b32 v125, 0xffff0000, v46
    v_lshlrev_b32 v126, 16, v47
    v_and_b32 v127, 0xffff0000, v47
    v_add_f32 v96, v96, v120
    v_add_f32 v97, v97, v121
    v_add_f32 v98, v98, v122
    v_add_f32 v99, v99, v123
    v_add_f32 v100, v100, v124
    v_add_f32 v101, v101, v125
    v_add_f32 v102, v102, v126
    v_add_f32 v103, v103, v127
    v_cndmask_b32 v108, v88, v90, s[20:21]
    v_cndmask_b32 v109, v89, v91, s[20:21]
    v_cndmask_b32 v110, v90, v88, s[20:21]
    v_cndmask_b32 v111, v91, v89, s[20:21]
    v_cvt_pk_bf16_f32 v104, v96, v97
    v_lshlrev_b32 v96, 16, v104
    v_and_b32 v97, 0xffff0000, v104
    v_lshlrev_b32 v104, 16, v80
    v_and_b32 v105, 0xffff0000, v80
    v_mul_f32 v96, v96, v104
    v_mul_f32 v97, v97, v105
    v_cvt_pk_bf16_f32 v104, v96, v97
    v_lshlrev_b32 v96, 16, v104
    v_and_b32 v97, 0xffff0000, v104
    v_lshlrev_b32 v104, 16, v108
    v_and_b32 v105, 0xffff0000, v108
    v_add_f32 v96, v96, v104
    v_add_f32 v97, v97, v105
    v_cvt_pk_bf16_f32 v112, v96, v97
    v_cvt_pk_bf16_f32 v104, v98, v99
    v_lshlrev_b32 v98, 16, v104
    v_and_b32 v99, 0xffff0000, v104
    v_lshlrev_b32 v104, 16, v81
    v_and_b32 v105, 0xffff0000, v81
    v_mul_f32 v98, v98, v104
    v_mul_f32 v99, v99, v105
    v_cvt_pk_bf16_f32 v104, v98, v99
    v_lshlrev_b32 v98, 16, v104
    v_and_b32 v99, 0xffff0000, v104
    v_lshlrev_b32 v104, 16, v109
    v_and_b32 v105, 0xffff0000, v109
    v_add_f32 v98, v98, v104
    v_add_f32 v99, v99, v105
    v_cvt_pk_bf16_f32 v113, v98, v99
    v_cvt_pk_bf16_f32 v104, v100, v101
    v_lshlrev_b32 v100, 16, v104
    v_and_b32 v101, 0xffff0000, v104
    v_lshlrev_b32 v104, 16, v82
    v_and_b32 v105, 0xffff0000, v82
    v_mul_f32 v100, v100, v104
    v_mul_f32 v101, v101, v105
    v_cvt_pk_bf16_f32 v104, v100, v101
    v_lshlrev_b32 v100, 16, v104
    v_and_b32 v101, 0xffff0000, v104
    v_lshlrev_b32 v104, 16, v110
    v_and_b32 v105, 0xffff0000, v110
    v_add_f32 v100, v100, v104
    v_add_f32 v101, v101, v105
    v_cvt_pk_bf16_f32 v114, v100, v101
    v_cvt_pk_bf16_f32 v104, v102, v103
    v_lshlrev_b32 v102, 16, v104
    v_and_b32 v103, 0xffff0000, v104
    v_lshlrev_b32 v104, 16, v83
    v_and_b32 v105, 0xffff0000, v83
    v_mul_f32 v102, v102, v104
    v_mul_f32 v103, v103, v105
    v_cvt_pk_bf16_f32 v104, v102, v103
    v_lshlrev_b32 v102, 16, v104
    v_and_b32 v103, 0xffff0000, v104
    v_lshlrev_b32 v104, 16, v111
    v_and_b32 v105, 0xffff0000, v111
    v_add_f32 v102, v102, v104
    v_add_f32 v103, v103, v105
    v_cvt_pk_bf16_f32 v115, v102, v103
    v_cndmask_b32 v128, v112, v114, s[20:21]
    v_cndmask_b32 v129, v113, v115, s[20:21]
    v_cndmask_b32 v130, v114, v112, s[20:21]
    v_cndmask_b32 v131, v115, v113, s[20:21]
    buffer_store_dwordx4 v[128:131], v4, s[12:15], s18 offen offset:0
    s_branch k_end
chain_map:
    s_and_b32 s14, s12, 1
    s_lshl_b32 s13, s13, 1
    s_lshr_b32 s15, s12, 1
    s_add_u32 s12, s13, s14
    s_mov_b32 s13, s15
    s_lshl_b32 s2, s13, 3
    s_add_u32 s2, s2, s12
    s_lshr_b32 s14, s13, 2
    s_and_b32 s15, s13, 3
    s_mov_b32 s16, 0
    s_mov_b32 s17, 209715200
    s_mov_b32 s18, 209977344
    s_mov_b32 s19, 210239488
    s_mov_b32 s20, 210501632
    s_mov_b32 s26, 131072
    s_mov_b32 s68, 0
    s_getreg_b32 s29, hwreg(HW_REG_XCC_ID)
    s_and_b32 s29, s29, 15
    s_mul_i32 s23, s29, s29
    s_lshl_b32 s23, s23, 18
    s_lshl_b32 s29, s29, 8
    s_add_u32 s29, s29, s23
    s_add_u32 s29, s29, 1
    s_lshr_b32 s28, s12, 1
    s_lshl_b32 s28, s28, 2
    s_add_u32 s28, s28, 128
    s_cmp_ge_u32 s3, 4
    s_cbranch_scc1 ch_a_pro
    s_lshl_b32 s32, s12, 15
    s_lshl_b32 s21, s14, 13
    s_add_u32 s32, s32, s21
    s_lshl_b32 s21, s15, 10
    s_add_u32 s32, s32, s21
    s_add_u32 s32, s32, 2097152
    s_lshr_b32 s33, s12, 1
    s_lshl_b32 s33, s33, 14
    s_add_u32 s33, s33, 1048576
    s_lshl_b32 s21, s13, 10
    s_add_u32 s36, s33, s21
    s_lshl_b32 s21, s3, 12
    s_add_u32 s33, s33, s21
    s_lshl_b32 s34, s13, 14
    s_lshl_b32 s21, s12, 10
    s_add_u32 s35, s34, s21
    s_lshl_b32 s37, s12, 22
    s_lshl_b32 s21, s13, 11
    s_add_u32 s37, s37, s21
    s_and_b32 s21, s3, 1
    s_lshl_b32 s21, s21, 15
    s_add_u32 s37, s37, s21
    s_lshr_b32 s21, s3, 1
    s_lshl_b32 s21, s21, 10
    s_add_u32 s37, s37, s21
    s_add_u32 s37, s37, 75497472
    v_and_b32 v20, 63, v0
    v_lshlrev_b32 v1, 4, v20
    v_mov_b32 v10, -1
    v_mov_b32 v11, -1
    v_lshrrev_b32 v21, 2, v20
    v_and_b32 v22, 3, v20
    v_lshlrev_b32 v21, 13, v21
    v_lshl_add_u32 v21, v22, 4, v21
    s_lshl_b32 s21, s3, 21
    s_lshl_b32 s22, s12, 10
    s_add_u32 s21, s21, s22
    s_lshl_b32 s23, s3, 15
    s_mov_b32 s10, 8388608
    s_mov_b32 s11, 131072
    v_lshrrev_b32 v24, 4, v20
    v_bfe_u32 v25, v20, 2, 2
    v_lshl_add_u32 v24, v24, 4, v25
    v_lshlrev_b32 v24, 6, v24
    v_lshl_add_u32 v24, v22, 3, v24
    v_add_u32 v24, s23, v24
    s_and_b32 s70, s13, 1
    s_lshl_b32 s71, s12, 4
    s_add_u32 s71, s71, s13
    s_cmp_eq_u32 s71, 127
    s_cselect_b32 s70, 1, 0
    s_cmp_eq_u32 s13, 7
    s_cselect_b32 s70, 1, s70
    s_lshl_b32 s72, s70, 20
    s_lshl_b32 s73, s70, 21
    s_lshl_b32 s70, s70, 13
    s_sub_u32 s71, s23, s70
    s_add_u32 s70, s23, s70
    s_load_dwordx2 s[8:9], s[0:1], 16
    s_lshl_b32 s25, s13, 6
    s_add_u32 s24, s21, s25
    s_add_u32 s24, s24, s72
    s_waitcnt lgkmcnt(0)
    s_add_u32 m0, s70, 0
    s_nop 0
    buffer_load_dwordx4 v21, s[8:11], s24 offen lds
    s_add_u32 s24, s24, 131072
    s_add_u32 m0, s70, 1024
    s_nop 0
    buffer_load_dwordx4 v21, s[8:11], s24 offen lds
    s_add_u32 s24, s24, 131072
    s_add_u32 m0, s70, 2048
    s_nop 0
    buffer_load_dwordx4 v21, s[8:11], s24 offen lds
    s_add_u32 s24, s24, 131072
    s_add_u32 m0, s70, 3072
    s_nop 0
    buffer_load_dwordx4 v21, s[8:11], s24 offen lds
    s_add_u32 s24, s24, 131072
    s_add_u32 m0, s70, 4096
    s_nop 0
    buffer_load_dwordx4 v21, s[8:11], s24 offen lds
    s_add_u32 s24, s24, 131072
    s_add_u32 m0, s70, 5120
    s_nop 0
    buffer_load_dwordx4 v21, s[8:11], s24 offen lds
    s_add_u32 s24, s24, 131072
    s_add_u32 m0, s70, 6144
    s_nop 0
    buffer_load_dwordx4 v21, s[8:11], s24 offen lds
    s_add_u32 s24, s24, 131072
    s_add_u32 m0, s70, 7168
    s_nop 0
    buffer_load_dwordx4 v21, s[8:11], s24 offen lds
    s_add_u32 s24, s24, 131072
    s_sub_u32 s24, s24, s73
    s_add_u32 m0, s71, 8192
    s_nop 0
    buffer_load_dwordx4 v21, s[8:11], s24 offen lds
    s_add_u32 s24, s24, 131072
    s_add_u32 m0, s71, 9216
    s_nop 0
    buffer_load_dwordx4 v21, s[8:11], s24 offen lds
    s_add_u32 s24, s24, 131072
    s_add_u32 m0, s71, 10240
    s_nop 0
    buffer_load_dwordx4 v21, s[8:11], s24 offen lds
    s_add_u32 s24, s24, 131072
    s_add_u32 m0, s71, 11264
    s_nop 0
    buffer_load_dwordx4 v21, s[8:11], s24 offen lds
    s_add_u32 s24, s24, 131072
    s_add_u32 m0, s71, 12288
    s_nop 0
    buffer_load_dwordx4 v21, s[8:11], s24 offen lds
    s_add_u32 s24, s24, 131072
    s_add_u32 m0, s71, 13312
    s_nop 0
    buffer_load_dwordx4 v21, s[8:11], s24 offen lds
    s_add_u32 s24, s24, 131072
    s_add_u32 m0, s71, 14336
    s_nop 0
    buffer_load_dwordx4 v21, s[8:11], s24 offen lds
    s_add_u32 s24, s24, 131072
    s_add_u32 m0, s71, 15360
    s_nop 0
    buffer_load_dwordx4 v21, s[8:11], s24 offen lds
    s_add_u32 s24, s24, 131072
    s_load_dwordx2 s[8:9], s[0:1], 24
    s_lshl_b32 s25, s13, 6
    s_add_u32 s24, s21, s25
    s_add_u32 s24, s24, s72
    s_waitcnt lgkmcnt(0)
    s_add_u32 m0, s70, 16384
    s_nop 0
    buffer_load_dwordx4 v21, s[8:11], s24 offen lds
    s_add_u32 s24, s24, 131072
    s_add_u32 m0, s70, 17408
    s_nop 0
    buffer_load_dwordx4 v21, s[8:11], s24 offen lds
    s_add_u32 s24, s24, 131072
    s_add_u32 m0, s70, 18432
    s_nop 0
    buffer_load_dwordx4 v21, s[8:11], s24 offen lds
    s_add_u32 s24, s24, 131072
    s_add_u32 m0, s70, 19456
    s_nop 0
    buffer_load_dwordx4 v21, s[8:11], s24 offen lds
    s_add_u32 s24, s24, 131072
    s_add_u32 m0, s70, 20480
    s_nop 0
    buffer_load_dwordx4 v21, s[8:11], s24 offen lds
    s_add_u32 s24, s24, 131072
    s_add_u32 m0, s70, 21504
    s_nop 0
    buffer_load_dwordx4 v21, s[8:11], s24 offen lds
    s_add_u32 s24, s24, 131072
    s_add_u32 m0, s70, 22528
    s_nop 0
    buffer_load_dwordx4 v21, s[8:11], s24 offen lds
    s_add_u32 s24, s24, 131072
    s_add_u32 m0, s70, 23552
    s_nop 0
    buffer_load_dwordx4 v21, s[8:11], s24 offen lds
    s_add_u32 s24, s24, 131072
    s_sub_u32 s24, s24, s73
    s_add_u32 m0, s71, 24576
    s_nop 0
    buffer_load_dwordx4 v21, s[8:11], s24 offen lds
    s_add_u32 s24, s24, 131072
    s_add_u32 m0, s71, 25600
    s_nop 0
    buffer_load_dwordx4 v21, s[8:11], s24 offen lds
    s_add_u32 s24, s24, 131072
    s_add_u32 m0, s71, 26624
    s_nop 0
    buffer_load_dwordx4 v21, s[8:11], s24 offen lds
    s_add_u32 s24, s24, 131072
    s_add_u32 m0, s71, 27648
    s_nop 0
    buffer_load_dwordx4 v21, s[8:11], s24 offen lds
    s_add_u32 s24, s24, 131072
    s_add_u32 m0, s71, 28672
    s_nop 0
    buffer_load_dwordx4 v21, s[8:11], s24 offen lds
    s_add_u32 s24, s24, 131072
    s_add_u32 m0, s71, 29696
    s_nop 0
    buffer_load_dwordx4 v21, s[8:11], s24 offen lds
    s_add_u32 s24, s24, 131072
    s_add_u32 m0, s71, 30720
    s_nop 0
    buffer_load_dwordx4 v21, s[8:11], s24 offen lds
    s_add_u32 s24, s24, 131072
    s_add_u32 m0, s71, 31744
    s_nop 0
    buffer_load_dwordx4 v21, s[8:11], s24 offen lds
    s_add_u32 s24, s24, 131072
    s_load_dwordx2 s[8:9], s[0:1], 32
    s_lshl_b32 s25, s13, 6
    s_add_u32 s24, s21, s25
    s_add_u32 s24, s24, s72
    s_waitcnt lgkmcnt(0)
    buffer_load_dwordx4 v[96:99], v21, s[8:11], s24 offen
    s_add_u32 s24, s24, 131072
    buffer_load_dwordx4 v[100:103], v21, s[8:11], s24 offen
    s_add_u32 s24, s24, 131072
    buffer_load_dwordx4 v[104:107], v21, s[8:11], s24 offen
    s_add_u32 s24, s24, 131072
    buffer_load_dwordx4 v[108:111], v21, s[8:11], s24 offen
    s_add_u32 s24, s24, 131072
    buffer_load_dwordx4 v[144:147], v21, s[8:11], s24 offen
    s_add_u32 s24, s24, 131072
    buffer_load_dwordx4 v[148:151], v21, s[8:11], s24 offen
    s_add_u32 s24, s24, 131072
    buffer_load_dwordx4 v[152:155], v21, s[8:11], s24 offen
    s_add_u32 s24, s24, 131072
    buffer_load_dwordx4 v[156:159], v21, s[8:11], s24 offen
    s_add_u32 s24, s24, 131072
    s_sub_u32 s24, s24, s73
    buffer_load_dwordx4 v[192:195], v21, s[8:11], s24 offen
    s_add_u32 s24, s24, 131072
    buffer_load_dwordx4 v[196:199], v21, s[8:11], s24 offen
    s_add_u32 s24, s24, 131072
    buffer_load_dwordx4 v[200:203], v21, s[8:11], s24 offen
    s_add_u32 s24, s24, 131072
    buffer_load_dwordx4 v[204:207], v21, s[8:11], s24 offen
    s_add_u32 s24, s24, 131072
    buffer_load_dwordx4 v[240:243], v21, s[8:11], s24 offen
    s_add_u32 s24, s24, 131072
    buffer_load_dwordx4 v[244:247], v21, s[8:11], s24 offen
    s_add_u32 s24, s24, 131072
    buffer_load_dwordx4 v[248:251], v21, s[8:11], s24 offen
    s_add_u32 s24, s24, 131072
    buffer_load_dwordx4 v[252:255], v21, s[8:11], s24 offen
    s_add_u32 s24, s24, 131072
    s_load_dwordx2 s[8:9], s[0:1], 8
    s_mov_b32 s10, 16384
    v_bfe_u32 v57, v20, 4, 1
    v_lshrrev_b32 v58, 5, v20
    v_and_b32 v59, 1, v20
    v_bfe_u32 v60, v20, 1, 3
    v_lshlrev_b32 v60, 11, v60
    v_lshl_add_u32 v60, v57, 6, v60
    v_lshl_add_u32 v60, v58, 4, v60
    v_lshl_add_u32 v15, v59, 2, v60
    s_lshl_b32 s24, s3, 9
    s_waitcnt lgkmcnt(0)
    buffer_load_dword v32, v15, s[8:11], s24 offen offset:0
    buffer_load_dword v33, v15, s[8:11], s24 offen offset:8
    buffer_load_dword v34, v15, s[8:11], s24 offen offset:32
    buffer_load_dword v35, v15, s[8:11], s24 offen offset:40
    buffer_load_dword v36, v15, s[8:11], s24 offen offset:128
    buffer_load_dword v37, v15, s[8:11], s24 offen offset:136
    buffer_load_dword v38, v15, s[8:11], s24 offen offset:160
    buffer_load_dword v39, v15, s[8:11], s24 offen offset:168
    buffer_load_dword v40, v15, s[8:11], s24 offen offset:256
    buffer_load_dword v41, v15, s[8:11], s24 offen offset:264
    buffer_load_dword v42, v15, s[8:11], s24 offen offset:288
    buffer_load_dword v43, v15, s[8:11], s24 offen offset:296
    buffer_load_dword v44, v15, s[8:11], s24 offen offset:384
    buffer_load_dword v45, v15, s[8:11], s24 offen offset:392
    buffer_load_dword v46, v15, s[8:11], s24 offen offset:416
    buffer_load_dword v47, v15, s[8:11], s24 offen offset:424
    s_barrier
    v_add_u32 v56, s70, v1
    s_add_u32 s71, s71, 8192
    v_add_u32 v26, s71, v1
    s_waitcnt vmcnt(48)
    ds_read_b64_tr_b16 v[64:65], v24 offset:0
    ds_read_b64_tr_b16 v[66:67], v24 offset:256
    ds_read_b64_tr_b16 v[68:69], v24 offset:512
    ds_read_b64_tr_b16 v[70:71], v24 offset:768
    ds_read_b64_tr_b16 v[72:73], v24 offset:32
    ds_read_b64_tr_b16 v[74:75], v24 offset:288
    ds_read_b64_tr_b16 v[76:77], v24 offset:544
    ds_read_b64_tr_b16 v[78:79], v24 offset:800
    s_waitcnt lgkmcnt(0)
    ds_read_b64_tr_b16 v[112:113], v24 offset:4096
    ds_read_b64_tr_b16 v[114:115], v24 offset:4352
    ds_read_b64_tr_b16 v[116:117], v24 offset:4608
    ds_read_b64_tr_b16 v[118:119], v24 offset:4864
    ds_read_b64_tr_b16 v[120:121], v24 offset:4128
    ds_read_b64_tr_b16 v[122:123], v24 offset:4384
    ds_read_b64_tr_b16 v[124:125], v24 offset:4640
    ds_read_b64_tr_b16 v[126:127], v24 offset:4896
    s_waitcnt lgkmcnt(0)
    ds_read_b64_tr_b16 v[160:161], v24 offset:8192
    ds_read_b64_tr_b16 v[162:163], v24 offset:8448
    ds_read_b64_tr_b16 v[164:165], v24 offset:8704
    ds_read_b64_tr_b16 v[166:167], v24 offset:8960
    ds_read_b64_tr_b16 v[168:169], v24 offset:8224
    ds_read_b64_tr_b16 v[170:171], v24 offset:8480
    ds_read_b64_tr_b16 v[172:173], v24 offset:8736
    ds_read_b64_tr_b16 v[174:175], v24 offset:8992
    s_waitcnt lgkmcnt(0)
    ds_read_b64_tr_b16 v[208:209], v24 offset:12288
    ds_read_b64_tr_b16 v[210:211], v24 offset:12544
    ds_read_b64_tr_b16 v[212:213], v24 offset:12800
    ds_read_b64_tr_b16 v[214:215], v24 offset:13056
    ds_read_b64_tr_b16 v[216:217], v24 offset:12320
    ds_read_b64_tr_b16 v[218:219], v24 offset:12576
    ds_read_b64_tr_b16 v[220:221], v24 offset:12832
    ds_read_b64_tr_b16 v[222:223], v24 offset:13088
    s_waitcnt lgkmcnt(0)
    s_waitcnt vmcnt(32)
    ds_read_b64_tr_b16 v[80:81], v24 offset:16384
    ds_read_b64_tr_b16 v[82:83], v24 offset:16640
    ds_read_b64_tr_b16 v[84:85], v24 offset:16896
    ds_read_b64_tr_b16 v[86:87], v24 offset:17152
    ds_read_b64_tr_b16 v[88:89], v24 offset:16416
    ds_read_b64_tr_b16 v[90:91], v24 offset:16672
    ds_read_b64_tr_b16 v[92:93], v24 offset:16928
    ds_read_b64_tr_b16 v[94:95], v24 offset:17184
    s_waitcnt lgkmcnt(0)
    ds_read_b64_tr_b16 v[128:129], v24 offset:20480
    ds_read_b64_tr_b16 v[130:131], v24 offset:20736
    ds_read_b64_tr_b16 v[132:133], v24 offset:20992
    ds_read_b64_tr_b16 v[134:135], v24 offset:21248
    ds_read_b64_tr_b16 v[136:137], v24 offset:20512
    ds_read_b64_tr_b16 v[138:139], v24 offset:20768
    ds_read_b64_tr_b16 v[140:141], v24 offset:21024
    ds_read_b64_tr_b16 v[142:143], v24 offset:21280
    s_waitcnt lgkmcnt(0)
    ds_read_b64_tr_b16 v[176:177], v24 offset:24576
    ds_read_b64_tr_b16 v[178:179], v24 offset:24832
    ds_read_b64_tr_b16 v[180:181], v24 offset:25088
    ds_read_b64_tr_b16 v[182:183], v24 offset:25344
    ds_read_b64_tr_b16 v[184:185], v24 offset:24608
    ds_read_b64_tr_b16 v[186:187], v24 offset:24864
    ds_read_b64_tr_b16 v[188:189], v24 offset:25120
    ds_read_b64_tr_b16 v[190:191], v24 offset:25376
    s_waitcnt lgkmcnt(0)
    ds_read_b64_tr_b16 v[224:225], v24 offset:28672
    ds_read_b64_tr_b16 v[226:227], v24 offset:28928
    ds_read_b64_tr_b16 v[228:229], v24 offset:29184
    ds_read_b64_tr_b16 v[230:231], v24 offset:29440
    ds_read_b64_tr_b16 v[232:233], v24 offset:28704
    ds_read_b64_tr_b16 v[234:235], v24 offset:28960
    ds_read_b64_tr_b16 v[236:237], v24 offset:29216
    ds_read_b64_tr_b16 v[238:239], v24 offset:29472
    s_waitcnt lgkmcnt(0)
    s_waitcnt vmcnt(16)
    ds_write_b128 v56, v[96:99] offset:0
    ds_write_b128 v56, v[100:103] offset:1024
    ds_write_b128 v56, v[104:107] offset:2048
    ds_write_b128 v56, v[108:111] offset:3072
    ds_write_b128 v56, v[144:147] offset:4096
    ds_write_b128 v56, v[148:151] offset:5120
    ds_write_b128 v56, v[152:155] offset:6144
    ds_write_b128 v56, v[156:159] offset:7168
    ds_write_b128 v26, v[192:195] offset:0
    ds_write_b128 v26, v[196:199] offset:1024
    ds_write_b128 v26, v[200:203] offset:2048
    ds_write_b128 v26, v[204:207] offset:3072
    ds_write_b128 v26, v[240:243] offset:4096
    ds_write_b128 v26, v[244:247] offset:5120
    ds_write_b128 v26, v[248:251] offset:6144
    ds_write_b128 v26, v[252:255] offset:7168
    s_waitcnt lgkmcnt(0)
    ds_read_b64_tr_b16 v[96:97], v24 offset:0
    ds_read_b64_tr_b16 v[98:99], v24 offset:256
    ds_read_b64_tr_b16 v[100:101], v24 offset:512
    ds_read_b64_tr_b16 v[102:103], v24 offset:768
    ds_read_b64_tr_b16 v[104:105], v24 offset:32
    ds_read_b64_tr_b16 v[106:107], v24 offset:288
    ds_read_b64_tr_b16 v[108:109], v24 offset:544
    ds_read_b64_tr_b16 v[110:111], v24 offset:800
    s_waitcnt lgkmcnt(0)
    ds_read_b64_tr_b16 v[144:145], v24 offset:4096
    ds_read_b64_tr_b16 v[146:147], v24 offset:4352
    ds_read_b64_tr_b16 v[148:149], v24 offset:4608
    ds_read_b64_tr_b16 v[150:151], v24 offset:4864
    ds_read_b64_tr_b16 v[152:153], v24 offset:4128
    ds_read_b64_tr_b16 v[154:155], v24 offset:4384
    ds_read_b64_tr_b16 v[156:157], v24 offset:4640
    ds_read_b64_tr_b16 v[158:159], v24 offset:4896
    s_waitcnt lgkmcnt(0)
    ds_read_b64_tr_b16 v[192:193], v24 offset:8192
    ds_read_b64_tr_b16 v[194:195], v24 offset:8448
    ds_read_b64_tr_b16 v[196:197], v24 offset:8704
    ds_read_b64_tr_b16 v[198:199], v24 offset:8960
    ds_read_b64_tr_b16 v[200:201], v24 offset:8224
    ds_read_b64_tr_b16 v[202:203], v24 offset:8480
    ds_read_b64_tr_b16 v[204:205], v24 offset:8736
    ds_read_b64_tr_b16 v[206:207], v24 offset:8992
    s_waitcnt lgkmcnt(0)
    ds_read_b64_tr_b16 v[240:241], v24 offset:12288
    ds_read_b64_tr_b16 v[242:243], v24 offset:12544
    ds_read_b64_tr_b16 v[244:245], v24 offset:12800
    ds_read_b64_tr_b16 v[246:247], v24 offset:13056
    ds_read_b64_tr_b16 v[248:249], v24 offset:12320
    ds_read_b64_tr_b16 v[250:251], v24 offset:12576
    ds_read_b64_tr_b16 v[252:253], v24 offset:12832
    ds_read_b64_tr_b16 v[254:255], v24 offset:13088
    s_waitcnt lgkmcnt(0)
    v_mov_b32 v21, 0x44444444
    v_mov_b32 v22, 0xeeeeeeee
    v_and_b32 v23, 1, v20
    v_cmp_eq_u32 vcc, 0, v23
    v_and_b32 v27, 255, v0
    v_lshlrev_b32 v2, 2, v27
    v_cndmask_b32 v62, v22, v21, vcc
    s_lshr_b32 s21, s15, 1
    s_sub_u32 s21, s21, s15
    s_add_u32 s21, s21, 4
    s_lshl_b32 s21, s21, 10
    s_and_b32 s22, s15, 1
    s_lshl_b32 s22, s22, 9
    s_add_u32 s21, s21, s22
    s_mov_b32 s28, s21
    s_and_b32 s62, s12, 1
    s_lshl_b32 s62, s62, 9
    s_add_u32 s62, s62, s36
    s_sub_u32 s62, s62, 512
    s_lshl_b32 s22, s3, 7
    s_add_u32 s21, s21, s22
    v_and_b32 v21, 31, v20
    v_lshlrev_b32 v21, 2, v21
    v_add_u32 v3, s21, v21
    v_lshrrev_b32 v21, 4, v20
    v_and_b32 v22, 15, v20
    v_mul_u32_u24 v21, 208, v21
    v_add_lshl_u32 v21, v21, v22, 2
    s_mul_i32 s21, s3, 3328
    v_add_u32 v4, s21, v21
    v_lshrrev_b32 v21, 4, v20
    v_bfe_u32 v22, v20, 2, 1
    v_lshl_add_u32 v21, v21, 1, v22
    v_mul_u32_u24 v21, 104, v21
    v_bfe_u32 v22, v20, 3, 1
    v_xor_b32 v22, 1, v22
    v_lshl_add_u32 v21, v22, 5, v21
    v_and_b32 v22, 3, v20
    v_lshlrev_b32 v22, 1, v22
    s_and_b32 s21, s3, 1
    s_lshl_b32 s21, s21, 2
    v_xor_b32 v22, s21, v22
    v_add_u32 v21, v21, v22
    s_lshl_b32 s21, s3, 3
    v_add_u32 v21, s21, v21
    v_lshlrev_b32 v5, 2, v21
    s_and_b32 s21, s3, 1
    s_lshl_b32 s21, s21, 2
    v_bfe_u32 v21, v20, 3, 2
    v_add_u32 v21, s21, v21
    v_mul_u32_u24 v21, 104, v21
    v_bfe_u32 v22, v20, 1, 1
    v_lshl_add_u32 v21, v22, 3, v21
    v_and_b32 v23, 1, v20
    v_xor_b32 v22, v22, v23
    v_lshl_add_u32 v21, v22, 2, v21
    v_bfe_u32 v22, v20, 2, 1
    v_lshl_add_u32 v21, v22, 1, v21
    s_lshr_b32 s21, s3, 1
    s_lshl_b32 s21, s21, 4
    s_add_u32 s21, s21, 64
    v_add_u32 v21, s21, v21
    v_lshlrev_b32 v6, 2, v21
    v_lshrrev_b32 v21, 6, v27
    v_bfe_u32 v22, v27, 1, 1
    v_lshrrev_b32 v23, 1, v21
    v_lshl_add_u32 v22, v22, 1, v23
    v_xor_b32 v23, v27, v22
    v_and_b32 v23, 1, v23
    v_and_b32 v21, 1, v21
    v_lshl_add_u32 v21, v21, 1, v23
    v_mul_u32_u24 v21, 544, v21
    v_lshl_add_u32 v21, v22, 5, v21
    v_bfe_u32 v23, v27, 4, 2
    v_mul_u32_u24 v23, 136, v23
    v_add_u32 v21, v21, v23
    v_bfe_u32 v24, v27, 3, 1
    v_lshl_add_u32 v21, v24, 2, v21
    v_bfe_u32 v24, v27, 2, 1
    v_lshl_add_u32 v21, v24, 4, v21
    v_add_u32 v7, 16384, v21
    v_lshlrev_b32 v8, 2, v20
    s_and_b32 s21, s12, 1
    s_lshl_b32 s21, s21, 9
    s_lshl_b32 s22, s3, 7
    s_add_u32 s21, s21, s22
    v_and_b32 v21, 7, v20
    v_lshlrev_b32 v21, 4, v21
    v_add_u32 v21, s21, v21
    v_lshrrev_b32 v22, 3, v20
    v_lshl_add_u32 v12, v22, 10, v21
    v_bfe_u32 v22, v20, 4, 1
    v_lshl_add_u32 v13, v22, 3, v21
    s_and_b32 s21, s3, 1
    s_lshl_b32 s21, s21, 12
    s_lshr_b32 s22, s3, 1
    s_lshl_b32 s22, s22, 11
    s_add_u32 s21, s21, s22
    s_add_u32 s21, s21, 18560
    v_add_u32 v61, s21, v1
    s_lshl_b32 s21, s3, 2
    s_add_u32 s21, s21, 13312
    v_mov_b32 v14, s21
    v_and_b32 v21, 15, v20
    v_and_b32 v22, 1, v20
    v_lshlrev_b32 v22, 4, v22
    v_mov_b32 v23, 0x3f80
    v_lshlrev_b32 v22, v22, v23
    v_lshrrev_b32 v21, 1, v21
    v_cmp_eq_u32 vcc, 0, v21
    s_nop 1
    v_cndmask_b32 v56, 0, v22, vcc
    v_cmp_eq_u32 vcc, 1, v21
    s_nop 1
    v_cndmask_b32 v57, 0, v22, vcc
    v_cmp_eq_u32 vcc, 2, v21
    s_nop 1
    v_cndmask_b32 v58, 0, v22, vcc
    v_cmp_eq_u32 vcc, 3, v21
    s_nop 1
    v_cndmask_b32 v59, 0, v22, vcc
    v_and_b32 v21, 7, v20
    v_lshlrev_b32 v21, 7, v21
    v_bfe_u32 v22, v20, 3, 1
    v_lshl_add_u32 v21, v22, 17, v21
    s_lshl_b32 s21, s12, 14
    s_lshl_b32 s22, s13, 10
    s_add_u32 s21, s21, s22
    s_add_u32 s21, s21, 4980736
    v_lshrrev_b32 v22, 4, v20
    v_lshl_add_u32 v21, v22, 24, v21
    v_add_u32 v63, s21, v21
    s_mov_b32 s47, 0x3e0293ee
    s_lshl_b32 s14, s12, 2
    s_add_u32 s14, s14, s3
    s_lshl_b32 s61, s14, 13
    s_add_u32 s61, s61, 2097152
    s_lshl_b32 s14, s14, 12
    s_and_b32 s22, s13, 1
    s_lshl_b32 s69, s22, 17
    s_add_u32 s69, s69, s14
    s_add_u32 s69, s69, 4194304
    s_add_u32 s52, s14, 20971520
    s_lshl_b32 s21, s22, 11
    s_add_u32 s14, s14, s21
    s_add_u32 s14, s14, 1179648
    s_lshr_b32 s21, s13, 1
    s_sub_u32 s21, s21, 0
    s_cmp_eq_u32 s21, s3
    s_cselect_b32 s15, 1, 0
    s_add_u32 s23, s3, 3
    s_and_b32 s23, s23, 3
    s_cmp_eq_u32 s21, s23
    s_cselect_b32 s31, 1, 0
    s_and_b32 s24, s23, 1
    s_and_b32 s25, s3, 1
    s_sub_i32 s24, s24, s25
    s_lshr_b32 s23, s23, 1
    s_lshr_b32 s25, s3, 1
    s_sub_i32 s23, s23, s25
    s_mul_i32 s46, s24, 4096
    s_mul_i32 s25, s23, 2048
    s_add_i32 s46, s46, s25
    s_mul_i32 s27, s24, 32768
    s_mul_i32 s25, s23, 1024
    s_add_i32 s27, s27, s25
    v_lshrrev_b32 v21, 4, v20
    v_and_b32 v23, 15, v20
    v_lshlrev_b32 v21, 2, v21
    v_add_u32 v24, 0, v21
    v_cmp_gt_u32 vcc, v24, v23
    s_cmp_eq_u32 s22, 0
    s_cselect_b64 s[38:39], vcc, 0
    s_cselect_b64 s[48:49], -1, vcc
    v_add_u32 v24, 1, v21
    v_cmp_gt_u32 vcc, v24, v23
    s_cmp_eq_u32 s22, 0
    s_cselect_b64 s[40:41], vcc, 0
    s_cselect_b64 s[50:51], -1, vcc
    v_add_u32 v24, 2, v21
    v_cmp_gt_u32 vcc, v24, v23
    s_cmp_eq_u32 s22, 0
    s_cselect_b64 s[42:43], vcc, 0
    s_cselect_b64 s[54:55], -1, vcc
    v_add_u32 v24, 3, v21
    v_cmp_gt_u32 vcc, v24, v23
    s_cmp_eq_u32 s22, 0
    s_cselect_b64 s[44:45], vcc, 0
    s_cselect_b64 s[56:57], -1, vcc
    s_waitcnt vmcnt(0)
    v_mov_b32 v16, v32
    v_mov_b32 v17, v33
    v_mov_b32 v18, v34
    v_mov_b32 v19, v35
    v_mov_b32 v20, v36
    v_mov_b32 v21, v37
    v_mov_b32 v22, v38
    v_mov_b32 v23, v39
    v_mov_b32 v24, v40
    v_mov_b32 v25, v41
    v_mov_b32 v26, v42
    v_mov_b32 v27, v43
    v_mov_b32 v28, v44
    v_mov_b32 v29, v45
    v_mov_b32 v30, v46
    v_mov_b32 v31, v47
    v_mov_b32 v32, -1
    v_mov_b32 v33, -1
    v_mov_b32 v34, -1
    v_mov_b32 v35, -1
    s_add_u32 s21, s37, 3997696
    buffer_store_dwordx4 v[32:35], v1, s[4:7], s21 offen sc1
    s_add_u32 s21, s37, 4063232
    buffer_store_dwordx4 v[32:35], v1, s[4:7], s21 offen sc1
    s_add_u32 s21, s37, 4128768
    buffer_store_dwordx4 v[32:35], v1, s[4:7], s21 offen sc1
    s_lshl_b32 s29, s29, 5
    s_barrier
    ds_write_b32 v14, v10
    ds_write_b32 v14, v10 offset:16
    ds_write_b32 v14, v10 offset:32
    s_lshl_b32 s53, s3, 13
    s_add_u32 s53, s53, 92160
    v_add_u32 v32, 14336, v1
    ds_write_b128 v32, v[56:59]
    s_lshl_b32 s60, s12, 4
    s_add_u32 s60, s60, 218104320
    v_mov_b32 v15, 0
    s_add_u32 s25, s16, 0
    s_min_u32 s25, s25, 63
    s_cmp_lt_u32 s25, 8
    s_cselect_b32 s59, 12, 24
    s_cselect_b32 s58, -4, -8
    s_and_b32 s25, s25, s58
    s_lshl_b32 s25, s25, 5
    s_add_u32 s58, s25, s60
    v_mov_b32 v32, 131072
    s_waitcnt vmcnt(0) lgkmcnt(0)
    s_barrier
    ds_read_b64 v[32:33], v32
    s_waitcnt lgkmcnt(0)
    v_cmp_ne_u32 vcc, s29, v32
    s_setprio 3
    v_readfirstlane_b32 s63, v33
    s_add_u32 s34, s34, s63
    s_add_u32 s35, s35, s63
    s_cbranch_vccnz ch_p_slow
    v_mov_b32 v32, 0
    v_mov_b32 v33, 0
    v_mov_b32 v34, 0
    v_mov_b32 v35, 0
    v_mov_b32 v36, 0
    v_mov_b32 v37, 0
    v_mov_b32 v38, 0
    v_mov_b32 v39, 0
    v_mov_b32 v40, 0
    v_mov_b32 v41, 0
    v_mov_b32 v42, 0
    v_mov_b32 v43, 0
    v_mov_b32 v44, 0
    v_mov_b32 v45, 0
    v_mov_b32 v46, 0
    v_mov_b32 v47, 0
    v_mov_b32 v48, 0
    v_mov_b32 v49, 0
    v_mov_b32 v50, 0
    v_mov_b32 v51, 0
    v_mov_b32 v52, 0
    v_mov_b32 v53, 0
    v_mov_b32 v54, 0
    v_mov_b32 v55, 0
    v_mov_b32 v0, 1.0
    s_mov_b32 exec_lo, 0xff00ff00
    s_mov_b32 exec_hi, 0xff00ff00
    v_mov_b32 v0, s47
    s_mov_b64 exec, -1
    v_mov_b32 v60, s16
    v_smfmac_f32_16x16x64_bf16 v[32:35], v[16:19], v[64:71], v62
    v_smfmac_f32_16x16x64_bf16 v[36:39], v[16:19], v[72:79], v62
    v_smfmac_f32_16x16x64_bf16 v[40:43], v[16:19], v[80:87], v62
    v_smfmac_f32_16x16x64_bf16 v[44:47], v[16:19], v[88:95], v62
    v_smfmac_f32_16x16x64_bf16 v[48:51], v[16:19], v[96:103], v62
    v_smfmac_f32_16x16x64_bf16 v[52:55], v[16:19], v[104:111], v62
    v_smfmac_f32_16x16x64_bf16 v[32:35], v[20:23], v[112:119], v62
    v_smfmac_f32_16x16x64_bf16 v[36:39], v[20:23], v[120:127], v62
    v_smfmac_f32_16x16x64_bf16 v[40:43], v[20:23], v[128:135], v62
    v_smfmac_f32_16x16x64_bf16 v[44:47], v[20:23], v[136:143], v62
    v_smfmac_f32_16x16x64_bf16 v[48:51], v[20:23], v[144:151], v62
    v_smfmac_f32_16x16x64_bf16 v[52:55], v[20:23], v[152:159], v62
    v_smfmac_f32_16x16x64_bf16 v[32:35], v[24:27], v[160:167], v62
    v_smfmac_f32_16x16x64_bf16 v[36:39], v[24:27], v[168:175], v62
    v_smfmac_f32_16x16x64_bf16 v[40:43], v[24:27], v[176:183], v62
    v_smfmac_f32_16x16x64_bf16 v[44:47], v[24:27], v[184:191], v62
    v_smfmac_f32_16x16x64_bf16 v[48:51], v[24:27], v[192:199], v62
    v_smfmac_f32_16x16x64_bf16 v[52:55], v[24:27], v[200:207], v62
    v_smfmac_f32_16x16x64_bf16 v[32:35], v[28:31], v[208:215], v62
    ds_write_b32 v14, v60
    v_smfmac_f32_16x16x64_bf16 v[36:39], v[28:31], v[216:223], v62
    v_smfmac_f32_16x16x64_bf16 v[40:43], v[28:31], v[224:231], v62
    v_smfmac_f32_16x16x64_bf16 v[44:47], v[28:31], v[232:239], v62
    v_add_f32 v32, v32, v33
    v_add_f32 v34, v34, v35
    v_smfmac_f32_16x16x64_bf16 v[48:51], v[28:31], v[240:247], v62
    v_add_f32 v36, v36, v37
    v_add_f32 v38, v38, v39
    ds_write2_b32 v4, v32, v34 offset0:0 offset1:104
    v_smfmac_f32_16x16x64_bf16 v[52:55], v[28:31], v[248:255], v62
    v_add_f32 v40, v40, v41
    v_add_f32 v42, v42, v43
    ds_write2_b32 v4, v36, v38 offset0:16 offset1:120
    v_add_f32 v44, v44, v45
    v_add_f32 v46, v46, v47
    ds_write2_b32 v4, v40, v42 offset0:32 offset1:136
    v_add_f32 v48, v48, v49
    v_add_f32 v50, v50, v51
    ds_write2_b32 v4, v44, v46 offset0:48 offset1:152
    v_add_f32 v52, v52, v53
    v_add_f32 v54, v54, v55
    ds_write2_b32 v4, v48, v50 offset0:64 offset1:168
    ds_write2_b32 v4, v52, v54 offset0:80 offset1:184
    s_waitcnt vmcnt(0)
    s_branch pnc_7_done
.p2align 6
    s_nop 0
    s_nop 0
    s_nop 0
    s_nop 0
    s_nop 0
    s_nop 0
    s_nop 0
    s_nop 0
ploop_6:
    s_add_u32 s21, s17, s33
    s_nop 15
    s_nop 5
    buffer_load_dwordx4 v[16:19], v1, s[4:7], s21 offen offset:0 sc1
    s_nop 7
    buffer_load_dwordx4 v[20:23], v1, s[4:7], s21 offen offset:1024 sc1
    s_nop 7
    buffer_load_dwordx4 v[24:27], v1, s[4:7], s21 offen offset:2048 sc1
    s_nop 7
    buffer_load_dwordx4 v[28:31], v1, s[4:7], s21 offen offset:3072 sc1
    s_waitcnt vmcnt(3)
    v_max3_u32 v9, v16, v17, v18
    v_max_u32 v9, v9, v19
    v_cmp_eq_u32 vcc, -1, v9
    s_cbranch_vccnz prm_9_0
prm_9_0ok:
    v_smfmac_f32_16x16x64_bf16 v[32:35], v[16:19], v[64:71], v62
    v_smfmac_f32_16x16x64_bf16 v[36:39], v[16:19], v[72:79], v62
    v_smfmac_f32_16x16x64_bf16 v[40:43], v[16:19], v[80:87], v62
    s_waitcnt vmcnt(2)
    v_max3_u32 v9, v20, v21, v22
    v_max_u32 v9, v9, v23
    v_cmp_eq_u32 vcc, -1, v9
    v_smfmac_f32_16x16x64_bf16 v[44:47], v[16:19], v[88:95], v62
    v_smfmac_f32_16x16x64_bf16 v[48:51], v[16:19], v[96:103], v62
    v_smfmac_f32_16x16x64_bf16 v[52:55], v[16:19], v[104:111], v62
    s_cbranch_vccnz prm_9_1
prm_9_1ok:
    v_smfmac_f32_16x16x64_bf16 v[32:35], v[20:23], v[112:119], v62
    v_readfirstlane_b32 s23, v15
    v_smfmac_f32_16x16x64_bf16 v[36:39], v[20:23], v[120:127], v62
    v_smfmac_f32_16x16x64_bf16 v[40:43], v[20:23], v[128:135], v62
    s_waitcnt vmcnt(1)
    v_max3_u32 v9, v24, v25, v26
    v_max_u32 v9, v9, v27
    v_cmp_eq_u32 vcc, -1, v9
    v_smfmac_f32_16x16x64_bf16 v[44:47], v[20:23], v[136:143], v62
    v_smfmac_f32_16x16x64_bf16 v[48:51], v[20:23], v[144:151], v62
    v_smfmac_f32_16x16x64_bf16 v[52:55], v[20:23], v[152:159], v62
    s_cbranch_vccnz prm_9_2
prm_9_2ok:
    v_smfmac_f32_16x16x64_bf16 v[32:35], v[24:27], v[160:167], v62
    v_smfmac_f32_16x16x64_bf16 v[36:39], v[24:27], v[168:175], v62
    v_smfmac_f32_16x16x64_bf16 v[40:43], v[24:27], v[176:183], v62
    s_waitcnt vmcnt(0)
    v_max3_u32 v9, v28, v29, v30
    v_max_u32 v9, v9, v31
    v_cmp_eq_u32 vcc, -1, v9
    v_smfmac_f32_16x16x64_bf16 v[44:47], v[24:27], v[184:191], v62
    v_smfmac_f32_16x16x64_bf16 v[48:51], v[24:27], v[192:199], v62
    v_smfmac_f32_16x16x64_bf16 v[52:55], v[24:27], v[200:207], v62
    s_cbranch_vccnz prm_9_3
prm_9_3ok:
    v_smfmac_f32_16x16x64_bf16 v[32:35], v[28:31], v[208:215], v62
    s_cmp_lt_u32 s23, s59
    s_cbranch_scc1 prm_9_gt
prm_9_gtb:
    ds_write_b32 v14, v60
    v_smfmac_f32_16x16x64_bf16 v[36:39], v[28:31], v[216:223], v62
    v_smfmac_f32_16x16x64_bf16 v[40:43], v[28:31], v[224:231], v62
    v_smfmac_f32_16x16x64_bf16 v[44:47], v[28:31], v[232:239], v62
    v_add_f32 v32, v32, v33
    v_add_f32 v34, v34, v35
    v_smfmac_f32_16x16x64_bf16 v[48:51], v[28:31], v[240:247], v62
    v_add_f32 v36, v36, v37
    v_add_f32 v38, v38, v39
    ds_write2_b32 v4, v32, v34 offset0:0 offset1:104
    v_smfmac_f32_16x16x64_bf16 v[52:55], v[28:31], v[248:255], v62
    v_add_f32 v40, v40, v41
    v_add_f32 v42, v42, v43
    ds_write2_b32 v4, v36, v38 offset0:16 offset1:120
    v_add_f32 v44, v44, v45
    v_add_f32 v46, v46, v47
    ds_write2_b32 v4, v40, v42 offset0:32 offset1:136
    v_add_f32 v48, v48, v49
    v_add_f32 v50, v50, v51
    ds_write2_b32 v4, v44, v46 offset0:48 offset1:152
    v_add_f32 v52, v52, v53
    v_add_f32 v54, v54, v55
    ds_write2_b32 v4, v48, v50 offset0:64 offset1:168
    ds_write2_b32 v4, v52, v54 offset0:80 offset1:184
pnc_7_done:
    s_add_u32 s21, s17, s32
    s_add_u32 s22, s19, s32
    s_add_u32 s24, s19, s35
    s_waitcnt lgkmcnt(0)
    s_barrier
    ds_read_b64 v[32:33], v5 offset:0
    ds_read_b64 v[34:35], v5 offset:3328
    ds_read_b64 v[36:37], v5 offset:6656
    ds_read_b64 v[38:39], v5 offset:9984
    ds_read_b64 v[40:41], v6 offset:0
    ds_read_b64 v[42:43], v6 offset:3328
    ds_read_b64 v[44:45], v6 offset:6656
    ds_read_b64 v[46:47], v6 offset:9984
    s_waitcnt lgkmcnt(6)
    v_add_f32 v32, v32, v34
    v_add_f32 v33, v33, v35
    v_mul_f32 v32, v32, v0
    v_mul_f32 v33, v33, v0
    s_waitcnt lgkmcnt(4)
    v_add_f32 v36, v36, v38
    v_add_f32 v37, v37, v39
    v_fma_f32 v32, v36, v0, v32
    v_fma_f32 v33, v37, v0, v33
    v_cvt_pk_bf16_f32 v32, v32, v33
    v_min_u32 v32, -2, v32
    buffer_store_dword v32, v2, s[4:7], s21 offen
    s_waitcnt lgkmcnt(2)
    v_add_f32 v40, v40, v42
    v_add_f32 v41, v41, v43
    s_waitcnt lgkmcnt(0)
    v_add_f32 v44, v44, v46
    v_add_f32 v45, v45, v47
    v_add_f32 v40, v40, v44
    v_add_f32 v41, v41, v45
    v_cvt_pk_bf16_f32 v40, v40, v41
    v_min_u32 v40, -2, v40
    s_mov_b32 exec_hi, 0
    buffer_store_dword v40, v3, s[4:7], s21 offen
    s_setprio 0
    s_mov_b64 exec, -1
    s_add_u32 s21, s17, s35
    s_add_u32 s30, s17, s34
    s_add_u32 s23, s18, s36
    s_cmp_lg_u32 s16, 0
    s_cbranch_scc1 ploop_6_n0
gate_11:
    v_readfirstlane_b32 s25, v15
    s_cmp_ge_u32 s25, s59
    s_cbranch_scc1 gate_11_ok
    s_sleep 8
    buffer_load_dword v15, off, s[4:7], s58 sc1
    s_waitcnt vmcnt(0)
    s_sub_u32 s26, s26, 1
    s_cbranch_scc0 gate_11
    s_mov_b32 s26, 0
gate_11_ok:
    s_cmp_eq_u32 s15, 0
    s_cbranch_scc1 ploop_6_st_nk
    s_add_u32 m0, s53, 0
    s_add_u32 s22, s52, 0
    buffer_load_dwordx4 v1, s[4:7], s22 offen offset:0 sc1 lds
    buffer_load_dwordx4 v1, s[4:7], s22 offen offset:1024 sc1 lds
    buffer_load_dwordx4 v1, s[4:7], s22 offen offset:2048 sc1 lds
    buffer_load_dwordx4 v1, s[4:7], s22 offen offset:3072 sc1 lds
    s_add_u32 m0, s53, 4096
    s_add_u32 s22, s52, 131072
    buffer_load_dwordx4 v1, s[4:7], s22 offen offset:0 sc1 lds
    buffer_load_dwordx4 v1, s[4:7], s22 offen offset:1024 sc1 lds
    buffer_load_dwordx4 v1, s[4:7], s22 offen offset:2048 sc1 lds
    buffer_load_dwordx4 v1, s[4:7], s22 offen offset:3072 sc1 lds
    s_add_u32 s52, s52, 262144
    s_sub_u32 s52, s52, 262144
ploop_6_st_nk:
    s_add_u32 s52, s52, 262144
    s_cmp_lg_u32 s3, 2
    s_cbranch_scc1 ploop_6_st_npf
    v_subrev_u32 v32, 786432, v63
    s_mov_b32 exec_hi, 0xffff
    s_mov_b32 s22, 262144
    buffer_load_dword v33, v32, s[4:7], s22 offen sc1
    s_mov_b32 s22, 524288
    buffer_load_dword v33, v32, s[4:7], s22 offen sc1
    s_mov_b32 exec_hi, -1
    s_waitcnt vmcnt(0)
ploop_6_st_npf:
    s_cmp_eq_u32 s15, 0
    s_cbranch_scc1 ploop_6_st_p_nd
    s_mov_b32 m0, 124928
    s_nop 0
    buffer_load_dwordx4 v1, s[4:7], s69 offen offset:0 sc1 lds
    buffer_load_dwordx4 v1, s[4:7], s69 offen offset:1024 sc1 lds
    buffer_load_dwordx4 v1, s[4:7], s69 offen offset:2048 sc1 lds
    buffer_load_dwordx4 v1, s[4:7], s69 offen offset:3072 sc1 lds
    s_add_u32 s69, s69, 262144
    s_waitcnt vmcnt(0)
ploop_6_st_p_nd:
ploop_6_n0:
    s_add_u32 s25, s16, 2
    s_min_u32 s25, s25, 63
    s_cmp_lt_u32 s25, 8
    s_cselect_b32 s59, 12, 24
    s_cselect_b32 s58, -4, -8
    s_and_b32 s25, s25, s58
    s_lshl_b32 s25, s25, 5
    s_add_u32 s58, s25, s60
    s_cmp_eq_u32 s15, 0
    s_cbranch_scc1 ploop_6_nd
    v_add_u32 v9, s53, v1
    v_add_u32 v0, 124928, v1
    ds_read_b128 v[16:19], v0 offset:0
    ds_read_b128 v[32:35], v9 offset:0
    ds_read_b128 v[20:23], v0 offset:1024
    ds_read_b128 v[36:39], v9 offset:1024
    ds_read_b128 v[24:27], v0 offset:2048
    ds_read_b128 v[40:43], v9 offset:2048
    ds_read_b128 v[28:31], v0 offset:3072
    ds_read_b128 v[44:47], v9 offset:3072
    s_add_u32 s22, s17, s61
    s_waitcnt lgkmcnt(6)
    v_mfma_f32_16x16x32_bf16 v[48:51], v[32:35], v[16:19], 0
    ds_read_b128 v[32:35], v9 offset:4096
    s_waitcnt lgkmcnt(5)
    v_mfma_f32_16x16x32_bf16 v[48:51], v[36:39], v[20:23], v[48:51]
    ds_read_b128 v[36:39], v9 offset:5120
    s_waitcnt lgkmcnt(4)
    v_mfma_f32_16x16x32_bf16 v[48:51], v[40:43], v[24:27], v[48:51]
    ds_read_b128 v[40:43], v9 offset:6144
    s_waitcnt lgkmcnt(3)
    v_mfma_f32_16x16x32_bf16 v[48:51], v[44:47], v[28:31], v[48:51]
    ds_read_b128 v[44:47], v9 offset:7168
    s_waitcnt lgkmcnt(3)
    v_mfma_f32_16x16x32_bf16 v[52:55], v[32:35], v[16:19], 0
    s_waitcnt lgkmcnt(2)
    v_mfma_f32_16x16x32_bf16 v[52:55], v[36:39], v[20:23], v[52:55]
    s_waitcnt lgkmcnt(1)
    v_mfma_f32_16x16x32_bf16 v[52:55], v[40:43], v[24:27], v[52:55]
    s_waitcnt lgkmcnt(0)
    v_mfma_f32_16x16x32_bf16 v[52:55], v[44:47], v[28:31], v[52:55]
    buffer_load_dwordx4 v[32:35], v1, s[4:7], s22 offen offset:0 sc1
    buffer_load_dwordx4 v[36:39], v1, s[4:7], s22 offen offset:1024 sc1
    buffer_load_dwordx4 v[40:43], v1, s[4:7], s22 offen offset:2048 sc1
    buffer_load_dwordx4 v[44:47], v1, s[4:7], s22 offen offset:3072 sc1
    v_mov_b32 v60, 0xff61b1e6
    s_nop 2
    v_cndmask_b32 v48, v48, v60, s[38:39]
    v_cndmask_b32 v49, v49, v60, s[40:41]
    v_cndmask_b32 v50, v50, v60, s[42:43]
    v_cndmask_b32 v51, v51, v60, s[44:45]
    v_cndmask_b32 v52, v52, v60, s[48:49]
    v_cndmask_b32 v53, v53, v60, s[50:51]
    v_cndmask_b32 v54, v54, v60, s[54:55]
    v_cndmask_b32 v55, v55, v60, s[56:57]
    v_max3_f32 v0, v48, v49, v50
    v_max3_f32 v9, v51, v52, v53
    v_max3_f32 v0, v0, v54, v55
    v_max_f32 v0, v0, v9
    v_mov_b32 v9, v0
    s_nop 1
    v_permlane16_swap_b32 v9, v0
    v_max_f32 v0, v0, v9
    v_mov_b32 v9, v0
    s_nop 1
    v_permlane32_swap_b32 v9, v0
    v_max_f32 v0, v0, v9
    v_mul_f32 v0, s47, v0
    v_fma_f32 v48, v48, s47, -v0
    v_fma_f32 v49, v49, s47, -v0
    v_fma_f32 v50, v50, s47, -v0
    v_fma_f32 v51, v51, s47, -v0
    v_fma_f32 v52, v52, s47, -v0
    v_fma_f32 v53, v53, s47, -v0
    v_fma_f32 v54, v54, s47, -v0
    v_fma_f32 v55, v55, s47, -v0
    v_exp_f32 v48, v48
    v_exp_f32 v49, v49
    v_exp_f32 v50, v50
    v_exp_f32 v51, v51
    v_exp_f32 v52, v52
    v_exp_f32 v53, v53
    v_exp_f32 v54, v54
    v_exp_f32 v55, v55
    v_add_f32 v15, v48, v49
    v_add_f32 v15, v15, v50
    v_add_f32 v15, v15, v51
    v_add_f32 v15, v15, v52
    v_add_f32 v15, v15, v53
    v_add_f32 v15, v15, v54
    v_add_f32 v15, v15, v55
ploop_6_za:
    s_waitcnt vmcnt(0)
    v_max3_u32 v9, v32, v33, v34
    v_max3_u32 v9, v9, v35, v36
    v_max3_u32 v9, v9, v37, v38
    v_max3_u32 v9, v9, v39, v40
    v_max3_u32 v9, v9, v41, v42
    v_max3_u32 v9, v9, v43, v44
    v_max3_u32 v9, v9, v45, v46
    v_max_u32 v9, v9, v47
    v_cmp_eq_u32 vcc, -1, v9
    s_cbranch_vccnz ploop_6_zr
ploop_6_zok:
    v_mfma_f32_16x16x32_bf16 v[56:59], v[32:35], v[16:19], 0
    v_mfma_f32_16x16x32_bf16 v[56:59], v[36:39], v[20:23], v[56:59]
    v_mfma_f32_16x16x32_bf16 v[56:59], v[40:43], v[24:27], v[56:59]
    v_mfma_f32_16x16x32_bf16 v[56:59], v[44:47], v[28:31], v[56:59]
    s_add_u32 s22, s17, s14
    s_nop 6
    v_max_f32 v60, v56, v57
    v_mov_b32 v9, v60
    s_nop 1
    v_permlane16_swap_b32 v9, v60
    v_max_f32 v60, v60, v9
    v_mov_b32 v9, v60
    s_nop 1
    v_permlane32_swap_b32 v9, v60
    v_max_f32 v60, v60, v9
    v_mul_f32 v60, s47, v60
    v_max_f32 v58, v60, v0
    v_sub_f32 v60, v0, v58
    v_fma_f32 v56, v56, s47, -v58
    v_fma_f32 v57, v57, s47, -v58
    v_exp_f32 v60, v60
    v_exp_f32 v56, v56
    v_exp_f32 v57, v57
    v_fma_f32 v15, v15, v60, v56
    v_add_f32 v15, v15, v57
    v_mov_b32 v9, v15
    s_nop 1
    v_permlane16_swap_b32 v9, v15
    v_add_f32 v15, v15, v9
    v_mov_b32 v9, v15
    s_nop 1
    v_permlane32_swap_b32 v9, v15
    v_add_f32 v15, v15, v9
    v_rcp_f32 v15, v15
    s_add_u32 s25, s19, s14
    v_mul_f32 v56, v56, v15
    v_mul_f32 v57, v57, v15
    v_mul_f32 v60, v60, v15
    v_mul_f32 v48, v48, v60
    v_mul_f32 v49, v49, v60
    v_mul_f32 v50, v50, v60
    v_mul_f32 v51, v51, v60
    v_mul_f32 v52, v52, v60
    v_mul_f32 v53, v53, v60
    v_mul_f32 v54, v54, v60
    v_mul_f32 v55, v55, v60
    v_cvt_pk_bf16_f32 v48, v48, v49
    v_cvt_pk_bf16_f32 v49, v50, v51
    v_cvt_pk_bf16_f32 v50, v52, v53
    v_cvt_pk_bf16_f32 v51, v54, v55
    v_min_u32 v48, -2, v48
    v_min_u32 v49, -2, v49
    v_min_u32 v50, -2, v50
    v_min_u32 v51, -2, v51
    v_lshlrev_b32 v54, 1, v8
    v_add_u32 v55, 14336, v1
    v_mov_b32 v53, 1.0
    v_cvt_pk_bf16_f32 v52, v56, v57
    v_min_u32 v53, -2, v53
    v_min_u32 v52, -2, v52
    buffer_store_dwordx4 v[48:51], v1, s[4:7], s22 offen
    buffer_store_dwordx2 v[52:53], v54, s[4:7], s22 offen offset:1024
    ds_read_b128 v[56:59], v55
    s_branch ploop_6_nd2
ploop_6_nd:
    s_cmp_eq_u32 s16, 0
    s_cbranch_scc1 ploop_6_ns
    s_cmp_eq_u32 s31, 0
    s_cbranch_scc1 ploop_6_n2
    s_add_u32 s25, s68, s46
    v_add_u32 v55, s25, v61
    ds_read_b128 v[24:27], v55 offset:0
    ds_read_b128 v[28:31], v55 offset:1024
    ds_read_b128 v[32:35], v55 offset:18560
    ds_read_b128 v[36:39], v55 offset:19584
    ds_read_b128 v[40:43], v55 offset:37120
    ds_read_b128 v[44:47], v55 offset:38144
    ds_read_b128 v[48:51], v55 offset:55680
    ds_read_b128 v[52:55], v55 offset:56704
    s_waitcnt lgkmcnt(4)
    v_add_f32 v24, v24, v32
    v_add_f32 v25, v25, v33
    v_add_f32 v26, v26, v34
    v_add_f32 v27, v27, v35
    v_add_f32 v28, v28, v36
    v_add_f32 v29, v29, v37
    v_add_f32 v30, v30, v38
    v_add_f32 v31, v31, v39
    s_waitcnt lgkmcnt(0)
    v_add_f32 v40, v40, v48
    v_add_f32 v41, v41, v49
    v_add_f32 v42, v42, v50
    v_add_f32 v43, v43, v51
    v_add_f32 v44, v44, v52
    v_add_f32 v45, v45, v53
    v_add_f32 v46, v46, v54
    v_add_f32 v47, v47, v55
    v_add_f32 v24, v24, v40
    v_add_f32 v25, v25, v41
    v_add_f32 v26, v26, v42
    v_add_f32 v27, v27, v43
    v_add_f32 v28, v28, v44
    v_add_f32 v29, v29, v45
    v_add_f32 v30, v30, v46
    v_add_f32 v31, v31, v47
    v_cvt_pk_bf16_f32 v24, v24, v25
    v_cvt_pk_bf16_f32 v25, v26, v27
    v_cvt_pk_bf16_f32 v26, v28, v29
    v_cvt_pk_bf16_f32 v27, v30, v31
    v_min_u32 v24, -2, v24
    v_min_u32 v25, -2, v25
    v_min_u32 v26, -2, v26
    v_min_u32 v27, -2, v27
    v_mov_b32 v16, v24
    v_mov_b32 v17, v25
    v_mov_b32 v18, v26
    v_mov_b32 v19, v27
ploop_6_n2:
    v_add_u32 v55, s68, v61
    ds_read_b128 v[24:27], v55 offset:0
    ds_read_b128 v[28:31], v55 offset:1024
    ds_read_b128 v[32:35], v55 offset:18560
    ds_read_b128 v[36:39], v55 offset:19584
    ds_read_b128 v[40:43], v55 offset:37120
    ds_read_b128 v[44:47], v55 offset:38144
    ds_read_b128 v[48:51], v55 offset:55680
    ds_read_b128 v[52:55], v55 offset:56704
    s_waitcnt lgkmcnt(4)
    v_add_f32 v24, v24, v32
    v_add_f32 v25, v25, v33
    v_add_f32 v26, v26, v34
    v_add_f32 v27, v27, v35
    v_add_f32 v28, v28, v36
    v_add_f32 v29, v29, v37
    v_add_f32 v30, v30, v38
    v_add_f32 v31, v31, v39
    s_waitcnt lgkmcnt(0)
    v_add_f32 v40, v40, v48
    v_add_f32 v41, v41, v49
    v_add_f32 v42, v42, v50
    v_add_f32 v43, v43, v51
    v_add_f32 v44, v44, v52
    v_add_f32 v45, v45, v53
    v_add_f32 v46, v46, v54
    v_add_f32 v47, v47, v55
    v_add_f32 v24, v24, v40
    v_add_f32 v25, v25, v41
    v_add_f32 v26, v26, v42
    v_add_f32 v27, v27, v43
    v_add_f32 v28, v28, v44
    v_add_f32 v29, v29, v45
    v_add_f32 v30, v30, v46
    v_add_f32 v31, v31, v47
    v_cvt_pk_bf16_f32 v24, v24, v25
    v_cvt_pk_bf16_f32 v25, v26, v27
    v_cvt_pk_bf16_f32 v26, v28, v29
    v_cvt_pk_bf16_f32 v27, v30, v31
    v_min_u32 v24, -2, v24
    v_min_u32 v25, -2, v25
    v_min_u32 v26, -2, v26
    v_min_u32 v27, -2, v27
ploop_6_ns:
ploop_6_flag:
    ds_read_b32 v9, v14 offset:16
    s_waitcnt lgkmcnt(0)
    v_readfirstlane_b32 s25, v9
    s_cmp_eq_u32 s25, s16
    s_cbranch_scc0 ploop_6_flag
    s_add_u32 m0, s53, 0
    s_add_u32 s22, s52, 0
    buffer_load_dwordx4 v1, s[4:7], s22 offen offset:0 sc1 lds
    buffer_load_dwordx4 v1, s[4:7], s22 offen offset:1024 sc1 lds
    buffer_load_dwordx4 v1, s[4:7], s22 offen offset:2048 sc1 lds
    buffer_load_dwordx4 v1, s[4:7], s22 offen offset:3072 sc1 lds
    s_add_u32 m0, s53, 4096
    s_add_u32 s22, s52, 131072
    buffer_load_dwordx4 v1, s[4:7], s22 offen offset:0 sc1 lds
    buffer_load_dwordx4 v1, s[4:7], s22 offen offset:1024 sc1 lds
    buffer_load_dwordx4 v1, s[4:7], s22 offen offset:2048 sc1 lds
    buffer_load_dwordx4 v1, s[4:7], s22 offen offset:3072 sc1 lds
    s_add_u32 s52, s52, 262144
ploop_6_nk:
    s_cmp_eq_u32 s16, 0
    s_cbranch_scc1 ploop_6_nd2
    buffer_store_dwordx4 v[24:27], v1, s[4:7], s37 offen sc1
    s_cmp_eq_u32 s31, 0
    s_cbranch_scc1 ploop_6_nd2
    s_add_u32 s25, s37, s27
    buffer_store_dwordx4 v[16:19], v1, s[4:7], s25 offen sc1
ploop_6_nd2:
    s_cmp_eq_u32 s16, 0
    s_cbranch_scc1 ploop_6_nn
    s_add_u32 s37, s37, 65536
    s_xor_b32 s68, s68, 8192
ploop_6_nn:
    s_cmp_lg_u32 s3, 2
    s_cbranch_scc1 ppf_12
    s_lshl_b32 s22, s16, 18
    s_mov_b32 exec_hi, 0xffff
    buffer_load_dword v9, v63, s[4:7], s22 offen sc1
    s_mov_b32 exec_hi, -1
ppf_12:
    v_add_u32 v24, 18560, v7
    v_add_u32 v25, 37120, v7
    v_add_u32 v26, 55680, v7
    s_cmp_eq_u32 s16, 63
    s_setprio 3
    s_barrier
    s_cbranch_scc1 ptail_8
    ds_read2_b32 v[16:17], v7 offset0:0 offset1:2
    ds_read2_b32 v[18:19], v24 offset0:0 offset1:2
    ds_read2_b32 v[20:21], v25 offset0:0 offset1:2
    ds_read2_b32 v[22:23], v26 offset0:0 offset1:2
    s_waitcnt lgkmcnt(2)
    v_add_f32 v16, v16, v18
    v_add_f32 v17, v17, v19
    s_waitcnt lgkmcnt(0)
    v_add_f32 v20, v20, v22
    v_add_f32 v21, v21, v23
    v_add_f32 v16, v16, v20
    v_add_f32 v17, v17, v21
    v_cvt_pk_bf16_f32 v16, v16, v17
    v_min_u32 v16, -2, v16
    buffer_store_dword v16, v2, s[4:7], s21 offen sc1
    buffer_store_dword v10, v2, s[4:7], s24 offen sc1
    s_cmp_eq_u32 s15, 0
    s_cbranch_scc1 ploop_6_pnd
    s_sleep 6
    s_nop 8
    buffer_load_dwordx4 v[16:19], v12, s[4:7], s30 offen sc1
    buffer_load_dword v15, off, s[4:7], s58 sc1
    s_add_u32 s25, s19, s14
    v_mov_b32 v20, -1
    v_mov_b32 v21, -1
    v_mov_b32 v22, -1
    v_mov_b32 v23, -1
    buffer_store_dwordx4 v[20:23], v1, s[4:7], s25 offen
    buffer_store_dwordx2 v[20:21], v54, s[4:7], s25 offen offset:1024
    s_mov_b32 m0, 124928
    s_nop 0
    buffer_load_dwordx4 v1, s[4:7], s69 offen offset:0 sc1 lds
    buffer_load_dwordx4 v1, s[4:7], s69 offen offset:1024 sc1 lds
    buffer_load_dwordx4 v1, s[4:7], s69 offen offset:2048 sc1 lds
    buffer_load_dwordx4 v1, s[4:7], s69 offen offset:3072 sc1 lds
    s_add_u32 s69, s69, 262144
    s_add_u32 m0, s53, 0
    s_add_u32 s22, s52, 0
    buffer_load_dwordx4 v1, s[4:7], s22 offen offset:0 sc1 lds
    buffer_load_dwordx4 v1, s[4:7], s22 offen offset:1024 sc1 lds
    buffer_load_dwordx4 v1, s[4:7], s22 offen offset:2048 sc1 lds
    buffer_load_dwordx4 v1, s[4:7], s22 offen offset:3072 sc1 lds
    s_add_u32 m0, s53, 4096
    s_add_u32 s22, s52, 131072
    buffer_load_dwordx4 v1, s[4:7], s22 offen offset:0 sc1 lds
    buffer_load_dwordx4 v1, s[4:7], s22 offen offset:1024 sc1 lds
    buffer_load_dwordx4 v1, s[4:7], s22 offen offset:2048 sc1 lds
    buffer_load_dwordx4 v1, s[4:7], s22 offen offset:3072 sc1 lds
    s_add_u32 s52, s52, 262144
    s_add_u32 s22, s16, 1
    v_mov_b32 v60, s22
    v_mov_b32 v32, 0
    v_mov_b32 v33, 0
    v_mov_b32 v34, 0
    v_mov_b32 v35, 0
    v_mov_b32 v36, 0
    v_mov_b32 v37, 0
    v_mov_b32 v38, 0
    v_mov_b32 v39, 0
    v_mov_b32 v40, 0
    v_mov_b32 v41, 0
    v_mov_b32 v42, 0
    v_mov_b32 v43, 0
    v_mov_b32 v44, 0
    v_mov_b32 v45, 0
    v_mov_b32 v46, 0
    v_mov_b32 v47, 0
    v_mov_b32 v48, 0
    v_mov_b32 v49, 0
    v_mov_b32 v50, 0
    v_mov_b32 v51, 0
    v_mov_b32 v52, 0
    v_mov_b32 v53, 0
    v_mov_b32 v54, 0
    v_mov_b32 v55, 0
    v_mov_b32 v0, 1.0
    s_mov_b32 exec_lo, 0xff00ff00
    s_mov_b32 exec_hi, 0xff00ff00
    v_mov_b32 v0, s47
    s_mov_b64 exec, -1
    s_add_u32 s22, s19, s32
    s_add_u32 s25, s22, s28
    s_cmp_eq_u32 s3, 0
    s_cselect_b32 s25, s22, s25
    v_add_u32 v28, s25, v1
    s_add_u32 s25, s20, s62
    s_cselect_b32 s25, s25, s25
    s_cmp_eq_u32 s3, 0
    s_cselect_b32 s25, s22, s25
    s_mov_b32 exec_lo, 0
    v_add_u32 v28, s25, v1
    s_mov_b32 exec_lo, -1
    v_mov_b32 v24, -1
    v_mov_b32 v25, -1
    v_mov_b32 v26, -1
    v_mov_b32 v27, -1
    s_waitcnt vmcnt(15) lgkmcnt(0)
    v_mfma_f32_16x16x32_bf16 v[20:23], v[56:59], v[16:19], 0
    v_max3_u32 v9, v16, v17, v18
    v_max_u32 v9, v9, v19
    v_cmp_eq_u32 vcc, -1, v9
    s_cbranch_vccnz prp_10
    s_nop 3
    v_add_f32_dpp v20, v20, v20 row_ror:8 row_mask:0xf bank_mask:0xf
    v_add_f32_dpp v21, v21, v21 row_ror:8 row_mask:0xf bank_mask:0xf
    v_add_f32_dpp v22, v22, v22 row_ror:8 row_mask:0xf bank_mask:0xf
    v_add_f32_dpp v23, v23, v23 row_ror:8 row_mask:0xf bank_mask:0xf
    v_cvt_pk_bf16_f32 v20, v20, v21
    v_cvt_pk_bf16_f32 v21, v22, v23
    s_mov_b32 exec_hi, 0
    v_min_u32 v20, -2, v20
    v_min_u32 v21, -2, v21
    s_mov_b32 exec_lo, 0x00ff00ff
    buffer_store_dwordx2 v[20:21], v13, s[4:7], s23 offen
    s_mov_b64 exec, -1
    s_branch ploop_6_pst
ploop_6_pnd:
    s_sleep 6
    s_nop 8
    buffer_load_dwordx4 v[16:19], v12, s[4:7], s30 offen sc1
    buffer_load_dword v15, off, s[4:7], s58 sc1
    s_add_u32 s22, s16, 1
    v_mov_b32 v60, s22
    v_mov_b32 v32, 0
    v_mov_b32 v33, 0
    v_mov_b32 v34, 0
    v_mov_b32 v35, 0
    v_mov_b32 v36, 0
    v_mov_b32 v37, 0
    v_mov_b32 v38, 0
    v_mov_b32 v39, 0
    v_mov_b32 v40, 0
    v_mov_b32 v41, 0
    v_mov_b32 v42, 0
    v_mov_b32 v43, 0
    v_mov_b32 v44, 0
    v_mov_b32 v45, 0
    v_mov_b32 v46, 0
    v_mov_b32 v47, 0
    v_mov_b32 v48, 0
    v_mov_b32 v49, 0
    v_mov_b32 v50, 0
    v_mov_b32 v51, 0
    v_mov_b32 v52, 0
    v_mov_b32 v53, 0
    v_mov_b32 v54, 0
    v_mov_b32 v55, 0
    v_mov_b32 v0, 1.0
    s_mov_b32 exec_lo, 0xff00ff00
    s_mov_b32 exec_hi, 0xff00ff00
    v_mov_b32 v0, s47
    s_mov_b64 exec, -1
    s_add_u32 s22, s19, s32
    s_add_u32 s25, s22, s28
    s_cmp_eq_u32 s3, 0
    s_cselect_b32 s25, s22, s25
    v_add_u32 v28, s25, v1
    s_add_u32 s25, s20, s62
    s_cselect_b32 s25, s25, s25
    s_cmp_eq_u32 s3, 0
    s_cselect_b32 s25, s22, s25
    s_mov_b32 exec_lo, 0
    v_add_u32 v28, s25, v1
    s_mov_b32 exec_lo, -1
    v_mov_b32 v24, -1
    v_mov_b32 v25, -1
    v_mov_b32 v26, -1
    v_mov_b32 v27, -1
ploop_6_pagain:
    s_waitcnt vmcnt(1) lgkmcnt(0)
    v_mfma_f32_16x16x32_bf16 v[20:23], v[56:59], v[16:19], 0
    v_max3_u32 v9, v16, v17, v18
    v_max_u32 v9, v9, v19
    v_cmp_eq_u32 vcc, -1, v9
    s_cbranch_vccnz prp_10
ploop_6_pgo:
    s_nop 3
    v_add_f32_dpp v20, v20, v20 row_ror:8 row_mask:0xf bank_mask:0xf
    v_add_f32_dpp v21, v21, v21 row_ror:8 row_mask:0xf bank_mask:0xf
    v_add_f32_dpp v22, v22, v22 row_ror:8 row_mask:0xf bank_mask:0xf
    v_add_f32_dpp v23, v23, v23 row_ror:8 row_mask:0xf bank_mask:0xf
    v_cvt_pk_bf16_f32 v20, v20, v21
    v_cvt_pk_bf16_f32 v21, v22, v23
    s_mov_b32 exec_hi, 0
    v_min_u32 v20, -2, v20
    v_min_u32 v21, -2, v21
    s_mov_b32 exec_lo, 0x00ff00ff
    buffer_store_dwordx2 v[20:21], v13, s[4:7], s23 offen
    s_mov_b64 exec, -1
ploop_6_pst:
    s_cmp_ge_u32 s3, 2
    s_cbranch_scc1 ploop_6_nlr
    buffer_store_dwordx4 v[24:27], v28, s[4:7], 0 offen
ploop_6_nlr:
    s_add_u32 s16, s16, 1
    s_mov_b32 s17, s18
    s_mov_b32 s18, s19
    s_mov_b32 s19, s20
    s_add_u32 s20, s20, 262144
    s_cmp_eq_u32 s20, 210763776
    s_cselect_b32 s20, 209715200, s20
    s_branch ploop_6
prm_9_gt:
gate_13:
    v_readfirstlane_b32 s25, v15
    s_cmp_ge_u32 s25, s59
    s_cbranch_scc1 gate_13_ok
    s_sleep 8
    buffer_load_dword v15, off, s[4:7], s58 sc1
    s_waitcnt vmcnt(0)
    s_sub_u32 s26, s26, 1
    s_cbranch_scc0 gate_13
    s_mov_b32 s26, 0
gate_13_ok:
    s_branch prm_9_gtb
prm_9_0:
    s_sub_u32 s26, s26, 1
    s_cbranch_scc1 prm_9_0_g
    buffer_load_dwordx4 v[16:19], v1, s[4:7], s21 offen offset:0 sc1
    buffer_load_dwordx4 v[20:23], v1, s[4:7], s21 offen offset:1024 sc1
    buffer_load_dwordx4 v[24:27], v1, s[4:7], s21 offen offset:2048 sc1
    buffer_load_dwordx4 v[28:31], v1, s[4:7], s21 offen offset:3072 sc1
    s_waitcnt vmcnt(3)
    v_max3_u32 v9, v16, v17, v18
    v_max_u32 v9, v9, v19
    v_cmp_eq_u32 vcc, -1, v9
    s_cbranch_vccnz prm_9_0
    s_branch prm_9_0ok
prm_9_0_g:
    s_mov_b32 s26, 0
    s_waitcnt vmcnt(0)
    s_branch prm_9_0ok
prm_9_1:
    s_sub_u32 s26, s26, 1
    s_cbranch_scc1 prm_9_1_g
    buffer_load_dwordx4 v[20:23], v1, s[4:7], s21 offen offset:1024 sc1
    buffer_load_dwordx4 v[24:27], v1, s[4:7], s21 offen offset:2048 sc1
    buffer_load_dwordx4 v[28:31], v1, s[4:7], s21 offen offset:3072 sc1
    s_waitcnt vmcnt(2)
    v_max3_u32 v9, v20, v21, v22
    v_max_u32 v9, v9, v23
    v_cmp_eq_u32 vcc, -1, v9
    s_cbranch_vccnz prm_9_1
    s_branch prm_9_1ok
prm_9_1_g:
    s_mov_b32 s26, 0
    s_waitcnt vmcnt(0)
    s_branch prm_9_1ok
prm_9_2:
    s_sub_u32 s26, s26, 1
    s_cbranch_scc1 prm_9_2_g
    buffer_load_dwordx4 v[24:27], v1, s[4:7], s21 offen offset:2048 sc1
    buffer_load_dwordx4 v[28:31], v1, s[4:7], s21 offen offset:3072 sc1
    s_waitcnt vmcnt(1)
    v_max3_u32 v9, v24, v25, v26
    v_max_u32 v9, v9, v27
    v_cmp_eq_u32 vcc, -1, v9
    s_cbranch_vccnz prm_9_2
    s_branch prm_9_2ok
prm_9_2_g:
    s_mov_b32 s26, 0
    s_waitcnt vmcnt(0)
    s_branch prm_9_2ok
prm_9_3:
    s_sub_u32 s26, s26, 1
    s_cbranch_scc1 prm_9_3_g
    buffer_load_dwordx4 v[28:31], v1, s[4:7], s21 offen offset:3072 sc1
    s_waitcnt vmcnt(0)
    v_max3_u32 v9, v28, v29, v30
    v_max_u32 v9, v9, v31
    v_cmp_eq_u32 vcc, -1, v9
    s_cbranch_vccnz prm_9_3
    s_branch prm_9_3ok
prm_9_3_g:
    s_mov_b32 s26, 0
    s_waitcnt vmcnt(0)
    s_branch prm_9_3ok
prm_9_d:
gate_14:
    v_readfirstlane_b32 s25, v15
    s_cmp_ge_u32 s25, s59
    s_cbranch_scc1 gate_14_ok
    s_sleep 8
    buffer_load_dword v15, off, s[4:7], s58 sc1
    s_waitcnt vmcnt(0)
    s_sub_u32 s26, s26, 1
    s_cbranch_scc0 gate_14
    s_mov_b32 s26, 0
gate_14_ok:
    ds_write_b32 v14, v60
    v_add_f32 v32, v32, v33
    v_add_f32 v34, v34, v35
    ds_write2_b32 v4, v32, v34 offset0:0 offset1:104
    v_add_f32 v36, v36, v37
    v_add_f32 v38, v38, v39
    ds_write2_b32 v4, v36, v38 offset0:16 offset1:120
    v_add_f32 v40, v40, v41
    v_add_f32 v42, v42, v43
    ds_write2_b32 v4, v40, v42 offset0:32 offset1:136
    v_add_f32 v44, v44, v45
    v_add_f32 v46, v46, v47
    ds_write2_b32 v4, v44, v46 offset0:48 offset1:152
    v_add_f32 v48, v48, v49
    v_add_f32 v50, v50, v51
    ds_write2_b32 v4, v48, v50 offset0:64 offset1:168
    v_add_f32 v52, v52, v53
    v_add_f32 v54, v54, v55
    ds_write2_b32 v4, v52, v54 offset0:80 offset1:184
    s_branch pnc_7_done
prp_10:
    s_sub_u32 s26, s26, 1
    s_nop 3
    s_cbranch_scc1 prp_10_g
    buffer_load_dwordx4 v[16:19], v12, s[4:7], s30 offen sc1
    buffer_load_dword v15, off, s[4:7], s58 sc1
    s_branch ploop_6_pagain
prp_10_g:
    s_mov_b32 s26, 0
    s_branch ploop_6_pgo
ploop_6_zr:
    s_sub_u32 s26, s26, 1
    s_cbranch_scc1 ploop_6_zg
    buffer_load_dwordx4 v[32:35], v1, s[4:7], s22 offen offset:0 sc1
    buffer_load_dwordx4 v[36:39], v1, s[4:7], s22 offen offset:1024 sc1
    buffer_load_dwordx4 v[40:43], v1, s[4:7], s22 offen offset:2048 sc1
    buffer_load_dwordx4 v[44:47], v1, s[4:7], s22 offen offset:3072 sc1
    s_branch ploop_6_za
ploop_6_zg:
    s_mov_b32 s26, 0
    s_branch ploop_6_zok
ptail_8:
    s_cmp_eq_u32 s15, 0
    s_cbranch_scc1 ptail_8_nd
    s_nop 0
ptail_8_nd:
    s_barrier
    v_add_u32 v55, s68, v61
    ds_read_b128 v[24:27], v55 offset:0
    ds_read_b128 v[28:31], v55 offset:1024
    ds_read_b128 v[32:35], v55 offset:18560
    ds_read_b128 v[36:39], v55 offset:19584
    ds_read_b128 v[40:43], v55 offset:37120
    ds_read_b128 v[44:47], v55 offset:38144
    ds_read_b128 v[48:51], v55 offset:55680
    ds_read_b128 v[52:55], v55 offset:56704
    s_waitcnt lgkmcnt(4)
    v_add_f32 v24, v24, v32
    v_add_f32 v25, v25, v33
    v_add_f32 v26, v26, v34
    v_add_f32 v27, v27, v35
    v_add_f32 v28, v28, v36
    v_add_f32 v29, v29, v37
    v_add_f32 v30, v30, v38
    v_add_f32 v31, v31, v39
    s_waitcnt lgkmcnt(0)
    v_add_f32 v40, v40, v48
    v_add_f32 v41, v41, v49
    v_add_f32 v42, v42, v50
    v_add_f32 v43, v43, v51
    v_add_f32 v44, v44, v52
    v_add_f32 v45, v45, v53
    v_add_f32 v46, v46, v54
    v_add_f32 v47, v47, v55
    v_add_f32 v24, v24, v40
    v_add_f32 v25, v25, v41
    v_add_f32 v26, v26, v42
    v_add_f32 v27, v27, v43
    v_add_f32 v28, v28, v44
    v_add_f32 v29, v29, v45
    v_add_f32 v30, v30, v46
    v_add_f32 v31, v31, v47
    v_cvt_pk_bf16_f32 v24, v24, v25
    v_cvt_pk_bf16_f32 v25, v26, v27
    v_cvt_pk_bf16_f32 v26, v28, v29
    v_cvt_pk_bf16_f32 v27, v30, v31
    v_min_u32 v24, -2, v24
    v_min_u32 v25, -2, v25
    v_min_u32 v26, -2, v26
    v_min_u32 v27, -2, v27
    buffer_store_dwordx4 v[24:27], v1, s[4:7], s37 offen sc1
    s_branch k_end
ch_p_slow:
    v_mov_b32 v32, 0
    v_mov_b32 v33, 0
    v_mov_b32 v34, 0
    v_mov_b32 v35, 0
    v_mov_b32 v36, 0
    v_mov_b32 v37, 0
    v_mov_b32 v38, 0
    v_mov_b32 v39, 0
    v_mov_b32 v40, 0
    v_mov_b32 v41, 0
    v_mov_b32 v42, 0
    v_mov_b32 v43, 0
    v_mov_b32 v44, 0
    v_mov_b32 v45, 0
    v_mov_b32 v46, 0
    v_mov_b32 v47, 0
    v_mov_b32 v48, 0
    v_mov_b32 v49, 0
    v_mov_b32 v50, 0
    v_mov_b32 v51, 0
    v_mov_b32 v52, 0
    v_mov_b32 v53, 0
    v_mov_b32 v54, 0
    v_mov_b32 v55, 0
    v_mov_b32 v0, 1.0
    s_mov_b32 exec_lo, 0xff00ff00
    s_mov_b32 exec_hi, 0xff00ff00
    v_mov_b32 v0, s47
    s_mov_b64 exec, -1
    v_mov_b32 v60, s16
    v_smfmac_f32_16x16x64_bf16 v[32:35], v[16:19], v[64:71], v62
    v_smfmac_f32_16x16x64_bf16 v[36:39], v[16:19], v[72:79], v62
    v_smfmac_f32_16x16x64_bf16 v[40:43], v[16:19], v[80:87], v62
    v_smfmac_f32_16x16x64_bf16 v[44:47], v[16:19], v[88:95], v62
    v_smfmac_f32_16x16x64_bf16 v[48:51], v[16:19], v[96:103], v62
    v_smfmac_f32_16x16x64_bf16 v[52:55], v[16:19], v[104:111], v62
    v_smfmac_f32_16x16x64_bf16 v[32:35], v[20:23], v[112:119], v62
    v_smfmac_f32_16x16x64_bf16 v[36:39], v[20:23], v[120:127], v62
    v_smfmac_f32_16x16x64_bf16 v[40:43], v[20:23], v[128:135], v62
    v_smfmac_f32_16x16x64_bf16 v[44:47], v[20:23], v[136:143], v62
    v_smfmac_f32_16x16x64_bf16 v[48:51], v[20:23], v[144:151], v62
    v_smfmac_f32_16x16x64_bf16 v[52:55], v[20:23], v[152:159], v62
    v_smfmac_f32_16x16x64_bf16 v[32:35], v[24:27], v[160:167], v62
    v_smfmac_f32_16x16x64_bf16 v[36:39], v[24:27], v[168:175], v62
    v_smfmac_f32_16x16x64_bf16 v[40:43], v[24:27], v[176:183], v62
    v_smfmac_f32_16x16x64_bf16 v[44:47], v[24:27], v[184:191], v62
    v_smfmac_f32_16x16x64_bf16 v[48:51], v[24:27], v[192:199], v62
    v_smfmac_f32_16x16x64_bf16 v[52:55], v[24:27], v[200:207], v62
    v_smfmac_f32_16x16x64_bf16 v[32:35], v[28:31], v[208:215], v62
    ds_write_b32 v14, v60
    v_smfmac_f32_16x16x64_bf16 v[36:39], v[28:31], v[216:223], v62
    v_smfmac_f32_16x16x64_bf16 v[40:43], v[28:31], v[224:231], v62
    v_smfmac_f32_16x16x64_bf16 v[44:47], v[28:31], v[232:239], v62
    v_add_f32 v32, v32, v33
    v_add_f32 v34, v34, v35
    v_smfmac_f32_16x16x64_bf16 v[48:51], v[28:31], v[240:247], v62
    v_add_f32 v36, v36, v37
    v_add_f32 v38, v38, v39
    ds_write2_b32 v4, v32, v34 offset0:0 offset1:104
    v_smfmac_f32_16x16x64_bf16 v[52:55], v[28:31], v[248:255], v62
    v_add_f32 v40, v40, v41
    v_add_f32 v42, v42, v43
    ds_write2_b32 v4, v36, v38 offset0:16 offset1:120
    v_add_f32 v44, v44, v45
    v_add_f32 v46, v46, v47
    ds_write2_b32 v4, v40, v42 offset0:32 offset1:136
    v_add_f32 v48, v48, v49
    v_add_f32 v50, v50, v51
    ds_write2_b32 v4, v44, v46 offset0:48 offset1:152
    v_add_f32 v52, v52, v53
    v_add_f32 v54, v54, v55
    ds_write2_b32 v4, v48, v50 offset0:64 offset1:168
    ds_write2_b32 v4, v52, v54 offset0:80 offset1:184
    s_waitcnt vmcnt(0)
    s_branch pnc_16_done
.p2align 6
    s_nop 0
    s_nop 0
    s_nop 0
    s_nop 0
    s_nop 0
    s_nop 0
    s_nop 0
    s_nop 0
ploop_15:
    s_add_u32 s21, s17, s33
    s_nop 15
    s_nop 5
    buffer_load_dwordx4 v[16:19], v1, s[4:7], s21 offen offset:0 sc1
    s_nop 7
    buffer_load_dwordx4 v[20:23], v1, s[4:7], s21 offen offset:1024 sc1
    s_nop 7
    buffer_load_dwordx4 v[24:27], v1, s[4:7], s21 offen offset:2048 sc1
    s_nop 7
    buffer_load_dwordx4 v[28:31], v1, s[4:7], s21 offen offset:3072 sc1
    s_waitcnt vmcnt(3)
    v_max3_u32 v9, v16, v17, v18
    v_max_u32 v9, v9, v19
    v_cmp_eq_u32 vcc, -1, v9
    s_cbranch_vccnz prm_18_0
prm_18_0ok:
    v_smfmac_f32_16x16x64_bf16 v[32:35], v[16:19], v[64:71], v62
    v_smfmac_f32_16x16x64_bf16 v[36:39], v[16:19], v[72:79], v62
    v_smfmac_f32_16x16x64_bf16 v[40:43], v[16:19], v[80:87], v62
    s_waitcnt vmcnt(2)
    v_max3_u32 v9, v20, v21, v22
    v_max_u32 v9, v9, v23
    v_cmp_eq_u32 vcc, -1, v9
    v_smfmac_f32_16x16x64_bf16 v[44:47], v[16:19], v[88:95], v62
    v_smfmac_f32_16x16x64_bf16 v[48:51], v[16:19], v[96:103], v62
    v_smfmac_f32_16x16x64_bf16 v[52:55], v[16:19], v[104:111], v62
    s_cbranch_vccnz prm_18_1
prm_18_1ok:
    v_smfmac_f32_16x16x64_bf16 v[32:35], v[20:23], v[112:119], v62
    v_readfirstlane_b32 s23, v15
    v_smfmac_f32_16x16x64_bf16 v[36:39], v[20:23], v[120:127], v62
    v_smfmac_f32_16x16x64_bf16 v[40:43], v[20:23], v[128:135], v62
    s_waitcnt vmcnt(1)
    v_max3_u32 v9, v24, v25, v26
    v_max_u32 v9, v9, v27
    v_cmp_eq_u32 vcc, -1, v9
    v_smfmac_f32_16x16x64_bf16 v[44:47], v[20:23], v[136:143], v62
    v_smfmac_f32_16x16x64_bf16 v[48:51], v[20:23], v[144:151], v62
    v_smfmac_f32_16x16x64_bf16 v[52:55], v[20:23], v[152:159], v62
    s_cbranch_vccnz prm_18_2
prm_18_2ok:
    v_smfmac_f32_16x16x64_bf16 v[32:35], v[24:27], v[160:167], v62
    v_smfmac_f32_16x16x64_bf16 v[36:39], v[24:27], v[168:175], v62
    v_smfmac_f32_16x16x64_bf16 v[40:43], v[24:27], v[176:183], v62
    s_waitcnt vmcnt(0)
    v_max3_u32 v9, v28, v29, v30
    v_max_u32 v9, v9, v31
    v_cmp_eq_u32 vcc, -1, v9
    v_smfmac_f32_16x16x64_bf16 v[44:47], v[24:27], v[184:191], v62
    v_smfmac_f32_16x16x64_bf16 v[48:51], v[24:27], v[192:199], v62
    v_smfmac_f32_16x16x64_bf16 v[52:55], v[24:27], v[200:207], v62
    s_cbranch_vccnz prm_18_3
prm_18_3ok:
    v_smfmac_f32_16x16x64_bf16 v[32:35], v[28:31], v[208:215], v62
    s_cmp_lt_u32 s23, s59
    s_cbranch_scc1 prm_18_gt
prm_18_gtb:
    ds_write_b32 v14, v60
    v_smfmac_f32_16x16x64_bf16 v[36:39], v[28:31], v[216:223], v62
    v_smfmac_f32_16x16x64_bf16 v[40:43], v[28:31], v[224:231], v62
    v_smfmac_f32_16x16x64_bf16 v[44:47], v[28:31], v[232:239], v62
    v_add_f32 v32, v32, v33
    v_add_f32 v34, v34, v35
    v_smfmac_f32_16x16x64_bf16 v[48:51], v[28:31], v[240:247], v62
    v_add_f32 v36, v36, v37
    v_add_f32 v38, v38, v39
    ds_write2_b32 v4, v32, v34 offset0:0 offset1:104
    v_smfmac_f32_16x16x64_bf16 v[52:55], v[28:31], v[248:255], v62
    v_add_f32 v40, v40, v41
    v_add_f32 v42, v42, v43
    ds_write2_b32 v4, v36, v38 offset0:16 offset1:120
    v_add_f32 v44, v44, v45
    v_add_f32 v46, v46, v47
    ds_write2_b32 v4, v40, v42 offset0:32 offset1:136
    v_add_f32 v48, v48, v49
    v_add_f32 v50, v50, v51
    ds_write2_b32 v4, v44, v46 offset0:48 offset1:152
    v_add_f32 v52, v52, v53
    v_add_f32 v54, v54, v55
    ds_write2_b32 v4, v48, v50 offset0:64 offset1:168
    ds_write2_b32 v4, v52, v54 offset0:80 offset1:184
pnc_16_done:
    s_add_u32 s21, s17, s32
    s_add_u32 s22, s19, s32
    s_add_u32 s24, s19, s35
    s_waitcnt lgkmcnt(0)
    s_barrier
    ds_read_b64 v[32:33], v5 offset:0
    ds_read_b64 v[34:35], v5 offset:3328
    ds_read_b64 v[36:37], v5 offset:6656
    ds_read_b64 v[38:39], v5 offset:9984
    ds_read_b64 v[40:41], v6 offset:0
    ds_read_b64 v[42:43], v6 offset:3328
    ds_read_b64 v[44:45], v6 offset:6656
    ds_read_b64 v[46:47], v6 offset:9984
    s_waitcnt lgkmcnt(6)
    v_add_f32 v32, v32, v34
    v_add_f32 v33, v33, v35
    v_mul_f32 v32, v32, v0
    v_mul_f32 v33, v33, v0
    s_waitcnt lgkmcnt(4)
    v_add_f32 v36, v36, v38
    v_add_f32 v37, v37, v39
    v_fma_f32 v32, v36, v0, v32
    v_fma_f32 v33, v37, v0, v33
    v_cvt_pk_bf16_f32 v32, v32, v33
    v_min_u32 v32, -2, v32
    buffer_store_dword v32, v2, s[4:7], s21 offen sc1
    s_waitcnt lgkmcnt(2)
    v_add_f32 v40, v40, v42
    v_add_f32 v41, v41, v43
    s_waitcnt lgkmcnt(0)
    v_add_f32 v44, v44, v46
    v_add_f32 v45, v45, v47
    v_add_f32 v40, v40, v44
    v_add_f32 v41, v41, v45
    v_cvt_pk_bf16_f32 v40, v40, v41
    v_min_u32 v40, -2, v40
    s_mov_b32 exec_hi, 0
    buffer_store_dword v40, v3, s[4:7], s21 offen sc1
    s_setprio 0
    s_mov_b64 exec, -1
    s_add_u32 s21, s17, s35
    s_add_u32 s30, s17, s34
    s_add_u32 s23, s18, s36
    s_cmp_lg_u32 s16, 0
    s_cbranch_scc1 ploop_15_n0
gate_20:
    v_readfirstlane_b32 s25, v15
    s_cmp_ge_u32 s25, s59
    s_cbranch_scc1 gate_20_ok
    s_sleep 8
    buffer_load_dword v15, off, s[4:7], s58 sc1
    s_waitcnt vmcnt(0)
    s_sub_u32 s26, s26, 1
    s_cbranch_scc0 gate_20
    s_mov_b32 s26, 0
gate_20_ok:
    s_cmp_eq_u32 s15, 0
    s_cbranch_scc1 ploop_15_st_nk
    s_add_u32 m0, s53, 0
    s_add_u32 s22, s52, 0
    buffer_load_dwordx4 v1, s[4:7], s22 offen offset:0 sc1 lds
    buffer_load_dwordx4 v1, s[4:7], s22 offen offset:1024 sc1 lds
    buffer_load_dwordx4 v1, s[4:7], s22 offen offset:2048 sc1 lds
    buffer_load_dwordx4 v1, s[4:7], s22 offen offset:3072 sc1 lds
    s_add_u32 m0, s53, 4096
    s_add_u32 s22, s52, 131072
    buffer_load_dwordx4 v1, s[4:7], s22 offen offset:0 sc1 lds
    buffer_load_dwordx4 v1, s[4:7], s22 offen offset:1024 sc1 lds
    buffer_load_dwordx4 v1, s[4:7], s22 offen offset:2048 sc1 lds
    buffer_load_dwordx4 v1, s[4:7], s22 offen offset:3072 sc1 lds
    s_add_u32 s52, s52, 262144
    s_sub_u32 s52, s52, 262144
ploop_15_st_nk:
    s_add_u32 s52, s52, 262144
    s_cmp_lg_u32 s3, 2
    s_cbranch_scc1 ploop_15_st_npf
    v_subrev_u32 v32, 786432, v63
    s_mov_b32 exec_hi, 0xffff
    s_mov_b32 s22, 262144
    buffer_load_dword v33, v32, s[4:7], s22 offen sc1
    s_mov_b32 s22, 524288
    buffer_load_dword v33, v32, s[4:7], s22 offen sc1
    s_mov_b32 exec_hi, -1
    s_waitcnt vmcnt(0)
ploop_15_st_npf:
    s_cmp_eq_u32 s15, 0
    s_cbranch_scc1 ploop_15_st_p_nd
    s_mov_b32 m0, 124928
    s_nop 0
    buffer_load_dwordx4 v1, s[4:7], s69 offen offset:0 sc1 lds
    buffer_load_dwordx4 v1, s[4:7], s69 offen offset:1024 sc1 lds
    buffer_load_dwordx4 v1, s[4:7], s69 offen offset:2048 sc1 lds
    buffer_load_dwordx4 v1, s[4:7], s69 offen offset:3072 sc1 lds
    s_add_u32 s69, s69, 262144
    s_waitcnt vmcnt(0)
ploop_15_st_p_nd:
ploop_15_n0:
    s_add_u32 s25, s16, 2
    s_min_u32 s25, s25, 63
    s_cmp_lt_u32 s25, 8
    s_cselect_b32 s59, 12, 24
    s_cselect_b32 s58, -4, -8
    s_and_b32 s25, s25, s58
    s_lshl_b32 s25, s25, 5
    s_add_u32 s58, s25, s60
    s_cmp_eq_u32 s15, 0
    s_cbranch_scc1 ploop_15_nd
    v_add_u32 v9, s53, v1
    v_add_u32 v0, 124928, v1
    ds_read_b128 v[16:19], v0 offset:0
    ds_read_b128 v[32:35], v9 offset:0
    ds_read_b128 v[20:23], v0 offset:1024
    ds_read_b128 v[36:39], v9 offset:1024
    ds_read_b128 v[24:27], v0 offset:2048
    ds_read_b128 v[40:43], v9 offset:2048
    ds_read_b128 v[28:31], v0 offset:3072
    ds_read_b128 v[44:47], v9 offset:3072
    s_add_u32 s22, s17, s61
    s_waitcnt lgkmcnt(6)
    v_mfma_f32_16x16x32_bf16 v[48:51], v[32:35], v[16:19], 0
    ds_read_b128 v[32:35], v9 offset:4096
    s_waitcnt lgkmcnt(5)
    v_mfma_f32_16x16x32_bf16 v[48:51], v[36:39], v[20:23], v[48:51]
    ds_read_b128 v[36:39], v9 offset:5120
    s_waitcnt lgkmcnt(4)
    v_mfma_f32_16x16x32_bf16 v[48:51], v[40:43], v[24:27], v[48:51]
    ds_read_b128 v[40:43], v9 offset:6144
    s_waitcnt lgkmcnt(3)
    v_mfma_f32_16x16x32_bf16 v[48:51], v[44:47], v[28:31], v[48:51]
    ds_read_b128 v[44:47], v9 offset:7168
    s_waitcnt lgkmcnt(3)
    v_mfma_f32_16x16x32_bf16 v[52:55], v[32:35], v[16:19], 0
    s_waitcnt lgkmcnt(2)
    v_mfma_f32_16x16x32_bf16 v[52:55], v[36:39], v[20:23], v[52:55]
    s_waitcnt lgkmcnt(1)
    v_mfma_f32_16x16x32_bf16 v[52:55], v[40:43], v[24:27], v[52:55]
    s_waitcnt lgkmcnt(0)
    v_mfma_f32_16x16x32_bf16 v[52:55], v[44:47], v[28:31], v[52:55]
    buffer_load_dwordx4 v[32:35], v1, s[4:7], s22 offen offset:0 sc1
    buffer_load_dwordx4 v[36:39], v1, s[4:7], s22 offen offset:1024 sc1
    buffer_load_dwordx4 v[40:43], v1, s[4:7], s22 offen offset:2048 sc1
    buffer_load_dwordx4 v[44:47], v1, s[4:7], s22 offen offset:3072 sc1
    v_mov_b32 v60, 0xff61b1e6
    s_nop 2
    v_cndmask_b32 v48, v48, v60, s[38:39]
    v_cndmask_b32 v49, v49, v60, s[40:41]
    v_cndmask_b32 v50, v50, v60, s[42:43]
    v_cndmask_b32 v51, v51, v60, s[44:45]
    v_cndmask_b32 v52, v52, v60, s[48:49]
    v_cndmask_b32 v53, v53, v60, s[50:51]
    v_cndmask_b32 v54, v54, v60, s[54:55]
    v_cndmask_b32 v55, v55, v60, s[56:57]
    v_max3_f32 v0, v48, v49, v50
    v_max3_f32 v9, v51, v52, v53
    v_max3_f32 v0, v0, v54, v55
    v_max_f32 v0, v0, v9
    v_mov_b32 v9, v0
    s_nop 1
    v_permlane16_swap_b32 v9, v0
    v_max_f32 v0, v0, v9
    v_mov_b32 v9, v0
    s_nop 1
    v_permlane32_swap_b32 v9, v0
    v_max_f32 v0, v0, v9
    v_mul_f32 v0, s47, v0
    v_fma_f32 v48, v48, s47, -v0
    v_fma_f32 v49, v49, s47, -v0
    v_fma_f32 v50, v50, s47, -v0
    v_fma_f32 v51, v51, s47, -v0
    v_fma_f32 v52, v52, s47, -v0
    v_fma_f32 v53, v53, s47, -v0
    v_fma_f32 v54, v54, s47, -v0
    v_fma_f32 v55, v55, s47, -v0
    v_exp_f32 v48, v48
    v_exp_f32 v49, v49
    v_exp_f32 v50, v50
    v_exp_f32 v51, v51
    v_exp_f32 v52, v52
    v_exp_f32 v53, v53
    v_exp_f32 v54, v54
    v_exp_f32 v55, v55
    v_add_f32 v15, v48, v49
    v_add_f32 v15, v15, v50
    v_add_f32 v15, v15, v51
    v_add_f32 v15, v15, v52
    v_add_f32 v15, v15, v53
    v_add_f32 v15, v15, v54
    v_add_f32 v15, v15, v55
ploop_15_za:
    s_waitcnt vmcnt(0)
    v_max3_u32 v9, v32, v33, v34
    v_max3_u32 v9, v9, v35, v36
    v_max3_u32 v9, v9, v37, v38
    v_max3_u32 v9, v9, v39, v40
    v_max3_u32 v9, v9, v41, v42
    v_max3_u32 v9, v9, v43, v44
    v_max3_u32 v9, v9, v45, v46
    v_max_u32 v9, v9, v47
    v_cmp_eq_u32 vcc, -1, v9
    s_cbranch_vccnz ploop_15_zr
ploop_15_zok:
    v_mfma_f32_16x16x32_bf16 v[56:59], v[32:35], v[16:19], 0
    v_mfma_f32_16x16x32_bf16 v[56:59], v[36:39], v[20:23], v[56:59]
    v_mfma_f32_16x16x32_bf16 v[56:59], v[40:43], v[24:27], v[56:59]
    v_mfma_f32_16x16x32_bf16 v[56:59], v[44:47], v[28:31], v[56:59]
    s_add_u32 s22, s17, s14
    s_nop 6
    v_max_f32 v60, v56, v57
    v_mov_b32 v9, v60
    s_nop 1
    v_permlane16_swap_b32 v9, v60
    v_max_f32 v60, v60, v9
    v_mov_b32 v9, v60
    s_nop 1
    v_permlane32_swap_b32 v9, v60
    v_max_f32 v60, v60, v9
    v_mul_f32 v60, s47, v60
    v_max_f32 v58, v60, v0
    v_sub_f32 v60, v0, v58
    v_fma_f32 v56, v56, s47, -v58
    v_fma_f32 v57, v57, s47, -v58
    v_exp_f32 v60, v60
    v_exp_f32 v56, v56
    v_exp_f32 v57, v57
    v_fma_f32 v15, v15, v60, v56
    v_add_f32 v15, v15, v57
    v_mov_b32 v9, v15
    s_nop 1
    v_permlane16_swap_b32 v9, v15
    v_add_f32 v15, v15, v9
    v_mov_b32 v9, v15
    s_nop 1
    v_permlane32_swap_b32 v9, v15
    v_add_f32 v15, v15, v9
    v_rcp_f32 v15, v15
    s_add_u32 s25, s19, s14
    v_mul_f32 v56, v56, v15
    v_mul_f32 v57, v57, v15
    v_mul_f32 v60, v60, v15
    v_mul_f32 v48, v48, v60
    v_mul_f32 v49, v49, v60
    v_mul_f32 v50, v50, v60
    v_mul_f32 v51, v51, v60
    v_mul_f32 v52, v52, v60
    v_mul_f32 v53, v53, v60
    v_mul_f32 v54, v54, v60
    v_mul_f32 v55, v55, v60
    v_cvt_pk_bf16_f32 v48, v48, v49
    v_cvt_pk_bf16_f32 v49, v50, v51
    v_cvt_pk_bf16_f32 v50, v52, v53
    v_cvt_pk_bf16_f32 v51, v54, v55
    v_min_u32 v48, -2, v48
    v_min_u32 v49, -2, v49
    v_min_u32 v50, -2, v50
    v_min_u32 v51, -2, v51
    v_lshlrev_b32 v54, 1, v8
    v_add_u32 v55, 14336, v1
    v_mov_b32 v53, 1.0
    v_cvt_pk_bf16_f32 v52, v56, v57
    v_min_u32 v53, -2, v53
    v_min_u32 v52, -2, v52
    buffer_store_dwordx4 v[48:51], v1, s[4:7], s22 offen sc1
    buffer_store_dwordx2 v[52:53], v54, s[4:7], s22 offen offset:1024 sc1
    ds_read_b128 v[56:59], v55
    s_branch ploop_15_nd2
ploop_15_nd:
    s_cmp_eq_u32 s16, 0
    s_cbranch_scc1 ploop_15_ns
    s_cmp_eq_u32 s31, 0
    s_cbranch_scc1 ploop_15_n2
    s_add_u32 s25, s68, s46
    v_add_u32 v55, s25, v61
    ds_read_b128 v[24:27], v55 offset:0
    ds_read_b128 v[28:31], v55 offset:1024
    ds_read_b128 v[32:35], v55 offset:18560
    ds_read_b128 v[36:39], v55 offset:19584
    ds_read_b128 v[40:43], v55 offset:37120
    ds_read_b128 v[44:47], v55 offset:38144
    ds_read_b128 v[48:51], v55 offset:55680
    ds_read_b128 v[52:55], v55 offset:56704
    s_waitcnt lgkmcnt(4)
    v_add_f32 v24, v24, v32
    v_add_f32 v25, v25, v33
    v_add_f32 v26, v26, v34
    v_add_f32 v27, v27, v35
    v_add_f32 v28, v28, v36
    v_add_f32 v29, v29, v37
    v_add_f32 v30, v30, v38
    v_add_f32 v31, v31, v39
    s_waitcnt lgkmcnt(0)
    v_add_f32 v40, v40, v48
    v_add_f32 v41, v41, v49
    v_add_f32 v42, v42, v50
    v_add_f32 v43, v43, v51
    v_add_f32 v44, v44, v52
    v_add_f32 v45, v45, v53
    v_add_f32 v46, v46, v54
    v_add_f32 v47, v47, v55
    v_add_f32 v24, v24, v40
    v_add_f32 v25, v25, v41
    v_add_f32 v26, v26, v42
    v_add_f32 v27, v27, v43
    v_add_f32 v28, v28, v44
    v_add_f32 v29, v29, v45
    v_add_f32 v30, v30, v46
    v_add_f32 v31, v31, v47
    v_cvt_pk_bf16_f32 v24, v24, v25
    v_cvt_pk_bf16_f32 v25, v26, v27
    v_cvt_pk_bf16_f32 v26, v28, v29
    v_cvt_pk_bf16_f32 v27, v30, v31
    v_min_u32 v24, -2, v24
    v_min_u32 v25, -2, v25
    v_min_u32 v26, -2, v26
    v_min_u32 v27, -2, v27
    v_mov_b32 v16, v24
    v_mov_b32 v17, v25
    v_mov_b32 v18, v26
    v_mov_b32 v19, v27
ploop_15_n2:
    v_add_u32 v55, s68, v61
    ds_read_b128 v[24:27], v55 offset:0
    ds_read_b128 v[28:31], v55 offset:1024
    ds_read_b128 v[32:35], v55 offset:18560
    ds_read_b128 v[36:39], v55 offset:19584
    ds_read_b128 v[40:43], v55 offset:37120
    ds_read_b128 v[44:47], v55 offset:38144
    ds_read_b128 v[48:51], v55 offset:55680
    ds_read_b128 v[52:55], v55 offset:56704
    s_waitcnt lgkmcnt(4)
    v_add_f32 v24, v24, v32
    v_add_f32 v25, v25, v33
    v_add_f32 v26, v26, v34
    v_add_f32 v27, v27, v35
    v_add_f32 v28, v28, v36
    v_add_f32 v29, v29, v37
    v_add_f32 v30, v30, v38
    v_add_f32 v31, v31, v39
    s_waitcnt lgkmcnt(0)
    v_add_f32 v40, v40, v48
    v_add_f32 v41, v41, v49
    v_add_f32 v42, v42, v50
    v_add_f32 v43, v43, v51
    v_add_f32 v44, v44, v52
    v_add_f32 v45, v45, v53
    v_add_f32 v46, v46, v54
    v_add_f32 v47, v47, v55
    v_add_f32 v24, v24, v40
    v_add_f32 v25, v25, v41
    v_add_f32 v26, v26, v42
    v_add_f32 v27, v27, v43
    v_add_f32 v28, v28, v44
    v_add_f32 v29, v29, v45
    v_add_f32 v30, v30, v46
    v_add_f32 v31, v31, v47
    v_cvt_pk_bf16_f32 v24, v24, v25
    v_cvt_pk_bf16_f32 v25, v26, v27
    v_cvt_pk_bf16_f32 v26, v28, v29
    v_cvt_pk_bf16_f32 v27, v30, v31
    v_min_u32 v24, -2, v24
    v_min_u32 v25, -2, v25
    v_min_u32 v26, -2, v26
    v_min_u32 v27, -2, v27
ploop_15_ns:
ploop_15_flag:
    ds_read_b32 v9, v14 offset:16
    s_waitcnt lgkmcnt(0)
    v_readfirstlane_b32 s25, v9
    s_cmp_eq_u32 s25, s16
    s_cbranch_scc0 ploop_15_flag
    s_add_u32 m0, s53, 0
    s_add_u32 s22, s52, 0
    buffer_load_dwordx4 v1, s[4:7], s22 offen offset:0 sc1 lds
    buffer_load_dwordx4 v1, s[4:7], s22 offen offset:1024 sc1 lds
    buffer_load_dwordx4 v1, s[4:7], s22 offen offset:2048 sc1 lds
    buffer_load_dwordx4 v1, s[4:7], s22 offen offset:3072 sc1 lds
    s_add_u32 m0, s53, 4096
    s_add_u32 s22, s52, 131072
    buffer_load_dwordx4 v1, s[4:7], s22 offen offset:0 sc1 lds
    buffer_load_dwordx4 v1, s[4:7], s22 offen offset:1024 sc1 lds
    buffer_load_dwordx4 v1, s[4:7], s22 offen offset:2048 sc1 lds
    buffer_load_dwordx4 v1, s[4:7], s22 offen offset:3072 sc1 lds
    s_add_u32 s52, s52, 262144
ploop_15_nk:
    s_cmp_eq_u32 s16, 0
    s_cbranch_scc1 ploop_15_nd2
    buffer_store_dwordx4 v[24:27], v1, s[4:7], s37 offen sc1
    s_cmp_eq_u32 s31, 0
    s_cbranch_scc1 ploop_15_nd2
    s_add_u32 s25, s37, s27
    buffer_store_dwordx4 v[16:19], v1, s[4:7], s25 offen sc1
ploop_15_nd2:
    s_cmp_eq_u32 s16, 0
    s_cbranch_scc1 ploop_15_nn
    s_add_u32 s37, s37, 65536
    s_xor_b32 s68, s68, 8192
ploop_15_nn:
    s_cmp_lg_u32 s3, 2
    s_cbranch_scc1 ppf_21
    s_lshl_b32 s22, s16, 18
    s_mov_b32 exec_hi, 0xffff
    buffer_load_dword v9, v63, s[4:7], s22 offen sc1
    s_mov_b32 exec_hi, -1
ppf_21:
    v_add_u32 v24, 18560, v7
    v_add_u32 v25, 37120, v7
    v_add_u32 v26, 55680, v7
    s_cmp_eq_u32 s16, 63
    s_setprio 3
    s_barrier
    s_cbranch_scc1 ptail_17
    ds_read2_b32 v[16:17], v7 offset0:0 offset1:2
    ds_read2_b32 v[18:19], v24 offset0:0 offset1:2
    ds_read2_b32 v[20:21], v25 offset0:0 offset1:2
    ds_read2_b32 v[22:23], v26 offset0:0 offset1:2
    s_waitcnt lgkmcnt(2)
    v_add_f32 v16, v16, v18
    v_add_f32 v17, v17, v19
    s_waitcnt lgkmcnt(0)
    v_add_f32 v20, v20, v22
    v_add_f32 v21, v21, v23
    v_add_f32 v16, v16, v20
    v_add_f32 v17, v17, v21
    v_cvt_pk_bf16_f32 v16, v16, v17
    v_min_u32 v16, -2, v16
    buffer_store_dword v16, v2, s[4:7], s21 offen sc1
    buffer_store_dword v10, v2, s[4:7], s24 offen sc1
    s_cmp_eq_u32 s15, 0
    s_cbranch_scc1 ploop_15_pnd
    s_sleep 6
    s_nop 8
    buffer_load_dwordx4 v[16:19], v12, s[4:7], s30 offen sc1
    buffer_load_dword v15, off, s[4:7], s58 sc1
    s_add_u32 s25, s19, s14
    v_mov_b32 v20, -1
    v_mov_b32 v21, -1
    v_mov_b32 v22, -1
    v_mov_b32 v23, -1
    buffer_store_dwordx4 v[20:23], v1, s[4:7], s25 offen sc1
    buffer_store_dwordx2 v[20:21], v54, s[4:7], s25 offen offset:1024 sc1
    s_mov_b32 m0, 124928
    s_nop 0
    buffer_load_dwordx4 v1, s[4:7], s69 offen offset:0 sc1 lds
    buffer_load_dwordx4 v1, s[4:7], s69 offen offset:1024 sc1 lds
    buffer_load_dwordx4 v1, s[4:7], s69 offen offset:2048 sc1 lds
    buffer_load_dwordx4 v1, s[4:7], s69 offen offset:3072 sc1 lds
    s_add_u32 s69, s69, 262144
    s_add_u32 m0, s53, 0
    s_add_u32 s22, s52, 0
    buffer_load_dwordx4 v1, s[4:7], s22 offen offset:0 sc1 lds
    buffer_load_dwordx4 v1, s[4:7], s22 offen offset:1024 sc1 lds
    buffer_load_dwordx4 v1, s[4:7], s22 offen offset:2048 sc1 lds
    buffer_load_dwordx4 v1, s[4:7], s22 offen offset:3072 sc1 lds
    s_add_u32 m0, s53, 4096
    s_add_u32 s22, s52, 131072
    buffer_load_dwordx4 v1, s[4:7], s22 offen offset:0 sc1 lds
    buffer_load_dwordx4 v1, s[4:7], s22 offen offset:1024 sc1 lds
    buffer_load_dwordx4 v1, s[4:7], s22 offen offset:2048 sc1 lds
    buffer_load_dwordx4 v1, s[4:7], s22 offen offset:3072 sc1 lds
    s_add_u32 s52, s52, 262144
    s_add_u32 s22, s16, 1
    v_mov_b32 v60, s22
    v_mov_b32 v32, 0
    v_mov_b32 v33, 0
    v_mov_b32 v34, 0
    v_mov_b32 v35, 0
    v_mov_b32 v36, 0
    v_mov_b32 v37, 0
    v_mov_b32 v38, 0
    v_mov_b32 v39, 0
    v_mov_b32 v40, 0
    v_mov_b32 v41, 0
    v_mov_b32 v42, 0
    v_mov_b32 v43, 0
    v_mov_b32 v44, 0
    v_mov_b32 v45, 0
    v_mov_b32 v46, 0
    v_mov_b32 v47, 0
    v_mov_b32 v48, 0
    v_mov_b32 v49, 0
    v_mov_b32 v50, 0
    v_mov_b32 v51, 0
    v_mov_b32 v52, 0
    v_mov_b32 v53, 0
    v_mov_b32 v54, 0
    v_mov_b32 v55, 0
    v_mov_b32 v0, 1.0
    s_mov_b32 exec_lo, 0xff00ff00
    s_mov_b32 exec_hi, 0xff00ff00
    v_mov_b32 v0, s47
    s_mov_b64 exec, -1
    s_add_u32 s22, s19, s32
    s_add_u32 s25, s22, s28
    s_cmp_eq_u32 s3, 0
    s_cselect_b32 s25, s22, s25
    v_add_u32 v28, s25, v1
    s_add_u32 s25, s20, s62
    s_cselect_b32 s25, s25, s25
    s_cmp_eq_u32 s3, 0
    s_cselect_b32 s25, s22, s25
    s_mov_b32 exec_lo, 0
    v_add_u32 v28, s25, v1
    s_mov_b32 exec_lo, -1
    v_mov_b32 v24, -1
    v_mov_b32 v25, -1
    v_mov_b32 v26, -1
    v_mov_b32 v27, -1
    s_waitcnt vmcnt(15) lgkmcnt(0)
    v_mfma_f32_16x16x32_bf16 v[20:23], v[56:59], v[16:19], 0
    v_max3_u32 v9, v16, v17, v18
    v_max_u32 v9, v9, v19
    v_cmp_eq_u32 vcc, -1, v9
    s_cbranch_vccnz prp_19
    s_nop 3
    v_add_f32_dpp v20, v20, v20 row_ror:8 row_mask:0xf bank_mask:0xf
    v_add_f32_dpp v21, v21, v21 row_ror:8 row_mask:0xf bank_mask:0xf
    v_add_f32_dpp v22, v22, v22 row_ror:8 row_mask:0xf bank_mask:0xf
    v_add_f32_dpp v23, v23, v23 row_ror:8 row_mask:0xf bank_mask:0xf
    v_cvt_pk_bf16_f32 v20, v20, v21
    v_cvt_pk_bf16_f32 v21, v22, v23
    s_mov_b32 exec_hi, 0
    v_min_u32 v20, -2, v20
    v_min_u32 v21, -2, v21
    s_mov_b32 exec_lo, 0x00ff00ff
    buffer_store_dwordx2 v[20:21], v13, s[4:7], s23 offen sc1
    s_mov_b64 exec, -1
    s_branch ploop_15_pst
ploop_15_pnd:
    s_sleep 6
    s_nop 8
    buffer_load_dwordx4 v[16:19], v12, s[4:7], s30 offen sc1
    buffer_load_dword v15, off, s[4:7], s58 sc1
    s_add_u32 s22, s16, 1
    v_mov_b32 v60, s22
    v_mov_b32 v32, 0
    v_mov_b32 v33, 0
    v_mov_b32 v34, 0
    v_mov_b32 v35, 0
    v_mov_b32 v36, 0
    v_mov_b32 v37, 0
    v_mov_b32 v38, 0
    v_mov_b32 v39, 0
    v_mov_b32 v40, 0
    v_mov_b32 v41, 0
    v_mov_b32 v42, 0
    v_mov_b32 v43, 0
    v_mov_b32 v44, 0
    v_mov_b32 v45, 0
    v_mov_b32 v46, 0
    v_mov_b32 v47, 0
    v_mov_b32 v48, 0
    v_mov_b32 v49, 0
    v_mov_b32 v50, 0
    v_mov_b32 v51, 0
    v_mov_b32 v52, 0
    v_mov_b32 v53, 0
    v_mov_b32 v54, 0
    v_mov_b32 v55, 0
    v_mov_b32 v0, 1.0
    s_mov_b32 exec_lo, 0xff00ff00
    s_mov_b32 exec_hi, 0xff00ff00
    v_mov_b32 v0, s47
    s_mov_b64 exec, -1
    s_add_u32 s22, s19, s32
    s_add_u32 s25, s22, s28
    s_cmp_eq_u32 s3, 0
    s_cselect_b32 s25, s22, s25
    v_add_u32 v28, s25, v1
    s_add_u32 s25, s20, s62
    s_cselect_b32 s25, s25, s25
    s_cmp_eq_u32 s3, 0
    s_cselect_b32 s25, s22, s25
    s_mov_b32 exec_lo, 0
    v_add_u32 v28, s25, v1
    s_mov_b32 exec_lo, -1
    v_mov_b32 v24, -1
    v_mov_b32 v25, -1
    v_mov_b32 v26, -1
    v_mov_b32 v27, -1
ploop_15_pagain:
    s_waitcnt vmcnt(1) lgkmcnt(0)
    v_mfma_f32_16x16x32_bf16 v[20:23], v[56:59], v[16:19], 0
    v_max3_u32 v9, v16, v17, v18
    v_max_u32 v9, v9, v19
    v_cmp_eq_u32 vcc, -1, v9
    s_cbranch_vccnz prp_19
ploop_15_pgo:
    s_nop 3
    v_add_f32_dpp v20, v20, v20 row_ror:8 row_mask:0xf bank_mask:0xf
    v_add_f32_dpp v21, v21, v21 row_ror:8 row_mask:0xf bank_mask:0xf
    v_add_f32_dpp v22, v22, v22 row_ror:8 row_mask:0xf bank_mask:0xf
    v_add_f32_dpp v23, v23, v23 row_ror:8 row_mask:0xf bank_mask:0xf
    v_cvt_pk_bf16_f32 v20, v20, v21
    v_cvt_pk_bf16_f32 v21, v22, v23
    s_mov_b32 exec_hi, 0
    v_min_u32 v20, -2, v20
    v_min_u32 v21, -2, v21
    s_mov_b32 exec_lo, 0x00ff00ff
    buffer_store_dwordx2 v[20:21], v13, s[4:7], s23 offen sc1
    s_mov_b64 exec, -1
ploop_15_pst:
    s_cmp_ge_u32 s3, 2
    s_cbranch_scc1 ploop_15_nlr
    buffer_store_dwordx4 v[24:27], v28, s[4:7], 0 offen sc1
ploop_15_nlr:
    s_add_u32 s16, s16, 1
    s_mov_b32 s17, s18
    s_mov_b32 s18, s19
    s_mov_b32 s19, s20
    s_add_u32 s20, s20, 262144
    s_cmp_eq_u32 s20, 210763776
    s_cselect_b32 s20, 209715200, s20
    s_branch ploop_15
prm_18_gt:
gate_22:
    v_readfirstlane_b32 s25, v15
    s_cmp_ge_u32 s25, s59
    s_cbranch_scc1 gate_22_ok
    s_sleep 8
    buffer_load_dword v15, off, s[4:7], s58 sc1
    s_waitcnt vmcnt(0)
    s_sub_u32 s26, s26, 1
    s_cbranch_scc0 gate_22
    s_mov_b32 s26, 0
gate_22_ok:
    s_branch prm_18_gtb
prm_18_0:
    s_sub_u32 s26, s26, 1
    s_cbranch_scc1 prm_18_0_g
    buffer_load_dwordx4 v[16:19], v1, s[4:7], s21 offen offset:0 sc1
    buffer_load_dwordx4 v[20:23], v1, s[4:7], s21 offen offset:1024 sc1
    buffer_load_dwordx4 v[24:27], v1, s[4:7], s21 offen offset:2048 sc1
    buffer_load_dwordx4 v[28:31], v1, s[4:7], s21 offen offset:3072 sc1
    s_waitcnt vmcnt(3)
    v_max3_u32 v9, v16, v17, v18
    v_max_u32 v9, v9, v19
    v_cmp_eq_u32 vcc, -1, v9
    s_cbranch_vccnz prm_18_0
    s_branch prm_18_0ok
prm_18_0_g:
    s_mov_b32 s26, 0
    s_waitcnt vmcnt(0)
    s_branch prm_18_0ok
prm_18_1:
    s_sub_u32 s26, s26, 1
    s_cbranch_scc1 prm_18_1_g
    buffer_load_dwordx4 v[20:23], v1, s[4:7], s21 offen offset:1024 sc1
    buffer_load_dwordx4 v[24:27], v1, s[4:7], s21 offen offset:2048 sc1
    buffer_load_dwordx4 v[28:31], v1, s[4:7], s21 offen offset:3072 sc1
    s_waitcnt vmcnt(2)
    v_max3_u32 v9, v20, v21, v22
    v_max_u32 v9, v9, v23
    v_cmp_eq_u32 vcc, -1, v9
    s_cbranch_vccnz prm_18_1
    s_branch prm_18_1ok
prm_18_1_g:
    s_mov_b32 s26, 0
    s_waitcnt vmcnt(0)
    s_branch prm_18_1ok
prm_18_2:
    s_sub_u32 s26, s26, 1
    s_cbranch_scc1 prm_18_2_g
    buffer_load_dwordx4 v[24:27], v1, s[4:7], s21 offen offset:2048 sc1
    buffer_load_dwordx4 v[28:31], v1, s[4:7], s21 offen offset:3072 sc1
    s_waitcnt vmcnt(1)
    v_max3_u32 v9, v24, v25, v26
    v_max_u32 v9, v9, v27
    v_cmp_eq_u32 vcc, -1, v9
    s_cbranch_vccnz prm_18_2
    s_branch prm_18_2ok
prm_18_2_g:
    s_mov_b32 s26, 0
    s_waitcnt vmcnt(0)
    s_branch prm_18_2ok
prm_18_3:
    s_sub_u32 s26, s26, 1
    s_cbranch_scc1 prm_18_3_g
    buffer_load_dwordx4 v[28:31], v1, s[4:7], s21 offen offset:3072 sc1
    s_waitcnt vmcnt(0)
    v_max3_u32 v9, v28, v29, v30
    v_max_u32 v9, v9, v31
    v_cmp_eq_u32 vcc, -1, v9
    s_cbranch_vccnz prm_18_3
    s_branch prm_18_3ok
prm_18_3_g:
    s_mov_b32 s26, 0
    s_waitcnt vmcnt(0)
    s_branch prm_18_3ok
prm_18_d:
gate_23:
    v_readfirstlane_b32 s25, v15
    s_cmp_ge_u32 s25, s59
    s_cbranch_scc1 gate_23_ok
    s_sleep 8
    buffer_load_dword v15, off, s[4:7], s58 sc1
    s_waitcnt vmcnt(0)
    s_sub_u32 s26, s26, 1
    s_cbranch_scc0 gate_23
    s_mov_b32 s26, 0
gate_23_ok:
    ds_write_b32 v14, v60
    v_add_f32 v32, v32, v33
    v_add_f32 v34, v34, v35
    ds_write2_b32 v4, v32, v34 offset0:0 offset1:104
    v_add_f32 v36, v36, v37
    v_add_f32 v38, v38, v39
    ds_write2_b32 v4, v36, v38 offset0:16 offset1:120
    v_add_f32 v40, v40, v41
    v_add_f32 v42, v42, v43
    ds_write2_b32 v4, v40, v42 offset0:32 offset1:136
    v_add_f32 v44, v44, v45
    v_add_f32 v46, v46, v47
    ds_write2_b32 v4, v44, v46 offset0:48 offset1:152
    v_add_f32 v48, v48, v49
    v_add_f32 v50, v50, v51
    ds_write2_b32 v4, v48, v50 offset0:64 offset1:168
    v_add_f32 v52, v52, v53
    v_add_f32 v54, v54, v55
    ds_write2_b32 v4, v52, v54 offset0:80 offset1:184
    s_branch pnc_16_done
prp_19:
    s_sub_u32 s26, s26, 1
    s_nop 3
    s_cbranch_scc1 prp_19_g
    buffer_load_dwordx4 v[16:19], v12, s[4:7], s30 offen sc1
    buffer_load_dword v15, off, s[4:7], s58 sc1
    s_branch ploop_15_pagain
prp_19_g:
    s_mov_b32 s26, 0
    s_branch ploop_15_pgo
ploop_15_zr:
    s_sub_u32 s26, s26, 1
    s_cbranch_scc1 ploop_15_zg
    buffer_load_dwordx4 v[32:35], v1, s[4:7], s22 offen offset:0 sc1
    buffer_load_dwordx4 v[36:39], v1, s[4:7], s22 offen offset:1024 sc1
    buffer_load_dwordx4 v[40:43], v1, s[4:7], s22 offen offset:2048 sc1
    buffer_load_dwordx4 v[44:47], v1, s[4:7], s22 offen offset:3072 sc1
    s_branch ploop_15_za
ploop_15_zg:
    s_mov_b32 s26, 0
    s_branch ploop_15_zok
ptail_17:
    s_cmp_eq_u32 s15, 0
    s_cbranch_scc1 ptail_17_nd
    s_nop 0
ptail_17_nd:
    s_barrier
    v_add_u32 v55, s68, v61
    ds_read_b128 v[24:27], v55 offset:0
    ds_read_b128 v[28:31], v55 offset:1024
    ds_read_b128 v[32:35], v55 offset:18560
    ds_read_b128 v[36:39], v55 offset:19584
    ds_read_b128 v[40:43], v55 offset:37120
    ds_read_b128 v[44:47], v55 offset:38144
    ds_read_b128 v[48:51], v55 offset:55680
    ds_read_b128 v[52:55], v55 offset:56704
    s_waitcnt lgkmcnt(4)
    v_add_f32 v24, v24, v32
    v_add_f32 v25, v25, v33
    v_add_f32 v26, v26, v34
    v_add_f32 v27, v27, v35
    v_add_f32 v28, v28, v36
    v_add_f32 v29, v29, v37
    v_add_f32 v30, v30, v38
    v_add_f32 v31, v31, v39
    s_waitcnt lgkmcnt(0)
    v_add_f32 v40, v40, v48
    v_add_f32 v41, v41, v49
    v_add_f32 v42, v42, v50
    v_add_f32 v43, v43, v51
    v_add_f32 v44, v44, v52
    v_add_f32 v45, v45, v53
    v_add_f32 v46, v46, v54
    v_add_f32 v47, v47, v55
    v_add_f32 v24, v24, v40
    v_add_f32 v25, v25, v41
    v_add_f32 v26, v26, v42
    v_add_f32 v27, v27, v43
    v_add_f32 v28, v28, v44
    v_add_f32 v29, v29, v45
    v_add_f32 v30, v30, v46
    v_add_f32 v31, v31, v47
    v_cvt_pk_bf16_f32 v24, v24, v25
    v_cvt_pk_bf16_f32 v25, v26, v27
    v_cvt_pk_bf16_f32 v26, v28, v29
    v_cvt_pk_bf16_f32 v27, v30, v31
    v_min_u32 v24, -2, v24
    v_min_u32 v25, -2, v25
    v_min_u32 v26, -2, v26
    v_min_u32 v27, -2, v27
    buffer_store_dwordx4 v[24:27], v1, s[4:7], s37 offen sc1
    s_branch k_end
ch_a_pro:
    s_mul_i32 s21, s2, 24576
    s_add_u32 s21, s21, 209711104
    v_lshlrev_b32 v1, 4, v0
    v_mov_b32 v4, -1
    v_mov_b32 v5, -1
    v_mov_b32 v6, -1
    v_mov_b32 v7, -1
    buffer_store_dwordx4 v[4:7], v1, s[4:7], s21 offen sc1
    s_add_u32 s21, s21, 4096
    buffer_store_dwordx4 v[4:7], v1, s[4:7], s21 offen sc1
    s_add_u32 s21, s21, 4096
    buffer_store_dwordx4 v[4:7], v1, s[4:7], s21 offen sc1
    s_add_u32 s21, s21, 4096
    buffer_store_dwordx4 v[4:7], v1, s[4:7], s21 offen sc1
    s_add_u32 s21, s21, 4096
    buffer_store_dwordx4 v[4:7], v1, s[4:7], s21 offen sc1
    s_add_u32 s21, s21, 4096
    buffer_store_dwordx4 v[4:7], v1, s[4:7], s21 offen sc1
    s_add_u32 s21, s21, 4096
    v_mov_b32 v2, s29
    s_waitcnt vmcnt(0)
    s_barrier
    s_cmp_lg_u32 s3, 4
    s_cbranch_scc1 ch_nox
    s_mov_b64 exec, 1
    buffer_atomic_add v2, off, s[64:67], s28 sc1
    s_mov_b64 exec, -1
ch_nox:
    v_and_b32 v20, 63, v0
    v_lshlrev_b32 v0, 4, v20
    s_sub_u32 s25, s3, 4
    s_lshl_b32 s46, s12, 2
    s_add_u32 s46, s46, s25
    s_lshl_b32 s21, s46, 18
    s_lshl_b32 s22, s13, 7
    s_add_u32 s21, s21, s22
    s_lshl_b32 s46, s46, 12
    s_lshl_b32 s23, s25, 13
    s_add_u32 s23, s23, 131072
    s_load_dwordx2 s[8:9], s[0:1], 40
    s_mov_b32 s10, 8388608
    s_mov_b32 s11, 131072
    v_lshrrev_b32 v21, 3, v20
    v_and_b32 v22, 7, v20
    v_lshlrev_b32 v21, 11, v21
    v_lshl_add_u32 v21, v22, 4, v21
    v_lshrrev_b32 v28, 4, v20
    v_and_b32 v29, 1, v28
    v_xor_b32 v29, 0, v29
    v_lshlrev_b32 v29, 2, v29
    v_lshl_add_u32 v29, v28, 3, v29
    v_bfe_u32 v28, v20, 2, 2
    v_add_u32 v29, v29, v28
    v_lshlrev_b32 v29, 7, v29
    v_and_b32 v28, 3, v20
    v_lshl_add_u32 v29, v28, 4, v29
    v_and_b32 v28, 1, v28
    v_xor_b32 v28, 0, v28
    v_lshl_add_u32 v24, v28, 3, v29
    v_add_u32 v24, s23, v24
    v_lshrrev_b32 v28, 4, v20
    v_and_b32 v29, 1, v28
    v_xor_b32 v29, 1, v29
    v_lshlrev_b32 v29, 2, v29
    v_lshl_add_u32 v29, v28, 3, v29
    v_bfe_u32 v28, v20, 2, 2
    v_add_u32 v29, v29, v28
    v_lshlrev_b32 v29, 7, v29
    v_and_b32 v28, 3, v20
    v_lshl_add_u32 v29, v28, 4, v29
    v_and_b32 v28, 1, v28
    v_xor_b32 v28, 0, v28
    v_lshl_add_u32 v25, v28, 3, v29
    v_add_u32 v25, s23, v25
    v_lshrrev_b32 v28, 4, v20
    v_and_b32 v29, 1, v28
    v_xor_b32 v29, 0, v29
    v_lshlrev_b32 v29, 2, v29
    v_lshl_add_u32 v29, v28, 3, v29
    v_bfe_u32 v28, v20, 2, 2
    v_add_u32 v29, v29, v28
    v_lshlrev_b32 v29, 7, v29
    v_and_b32 v28, 3, v20
    v_lshl_add_u32 v29, v28, 4, v29
    v_and_b32 v28, 1, v28
    v_xor_b32 v28, 1, v28
    v_lshl_add_u32 v26, v28, 3, v29
    v_add_u32 v26, s23, v26
    v_lshrrev_b32 v28, 4, v20
    v_and_b32 v29, 1, v28
    v_xor_b32 v29, 1, v29
    v_lshlrev_b32 v29, 2, v29
    v_lshl_add_u32 v29, v28, 3, v29
    v_bfe_u32 v28, v20, 2, 2
    v_add_u32 v29, v29, v28
    v_lshlrev_b32 v29, 7, v29
    v_and_b32 v28, 3, v20
    v_lshl_add_u32 v29, v28, 4, v29
    v_and_b32 v28, 1, v28
    v_xor_b32 v28, 1, v28
    v_lshl_add_u32 v27, v28, 3, v29
    v_add_u32 v27, s23, v27
    s_waitcnt lgkmcnt(0)
    s_add_u32 m0, s23, 0
    s_nop 0
    buffer_load_dwordx4 v21, s[8:11], s21 offen lds
    s_add_u32 s21, s21, 16384
    s_add_u32 m0, s23, 1024
    s_nop 0
    buffer_load_dwordx4 v21, s[8:11], s21 offen lds
    s_add_u32 s21, s21, 16384
    s_add_u32 m0, s23, 2048
    s_nop 0
    buffer_load_dwordx4 v21, s[8:11], s21 offen lds
    s_add_u32 s21, s21, 16384
    s_add_u32 m0, s23, 3072
    s_nop 0
    buffer_load_dwordx4 v21, s[8:11], s21 offen lds
    s_add_u32 s21, s21, 16384
    s_add_u32 m0, s23, 4096
    s_nop 0
    buffer_load_dwordx4 v21, s[8:11], s21 offen lds
    s_add_u32 s21, s21, 16384
    s_add_u32 m0, s23, 5120
    s_nop 0
    buffer_load_dwordx4 v21, s[8:11], s21 offen lds
    s_add_u32 s21, s21, 16384
    s_add_u32 m0, s23, 6144
    s_nop 0
    buffer_load_dwordx4 v21, s[8:11], s21 offen lds
    s_add_u32 s21, s21, 16384
    s_add_u32 m0, s23, 7168
    s_nop 0
    buffer_load_dwordx4 v21, s[8:11], s21 offen lds
    s_add_u32 s21, s21, 16384
    buffer_load_dwordx4 v[98:101], v21, s[8:11], s21 offen
    s_add_u32 s21, s21, 16384
    buffer_load_dwordx4 v[102:105], v21, s[8:11], s21 offen
    s_add_u32 s21, s21, 16384
    buffer_load_dwordx4 v[106:109], v21, s[8:11], s21 offen
    s_add_u32 s21, s21, 16384
    buffer_load_dwordx4 v[110:113], v21, s[8:11], s21 offen
    s_add_u32 s21, s21, 16384
    buffer_load_dwordx4 v[114:117], v21, s[8:11], s21 offen
    s_add_u32 s21, s21, 16384
    buffer_load_dwordx4 v[118:121], v21, s[8:11], s21 offen
    s_add_u32 s21, s21, 16384
    buffer_load_dwordx4 v[122:125], v21, s[8:11], s21 offen
    s_add_u32 s21, s21, 16384
    buffer_load_dwordx4 v[126:129], v21, s[8:11], s21 offen
    s_add_u32 s21, s21, 16384
    v_add_u32 v30, s23, v0
    s_waitcnt vmcnt(8)
    ds_read_b64_tr_b16 v[192:193], v24 offset:0
    ds_read_b64_tr_b16 v[194:195], v25 offset:0
    ds_read_b64_tr_b16 v[200:201], v26 offset:0
    ds_read_b64_tr_b16 v[202:203], v27 offset:0
    ds_read_b64_tr_b16 v[208:209], v24 offset:64
    ds_read_b64_tr_b16 v[210:211], v25 offset:64
    ds_read_b64_tr_b16 v[216:217], v26 offset:64
    ds_read_b64_tr_b16 v[218:219], v27 offset:64
    s_waitcnt lgkmcnt(0)
    ds_read_b64_tr_b16 v[196:197], v24 offset:4096
    ds_read_b64_tr_b16 v[198:199], v25 offset:4096
    ds_read_b64_tr_b16 v[204:205], v26 offset:4096
    ds_read_b64_tr_b16 v[206:207], v27 offset:4096
    ds_read_b64_tr_b16 v[212:213], v24 offset:4160
    ds_read_b64_tr_b16 v[214:215], v25 offset:4160
    ds_read_b64_tr_b16 v[220:221], v26 offset:4160
    ds_read_b64_tr_b16 v[222:223], v27 offset:4160
    s_waitcnt lgkmcnt(0)
    s_waitcnt vmcnt(0)
    ds_write_b128 v30, v[98:101] offset:0
    ds_write_b128 v30, v[102:105] offset:1024
    ds_write_b128 v30, v[106:109] offset:2048
    ds_write_b128 v30, v[110:113] offset:3072
    ds_write_b128 v30, v[114:117] offset:4096
    ds_write_b128 v30, v[118:121] offset:5120
    ds_write_b128 v30, v[122:125] offset:6144
    ds_write_b128 v30, v[126:129] offset:7168
    s_waitcnt lgkmcnt(0)
    ds_read_b64_tr_b16 v[224:225], v24 offset:0
    ds_read_b64_tr_b16 v[226:227], v25 offset:0
    ds_read_b64_tr_b16 v[232:233], v26 offset:0
    ds_read_b64_tr_b16 v[234:235], v27 offset:0
    ds_read_b64_tr_b16 v[240:241], v24 offset:64
    ds_read_b64_tr_b16 v[242:243], v25 offset:64
    ds_read_b64_tr_b16 v[248:249], v26 offset:64
    ds_read_b64_tr_b16 v[250:251], v27 offset:64
    s_waitcnt lgkmcnt(0)
    ds_read_b64_tr_b16 v[228:229], v24 offset:4096
    ds_read_b64_tr_b16 v[230:231], v25 offset:4096
    ds_read_b64_tr_b16 v[236:237], v26 offset:4096
    ds_read_b64_tr_b16 v[238:239], v27 offset:4096
    ds_read_b64_tr_b16 v[244:245], v24 offset:4160
    ds_read_b64_tr_b16 v[246:247], v25 offset:4160
    ds_read_b64_tr_b16 v[252:253], v26 offset:4160
    ds_read_b64_tr_b16 v[254:255], v27 offset:4160
    s_waitcnt lgkmcnt(0)
    v_lshrrev_b32 v21, 4, v20
    s_mul_i32 s21, s25, 18560
    s_add_u32 s21, s21, 16384
    v_add_u32 v1, s21, v0
    v_and_b32 v23, 15, v20
    v_mul_u32_u24 v21, 136, v21
    v_lshl_add_u32 v21, v23, 3, v21
    v_add_u32 v45, s21, v21
    s_lshl_b32 s53, s25, 13
    s_add_u32 s53, s53, 92160
    v_add_u32 v49, s53, v0
    v_mov_b32 v48, 0
    v_mov_b32 v4, 0x3f803f80
    v_mov_b32 v5, 0x3f803f80
    v_mov_b32 v6, 0x3f803f80
    v_mov_b32 v7, 0x3f803f80
    v_mov_b32 v8, 0
    v_mov_b32 v9, 0
    v_mov_b32 v10, 0
    v_mov_b32 v11, 0
    v_lshlrev_b32 v43, 2, v20
    v_mov_b32 v26, 0x44444444
    v_mov_b32 v27, 0xeeeeeeee
    v_and_b32 v28, 1, v20
    v_cmp_eq_u32 vcc, 0, v28
    s_mov_b32 s47, 0x3e0293ee
    s_lshl_b32 s32, s12, 15
    v_cndmask_b32 v41, v27, v26, vcc
    s_lshl_b32 s21, s25, 13
    s_add_u32 s32, s32, s21
    s_add_u32 s32, s32, 2097152
    s_lshl_b32 s21, s25, 2
    s_add_u32 s21, s21, 13312
    v_mov_b32 v47, s21
    s_lshl_b32 s27, s13, 2
    s_add_u32 s27, s27, s25
    s_lshl_b32 s62, s12, 7
    s_add_u32 s62, s62, 218112000
    s_lshl_b32 s33, s12, 14
    s_lshl_b32 s21, s25, 12
    s_add_u32 s33, s33, s21
    s_add_u32 s33, s33, 1179648
    v_mov_b32 v139, 0
    v_mov_b32 v140, 0
    v_mov_b32 v141, 0
    v_mov_b32 v143, 0
    v_mov_b32 v144, 0
    v_mov_b32 v145, 0
    v_mov_b32 v40, 0
    v_mov_b32 v42, 0
    v_mov_b32 v44, 0
    v_mov_b32 v46, 0
    v_mov_b32 v158, 0x7f800000
    s_mov_b32 exec_lo, 0xcccccccc
    s_mov_b32 exec_hi, 0xcccccccc
    v_mov_b32 v158, 0x42700000
    s_mov_b64 exec, -1
    s_cmp_lg_u32 s3, 4
    s_cbranch_scc1 ch_xcc_skip
    v_add_u32 v56, 128, v43
    s_movk_i32 s21, 192
    v_writelane_b32 v56, s21, 4
    v_mov_b32 v59, 63
    v_writelane_b32 v59, -1, 4
    v_mov_b32 v60, 32
    s_mov_b64 exec, 0x1f
ch_xcc:
    buffer_load_dword v57, v56, s[64:67], 0 offen sc1
    s_waitcnt vmcnt(0)
    v_and_b32 v62, v59, v57
    v_cmp_ne_u32 vcc, v62, v60
    s_cbranch_vccz ch_xcc_ok
    s_sleep 16
    s_sub_u32 s26, s26, 1
    s_cbranch_scc0 ch_xcc
    s_mov_b32 s26, 0
ch_xcc_ok:
    s_lshr_b32 s22, s12, 1
    v_readlane_b32 s23, v57, 0
    s_nop 2
    v_readlane_b32 s21, v57, s22
    s_mov_b64 exec, -1
    v_mov_b32 v58, 131072
    v_mov_b32 v57, s21
    ds_write_b32 v58, v57
    s_bfe_u32 s23, s23, 0x1000f
    v_and_b32 v60, 0x70, v0
    v_lshlrev_b32 v60, 3, v60
    s_mov_b32 s22, 218112000
ch_pgv:
    buffer_load_dword v61, v60, s[4:7], s22 offen offset:8 sc1
    s_waitcnt vmcnt(0) lgkmcnt(0)
    v_and_b32 v62, 1, v61
    v_cmp_eq_u32 vcc, 0, v62
    s_cbranch_vccz ch_pgvok
    s_sleep 8
    s_sub_u32 s26, s26, 1
    s_cbranch_scc0 ch_pgv
    s_mov_b32 s26, 0
ch_pgvok:
    v_bfe_u32 v62, v61, 1, 1
    v_ashrrev_i32 v61, 8, v61
    v_sub_u32 v59, 0, v61
    v_cmp_eq_u32 vcc, s23, v62
    s_mov_b32 s21, 0
    s_nop 1
    v_cndmask_b32 v61, v59, v61, vcc
    s_nop 1
    v_readlane_b32 s22, v61, 0
    s_add_i32 s21, s21, s22
    v_readlane_b32 s22, v61, 1
    s_add_i32 s21, s21, s22
    v_readlane_b32 s22, v61, 2
    s_add_i32 s21, s21, s22
    v_readlane_b32 s22, v61, 3
    s_add_i32 s21, s21, s22
    v_readlane_b32 s22, v61, 4
    s_add_i32 s21, s21, s22
    v_readlane_b32 s22, v61, 5
    s_add_i32 s21, s21, s22
    v_readlane_b32 s22, v61, 6
    s_add_i32 s21, s21, s22
    v_readlane_b32 s22, v61, 7
    s_add_i32 s21, s21, s22
    s_cmp_gt_i32 s21, 0
    s_cselect_b32 s21, 0x2000, 0
    v_mov_b32 v59, s21
    ds_write_b32 v58, v59 offset:4
    s_waitcnt lgkmcnt(0)
ch_xcc_skip:
    s_barrier
    s_barrier
    s_lshl_b32 s60, s12, 4
    s_add_u32 s60, s60, 218104320
    s_barrier
ch_g0:
    buffer_load_dword v57, off, s[4:7], s60 sc1
    s_waitcnt vmcnt(0)
    v_readfirstlane_b32 s21, v57
    s_cmp_ge_u32 s21, 12
    s_cbranch_scc1 ch_g0b
    s_sleep 8
    s_sub_u32 s26, s26, 1
    s_cbranch_scc0 ch_g0
    s_mov_b32 s26, 0
ch_g0b:
    s_add_u32 s21, s16, 0
    s_lshl_b32 s21, s21, 18
    s_add_u32 s21, s21, s46
    s_add_u32 s21, s21, 37748736
    s_add_u32 s22, s21, 131072
    buffer_load_dwordx4 v[160:163], v0, s[4:7], s21 offen offset:0 sc1
    buffer_load_dwordx4 v[164:167], v0, s[4:7], s21 offen offset:1024 sc1
    buffer_load_dwordx4 v[168:171], v0, s[4:7], s21 offen offset:2048 sc1
    buffer_load_dwordx4 v[172:175], v0, s[4:7], s21 offen offset:3072 sc1
    buffer_load_dwordx4 v[176:179], v0, s[4:7], s22 offen offset:0 sc1
    buffer_load_dwordx4 v[180:183], v0, s[4:7], s22 offen offset:1024 sc1
    buffer_load_dwordx4 v[184:187], v0, s[4:7], s22 offen offset:2048 sc1
    buffer_load_dwordx4 v[188:191], v0, s[4:7], s22 offen offset:3072 sc1
    s_add_u32 s21, s16, 0
    s_lshl_b32 s21, s21, 18
    s_add_u32 s21, s21, s46
    s_add_u32 s21, s21, 20971520
    s_add_u32 s22, s21, 131072
    buffer_load_dwordx4 v[98:101], v0, s[4:7], s21 offen offset:0 sc1
    buffer_load_dwordx4 v[102:105], v0, s[4:7], s21 offen offset:1024 sc1
    buffer_load_dwordx4 v[106:109], v0, s[4:7], s21 offen offset:2048 sc1
    buffer_load_dwordx4 v[110:113], v0, s[4:7], s21 offen offset:3072 sc1
    buffer_load_dwordx4 v[114:117], v0, s[4:7], s22 offen offset:0 sc1
    buffer_load_dwordx4 v[118:121], v0, s[4:7], s22 offen offset:1024 sc1
    buffer_load_dwordx4 v[122:125], v0, s[4:7], s22 offen offset:2048 sc1
    buffer_load_dwordx4 v[126:129], v0, s[4:7], s22 offen offset:3072 sc1
    s_waitcnt vmcnt(8)
    v_mfma_f32_16x16x32_bf16 v[50:53], v[160:163], v[192:195], 0
    v_mfma_f32_16x16x32_bf16 v[54:57], v[160:163], v[200:203], 0
    v_mfma_f32_16x16x32_bf16 v[58:61], v[160:163], v[208:211], 0
    v_mfma_f32_16x16x32_bf16 v[62:65], v[160:163], v[216:219], 0
    v_mfma_f32_16x16x32_bf16 v[66:69], v[176:179], v[192:195], 0
    v_mfma_f32_16x16x32_bf16 v[70:73], v[176:179], v[200:203], 0
    v_mfma_f32_16x16x32_bf16 v[74:77], v[176:179], v[208:211], 0
    v_mfma_f32_16x16x32_bf16 v[78:81], v[176:179], v[216:219], 0
    v_mfma_f32_16x16x32_bf16 v[50:53], v[164:167], v[196:199], v[50:53]
    v_mfma_f32_16x16x32_bf16 v[54:57], v[164:167], v[204:207], v[54:57]
    v_mfma_f32_16x16x32_bf16 v[58:61], v[164:167], v[212:215], v[58:61]
    v_mfma_f32_16x16x32_bf16 v[62:65], v[164:167], v[220:223], v[62:65]
    v_mfma_f32_16x16x32_bf16 v[66:69], v[180:183], v[196:199], v[66:69]
    v_mfma_f32_16x16x32_bf16 v[70:73], v[180:183], v[204:207], v[70:73]
    v_mfma_f32_16x16x32_bf16 v[74:77], v[180:183], v[212:215], v[74:77]
    v_mfma_f32_16x16x32_bf16 v[78:81], v[180:183], v[220:223], v[78:81]
    v_mfma_f32_16x16x32_bf16 v[50:53], v[168:171], v[224:227], v[50:53]
    v_mfma_f32_16x16x32_bf16 v[54:57], v[168:171], v[232:235], v[54:57]
    v_mfma_f32_16x16x32_bf16 v[58:61], v[168:171], v[240:243], v[58:61]
    v_mfma_f32_16x16x32_bf16 v[62:65], v[168:171], v[248:251], v[62:65]
    v_mfma_f32_16x16x32_bf16 v[66:69], v[184:187], v[224:227], v[66:69]
    v_mfma_f32_16x16x32_bf16 v[70:73], v[184:187], v[232:235], v[70:73]
    v_mfma_f32_16x16x32_bf16 v[74:77], v[184:187], v[240:243], v[74:77]
    v_mfma_f32_16x16x32_bf16 v[78:81], v[184:187], v[248:251], v[78:81]
    v_mfma_f32_16x16x32_bf16 v[50:53], v[172:175], v[228:231], v[50:53]
    v_mfma_f32_16x16x32_bf16 v[54:57], v[172:175], v[236:239], v[54:57]
    v_mfma_f32_16x16x32_bf16 v[58:61], v[172:175], v[244:247], v[58:61]
    v_mfma_f32_16x16x32_bf16 v[62:65], v[172:175], v[252:255], v[62:65]
    v_mfma_f32_16x16x32_bf16 v[66:69], v[188:191], v[228:231], v[66:69]
    v_mfma_f32_16x16x32_bf16 v[70:73], v[188:191], v[236:239], v[70:73]
    v_mfma_f32_16x16x32_bf16 v[74:77], v[188:191], v[244:247], v[74:77]
    v_mfma_f32_16x16x32_bf16 v[78:81], v[188:191], v[252:255], v[78:81]
    s_add_u32 s21, s16, 1
    s_lshl_b32 s21, s21, 18
    s_add_u32 s21, s21, s46
    s_add_u32 s21, s21, 37748736
    s_add_u32 s22, s21, 131072
    buffer_load_dwordx4 v[160:163], v0, s[4:7], s21 offen offset:0 sc1
    buffer_load_dwordx4 v[164:167], v0, s[4:7], s21 offen offset:1024 sc1
    buffer_load_dwordx4 v[168:171], v0, s[4:7], s21 offen offset:2048 sc1
    buffer_load_dwordx4 v[172:175], v0, s[4:7], s21 offen offset:3072 sc1
    buffer_load_dwordx4 v[176:179], v0, s[4:7], s22 offen offset:0 sc1
    buffer_load_dwordx4 v[180:183], v0, s[4:7], s22 offen offset:1024 sc1
    buffer_load_dwordx4 v[184:187], v0, s[4:7], s22 offen offset:2048 sc1
    buffer_load_dwordx4 v[188:191], v0, s[4:7], s22 offen offset:3072 sc1
    s_mov_b32 s34, 1
    s_nop 7
    v_cvt_pk_bf16_f32 v82, v50, v51
    v_cvt_pk_bf16_f32 v83, v52, v53
    v_cvt_pk_bf16_f32 v84, v66, v67
    v_cvt_pk_bf16_f32 v85, v68, v69
    v_cvt_pk_bf16_f32 v86, v54, v55
    v_cvt_pk_bf16_f32 v87, v56, v57
    v_cvt_pk_bf16_f32 v88, v70, v71
    v_cvt_pk_bf16_f32 v89, v72, v73
    v_cvt_pk_bf16_f32 v90, v58, v59
    v_cvt_pk_bf16_f32 v91, v60, v61
    v_cvt_pk_bf16_f32 v92, v74, v75
    v_cvt_pk_bf16_f32 v93, v76, v77
    v_cvt_pk_bf16_f32 v94, v62, v63
    v_cvt_pk_bf16_f32 v95, v64, v65
    v_cvt_pk_bf16_f32 v96, v78, v79
    v_cvt_pk_bf16_f32 v97, v80, v81
    v_mov_b32 v74, 0
    v_mov_b32 v75, 0
    v_mov_b32 v76, 0
    v_mov_b32 v77, 0
    v_mov_b32 v78, 0
    v_mov_b32 v79, 0
    v_mov_b32 v80, 0
    v_mov_b32 v81, 0
    v_mov_b32 v146, 0
    v_mov_b32 v147, 0
    v_mov_b32 v148, 0
    v_mov_b32 v149, 0
    v_mov_b32 v150, 0
    v_mov_b32 v151, 0
    v_mov_b32 v152, 0
    v_mov_b32 v153, 0
    v_mov_b32 v12, 0
    v_mov_b32 v13, 0
    v_mov_b32 v14, 0
    v_mov_b32 v15, 0
    v_mov_b32 v16, 0
    v_mov_b32 v17, 0
    v_mov_b32 v18, 0
    v_mov_b32 v19, 0
    v_mov_b32 v20, 0
    v_mov_b32 v21, 0
    v_mov_b32 v22, 0
    v_mov_b32 v23, 0
    v_mov_b32 v2, 0
    s_add_u32 s21, s17, s32
    s_add_u32 s22, s21, 4096
    s_setprio 2
    s_branch a_zl
.p2align 6
    s_nop 0
    s_nop 0
    s_nop 0
    s_nop 0
    s_nop 0
    s_nop 0
    s_nop 0
    s_nop 0
aloop_24:
    s_add_u32 s21, s17, s32
    s_add_u32 s22, s21, 4096
    v_mov_b32 v74, 0
    v_mov_b32 v75, 0
    v_mov_b32 v76, 0
    v_mov_b32 v77, 0
    v_mov_b32 v78, 0
    v_mov_b32 v79, 0
    v_mov_b32 v80, 0
    v_mov_b32 v81, 0
    v_mov_b32 v146, 0
    v_mov_b32 v147, 0
    v_mov_b32 v148, 0
    v_mov_b32 v149, 0
    v_mov_b32 v150, 0
    v_mov_b32 v151, 0
    v_mov_b32 v152, 0
    v_mov_b32 v153, 0
    s_add_u32 s30, s16, 1
    s_lshl_b32 s30, s30, 18
    s_add_u32 s30, s30, s46
    s_add_u32 s30, s30, 37748736
    s_add_u32 s31, s30, 131072
aloop_24_wm:
    ds_read_b32 v3, v47
    s_waitcnt lgkmcnt(0)
    v_readfirstlane_b32 s23, v3
    s_cmp_eq_u32 s23, s16
    s_cbranch_scc1 aloop_24_wmok
    s_sleep 1
    s_branch aloop_24_wm
aloop_24_wmok:
    buffer_load_dwordx4 v[160:163], v0, s[4:7], s30 offen offset:0 sc1
    buffer_load_dwordx4 v[164:167], v0, s[4:7], s30 offen offset:1024 sc1
    buffer_load_dwordx4 v[168:171], v0, s[4:7], s30 offen offset:2048 sc1
    buffer_load_dwordx4 v[172:175], v0, s[4:7], s30 offen offset:3072 sc1
    buffer_load_dwordx4 v[176:179], v0, s[4:7], s31 offen offset:0 sc1
    buffer_load_dwordx4 v[180:183], v0, s[4:7], s31 offen offset:1024 sc1
    buffer_load_dwordx4 v[184:187], v0, s[4:7], s31 offen offset:2048 sc1
    buffer_load_dwordx4 v[188:191], v0, s[4:7], s31 offen offset:3072 sc1
aloop_24_nv:
    s_setprio 2
    v_mov_b32 v2, s16
    s_barrier
    s_nop 15
    s_nop 13
    ds_read_b128 v[98:101], v49 offset:0
    ds_read_b128 v[102:105], v49 offset:1024
    ds_read_b128 v[106:109], v49 offset:2048
    ds_read_b128 v[110:113], v49 offset:3072
    ds_read_b128 v[114:117], v49 offset:4096
    ds_read_b128 v[118:121], v49 offset:5120
    ds_read_b128 v[122:125], v49 offset:6144
    ds_read_b128 v[126:129], v49 offset:7168
    v_mov_b32 v12, 0
    v_mov_b32 v13, 0
    v_mov_b32 v14, 0
    v_mov_b32 v15, 0
    v_mov_b32 v16, 0
    v_mov_b32 v17, 0
    v_mov_b32 v18, 0
    v_mov_b32 v19, 0
    v_mov_b32 v20, 0
    v_mov_b32 v21, 0
    v_mov_b32 v22, 0
    v_mov_b32 v23, 0
    s_sleep 3
    s_nop 13
a_zl:
    buffer_load_dwordx4 v[50:53], v0, s[4:7], s21 offen offset:0 sc1
    s_nop 7
    buffer_load_dwordx4 v[54:57], v0, s[4:7], s21 offen offset:1024 sc1
    s_nop 7
    buffer_load_dwordx4 v[58:61], v0, s[4:7], s21 offen offset:2048 sc1
    s_nop 7
    buffer_load_dwordx4 v[62:65], v0, s[4:7], s21 offen offset:3072 sc1
    s_nop 7
    buffer_load_dwordx4 v[66:69], v0, s[4:7], s22 offen offset:0 sc1
    s_nop 7
    buffer_load_dwordx4 v[70:73], v0, s[4:7], s22 offen offset:1024 sc1
    s_waitcnt lgkmcnt(0)
    s_waitcnt vmcnt(5)
    v_max3_u32 v3, v50, v51, v52
    v_max_u32 v3, v3, v53
    v_cmp_eq_u32 vcc, -1, v3
    s_cbranch_vccnz arq_25_0
arq_25_0ok:
    v_mfma_f32_16x16x32_bf16 v[12:15], v[98:101], v[50:53], v[12:15]
    v_mfma_f32_16x16x32_bf16 v[16:19], v[114:117], v[50:53], v[16:19]
    s_waitcnt vmcnt(4)
    v_max3_u32 v3, v54, v55, v56
    v_max_u32 v3, v3, v57
    v_cmp_eq_u32 vcc, -1, v3
    v_mfma_f32_16x16x32_bf16 v[20:23], v[50:53], v[50:53], v[20:23]
    s_cbranch_vccnz arq_25_1
arq_25_1ok:
    v_mfma_f32_16x16x32_bf16 v[12:15], v[102:105], v[54:57], v[12:15]
    v_mfma_f32_16x16x32_bf16 v[16:19], v[118:121], v[54:57], v[16:19]
    s_waitcnt vmcnt(3)
    v_max3_u32 v3, v58, v59, v60
    v_max_u32 v3, v3, v61
    v_cmp_eq_u32 vcc, -1, v3
    v_mfma_f32_16x16x32_bf16 v[20:23], v[54:57], v[54:57], v[20:23]
    s_cbranch_vccnz arq_25_2
arq_25_2ok:
    v_mfma_f32_16x16x32_bf16 v[12:15], v[106:109], v[58:61], v[12:15]
    v_mfma_f32_16x16x32_bf16 v[16:19], v[122:125], v[58:61], v[16:19]
    s_waitcnt vmcnt(2)
    v_max3_u32 v3, v62, v63, v64
    v_max_u32 v3, v3, v65
    v_cmp_eq_u32 vcc, -1, v3
    v_mfma_f32_16x16x32_bf16 v[20:23], v[58:61], v[58:61], v[20:23]
    s_cbranch_vccnz arq_25_3
arq_25_3ok:
    v_mfma_f32_16x16x32_bf16 v[12:15], v[110:113], v[62:65], v[12:15]
    ds_write_b32 v47, v2 offset:16
    v_mfma_f32_16x16x32_bf16 v[16:19], v[126:129], v[62:65], v[16:19]
    v_mfma_f32_16x16x32_bf16 v[20:23], v[62:65], v[62:65], v[20:23]
aloop_24_sdone:
    s_nop 0
    s_cmp_eq_u32 s16, 63
    s_cbranch_scc1 aloop_24_lsk
    s_nop 1
    v_exp_f32 v54, v12
    v_exp_f32 v55, v13
    s_waitcnt vmcnt(0)
    v_max3_u32 v24, v66, v67, v68
    v_max3_u32 v24, v24, v69, v70
    v_max3_u32 v24, v24, v71, v72
    v_max_u32 v24, v24, v73
    v_cmp_eq_u32 vcc, -1, v24
    s_cbranch_vccnz arq_25_v
    v_smfmac_f32_16x16x64_bf16 v[74:77], v[66:69], v[192:199], v41
    v_exp_f32 v56, v14
    v_smfmac_f32_16x16x64_bf16 v[78:81], v[66:69], v[200:207], v41
    v_exp_f32 v57, v15
    v_smfmac_f32_16x16x64_bf16 v[146:149], v[66:69], v[208:215], v41
    v_exp_f32 v58, v16
    v_smfmac_f32_16x16x64_bf16 v[150:153], v[66:69], v[216:223], v41
    v_exp_f32 v59, v17
    v_smfmac_f32_16x16x64_bf16 v[74:77], v[70:73], v[224:231], v41
    v_exp_f32 v60, v18
    v_smfmac_f32_16x16x64_bf16 v[78:81], v[70:73], v[232:239], v41
    v_exp_f32 v61, v19
    v_smfmac_f32_16x16x64_bf16 v[146:149], v[70:73], v[240:247], v41
    v_exp_f32 v62, v20
    v_smfmac_f32_16x16x64_bf16 v[150:153], v[70:73], v[248:255], v41
    v_exp_f32 v63, v21
    v_cvt_pk_bf16_f32 v154, v54, v55
    v_cvt_pk_bf16_f32 v155, v56, v57
    v_cvt_pk_bf16_f32 v156, v58, v59
    v_cvt_pk_bf16_f32 v157, v60, v61
    v_cvt_pk_bf16_f32 v8, v62, v63
    v_max3_f32 v2, |v12|, |v13|, |v14|
    v_mfma_f32_16x16x32_bf16 v[50:53], v[154:157], v[4:7], 0
    v_max3_f32 v3, |v15|, |v16|, |v17|
    v_add_f32 v74, v74, v75
    v_mfma_f32_16x16x32_bf16 v[50:53], v[8:11], v[4:7], v[50:53]
    v_add_f32 v76, v76, v77
    v_cvt_pk_bf16_f32 v40, v74, v76
    v_mfma_f32_16x16x32_bf16 v[24:27], v[154:157], v[82:85], 0
    v_add_f32 v78, v78, v79
    v_add_f32 v80, v80, v81
    v_mfma_f32_16x16x32_bf16 v[24:27], v[8:11], v[40:43], v[24:27]
    v_cvt_pk_bf16_f32 v42, v78, v80
    v_add_f32 v146, v146, v147
    v_mfma_f32_16x16x32_bf16 v[28:31], v[154:157], v[86:89], 0
    v_add_f32 v148, v148, v149
    v_cvt_pk_bf16_f32 v44, v146, v148
    v_mfma_f32_16x16x32_bf16 v[28:31], v[8:11], v[42:45], v[28:31]
    v_add_f32 v150, v150, v151
    v_add_f32 v152, v152, v153
    v_mfma_f32_16x16x32_bf16 v[32:35], v[154:157], v[90:93], 0
    v_cvt_pk_bf16_f32 v46, v150, v152
    v_rcp_f32 v52, v52
    v_mfma_f32_16x16x32_bf16 v[32:35], v[8:11], v[44:47], v[32:35]
    v_rcp_f32 v53, v53
    v_max3_f32 v2, v2, |v18|, |v19|
    v_mfma_f32_16x16x32_bf16 v[36:39], v[154:157], v[94:97], 0
    v_max3_f32 v3, v3, |v20|, |v21|
    v_max_f32 v2, v2, v3
    v_mfma_f32_16x16x32_bf16 v[36:39], v[8:11], v[46:49], v[36:39]
    v_cmp_nle_f32 vcc, v2, v158
    v_mul_f32 v26, v26, v52
    v_mul_f32 v27, v27, v53
    s_cbranch_vccnz aloop_24_tm
    v_mul_f32 v30, v30, v52
    v_mul_f32 v31, v31, v53
aloop_24_pvd:
    ds_write_b64 v45, v[26:27] offset:0
    v_mul_f32 v34, v34, v52
    v_mul_f32 v35, v35, v53
    ds_write_b64 v45, v[30:31] offset:544
    v_mul_f32 v38, v38, v52
    v_mul_f32 v39, v39, v53
    ds_write_b64 v45, v[34:35] offset:1088
    ds_write_b64 v45, v[38:39] offset:1632
aloop_24_lskb:
    s_waitcnt lgkmcnt(0)
    s_barrier
    s_setprio 0
    s_cmp_lg_u32 s27, 0
    s_cbranch_scc1 pg_26
    s_sub_u32 s25, s16, 1
    s_cbranch_scc1 pg_26
    v_mov_b32 v3, s25
    s_mov_b64 exec, 1
    buffer_store_dword v3, off, s[4:7], s62 sc1
    s_mov_b64 exec, -1
pg_26:
    s_add_u32 s21, s17, s33
    v_lshlrev_b32 v2, 1, v43
    s_cmp_eq_u32 s16, 63
    s_cbranch_scc1 aloop_24_nvw
    v_mfma_f32_16x16x32_bf16 v[50:53], v[160:163], v[192:195], 0
    v_mfma_f32_16x16x32_bf16 v[54:57], v[160:163], v[200:203], 0
    v_mfma_f32_16x16x32_bf16 v[58:61], v[160:163], v[208:211], 0
    v_mfma_f32_16x16x32_bf16 v[62:65], v[160:163], v[216:219], 0
    v_mfma_f32_16x16x32_bf16 v[66:69], v[176:179], v[192:195], 0
    v_mfma_f32_16x16x32_bf16 v[70:73], v[176:179], v[200:203], 0
    v_mfma_f32_16x16x32_bf16 v[74:77], v[176:179], v[208:211], 0
    v_mfma_f32_16x16x32_bf16 v[78:81], v[176:179], v[216:219], 0
    v_mfma_f32_16x16x32_bf16 v[50:53], v[164:167], v[196:199], v[50:53]
    v_mfma_f32_16x16x32_bf16 v[54:57], v[164:167], v[204:207], v[54:57]
    v_mfma_f32_16x16x32_bf16 v[58:61], v[164:167], v[212:215], v[58:61]
    v_mfma_f32_16x16x32_bf16 v[62:65], v[164:167], v[220:223], v[62:65]
    v_mfma_f32_16x16x32_bf16 v[66:69], v[180:183], v[196:199], v[66:69]
    v_mfma_f32_16x16x32_bf16 v[70:73], v[180:183], v[204:207], v[70:73]
    v_mfma_f32_16x16x32_bf16 v[74:77], v[180:183], v[212:215], v[74:77]
    v_mfma_f32_16x16x32_bf16 v[78:81], v[180:183], v[220:223], v[78:81]
    v_mfma_f32_16x16x32_bf16 v[50:53], v[168:171], v[224:227], v[50:53]
    v_mfma_f32_16x16x32_bf16 v[54:57], v[168:171], v[232:235], v[54:57]
    v_mfma_f32_16x16x32_bf16 v[58:61], v[168:171], v[240:243], v[58:61]
    v_mfma_f32_16x16x32_bf16 v[62:65], v[168:171], v[248:251], v[62:65]
    v_mfma_f32_16x16x32_bf16 v[66:69], v[184:187], v[224:227], v[66:69]
    v_mfma_f32_16x16x32_bf16 v[70:73], v[184:187], v[232:235], v[70:73]
    v_mfma_f32_16x16x32_bf16 v[74:77], v[184:187], v[240:243], v[74:77]
    v_mfma_f32_16x16x32_bf16 v[78:81], v[184:187], v[248:251], v[78:81]
    v_mfma_f32_16x16x32_bf16 v[50:53], v[172:175], v[228:231], v[50:53]
    v_mfma_f32_16x16x32_bf16 v[54:57], v[172:175], v[236:239], v[54:57]
    v_mfma_f32_16x16x32_bf16 v[58:61], v[172:175], v[244:247], v[58:61]
    v_mfma_f32_16x16x32_bf16 v[62:65], v[172:175], v[252:255], v[62:65]
    v_mfma_f32_16x16x32_bf16 v[66:69], v[188:191], v[228:231], v[66:69]
    v_mfma_f32_16x16x32_bf16 v[70:73], v[188:191], v[236:239], v[70:73]
    v_mfma_f32_16x16x32_bf16 v[74:77], v[188:191], v[244:247], v[74:77]
    v_mfma_f32_16x16x32_bf16 v[78:81], v[188:191], v[252:255], v[78:81]
    buffer_load_dwordx4 v[130:133], v0, s[4:7], s21 offen sc1
    buffer_load_dwordx2 v[146:147], v2, s[4:7], s21 offen offset:1024 sc1
    buffer_load_dwordx4 v[134:137], v0, s[4:7], s21 offen offset:2048 sc1
    buffer_load_dwordx2 v[148:149], v2, s[4:7], s21 offen offset:3072 sc1
    s_add_u32 s30, s16, 2
    s_lshl_b32 s30, s30, 18
    s_add_u32 s30, s30, s46
    s_add_u32 s30, s30, 37748736
    s_add_u32 s31, s30, 131072
    s_branch aloop_24_vwd
aloop_24_nvw:
    buffer_load_dwordx4 v[130:133], v0, s[4:7], s21 offen sc1
    buffer_load_dwordx2 v[146:147], v2, s[4:7], s21 offen offset:1024 sc1
    buffer_load_dwordx4 v[134:137], v0, s[4:7], s21 offen offset:2048 sc1
    buffer_load_dwordx2 v[148:149], v2, s[4:7], s21 offen offset:3072 sc1
aloop_24_vwd:
    v_add_u32 v48, s68, v1
    s_xor_b32 s68, s68, 8192
aloop_24_psa:
    s_waitcnt vmcnt(0)
    v_max3_u32 v3, v130, v131, v132
    v_max3_u32 v3, v3, v133, v134
    v_max3_u32 v3, v3, v135, v136
    v_max3_u32 v3, v3, v137, v146
    v_max3_u32 v3, v3, v147, v148
    v_max_u32 v3, v3, v149
    v_cmp_eq_u32 vcc, -1, v3
    s_cbranch_vccnz arq_25_ps
aloop_24_psok:
    v_mfma_f32_16x16x32_bf16 v[24:27], v[82:85], v[130:133], 0
    v_mfma_f32_16x16x32_bf16 v[28:31], v[86:89], v[130:133], 0
    v_mfma_f32_16x16x32_bf16 v[32:35], v[90:93], v[130:133], 0
    v_mfma_f32_16x16x32_bf16 v[36:39], v[94:97], v[130:133], 0
    v_mov_b32 v138, v146
    v_mfma_f32_16x16x32_bf16 v[12:15], v[82:85], v[134:137], 0
    v_mfma_f32_16x16x32_bf16 v[16:19], v[86:89], v[134:137], 0
    v_mfma_f32_16x16x32_bf16 v[20:23], v[90:93], v[134:137], 0
    v_mfma_f32_16x16x32_bf16 v[154:157], v[94:97], v[134:137], 0
    v_mov_b32 v142, v148
    v_mfma_f32_16x16x32_bf16 v[24:27], v[40:43], v[138:141], v[24:27]
    v_mfma_f32_16x16x32_bf16 v[28:31], v[42:45], v[138:141], v[28:31]
    v_mfma_f32_16x16x32_bf16 v[32:35], v[44:47], v[138:141], v[32:35]
    v_mfma_f32_16x16x32_bf16 v[36:39], v[46:49], v[138:141], v[36:39]
    v_mfma_f32_16x16x32_bf16 v[12:15], v[40:43], v[142:145], v[12:15]
    v_mfma_f32_16x16x32_bf16 v[16:19], v[42:45], v[142:145], v[16:19]
    v_mfma_f32_16x16x32_bf16 v[20:23], v[44:47], v[142:145], v[20:23]
    s_nop 1
    v_mfma_f32_16x16x32_bf16 v[154:157], v[46:49], v[142:145], v[154:157]
aloop_24_nev:
    ds_write_b128 v48, v[24:27] offset:2176
    v_cvt_pk_bf16_f32 v82, v50, v51
    v_cvt_pk_bf16_f32 v83, v52, v53
    ds_write_b128 v48, v[28:31] offset:3200
    v_cvt_pk_bf16_f32 v84, v66, v67
    v_cvt_pk_bf16_f32 v85, v68, v69
    ds_write_b128 v48, v[32:35] offset:4224
    v_cvt_pk_bf16_f32 v86, v54, v55
    v_cvt_pk_bf16_f32 v87, v56, v57
    ds_write_b128 v48, v[36:39] offset:5248
    v_cvt_pk_bf16_f32 v88, v70, v71
    v_cvt_pk_bf16_f32 v89, v72, v73
    ds_write_b128 v48, v[12:15] offset:6272
    v_cvt_pk_bf16_f32 v90, v58, v59
    v_cvt_pk_bf16_f32 v91, v60, v61
    ds_write_b128 v48, v[16:19] offset:7296
    v_cvt_pk_bf16_f32 v92, v74, v75
    v_cvt_pk_bf16_f32 v93, v76, v77
    ds_write_b128 v48, v[20:23] offset:8320
    v_cvt_pk_bf16_f32 v94, v62, v63
    v_cvt_pk_bf16_f32 v95, v64, v65
    ds_write_b128 v48, v[154:157] offset:9344
    v_cvt_pk_bf16_f32 v96, v78, v79
    v_cvt_pk_bf16_f32 v97, v80, v81
aloop_24_bgskip:
    s_waitcnt lgkmcnt(0)
    s_cmp_eq_u32 s16, 63
    s_cbranch_scc1 aloop_24_fin
    s_add_u32 s16, s16, 1
    s_mov_b32 s17, s18
    s_mov_b32 s18, s19
    s_mov_b32 s19, s20
    s_add_u32 s20, s20, 262144
    s_cmp_eq_u32 s20, 210763776
    s_cselect_b32 s20, 209715200, s20
    s_branch aloop_24
arq_25_0:
    s_sub_u32 s26, s26, 1
    s_cbranch_scc1 arq_25_0_g
    buffer_load_dwordx4 v[50:53], v0, s[4:7], s21 offen offset:0 sc1
    buffer_load_dwordx4 v[54:57], v0, s[4:7], s21 offen offset:1024 sc1
    buffer_load_dwordx4 v[58:61], v0, s[4:7], s21 offen offset:2048 sc1
    buffer_load_dwordx4 v[62:65], v0, s[4:7], s21 offen offset:3072 sc1
    buffer_load_dwordx4 v[66:69], v0, s[4:7], s22 offen offset:0 sc1
    buffer_load_dwordx4 v[70:73], v0, s[4:7], s22 offen offset:1024 sc1
    s_waitcnt vmcnt(5)
    v_max3_u32 v3, v50, v51, v52
    v_max_u32 v3, v3, v53
    v_cmp_eq_u32 vcc, -1, v3
    s_cbranch_vccnz arq_25_0
    s_branch arq_25_0ok
arq_25_0_g:
    s_mov_b32 s26, 0
    s_waitcnt vmcnt(0)
    s_branch arq_25_0ok
arq_25_1:
    s_sub_u32 s26, s26, 1
    s_cbranch_scc1 arq_25_1_g
    buffer_load_dwordx4 v[54:57], v0, s[4:7], s21 offen offset:1024 sc1
    buffer_load_dwordx4 v[58:61], v0, s[4:7], s21 offen offset:2048 sc1
    buffer_load_dwordx4 v[62:65], v0, s[4:7], s21 offen offset:3072 sc1
    buffer_load_dwordx4 v[66:69], v0, s[4:7], s22 offen offset:0 sc1
    buffer_load_dwordx4 v[70:73], v0, s[4:7], s22 offen offset:1024 sc1
    s_waitcnt vmcnt(4)
    v_max3_u32 v3, v54, v55, v56
    v_max_u32 v3, v3, v57
    v_cmp_eq_u32 vcc, -1, v3
    s_cbranch_vccnz arq_25_1
    s_branch arq_25_1ok
arq_25_1_g:
    s_mov_b32 s26, 0
    s_waitcnt vmcnt(0)
    s_branch arq_25_1ok
arq_25_2:
    s_sub_u32 s26, s26, 1
    s_cbranch_scc1 arq_25_2_g
    buffer_load_dwordx4 v[58:61], v0, s[4:7], s21 offen offset:2048 sc1
    buffer_load_dwordx4 v[62:65], v0, s[4:7], s21 offen offset:3072 sc1
    buffer_load_dwordx4 v[66:69], v0, s[4:7], s22 offen offset:0 sc1
    buffer_load_dwordx4 v[70:73], v0, s[4:7], s22 offen offset:1024 sc1
    s_waitcnt vmcnt(3)
    v_max3_u32 v3, v58, v59, v60
    v_max_u32 v3, v3, v61
    v_cmp_eq_u32 vcc, -1, v3
    s_cbranch_vccnz arq_25_2
    s_branch arq_25_2ok
arq_25_2_g:
    s_mov_b32 s26, 0
    s_waitcnt vmcnt(0)
    s_branch arq_25_2ok
arq_25_3:
    s_sub_u32 s26, s26, 1
    s_cbranch_scc1 arq_25_3_g
    buffer_load_dwordx4 v[62:65], v0, s[4:7], s21 offen offset:3072 sc1
    buffer_load_dwordx4 v[66:69], v0, s[4:7], s22 offen offset:0 sc1
    buffer_load_dwordx4 v[70:73], v0, s[4:7], s22 offen offset:1024 sc1
    s_waitcnt vmcnt(2)
    v_max3_u32 v3, v62, v63, v64
    v_max_u32 v3, v3, v65
    v_cmp_eq_u32 vcc, -1, v3
    s_cbranch_vccnz arq_25_3
    s_branch arq_25_3ok
arq_25_3_g:
    s_mov_b32 s26, 0
    s_waitcnt vmcnt(0)
    s_branch arq_25_3ok
arq_25_v:
    buffer_load_dwordx4 v[66:69], v0, s[4:7], s22 offen offset:0 sc1
    buffer_load_dwordx4 v[70:73], v0, s[4:7], s22 offen offset:1024 sc1
    v_max3_f32 v2, v12, v13, v14
    v_max3_f32 v3, v15, v16, v17
    v_max3_f32 v2, v2, v18, v19
    v_max3_f32 v3, v3, v20, v21
    v_max_f32 v2, v2, v3
    v_mov_b32 v3, v2
    s_nop 1
    v_permlane16_swap_b32 v3, v2
    v_max_f32 v2, v2, v3
    v_mov_b32 v3, v2
    s_nop 1
    v_permlane32_swap_b32 v3, v2
    v_max_f32 v2, v2, v3
    v_sub_f32 v12, v12, v2
    v_sub_f32 v13, v13, v2
    v_sub_f32 v14, v14, v2
    v_sub_f32 v15, v15, v2
    v_sub_f32 v16, v16, v2
    v_sub_f32 v17, v17, v2
    v_sub_f32 v18, v18, v2
    v_sub_f32 v19, v19, v2
    v_sub_f32 v20, v20, v2
    v_sub_f32 v21, v21, v2
    v_exp_f32 v54, v12
    v_exp_f32 v55, v13
    v_exp_f32 v56, v14
    v_exp_f32 v57, v15
    v_exp_f32 v58, v16
    v_exp_f32 v59, v17
    v_exp_f32 v60, v18
    v_exp_f32 v61, v19
    v_exp_f32 v62, v20
    v_exp_f32 v63, v21
    s_nop 0
    v_cvt_pk_bf16_f32 v154, v54, v55
    v_cvt_pk_bf16_f32 v155, v56, v57
    v_cvt_pk_bf16_f32 v156, v58, v59
    v_cvt_pk_bf16_f32 v157, v60, v61
    v_cvt_pk_bf16_f32 v8, v62, v63
    s_nop 0
    v_mfma_f32_16x16x32_bf16 v[50:53], v[154:157], v[4:7], 0
    v_mfma_f32_16x16x32_bf16 v[50:53], v[8:11], v[4:7], v[50:53]
    v_mfma_f32_16x16x32_bf16 v[24:27], v[154:157], v[82:85], 0
    v_mfma_f32_16x16x32_bf16 v[28:31], v[154:157], v[86:89], 0
    v_mfma_f32_16x16x32_bf16 v[32:35], v[154:157], v[90:93], 0
    v_mfma_f32_16x16x32_bf16 v[36:39], v[154:157], v[94:97], 0
arq_25_vs:
    s_waitcnt vmcnt(0)
    v_max3_u32 v3, v66, v67, v68
    v_max3_u32 v3, v3, v69, v70
    v_max3_u32 v3, v3, v71, v72
    v_max_u32 v3, v3, v73
    v_cmp_eq_u32 vcc, -1, v3
    s_cbranch_vccnz arq_25_vsr
    s_branch arq_25_vsok
arq_25_vsr:
    s_sub_u32 s26, s26, 1
    s_cbranch_scc1 arq_25_vsg
    buffer_load_dwordx4 v[66:69], v0, s[4:7], s22 offen offset:0 sc1
    buffer_load_dwordx4 v[70:73], v0, s[4:7], s22 offen offset:1024 sc1
    s_branch arq_25_vs
arq_25_vsg:
    s_mov_b32 s26, 0
arq_25_vsok:
    v_smfmac_f32_16x16x64_bf16 v[74:77], v[66:69], v[192:199], v41
    v_smfmac_f32_16x16x64_bf16 v[78:81], v[66:69], v[200:207], v41
    v_smfmac_f32_16x16x64_bf16 v[146:149], v[66:69], v[208:215], v41
    v_smfmac_f32_16x16x64_bf16 v[150:153], v[66:69], v[216:223], v41
    v_smfmac_f32_16x16x64_bf16 v[74:77], v[70:73], v[224:231], v41
    v_smfmac_f32_16x16x64_bf16 v[78:81], v[70:73], v[232:239], v41
    v_smfmac_f32_16x16x64_bf16 v[146:149], v[70:73], v[240:247], v41
    v_smfmac_f32_16x16x64_bf16 v[150:153], v[70:73], v[248:255], v41
    v_rcp_f32 v52, v52
    v_rcp_f32 v53, v53
    s_nop 2
    v_add_f32 v74, v74, v75
    v_add_f32 v76, v76, v77
    v_cvt_pk_bf16_f32 v40, v74, v76
    v_add_f32 v78, v78, v79
    v_add_f32 v80, v80, v81
    v_cvt_pk_bf16_f32 v42, v78, v80
    v_add_f32 v146, v146, v147
    v_add_f32 v148, v148, v149
    v_cvt_pk_bf16_f32 v44, v146, v148
    v_add_f32 v150, v150, v151
    v_add_f32 v152, v152, v153
    v_cvt_pk_bf16_f32 v46, v150, v152
    s_nop 1
    v_mfma_f32_16x16x32_bf16 v[24:27], v[8:11], v[40:43], v[24:27]
    v_mfma_f32_16x16x32_bf16 v[28:31], v[8:11], v[42:45], v[28:31]
    v_mfma_f32_16x16x32_bf16 v[32:35], v[8:11], v[44:47], v[32:35]
    v_mfma_f32_16x16x32_bf16 v[36:39], v[8:11], v[46:49], v[36:39]
    s_nop 4
    v_mul_f32 v26, v26, v52
    v_mul_f32 v27, v27, v53
    v_mul_f32 v30, v30, v52
    v_mul_f32 v31, v31, v53
    s_branch aloop_24_pvd
aloop_24_tm:
    s_nop 7
    v_max3_f32 v2, v12, v13, v14
    v_max3_f32 v3, v15, v16, v17
    v_max3_f32 v2, v2, v18, v19
    v_max3_f32 v3, v3, v20, v21
    v_max_f32 v2, v2, v3
    v_mov_b32 v3, v2
    s_nop 1
    v_permlane16_swap_b32 v3, v2
    v_max_f32 v2, v2, v3
    v_mov_b32 v3, v2
    s_nop 1
    v_permlane32_swap_b32 v3, v2
    v_max_f32 v2, v2, v3
    v_sub_f32 v12, v12, v2
    v_sub_f32 v13, v13, v2
    v_sub_f32 v14, v14, v2
    v_sub_f32 v15, v15, v2
    v_sub_f32 v16, v16, v2
    v_sub_f32 v17, v17, v2
    v_sub_f32 v18, v18, v2
    v_sub_f32 v19, v19, v2
    v_sub_f32 v20, v20, v2
    v_sub_f32 v21, v21, v2
    v_exp_f32 v54, v12
    v_exp_f32 v55, v13
    v_exp_f32 v56, v14
    v_exp_f32 v57, v15
    v_exp_f32 v58, v16
    v_exp_f32 v59, v17
    v_exp_f32 v60, v18
    v_exp_f32 v61, v19
    v_exp_f32 v62, v20
    v_exp_f32 v63, v21
    s_nop 0
    v_cvt_pk_bf16_f32 v154, v54, v55
    v_cvt_pk_bf16_f32 v155, v56, v57
    v_cvt_pk_bf16_f32 v156, v58, v59
    v_cvt_pk_bf16_f32 v157, v60, v61
    v_cvt_pk_bf16_f32 v8, v62, v63
    s_nop 0
    v_mfma_f32_16x16x32_bf16 v[50:53], v[154:157], v[4:7], 0
    v_mfma_f32_16x16x32_bf16 v[50:53], v[8:11], v[4:7], v[50:53]
    v_mfma_f32_16x16x32_bf16 v[24:27], v[154:157], v[82:85], 0
    v_mfma_f32_16x16x32_bf16 v[28:31], v[154:157], v[86:89], 0
    v_mfma_f32_16x16x32_bf16 v[32:35], v[154:157], v[90:93], 0
    v_mfma_f32_16x16x32_bf16 v[36:39], v[154:157], v[94:97], 0
    v_mfma_f32_16x16x32_bf16 v[24:27], v[8:11], v[40:43], v[24:27]
    v_mfma_f32_16x16x32_bf16 v[28:31], v[8:11], v[42:45], v[28:31]
    v_mfma_f32_16x16x32_bf16 v[32:35], v[8:11], v[44:47], v[32:35]
    v_mfma_f32_16x16x32_bf16 v[36:39], v[8:11], v[46:49], v[36:39]
    v_rcp_f32 v52, v52
    v_rcp_f32 v53, v53
    s_nop 4
    v_mul_f32 v26, v26, v52
    v_mul_f32 v27, v27, v53
    v_mul_f32 v30, v30, v52
    v_mul_f32 v31, v31, v53
    s_branch aloop_24_pvd
aloop_24_lz:
    buffer_load_dwordx4 v[66:69], v0, s[4:7], s22 offen offset:0 sc1
    buffer_load_dwordx4 v[70:73], v0, s[4:7], s22 offen offset:1024 sc1
    ds_write_b32 v47, v2 offset:16
aloop_24_lsk:
arq_25_vl:
    s_waitcnt vmcnt(0)
    v_max3_u32 v3, v66, v67, v68
    v_max3_u32 v3, v3, v69, v70
    v_max3_u32 v3, v3, v71, v72
    v_max_u32 v3, v3, v73
    v_cmp_eq_u32 vcc, -1, v3
    s_cbranch_vccnz arq_25_vlr
    s_branch arq_25_vlok
arq_25_vlr:
    s_sub_u32 s26, s26, 1
    s_cbranch_scc1 arq_25_vlg
    buffer_load_dwordx4 v[66:69], v0, s[4:7], s22 offen offset:0 sc1
    buffer_load_dwordx4 v[70:73], v0, s[4:7], s22 offen offset:1024 sc1
    s_branch arq_25_vl
arq_25_vlg:
    s_mov_b32 s26, 0
arq_25_vlok:
    v_smfmac_f32_16x16x64_bf16 v[74:77], v[66:69], v[192:199], v41
    v_smfmac_f32_16x16x64_bf16 v[78:81], v[66:69], v[200:207], v41
    v_smfmac_f32_16x16x64_bf16 v[146:149], v[66:69], v[208:215], v41
    v_smfmac_f32_16x16x64_bf16 v[150:153], v[66:69], v[216:223], v41
    v_smfmac_f32_16x16x64_bf16 v[74:77], v[70:73], v[224:231], v41
    v_smfmac_f32_16x16x64_bf16 v[78:81], v[70:73], v[232:239], v41
    v_smfmac_f32_16x16x64_bf16 v[146:149], v[70:73], v[240:247], v41
    v_smfmac_f32_16x16x64_bf16 v[150:153], v[70:73], v[248:255], v41
    s_nop 4
    v_add_f32 v74, v74, v75
    v_add_f32 v76, v76, v77
    v_cvt_pk_bf16_f32 v40, v74, v76
    v_add_f32 v78, v78, v79
    v_add_f32 v80, v80, v81
    v_cvt_pk_bf16_f32 v42, v78, v80
    v_add_f32 v146, v146, v147
    v_add_f32 v148, v148, v149
    v_cvt_pk_bf16_f32 v44, v146, v148
    v_add_f32 v150, v150, v151
    v_add_f32 v152, v152, v153
    v_cvt_pk_bf16_f32 v46, v150, v152
    s_branch aloop_24_lskb
arq_25_ps:
    s_sub_u32 s26, s26, 1
    s_cbranch_scc1 arq_25_psg
    s_sleep 2
    buffer_load_dwordx4 v[130:133], v0, s[4:7], s21 offen sc1
    buffer_load_dwordx2 v[146:147], v2, s[4:7], s21 offen offset:1024 sc1
    buffer_load_dwordx4 v[134:137], v0, s[4:7], s21 offen offset:2048 sc1
    buffer_load_dwordx2 v[148:149], v2, s[4:7], s21 offen offset:3072 sc1
    s_branch aloop_24_psa
arq_25_psg:
    s_mov_b32 s26, 0
    s_branch aloop_24_psok
aloop_24_fin:
    s_barrier
    s_branch k_end
k_end:
k_exit:
    s_endpgm
.section .rodata,"a"
.p2align 6
jobtab:
    .long 6, 24, 24, 8192, 0, 262144, 8388608, 0, 32768, 4, 20971520, 131072, 0, 0, 218104320, 1
    .long 4, 24, 24, 8192, 0, 262144, 8388608, 262144, 32768, 4, 22020096, 131072, 0, 0, 218104448, 1
    .long 1, 32, 32, 8192, 0, 256, 8388608, 1048576, 32768, 8, 41943040, 131072, 0, 0, 218104832, 4
    .long 1, 16, 16, 8192, 0, 256, 8388608, 2097152, 32768, 8, 12582912, 131072, 0, 0, 218105344, 4
    .long 1, 32, 32, 8192, 0, 256, 8388608, 3145728, 32768, 8, 50331648, 131072, 0, 0, 218105856, 4
    .long 1, 32, 32, 8192, 0, 256, 8388608, 3670016, 32768, 8, 52428800, 131072, 0, 0, 218106112, 4
    .long 1, 80, 80, 2048, 0, 256, 7340032, 54525952, 114688, 7, 167772160, 32768, 218103808, 7, 218106368, 1
    .long 0, 0, 0, 0, 0, 0, 0, 0, 0, 0, 0, 0, 0, 0, 0, 0
    .long 0, 0, 0, 0, 0, 0, 0, 0, 0, 0, 0, 0, 0, 0, 0, 0
    .long 0, 0, 0, 0, 0, 0, 0, 0, 0, 0, 0, 0, 0, 0, 0, 0
    .long 6, 24, 24, 8192, 2048, 264192, 8388608, 0, 32768, 4, 21004288, 131072, 0, 0, 218104352, 1
    .long 4, 24, 24, 8192, 2048, 264192, 8388608, 262144, 32768, 4, 22052864, 131072, 0, 0, 218104480, 1
    .long 1, 32, 32, 8192, 2048, 2304, 8388608, 1048576, 32768, 8, 41975808, 131072, 0, 0, 218104864, 4
    .long 1, 16, 16, 8192, 2048, 2304, 8388608, 2097152, 32768, 8, 12615680, 131072, 0, 0, 218105376, 4
    .long 1, 32, 32, 8192, 2048, 2304, 8388608, 3145728, 32768, 8, 50364416, 131072, 0, 0, 218105888, 4
    .long 1, 32, 32, 8192, 2048, 2304, 8388608, 3670016, 32768, 8, 52461568, 131072, 0, 0, 218106144, 4
    .long 1, 80, 80, 2048, 1835008, 1835264, 7340032, 54554624, 114688, 7, 171966464, 32768, 218103824, 7, 218106368, 1
    .long 0, 0, 0, 0, 0, 0, 0, 0, 0, 0, 0, 0, 0, 0, 0, 0
    .long 0, 0, 0, 0, 0, 0, 0, 0, 0, 0, 0, 0, 0, 0, 0, 0
    .long 0, 0, 0, 0, 0, 0, 0, 0, 0, 0, 0, 0, 0, 0, 0, 0
    .long 6, 24, 24, 8192, 4096, 266240, 8388608, 0, 32768, 4, 21037056, 131072, 0, 0, 218104384, 1
    .long 4, 24, 24, 8192, 4096, 266240, 8388608, 262144, 32768, 4, 22085632, 131072, 0, 0, 218104512, 1
    .long 1, 32, 32, 8192, 4096, 4352, 8388608, 1048576, 32768, 8, 42008576, 131072, 0, 0, 218104896, 4
    .long 1, 16, 16, 8192, 4096, 4352, 8388608, 2097152, 32768, 8, 12648448, 131072, 0, 0, 218105408, 4
    .long 1, 32, 32, 8192, 4096, 4352, 8388608, 3145728, 32768, 8, 50397184, 131072, 0, 0, 218105920, 4
    .long 1, 32, 32, 8192, 4096, 4352, 8388608, 3670016, 32768, 8, 52494336, 131072, 0, 0, 218106176, 4
    .long 1, 80, 80, 2048, 3670016, 3670272, 7340032, 54583296, 114688, 7, 176160768, 32768, 218103840, 7, 218106368, 1
    .long 0, 0, 0, 0, 0, 0, 0, 0, 0, 0, 0, 0, 0, 0, 0, 0
    .long 0, 0, 0, 0, 0, 0, 0, 0, 0, 0, 0, 0, 0, 0, 0, 0
    .long 0, 0, 0, 0, 0, 0, 0, 0, 0, 0, 0, 0, 0, 0, 0, 0
    .long 6, 24, 24, 8192, 6144, 268288, 8388608, 0, 32768, 4, 21069824, 131072, 0, 0, 218104416, 1
    .long 4, 24, 24, 8192, 6144, 268288, 8388608, 262144, 32768, 4, 22118400, 131072, 0, 0, 218104544, 1
    .long 1, 32, 32, 8192, 6144, 6400, 8388608, 1048576, 32768, 8, 42041344, 131072, 0, 0, 218104928, 4
    .long 1, 16, 16, 8192, 6144, 6400, 8388608, 2097152, 32768, 8, 12681216, 131072, 0, 0, 218105440, 4
    .long 1, 32, 32, 8192, 6144, 6400, 8388608, 3145728, 32768, 8, 50429952, 131072, 0, 0, 218105952, 4
    .long 1, 32, 32, 8192, 6144, 6400, 8388608, 3670016, 32768, 8, 52527104, 131072, 0, 0, 218106208, 4
    .long 1, 80, 80, 2048, 5505024, 5505280, 7340032, 54611968, 114688, 7, 180355072, 32768, 218103856, 7, 218106368, 1
    .long 0, 0, 0, 0, 0, 0, 0, 0, 0, 0, 0, 0, 0, 0, 0, 0
    .long 0, 0, 0, 0, 0, 0, 0, 0, 0, 0, 0, 0, 0, 0, 0, 0
    .long 0, 0, 0, 0, 0, 0, 0, 0, 0, 0, 0, 0, 0, 0, 0, 0
    .long 6, 24, 24, 8192, 256, 262400, 8388608, 0, 32768, 4, 20975616, 131072, 0, 0, 218104320, 1
    .long 4, 24, 24, 8192, 256, 262400, 8388608, 262144, 32768, 4, 22024192, 131072, 0, 0, 218104448, 1
    .long 1, 32, 32, 8192, 512, 768, 8388608, 1048576, 32768, 8, 41951232, 131072, 0, 0, 218104832, 4
    .long 1, 16, 16, 8192, 512, 768, 8388608, 2097152, 32768, 8, 12591104, 131072, 0, 0, 218105344, 4
    .long 1, 32, 32, 8192, 512, 768, 8388608, 3145728, 32768, 8, 50339840, 131072, 0, 0, 218105856, 4
    .long 1, 32, 32, 8192, 512, 768, 8388608, 3670016, 32768, 8, 52436992, 131072, 0, 0, 218106112, 4
    .long 1, 80, 80, 2048, 512, 768, 7340032, 54525952, 114688, 7, 167780352, 32768, 218103808, 7, 218106368, 1
    .long 0, 0, 0, 0, 0, 0, 0, 0, 0, 0, 0, 0, 0, 0, 0, 0
    .long 0, 0, 0, 0, 0, 0, 0, 0, 0, 0, 0, 0, 0, 0, 0, 0
    .long 0, 0, 0, 0, 0, 0, 0, 0, 0, 0, 0, 0, 0, 0, 0, 0
    .long 6, 24, 24, 8192, 2304, 264448, 8388608, 0, 32768, 4, 21008384, 131072, 0, 0, 218104352, 1
    .long 4, 24, 24, 8192, 2304, 264448, 8388608, 262144, 32768, 4, 22056960, 131072, 0, 0, 218104480, 1
    .long 1, 32, 32, 8192, 2560, 2816, 8388608, 1048576, 32768, 8, 41984000, 131072, 0, 0, 218104864, 4
    .long 1, 16, 16, 8192, 2560, 2816, 8388608, 2097152, 32768, 8, 12623872, 131072, 0, 0, 218105376, 4
    .long 1, 32, 32, 8192, 2560, 2816, 8388608, 3145728, 32768, 8, 50372608, 131072, 0, 0, 218105888, 4
    .long 1, 32, 32, 8192, 2560, 2816, 8388608, 3670016, 32768, 8, 52469760, 131072, 0, 0, 218106144, 4
    .long 1, 80, 80, 2048, 1835520, 1835776, 7340032, 54554624, 114688, 7, 171974656, 32768, 218103824, 7, 218106368, 1
    .long 0, 0, 0, 0, 0, 0, 0, 0, 0, 0, 0, 0, 0, 0, 0, 0
    .long 0, 0, 0, 0, 0, 0, 0, 0, 0, 0, 0, 0, 0, 0, 0, 0
    .long 0, 0, 0, 0, 0, 0, 0, 0, 0, 0, 0, 0, 0, 0, 0, 0
    .long 6, 24, 24, 8192, 4352, 266496, 8388608, 0, 32768, 4, 21041152, 131072, 0, 0, 218104384, 1
    .long 4, 24, 24, 8192, 4352, 266496, 8388608, 262144, 32768, 4, 22089728, 131072, 0, 0, 218104512, 1
    .long 1, 32, 32, 8192, 4608, 4864, 8388608, 1048576, 32768, 8, 42016768, 131072, 0, 0, 218104896, 4
    .long 1, 16, 16, 8192, 4608, 4864, 8388608, 2097152, 32768, 8, 12656640, 131072, 0, 0, 218105408, 4
    .long 1, 32, 32, 8192, 4608, 4864, 8388608, 3145728, 32768, 8, 50405376, 131072, 0, 0, 218105920, 4
    .long 1, 32, 32, 8192, 4608, 4864, 8388608, 3670016, 32768, 8, 52502528, 131072, 0, 0, 218106176, 4
    .long 1, 80, 80, 2048, 3670528, 3670784, 7340032, 54583296, 114688, 7, 176168960, 32768, 218103840, 7, 218106368, 1
    .long 0, 0, 0, 0, 0, 0, 0, 0, 0, 0, 0, 0, 0, 0, 0, 0
    .long 0, 0, 0, 0, 0, 0, 0, 0, 0, 0, 0, 0, 0, 0, 0, 0
    .long 0, 0, 0, 0, 0, 0, 0, 0, 0, 0, 0, 0, 0, 0, 0, 0
    .long 6, 24, 24, 8192, 6400, 268544, 8388608, 0, 32768, 4, 21073920, 131072, 0, 0, 218104416, 1
    .long 4, 24, 24, 8192, 6400, 268544, 8388608, 262144, 32768, 4, 22122496, 131072, 0, 0, 218104544, 1
    .long 1, 32, 32, 8192, 6656, 6912, 8388608, 1048576, 32768, 8, 42049536, 131072, 0, 0, 218104928, 4
    .long 1, 16, 16, 8192, 6656, 6912, 8388608, 2097152, 32768, 8, 12689408, 131072, 0, 0, 218105440, 4
    .long 1, 32, 32, 8192, 6656, 6912, 8388608, 3145728, 32768, 8, 50438144, 131072, 0, 0, 218105952, 4
    .long 1, 32, 32, 8192, 6656, 6912, 8388608, 3670016, 32768, 8, 52535296, 131072, 0, 0, 218106208, 4
    .long 1, 80, 80, 2048, 5505536, 5505792, 7340032, 54611968, 114688, 7, 180363264, 32768, 218103856, 7, 218106368, 1
    .long 0, 0, 0, 0, 0, 0, 0, 0, 0, 0, 0, 0, 0, 0, 0, 0
    .long 0, 0, 0, 0, 0, 0, 0, 0, 0, 0, 0, 0, 0, 0, 0, 0
    .long 0, 0, 0, 0, 0, 0, 0, 0, 0, 0, 0, 0, 0, 0, 0, 0
    .long 6, 24, 24, 8192, 512, 262656, 8388608, 0, 32768, 4, 20979712, 131072, 0, 0, 218104320, 1
    .long 4, 24, 24, 8192, 512, 262656, 8388608, 262144, 32768, 4, 22028288, 131072, 0, 0, 218104448, 1
    .long 1, 32, 32, 8192, 1024, 1280, 8388608, 1048576, 32768, 8, 41959424, 131072, 0, 0, 218104848, 4
    .long 1, 16, 16, 8192, 1024, 1280, 8388608, 2097152, 32768, 8, 12599296, 131072, 0, 0, 218105360, 4
    .long 1, 32, 32, 8192, 1024, 1280, 8388608, 3145728, 32768, 8, 50348032, 131072, 0, 0, 218105872, 4
    .long 1, 32, 32, 8192, 1024, 1280, 8388608, 3670016, 32768, 8, 52445184, 131072, 0, 0, 218106128, 4
    .long 1, 80, 80, 2048, 1024, 1280, 7340032, 54525952, 114688, 7, 167788544, 32768, 218103808, 7, 218106368, 1
    .long 0, 0, 0, 0, 0, 0, 0, 0, 0, 0, 0, 0, 0, 0, 0, 0
    .long 0, 0, 0, 0, 0, 0, 0, 0, 0, 0, 0, 0, 0, 0, 0, 0
    .long 0, 0, 0, 0, 0, 0, 0, 0, 0, 0, 0, 0, 0, 0, 0, 0
    .long 6, 24, 24, 8192, 2560, 264704, 8388608, 0, 32768, 4, 21012480, 131072, 0, 0, 218104352, 1
    .long 4, 24, 24, 8192, 2560, 264704, 8388608, 262144, 32768, 4, 22061056, 131072, 0, 0, 218104480, 1
    .long 1, 32, 32, 8192, 3072, 3328, 8388608, 1048576, 32768, 8, 41992192, 131072, 0, 0, 218104880, 4
    .long 1, 16, 16, 8192, 3072, 3328, 8388608, 2097152, 32768, 8, 12632064, 131072, 0, 0, 218105392, 4
    .long 1, 32, 32, 8192, 3072, 3328, 8388608, 3145728, 32768, 8, 50380800, 131072, 0, 0, 218105904, 4
    .long 1, 32, 32, 8192, 3072, 3328, 8388608, 3670016, 32768, 8, 52477952, 131072, 0, 0, 218106160, 4
    .long 1, 80, 80, 2048, 1836032, 1836288, 7340032, 54554624, 114688, 7, 171982848, 32768, 218103824, 7, 218106368, 1
    .long 0, 0, 0, 0, 0, 0, 0, 0, 0, 0, 0, 0, 0, 0, 0, 0
    .long 0, 0, 0, 0, 0, 0, 0, 0, 0, 0, 0, 0, 0, 0, 0, 0
    .long 0, 0, 0, 0, 0, 0, 0, 0, 0, 0, 0, 0, 0, 0, 0, 0
    .long 6, 24, 24, 8192, 4608, 266752, 8388608, 0, 32768, 4, 21045248, 131072, 0, 0, 218104384, 1
    .long 4, 24, 24, 8192, 4608, 266752, 8388608, 262144, 32768, 4, 22093824, 131072, 0, 0, 218104512, 1
    .long 1, 32, 32, 8192, 5120, 5376, 8388608, 1048576, 32768, 8, 42024960, 131072, 0, 0, 218104912, 4
    .long 1, 16, 16, 8192, 5120, 5376, 8388608, 2097152, 32768, 8, 12664832, 131072, 0, 0, 218105424, 4
    .long 1, 32, 32, 8192, 5120, 5376, 8388608, 3145728, 32768, 8, 50413568, 131072, 0, 0, 218105936, 4
    .long 1, 32, 32, 8192, 5120, 5376, 8388608, 3670016, 32768, 8, 52510720, 131072, 0, 0, 218106192, 4
    .long 1, 80, 80, 2048, 3671040, 3671296, 7340032, 54583296, 114688, 7, 176177152, 32768, 218103840, 7, 218106368, 1
    .long 0, 0, 0, 0, 0, 0, 0, 0, 0, 0, 0, 0, 0, 0, 0, 0
    .long 0, 0, 0, 0, 0, 0, 0, 0, 0, 0, 0, 0, 0, 0, 0, 0
    .long 0, 0, 0, 0, 0, 0, 0, 0, 0, 0, 0, 0, 0, 0, 0, 0
    .long 6, 24, 24, 8192, 6656, 268800, 8388608, 0, 32768, 4, 21078016, 131072, 0, 0, 218104416, 1
    .long 4, 24, 24, 8192, 6656, 268800, 8388608, 262144, 32768, 4, 22126592, 131072, 0, 0, 218104544, 1
    .long 1, 32, 32, 8192, 7168, 7424, 8388608, 1048576, 32768, 8, 42057728, 131072, 0, 0, 218104944, 4
    .long 1, 16, 16, 8192, 7168, 7424, 8388608, 2097152, 32768, 8, 12697600, 131072, 0, 0, 218105456, 4
    .long 1, 32, 32, 8192, 7168, 7424, 8388608, 3145728, 32768, 8, 50446336, 131072, 0, 0, 218105968, 4
    .long 1, 32, 32, 8192, 7168, 7424, 8388608, 3670016, 32768, 8, 52543488, 131072, 0, 0, 218106224, 4
    .long 1, 80, 80, 2048, 5506048, 5506304, 7340032, 54611968, 114688, 7, 180371456, 32768, 218103856, 7, 218106368, 1
    .long 0, 0, 0, 0, 0, 0, 0, 0, 0, 0, 0, 0, 0, 0, 0, 0
    .long 0, 0, 0, 0, 0, 0, 0, 0, 0, 0, 0, 0, 0, 0, 0, 0
    .long 0, 0, 0, 0, 0, 0, 0, 0, 0, 0, 0, 0, 0, 0, 0, 0
    .long 6, 24, 24, 8192, 768, 262912, 8388608, 0, 32768, 4, 20983808, 131072, 0, 0, 218104320, 1
    .long 4, 24, 24, 8192, 768, 262912, 8388608, 262144, 32768, 4, 22032384, 131072, 0, 0, 218104448, 1
    .long 1, 32, 32, 8192, 1536, 1792, 8388608, 1048576, 32768, 8, 41967616, 131072, 0, 0, 218104848, 4
    .long 1, 16, 16, 8192, 1536, 1792, 8388608, 2097152, 32768, 8, 12607488, 131072, 0, 0, 218105360, 4
    .long 1, 32, 32, 8192, 1536, 1792, 8388608, 3145728, 32768, 8, 50356224, 131072, 0, 0, 218105872, 4
    .long 1, 32, 32, 8192, 1536, 1792, 8388608, 3670016, 32768, 8, 52453376, 131072, 0, 0, 218106128, 4
    .long 1, 80, 80, 2048, 1536, 1792, 7340032, 54525952, 114688, 7, 167796736, 32768, 218103808, 7, 218106368, 1
    .long 0, 0, 0, 0, 0, 0, 0, 0, 0, 0, 0, 0, 0, 0, 0, 0
    .long 0, 0, 0, 0, 0, 0, 0, 0, 0, 0, 0, 0, 0, 0, 0, 0
    .long 0, 0, 0, 0, 0, 0, 0, 0, 0, 0, 0, 0, 0, 0, 0, 0
    .long 6, 24, 24, 8192, 2816, 264960, 8388608, 0, 32768, 4, 21016576, 131072, 0, 0, 218104352, 1
    .long 4, 24, 24, 8192, 2816, 264960, 8388608, 262144, 32768, 4, 22065152, 131072, 0, 0, 218104480, 1
    .long 1, 32, 32, 8192, 3584, 3840, 8388608, 1048576, 32768, 8, 42000384, 131072, 0, 0, 218104880, 4
    .long 1, 16, 16, 8192, 3584, 3840, 8388608, 2097152, 32768, 8, 12640256, 131072, 0, 0, 218105392, 4
    .long 1, 32, 32, 8192, 3584, 3840, 8388608, 3145728, 32768, 8, 50388992, 131072, 0, 0, 218105904, 4
    .long 1, 32, 32, 8192, 3584, 3840, 8388608, 3670016, 32768, 8, 52486144, 131072, 0, 0, 218106160, 4
    .long 1, 80, 80, 2048, 1836544, 1836800, 7340032, 54554624, 114688, 7, 171991040, 32768, 218103824, 7, 218106368, 1
    .long 0, 0, 0, 0, 0, 0, 0, 0, 0, 0, 0, 0, 0, 0, 0, 0
    .long 0, 0, 0, 0, 0, 0, 0, 0, 0, 0, 0, 0, 0, 0, 0, 0
    .long 0, 0, 0, 0, 0, 0, 0, 0, 0, 0, 0, 0, 0, 0, 0, 0
    .long 6, 24, 24, 8192, 4864, 267008, 8388608, 0, 32768, 4, 21049344, 131072, 0, 0, 218104384, 1
    .long 4, 24, 24, 8192, 4864, 267008, 8388608, 262144, 32768, 4, 22097920, 131072, 0, 0, 218104512, 1
    .long 1, 32, 32, 8192, 5632, 5888, 8388608, 1048576, 32768, 8, 42033152, 131072, 0, 0, 218104912, 4
    .long 1, 16, 16, 8192, 5632, 5888, 8388608, 2097152, 32768, 8, 12673024, 131072, 0, 0, 218105424, 4
    .long 1, 32, 32, 8192, 5632, 5888, 8388608, 3145728, 32768, 8, 50421760, 131072, 0, 0, 218105936, 4
    .long 1, 32, 32, 8192, 5632, 5888, 8388608, 3670016, 32768, 8, 52518912, 131072, 0, 0, 218106192, 4
    .long 1, 80, 80, 2048, 3671552, 3671808, 7340032, 54583296, 114688, 7, 176185344, 32768, 218103840, 7, 218106368, 1
    .long 0, 0, 0, 0, 0, 0, 0, 0, 0, 0, 0, 0, 0, 0, 0, 0
    .long 0, 0, 0, 0, 0, 0, 0, 0, 0, 0, 0, 0, 0, 0, 0, 0
    .long 0, 0, 0, 0, 0, 0, 0, 0, 0, 0, 0, 0, 0, 0, 0, 0
    .long 6, 24, 24, 8192, 6912, 269056, 8388608, 0, 32768, 4, 21082112, 131072, 0, 0, 218104416, 1
    .long 4, 24, 24, 8192, 6912, 269056, 8388608, 262144, 32768, 4, 22130688, 131072, 0, 0, 218104544, 1
    .long 1, 32, 32, 8192, 7680, 7936, 8388608, 1048576, 32768, 8, 42065920, 131072, 0, 0, 218104944, 4
    .long 1, 16, 16, 8192, 7680, 7936, 8388608, 2097152, 32768, 8, 12705792, 131072, 0, 0, 218105456, 4
    .long 1, 32, 32, 8192, 7680, 7936, 8388608, 3145728, 32768, 8, 50454528, 131072, 0, 0, 218105968, 4
    .long 1, 32, 32, 8192, 7680, 7936, 8388608, 3670016, 32768, 8, 52551680, 131072, 0, 0, 218106224, 4
    .long 1, 80, 80, 2048, 5506560, 5506816, 7340032, 54611968, 114688, 7, 180379648, 32768, 218103856, 7, 218106368, 1
    .long 0, 0, 0, 0, 0, 0, 0, 0, 0, 0, 0, 0, 0, 0, 0, 0
    .long 0, 0, 0, 0, 0, 0, 0, 0, 0, 0, 0, 0, 0, 0, 0, 0
    .long 0, 0, 0, 0, 0, 0, 0, 0, 0, 0, 0, 0, 0, 0, 0, 0
    .long 6, 24, 24, 8192, 1024, 263168, 8388608, 0, 32768, 4, 20987904, 131072, 0, 0, 218104336, 1
    .long 4, 24, 24, 8192, 1024, 263168, 8388608, 262144, 32768, 4, 22036480, 131072, 0, 0, 218104464, 1
    .long 1, 24, 24, 8192, 0, 256, 8388608, 1048576, 32768, 8, 25165824, 131072, 0, 0, 218104832, 4
    .long 1, 32, 32, 8192, 0, 256, 8388608, 2621440, 32768, 8, 48234496, 131072, 0, 0, 218105600, 4
    .long 1, 24, 24, 8192, 0, 256, 8388608, 3145728, 32768, 8, 33554432, 131072, 0, 0, 218105856, 4
    .long 1, 24, 24, 8192, 0, 256, 8388608, 3670016, 32768, 8, 35651584, 131072, 0, 0, 218106112, 4
    .long 1, 80, 80, 2048, 0, 256, 7340032, 56360960, 114688, 7, 168296448, 32768, 218103872, 7, 218106432, 1
    .long 0, 0, 0, 0, 0, 0, 0, 0, 0, 0, 0, 0, 0, 0, 0, 0
    .long 0, 0, 0, 0, 0, 0, 0, 0, 0, 0, 0, 0, 0, 0, 0, 0
    .long 0, 0, 0, 0, 0, 0, 0, 0, 0, 0, 0, 0, 0, 0, 0, 0
    .long 6, 24, 24, 8192, 3072, 265216, 8388608, 0, 32768, 4, 21020672, 131072, 0, 0, 218104368, 1
    .long 4, 24, 24, 8192, 3072, 265216, 8388608, 262144, 32768, 4, 22069248, 131072, 0, 0, 218104496, 1
    .long 1, 24, 24, 8192, 2048, 2304, 8388608, 1048576, 32768, 8, 25198592, 131072, 0, 0, 218104864, 4
    .long 1, 32, 32, 8192, 2048, 2304, 8388608, 2621440, 32768, 8, 48267264, 131072, 0, 0, 218105632, 4
    .long 1, 24, 24, 8192, 2048, 2304, 8388608, 3145728, 32768, 8, 33587200, 131072, 0, 0, 218105888, 4
    .long 1, 24, 24, 8192, 2048, 2304, 8388608, 3670016, 32768, 8, 35684352, 131072, 0, 0, 218106144, 4
    .long 1, 80, 80, 2048, 1835008, 1835264, 7340032, 56389632, 114688, 7, 172490752, 32768, 218103888, 7, 218106432, 1
    .long 0, 0, 0, 0, 0, 0, 0, 0, 0, 0, 0, 0, 0, 0, 0, 0
    .long 0, 0, 0, 0, 0, 0, 0, 0, 0, 0, 0, 0, 0, 0, 0, 0
    .long 0, 0, 0, 0, 0, 0, 0, 0, 0, 0, 0, 0, 0, 0, 0, 0
    .long 6, 24, 24, 8192, 5120, 267264, 8388608, 0, 32768, 4, 21053440, 131072, 0, 0, 218104400, 1
    .long 4, 24, 24, 8192, 5120, 267264, 8388608, 262144, 32768, 4, 22102016, 131072, 0, 0, 218104528, 1
    .long 1, 24, 24, 8192, 4096, 4352, 8388608, 1048576, 32768, 8, 25231360, 131072, 0, 0, 218104896, 4
    .long 1, 32, 32, 8192, 4096, 4352, 8388608, 2621440, 32768, 8, 48300032, 131072, 0, 0, 218105664, 4
    .long 1, 24, 24, 8192, 4096, 4352, 8388608, 3145728, 32768, 8, 33619968, 131072, 0, 0, 218105920, 4
    .long 1, 24, 24, 8192, 4096, 4352, 8388608, 3670016, 32768, 8, 35717120, 131072, 0, 0, 218106176, 4
    .long 1, 80, 80, 2048, 3670016, 3670272, 7340032, 56418304, 114688, 7, 176685056, 32768, 218103904, 7, 218106432, 1
    .long 0, 0, 0, 0, 0, 0, 0, 0, 0, 0, 0, 0, 0, 0, 0, 0
    .long 0, 0, 0, 0, 0, 0, 0, 0, 0, 0, 0, 0, 0, 0, 0, 0
    .long 0, 0, 0, 0, 0, 0, 0, 0, 0, 0, 0, 0, 0, 0, 0, 0
    .long 6, 24, 24, 8192, 7168, 269312, 8388608, 0, 32768, 4, 21086208, 131072, 0, 0, 218104432, 1
    .long 4, 24, 24, 8192, 7168, 269312, 8388608, 262144, 32768, 4, 22134784, 131072, 0, 0, 218104560, 1
    .long 1, 24, 24, 8192, 6144, 6400, 8388608, 1048576, 32768, 8, 25264128, 131072, 0, 0, 218104928, 4
    .long 1, 32, 32, 8192, 6144, 6400, 8388608, 2621440, 32768, 8, 48332800, 131072, 0, 0, 218105696, 4
    .long 1, 24, 24, 8192, 6144, 6400, 8388608, 3145728, 32768, 8, 33652736, 131072, 0, 0, 218105952, 4
    .long 1, 24, 24, 8192, 6144, 6400, 8388608, 3670016, 32768, 8, 35749888, 131072, 0, 0, 218106208, 4
    .long 1, 80, 80, 2048, 5505024, 5505280, 7340032, 56446976, 114688, 7, 180879360, 32768, 218103920, 7, 218106432, 1
    .long 0, 0, 0, 0, 0, 0, 0, 0, 0, 0, 0, 0, 0, 0, 0, 0
    .long 0, 0, 0, 0, 0, 0, 0, 0, 0, 0, 0, 0, 0, 0, 0, 0
    .long 0, 0, 0, 0, 0, 0, 0, 0, 0, 0, 0, 0, 0, 0, 0, 0
    .long 6, 24, 24, 8192, 1280, 263424, 8388608, 0, 32768, 4, 20992000, 131072, 0, 0, 218104336, 1
    .long 4, 24, 24, 8192, 1280, 263424, 8388608, 262144, 32768, 4, 22040576, 131072, 0, 0, 218104464, 1
    .long 1, 24, 24, 8192, 512, 768, 8388608, 1048576, 32768, 8, 25174016, 131072, 0, 0, 218104832, 4
    .long 1, 32, 32, 8192, 512, 768, 8388608, 2621440, 32768, 8, 48242688, 131072, 0, 0, 218105600, 4
    .long 1, 24, 24, 8192, 512, 768, 8388608, 3145728, 32768, 8, 33562624, 131072, 0, 0, 218105856, 4
    .long 1, 24, 24, 8192, 512, 768, 8388608, 3670016, 32768, 8, 35659776, 131072, 0, 0, 218106112, 4
    .long 1, 80, 80, 2048, 512, 768, 7340032, 56360960, 114688, 7, 168304640, 32768, 218103872, 7, 218106432, 1
    .long 0, 0, 0, 0, 0, 0, 0, 0, 0, 0, 0, 0, 0, 0, 0, 0
    .long 0, 0, 0, 0, 0, 0, 0, 0, 0, 0, 0, 0, 0, 0, 0, 0
    .long 0, 0, 0, 0, 0, 0, 0, 0, 0, 0, 0, 0, 0, 0, 0, 0
    .long 6, 24, 24, 8192, 3328, 265472, 8388608, 0, 32768, 4, 21024768, 131072, 0, 0, 218104368, 1
    .long 4, 24, 24, 8192, 3328, 265472, 8388608, 262144, 32768, 4, 22073344, 131072, 0, 0, 218104496, 1
    .long 1, 24, 24, 8192, 2560, 2816, 8388608, 1048576, 32768, 8, 25206784, 131072, 0, 0, 218104864, 4
    .long 1, 32, 32, 8192, 2560, 2816, 8388608, 2621440, 32768, 8, 48275456, 131072, 0, 0, 218105632, 4
    .long 1, 24, 24, 8192, 2560, 2816, 8388608, 3145728, 32768, 8, 33595392, 131072, 0, 0, 218105888, 4
    .long 1, 24, 24, 8192, 2560, 2816, 8388608, 3670016, 32768, 8, 35692544, 131072, 0, 0, 218106144, 4
    .long 1, 80, 80, 2048, 1835520, 1835776, 7340032, 56389632, 114688, 7, 172498944, 32768, 218103888, 7, 218106432, 1
    .long 0, 0, 0, 0, 0, 0, 0, 0, 0, 0, 0, 0, 0, 0, 0, 0
    .long 0, 0, 0, 0, 0, 0, 0, 0, 0, 0, 0, 0, 0, 0, 0, 0
    .long 0, 0, 0, 0, 0, 0, 0, 0, 0, 0, 0, 0, 0, 0, 0, 0
    .long 6, 24, 24, 8192, 5376, 267520, 8388608, 0, 32768, 4, 21057536, 131072, 0, 0, 218104400, 1
    .long 4, 24, 24, 8192, 5376, 267520, 8388608, 262144, 32768, 4, 22106112, 131072, 0, 0, 218104528, 1
    .long 1, 24, 24, 8192, 4608, 4864, 8388608, 1048576, 32768, 8, 25239552, 131072, 0, 0, 218104896, 4
    .long 1, 32, 32, 8192, 4608, 4864, 8388608, 2621440, 32768, 8, 48308224, 131072, 0, 0, 218105664, 4
    .long 1, 24, 24, 8192, 4608, 4864, 8388608, 3145728, 32768, 8, 33628160, 131072, 0, 0, 218105920, 4
    .long 1, 24, 24, 8192, 4608, 4864, 8388608, 3670016, 32768, 8, 35725312, 131072, 0, 0, 218106176, 4
    .long 1, 80, 80, 2048, 3670528, 3670784, 7340032, 56418304, 114688, 7, 176693248, 32768, 218103904, 7, 218106432, 1
    .long 0, 0, 0, 0, 0, 0, 0, 0, 0, 0, 0, 0, 0, 0, 0, 0
    .long 0, 0, 0, 0, 0, 0, 0, 0, 0, 0, 0, 0, 0, 0, 0, 0
    .long 0, 0, 0, 0, 0, 0, 0, 0, 0, 0, 0, 0, 0, 0, 0, 0
    .long 6, 24, 24, 8192, 7424, 269568, 8388608, 0, 32768, 4, 21090304, 131072, 0, 0, 218104432, 1
    .long 4, 24, 24, 8192, 7424, 269568, 8388608, 262144, 32768, 4, 22138880, 131072, 0, 0, 218104560, 1
    .long 1, 24, 24, 8192, 6656, 6912, 8388608, 1048576, 32768, 8, 25272320, 131072, 0, 0, 218104928, 4
    .long 1, 32, 32, 8192, 6656, 6912, 8388608, 2621440, 32768, 8, 48340992, 131072, 0, 0, 218105696, 4
    .long 1, 24, 24, 8192, 6656, 6912, 8388608, 3145728, 32768, 8, 33660928, 131072, 0, 0, 218105952, 4
    .long 1, 24, 24, 8192, 6656, 6912, 8388608, 3670016, 32768, 8, 35758080, 131072, 0, 0, 218106208, 4
    .long 1, 80, 80, 2048, 5505536, 5505792, 7340032, 56446976, 114688, 7, 180887552, 32768, 218103920, 7, 218106432, 1
    .long 0, 0, 0, 0, 0, 0, 0, 0, 0, 0, 0, 0, 0, 0, 0, 0
    .long 0, 0, 0, 0, 0, 0, 0, 0, 0, 0, 0, 0, 0, 0, 0, 0
    .long 0, 0, 0, 0, 0, 0, 0, 0, 0, 0, 0, 0, 0, 0, 0, 0
    .long 6, 24, 24, 8192, 1536, 263680, 8388608, 0, 32768, 4, 20996096, 131072, 0, 0, 218104336, 1
    .long 4, 24, 24, 8192, 1536, 263680, 8388608, 262144, 32768, 4, 22044672, 131072, 0, 0, 218104464, 1
    .long 1, 24, 24, 8192, 1024, 1280, 8388608, 1048576, 32768, 8, 25182208, 131072, 0, 0, 218104848, 4
    .long 1, 32, 32, 8192, 1024, 1280, 8388608, 2621440, 32768, 8, 48250880, 131072, 0, 0, 218105616, 4
    .long 1, 24, 24, 8192, 1024, 1280, 8388608, 3145728, 32768, 8, 33570816, 131072, 0, 0, 218105872, 4
    .long 1, 24, 24, 8192, 1024, 1280, 8388608, 3670016, 32768, 8, 35667968, 131072, 0, 0, 218106128, 4
    .long 1, 80, 80, 2048, 1024, 1280, 7340032, 56360960, 114688, 7, 168312832, 32768, 218103872, 7, 218106432, 1
    .long 0, 0, 0, 0, 0, 0, 0, 0, 0, 0, 0, 0, 0, 0, 0, 0
    .long 0, 0, 0, 0, 0, 0, 0, 0, 0, 0, 0, 0, 0, 0, 0, 0
    .long 0, 0, 0, 0, 0, 0, 0, 0, 0, 0, 0, 0, 0, 0, 0, 0
    .long 6, 24, 24, 8192, 3584, 265728, 8388608, 0, 32768, 4, 21028864, 131072, 0, 0, 218104368, 1
    .long 4, 24, 24, 8192, 3584, 265728, 8388608, 262144, 32768, 4, 22077440, 131072, 0, 0, 218104496, 1
    .long 1, 24, 24, 8192, 3072, 3328, 8388608, 1048576, 32768, 8, 25214976, 131072, 0, 0, 218104880, 4
    .long 1, 32, 32, 8192, 3072, 3328, 8388608, 2621440, 32768, 8, 48283648, 131072, 0, 0, 218105648, 4
    .long 1, 24, 24, 8192, 3072, 3328, 8388608, 3145728, 32768, 8, 33603584, 131072, 0, 0, 218105904, 4
    .long 1, 24, 24, 8192, 3072, 3328, 8388608, 3670016, 32768, 8, 35700736, 131072, 0, 0, 218106160, 4
    .long 1, 80, 80, 2048, 1836032, 1836288, 7340032, 56389632, 114688, 7, 172507136, 32768, 218103888, 7, 218106432, 1
    .long 0, 0, 0, 0, 0, 0, 0, 0, 0, 0, 0, 0, 0, 0, 0, 0
    .long 0, 0, 0, 0, 0, 0, 0, 0, 0, 0, 0, 0, 0, 0, 0, 0
    .long 0, 0, 0, 0, 0, 0, 0, 0, 0, 0, 0, 0, 0, 0, 0, 0
    .long 6, 24, 24, 8192, 5632, 267776, 8388608, 0, 32768, 4, 21061632, 131072, 0, 0, 218104400, 1
    .long 4, 24, 24, 8192, 5632, 267776, 8388608, 262144, 32768, 4, 22110208, 131072, 0, 0, 218104528, 1
    .long 1, 24, 24, 8192, 5120, 5376, 8388608, 1048576, 32768, 8, 25247744, 131072, 0, 0, 218104912, 4
    .long 1, 32, 32, 8192, 5120, 5376, 8388608, 2621440, 32768, 8, 48316416, 131072, 0, 0, 218105680, 4
    .long 1, 24, 24, 8192, 5120, 5376, 8388608, 3145728, 32768, 8, 33636352, 131072, 0, 0, 218105936, 4
    .long 1, 24, 24, 8192, 5120, 5376, 8388608, 3670016, 32768, 8, 35733504, 131072, 0, 0, 218106192, 4
    .long 1, 80, 80, 2048, 3671040, 3671296, 7340032, 56418304, 114688, 7, 176701440, 32768, 218103904, 7, 218106432, 1
    .long 0, 0, 0, 0, 0, 0, 0, 0, 0, 0, 0, 0, 0, 0, 0, 0
    .long 0, 0, 0, 0, 0, 0, 0, 0, 0, 0, 0, 0, 0, 0, 0, 0
    .long 0, 0, 0, 0, 0, 0, 0, 0, 0, 0, 0, 0, 0, 0, 0, 0
    .long 6, 24, 24, 8192, 7680, 269824, 8388608, 0, 32768, 4, 21094400, 131072, 0, 0, 218104432, 1
    .long 4, 24, 24, 8192, 7680, 269824, 8388608, 262144, 32768, 4, 22142976, 131072, 0, 0, 218104560, 1
    .long 1, 24, 24, 8192, 7168, 7424, 8388608, 1048576, 32768, 8, 25280512, 131072, 0, 0, 218104944, 4
    .long 1, 32, 32, 8192, 7168, 7424, 8388608, 2621440, 32768, 8, 48349184, 131072, 0, 0, 218105712, 4
    .long 1, 24, 24, 8192, 7168, 7424, 8388608, 3145728, 32768, 8, 33669120, 131072, 0, 0, 218105968, 4
    .long 1, 24, 24, 8192, 7168, 7424, 8388608, 3670016, 32768, 8, 35766272, 131072, 0, 0, 218106224, 4
    .long 1, 80, 80, 2048, 5506048, 5506304, 7340032, 56446976, 114688, 7, 180895744, 32768, 218103920, 7, 218106432, 1
    .long 0, 0, 0, 0, 0, 0, 0, 0, 0, 0, 0, 0, 0, 0, 0, 0
    .long 0, 0, 0, 0, 0, 0, 0, 0, 0, 0, 0, 0, 0, 0, 0, 0
    .long 0, 0, 0, 0, 0, 0, 0, 0, 0, 0, 0, 0, 0, 0, 0, 0
    .long 6, 24, 24, 8192, 1792, 263936, 8388608, 0, 32768, 4, 21000192, 131072, 0, 0, 218104336, 1
    .long 4, 24, 24, 8192, 1792, 263936, 8388608, 262144, 32768, 4, 22048768, 131072, 0, 0, 218104464, 1
    .long 1, 24, 24, 8192, 1536, 1792, 8388608, 1048576, 32768, 8, 25190400, 131072, 0, 0, 218104848, 4
    .long 1, 32, 32, 8192, 1536, 1792, 8388608, 2621440, 32768, 8, 48259072, 131072, 0, 0, 218105616, 4
    .long 1, 24, 24, 8192, 1536, 1792, 8388608, 3145728, 32768, 8, 33579008, 131072, 0, 0, 218105872, 4
    .long 1, 24, 24, 8192, 1536, 1792, 8388608, 3670016, 32768, 8, 35676160, 131072, 0, 0, 218106128, 4
    .long 1, 80, 80, 2048, 1536, 1792, 7340032, 56360960, 114688, 7, 168321024, 32768, 218103872, 7, 218106432, 1
    .long 0, 0, 0, 0, 0, 0, 0, 0, 0, 0, 0, 0, 0, 0, 0, 0
    .long 0, 0, 0, 0, 0, 0, 0, 0, 0, 0, 0, 0, 0, 0, 0, 0
    .long 0, 0, 0, 0, 0, 0, 0, 0, 0, 0, 0, 0, 0, 0, 0, 0
    .long 6, 24, 24, 8192, 3840, 265984, 8388608, 0, 32768, 4, 21032960, 131072, 0, 0, 218104368, 1
    .long 4, 24, 24, 8192, 3840, 265984, 8388608, 262144, 32768, 4, 22081536, 131072, 0, 0, 218104496, 1
    .long 1, 24, 24, 8192, 3584, 3840, 8388608, 1048576, 32768, 8, 25223168, 131072, 0, 0, 218104880, 4
    .long 1, 32, 32, 8192, 3584, 3840, 8388608, 2621440, 32768, 8, 48291840, 131072, 0, 0, 218105648, 4
    .long 1, 24, 24, 8192, 3584, 3840, 8388608, 3145728, 32768, 8, 33611776, 131072, 0, 0, 218105904, 4
    .long 1, 24, 24, 8192, 3584, 3840, 8388608, 3670016, 32768, 8, 35708928, 131072, 0, 0, 218106160, 4
    .long 1, 80, 80, 2048, 1836544, 1836800, 7340032, 56389632, 114688, 7, 172515328, 32768, 218103888, 7, 218106432, 1
    .long 0, 0, 0, 0, 0, 0, 0, 0, 0, 0, 0, 0, 0, 0, 0, 0
    .long 0, 0, 0, 0, 0, 0, 0, 0, 0, 0, 0, 0, 0, 0, 0, 0
    .long 0, 0, 0, 0, 0, 0, 0, 0, 0, 0, 0, 0, 0, 0, 0, 0
    .long 6, 24, 24, 8192, 5888, 268032, 8388608, 0, 32768, 4, 21065728, 131072, 0, 0, 218104400, 1
    .long 4, 24, 24, 8192, 5888, 268032, 8388608, 262144, 32768, 4, 22114304, 131072, 0, 0, 218104528, 1
    .long 1, 24, 24, 8192, 5632, 5888, 8388608, 1048576, 32768, 8, 25255936, 131072, 0, 0, 218104912, 4
    .long 1, 32, 32, 8192, 5632, 5888, 8388608, 2621440, 32768, 8, 48324608, 131072, 0, 0, 218105680, 4
    .long 1, 24, 24, 8192, 5632, 5888, 8388608, 3145728, 32768, 8, 33644544, 131072, 0, 0, 218105936, 4
    .long 1, 24, 24, 8192, 5632, 5888, 8388608, 3670016, 32768, 8, 35741696, 131072, 0, 0, 218106192, 4
    .long 1, 80, 80, 2048, 3671552, 3671808, 7340032, 56418304, 114688, 7, 176709632, 32768, 218103904, 7, 218106432, 1
    .long 0, 0, 0, 0, 0, 0, 0, 0, 0, 0, 0, 0, 0, 0, 0, 0
    .long 0, 0, 0, 0, 0, 0, 0, 0, 0, 0, 0, 0, 0, 0, 0, 0
    .long 0, 0, 0, 0, 0, 0, 0, 0, 0, 0, 0, 0, 0, 0, 0, 0
    .long 6, 24, 24, 8192, 7936, 270080, 8388608, 0, 32768, 4, 21098496, 131072, 0, 0, 218104432, 1
    .long 4, 24, 24, 8192, 7936, 270080, 8388608, 262144, 32768, 4, 22147072, 131072, 0, 0, 218104560, 1
    .long 1, 24, 24, 8192, 7680, 7936, 8388608, 1048576, 32768, 8, 25288704, 131072, 0, 0, 218104944, 4
    .long 1, 32, 32, 8192, 7680, 7936, 8388608, 2621440, 32768, 8, 48357376, 131072, 0, 0, 218105712, 4
    .long 1, 24, 24, 8192, 7680, 7936, 8388608, 3145728, 32768, 8, 33677312, 131072, 0, 0, 218105968, 4
    .long 1, 24, 24, 8192, 7680, 7936, 8388608, 3670016, 32768, 8, 35774464, 131072, 0, 0, 218106224, 4
    .long 1, 80, 80, 2048, 5506560, 5506816, 7340032, 56446976, 114688, 7, 180903936, 32768, 218103920, 7, 218106432, 1
    .long 0, 0, 0, 0, 0, 0, 0, 0, 0, 0, 0, 0, 0, 0, 0, 0
    .long 0, 0, 0, 0, 0, 0, 0, 0, 0, 0, 0, 0, 0, 0, 0, 0
    .long 0, 0, 0, 0, 0, 0, 0, 0, 0, 0, 0, 0, 0, 0, 0, 0
    .long 6, 32, 32, 8192, 0, 262144, 8388608, 0, 32768, 4, 37748736, 131072, 0, 0, 218104320, 1
    .long 4, 32, 32, 8192, 0, 262144, 8388608, 262144, 32768, 4, 38797312, 131072, 0, 0, 218104448, 1
    .long 4, 16, 16, 8192, 1792, 263936, 8388608, 786432, 32768, 4, 7368704, 131072, 0, 0, 218104592, 1
    .long 1, 24, 24, 8192, 0, 256, 8388608, 1572864, 32768, 8, 27262976, 131072, 0, 0, 218105088, 4
    .long 2, 64, 72, 7168, 0, 0, 7340032, 0, 32768, 8, 54525952, 114688, 0, 0, 218103808, 1
    .long 2, 64, 72, 7168, 6144, 6144, 7340032, 1048576, 32768, 8, 58294272, 114688, 0, 0, 218103984, 1
    .long 2, 64, 72, 7168, 5120, 5120, 7340032, 2621440, 32768, 8, 63782912, 114688, 0, 0, 218104160, 1
    .long 1, 80, 80, 2048, 0, 256, 7340032, 61865984, 114688, 7, 169869312, 32768, 218104064, 7, 218106624, 1
    .long 0, 0, 0, 0, 0, 0, 0, 0, 0, 0, 0, 0, 0, 0, 0, 0
    .long 0, 0, 0, 0, 0, 0, 0, 0, 0, 0, 0, 0, 0, 0, 0, 0
    .long 6, 32, 32, 8192, 2048, 264192, 8388608, 0, 32768, 4, 37781504, 131072, 0, 0, 218104352, 1
    .long 4, 32, 32, 8192, 2048, 264192, 8388608, 262144, 32768, 4, 38830080, 131072, 0, 0, 218104480, 1
    .long 4, 16, 16, 8192, 3840, 265984, 8388608, 786432, 32768, 4, 7401472, 131072, 0, 0, 218104624, 1
    .long 1, 24, 24, 8192, 2048, 2304, 8388608, 1572864, 32768, 8, 27295744, 131072, 0, 0, 218105120, 4
    .long 2, 64, 72, 7168, 256, 256, 7340032, 0, 32768, 8, 54530048, 114688, 0, 0, 218103808, 1
    .long 2, 64, 72, 7168, 6400, 6400, 7340032, 1048576, 32768, 8, 58298368, 114688, 0, 0, 218103984, 1
    .long 2, 64, 72, 7168, 5376, 5376, 7340032, 2621440, 32768, 8, 63787008, 114688, 0, 0, 218104176, 1
    .long 1, 80, 80, 2048, 1835008, 1835264, 7340032, 61894656, 114688, 7, 174063616, 32768, 218104080, 7, 218106624, 1
    .long 0, 0, 0, 0, 0, 0, 0, 0, 0, 0, 0, 0, 0, 0, 0, 0
    .long 0, 0, 0, 0, 0, 0, 0, 0, 0, 0, 0, 0, 0, 0, 0, 0
    .long 6, 32, 32, 8192, 4096, 266240, 8388608, 0, 32768, 4, 37814272, 131072, 0, 0, 218104384, 1
    .long 4, 32, 32, 8192, 4096, 266240, 8388608, 262144, 32768, 4, 38862848, 131072, 0, 0, 218104512, 1
    .long 4, 16, 16, 8192, 5888, 268032, 8388608, 786432, 32768, 4, 7434240, 131072, 0, 0, 218104656, 1
    .long 1, 24, 24, 8192, 4096, 4352, 8388608, 1572864, 32768, 8, 27328512, 131072, 0, 0, 218105152, 4
    .long 2, 64, 72, 7168, 512, 512, 7340032, 0, 32768, 8, 54534144, 114688, 0, 0, 218103808, 1
    .long 2, 64, 72, 7168, 6656, 6656, 7340032, 1048576, 32768, 8, 58302464, 114688, 0, 0, 218103984, 1
    .long 2, 64, 72, 7168, 5632, 5632, 7340032, 2621440, 32768, 8, 63791104, 114688, 0, 0, 218104176, 1
    .long 1, 80, 80, 2048, 3670016, 3670272, 7340032, 61923328, 114688, 7, 178257920, 32768, 218104096, 7, 218106624, 1
    .long 0, 0, 0, 0, 0, 0, 0, 0, 0, 0, 0, 0, 0, 0, 0, 0
    .long 0, 0, 0, 0, 0, 0, 0, 0, 0, 0, 0, 0, 0, 0, 0, 0
    .long 6, 32, 32, 8192, 6144, 268288, 8388608, 0, 32768, 4, 37847040, 131072, 0, 0, 218104416, 1
    .long 4, 32, 32, 8192, 6144, 268288, 8388608, 262144, 32768, 4, 38895616, 131072, 0, 0, 218104544, 1
    .long 4, 16, 16, 8192, 7936, 270080, 8388608, 786432, 32768, 4, 7467008, 131072, 0, 0, 218104688, 1
    .long 1, 24, 24, 8192, 6144, 6400, 8388608, 1572864, 32768, 8, 27361280, 131072, 0, 0, 218105184, 4
    .long 2, 64, 72, 7168, 768, 768, 7340032, 0, 32768, 8, 54538240, 114688, 0, 0, 218103808, 1
    .long 2, 64, 72, 7168, 6912, 6912, 7340032, 1048576, 32768, 8, 58306560, 114688, 0, 0, 218103984, 1
    .long 2, 64, 72, 7168, 5888, 5888, 7340032, 2621440, 32768, 8, 63795200, 114688, 0, 0, 218104176, 1
    .long 1, 80, 80, 2048, 5505024, 5505280, 7340032, 61952000, 114688, 7, 182452224, 32768, 218104112, 7, 218106624, 1
    .long 0, 0, 0, 0, 0, 0, 0, 0, 0, 0, 0, 0, 0, 0, 0, 0
    .long 0, 0, 0, 0, 0, 0, 0, 0, 0, 0, 0, 0, 0, 0, 0, 0
    .long 6, 32, 32, 8192, 256, 262400, 8388608, 0, 32768, 4, 37752832, 131072, 0, 0, 218104320, 1
    .long 4, 32, 32, 8192, 256, 262400, 8388608, 262144, 32768, 4, 38801408, 131072, 0, 0, 218104448, 1
    .long 4, 16, 16, 8192, 1792, 263936, 8388608, 524288, 32768, 4, 6320128, 131072, 0, 0, 218104592, 1
    .long 1, 24, 24, 8192, 512, 768, 8388608, 1572864, 32768, 8, 27271168, 131072, 0, 0, 218105088, 4
    .long 2, 64, 72, 7168, 1024, 1024, 7340032, 0, 32768, 8, 54542336, 114688, 0, 0, 218103808, 1
    .long 2, 64, 72, 7168, 0, 0, 7340032, 1572864, 32768, 8, 60030976, 114688, 0, 0, 218104000, 1
    .long 2, 64, 72, 7168, 6144, 6144, 7340032, 2621440, 32768, 8, 63799296, 114688, 0, 0, 218104176, 1
    .long 1, 80, 80, 2048, 512, 768, 7340032, 61865984, 114688, 7, 169877504, 32768, 218104064, 7, 218106624, 1
    .long 0, 0, 0, 0, 0, 0, 0, 0, 0, 0, 0, 0, 0, 0, 0, 0
    .long 0, 0, 0, 0, 0, 0, 0, 0, 0, 0, 0, 0, 0, 0, 0, 0
    .long 6, 32, 32, 8192, 2304, 264448, 8388608, 0, 32768, 4, 37785600, 131072, 0, 0, 218104352, 1
    .long 4, 32, 32, 8192, 2304, 264448, 8388608, 262144, 32768, 4, 38834176, 131072, 0, 0, 218104480, 1
    .long 4, 16, 16, 8192, 3840, 265984, 8388608, 524288, 32768, 4, 6352896, 131072, 0, 0, 218104624, 1
    .long 1, 24, 24, 8192, 2560, 2816, 8388608, 1572864, 32768, 8, 27303936, 131072, 0, 0, 218105120, 4
    .long 2, 64, 72, 7168, 1280, 1280, 7340032, 0, 32768, 8, 54546432, 114688, 0, 0, 218103808, 1
    .long 2, 64, 72, 7168, 256, 256, 7340032, 1572864, 32768, 8, 60035072, 114688, 0, 0, 218104000, 1
    .long 2, 64, 72, 7168, 6400, 6400, 7340032, 2621440, 32768, 8, 63803392, 114688, 0, 0, 218104176, 1
    .long 1, 80, 80, 2048, 1835520, 1835776, 7340032, 61894656, 114688, 7, 174071808, 32768, 218104080, 7, 218106624, 1
    .long 0, 0, 0, 0, 0, 0, 0, 0, 0, 0, 0, 0, 0, 0, 0, 0
    .long 0, 0, 0, 0, 0, 0, 0, 0, 0, 0, 0, 0, 0, 0, 0, 0
    .long 6, 32, 32, 8192, 4352, 266496, 8388608, 0, 32768, 4, 37818368, 131072, 0, 0, 218104384, 1
    .long 4, 32, 32, 8192, 4352, 266496, 8388608, 262144, 32768, 4, 38866944, 131072, 0, 0, 218104512, 1
    .long 4, 16, 16, 8192, 5888, 268032, 8388608, 524288, 32768, 4, 6385664, 131072, 0, 0, 218104656, 1
    .long 1, 24, 24, 8192, 4608, 4864, 8388608, 1572864, 32768, 8, 27336704, 131072, 0, 0, 218105152, 4
    .long 2, 64, 72, 7168, 1536, 1536, 7340032, 0, 32768, 8, 54550528, 114688, 0, 0, 218103808, 1
    .long 2, 64, 72, 7168, 512, 512, 7340032, 1572864, 32768, 8, 60039168, 114688, 0, 0, 218104000, 1
    .long 2, 64, 72, 7168, 6656, 6656, 7340032, 2621440, 32768, 8, 63807488, 114688, 0, 0, 218104176, 1
    .long 1, 80, 80, 2048, 3670528, 3670784, 7340032, 61923328, 114688, 7, 178266112, 32768, 218104096, 7, 218106624, 1
    .long 0, 0, 0, 0, 0, 0, 0, 0, 0, 0, 0, 0, 0, 0, 0, 0
    .long 0, 0, 0, 0, 0, 0, 0, 0, 0, 0, 0, 0, 0, 0, 0, 0
    .long 6, 32, 32, 8192, 6400, 268544, 8388608, 0, 32768, 4, 37851136, 131072, 0, 0, 218104416, 1
    .long 4, 32, 32, 8192, 6400, 268544, 8388608, 262144, 32768, 4, 38899712, 131072, 0, 0, 218104544, 1
    .long 4, 16, 16, 8192, 7936, 270080, 8388608, 524288, 32768, 4, 6418432, 131072, 0, 0, 218104688, 1
    .long 1, 24, 24, 8192, 6656, 6912, 8388608, 1572864, 32768, 8, 27369472, 131072, 0, 0, 218105184, 4
    .long 2, 64, 72, 7168, 1792, 1792, 7340032, 0, 32768, 8, 54554624, 114688, 0, 0, 218103824, 1
    .long 2, 64, 72, 7168, 768, 768, 7340032, 1572864, 32768, 8, 60043264, 114688, 0, 0, 218104000, 1
    .long 2, 64, 72, 7168, 6912, 6912, 7340032, 2621440, 32768, 8, 63811584, 114688, 0, 0, 218104176, 1
    .long 1, 80, 80, 2048, 5505536, 5505792, 7340032, 61952000, 114688, 7, 182460416, 32768, 218104112, 7, 218106624, 1
    .long 0, 0, 0, 0, 0, 0, 0, 0, 0, 0, 0, 0, 0, 0, 0, 0
    .long 0, 0, 0, 0, 0, 0, 0, 0, 0, 0, 0, 0, 0, 0, 0, 0
    .long 6, 32, 32, 8192, 512, 262656, 8388608, 0, 32768, 4, 37756928, 131072, 0, 0, 218104320, 1
    .long 4, 32, 32, 8192, 512, 262656, 8388608, 262144, 32768, 4, 38805504, 131072, 0, 0, 218104448, 1
    .long 4, 16, 16, 8192, 1536, 263680, 8388608, 786432, 32768, 4, 7364608, 131072, 0, 0, 218104592, 1
    .long 1, 24, 24, 8192, 1024, 1280, 8388608, 1572864, 32768, 8, 27279360, 131072, 0, 0, 218105104, 4
    .long 2, 64, 72, 7168, 2048, 2048, 7340032, 0, 32768, 8, 54558720, 114688, 0, 0, 218103824, 1
    .long 2, 64, 72, 7168, 1024, 1024, 7340032, 1572864, 32768, 8, 60047360, 114688, 0, 0, 218104000, 1
    .long 2, 64, 72, 7168, 0, 0, 7340032, 3145728, 32768, 8, 65536000, 114688, 0, 0, 218104192, 1
    .long 1, 80, 80, 2048, 1024, 1280, 7340032, 61865984, 114688, 7, 169885696, 32768, 218104064, 7, 218106624, 1
    .long 0, 0, 0, 0, 0, 0, 0, 0, 0, 0, 0, 0, 0, 0, 0, 0
    .long 0, 0, 0, 0, 0, 0, 0, 0, 0, 0, 0, 0, 0, 0, 0, 0
    .long 6, 32, 32, 8192, 2560, 264704, 8388608, 0, 32768, 4, 37789696, 131072, 0, 0, 218104352, 1
    .long 4, 32, 32, 8192, 2560, 264704, 8388608, 262144, 32768, 4, 38838272, 131072, 0, 0, 218104480, 1
    .long 4, 16, 16, 8192, 3584, 265728, 8388608, 786432, 32768, 4, 7397376, 131072, 0, 0, 218104624, 1
    .long 1, 24, 24, 8192, 3072, 3328, 8388608, 1572864, 32768, 8, 27312128, 131072, 0, 0, 218105136, 4
    .long 2, 64, 72, 7168, 2304, 2304, 7340032, 0, 32768, 8, 54562816, 114688, 0, 0, 218103824, 1
    .long 2, 64, 72, 7168, 1280, 1280, 7340032, 1572864, 32768, 8, 60051456, 114688, 0, 0, 218104000, 1
    .long 2, 64, 72, 7168, 256, 256, 7340032, 3145728, 32768, 8, 65540096, 114688, 0, 0, 218104192, 1
    .long 1, 80, 80, 2048, 1836032, 1836288, 7340032, 61894656, 114688, 7, 174080000, 32768, 218104080, 7, 218106624, 1
    .long 0, 0, 0, 0, 0, 0, 0, 0, 0, 0, 0, 0, 0, 0, 0, 0
    .long 0, 0, 0, 0, 0, 0, 0, 0, 0, 0, 0, 0, 0, 0, 0, 0
    .long 6, 32, 32, 8192, 4608, 266752, 8388608, 0, 32768, 4, 37822464, 131072, 0, 0, 218104384, 1
    .long 4, 32, 32, 8192, 4608, 266752, 8388608, 262144, 32768, 4, 38871040, 131072, 0, 0, 218104512, 1
    .long 4, 16, 16, 8192, 5632, 267776, 8388608, 786432, 32768, 4, 7430144, 131072, 0, 0, 218104656, 1
    .long 1, 24, 24, 8192, 5120, 5376, 8388608, 1572864, 32768, 8, 27344896, 131072, 0, 0, 218105168, 4
    .long 2, 64, 72, 7168, 2560, 2560, 7340032, 0, 32768, 8, 54566912, 114688, 0, 0, 218103824, 1
    .long 2, 64, 72, 7168, 1536, 1536, 7340032, 1572864, 32768, 8, 60055552, 114688, 0, 0, 218104000, 1
    .long 2, 64, 72, 7168, 512, 512, 7340032, 3145728, 32768, 8, 65544192, 114688, 0, 0, 218104192, 1
    .long 1, 80, 80, 2048, 3671040, 3671296, 7340032, 61923328, 114688, 7, 178274304, 32768, 218104096, 7, 218106624, 1
    .long 0, 0, 0, 0, 0, 0, 0, 0, 0, 0, 0, 0, 0, 0, 0, 0
    .long 0, 0, 0, 0, 0, 0, 0, 0, 0, 0, 0, 0, 0, 0, 0, 0
    .long 6, 32, 32, 8192, 6656, 268800, 8388608, 0, 32768, 4, 37855232, 131072, 0, 0, 218104416, 1
    .long 4, 32, 32, 8192, 6656, 268800, 8388608, 262144, 32768, 4, 38903808, 131072, 0, 0, 218104544, 1
    .long 4, 16, 16, 8192, 7680, 269824, 8388608, 786432, 32768, 4, 7462912, 131072, 0, 0, 218104688, 1
    .long 1, 24, 24, 8192, 7168, 7424, 8388608, 1572864, 32768, 8, 27377664, 131072, 0, 0, 218105200, 4
    .long 2, 64, 72, 7168, 2816, 2816, 7340032, 0, 32768, 8, 54571008, 114688, 0, 0, 218103824, 1
    .long 2, 64, 72, 7168, 1792, 1792, 7340032, 1572864, 32768, 8, 60059648, 114688, 0, 0, 218104016, 1
    .long 2, 64, 72, 7168, 768, 768, 7340032, 3145728, 32768, 8, 65548288, 114688, 0, 0, 218104192, 1
    .long 1, 80, 80, 2048, 5506048, 5506304, 7340032, 61952000, 114688, 7, 182468608, 32768, 218104112, 7, 218106624, 1
    .long 0, 0, 0, 0, 0, 0, 0, 0, 0, 0, 0, 0, 0, 0, 0, 0
    .long 0, 0, 0, 0, 0, 0, 0, 0, 0, 0, 0, 0, 0, 0, 0, 0
    .long 6, 32, 32, 8192, 768, 262912, 8388608, 0, 32768, 4, 37761024, 131072, 0, 0, 218104320, 1
    .long 4, 32, 32, 8192, 768, 262912, 8388608, 262144, 32768, 4, 38809600, 131072, 0, 0, 218104448, 1
    .long 4, 16, 16, 8192, 1536, 263680, 8388608, 524288, 32768, 4, 6316032, 131072, 0, 0, 218104592, 1
    .long 1, 24, 24, 8192, 1536, 1792, 8388608, 1572864, 32768, 8, 27287552, 131072, 0, 0, 218105104, 4
    .long 2, 64, 72, 7168, 3072, 3072, 7340032, 0, 32768, 8, 54575104, 114688, 0, 0, 218103824, 1
    .long 2, 64, 72, 7168, 2048, 2048, 7340032, 1572864, 32768, 8, 60063744, 114688, 0, 0, 218104016, 1
    .long 2, 64, 72, 7168, 1024, 1024, 7340032, 3145728, 32768, 8, 65552384, 114688, 0, 0, 218104192, 1
    .long 1, 80, 80, 2048, 1536, 1792, 7340032, 61865984, 114688, 7, 169893888, 32768, 218104064, 7, 218106624, 1
    .long 0, 0, 0, 0, 0, 0, 0, 0, 0, 0, 0, 0, 0, 0, 0, 0
    .long 0, 0, 0, 0, 0, 0, 0, 0, 0, 0, 0, 0, 0, 0, 0, 0
    .long 6, 32, 32, 8192, 2816, 264960, 8388608, 0, 32768, 4, 37793792, 131072, 0, 0, 218104352, 1
    .long 4, 32, 32, 8192, 2816, 264960, 8388608, 262144, 32768, 4, 38842368, 131072, 0, 0, 218104480, 1
    .long 4, 16, 16, 8192, 3584, 265728, 8388608, 524288, 32768, 4, 6348800, 131072, 0, 0, 218104624, 1
    .long 1, 24, 24, 8192, 3584, 3840, 8388608, 1572864, 32768, 8, 27320320, 131072, 0, 0, 218105136, 4
    .long 2, 64, 72, 7168, 3328, 3328, 7340032, 0, 32768, 8, 54579200, 114688, 0, 0, 218103824, 1
    .long 2, 64, 72, 7168, 2304, 2304, 7340032, 1572864, 32768, 8, 60067840, 114688, 0, 0, 218104016, 1
    .long 2, 64, 72, 7168, 1280, 1280, 7340032, 3145728, 32768, 8, 65556480, 114688, 0, 0, 218104192, 1
    .long 1, 80, 80, 2048, 1836544, 1836800, 7340032, 61894656, 114688, 7, 174088192, 32768, 218104080, 7, 218106624, 1
    .long 0, 0, 0, 0, 0, 0, 0, 0, 0, 0, 0, 0, 0, 0, 0, 0
    .long 0, 0, 0, 0, 0, 0, 0, 0, 0, 0, 0, 0, 0, 0, 0, 0
    .long 6, 32, 32, 8192, 4864, 267008, 8388608, 0, 32768, 4, 37826560, 131072, 0, 0, 218104384, 1
    .long 4, 32, 32, 8192, 4864, 267008, 8388608, 262144, 32768, 4, 38875136, 131072, 0, 0, 218104512, 1
    .long 4, 16, 16, 8192, 5632, 267776, 8388608, 524288, 32768, 4, 6381568, 131072, 0, 0, 218104656, 1
    .long 1, 24, 24, 8192, 5632, 5888, 8388608, 1572864, 32768, 8, 27353088, 131072, 0, 0, 218105168, 4
    .long 2, 64, 72, 7168, 3584, 3584, 7340032, 0, 32768, 8, 54583296, 114688, 0, 0, 218103840, 1
    .long 2, 64, 72, 7168, 2560, 2560, 7340032, 1572864, 32768, 8, 60071936, 114688, 0, 0, 218104016, 1
    .long 2, 64, 72, 7168, 1536, 1536, 7340032, 3145728, 32768, 8, 65560576, 114688, 0, 0, 218104192, 1
    .long 1, 80, 80, 2048, 3671552, 3671808, 7340032, 61923328, 114688, 7, 178282496, 32768, 218104096, 7, 218106624, 1
    .long 0, 0, 0, 0, 0, 0, 0, 0, 0, 0, 0, 0, 0, 0, 0, 0
    .long 0, 0, 0, 0, 0, 0, 0, 0, 0, 0, 0, 0, 0, 0, 0, 0
    .long 6, 32, 32, 8192, 6912, 269056, 8388608, 0, 32768, 4, 37859328, 131072, 0, 0, 218104416, 1
    .long 4, 32, 32, 8192, 6912, 269056, 8388608, 262144, 32768, 4, 38907904, 131072, 0, 0, 218104544, 1
    .long 4, 16, 16, 8192, 7680, 269824, 8388608, 524288, 32768, 4, 6414336, 131072, 0, 0, 218104688, 1
    .long 1, 24, 24, 8192, 7680, 7936, 8388608, 1572864, 32768, 8, 27385856, 131072, 0, 0, 218105200, 4
    .long 2, 64, 72, 7168, 3840, 3840, 7340032, 0, 32768, 8, 54587392, 114688, 0, 0, 218103840, 1
    .long 2, 64, 72, 7168, 2816, 2816, 7340032, 1572864, 32768, 8, 60076032, 114688, 0, 0, 218104016, 1
    .long 2, 64, 72, 7168, 1792, 1792, 7340032, 3145728, 32768, 8, 65564672, 114688, 0, 0, 218104208, 1
    .long 1, 80, 80, 2048, 5506560, 5506816, 7340032, 61952000, 114688, 7, 182476800, 32768, 218104112, 7, 218106624, 1
    .long 0, 0, 0, 0, 0, 0, 0, 0, 0, 0, 0, 0, 0, 0, 0, 0
    .long 0, 0, 0, 0, 0, 0, 0, 0, 0, 0, 0, 0, 0, 0, 0, 0
    .long 6, 32, 32, 8192, 1024, 263168, 8388608, 0, 32768, 4, 37765120, 131072, 0, 0, 218104336, 1
    .long 4, 32, 32, 8192, 1024, 263168, 8388608, 262144, 32768, 4, 38813696, 131072, 0, 0, 218104464, 1
    .long 4, 16, 16, 8192, 1280, 263424, 8388608, 786432, 32768, 4, 7360512, 131072, 0, 0, 218104592, 1
    .long 1, 16, 16, 8192, 0, 256, 8388608, 1572864, 32768, 8, 10485760, 131072, 0, 0, 218105088, 4
    .long 2, 64, 72, 7168, 4096, 4096, 7340032, 0, 32768, 8, 54591488, 114688, 0, 0, 218103840, 1
    .long 2, 64, 72, 7168, 3072, 3072, 7340032, 1572864, 32768, 8, 60080128, 114688, 0, 0, 218104016, 1
    .long 2, 64, 72, 7168, 2048, 2048, 7340032, 3145728, 32768, 8, 65568768, 114688, 0, 0, 218104208, 1
    .long 1, 80, 80, 2048, 0, 256, 7340032, 63700992, 114688, 7, 170393600, 32768, 218104128, 7, 218106688, 1
    .long 0, 0, 0, 0, 0, 0, 0, 0, 0, 0, 0, 0, 0, 0, 0, 0
    .long 0, 0, 0, 0, 0, 0, 0, 0, 0, 0, 0, 0, 0, 0, 0, 0
    .long 6, 32, 32, 8192, 3072, 265216, 8388608, 0, 32768, 4, 37797888, 131072, 0, 0, 218104368, 1
    .long 4, 32, 32, 8192, 3072, 265216, 8388608, 262144, 32768, 4, 38846464, 131072, 0, 0, 218104496, 1
    .long 4, 16, 16, 8192, 3328, 265472, 8388608, 786432, 32768, 4, 7393280, 131072, 0, 0, 218104624, 1
    .long 1, 16, 16, 8192, 2048, 2304, 8388608, 1572864, 32768, 8, 10518528, 131072, 0, 0, 218105120, 4
    .long 2, 64, 72, 7168, 4352, 4352, 7340032, 0, 32768, 8, 54595584, 114688, 0, 0, 218103840, 1
    .long 2, 64, 72, 7168, 3328, 3328, 7340032, 1572864, 32768, 8, 60084224, 114688, 0, 0, 218104016, 1
    .long 2, 64, 72, 7168, 2304, 2304, 7340032, 3145728, 32768, 8, 65572864, 114688, 0, 0, 218104208, 1
    .long 1, 80, 80, 2048, 1835008, 1835264, 7340032, 63729664, 114688, 7, 174587904, 32768, 218104144, 7, 218106688, 1
    .long 0, 0, 0, 0, 0, 0, 0, 0, 0, 0, 0, 0, 0, 0, 0, 0
    .long 0, 0, 0, 0, 0, 0, 0, 0, 0, 0, 0, 0, 0, 0, 0, 0
    .long 6, 32, 32, 8192, 5120, 267264, 8388608, 0, 32768, 4, 37830656, 131072, 0, 0, 218104400, 1
    .long 4, 32, 32, 8192, 5120, 267264, 8388608, 262144, 32768, 4, 38879232, 131072, 0, 0, 218104528, 1
    .long 4, 16, 16, 8192, 5376, 267520, 8388608, 786432, 32768, 4, 7426048, 131072, 0, 0, 218104656, 1
    .long 1, 16, 16, 8192, 4096, 4352, 8388608, 1572864, 32768, 8, 10551296, 131072, 0, 0, 218105152, 4
    .long 2, 64, 72, 7168, 4608, 4608, 7340032, 0, 32768, 8, 54599680, 114688, 0, 0, 218103840, 1
    .long 2, 64, 72, 7168, 3584, 3584, 7340032, 1572864, 32768, 8, 60088320, 114688, 0, 0, 218104032, 1
    .long 2, 64, 72, 7168, 2560, 2560, 7340032, 3145728, 32768, 8, 65576960, 114688, 0, 0, 218104208, 1
    .long 1, 80, 80, 2048, 3670016, 3670272, 7340032, 63758336, 114688, 7, 178782208, 32768, 218104160, 7, 218106688, 1
    .long 0, 0, 0, 0, 0, 0, 0, 0, 0, 0, 0, 0, 0, 0, 0, 0
    .long 0, 0, 0, 0, 0, 0, 0, 0, 0, 0, 0, 0, 0, 0, 0, 0
    .long 6, 32, 32, 8192, 7168, 269312, 8388608, 0, 32768, 4, 37863424, 131072, 0, 0, 218104432, 1
    .long 4, 32, 32, 8192, 7168, 269312, 8388608, 262144, 32768, 4, 38912000, 131072, 0, 0, 218104560, 1
    .long 4, 16, 16, 8192, 7424, 269568, 8388608, 786432, 32768, 4, 7458816, 131072, 0, 0, 218104688, 1
    .long 1, 16, 16, 8192, 6144, 6400, 8388608, 1572864, 32768, 8, 10584064, 131072, 0, 0, 218105184, 4
    .long 2, 64, 72, 7168, 4864, 4864, 7340032, 0, 32768, 8, 54603776, 114688, 0, 0, 218103840, 1
    .long 2, 64, 72, 7168, 3840, 3840, 7340032, 1572864, 32768, 8, 60092416, 114688, 0, 0, 218104032, 1
    .long 2, 64, 72, 7168, 2816, 2816, 7340032, 3145728, 32768, 8, 65581056, 114688, 0, 0, 218104208, 1
    .long 1, 80, 80, 2048, 5505024, 5505280, 7340032, 63787008, 114688, 7, 182976512, 32768, 218104176, 7, 218106688, 1
    .long 0, 0, 0, 0, 0, 0, 0, 0, 0, 0, 0, 0, 0, 0, 0, 0
    .long 0, 0, 0, 0, 0, 0, 0, 0, 0, 0, 0, 0, 0, 0, 0, 0
    .long 6, 32, 32, 8192, 1280, 263424, 8388608, 0, 32768, 4, 37769216, 131072, 0, 0, 218104336, 1
    .long 4, 32, 32, 8192, 1280, 263424, 8388608, 262144, 32768, 4, 38817792, 131072, 0, 0, 218104464, 1
    .long 4, 16, 16, 8192, 1280, 263424, 8388608, 524288, 32768, 4, 6311936, 131072, 0, 0, 218104592, 1
    .long 1, 16, 16, 8192, 512, 768, 8388608, 1572864, 32768, 8, 10493952, 131072, 0, 0, 218105088, 4
    .long 2, 64, 72, 7168, 5120, 5120, 7340032, 0, 32768, 8, 54607872, 114688, 0, 0, 218103840, 1
    .long 2, 64, 72, 7168, 4096, 4096, 7340032, 1572864, 32768, 8, 60096512, 114688, 0, 0, 218104032, 1
    .long 2, 64, 72, 7168, 3072, 3072, 7340032, 3145728, 32768, 8, 65585152, 114688, 0, 0, 218104208, 1
    .long 1, 80, 80, 2048, 512, 768, 7340032, 63700992, 114688, 7, 170401792, 32768, 218104128, 7, 218106688, 1
    .long 0, 0, 0, 0, 0, 0, 0, 0, 0, 0, 0, 0, 0, 0, 0, 0
    .long 0, 0, 0, 0, 0, 0, 0, 0, 0, 0, 0, 0, 0, 0, 0, 0
    .long 6, 32, 32, 8192, 3328, 265472, 8388608, 0, 32768, 4, 37801984, 131072, 0, 0, 218104368, 1
    .long 4, 32, 32, 8192, 3328, 265472, 8388608, 262144, 32768, 4, 38850560, 131072, 0, 0, 218104496, 1
    .long 4, 16, 16, 8192, 3328, 265472, 8388608, 524288, 32768, 4, 6344704, 131072, 0, 0, 218104624, 1
    .long 1, 16, 16, 8192, 2560, 2816, 8388608, 1572864, 32768, 8, 10526720, 131072, 0, 0, 218105120, 4
    .long 2, 64, 72, 7168, 5376, 5376, 7340032, 0, 32768, 8, 54611968, 114688, 0, 0, 218103856, 1
    .long 2, 64, 72, 7168, 4352, 4352, 7340032, 1572864, 32768, 8, 60100608, 114688, 0, 0, 218104032, 1
    .long 2, 64, 72, 7168, 3328, 3328, 7340032, 3145728, 32768, 8, 65589248, 114688, 0, 0, 218104208, 1
    .long 1, 80, 80, 2048, 1835520, 1835776, 7340032, 63729664, 114688, 7, 174596096, 32768, 218104144, 7, 218106688, 1
    .long 0, 0, 0, 0, 0, 0, 0, 0, 0, 0, 0, 0, 0, 0, 0, 0
    .long 0, 0, 0, 0, 0, 0, 0, 0, 0, 0, 0, 0, 0, 0, 0, 0
    .long 6, 32, 32, 8192, 5376, 267520, 8388608, 0, 32768, 4, 37834752, 131072, 0, 0, 218104400, 1
    .long 4, 32, 32, 8192, 5376, 267520, 8388608, 262144, 32768, 4, 38883328, 131072, 0, 0, 218104528, 1
    .long 4, 16, 16, 8192, 5376, 267520, 8388608, 524288, 32768, 4, 6377472, 131072, 0, 0, 218104656, 1
    .long 1, 16, 16, 8192, 4608, 4864, 8388608, 1572864, 32768, 8, 10559488, 131072, 0, 0, 218105152, 4
    .long 2, 64, 72, 7168, 5632, 5632, 7340032, 0, 32768, 8, 54616064, 114688, 0, 0, 218103856, 1
    .long 2, 64, 72, 7168, 4608, 4608, 7340032, 1572864, 32768, 8, 60104704, 114688, 0, 0, 218104032, 1
    .long 2, 64, 72, 7168, 3584, 3584, 7340032, 3145728, 32768, 8, 65593344, 114688, 0, 0, 218104224, 1
    .long 1, 80, 80, 2048, 3670528, 3670784, 7340032, 63758336, 114688, 7, 178790400, 32768, 218104160, 7, 218106688, 1
    .long 0, 0, 0, 0, 0, 0, 0, 0, 0, 0, 0, 0, 0, 0, 0, 0
    .long 0, 0, 0, 0, 0, 0, 0, 0, 0, 0, 0, 0, 0, 0, 0, 0
    .long 6, 32, 32, 8192, 7424, 269568, 8388608, 0, 32768, 4, 37867520, 131072, 0, 0, 218104432, 1
    .long 4, 32, 32, 8192, 7424, 269568, 8388608, 262144, 32768, 4, 38916096, 131072, 0, 0, 218104560, 1
    .long 4, 16, 16, 8192, 7424, 269568, 8388608, 524288, 32768, 4, 6410240, 131072, 0, 0, 218104688, 1
    .long 1, 16, 16, 8192, 6656, 6912, 8388608, 1572864, 32768, 8, 10592256, 131072, 0, 0, 218105184, 4
    .long 2, 64, 72, 7168, 5888, 5888, 7340032, 0, 32768, 8, 54620160, 114688, 0, 0, 218103856, 1
    .long 2, 64, 72, 7168, 4864, 4864, 7340032, 1572864, 32768, 8, 60108800, 114688, 0, 0, 218104032, 1
    .long 2, 64, 72, 7168, 3840, 3840, 7340032, 3145728, 32768, 8, 65597440, 114688, 0, 0, 218104224, 1
    .long 1, 80, 80, 2048, 5505536, 5505792, 7340032, 63787008, 114688, 7, 182984704, 32768, 218104176, 7, 218106688, 1
    .long 0, 0, 0, 0, 0, 0, 0, 0, 0, 0, 0, 0, 0, 0, 0, 0
    .long 0, 0, 0, 0, 0, 0, 0, 0, 0, 0, 0, 0, 0, 0, 0, 0
    .long 6, 32, 32, 8192, 1536, 263680, 8388608, 0, 32768, 4, 37773312, 131072, 0, 0, 218104336, 1
    .long 4, 32, 32, 8192, 1536, 263680, 8388608, 262144, 32768, 4, 38821888, 131072, 0, 0, 218104464, 1
    .long 4, 16, 16, 8192, 1024, 263168, 8388608, 786432, 32768, 4, 7356416, 131072, 0, 0, 218104592, 1
    .long 1, 16, 16, 8192, 1024, 1280, 8388608, 1572864, 32768, 8, 10502144, 131072, 0, 0, 218105104, 4
    .long 2, 64, 72, 7168, 6144, 6144, 7340032, 0, 32768, 8, 54624256, 114688, 0, 0, 218103856, 1
    .long 2, 64, 72, 7168, 5120, 5120, 7340032, 1572864, 32768, 8, 60112896, 114688, 0, 0, 218104032, 1
    .long 2, 64, 72, 7168, 4096, 4096, 7340032, 3145728, 32768, 8, 65601536, 114688, 0, 0, 218104224, 1
    .long 1, 80, 80, 2048, 1024, 1280, 7340032, 63700992, 114688, 7, 170409984, 32768, 218104128, 7, 218106688, 1
    .long 0, 0, 0, 0, 0, 0, 0, 0, 0, 0, 0, 0, 0, 0, 0, 0
    .long 0, 0, 0, 0, 0, 0, 0, 0, 0, 0, 0, 0, 0, 0, 0, 0
    .long 6, 32, 32, 8192, 3584, 265728, 8388608, 0, 32768, 4, 37806080, 131072, 0, 0, 218104368, 1
    .long 4, 32, 32, 8192, 3584, 265728, 8388608, 262144, 32768, 4, 38854656, 131072, 0, 0, 218104496, 1
    .long 4, 16, 16, 8192, 3072, 265216, 8388608, 786432, 32768, 4, 7389184, 131072, 0, 0, 218104624, 1
    .long 1, 16, 16, 8192, 3072, 3328, 8388608, 1572864, 32768, 8, 10534912, 131072, 0, 0, 218105136, 4
    .long 2, 64, 72, 7168, 6400, 6400, 7340032, 0, 32768, 8, 54628352, 114688, 0, 0, 218103856, 1
    .long 2, 64, 72, 7168, 5376, 5376, 7340032, 1572864, 32768, 8, 60116992, 114688, 0, 0, 218104048, 1
    .long 2, 64, 72, 7168, 4352, 4352, 7340032, 3145728, 32768, 8, 65605632, 114688, 0, 0, 218104224, 1
    .long 1, 80, 80, 2048, 1836032, 1836288, 7340032, 63729664, 114688, 7, 174604288, 32768, 218104144, 7, 218106688, 1
    .long 0, 0, 0, 0, 0, 0, 0, 0, 0, 0, 0, 0, 0, 0, 0, 0
    .long 0, 0, 0, 0, 0, 0, 0, 0, 0, 0, 0, 0, 0, 0, 0, 0
    .long 6, 32, 32, 8192, 5632, 267776, 8388608, 0, 32768, 4, 37838848, 131072, 0, 0, 218104400, 1
    .long 4, 32, 32, 8192, 5632, 267776, 8388608, 262144, 32768, 4, 38887424, 131072, 0, 0, 218104528, 1
    .long 4, 16, 16, 8192, 5120, 267264, 8388608, 786432, 32768, 4, 7421952, 131072, 0, 0, 218104656, 1
    .long 1, 16, 16, 8192, 5120, 5376, 8388608, 1572864, 32768, 8, 10567680, 131072, 0, 0, 218105168, 4
    .long 2, 64, 72, 7168, 6656, 6656, 7340032, 0, 32768, 8, 54632448, 114688, 0, 0, 218103856, 1
    .long 2, 64, 72, 7168, 5632, 5632, 7340032, 1572864, 32768, 8, 60121088, 114688, 0, 0, 218104048, 1
    .long 2, 64, 72, 7168, 4608, 4608, 7340032, 3145728, 32768, 8, 65609728, 114688, 0, 0, 218104224, 1
    .long 1, 80, 80, 2048, 3671040, 3671296, 7340032, 63758336, 114688, 7, 178798592, 32768, 218104160, 7, 218106688, 1
    .long 0, 0, 0, 0, 0, 0, 0, 0, 0, 0, 0, 0, 0, 0, 0, 0
    .long 0, 0, 0, 0, 0, 0, 0, 0, 0, 0, 0, 0, 0, 0, 0, 0
    .long 6, 32, 32, 8192, 7680, 269824, 8388608, 0, 32768, 4, 37871616, 131072, 0, 0, 218104432, 1
    .long 4, 32, 32, 8192, 7680, 269824, 8388608, 262144, 32768, 4, 38920192, 131072, 0, 0, 218104560, 1
    .long 4, 16, 16, 8192, 7168, 269312, 8388608, 786432, 32768, 4, 7454720, 131072, 0, 0, 218104688, 1
    .long 1, 16, 16, 8192, 7168, 7424, 8388608, 1572864, 32768, 8, 10600448, 131072, 0, 0, 218105200, 4
    .long 2, 64, 72, 7168, 6912, 6912, 7340032, 0, 32768, 8, 54636544, 114688, 0, 0, 218103856, 1
    .long 2, 64, 72, 7168, 5888, 5888, 7340032, 1572864, 32768, 8, 60125184, 114688, 0, 0, 218104048, 1
    .long 2, 64, 72, 7168, 4864, 4864, 7340032, 3145728, 32768, 8, 65613824, 114688, 0, 0, 218104224, 1
    .long 1, 80, 80, 2048, 5506048, 5506304, 7340032, 63787008, 114688, 7, 182992896, 32768, 218104176, 7, 218106688, 1
    .long 0, 0, 0, 0, 0, 0, 0, 0, 0, 0, 0, 0, 0, 0, 0, 0
    .long 0, 0, 0, 0, 0, 0, 0, 0, 0, 0, 0, 0, 0, 0, 0, 0
    .long 6, 32, 32, 8192, 1792, 263936, 8388608, 0, 32768, 4, 37777408, 131072, 0, 0, 218104336, 1
    .long 4, 32, 32, 8192, 1792, 263936, 8388608, 262144, 32768, 4, 38825984, 131072, 0, 0, 218104464, 1
    .long 4, 16, 16, 8192, 1024, 263168, 8388608, 524288, 32768, 4, 6307840, 131072, 0, 0, 218104592, 1
    .long 1, 16, 16, 8192, 1536, 1792, 8388608, 1572864, 32768, 8, 10510336, 131072, 0, 0, 218105104, 4
    .long 2, 64, 72, 7168, 0, 0, 7340032, 524288, 32768, 8, 56360960, 114688, 0, 0, 218103872, 1
    .long 2, 64, 72, 7168, 6144, 6144, 7340032, 1572864, 32768, 8, 60129280, 114688, 0, 0, 218104048, 1
    .long 2, 64, 72, 7168, 5120, 5120, 7340032, 3145728, 32768, 8, 65617920, 114688, 0, 0, 218104224, 1
    .long 1, 80, 80, 2048, 1536, 1792, 7340032, 63700992, 114688, 7, 170418176, 32768, 218104128, 7, 218106688, 1
    .long 0, 0, 0, 0, 0, 0, 0, 0, 0, 0, 0, 0, 0, 0, 0, 0
    .long 0, 0, 0, 0, 0, 0, 0, 0, 0, 0, 0, 0, 0, 0, 0, 0
    .long 6, 32, 32, 8192, 3840, 265984, 8388608, 0, 32768, 4, 37810176, 131072, 0, 0, 218104368, 1
    .long 4, 32, 32, 8192, 3840, 265984, 8388608, 262144, 32768, 4, 38858752, 131072, 0, 0, 218104496, 1
    .long 4, 16, 16, 8192, 3072, 265216, 8388608, 524288, 32768, 4, 6340608, 131072, 0, 0, 218104624, 1
    .long 1, 16, 16, 8192, 3584, 3840, 8388608, 1572864, 32768, 8, 10543104, 131072, 0, 0, 218105136, 4
    .long 2, 64, 72, 7168, 256, 256, 7340032, 524288, 32768, 8, 56365056, 114688, 0, 0, 218103872, 1
    .long 2, 64, 72, 7168, 6400, 6400, 7340032, 1572864, 32768, 8, 60133376, 114688, 0, 0, 218104048, 1
    .long 2, 64, 72, 7168, 5376, 5376, 7340032, 3145728, 32768, 8, 65622016, 114688, 0, 0, 218104240, 1
    .long 1, 80, 80, 2048, 1836544, 1836800, 7340032, 63729664, 114688, 7, 174612480, 32768, 218104144, 7, 218106688, 1
    .long 0, 0, 0, 0, 0, 0, 0, 0, 0, 0, 0, 0, 0, 0, 0, 0
    .long 0, 0, 0, 0, 0, 0, 0, 0, 0, 0, 0, 0, 0, 0, 0, 0
    .long 6, 32, 32, 8192, 5888, 268032, 8388608, 0, 32768, 4, 37842944, 131072, 0, 0, 218104400, 1
    .long 4, 32, 32, 8192, 5888, 268032, 8388608, 262144, 32768, 4, 38891520, 131072, 0, 0, 218104528, 1
    .long 4, 16, 16, 8192, 5120, 267264, 8388608, 524288, 32768, 4, 6373376, 131072, 0, 0, 218104656, 1
    .long 1, 16, 16, 8192, 5632, 5888, 8388608, 1572864, 32768, 8, 10575872, 131072, 0, 0, 218105168, 4
    .long 2, 64, 72, 7168, 512, 512, 7340032, 524288, 32768, 8, 56369152, 114688, 0, 0, 218103872, 1
    .long 2, 64, 72, 7168, 6656, 6656, 7340032, 1572864, 32768, 8, 60137472, 114688, 0, 0, 218104048, 1
    .long 2, 64, 72, 7168, 5632, 5632, 7340032, 3145728, 32768, 8, 65626112, 114688, 0, 0, 218104240, 1
    .long 1, 80, 80, 2048, 3671552, 3671808, 7340032, 63758336, 114688, 7, 178806784, 32768, 218104160, 7, 218106688, 1
    .long 0, 0, 0, 0, 0, 0, 0, 0, 0, 0, 0, 0, 0, 0, 0, 0
    .long 0, 0, 0, 0, 0, 0, 0, 0, 0, 0, 0, 0, 0, 0, 0, 0
    .long 6, 32, 32, 8192, 7936, 270080, 8388608, 0, 32768, 4, 37875712, 131072, 0, 0, 218104432, 1
    .long 4, 32, 32, 8192, 7936, 270080, 8388608, 262144, 32768, 4, 38924288, 131072, 0, 0, 218104560, 1
    .long 4, 16, 16, 8192, 7168, 269312, 8388608, 524288, 32768, 4, 6406144, 131072, 0, 0, 218104688, 1
    .long 1, 16, 16, 8192, 7680, 7936, 8388608, 1572864, 32768, 8, 10608640, 131072, 0, 0, 218105200, 4
    .long 2, 64, 72, 7168, 768, 768, 7340032, 524288, 32768, 8, 56373248, 114688, 0, 0, 218103872, 1
    .long 2, 64, 72, 7168, 6912, 6912, 7340032, 1572864, 32768, 8, 60141568, 114688, 0, 0, 218104048, 1
    .long 2, 64, 72, 7168, 5888, 5888, 7340032, 3145728, 32768, 8, 65630208, 114688, 0, 0, 218104240, 1
    .long 1, 80, 80, 2048, 5506560, 5506816, 7340032, 63787008, 114688, 7, 183001088, 32768, 218104176, 7, 218106688, 1
    .long 0, 0, 0, 0, 0, 0, 0, 0, 0, 0, 0, 0, 0, 0, 0, 0
    .long 0, 0, 0, 0, 0, 0, 0, 0, 0, 0, 0, 0, 0, 0, 0, 0
    .long 6, 16, 16, 8192, 0, 262144, 8388608, 0, 32768, 4, 4194304, 131072, 0, 0, 218104320, 1
    .long 4, 16, 16, 8192, 0, 262144, 8388608, 262144, 32768, 4, 5242880, 131072, 0, 0, 218104448, 1
    .long 4, 16, 16, 8192, 0, 262144, 8388608, 524288, 32768, 4, 6291456, 131072, 0, 0, 218104576, 1
    .long 1, 32, 32, 8192, 0, 256, 8388608, 2097152, 32768, 8, 46137344, 131072, 0, 0, 218105344, 4
    .long 2, 64, 72, 7168, 1024, 1024, 7340032, 524288, 32768, 8, 56377344, 114688, 0, 0, 218103872, 1
    .long 2, 64, 72, 7168, 0, 0, 7340032, 2097152, 32768, 8, 61865984, 114688, 0, 0, 218104064, 1
    .long 2, 64, 72, 7168, 6144, 6144, 7340032, 3145728, 32768, 8, 65634304, 114688, 0, 0, 218104240, 1
    .long 1, 80, 80, 2048, 0, 256, 7340032, 65536000, 114688, 7, 170917888, 32768, 218104192, 7, 218106752, 1
    .long 0, 0, 0, 0, 0, 0, 0, 0, 0, 0, 0, 0, 0, 0, 0, 0
    .long 0, 0, 0, 0, 0, 0, 0, 0, 0, 0, 0, 0, 0, 0, 0, 0
    .long 6, 16, 16, 8192, 2048, 264192, 8388608, 0, 32768, 4, 4227072, 131072, 0, 0, 218104352, 1
    .long 4, 16, 16, 8192, 2048, 264192, 8388608, 262144, 32768, 4, 5275648, 131072, 0, 0, 218104480, 1
    .long 4, 16, 16, 8192, 2048, 264192, 8388608, 524288, 32768, 4, 6324224, 131072, 0, 0, 218104608, 1
    .long 1, 32, 32, 8192, 2048, 2304, 8388608, 2097152, 32768, 8, 46170112, 131072, 0, 0, 218105376, 4
    .long 2, 64, 72, 7168, 1280, 1280, 7340032, 524288, 32768, 8, 56381440, 114688, 0, 0, 218103872, 1
    .long 2, 64, 72, 7168, 256, 256, 7340032, 2097152, 32768, 8, 61870080, 114688, 0, 0, 218104064, 1
    .long 2, 64, 72, 7168, 6400, 6400, 7340032, 3145728, 32768, 8, 65638400, 114688, 0, 0, 218104240, 1
    .long 1, 80, 80, 2048, 1835008, 1835264, 7340032, 65564672, 114688, 7, 175112192, 32768, 218104208, 7, 218106752, 1
    .long 0, 0, 0, 0, 0, 0, 0, 0, 0, 0, 0, 0, 0, 0, 0, 0
    .long 0, 0, 0, 0, 0, 0, 0, 0, 0, 0, 0, 0, 0, 0, 0, 0
    .long 6, 16, 16, 8192, 4096, 266240, 8388608, 0, 32768, 4, 4259840, 131072, 0, 0, 218104384, 1
    .long 4, 16, 16, 8192, 4096, 266240, 8388608, 262144, 32768, 4, 5308416, 131072, 0, 0, 218104512, 1
    .long 4, 16, 16, 8192, 4096, 266240, 8388608, 524288, 32768, 4, 6356992, 131072, 0, 0, 218104640, 1
    .long 1, 32, 32, 8192, 4096, 4352, 8388608, 2097152, 32768, 8, 46202880, 131072, 0, 0, 218105408, 4
    .long 2, 64, 72, 7168, 1536, 1536, 7340032, 524288, 32768, 8, 56385536, 114688, 0, 0, 218103872, 1
    .long 2, 64, 72, 7168, 512, 512, 7340032, 2097152, 32768, 8, 61874176, 114688, 0, 0, 218104064, 1
    .long 2, 64, 72, 7168, 6656, 6656, 7340032, 3145728, 32768, 8, 65642496, 114688, 0, 0, 218104240, 1
    .long 1, 80, 80, 2048, 3670016, 3670272, 7340032, 65593344, 114688, 7, 179306496, 32768, 218104224, 7, 218106752, 1
    .long 0, 0, 0, 0, 0, 0, 0, 0, 0, 0, 0, 0, 0, 0, 0, 0
    .long 0, 0, 0, 0, 0, 0, 0, 0, 0, 0, 0, 0, 0, 0, 0, 0
    .long 6, 16, 16, 8192, 6144, 268288, 8388608, 0, 32768, 4, 4292608, 131072, 0, 0, 218104416, 1
    .long 4, 16, 16, 8192, 6144, 268288, 8388608, 262144, 32768, 4, 5341184, 131072, 0, 0, 218104544, 1
    .long 4, 16, 16, 8192, 6144, 268288, 8388608, 524288, 32768, 4, 6389760, 131072, 0, 0, 218104672, 1
    .long 1, 32, 32, 8192, 6144, 6400, 8388608, 2097152, 32768, 8, 46235648, 131072, 0, 0, 218105440, 4
    .long 2, 64, 72, 7168, 1792, 1792, 7340032, 524288, 32768, 8, 56389632, 114688, 0, 0, 218103888, 1
    .long 2, 64, 72, 7168, 768, 768, 7340032, 2097152, 32768, 8, 61878272, 114688, 0, 0, 218104064, 1
    .long 2, 64, 72, 7168, 6912, 6912, 7340032, 3145728, 32768, 8, 65646592, 114688, 0, 0, 218104240, 1
    .long 1, 80, 80, 2048, 5505024, 5505280, 7340032, 65622016, 114688, 7, 183500800, 32768, 218104240, 7, 218106752, 1
    .long 0, 0, 0, 0, 0, 0, 0, 0, 0, 0, 0, 0, 0, 0, 0, 0
    .long 0, 0, 0, 0, 0, 0, 0, 0, 0, 0, 0, 0, 0, 0, 0, 0
    .long 6, 16, 16, 8192, 256, 262400, 8388608, 0, 32768, 4, 4198400, 131072, 0, 0, 218104320, 1
    .long 4, 16, 16, 8192, 256, 262400, 8388608, 262144, 32768, 4, 5246976, 131072, 0, 0, 218104448, 1
    .long 4, 16, 16, 8192, 256, 262400, 8388608, 524288, 32768, 4, 6295552, 131072, 0, 0, 218104576, 1
    .long 1, 32, 32, 8192, 512, 768, 8388608, 2097152, 32768, 8, 46145536, 131072, 0, 0, 218105344, 4
    .long 2, 64, 72, 7168, 2048, 2048, 7340032, 524288, 32768, 8, 56393728, 114688, 0, 0, 218103888, 1
    .long 2, 64, 72, 7168, 1024, 1024, 7340032, 2097152, 32768, 8, 61882368, 114688, 0, 0, 218104064, 1
    .long 2, 64, 72, 7168, 0, 0, 7340032, 3670016, 32768, 8, 67371008, 114688, 0, 0, 218104256, 1
    .long 1, 80, 80, 2048, 512, 768, 7340032, 65536000, 114688, 7, 170926080, 32768, 218104192, 7, 218106752, 1
    .long 0, 0, 0, 0, 0, 0, 0, 0, 0, 0, 0, 0, 0, 0, 0, 0
    .long 0, 0, 0, 0, 0, 0, 0, 0, 0, 0, 0, 0, 0, 0, 0, 0
    .long 6, 16, 16, 8192, 2304, 264448, 8388608, 0, 32768, 4, 4231168, 131072, 0, 0, 218104352, 1
    .long 4, 16, 16, 8192, 2304, 264448, 8388608, 262144, 32768, 4, 5279744, 131072, 0, 0, 218104480, 1
    .long 4, 16, 16, 8192, 2304, 264448, 8388608, 524288, 32768, 4, 6328320, 131072, 0, 0, 218104608, 1
    .long 1, 32, 32, 8192, 2560, 2816, 8388608, 2097152, 32768, 8, 46178304, 131072, 0, 0, 218105376, 4
    .long 2, 64, 72, 7168, 2304, 2304, 7340032, 524288, 32768, 8, 56397824, 114688, 0, 0, 218103888, 1
    .long 2, 64, 72, 7168, 1280, 1280, 7340032, 2097152, 32768, 8, 61886464, 114688, 0, 0, 218104064, 1
    .long 2, 64, 72, 7168, 256, 256, 7340032, 3670016, 32768, 8, 67375104, 114688, 0, 0, 218104256, 1
    .long 1, 80, 80, 2048, 1835520, 1835776, 7340032, 65564672, 114688, 7, 175120384, 32768, 218104208, 7, 218106752, 1
    .long 0, 0, 0, 0, 0, 0, 0, 0, 0, 0, 0, 0, 0, 0, 0, 0
    .long 0, 0, 0, 0, 0, 0, 0, 0, 0, 0, 0, 0, 0, 0, 0, 0
    .long 6, 16, 16, 8192, 4352, 266496, 8388608, 0, 32768, 4, 4263936, 131072, 0, 0, 218104384, 1
    .long 4, 16, 16, 8192, 4352, 266496, 8388608, 262144, 32768, 4, 5312512, 131072, 0, 0, 218104512, 1
    .long 4, 16, 16, 8192, 4352, 266496, 8388608, 524288, 32768, 4, 6361088, 131072, 0, 0, 218104640, 1
    .long 1, 32, 32, 8192, 4608, 4864, 8388608, 2097152, 32768, 8, 46211072, 131072, 0, 0, 218105408, 4
    .long 2, 64, 72, 7168, 2560, 2560, 7340032, 524288, 32768, 8, 56401920, 114688, 0, 0, 218103888, 1
    .long 2, 64, 72, 7168, 1536, 1536, 7340032, 2097152, 32768, 8, 61890560, 114688, 0, 0, 218104064, 1
    .long 2, 64, 72, 7168, 512, 512, 7340032, 3670016, 32768, 8, 67379200, 114688, 0, 0, 218104256, 1
    .long 1, 80, 80, 2048, 3670528, 3670784, 7340032, 65593344, 114688, 7, 179314688, 32768, 218104224, 7, 218106752, 1
    .long 0, 0, 0, 0, 0, 0, 0, 0, 0, 0, 0, 0, 0, 0, 0, 0
    .long 0, 0, 0, 0, 0, 0, 0, 0, 0, 0, 0, 0, 0, 0, 0, 0
    .long 6, 16, 16, 8192, 6400, 268544, 8388608, 0, 32768, 4, 4296704, 131072, 0, 0, 218104416, 1
    .long 4, 16, 16, 8192, 6400, 268544, 8388608, 262144, 32768, 4, 5345280, 131072, 0, 0, 218104544, 1
    .long 4, 16, 16, 8192, 6400, 268544, 8388608, 524288, 32768, 4, 6393856, 131072, 0, 0, 218104672, 1
    .long 1, 32, 32, 8192, 6656, 6912, 8388608, 2097152, 32768, 8, 46243840, 131072, 0, 0, 218105440, 4
    .long 2, 64, 72, 7168, 2816, 2816, 7340032, 524288, 32768, 8, 56406016, 114688, 0, 0, 218103888, 1
    .long 2, 64, 72, 7168, 1792, 1792, 7340032, 2097152, 32768, 8, 61894656, 114688, 0, 0, 218104080, 1
    .long 2, 64, 72, 7168, 768, 768, 7340032, 3670016, 32768, 8, 67383296, 114688, 0, 0, 218104256, 1
    .long 1, 80, 80, 2048, 5505536, 5505792, 7340032, 65622016, 114688, 7, 183508992, 32768, 218104240, 7, 218106752, 1
    .long 0, 0, 0, 0, 0, 0, 0, 0, 0, 0, 0, 0, 0, 0, 0, 0
    .long 0, 0, 0, 0, 0, 0, 0, 0, 0, 0, 0, 0, 0, 0, 0, 0
    .long 6, 16, 16, 8192, 512, 262656, 8388608, 0, 32768, 4, 4202496, 131072, 0, 0, 218104320, 1
    .long 4, 16, 16, 8192, 512, 262656, 8388608, 262144, 32768, 4, 5251072, 131072, 0, 0, 218104448, 1
    .long 4, 16, 16, 8192, 512, 262656, 8388608, 524288, 32768, 4, 6299648, 131072, 0, 0, 218104576, 1
    .long 1, 32, 32, 8192, 1024, 1280, 8388608, 2097152, 32768, 8, 46153728, 131072, 0, 0, 218105360, 4
    .long 2, 64, 72, 7168, 3072, 3072, 7340032, 524288, 32768, 8, 56410112, 114688, 0, 0, 218103888, 1
    .long 2, 64, 72, 7168, 2048, 2048, 7340032, 2097152, 32768, 8, 61898752, 114688, 0, 0, 218104080, 1
    .long 2, 64, 72, 7168, 1024, 1024, 7340032, 3670016, 32768, 8, 67387392, 114688, 0, 0, 218104256, 1
    .long 1, 80, 80, 2048, 1024, 1280, 7340032, 65536000, 114688, 7, 170934272, 32768, 218104192, 7, 218106752, 1
    .long 0, 0, 0, 0, 0, 0, 0, 0, 0, 0, 0, 0, 0, 0, 0, 0
    .long 0, 0, 0, 0, 0, 0, 0, 0, 0, 0, 0, 0, 0, 0, 0, 0
    .long 6, 16, 16, 8192, 2560, 264704, 8388608, 0, 32768, 4, 4235264, 131072, 0, 0, 218104352, 1
    .long 4, 16, 16, 8192, 2560, 264704, 8388608, 262144, 32768, 4, 5283840, 131072, 0, 0, 218104480, 1
    .long 4, 16, 16, 8192, 2560, 264704, 8388608, 524288, 32768, 4, 6332416, 131072, 0, 0, 218104608, 1
    .long 1, 32, 32, 8192, 3072, 3328, 8388608, 2097152, 32768, 8, 46186496, 131072, 0, 0, 218105392, 4
    .long 2, 64, 72, 7168, 3328, 3328, 7340032, 524288, 32768, 8, 56414208, 114688, 0, 0, 218103888, 1
    .long 2, 64, 72, 7168, 2304, 2304, 7340032, 2097152, 32768, 8, 61902848, 114688, 0, 0, 218104080, 1
    .long 2, 64, 72, 7168, 1280, 1280, 7340032, 3670016, 32768, 8, 67391488, 114688, 0, 0, 218104256, 1
    .long 1, 80, 80, 2048, 1836032, 1836288, 7340032, 65564672, 114688, 7, 175128576, 32768, 218104208, 7, 218106752, 1
    .long 0, 0, 0, 0, 0, 0, 0, 0, 0, 0, 0, 0, 0, 0, 0, 0
    .long 0, 0, 0, 0, 0, 0, 0, 0, 0, 0, 0, 0, 0, 0, 0, 0
    .long 6, 16, 16, 8192, 4608, 266752, 8388608, 0, 32768, 4, 4268032, 131072, 0, 0, 218104384, 1
    .long 4, 16, 16, 8192, 4608, 266752, 8388608, 262144, 32768, 4, 5316608, 131072, 0, 0, 218104512, 1
    .long 4, 16, 16, 8192, 4608, 266752, 8388608, 524288, 32768, 4, 6365184, 131072, 0, 0, 218104640, 1
    .long 1, 32, 32, 8192, 5120, 5376, 8388608, 2097152, 32768, 8, 46219264, 131072, 0, 0, 218105424, 4
    .long 2, 64, 72, 7168, 3584, 3584, 7340032, 524288, 32768, 8, 56418304, 114688, 0, 0, 218103904, 1
    .long 2, 64, 72, 7168, 2560, 2560, 7340032, 2097152, 32768, 8, 61906944, 114688, 0, 0, 218104080, 1
    .long 2, 64, 72, 7168, 1536, 1536, 7340032, 3670016, 32768, 8, 67395584, 114688, 0, 0, 218104256, 1
    .long 1, 80, 80, 2048, 3671040, 3671296, 7340032, 65593344, 114688, 7, 179322880, 32768, 218104224, 7, 218106752, 1
    .long 0, 0, 0, 0, 0, 0, 0, 0, 0, 0, 0, 0, 0, 0, 0, 0
    .long 0, 0, 0, 0, 0, 0, 0, 0, 0, 0, 0, 0, 0, 0, 0, 0
    .long 6, 16, 16, 8192, 6656, 268800, 8388608, 0, 32768, 4, 4300800, 131072, 0, 0, 218104416, 1
    .long 4, 16, 16, 8192, 6656, 268800, 8388608, 262144, 32768, 4, 5349376, 131072, 0, 0, 218104544, 1
    .long 4, 16, 16, 8192, 6656, 268800, 8388608, 524288, 32768, 4, 6397952, 131072, 0, 0, 218104672, 1
    .long 1, 32, 32, 8192, 7168, 7424, 8388608, 2097152, 32768, 8, 46252032, 131072, 0, 0, 218105456, 4
    .long 2, 64, 72, 7168, 3840, 3840, 7340032, 524288, 32768, 8, 56422400, 114688, 0, 0, 218103904, 1
    .long 2, 64, 72, 7168, 2816, 2816, 7340032, 2097152, 32768, 8, 61911040, 114688, 0, 0, 218104080, 1
    .long 2, 64, 72, 7168, 1792, 1792, 7340032, 3670016, 32768, 8, 67399680, 114688, 0, 0, 218104272, 1
    .long 1, 80, 80, 2048, 5506048, 5506304, 7340032, 65622016, 114688, 7, 183517184, 32768, 218104240, 7, 218106752, 1
    .long 0, 0, 0, 0, 0, 0, 0, 0, 0, 0, 0, 0, 0, 0, 0, 0
    .long 0, 0, 0, 0, 0, 0, 0, 0, 0, 0, 0, 0, 0, 0, 0, 0
    .long 6, 16, 16, 8192, 768, 262912, 8388608, 0, 32768, 4, 4206592, 131072, 0, 0, 218104320, 1
    .long 4, 16, 16, 8192, 768, 262912, 8388608, 262144, 32768, 4, 5255168, 131072, 0, 0, 218104448, 1
    .long 4, 16, 16, 8192, 768, 262912, 8388608, 524288, 32768, 4, 6303744, 131072, 0, 0, 218104576, 1
    .long 1, 32, 32, 8192, 1536, 1792, 8388608, 2097152, 32768, 8, 46161920, 131072, 0, 0, 218105360, 4
    .long 2, 64, 72, 7168, 4096, 4096, 7340032, 524288, 32768, 8, 56426496, 114688, 0, 0, 218103904, 1
    .long 2, 64, 72, 7168, 3072, 3072, 7340032, 2097152, 32768, 8, 61915136, 114688, 0, 0, 218104080, 1
    .long 2, 64, 72, 7168, 2048, 2048, 7340032, 3670016, 32768, 8, 67403776, 114688, 0, 0, 218104272, 1
    .long 1, 80, 80, 2048, 1536, 1792, 7340032, 65536000, 114688, 7, 170942464, 32768, 218104192, 7, 218106752, 1
    .long 0, 0, 0, 0, 0, 0, 0, 0, 0, 0, 0, 0, 0, 0, 0, 0
    .long 0, 0, 0, 0, 0, 0, 0, 0, 0, 0, 0, 0, 0, 0, 0, 0
    .long 6, 16, 16, 8192, 2816, 264960, 8388608, 0, 32768, 4, 4239360, 131072, 0, 0, 218104352, 1
    .long 4, 16, 16, 8192, 2816, 264960, 8388608, 262144, 32768, 4, 5287936, 131072, 0, 0, 218104480, 1
    .long 4, 16, 16, 8192, 2816, 264960, 8388608, 524288, 32768, 4, 6336512, 131072, 0, 0, 218104608, 1
    .long 1, 32, 32, 8192, 3584, 3840, 8388608, 2097152, 32768, 8, 46194688, 131072, 0, 0, 218105392, 4
    .long 2, 64, 72, 7168, 4352, 4352, 7340032, 524288, 32768, 8, 56430592, 114688, 0, 0, 218103904, 1
    .long 2, 64, 72, 7168, 3328, 3328, 7340032, 2097152, 32768, 8, 61919232, 114688, 0, 0, 218104080, 1
    .long 2, 64, 72, 7168, 2304, 2304, 7340032, 3670016, 32768, 8, 67407872, 114688, 0, 0, 218104272, 1
    .long 1, 80, 80, 2048, 1836544, 1836800, 7340032, 65564672, 114688, 7, 175136768, 32768, 218104208, 7, 218106752, 1
    .long 0, 0, 0, 0, 0, 0, 0, 0, 0, 0, 0, 0, 0, 0, 0, 0
    .long 0, 0, 0, 0, 0, 0, 0, 0, 0, 0, 0, 0, 0, 0, 0, 0
    .long 6, 16, 16, 8192, 4864, 267008, 8388608, 0, 32768, 4, 4272128, 131072, 0, 0, 218104384, 1
    .long 4, 16, 16, 8192, 4864, 267008, 8388608, 262144, 32768, 4, 5320704, 131072, 0, 0, 218104512, 1
    .long 4, 16, 16, 8192, 4864, 267008, 8388608, 524288, 32768, 4, 6369280, 131072, 0, 0, 218104640, 1
    .long 1, 32, 32, 8192, 5632, 5888, 8388608, 2097152, 32768, 8, 46227456, 131072, 0, 0, 218105424, 4
    .long 2, 64, 72, 7168, 4608, 4608, 7340032, 524288, 32768, 8, 56434688, 114688, 0, 0, 218103904, 1
    .long 2, 64, 72, 7168, 3584, 3584, 7340032, 2097152, 32768, 8, 61923328, 114688, 0, 0, 218104096, 1
    .long 2, 64, 72, 7168, 2560, 2560, 7340032, 3670016, 32768, 8, 67411968, 114688, 0, 0, 218104272, 1
    .long 1, 80, 80, 2048, 3671552, 3671808, 7340032, 65593344, 114688, 7, 179331072, 32768, 218104224, 7, 218106752, 1
    .long 0, 0, 0, 0, 0, 0, 0, 0, 0, 0, 0, 0, 0, 0, 0, 0
    .long 0, 0, 0, 0, 0, 0, 0, 0, 0, 0, 0, 0, 0, 0, 0, 0
    .long 6, 16, 16, 8192, 6912, 269056, 8388608, 0, 32768, 4, 4304896, 131072, 0, 0, 218104416, 1
    .long 4, 16, 16, 8192, 6912, 269056, 8388608, 262144, 32768, 4, 5353472, 131072, 0, 0, 218104544, 1
    .long 4, 16, 16, 8192, 6912, 269056, 8388608, 524288, 32768, 4, 6402048, 131072, 0, 0, 218104672, 1
    .long 1, 32, 32, 8192, 7680, 7936, 8388608, 2097152, 32768, 8, 46260224, 131072, 0, 0, 218105456, 4
    .long 2, 64, 72, 7168, 4864, 4864, 7340032, 524288, 32768, 8, 56438784, 114688, 0, 0, 218103904, 1
    .long 2, 64, 72, 7168, 3840, 3840, 7340032, 2097152, 32768, 8, 61927424, 114688, 0, 0, 218104096, 1
    .long 2, 64, 72, 7168, 2816, 2816, 7340032, 3670016, 32768, 8, 67416064, 114688, 0, 0, 218104272, 1
    .long 1, 80, 80, 2048, 5506560, 5506816, 7340032, 65622016, 114688, 7, 183525376, 32768, 218104240, 7, 218106752, 1
    .long 0, 0, 0, 0, 0, 0, 0, 0, 0, 0, 0, 0, 0, 0, 0, 0
    .long 0, 0, 0, 0, 0, 0, 0, 0, 0, 0, 0, 0, 0, 0, 0, 0
    .long 6, 16, 16, 8192, 1024, 263168, 8388608, 0, 32768, 4, 4210688, 131072, 0, 0, 218104336, 1
    .long 4, 16, 16, 8192, 1024, 263168, 8388608, 262144, 32768, 4, 5259264, 131072, 0, 0, 218104464, 1
    .long 4, 16, 16, 8192, 768, 262912, 8388608, 786432, 32768, 4, 7352320, 131072, 0, 0, 218104576, 1
    .long 1, 24, 24, 8192, 0, 256, 8388608, 2097152, 32768, 8, 29360128, 131072, 0, 0, 218105344, 4
    .long 2, 64, 72, 7168, 5120, 5120, 7340032, 524288, 32768, 8, 56442880, 114688, 0, 0, 218103904, 1
    .long 2, 64, 72, 7168, 4096, 4096, 7340032, 2097152, 32768, 8, 61931520, 114688, 0, 0, 218104096, 1
    .long 2, 64, 72, 7168, 3072, 3072, 7340032, 3670016, 32768, 8, 67420160, 114688, 0, 0, 218104272, 1
    .long 1, 80, 80, 2048, 0, 256, 7340032, 67371008, 114688, 7, 171442176, 32768, 218104256, 7, 218106816, 1
    .long 0, 0, 0, 0, 0, 0, 0, 0, 0, 0, 0, 0, 0, 0, 0, 0
    .long 0, 0, 0, 0, 0, 0, 0, 0, 0, 0, 0, 0, 0, 0, 0, 0
    .long 6, 16, 16, 8192, 3072, 265216, 8388608, 0, 32768, 4, 4243456, 131072, 0, 0, 218104368, 1
    .long 4, 16, 16, 8192, 3072, 265216, 8388608, 262144, 32768, 4, 5292032, 131072, 0, 0, 218104496, 1
    .long 4, 16, 16, 8192, 2816, 264960, 8388608, 786432, 32768, 4, 7385088, 131072, 0, 0, 218104608, 1
    .long 1, 24, 24, 8192, 2048, 2304, 8388608, 2097152, 32768, 8, 29392896, 131072, 0, 0, 218105376, 4
    .long 2, 64, 72, 7168, 5376, 5376, 7340032, 524288, 32768, 8, 56446976, 114688, 0, 0, 218103920, 1
    .long 2, 64, 72, 7168, 4352, 4352, 7340032, 2097152, 32768, 8, 61935616, 114688, 0, 0, 218104096, 1
    .long 2, 64, 72, 7168, 3328, 3328, 7340032, 3670016, 32768, 8, 67424256, 114688, 0, 0, 218104272, 1
    .long 1, 80, 80, 2048, 1835008, 1835264, 7340032, 67399680, 114688, 7, 175636480, 32768, 218104272, 7, 218106816, 1
    .long 0, 0, 0, 0, 0, 0, 0, 0, 0, 0, 0, 0, 0, 0, 0, 0
    .long 0, 0, 0, 0, 0, 0, 0, 0, 0, 0, 0, 0, 0, 0, 0, 0
    .long 6, 16, 16, 8192, 5120, 267264, 8388608, 0, 32768, 4, 4276224, 131072, 0, 0, 218104400, 1
    .long 4, 16, 16, 8192, 5120, 267264, 8388608, 262144, 32768, 4, 5324800, 131072, 0, 0, 218104528, 1
    .long 4, 16, 16, 8192, 4864, 267008, 8388608, 786432, 32768, 4, 7417856, 131072, 0, 0, 218104640, 1
    .long 1, 24, 24, 8192, 4096, 4352, 8388608, 2097152, 32768, 8, 29425664, 131072, 0, 0, 218105408, 4
    .long 2, 64, 72, 7168, 5632, 5632, 7340032, 524288, 32768, 8, 56451072, 114688, 0, 0, 218103920, 1
    .long 2, 64, 72, 7168, 4608, 4608, 7340032, 2097152, 32768, 8, 61939712, 114688, 0, 0, 218104096, 1
    .long 2, 64, 72, 7168, 3584, 3584, 7340032, 3670016, 32768, 8, 67428352, 114688, 0, 0, 218104288, 1
    .long 1, 80, 80, 2048, 3670016, 3670272, 7340032, 67428352, 114688, 7, 179830784, 32768, 218104288, 7, 218106816, 1
    .long 0, 0, 0, 0, 0, 0, 0, 0, 0, 0, 0, 0, 0, 0, 0, 0
    .long 0, 0, 0, 0, 0, 0, 0, 0, 0, 0, 0, 0, 0, 0, 0, 0
    .long 6, 16, 16, 8192, 7168, 269312, 8388608, 0, 32768, 4, 4308992, 131072, 0, 0, 218104432, 1
    .long 4, 16, 16, 8192, 7168, 269312, 8388608, 262144, 32768, 4, 5357568, 131072, 0, 0, 218104560, 1
    .long 4, 16, 16, 8192, 6912, 269056, 8388608, 786432, 32768, 4, 7450624, 131072, 0, 0, 218104672, 1
    .long 1, 24, 24, 8192, 6144, 6400, 8388608, 2097152, 32768, 8, 29458432, 131072, 0, 0, 218105440, 4
    .long 2, 64, 72, 7168, 5888, 5888, 7340032, 524288, 32768, 8, 56455168, 114688, 0, 0, 218103920, 1
    .long 2, 64, 72, 7168, 4864, 4864, 7340032, 2097152, 32768, 8, 61943808, 114688, 0, 0, 218104096, 1
    .long 2, 64, 72, 7168, 3840, 3840, 7340032, 3670016, 32768, 8, 67432448, 114688, 0, 0, 218104288, 1
    .long 1, 80, 80, 2048, 5505024, 5505280, 7340032, 67457024, 114688, 7, 184025088, 32768, 218104304, 7, 218106816, 1
    .long 0, 0, 0, 0, 0, 0, 0, 0, 0, 0, 0, 0, 0, 0, 0, 0
    .long 0, 0, 0, 0, 0, 0, 0, 0, 0, 0, 0, 0, 0, 0, 0, 0
    .long 6, 16, 16, 8192, 1280, 263424, 8388608, 0, 32768, 4, 4214784, 131072, 0, 0, 218104336, 1
    .long 4, 16, 16, 8192, 1280, 263424, 8388608, 262144, 32768, 4, 5263360, 131072, 0, 0, 218104464, 1
    .long 4, 16, 16, 8192, 512, 262656, 8388608, 786432, 32768, 4, 7348224, 131072, 0, 0, 218104576, 1
    .long 1, 24, 24, 8192, 512, 768, 8388608, 2097152, 32768, 8, 29368320, 131072, 0, 0, 218105344, 4
    .long 2, 64, 72, 7168, 6144, 6144, 7340032, 524288, 32768, 8, 56459264, 114688, 0, 0, 218103920, 1
    .long 2, 64, 72, 7168, 5120, 5120, 7340032, 2097152, 32768, 8, 61947904, 114688, 0, 0, 218104096, 1
    .long 2, 64, 72, 7168, 4096, 4096, 7340032, 3670016, 32768, 8, 67436544, 114688, 0, 0, 218104288, 1
    .long 1, 80, 80, 2048, 512, 768, 7340032, 67371008, 114688, 7, 171450368, 32768, 218104256, 7, 218106816, 1
    .long 0, 0, 0, 0, 0, 0, 0, 0, 0, 0, 0, 0, 0, 0, 0, 0
    .long 0, 0, 0, 0, 0, 0, 0, 0, 0, 0, 0, 0, 0, 0, 0, 0
    .long 6, 16, 16, 8192, 3328, 265472, 8388608, 0, 32768, 4, 4247552, 131072, 0, 0, 218104368, 1
    .long 4, 16, 16, 8192, 3328, 265472, 8388608, 262144, 32768, 4, 5296128, 131072, 0, 0, 218104496, 1
    .long 4, 16, 16, 8192, 2560, 264704, 8388608, 786432, 32768, 4, 7380992, 131072, 0, 0, 218104608, 1
    .long 1, 24, 24, 8192, 2560, 2816, 8388608, 2097152, 32768, 8, 29401088, 131072, 0, 0, 218105376, 4
    .long 2, 64, 72, 7168, 6400, 6400, 7340032, 524288, 32768, 8, 56463360, 114688, 0, 0, 218103920, 1
    .long 2, 64, 72, 7168, 5376, 5376, 7340032, 2097152, 32768, 8, 61952000, 114688, 0, 0, 218104112, 1
    .long 2, 64, 72, 7168, 4352, 4352, 7340032, 3670016, 32768, 8, 67440640, 114688, 0, 0, 218104288, 1
    .long 1, 80, 80, 2048, 1835520, 1835776, 7340032, 67399680, 114688, 7, 175644672, 32768, 218104272, 7, 218106816, 1
    .long 0, 0, 0, 0, 0, 0, 0, 0, 0, 0, 0, 0, 0, 0, 0, 0
    .long 0, 0, 0, 0, 0, 0, 0, 0, 0, 0, 0, 0, 0, 0, 0, 0
    .long 6, 16, 16, 8192, 5376, 267520, 8388608, 0, 32768, 4, 4280320, 131072, 0, 0, 218104400, 1
    .long 4, 16, 16, 8192, 5376, 267520, 8388608, 262144, 32768, 4, 5328896, 131072, 0, 0, 218104528, 1
    .long 4, 16, 16, 8192, 4608, 266752, 8388608, 786432, 32768, 4, 7413760, 131072, 0, 0, 218104640, 1
    .long 1, 24, 24, 8192, 4608, 4864, 8388608, 2097152, 32768, 8, 29433856, 131072, 0, 0, 218105408, 4
    .long 2, 64, 72, 7168, 6656, 6656, 7340032, 524288, 32768, 8, 56467456, 114688, 0, 0, 218103920, 1
    .long 2, 64, 72, 7168, 5632, 5632, 7340032, 2097152, 32768, 8, 61956096, 114688, 0, 0, 218104112, 1
    .long 2, 64, 72, 7168, 4608, 4608, 7340032, 3670016, 32768, 8, 67444736, 114688, 0, 0, 218104288, 1
    .long 1, 80, 80, 2048, 3670528, 3670784, 7340032, 67428352, 114688, 7, 179838976, 32768, 218104288, 7, 218106816, 1
    .long 0, 0, 0, 0, 0, 0, 0, 0, 0, 0, 0, 0, 0, 0, 0, 0
    .long 0, 0, 0, 0, 0, 0, 0, 0, 0, 0, 0, 0, 0, 0, 0, 0
    .long 6, 16, 16, 8192, 7424, 269568, 8388608, 0, 32768, 4, 4313088, 131072, 0, 0, 218104432, 1
    .long 4, 16, 16, 8192, 7424, 269568, 8388608, 262144, 32768, 4, 5361664, 131072, 0, 0, 218104560, 1
    .long 4, 16, 16, 8192, 6656, 268800, 8388608, 786432, 32768, 4, 7446528, 131072, 0, 0, 218104672, 1
    .long 1, 24, 24, 8192, 6656, 6912, 8388608, 2097152, 32768, 8, 29466624, 131072, 0, 0, 218105440, 4
    .long 2, 64, 72, 7168, 6912, 6912, 7340032, 524288, 32768, 8, 56471552, 114688, 0, 0, 218103920, 1
    .long 2, 64, 72, 7168, 5888, 5888, 7340032, 2097152, 32768, 8, 61960192, 114688, 0, 0, 218104112, 1
    .long 2, 64, 72, 7168, 4864, 4864, 7340032, 3670016, 32768, 8, 67448832, 114688, 0, 0, 218104288, 1
    .long 1, 80, 80, 2048, 5505536, 5505792, 7340032, 67457024, 114688, 7, 184033280, 32768, 218104304, 7, 218106816, 1
    .long 0, 0, 0, 0, 0, 0, 0, 0, 0, 0, 0, 0, 0, 0, 0, 0
    .long 0, 0, 0, 0, 0, 0, 0, 0, 0, 0, 0, 0, 0, 0, 0, 0
    .long 6, 16, 16, 8192, 1536, 263680, 8388608, 0, 32768, 4, 4218880, 131072, 0, 0, 218104336, 1
    .long 4, 16, 16, 8192, 1536, 263680, 8388608, 262144, 32768, 4, 5267456, 131072, 0, 0, 218104464, 1
    .long 4, 16, 16, 8192, 256, 262400, 8388608, 786432, 32768, 4, 7344128, 131072, 0, 0, 218104576, 1
    .long 1, 24, 24, 8192, 1024, 1280, 8388608, 2097152, 32768, 8, 29376512, 131072, 0, 0, 218105360, 4
    .long 2, 64, 72, 7168, 0, 0, 7340032, 1048576, 32768, 8, 58195968, 114688, 0, 0, 218103936, 1
    .long 2, 64, 72, 7168, 6144, 6144, 7340032, 2097152, 32768, 8, 61964288, 114688, 0, 0, 218104112, 1
    .long 2, 64, 72, 7168, 5120, 5120, 7340032, 3670016, 32768, 8, 67452928, 114688, 0, 0, 218104288, 1
    .long 1, 80, 80, 2048, 1024, 1280, 7340032, 67371008, 114688, 7, 171458560, 32768, 218104256, 7, 218106816, 1
    .long 0, 0, 0, 0, 0, 0, 0, 0, 0, 0, 0, 0, 0, 0, 0, 0
    .long 0, 0, 0, 0, 0, 0, 0, 0, 0, 0, 0, 0, 0, 0, 0, 0
    .long 6, 16, 16, 8192, 3584, 265728, 8388608, 0, 32768, 4, 4251648, 131072, 0, 0, 218104368, 1
    .long 4, 16, 16, 8192, 3584, 265728, 8388608, 262144, 32768, 4, 5300224, 131072, 0, 0, 218104496, 1
    .long 4, 16, 16, 8192, 2304, 264448, 8388608, 786432, 32768, 4, 7376896, 131072, 0, 0, 218104608, 1
    .long 1, 24, 24, 8192, 3072, 3328, 8388608, 2097152, 32768, 8, 29409280, 131072, 0, 0, 218105392, 4
    .long 2, 64, 72, 7168, 256, 256, 7340032, 1048576, 32768, 8, 58200064, 114688, 0, 0, 218103936, 1
    .long 2, 64, 72, 7168, 6400, 6400, 7340032, 2097152, 32768, 8, 61968384, 114688, 0, 0, 218104112, 1
    .long 2, 64, 72, 7168, 5376, 5376, 7340032, 3670016, 32768, 8, 67457024, 114688, 0, 0, 218104304, 1
    .long 1, 80, 80, 2048, 1836032, 1836288, 7340032, 67399680, 114688, 7, 175652864, 32768, 218104272, 7, 218106816, 1
    .long 0, 0, 0, 0, 0, 0, 0, 0, 0, 0, 0, 0, 0, 0, 0, 0
    .long 0, 0, 0, 0, 0, 0, 0, 0, 0, 0, 0, 0, 0, 0, 0, 0
    .long 6, 16, 16, 8192, 5632, 267776, 8388608, 0, 32768, 4, 4284416, 131072, 0, 0, 218104400, 1
    .long 4, 16, 16, 8192, 5632, 267776, 8388608, 262144, 32768, 4, 5332992, 131072, 0, 0, 218104528, 1
    .long 4, 16, 16, 8192, 4352, 266496, 8388608, 786432, 32768, 4, 7409664, 131072, 0, 0, 218104640, 1
    .long 1, 24, 24, 8192, 5120, 5376, 8388608, 2097152, 32768, 8, 29442048, 131072, 0, 0, 218105424, 4
    .long 2, 64, 72, 7168, 512, 512, 7340032, 1048576, 32768, 8, 58204160, 114688, 0, 0, 218103936, 1
    .long 2, 64, 72, 7168, 6656, 6656, 7340032, 2097152, 32768, 8, 61972480, 114688, 0, 0, 218104112, 1
    .long 2, 64, 72, 7168, 5632, 5632, 7340032, 3670016, 32768, 8, 67461120, 114688, 0, 0, 218104304, 1
    .long 1, 80, 80, 2048, 3671040, 3671296, 7340032, 67428352, 114688, 7, 179847168, 32768, 218104288, 7, 218106816, 1
    .long 0, 0, 0, 0, 0, 0, 0, 0, 0, 0, 0, 0, 0, 0, 0, 0
    .long 0, 0, 0, 0, 0, 0, 0, 0, 0, 0, 0, 0, 0, 0, 0, 0
    .long 6, 16, 16, 8192, 7680, 269824, 8388608, 0, 32768, 4, 4317184, 131072, 0, 0, 218104432, 1
    .long 4, 16, 16, 8192, 7680, 269824, 8388608, 262144, 32768, 4, 5365760, 131072, 0, 0, 218104560, 1
    .long 4, 16, 16, 8192, 6400, 268544, 8388608, 786432, 32768, 4, 7442432, 131072, 0, 0, 218104672, 1
    .long 1, 24, 24, 8192, 7168, 7424, 8388608, 2097152, 32768, 8, 29474816, 131072, 0, 0, 218105456, 4
    .long 2, 64, 72, 7168, 768, 768, 7340032, 1048576, 32768, 8, 58208256, 114688, 0, 0, 218103936, 1
    .long 2, 64, 72, 7168, 6912, 6912, 7340032, 2097152, 32768, 8, 61976576, 114688, 0, 0, 218104112, 1
    .long 2, 64, 72, 7168, 5888, 5888, 7340032, 3670016, 32768, 8, 67465216, 114688, 0, 0, 218104304, 1
    .long 1, 80, 80, 2048, 5506048, 5506304, 7340032, 67457024, 114688, 7, 184041472, 32768, 218104304, 7, 218106816, 1
    .long 0, 0, 0, 0, 0, 0, 0, 0, 0, 0, 0, 0, 0, 0, 0, 0
    .long 0, 0, 0, 0, 0, 0, 0, 0, 0, 0, 0, 0, 0, 0, 0, 0
    .long 6, 16, 16, 8192, 1792, 263936, 8388608, 0, 32768, 4, 4222976, 131072, 0, 0, 218104336, 1
    .long 4, 16, 16, 8192, 1792, 263936, 8388608, 262144, 32768, 4, 5271552, 131072, 0, 0, 218104464, 1
    .long 4, 16, 16, 8192, 0, 262144, 8388608, 786432, 32768, 4, 7340032, 131072, 0, 0, 218104576, 1
    .long 1, 24, 24, 8192, 1536, 1792, 8388608, 2097152, 32768, 8, 29384704, 131072, 0, 0, 218105360, 4
    .long 2, 64, 72, 7168, 1024, 1024, 7340032, 1048576, 32768, 8, 58212352, 114688, 0, 0, 218103936, 1
    .long 2, 64, 72, 7168, 0, 0, 7340032, 2621440, 32768, 8, 63700992, 114688, 0, 0, 218104128, 1
    .long 2, 64, 72, 7168, 6144, 6144, 7340032, 3670016, 32768, 8, 67469312, 114688, 0, 0, 218104304, 1
    .long 1, 80, 80, 2048, 1536, 1792, 7340032, 67371008, 114688, 7, 171466752, 32768, 218104256, 7, 218106816, 1
    .long 0, 0, 0, 0, 0, 0, 0, 0, 0, 0, 0, 0, 0, 0, 0, 0
    .long 0, 0, 0, 0, 0, 0, 0, 0, 0, 0, 0, 0, 0, 0, 0, 0
    .long 6, 16, 16, 8192, 3840, 265984, 8388608, 0, 32768, 4, 4255744, 131072, 0, 0, 218104368, 1
    .long 4, 16, 16, 8192, 3840, 265984, 8388608, 262144, 32768, 4, 5304320, 131072, 0, 0, 218104496, 1
    .long 4, 16, 16, 8192, 2048, 264192, 8388608, 786432, 32768, 4, 7372800, 131072, 0, 0, 218104608, 1
    .long 1, 24, 24, 8192, 3584, 3840, 8388608, 2097152, 32768, 8, 29417472, 131072, 0, 0, 218105392, 4
    .long 2, 64, 72, 7168, 1280, 1280, 7340032, 1048576, 32768, 8, 58216448, 114688, 0, 0, 218103936, 1
    .long 2, 64, 72, 7168, 256, 256, 7340032, 2621440, 32768, 8, 63705088, 114688, 0, 0, 218104128, 1
    .long 2, 64, 72, 7168, 6400, 6400, 7340032, 3670016, 32768, 8, 67473408, 114688, 0, 0, 218104304, 1
    .long 1, 80, 80, 2048, 1836544, 1836800, 7340032, 67399680, 114688, 7, 175661056, 32768, 218104272, 7, 218106816, 1
    .long 0, 0, 0, 0, 0, 0, 0, 0, 0, 0, 0, 0, 0, 0, 0, 0
    .long 0, 0, 0, 0, 0, 0, 0, 0, 0, 0, 0, 0, 0, 0, 0, 0
    .long 6, 16, 16, 8192, 5888, 268032, 8388608, 0, 32768, 4, 4288512, 131072, 0, 0, 218104400, 1
    .long 4, 16, 16, 8192, 5888, 268032, 8388608, 262144, 32768, 4, 5337088, 131072, 0, 0, 218104528, 1
    .long 4, 16, 16, 8192, 4096, 266240, 8388608, 786432, 32768, 4, 7405568, 131072, 0, 0, 218104640, 1
    .long 1, 24, 24, 8192, 5632, 5888, 8388608, 2097152, 32768, 8, 29450240, 131072, 0, 0, 218105424, 4
    .long 2, 64, 72, 7168, 1536, 1536, 7340032, 1048576, 32768, 8, 58220544, 114688, 0, 0, 218103936, 1
    .long 2, 64, 72, 7168, 512, 512, 7340032, 2621440, 32768, 8, 63709184, 114688, 0, 0, 218104128, 1
    .long 2, 64, 72, 7168, 6656, 6656, 7340032, 3670016, 32768, 8, 67477504, 114688, 0, 0, 218104304, 1
    .long 1, 80, 80, 2048, 3671552, 3671808, 7340032, 67428352, 114688, 7, 179855360, 32768, 218104288, 7, 218106816, 1
    .long 0, 0, 0, 0, 0, 0, 0, 0, 0, 0, 0, 0, 0, 0, 0, 0
    .long 0, 0, 0, 0, 0, 0, 0, 0, 0, 0, 0, 0, 0, 0, 0, 0
    .long 6, 16, 16, 8192, 7936, 270080, 8388608, 0, 32768, 4, 4321280, 131072, 0, 0, 218104432, 1
    .long 4, 16, 16, 8192, 7936, 270080, 8388608, 262144, 32768, 4, 5369856, 131072, 0, 0, 218104560, 1
    .long 4, 16, 16, 8192, 6144, 268288, 8388608, 786432, 32768, 4, 7438336, 131072, 0, 0, 218104672, 1
    .long 1, 24, 24, 8192, 7680, 7936, 8388608, 2097152, 32768, 8, 29483008, 131072, 0, 0, 218105456, 4
    .long 2, 64, 72, 7168, 1792, 1792, 7340032, 1048576, 32768, 8, 58224640, 114688, 0, 0, 218103952, 1
    .long 2, 64, 72, 7168, 768, 768, 7340032, 2621440, 32768, 8, 63713280, 114688, 0, 0, 218104128, 1
    .long 2, 64, 72, 7168, 6912, 6912, 7340032, 3670016, 32768, 8, 67481600, 114688, 0, 0, 218104304, 1
    .long 1, 80, 80, 2048, 5506560, 5506816, 7340032, 67457024, 114688, 7, 184049664, 32768, 218104304, 7, 218106816, 1
    .long 0, 0, 0, 0, 0, 0, 0, 0, 0, 0, 0, 0, 0, 0, 0, 0
    .long 0, 0, 0, 0, 0, 0, 0, 0, 0, 0, 0, 0, 0, 0, 0, 0
    .long 1, 32, 32, 8192, 0, 256, 8388608, 524288, 32768, 8, 39845888, 131072, 0, 0, 218104576, 4
    .long 1, 16, 16, 8192, 0, 256, 8388608, 1048576, 32768, 8, 8388608, 131072, 0, 0, 218104832, 4
    .long 1, 24, 24, 8192, 0, 256, 8388608, 2621440, 32768, 8, 31457280, 131072, 0, 0, 218105600, 4
    .long 1, 16, 16, 8192, 0, 256, 8388608, 3145728, 32768, 8, 16777216, 131072, 0, 0, 218105856, 4
    .long 1, 16, 16, 8192, 0, 256, 8388608, 3670016, 32768, 8, 18874368, 131072, 0, 0, 218106112, 4
    .long 1, 80, 80, 2048, 0, 256, 7340032, 58195968, 114688, 7, 168820736, 32768, 218103936, 7, 218106496, 1
    .long 0, 0, 0, 0, 0, 0, 0, 0, 0, 0, 0, 0, 0, 0, 0, 0
    .long 0, 0, 0, 0, 0, 0, 0, 0, 0, 0, 0, 0, 0, 0, 0, 0
    .long 0, 0, 0, 0, 0, 0, 0, 0, 0, 0, 0, 0, 0, 0, 0, 0
    .long 0, 0, 0, 0, 0, 0, 0, 0, 0, 0, 0, 0, 0, 0, 0, 0
    .long 1, 32, 32, 8192, 2048, 2304, 8388608, 524288, 32768, 8, 39878656, 131072, 0, 0, 218104608, 4
    .long 1, 16, 16, 8192, 2048, 2304, 8388608, 1048576, 32768, 8, 8421376, 131072, 0, 0, 218104864, 4
    .long 1, 24, 24, 8192, 2048, 2304, 8388608, 2621440, 32768, 8, 31490048, 131072, 0, 0, 218105632, 4
    .long 1, 16, 16, 8192, 2048, 2304, 8388608, 3145728, 32768, 8, 16809984, 131072, 0, 0, 218105888, 4
    .long 1, 16, 16, 8192, 2048, 2304, 8388608, 3670016, 32768, 8, 18907136, 131072, 0, 0, 218106144, 4
    .long 1, 80, 80, 2048, 1835008, 1835264, 7340032, 58224640, 114688, 7, 173015040, 32768, 218103952, 7, 218106496, 1
    .long 0, 0, 0, 0, 0, 0, 0, 0, 0, 0, 0, 0, 0, 0, 0, 0
    .long 0, 0, 0, 0, 0, 0, 0, 0, 0, 0, 0, 0, 0, 0, 0, 0
    .long 0, 0, 0, 0, 0, 0, 0, 0, 0, 0, 0, 0, 0, 0, 0, 0
    .long 0, 0, 0, 0, 0, 0, 0, 0, 0, 0, 0, 0, 0, 0, 0, 0
    .long 1, 32, 32, 8192, 4096, 4352, 8388608, 524288, 32768, 8, 39911424, 131072, 0, 0, 218104640, 4
    .long 1, 16, 16, 8192, 4096, 4352, 8388608, 1048576, 32768, 8, 8454144, 131072, 0, 0, 218104896, 4
    .long 1, 24, 24, 8192, 4096, 4352, 8388608, 2621440, 32768, 8, 31522816, 131072, 0, 0, 218105664, 4
    .long 1, 16, 16, 8192, 4096, 4352, 8388608, 3145728, 32768, 8, 16842752, 131072, 0, 0, 218105920, 4
    .long 1, 16, 16, 8192, 4096, 4352, 8388608, 3670016, 32768, 8, 18939904, 131072, 0, 0, 218106176, 4
    .long 1, 80, 80, 2048, 3670016, 3670272, 7340032, 58253312, 114688, 7, 177209344, 32768, 218103968, 7, 218106496, 1
    .long 0, 0, 0, 0, 0, 0, 0, 0, 0, 0, 0, 0, 0, 0, 0, 0
    .long 0, 0, 0, 0, 0, 0, 0, 0, 0, 0, 0, 0, 0, 0, 0, 0
    .long 0, 0, 0, 0, 0, 0, 0, 0, 0, 0, 0, 0, 0, 0, 0, 0
    .long 0, 0, 0, 0, 0, 0, 0, 0, 0, 0, 0, 0, 0, 0, 0, 0
    .long 1, 32, 32, 8192, 6144, 6400, 8388608, 524288, 32768, 8, 39944192, 131072, 0, 0, 218104672, 4
    .long 1, 16, 16, 8192, 6144, 6400, 8388608, 1048576, 32768, 8, 8486912, 131072, 0, 0, 218104928, 4
    .long 1, 24, 24, 8192, 6144, 6400, 8388608, 2621440, 32768, 8, 31555584, 131072, 0, 0, 218105696, 4
    .long 1, 16, 16, 8192, 6144, 6400, 8388608, 3145728, 32768, 8, 16875520, 131072, 0, 0, 218105952, 4
    .long 1, 16, 16, 8192, 6144, 6400, 8388608, 3670016, 32768, 8, 18972672, 131072, 0, 0, 218106208, 4
    .long 1, 80, 80, 2048, 5505024, 5505280, 7340032, 58281984, 114688, 7, 181403648, 32768, 218103984, 7, 218106496, 1
    .long 0, 0, 0, 0, 0, 0, 0, 0, 0, 0, 0, 0, 0, 0, 0, 0
    .long 0, 0, 0, 0, 0, 0, 0, 0, 0, 0, 0, 0, 0, 0, 0, 0
    .long 0, 0, 0, 0, 0, 0, 0, 0, 0, 0, 0, 0, 0, 0, 0, 0
    .long 0, 0, 0, 0, 0, 0, 0, 0, 0, 0, 0, 0, 0, 0, 0, 0
    .long 1, 32, 32, 8192, 512, 768, 8388608, 524288, 32768, 8, 39854080, 131072, 0, 0, 218104576, 4
    .long 1, 16, 16, 8192, 512, 768, 8388608, 1048576, 32768, 8, 8396800, 131072, 0, 0, 218104832, 4
    .long 1, 24, 24, 8192, 512, 768, 8388608, 2621440, 32768, 8, 31465472, 131072, 0, 0, 218105600, 4
    .long 1, 16, 16, 8192, 512, 768, 8388608, 3145728, 32768, 8, 16785408, 131072, 0, 0, 218105856, 4
    .long 1, 16, 16, 8192, 512, 768, 8388608, 3670016, 32768, 8, 18882560, 131072, 0, 0, 218106112, 4
    .long 1, 80, 80, 2048, 512, 768, 7340032, 58195968, 114688, 7, 168828928, 32768, 218103936, 7, 218106496, 1
    .long 0, 0, 0, 0, 0, 0, 0, 0, 0, 0, 0, 0, 0, 0, 0, 0
    .long 0, 0, 0, 0, 0, 0, 0, 0, 0, 0, 0, 0, 0, 0, 0, 0
    .long 0, 0, 0, 0, 0, 0, 0, 0, 0, 0, 0, 0, 0, 0, 0, 0
    .long 0, 0, 0, 0, 0, 0, 0, 0, 0, 0, 0, 0, 0, 0, 0, 0
    .long 1, 32, 32, 8192, 2560, 2816, 8388608, 524288, 32768, 8, 39886848, 131072, 0, 0, 218104608, 4
    .long 1, 16, 16, 8192, 2560, 2816, 8388608, 1048576, 32768, 8, 8429568, 131072, 0, 0, 218104864, 4
    .long 1, 24, 24, 8192, 2560, 2816, 8388608, 2621440, 32768, 8, 31498240, 131072, 0, 0, 218105632, 4
    .long 1, 16, 16, 8192, 2560, 2816, 8388608, 3145728, 32768, 8, 16818176, 131072, 0, 0, 218105888, 4
    .long 1, 16, 16, 8192, 2560, 2816, 8388608, 3670016, 32768, 8, 18915328, 131072, 0, 0, 218106144, 4
    .long 1, 80, 80, 2048, 1835520, 1835776, 7340032, 58224640, 114688, 7, 173023232, 32768, 218103952, 7, 218106496, 1
    .long 0, 0, 0, 0, 0, 0, 0, 0, 0, 0, 0, 0, 0, 0, 0, 0
    .long 0, 0, 0, 0, 0, 0, 0, 0, 0, 0, 0, 0, 0, 0, 0, 0
    .long 0, 0, 0, 0, 0, 0, 0, 0, 0, 0, 0, 0, 0, 0, 0, 0
    .long 0, 0, 0, 0, 0, 0, 0, 0, 0, 0, 0, 0, 0, 0, 0, 0
    .long 1, 32, 32, 8192, 4608, 4864, 8388608, 524288, 32768, 8, 39919616, 131072, 0, 0, 218104640, 4
    .long 1, 16, 16, 8192, 4608, 4864, 8388608, 1048576, 32768, 8, 8462336, 131072, 0, 0, 218104896, 4
    .long 1, 24, 24, 8192, 4608, 4864, 8388608, 2621440, 32768, 8, 31531008, 131072, 0, 0, 218105664, 4
    .long 1, 16, 16, 8192, 4608, 4864, 8388608, 3145728, 32768, 8, 16850944, 131072, 0, 0, 218105920, 4
    .long 1, 16, 16, 8192, 4608, 4864, 8388608, 3670016, 32768, 8, 18948096, 131072, 0, 0, 218106176, 4
    .long 1, 80, 80, 2048, 3670528, 3670784, 7340032, 58253312, 114688, 7, 177217536, 32768, 218103968, 7, 218106496, 1
    .long 0, 0, 0, 0, 0, 0, 0, 0, 0, 0, 0, 0, 0, 0, 0, 0
    .long 0, 0, 0, 0, 0, 0, 0, 0, 0, 0, 0, 0, 0, 0, 0, 0
    .long 0, 0, 0, 0, 0, 0, 0, 0, 0, 0, 0, 0, 0, 0, 0, 0
    .long 0, 0, 0, 0, 0, 0, 0, 0, 0, 0, 0, 0, 0, 0, 0, 0
    .long 1, 32, 32, 8192, 6656, 6912, 8388608, 524288, 32768, 8, 39952384, 131072, 0, 0, 218104672, 4
    .long 1, 16, 16, 8192, 6656, 6912, 8388608, 1048576, 32768, 8, 8495104, 131072, 0, 0, 218104928, 4
    .long 1, 24, 24, 8192, 6656, 6912, 8388608, 2621440, 32768, 8, 31563776, 131072, 0, 0, 218105696, 4
    .long 1, 16, 16, 8192, 6656, 6912, 8388608, 3145728, 32768, 8, 16883712, 131072, 0, 0, 218105952, 4
    .long 1, 16, 16, 8192, 6656, 6912, 8388608, 3670016, 32768, 8, 18980864, 131072, 0, 0, 218106208, 4
    .long 1, 80, 80, 2048, 5505536, 5505792, 7340032, 58281984, 114688, 7, 181411840, 32768, 218103984, 7, 218106496, 1
    .long 0, 0, 0, 0, 0, 0, 0, 0, 0, 0, 0, 0, 0, 0, 0, 0
    .long 0, 0, 0, 0, 0, 0, 0, 0, 0, 0, 0, 0, 0, 0, 0, 0
    .long 0, 0, 0, 0, 0, 0, 0, 0, 0, 0, 0, 0, 0, 0, 0, 0
    .long 0, 0, 0, 0, 0, 0, 0, 0, 0, 0, 0, 0, 0, 0, 0, 0
    .long 1, 32, 32, 8192, 1024, 1280, 8388608, 524288, 32768, 8, 39862272, 131072, 0, 0, 218104592, 4
    .long 1, 16, 16, 8192, 1024, 1280, 8388608, 1048576, 32768, 8, 8404992, 131072, 0, 0, 218104848, 4
    .long 1, 24, 24, 8192, 1024, 1280, 8388608, 2621440, 32768, 8, 31473664, 131072, 0, 0, 218105616, 4
    .long 1, 16, 16, 8192, 1024, 1280, 8388608, 3145728, 32768, 8, 16793600, 131072, 0, 0, 218105872, 4
    .long 1, 16, 16, 8192, 1024, 1280, 8388608, 3670016, 32768, 8, 18890752, 131072, 0, 0, 218106128, 4
    .long 1, 80, 80, 2048, 1024, 1280, 7340032, 58195968, 114688, 7, 168837120, 32768, 218103936, 7, 218106496, 1
    .long 0, 0, 0, 0, 0, 0, 0, 0, 0, 0, 0, 0, 0, 0, 0, 0
    .long 0, 0, 0, 0, 0, 0, 0, 0, 0, 0, 0, 0, 0, 0, 0, 0
    .long 0, 0, 0, 0, 0, 0, 0, 0, 0, 0, 0, 0, 0, 0, 0, 0
    .long 0, 0, 0, 0, 0, 0, 0, 0, 0, 0, 0, 0, 0, 0, 0, 0
    .long 1, 32, 32, 8192, 3072, 3328, 8388608, 524288, 32768, 8, 39895040, 131072, 0, 0, 218104624, 4
    .long 1, 16, 16, 8192, 3072, 3328, 8388608, 1048576, 32768, 8, 8437760, 131072, 0, 0, 218104880, 4
    .long 1, 24, 24, 8192, 3072, 3328, 8388608, 2621440, 32768, 8, 31506432, 131072, 0, 0, 218105648, 4
    .long 1, 16, 16, 8192, 3072, 3328, 8388608, 3145728, 32768, 8, 16826368, 131072, 0, 0, 218105904, 4
    .long 1, 16, 16, 8192, 3072, 3328, 8388608, 3670016, 32768, 8, 18923520, 131072, 0, 0, 218106160, 4
    .long 1, 80, 80, 2048, 1836032, 1836288, 7340032, 58224640, 114688, 7, 173031424, 32768, 218103952, 7, 218106496, 1
    .long 0, 0, 0, 0, 0, 0, 0, 0, 0, 0, 0, 0, 0, 0, 0, 0
    .long 0, 0, 0, 0, 0, 0, 0, 0, 0, 0, 0, 0, 0, 0, 0, 0
    .long 0, 0, 0, 0, 0, 0, 0, 0, 0, 0, 0, 0, 0, 0, 0, 0
    .long 0, 0, 0, 0, 0, 0, 0, 0, 0, 0, 0, 0, 0, 0, 0, 0
    .long 1, 32, 32, 8192, 5120, 5376, 8388608, 524288, 32768, 8, 39927808, 131072, 0, 0, 218104656, 4
    .long 1, 16, 16, 8192, 5120, 5376, 8388608, 1048576, 32768, 8, 8470528, 131072, 0, 0, 218104912, 4
    .long 1, 24, 24, 8192, 5120, 5376, 8388608, 2621440, 32768, 8, 31539200, 131072, 0, 0, 218105680, 4
    .long 1, 16, 16, 8192, 5120, 5376, 8388608, 3145728, 32768, 8, 16859136, 131072, 0, 0, 218105936, 4
    .long 1, 16, 16, 8192, 5120, 5376, 8388608, 3670016, 32768, 8, 18956288, 131072, 0, 0, 218106192, 4
    .long 1, 80, 80, 2048, 3671040, 3671296, 7340032, 58253312, 114688, 7, 177225728, 32768, 218103968, 7, 218106496, 1
    .long 0, 0, 0, 0, 0, 0, 0, 0, 0, 0, 0, 0, 0, 0, 0, 0
    .long 0, 0, 0, 0, 0, 0, 0, 0, 0, 0, 0, 0, 0, 0, 0, 0
    .long 0, 0, 0, 0, 0, 0, 0, 0, 0, 0, 0, 0, 0, 0, 0, 0
    .long 0, 0, 0, 0, 0, 0, 0, 0, 0, 0, 0, 0, 0, 0, 0, 0
    .long 1, 32, 32, 8192, 7168, 7424, 8388608, 524288, 32768, 8, 39960576, 131072, 0, 0, 218104688, 4
    .long 1, 16, 16, 8192, 7168, 7424, 8388608, 1048576, 32768, 8, 8503296, 131072, 0, 0, 218104944, 4
    .long 1, 24, 24, 8192, 7168, 7424, 8388608, 2621440, 32768, 8, 31571968, 131072, 0, 0, 218105712, 4
    .long 1, 16, 16, 8192, 7168, 7424, 8388608, 3145728, 32768, 8, 16891904, 131072, 0, 0, 218105968, 4
    .long 1, 16, 16, 8192, 7168, 7424, 8388608, 3670016, 32768, 8, 18989056, 131072, 0, 0, 218106224, 4
    .long 1, 80, 80, 2048, 5506048, 5506304, 7340032, 58281984, 114688, 7, 181420032, 32768, 218103984, 7, 218106496, 1
    .long 0, 0, 0, 0, 0, 0, 0, 0, 0, 0, 0, 0, 0, 0, 0, 0
    .long 0, 0, 0, 0, 0, 0, 0, 0, 0, 0, 0, 0, 0, 0, 0, 0
    .long 0, 0, 0, 0, 0, 0, 0, 0, 0, 0, 0, 0, 0, 0, 0, 0
    .long 0, 0, 0, 0, 0, 0, 0, 0, 0, 0, 0, 0, 0, 0, 0, 0
    .long 1, 32, 32, 8192, 1536, 1792, 8388608, 524288, 32768, 8, 39870464, 131072, 0, 0, 218104592, 4
    .long 1, 16, 16, 8192, 1536, 1792, 8388608, 1048576, 32768, 8, 8413184, 131072, 0, 0, 218104848, 4
    .long 1, 24, 24, 8192, 1536, 1792, 8388608, 2621440, 32768, 8, 31481856, 131072, 0, 0, 218105616, 4
    .long 1, 16, 16, 8192, 1536, 1792, 8388608, 3145728, 32768, 8, 16801792, 131072, 0, 0, 218105872, 4
    .long 1, 16, 16, 8192, 1536, 1792, 8388608, 3670016, 32768, 8, 18898944, 131072, 0, 0, 218106128, 4
    .long 1, 80, 80, 2048, 1536, 1792, 7340032, 58195968, 114688, 7, 168845312, 32768, 218103936, 7, 218106496, 1
    .long 0, 0, 0, 0, 0, 0, 0, 0, 0, 0, 0, 0, 0, 0, 0, 0
    .long 0, 0, 0, 0, 0, 0, 0, 0, 0, 0, 0, 0, 0, 0, 0, 0
    .long 0, 0, 0, 0, 0, 0, 0, 0, 0, 0, 0, 0, 0, 0, 0, 0
    .long 0, 0, 0, 0, 0, 0, 0, 0, 0, 0, 0, 0, 0, 0, 0, 0
    .long 1, 32, 32, 8192, 3584, 3840, 8388608, 524288, 32768, 8, 39903232, 131072, 0, 0, 218104624, 4
    .long 1, 16, 16, 8192, 3584, 3840, 8388608, 1048576, 32768, 8, 8445952, 131072, 0, 0, 218104880, 4
    .long 1, 24, 24, 8192, 3584, 3840, 8388608, 2621440, 32768, 8, 31514624, 131072, 0, 0, 218105648, 4
    .long 1, 16, 16, 8192, 3584, 3840, 8388608, 3145728, 32768, 8, 16834560, 131072, 0, 0, 218105904, 4
    .long 1, 16, 16, 8192, 3584, 3840, 8388608, 3670016, 32768, 8, 18931712, 131072, 0, 0, 218106160, 4
    .long 1, 80, 80, 2048, 1836544, 1836800, 7340032, 58224640, 114688, 7, 173039616, 32768, 218103952, 7, 218106496, 1
    .long 0, 0, 0, 0, 0, 0, 0, 0, 0, 0, 0, 0, 0, 0, 0, 0
    .long 0, 0, 0, 0, 0, 0, 0, 0, 0, 0, 0, 0, 0, 0, 0, 0
    .long 0, 0, 0, 0, 0, 0, 0, 0, 0, 0, 0, 0, 0, 0, 0, 0
    .long 0, 0, 0, 0, 0, 0, 0, 0, 0, 0, 0, 0, 0, 0, 0, 0
    .long 1, 32, 32, 8192, 5632, 5888, 8388608, 524288, 32768, 8, 39936000, 131072, 0, 0, 218104656, 4
    .long 1, 16, 16, 8192, 5632, 5888, 8388608, 1048576, 32768, 8, 8478720, 131072, 0, 0, 218104912, 4
    .long 1, 24, 24, 8192, 5632, 5888, 8388608, 2621440, 32768, 8, 31547392, 131072, 0, 0, 218105680, 4
    .long 1, 16, 16, 8192, 5632, 5888, 8388608, 3145728, 32768, 8, 16867328, 131072, 0, 0, 218105936, 4
    .long 1, 16, 16, 8192, 5632, 5888, 8388608, 3670016, 32768, 8, 18964480, 131072, 0, 0, 218106192, 4
    .long 1, 80, 80, 2048, 3671552, 3671808, 7340032, 58253312, 114688, 7, 177233920, 32768, 218103968, 7, 218106496, 1
    .long 0, 0, 0, 0, 0, 0, 0, 0, 0, 0, 0, 0, 0, 0, 0, 0
    .long 0, 0, 0, 0, 0, 0, 0, 0, 0, 0, 0, 0, 0, 0, 0, 0
    .long 0, 0, 0, 0, 0, 0, 0, 0, 0, 0, 0, 0, 0, 0, 0, 0
    .long 0, 0, 0, 0, 0, 0, 0, 0, 0, 0, 0, 0, 0, 0, 0, 0
    .long 1, 32, 32, 8192, 7680, 7936, 8388608, 524288, 32768, 8, 39968768, 131072, 0, 0, 218104688, 4
    .long 1, 16, 16, 8192, 7680, 7936, 8388608, 1048576, 32768, 8, 8511488, 131072, 0, 0, 218104944, 4
    .long 1, 24, 24, 8192, 7680, 7936, 8388608, 2621440, 32768, 8, 31580160, 131072, 0, 0, 218105712, 4
    .long 1, 16, 16, 8192, 7680, 7936, 8388608, 3145728, 32768, 8, 16900096, 131072, 0, 0, 218105968, 4
    .long 1, 16, 16, 8192, 7680, 7936, 8388608, 3670016, 32768, 8, 18997248, 131072, 0, 0, 218106224, 4
    .long 1, 80, 80, 2048, 5506560, 5506816, 7340032, 58281984, 114688, 7, 181428224, 32768, 218103984, 7, 218106496, 1
    .long 0, 0, 0, 0, 0, 0, 0, 0, 0, 0, 0, 0, 0, 0, 0, 0
    .long 0, 0, 0, 0, 0, 0, 0, 0, 0, 0, 0, 0, 0, 0, 0, 0
    .long 0, 0, 0, 0, 0, 0, 0, 0, 0, 0, 0, 0, 0, 0, 0, 0
    .long 0, 0, 0, 0, 0, 0, 0, 0, 0, 0, 0, 0, 0, 0, 0, 0
    .long 1, 24, 24, 8192, 0, 256, 8388608, 524288, 32768, 8, 23068672, 131072, 0, 0, 218104576, 4
    .long 1, 32, 32, 8192, 0, 256, 8388608, 1572864, 32768, 8, 44040192, 131072, 0, 0, 218105088, 4
    .long 1, 16, 16, 8192, 0, 256, 8388608, 2621440, 32768, 8, 14680064, 131072, 0, 0, 218105600, 4
    .long 2, 64, 72, 7168, 2048, 2048, 7340032, 1048576, 32768, 8, 58228736, 114688, 0, 0, 218103952, 1
    .long 2, 64, 72, 7168, 1024, 1024, 7340032, 2621440, 32768, 8, 63717376, 114688, 0, 0, 218104128, 1
    .long 1, 80, 80, 2048, 0, 256, 7340032, 60030976, 114688, 7, 169345024, 32768, 218104000, 7, 218106560, 1
    .long 0, 0, 0, 0, 0, 0, 0, 0, 0, 0, 0, 0, 0, 0, 0, 0
    .long 0, 0, 0, 0, 0, 0, 0, 0, 0, 0, 0, 0, 0, 0, 0, 0
    .long 0, 0, 0, 0, 0, 0, 0, 0, 0, 0, 0, 0, 0, 0, 0, 0
    .long 0, 0, 0, 0, 0, 0, 0, 0, 0, 0, 0, 0, 0, 0, 0, 0
    .long 1, 24, 24, 8192, 2048, 2304, 8388608, 524288, 32768, 8, 23101440, 131072, 0, 0, 218104608, 4
    .long 1, 32, 32, 8192, 2048, 2304, 8388608, 1572864, 32768, 8, 44072960, 131072, 0, 0, 218105120, 4
    .long 1, 16, 16, 8192, 2048, 2304, 8388608, 2621440, 32768, 8, 14712832, 131072, 0, 0, 218105632, 4
    .long 2, 64, 72, 7168, 2304, 2304, 7340032, 1048576, 32768, 8, 58232832, 114688, 0, 0, 218103952, 1
    .long 2, 64, 72, 7168, 1280, 1280, 7340032, 2621440, 32768, 8, 63721472, 114688, 0, 0, 218104128, 1
    .long 1, 80, 80, 2048, 1835008, 1835264, 7340032, 60059648, 114688, 7, 173539328, 32768, 218104016, 7, 218106560, 1
    .long 0, 0, 0, 0, 0, 0, 0, 0, 0, 0, 0, 0, 0, 0, 0, 0
    .long 0, 0, 0, 0, 0, 0, 0, 0, 0, 0, 0, 0, 0, 0, 0, 0
    .long 0, 0, 0, 0, 0, 0, 0, 0, 0, 0, 0, 0, 0, 0, 0, 0
    .long 0, 0, 0, 0, 0, 0, 0, 0, 0, 0, 0, 0, 0, 0, 0, 0
    .long 1, 24, 24, 8192, 4096, 4352, 8388608, 524288, 32768, 8, 23134208, 131072, 0, 0, 218104640, 4
    .long 1, 32, 32, 8192, 4096, 4352, 8388608, 1572864, 32768, 8, 44105728, 131072, 0, 0, 218105152, 4
    .long 1, 16, 16, 8192, 4096, 4352, 8388608, 2621440, 32768, 8, 14745600, 131072, 0, 0, 218105664, 4
    .long 2, 64, 72, 7168, 2560, 2560, 7340032, 1048576, 32768, 8, 58236928, 114688, 0, 0, 218103952, 1
    .long 2, 64, 72, 7168, 1536, 1536, 7340032, 2621440, 32768, 8, 63725568, 114688, 0, 0, 218104128, 1
    .long 1, 80, 80, 2048, 3670016, 3670272, 7340032, 60088320, 114688, 7, 177733632, 32768, 218104032, 7, 218106560, 1
    .long 0, 0, 0, 0, 0, 0, 0, 0, 0, 0, 0, 0, 0, 0, 0, 0
    .long 0, 0, 0, 0, 0, 0, 0, 0, 0, 0, 0, 0, 0, 0, 0, 0
    .long 0, 0, 0, 0, 0, 0, 0, 0, 0, 0, 0, 0, 0, 0, 0, 0
    .long 0, 0, 0, 0, 0, 0, 0, 0, 0, 0, 0, 0, 0, 0, 0, 0
    .long 1, 24, 24, 8192, 6144, 6400, 8388608, 524288, 32768, 8, 23166976, 131072, 0, 0, 218104672, 4
    .long 1, 32, 32, 8192, 6144, 6400, 8388608, 1572864, 32768, 8, 44138496, 131072, 0, 0, 218105184, 4
    .long 1, 16, 16, 8192, 6144, 6400, 8388608, 2621440, 32768, 8, 14778368, 131072, 0, 0, 218105696, 4
    .long 2, 64, 72, 7168, 2816, 2816, 7340032, 1048576, 32768, 8, 58241024, 114688, 0, 0, 218103952, 1
    .long 2, 64, 72, 7168, 1792, 1792, 7340032, 2621440, 32768, 8, 63729664, 114688, 0, 0, 218104144, 1
    .long 1, 80, 80, 2048, 5505024, 5505280, 7340032, 60116992, 114688, 7, 181927936, 32768, 218104048, 7, 218106560, 1
    .long 0, 0, 0, 0, 0, 0, 0, 0, 0, 0, 0, 0, 0, 0, 0, 0
    .long 0, 0, 0, 0, 0, 0, 0, 0, 0, 0, 0, 0, 0, 0, 0, 0
    .long 0, 0, 0, 0, 0, 0, 0, 0, 0, 0, 0, 0, 0, 0, 0, 0
    .long 0, 0, 0, 0, 0, 0, 0, 0, 0, 0, 0, 0, 0, 0, 0, 0
    .long 1, 24, 24, 8192, 512, 768, 8388608, 524288, 32768, 8, 23076864, 131072, 0, 0, 218104576, 4
    .long 1, 32, 32, 8192, 512, 768, 8388608, 1572864, 32768, 8, 44048384, 131072, 0, 0, 218105088, 4
    .long 1, 16, 16, 8192, 512, 768, 8388608, 2621440, 32768, 8, 14688256, 131072, 0, 0, 218105600, 4
    .long 2, 64, 72, 7168, 3072, 3072, 7340032, 1048576, 32768, 8, 58245120, 114688, 0, 0, 218103952, 1
    .long 2, 64, 72, 7168, 2048, 2048, 7340032, 2621440, 32768, 8, 63733760, 114688, 0, 0, 218104144, 1
    .long 1, 80, 80, 2048, 512, 768, 7340032, 60030976, 114688, 7, 169353216, 32768, 218104000, 7, 218106560, 1
    .long 0, 0, 0, 0, 0, 0, 0, 0, 0, 0, 0, 0, 0, 0, 0, 0
    .long 0, 0, 0, 0, 0, 0, 0, 0, 0, 0, 0, 0, 0, 0, 0, 0
    .long 0, 0, 0, 0, 0, 0, 0, 0, 0, 0, 0, 0, 0, 0, 0, 0
    .long 0, 0, 0, 0, 0, 0, 0, 0, 0, 0, 0, 0, 0, 0, 0, 0
    .long 1, 24, 24, 8192, 2560, 2816, 8388608, 524288, 32768, 8, 23109632, 131072, 0, 0, 218104608, 4
    .long 1, 32, 32, 8192, 2560, 2816, 8388608, 1572864, 32768, 8, 44081152, 131072, 0, 0, 218105120, 4
    .long 1, 16, 16, 8192, 2560, 2816, 8388608, 2621440, 32768, 8, 14721024, 131072, 0, 0, 218105632, 4
    .long 2, 64, 72, 7168, 3328, 3328, 7340032, 1048576, 32768, 8, 58249216, 114688, 0, 0, 218103952, 1
    .long 2, 64, 72, 7168, 2304, 2304, 7340032, 2621440, 32768, 8, 63737856, 114688, 0, 0, 218104144, 1
    .long 1, 80, 80, 2048, 1835520, 1835776, 7340032, 60059648, 114688, 7, 173547520, 32768, 218104016, 7, 218106560, 1
    .long 0, 0, 0, 0, 0, 0, 0, 0, 0, 0, 0, 0, 0, 0, 0, 0
    .long 0, 0, 0, 0, 0, 0, 0, 0, 0, 0, 0, 0, 0, 0, 0, 0
    .long 0, 0, 0, 0, 0, 0, 0, 0, 0, 0, 0, 0, 0, 0, 0, 0
    .long 0, 0, 0, 0, 0, 0, 0, 0, 0, 0, 0, 0, 0, 0, 0, 0
    .long 1, 24, 24, 8192, 4608, 4864, 8388608, 524288, 32768, 8, 23142400, 131072, 0, 0, 218104640, 4
    .long 1, 32, 32, 8192, 4608, 4864, 8388608, 1572864, 32768, 8, 44113920, 131072, 0, 0, 218105152, 4
    .long 1, 16, 16, 8192, 4608, 4864, 8388608, 2621440, 32768, 8, 14753792, 131072, 0, 0, 218105664, 4
    .long 2, 64, 72, 7168, 3584, 3584, 7340032, 1048576, 32768, 8, 58253312, 114688, 0, 0, 218103968, 1
    .long 2, 64, 72, 7168, 2560, 2560, 7340032, 2621440, 32768, 8, 63741952, 114688, 0, 0, 218104144, 1
    .long 1, 80, 80, 2048, 3670528, 3670784, 7340032, 60088320, 114688, 7, 177741824, 32768, 218104032, 7, 218106560, 1
    .long 0, 0, 0, 0, 0, 0, 0, 0, 0, 0, 0, 0, 0, 0, 0, 0
    .long 0, 0, 0, 0, 0, 0, 0, 0, 0, 0, 0, 0, 0, 0, 0, 0
    .long 0, 0, 0, 0, 0, 0, 0, 0, 0, 0, 0, 0, 0, 0, 0, 0
    .long 0, 0, 0, 0, 0, 0, 0, 0, 0, 0, 0, 0, 0, 0, 0, 0
    .long 1, 24, 24, 8192, 6656, 6912, 8388608, 524288, 32768, 8, 23175168, 131072, 0, 0, 218104672, 4
    .long 1, 32, 32, 8192, 6656, 6912, 8388608, 1572864, 32768, 8, 44146688, 131072, 0, 0, 218105184, 4
    .long 1, 16, 16, 8192, 6656, 6912, 8388608, 2621440, 32768, 8, 14786560, 131072, 0, 0, 218105696, 4
    .long 2, 64, 72, 7168, 3840, 3840, 7340032, 1048576, 32768, 8, 58257408, 114688, 0, 0, 218103968, 1
    .long 2, 64, 72, 7168, 2816, 2816, 7340032, 2621440, 32768, 8, 63746048, 114688, 0, 0, 218104144, 1
    .long 1, 80, 80, 2048, 5505536, 5505792, 7340032, 60116992, 114688, 7, 181936128, 32768, 218104048, 7, 218106560, 1
    .long 0, 0, 0, 0, 0, 0, 0, 0, 0, 0, 0, 0, 0, 0, 0, 0
    .long 0, 0, 0, 0, 0, 0, 0, 0, 0, 0, 0, 0, 0, 0, 0, 0
    .long 0, 0, 0, 0, 0, 0, 0, 0, 0, 0, 0, 0, 0, 0, 0, 0
    .long 0, 0, 0, 0, 0, 0, 0, 0, 0, 0, 0, 0, 0, 0, 0, 0
    .long 1, 24, 24, 8192, 1024, 1280, 8388608, 524288, 32768, 8, 23085056, 131072, 0, 0, 218104592, 4
    .long 1, 32, 32, 8192, 1024, 1280, 8388608, 1572864, 32768, 8, 44056576, 131072, 0, 0, 218105104, 4
    .long 1, 16, 16, 8192, 1024, 1280, 8388608, 2621440, 32768, 8, 14696448, 131072, 0, 0, 218105616, 4
    .long 2, 64, 72, 7168, 4096, 4096, 7340032, 1048576, 32768, 8, 58261504, 114688, 0, 0, 218103968, 1
    .long 2, 64, 72, 7168, 3072, 3072, 7340032, 2621440, 32768, 8, 63750144, 114688, 0, 0, 218104144, 1
    .long 1, 80, 80, 2048, 1024, 1280, 7340032, 60030976, 114688, 7, 169361408, 32768, 218104000, 7, 218106560, 1
    .long 0, 0, 0, 0, 0, 0, 0, 0, 0, 0, 0, 0, 0, 0, 0, 0
    .long 0, 0, 0, 0, 0, 0, 0, 0, 0, 0, 0, 0, 0, 0, 0, 0
    .long 0, 0, 0, 0, 0, 0, 0, 0, 0, 0, 0, 0, 0, 0, 0, 0
    .long 0, 0, 0, 0, 0, 0, 0, 0, 0, 0, 0, 0, 0, 0, 0, 0
    .long 1, 24, 24, 8192, 3072, 3328, 8388608, 524288, 32768, 8, 23117824, 131072, 0, 0, 218104624, 4
    .long 1, 32, 32, 8192, 3072, 3328, 8388608, 1572864, 32768, 8, 44089344, 131072, 0, 0, 218105136, 4
    .long 1, 16, 16, 8192, 3072, 3328, 8388608, 2621440, 32768, 8, 14729216, 131072, 0, 0, 218105648, 4
    .long 2, 64, 72, 7168, 4352, 4352, 7340032, 1048576, 32768, 8, 58265600, 114688, 0, 0, 218103968, 1
    .long 2, 64, 72, 7168, 3328, 3328, 7340032, 2621440, 32768, 8, 63754240, 114688, 0, 0, 218104144, 1
    .long 1, 80, 80, 2048, 1836032, 1836288, 7340032, 60059648, 114688, 7, 173555712, 32768, 218104016, 7, 218106560, 1
    .long 0, 0, 0, 0, 0, 0, 0, 0, 0, 0, 0, 0, 0, 0, 0, 0
    .long 0, 0, 0, 0, 0, 0, 0, 0, 0, 0, 0, 0, 0, 0, 0, 0
    .long 0, 0, 0, 0, 0, 0, 0, 0, 0, 0, 0, 0, 0, 0, 0, 0
    .long 0, 0, 0, 0, 0, 0, 0, 0, 0, 0, 0, 0, 0, 0, 0, 0
    .long 1, 24, 24, 8192, 5120, 5376, 8388608, 524288, 32768, 8, 23150592, 131072, 0, 0, 218104656, 4
    .long 1, 32, 32, 8192, 5120, 5376, 8388608, 1572864, 32768, 8, 44122112, 131072, 0, 0, 218105168, 4
    .long 1, 16, 16, 8192, 5120, 5376, 8388608, 2621440, 32768, 8, 14761984, 131072, 0, 0, 218105680, 4
    .long 2, 64, 72, 7168, 4608, 4608, 7340032, 1048576, 32768, 8, 58269696, 114688, 0, 0, 218103968, 1
    .long 2, 64, 72, 7168, 3584, 3584, 7340032, 2621440, 32768, 8, 63758336, 114688, 0, 0, 218104160, 1
    .long 1, 80, 80, 2048, 3671040, 3671296, 7340032, 60088320, 114688, 7, 177750016, 32768, 218104032, 7, 218106560, 1
    .long 0, 0, 0, 0, 0, 0, 0, 0, 0, 0, 0, 0, 0, 0, 0, 0
    .long 0, 0, 0, 0, 0, 0, 0, 0, 0, 0, 0, 0, 0, 0, 0, 0
    .long 0, 0, 0, 0, 0, 0, 0, 0, 0, 0, 0, 0, 0, 0, 0, 0
    .long 0, 0, 0, 0, 0, 0, 0, 0, 0, 0, 0, 0, 0, 0, 0, 0
    .long 1, 24, 24, 8192, 7168, 7424, 8388608, 524288, 32768, 8, 23183360, 131072, 0, 0, 218104688, 4
    .long 1, 32, 32, 8192, 7168, 7424, 8388608, 1572864, 32768, 8, 44154880, 131072, 0, 0, 218105200, 4
    .long 1, 16, 16, 8192, 7168, 7424, 8388608, 2621440, 32768, 8, 14794752, 131072, 0, 0, 218105712, 4
    .long 2, 64, 72, 7168, 4864, 4864, 7340032, 1048576, 32768, 8, 58273792, 114688, 0, 0, 218103968, 1
    .long 2, 64, 72, 7168, 3840, 3840, 7340032, 2621440, 32768, 8, 63762432, 114688, 0, 0, 218104160, 1
    .long 1, 80, 80, 2048, 5506048, 5506304, 7340032, 60116992, 114688, 7, 181944320, 32768, 218104048, 7, 218106560, 1
    .long 0, 0, 0, 0, 0, 0, 0, 0, 0, 0, 0, 0, 0, 0, 0, 0
    .long 0, 0, 0, 0, 0, 0, 0, 0, 0, 0, 0, 0, 0, 0, 0, 0
    .long 0, 0, 0, 0, 0, 0, 0, 0, 0, 0, 0, 0, 0, 0, 0, 0
    .long 0, 0, 0, 0, 0, 0, 0, 0, 0, 0, 0, 0, 0, 0, 0, 0
    .long 1, 24, 24, 8192, 1536, 1792, 8388608, 524288, 32768, 8, 23093248, 131072, 0, 0, 218104592, 4
    .long 1, 32, 32, 8192, 1536, 1792, 8388608, 1572864, 32768, 8, 44064768, 131072, 0, 0, 218105104, 4
    .long 1, 16, 16, 8192, 1536, 1792, 8388608, 2621440, 32768, 8, 14704640, 131072, 0, 0, 218105616, 4
    .long 2, 64, 72, 7168, 5120, 5120, 7340032, 1048576, 32768, 8, 58277888, 114688, 0, 0, 218103968, 1
    .long 2, 64, 72, 7168, 4096, 4096, 7340032, 2621440, 32768, 8, 63766528, 114688, 0, 0, 218104160, 1
    .long 1, 80, 80, 2048, 1536, 1792, 7340032, 60030976, 114688, 7, 169369600, 32768, 218104000, 7, 218106560, 1
    .long 0, 0, 0, 0, 0, 0, 0, 0, 0, 0, 0, 0, 0, 0, 0, 0
    .long 0, 0, 0, 0, 0, 0, 0, 0, 0, 0, 0, 0, 0, 0, 0, 0
    .long 0, 0, 0, 0, 0, 0, 0, 0, 0, 0, 0, 0, 0, 0, 0, 0
    .long 0, 0, 0, 0, 0, 0, 0, 0, 0, 0, 0, 0, 0, 0, 0, 0
    .long 1, 24, 24, 8192, 3584, 3840, 8388608, 524288, 32768, 8, 23126016, 131072, 0, 0, 218104624, 4
    .long 1, 32, 32, 8192, 3584, 3840, 8388608, 1572864, 32768, 8, 44097536, 131072, 0, 0, 218105136, 4
    .long 1, 16, 16, 8192, 3584, 3840, 8388608, 2621440, 32768, 8, 14737408, 131072, 0, 0, 218105648, 4
    .long 2, 64, 72, 7168, 5376, 5376, 7340032, 1048576, 32768, 8, 58281984, 114688, 0, 0, 218103984, 1
    .long 2, 64, 72, 7168, 4352, 4352, 7340032, 2621440, 32768, 8, 63770624, 114688, 0, 0, 218104160, 1
    .long 1, 80, 80, 2048, 1836544, 1836800, 7340032, 60059648, 114688, 7, 173563904, 32768, 218104016, 7, 218106560, 1
    .long 0, 0, 0, 0, 0, 0, 0, 0, 0, 0, 0, 0, 0, 0, 0, 0
    .long 0, 0, 0, 0, 0, 0, 0, 0, 0, 0, 0, 0, 0, 0, 0, 0
    .long 0, 0, 0, 0, 0, 0, 0, 0, 0, 0, 0, 0, 0, 0, 0, 0
    .long 0, 0, 0, 0, 0, 0, 0, 0, 0, 0, 0, 0, 0, 0, 0, 0
    .long 1, 24, 24, 8192, 5632, 5888, 8388608, 524288, 32768, 8, 23158784, 131072, 0, 0, 218104656, 4
    .long 1, 32, 32, 8192, 5632, 5888, 8388608, 1572864, 32768, 8, 44130304, 131072, 0, 0, 218105168, 4
    .long 1, 16, 16, 8192, 5632, 5888, 8388608, 2621440, 32768, 8, 14770176, 131072, 0, 0, 218105680, 4
    .long 2, 64, 72, 7168, 5632, 5632, 7340032, 1048576, 32768, 8, 58286080, 114688, 0, 0, 218103984, 1
    .long 2, 64, 72, 7168, 4608, 4608, 7340032, 2621440, 32768, 8, 63774720, 114688, 0, 0, 218104160, 1
    .long 1, 80, 80, 2048, 3671552, 3671808, 7340032, 60088320, 114688, 7, 177758208, 32768, 218104032, 7, 218106560, 1
    .long 0, 0, 0, 0, 0, 0, 0, 0, 0, 0, 0, 0, 0, 0, 0, 0
    .long 0, 0, 0, 0, 0, 0, 0, 0, 0, 0, 0, 0, 0, 0, 0, 0
    .long 0, 0, 0, 0, 0, 0, 0, 0, 0, 0, 0, 0, 0, 0, 0, 0
    .long 0, 0, 0, 0, 0, 0, 0, 0, 0, 0, 0, 0, 0, 0, 0, 0
    .long 1, 24, 24, 8192, 7680, 7936, 8388608, 524288, 32768, 8, 23191552, 131072, 0, 0, 218104688, 4
    .long 1, 32, 32, 8192, 7680, 7936, 8388608, 1572864, 32768, 8, 44163072, 131072, 0, 0, 218105200, 4
    .long 1, 16, 16, 8192, 7680, 7936, 8388608, 2621440, 32768, 8, 14802944, 131072, 0, 0, 218105712, 4
    .long 2, 64, 72, 7168, 5888, 5888, 7340032, 1048576, 32768, 8, 58290176, 114688, 0, 0, 218103984, 1
    .long 2, 64, 72, 7168, 4864, 4864, 7340032, 2621440, 32768, 8, 63778816, 114688, 0, 0, 218104160, 1
    .long 1, 80, 80, 2048, 5506560, 5506816, 7340032, 60116992, 114688, 7, 181952512, 32768, 218104048, 7, 218106560, 1
    .long 0, 0, 0, 0, 0, 0, 0, 0, 0, 0, 0, 0, 0, 0, 0, 0
    .long 0, 0, 0, 0, 0, 0, 0, 0, 0, 0, 0, 0, 0, 0, 0, 0
    .long 0, 0, 0, 0, 0, 0, 0, 0, 0, 0, 0, 0, 0, 0, 0, 0
    .long 0, 0, 0, 0, 0, 0, 0, 0, 0, 0, 0, 0, 0, 0, 0, 0
.p2align 6
.amdhsa_kernel recurrent_scan__memory_aug_recurrent_mem_tr__glu_gated_glu__prompt_kernel
  .amdhsa_next_free_vgpr 256
  .amdhsa_next_free_sgpr 102
  .amdhsa_accum_offset 256
  .amdhsa_group_segment_fixed_size 0
  .amdhsa_kernarg_size 112
  .amdhsa_user_sgpr_count 2
  .amdhsa_user_sgpr_kernarg_segment_ptr 1
  .amdhsa_system_sgpr_workgroup_id_x 1
  .amdhsa_float_denorm_mode_32 3
.end_amdhsa_kernel
```

```asm
; @launch grid=(256,1,1) block=(512,1,1) lds=163840
.amdgcn_target "amdgcn-amd-amdhsa--gfx950"
.text
.globl recurrent_scan__memory_aug_recurrent_mem_tr__glu_gated_glu__prompt_kernel
.p2align 8
.type recurrent_scan__memory_aug_recurrent_mem_tr__glu_gated_glu__prompt_kernel,@function
recurrent_scan__memory_aug_recurrent_mem_tr__glu_gated_glu__prompt_kernel:
    s_cmp_ge_u32 s2, 256
    s_cbranch_scc1 k_exit
    s_mov_b32 s99, s2
    s_load_dwordx2 s[4:5], s[0:1], 104
    s_load_dwordx2 s[64:65], s[0:1], 96
    v_lshrrev_b32 v2, 6, v0
    s_mov_b32 s6, 268435456
    s_mov_b32 s7, 131072
    s_mov_b32 s66, 256
    s_mov_b32 s67, 131072
    v_readfirstlane_b32 s3, v2
    s_lshr_b32 s12, s2, 3
    s_and_b32 s13, s2, 3
    s_waitcnt lgkmcnt(0)
    s_bitcmp0_b32 s2, 2
    s_cbranch_scc1 chain_map
    s_lshl_b32 s63, s12, 2
    s_add_u32 s63, s63, s13
    s_mov_b32 s29, s63
    v_and_b32 v20, 63, v0
    v_lshlrev_b32 v1, 4, v20
    v_add_u32 v19, 0x1000, v1
    v_lshrrev_b32 v4, 4, v20
    v_mov_b32 v17, 0
    v_mov_b32 v18, 1
    s_lshr_b32 s26, s3, 2
    s_and_b32 s27, s3, 3
    s_lshl_b32 s21, s3, 11
    s_lshl_b32 s22, s3, 10
    s_add_u32 s22, s22, 16384
    s_mov_b32 s11, 131072
    s_mov_b32 s15, 131072
    s_mov_b32 s28, 0
    v_and_b32 v21, 15, v20
    v_lshlrev_b32 v22, 2, v4
    v_xor_b32 v21, v21, v22
    s_lshr_b32 s30, s3, 1
    s_and_b32 s30, s30, 1
    v_xor_b32 v21, s30, v21
    v_lshlrev_b32 v3, 4, v21
    s_lshl_b32 s30, s26, 13
    v_add_u32 v5, s30, v1
    v_add_u32 v6, 0x10000, v5
    v_bfe_u32 v21, v20, 2, 2
    v_and_b32 v22, 3, v20
    v_and_b32 v23, 1, v4
    v_xor_b32 v24, s27, v21
    v_xor_b32 v25, v22, v23
    v_lshl_add_u32 v24, v24, 2, v25
    v_lshlrev_b32 v24, 4, v24
    v_lshl_add_u32 v25, v4, 3, v21
    v_lshl_add_u32 v24, v25, 8, v24
    v_and_b32 v22, 1, v22
    v_xor_b32 v25, 0, v23
    v_lshl_add_u32 v8, v25, 10, v24
    v_xor_b32 v25, 0, v22
    v_lshl_add_u32 v8, v25, 3, v8
    v_add_u32 v12, 0x10000, v8
    v_xor_b32 v25, 1, v23
    v_lshl_add_u32 v9, v25, 10, v24
    v_xor_b32 v25, 0, v22
    v_lshl_add_u32 v9, v25, 3, v9
    v_add_u32 v13, 0x10000, v9
    v_xor_b32 v25, 0, v23
    v_lshl_add_u32 v10, v25, 10, v24
    v_xor_b32 v25, 1, v22
    v_lshl_add_u32 v10, v25, 3, v10
    v_add_u32 v14, 0x10000, v10
    v_xor_b32 v25, 1, v23
    v_lshl_add_u32 v11, v25, 10, v24
    v_xor_b32 v25, 1, v22
    v_lshl_add_u32 v11, v25, 3, v11
    v_add_u32 v15, 0x10000, v11
    s_lshl_b32 s30, s3, 2
    s_add_u32 s30, s30, 131072
    v_mov_b32 v7, s30
    s_getpc_b64 s[24:25]
    s_add_u32 s24, s24, jobtab@rel32@lo+4
    s_addc_u32 s25, s25, jobtab@rel32@hi+12
    s_mul_i32 s30, s29, 640
    s_add_u32 s24, s24, s30
    s_addc_u32 s25, s25, 0
    s_load_dwordx16 s[32:47], s[24:25], 0
    s_add_u32 s24, s24, 64
    s_addc_u32 s25, s25, 0
    s_waitcnt lgkmcnt(0)
    s_mov_b32 s8, s4
    s_mov_b32 s9, s5
    s_mov_b32 s10, 0
    s_mov_b32 s12, s4
    s_mov_b32 s13, s5
    s_mov_b32 s14, 0
    s_load_dwordx2 s[88:89], s[0:1], 0
    s_mov_b32 s90, 4194304
    s_mov_b32 s91, 131072
    s_mov_b32 s98, 0
    v_mov_b32 v22, 0
    s_mov_b32 s70, 1
    v_and_b32 v245, 15, v0
    v_lshlrev_b32 v246, 11, v245
    v_lshl_add_u32 v246, v4, 4, v246
    s_add_u32 s71, s63, 32
    s_and_b32 s71, s71, 127
    s_lshl_b32 s72, s71, 15
    s_lshl_b32 s73, s3, 8
    s_add_u32 s72, s72, s73
    s_waitcnt lgkmcnt(0)
    buffer_load_dwordx4 v[228:231], v246, s[88:91], s72 offen offset:0
    buffer_load_dwordx4 v[232:235], v246, s[88:91], s72 offen offset:64
    buffer_load_dwordx4 v[236:239], v246, s[88:91], s72 offen offset:128
    buffer_load_dwordx4 v[240:243], v246, s[88:91], s72 offen offset:192
    s_cmp_lg_u32 s32, 6
    s_cbranch_scc1 ln_nx
    s_mov_b32 s98, 3
    s_cmp_lg_u32 s32, 6
    s_cbranch_scc1 xs_1
    s_load_dwordx2 s[8:9], s[0:1], s33
    s_load_dwordx2 s[12:13], s[0:1], s34
    s_mov_b32 s10, s38
    s_mov_b32 s14, s38
    s_cmp_ge_u32 s32, 4
    s_cselect_b32 s31, 0, 1
    s_lshl_b32 s30, s3, s31
    s_mul_i32 s30, s30, s40
    s_add_u32 s16, s39, s30
    s_cmp_eq_u32 s32, 4
    s_cselect_b32 s30, 1024, s40
    s_cselect_b32 s31, 6, 5
    s_lshl_b32 s62, 32, s31
    s_add_u32 s17, s16, s30
    s_lshl_b32 s30, s3, 2
    s_mul_i32 s30, s30, s35
    s_add_u32 s18, s36, s30
    s_add_u32 s19, s37, s30
    s_lshl_b32 s20, s35, s31
    v_mul_u32_u24 v2, s35, v4
    v_add_u32 v2, v2, v3
    s_waitcnt lgkmcnt(0)
    s_lshl_b32 s16, s3, 15
    s_add_u32 s16, s16, s39
    s_add_u32 s92, s16, 2048
    s_lshl_b32 s93, s35, 10
    s_lshr_b32 s94, s63, 2
    s_mul_i32 s94, s94, 1
    s_and_b32 s94, s94, 15
    s_lshl_b32 s95, s94, 7
    s_add_u32 s16, s16, s95
    s_lshl_b32 s95, s35, 6
    s_mul_i32 s94, s95, s94
    s_add_u32 s95, s18, s93
    s_add_u32 s18, s18, s94
    s_add_u32 s19, s19, s94
    s_add_u32 s17, s16, 16384
    s_mov_b32 s62, 128
    s_lshl_b32 s20, s35, 6
    v_lshrrev_b32 v21, 7, v1
    v_bfe_u32 v23, v1, 4, 3
    v_xor_b32 v23, v21, v23
    v_lshlrev_b32 v23, 4, v23
    v_lshl_add_u32 v23, v21, 11, v23
    s_add_u32 m0, s21, 0
    s_nop 0
    buffer_load_dwordx4 v23, s[88:91], s16 offen lds
    s_add_u32 s16, s16, s62
    s_add_u32 m0, s21, 1024
    s_nop 0
    buffer_load_dwordx4 v23, s[88:91], s17 offen lds
    s_add_u32 s17, s17, s62
    s_cmp_ge_u32 s16, s92
    s_cselect_b32 s94, 2048, 0
    s_sub_u32 s16, s16, s94
    s_sub_u32 s17, s17, s94
    s_add_u32 m0, s22, 0
    s_nop 0
    buffer_load_dwordx4 v2, s[8:11], s18 offen lds
    s_add_u32 s18, s18, s20
    s_add_u32 m0, s22, 8192
    s_nop 0
    buffer_load_dwordx4 v2, s[12:15], s19 offen lds
    s_add_u32 s19, s19, s20
    s_cmp_ge_u32 s18, s95
    s_cselect_b32 s94, s93, 0
    s_sub_u32 s18, s18, s94
    s_sub_u32 s19, s19, s94
    s_add_u32 m0, s21, 32768
    s_nop 0
    buffer_load_dwordx4 v23, s[88:91], s16 offen lds
    s_add_u32 s16, s16, s62
    s_add_u32 m0, s21, 33792
    s_nop 0
    buffer_load_dwordx4 v23, s[88:91], s17 offen lds
    s_add_u32 s17, s17, s62
    s_cmp_ge_u32 s16, s92
    s_cselect_b32 s94, 2048, 0
    s_sub_u32 s16, s16, s94
    s_sub_u32 s17, s17, s94
    s_add_u32 m0, s22, 32768
    s_nop 0
    buffer_load_dwordx4 v2, s[8:11], s18 offen lds
    s_add_u32 s18, s18, s20
    s_add_u32 m0, s22, 40960
    s_nop 0
    buffer_load_dwordx4 v2, s[12:15], s19 offen lds
    s_add_u32 s19, s19, s20
    s_cmp_ge_u32 s18, s95
    s_cselect_b32 s94, s93, 0
    s_sub_u32 s18, s18, s94
    s_sub_u32 s19, s19, s94
    s_add_u32 m0, s21, 65536
    s_nop 0
    buffer_load_dwordx4 v23, s[88:91], s16 offen lds
    s_add_u32 s16, s16, s62
    s_add_u32 m0, s21, 66560
    s_nop 0
    buffer_load_dwordx4 v23, s[88:91], s17 offen lds
    s_add_u32 s17, s17, s62
    s_cmp_ge_u32 s16, s92
    s_cselect_b32 s94, 2048, 0
    s_sub_u32 s16, s16, s94
    s_sub_u32 s17, s17, s94
    s_add_u32 m0, s22, 65536
    s_nop 0
    buffer_load_dwordx4 v2, s[8:11], s18 offen lds
    s_add_u32 s18, s18, s20
    s_add_u32 m0, s22, 73728
    s_nop 0
    buffer_load_dwordx4 v2, s[12:15], s19 offen lds
    s_add_u32 s19, s19, s20
    s_cmp_ge_u32 s18, s95
    s_cselect_b32 s94, s93, 0
    s_sub_u32 s18, s18, s94
    s_sub_u32 s19, s19, s94
    s_add_u32 m0, s21, 98304
    s_nop 0
    buffer_load_dwordx4 v23, s[88:91], s16 offen lds
    s_add_u32 s16, s16, s62
    s_add_u32 m0, s21, 99328
    s_nop 0
    buffer_load_dwordx4 v23, s[88:91], s17 offen lds
    s_add_u32 s17, s17, s62
    s_cmp_ge_u32 s16, s92
    s_cselect_b32 s94, 2048, 0
    s_sub_u32 s16, s16, s94
    s_sub_u32 s17, s17, s94
    s_add_u32 m0, s22, 98304
    s_nop 0
    buffer_load_dwordx4 v2, s[8:11], s18 offen lds
    s_add_u32 s18, s18, s20
    s_add_u32 m0, s22, 106496
    s_nop 0
    buffer_load_dwordx4 v2, s[12:15], s19 offen lds
    s_add_u32 s19, s19, s20
    s_cmp_ge_u32 s18, s95
    s_cselect_b32 s94, s93, 0
    s_sub_u32 s18, s18, s94
    s_sub_u32 s19, s19, s94
    v_and_b32 v21, 1, v4
    v_lshlrev_b32 v21, 10, v21
    v_xor_b32 v8, v21, v8
    v_xor_b32 v9, v21, v9
    v_xor_b32 v10, v21, v10
    v_xor_b32 v11, v21, v11
    v_xor_b32 v12, v21, v12
    v_xor_b32 v13, v21, v13
    v_xor_b32 v14, v21, v14
    v_xor_b32 v15, v21, v15
xs_1:
    s_branch w_adopt
ln_nx:
    s_lshl_b32 s73, s71, 9
    s_add_u32 s73, s73, 218103808
    v_lshlrev_b32 v252, 2, v0
    s_cmp_ge_u32 s71, 32
    s_cbranch_scc1 ln_nz
    s_cmp_ge_u32 s3, 2
    s_cbranch_scc1 ln_nz
    buffer_store_dword v17, v252, s[4:7], s73 offen sc1
ln_nz:
    s_waitcnt vmcnt(0)
ln_entry:
    v_lshlrev_b32 v247, 5, v245
    v_add_u32 v247, 135168, v247
    s_lshl_b32 s74, s3, 2
    v_add_u32 v248, s74, v247
    s_lshl_b32 s75, s71, 15
    s_lshl_b32 s76, s3, 12
    s_add_u32 s75, s75, s76
    v_and_b32 v249, 1, v4
    v_cmp_eq_u32 s[80:81], 1, v249
    v_lshlrev_b32 v56, 16, v228
    v_and_b32 v57, 0xffff0000, v228
    v_lshlrev_b32 v58, 16, v229
    v_and_b32 v59, 0xffff0000, v229
    v_lshlrev_b32 v60, 16, v230
    v_and_b32 v61, 0xffff0000, v230
    v_lshlrev_b32 v62, 16, v231
    v_and_b32 v63, 0xffff0000, v231
    v_lshlrev_b32 v64, 16, v232
    v_and_b32 v65, 0xffff0000, v232
    v_lshlrev_b32 v66, 16, v233
    v_and_b32 v67, 0xffff0000, v233
    v_lshlrev_b32 v68, 16, v234
    v_and_b32 v69, 0xffff0000, v234
    v_lshlrev_b32 v70, 16, v235
    v_and_b32 v71, 0xffff0000, v235
    v_lshlrev_b32 v72, 16, v236
    v_and_b32 v73, 0xffff0000, v236
    v_lshlrev_b32 v74, 16, v237
    v_and_b32 v75, 0xffff0000, v237
    v_lshlrev_b32 v76, 16, v238
    v_and_b32 v77, 0xffff0000, v238
    v_lshlrev_b32 v78, 16, v239
    v_and_b32 v79, 0xffff0000, v239
    v_lshlrev_b32 v80, 16, v240
    v_and_b32 v81, 0xffff0000, v240
    v_lshlrev_b32 v82, 16, v241
    v_and_b32 v83, 0xffff0000, v241
    v_lshlrev_b32 v84, 16, v242
    v_and_b32 v85, 0xffff0000, v242
    v_lshlrev_b32 v86, 16, v243
    v_and_b32 v87, 0xffff0000, v243
    v_add_f32 v120, v56, v72
    v_add_f32 v121, v57, v73
    v_add_f32 v122, v58, v74
    v_add_f32 v123, v59, v75
    v_add_f32 v124, v60, v76
    v_add_f32 v125, v61, v77
    v_add_f32 v126, v62, v78
    v_add_f32 v127, v63, v79
    v_add_f32 v128, v64, v80
    v_add_f32 v129, v65, v81
    v_add_f32 v130, v66, v82
    v_add_f32 v131, v67, v83
    v_add_f32 v132, v68, v84
    v_add_f32 v133, v69, v85
    v_add_f32 v134, v70, v86
    v_add_f32 v135, v71, v87
    v_add_f32 v120, v120, v128
    v_add_f32 v121, v121, v129
    v_add_f32 v122, v122, v130
    v_add_f32 v123, v123, v131
    v_add_f32 v124, v124, v132
    v_add_f32 v125, v125, v133
    v_add_f32 v126, v126, v134
    v_add_f32 v127, v127, v135
    v_add_f32 v120, v120, v124
    v_add_f32 v121, v121, v125
    v_add_f32 v122, v122, v126
    v_add_f32 v123, v123, v127
    v_add_f32 v120, v120, v122
    v_add_f32 v121, v121, v123
    v_add_f32 v120, v120, v121
    v_mov_b32 v121, v120
    s_nop 1
    v_permlane16_swap_b32 v121, v120
    v_add_f32 v120, v120, v121
    v_mov_b32 v121, v120
    s_nop 1
    v_permlane32_swap_b32 v121, v120
    v_add_f32 v120, v120, v121
    ds_write_b32 v248, v120 offset:0
    s_waitcnt lgkmcnt(0)
    s_barrier
    ds_read_b128 v[120:123], v247 offset:0
    ds_read_b128 v[124:127], v247 offset:16
    s_waitcnt lgkmcnt(0)
    v_add_f32 v120, v120, v124
    v_add_f32 v121, v121, v125
    v_add_f32 v122, v122, v126
    v_add_f32 v123, v123, v127
    v_add_f32 v120, v120, v122
    v_add_f32 v121, v121, v123
    v_add_f32 v120, v120, v121
    v_mul_f32 v250, 0x3a800000, v120
    v_sub_f32 v152, v56, v250
    v_sub_f32 v153, v57, v250
    v_sub_f32 v154, v58, v250
    v_sub_f32 v155, v59, v250
    v_sub_f32 v156, v60, v250
    v_sub_f32 v157, v61, v250
    v_sub_f32 v158, v62, v250
    v_sub_f32 v159, v63, v250
    v_sub_f32 v160, v64, v250
    v_sub_f32 v161, v65, v250
    v_sub_f32 v162, v66, v250
    v_sub_f32 v163, v67, v250
    v_sub_f32 v164, v68, v250
    v_sub_f32 v165, v69, v250
    v_sub_f32 v166, v70, v250
    v_sub_f32 v167, v71, v250
    v_sub_f32 v168, v72, v250
    v_sub_f32 v169, v73, v250
    v_sub_f32 v170, v74, v250
    v_sub_f32 v171, v75, v250
    v_sub_f32 v172, v76, v250
    v_sub_f32 v173, v77, v250
    v_sub_f32 v174, v78, v250
    v_sub_f32 v175, v79, v250
    v_sub_f32 v176, v80, v250
    v_sub_f32 v177, v81, v250
    v_sub_f32 v178, v82, v250
    v_sub_f32 v179, v83, v250
    v_sub_f32 v180, v84, v250
    v_sub_f32 v181, v85, v250
    v_sub_f32 v182, v86, v250
    v_sub_f32 v183, v87, v250
    v_mul_f32 v120, v152, v152
    v_fmac_f32 v120, v168, v168
    v_mul_f32 v121, v153, v153
    v_fmac_f32 v121, v169, v169
    v_mul_f32 v122, v154, v154
    v_fmac_f32 v122, v170, v170
    v_mul_f32 v123, v155, v155
    v_fmac_f32 v123, v171, v171
    v_mul_f32 v124, v156, v156
    v_fmac_f32 v124, v172, v172
    v_mul_f32 v125, v157, v157
    v_fmac_f32 v125, v173, v173
    v_mul_f32 v126, v158, v158
    v_fmac_f32 v126, v174, v174
    v_mul_f32 v127, v159, v159
    v_fmac_f32 v127, v175, v175
    v_mul_f32 v128, v160, v160
    v_fmac_f32 v128, v176, v176
    v_mul_f32 v129, v161, v161
    v_fmac_f32 v129, v177, v177
    v_mul_f32 v130, v162, v162
    v_fmac_f32 v130, v178, v178
    v_mul_f32 v131, v163, v163
    v_fmac_f32 v131, v179, v179
    v_mul_f32 v132, v164, v164
    v_fmac_f32 v132, v180, v180
    v_mul_f32 v133, v165, v165
    v_fmac_f32 v133, v181, v181
    v_mul_f32 v134, v166, v166
    v_fmac_f32 v134, v182, v182
    v_mul_f32 v135, v167, v167
    v_fmac_f32 v135, v183, v183
    v_add_f32 v120, v120, v128
    v_add_f32 v121, v121, v129
    v_add_f32 v122, v122, v130
    v_add_f32 v123, v123, v131
    v_add_f32 v124, v124, v132
    v_add_f32 v125, v125, v133
    v_add_f32 v126, v126, v134
    v_add_f32 v127, v127, v135
    v_add_f32 v120, v120, v124
    v_add_f32 v121, v121, v125
    v_add_f32 v122, v122, v126
    v_add_f32 v123, v123, v127
    v_add_f32 v120, v120, v122
    v_add_f32 v121, v121, v123
    v_add_f32 v120, v120, v121
    v_mov_b32 v121, v120
    s_nop 1
    v_permlane16_swap_b32 v121, v120
    v_add_f32 v120, v120, v121
    v_mov_b32 v121, v120
    s_nop 1
    v_permlane32_swap_b32 v121, v120
    v_add_f32 v120, v120, v121
    ds_write_b32 v248, v120 offset:512
    s_waitcnt lgkmcnt(0)
    s_barrier
    ds_read_b128 v[120:123], v247 offset:512
    ds_read_b128 v[124:127], v247 offset:528
    s_waitcnt lgkmcnt(0)
    v_add_f32 v120, v120, v124
    v_add_f32 v121, v121, v125
    v_add_f32 v122, v122, v126
    v_add_f32 v123, v123, v127
    v_add_f32 v120, v120, v122
    v_add_f32 v121, v121, v123
    v_add_f32 v120, v120, v121
    v_mul_f32 v251, 0x3a800000, v120
    v_cvt_pk_bf16_f32 v250, v250, v250
    v_lshlrev_b32 v250, 16, v250
    v_cvt_pk_bf16_f32 v251, v251, v251
    v_lshlrev_b32 v251, 16, v251
    v_add_f32 v251, 0x3727c5ac, v251
    v_cvt_pk_bf16_f32 v251, v251, v251
    v_lshlrev_b32 v251, 16, v251
    v_sqrt_f32 v251, v251
    s_nop 0
    v_cvt_pk_bf16_f32 v251, v251, v251
    v_lshlrev_b32 v251, 16, v251
    v_rcp_f32 v251, v251
    s_nop 0
    s_cmp_lg_u32 s3, 0
    s_cbranch_scc1 ln_nst
    s_lshl_b32 s77, s71, 7
    s_add_u32 s77, s77, 188743680
    v_lshlrev_b32 v249, 3, v245
    s_mov_b64 exec, 0xffff
    buffer_store_dwordx2 v[250:251], v249, s[4:7], s77 offen sc1
    s_mov_b64 exec, -1
ln_nst:
    v_sub_f32 v56, v56, v250
    v_sub_f32 v57, v57, v250
    v_cvt_pk_bf16_f32 v228, v56, v57
    v_lshlrev_b32 v56, 16, v228
    v_and_b32 v57, 0xffff0000, v228
    v_mul_f32 v56, v56, v251
    v_mul_f32 v57, v57, v251
    v_cvt_pk_bf16_f32 v228, v56, v57
    v_sub_f32 v58, v58, v250
    v_sub_f32 v59, v59, v250
    v_cvt_pk_bf16_f32 v229, v58, v59
    v_lshlrev_b32 v58, 16, v229
    v_and_b32 v59, 0xffff0000, v229
    v_mul_f32 v58, v58, v251
    v_mul_f32 v59, v59, v251
    v_cvt_pk_bf16_f32 v229, v58, v59
    v_sub_f32 v60, v60, v250
    v_sub_f32 v61, v61, v250
    v_cvt_pk_bf16_f32 v230, v60, v61
    v_lshlrev_b32 v60, 16, v230
    v_and_b32 v61, 0xffff0000, v230
    v_mul_f32 v60, v60, v251
    v_mul_f32 v61, v61, v251
    v_cvt_pk_bf16_f32 v230, v60, v61
    v_sub_f32 v62, v62, v250
    v_sub_f32 v63, v63, v250
    v_cvt_pk_bf16_f32 v231, v62, v63
    v_lshlrev_b32 v62, 16, v231
    v_and_b32 v63, 0xffff0000, v231
    v_mul_f32 v62, v62, v251
    v_mul_f32 v63, v63, v251
    v_cvt_pk_bf16_f32 v231, v62, v63
    v_cndmask_b32 v120, v228, v230, s[80:81]
    v_cndmask_b32 v121, v229, v231, s[80:81]
    v_cndmask_b32 v122, v230, v228, s[80:81]
    v_cndmask_b32 v123, v231, v229, s[80:81]
    buffer_store_dwordx4 v[120:123], v1, s[4:7], s75 offen offset:0 sc1
    v_sub_f32 v64, v64, v250
    v_sub_f32 v65, v65, v250
    v_cvt_pk_bf16_f32 v232, v64, v65
    v_lshlrev_b32 v64, 16, v232
    v_and_b32 v65, 0xffff0000, v232
    v_mul_f32 v64, v64, v251
    v_mul_f32 v65, v65, v251
    v_cvt_pk_bf16_f32 v232, v64, v65
    v_sub_f32 v66, v66, v250
    v_sub_f32 v67, v67, v250
    v_cvt_pk_bf16_f32 v233, v66, v67
    v_lshlrev_b32 v66, 16, v233
    v_and_b32 v67, 0xffff0000, v233
    v_mul_f32 v66, v66, v251
    v_mul_f32 v67, v67, v251
    v_cvt_pk_bf16_f32 v233, v66, v67
    v_sub_f32 v68, v68, v250
    v_sub_f32 v69, v69, v250
    v_cvt_pk_bf16_f32 v234, v68, v69
    v_lshlrev_b32 v68, 16, v234
    v_and_b32 v69, 0xffff0000, v234
    v_mul_f32 v68, v68, v251
    v_mul_f32 v69, v69, v251
    v_cvt_pk_bf16_f32 v234, v68, v69
    v_sub_f32 v70, v70, v250
    v_sub_f32 v71, v71, v250
    v_cvt_pk_bf16_f32 v235, v70, v71
    v_lshlrev_b32 v70, 16, v235
    v_and_b32 v71, 0xffff0000, v235
    v_mul_f32 v70, v70, v251
    v_mul_f32 v71, v71, v251
    v_cvt_pk_bf16_f32 v235, v70, v71
    v_cndmask_b32 v124, v232, v234, s[80:81]
    v_cndmask_b32 v125, v233, v235, s[80:81]
    v_cndmask_b32 v126, v234, v232, s[80:81]
    v_cndmask_b32 v127, v235, v233, s[80:81]
    buffer_store_dwordx4 v[124:127], v1, s[4:7], s75 offen offset:1024 sc1
    v_sub_f32 v72, v72, v250
    v_sub_f32 v73, v73, v250
    v_cvt_pk_bf16_f32 v236, v72, v73
    v_lshlrev_b32 v72, 16, v236
    v_and_b32 v73, 0xffff0000, v236
    v_mul_f32 v72, v72, v251
    v_mul_f32 v73, v73, v251
    v_cvt_pk_bf16_f32 v236, v72, v73
    v_sub_f32 v74, v74, v250
    v_sub_f32 v75, v75, v250
    v_cvt_pk_bf16_f32 v237, v74, v75
    v_lshlrev_b32 v74, 16, v237
    v_and_b32 v75, 0xffff0000, v237
    v_mul_f32 v74, v74, v251
    v_mul_f32 v75, v75, v251
    v_cvt_pk_bf16_f32 v237, v74, v75
    v_sub_f32 v76, v76, v250
    v_sub_f32 v77, v77, v250
    v_cvt_pk_bf16_f32 v238, v76, v77
    v_lshlrev_b32 v76, 16, v238
    v_and_b32 v77, 0xffff0000, v238
    v_mul_f32 v76, v76, v251
    v_mul_f32 v77, v77, v251
    v_cvt_pk_bf16_f32 v238, v76, v77
    v_sub_f32 v78, v78, v250
    v_sub_f32 v79, v79, v250
    v_cvt_pk_bf16_f32 v239, v78, v79
    v_lshlrev_b32 v78, 16, v239
    v_and_b32 v79, 0xffff0000, v239
    v_mul_f32 v78, v78, v251
    v_mul_f32 v79, v79, v251
    v_cvt_pk_bf16_f32 v239, v78, v79
    v_cndmask_b32 v128, v236, v238, s[80:81]
    v_cndmask_b32 v129, v237, v239, s[80:81]
    v_cndmask_b32 v130, v238, v236, s[80:81]
    v_cndmask_b32 v131, v239, v237, s[80:81]
    buffer_store_dwordx4 v[128:131], v1, s[4:7], s75 offen offset:2048 sc1
    v_sub_f32 v80, v80, v250
    v_sub_f32 v81, v81, v250
    v_cvt_pk_bf16_f32 v240, v80, v81
    v_lshlrev_b32 v80, 16, v240
    v_and_b32 v81, 0xffff0000, v240
    v_mul_f32 v80, v80, v251
    v_mul_f32 v81, v81, v251
    v_cvt_pk_bf16_f32 v240, v80, v81
    v_sub_f32 v82, v82, v250
    v_sub_f32 v83, v83, v250
    v_cvt_pk_bf16_f32 v241, v82, v83
    v_lshlrev_b32 v82, 16, v241
    v_and_b32 v83, 0xffff0000, v241
    v_mul_f32 v82, v82, v251
    v_mul_f32 v83, v83, v251
    v_cvt_pk_bf16_f32 v241, v82, v83
    v_sub_f32 v84, v84, v250
    v_sub_f32 v85, v85, v250
    v_cvt_pk_bf16_f32 v242, v84, v85
    v_lshlrev_b32 v84, 16, v242
    v_and_b32 v85, 0xffff0000, v242
    v_mul_f32 v84, v84, v251
    v_mul_f32 v85, v85, v251
    v_cvt_pk_bf16_f32 v242, v84, v85
    v_sub_f32 v86, v86, v250
    v_sub_f32 v87, v87, v250
    v_cvt_pk_bf16_f32 v243, v86, v87
    v_lshlrev_b32 v86, 16, v243
    v_and_b32 v87, 0xffff0000, v243
    v_mul_f32 v86, v86, v251
    v_mul_f32 v87, v87, v251
    v_cvt_pk_bf16_f32 v243, v86, v87
    v_cndmask_b32 v132, v240, v242, s[80:81]
    v_cndmask_b32 v133, v241, v243, s[80:81]
    v_cndmask_b32 v134, v242, v240, s[80:81]
    v_cndmask_b32 v135, v243, v241, s[80:81]
    buffer_store_dwordx4 v[132:135], v1, s[4:7], s75 offen offset:3072 sc1
    s_cmp_lg_u32 s98, 1
    s_cbranch_scc1 ln_now
    s_mov_b32 s98, 2
    s_branch w_adopt2
ln_now:
    v_mov_b32 v18, 1
    s_waitcnt vmcnt(0)
    s_barrier
    s_cmp_lg_u32 s3, 0
    s_cbranch_scc1 ln_sig
    s_mov_b64 exec, 1
    s_cmp_ge_u32 s71, 32
    s_cbranch_scc1 ln_sb
    buffer_atomic_add v18, off, s[64:67], 0 offset:192 sc1
ln_sb:
    buffer_atomic_add v18, off, s[64:67], 0 offset:0 sc1
    s_mov_b64 exec, -1
ln_sig:
    s_cmp_lt_u32 s63, 120
    s_cbranch_scc1 prb_done
    s_cmp_lg_u32 s3, 0
    s_cbranch_scc1 prb_bar
    s_sub_u32 s82, s63, 120
    s_lshl_b32 s83, s82, 7
    s_add_u32 s83, s83, 218112000
    s_lshl_b32 s84, s82, 10
    s_add_u32 s84, s84, 209715200
    s_mov_b32 s80, -1
    s_mov_b32 s81, -1
    s_mov_b64 exec, 1
    s_memtime s[74:75]
    s_add_u32 s87, s84, 0
    s_waitcnt lgkmcnt(0)
    buffer_load_dword v20, off, s[4:7], s87 sc1
    s_waitcnt vmcnt(0)
    s_memtime s[76:77]
    s_waitcnt lgkmcnt(0)
    s_sub_u32 s87, s76, s74
    s_min_u32 s80, s80, s87
    s_memtime s[74:75]
    s_add_u32 s87, s84, 8192
    s_waitcnt lgkmcnt(0)
    buffer_load_dword v20, off, s[4:7], s87 sc1
    s_waitcnt vmcnt(0)
    s_memtime s[76:77]
    s_waitcnt lgkmcnt(0)
    s_sub_u32 s87, s76, s74
    s_min_u32 s81, s81, s87
    s_memtime s[74:75]
    s_add_u32 s87, s84, 16384
    s_waitcnt lgkmcnt(0)
    buffer_load_dword v20, off, s[4:7], s87 sc1
    s_waitcnt vmcnt(0)
    s_memtime s[76:77]
    s_waitcnt lgkmcnt(0)
    s_sub_u32 s87, s76, s74
    s_min_u32 s80, s80, s87
    s_memtime s[74:75]
    s_add_u32 s87, s84, 24576
    s_waitcnt lgkmcnt(0)
    buffer_load_dword v20, off, s[4:7], s87 sc1
    s_waitcnt vmcnt(0)
    s_memtime s[76:77]
    s_waitcnt lgkmcnt(0)
    s_sub_u32 s87, s76, s74
    s_min_u32 s81, s81, s87
    s_memtime s[74:75]
    s_add_u32 s87, s84, 32768
    s_waitcnt lgkmcnt(0)
    buffer_load_dword v20, off, s[4:7], s87 sc1
    s_waitcnt vmcnt(0)
    s_memtime s[76:77]
    s_waitcnt lgkmcnt(0)
    s_sub_u32 s87, s76, s74
    s_min_u32 s80, s80, s87
    s_memtime s[74:75]
    s_add_u32 s87, s84, 40960
    s_waitcnt lgkmcnt(0)
    buffer_load_dword v20, off, s[4:7], s87 sc1
    s_waitcnt vmcnt(0)
    s_memtime s[76:77]
    s_waitcnt lgkmcnt(0)
    s_sub_u32 s87, s76, s74
    s_min_u32 s81, s81, s87
    s_memtime s[74:75]
    s_add_u32 s87, s84, 49152
    s_waitcnt lgkmcnt(0)
    buffer_load_dword v20, off, s[4:7], s87 sc1
    s_waitcnt vmcnt(0)
    s_memtime s[76:77]
    s_waitcnt lgkmcnt(0)
    s_sub_u32 s87, s76, s74
    s_min_u32 s80, s80, s87
    s_memtime s[74:75]
    s_add_u32 s87, s84, 57344
    s_waitcnt lgkmcnt(0)
    buffer_load_dword v20, off, s[4:7], s87 sc1
    s_waitcnt vmcnt(0)
    s_memtime s[76:77]
    s_waitcnt lgkmcnt(0)
    s_sub_u32 s87, s76, s74
    s_min_u32 s81, s81, s87
    s_memtime s[74:75]
    s_add_u32 s87, s84, 65536
    s_waitcnt lgkmcnt(0)
    buffer_load_dword v20, off, s[4:7], s87 sc1
    s_waitcnt vmcnt(0)
    s_memtime s[76:77]
    s_waitcnt lgkmcnt(0)
    s_sub_u32 s87, s76, s74
    s_min_u32 s80, s80, s87
    s_memtime s[74:75]
    s_add_u32 s87, s84, 73728
    s_waitcnt lgkmcnt(0)
    buffer_load_dword v20, off, s[4:7], s87 sc1
    s_waitcnt vmcnt(0)
    s_memtime s[76:77]
    s_waitcnt lgkmcnt(0)
    s_sub_u32 s87, s76, s74
    s_min_u32 s81, s81, s87
    s_memtime s[74:75]
    s_add_u32 s87, s84, 81920
    s_waitcnt lgkmcnt(0)
    buffer_load_dword v20, off, s[4:7], s87 sc1
    s_waitcnt vmcnt(0)
    s_memtime s[76:77]
    s_waitcnt lgkmcnt(0)
    s_sub_u32 s87, s76, s74
    s_min_u32 s80, s80, s87
    s_memtime s[74:75]
    s_add_u32 s87, s84, 90112
    s_waitcnt lgkmcnt(0)
    buffer_load_dword v20, off, s[4:7], s87 sc1
    s_waitcnt vmcnt(0)
    s_memtime s[76:77]
    s_waitcnt lgkmcnt(0)
    s_sub_u32 s87, s76, s74
    s_min_u32 s81, s81, s87
    s_sub_i32 s85, s80, s81
    s_min_i32 s85, s85, 400
    s_max_i32 s85, s85, -400
    s_lshl_b32 s85, s85, 8
    s_getreg_b32 s86, hwreg(HW_REG_XCC_ID)
    s_bfe_u32 s86, s86, 0x10002
    s_lshl_b32 s86, s86, 1
    s_or_b32 s85, s85, s86
    s_or_b32 s85, s85, 1
    s_mov_b32 s86, 65536
prb_i:
    buffer_load_dword v20, off, s[64:67], 0 offset:192 sc1
    s_waitcnt vmcnt(0)
    v_readfirstlane_b32 s84, v20
    s_cmp_ge_u32 s84, 32
    s_cbranch_scc1 prb_i_ok
    s_sleep 8
    s_sub_u32 s86, s86, 1
    s_cbranch_scc0 prb_i
prb_i_ok:
    v_mov_b32 v20, s85
    buffer_store_dword v20, off, s[4:7], s83 offset:8 sc1
    s_mov_b64 exec, -1
prb_bar:
    s_barrier
prb_done:
    s_cmp_lt_u32 s32, 4
    s_cbranch_scc1 w_nopre
    s_load_dwordx2 s[8:9], s[0:1], s33
    s_load_dwordx2 s[12:13], s[0:1], s34
    s_mov_b32 s10, s38
    s_mov_b32 s14, s38
    s_cmp_ge_u32 s32, 4
    s_cselect_b32 s31, 0, 1
    s_lshl_b32 s30, s3, s31
    s_mul_i32 s30, s30, s40
    s_add_u32 s16, s39, s30
    s_cmp_eq_u32 s32, 4
    s_cselect_b32 s30, 1024, s40
    s_cselect_b32 s31, 6, 5
    s_lshl_b32 s62, 32, s31
    s_add_u32 s17, s16, s30
    s_lshl_b32 s30, s3, 2
    s_mul_i32 s30, s30, s35
    s_add_u32 s18, s36, s30
    s_add_u32 s19, s37, s30
    s_lshl_b32 s20, s35, s31
    v_mul_u32_u24 v2, s35, v4
    v_add_u32 v2, v2, v3
    s_waitcnt lgkmcnt(0)
    s_add_u32 m0, s22, 0
    s_nop 0
    buffer_load_dwordx4 v2, s[8:11], s18 offen lds
    s_add_u32 s18, s18, s20
    s_add_u32 m0, s22, 8192
    s_nop 0
    buffer_load_dwordx4 v2, s[12:15], s19 offen lds
    s_add_u32 s19, s19, s20
    s_add_u32 m0, s22, 32768
    s_nop 0
    buffer_load_dwordx4 v2, s[8:11], s18 offen lds
    s_add_u32 s18, s18, s20
    s_add_u32 m0, s22, 40960
    s_nop 0
    buffer_load_dwordx4 v2, s[12:15], s19 offen lds
    s_add_u32 s19, s19, s20
    s_add_u32 m0, s22, 65536
    s_nop 0
    buffer_load_dwordx4 v2, s[8:11], s18 offen lds
    s_add_u32 s18, s18, s20
    s_add_u32 m0, s22, 73728
    s_nop 0
    buffer_load_dwordx4 v2, s[12:15], s19 offen lds
    s_add_u32 s19, s19, s20
    s_add_u32 m0, s22, 98304
    s_nop 0
    buffer_load_dwordx4 v2, s[8:11], s18 offen lds
    s_add_u32 s18, s18, s20
    s_add_u32 m0, s22, 106496
    s_nop 0
    buffer_load_dwordx4 v2, s[12:15], s19 offen lds
    s_add_u32 s19, s19, s20
    s_mov_b32 s70, 1
    s_cmp_lt_u32 s39, 1048576
    s_cselect_b32 s70, s70, 0
    s_cmp_lg_u32 s3, 0
    s_cbranch_scc1 lnwp_ok
    s_cmp_eq_u32 s70, 0
    s_cbranch_scc1 lnwp_full
    s_mov_b32 s69, 65536
lnwap:
    buffer_load_dword v20, off, s[64:67], 0 offset:192 sc1
    s_waitcnt vmcnt(0)
    v_readfirstlane_b32 s68, v20
    s_cmp_ge_u32 s68, 32
    s_cbranch_scc1 lnwap_ok
    s_sleep 8
    s_sub_u32 s69, s69, 1
    s_cbranch_scc0 lnwap
lnwap_ok:
    s_branch lnwp_ok
lnwp_full:
    s_mov_b32 s69, 65536
lnwp:
    buffer_load_dword v20, off, s[64:67], 0 offset:0 sc1
    s_waitcnt vmcnt(0)
    v_readfirstlane_b32 s68, v20
    s_cmp_ge_u32 s68, 128
    s_cbranch_scc1 lnwp_ok
    s_sleep 8
    s_sub_u32 s69, s69, 1
    s_cbranch_scc0 lnwp
lnwp_ok:
    s_barrier
    s_add_u32 m0, s21, 0
    s_nop 0
    buffer_load_dwordx4 v1, s[4:7], s16 offen sc1 lds
    s_add_u32 s16, s16, s62
    s_add_u32 m0, s21, 1024
    s_nop 0
    buffer_load_dwordx4 v1, s[4:7], s17 offen sc1 lds
    s_add_u32 s17, s17, s62
    s_add_u32 m0, s21, 32768
    s_nop 0
    buffer_load_dwordx4 v1, s[4:7], s16 offen sc1 lds
    s_add_u32 s16, s16, s62
    s_add_u32 m0, s21, 33792
    s_nop 0
    buffer_load_dwordx4 v1, s[4:7], s17 offen sc1 lds
    s_add_u32 s17, s17, s62
    s_add_u32 m0, s21, 65536
    s_nop 0
    buffer_load_dwordx4 v1, s[4:7], s16 offen sc1 lds
    s_add_u32 s16, s16, s62
    s_add_u32 m0, s21, 66560
    s_nop 0
    buffer_load_dwordx4 v1, s[4:7], s17 offen sc1 lds
    s_add_u32 s17, s17, s62
    s_add_u32 m0, s21, 98304
    s_nop 0
    buffer_load_dwordx4 v1, s[4:7], s16 offen sc1 lds
    s_add_u32 s16, s16, s62
    s_add_u32 m0, s21, 99328
    s_nop 0
    buffer_load_dwordx4 v1, s[4:7], s17 offen sc1 lds
    s_add_u32 s17, s17, s62
    s_branch w_adopt
w_nopre:
    s_mov_b32 s70, 1
    s_cmp_lt_u32 s39, 1048576
    s_cselect_b32 s70, s70, 0
    s_cmp_lg_u32 s3, 0
    s_cbranch_scc1 lnw_ok
    s_cmp_eq_u32 s70, 0
    s_cbranch_scc1 lnw_full
    s_mov_b32 s69, 65536
lnwa:
    buffer_load_dword v20, off, s[64:67], 0 offset:192 sc1
    s_waitcnt vmcnt(0)
    v_readfirstlane_b32 s68, v20
    s_cmp_ge_u32 s68, 32
    s_cbranch_scc1 lnwa_ok
    s_sleep 8
    s_sub_u32 s69, s69, 1
    s_cbranch_scc0 lnwa
lnwa_ok:
    s_branch lnw_ok
lnw_full:
    s_mov_b32 s69, 65536
lnw:
    buffer_load_dword v20, off, s[64:67], 0 offset:0 sc1
    s_waitcnt vmcnt(0)
    v_readfirstlane_b32 s68, v20
    s_cmp_ge_u32 s68, 128
    s_cbranch_scc1 lnw_ok
    s_sleep 8
    s_sub_u32 s69, s69, 1
    s_cbranch_scc0 lnw
lnw_ok:
    s_barrier
w_cold:
    s_cmp_eq_u32 s32, 0
    s_cbranch_scc1 fin_entry
    s_cmp_lg_u32 s3, 0
    s_cbranch_scc1 w_depok
    s_cmp_eq_u32 s45, 0
    s_cbranch_scc1 w_depok
    s_mov_b32 s31, 0x40000
w_waitdep:
    buffer_load_dword v16, v17, s[4:7], s44 offen sc1
    s_waitcnt vmcnt(0)
    v_readfirstlane_b32 s30, v16
    s_cmp_ge_u32 s30, s45
    s_cbranch_scc1 w_depok
    s_sleep 16
    s_sub_u32 s31, s31, 1
    s_cbranch_scc0 w_waitdep
w_depok:
    s_load_dwordx2 s[8:9], s[0:1], s33
    s_load_dwordx2 s[12:13], s[0:1], s34
    s_mov_b32 s10, s38
    s_mov_b32 s14, s38
    s_cmp_ge_u32 s32, 4
    s_cselect_b32 s31, 0, 1
    s_lshl_b32 s30, s3, s31
    s_mul_i32 s30, s30, s40
    s_add_u32 s16, s39, s30
    s_cmp_eq_u32 s32, 4
    s_cselect_b32 s30, 1024, s40
    s_cselect_b32 s31, 6, 5
    s_lshl_b32 s62, 32, s31
    s_add_u32 s17, s16, s30
    s_lshl_b32 s30, s3, 2
    s_mul_i32 s30, s30, s35
    s_add_u32 s18, s36, s30
    s_add_u32 s19, s37, s30
    s_lshl_b32 s20, s35, s31
    v_mul_u32_u24 v2, s35, v4
    v_add_u32 v2, v2, v3
    s_waitcnt lgkmcnt(0)
    s_barrier
    s_add_u32 m0, s21, 0
    s_nop 0
    buffer_load_dwordx4 v1, s[4:7], s16 offen sc1 lds
    s_add_u32 s16, s16, s62
    s_add_u32 m0, s21, 1024
    s_nop 0
    buffer_load_dwordx4 v1, s[4:7], s17 offen sc1 lds
    s_add_u32 s17, s17, s62
    s_add_u32 m0, s22, 0
    s_nop 0
    buffer_load_dwordx4 v2, s[8:11], s18 offen lds
    s_add_u32 s18, s18, s20
    s_add_u32 m0, s22, 8192
    s_nop 0
    buffer_load_dwordx4 v2, s[12:15], s19 offen lds
    s_add_u32 s19, s19, s20
    s_add_u32 m0, s21, 32768
    s_nop 0
    buffer_load_dwordx4 v1, s[4:7], s16 offen sc1 lds
    s_add_u32 s16, s16, s62
    s_add_u32 m0, s21, 33792
    s_nop 0
    buffer_load_dwordx4 v1, s[4:7], s17 offen sc1 lds
    s_add_u32 s17, s17, s62
    s_add_u32 m0, s22, 32768
    s_nop 0
    buffer_load_dwordx4 v2, s[8:11], s18 offen lds
    s_add_u32 s18, s18, s20
    s_add_u32 m0, s22, 40960
    s_nop 0
    buffer_load_dwordx4 v2, s[12:15], s19 offen lds
    s_add_u32 s19, s19, s20
    s_add_u32 m0, s21, 65536
    s_nop 0
    buffer_load_dwordx4 v1, s[4:7], s16 offen sc1 lds
    s_add_u32 s16, s16, s62
    s_add_u32 m0, s21, 66560
    s_nop 0
    buffer_load_dwordx4 v1, s[4:7], s17 offen sc1 lds
    s_add_u32 s17, s17, s62
    s_add_u32 m0, s22, 65536
    s_nop 0
    buffer_load_dwordx4 v2, s[8:11], s18 offen lds
    s_add_u32 s18, s18, s20
    s_add_u32 m0, s22, 73728
    s_nop 0
    buffer_load_dwordx4 v2, s[12:15], s19 offen lds
    s_add_u32 s19, s19, s20
    s_add_u32 m0, s21, 98304
    s_nop 0
    buffer_load_dwordx4 v1, s[4:7], s16 offen sc1 lds
    s_add_u32 s16, s16, s62
    s_add_u32 m0, s21, 99328
    s_nop 0
    buffer_load_dwordx4 v1, s[4:7], s17 offen sc1 lds
    s_add_u32 s17, s17, s62
    s_add_u32 m0, s22, 98304
    s_nop 0
    buffer_load_dwordx4 v2, s[8:11], s18 offen lds
    s_add_u32 s18, s18, s20
    s_add_u32 m0, s22, 106496
    s_nop 0
    buffer_load_dwordx4 v2, s[12:15], s19 offen lds
    s_add_u32 s19, s19, s20
w_adopt:
    s_cmp_eq_u32 s98, 1
    s_cbranch_scc1 ln_entry
w_adopt2:
    s_mov_b32 s48, s32
    s_cmp_ge_u32 s32, 4
    s_cselect_b32 s30, 2, 3
    s_lshl_b32 s30, s26, s30
    s_mul_i32 s30, s30, s43
    s_add_u32 s49, s42, s30
    s_mov_b32 s50, s43
    s_mov_b32 s51, s46
    s_mov_b32 s23, s41
    s_mov_b32 s53, s47
    s_nop 0
    s_load_dwordx16 s[32:47], s[24:25], 0
    s_add_u32 s24, s24, 64
    s_addc_u32 s25, s25, 0
    s_cmp_eq_u32 s48, 6
    s_cbranch_scc1 w_firstX
    s_waitcnt vmcnt(0)
    s_barrier
    s_cmp_lg_u32 s98, 2
    s_cbranch_scc1 lls_done
    s_mov_b32 s98, 0
    s_cmp_lg_u32 s3, 0
    s_cbranch_scc1 lls_done
    v_mov_b32 v20, 1
    s_mov_b64 exec, 1
    buffer_atomic_add v20, off, s[64:67], 0 offset:0 sc1
    s_mov_b64 exec, -1
lls_done:
    ds_read_b64_tr_b16 v[64:65], v8 offset:16384
    ds_read_b64_tr_b16 v[66:67], v9 offset:16384
    ds_read_b64_tr_b16 v[68:69], v10 offset:16384
    ds_read_b64_tr_b16 v[70:71], v11 offset:16384
    ds_read_b64_tr_b16 v[72:73], v8 offset:24576
    ds_read_b64_tr_b16 v[74:75], v9 offset:24576
    ds_read_b64_tr_b16 v[76:77], v10 offset:24576
    ds_read_b64_tr_b16 v[78:79], v11 offset:24576
    ds_read_b128 v[32:35], v5 offset:0
    ds_read_b128 v[36:39], v5 offset:1024
    ds_read_b128 v[40:43], v5 offset:2048
    ds_read_b128 v[44:47], v5 offset:3072
    ds_read_b128 v[48:51], v5 offset:4096
    ds_read_b128 v[52:55], v5 offset:5120
    ds_read_b128 v[56:59], v5 offset:6144
    ds_read_b128 v[60:63], v5 offset:7168
    s_waitcnt lgkmcnt(0)
    s_cmp_eq_u32 s48, 4
    s_cbranch_scc1 w_firstH
    s_cmp_eq_u32 s48, 5
    s_cbranch_scc1 w_firstM
    s_branch w_first16
w_first4:
    s_waitcnt vmcnt(12)
    s_barrier
    v_mfma_f32_16x16x32_bf16 v[128:131], v[64:67], v[32:35], 0
    ds_read_b64_tr_b16 v[112:113], v8 offset:49152
    v_mfma_f32_16x16x32_bf16 v[132:135], v[68:71], v[32:35], 0
    ds_read_b64_tr_b16 v[114:115], v9 offset:49152
    v_mfma_f32_16x16x32_bf16 v[136:139], v[72:75], v[32:35], 0
    ds_read_b64_tr_b16 v[116:117], v10 offset:49152
    v_mfma_f32_16x16x32_bf16 v[140:143], v[76:79], v[32:35], 0
    ds_read_b64_tr_b16 v[118:119], v11 offset:49152
    v_mfma_f32_16x16x32_bf16 v[144:147], v[64:67], v[36:39], 0
    ds_read_b64_tr_b16 v[120:121], v8 offset:57344
    v_mfma_f32_16x16x32_bf16 v[148:151], v[68:71], v[36:39], 0
    ds_read_b64_tr_b16 v[122:123], v9 offset:57344
    v_mfma_f32_16x16x32_bf16 v[152:155], v[72:75], v[36:39], 0
    ds_read_b64_tr_b16 v[124:125], v10 offset:57344
    v_mfma_f32_16x16x32_bf16 v[156:159], v[76:79], v[36:39], 0
    ds_read_b64_tr_b16 v[126:127], v11 offset:57344
    v_mfma_f32_16x16x32_bf16 v[160:163], v[64:67], v[40:43], 0
    ds_read_b128 v[80:83], v5 offset:32768
    v_mfma_f32_16x16x32_bf16 v[164:167], v[68:71], v[40:43], 0
    ds_read_b128 v[84:87], v5 offset:33792
    v_mfma_f32_16x16x32_bf16 v[168:171], v[72:75], v[40:43], 0
    ds_read_b128 v[88:91], v5 offset:34816
    v_mfma_f32_16x16x32_bf16 v[172:175], v[76:79], v[40:43], 0
    ds_read_b128 v[92:95], v5 offset:35840
    v_mfma_f32_16x16x32_bf16 v[176:179], v[64:67], v[44:47], 0
    ds_read_b128 v[96:99], v5 offset:36864
    v_mfma_f32_16x16x32_bf16 v[180:183], v[68:71], v[44:47], 0
    ds_read_b128 v[100:103], v5 offset:37888
    v_mfma_f32_16x16x32_bf16 v[184:187], v[72:75], v[44:47], 0
    ds_read_b128 v[104:107], v5 offset:38912
    v_mfma_f32_16x16x32_bf16 v[188:191], v[76:79], v[44:47], 0
    ds_read_b128 v[108:111], v5 offset:39936
    v_mfma_f32_16x16x32_bf16 v[192:195], v[64:67], v[48:51], 0
    v_mfma_f32_16x16x32_bf16 v[196:199], v[68:71], v[48:51], 0
    s_add_u32 m0, s21, 0
    s_nop 0
    buffer_load_dwordx4 v1, s[4:7], s16 offen sc1 lds
    s_add_u32 s16, s16, s62
    v_mfma_f32_16x16x32_bf16 v[200:203], v[72:75], v[48:51], 0
    v_mfma_f32_16x16x32_bf16 v[204:207], v[76:79], v[48:51], 0
    v_mfma_f32_16x16x32_bf16 v[208:211], v[64:67], v[52:55], 0
    s_add_u32 m0, s21, 1024
    s_nop 0
    buffer_load_dwordx4 v1, s[4:7], s17 offen sc1 lds
    s_add_u32 s17, s17, s62
    v_mfma_f32_16x16x32_bf16 v[212:215], v[68:71], v[52:55], 0
    v_mfma_f32_16x16x32_bf16 v[216:219], v[72:75], v[52:55], 0
    v_mfma_f32_16x16x32_bf16 v[220:223], v[76:79], v[52:55], 0
    s_add_u32 m0, s22, 0
    s_nop 0
    buffer_load_dwordx4 v2, s[8:11], s18 offen lds
    s_add_u32 s18, s18, s20
    v_mfma_f32_16x16x32_bf16 v[224:227], v[64:67], v[56:59], 0
    v_mfma_f32_16x16x32_bf16 v[228:231], v[68:71], v[56:59], 0
    v_mfma_f32_16x16x32_bf16 v[232:235], v[72:75], v[56:59], 0
    s_add_u32 m0, s22, 8192
    s_nop 0
    buffer_load_dwordx4 v2, s[12:15], s19 offen lds
    s_add_u32 s19, s19, s20
    v_mfma_f32_16x16x32_bf16 v[236:239], v[76:79], v[56:59], 0
    v_mfma_f32_16x16x32_bf16 v[240:243], v[64:67], v[60:63], 0
    v_mfma_f32_16x16x32_bf16 v[244:247], v[68:71], v[60:63], 0
    v_mfma_f32_16x16x32_bf16 v[248:251], v[72:75], v[60:63], 0
    v_mfma_f32_16x16x32_bf16 v[252:255], v[76:79], v[60:63], 0
    s_waitcnt lgkmcnt(0)
    s_waitcnt vmcnt(12)
    s_barrier
    v_mfma_f32_16x16x32_bf16 v[128:131], v[112:115], v[80:83], v[128:131]
    ds_read_b64_tr_b16 v[64:65], v12 offset:16384
    v_mfma_f32_16x16x32_bf16 v[132:135], v[116:119], v[80:83], v[132:135]
    ds_read_b64_tr_b16 v[66:67], v13 offset:16384
    v_mfma_f32_16x16x32_bf16 v[136:139], v[120:123], v[80:83], v[136:139]
    ds_read_b64_tr_b16 v[68:69], v14 offset:16384
    v_mfma_f32_16x16x32_bf16 v[140:143], v[124:127], v[80:83], v[140:143]
    ds_read_b64_tr_b16 v[70:71], v15 offset:16384
    v_mfma_f32_16x16x32_bf16 v[144:147], v[112:115], v[84:87], v[144:147]
    ds_read_b64_tr_b16 v[72:73], v12 offset:24576
    v_mfma_f32_16x16x32_bf16 v[148:151], v[116:119], v[84:87], v[148:151]
    ds_read_b64_tr_b16 v[74:75], v13 offset:24576
    v_mfma_f32_16x16x32_bf16 v[152:155], v[120:123], v[84:87], v[152:155]
    ds_read_b64_tr_b16 v[76:77], v14 offset:24576
    v_mfma_f32_16x16x32_bf16 v[156:159], v[124:127], v[84:87], v[156:159]
    ds_read_b64_tr_b16 v[78:79], v15 offset:24576
    v_mfma_f32_16x16x32_bf16 v[160:163], v[112:115], v[88:91], v[160:163]
    ds_read_b128 v[32:35], v6 offset:0
    v_mfma_f32_16x16x32_bf16 v[164:167], v[116:119], v[88:91], v[164:167]
    ds_read_b128 v[36:39], v6 offset:1024
    v_mfma_f32_16x16x32_bf16 v[168:171], v[120:123], v[88:91], v[168:171]
    ds_read_b128 v[40:43], v6 offset:2048
    v_mfma_f32_16x16x32_bf16 v[172:175], v[124:127], v[88:91], v[172:175]
    ds_read_b128 v[44:47], v6 offset:3072
    v_mfma_f32_16x16x32_bf16 v[176:179], v[112:115], v[92:95], v[176:179]
    ds_read_b128 v[48:51], v6 offset:4096
    v_mfma_f32_16x16x32_bf16 v[180:183], v[116:119], v[92:95], v[180:183]
    ds_read_b128 v[52:55], v6 offset:5120
    v_mfma_f32_16x16x32_bf16 v[184:187], v[120:123], v[92:95], v[184:187]
    ds_read_b128 v[56:59], v6 offset:6144
    v_mfma_f32_16x16x32_bf16 v[188:191], v[124:127], v[92:95], v[188:191]
    ds_read_b128 v[60:63], v6 offset:7168
    v_mfma_f32_16x16x32_bf16 v[192:195], v[112:115], v[96:99], v[192:195]
    v_mfma_f32_16x16x32_bf16 v[196:199], v[116:119], v[96:99], v[196:199]
    s_add_u32 m0, s21, 32768
    s_nop 0
    buffer_load_dwordx4 v1, s[4:7], s16 offen sc1 lds
    s_add_u32 s16, s16, s62
    v_mfma_f32_16x16x32_bf16 v[200:203], v[120:123], v[96:99], v[200:203]
    v_mfma_f32_16x16x32_bf16 v[204:207], v[124:127], v[96:99], v[204:207]
    v_mfma_f32_16x16x32_bf16 v[208:211], v[112:115], v[100:103], v[208:211]
    s_add_u32 m0, s21, 33792
    s_nop 0
    buffer_load_dwordx4 v1, s[4:7], s17 offen sc1 lds
    s_add_u32 s17, s17, s62
    v_mfma_f32_16x16x32_bf16 v[212:215], v[116:119], v[100:103], v[212:215]
    v_mfma_f32_16x16x32_bf16 v[216:219], v[120:123], v[100:103], v[216:219]
    v_mfma_f32_16x16x32_bf16 v[220:223], v[124:127], v[100:103], v[220:223]
    s_add_u32 m0, s22, 32768
    s_nop 0
    buffer_load_dwordx4 v2, s[8:11], s18 offen lds
    s_add_u32 s18, s18, s20
    v_mfma_f32_16x16x32_bf16 v[224:227], v[112:115], v[104:107], v[224:227]
    v_mfma_f32_16x16x32_bf16 v[228:231], v[116:119], v[104:107], v[228:231]
    v_mfma_f32_16x16x32_bf16 v[232:235], v[120:123], v[104:107], v[232:235]
    s_add_u32 m0, s22, 40960
    s_nop 0
    buffer_load_dwordx4 v2, s[12:15], s19 offen lds
    s_add_u32 s19, s19, s20
    v_mfma_f32_16x16x32_bf16 v[236:239], v[124:127], v[104:107], v[236:239]
    v_mfma_f32_16x16x32_bf16 v[240:243], v[112:115], v[108:111], v[240:243]
    v_mfma_f32_16x16x32_bf16 v[244:247], v[116:119], v[108:111], v[244:247]
    v_mfma_f32_16x16x32_bf16 v[248:251], v[120:123], v[108:111], v[248:251]
    v_mfma_f32_16x16x32_bf16 v[252:255], v[124:127], v[108:111], v[252:255]
    s_waitcnt lgkmcnt(0)
    s_waitcnt vmcnt(12)
    s_barrier
    v_mfma_f32_16x16x32_bf16 v[128:131], v[64:67], v[32:35], v[128:131]
    ds_read_b64_tr_b16 v[112:113], v12 offset:49152
    v_mfma_f32_16x16x32_bf16 v[132:135], v[68:71], v[32:35], v[132:135]
    ds_read_b64_tr_b16 v[114:115], v13 offset:49152
    v_mfma_f32_16x16x32_bf16 v[136:139], v[72:75], v[32:35], v[136:139]
    ds_read_b64_tr_b16 v[116:117], v14 offset:49152
    v_mfma_f32_16x16x32_bf16 v[140:143], v[76:79], v[32:35], v[140:143]
    ds_read_b64_tr_b16 v[118:119], v15 offset:49152
    v_mfma_f32_16x16x32_bf16 v[144:147], v[64:67], v[36:39], v[144:147]
    ds_read_b64_tr_b16 v[120:121], v12 offset:57344
    v_mfma_f32_16x16x32_bf16 v[148:151], v[68:71], v[36:39], v[148:151]
    ds_read_b64_tr_b16 v[122:123], v13 offset:57344
    v_mfma_f32_16x16x32_bf16 v[152:155], v[72:75], v[36:39], v[152:155]
    ds_read_b64_tr_b16 v[124:125], v14 offset:57344
    v_mfma_f32_16x16x32_bf16 v[156:159], v[76:79], v[36:39], v[156:159]
    ds_read_b64_tr_b16 v[126:127], v15 offset:57344
    v_mfma_f32_16x16x32_bf16 v[160:163], v[64:67], v[40:43], v[160:163]
    ds_read_b128 v[80:83], v6 offset:32768
    v_mfma_f32_16x16x32_bf16 v[164:167], v[68:71], v[40:43], v[164:167]
    ds_read_b128 v[84:87], v6 offset:33792
    v_mfma_f32_16x16x32_bf16 v[168:171], v[72:75], v[40:43], v[168:171]
    ds_read_b128 v[88:91], v6 offset:34816
    v_mfma_f32_16x16x32_bf16 v[172:175], v[76:79], v[40:43], v[172:175]
    ds_read_b128 v[92:95], v6 offset:35840
    v_mfma_f32_16x16x32_bf16 v[176:179], v[64:67], v[44:47], v[176:179]
    ds_read_b128 v[96:99], v6 offset:36864
    v_mfma_f32_16x16x32_bf16 v[180:183], v[68:71], v[44:47], v[180:183]
    ds_read_b128 v[100:103], v6 offset:37888
    v_mfma_f32_16x16x32_bf16 v[184:187], v[72:75], v[44:47], v[184:187]
    ds_read_b128 v[104:107], v6 offset:38912
    v_mfma_f32_16x16x32_bf16 v[188:191], v[76:79], v[44:47], v[188:191]
    ds_read_b128 v[108:111], v6 offset:39936
    v_mfma_f32_16x16x32_bf16 v[192:195], v[64:67], v[48:51], v[192:195]
    v_mfma_f32_16x16x32_bf16 v[196:199], v[68:71], v[48:51], v[196:199]
    s_add_u32 m0, s21, 65536
    s_nop 0
    buffer_load_dwordx4 v1, s[4:7], s16 offen sc1 lds
    s_add_u32 s16, s16, s62
    v_mfma_f32_16x16x32_bf16 v[200:203], v[72:75], v[48:51], v[200:203]
    v_mfma_f32_16x16x32_bf16 v[204:207], v[76:79], v[48:51], v[204:207]
    v_mfma_f32_16x16x32_bf16 v[208:211], v[64:67], v[52:55], v[208:211]
    s_add_u32 m0, s21, 66560
    s_nop 0
    buffer_load_dwordx4 v1, s[4:7], s17 offen sc1 lds
    s_add_u32 s17, s17, s62
    v_mfma_f32_16x16x32_bf16 v[212:215], v[68:71], v[52:55], v[212:215]
    v_mfma_f32_16x16x32_bf16 v[216:219], v[72:75], v[52:55], v[216:219]
    v_mfma_f32_16x16x32_bf16 v[220:223], v[76:79], v[52:55], v[220:223]
    s_add_u32 m0, s22, 65536
    s_nop 0
    buffer_load_dwordx4 v2, s[8:11], s18 offen lds
    s_add_u32 s18, s18, s20
    v_mfma_f32_16x16x32_bf16 v[224:227], v[64:67], v[56:59], v[224:227]
    v_mfma_f32_16x16x32_bf16 v[228:231], v[68:71], v[56:59], v[228:231]
    v_mfma_f32_16x16x32_bf16 v[232:235], v[72:75], v[56:59], v[232:235]
    s_add_u32 m0, s22, 73728
    s_nop 0
    buffer_load_dwordx4 v2, s[12:15], s19 offen lds
    s_add_u32 s19, s19, s20
    v_mfma_f32_16x16x32_bf16 v[236:239], v[76:79], v[56:59], v[236:239]
    v_mfma_f32_16x16x32_bf16 v[240:243], v[64:67], v[60:63], v[240:243]
    v_mfma_f32_16x16x32_bf16 v[244:247], v[68:71], v[60:63], v[244:247]
    v_mfma_f32_16x16x32_bf16 v[248:251], v[72:75], v[60:63], v[248:251]
    v_mfma_f32_16x16x32_bf16 v[252:255], v[76:79], v[60:63], v[252:255]
    s_waitcnt lgkmcnt(0)
    s_waitcnt vmcnt(8)
    s_barrier
    s_cmp_eq_u32 s28, 0
    s_cbranch_scc1 sig_2
    s_cmp_lg_u32 s3, 0
    s_cbranch_scc1 sig_2
    s_mov_b64 exec, 1
    v_mov_b32 v18, s57
    buffer_atomic_add v18, v17, s[4:7], s28 offen sc1
    s_mov_b64 exec, -1
sig_2:
    s_mov_b32 s28, 0
    v_mfma_f32_16x16x32_bf16 v[128:131], v[112:115], v[80:83], v[128:131]
    ds_read_b64_tr_b16 v[64:65], v8 offset:16384
    v_mfma_f32_16x16x32_bf16 v[132:135], v[116:119], v[80:83], v[132:135]
    ds_read_b64_tr_b16 v[66:67], v9 offset:16384
    v_mfma_f32_16x16x32_bf16 v[136:139], v[120:123], v[80:83], v[136:139]
    ds_read_b64_tr_b16 v[68:69], v10 offset:16384
    v_mfma_f32_16x16x32_bf16 v[140:143], v[124:127], v[80:83], v[140:143]
    ds_read_b64_tr_b16 v[70:71], v11 offset:16384
    v_mfma_f32_16x16x32_bf16 v[144:147], v[112:115], v[84:87], v[144:147]
    ds_read_b64_tr_b16 v[72:73], v8 offset:24576
    v_mfma_f32_16x16x32_bf16 v[148:151], v[116:119], v[84:87], v[148:151]
    ds_read_b64_tr_b16 v[74:75], v9 offset:24576
    v_mfma_f32_16x16x32_bf16 v[152:155], v[120:123], v[84:87], v[152:155]
    ds_read_b64_tr_b16 v[76:77], v10 offset:24576
    v_mfma_f32_16x16x32_bf16 v[156:159], v[124:127], v[84:87], v[156:159]
    ds_read_b64_tr_b16 v[78:79], v11 offset:24576
    v_mfma_f32_16x16x32_bf16 v[160:163], v[112:115], v[88:91], v[160:163]
    ds_read_b128 v[32:35], v5 offset:0
    v_mfma_f32_16x16x32_bf16 v[164:167], v[116:119], v[88:91], v[164:167]
    ds_read_b128 v[36:39], v5 offset:1024
    v_mfma_f32_16x16x32_bf16 v[168:171], v[120:123], v[88:91], v[168:171]
    ds_read_b128 v[40:43], v5 offset:2048
    v_mfma_f32_16x16x32_bf16 v[172:175], v[124:127], v[88:91], v[172:175]
    ds_read_b128 v[44:47], v5 offset:3072
    v_mfma_f32_16x16x32_bf16 v[176:179], v[112:115], v[92:95], v[176:179]
    ds_read_b128 v[48:51], v5 offset:4096
    v_mfma_f32_16x16x32_bf16 v[180:183], v[116:119], v[92:95], v[180:183]
    ds_read_b128 v[52:55], v5 offset:5120
    v_mfma_f32_16x16x32_bf16 v[184:187], v[120:123], v[92:95], v[184:187]
    ds_read_b128 v[56:59], v5 offset:6144
    v_mfma_f32_16x16x32_bf16 v[188:191], v[124:127], v[92:95], v[188:191]
    ds_read_b128 v[60:63], v5 offset:7168
    v_mfma_f32_16x16x32_bf16 v[192:195], v[112:115], v[96:99], v[192:195]
    v_mfma_f32_16x16x32_bf16 v[196:199], v[116:119], v[96:99], v[196:199]
    s_add_u32 m0, s21, 98304
    s_nop 0
    buffer_load_dwordx4 v1, s[4:7], s16 offen sc1 lds
    s_add_u32 s16, s16, s62
    v_mfma_f32_16x16x32_bf16 v[200:203], v[120:123], v[96:99], v[200:203]
    v_mfma_f32_16x16x32_bf16 v[204:207], v[124:127], v[96:99], v[204:207]
    v_mfma_f32_16x16x32_bf16 v[208:211], v[112:115], v[100:103], v[208:211]
    s_add_u32 m0, s21, 99328
    s_nop 0
    buffer_load_dwordx4 v1, s[4:7], s17 offen sc1 lds
    s_add_u32 s17, s17, s62
    v_mfma_f32_16x16x32_bf16 v[212:215], v[116:119], v[100:103], v[212:215]
    v_mfma_f32_16x16x32_bf16 v[216:219], v[120:123], v[100:103], v[216:219]
    v_mfma_f32_16x16x32_bf16 v[220:223], v[124:127], v[100:103], v[220:223]
    s_add_u32 m0, s22, 98304
    s_nop 0
    buffer_load_dwordx4 v2, s[8:11], s18 offen lds
    s_add_u32 s18, s18, s20
    v_mfma_f32_16x16x32_bf16 v[224:227], v[112:115], v[104:107], v[224:227]
    v_mfma_f32_16x16x32_bf16 v[228:231], v[116:119], v[104:107], v[228:231]
    v_mfma_f32_16x16x32_bf16 v[232:235], v[120:123], v[104:107], v[232:235]
    s_add_u32 m0, s22, 106496
    s_nop 0
    buffer_load_dwordx4 v2, s[12:15], s19 offen lds
    s_add_u32 s19, s19, s20
    v_mfma_f32_16x16x32_bf16 v[236:239], v[124:127], v[104:107], v[236:239]
    v_mfma_f32_16x16x32_bf16 v[240:243], v[112:115], v[108:111], v[240:243]
    v_mfma_f32_16x16x32_bf16 v[244:247], v[116:119], v[108:111], v[244:247]
    v_mfma_f32_16x16x32_bf16 v[248:251], v[120:123], v[108:111], v[248:251]
    v_mfma_f32_16x16x32_bf16 v[252:255], v[124:127], v[108:111], v[252:255]
    s_waitcnt lgkmcnt(0)
    s_branch w_loop_chk
w_first8:
    s_waitcnt vmcnt(16)
    s_barrier
    v_mfma_f32_16x16x32_bf16 v[128:131], v[64:67], v[32:35], 0
    ds_read_b64_tr_b16 v[112:113], v8 offset:49152
    v_mfma_f32_16x16x32_bf16 v[132:135], v[68:71], v[32:35], 0
    ds_read_b64_tr_b16 v[114:115], v9 offset:49152
    v_mfma_f32_16x16x32_bf16 v[136:139], v[72:75], v[32:35], 0
    ds_read_b64_tr_b16 v[116:117], v10 offset:49152
    v_mfma_f32_16x16x32_bf16 v[140:143], v[76:79], v[32:35], 0
    ds_read_b64_tr_b16 v[118:119], v11 offset:49152
    v_mfma_f32_16x16x32_bf16 v[144:147], v[64:67], v[36:39], 0
    ds_read_b64_tr_b16 v[120:121], v8 offset:57344
    v_mfma_f32_16x16x32_bf16 v[148:151], v[68:71], v[36:39], 0
    ds_read_b64_tr_b16 v[122:123], v9 offset:57344
    v_mfma_f32_16x16x32_bf16 v[152:155], v[72:75], v[36:39], 0
    ds_read_b64_tr_b16 v[124:125], v10 offset:57344
    v_mfma_f32_16x16x32_bf16 v[156:159], v[76:79], v[36:39], 0
    ds_read_b64_tr_b16 v[126:127], v11 offset:57344
    v_mfma_f32_16x16x32_bf16 v[160:163], v[64:67], v[40:43], 0
    ds_read_b128 v[80:83], v5 offset:32768
    v_mfma_f32_16x16x32_bf16 v[164:167], v[68:71], v[40:43], 0
    ds_read_b128 v[84:87], v5 offset:33792
    v_mfma_f32_16x16x32_bf16 v[168:171], v[72:75], v[40:43], 0
    ds_read_b128 v[88:91], v5 offset:34816
    v_mfma_f32_16x16x32_bf16 v[172:175], v[76:79], v[40:43], 0
    ds_read_b128 v[92:95], v5 offset:35840
    v_mfma_f32_16x16x32_bf16 v[176:179], v[64:67], v[44:47], 0
    ds_read_b128 v[96:99], v5 offset:36864
    v_mfma_f32_16x16x32_bf16 v[180:183], v[68:71], v[44:47], 0
    ds_read_b128 v[100:103], v5 offset:37888
    v_mfma_f32_16x16x32_bf16 v[184:187], v[72:75], v[44:47], 0
    ds_read_b128 v[104:107], v5 offset:38912
    v_mfma_f32_16x16x32_bf16 v[188:191], v[76:79], v[44:47], 0
    ds_read_b128 v[108:111], v5 offset:39936
    v_mfma_f32_16x16x32_bf16 v[192:195], v[64:67], v[48:51], 0
    v_mfma_f32_16x16x32_bf16 v[196:199], v[68:71], v[48:51], 0
    s_add_u32 m0, s21, 0
    s_nop 0
    buffer_load_dwordx4 v1, s[4:7], s16 offen sc1 lds
    s_add_u32 s16, s16, s62
    v_mfma_f32_16x16x32_bf16 v[200:203], v[72:75], v[48:51], 0
    v_mfma_f32_16x16x32_bf16 v[204:207], v[76:79], v[48:51], 0
    v_mfma_f32_16x16x32_bf16 v[208:211], v[64:67], v[52:55], 0
    s_add_u32 m0, s21, 1024
    s_nop 0
    buffer_load_dwordx4 v1, s[4:7], s17 offen sc1 lds
    s_add_u32 s17, s17, s62
    v_mfma_f32_16x16x32_bf16 v[212:215], v[68:71], v[52:55], 0
    v_mfma_f32_16x16x32_bf16 v[216:219], v[72:75], v[52:55], 0
    v_mfma_f32_16x16x32_bf16 v[220:223], v[76:79], v[52:55], 0
    s_add_u32 m0, s22, 0
    s_nop 0
    buffer_load_dwordx4 v2, s[8:11], s18 offen lds
    s_add_u32 s18, s18, s20
    v_mfma_f32_16x16x32_bf16 v[224:227], v[64:67], v[56:59], 0
    v_mfma_f32_16x16x32_bf16 v[228:231], v[68:71], v[56:59], 0
    v_mfma_f32_16x16x32_bf16 v[232:235], v[72:75], v[56:59], 0
    s_add_u32 m0, s22, 8192
    s_nop 0
    buffer_load_dwordx4 v2, s[12:15], s19 offen lds
    s_add_u32 s19, s19, s20
    v_mfma_f32_16x16x32_bf16 v[236:239], v[76:79], v[56:59], 0
    v_mfma_f32_16x16x32_bf16 v[240:243], v[64:67], v[60:63], 0
    v_mfma_f32_16x16x32_bf16 v[244:247], v[68:71], v[60:63], 0
    v_mfma_f32_16x16x32_bf16 v[248:251], v[72:75], v[60:63], 0
    v_mfma_f32_16x16x32_bf16 v[252:255], v[76:79], v[60:63], 0
    s_waitcnt lgkmcnt(0)
    s_waitcnt vmcnt(16)
    s_barrier
    v_mfma_f32_16x16x32_bf16 v[128:131], v[112:115], v[80:83], v[128:131]
    ds_read_b64_tr_b16 v[64:65], v12 offset:16384
    v_mfma_f32_16x16x32_bf16 v[132:135], v[116:119], v[80:83], v[132:135]
    ds_read_b64_tr_b16 v[66:67], v13 offset:16384
    v_mfma_f32_16x16x32_bf16 v[136:139], v[120:123], v[80:83], v[136:139]
    ds_read_b64_tr_b16 v[68:69], v14 offset:16384
    v_mfma_f32_16x16x32_bf16 v[140:143], v[124:127], v[80:83], v[140:143]
    ds_read_b64_tr_b16 v[70:71], v15 offset:16384
    v_mfma_f32_16x16x32_bf16 v[144:147], v[112:115], v[84:87], v[144:147]
    ds_read_b64_tr_b16 v[72:73], v12 offset:24576
    v_mfma_f32_16x16x32_bf16 v[148:151], v[116:119], v[84:87], v[148:151]
    ds_read_b64_tr_b16 v[74:75], v13 offset:24576
    v_mfma_f32_16x16x32_bf16 v[152:155], v[120:123], v[84:87], v[152:155]
    ds_read_b64_tr_b16 v[76:77], v14 offset:24576
    v_mfma_f32_16x16x32_bf16 v[156:159], v[124:127], v[84:87], v[156:159]
    ds_read_b64_tr_b16 v[78:79], v15 offset:24576
    v_mfma_f32_16x16x32_bf16 v[160:163], v[112:115], v[88:91], v[160:163]
    ds_read_b128 v[32:35], v6 offset:0
    v_mfma_f32_16x16x32_bf16 v[164:167], v[116:119], v[88:91], v[164:167]
    ds_read_b128 v[36:39], v6 offset:1024
    v_mfma_f32_16x16x32_bf16 v[168:171], v[120:123], v[88:91], v[168:171]
    ds_read_b128 v[40:43], v6 offset:2048
    v_mfma_f32_16x16x32_bf16 v[172:175], v[124:127], v[88:91], v[172:175]
    ds_read_b128 v[44:47], v6 offset:3072
    v_mfma_f32_16x16x32_bf16 v[176:179], v[112:115], v[92:95], v[176:179]
    ds_read_b128 v[48:51], v6 offset:4096
    v_mfma_f32_16x16x32_bf16 v[180:183], v[116:119], v[92:95], v[180:183]
    ds_read_b128 v[52:55], v6 offset:5120
    v_mfma_f32_16x16x32_bf16 v[184:187], v[120:123], v[92:95], v[184:187]
    ds_read_b128 v[56:59], v6 offset:6144
    v_mfma_f32_16x16x32_bf16 v[188:191], v[124:127], v[92:95], v[188:191]
    ds_read_b128 v[60:63], v6 offset:7168
    v_mfma_f32_16x16x32_bf16 v[192:195], v[112:115], v[96:99], v[192:195]
    v_mfma_f32_16x16x32_bf16 v[196:199], v[116:119], v[96:99], v[196:199]
    s_add_u32 m0, s21, 32768
    s_nop 0
    buffer_load_dwordx4 v1, s[4:7], s16 offen sc1 lds
    s_add_u32 s16, s16, s62
    v_mfma_f32_16x16x32_bf16 v[200:203], v[120:123], v[96:99], v[200:203]
    v_mfma_f32_16x16x32_bf16 v[204:207], v[124:127], v[96:99], v[204:207]
    v_mfma_f32_16x16x32_bf16 v[208:211], v[112:115], v[100:103], v[208:211]
    s_add_u32 m0, s21, 33792
    s_nop 0
    buffer_load_dwordx4 v1, s[4:7], s17 offen sc1 lds
    s_add_u32 s17, s17, s62
    v_mfma_f32_16x16x32_bf16 v[212:215], v[116:119], v[100:103], v[212:215]
    v_mfma_f32_16x16x32_bf16 v[216:219], v[120:123], v[100:103], v[216:219]
    v_mfma_f32_16x16x32_bf16 v[220:223], v[124:127], v[100:103], v[220:223]
    s_add_u32 m0, s22, 32768
    s_nop 0
    buffer_load_dwordx4 v2, s[8:11], s18 offen lds
    s_add_u32 s18, s18, s20
    v_mfma_f32_16x16x32_bf16 v[224:227], v[112:115], v[104:107], v[224:227]
    v_mfma_f32_16x16x32_bf16 v[228:231], v[116:119], v[104:107], v[228:231]
    v_mfma_f32_16x16x32_bf16 v[232:235], v[120:123], v[104:107], v[232:235]
    s_add_u32 m0, s22, 40960
    s_nop 0
    buffer_load_dwordx4 v2, s[12:15], s19 offen lds
    s_add_u32 s19, s19, s20
    v_mfma_f32_16x16x32_bf16 v[236:239], v[124:127], v[104:107], v[236:239]
    v_mfma_f32_16x16x32_bf16 v[240:243], v[112:115], v[108:111], v[240:243]
    v_mfma_f32_16x16x32_bf16 v[244:247], v[116:119], v[108:111], v[244:247]
    v_mfma_f32_16x16x32_bf16 v[248:251], v[120:123], v[108:111], v[248:251]
    v_mfma_f32_16x16x32_bf16 v[252:255], v[124:127], v[108:111], v[252:255]
    s_waitcnt lgkmcnt(0)
    s_waitcnt vmcnt(16)
    s_barrier
    v_mfma_f32_16x16x32_bf16 v[128:131], v[64:67], v[32:35], v[128:131]
    ds_read_b64_tr_b16 v[112:113], v12 offset:49152
    v_mfma_f32_16x16x32_bf16 v[132:135], v[68:71], v[32:35], v[132:135]
    ds_read_b64_tr_b16 v[114:115], v13 offset:49152
    v_mfma_f32_16x16x32_bf16 v[136:139], v[72:75], v[32:35], v[136:139]
    ds_read_b64_tr_b16 v[116:117], v14 offset:49152
    v_mfma_f32_16x16x32_bf16 v[140:143], v[76:79], v[32:35], v[140:143]
    ds_read_b64_tr_b16 v[118:119], v15 offset:49152
    v_mfma_f32_16x16x32_bf16 v[144:147], v[64:67], v[36:39], v[144:147]
    ds_read_b64_tr_b16 v[120:121], v12 offset:57344
    v_mfma_f32_16x16x32_bf16 v[148:151], v[68:71], v[36:39], v[148:151]
    ds_read_b64_tr_b16 v[122:123], v13 offset:57344
    v_mfma_f32_16x16x32_bf16 v[152:155], v[72:75], v[36:39], v[152:155]
    ds_read_b64_tr_b16 v[124:125], v14 offset:57344
    v_mfma_f32_16x16x32_bf16 v[156:159], v[76:79], v[36:39], v[156:159]
    ds_read_b64_tr_b16 v[126:127], v15 offset:57344
    v_mfma_f32_16x16x32_bf16 v[160:163], v[64:67], v[40:43], v[160:163]
    ds_read_b128 v[80:83], v6 offset:32768
    v_mfma_f32_16x16x32_bf16 v[164:167], v[68:71], v[40:43], v[164:167]
    ds_read_b128 v[84:87], v6 offset:33792
    v_mfma_f32_16x16x32_bf16 v[168:171], v[72:75], v[40:43], v[168:171]
    ds_read_b128 v[88:91], v6 offset:34816
    v_mfma_f32_16x16x32_bf16 v[172:175], v[76:79], v[40:43], v[172:175]
    ds_read_b128 v[92:95], v6 offset:35840
    v_mfma_f32_16x16x32_bf16 v[176:179], v[64:67], v[44:47], v[176:179]
    ds_read_b128 v[96:99], v6 offset:36864
    v_mfma_f32_16x16x32_bf16 v[180:183], v[68:71], v[44:47], v[180:183]
    ds_read_b128 v[100:103], v6 offset:37888
    v_mfma_f32_16x16x32_bf16 v[184:187], v[72:75], v[44:47], v[184:187]
    ds_read_b128 v[104:107], v6 offset:38912
    v_mfma_f32_16x16x32_bf16 v[188:191], v[76:79], v[44:47], v[188:191]
    ds_read_b128 v[108:111], v6 offset:39936
    v_mfma_f32_16x16x32_bf16 v[192:195], v[64:67], v[48:51], v[192:195]
    v_mfma_f32_16x16x32_bf16 v[196:199], v[68:71], v[48:51], v[196:199]
    s_add_u32 m0, s21, 65536
    s_nop 0
    buffer_load_dwordx4 v1, s[4:7], s16 offen sc1 lds
    s_add_u32 s16, s16, s62
    v_mfma_f32_16x16x32_bf16 v[200:203], v[72:75], v[48:51], v[200:203]
    v_mfma_f32_16x16x32_bf16 v[204:207], v[76:79], v[48:51], v[204:207]
    v_mfma_f32_16x16x32_bf16 v[208:211], v[64:67], v[52:55], v[208:211]
    s_add_u32 m0, s21, 66560
    s_nop 0
    buffer_load_dwordx4 v1, s[4:7], s17 offen sc1 lds
    s_add_u32 s17, s17, s62
    v_mfma_f32_16x16x32_bf16 v[212:215], v[68:71], v[52:55], v[212:215]
    v_mfma_f32_16x16x32_bf16 v[216:219], v[72:75], v[52:55], v[216:219]
    v_mfma_f32_16x16x32_bf16 v[220:223], v[76:79], v[52:55], v[220:223]
    s_add_u32 m0, s22, 65536
    s_nop 0
    buffer_load_dwordx4 v2, s[8:11], s18 offen lds
    s_add_u32 s18, s18, s20
    v_mfma_f32_16x16x32_bf16 v[224:227], v[64:67], v[56:59], v[224:227]
    v_mfma_f32_16x16x32_bf16 v[228:231], v[68:71], v[56:59], v[228:231]
    v_mfma_f32_16x16x32_bf16 v[232:235], v[72:75], v[56:59], v[232:235]
    s_add_u32 m0, s22, 73728
    s_nop 0
    buffer_load_dwordx4 v2, s[12:15], s19 offen lds
    s_add_u32 s19, s19, s20
    v_mfma_f32_16x16x32_bf16 v[236:239], v[76:79], v[56:59], v[236:239]
    v_mfma_f32_16x16x32_bf16 v[240:243], v[64:67], v[60:63], v[240:243]
    v_mfma_f32_16x16x32_bf16 v[244:247], v[68:71], v[60:63], v[244:247]
    v_mfma_f32_16x16x32_bf16 v[248:251], v[72:75], v[60:63], v[248:251]
    v_mfma_f32_16x16x32_bf16 v[252:255], v[76:79], v[60:63], v[252:255]
    s_waitcnt lgkmcnt(0)
    s_waitcnt vmcnt(8)
    s_barrier
    s_cmp_eq_u32 s28, 0
    s_cbranch_scc1 sig_3
    s_cmp_lg_u32 s3, 0
    s_cbranch_scc1 sig_3
    s_mov_b64 exec, 1
    v_mov_b32 v18, s57
    buffer_atomic_add v18, v17, s[4:7], s28 offen sc1
    s_mov_b64 exec, -1
sig_3:
    s_mov_b32 s28, 0
    v_mfma_f32_16x16x32_bf16 v[128:131], v[112:115], v[80:83], v[128:131]
    ds_read_b64_tr_b16 v[64:65], v8 offset:16384
    v_mfma_f32_16x16x32_bf16 v[132:135], v[116:119], v[80:83], v[132:135]
    ds_read_b64_tr_b16 v[66:67], v9 offset:16384
    v_mfma_f32_16x16x32_bf16 v[136:139], v[120:123], v[80:83], v[136:139]
    ds_read_b64_tr_b16 v[68:69], v10 offset:16384
    v_mfma_f32_16x16x32_bf16 v[140:143], v[124:127], v[80:83], v[140:143]
    ds_read_b64_tr_b16 v[70:71], v11 offset:16384
    v_mfma_f32_16x16x32_bf16 v[144:147], v[112:115], v[84:87], v[144:147]
    ds_read_b64_tr_b16 v[72:73], v8 offset:24576
    v_mfma_f32_16x16x32_bf16 v[148:151], v[116:119], v[84:87], v[148:151]
    ds_read_b64_tr_b16 v[74:75], v9 offset:24576
    v_mfma_f32_16x16x32_bf16 v[152:155], v[120:123], v[84:87], v[152:155]
    ds_read_b64_tr_b16 v[76:77], v10 offset:24576
    v_mfma_f32_16x16x32_bf16 v[156:159], v[124:127], v[84:87], v[156:159]
    ds_read_b64_tr_b16 v[78:79], v11 offset:24576
    v_mfma_f32_16x16x32_bf16 v[160:163], v[112:115], v[88:91], v[160:163]
    ds_read_b128 v[32:35], v5 offset:0
    v_mfma_f32_16x16x32_bf16 v[164:167], v[116:119], v[88:91], v[164:167]
    ds_read_b128 v[36:39], v5 offset:1024
    v_mfma_f32_16x16x32_bf16 v[168:171], v[120:123], v[88:91], v[168:171]
    ds_read_b128 v[40:43], v5 offset:2048
    v_mfma_f32_16x16x32_bf16 v[172:175], v[124:127], v[88:91], v[172:175]
    ds_read_b128 v[44:47], v5 offset:3072
    v_mfma_f32_16x16x32_bf16 v[176:179], v[112:115], v[92:95], v[176:179]
    ds_read_b128 v[48:51], v5 offset:4096
    v_mfma_f32_16x16x32_bf16 v[180:183], v[116:119], v[92:95], v[180:183]
    ds_read_b128 v[52:55], v5 offset:5120
    v_mfma_f32_16x16x32_bf16 v[184:187], v[120:123], v[92:95], v[184:187]
    ds_read_b128 v[56:59], v5 offset:6144
    v_mfma_f32_16x16x32_bf16 v[188:191], v[124:127], v[92:95], v[188:191]
    ds_read_b128 v[60:63], v5 offset:7168
    v_mfma_f32_16x16x32_bf16 v[192:195], v[112:115], v[96:99], v[192:195]
    v_mfma_f32_16x16x32_bf16 v[196:199], v[116:119], v[96:99], v[196:199]
    s_add_u32 m0, s21, 98304
    s_nop 0
    buffer_load_dwordx4 v1, s[4:7], s16 offen sc1 lds
    s_add_u32 s16, s16, s62
    v_mfma_f32_16x16x32_bf16 v[200:203], v[120:123], v[96:99], v[200:203]
    v_mfma_f32_16x16x32_bf16 v[204:207], v[124:127], v[96:99], v[204:207]
    v_mfma_f32_16x16x32_bf16 v[208:211], v[112:115], v[100:103], v[208:211]
    s_add_u32 m0, s21, 99328
    s_nop 0
    buffer_load_dwordx4 v1, s[4:7], s17 offen sc1 lds
    s_add_u32 s17, s17, s62
    v_mfma_f32_16x16x32_bf16 v[212:215], v[116:119], v[100:103], v[212:215]
    v_mfma_f32_16x16x32_bf16 v[216:219], v[120:123], v[100:103], v[216:219]
    v_mfma_f32_16x16x32_bf16 v[220:223], v[124:127], v[100:103], v[220:223]
    s_add_u32 m0, s22, 98304
    s_nop 0
    buffer_load_dwordx4 v2, s[8:11], s18 offen lds
    s_add_u32 s18, s18, s20
    v_mfma_f32_16x16x32_bf16 v[224:227], v[112:115], v[104:107], v[224:227]
    v_mfma_f32_16x16x32_bf16 v[228:231], v[116:119], v[104:107], v[228:231]
    v_mfma_f32_16x16x32_bf16 v[232:235], v[120:123], v[104:107], v[232:235]
    s_add_u32 m0, s22, 106496
    s_nop 0
    buffer_load_dwordx4 v2, s[12:15], s19 offen lds
    s_add_u32 s19, s19, s20
    v_mfma_f32_16x16x32_bf16 v[236:239], v[124:127], v[104:107], v[236:239]
    v_mfma_f32_16x16x32_bf16 v[240:243], v[112:115], v[108:111], v[240:243]
    v_mfma_f32_16x16x32_bf16 v[244:247], v[116:119], v[108:111], v[244:247]
    v_mfma_f32_16x16x32_bf16 v[248:251], v[120:123], v[108:111], v[248:251]
    v_mfma_f32_16x16x32_bf16 v[252:255], v[124:127], v[108:111], v[252:255]
    s_waitcnt lgkmcnt(0)
    s_branch w_loop_chk
w_first16:
    s_waitcnt vmcnt(24)
    s_barrier
    v_mfma_f32_16x16x32_bf16 v[128:131], v[64:67], v[32:35], 0
    ds_read_b64_tr_b16 v[112:113], v8 offset:49152
    v_mfma_f32_16x16x32_bf16 v[132:135], v[68:71], v[32:35], 0
    ds_read_b64_tr_b16 v[114:115], v9 offset:49152
    v_mfma_f32_16x16x32_bf16 v[136:139], v[72:75], v[32:35], 0
    ds_read_b64_tr_b16 v[116:117], v10 offset:49152
    v_mfma_f32_16x16x32_bf16 v[140:143], v[76:79], v[32:35], 0
    ds_read_b64_tr_b16 v[118:119], v11 offset:49152
    v_mfma_f32_16x16x32_bf16 v[144:147], v[64:67], v[36:39], 0
    ds_read_b64_tr_b16 v[120:121], v8 offset:57344
    v_mfma_f32_16x16x32_bf16 v[148:151], v[68:71], v[36:39], 0
    ds_read_b64_tr_b16 v[122:123], v9 offset:57344
    v_mfma_f32_16x16x32_bf16 v[152:155], v[72:75], v[36:39], 0
    ds_read_b64_tr_b16 v[124:125], v10 offset:57344
    v_mfma_f32_16x16x32_bf16 v[156:159], v[76:79], v[36:39], 0
    ds_read_b64_tr_b16 v[126:127], v11 offset:57344
    v_mfma_f32_16x16x32_bf16 v[160:163], v[64:67], v[40:43], 0
    ds_read_b128 v[80:83], v5 offset:32768
    v_mfma_f32_16x16x32_bf16 v[164:167], v[68:71], v[40:43], 0
    ds_read_b128 v[84:87], v5 offset:33792
    v_mfma_f32_16x16x32_bf16 v[168:171], v[72:75], v[40:43], 0
    ds_read_b128 v[88:91], v5 offset:34816
    v_mfma_f32_16x16x32_bf16 v[172:175], v[76:79], v[40:43], 0
    ds_read_b128 v[92:95], v5 offset:35840
    v_mfma_f32_16x16x32_bf16 v[176:179], v[64:67], v[44:47], 0
    ds_read_b128 v[96:99], v5 offset:36864
    v_mfma_f32_16x16x32_bf16 v[180:183], v[68:71], v[44:47], 0
    ds_read_b128 v[100:103], v5 offset:37888
    v_mfma_f32_16x16x32_bf16 v[184:187], v[72:75], v[44:47], 0
    ds_read_b128 v[104:107], v5 offset:38912
    v_mfma_f32_16x16x32_bf16 v[188:191], v[76:79], v[44:47], 0
    ds_read_b128 v[108:111], v5 offset:39936
    v_mfma_f32_16x16x32_bf16 v[192:195], v[64:67], v[48:51], 0
    v_mfma_f32_16x16x32_bf16 v[196:199], v[68:71], v[48:51], 0
    s_add_u32 m0, s21, 0
    s_nop 0
    buffer_load_dwordx4 v1, s[4:7], s16 offen sc1 lds
    s_add_u32 s16, s16, s62
    v_mfma_f32_16x16x32_bf16 v[200:203], v[72:75], v[48:51], 0
    v_mfma_f32_16x16x32_bf16 v[204:207], v[76:79], v[48:51], 0
    v_mfma_f32_16x16x32_bf16 v[208:211], v[64:67], v[52:55], 0
    s_add_u32 m0, s21, 1024
    s_nop 0
    buffer_load_dwordx4 v1, s[4:7], s17 offen sc1 lds
    s_add_u32 s17, s17, s62
    v_mfma_f32_16x16x32_bf16 v[212:215], v[68:71], v[52:55], 0
    v_mfma_f32_16x16x32_bf16 v[216:219], v[72:75], v[52:55], 0
    v_mfma_f32_16x16x32_bf16 v[220:223], v[76:79], v[52:55], 0
    s_add_u32 m0, s22, 0
    s_nop 0
    buffer_load_dwordx4 v2, s[8:11], s18 offen lds
    s_add_u32 s18, s18, s20
    v_mfma_f32_16x16x32_bf16 v[224:227], v[64:67], v[56:59], 0
    v_mfma_f32_16x16x32_bf16 v[228:231], v[68:71], v[56:59], 0
    v_mfma_f32_16x16x32_bf16 v[232:235], v[72:75], v[56:59], 0
    s_add_u32 m0, s22, 8192
    s_nop 0
    buffer_load_dwordx4 v2, s[12:15], s19 offen lds
    s_add_u32 s19, s19, s20
    v_mfma_f32_16x16x32_bf16 v[236:239], v[76:79], v[56:59], 0
    v_mfma_f32_16x16x32_bf16 v[240:243], v[64:67], v[60:63], 0
    v_mfma_f32_16x16x32_bf16 v[244:247], v[68:71], v[60:63], 0
    v_mfma_f32_16x16x32_bf16 v[248:251], v[72:75], v[60:63], 0
    v_mfma_f32_16x16x32_bf16 v[252:255], v[76:79], v[60:63], 0
    s_waitcnt lgkmcnt(0)
    s_waitcnt vmcnt(24)
    s_barrier
    v_mfma_f32_16x16x32_bf16 v[128:131], v[112:115], v[80:83], v[128:131]
    ds_read_b64_tr_b16 v[64:65], v12 offset:16384
    v_mfma_f32_16x16x32_bf16 v[132:135], v[116:119], v[80:83], v[132:135]
    ds_read_b64_tr_b16 v[66:67], v13 offset:16384
    v_mfma_f32_16x16x32_bf16 v[136:139], v[120:123], v[80:83], v[136:139]
    ds_read_b64_tr_b16 v[68:69], v14 offset:16384
    v_mfma_f32_16x16x32_bf16 v[140:143], v[124:127], v[80:83], v[140:143]
    ds_read_b64_tr_b16 v[70:71], v15 offset:16384
    v_mfma_f32_16x16x32_bf16 v[144:147], v[112:115], v[84:87], v[144:147]
    ds_read_b64_tr_b16 v[72:73], v12 offset:24576
    v_mfma_f32_16x16x32_bf16 v[148:151], v[116:119], v[84:87], v[148:151]
    ds_read_b64_tr_b16 v[74:75], v13 offset:24576
    v_mfma_f32_16x16x32_bf16 v[152:155], v[120:123], v[84:87], v[152:155]
    ds_read_b64_tr_b16 v[76:77], v14 offset:24576
    v_mfma_f32_16x16x32_bf16 v[156:159], v[124:127], v[84:87], v[156:159]
    ds_read_b64_tr_b16 v[78:79], v15 offset:24576
    v_mfma_f32_16x16x32_bf16 v[160:163], v[112:115], v[88:91], v[160:163]
    ds_read_b128 v[32:35], v6 offset:0
    v_mfma_f32_16x16x32_bf16 v[164:167], v[116:119], v[88:91], v[164:167]
    ds_read_b128 v[36:39], v6 offset:1024
    v_mfma_f32_16x16x32_bf16 v[168:171], v[120:123], v[88:91], v[168:171]
    ds_read_b128 v[40:43], v6 offset:2048
    v_mfma_f32_16x16x32_bf16 v[172:175], v[124:127], v[88:91], v[172:175]
    ds_read_b128 v[44:47], v6 offset:3072
    v_mfma_f32_16x16x32_bf16 v[176:179], v[112:115], v[92:95], v[176:179]
    ds_read_b128 v[48:51], v6 offset:4096
    v_mfma_f32_16x16x32_bf16 v[180:183], v[116:119], v[92:95], v[180:183]
    ds_read_b128 v[52:55], v6 offset:5120
    v_mfma_f32_16x16x32_bf16 v[184:187], v[120:123], v[92:95], v[184:187]
    ds_read_b128 v[56:59], v6 offset:6144
    v_mfma_f32_16x16x32_bf16 v[188:191], v[124:127], v[92:95], v[188:191]
    ds_read_b128 v[60:63], v6 offset:7168
    v_mfma_f32_16x16x32_bf16 v[192:195], v[112:115], v[96:99], v[192:195]
    v_mfma_f32_16x16x32_bf16 v[196:199], v[116:119], v[96:99], v[196:199]
    s_add_u32 m0, s21, 32768
    s_nop 0
    buffer_load_dwordx4 v1, s[4:7], s16 offen sc1 lds
    s_add_u32 s16, s16, s62
    v_mfma_f32_16x16x32_bf16 v[200:203], v[120:123], v[96:99], v[200:203]
    v_mfma_f32_16x16x32_bf16 v[204:207], v[124:127], v[96:99], v[204:207]
    v_mfma_f32_16x16x32_bf16 v[208:211], v[112:115], v[100:103], v[208:211]
    s_add_u32 m0, s21, 33792
    s_nop 0
    buffer_load_dwordx4 v1, s[4:7], s17 offen sc1 lds
    s_add_u32 s17, s17, s62
    v_mfma_f32_16x16x32_bf16 v[212:215], v[116:119], v[100:103], v[212:215]
    v_mfma_f32_16x16x32_bf16 v[216:219], v[120:123], v[100:103], v[216:219]
    v_mfma_f32_16x16x32_bf16 v[220:223], v[124:127], v[100:103], v[220:223]
    s_add_u32 m0, s22, 32768
    s_nop 0
    buffer_load_dwordx4 v2, s[8:11], s18 offen lds
    s_add_u32 s18, s18, s20
    v_mfma_f32_16x16x32_bf16 v[224:227], v[112:115], v[104:107], v[224:227]
    v_mfma_f32_16x16x32_bf16 v[228:231], v[116:119], v[104:107], v[228:231]
    v_mfma_f32_16x16x32_bf16 v[232:235], v[120:123], v[104:107], v[232:235]
    s_add_u32 m0, s22, 40960
    s_nop 0
    buffer_load_dwordx4 v2, s[12:15], s19 offen lds
    s_add_u32 s19, s19, s20
    v_mfma_f32_16x16x32_bf16 v[236:239], v[124:127], v[104:107], v[236:239]
    v_mfma_f32_16x16x32_bf16 v[240:243], v[112:115], v[108:111], v[240:243]
    v_mfma_f32_16x16x32_bf16 v[244:247], v[116:119], v[108:111], v[244:247]
    v_mfma_f32_16x16x32_bf16 v[248:251], v[120:123], v[108:111], v[248:251]
    v_mfma_f32_16x16x32_bf16 v[252:255], v[124:127], v[108:111], v[252:255]
    s_waitcnt lgkmcnt(0)
    s_waitcnt vmcnt(24)
    s_barrier
    v_mfma_f32_16x16x32_bf16 v[128:131], v[64:67], v[32:35], v[128:131]
    ds_read_b64_tr_b16 v[112:113], v12 offset:49152
    v_mfma_f32_16x16x32_bf16 v[132:135], v[68:71], v[32:35], v[132:135]
    ds_read_b64_tr_b16 v[114:115], v13 offset:49152
    v_mfma_f32_16x16x32_bf16 v[136:139], v[72:75], v[32:35], v[136:139]
    ds_read_b64_tr_b16 v[116:117], v14 offset:49152
    v_mfma_f32_16x16x32_bf16 v[140:143], v[76:79], v[32:35], v[140:143]
    ds_read_b64_tr_b16 v[118:119], v15 offset:49152
    v_mfma_f32_16x16x32_bf16 v[144:147], v[64:67], v[36:39], v[144:147]
    ds_read_b64_tr_b16 v[120:121], v12 offset:57344
    v_mfma_f32_16x16x32_bf16 v[148:151], v[68:71], v[36:39], v[148:151]
    ds_read_b64_tr_b16 v[122:123], v13 offset:57344
    v_mfma_f32_16x16x32_bf16 v[152:155], v[72:75], v[36:39], v[152:155]
    ds_read_b64_tr_b16 v[124:125], v14 offset:57344
    v_mfma_f32_16x16x32_bf16 v[156:159], v[76:79], v[36:39], v[156:159]
    ds_read_b64_tr_b16 v[126:127], v15 offset:57344
    v_mfma_f32_16x16x32_bf16 v[160:163], v[64:67], v[40:43], v[160:163]
    ds_read_b128 v[80:83], v6 offset:32768
    v_mfma_f32_16x16x32_bf16 v[164:167], v[68:71], v[40:43], v[164:167]
    ds_read_b128 v[84:87], v6 offset:33792
    v_mfma_f32_16x16x32_bf16 v[168:171], v[72:75], v[40:43], v[168:171]
    ds_read_b128 v[88:91], v6 offset:34816
    v_mfma_f32_16x16x32_bf16 v[172:175], v[76:79], v[40:43], v[172:175]
    ds_read_b128 v[92:95], v6 offset:35840
    v_mfma_f32_16x16x32_bf16 v[176:179], v[64:67], v[44:47], v[176:179]
    ds_read_b128 v[96:99], v6 offset:36864
    v_mfma_f32_16x16x32_bf16 v[180:183], v[68:71], v[44:47], v[180:183]
    ds_read_b128 v[100:103], v6 offset:37888
    v_mfma_f32_16x16x32_bf16 v[184:187], v[72:75], v[44:47], v[184:187]
    ds_read_b128 v[104:107], v6 offset:38912
    v_mfma_f32_16x16x32_bf16 v[188:191], v[76:79], v[44:47], v[188:191]
    ds_read_b128 v[108:111], v6 offset:39936
    v_mfma_f32_16x16x32_bf16 v[192:195], v[64:67], v[48:51], v[192:195]
    v_mfma_f32_16x16x32_bf16 v[196:199], v[68:71], v[48:51], v[196:199]
    s_add_u32 m0, s21, 65536
    s_nop 0
    buffer_load_dwordx4 v1, s[4:7], s16 offen sc1 lds
    s_add_u32 s16, s16, s62
    v_mfma_f32_16x16x32_bf16 v[200:203], v[72:75], v[48:51], v[200:203]
    v_mfma_f32_16x16x32_bf16 v[204:207], v[76:79], v[48:51], v[204:207]
    v_mfma_f32_16x16x32_bf16 v[208:211], v[64:67], v[52:55], v[208:211]
    s_add_u32 m0, s21, 66560
    s_nop 0
    buffer_load_dwordx4 v1, s[4:7], s17 offen sc1 lds
    s_add_u32 s17, s17, s62
    v_mfma_f32_16x16x32_bf16 v[212:215], v[68:71], v[52:55], v[212:215]
    v_mfma_f32_16x16x32_bf16 v[216:219], v[72:75], v[52:55], v[216:219]
    v_mfma_f32_16x16x32_bf16 v[220:223], v[76:79], v[52:55], v[220:223]
    s_add_u32 m0, s22, 65536
    s_nop 0
    buffer_load_dwordx4 v2, s[8:11], s18 offen lds
    s_add_u32 s18, s18, s20
    v_mfma_f32_16x16x32_bf16 v[224:227], v[64:67], v[56:59], v[224:227]
    v_mfma_f32_16x16x32_bf16 v[228:231], v[68:71], v[56:59], v[228:231]
    v_mfma_f32_16x16x32_bf16 v[232:235], v[72:75], v[56:59], v[232:235]
    s_add_u32 m0, s22, 73728
    s_nop 0
    buffer_load_dwordx4 v2, s[12:15], s19 offen lds
    s_add_u32 s19, s19, s20
    v_mfma_f32_16x16x32_bf16 v[236:239], v[76:79], v[56:59], v[236:239]
    v_mfma_f32_16x16x32_bf16 v[240:243], v[64:67], v[60:63], v[240:243]
    v_mfma_f32_16x16x32_bf16 v[244:247], v[68:71], v[60:63], v[244:247]
    v_mfma_f32_16x16x32_bf16 v[248:251], v[72:75], v[60:63], v[248:251]
    v_mfma_f32_16x16x32_bf16 v[252:255], v[76:79], v[60:63], v[252:255]
    s_waitcnt lgkmcnt(0)
    s_waitcnt vmcnt(8)
    s_barrier
    s_cmp_eq_u32 s28, 0
    s_cbranch_scc1 sig_4
    s_cmp_lg_u32 s3, 0
    s_cbranch_scc1 sig_4
    s_mov_b64 exec, 1
    v_mov_b32 v18, s57
    buffer_atomic_add v18, v17, s[4:7], s28 offen sc1
    s_mov_b64 exec, -1
sig_4:
    s_mov_b32 s28, 0
    v_mfma_f32_16x16x32_bf16 v[128:131], v[112:115], v[80:83], v[128:131]
    ds_read_b64_tr_b16 v[64:65], v8 offset:16384
    v_mfma_f32_16x16x32_bf16 v[132:135], v[116:119], v[80:83], v[132:135]
    ds_read_b64_tr_b16 v[66:67], v9 offset:16384
    v_mfma_f32_16x16x32_bf16 v[136:139], v[120:123], v[80:83], v[136:139]
    ds_read_b64_tr_b16 v[68:69], v10 offset:16384
    v_mfma_f32_16x16x32_bf16 v[140:143], v[124:127], v[80:83], v[140:143]
    ds_read_b64_tr_b16 v[70:71], v11 offset:16384
    v_mfma_f32_16x16x32_bf16 v[144:147], v[112:115], v[84:87], v[144:147]
    ds_read_b64_tr_b16 v[72:73], v8 offset:24576
    v_mfma_f32_16x16x32_bf16 v[148:151], v[116:119], v[84:87], v[148:151]
    ds_read_b64_tr_b16 v[74:75], v9 offset:24576
    v_mfma_f32_16x16x32_bf16 v[152:155], v[120:123], v[84:87], v[152:155]
    ds_read_b64_tr_b16 v[76:77], v10 offset:24576
    v_mfma_f32_16x16x32_bf16 v[156:159], v[124:127], v[84:87], v[156:159]
    ds_read_b64_tr_b16 v[78:79], v11 offset:24576
    v_mfma_f32_16x16x32_bf16 v[160:163], v[112:115], v[88:91], v[160:163]
    ds_read_b128 v[32:35], v5 offset:0
    v_mfma_f32_16x16x32_bf16 v[164:167], v[116:119], v[88:91], v[164:167]
    ds_read_b128 v[36:39], v5 offset:1024
    v_mfma_f32_16x16x32_bf16 v[168:171], v[120:123], v[88:91], v[168:171]
    ds_read_b128 v[40:43], v5 offset:2048
    v_mfma_f32_16x16x32_bf16 v[172:175], v[124:127], v[88:91], v[172:175]
    ds_read_b128 v[44:47], v5 offset:3072
    v_mfma_f32_16x16x32_bf16 v[176:179], v[112:115], v[92:95], v[176:179]
    ds_read_b128 v[48:51], v5 offset:4096
    v_mfma_f32_16x16x32_bf16 v[180:183], v[116:119], v[92:95], v[180:183]
    ds_read_b128 v[52:55], v5 offset:5120
    v_mfma_f32_16x16x32_bf16 v[184:187], v[120:123], v[92:95], v[184:187]
    ds_read_b128 v[56:59], v5 offset:6144
    v_mfma_f32_16x16x32_bf16 v[188:191], v[124:127], v[92:95], v[188:191]
    ds_read_b128 v[60:63], v5 offset:7168
    v_mfma_f32_16x16x32_bf16 v[192:195], v[112:115], v[96:99], v[192:195]
    v_mfma_f32_16x16x32_bf16 v[196:199], v[116:119], v[96:99], v[196:199]
    s_add_u32 m0, s21, 98304
    s_nop 0
    buffer_load_dwordx4 v1, s[4:7], s16 offen sc1 lds
    s_add_u32 s16, s16, s62
    v_mfma_f32_16x16x32_bf16 v[200:203], v[120:123], v[96:99], v[200:203]
    v_mfma_f32_16x16x32_bf16 v[204:207], v[124:127], v[96:99], v[204:207]
    v_mfma_f32_16x16x32_bf16 v[208:211], v[112:115], v[100:103], v[208:211]
    s_add_u32 m0, s21, 99328
    s_nop 0
    buffer_load_dwordx4 v1, s[4:7], s17 offen sc1 lds
    s_add_u32 s17, s17, s62
    v_mfma_f32_16x16x32_bf16 v[212:215], v[116:119], v[100:103], v[212:215]
    v_mfma_f32_16x16x32_bf16 v[216:219], v[120:123], v[100:103], v[216:219]
    v_mfma_f32_16x16x32_bf16 v[220:223], v[124:127], v[100:103], v[220:223]
    s_add_u32 m0, s22, 98304
    s_nop 0
    buffer_load_dwordx4 v2, s[8:11], s18 offen lds
    s_add_u32 s18, s18, s20
    v_mfma_f32_16x16x32_bf16 v[224:227], v[112:115], v[104:107], v[224:227]
    v_mfma_f32_16x16x32_bf16 v[228:231], v[116:119], v[104:107], v[228:231]
    v_mfma_f32_16x16x32_bf16 v[232:235], v[120:123], v[104:107], v[232:235]
    s_add_u32 m0, s22, 106496
    s_nop 0
    buffer_load_dwordx4 v2, s[12:15], s19 offen lds
    s_add_u32 s19, s19, s20
    v_mfma_f32_16x16x32_bf16 v[236:239], v[124:127], v[104:107], v[236:239]
    v_mfma_f32_16x16x32_bf16 v[240:243], v[112:115], v[108:111], v[240:243]
    v_mfma_f32_16x16x32_bf16 v[244:247], v[116:119], v[108:111], v[244:247]
    v_mfma_f32_16x16x32_bf16 v[248:251], v[120:123], v[108:111], v[248:251]
    v_mfma_f32_16x16x32_bf16 v[252:255], v[124:127], v[108:111], v[252:255]
    s_waitcnt lgkmcnt(0)
w_loop_chk:
    s_sub_u32 s23, s23, 1
w_loop:
    s_cmp_lg_u32 s23, 1
    s_cbranch_scc1 w_body
    v_readfirstlane_b32 s30, v16
    s_cmp_ge_u32 s30, s45
    s_cselect_b32 s30, 0, 1
    s_or_b32 s30, s30, s70
    s_cmp_ge_u32 s32, 4
    s_cselect_b32 s30, 1, s30
    s_cmp_eq_u32 s32, 0
    s_cselect_b32 s30, 1, s30
    v_mov_b32 v20, s30
    ds_write_b32 v7, v20
    s_cbranch_scc1 w_nd
    s_cmp_ge_u32 s32, 4
    s_cbranch_scc1 w_nd
    s_cmp_lg_u32 s70, 0
    s_cbranch_scc1 w_nd
    s_load_dwordx2 s[8:9], s[0:1], s33
    s_load_dwordx2 s[12:13], s[0:1], s34
    s_mov_b32 s10, s38
    s_mov_b32 s14, s38
    s_cmp_ge_u32 s32, 4
    s_cselect_b32 s31, 0, 1
    s_lshl_b32 s30, s3, s31
    s_mul_i32 s30, s30, s40
    s_add_u32 s16, s39, s30
    s_cmp_eq_u32 s32, 4
    s_cselect_b32 s30, 1024, s40
    s_cselect_b32 s31, 6, 5
    s_lshl_b32 s62, 32, s31
    s_add_u32 s17, s16, s30
    s_lshl_b32 s30, s3, 2
    s_mul_i32 s30, s30, s35
    s_add_u32 s18, s36, s30
    s_add_u32 s19, s37, s30
    s_lshl_b32 s20, s35, s31
    v_mul_u32_u24 v2, s35, v4
    v_add_u32 v2, v2, v3
    s_waitcnt lgkmcnt(0)
w_body:
    s_waitcnt vmcnt(8)
    s_barrier
    v_mfma_f32_16x16x32_bf16 v[128:131], v[64:67], v[32:35], v[128:131]
    ds_read_b64_tr_b16 v[112:113], v8 offset:49152
    v_mfma_f32_16x16x32_bf16 v[132:135], v[68:71], v[32:35], v[132:135]
    ds_read_b64_tr_b16 v[114:115], v9 offset:49152
    v_mfma_f32_16x16x32_bf16 v[136:139], v[72:75], v[32:35], v[136:139]
    ds_read_b64_tr_b16 v[116:117], v10 offset:49152
    v_mfma_f32_16x16x32_bf16 v[140:143], v[76:79], v[32:35], v[140:143]
    ds_read_b64_tr_b16 v[118:119], v11 offset:49152
    v_mfma_f32_16x16x32_bf16 v[144:147], v[64:67], v[36:39], v[144:147]
    ds_read_b64_tr_b16 v[120:121], v8 offset:57344
    v_mfma_f32_16x16x32_bf16 v[148:151], v[68:71], v[36:39], v[148:151]
    ds_read_b64_tr_b16 v[122:123], v9 offset:57344
    v_mfma_f32_16x16x32_bf16 v[152:155], v[72:75], v[36:39], v[152:155]
    ds_read_b64_tr_b16 v[124:125], v10 offset:57344
    v_mfma_f32_16x16x32_bf16 v[156:159], v[76:79], v[36:39], v[156:159]
    ds_read_b64_tr_b16 v[126:127], v11 offset:57344
    v_mfma_f32_16x16x32_bf16 v[160:163], v[64:67], v[40:43], v[160:163]
    ds_read_b128 v[80:83], v5 offset:32768
    v_mfma_f32_16x16x32_bf16 v[164:167], v[68:71], v[40:43], v[164:167]
    ds_read_b128 v[84:87], v5 offset:33792
    v_mfma_f32_16x16x32_bf16 v[168:171], v[72:75], v[40:43], v[168:171]
    ds_read_b128 v[88:91], v5 offset:34816
    v_mfma_f32_16x16x32_bf16 v[172:175], v[76:79], v[40:43], v[172:175]
    ds_read_b128 v[92:95], v5 offset:35840
    v_mfma_f32_16x16x32_bf16 v[176:179], v[64:67], v[44:47], v[176:179]
    ds_read_b128 v[96:99], v5 offset:36864
    v_mfma_f32_16x16x32_bf16 v[180:183], v[68:71], v[44:47], v[180:183]
    ds_read_b128 v[100:103], v5 offset:37888
    v_mfma_f32_16x16x32_bf16 v[184:187], v[72:75], v[44:47], v[184:187]
    ds_read_b128 v[104:107], v5 offset:38912
    v_mfma_f32_16x16x32_bf16 v[188:191], v[76:79], v[44:47], v[188:191]
    ds_read_b128 v[108:111], v5 offset:39936
    v_mfma_f32_16x16x32_bf16 v[192:195], v[64:67], v[48:51], v[192:195]
    v_mfma_f32_16x16x32_bf16 v[196:199], v[68:71], v[48:51], v[196:199]
    s_add_u32 m0, s21, 0
    s_nop 0
    buffer_load_dwordx4 v1, s[4:7], s16 offen sc1 lds
    s_add_u32 s16, s16, s62
    v_mfma_f32_16x16x32_bf16 v[200:203], v[72:75], v[48:51], v[200:203]
    v_mfma_f32_16x16x32_bf16 v[204:207], v[76:79], v[48:51], v[204:207]
    v_mfma_f32_16x16x32_bf16 v[208:211], v[64:67], v[52:55], v[208:211]
    s_add_u32 m0, s21, 1024
    s_nop 0
    buffer_load_dwordx4 v1, s[4:7], s17 offen sc1 lds
    s_add_u32 s17, s17, s62
    v_mfma_f32_16x16x32_bf16 v[212:215], v[68:71], v[52:55], v[212:215]
    v_mfma_f32_16x16x32_bf16 v[216:219], v[72:75], v[52:55], v[216:219]
    v_mfma_f32_16x16x32_bf16 v[220:223], v[76:79], v[52:55], v[220:223]
    s_add_u32 m0, s22, 0
    s_nop 0
    buffer_load_dwordx4 v2, s[8:11], s18 offen lds
    s_add_u32 s18, s18, s20
    v_mfma_f32_16x16x32_bf16 v[224:227], v[64:67], v[56:59], v[224:227]
    v_mfma_f32_16x16x32_bf16 v[228:231], v[68:71], v[56:59], v[228:231]
    v_mfma_f32_16x16x32_bf16 v[232:235], v[72:75], v[56:59], v[232:235]
    s_add_u32 m0, s22, 8192
    s_nop 0
    buffer_load_dwordx4 v2, s[12:15], s19 offen lds
    s_add_u32 s19, s19, s20
    v_mfma_f32_16x16x32_bf16 v[236:239], v[76:79], v[56:59], v[236:239]
    v_mfma_f32_16x16x32_bf16 v[240:243], v[64:67], v[60:63], v[240:243]
    v_mfma_f32_16x16x32_bf16 v[244:247], v[68:71], v[60:63], v[244:247]
    buffer_load_dword v16, v17, s[4:7], s44 offen sc1
    v_mfma_f32_16x16x32_bf16 v[248:251], v[72:75], v[60:63], v[248:251]
    v_mfma_f32_16x16x32_bf16 v[252:255], v[76:79], v[60:63], v[252:255]
    s_waitcnt lgkmcnt(0)
    s_waitcnt vmcnt(8)
    s_barrier
    v_mfma_f32_16x16x32_bf16 v[128:131], v[112:115], v[80:83], v[128:131]
    ds_read_b64_tr_b16 v[64:65], v12 offset:16384
    v_mfma_f32_16x16x32_bf16 v[132:135], v[116:119], v[80:83], v[132:135]
    ds_read_b64_tr_b16 v[66:67], v13 offset:16384
    v_mfma_f32_16x16x32_bf16 v[136:139], v[120:123], v[80:83], v[136:139]
    ds_read_b64_tr_b16 v[68:69], v14 offset:16384
    v_mfma_f32_16x16x32_bf16 v[140:143], v[124:127], v[80:83], v[140:143]
    ds_read_b64_tr_b16 v[70:71], v15 offset:16384
    v_mfma_f32_16x16x32_bf16 v[144:147], v[112:115], v[84:87], v[144:147]
    ds_read_b64_tr_b16 v[72:73], v12 offset:24576
    v_mfma_f32_16x16x32_bf16 v[148:151], v[116:119], v[84:87], v[148:151]
    ds_read_b64_tr_b16 v[74:75], v13 offset:24576
    v_mfma_f32_16x16x32_bf16 v[152:155], v[120:123], v[84:87], v[152:155]
    ds_read_b64_tr_b16 v[76:77], v14 offset:24576
    v_mfma_f32_16x16x32_bf16 v[156:159], v[124:127], v[84:87], v[156:159]
    ds_read_b64_tr_b16 v[78:79], v15 offset:24576
    v_mfma_f32_16x16x32_bf16 v[160:163], v[112:115], v[88:91], v[160:163]
    ds_read_b128 v[32:35], v6 offset:0
    v_mfma_f32_16x16x32_bf16 v[164:167], v[116:119], v[88:91], v[164:167]
    ds_read_b128 v[36:39], v6 offset:1024
    v_mfma_f32_16x16x32_bf16 v[168:171], v[120:123], v[88:91], v[168:171]
    ds_read_b128 v[40:43], v6 offset:2048
    v_mfma_f32_16x16x32_bf16 v[172:175], v[124:127], v[88:91], v[172:175]
    ds_read_b128 v[44:47], v6 offset:3072
    v_mfma_f32_16x16x32_bf16 v[176:179], v[112:115], v[92:95], v[176:179]
    ds_read_b128 v[48:51], v6 offset:4096
    v_mfma_f32_16x16x32_bf16 v[180:183], v[116:119], v[92:95], v[180:183]
    ds_read_b128 v[52:55], v6 offset:5120
    v_mfma_f32_16x16x32_bf16 v[184:187], v[120:123], v[92:95], v[184:187]
    ds_read_b128 v[56:59], v6 offset:6144
    v_mfma_f32_16x16x32_bf16 v[188:191], v[124:127], v[92:95], v[188:191]
    ds_read_b128 v[60:63], v6 offset:7168
    v_mfma_f32_16x16x32_bf16 v[192:195], v[112:115], v[96:99], v[192:195]
    v_mfma_f32_16x16x32_bf16 v[196:199], v[116:119], v[96:99], v[196:199]
    s_add_u32 m0, s21, 32768
    s_nop 0
    buffer_load_dwordx4 v1, s[4:7], s16 offen sc1 lds
    s_add_u32 s16, s16, s62
    v_mfma_f32_16x16x32_bf16 v[200:203], v[120:123], v[96:99], v[200:203]
    v_mfma_f32_16x16x32_bf16 v[204:207], v[124:127], v[96:99], v[204:207]
    v_mfma_f32_16x16x32_bf16 v[208:211], v[112:115], v[100:103], v[208:211]
    s_add_u32 m0, s21, 33792
    s_nop 0
    buffer_load_dwordx4 v1, s[4:7], s17 offen sc1 lds
    s_add_u32 s17, s17, s62
    v_mfma_f32_16x16x32_bf16 v[212:215], v[116:119], v[100:103], v[212:215]
    v_mfma_f32_16x16x32_bf16 v[216:219], v[120:123], v[100:103], v[216:219]
    v_mfma_f32_16x16x32_bf16 v[220:223], v[124:127], v[100:103], v[220:223]
    s_add_u32 m0, s22, 32768
    s_nop 0
    buffer_load_dwordx4 v2, s[8:11], s18 offen lds
    s_add_u32 s18, s18, s20
    v_mfma_f32_16x16x32_bf16 v[224:227], v[112:115], v[104:107], v[224:227]
    v_mfma_f32_16x16x32_bf16 v[228:231], v[116:119], v[104:107], v[228:231]
    v_mfma_f32_16x16x32_bf16 v[232:235], v[120:123], v[104:107], v[232:235]
    s_add_u32 m0, s22, 40960
    s_nop 0
    buffer_load_dwordx4 v2, s[12:15], s19 offen lds
    s_add_u32 s19, s19, s20
    v_mfma_f32_16x16x32_bf16 v[236:239], v[124:127], v[104:107], v[236:239]
    v_mfma_f32_16x16x32_bf16 v[240:243], v[112:115], v[108:111], v[240:243]
    v_mfma_f32_16x16x32_bf16 v[244:247], v[116:119], v[108:111], v[244:247]
    v_mfma_f32_16x16x32_bf16 v[248:251], v[120:123], v[108:111], v[248:251]
    v_mfma_f32_16x16x32_bf16 v[252:255], v[124:127], v[108:111], v[252:255]
    s_waitcnt lgkmcnt(0)
    s_waitcnt vmcnt(8)
    s_barrier
    v_mfma_f32_16x16x32_bf16 v[128:131], v[64:67], v[32:35], v[128:131]
    ds_read_b64_tr_b16 v[112:113], v12 offset:49152
    v_mfma_f32_16x16x32_bf16 v[132:135], v[68:71], v[32:35], v[132:135]
    ds_read_b64_tr_b16 v[114:115], v13 offset:49152
    v_mfma_f32_16x16x32_bf16 v[136:139], v[72:75], v[32:35], v[136:139]
    ds_read_b64_tr_b16 v[116:117], v14 offset:49152
    v_mfma_f32_16x16x32_bf16 v[140:143], v[76:79], v[32:35], v[140:143]
    ds_read_b64_tr_b16 v[118:119], v15 offset:49152
    v_mfma_f32_16x16x32_bf16 v[144:147], v[64:67], v[36:39], v[144:147]
    ds_read_b64_tr_b16 v[120:121], v12 offset:57344
    v_mfma_f32_16x16x32_bf16 v[148:151], v[68:71], v[36:39], v[148:151]
    ds_read_b64_tr_b16 v[122:123], v13 offset:57344
    v_mfma_f32_16x16x32_bf16 v[152:155], v[72:75], v[36:39], v[152:155]
    ds_read_b64_tr_b16 v[124:125], v14 offset:57344
    v_mfma_f32_16x16x32_bf16 v[156:159], v[76:79], v[36:39], v[156:159]
    ds_read_b64_tr_b16 v[126:127], v15 offset:57344
    v_mfma_f32_16x16x32_bf16 v[160:163], v[64:67], v[40:43], v[160:163]
    ds_read_b128 v[80:83], v6 offset:32768
    v_mfma_f32_16x16x32_bf16 v[164:167], v[68:71], v[40:43], v[164:167]
    ds_read_b128 v[84:87], v6 offset:33792
    v_mfma_f32_16x16x32_bf16 v[168:171], v[72:75], v[40:43], v[168:171]
    ds_read_b128 v[88:91], v6 offset:34816
    v_mfma_f32_16x16x32_bf16 v[172:175], v[76:79], v[40:43], v[172:175]
    ds_read_b128 v[92:95], v6 offset:35840
    v_mfma_f32_16x16x32_bf16 v[176:179], v[64:67], v[44:47], v[176:179]
    ds_read_b128 v[96:99], v6 offset:36864
    v_mfma_f32_16x16x32_bf16 v[180:183], v[68:71], v[44:47], v[180:183]
    ds_read_b128 v[100:103], v6 offset:37888
    v_mfma_f32_16x16x32_bf16 v[184:187], v[72:75], v[44:47], v[184:187]
    ds_read_b128 v[104:107], v6 offset:38912
    v_mfma_f32_16x16x32_bf16 v[188:191], v[76:79], v[44:47], v[188:191]
    ds_read_b128 v[108:111], v6 offset:39936
    v_mfma_f32_16x16x32_bf16 v[192:195], v[64:67], v[48:51], v[192:195]
    v_mfma_f32_16x16x32_bf16 v[196:199], v[68:71], v[48:51], v[196:199]
    s_add_u32 m0, s21, 65536
    s_nop 0
    buffer_load_dwordx4 v1, s[4:7], s16 offen sc1 lds
    s_add_u32 s16, s16, s62
    v_mfma_f32_16x16x32_bf16 v[200:203], v[72:75], v[48:51], v[200:203]
    v_mfma_f32_16x16x32_bf16 v[204:207], v[76:79], v[48:51], v[204:207]
    v_mfma_f32_16x16x32_bf16 v[208:211], v[64:67], v[52:55], v[208:211]
    s_add_u32 m0, s21, 66560
    s_nop 0
    buffer_load_dwordx4 v1, s[4:7], s17 offen sc1 lds
    s_add_u32 s17, s17, s62
    v_mfma_f32_16x16x32_bf16 v[212:215], v[68:71], v[52:55], v[212:215]
    v_mfma_f32_16x16x32_bf16 v[216:219], v[72:75], v[52:55], v[216:219]
    v_mfma_f32_16x16x32_bf16 v[220:223], v[76:79], v[52:55], v[220:223]
    s_add_u32 m0, s22, 65536
    s_nop 0
    buffer_load_dwordx4 v2, s[8:11], s18 offen lds
    s_add_u32 s18, s18, s20
    v_mfma_f32_16x16x32_bf16 v[224:227], v[64:67], v[56:59], v[224:227]
    v_mfma_f32_16x16x32_bf16 v[228:231], v[68:71], v[56:59], v[228:231]
    v_mfma_f32_16x16x32_bf16 v[232:235], v[72:75], v[56:59], v[232:235]
    s_add_u32 m0, s22, 73728
    s_nop 0
    buffer_load_dwordx4 v2, s[12:15], s19 offen lds
    s_add_u32 s19, s19, s20
    v_mfma_f32_16x16x32_bf16 v[236:239], v[76:79], v[56:59], v[236:239]
    v_mfma_f32_16x16x32_bf16 v[240:243], v[64:67], v[60:63], v[240:243]
    v_mfma_f32_16x16x32_bf16 v[244:247], v[68:71], v[60:63], v[244:247]
    v_mfma_f32_16x16x32_bf16 v[248:251], v[72:75], v[60:63], v[248:251]
    v_mfma_f32_16x16x32_bf16 v[252:255], v[76:79], v[60:63], v[252:255]
    s_waitcnt lgkmcnt(0)
    s_waitcnt vmcnt(8)
    s_barrier
    v_mfma_f32_16x16x32_bf16 v[128:131], v[112:115], v[80:83], v[128:131]
    ds_read_b64_tr_b16 v[64:65], v8 offset:16384
    v_mfma_f32_16x16x32_bf16 v[132:135], v[116:119], v[80:83], v[132:135]
    ds_read_b64_tr_b16 v[66:67], v9 offset:16384
    v_mfma_f32_16x16x32_bf16 v[136:139], v[120:123], v[80:83], v[136:139]
    ds_read_b64_tr_b16 v[68:69], v10 offset:16384
    v_mfma_f32_16x16x32_bf16 v[140:143], v[124:127], v[80:83], v[140:143]
    ds_read_b64_tr_b16 v[70:71], v11 offset:16384
    v_mfma_f32_16x16x32_bf16 v[144:147], v[112:115], v[84:87], v[144:147]
    ds_read_b64_tr_b16 v[72:73], v8 offset:24576
    v_mfma_f32_16x16x32_bf16 v[148:151], v[116:119], v[84:87], v[148:151]
    ds_read_b64_tr_b16 v[74:75], v9 offset:24576
    v_mfma_f32_16x16x32_bf16 v[152:155], v[120:123], v[84:87], v[152:155]
    ds_read_b64_tr_b16 v[76:77], v10 offset:24576
    v_mfma_f32_16x16x32_bf16 v[156:159], v[124:127], v[84:87], v[156:159]
    ds_read_b64_tr_b16 v[78:79], v11 offset:24576
    v_mfma_f32_16x16x32_bf16 v[160:163], v[112:115], v[88:91], v[160:163]
    ds_read_b128 v[32:35], v5 offset:0
    v_mfma_f32_16x16x32_bf16 v[164:167], v[116:119], v[88:91], v[164:167]
    ds_read_b128 v[36:39], v5 offset:1024
    v_mfma_f32_16x16x32_bf16 v[168:171], v[120:123], v[88:91], v[168:171]
    ds_read_b128 v[40:43], v5 offset:2048
    v_mfma_f32_16x16x32_bf16 v[172:175], v[124:127], v[88:91], v[172:175]
    ds_read_b128 v[44:47], v5 offset:3072
    v_mfma_f32_16x16x32_bf16 v[176:179], v[112:115], v[92:95], v[176:179]
    ds_read_b128 v[48:51], v5 offset:4096
    v_mfma_f32_16x16x32_bf16 v[180:183], v[116:119], v[92:95], v[180:183]
    ds_read_b128 v[52:55], v5 offset:5120
    v_mfma_f32_16x16x32_bf16 v[184:187], v[120:123], v[92:95], v[184:187]
    ds_read_b128 v[56:59], v5 offset:6144
    v_mfma_f32_16x16x32_bf16 v[188:191], v[124:127], v[92:95], v[188:191]
    ds_read_b128 v[60:63], v5 offset:7168
    v_mfma_f32_16x16x32_bf16 v[192:195], v[112:115], v[96:99], v[192:195]
    v_mfma_f32_16x16x32_bf16 v[196:199], v[116:119], v[96:99], v[196:199]
    s_add_u32 m0, s21, 98304
    s_nop 0
    buffer_load_dwordx4 v1, s[4:7], s16 offen sc1 lds
    s_add_u32 s16, s16, s62
    v_mfma_f32_16x16x32_bf16 v[200:203], v[120:123], v[96:99], v[200:203]
    v_mfma_f32_16x16x32_bf16 v[204:207], v[124:127], v[96:99], v[204:207]
    v_mfma_f32_16x16x32_bf16 v[208:211], v[112:115], v[100:103], v[208:211]
    s_add_u32 m0, s21, 99328
    s_nop 0
    buffer_load_dwordx4 v1, s[4:7], s17 offen sc1 lds
    s_add_u32 s17, s17, s62
    v_mfma_f32_16x16x32_bf16 v[212:215], v[116:119], v[100:103], v[212:215]
    v_mfma_f32_16x16x32_bf16 v[216:219], v[120:123], v[100:103], v[216:219]
    v_mfma_f32_16x16x32_bf16 v[220:223], v[124:127], v[100:103], v[220:223]
    s_add_u32 m0, s22, 98304
    s_nop 0
    buffer_load_dwordx4 v2, s[8:11], s18 offen lds
    s_add_u32 s18, s18, s20
    v_mfma_f32_16x16x32_bf16 v[224:227], v[112:115], v[104:107], v[224:227]
    v_mfma_f32_16x16x32_bf16 v[228:231], v[116:119], v[104:107], v[228:231]
    v_mfma_f32_16x16x32_bf16 v[232:235], v[120:123], v[104:107], v[232:235]
    s_add_u32 m0, s22, 106496
    s_nop 0
    buffer_load_dwordx4 v2, s[12:15], s19 offen lds
    s_add_u32 s19, s19, s20
    v_mfma_f32_16x16x32_bf16 v[236:239], v[124:127], v[104:107], v[236:239]
    v_mfma_f32_16x16x32_bf16 v[240:243], v[112:115], v[108:111], v[240:243]
    v_mfma_f32_16x16x32_bf16 v[244:247], v[116:119], v[108:111], v[244:247]
    v_mfma_f32_16x16x32_bf16 v[248:251], v[120:123], v[108:111], v[248:251]
    v_mfma_f32_16x16x32_bf16 v[252:255], v[124:127], v[108:111], v[252:255]
    s_waitcnt lgkmcnt(0)
    s_sub_u32 s23, s23, 1
    s_cmp_lg_u32 s23, 0
    s_cbranch_scc1 w_loop
    s_branch w_end
w_nd:
    s_waitcnt vmcnt(8)
    s_barrier
    v_mfma_f32_16x16x32_bf16 v[128:131], v[64:67], v[32:35], v[128:131]
    ds_read_b64_tr_b16 v[112:113], v8 offset:49152
    v_mfma_f32_16x16x32_bf16 v[132:135], v[68:71], v[32:35], v[132:135]
    ds_read_b64_tr_b16 v[114:115], v9 offset:49152
    v_mfma_f32_16x16x32_bf16 v[136:139], v[72:75], v[32:35], v[136:139]
    ds_read_b64_tr_b16 v[116:117], v10 offset:49152
    v_mfma_f32_16x16x32_bf16 v[140:143], v[76:79], v[32:35], v[140:143]
    ds_read_b64_tr_b16 v[118:119], v11 offset:49152
    v_mfma_f32_16x16x32_bf16 v[144:147], v[64:67], v[36:39], v[144:147]
    ds_read_b64_tr_b16 v[120:121], v8 offset:57344
    v_mfma_f32_16x16x32_bf16 v[148:151], v[68:71], v[36:39], v[148:151]
    ds_read_b64_tr_b16 v[122:123], v9 offset:57344
    v_mfma_f32_16x16x32_bf16 v[152:155], v[72:75], v[36:39], v[152:155]
    ds_read_b64_tr_b16 v[124:125], v10 offset:57344
    v_mfma_f32_16x16x32_bf16 v[156:159], v[76:79], v[36:39], v[156:159]
    ds_read_b64_tr_b16 v[126:127], v11 offset:57344
    v_mfma_f32_16x16x32_bf16 v[160:163], v[64:67], v[40:43], v[160:163]
    ds_read_b128 v[80:83], v5 offset:32768
    v_mfma_f32_16x16x32_bf16 v[164:167], v[68:71], v[40:43], v[164:167]
    ds_read_b128 v[84:87], v5 offset:33792
    v_mfma_f32_16x16x32_bf16 v[168:171], v[72:75], v[40:43], v[168:171]
    ds_read_b128 v[88:91], v5 offset:34816
    v_mfma_f32_16x16x32_bf16 v[172:175], v[76:79], v[40:43], v[172:175]
    ds_read_b128 v[92:95], v5 offset:35840
    v_mfma_f32_16x16x32_bf16 v[176:179], v[64:67], v[44:47], v[176:179]
    ds_read_b128 v[96:99], v5 offset:36864
    v_mfma_f32_16x16x32_bf16 v[180:183], v[68:71], v[44:47], v[180:183]
    ds_read_b128 v[100:103], v5 offset:37888
    v_mfma_f32_16x16x32_bf16 v[184:187], v[72:75], v[44:47], v[184:187]
    ds_read_b128 v[104:107], v5 offset:38912
    v_mfma_f32_16x16x32_bf16 v[188:191], v[76:79], v[44:47], v[188:191]
    ds_read_b128 v[108:111], v5 offset:39936
    v_mfma_f32_16x16x32_bf16 v[192:195], v[64:67], v[48:51], v[192:195]
    v_mfma_f32_16x16x32_bf16 v[196:199], v[68:71], v[48:51], v[196:199]
    v_mfma_f32_16x16x32_bf16 v[200:203], v[72:75], v[48:51], v[200:203]
    v_mfma_f32_16x16x32_bf16 v[204:207], v[76:79], v[48:51], v[204:207]
    v_mfma_f32_16x16x32_bf16 v[208:211], v[64:67], v[52:55], v[208:211]
    v_mfma_f32_16x16x32_bf16 v[212:215], v[68:71], v[52:55], v[212:215]
    v_mfma_f32_16x16x32_bf16 v[216:219], v[72:75], v[52:55], v[216:219]
    v_mfma_f32_16x16x32_bf16 v[220:223], v[76:79], v[52:55], v[220:223]
    v_mfma_f32_16x16x32_bf16 v[224:227], v[64:67], v[56:59], v[224:227]
    v_mfma_f32_16x16x32_bf16 v[228:231], v[68:71], v[56:59], v[228:231]
    v_mfma_f32_16x16x32_bf16 v[232:235], v[72:75], v[56:59], v[232:235]
    v_mfma_f32_16x16x32_bf16 v[236:239], v[76:79], v[56:59], v[236:239]
    v_mfma_f32_16x16x32_bf16 v[240:243], v[64:67], v[60:63], v[240:243]
    v_mfma_f32_16x16x32_bf16 v[244:247], v[68:71], v[60:63], v[244:247]
    v_mfma_f32_16x16x32_bf16 v[248:251], v[72:75], v[60:63], v[248:251]
    v_mfma_f32_16x16x32_bf16 v[252:255], v[76:79], v[60:63], v[252:255]
    s_waitcnt lgkmcnt(0)
    s_waitcnt vmcnt(4)
    s_barrier
    v_mfma_f32_16x16x32_bf16 v[128:131], v[112:115], v[80:83], v[128:131]
    ds_read_b64_tr_b16 v[64:65], v12 offset:16384
    v_mfma_f32_16x16x32_bf16 v[132:135], v[116:119], v[80:83], v[132:135]
    ds_read_b64_tr_b16 v[66:67], v13 offset:16384
    v_mfma_f32_16x16x32_bf16 v[136:139], v[120:123], v[80:83], v[136:139]
    ds_read_b64_tr_b16 v[68:69], v14 offset:16384
    v_mfma_f32_16x16x32_bf16 v[140:143], v[124:127], v[80:83], v[140:143]
    ds_read_b64_tr_b16 v[70:71], v15 offset:16384
    v_mfma_f32_16x16x32_bf16 v[144:147], v[112:115], v[84:87], v[144:147]
    ds_read_b64_tr_b16 v[72:73], v12 offset:24576
    v_mfma_f32_16x16x32_bf16 v[148:151], v[116:119], v[84:87], v[148:151]
    ds_read_b64_tr_b16 v[74:75], v13 offset:24576
    v_mfma_f32_16x16x32_bf16 v[152:155], v[120:123], v[84:87], v[152:155]
    ds_read_b64_tr_b16 v[76:77], v14 offset:24576
    v_mfma_f32_16x16x32_bf16 v[156:159], v[124:127], v[84:87], v[156:159]
    ds_read_b64_tr_b16 v[78:79], v15 offset:24576
    v_mfma_f32_16x16x32_bf16 v[160:163], v[112:115], v[88:91], v[160:163]
    ds_read_b128 v[32:35], v6 offset:0
    v_mfma_f32_16x16x32_bf16 v[164:167], v[116:119], v[88:91], v[164:167]
    ds_read_b128 v[36:39], v6 offset:1024
    v_mfma_f32_16x16x32_bf16 v[168:171], v[120:123], v[88:91], v[168:171]
    ds_read_b128 v[40:43], v6 offset:2048
    v_mfma_f32_16x16x32_bf16 v[172:175], v[124:127], v[88:91], v[172:175]
    ds_read_b128 v[44:47], v6 offset:3072
    v_mfma_f32_16x16x32_bf16 v[176:179], v[112:115], v[92:95], v[176:179]
    ds_read_b128 v[48:51], v6 offset:4096
    v_mfma_f32_16x16x32_bf16 v[180:183], v[116:119], v[92:95], v[180:183]
    ds_read_b128 v[52:55], v6 offset:5120
    v_mfma_f32_16x16x32_bf16 v[184:187], v[120:123], v[92:95], v[184:187]
    ds_read_b128 v[56:59], v6 offset:6144
    v_mfma_f32_16x16x32_bf16 v[188:191], v[124:127], v[92:95], v[188:191]
    ds_read_b128 v[60:63], v6 offset:7168
    v_mfma_f32_16x16x32_bf16 v[192:195], v[112:115], v[96:99], v[192:195]
    v_mfma_f32_16x16x32_bf16 v[196:199], v[116:119], v[96:99], v[196:199]
    v_mfma_f32_16x16x32_bf16 v[200:203], v[120:123], v[96:99], v[200:203]
    v_mfma_f32_16x16x32_bf16 v[204:207], v[124:127], v[96:99], v[204:207]
    v_mfma_f32_16x16x32_bf16 v[208:211], v[112:115], v[100:103], v[208:211]
    v_mfma_f32_16x16x32_bf16 v[212:215], v[116:119], v[100:103], v[212:215]
    v_mfma_f32_16x16x32_bf16 v[216:219], v[120:123], v[100:103], v[216:219]
    v_mfma_f32_16x16x32_bf16 v[220:223], v[124:127], v[100:103], v[220:223]
    v_mfma_f32_16x16x32_bf16 v[224:227], v[112:115], v[104:107], v[224:227]
    v_mfma_f32_16x16x32_bf16 v[228:231], v[116:119], v[104:107], v[228:231]
    v_mfma_f32_16x16x32_bf16 v[232:235], v[120:123], v[104:107], v[232:235]
    v_mfma_f32_16x16x32_bf16 v[236:239], v[124:127], v[104:107], v[236:239]
    v_mfma_f32_16x16x32_bf16 v[240:243], v[112:115], v[108:111], v[240:243]
    v_mfma_f32_16x16x32_bf16 v[244:247], v[116:119], v[108:111], v[244:247]
    v_mfma_f32_16x16x32_bf16 v[248:251], v[120:123], v[108:111], v[248:251]
    v_mfma_f32_16x16x32_bf16 v[252:255], v[124:127], v[108:111], v[252:255]
    s_waitcnt lgkmcnt(0)
    s_waitcnt vmcnt(0)
    s_barrier
    v_mfma_f32_16x16x32_bf16 v[128:131], v[64:67], v[32:35], v[128:131]
    ds_read_b64_tr_b16 v[112:113], v12 offset:49152
    v_mfma_f32_16x16x32_bf16 v[132:135], v[68:71], v[32:35], v[132:135]
    ds_read_b64_tr_b16 v[114:115], v13 offset:49152
    v_mfma_f32_16x16x32_bf16 v[136:139], v[72:75], v[32:35], v[136:139]
    ds_read_b64_tr_b16 v[116:117], v14 offset:49152
    v_mfma_f32_16x16x32_bf16 v[140:143], v[76:79], v[32:35], v[140:143]
    ds_read_b64_tr_b16 v[118:119], v15 offset:49152
    v_mfma_f32_16x16x32_bf16 v[144:147], v[64:67], v[36:39], v[144:147]
    ds_read_b64_tr_b16 v[120:121], v12 offset:57344
    v_mfma_f32_16x16x32_bf16 v[148:151], v[68:71], v[36:39], v[148:151]
    ds_read_b64_tr_b16 v[122:123], v13 offset:57344
    v_mfma_f32_16x16x32_bf16 v[152:155], v[72:75], v[36:39], v[152:155]
    ds_read_b64_tr_b16 v[124:125], v14 offset:57344
    v_mfma_f32_16x16x32_bf16 v[156:159], v[76:79], v[36:39], v[156:159]
    ds_read_b64_tr_b16 v[126:127], v15 offset:57344
    v_mfma_f32_16x16x32_bf16 v[160:163], v[64:67], v[40:43], v[160:163]
    ds_read_b128 v[80:83], v6 offset:32768
    v_mfma_f32_16x16x32_bf16 v[164:167], v[68:71], v[40:43], v[164:167]
    ds_read_b128 v[84:87], v6 offset:33792
    v_mfma_f32_16x16x32_bf16 v[168:171], v[72:75], v[40:43], v[168:171]
    ds_read_b128 v[88:91], v6 offset:34816
    v_mfma_f32_16x16x32_bf16 v[172:175], v[76:79], v[40:43], v[172:175]
    ds_read_b128 v[92:95], v6 offset:35840
    v_mfma_f32_16x16x32_bf16 v[176:179], v[64:67], v[44:47], v[176:179]
    ds_read_b128 v[96:99], v6 offset:36864
    v_mfma_f32_16x16x32_bf16 v[180:183], v[68:71], v[44:47], v[180:183]
    ds_read_b128 v[100:103], v6 offset:37888
    v_mfma_f32_16x16x32_bf16 v[184:187], v[72:75], v[44:47], v[184:187]
    ds_read_b128 v[104:107], v6 offset:38912
    v_mfma_f32_16x16x32_bf16 v[188:191], v[76:79], v[44:47], v[188:191]
    ds_read_b128 v[108:111], v6 offset:39936
    v_mfma_f32_16x16x32_bf16 v[192:195], v[64:67], v[48:51], v[192:195]
    v_mfma_f32_16x16x32_bf16 v[196:199], v[68:71], v[48:51], v[196:199]
    v_mfma_f32_16x16x32_bf16 v[200:203], v[72:75], v[48:51], v[200:203]
    v_mfma_f32_16x16x32_bf16 v[204:207], v[76:79], v[48:51], v[204:207]
    v_mfma_f32_16x16x32_bf16 v[208:211], v[64:67], v[52:55], v[208:211]
    v_mfma_f32_16x16x32_bf16 v[212:215], v[68:71], v[52:55], v[212:215]
    v_mfma_f32_16x16x32_bf16 v[216:219], v[72:75], v[52:55], v[216:219]
    v_mfma_f32_16x16x32_bf16 v[220:223], v[76:79], v[52:55], v[220:223]
    v_mfma_f32_16x16x32_bf16 v[224:227], v[64:67], v[56:59], v[224:227]
    v_mfma_f32_16x16x32_bf16 v[228:231], v[68:71], v[56:59], v[228:231]
    v_mfma_f32_16x16x32_bf16 v[232:235], v[72:75], v[56:59], v[232:235]
    v_mfma_f32_16x16x32_bf16 v[236:239], v[76:79], v[56:59], v[236:239]
    v_mfma_f32_16x16x32_bf16 v[240:243], v[64:67], v[60:63], v[240:243]
    v_mfma_f32_16x16x32_bf16 v[244:247], v[68:71], v[60:63], v[244:247]
    v_mfma_f32_16x16x32_bf16 v[248:251], v[72:75], v[60:63], v[248:251]
    v_mfma_f32_16x16x32_bf16 v[252:255], v[76:79], v[60:63], v[252:255]
    s_waitcnt lgkmcnt(0)
    s_waitcnt vmcnt(0)
    s_barrier
    v_mfma_f32_16x16x32_bf16 v[128:131], v[112:115], v[80:83], v[128:131]
    ds_read_b64_tr_b16 v[64:65], v8 offset:16384
    v_mfma_f32_16x16x32_bf16 v[132:135], v[116:119], v[80:83], v[132:135]
    ds_read_b64_tr_b16 v[66:67], v9 offset:16384
    v_mfma_f32_16x16x32_bf16 v[136:139], v[120:123], v[80:83], v[136:139]
    ds_read_b64_tr_b16 v[68:69], v10 offset:16384
    v_mfma_f32_16x16x32_bf16 v[140:143], v[124:127], v[80:83], v[140:143]
    ds_read_b64_tr_b16 v[70:71], v11 offset:16384
    v_mfma_f32_16x16x32_bf16 v[144:147], v[112:115], v[84:87], v[144:147]
    ds_read_b64_tr_b16 v[72:73], v8 offset:24576
    v_mfma_f32_16x16x32_bf16 v[148:151], v[116:119], v[84:87], v[148:151]
    ds_read_b64_tr_b16 v[74:75], v9 offset:24576
    v_mfma_f32_16x16x32_bf16 v[152:155], v[120:123], v[84:87], v[152:155]
    ds_read_b64_tr_b16 v[76:77], v10 offset:24576
    v_mfma_f32_16x16x32_bf16 v[156:159], v[124:127], v[84:87], v[156:159]
    ds_read_b64_tr_b16 v[78:79], v11 offset:24576
    v_mfma_f32_16x16x32_bf16 v[160:163], v[112:115], v[88:91], v[160:163]
    ds_read_b128 v[32:35], v5 offset:0
    v_mfma_f32_16x16x32_bf16 v[164:167], v[116:119], v[88:91], v[164:167]
    ds_read_b128 v[36:39], v5 offset:1024
    v_mfma_f32_16x16x32_bf16 v[168:171], v[120:123], v[88:91], v[168:171]
    ds_read_b128 v[40:43], v5 offset:2048
    v_mfma_f32_16x16x32_bf16 v[172:175], v[124:127], v[88:91], v[172:175]
    ds_read_b128 v[44:47], v5 offset:3072
    v_mfma_f32_16x16x32_bf16 v[176:179], v[112:115], v[92:95], v[176:179]
    ds_read_b128 v[48:51], v5 offset:4096
    v_mfma_f32_16x16x32_bf16 v[180:183], v[116:119], v[92:95], v[180:183]
    ds_read_b128 v[52:55], v5 offset:5120
    v_mfma_f32_16x16x32_bf16 v[184:187], v[120:123], v[92:95], v[184:187]
    ds_read_b128 v[56:59], v5 offset:6144
    v_mfma_f32_16x16x32_bf16 v[188:191], v[124:127], v[92:95], v[188:191]
    ds_read_b128 v[60:63], v5 offset:7168
    v_mfma_f32_16x16x32_bf16 v[192:195], v[112:115], v[96:99], v[192:195]
    v_mfma_f32_16x16x32_bf16 v[196:199], v[116:119], v[96:99], v[196:199]
    v_mfma_f32_16x16x32_bf16 v[200:203], v[120:123], v[96:99], v[200:203]
    v_mfma_f32_16x16x32_bf16 v[204:207], v[124:127], v[96:99], v[204:207]
    v_mfma_f32_16x16x32_bf16 v[208:211], v[112:115], v[100:103], v[208:211]
    v_mfma_f32_16x16x32_bf16 v[212:215], v[116:119], v[100:103], v[212:215]
    v_mfma_f32_16x16x32_bf16 v[216:219], v[120:123], v[100:103], v[216:219]
    v_mfma_f32_16x16x32_bf16 v[220:223], v[124:127], v[100:103], v[220:223]
    v_mfma_f32_16x16x32_bf16 v[224:227], v[112:115], v[104:107], v[224:227]
    v_mfma_f32_16x16x32_bf16 v[228:231], v[116:119], v[104:107], v[228:231]
    v_mfma_f32_16x16x32_bf16 v[232:235], v[120:123], v[104:107], v[232:235]
    v_mfma_f32_16x16x32_bf16 v[236:239], v[124:127], v[104:107], v[236:239]
    v_mfma_f32_16x16x32_bf16 v[240:243], v[112:115], v[108:111], v[240:243]
    v_mfma_f32_16x16x32_bf16 v[244:247], v[116:119], v[108:111], v[244:247]
    v_mfma_f32_16x16x32_bf16 v[248:251], v[120:123], v[108:111], v[248:251]
    v_mfma_f32_16x16x32_bf16 v[252:255], v[124:127], v[108:111], v[252:255]
    s_waitcnt lgkmcnt(0)
w_end:
    v_mov_b32 v20, 131072
    ds_read_b128 v[24:27], v20
    ds_read_b128 v[28:31], v20 offset:16
    s_cmp_eq_u32 s48, 2
    s_cbranch_scc1 w_epi_glu
    s_cmp_eq_u32 s48, 3
    s_cbranch_scc1 w_epi_silu
    s_lshl_b32 s30, s27, 10
    s_add_u32 s30, s30, s49
    s_nop 7
    v_cvt_pk_bf16_f32 v80, v128, v129
    v_cvt_pk_bf16_f32 v81, v130, v131
    v_cvt_pk_bf16_f32 v82, v132, v133
    v_cvt_pk_bf16_f32 v83, v134, v135
    buffer_store_dwordx4 v[80:83], v1, s[4:7], s30 offen sc1
    v_cvt_pk_bf16_f32 v84, v136, v137
    v_cvt_pk_bf16_f32 v85, v138, v139
    v_cvt_pk_bf16_f32 v86, v140, v141
    v_cvt_pk_bf16_f32 v87, v142, v143
    buffer_store_dwordx4 v[84:87], v19, s[4:7], s30 offen sc1
    s_add_u32 s30, s30, s50
    v_cvt_pk_bf16_f32 v88, v144, v145
    v_cvt_pk_bf16_f32 v89, v146, v147
    v_cvt_pk_bf16_f32 v90, v148, v149
    v_cvt_pk_bf16_f32 v91, v150, v151
    buffer_store_dwordx4 v[88:91], v1, s[4:7], s30 offen sc1
    v_cvt_pk_bf16_f32 v92, v152, v153
    v_cvt_pk_bf16_f32 v93, v154, v155
    v_cvt_pk_bf16_f32 v94, v156, v157
    v_cvt_pk_bf16_f32 v95, v158, v159
    buffer_store_dwordx4 v[92:95], v19, s[4:7], s30 offen sc1
    s_add_u32 s30, s30, s50
    v_cvt_pk_bf16_f32 v80, v160, v161
    v_cvt_pk_bf16_f32 v81, v162, v163
    v_cvt_pk_bf16_f32 v82, v164, v165
    v_cvt_pk_bf16_f32 v83, v166, v167
    buffer_store_dwordx4 v[80:83], v1, s[4:7], s30 offen sc1
    v_cvt_pk_bf16_f32 v84, v168, v169
    v_cvt_pk_bf16_f32 v85, v170, v171
    v_cvt_pk_bf16_f32 v86, v172, v173
    v_cvt_pk_bf16_f32 v87, v174, v175
    buffer_store_dwordx4 v[84:87], v19, s[4:7], s30 offen sc1
    s_add_u32 s30, s30, s50
    v_cvt_pk_bf16_f32 v88, v176, v177
    v_cvt_pk_bf16_f32 v89, v178, v179
    v_cvt_pk_bf16_f32 v90, v180, v181
    v_cvt_pk_bf16_f32 v91, v182, v183
    buffer_store_dwordx4 v[88:91], v1, s[4:7], s30 offen sc1
    v_cvt_pk_bf16_f32 v92, v184, v185
    v_cvt_pk_bf16_f32 v93, v186, v187
    v_cvt_pk_bf16_f32 v94, v188, v189
    v_cvt_pk_bf16_f32 v95, v190, v191
    buffer_store_dwordx4 v[92:95], v19, s[4:7], s30 offen sc1
    s_add_u32 s30, s30, s50
    v_cvt_pk_bf16_f32 v80, v192, v193
    v_cvt_pk_bf16_f32 v81, v194, v195
    v_cvt_pk_bf16_f32 v82, v196, v197
    v_cvt_pk_bf16_f32 v83, v198, v199
    buffer_store_dwordx4 v[80:83], v1, s[4:7], s30 offen sc1
    v_cvt_pk_bf16_f32 v84, v200, v201
    v_cvt_pk_bf16_f32 v85, v202, v203
    v_cvt_pk_bf16_f32 v86, v204, v205
    v_cvt_pk_bf16_f32 v87, v206, v207
    buffer_store_dwordx4 v[84:87], v19, s[4:7], s30 offen sc1
    s_add_u32 s30, s30, s50
    v_cvt_pk_bf16_f32 v88, v208, v209
    v_cvt_pk_bf16_f32 v89, v210, v211
    v_cvt_pk_bf16_f32 v90, v212, v213
    v_cvt_pk_bf16_f32 v91, v214, v215
    buffer_store_dwordx4 v[88:91], v1, s[4:7], s30 offen sc1
    v_cvt_pk_bf16_f32 v92, v216, v217
    v_cvt_pk_bf16_f32 v93, v218, v219
    v_cvt_pk_bf16_f32 v94, v220, v221
    v_cvt_pk_bf16_f32 v95, v222, v223
    buffer_store_dwordx4 v[92:95], v19, s[4:7], s30 offen sc1
    s_add_u32 s30, s30, s50
    v_cvt_pk_bf16_f32 v80, v224, v225
    v_cvt_pk_bf16_f32 v81, v226, v227
    v_cvt_pk_bf16_f32 v82, v228, v229
    v_cvt_pk_bf16_f32 v83, v230, v231
    buffer_store_dwordx4 v[80:83], v1, s[4:7], s30 offen sc1
    v_cvt_pk_bf16_f32 v84, v232, v233
    v_cvt_pk_bf16_f32 v85, v234, v235
    v_cvt_pk_bf16_f32 v86, v236, v237
    v_cvt_pk_bf16_f32 v87, v238, v239
    buffer_store_dwordx4 v[84:87], v19, s[4:7], s30 offen sc1
    s_add_u32 s30, s30, s50
    v_cvt_pk_bf16_f32 v88, v240, v241
    v_cvt_pk_bf16_f32 v89, v242, v243
    v_cvt_pk_bf16_f32 v90, v244, v245
    v_cvt_pk_bf16_f32 v91, v246, v247
    buffer_store_dwordx4 v[88:91], v1, s[4:7], s30 offen sc1
    v_cvt_pk_bf16_f32 v92, v248, v249
    v_cvt_pk_bf16_f32 v93, v250, v251
    v_cvt_pk_bf16_f32 v94, v252, v253
    v_cvt_pk_bf16_f32 v95, v254, v255
    buffer_store_dwordx4 v[92:95], v19, s[4:7], s30 offen sc1
    s_waitcnt lgkmcnt(0)
    v_or3_b32 v24, v24, v25, v26
    v_or3_b32 v28, v28, v29, v30
    v_or3_b32 v24, v24, v27, v31
    v_or_b32 v24, v24, v28
    s_mov_b32 s28, s51
    s_mov_b32 s57, s53
    v_readfirstlane_b32 s30, v24
    s_cmp_lg_u32 s30, 0
    s_cbranch_scc1 w_drain
    s_mov_b32 s48, s32
    s_cmp_ge_u32 s32, 4
    s_cselect_b32 s30, 2, 3
    s_lshl_b32 s30, s26, s30
    s_mul_i32 s30, s30, s43
    s_add_u32 s49, s42, s30
    s_mov_b32 s50, s43
    s_mov_b32 s51, s46
    s_mov_b32 s23, s41
    s_mov_b32 s53, s47
    s_nop 0
    s_load_dwordx16 s[32:47], s[24:25], 0
    s_add_u32 s24, s24, 64
    s_addc_u32 s25, s25, 0
    s_branch w_first16
w_epi_glu:
    s_lshl_b32 s30, s27, 10
    s_add_u32 s30, s30, s49
    s_mov_b32 s54, 0xbfb8aa3b
    s_nop 7
    v_cvt_pk_bf16_f32 v80, v128, v129
    v_cvt_pk_bf16_f32 v81, v130, v131
    v_cvt_pk_bf16_f32 v82, v132, v133
    v_cvt_pk_bf16_f32 v83, v134, v135
    v_lshlrev_b32 v96, 16, v80
    v_and_b32 v97, 0xffff0000, v80
    v_lshlrev_b32 v98, 16, v81
    v_and_b32 v99, 0xffff0000, v81
    v_lshlrev_b32 v100, 16, v82
    v_and_b32 v101, 0xffff0000, v82
    v_lshlrev_b32 v102, 16, v83
    v_and_b32 v103, 0xffff0000, v83
    v_mul_f32 v96, s54, v96
    v_mul_f32 v97, s54, v97
    v_mul_f32 v98, s54, v98
    v_mul_f32 v99, s54, v99
    v_mul_f32 v100, s54, v100
    v_mul_f32 v101, s54, v101
    v_mul_f32 v102, s54, v102
    v_mul_f32 v103, s54, v103
    v_exp_f32 v96, v96
    v_exp_f32 v97, v97
    v_exp_f32 v98, v98
    v_exp_f32 v99, v99
    v_exp_f32 v100, v100
    v_exp_f32 v101, v101
    v_exp_f32 v102, v102
    v_exp_f32 v103, v103
    v_add_f32 v96, 1.0, v96
    v_add_f32 v97, 1.0, v97
    v_add_f32 v98, 1.0, v98
    v_add_f32 v99, 1.0, v99
    v_add_f32 v100, 1.0, v100
    v_add_f32 v101, 1.0, v101
    v_add_f32 v102, 1.0, v102
    v_add_f32 v103, 1.0, v103
    v_rcp_f32 v96, v96
    v_rcp_f32 v97, v97
    v_rcp_f32 v98, v98
    v_rcp_f32 v99, v99
    v_rcp_f32 v100, v100
    v_rcp_f32 v101, v101
    v_rcp_f32 v102, v102
    v_rcp_f32 v103, v103
    v_mul_f32 v96, v96, v136
    v_mul_f32 v97, v97, v137
    v_mul_f32 v98, v98, v138
    v_mul_f32 v99, v99, v139
    v_mul_f32 v100, v100, v140
    v_mul_f32 v101, v101, v141
    v_mul_f32 v102, v102, v142
    v_mul_f32 v103, v103, v143
    v_cvt_pk_bf16_f32 v80, v96, v97
    v_cvt_pk_bf16_f32 v81, v98, v99
    v_cvt_pk_bf16_f32 v82, v100, v101
    v_cvt_pk_bf16_f32 v83, v102, v103
    buffer_store_dwordx4 v[80:83], v1, s[4:7], s30 offen sc1
    s_add_u32 s30, s30, s50
    v_cvt_pk_bf16_f32 v84, v144, v145
    v_cvt_pk_bf16_f32 v85, v146, v147
    v_cvt_pk_bf16_f32 v86, v148, v149
    v_cvt_pk_bf16_f32 v87, v150, v151
    v_lshlrev_b32 v104, 16, v84
    v_and_b32 v105, 0xffff0000, v84
    v_lshlrev_b32 v106, 16, v85
    v_and_b32 v107, 0xffff0000, v85
    v_lshlrev_b32 v108, 16, v86
    v_and_b32 v109, 0xffff0000, v86
    v_lshlrev_b32 v110, 16, v87
    v_and_b32 v111, 0xffff0000, v87
    v_mul_f32 v104, s54, v104
    v_mul_f32 v105, s54, v105
    v_mul_f32 v106, s54, v106
    v_mul_f32 v107, s54, v107
    v_mul_f32 v108, s54, v108
    v_mul_f32 v109, s54, v109
    v_mul_f32 v110, s54, v110
    v_mul_f32 v111, s54, v111
    v_exp_f32 v104, v104
    v_exp_f32 v105, v105
    v_exp_f32 v106, v106
    v_exp_f32 v107, v107
    v_exp_f32 v108, v108
    v_exp_f32 v109, v109
    v_exp_f32 v110, v110
    v_exp_f32 v111, v111
    v_add_f32 v104, 1.0, v104
    v_add_f32 v105, 1.0, v105
    v_add_f32 v106, 1.0, v106
    v_add_f32 v107, 1.0, v107
    v_add_f32 v108, 1.0, v108
    v_add_f32 v109, 1.0, v109
    v_add_f32 v110, 1.0, v110
    v_add_f32 v111, 1.0, v111
    v_rcp_f32 v104, v104
    v_rcp_f32 v105, v105
    v_rcp_f32 v106, v106
    v_rcp_f32 v107, v107
    v_rcp_f32 v108, v108
    v_rcp_f32 v109, v109
    v_rcp_f32 v110, v110
    v_rcp_f32 v111, v111
    v_mul_f32 v104, v104, v152
    v_mul_f32 v105, v105, v153
    v_mul_f32 v106, v106, v154
    v_mul_f32 v107, v107, v155
    v_mul_f32 v108, v108, v156
    v_mul_f32 v109, v109, v157
    v_mul_f32 v110, v110, v158
    v_mul_f32 v111, v111, v159
    v_cvt_pk_bf16_f32 v84, v104, v105
    v_cvt_pk_bf16_f32 v85, v106, v107
    v_cvt_pk_bf16_f32 v86, v108, v109
    v_cvt_pk_bf16_f32 v87, v110, v111
    buffer_store_dwordx4 v[84:87], v1, s[4:7], s30 offen sc1
    s_add_u32 s30, s30, s50
    v_cvt_pk_bf16_f32 v88, v160, v161
    v_cvt_pk_bf16_f32 v89, v162, v163
    v_cvt_pk_bf16_f32 v90, v164, v165
    v_cvt_pk_bf16_f32 v91, v166, v167
    v_lshlrev_b32 v96, 16, v88
    v_and_b32 v97, 0xffff0000, v88
    v_lshlrev_b32 v98, 16, v89
    v_and_b32 v99, 0xffff0000, v89
    v_lshlrev_b32 v100, 16, v90
    v_and_b32 v101, 0xffff0000, v90
    v_lshlrev_b32 v102, 16, v91
    v_and_b32 v103, 0xffff0000, v91
    v_mul_f32 v96, s54, v96
    v_mul_f32 v97, s54, v97
    v_mul_f32 v98, s54, v98
    v_mul_f32 v99, s54, v99
    v_mul_f32 v100, s54, v100
    v_mul_f32 v101, s54, v101
    v_mul_f32 v102, s54, v102
    v_mul_f32 v103, s54, v103
    v_exp_f32 v96, v96
    v_exp_f32 v97, v97
    v_exp_f32 v98, v98
    v_exp_f32 v99, v99
    v_exp_f32 v100, v100
    v_exp_f32 v101, v101
    v_exp_f32 v102, v102
    v_exp_f32 v103, v103
    v_add_f32 v96, 1.0, v96
    v_add_f32 v97, 1.0, v97
    v_add_f32 v98, 1.0, v98
    v_add_f32 v99, 1.0, v99
    v_add_f32 v100, 1.0, v100
    v_add_f32 v101, 1.0, v101
    v_add_f32 v102, 1.0, v102
    v_add_f32 v103, 1.0, v103
    v_rcp_f32 v96, v96
    v_rcp_f32 v97, v97
    v_rcp_f32 v98, v98
    v_rcp_f32 v99, v99
    v_rcp_f32 v100, v100
    v_rcp_f32 v101, v101
    v_rcp_f32 v102, v102
    v_rcp_f32 v103, v103
    v_mul_f32 v96, v96, v168
    v_mul_f32 v97, v97, v169
    v_mul_f32 v98, v98, v170
    v_mul_f32 v99, v99, v171
    v_mul_f32 v100, v100, v172
    v_mul_f32 v101, v101, v173
    v_mul_f32 v102, v102, v174
    v_mul_f32 v103, v103, v175
    v_cvt_pk_bf16_f32 v88, v96, v97
    v_cvt_pk_bf16_f32 v89, v98, v99
    v_cvt_pk_bf16_f32 v90, v100, v101
    v_cvt_pk_bf16_f32 v91, v102, v103
    buffer_store_dwordx4 v[88:91], v1, s[4:7], s30 offen sc1
    s_add_u32 s30, s30, s50
    v_cvt_pk_bf16_f32 v92, v176, v177
    v_cvt_pk_bf16_f32 v93, v178, v179
    v_cvt_pk_bf16_f32 v94, v180, v181
    v_cvt_pk_bf16_f32 v95, v182, v183
    v_lshlrev_b32 v104, 16, v92
    v_and_b32 v105, 0xffff0000, v92
    v_lshlrev_b32 v106, 16, v93
    v_and_b32 v107, 0xffff0000, v93
    v_lshlrev_b32 v108, 16, v94
    v_and_b32 v109, 0xffff0000, v94
    v_lshlrev_b32 v110, 16, v95
    v_and_b32 v111, 0xffff0000, v95
    v_mul_f32 v104, s54, v104
    v_mul_f32 v105, s54, v105
    v_mul_f32 v106, s54, v106
    v_mul_f32 v107, s54, v107
    v_mul_f32 v108, s54, v108
    v_mul_f32 v109, s54, v109
    v_mul_f32 v110, s54, v110
    v_mul_f32 v111, s54, v111
    v_exp_f32 v104, v104
    v_exp_f32 v105, v105
    v_exp_f32 v106, v106
    v_exp_f32 v107, v107
    v_exp_f32 v108, v108
    v_exp_f32 v109, v109
    v_exp_f32 v110, v110
    v_exp_f32 v111, v111
    v_add_f32 v104, 1.0, v104
    v_add_f32 v105, 1.0, v105
    v_add_f32 v106, 1.0, v106
    v_add_f32 v107, 1.0, v107
    v_add_f32 v108, 1.0, v108
    v_add_f32 v109, 1.0, v109
    v_add_f32 v110, 1.0, v110
    v_add_f32 v111, 1.0, v111
    v_rcp_f32 v104, v104
    v_rcp_f32 v105, v105
    v_rcp_f32 v106, v106
    v_rcp_f32 v107, v107
    v_rcp_f32 v108, v108
    v_rcp_f32 v109, v109
    v_rcp_f32 v110, v110
    v_rcp_f32 v111, v111
    v_mul_f32 v104, v104, v184
    v_mul_f32 v105, v105, v185
    v_mul_f32 v106, v106, v186
    v_mul_f32 v107, v107, v187
    v_mul_f32 v108, v108, v188
    v_mul_f32 v109, v109, v189
    v_mul_f32 v110, v110, v190
    v_mul_f32 v111, v111, v191
    v_cvt_pk_bf16_f32 v92, v104, v105
    v_cvt_pk_bf16_f32 v93, v106, v107
    v_cvt_pk_bf16_f32 v94, v108, v109
    v_cvt_pk_bf16_f32 v95, v110, v111
    buffer_store_dwordx4 v[92:95], v1, s[4:7], s30 offen sc1
    s_add_u32 s30, s30, s50
    v_cvt_pk_bf16_f32 v80, v192, v193
    v_cvt_pk_bf16_f32 v81, v194, v195
    v_cvt_pk_bf16_f32 v82, v196, v197
    v_cvt_pk_bf16_f32 v83, v198, v199
    v_lshlrev_b32 v96, 16, v80
    v_and_b32 v97, 0xffff0000, v80
    v_lshlrev_b32 v98, 16, v81
    v_and_b32 v99, 0xffff0000, v81
    v_lshlrev_b32 v100, 16, v82
    v_and_b32 v101, 0xffff0000, v82
    v_lshlrev_b32 v102, 16, v83
    v_and_b32 v103, 0xffff0000, v83
    v_mul_f32 v96, s54, v96
    v_mul_f32 v97, s54, v97
    v_mul_f32 v98, s54, v98
    v_mul_f32 v99, s54, v99
    v_mul_f32 v100, s54, v100
    v_mul_f32 v101, s54, v101
    v_mul_f32 v102, s54, v102
    v_mul_f32 v103, s54, v103
    v_exp_f32 v96, v96
    v_exp_f32 v97, v97
    v_exp_f32 v98, v98
    v_exp_f32 v99, v99
    v_exp_f32 v100, v100
    v_exp_f32 v101, v101
    v_exp_f32 v102, v102
    v_exp_f32 v103, v103
    v_add_f32 v96, 1.0, v96
    v_add_f32 v97, 1.0, v97
    v_add_f32 v98, 1.0, v98
    v_add_f32 v99, 1.0, v99
    v_add_f32 v100, 1.0, v100
    v_add_f32 v101, 1.0, v101
    v_add_f32 v102, 1.0, v102
    v_add_f32 v103, 1.0, v103
    v_rcp_f32 v96, v96
    v_rcp_f32 v97, v97
    v_rcp_f32 v98, v98
    v_rcp_f32 v99, v99
    v_rcp_f32 v100, v100
    v_rcp_f32 v101, v101
    v_rcp_f32 v102, v102
    v_rcp_f32 v103, v103
    v_mul_f32 v96, v96, v200
    v_mul_f32 v97, v97, v201
    v_mul_f32 v98, v98, v202
    v_mul_f32 v99, v99, v203
    v_mul_f32 v100, v100, v204
    v_mul_f32 v101, v101, v205
    v_mul_f32 v102, v102, v206
    v_mul_f32 v103, v103, v207
    v_cvt_pk_bf16_f32 v80, v96, v97
    v_cvt_pk_bf16_f32 v81, v98, v99
    v_cvt_pk_bf16_f32 v82, v100, v101
    v_cvt_pk_bf16_f32 v83, v102, v103
    buffer_store_dwordx4 v[80:83], v1, s[4:7], s30 offen sc1
    s_add_u32 s30, s30, s50
    v_cvt_pk_bf16_f32 v84, v208, v209
    v_cvt_pk_bf16_f32 v85, v210, v211
    v_cvt_pk_bf16_f32 v86, v212, v213
    v_cvt_pk_bf16_f32 v87, v214, v215
    v_lshlrev_b32 v104, 16, v84
    v_and_b32 v105, 0xffff0000, v84
    v_lshlrev_b32 v106, 16, v85
    v_and_b32 v107, 0xffff0000, v85
    v_lshlrev_b32 v108, 16, v86
    v_and_b32 v109, 0xffff0000, v86
    v_lshlrev_b32 v110, 16, v87
    v_and_b32 v111, 0xffff0000, v87
    v_mul_f32 v104, s54, v104
    v_mul_f32 v105, s54, v105
    v_mul_f32 v106, s54, v106
    v_mul_f32 v107, s54, v107
    v_mul_f32 v108, s54, v108
    v_mul_f32 v109, s54, v109
    v_mul_f32 v110, s54, v110
    v_mul_f32 v111, s54, v111
    v_exp_f32 v104, v104
    v_exp_f32 v105, v105
    v_exp_f32 v106, v106
    v_exp_f32 v107, v107
    v_exp_f32 v108, v108
    v_exp_f32 v109, v109
    v_exp_f32 v110, v110
    v_exp_f32 v111, v111
    v_add_f32 v104, 1.0, v104
    v_add_f32 v105, 1.0, v105
    v_add_f32 v106, 1.0, v106
    v_add_f32 v107, 1.0, v107
    v_add_f32 v108, 1.0, v108
    v_add_f32 v109, 1.0, v109
    v_add_f32 v110, 1.0, v110
    v_add_f32 v111, 1.0, v111
    v_rcp_f32 v104, v104
    v_rcp_f32 v105, v105
    v_rcp_f32 v106, v106
    v_rcp_f32 v107, v107
    v_rcp_f32 v108, v108
    v_rcp_f32 v109, v109
    v_rcp_f32 v110, v110
    v_rcp_f32 v111, v111
    v_mul_f32 v104, v104, v216
    v_mul_f32 v105, v105, v217
    v_mul_f32 v106, v106, v218
    v_mul_f32 v107, v107, v219
    v_mul_f32 v108, v108, v220
    v_mul_f32 v109, v109, v221
    v_mul_f32 v110, v110, v222
    v_mul_f32 v111, v111, v223
    v_cvt_pk_bf16_f32 v84, v104, v105
    v_cvt_pk_bf16_f32 v85, v106, v107
    v_cvt_pk_bf16_f32 v86, v108, v109
    v_cvt_pk_bf16_f32 v87, v110, v111
    buffer_store_dwordx4 v[84:87], v1, s[4:7], s30 offen sc1
    s_add_u32 s30, s30, s50
    v_cvt_pk_bf16_f32 v88, v224, v225
    v_cvt_pk_bf16_f32 v89, v226, v227
    v_cvt_pk_bf16_f32 v90, v228, v229
    v_cvt_pk_bf16_f32 v91, v230, v231
    v_lshlrev_b32 v96, 16, v88
    v_and_b32 v97, 0xffff0000, v88
    v_lshlrev_b32 v98, 16, v89
    v_and_b32 v99, 0xffff0000, v89
    v_lshlrev_b32 v100, 16, v90
    v_and_b32 v101, 0xffff0000, v90
    v_lshlrev_b32 v102, 16, v91
    v_and_b32 v103, 0xffff0000, v91
    v_mul_f32 v96, s54, v96
    v_mul_f32 v97, s54, v97
    v_mul_f32 v98, s54, v98
    v_mul_f32 v99, s54, v99
    v_mul_f32 v100, s54, v100
    v_mul_f32 v101, s54, v101
    v_mul_f32 v102, s54, v102
    v_mul_f32 v103, s54, v103
    v_exp_f32 v96, v96
    v_exp_f32 v97, v97
    v_exp_f32 v98, v98
    v_exp_f32 v99, v99
    v_exp_f32 v100, v100
    v_exp_f32 v101, v101
    v_exp_f32 v102, v102
    v_exp_f32 v103, v103
    v_add_f32 v96, 1.0, v96
    v_add_f32 v97, 1.0, v97
    v_add_f32 v98, 1.0, v98
    v_add_f32 v99, 1.0, v99
    v_add_f32 v100, 1.0, v100
    v_add_f32 v101, 1.0, v101
    v_add_f32 v102, 1.0, v102
    v_add_f32 v103, 1.0, v103
    v_rcp_f32 v96, v96
    v_rcp_f32 v97, v97
    v_rcp_f32 v98, v98
    v_rcp_f32 v99, v99
    v_rcp_f32 v100, v100
    v_rcp_f32 v101, v101
    v_rcp_f32 v102, v102
    v_rcp_f32 v103, v103
    v_mul_f32 v96, v96, v232
    v_mul_f32 v97, v97, v233
    v_mul_f32 v98, v98, v234
    v_mul_f32 v99, v99, v235
    v_mul_f32 v100, v100, v236
    v_mul_f32 v101, v101, v237
    v_mul_f32 v102, v102, v238
    v_mul_f32 v103, v103, v239
    v_cvt_pk_bf16_f32 v88, v96, v97
    v_cvt_pk_bf16_f32 v89, v98, v99
    v_cvt_pk_bf16_f32 v90, v100, v101
    v_cvt_pk_bf16_f32 v91, v102, v103
    buffer_store_dwordx4 v[88:91], v1, s[4:7], s30 offen sc1
    s_add_u32 s30, s30, s50
    v_cvt_pk_bf16_f32 v92, v240, v241
    v_cvt_pk_bf16_f32 v93, v242, v243
    v_cvt_pk_bf16_f32 v94, v244, v245
    v_cvt_pk_bf16_f32 v95, v246, v247
    v_lshlrev_b32 v104, 16, v92
    v_and_b32 v105, 0xffff0000, v92
    v_lshlrev_b32 v106, 16, v93
    v_and_b32 v107, 0xffff0000, v93
    v_lshlrev_b32 v108, 16, v94
    v_and_b32 v109, 0xffff0000, v94
    v_lshlrev_b32 v110, 16, v95
    v_and_b32 v111, 0xffff0000, v95
    v_mul_f32 v104, s54, v104
    v_mul_f32 v105, s54, v105
    v_mul_f32 v106, s54, v106
    v_mul_f32 v107, s54, v107
    v_mul_f32 v108, s54, v108
    v_mul_f32 v109, s54, v109
    v_mul_f32 v110, s54, v110
    v_mul_f32 v111, s54, v111
    v_exp_f32 v104, v104
    v_exp_f32 v105, v105
    v_exp_f32 v106, v106
    v_exp_f32 v107, v107
    v_exp_f32 v108, v108
    v_exp_f32 v109, v109
    v_exp_f32 v110, v110
    v_exp_f32 v111, v111
    v_add_f32 v104, 1.0, v104
    v_add_f32 v105, 1.0, v105
    v_add_f32 v106, 1.0, v106
    v_add_f32 v107, 1.0, v107
    v_add_f32 v108, 1.0, v108
    v_add_f32 v109, 1.0, v109
    v_add_f32 v110, 1.0, v110
    v_add_f32 v111, 1.0, v111
    v_rcp_f32 v104, v104
    v_rcp_f32 v105, v105
    v_rcp_f32 v106, v106
    v_rcp_f32 v107, v107
    v_rcp_f32 v108, v108
    v_rcp_f32 v109, v109
    v_rcp_f32 v110, v110
    v_rcp_f32 v111, v111
    v_mul_f32 v104, v104, v248
    v_mul_f32 v105, v105, v249
    v_mul_f32 v106, v106, v250
    v_mul_f32 v107, v107, v251
    v_mul_f32 v108, v108, v252
    v_mul_f32 v109, v109, v253
    v_mul_f32 v110, v110, v254
    v_mul_f32 v111, v111, v255
    v_cvt_pk_bf16_f32 v92, v104, v105
    v_cvt_pk_bf16_f32 v93, v106, v107
    v_cvt_pk_bf16_f32 v94, v108, v109
    v_cvt_pk_bf16_f32 v95, v110, v111
    buffer_store_dwordx4 v[92:95], v1, s[4:7], s30 offen sc1
    s_waitcnt lgkmcnt(0)
    v_or3_b32 v24, v24, v25, v26
    v_or3_b32 v28, v28, v29, v30
    v_or3_b32 v24, v24, v27, v31
    v_or_b32 v24, v24, v28
    s_mov_b32 s28, s51
    s_mov_b32 s57, s53
    v_readfirstlane_b32 s30, v24
    s_cmp_lg_u32 s30, 0
    s_cbranch_scc1 w_drain
    s_mov_b32 s48, s32
    s_cmp_ge_u32 s32, 4
    s_cselect_b32 s30, 2, 3
    s_lshl_b32 s30, s26, s30
    s_mul_i32 s30, s30, s43
    s_add_u32 s49, s42, s30
    s_mov_b32 s50, s43
    s_mov_b32 s51, s46
    s_mov_b32 s23, s41
    s_mov_b32 s53, s47
    s_nop 0
    s_load_dwordx16 s[32:47], s[24:25], 0
    s_add_u32 s24, s24, 64
    s_addc_u32 s25, s25, 0
    s_branch w_first8
w_epi_silu:
    s_lshl_b32 s30, s27, 10
    s_add_u32 s30, s30, s49
    s_mov_b32 s54, 0xbfb8aa3b
    s_nop 7
    v_cvt_pk_bf16_f32 v80, v128, v129
    v_cvt_pk_bf16_f32 v81, v130, v131
    v_cvt_pk_bf16_f32 v82, v132, v133
    v_cvt_pk_bf16_f32 v83, v134, v135
    v_lshlrev_b32 v128, 16, v80
    v_and_b32 v129, 0xffff0000, v80
    v_lshlrev_b32 v130, 16, v81
    v_and_b32 v131, 0xffff0000, v81
    v_lshlrev_b32 v132, 16, v82
    v_and_b32 v133, 0xffff0000, v82
    v_lshlrev_b32 v134, 16, v83
    v_and_b32 v135, 0xffff0000, v83
    v_mul_f32 v104, s54, v128
    v_mul_f32 v105, s54, v129
    v_mul_f32 v106, s54, v130
    v_mul_f32 v107, s54, v131
    v_mul_f32 v108, s54, v132
    v_mul_f32 v109, s54, v133
    v_mul_f32 v110, s54, v134
    v_mul_f32 v111, s54, v135
    v_exp_f32 v104, v104
    v_exp_f32 v105, v105
    v_exp_f32 v106, v106
    v_exp_f32 v107, v107
    v_exp_f32 v108, v108
    v_exp_f32 v109, v109
    v_exp_f32 v110, v110
    v_exp_f32 v111, v111
    v_add_f32 v104, 1.0, v104
    v_add_f32 v105, 1.0, v105
    v_add_f32 v106, 1.0, v106
    v_add_f32 v107, 1.0, v107
    v_add_f32 v108, 1.0, v108
    v_add_f32 v109, 1.0, v109
    v_add_f32 v110, 1.0, v110
    v_add_f32 v111, 1.0, v111
    v_rcp_f32 v104, v104
    v_rcp_f32 v105, v105
    v_rcp_f32 v106, v106
    v_rcp_f32 v107, v107
    v_rcp_f32 v108, v108
    v_rcp_f32 v109, v109
    v_rcp_f32 v110, v110
    v_rcp_f32 v111, v111
    v_mul_f32 v128, v128, v104
    v_mul_f32 v129, v129, v105
    v_mul_f32 v130, v130, v106
    v_mul_f32 v131, v131, v107
    v_mul_f32 v132, v132, v108
    v_mul_f32 v133, v133, v109
    v_mul_f32 v134, v134, v110
    v_mul_f32 v135, v135, v111
    v_cvt_pk_bf16_f32 v80, v128, v129
    v_cvt_pk_bf16_f32 v81, v130, v131
    v_cvt_pk_bf16_f32 v82, v132, v133
    v_cvt_pk_bf16_f32 v83, v134, v135
    buffer_store_dwordx4 v[80:83], v1, s[4:7], s30 offen sc1
    v_cvt_pk_bf16_f32 v84, v136, v137
    v_cvt_pk_bf16_f32 v85, v138, v139
    v_cvt_pk_bf16_f32 v86, v140, v141
    v_cvt_pk_bf16_f32 v87, v142, v143
    v_lshlrev_b32 v136, 16, v84
    v_and_b32 v137, 0xffff0000, v84
    v_lshlrev_b32 v138, 16, v85
    v_and_b32 v139, 0xffff0000, v85
    v_lshlrev_b32 v140, 16, v86
    v_and_b32 v141, 0xffff0000, v86
    v_lshlrev_b32 v142, 16, v87
    v_and_b32 v143, 0xffff0000, v87
    v_mul_f32 v96, s54, v136
    v_mul_f32 v97, s54, v137
    v_mul_f32 v98, s54, v138
    v_mul_f32 v99, s54, v139
    v_mul_f32 v100, s54, v140
    v_mul_f32 v101, s54, v141
    v_mul_f32 v102, s54, v142
    v_mul_f32 v103, s54, v143
    v_exp_f32 v96, v96
    v_exp_f32 v97, v97
    v_exp_f32 v98, v98
    v_exp_f32 v99, v99
    v_exp_f32 v100, v100
    v_exp_f32 v101, v101
    v_exp_f32 v102, v102
    v_exp_f32 v103, v103
    v_add_f32 v96, 1.0, v96
    v_add_f32 v97, 1.0, v97
    v_add_f32 v98, 1.0, v98
    v_add_f32 v99, 1.0, v99
    v_add_f32 v100, 1.0, v100
    v_add_f32 v101, 1.0, v101
    v_add_f32 v102, 1.0, v102
    v_add_f32 v103, 1.0, v103
    v_rcp_f32 v96, v96
    v_rcp_f32 v97, v97
    v_rcp_f32 v98, v98
    v_rcp_f32 v99, v99
    v_rcp_f32 v100, v100
    v_rcp_f32 v101, v101
    v_rcp_f32 v102, v102
    v_rcp_f32 v103, v103
    v_mul_f32 v136, v136, v96
    v_mul_f32 v137, v137, v97
    v_mul_f32 v138, v138, v98
    v_mul_f32 v139, v139, v99
    v_mul_f32 v140, v140, v100
    v_mul_f32 v141, v141, v101
    v_mul_f32 v142, v142, v102
    v_mul_f32 v143, v143, v103
    v_cvt_pk_bf16_f32 v84, v136, v137
    v_cvt_pk_bf16_f32 v85, v138, v139
    v_cvt_pk_bf16_f32 v86, v140, v141
    v_cvt_pk_bf16_f32 v87, v142, v143
    buffer_store_dwordx4 v[84:87], v19, s[4:7], s30 offen sc1
    s_add_u32 s30, s30, s50
    v_cvt_pk_bf16_f32 v88, v144, v145
    v_cvt_pk_bf16_f32 v89, v146, v147
    v_cvt_pk_bf16_f32 v90, v148, v149
    v_cvt_pk_bf16_f32 v91, v150, v151
    v_lshlrev_b32 v144, 16, v88
    v_and_b32 v145, 0xffff0000, v88
    v_lshlrev_b32 v146, 16, v89
    v_and_b32 v147, 0xffff0000, v89
    v_lshlrev_b32 v148, 16, v90
    v_and_b32 v149, 0xffff0000, v90
    v_lshlrev_b32 v150, 16, v91
    v_and_b32 v151, 0xffff0000, v91
    v_mul_f32 v104, s54, v144
    v_mul_f32 v105, s54, v145
    v_mul_f32 v106, s54, v146
    v_mul_f32 v107, s54, v147
    v_mul_f32 v108, s54, v148
    v_mul_f32 v109, s54, v149
    v_mul_f32 v110, s54, v150
    v_mul_f32 v111, s54, v151
    v_exp_f32 v104, v104
    v_exp_f32 v105, v105
    v_exp_f32 v106, v106
    v_exp_f32 v107, v107
    v_exp_f32 v108, v108
    v_exp_f32 v109, v109
    v_exp_f32 v110, v110
    v_exp_f32 v111, v111
    v_add_f32 v104, 1.0, v104
    v_add_f32 v105, 1.0, v105
    v_add_f32 v106, 1.0, v106
    v_add_f32 v107, 1.0, v107
    v_add_f32 v108, 1.0, v108
    v_add_f32 v109, 1.0, v109
    v_add_f32 v110, 1.0, v110
    v_add_f32 v111, 1.0, v111
    v_rcp_f32 v104, v104
    v_rcp_f32 v105, v105
    v_rcp_f32 v106, v106
    v_rcp_f32 v107, v107
    v_rcp_f32 v108, v108
    v_rcp_f32 v109, v109
    v_rcp_f32 v110, v110
    v_rcp_f32 v111, v111
    v_mul_f32 v144, v144, v104
    v_mul_f32 v145, v145, v105
    v_mul_f32 v146, v146, v106
    v_mul_f32 v147, v147, v107
    v_mul_f32 v148, v148, v108
    v_mul_f32 v149, v149, v109
    v_mul_f32 v150, v150, v110
    v_mul_f32 v151, v151, v111
    v_cvt_pk_bf16_f32 v88, v144, v145
    v_cvt_pk_bf16_f32 v89, v146, v147
    v_cvt_pk_bf16_f32 v90, v148, v149
    v_cvt_pk_bf16_f32 v91, v150, v151
    buffer_store_dwordx4 v[88:91], v1, s[4:7], s30 offen sc1
    v_cvt_pk_bf16_f32 v92, v152, v153
    v_cvt_pk_bf16_f32 v93, v154, v155
    v_cvt_pk_bf16_f32 v94, v156, v157
    v_cvt_pk_bf16_f32 v95, v158, v159
    v_lshlrev_b32 v152, 16, v92
    v_and_b32 v153, 0xffff0000, v92
    v_lshlrev_b32 v154, 16, v93
    v_and_b32 v155, 0xffff0000, v93
    v_lshlrev_b32 v156, 16, v94
    v_and_b32 v157, 0xffff0000, v94
    v_lshlrev_b32 v158, 16, v95
    v_and_b32 v159, 0xffff0000, v95
    v_mul_f32 v96, s54, v152
    v_mul_f32 v97, s54, v153
    v_mul_f32 v98, s54, v154
    v_mul_f32 v99, s54, v155
    v_mul_f32 v100, s54, v156
    v_mul_f32 v101, s54, v157
    v_mul_f32 v102, s54, v158
    v_mul_f32 v103, s54, v159
    v_exp_f32 v96, v96
    v_exp_f32 v97, v97
    v_exp_f32 v98, v98
    v_exp_f32 v99, v99
    v_exp_f32 v100, v100
    v_exp_f32 v101, v101
    v_exp_f32 v102, v102
    v_exp_f32 v103, v103
    v_add_f32 v96, 1.0, v96
    v_add_f32 v97, 1.0, v97
    v_add_f32 v98, 1.0, v98
    v_add_f32 v99, 1.0, v99
    v_add_f32 v100, 1.0, v100
    v_add_f32 v101, 1.0, v101
    v_add_f32 v102, 1.0, v102
    v_add_f32 v103, 1.0, v103
    v_rcp_f32 v96, v96
    v_rcp_f32 v97, v97
    v_rcp_f32 v98, v98
    v_rcp_f32 v99, v99
    v_rcp_f32 v100, v100
    v_rcp_f32 v101, v101
    v_rcp_f32 v102, v102
    v_rcp_f32 v103, v103
    v_mul_f32 v152, v152, v96
    v_mul_f32 v153, v153, v97
    v_mul_f32 v154, v154, v98
    v_mul_f32 v155, v155, v99
    v_mul_f32 v156, v156, v100
    v_mul_f32 v157, v157, v101
    v_mul_f32 v158, v158, v102
    v_mul_f32 v159, v159, v103
    v_cvt_pk_bf16_f32 v92, v152, v153
    v_cvt_pk_bf16_f32 v93, v154, v155
    v_cvt_pk_bf16_f32 v94, v156, v157
    v_cvt_pk_bf16_f32 v95, v158, v159
    buffer_store_dwordx4 v[92:95], v19, s[4:7], s30 offen sc1
    s_add_u32 s30, s30, s50
    v_cvt_pk_bf16_f32 v80, v160, v161
    v_cvt_pk_bf16_f32 v81, v162, v163
    v_cvt_pk_bf16_f32 v82, v164, v165
    v_cvt_pk_bf16_f32 v83, v166, v167
    v_lshlrev_b32 v160, 16, v80
    v_and_b32 v161, 0xffff0000, v80
    v_lshlrev_b32 v162, 16, v81
    v_and_b32 v163, 0xffff0000, v81
    v_lshlrev_b32 v164, 16, v82
    v_and_b32 v165, 0xffff0000, v82
    v_lshlrev_b32 v166, 16, v83
    v_and_b32 v167, 0xffff0000, v83
    v_mul_f32 v104, s54, v160
    v_mul_f32 v105, s54, v161
    v_mul_f32 v106, s54, v162
    v_mul_f32 v107, s54, v163
    v_mul_f32 v108, s54, v164
    v_mul_f32 v109, s54, v165
    v_mul_f32 v110, s54, v166
    v_mul_f32 v111, s54, v167
    v_exp_f32 v104, v104
    v_exp_f32 v105, v105
    v_exp_f32 v106, v106
    v_exp_f32 v107, v107
    v_exp_f32 v108, v108
    v_exp_f32 v109, v109
    v_exp_f32 v110, v110
    v_exp_f32 v111, v111
    v_add_f32 v104, 1.0, v104
    v_add_f32 v105, 1.0, v105
    v_add_f32 v106, 1.0, v106
    v_add_f32 v107, 1.0, v107
    v_add_f32 v108, 1.0, v108
    v_add_f32 v109, 1.0, v109
    v_add_f32 v110, 1.0, v110
    v_add_f32 v111, 1.0, v111
    v_rcp_f32 v104, v104
    v_rcp_f32 v105, v105
    v_rcp_f32 v106, v106
    v_rcp_f32 v107, v107
    v_rcp_f32 v108, v108
    v_rcp_f32 v109, v109
    v_rcp_f32 v110, v110
    v_rcp_f32 v111, v111
    v_mul_f32 v160, v160, v104
    v_mul_f32 v161, v161, v105
    v_mul_f32 v162, v162, v106
    v_mul_f32 v163, v163, v107
    v_mul_f32 v164, v164, v108
    v_mul_f32 v165, v165, v109
    v_mul_f32 v166, v166, v110
    v_mul_f32 v167, v167, v111
    v_cvt_pk_bf16_f32 v80, v160, v161
    v_cvt_pk_bf16_f32 v81, v162, v163
    v_cvt_pk_bf16_f32 v82, v164, v165
    v_cvt_pk_bf16_f32 v83, v166, v167
    buffer_store_dwordx4 v[80:83], v1, s[4:7], s30 offen sc1
    v_cvt_pk_bf16_f32 v84, v168, v169
    v_cvt_pk_bf16_f32 v85, v170, v171
    v_cvt_pk_bf16_f32 v86, v172, v173
    v_cvt_pk_bf16_f32 v87, v174, v175
    v_lshlrev_b32 v168, 16, v84
    v_and_b32 v169, 0xffff0000, v84
    v_lshlrev_b32 v170, 16, v85
    v_and_b32 v171, 0xffff0000, v85
    v_lshlrev_b32 v172, 16, v86
    v_and_b32 v173, 0xffff0000, v86
    v_lshlrev_b32 v174, 16, v87
    v_and_b32 v175, 0xffff0000, v87
    v_mul_f32 v96, s54, v168
    v_mul_f32 v97, s54, v169
    v_mul_f32 v98, s54, v170
    v_mul_f32 v99, s54, v171
    v_mul_f32 v100, s54, v172
    v_mul_f32 v101, s54, v173
    v_mul_f32 v102, s54, v174
    v_mul_f32 v103, s54, v175
    v_exp_f32 v96, v96
    v_exp_f32 v97, v97
    v_exp_f32 v98, v98
    v_exp_f32 v99, v99
    v_exp_f32 v100, v100
    v_exp_f32 v101, v101
    v_exp_f32 v102, v102
    v_exp_f32 v103, v103
    v_add_f32 v96, 1.0, v96
    v_add_f32 v97, 1.0, v97
    v_add_f32 v98, 1.0, v98
    v_add_f32 v99, 1.0, v99
    v_add_f32 v100, 1.0, v100
    v_add_f32 v101, 1.0, v101
    v_add_f32 v102, 1.0, v102
    v_add_f32 v103, 1.0, v103
    v_rcp_f32 v96, v96
    v_rcp_f32 v97, v97
    v_rcp_f32 v98, v98
    v_rcp_f32 v99, v99
    v_rcp_f32 v100, v100
    v_rcp_f32 v101, v101
    v_rcp_f32 v102, v102
    v_rcp_f32 v103, v103
    v_mul_f32 v168, v168, v96
    v_mul_f32 v169, v169, v97
    v_mul_f32 v170, v170, v98
    v_mul_f32 v171, v171, v99
    v_mul_f32 v172, v172, v100
    v_mul_f32 v173, v173, v101
    v_mul_f32 v174, v174, v102
    v_mul_f32 v175, v175, v103
    v_cvt_pk_bf16_f32 v84, v168, v169
    v_cvt_pk_bf16_f32 v85, v170, v171
    v_cvt_pk_bf16_f32 v86, v172, v173
    v_cvt_pk_bf16_f32 v87, v174, v175
    buffer_store_dwordx4 v[84:87], v19, s[4:7], s30 offen sc1
    s_add_u32 s30, s30, s50
    v_cvt_pk_bf16_f32 v88, v176, v177
    v_cvt_pk_bf16_f32 v89, v178, v179
    v_cvt_pk_bf16_f32 v90, v180, v181
    v_cvt_pk_bf16_f32 v91, v182, v183
    v_lshlrev_b32 v176, 16, v88
    v_and_b32 v177, 0xffff0000, v88
    v_lshlrev_b32 v178, 16, v89
    v_and_b32 v179, 0xffff0000, v89
    v_lshlrev_b32 v180, 16, v90
    v_and_b32 v181, 0xffff0000, v90
    v_lshlrev_b32 v182, 16, v91
    v_and_b32 v183, 0xffff0000, v91
    v_mul_f32 v104, s54, v176
    v_mul_f32 v105, s54, v177
    v_mul_f32 v106, s54, v178
    v_mul_f32 v107, s54, v179
    v_mul_f32 v108, s54, v180
    v_mul_f32 v109, s54, v181
    v_mul_f32 v110, s54, v182
    v_mul_f32 v111, s54, v183
    v_exp_f32 v104, v104
    v_exp_f32 v105, v105
    v_exp_f32 v106, v106
    v_exp_f32 v107, v107
    v_exp_f32 v108, v108
    v_exp_f32 v109, v109
    v_exp_f32 v110, v110
    v_exp_f32 v111, v111
    v_add_f32 v104, 1.0, v104
    v_add_f32 v105, 1.0, v105
    v_add_f32 v106, 1.0, v106
    v_add_f32 v107, 1.0, v107
    v_add_f32 v108, 1.0, v108
    v_add_f32 v109, 1.0, v109
    v_add_f32 v110, 1.0, v110
    v_add_f32 v111, 1.0, v111
    v_rcp_f32 v104, v104
    v_rcp_f32 v105, v105
    v_rcp_f32 v106, v106
    v_rcp_f32 v107, v107
    v_rcp_f32 v108, v108
    v_rcp_f32 v109, v109
    v_rcp_f32 v110, v110
    v_rcp_f32 v111, v111
    v_mul_f32 v176, v176, v104
    v_mul_f32 v177, v177, v105
    v_mul_f32 v178, v178, v106
    v_mul_f32 v179, v179, v107
    v_mul_f32 v180, v180, v108
    v_mul_f32 v181, v181, v109
    v_mul_f32 v182, v182, v110
    v_mul_f32 v183, v183, v111
    v_cvt_pk_bf16_f32 v88, v176, v177
    v_cvt_pk_bf16_f32 v89, v178, v179
    v_cvt_pk_bf16_f32 v90, v180, v181
    v_cvt_pk_bf16_f32 v91, v182, v183
    buffer_store_dwordx4 v[88:91], v1, s[4:7], s30 offen sc1
    v_cvt_pk_bf16_f32 v92, v184, v185
    v_cvt_pk_bf16_f32 v93, v186, v187
    v_cvt_pk_bf16_f32 v94, v188, v189
    v_cvt_pk_bf16_f32 v95, v190, v191
    v_lshlrev_b32 v184, 16, v92
    v_and_b32 v185, 0xffff0000, v92
    v_lshlrev_b32 v186, 16, v93
    v_and_b32 v187, 0xffff0000, v93
    v_lshlrev_b32 v188, 16, v94
    v_and_b32 v189, 0xffff0000, v94
    v_lshlrev_b32 v190, 16, v95
    v_and_b32 v191, 0xffff0000, v95
    v_mul_f32 v96, s54, v184
    v_mul_f32 v97, s54, v185
    v_mul_f32 v98, s54, v186
    v_mul_f32 v99, s54, v187
    v_mul_f32 v100, s54, v188
    v_mul_f32 v101, s54, v189
    v_mul_f32 v102, s54, v190
    v_mul_f32 v103, s54, v191
    v_exp_f32 v96, v96
    v_exp_f32 v97, v97
    v_exp_f32 v98, v98
    v_exp_f32 v99, v99
    v_exp_f32 v100, v100
    v_exp_f32 v101, v101
    v_exp_f32 v102, v102
    v_exp_f32 v103, v103
    v_add_f32 v96, 1.0, v96
    v_add_f32 v97, 1.0, v97
    v_add_f32 v98, 1.0, v98
    v_add_f32 v99, 1.0, v99
    v_add_f32 v100, 1.0, v100
    v_add_f32 v101, 1.0, v101
    v_add_f32 v102, 1.0, v102
    v_add_f32 v103, 1.0, v103
    v_rcp_f32 v96, v96
    v_rcp_f32 v97, v97
    v_rcp_f32 v98, v98
    v_rcp_f32 v99, v99
    v_rcp_f32 v100, v100
    v_rcp_f32 v101, v101
    v_rcp_f32 v102, v102
    v_rcp_f32 v103, v103
    v_mul_f32 v184, v184, v96
    v_mul_f32 v185, v185, v97
    v_mul_f32 v186, v186, v98
    v_mul_f32 v187, v187, v99
    v_mul_f32 v188, v188, v100
    v_mul_f32 v189, v189, v101
    v_mul_f32 v190, v190, v102
    v_mul_f32 v191, v191, v103
    v_cvt_pk_bf16_f32 v92, v184, v185
    v_cvt_pk_bf16_f32 v93, v186, v187
    v_cvt_pk_bf16_f32 v94, v188, v189
    v_cvt_pk_bf16_f32 v95, v190, v191
    buffer_store_dwordx4 v[92:95], v19, s[4:7], s30 offen sc1
    s_add_u32 s30, s30, s50
    v_cvt_pk_bf16_f32 v80, v192, v193
    v_cvt_pk_bf16_f32 v81, v194, v195
    v_cvt_pk_bf16_f32 v82, v196, v197
    v_cvt_pk_bf16_f32 v83, v198, v199
    v_lshlrev_b32 v192, 16, v80
    v_and_b32 v193, 0xffff0000, v80
    v_lshlrev_b32 v194, 16, v81
    v_and_b32 v195, 0xffff0000, v81
    v_lshlrev_b32 v196, 16, v82
    v_and_b32 v197, 0xffff0000, v82
    v_lshlrev_b32 v198, 16, v83
    v_and_b32 v199, 0xffff0000, v83
    v_mul_f32 v104, s54, v192
    v_mul_f32 v105, s54, v193
    v_mul_f32 v106, s54, v194
    v_mul_f32 v107, s54, v195
    v_mul_f32 v108, s54, v196
    v_mul_f32 v109, s54, v197
    v_mul_f32 v110, s54, v198
    v_mul_f32 v111, s54, v199
    v_exp_f32 v104, v104
    v_exp_f32 v105, v105
    v_exp_f32 v106, v106
    v_exp_f32 v107, v107
    v_exp_f32 v108, v108
    v_exp_f32 v109, v109
    v_exp_f32 v110, v110
    v_exp_f32 v111, v111
    v_add_f32 v104, 1.0, v104
    v_add_f32 v105, 1.0, v105
    v_add_f32 v106, 1.0, v106
    v_add_f32 v107, 1.0, v107
    v_add_f32 v108, 1.0, v108
    v_add_f32 v109, 1.0, v109
    v_add_f32 v110, 1.0, v110
    v_add_f32 v111, 1.0, v111
    v_rcp_f32 v104, v104
    v_rcp_f32 v105, v105
    v_rcp_f32 v106, v106
    v_rcp_f32 v107, v107
    v_rcp_f32 v108, v108
    v_rcp_f32 v109, v109
    v_rcp_f32 v110, v110
    v_rcp_f32 v111, v111
    v_mul_f32 v192, v192, v104
    v_mul_f32 v193, v193, v105
    v_mul_f32 v194, v194, v106
    v_mul_f32 v195, v195, v107
    v_mul_f32 v196, v196, v108
    v_mul_f32 v197, v197, v109
    v_mul_f32 v198, v198, v110
    v_mul_f32 v199, v199, v111
    v_cvt_pk_bf16_f32 v80, v192, v193
    v_cvt_pk_bf16_f32 v81, v194, v195
    v_cvt_pk_bf16_f32 v82, v196, v197
    v_cvt_pk_bf16_f32 v83, v198, v199
    buffer_store_dwordx4 v[80:83], v1, s[4:7], s30 offen sc1
    v_cvt_pk_bf16_f32 v84, v200, v201
    v_cvt_pk_bf16_f32 v85, v202, v203
    v_cvt_pk_bf16_f32 v86, v204, v205
    v_cvt_pk_bf16_f32 v87, v206, v207
    v_lshlrev_b32 v200, 16, v84
    v_and_b32 v201, 0xffff0000, v84
    v_lshlrev_b32 v202, 16, v85
    v_and_b32 v203, 0xffff0000, v85
    v_lshlrev_b32 v204, 16, v86
    v_and_b32 v205, 0xffff0000, v86
    v_lshlrev_b32 v206, 16, v87
    v_and_b32 v207, 0xffff0000, v87
    v_mul_f32 v96, s54, v200
    v_mul_f32 v97, s54, v201
    v_mul_f32 v98, s54, v202
    v_mul_f32 v99, s54, v203
    v_mul_f32 v100, s54, v204
    v_mul_f32 v101, s54, v205
    v_mul_f32 v102, s54, v206
    v_mul_f32 v103, s54, v207
    v_exp_f32 v96, v96
    v_exp_f32 v97, v97
    v_exp_f32 v98, v98
    v_exp_f32 v99, v99
    v_exp_f32 v100, v100
    v_exp_f32 v101, v101
    v_exp_f32 v102, v102
    v_exp_f32 v103, v103
    v_add_f32 v96, 1.0, v96
    v_add_f32 v97, 1.0, v97
    v_add_f32 v98, 1.0, v98
    v_add_f32 v99, 1.0, v99
    v_add_f32 v100, 1.0, v100
    v_add_f32 v101, 1.0, v101
    v_add_f32 v102, 1.0, v102
    v_add_f32 v103, 1.0, v103
    v_rcp_f32 v96, v96
    v_rcp_f32 v97, v97
    v_rcp_f32 v98, v98
    v_rcp_f32 v99, v99
    v_rcp_f32 v100, v100
    v_rcp_f32 v101, v101
    v_rcp_f32 v102, v102
    v_rcp_f32 v103, v103
    v_mul_f32 v200, v200, v96
    v_mul_f32 v201, v201, v97
    v_mul_f32 v202, v202, v98
    v_mul_f32 v203, v203, v99
    v_mul_f32 v204, v204, v100
    v_mul_f32 v205, v205, v101
    v_mul_f32 v206, v206, v102
    v_mul_f32 v207, v207, v103
    v_cvt_pk_bf16_f32 v84, v200, v201
    v_cvt_pk_bf16_f32 v85, v202, v203
    v_cvt_pk_bf16_f32 v86, v204, v205
    v_cvt_pk_bf16_f32 v87, v206, v207
    buffer_store_dwordx4 v[84:87], v19, s[4:7], s30 offen sc1
    s_add_u32 s30, s30, s50
    v_cvt_pk_bf16_f32 v88, v208, v209
    v_cvt_pk_bf16_f32 v89, v210, v211
    v_cvt_pk_bf16_f32 v90, v212, v213
    v_cvt_pk_bf16_f32 v91, v214, v215
    v_lshlrev_b32 v208, 16, v88
    v_and_b32 v209, 0xffff0000, v88
    v_lshlrev_b32 v210, 16, v89
    v_and_b32 v211, 0xffff0000, v89
    v_lshlrev_b32 v212, 16, v90
    v_and_b32 v213, 0xffff0000, v90
    v_lshlrev_b32 v214, 16, v91
    v_and_b32 v215, 0xffff0000, v91
    v_mul_f32 v104, s54, v208
    v_mul_f32 v105, s54, v209
    v_mul_f32 v106, s54, v210
    v_mul_f32 v107, s54, v211
    v_mul_f32 v108, s54, v212
    v_mul_f32 v109, s54, v213
    v_mul_f32 v110, s54, v214
    v_mul_f32 v111, s54, v215
    v_exp_f32 v104, v104
    v_exp_f32 v105, v105
    v_exp_f32 v106, v106
    v_exp_f32 v107, v107
    v_exp_f32 v108, v108
    v_exp_f32 v109, v109
    v_exp_f32 v110, v110
    v_exp_f32 v111, v111
    v_add_f32 v104, 1.0, v104
    v_add_f32 v105, 1.0, v105
    v_add_f32 v106, 1.0, v106
    v_add_f32 v107, 1.0, v107
    v_add_f32 v108, 1.0, v108
    v_add_f32 v109, 1.0, v109
    v_add_f32 v110, 1.0, v110
    v_add_f32 v111, 1.0, v111
    v_rcp_f32 v104, v104
    v_rcp_f32 v105, v105
    v_rcp_f32 v106, v106
    v_rcp_f32 v107, v107
    v_rcp_f32 v108, v108
    v_rcp_f32 v109, v109
    v_rcp_f32 v110, v110
    v_rcp_f32 v111, v111
    v_mul_f32 v208, v208, v104
    v_mul_f32 v209, v209, v105
    v_mul_f32 v210, v210, v106
    v_mul_f32 v211, v211, v107
    v_mul_f32 v212, v212, v108
    v_mul_f32 v213, v213, v109
    v_mul_f32 v214, v214, v110
    v_mul_f32 v215, v215, v111
    v_cvt_pk_bf16_f32 v88, v208, v209
    v_cvt_pk_bf16_f32 v89, v210, v211
    v_cvt_pk_bf16_f32 v90, v212, v213
    v_cvt_pk_bf16_f32 v91, v214, v215
    buffer_store_dwordx4 v[88:91], v1, s[4:7], s30 offen sc1
    v_cvt_pk_bf16_f32 v92, v216, v217
    v_cvt_pk_bf16_f32 v93, v218, v219
    v_cvt_pk_bf16_f32 v94, v220, v221
    v_cvt_pk_bf16_f32 v95, v222, v223
    v_lshlrev_b32 v216, 16, v92
    v_and_b32 v217, 0xffff0000, v92
    v_lshlrev_b32 v218, 16, v93
    v_and_b32 v219, 0xffff0000, v93
    v_lshlrev_b32 v220, 16, v94
    v_and_b32 v221, 0xffff0000, v94
    v_lshlrev_b32 v222, 16, v95
    v_and_b32 v223, 0xffff0000, v95
    v_mul_f32 v96, s54, v216
    v_mul_f32 v97, s54, v217
    v_mul_f32 v98, s54, v218
    v_mul_f32 v99, s54, v219
    v_mul_f32 v100, s54, v220
    v_mul_f32 v101, s54, v221
    v_mul_f32 v102, s54, v222
    v_mul_f32 v103, s54, v223
    v_exp_f32 v96, v96
    v_exp_f32 v97, v97
    v_exp_f32 v98, v98
    v_exp_f32 v99, v99
    v_exp_f32 v100, v100
    v_exp_f32 v101, v101
    v_exp_f32 v102, v102
    v_exp_f32 v103, v103
    v_add_f32 v96, 1.0, v96
    v_add_f32 v97, 1.0, v97
    v_add_f32 v98, 1.0, v98
    v_add_f32 v99, 1.0, v99
    v_add_f32 v100, 1.0, v100
    v_add_f32 v101, 1.0, v101
    v_add_f32 v102, 1.0, v102
    v_add_f32 v103, 1.0, v103
    v_rcp_f32 v96, v96
    v_rcp_f32 v97, v97
    v_rcp_f32 v98, v98
    v_rcp_f32 v99, v99
    v_rcp_f32 v100, v100
    v_rcp_f32 v101, v101
    v_rcp_f32 v102, v102
    v_rcp_f32 v103, v103
    v_mul_f32 v216, v216, v96
    v_mul_f32 v217, v217, v97
    v_mul_f32 v218, v218, v98
    v_mul_f32 v219, v219, v99
    v_mul_f32 v220, v220, v100
    v_mul_f32 v221, v221, v101
    v_mul_f32 v222, v222, v102
    v_mul_f32 v223, v223, v103
    v_cvt_pk_bf16_f32 v92, v216, v217
    v_cvt_pk_bf16_f32 v93, v218, v219
    v_cvt_pk_bf16_f32 v94, v220, v221
    v_cvt_pk_bf16_f32 v95, v222, v223
    buffer_store_dwordx4 v[92:95], v19, s[4:7], s30 offen sc1
    s_add_u32 s30, s30, s50
    v_cvt_pk_bf16_f32 v80, v224, v225
    v_cvt_pk_bf16_f32 v81, v226, v227
    v_cvt_pk_bf16_f32 v82, v228, v229
    v_cvt_pk_bf16_f32 v83, v230, v231
    v_lshlrev_b32 v224, 16, v80
    v_and_b32 v225, 0xffff0000, v80
    v_lshlrev_b32 v226, 16, v81
    v_and_b32 v227, 0xffff0000, v81
    v_lshlrev_b32 v228, 16, v82
    v_and_b32 v229, 0xffff0000, v82
    v_lshlrev_b32 v230, 16, v83
    v_and_b32 v231, 0xffff0000, v83
    v_mul_f32 v104, s54, v224
    v_mul_f32 v105, s54, v225
    v_mul_f32 v106, s54, v226
    v_mul_f32 v107, s54, v227
    v_mul_f32 v108, s54, v228
    v_mul_f32 v109, s54, v229
    v_mul_f32 v110, s54, v230
    v_mul_f32 v111, s54, v231
    v_exp_f32 v104, v104
    v_exp_f32 v105, v105
    v_exp_f32 v106, v106
    v_exp_f32 v107, v107
    v_exp_f32 v108, v108
    v_exp_f32 v109, v109
    v_exp_f32 v110, v110
    v_exp_f32 v111, v111
    v_add_f32 v104, 1.0, v104
    v_add_f32 v105, 1.0, v105
    v_add_f32 v106, 1.0, v106
    v_add_f32 v107, 1.0, v107
    v_add_f32 v108, 1.0, v108
    v_add_f32 v109, 1.0, v109
    v_add_f32 v110, 1.0, v110
    v_add_f32 v111, 1.0, v111
    v_rcp_f32 v104, v104
    v_rcp_f32 v105, v105
    v_rcp_f32 v106, v106
    v_rcp_f32 v107, v107
    v_rcp_f32 v108, v108
    v_rcp_f32 v109, v109
    v_rcp_f32 v110, v110
    v_rcp_f32 v111, v111
    v_mul_f32 v224, v224, v104
    v_mul_f32 v225, v225, v105
    v_mul_f32 v226, v226, v106
    v_mul_f32 v227, v227, v107
    v_mul_f32 v228, v228, v108
    v_mul_f32 v229, v229, v109
    v_mul_f32 v230, v230, v110
    v_mul_f32 v231, v231, v111
    v_cvt_pk_bf16_f32 v80, v224, v225
    v_cvt_pk_bf16_f32 v81, v226, v227
    v_cvt_pk_bf16_f32 v82, v228, v229
    v_cvt_pk_bf16_f32 v83, v230, v231
    buffer_store_dwordx4 v[80:83], v1, s[4:7], s30 offen sc1
    v_cvt_pk_bf16_f32 v84, v232, v233
    v_cvt_pk_bf16_f32 v85, v234, v235
    v_cvt_pk_bf16_f32 v86, v236, v237
    v_cvt_pk_bf16_f32 v87, v238, v239
    v_lshlrev_b32 v232, 16, v84
    v_and_b32 v233, 0xffff0000, v84
    v_lshlrev_b32 v234, 16, v85
    v_and_b32 v235, 0xffff0000, v85
    v_lshlrev_b32 v236, 16, v86
    v_and_b32 v237, 0xffff0000, v86
    v_lshlrev_b32 v238, 16, v87
    v_and_b32 v239, 0xffff0000, v87
    v_mul_f32 v96, s54, v232
    v_mul_f32 v97, s54, v233
    v_mul_f32 v98, s54, v234
    v_mul_f32 v99, s54, v235
    v_mul_f32 v100, s54, v236
    v_mul_f32 v101, s54, v237
    v_mul_f32 v102, s54, v238
    v_mul_f32 v103, s54, v239
    v_exp_f32 v96, v96
    v_exp_f32 v97, v97
    v_exp_f32 v98, v98
    v_exp_f32 v99, v99
    v_exp_f32 v100, v100
    v_exp_f32 v101, v101
    v_exp_f32 v102, v102
    v_exp_f32 v103, v103
    v_add_f32 v96, 1.0, v96
    v_add_f32 v97, 1.0, v97
    v_add_f32 v98, 1.0, v98
    v_add_f32 v99, 1.0, v99
    v_add_f32 v100, 1.0, v100
    v_add_f32 v101, 1.0, v101
    v_add_f32 v102, 1.0, v102
    v_add_f32 v103, 1.0, v103
    v_rcp_f32 v96, v96
    v_rcp_f32 v97, v97
    v_rcp_f32 v98, v98
    v_rcp_f32 v99, v99
    v_rcp_f32 v100, v100
    v_rcp_f32 v101, v101
    v_rcp_f32 v102, v102
    v_rcp_f32 v103, v103
    v_mul_f32 v232, v232, v96
    v_mul_f32 v233, v233, v97
    v_mul_f32 v234, v234, v98
    v_mul_f32 v235, v235, v99
    v_mul_f32 v236, v236, v100
    v_mul_f32 v237, v237, v101
    v_mul_f32 v238, v238, v102
    v_mul_f32 v239, v239, v103
    v_cvt_pk_bf16_f32 v84, v232, v233
    v_cvt_pk_bf16_f32 v85, v234, v235
    v_cvt_pk_bf16_f32 v86, v236, v237
    v_cvt_pk_bf16_f32 v87, v238, v239
    buffer_store_dwordx4 v[84:87], v19, s[4:7], s30 offen sc1
    s_add_u32 s30, s30, s50
    v_cvt_pk_bf16_f32 v88, v240, v241
    v_cvt_pk_bf16_f32 v89, v242, v243
    v_cvt_pk_bf16_f32 v90, v244, v245
    v_cvt_pk_bf16_f32 v91, v246, v247
    v_lshlrev_b32 v240, 16, v88
    v_and_b32 v241, 0xffff0000, v88
    v_lshlrev_b32 v242, 16, v89
    v_and_b32 v243, 0xffff0000, v89
    v_lshlrev_b32 v244, 16, v90
    v_and_b32 v245, 0xffff0000, v90
    v_lshlrev_b32 v246, 16, v91
    v_and_b32 v247, 0xffff0000, v91
    v_mul_f32 v104, s54, v240
    v_mul_f32 v105, s54, v241
    v_mul_f32 v106, s54, v242
    v_mul_f32 v107, s54, v243
    v_mul_f32 v108, s54, v244
    v_mul_f32 v109, s54, v245
    v_mul_f32 v110, s54, v246
    v_mul_f32 v111, s54, v247
    v_exp_f32 v104, v104
    v_exp_f32 v105, v105
    v_exp_f32 v106, v106
    v_exp_f32 v107, v107
    v_exp_f32 v108, v108
    v_exp_f32 v109, v109
    v_exp_f32 v110, v110
    v_exp_f32 v111, v111
    v_add_f32 v104, 1.0, v104
    v_add_f32 v105, 1.0, v105
    v_add_f32 v106, 1.0, v106
    v_add_f32 v107, 1.0, v107
    v_add_f32 v108, 1.0, v108
    v_add_f32 v109, 1.0, v109
    v_add_f32 v110, 1.0, v110
    v_add_f32 v111, 1.0, v111
    v_rcp_f32 v104, v104
    v_rcp_f32 v105, v105
    v_rcp_f32 v106, v106
    v_rcp_f32 v107, v107
    v_rcp_f32 v108, v108
    v_rcp_f32 v109, v109
    v_rcp_f32 v110, v110
    v_rcp_f32 v111, v111
    v_mul_f32 v240, v240, v104
    v_mul_f32 v241, v241, v105
    v_mul_f32 v242, v242, v106
    v_mul_f32 v243, v243, v107
    v_mul_f32 v244, v244, v108
    v_mul_f32 v245, v245, v109
    v_mul_f32 v246, v246, v110
    v_mul_f32 v247, v247, v111
    v_cvt_pk_bf16_f32 v88, v240, v241
    v_cvt_pk_bf16_f32 v89, v242, v243
    v_cvt_pk_bf16_f32 v90, v244, v245
    v_cvt_pk_bf16_f32 v91, v246, v247
    buffer_store_dwordx4 v[88:91], v1, s[4:7], s30 offen sc1
    v_cvt_pk_bf16_f32 v92, v248, v249
    v_cvt_pk_bf16_f32 v93, v250, v251
    v_cvt_pk_bf16_f32 v94, v252, v253
    v_cvt_pk_bf16_f32 v95, v254, v255
    v_lshlrev_b32 v248, 16, v92
    v_and_b32 v249, 0xffff0000, v92
    v_lshlrev_b32 v250, 16, v93
    v_and_b32 v251, 0xffff0000, v93
    v_lshlrev_b32 v252, 16, v94
    v_and_b32 v253, 0xffff0000, v94
    v_lshlrev_b32 v254, 16, v95
    v_and_b32 v255, 0xffff0000, v95
    v_mul_f32 v96, s54, v248
    v_mul_f32 v97, s54, v249
    v_mul_f32 v98, s54, v250
    v_mul_f32 v99, s54, v251
    v_mul_f32 v100, s54, v252
    v_mul_f32 v101, s54, v253
    v_mul_f32 v102, s54, v254
    v_mul_f32 v103, s54, v255
    v_exp_f32 v96, v96
    v_exp_f32 v97, v97
    v_exp_f32 v98, v98
    v_exp_f32 v99, v99
    v_exp_f32 v100, v100
    v_exp_f32 v101, v101
    v_exp_f32 v102, v102
    v_exp_f32 v103, v103
    v_add_f32 v96, 1.0, v96
    v_add_f32 v97, 1.0, v97
    v_add_f32 v98, 1.0, v98
    v_add_f32 v99, 1.0, v99
    v_add_f32 v100, 1.0, v100
    v_add_f32 v101, 1.0, v101
    v_add_f32 v102, 1.0, v102
    v_add_f32 v103, 1.0, v103
    v_rcp_f32 v96, v96
    v_rcp_f32 v97, v97
    v_rcp_f32 v98, v98
    v_rcp_f32 v99, v99
    v_rcp_f32 v100, v100
    v_rcp_f32 v101, v101
    v_rcp_f32 v102, v102
    v_rcp_f32 v103, v103
    v_mul_f32 v248, v248, v96
    v_mul_f32 v249, v249, v97
    v_mul_f32 v250, v250, v98
    v_mul_f32 v251, v251, v99
    v_mul_f32 v252, v252, v100
    v_mul_f32 v253, v253, v101
    v_mul_f32 v254, v254, v102
    v_mul_f32 v255, v255, v103
    v_cvt_pk_bf16_f32 v92, v248, v249
    v_cvt_pk_bf16_f32 v93, v250, v251
    v_cvt_pk_bf16_f32 v94, v252, v253
    v_cvt_pk_bf16_f32 v95, v254, v255
    buffer_store_dwordx4 v[92:95], v19, s[4:7], s30 offen sc1
    s_waitcnt lgkmcnt(0)
    v_or3_b32 v24, v24, v25, v26
    v_or3_b32 v28, v28, v29, v30
    v_or3_b32 v24, v24, v27, v31
    v_or_b32 v24, v24, v28
    s_mov_b32 s28, s51
    s_mov_b32 s57, s53
    v_readfirstlane_b32 s30, v24
    s_cmp_lg_u32 s30, 0
    s_cbranch_scc1 w_drain
    s_mov_b32 s48, s32
    s_cmp_ge_u32 s32, 4
    s_cselect_b32 s30, 2, 3
    s_lshl_b32 s30, s26, s30
    s_mul_i32 s30, s30, s43
    s_add_u32 s49, s42, s30
    s_mov_b32 s50, s43
    s_mov_b32 s51, s46
    s_mov_b32 s23, s41
    s_mov_b32 s53, s47
    s_nop 0
    s_load_dwordx16 s[32:47], s[24:25], 0
    s_add_u32 s24, s24, 64
    s_addc_u32 s25, s25, 0
    s_branch w_first16
w_firstH:
    s_waitcnt vmcnt(8)
    s_barrier
    s_add_u32 m0, s21, 0
    s_nop 0
    buffer_load_dwordx4 v1, s[4:7], s16 offen sc1 lds
    s_add_u32 s16, s16, s62
    s_add_u32 m0, s21, 1024
    s_nop 0
    buffer_load_dwordx4 v1, s[4:7], s17 offen sc1 lds
    s_add_u32 s17, s17, s62
    s_add_u32 m0, s22, 0
    s_nop 0
    buffer_load_dwordx4 v2, s[8:11], s18 offen lds
    s_add_u32 s18, s18, s20
    s_add_u32 m0, s22, 8192
    s_nop 0
    buffer_load_dwordx4 v2, s[12:15], s19 offen lds
    s_add_u32 s19, s19, s20
    v_mfma_f32_16x16x32_bf16 v[128:131], v[64:67], v[32:35], 0
    ds_read_b64_tr_b16 v[112:113], v8 offset:49152
    v_mfma_f32_16x16x32_bf16 v[132:135], v[68:71], v[32:35], 0
    ds_read_b64_tr_b16 v[114:115], v9 offset:49152
    v_mfma_f32_16x16x32_bf16 v[144:147], v[64:67], v[40:43], 0
    ds_read_b64_tr_b16 v[116:117], v10 offset:49152
    v_mfma_f32_16x16x32_bf16 v[148:151], v[68:71], v[40:43], 0
    ds_read_b64_tr_b16 v[118:119], v11 offset:49152
    v_mfma_f32_16x16x32_bf16 v[160:163], v[64:67], v[48:51], 0
    ds_read_b64_tr_b16 v[120:121], v8 offset:57344
    v_mfma_f32_16x16x32_bf16 v[164:167], v[68:71], v[48:51], 0
    ds_read_b64_tr_b16 v[122:123], v9 offset:57344
    v_mfma_f32_16x16x32_bf16 v[176:179], v[64:67], v[56:59], 0
    ds_read_b64_tr_b16 v[124:125], v10 offset:57344
    v_mfma_f32_16x16x32_bf16 v[180:183], v[68:71], v[56:59], 0
    ds_read_b64_tr_b16 v[126:127], v11 offset:57344
    v_mfma_f32_16x16x32_bf16 v[128:131], v[72:75], v[36:39], v[128:131]
    ds_read_b128 v[80:83], v5 offset:32768
    v_mfma_f32_16x16x32_bf16 v[132:135], v[76:79], v[36:39], v[132:135]
    ds_read_b128 v[84:87], v5 offset:33792
    v_mfma_f32_16x16x32_bf16 v[144:147], v[72:75], v[44:47], v[144:147]
    ds_read_b128 v[88:91], v5 offset:34816
    v_mfma_f32_16x16x32_bf16 v[148:151], v[76:79], v[44:47], v[148:151]
    ds_read_b128 v[92:95], v5 offset:35840
    v_mfma_f32_16x16x32_bf16 v[160:163], v[72:75], v[52:55], v[160:163]
    ds_read_b128 v[96:99], v5 offset:36864
    v_mfma_f32_16x16x32_bf16 v[164:167], v[76:79], v[52:55], v[164:167]
    ds_read_b128 v[100:103], v5 offset:37888
    v_mfma_f32_16x16x32_bf16 v[176:179], v[72:75], v[60:63], v[176:179]
    ds_read_b128 v[104:107], v5 offset:38912
    v_mfma_f32_16x16x32_bf16 v[180:183], v[76:79], v[60:63], v[180:183]
    ds_read_b128 v[108:111], v5 offset:39936
    s_waitcnt lgkmcnt(0)
    s_waitcnt vmcnt(8)
    s_barrier
    s_add_u32 m0, s21, 32768
    s_nop 0
    buffer_load_dwordx4 v1, s[4:7], s16 offen sc1 lds
    s_add_u32 s16, s16, s62
    s_add_u32 m0, s21, 33792
    s_nop 0
    buffer_load_dwordx4 v1, s[4:7], s17 offen sc1 lds
    s_add_u32 s17, s17, s62
    s_add_u32 m0, s22, 32768
    s_nop 0
    buffer_load_dwordx4 v2, s[8:11], s18 offen lds
    s_add_u32 s18, s18, s20
    s_add_u32 m0, s22, 40960
    s_nop 0
    buffer_load_dwordx4 v2, s[12:15], s19 offen lds
    s_add_u32 s19, s19, s20
    v_mfma_f32_16x16x32_bf16 v[128:131], v[112:115], v[80:83], v[128:131]
    ds_read_b64_tr_b16 v[64:65], v12 offset:16384
    v_mfma_f32_16x16x32_bf16 v[132:135], v[116:119], v[80:83], v[132:135]
    ds_read_b64_tr_b16 v[66:67], v13 offset:16384
    v_mfma_f32_16x16x32_bf16 v[144:147], v[112:115], v[88:91], v[144:147]
    ds_read_b64_tr_b16 v[68:69], v14 offset:16384
    v_mfma_f32_16x16x32_bf16 v[148:151], v[116:119], v[88:91], v[148:151]
    ds_read_b64_tr_b16 v[70:71], v15 offset:16384
    v_mfma_f32_16x16x32_bf16 v[160:163], v[112:115], v[96:99], v[160:163]
    ds_read_b64_tr_b16 v[72:73], v12 offset:24576
    v_mfma_f32_16x16x32_bf16 v[164:167], v[116:119], v[96:99], v[164:167]
    ds_read_b64_tr_b16 v[74:75], v13 offset:24576
    v_mfma_f32_16x16x32_bf16 v[176:179], v[112:115], v[104:107], v[176:179]
    ds_read_b64_tr_b16 v[76:77], v14 offset:24576
    v_mfma_f32_16x16x32_bf16 v[180:183], v[116:119], v[104:107], v[180:183]
    ds_read_b64_tr_b16 v[78:79], v15 offset:24576
    v_mfma_f32_16x16x32_bf16 v[128:131], v[120:123], v[84:87], v[128:131]
    ds_read_b128 v[32:35], v6 offset:0
    v_mfma_f32_16x16x32_bf16 v[132:135], v[124:127], v[84:87], v[132:135]
    ds_read_b128 v[36:39], v6 offset:1024
    v_mfma_f32_16x16x32_bf16 v[144:147], v[120:123], v[92:95], v[144:147]
    ds_read_b128 v[40:43], v6 offset:2048
    v_mfma_f32_16x16x32_bf16 v[148:151], v[124:127], v[92:95], v[148:151]
    ds_read_b128 v[44:47], v6 offset:3072
    v_mfma_f32_16x16x32_bf16 v[160:163], v[120:123], v[100:103], v[160:163]
    ds_read_b128 v[48:51], v6 offset:4096
    v_mfma_f32_16x16x32_bf16 v[164:167], v[124:127], v[100:103], v[164:167]
    ds_read_b128 v[52:55], v6 offset:5120
    v_mfma_f32_16x16x32_bf16 v[176:179], v[120:123], v[108:111], v[176:179]
    ds_read_b128 v[56:59], v6 offset:6144
    v_mfma_f32_16x16x32_bf16 v[180:183], v[124:127], v[108:111], v[180:183]
    ds_read_b128 v[60:63], v6 offset:7168
    s_waitcnt lgkmcnt(0)
    s_waitcnt vmcnt(8)
    s_barrier
    s_add_u32 m0, s21, 65536
    s_nop 0
    buffer_load_dwordx4 v1, s[4:7], s16 offen sc1 lds
    s_add_u32 s16, s16, s62
    s_add_u32 m0, s21, 66560
    s_nop 0
    buffer_load_dwordx4 v1, s[4:7], s17 offen sc1 lds
    s_add_u32 s17, s17, s62
    s_add_u32 m0, s22, 65536
    s_nop 0
    buffer_load_dwordx4 v2, s[8:11], s18 offen lds
    s_add_u32 s18, s18, s20
    s_add_u32 m0, s22, 73728
    s_nop 0
    buffer_load_dwordx4 v2, s[12:15], s19 offen lds
    s_add_u32 s19, s19, s20
    v_mfma_f32_16x16x32_bf16 v[128:131], v[64:67], v[32:35], v[128:131]
    ds_read_b64_tr_b16 v[112:113], v12 offset:49152
    v_mfma_f32_16x16x32_bf16 v[132:135], v[68:71], v[32:35], v[132:135]
    ds_read_b64_tr_b16 v[114:115], v13 offset:49152
    v_mfma_f32_16x16x32_bf16 v[144:147], v[64:67], v[40:43], v[144:147]
    ds_read_b64_tr_b16 v[116:117], v14 offset:49152
    v_mfma_f32_16x16x32_bf16 v[148:151], v[68:71], v[40:43], v[148:151]
    ds_read_b64_tr_b16 v[118:119], v15 offset:49152
    v_mfma_f32_16x16x32_bf16 v[160:163], v[64:67], v[48:51], v[160:163]
    ds_read_b64_tr_b16 v[120:121], v12 offset:57344
    v_mfma_f32_16x16x32_bf16 v[164:167], v[68:71], v[48:51], v[164:167]
    ds_read_b64_tr_b16 v[122:123], v13 offset:57344
    v_mfma_f32_16x16x32_bf16 v[176:179], v[64:67], v[56:59], v[176:179]
    ds_read_b64_tr_b16 v[124:125], v14 offset:57344
    v_mfma_f32_16x16x32_bf16 v[180:183], v[68:71], v[56:59], v[180:183]
    ds_read_b64_tr_b16 v[126:127], v15 offset:57344
    v_mfma_f32_16x16x32_bf16 v[128:131], v[72:75], v[36:39], v[128:131]
    ds_read_b128 v[80:83], v6 offset:32768
    v_mfma_f32_16x16x32_bf16 v[132:135], v[76:79], v[36:39], v[132:135]
    ds_read_b128 v[84:87], v6 offset:33792
    v_mfma_f32_16x16x32_bf16 v[144:147], v[72:75], v[44:47], v[144:147]
    ds_read_b128 v[88:91], v6 offset:34816
    v_mfma_f32_16x16x32_bf16 v[148:151], v[76:79], v[44:47], v[148:151]
    ds_read_b128 v[92:95], v6 offset:35840
    v_mfma_f32_16x16x32_bf16 v[160:163], v[72:75], v[52:55], v[160:163]
    ds_read_b128 v[96:99], v6 offset:36864
    v_mfma_f32_16x16x32_bf16 v[164:167], v[76:79], v[52:55], v[164:167]
    ds_read_b128 v[100:103], v6 offset:37888
    v_mfma_f32_16x16x32_bf16 v[176:179], v[72:75], v[60:63], v[176:179]
    ds_read_b128 v[104:107], v6 offset:38912
    v_mfma_f32_16x16x32_bf16 v[180:183], v[76:79], v[60:63], v[180:183]
    ds_read_b128 v[108:111], v6 offset:39936
    s_waitcnt lgkmcnt(0)
    s_waitcnt vmcnt(8)
    s_barrier
    s_add_u32 m0, s21, 98304
    s_nop 0
    buffer_load_dwordx4 v1, s[4:7], s16 offen sc1 lds
    s_add_u32 s16, s16, s62
    s_add_u32 m0, s21, 99328
    s_nop 0
    buffer_load_dwordx4 v1, s[4:7], s17 offen sc1 lds
    s_add_u32 s17, s17, s62
    s_add_u32 m0, s22, 98304
    s_nop 0
    buffer_load_dwordx4 v2, s[8:11], s18 offen lds
    s_add_u32 s18, s18, s20
    s_add_u32 m0, s22, 106496
    s_nop 0
    buffer_load_dwordx4 v2, s[12:15], s19 offen lds
    s_add_u32 s19, s19, s20
    v_mfma_f32_16x16x32_bf16 v[128:131], v[112:115], v[80:83], v[128:131]
    ds_read_b64_tr_b16 v[64:65], v8 offset:16384
    v_mfma_f32_16x16x32_bf16 v[132:135], v[116:119], v[80:83], v[132:135]
    ds_read_b64_tr_b16 v[66:67], v9 offset:16384
    v_mfma_f32_16x16x32_bf16 v[144:147], v[112:115], v[88:91], v[144:147]
    ds_read_b64_tr_b16 v[68:69], v10 offset:16384
    v_mfma_f32_16x16x32_bf16 v[148:151], v[116:119], v[88:91], v[148:151]
    ds_read_b64_tr_b16 v[70:71], v11 offset:16384
    v_mfma_f32_16x16x32_bf16 v[160:163], v[112:115], v[96:99], v[160:163]
    ds_read_b64_tr_b16 v[72:73], v8 offset:24576
    v_mfma_f32_16x16x32_bf16 v[164:167], v[116:119], v[96:99], v[164:167]
    ds_read_b64_tr_b16 v[74:75], v9 offset:24576
    v_mfma_f32_16x16x32_bf16 v[176:179], v[112:115], v[104:107], v[176:179]
    ds_read_b64_tr_b16 v[76:77], v10 offset:24576
    v_mfma_f32_16x16x32_bf16 v[180:183], v[116:119], v[104:107], v[180:183]
    ds_read_b64_tr_b16 v[78:79], v11 offset:24576
    v_mfma_f32_16x16x32_bf16 v[128:131], v[120:123], v[84:87], v[128:131]
    ds_read_b128 v[32:35], v5 offset:0
    v_mfma_f32_16x16x32_bf16 v[132:135], v[124:127], v[84:87], v[132:135]
    ds_read_b128 v[36:39], v5 offset:1024
    v_mfma_f32_16x16x32_bf16 v[144:147], v[120:123], v[92:95], v[144:147]
    ds_read_b128 v[40:43], v5 offset:2048
    v_mfma_f32_16x16x32_bf16 v[148:151], v[124:127], v[92:95], v[148:151]
    ds_read_b128 v[44:47], v5 offset:3072
    v_mfma_f32_16x16x32_bf16 v[160:163], v[120:123], v[100:103], v[160:163]
    ds_read_b128 v[48:51], v5 offset:4096
    v_mfma_f32_16x16x32_bf16 v[164:167], v[124:127], v[100:103], v[164:167]
    ds_read_b128 v[52:55], v5 offset:5120
    v_mfma_f32_16x16x32_bf16 v[176:179], v[120:123], v[108:111], v[176:179]
    ds_read_b128 v[56:59], v5 offset:6144
    v_mfma_f32_16x16x32_bf16 v[180:183], v[124:127], v[108:111], v[180:183]
    ds_read_b128 v[60:63], v5 offset:7168
    s_waitcnt lgkmcnt(0)
w_loop_chkH:
    s_sub_u32 s23, s23, 1
w_loopH:
    s_cmp_lg_u32 s23, 1
    s_cbranch_scc1 w_bodyH
    buffer_load_dword v22, off, s[64:67], 0 sc1
    v_readfirstlane_b32 s30, v16
    s_cmp_ge_u32 s30, s45
    s_cselect_b32 s30, 0, 1
    s_or_b32 s30, s30, s70
    s_cmp_ge_u32 s32, 4
    s_cselect_b32 s30, 1, s30
    s_cmp_eq_u32 s32, 0
    s_cselect_b32 s30, 1, s30
    v_mov_b32 v20, s30
    ds_write_b32 v7, v20
    s_cbranch_scc1 w_ndH
    s_cmp_ge_u32 s32, 4
    s_cbranch_scc1 w_ndH
    s_cmp_lg_u32 s70, 0
    s_cbranch_scc1 w_ndH
    s_load_dwordx2 s[8:9], s[0:1], s33
    s_load_dwordx2 s[12:13], s[0:1], s34
    s_mov_b32 s10, s38
    s_mov_b32 s14, s38
    s_cmp_ge_u32 s32, 4
    s_cselect_b32 s31, 0, 1
    s_lshl_b32 s30, s3, s31
    s_mul_i32 s30, s30, s40
    s_add_u32 s16, s39, s30
    s_cmp_eq_u32 s32, 4
    s_cselect_b32 s30, 1024, s40
    s_cselect_b32 s31, 6, 5
    s_lshl_b32 s62, 32, s31
    s_add_u32 s17, s16, s30
    s_lshl_b32 s30, s3, 2
    s_mul_i32 s30, s30, s35
    s_add_u32 s18, s36, s30
    s_add_u32 s19, s37, s30
    s_lshl_b32 s20, s35, s31
    v_mul_u32_u24 v2, s35, v4
    v_add_u32 v2, v2, v3
    s_waitcnt lgkmcnt(0)
w_bodyH:
    s_waitcnt vmcnt(8)
    s_barrier
    s_add_u32 m0, s21, 0
    s_nop 0
    buffer_load_dwordx4 v1, s[4:7], s16 offen sc1 lds
    s_add_u32 s16, s16, s62
    s_add_u32 m0, s21, 1024
    s_nop 0
    buffer_load_dwordx4 v1, s[4:7], s17 offen sc1 lds
    s_add_u32 s17, s17, s62
    s_add_u32 m0, s22, 0
    s_nop 0
    buffer_load_dwordx4 v2, s[8:11], s18 offen lds
    s_add_u32 s18, s18, s20
    s_add_u32 m0, s22, 8192
    s_nop 0
    buffer_load_dwordx4 v2, s[12:15], s19 offen lds
    s_add_u32 s19, s19, s20
    v_mfma_f32_16x16x32_bf16 v[128:131], v[64:67], v[32:35], v[128:131]
    ds_read_b64_tr_b16 v[112:113], v8 offset:49152
    v_mfma_f32_16x16x32_bf16 v[132:135], v[68:71], v[32:35], v[132:135]
    ds_read_b64_tr_b16 v[114:115], v9 offset:49152
    v_mfma_f32_16x16x32_bf16 v[144:147], v[64:67], v[40:43], v[144:147]
    ds_read_b64_tr_b16 v[116:117], v10 offset:49152
    v_mfma_f32_16x16x32_bf16 v[148:151], v[68:71], v[40:43], v[148:151]
    ds_read_b64_tr_b16 v[118:119], v11 offset:49152
    v_mfma_f32_16x16x32_bf16 v[160:163], v[64:67], v[48:51], v[160:163]
    ds_read_b64_tr_b16 v[120:121], v8 offset:57344
    v_mfma_f32_16x16x32_bf16 v[164:167], v[68:71], v[48:51], v[164:167]
    ds_read_b64_tr_b16 v[122:123], v9 offset:57344
    v_mfma_f32_16x16x32_bf16 v[176:179], v[64:67], v[56:59], v[176:179]
    ds_read_b64_tr_b16 v[124:125], v10 offset:57344
    v_mfma_f32_16x16x32_bf16 v[180:183], v[68:71], v[56:59], v[180:183]
    ds_read_b64_tr_b16 v[126:127], v11 offset:57344
    v_mfma_f32_16x16x32_bf16 v[128:131], v[72:75], v[36:39], v[128:131]
    ds_read_b128 v[80:83], v5 offset:32768
    v_mfma_f32_16x16x32_bf16 v[132:135], v[76:79], v[36:39], v[132:135]
    ds_read_b128 v[84:87], v5 offset:33792
    v_mfma_f32_16x16x32_bf16 v[144:147], v[72:75], v[44:47], v[144:147]
    ds_read_b128 v[88:91], v5 offset:34816
    v_mfma_f32_16x16x32_bf16 v[148:151], v[76:79], v[44:47], v[148:151]
    ds_read_b128 v[92:95], v5 offset:35840
    v_mfma_f32_16x16x32_bf16 v[160:163], v[72:75], v[52:55], v[160:163]
    ds_read_b128 v[96:99], v5 offset:36864
    v_mfma_f32_16x16x32_bf16 v[164:167], v[76:79], v[52:55], v[164:167]
    ds_read_b128 v[100:103], v5 offset:37888
    v_mfma_f32_16x16x32_bf16 v[176:179], v[72:75], v[60:63], v[176:179]
    ds_read_b128 v[104:107], v5 offset:38912
    v_mfma_f32_16x16x32_bf16 v[180:183], v[76:79], v[60:63], v[180:183]
    ds_read_b128 v[108:111], v5 offset:39936
    buffer_load_dword v16, v17, s[4:7], s44 offen sc1
    s_waitcnt lgkmcnt(0)
    s_waitcnt vmcnt(8)
    s_barrier
    s_add_u32 m0, s21, 32768
    s_nop 0
    buffer_load_dwordx4 v1, s[4:7], s16 offen sc1 lds
    s_add_u32 s16, s16, s62
    s_add_u32 m0, s21, 33792
    s_nop 0
    buffer_load_dwordx4 v1, s[4:7], s17 offen sc1 lds
    s_add_u32 s17, s17, s62
    s_add_u32 m0, s22, 32768
    s_nop 0
    buffer_load_dwordx4 v2, s[8:11], s18 offen lds
    s_add_u32 s18, s18, s20
    s_add_u32 m0, s22, 40960
    s_nop 0
    buffer_load_dwordx4 v2, s[12:15], s19 offen lds
    s_add_u32 s19, s19, s20
    v_mfma_f32_16x16x32_bf16 v[128:131], v[112:115], v[80:83], v[128:131]
    ds_read_b64_tr_b16 v[64:65], v12 offset:16384
    v_mfma_f32_16x16x32_bf16 v[132:135], v[116:119], v[80:83], v[132:135]
    ds_read_b64_tr_b16 v[66:67], v13 offset:16384
    v_mfma_f32_16x16x32_bf16 v[144:147], v[112:115], v[88:91], v[144:147]
    ds_read_b64_tr_b16 v[68:69], v14 offset:16384
    v_mfma_f32_16x16x32_bf16 v[148:151], v[116:119], v[88:91], v[148:151]
    ds_read_b64_tr_b16 v[70:71], v15 offset:16384
    v_mfma_f32_16x16x32_bf16 v[160:163], v[112:115], v[96:99], v[160:163]
    ds_read_b64_tr_b16 v[72:73], v12 offset:24576
    v_mfma_f32_16x16x32_bf16 v[164:167], v[116:119], v[96:99], v[164:167]
    ds_read_b64_tr_b16 v[74:75], v13 offset:24576
    v_mfma_f32_16x16x32_bf16 v[176:179], v[112:115], v[104:107], v[176:179]
    ds_read_b64_tr_b16 v[76:77], v14 offset:24576
    v_mfma_f32_16x16x32_bf16 v[180:183], v[116:119], v[104:107], v[180:183]
    ds_read_b64_tr_b16 v[78:79], v15 offset:24576
    v_mfma_f32_16x16x32_bf16 v[128:131], v[120:123], v[84:87], v[128:131]
    ds_read_b128 v[32:35], v6 offset:0
    v_mfma_f32_16x16x32_bf16 v[132:135], v[124:127], v[84:87], v[132:135]
    ds_read_b128 v[36:39], v6 offset:1024
    v_mfma_f32_16x16x32_bf16 v[144:147], v[120:123], v[92:95], v[144:147]
    ds_read_b128 v[40:43], v6 offset:2048
    v_mfma_f32_16x16x32_bf16 v[148:151], v[124:127], v[92:95], v[148:151]
    ds_read_b128 v[44:47], v6 offset:3072
    v_mfma_f32_16x16x32_bf16 v[160:163], v[120:123], v[100:103], v[160:163]
    ds_read_b128 v[48:51], v6 offset:4096
    v_mfma_f32_16x16x32_bf16 v[164:167], v[124:127], v[100:103], v[164:167]
    ds_read_b128 v[52:55], v6 offset:5120
    v_mfma_f32_16x16x32_bf16 v[176:179], v[120:123], v[108:111], v[176:179]
    ds_read_b128 v[56:59], v6 offset:6144
    v_mfma_f32_16x16x32_bf16 v[180:183], v[124:127], v[108:111], v[180:183]
    ds_read_b128 v[60:63], v6 offset:7168
    s_waitcnt lgkmcnt(0)
    s_waitcnt vmcnt(8)
    s_barrier
    s_add_u32 m0, s21, 65536
    s_nop 0
    buffer_load_dwordx4 v1, s[4:7], s16 offen sc1 lds
    s_add_u32 s16, s16, s62
    s_add_u32 m0, s21, 66560
    s_nop 0
    buffer_load_dwordx4 v1, s[4:7], s17 offen sc1 lds
    s_add_u32 s17, s17, s62
    s_add_u32 m0, s22, 65536
    s_nop 0
    buffer_load_dwordx4 v2, s[8:11], s18 offen lds
    s_add_u32 s18, s18, s20
    s_add_u32 m0, s22, 73728
    s_nop 0
    buffer_load_dwordx4 v2, s[12:15], s19 offen lds
    s_add_u32 s19, s19, s20
    v_mfma_f32_16x16x32_bf16 v[128:131], v[64:67], v[32:35], v[128:131]
    ds_read_b64_tr_b16 v[112:113], v12 offset:49152
    v_mfma_f32_16x16x32_bf16 v[132:135], v[68:71], v[32:35], v[132:135]
    ds_read_b64_tr_b16 v[114:115], v13 offset:49152
    v_mfma_f32_16x16x32_bf16 v[144:147], v[64:67], v[40:43], v[144:147]
    ds_read_b64_tr_b16 v[116:117], v14 offset:49152
    v_mfma_f32_16x16x32_bf16 v[148:151], v[68:71], v[40:43], v[148:151]
    ds_read_b64_tr_b16 v[118:119], v15 offset:49152
    v_mfma_f32_16x16x32_bf16 v[160:163], v[64:67], v[48:51], v[160:163]
    ds_read_b64_tr_b16 v[120:121], v12 offset:57344
    v_mfma_f32_16x16x32_bf16 v[164:167], v[68:71], v[48:51], v[164:167]
    ds_read_b64_tr_b16 v[122:123], v13 offset:57344
    v_mfma_f32_16x16x32_bf16 v[176:179], v[64:67], v[56:59], v[176:179]
    ds_read_b64_tr_b16 v[124:125], v14 offset:57344
    v_mfma_f32_16x16x32_bf16 v[180:183], v[68:71], v[56:59], v[180:183]
    ds_read_b64_tr_b16 v[126:127], v15 offset:57344
    v_mfma_f32_16x16x32_bf16 v[128:131], v[72:75], v[36:39], v[128:131]
    ds_read_b128 v[80:83], v6 offset:32768
    v_mfma_f32_16x16x32_bf16 v[132:135], v[76:79], v[36:39], v[132:135]
    ds_read_b128 v[84:87], v6 offset:33792
    v_mfma_f32_16x16x32_bf16 v[144:147], v[72:75], v[44:47], v[144:147]
    ds_read_b128 v[88:91], v6 offset:34816
    v_mfma_f32_16x16x32_bf16 v[148:151], v[76:79], v[44:47], v[148:151]
    ds_read_b128 v[92:95], v6 offset:35840
    v_mfma_f32_16x16x32_bf16 v[160:163], v[72:75], v[52:55], v[160:163]
    ds_read_b128 v[96:99], v6 offset:36864
    v_mfma_f32_16x16x32_bf16 v[164:167], v[76:79], v[52:55], v[164:167]
    ds_read_b128 v[100:103], v6 offset:37888
    v_mfma_f32_16x16x32_bf16 v[176:179], v[72:75], v[60:63], v[176:179]
    ds_read_b128 v[104:107], v6 offset:38912
    v_mfma_f32_16x16x32_bf16 v[180:183], v[76:79], v[60:63], v[180:183]
    ds_read_b128 v[108:111], v6 offset:39936
    s_waitcnt lgkmcnt(0)
    s_waitcnt vmcnt(8)
    s_barrier
    s_add_u32 m0, s21, 98304
    s_nop 0
    buffer_load_dwordx4 v1, s[4:7], s16 offen sc1 lds
    s_add_u32 s16, s16, s62
    s_add_u32 m0, s21, 99328
    s_nop 0
    buffer_load_dwordx4 v1, s[4:7], s17 offen sc1 lds
    s_add_u32 s17, s17, s62
    s_add_u32 m0, s22, 98304
    s_nop 0
    buffer_load_dwordx4 v2, s[8:11], s18 offen lds
    s_add_u32 s18, s18, s20
    s_add_u32 m0, s22, 106496
    s_nop 0
    buffer_load_dwordx4 v2, s[12:15], s19 offen lds
    s_add_u32 s19, s19, s20
    v_mfma_f32_16x16x32_bf16 v[128:131], v[112:115], v[80:83], v[128:131]
    ds_read_b64_tr_b16 v[64:65], v8 offset:16384
    v_mfma_f32_16x16x32_bf16 v[132:135], v[116:119], v[80:83], v[132:135]
    ds_read_b64_tr_b16 v[66:67], v9 offset:16384
    v_mfma_f32_16x16x32_bf16 v[144:147], v[112:115], v[88:91], v[144:147]
    ds_read_b64_tr_b16 v[68:69], v10 offset:16384
    v_mfma_f32_16x16x32_bf16 v[148:151], v[116:119], v[88:91], v[148:151]
    ds_read_b64_tr_b16 v[70:71], v11 offset:16384
    v_mfma_f32_16x16x32_bf16 v[160:163], v[112:115], v[96:99], v[160:163]
    ds_read_b64_tr_b16 v[72:73], v8 offset:24576
    v_mfma_f32_16x16x32_bf16 v[164:167], v[116:119], v[96:99], v[164:167]
    ds_read_b64_tr_b16 v[74:75], v9 offset:24576
    v_mfma_f32_16x16x32_bf16 v[176:179], v[112:115], v[104:107], v[176:179]
    ds_read_b64_tr_b16 v[76:77], v10 offset:24576
    v_mfma_f32_16x16x32_bf16 v[180:183], v[116:119], v[104:107], v[180:183]
    ds_read_b64_tr_b16 v[78:79], v11 offset:24576
    v_mfma_f32_16x16x32_bf16 v[128:131], v[120:123], v[84:87], v[128:131]
    ds_read_b128 v[32:35], v5 offset:0
    v_mfma_f32_16x16x32_bf16 v[132:135], v[124:127], v[84:87], v[132:135]
    ds_read_b128 v[36:39], v5 offset:1024
    v_mfma_f32_16x16x32_bf16 v[144:147], v[120:123], v[92:95], v[144:147]
    ds_read_b128 v[40:43], v5 offset:2048
    v_mfma_f32_16x16x32_bf16 v[148:151], v[124:127], v[92:95], v[148:151]
    ds_read_b128 v[44:47], v5 offset:3072
    v_mfma_f32_16x16x32_bf16 v[160:163], v[120:123], v[100:103], v[160:163]
    ds_read_b128 v[48:51], v5 offset:4096
    v_mfma_f32_16x16x32_bf16 v[164:167], v[124:127], v[100:103], v[164:167]
    ds_read_b128 v[52:55], v5 offset:5120
    v_mfma_f32_16x16x32_bf16 v[176:179], v[120:123], v[108:111], v[176:179]
    ds_read_b128 v[56:59], v5 offset:6144
    v_mfma_f32_16x16x32_bf16 v[180:183], v[124:127], v[108:111], v[180:183]
    ds_read_b128 v[60:63], v5 offset:7168
    s_waitcnt lgkmcnt(0)
    s_sub_u32 s23, s23, 1
    s_cmp_lg_u32 s23, 0
    s_cbranch_scc1 w_loopH
    s_branch w_endH
w_ndH:
    s_waitcnt vmcnt(8)
    s_barrier
    v_mfma_f32_16x16x32_bf16 v[128:131], v[64:67], v[32:35], v[128:131]
    ds_read_b64_tr_b16 v[112:113], v8 offset:49152
    v_mfma_f32_16x16x32_bf16 v[132:135], v[68:71], v[32:35], v[132:135]
    ds_read_b64_tr_b16 v[114:115], v9 offset:49152
    v_mfma_f32_16x16x32_bf16 v[144:147], v[64:67], v[40:43], v[144:147]
    ds_read_b64_tr_b16 v[116:117], v10 offset:49152
    v_mfma_f32_16x16x32_bf16 v[148:151], v[68:71], v[40:43], v[148:151]
    ds_read_b64_tr_b16 v[118:119], v11 offset:49152
    v_mfma_f32_16x16x32_bf16 v[160:163], v[64:67], v[48:51], v[160:163]
    ds_read_b64_tr_b16 v[120:121], v8 offset:57344
    v_mfma_f32_16x16x32_bf16 v[164:167], v[68:71], v[48:51], v[164:167]
    ds_read_b64_tr_b16 v[122:123], v9 offset:57344
    v_mfma_f32_16x16x32_bf16 v[176:179], v[64:67], v[56:59], v[176:179]
    ds_read_b64_tr_b16 v[124:125], v10 offset:57344
    v_mfma_f32_16x16x32_bf16 v[180:183], v[68:71], v[56:59], v[180:183]
    ds_read_b64_tr_b16 v[126:127], v11 offset:57344
    v_mfma_f32_16x16x32_bf16 v[128:131], v[72:75], v[36:39], v[128:131]
    ds_read_b128 v[80:83], v5 offset:32768
    v_mfma_f32_16x16x32_bf16 v[132:135], v[76:79], v[36:39], v[132:135]
    ds_read_b128 v[84:87], v5 offset:33792
    v_mfma_f32_16x16x32_bf16 v[144:147], v[72:75], v[44:47], v[144:147]
    ds_read_b128 v[88:91], v5 offset:34816
    v_mfma_f32_16x16x32_bf16 v[148:151], v[76:79], v[44:47], v[148:151]
    ds_read_b128 v[92:95], v5 offset:35840
    v_mfma_f32_16x16x32_bf16 v[160:163], v[72:75], v[52:55], v[160:163]
    ds_read_b128 v[96:99], v5 offset:36864
    v_mfma_f32_16x16x32_bf16 v[164:167], v[76:79], v[52:55], v[164:167]
    ds_read_b128 v[100:103], v5 offset:37888
    v_mfma_f32_16x16x32_bf16 v[176:179], v[72:75], v[60:63], v[176:179]
    ds_read_b128 v[104:107], v5 offset:38912
    v_mfma_f32_16x16x32_bf16 v[180:183], v[76:79], v[60:63], v[180:183]
    ds_read_b128 v[108:111], v5 offset:39936
    s_waitcnt lgkmcnt(0)
    s_waitcnt vmcnt(4)
    s_barrier
    v_mfma_f32_16x16x32_bf16 v[128:131], v[112:115], v[80:83], v[128:131]
    ds_read_b64_tr_b16 v[64:65], v12 offset:16384
    v_mfma_f32_16x16x32_bf16 v[132:135], v[116:119], v[80:83], v[132:135]
    ds_read_b64_tr_b16 v[66:67], v13 offset:16384
    v_mfma_f32_16x16x32_bf16 v[144:147], v[112:115], v[88:91], v[144:147]
    ds_read_b64_tr_b16 v[68:69], v14 offset:16384
    v_mfma_f32_16x16x32_bf16 v[148:151], v[116:119], v[88:91], v[148:151]
    ds_read_b64_tr_b16 v[70:71], v15 offset:16384
    v_mfma_f32_16x16x32_bf16 v[160:163], v[112:115], v[96:99], v[160:163]
    ds_read_b64_tr_b16 v[72:73], v12 offset:24576
    v_mfma_f32_16x16x32_bf16 v[164:167], v[116:119], v[96:99], v[164:167]
    ds_read_b64_tr_b16 v[74:75], v13 offset:24576
    v_mfma_f32_16x16x32_bf16 v[176:179], v[112:115], v[104:107], v[176:179]
    ds_read_b64_tr_b16 v[76:77], v14 offset:24576
    v_mfma_f32_16x16x32_bf16 v[180:183], v[116:119], v[104:107], v[180:183]
    ds_read_b64_tr_b16 v[78:79], v15 offset:24576
    v_mfma_f32_16x16x32_bf16 v[128:131], v[120:123], v[84:87], v[128:131]
    ds_read_b128 v[32:35], v6 offset:0
    v_mfma_f32_16x16x32_bf16 v[132:135], v[124:127], v[84:87], v[132:135]
    ds_read_b128 v[36:39], v6 offset:1024
    v_mfma_f32_16x16x32_bf16 v[144:147], v[120:123], v[92:95], v[144:147]
    ds_read_b128 v[40:43], v6 offset:2048
    v_mfma_f32_16x16x32_bf16 v[148:151], v[124:127], v[92:95], v[148:151]
    ds_read_b128 v[44:47], v6 offset:3072
    v_mfma_f32_16x16x32_bf16 v[160:163], v[120:123], v[100:103], v[160:163]
    ds_read_b128 v[48:51], v6 offset:4096
    v_mfma_f32_16x16x32_bf16 v[164:167], v[124:127], v[100:103], v[164:167]
    ds_read_b128 v[52:55], v6 offset:5120
    v_mfma_f32_16x16x32_bf16 v[176:179], v[120:123], v[108:111], v[176:179]
    ds_read_b128 v[56:59], v6 offset:6144
    v_mfma_f32_16x16x32_bf16 v[180:183], v[124:127], v[108:111], v[180:183]
    ds_read_b128 v[60:63], v6 offset:7168
    s_waitcnt lgkmcnt(0)
    s_waitcnt vmcnt(0)
    s_barrier
    v_mfma_f32_16x16x32_bf16 v[128:131], v[64:67], v[32:35], v[128:131]
    ds_read_b64_tr_b16 v[112:113], v12 offset:49152
    v_mfma_f32_16x16x32_bf16 v[132:135], v[68:71], v[32:35], v[132:135]
    ds_read_b64_tr_b16 v[114:115], v13 offset:49152
    v_mfma_f32_16x16x32_bf16 v[144:147], v[64:67], v[40:43], v[144:147]
    ds_read_b64_tr_b16 v[116:117], v14 offset:49152
    v_mfma_f32_16x16x32_bf16 v[148:151], v[68:71], v[40:43], v[148:151]
    ds_read_b64_tr_b16 v[118:119], v15 offset:49152
    v_mfma_f32_16x16x32_bf16 v[160:163], v[64:67], v[48:51], v[160:163]
    ds_read_b64_tr_b16 v[120:121], v12 offset:57344
    v_mfma_f32_16x16x32_bf16 v[164:167], v[68:71], v[48:51], v[164:167]
    ds_read_b64_tr_b16 v[122:123], v13 offset:57344
    v_mfma_f32_16x16x32_bf16 v[176:179], v[64:67], v[56:59], v[176:179]
    ds_read_b64_tr_b16 v[124:125], v14 offset:57344
    v_mfma_f32_16x16x32_bf16 v[180:183], v[68:71], v[56:59], v[180:183]
    ds_read_b64_tr_b16 v[126:127], v15 offset:57344
    v_mfma_f32_16x16x32_bf16 v[128:131], v[72:75], v[36:39], v[128:131]
    ds_read_b128 v[80:83], v6 offset:32768
    v_mfma_f32_16x16x32_bf16 v[132:135], v[76:79], v[36:39], v[132:135]
    ds_read_b128 v[84:87], v6 offset:33792
    v_mfma_f32_16x16x32_bf16 v[144:147], v[72:75], v[44:47], v[144:147]
    ds_read_b128 v[88:91], v6 offset:34816
    v_mfma_f32_16x16x32_bf16 v[148:151], v[76:79], v[44:47], v[148:151]
    ds_read_b128 v[92:95], v6 offset:35840
    v_mfma_f32_16x16x32_bf16 v[160:163], v[72:75], v[52:55], v[160:163]
    ds_read_b128 v[96:99], v6 offset:36864
    v_mfma_f32_16x16x32_bf16 v[164:167], v[76:79], v[52:55], v[164:167]
    ds_read_b128 v[100:103], v6 offset:37888
    v_mfma_f32_16x16x32_bf16 v[176:179], v[72:75], v[60:63], v[176:179]
    ds_read_b128 v[104:107], v6 offset:38912
    v_mfma_f32_16x16x32_bf16 v[180:183], v[76:79], v[60:63], v[180:183]
    ds_read_b128 v[108:111], v6 offset:39936
    s_waitcnt lgkmcnt(0)
    s_waitcnt vmcnt(0)
    s_barrier
    v_mfma_f32_16x16x32_bf16 v[128:131], v[112:115], v[80:83], v[128:131]
    ds_read_b64_tr_b16 v[64:65], v8 offset:16384
    v_mfma_f32_16x16x32_bf16 v[132:135], v[116:119], v[80:83], v[132:135]
    ds_read_b64_tr_b16 v[66:67], v9 offset:16384
    v_mfma_f32_16x16x32_bf16 v[144:147], v[112:115], v[88:91], v[144:147]
    ds_read_b64_tr_b16 v[68:69], v10 offset:16384
    v_mfma_f32_16x16x32_bf16 v[148:151], v[116:119], v[88:91], v[148:151]
    ds_read_b64_tr_b16 v[70:71], v11 offset:16384
    v_mfma_f32_16x16x32_bf16 v[160:163], v[112:115], v[96:99], v[160:163]
    ds_read_b64_tr_b16 v[72:73], v8 offset:24576
    v_mfma_f32_16x16x32_bf16 v[164:167], v[116:119], v[96:99], v[164:167]
    ds_read_b64_tr_b16 v[74:75], v9 offset:24576
    v_mfma_f32_16x16x32_bf16 v[176:179], v[112:115], v[104:107], v[176:179]
    ds_read_b64_tr_b16 v[76:77], v10 offset:24576
    v_mfma_f32_16x16x32_bf16 v[180:183], v[116:119], v[104:107], v[180:183]
    ds_read_b64_tr_b16 v[78:79], v11 offset:24576
    v_mfma_f32_16x16x32_bf16 v[128:131], v[120:123], v[84:87], v[128:131]
    ds_read_b128 v[32:35], v5 offset:0
    v_mfma_f32_16x16x32_bf16 v[132:135], v[124:127], v[84:87], v[132:135]
    ds_read_b128 v[36:39], v5 offset:1024
    v_mfma_f32_16x16x32_bf16 v[144:147], v[120:123], v[92:95], v[144:147]
    ds_read_b128 v[40:43], v5 offset:2048
    v_mfma_f32_16x16x32_bf16 v[148:151], v[124:127], v[92:95], v[148:151]
    ds_read_b128 v[44:47], v5 offset:3072
    v_mfma_f32_16x16x32_bf16 v[160:163], v[120:123], v[100:103], v[160:163]
    ds_read_b128 v[48:51], v5 offset:4096
    v_mfma_f32_16x16x32_bf16 v[164:167], v[124:127], v[100:103], v[164:167]
    ds_read_b128 v[52:55], v5 offset:5120
    v_mfma_f32_16x16x32_bf16 v[176:179], v[120:123], v[108:111], v[176:179]
    ds_read_b128 v[56:59], v5 offset:6144
    v_mfma_f32_16x16x32_bf16 v[180:183], v[124:127], v[108:111], v[180:183]
    ds_read_b128 v[60:63], v5 offset:7168
    s_waitcnt lgkmcnt(0)
w_endH:
    v_mov_b32 v20, 131072
    ds_read_b128 v[24:27], v20
    ds_read_b128 v[28:31], v20 offset:16
    s_cmp_lg_u32 s53, s53
    s_cbranch_scc1 w_epi_siluH
    s_lshl_b32 s30, s27, 10
    s_add_u32 s30, s30, s49
    s_nop 7
    v_cvt_pk_bf16_f32 v80, v128, v129
    v_cvt_pk_bf16_f32 v81, v130, v131
    v_cvt_pk_bf16_f32 v82, v132, v133
    v_cvt_pk_bf16_f32 v83, v134, v135
    buffer_store_dwordx4 v[80:83], v1, s[4:7], s30 offen sc1
    s_add_u32 s30, s30, s50
    v_cvt_pk_bf16_f32 v84, v144, v145
    v_cvt_pk_bf16_f32 v85, v146, v147
    v_cvt_pk_bf16_f32 v86, v148, v149
    v_cvt_pk_bf16_f32 v87, v150, v151
    buffer_store_dwordx4 v[84:87], v1, s[4:7], s30 offen sc1
    s_add_u32 s30, s30, s50
    v_cvt_pk_bf16_f32 v88, v160, v161
    v_cvt_pk_bf16_f32 v89, v162, v163
    v_cvt_pk_bf16_f32 v90, v164, v165
    v_cvt_pk_bf16_f32 v91, v166, v167
    buffer_store_dwordx4 v[88:91], v1, s[4:7], s30 offen sc1
    s_add_u32 s30, s30, s50
    v_cvt_pk_bf16_f32 v92, v176, v177
    v_cvt_pk_bf16_f32 v93, v178, v179
    v_cvt_pk_bf16_f32 v94, v180, v181
    v_cvt_pk_bf16_f32 v95, v182, v183
    buffer_store_dwordx4 v[92:95], v1, s[4:7], s30 offen sc1
    s_add_u32 s30, s30, s50
    s_waitcnt lgkmcnt(0)
    v_or3_b32 v24, v24, v25, v26
    v_or3_b32 v28, v28, v29, v30
    v_or3_b32 v24, v24, v27, v31
    v_or_b32 v24, v24, v28
    s_mov_b32 s28, s51
    s_mov_b32 s57, s53
    v_readfirstlane_b32 s30, v24
    s_cmp_lg_u32 s30, 0
    s_cbranch_scc1 w_drain
    s_mov_b32 s48, s32
    s_cmp_ge_u32 s32, 4
    s_cselect_b32 s30, 2, 3
    s_lshl_b32 s30, s26, s30
    s_mul_i32 s30, s30, s43
    s_add_u32 s49, s42, s30
    s_mov_b32 s50, s43
    s_mov_b32 s51, s46
    s_mov_b32 s23, s41
    s_mov_b32 s53, s47
    s_nop 0
    s_load_dwordx16 s[32:47], s[24:25], 0
    s_add_u32 s24, s24, 64
    s_addc_u32 s25, s25, 0
    s_branch w_first4
w_epi_siluH:
    s_lshl_b32 s30, s27, 10
    s_add_u32 s30, s30, s49
    s_mov_b32 s54, 0xbfb8aa3b
    s_nop 7
    v_cvt_pk_bf16_f32 v80, v128, v129
    v_cvt_pk_bf16_f32 v81, v130, v131
    v_cvt_pk_bf16_f32 v82, v132, v133
    v_cvt_pk_bf16_f32 v83, v134, v135
    v_lshlrev_b32 v128, 16, v80
    v_and_b32 v129, 0xffff0000, v80
    v_lshlrev_b32 v130, 16, v81
    v_and_b32 v131, 0xffff0000, v81
    v_lshlrev_b32 v132, 16, v82
    v_and_b32 v133, 0xffff0000, v82
    v_lshlrev_b32 v134, 16, v83
    v_and_b32 v135, 0xffff0000, v83
    v_mul_f32 v104, s54, v128
    v_mul_f32 v105, s54, v129
    v_mul_f32 v106, s54, v130
    v_mul_f32 v107, s54, v131
    v_mul_f32 v108, s54, v132
    v_mul_f32 v109, s54, v133
    v_mul_f32 v110, s54, v134
    v_mul_f32 v111, s54, v135
    v_exp_f32 v104, v104
    v_exp_f32 v105, v105
    v_exp_f32 v106, v106
    v_exp_f32 v107, v107
    v_exp_f32 v108, v108
    v_exp_f32 v109, v109
    v_exp_f32 v110, v110
    v_exp_f32 v111, v111
    v_add_f32 v104, 1.0, v104
    v_add_f32 v105, 1.0, v105
    v_add_f32 v106, 1.0, v106
    v_add_f32 v107, 1.0, v107
    v_add_f32 v108, 1.0, v108
    v_add_f32 v109, 1.0, v109
    v_add_f32 v110, 1.0, v110
    v_add_f32 v111, 1.0, v111
    v_rcp_f32 v104, v104
    v_rcp_f32 v105, v105
    v_rcp_f32 v106, v106
    v_rcp_f32 v107, v107
    v_rcp_f32 v108, v108
    v_rcp_f32 v109, v109
    v_rcp_f32 v110, v110
    v_rcp_f32 v111, v111
    v_mul_f32 v128, v128, v104
    v_mul_f32 v129, v129, v105
    v_mul_f32 v130, v130, v106
    v_mul_f32 v131, v131, v107
    v_mul_f32 v132, v132, v108
    v_mul_f32 v133, v133, v109
    v_mul_f32 v134, v134, v110
    v_mul_f32 v135, v135, v111
    v_cvt_pk_bf16_f32 v80, v128, v129
    v_cvt_pk_bf16_f32 v81, v130, v131
    v_cvt_pk_bf16_f32 v82, v132, v133
    v_cvt_pk_bf16_f32 v83, v134, v135
    buffer_store_dwordx4 v[80:83], v1, s[4:7], s30 offen sc1
    s_add_u32 s30, s30, s50
    v_cvt_pk_bf16_f32 v84, v144, v145
    v_cvt_pk_bf16_f32 v85, v146, v147
    v_cvt_pk_bf16_f32 v86, v148, v149
    v_cvt_pk_bf16_f32 v87, v150, v151
    v_lshlrev_b32 v144, 16, v84
    v_and_b32 v145, 0xffff0000, v84
    v_lshlrev_b32 v146, 16, v85
    v_and_b32 v147, 0xffff0000, v85
    v_lshlrev_b32 v148, 16, v86
    v_and_b32 v149, 0xffff0000, v86
    v_lshlrev_b32 v150, 16, v87
    v_and_b32 v151, 0xffff0000, v87
    v_mul_f32 v96, s54, v144
    v_mul_f32 v97, s54, v145
    v_mul_f32 v98, s54, v146
    v_mul_f32 v99, s54, v147
    v_mul_f32 v100, s54, v148
    v_mul_f32 v101, s54, v149
    v_mul_f32 v102, s54, v150
    v_mul_f32 v103, s54, v151
    v_exp_f32 v96, v96
    v_exp_f32 v97, v97
    v_exp_f32 v98, v98
    v_exp_f32 v99, v99
    v_exp_f32 v100, v100
    v_exp_f32 v101, v101
    v_exp_f32 v102, v102
    v_exp_f32 v103, v103
    v_add_f32 v96, 1.0, v96
    v_add_f32 v97, 1.0, v97
    v_add_f32 v98, 1.0, v98
    v_add_f32 v99, 1.0, v99
    v_add_f32 v100, 1.0, v100
    v_add_f32 v101, 1.0, v101
    v_add_f32 v102, 1.0, v102
    v_add_f32 v103, 1.0, v103
    v_rcp_f32 v96, v96
    v_rcp_f32 v97, v97
    v_rcp_f32 v98, v98
    v_rcp_f32 v99, v99
    v_rcp_f32 v100, v100
    v_rcp_f32 v101, v101
    v_rcp_f32 v102, v102
    v_rcp_f32 v103, v103
    v_mul_f32 v144, v144, v96
    v_mul_f32 v145, v145, v97
    v_mul_f32 v146, v146, v98
    v_mul_f32 v147, v147, v99
    v_mul_f32 v148, v148, v100
    v_mul_f32 v149, v149, v101
    v_mul_f32 v150, v150, v102
    v_mul_f32 v151, v151, v103
    v_cvt_pk_bf16_f32 v84, v144, v145
    v_cvt_pk_bf16_f32 v85, v146, v147
    v_cvt_pk_bf16_f32 v86, v148, v149
    v_cvt_pk_bf16_f32 v87, v150, v151
    buffer_store_dwordx4 v[84:87], v1, s[4:7], s30 offen sc1
    s_add_u32 s30, s30, s50
    v_cvt_pk_bf16_f32 v88, v160, v161
    v_cvt_pk_bf16_f32 v89, v162, v163
    v_cvt_pk_bf16_f32 v90, v164, v165
    v_cvt_pk_bf16_f32 v91, v166, v167
    v_lshlrev_b32 v160, 16, v88
    v_and_b32 v161, 0xffff0000, v88
    v_lshlrev_b32 v162, 16, v89
    v_and_b32 v163, 0xffff0000, v89
    v_lshlrev_b32 v164, 16, v90
    v_and_b32 v165, 0xffff0000, v90
    v_lshlrev_b32 v166, 16, v91
    v_and_b32 v167, 0xffff0000, v91
    v_mul_f32 v104, s54, v160
    v_mul_f32 v105, s54, v161
    v_mul_f32 v106, s54, v162
    v_mul_f32 v107, s54, v163
    v_mul_f32 v108, s54, v164
    v_mul_f32 v109, s54, v165
    v_mul_f32 v110, s54, v166
    v_mul_f32 v111, s54, v167
    v_exp_f32 v104, v104
    v_exp_f32 v105, v105
    v_exp_f32 v106, v106
    v_exp_f32 v107, v107
    v_exp_f32 v108, v108
    v_exp_f32 v109, v109
    v_exp_f32 v110, v110
    v_exp_f32 v111, v111
    v_add_f32 v104, 1.0, v104
    v_add_f32 v105, 1.0, v105
    v_add_f32 v106, 1.0, v106
    v_add_f32 v107, 1.0, v107
    v_add_f32 v108, 1.0, v108
    v_add_f32 v109, 1.0, v109
    v_add_f32 v110, 1.0, v110
    v_add_f32 v111, 1.0, v111
    v_rcp_f32 v104, v104
    v_rcp_f32 v105, v105
    v_rcp_f32 v106, v106
    v_rcp_f32 v107, v107
    v_rcp_f32 v108, v108
    v_rcp_f32 v109, v109
    v_rcp_f32 v110, v110
    v_rcp_f32 v111, v111
    v_mul_f32 v160, v160, v104
    v_mul_f32 v161, v161, v105
    v_mul_f32 v162, v162, v106
    v_mul_f32 v163, v163, v107
    v_mul_f32 v164, v164, v108
    v_mul_f32 v165, v165, v109
    v_mul_f32 v166, v166, v110
    v_mul_f32 v167, v167, v111
    v_cvt_pk_bf16_f32 v88, v160, v161
    v_cvt_pk_bf16_f32 v89, v162, v163
    v_cvt_pk_bf16_f32 v90, v164, v165
    v_cvt_pk_bf16_f32 v91, v166, v167
    buffer_store_dwordx4 v[88:91], v1, s[4:7], s30 offen sc1
    s_add_u32 s30, s30, s50
    v_cvt_pk_bf16_f32 v92, v176, v177
    v_cvt_pk_bf16_f32 v93, v178, v179
    v_cvt_pk_bf16_f32 v94, v180, v181
    v_cvt_pk_bf16_f32 v95, v182, v183
    v_lshlrev_b32 v176, 16, v92
    v_and_b32 v177, 0xffff0000, v92
    v_lshlrev_b32 v178, 16, v93
    v_and_b32 v179, 0xffff0000, v93
    v_lshlrev_b32 v180, 16, v94
    v_and_b32 v181, 0xffff0000, v94
    v_lshlrev_b32 v182, 16, v95
    v_and_b32 v183, 0xffff0000, v95
    v_mul_f32 v96, s54, v176
    v_mul_f32 v97, s54, v177
    v_mul_f32 v98, s54, v178
    v_mul_f32 v99, s54, v179
    v_mul_f32 v100, s54, v180
    v_mul_f32 v101, s54, v181
    v_mul_f32 v102, s54, v182
    v_mul_f32 v103, s54, v183
    v_exp_f32 v96, v96
    v_exp_f32 v97, v97
    v_exp_f32 v98, v98
    v_exp_f32 v99, v99
    v_exp_f32 v100, v100
    v_exp_f32 v101, v101
    v_exp_f32 v102, v102
    v_exp_f32 v103, v103
    v_add_f32 v96, 1.0, v96
    v_add_f32 v97, 1.0, v97
    v_add_f32 v98, 1.0, v98
    v_add_f32 v99, 1.0, v99
    v_add_f32 v100, 1.0, v100
    v_add_f32 v101, 1.0, v101
    v_add_f32 v102, 1.0, v102
    v_add_f32 v103, 1.0, v103
    v_rcp_f32 v96, v96
    v_rcp_f32 v97, v97
    v_rcp_f32 v98, v98
    v_rcp_f32 v99, v99
    v_rcp_f32 v100, v100
    v_rcp_f32 v101, v101
    v_rcp_f32 v102, v102
    v_rcp_f32 v103, v103
    v_mul_f32 v176, v176, v96
    v_mul_f32 v177, v177, v97
    v_mul_f32 v178, v178, v98
    v_mul_f32 v179, v179, v99
    v_mul_f32 v180, v180, v100
    v_mul_f32 v181, v181, v101
    v_mul_f32 v182, v182, v102
    v_mul_f32 v183, v183, v103
    v_cvt_pk_bf16_f32 v92, v176, v177
    v_cvt_pk_bf16_f32 v93, v178, v179
    v_cvt_pk_bf16_f32 v94, v180, v181
    v_cvt_pk_bf16_f32 v95, v182, v183
    buffer_store_dwordx4 v[92:95], v1, s[4:7], s30 offen sc1
    s_add_u32 s30, s30, s50
    s_waitcnt lgkmcnt(0)
    v_or3_b32 v24, v24, v25, v26
    v_or3_b32 v28, v28, v29, v30
    v_or3_b32 v24, v24, v27, v31
    v_or_b32 v24, v24, v28
    s_mov_b32 s28, s51
    s_mov_b32 s57, s53
    v_readfirstlane_b32 s30, v24
    s_cmp_lg_u32 s30, 0
    s_cbranch_scc1 w_drain
    s_mov_b32 s48, s32
    s_cmp_ge_u32 s32, 4
    s_cselect_b32 s30, 2, 3
    s_lshl_b32 s30, s26, s30
    s_mul_i32 s30, s30, s43
    s_add_u32 s49, s42, s30
    s_mov_b32 s50, s43
    s_mov_b32 s51, s46
    s_mov_b32 s23, s41
    s_mov_b32 s53, s47
    s_nop 0
    s_load_dwordx16 s[32:47], s[24:25], 0
    s_add_u32 s24, s24, 64
    s_addc_u32 s25, s25, 0
    s_branch w_first4
w_firstX:
    s_waitcnt vmcnt(0)
    s_barrier
    v_bfe_u32 v20, v1, 4, 3
    v_xor_b32 v21, v4, v20
    v_lshlrev_b32 v21, 4, v21
    v_lshl_add_u32 v21, v20, 7, v21
    v_bfe_u32 v20, v1, 7, 1
    v_lshl_add_u32 v21, v20, 10, v21
    s_lshl_b32 s30, s26, 13
    v_add_u32 v24, s30, v21
    v_xor_b32 v25, 64, v24
    v_add_u32 v26, 0x10000, v24
    v_add_u32 v27, 0x10000, v25
    v_add_u32 v28, s22, v1
    v_add_u32 v29, 0x10000, v28
    ds_read_b64_tr_b16 v[64:65], v8 offset:16384
    ds_read_b64_tr_b16 v[66:67], v9 offset:16384
    ds_read_b64_tr_b16 v[68:69], v10 offset:16384
    ds_read_b64_tr_b16 v[70:71], v11 offset:16384
    ds_read_b64_tr_b16 v[72:73], v8 offset:24576
    ds_read_b64_tr_b16 v[74:75], v9 offset:24576
    ds_read_b64_tr_b16 v[76:77], v10 offset:24576
    ds_read_b64_tr_b16 v[78:79], v11 offset:24576
    ds_read_b128 v[32:35], v24 offset:0
    ds_read_b128 v[36:39], v25 offset:0
    ds_read_b128 v[40:43], v24 offset:2048
    ds_read_b128 v[44:47], v25 offset:2048
    ds_read_b128 v[48:51], v24 offset:4096
    ds_read_b128 v[52:55], v25 offset:4096
    ds_read_b128 v[56:59], v24 offset:6144
    ds_read_b128 v[60:63], v25 offset:6144
    v_mov_b32 v208, 0x3f803f80
    v_mov_b32 v209, 0x3f803f80
    v_mov_b32 v210, 0x3f803f80
    v_mov_b32 v211, 0x3f803f80
    s_waitcnt lgkmcnt(0)
    s_waitcnt vmcnt(8)
    s_barrier
    s_add_u32 m0, s21, 0
    s_nop 0
    buffer_load_dwordx4 v23, s[88:91], s16 offen lds
    s_add_u32 s16, s16, s62
    s_add_u32 m0, s21, 1024
    s_nop 0
    buffer_load_dwordx4 v23, s[88:91], s17 offen lds
    s_add_u32 s17, s17, s62
    s_cmp_ge_u32 s16, s92
    s_cselect_b32 s94, 2048, 0
    s_sub_u32 s16, s16, s94
    s_sub_u32 s17, s17, s94
    s_add_u32 m0, s22, 0
    s_nop 0
    buffer_load_dwordx4 v2, s[8:11], s18 offen lds
    s_add_u32 s18, s18, s20
    s_add_u32 m0, s22, 8192
    s_nop 0
    buffer_load_dwordx4 v2, s[12:15], s19 offen lds
    s_add_u32 s19, s19, s20
    s_cmp_ge_u32 s18, s95
    s_cselect_b32 s94, s93, 0
    s_sub_u32 s18, s18, s94
    s_sub_u32 s19, s19, s94
    v_mfma_f32_16x16x32_bf16 v[128:131], v[64:67], v[32:35], 0
    ds_read_b64_tr_b16 v[112:113], v8 offset:49152
    v_mfma_f32_16x16x32_bf16 v[132:135], v[68:71], v[32:35], 0
    ds_read_b64_tr_b16 v[114:115], v9 offset:49152
    v_mfma_f32_16x16x32_bf16 v[144:147], v[64:67], v[40:43], 0
    ds_read_b64_tr_b16 v[116:117], v10 offset:49152
    v_mfma_f32_16x16x32_bf16 v[148:151], v[68:71], v[40:43], 0
    ds_read_b64_tr_b16 v[118:119], v11 offset:49152
    v_mfma_f32_16x16x32_bf16 v[160:163], v[64:67], v[48:51], 0
    ds_read_b64_tr_b16 v[120:121], v8 offset:57344
    v_mfma_f32_16x16x32_bf16 v[164:167], v[68:71], v[48:51], 0
    ds_read_b64_tr_b16 v[122:123], v9 offset:57344
    v_mfma_f32_16x16x32_bf16 v[176:179], v[64:67], v[56:59], 0
    ds_read_b64_tr_b16 v[124:125], v10 offset:57344
    v_mfma_f32_16x16x32_bf16 v[180:183], v[68:71], v[56:59], 0
    ds_read_b64_tr_b16 v[126:127], v11 offset:57344
    v_mfma_f32_16x16x32_bf16 v[192:195], v[64:67], v[208:211], 0
    ds_read_b128 v[80:83], v24 offset:32768
    v_mfma_f32_16x16x32_bf16 v[196:199], v[68:71], v[208:211], 0
    ds_read_b128 v[84:87], v25 offset:32768
    v_mfma_f32_16x16x32_bf16 v[128:131], v[72:75], v[36:39], v[128:131]
    ds_read_b128 v[88:91], v24 offset:34816
    v_mfma_f32_16x16x32_bf16 v[132:135], v[76:79], v[36:39], v[132:135]
    ds_read_b128 v[92:95], v25 offset:34816
    v_mfma_f32_16x16x32_bf16 v[144:147], v[72:75], v[44:47], v[144:147]
    ds_read_b128 v[96:99], v24 offset:36864
    v_mfma_f32_16x16x32_bf16 v[148:151], v[76:79], v[44:47], v[148:151]
    ds_read_b128 v[100:103], v25 offset:36864
    v_mfma_f32_16x16x32_bf16 v[160:163], v[72:75], v[52:55], v[160:163]
    ds_read_b128 v[104:107], v24 offset:38912
    v_mfma_f32_16x16x32_bf16 v[164:167], v[76:79], v[52:55], v[164:167]
    ds_read_b128 v[108:111], v25 offset:38912
    v_mfma_f32_16x16x32_bf16 v[176:179], v[72:75], v[60:63], v[176:179]
    v_mfma_f32_16x16x32_bf16 v[180:183], v[76:79], v[60:63], v[180:183]
    v_mfma_f32_16x16x32_bf16 v[192:195], v[72:75], v[208:211], v[192:195]
    v_mfma_f32_16x16x32_bf16 v[196:199], v[76:79], v[208:211], v[196:199]
    s_waitcnt lgkmcnt(0)
    s_waitcnt vmcnt(8)
    s_barrier
    s_add_u32 m0, s21, 32768
    s_nop 0
    buffer_load_dwordx4 v23, s[88:91], s16 offen lds
    s_add_u32 s16, s16, s62
    s_add_u32 m0, s21, 33792
    s_nop 0
    buffer_load_dwordx4 v23, s[88:91], s17 offen lds
    s_add_u32 s17, s17, s62
    s_cmp_ge_u32 s16, s92
    s_cselect_b32 s94, 2048, 0
    s_sub_u32 s16, s16, s94
    s_sub_u32 s17, s17, s94
    s_add_u32 m0, s22, 32768
    s_nop 0
    buffer_load_dwordx4 v2, s[8:11], s18 offen lds
    s_add_u32 s18, s18, s20
    s_add_u32 m0, s22, 40960
    s_nop 0
    buffer_load_dwordx4 v2, s[12:15], s19 offen lds
    s_add_u32 s19, s19, s20
    s_cmp_ge_u32 s18, s95
    s_cselect_b32 s94, s93, 0
    s_sub_u32 s18, s18, s94
    s_sub_u32 s19, s19, s94
    v_mfma_f32_16x16x32_bf16 v[128:131], v[112:115], v[80:83], v[128:131]
    ds_read_b64_tr_b16 v[64:65], v12 offset:16384
    v_mfma_f32_16x16x32_bf16 v[132:135], v[116:119], v[80:83], v[132:135]
    ds_read_b64_tr_b16 v[66:67], v13 offset:16384
    v_mfma_f32_16x16x32_bf16 v[144:147], v[112:115], v[88:91], v[144:147]
    ds_read_b64_tr_b16 v[68:69], v14 offset:16384
    v_mfma_f32_16x16x32_bf16 v[148:151], v[116:119], v[88:91], v[148:151]
    ds_read_b64_tr_b16 v[70:71], v15 offset:16384
    v_mfma_f32_16x16x32_bf16 v[160:163], v[112:115], v[96:99], v[160:163]
    ds_read_b64_tr_b16 v[72:73], v12 offset:24576
    v_mfma_f32_16x16x32_bf16 v[164:167], v[116:119], v[96:99], v[164:167]
    ds_read_b64_tr_b16 v[74:75], v13 offset:24576
    v_mfma_f32_16x16x32_bf16 v[176:179], v[112:115], v[104:107], v[176:179]
    ds_read_b64_tr_b16 v[76:77], v14 offset:24576
    v_mfma_f32_16x16x32_bf16 v[180:183], v[116:119], v[104:107], v[180:183]
    ds_read_b64_tr_b16 v[78:79], v15 offset:24576
    v_mfma_f32_16x16x32_bf16 v[192:195], v[112:115], v[208:211], v[192:195]
    ds_read_b128 v[32:35], v26 offset:0
    v_mfma_f32_16x16x32_bf16 v[196:199], v[116:119], v[208:211], v[196:199]
    ds_read_b128 v[36:39], v27 offset:0
    v_mfma_f32_16x16x32_bf16 v[128:131], v[120:123], v[84:87], v[128:131]
    ds_read_b128 v[40:43], v26 offset:2048
    v_mfma_f32_16x16x32_bf16 v[132:135], v[124:127], v[84:87], v[132:135]
    ds_read_b128 v[44:47], v27 offset:2048
    v_mfma_f32_16x16x32_bf16 v[144:147], v[120:123], v[92:95], v[144:147]
    ds_read_b128 v[48:51], v26 offset:4096
    v_mfma_f32_16x16x32_bf16 v[148:151], v[124:127], v[92:95], v[148:151]
    ds_read_b128 v[52:55], v27 offset:4096
    v_mfma_f32_16x16x32_bf16 v[160:163], v[120:123], v[100:103], v[160:163]
    ds_read_b128 v[56:59], v26 offset:6144
    v_mfma_f32_16x16x32_bf16 v[164:167], v[124:127], v[100:103], v[164:167]
    ds_read_b128 v[60:63], v27 offset:6144
    v_mfma_f32_16x16x32_bf16 v[176:179], v[120:123], v[108:111], v[176:179]
    v_mfma_f32_16x16x32_bf16 v[180:183], v[124:127], v[108:111], v[180:183]
    v_mfma_f32_16x16x32_bf16 v[192:195], v[120:123], v[208:211], v[192:195]
    v_mfma_f32_16x16x32_bf16 v[196:199], v[124:127], v[208:211], v[196:199]
    s_waitcnt lgkmcnt(0)
    s_waitcnt vmcnt(8)
    s_barrier
    s_add_u32 m0, s21, 65536
    s_nop 0
    buffer_load_dwordx4 v23, s[88:91], s16 offen lds
    s_add_u32 s16, s16, s62
    s_add_u32 m0, s21, 66560
    s_nop 0
    buffer_load_dwordx4 v23, s[88:91], s17 offen lds
    s_add_u32 s17, s17, s62
    s_cmp_ge_u32 s16, s92
    s_cselect_b32 s94, 2048, 0
    s_sub_u32 s16, s16, s94
    s_sub_u32 s17, s17, s94
    s_add_u32 m0, s22, 65536
    s_nop 0
    buffer_load_dwordx4 v2, s[8:11], s18 offen lds
    s_add_u32 s18, s18, s20
    s_add_u32 m0, s22, 73728
    s_nop 0
    buffer_load_dwordx4 v2, s[12:15], s19 offen lds
    s_add_u32 s19, s19, s20
    s_cmp_ge_u32 s18, s95
    s_cselect_b32 s94, s93, 0
    s_sub_u32 s18, s18, s94
    s_sub_u32 s19, s19, s94
    v_mfma_f32_16x16x32_bf16 v[128:131], v[64:67], v[32:35], v[128:131]
    ds_read_b64_tr_b16 v[112:113], v12 offset:49152
    v_mfma_f32_16x16x32_bf16 v[132:135], v[68:71], v[32:35], v[132:135]
    ds_read_b64_tr_b16 v[114:115], v13 offset:49152
    v_mfma_f32_16x16x32_bf16 v[144:147], v[64:67], v[40:43], v[144:147]
    ds_read_b64_tr_b16 v[116:117], v14 offset:49152
    v_mfma_f32_16x16x32_bf16 v[148:151], v[68:71], v[40:43], v[148:151]
    ds_read_b64_tr_b16 v[118:119], v15 offset:49152
    v_mfma_f32_16x16x32_bf16 v[160:163], v[64:67], v[48:51], v[160:163]
    ds_read_b64_tr_b16 v[120:121], v12 offset:57344
    v_mfma_f32_16x16x32_bf16 v[164:167], v[68:71], v[48:51], v[164:167]
    ds_read_b64_tr_b16 v[122:123], v13 offset:57344
    v_mfma_f32_16x16x32_bf16 v[176:179], v[64:67], v[56:59], v[176:179]
    ds_read_b64_tr_b16 v[124:125], v14 offset:57344
    v_mfma_f32_16x16x32_bf16 v[180:183], v[68:71], v[56:59], v[180:183]
    ds_read_b64_tr_b16 v[126:127], v15 offset:57344
    v_mfma_f32_16x16x32_bf16 v[192:195], v[64:67], v[208:211], v[192:195]
    ds_read_b128 v[80:83], v26 offset:32768
    v_mfma_f32_16x16x32_bf16 v[196:199], v[68:71], v[208:211], v[196:199]
    ds_read_b128 v[84:87], v27 offset:32768
    v_mfma_f32_16x16x32_bf16 v[128:131], v[72:75], v[36:39], v[128:131]
    ds_read_b128 v[88:91], v26 offset:34816
    v_mfma_f32_16x16x32_bf16 v[132:135], v[76:79], v[36:39], v[132:135]
    ds_read_b128 v[92:95], v27 offset:34816
    v_mfma_f32_16x16x32_bf16 v[144:147], v[72:75], v[44:47], v[144:147]
    ds_read_b128 v[96:99], v26 offset:36864
    v_mfma_f32_16x16x32_bf16 v[148:151], v[76:79], v[44:47], v[148:151]
    ds_read_b128 v[100:103], v27 offset:36864
    v_mfma_f32_16x16x32_bf16 v[160:163], v[72:75], v[52:55], v[160:163]
    ds_read_b128 v[104:107], v26 offset:38912
    v_mfma_f32_16x16x32_bf16 v[164:167], v[76:79], v[52:55], v[164:167]
    ds_read_b128 v[108:111], v27 offset:38912
    v_mfma_f32_16x16x32_bf16 v[176:179], v[72:75], v[60:63], v[176:179]
    v_mfma_f32_16x16x32_bf16 v[180:183], v[76:79], v[60:63], v[180:183]
    v_mfma_f32_16x16x32_bf16 v[192:195], v[72:75], v[208:211], v[192:195]
    v_mfma_f32_16x16x32_bf16 v[196:199], v[76:79], v[208:211], v[196:199]
    s_waitcnt lgkmcnt(0)
    s_waitcnt vmcnt(8)
    s_barrier
    s_add_u32 m0, s21, 98304
    s_nop 0
    buffer_load_dwordx4 v23, s[88:91], s16 offen lds
    s_add_u32 s16, s16, s62
    s_add_u32 m0, s21, 99328
    s_nop 0
    buffer_load_dwordx4 v23, s[88:91], s17 offen lds
    s_add_u32 s17, s17, s62
    s_cmp_ge_u32 s16, s92
    s_cselect_b32 s94, 2048, 0
    s_sub_u32 s16, s16, s94
    s_sub_u32 s17, s17, s94
    s_add_u32 m0, s22, 98304
    s_nop 0
    buffer_load_dwordx4 v2, s[8:11], s18 offen lds
    s_add_u32 s18, s18, s20
    s_add_u32 m0, s22, 106496
    s_nop 0
    buffer_load_dwordx4 v2, s[12:15], s19 offen lds
    s_add_u32 s19, s19, s20
    s_cmp_ge_u32 s18, s95
    s_cselect_b32 s94, s93, 0
    s_sub_u32 s18, s18, s94
    s_sub_u32 s19, s19, s94
    v_mfma_f32_16x16x32_bf16 v[128:131], v[112:115], v[80:83], v[128:131]
    ds_read_b64_tr_b16 v[64:65], v8 offset:16384
    v_mfma_f32_16x16x32_bf16 v[132:135], v[116:119], v[80:83], v[132:135]
    ds_read_b64_tr_b16 v[66:67], v9 offset:16384
    v_mfma_f32_16x16x32_bf16 v[144:147], v[112:115], v[88:91], v[144:147]
    ds_read_b64_tr_b16 v[68:69], v10 offset:16384
    v_mfma_f32_16x16x32_bf16 v[148:151], v[116:119], v[88:91], v[148:151]
    ds_read_b64_tr_b16 v[70:71], v11 offset:16384
    v_mfma_f32_16x16x32_bf16 v[160:163], v[112:115], v[96:99], v[160:163]
    ds_read_b64_tr_b16 v[72:73], v8 offset:24576
    v_mfma_f32_16x16x32_bf16 v[164:167], v[116:119], v[96:99], v[164:167]
    ds_read_b64_tr_b16 v[74:75], v9 offset:24576
    v_mfma_f32_16x16x32_bf16 v[176:179], v[112:115], v[104:107], v[176:179]
    ds_read_b64_tr_b16 v[76:77], v10 offset:24576
    v_mfma_f32_16x16x32_bf16 v[180:183], v[116:119], v[104:107], v[180:183]
    ds_read_b64_tr_b16 v[78:79], v11 offset:24576
    v_mfma_f32_16x16x32_bf16 v[192:195], v[112:115], v[208:211], v[192:195]
    ds_read_b128 v[32:35], v24 offset:0
    v_mfma_f32_16x16x32_bf16 v[196:199], v[116:119], v[208:211], v[196:199]
    ds_read_b128 v[36:39], v25 offset:0
    v_mfma_f32_16x16x32_bf16 v[128:131], v[120:123], v[84:87], v[128:131]
    ds_read_b128 v[40:43], v24 offset:2048
    v_mfma_f32_16x16x32_bf16 v[132:135], v[124:127], v[84:87], v[132:135]
    ds_read_b128 v[44:47], v25 offset:2048
    v_mfma_f32_16x16x32_bf16 v[144:147], v[120:123], v[92:95], v[144:147]
    ds_read_b128 v[48:51], v24 offset:4096
    v_mfma_f32_16x16x32_bf16 v[148:151], v[124:127], v[92:95], v[148:151]
    ds_read_b128 v[52:55], v25 offset:4096
    v_mfma_f32_16x16x32_bf16 v[160:163], v[120:123], v[100:103], v[160:163]
    ds_read_b128 v[56:59], v24 offset:6144
    v_mfma_f32_16x16x32_bf16 v[164:167], v[124:127], v[100:103], v[164:167]
    ds_read_b128 v[60:63], v25 offset:6144
    v_mfma_f32_16x16x32_bf16 v[176:179], v[120:123], v[108:111], v[176:179]
    v_mfma_f32_16x16x32_bf16 v[180:183], v[124:127], v[108:111], v[180:183]
    v_mfma_f32_16x16x32_bf16 v[192:195], v[120:123], v[208:211], v[192:195]
    v_mfma_f32_16x16x32_bf16 v[196:199], v[124:127], v[208:211], v[196:199]
    s_waitcnt lgkmcnt(0)
    s_waitcnt vmcnt(8)
    s_barrier
    s_add_u32 m0, s21, 0
    s_nop 0
    buffer_load_dwordx4 v23, s[88:91], s16 offen lds
    s_add_u32 s16, s16, s62
    s_add_u32 m0, s21, 1024
    s_nop 0
    buffer_load_dwordx4 v23, s[88:91], s17 offen lds
    s_add_u32 s17, s17, s62
    s_cmp_ge_u32 s16, s92
    s_cselect_b32 s94, 2048, 0
    s_sub_u32 s16, s16, s94
    s_sub_u32 s17, s17, s94
    s_add_u32 m0, s22, 0
    s_nop 0
    buffer_load_dwordx4 v2, s[8:11], s18 offen lds
    s_add_u32 s18, s18, s20
    s_add_u32 m0, s22, 8192
    s_nop 0
    buffer_load_dwordx4 v2, s[12:15], s19 offen lds
    s_add_u32 s19, s19, s20
    s_cmp_ge_u32 s18, s95
    s_cselect_b32 s94, s93, 0
    s_sub_u32 s18, s18, s94
    s_sub_u32 s19, s19, s94
    v_mfma_f32_16x16x32_bf16 v[128:131], v[64:67], v[32:35], v[128:131]
    ds_read_b64_tr_b16 v[112:113], v8 offset:49152
    v_mfma_f32_16x16x32_bf16 v[132:135], v[68:71], v[32:35], v[132:135]
    ds_read_b64_tr_b16 v[114:115], v9 offset:49152
    v_mfma_f32_16x16x32_bf16 v[144:147], v[64:67], v[40:43], v[144:147]
    ds_read_b64_tr_b16 v[116:117], v10 offset:49152
    v_mfma_f32_16x16x32_bf16 v[148:151], v[68:71], v[40:43], v[148:151]
    ds_read_b64_tr_b16 v[118:119], v11 offset:49152
    v_mfma_f32_16x16x32_bf16 v[160:163], v[64:67], v[48:51], v[160:163]
    ds_read_b64_tr_b16 v[120:121], v8 offset:57344
    v_mfma_f32_16x16x32_bf16 v[164:167], v[68:71], v[48:51], v[164:167]
    ds_read_b64_tr_b16 v[122:123], v9 offset:57344
    v_mfma_f32_16x16x32_bf16 v[176:179], v[64:67], v[56:59], v[176:179]
    ds_read_b64_tr_b16 v[124:125], v10 offset:57344
    v_mfma_f32_16x16x32_bf16 v[180:183], v[68:71], v[56:59], v[180:183]
    ds_read_b64_tr_b16 v[126:127], v11 offset:57344
    v_mfma_f32_16x16x32_bf16 v[192:195], v[64:67], v[208:211], v[192:195]
    ds_read_b128 v[80:83], v24 offset:32768
    v_mfma_f32_16x16x32_bf16 v[196:199], v[68:71], v[208:211], v[196:199]
    ds_read_b128 v[84:87], v25 offset:32768
    v_mfma_f32_16x16x32_bf16 v[128:131], v[72:75], v[36:39], v[128:131]
    ds_read_b128 v[88:91], v24 offset:34816
    v_mfma_f32_16x16x32_bf16 v[132:135], v[76:79], v[36:39], v[132:135]
    ds_read_b128 v[92:95], v25 offset:34816
    v_mfma_f32_16x16x32_bf16 v[144:147], v[72:75], v[44:47], v[144:147]
    ds_read_b128 v[96:99], v24 offset:36864
    v_mfma_f32_16x16x32_bf16 v[148:151], v[76:79], v[44:47], v[148:151]
    ds_read_b128 v[100:103], v25 offset:36864
    v_mfma_f32_16x16x32_bf16 v[160:163], v[72:75], v[52:55], v[160:163]
    ds_read_b128 v[104:107], v24 offset:38912
    v_mfma_f32_16x16x32_bf16 v[164:167], v[76:79], v[52:55], v[164:167]
    ds_read_b128 v[108:111], v25 offset:38912
    v_mfma_f32_16x16x32_bf16 v[176:179], v[72:75], v[60:63], v[176:179]
    v_mfma_f32_16x16x32_bf16 v[180:183], v[76:79], v[60:63], v[180:183]
    v_mfma_f32_16x16x32_bf16 v[192:195], v[72:75], v[208:211], v[192:195]
    v_mfma_f32_16x16x32_bf16 v[196:199], v[76:79], v[208:211], v[196:199]
    s_waitcnt lgkmcnt(0)
    s_waitcnt vmcnt(8)
    s_barrier
    s_add_u32 m0, s21, 32768
    s_nop 0
    buffer_load_dwordx4 v23, s[88:91], s16 offen lds
    s_add_u32 s16, s16, s62
    s_add_u32 m0, s21, 33792
    s_nop 0
    buffer_load_dwordx4 v23, s[88:91], s17 offen lds
    s_add_u32 s17, s17, s62
    s_cmp_ge_u32 s16, s92
    s_cselect_b32 s94, 2048, 0
    s_sub_u32 s16, s16, s94
    s_sub_u32 s17, s17, s94
    s_add_u32 m0, s22, 32768
    s_nop 0
    buffer_load_dwordx4 v2, s[8:11], s18 offen lds
    s_add_u32 s18, s18, s20
    s_add_u32 m0, s22, 40960
    s_nop 0
    buffer_load_dwordx4 v2, s[12:15], s19 offen lds
    s_add_u32 s19, s19, s20
    s_cmp_ge_u32 s18, s95
    s_cselect_b32 s94, s93, 0
    s_sub_u32 s18, s18, s94
    s_sub_u32 s19, s19, s94
    v_mfma_f32_16x16x32_bf16 v[128:131], v[112:115], v[80:83], v[128:131]
    ds_read_b64_tr_b16 v[64:65], v12 offset:16384
    v_mfma_f32_16x16x32_bf16 v[132:135], v[116:119], v[80:83], v[132:135]
    ds_read_b64_tr_b16 v[66:67], v13 offset:16384
    v_mfma_f32_16x16x32_bf16 v[144:147], v[112:115], v[88:91], v[144:147]
    ds_read_b64_tr_b16 v[68:69], v14 offset:16384
    v_mfma_f32_16x16x32_bf16 v[148:151], v[116:119], v[88:91], v[148:151]
    ds_read_b64_tr_b16 v[70:71], v15 offset:16384
    v_mfma_f32_16x16x32_bf16 v[160:163], v[112:115], v[96:99], v[160:163]
    ds_read_b64_tr_b16 v[72:73], v12 offset:24576
    v_mfma_f32_16x16x32_bf16 v[164:167], v[116:119], v[96:99], v[164:167]
    ds_read_b64_tr_b16 v[74:75], v13 offset:24576
    v_mfma_f32_16x16x32_bf16 v[176:179], v[112:115], v[104:107], v[176:179]
    ds_read_b64_tr_b16 v[76:77], v14 offset:24576
    v_mfma_f32_16x16x32_bf16 v[180:183], v[116:119], v[104:107], v[180:183]
    ds_read_b64_tr_b16 v[78:79], v15 offset:24576
    v_mfma_f32_16x16x32_bf16 v[192:195], v[112:115], v[208:211], v[192:195]
    ds_read_b128 v[32:35], v26 offset:0
    v_mfma_f32_16x16x32_bf16 v[196:199], v[116:119], v[208:211], v[196:199]
    ds_read_b128 v[36:39], v27 offset:0
    v_mfma_f32_16x16x32_bf16 v[128:131], v[120:123], v[84:87], v[128:131]
    ds_read_b128 v[40:43], v26 offset:2048
    v_mfma_f32_16x16x32_bf16 v[132:135], v[124:127], v[84:87], v[132:135]
    ds_read_b128 v[44:47], v27 offset:2048
    v_mfma_f32_16x16x32_bf16 v[144:147], v[120:123], v[92:95], v[144:147]
    ds_read_b128 v[48:51], v26 offset:4096
    v_mfma_f32_16x16x32_bf16 v[148:151], v[124:127], v[92:95], v[148:151]
    ds_read_b128 v[52:55], v27 offset:4096
    v_mfma_f32_16x16x32_bf16 v[160:163], v[120:123], v[100:103], v[160:163]
    ds_read_b128 v[56:59], v26 offset:6144
    v_mfma_f32_16x16x32_bf16 v[164:167], v[124:127], v[100:103], v[164:167]
    ds_read_b128 v[60:63], v27 offset:6144
    v_mfma_f32_16x16x32_bf16 v[176:179], v[120:123], v[108:111], v[176:179]
    v_mfma_f32_16x16x32_bf16 v[180:183], v[124:127], v[108:111], v[180:183]
    v_mfma_f32_16x16x32_bf16 v[192:195], v[120:123], v[208:211], v[192:195]
    v_mfma_f32_16x16x32_bf16 v[196:199], v[124:127], v[208:211], v[196:199]
    s_waitcnt lgkmcnt(0)
    s_waitcnt vmcnt(8)
    s_barrier
    s_add_u32 m0, s21, 65536
    s_nop 0
    buffer_load_dwordx4 v23, s[88:91], s16 offen lds
    s_add_u32 s16, s16, s62
    s_add_u32 m0, s21, 66560
    s_nop 0
    buffer_load_dwordx4 v23, s[88:91], s17 offen lds
    s_add_u32 s17, s17, s62
    s_cmp_ge_u32 s16, s92
    s_cselect_b32 s94, 2048, 0
    s_sub_u32 s16, s16, s94
    s_sub_u32 s17, s17, s94
    s_add_u32 m0, s22, 65536
    s_nop 0
    buffer_load_dwordx4 v2, s[8:11], s18 offen lds
    s_add_u32 s18, s18, s20
    s_add_u32 m0, s22, 73728
    s_nop 0
    buffer_load_dwordx4 v2, s[12:15], s19 offen lds
    s_add_u32 s19, s19, s20
    s_cmp_ge_u32 s18, s95
    s_cselect_b32 s94, s93, 0
    s_sub_u32 s18, s18, s94
    s_sub_u32 s19, s19, s94
    v_mfma_f32_16x16x32_bf16 v[128:131], v[64:67], v[32:35], v[128:131]
    ds_read_b64_tr_b16 v[112:113], v12 offset:49152
    v_mfma_f32_16x16x32_bf16 v[132:135], v[68:71], v[32:35], v[132:135]
    ds_read_b64_tr_b16 v[114:115], v13 offset:49152
    v_mfma_f32_16x16x32_bf16 v[144:147], v[64:67], v[40:43], v[144:147]
    ds_read_b64_tr_b16 v[116:117], v14 offset:49152
    v_mfma_f32_16x16x32_bf16 v[148:151], v[68:71], v[40:43], v[148:151]
    ds_read_b64_tr_b16 v[118:119], v15 offset:49152
    v_mfma_f32_16x16x32_bf16 v[160:163], v[64:67], v[48:51], v[160:163]
    ds_read_b64_tr_b16 v[120:121], v12 offset:57344
    v_mfma_f32_16x16x32_bf16 v[164:167], v[68:71], v[48:51], v[164:167]
    ds_read_b64_tr_b16 v[122:123], v13 offset:57344
    v_mfma_f32_16x16x32_bf16 v[176:179], v[64:67], v[56:59], v[176:179]
    ds_read_b64_tr_b16 v[124:125], v14 offset:57344
    v_mfma_f32_16x16x32_bf16 v[180:183], v[68:71], v[56:59], v[180:183]
    ds_read_b64_tr_b16 v[126:127], v15 offset:57344
    v_mfma_f32_16x16x32_bf16 v[192:195], v[64:67], v[208:211], v[192:195]
    ds_read_b128 v[80:83], v26 offset:32768
    v_mfma_f32_16x16x32_bf16 v[196:199], v[68:71], v[208:211], v[196:199]
    ds_read_b128 v[84:87], v27 offset:32768
    v_mfma_f32_16x16x32_bf16 v[128:131], v[72:75], v[36:39], v[128:131]
    ds_read_b128 v[88:91], v26 offset:34816
    v_mfma_f32_16x16x32_bf16 v[132:135], v[76:79], v[36:39], v[132:135]
    ds_read_b128 v[92:95], v27 offset:34816
    v_mfma_f32_16x16x32_bf16 v[144:147], v[72:75], v[44:47], v[144:147]
    ds_read_b128 v[96:99], v26 offset:36864
    v_mfma_f32_16x16x32_bf16 v[148:151], v[76:79], v[44:47], v[148:151]
    ds_read_b128 v[100:103], v27 offset:36864
    v_mfma_f32_16x16x32_bf16 v[160:163], v[72:75], v[52:55], v[160:163]
    ds_read_b128 v[104:107], v26 offset:38912
    v_mfma_f32_16x16x32_bf16 v[164:167], v[76:79], v[52:55], v[164:167]
    ds_read_b128 v[108:111], v27 offset:38912
    v_mfma_f32_16x16x32_bf16 v[176:179], v[72:75], v[60:63], v[176:179]
    v_mfma_f32_16x16x32_bf16 v[180:183], v[76:79], v[60:63], v[180:183]
    v_mfma_f32_16x16x32_bf16 v[192:195], v[72:75], v[208:211], v[192:195]
    v_mfma_f32_16x16x32_bf16 v[196:199], v[76:79], v[208:211], v[196:199]
    s_waitcnt lgkmcnt(0)
    s_waitcnt vmcnt(8)
    s_barrier
    s_add_u32 m0, s21, 98304
    s_nop 0
    buffer_load_dwordx4 v23, s[88:91], s16 offen lds
    s_add_u32 s16, s16, s62
    s_add_u32 m0, s21, 99328
    s_nop 0
    buffer_load_dwordx4 v23, s[88:91], s17 offen lds
    s_add_u32 s17, s17, s62
    s_cmp_ge_u32 s16, s92
    s_cselect_b32 s94, 2048, 0
    s_sub_u32 s16, s16, s94
    s_sub_u32 s17, s17, s94
    s_add_u32 m0, s22, 98304
    s_nop 0
    buffer_load_dwordx4 v2, s[8:11], s18 offen lds
    s_add_u32 s18, s18, s20
    s_add_u32 m0, s22, 106496
    s_nop 0
    buffer_load_dwordx4 v2, s[12:15], s19 offen lds
    s_add_u32 s19, s19, s20
    s_cmp_ge_u32 s18, s95
    s_cselect_b32 s94, s93, 0
    s_sub_u32 s18, s18, s94
    s_sub_u32 s19, s19, s94
    v_mfma_f32_16x16x32_bf16 v[128:131], v[112:115], v[80:83], v[128:131]
    ds_read_b64_tr_b16 v[64:65], v8 offset:16384
    v_mfma_f32_16x16x32_bf16 v[132:135], v[116:119], v[80:83], v[132:135]
    ds_read_b64_tr_b16 v[66:67], v9 offset:16384
    v_mfma_f32_16x16x32_bf16 v[144:147], v[112:115], v[88:91], v[144:147]
    ds_read_b64_tr_b16 v[68:69], v10 offset:16384
    v_mfma_f32_16x16x32_bf16 v[148:151], v[116:119], v[88:91], v[148:151]
    ds_read_b64_tr_b16 v[70:71], v11 offset:16384
    v_mfma_f32_16x16x32_bf16 v[160:163], v[112:115], v[96:99], v[160:163]
    ds_read_b64_tr_b16 v[72:73], v8 offset:24576
    v_mfma_f32_16x16x32_bf16 v[164:167], v[116:119], v[96:99], v[164:167]
    ds_read_b64_tr_b16 v[74:75], v9 offset:24576
    v_mfma_f32_16x16x32_bf16 v[176:179], v[112:115], v[104:107], v[176:179]
    ds_read_b64_tr_b16 v[76:77], v10 offset:24576
    v_mfma_f32_16x16x32_bf16 v[180:183], v[116:119], v[104:107], v[180:183]
    ds_read_b64_tr_b16 v[78:79], v11 offset:24576
    v_mfma_f32_16x16x32_bf16 v[192:195], v[112:115], v[208:211], v[192:195]
    ds_read_b128 v[32:35], v24 offset:0
    v_mfma_f32_16x16x32_bf16 v[196:199], v[116:119], v[208:211], v[196:199]
    ds_read_b128 v[36:39], v25 offset:0
    v_mfma_f32_16x16x32_bf16 v[128:131], v[120:123], v[84:87], v[128:131]
    ds_read_b128 v[40:43], v24 offset:2048
    v_mfma_f32_16x16x32_bf16 v[132:135], v[124:127], v[84:87], v[132:135]
    ds_read_b128 v[44:47], v25 offset:2048
    v_mfma_f32_16x16x32_bf16 v[144:147], v[120:123], v[92:95], v[144:147]
    ds_read_b128 v[48:51], v24 offset:4096
    v_mfma_f32_16x16x32_bf16 v[148:151], v[124:127], v[92:95], v[148:151]
    ds_read_b128 v[52:55], v25 offset:4096
    v_mfma_f32_16x16x32_bf16 v[160:163], v[120:123], v[100:103], v[160:163]
    ds_read_b128 v[56:59], v24 offset:6144
    v_mfma_f32_16x16x32_bf16 v[164:167], v[124:127], v[100:103], v[164:167]
    ds_read_b128 v[60:63], v25 offset:6144
    v_mfma_f32_16x16x32_bf16 v[176:179], v[120:123], v[108:111], v[176:179]
    v_mfma_f32_16x16x32_bf16 v[180:183], v[124:127], v[108:111], v[180:183]
    v_mfma_f32_16x16x32_bf16 v[192:195], v[120:123], v[208:211], v[192:195]
    v_mfma_f32_16x16x32_bf16 v[196:199], v[124:127], v[208:211], v[196:199]
    s_waitcnt lgkmcnt(0)
    s_waitcnt vmcnt(8)
    s_barrier
    s_add_u32 m0, s21, 0
    s_nop 0
    buffer_load_dwordx4 v23, s[88:91], s16 offen lds
    s_add_u32 s16, s16, s62
    s_add_u32 m0, s21, 1024
    s_nop 0
    buffer_load_dwordx4 v23, s[88:91], s17 offen lds
    s_add_u32 s17, s17, s62
    s_cmp_ge_u32 s16, s92
    s_cselect_b32 s94, 2048, 0
    s_sub_u32 s16, s16, s94
    s_sub_u32 s17, s17, s94
    s_add_u32 m0, s22, 0
    s_nop 0
    buffer_load_dwordx4 v2, s[8:11], s18 offen lds
    s_add_u32 s18, s18, s20
    s_add_u32 m0, s22, 8192
    s_nop 0
    buffer_load_dwordx4 v2, s[12:15], s19 offen lds
    s_add_u32 s19, s19, s20
    s_cmp_ge_u32 s18, s95
    s_cselect_b32 s94, s93, 0
    s_sub_u32 s18, s18, s94
    s_sub_u32 s19, s19, s94
    v_mfma_f32_16x16x32_bf16 v[128:131], v[64:67], v[32:35], v[128:131]
    ds_read_b64_tr_b16 v[112:113], v8 offset:49152
    v_mfma_f32_16x16x32_bf16 v[132:135], v[68:71], v[32:35], v[132:135]
    ds_read_b64_tr_b16 v[114:115], v9 offset:49152
    v_mfma_f32_16x16x32_bf16 v[144:147], v[64:67], v[40:43], v[144:147]
    ds_read_b64_tr_b16 v[116:117], v10 offset:49152
    v_mfma_f32_16x16x32_bf16 v[148:151], v[68:71], v[40:43], v[148:151]
    ds_read_b64_tr_b16 v[118:119], v11 offset:49152
    v_mfma_f32_16x16x32_bf16 v[160:163], v[64:67], v[48:51], v[160:163]
    ds_read_b64_tr_b16 v[120:121], v8 offset:57344
    v_mfma_f32_16x16x32_bf16 v[164:167], v[68:71], v[48:51], v[164:167]
    ds_read_b64_tr_b16 v[122:123], v9 offset:57344
    v_mfma_f32_16x16x32_bf16 v[176:179], v[64:67], v[56:59], v[176:179]
    ds_read_b64_tr_b16 v[124:125], v10 offset:57344
    v_mfma_f32_16x16x32_bf16 v[180:183], v[68:71], v[56:59], v[180:183]
    ds_read_b64_tr_b16 v[126:127], v11 offset:57344
    v_mfma_f32_16x16x32_bf16 v[192:195], v[64:67], v[208:211], v[192:195]
    ds_read_b128 v[80:83], v24 offset:32768
    v_mfma_f32_16x16x32_bf16 v[196:199], v[68:71], v[208:211], v[196:199]
    ds_read_b128 v[84:87], v25 offset:32768
    v_mfma_f32_16x16x32_bf16 v[128:131], v[72:75], v[36:39], v[128:131]
    ds_read_b128 v[88:91], v24 offset:34816
    v_mfma_f32_16x16x32_bf16 v[132:135], v[76:79], v[36:39], v[132:135]
    ds_read_b128 v[92:95], v25 offset:34816
    v_mfma_f32_16x16x32_bf16 v[144:147], v[72:75], v[44:47], v[144:147]
    ds_read_b128 v[96:99], v24 offset:36864
    v_mfma_f32_16x16x32_bf16 v[148:151], v[76:79], v[44:47], v[148:151]
    ds_read_b128 v[100:103], v25 offset:36864
    v_mfma_f32_16x16x32_bf16 v[160:163], v[72:75], v[52:55], v[160:163]
    ds_read_b128 v[104:107], v24 offset:38912
    v_mfma_f32_16x16x32_bf16 v[164:167], v[76:79], v[52:55], v[164:167]
    ds_read_b128 v[108:111], v25 offset:38912
    v_mfma_f32_16x16x32_bf16 v[176:179], v[72:75], v[60:63], v[176:179]
    v_mfma_f32_16x16x32_bf16 v[180:183], v[76:79], v[60:63], v[180:183]
    v_mfma_f32_16x16x32_bf16 v[192:195], v[72:75], v[208:211], v[192:195]
    v_mfma_f32_16x16x32_bf16 v[196:199], v[76:79], v[208:211], v[196:199]
    s_waitcnt lgkmcnt(0)
    s_waitcnt vmcnt(8)
    s_barrier
    s_add_u32 m0, s21, 32768
    s_nop 0
    buffer_load_dwordx4 v23, s[88:91], s16 offen lds
    s_add_u32 s16, s16, s62
    s_add_u32 m0, s21, 33792
    s_nop 0
    buffer_load_dwordx4 v23, s[88:91], s17 offen lds
    s_add_u32 s17, s17, s62
    s_cmp_ge_u32 s16, s92
    s_cselect_b32 s94, 2048, 0
    s_sub_u32 s16, s16, s94
    s_sub_u32 s17, s17, s94
    s_add_u32 m0, s22, 32768
    s_nop 0
    buffer_load_dwordx4 v2, s[8:11], s18 offen lds
    s_add_u32 s18, s18, s20
    s_add_u32 m0, s22, 40960
    s_nop 0
    buffer_load_dwordx4 v2, s[12:15], s19 offen lds
    s_add_u32 s19, s19, s20
    s_cmp_ge_u32 s18, s95
    s_cselect_b32 s94, s93, 0
    s_sub_u32 s18, s18, s94
    s_sub_u32 s19, s19, s94
    v_mfma_f32_16x16x32_bf16 v[128:131], v[112:115], v[80:83], v[128:131]
    ds_read_b64_tr_b16 v[64:65], v12 offset:16384
    v_mfma_f32_16x16x32_bf16 v[132:135], v[116:119], v[80:83], v[132:135]
    ds_read_b64_tr_b16 v[66:67], v13 offset:16384
    v_mfma_f32_16x16x32_bf16 v[144:147], v[112:115], v[88:91], v[144:147]
    ds_read_b64_tr_b16 v[68:69], v14 offset:16384
    v_mfma_f32_16x16x32_bf16 v[148:151], v[116:119], v[88:91], v[148:151]
    ds_read_b64_tr_b16 v[70:71], v15 offset:16384
    v_mfma_f32_16x16x32_bf16 v[160:163], v[112:115], v[96:99], v[160:163]
    ds_read_b64_tr_b16 v[72:73], v12 offset:24576
    v_mfma_f32_16x16x32_bf16 v[164:167], v[116:119], v[96:99], v[164:167]
    ds_read_b64_tr_b16 v[74:75], v13 offset:24576
    v_mfma_f32_16x16x32_bf16 v[176:179], v[112:115], v[104:107], v[176:179]
    ds_read_b64_tr_b16 v[76:77], v14 offset:24576
    v_mfma_f32_16x16x32_bf16 v[180:183], v[116:119], v[104:107], v[180:183]
    ds_read_b64_tr_b16 v[78:79], v15 offset:24576
    v_mfma_f32_16x16x32_bf16 v[192:195], v[112:115], v[208:211], v[192:195]
    ds_read_b128 v[32:35], v26 offset:0
    v_mfma_f32_16x16x32_bf16 v[196:199], v[116:119], v[208:211], v[196:199]
    ds_read_b128 v[36:39], v27 offset:0
    v_mfma_f32_16x16x32_bf16 v[128:131], v[120:123], v[84:87], v[128:131]
    ds_read_b128 v[40:43], v26 offset:2048
    v_mfma_f32_16x16x32_bf16 v[132:135], v[124:127], v[84:87], v[132:135]
    ds_read_b128 v[44:47], v27 offset:2048
    v_mfma_f32_16x16x32_bf16 v[144:147], v[120:123], v[92:95], v[144:147]
    ds_read_b128 v[48:51], v26 offset:4096
    v_mfma_f32_16x16x32_bf16 v[148:151], v[124:127], v[92:95], v[148:151]
    ds_read_b128 v[52:55], v27 offset:4096
    v_mfma_f32_16x16x32_bf16 v[160:163], v[120:123], v[100:103], v[160:163]
    ds_read_b128 v[56:59], v26 offset:6144
    v_mfma_f32_16x16x32_bf16 v[164:167], v[124:127], v[100:103], v[164:167]
    ds_read_b128 v[60:63], v27 offset:6144
    v_mfma_f32_16x16x32_bf16 v[176:179], v[120:123], v[108:111], v[176:179]
    v_mfma_f32_16x16x32_bf16 v[180:183], v[124:127], v[108:111], v[180:183]
    v_mfma_f32_16x16x32_bf16 v[192:195], v[120:123], v[208:211], v[192:195]
    v_mfma_f32_16x16x32_bf16 v[196:199], v[124:127], v[208:211], v[196:199]
    s_waitcnt lgkmcnt(0)
    s_waitcnt vmcnt(8)
    s_barrier
    s_add_u32 m0, s21, 65536
    s_nop 0
    buffer_load_dwordx4 v23, s[88:91], s16 offen lds
    s_add_u32 s16, s16, s62
    s_add_u32 m0, s21, 66560
    s_nop 0
    buffer_load_dwordx4 v23, s[88:91], s17 offen lds
    s_add_u32 s17, s17, s62
    s_cmp_ge_u32 s16, s92
    s_cselect_b32 s94, 2048, 0
    s_sub_u32 s16, s16, s94
    s_sub_u32 s17, s17, s94
    s_add_u32 m0, s22, 65536
    s_nop 0
    buffer_load_dwordx4 v2, s[8:11], s18 offen lds
    s_add_u32 s18, s18, s20
    s_add_u32 m0, s22, 73728
    s_nop 0
    buffer_load_dwordx4 v2, s[12:15], s19 offen lds
    s_add_u32 s19, s19, s20
    s_cmp_ge_u32 s18, s95
    s_cselect_b32 s94, s93, 0
    s_sub_u32 s18, s18, s94
    s_sub_u32 s19, s19, s94
    v_mfma_f32_16x16x32_bf16 v[128:131], v[64:67], v[32:35], v[128:131]
    ds_read_b64_tr_b16 v[112:113], v12 offset:49152
    v_mfma_f32_16x16x32_bf16 v[132:135], v[68:71], v[32:35], v[132:135]
    ds_read_b64_tr_b16 v[114:115], v13 offset:49152
    v_mfma_f32_16x16x32_bf16 v[144:147], v[64:67], v[40:43], v[144:147]
    ds_read_b64_tr_b16 v[116:117], v14 offset:49152
    v_mfma_f32_16x16x32_bf16 v[148:151], v[68:71], v[40:43], v[148:151]
    ds_read_b64_tr_b16 v[118:119], v15 offset:49152
    v_mfma_f32_16x16x32_bf16 v[160:163], v[64:67], v[48:51], v[160:163]
    ds_read_b64_tr_b16 v[120:121], v12 offset:57344
    v_mfma_f32_16x16x32_bf16 v[164:167], v[68:71], v[48:51], v[164:167]
    ds_read_b64_tr_b16 v[122:123], v13 offset:57344
    v_mfma_f32_16x16x32_bf16 v[176:179], v[64:67], v[56:59], v[176:179]
    ds_read_b64_tr_b16 v[124:125], v14 offset:57344
    v_mfma_f32_16x16x32_bf16 v[180:183], v[68:71], v[56:59], v[180:183]
    ds_read_b64_tr_b16 v[126:127], v15 offset:57344
    v_mfma_f32_16x16x32_bf16 v[192:195], v[64:67], v[208:211], v[192:195]
    ds_read_b128 v[80:83], v26 offset:32768
    v_mfma_f32_16x16x32_bf16 v[196:199], v[68:71], v[208:211], v[196:199]
    ds_read_b128 v[84:87], v27 offset:32768
    v_mfma_f32_16x16x32_bf16 v[128:131], v[72:75], v[36:39], v[128:131]
    ds_read_b128 v[88:91], v26 offset:34816
    v_mfma_f32_16x16x32_bf16 v[132:135], v[76:79], v[36:39], v[132:135]
    ds_read_b128 v[92:95], v27 offset:34816
    v_mfma_f32_16x16x32_bf16 v[144:147], v[72:75], v[44:47], v[144:147]
    ds_read_b128 v[96:99], v26 offset:36864
    v_mfma_f32_16x16x32_bf16 v[148:151], v[76:79], v[44:47], v[148:151]
    ds_read_b128 v[100:103], v27 offset:36864
    v_mfma_f32_16x16x32_bf16 v[160:163], v[72:75], v[52:55], v[160:163]
    ds_read_b128 v[104:107], v26 offset:38912
    v_mfma_f32_16x16x32_bf16 v[164:167], v[76:79], v[52:55], v[164:167]
    ds_read_b128 v[108:111], v27 offset:38912
    v_mfma_f32_16x16x32_bf16 v[176:179], v[72:75], v[60:63], v[176:179]
    v_mfma_f32_16x16x32_bf16 v[180:183], v[76:79], v[60:63], v[180:183]
    v_mfma_f32_16x16x32_bf16 v[192:195], v[72:75], v[208:211], v[192:195]
    v_mfma_f32_16x16x32_bf16 v[196:199], v[76:79], v[208:211], v[196:199]
    s_waitcnt lgkmcnt(0)
    s_waitcnt vmcnt(8)
    s_barrier
    s_add_u32 m0, s21, 98304
    s_nop 0
    buffer_load_dwordx4 v23, s[88:91], s16 offen lds
    s_add_u32 s16, s16, s62
    s_add_u32 m0, s21, 99328
    s_nop 0
    buffer_load_dwordx4 v23, s[88:91], s17 offen lds
    s_add_u32 s17, s17, s62
    s_cmp_ge_u32 s16, s92
    s_cselect_b32 s94, 2048, 0
    s_sub_u32 s16, s16, s94
    s_sub_u32 s17, s17, s94
    s_add_u32 m0, s22, 98304
    s_nop 0
    buffer_load_dwordx4 v2, s[8:11], s18 offen lds
    s_add_u32 s18, s18, s20
    s_add_u32 m0, s22, 106496
    s_nop 0
    buffer_load_dwordx4 v2, s[12:15], s19 offen lds
    s_add_u32 s19, s19, s20
    s_cmp_ge_u32 s18, s95
    s_cselect_b32 s94, s93, 0
    s_sub_u32 s18, s18, s94
    s_sub_u32 s19, s19, s94
    v_mfma_f32_16x16x32_bf16 v[128:131], v[112:115], v[80:83], v[128:131]
    ds_read_b64_tr_b16 v[64:65], v8 offset:16384
    v_mfma_f32_16x16x32_bf16 v[132:135], v[116:119], v[80:83], v[132:135]
    ds_read_b64_tr_b16 v[66:67], v9 offset:16384
    v_mfma_f32_16x16x32_bf16 v[144:147], v[112:115], v[88:91], v[144:147]
    ds_read_b64_tr_b16 v[68:69], v10 offset:16384
    v_mfma_f32_16x16x32_bf16 v[148:151], v[116:119], v[88:91], v[148:151]
    ds_read_b64_tr_b16 v[70:71], v11 offset:16384
    v_mfma_f32_16x16x32_bf16 v[160:163], v[112:115], v[96:99], v[160:163]
    ds_read_b64_tr_b16 v[72:73], v8 offset:24576
    v_mfma_f32_16x16x32_bf16 v[164:167], v[116:119], v[96:99], v[164:167]
    ds_read_b64_tr_b16 v[74:75], v9 offset:24576
    v_mfma_f32_16x16x32_bf16 v[176:179], v[112:115], v[104:107], v[176:179]
    ds_read_b64_tr_b16 v[76:77], v10 offset:24576
    v_mfma_f32_16x16x32_bf16 v[180:183], v[116:119], v[104:107], v[180:183]
    ds_read_b64_tr_b16 v[78:79], v11 offset:24576
    v_mfma_f32_16x16x32_bf16 v[192:195], v[112:115], v[208:211], v[192:195]
    ds_read_b128 v[32:35], v24 offset:0
    v_mfma_f32_16x16x32_bf16 v[196:199], v[116:119], v[208:211], v[196:199]
    ds_read_b128 v[36:39], v25 offset:0
    v_mfma_f32_16x16x32_bf16 v[128:131], v[120:123], v[84:87], v[128:131]
    ds_read_b128 v[40:43], v24 offset:2048
    v_mfma_f32_16x16x32_bf16 v[132:135], v[124:127], v[84:87], v[132:135]
    ds_read_b128 v[44:47], v25 offset:2048
    v_mfma_f32_16x16x32_bf16 v[144:147], v[120:123], v[92:95], v[144:147]
    ds_read_b128 v[48:51], v24 offset:4096
    v_mfma_f32_16x16x32_bf16 v[148:151], v[124:127], v[92:95], v[148:151]
    ds_read_b128 v[52:55], v25 offset:4096
    v_mfma_f32_16x16x32_bf16 v[160:163], v[120:123], v[100:103], v[160:163]
    ds_read_b128 v[56:59], v24 offset:6144
    v_mfma_f32_16x16x32_bf16 v[164:167], v[124:127], v[100:103], v[164:167]
    ds_read_b128 v[60:63], v25 offset:6144
    v_mfma_f32_16x16x32_bf16 v[176:179], v[120:123], v[108:111], v[176:179]
    v_mfma_f32_16x16x32_bf16 v[180:183], v[124:127], v[108:111], v[180:183]
    v_mfma_f32_16x16x32_bf16 v[192:195], v[120:123], v[208:211], v[192:195]
    v_mfma_f32_16x16x32_bf16 v[196:199], v[124:127], v[208:211], v[196:199]
    s_waitcnt lgkmcnt(0)
    s_waitcnt vmcnt(8)
    s_barrier
    v_mfma_f32_16x16x32_bf16 v[128:131], v[64:67], v[32:35], v[128:131]
    ds_read_b64_tr_b16 v[112:113], v8 offset:49152
    v_mfma_f32_16x16x32_bf16 v[132:135], v[68:71], v[32:35], v[132:135]
    ds_read_b64_tr_b16 v[114:115], v9 offset:49152
    v_mfma_f32_16x16x32_bf16 v[144:147], v[64:67], v[40:43], v[144:147]
    ds_read_b64_tr_b16 v[116:117], v10 offset:49152
    v_mfma_f32_16x16x32_bf16 v[148:151], v[68:71], v[40:43], v[148:151]
    ds_read_b64_tr_b16 v[118:119], v11 offset:49152
    v_mfma_f32_16x16x32_bf16 v[160:163], v[64:67], v[48:51], v[160:163]
    ds_read_b64_tr_b16 v[120:121], v8 offset:57344
    v_mfma_f32_16x16x32_bf16 v[164:167], v[68:71], v[48:51], v[164:167]
    ds_read_b64_tr_b16 v[122:123], v9 offset:57344
    v_mfma_f32_16x16x32_bf16 v[176:179], v[64:67], v[56:59], v[176:179]
    ds_read_b64_tr_b16 v[124:125], v10 offset:57344
    v_mfma_f32_16x16x32_bf16 v[180:183], v[68:71], v[56:59], v[180:183]
    ds_read_b64_tr_b16 v[126:127], v11 offset:57344
    v_mfma_f32_16x16x32_bf16 v[192:195], v[64:67], v[208:211], v[192:195]
    ds_read_b128 v[80:83], v24 offset:32768
    v_mfma_f32_16x16x32_bf16 v[196:199], v[68:71], v[208:211], v[196:199]
    ds_read_b128 v[84:87], v25 offset:32768
    v_mfma_f32_16x16x32_bf16 v[128:131], v[72:75], v[36:39], v[128:131]
    ds_read_b128 v[88:91], v24 offset:34816
    v_mfma_f32_16x16x32_bf16 v[132:135], v[76:79], v[36:39], v[132:135]
    ds_read_b128 v[92:95], v25 offset:34816
    v_mfma_f32_16x16x32_bf16 v[144:147], v[72:75], v[44:47], v[144:147]
    ds_read_b128 v[96:99], v24 offset:36864
    v_mfma_f32_16x16x32_bf16 v[148:151], v[76:79], v[44:47], v[148:151]
    ds_read_b128 v[100:103], v25 offset:36864
    v_mfma_f32_16x16x32_bf16 v[160:163], v[72:75], v[52:55], v[160:163]
    ds_read_b128 v[104:107], v24 offset:38912
    v_mfma_f32_16x16x32_bf16 v[164:167], v[76:79], v[52:55], v[164:167]
    ds_read_b128 v[108:111], v25 offset:38912
    v_mfma_f32_16x16x32_bf16 v[176:179], v[72:75], v[60:63], v[176:179]
    v_mfma_f32_16x16x32_bf16 v[180:183], v[76:79], v[60:63], v[180:183]
    v_mfma_f32_16x16x32_bf16 v[192:195], v[72:75], v[208:211], v[192:195]
    v_mfma_f32_16x16x32_bf16 v[196:199], v[76:79], v[208:211], v[196:199]
    s_waitcnt lgkmcnt(0)
    s_waitcnt vmcnt(4)
    s_barrier
    v_mfma_f32_16x16x32_bf16 v[128:131], v[112:115], v[80:83], v[128:131]
    ds_read_b64_tr_b16 v[64:65], v12 offset:16384
    v_mfma_f32_16x16x32_bf16 v[132:135], v[116:119], v[80:83], v[132:135]
    ds_read_b64_tr_b16 v[66:67], v13 offset:16384
    v_mfma_f32_16x16x32_bf16 v[144:147], v[112:115], v[88:91], v[144:147]
    ds_read_b64_tr_b16 v[68:69], v14 offset:16384
    v_mfma_f32_16x16x32_bf16 v[148:151], v[116:119], v[88:91], v[148:151]
    ds_read_b64_tr_b16 v[70:71], v15 offset:16384
    v_mfma_f32_16x16x32_bf16 v[160:163], v[112:115], v[96:99], v[160:163]
    ds_read_b64_tr_b16 v[72:73], v12 offset:24576
    v_mfma_f32_16x16x32_bf16 v[164:167], v[116:119], v[96:99], v[164:167]
    ds_read_b64_tr_b16 v[74:75], v13 offset:24576
    v_mfma_f32_16x16x32_bf16 v[176:179], v[112:115], v[104:107], v[176:179]
    ds_read_b64_tr_b16 v[76:77], v14 offset:24576
    v_mfma_f32_16x16x32_bf16 v[180:183], v[116:119], v[104:107], v[180:183]
    ds_read_b64_tr_b16 v[78:79], v15 offset:24576
    v_mfma_f32_16x16x32_bf16 v[192:195], v[112:115], v[208:211], v[192:195]
    ds_read_b128 v[32:35], v26 offset:0
    v_mfma_f32_16x16x32_bf16 v[196:199], v[116:119], v[208:211], v[196:199]
    ds_read_b128 v[36:39], v27 offset:0
    v_mfma_f32_16x16x32_bf16 v[128:131], v[120:123], v[84:87], v[128:131]
    ds_read_b128 v[40:43], v26 offset:2048
    v_mfma_f32_16x16x32_bf16 v[132:135], v[124:127], v[84:87], v[132:135]
    ds_read_b128 v[44:47], v27 offset:2048
    v_mfma_f32_16x16x32_bf16 v[144:147], v[120:123], v[92:95], v[144:147]
    ds_read_b128 v[48:51], v26 offset:4096
    v_mfma_f32_16x16x32_bf16 v[148:151], v[124:127], v[92:95], v[148:151]
    ds_read_b128 v[52:55], v27 offset:4096
    v_mfma_f32_16x16x32_bf16 v[160:163], v[120:123], v[100:103], v[160:163]
    ds_read_b128 v[56:59], v26 offset:6144
    v_mfma_f32_16x16x32_bf16 v[164:167], v[124:127], v[100:103], v[164:167]
    ds_read_b128 v[60:63], v27 offset:6144
    v_mfma_f32_16x16x32_bf16 v[176:179], v[120:123], v[108:111], v[176:179]
    v_mfma_f32_16x16x32_bf16 v[180:183], v[124:127], v[108:111], v[180:183]
    v_mfma_f32_16x16x32_bf16 v[192:195], v[120:123], v[208:211], v[192:195]
    v_mfma_f32_16x16x32_bf16 v[196:199], v[124:127], v[208:211], v[196:199]
    s_waitcnt lgkmcnt(0)
    s_waitcnt vmcnt(0)
    s_barrier
    v_mfma_f32_16x16x32_bf16 v[128:131], v[64:67], v[32:35], v[128:131]
    ds_read_b64_tr_b16 v[112:113], v12 offset:49152
    v_mfma_f32_16x16x32_bf16 v[132:135], v[68:71], v[32:35], v[132:135]
    ds_read_b64_tr_b16 v[114:115], v13 offset:49152
    v_mfma_f32_16x16x32_bf16 v[144:147], v[64:67], v[40:43], v[144:147]
    ds_read_b64_tr_b16 v[116:117], v14 offset:49152
    v_mfma_f32_16x16x32_bf16 v[148:151], v[68:71], v[40:43], v[148:151]
    ds_read_b64_tr_b16 v[118:119], v15 offset:49152
    v_mfma_f32_16x16x32_bf16 v[160:163], v[64:67], v[48:51], v[160:163]
    ds_read_b64_tr_b16 v[120:121], v12 offset:57344
    v_mfma_f32_16x16x32_bf16 v[164:167], v[68:71], v[48:51], v[164:167]
    ds_read_b64_tr_b16 v[122:123], v13 offset:57344
    v_mfma_f32_16x16x32_bf16 v[176:179], v[64:67], v[56:59], v[176:179]
    ds_read_b64_tr_b16 v[124:125], v14 offset:57344
    v_mfma_f32_16x16x32_bf16 v[180:183], v[68:71], v[56:59], v[180:183]
    ds_read_b64_tr_b16 v[126:127], v15 offset:57344
    v_mfma_f32_16x16x32_bf16 v[192:195], v[64:67], v[208:211], v[192:195]
    ds_read_b128 v[80:83], v26 offset:32768
    v_mfma_f32_16x16x32_bf16 v[196:199], v[68:71], v[208:211], v[196:199]
    ds_read_b128 v[84:87], v27 offset:32768
    v_mfma_f32_16x16x32_bf16 v[128:131], v[72:75], v[36:39], v[128:131]
    ds_read_b128 v[88:91], v26 offset:34816
    v_mfma_f32_16x16x32_bf16 v[132:135], v[76:79], v[36:39], v[132:135]
    ds_read_b128 v[92:95], v27 offset:34816
    v_mfma_f32_16x16x32_bf16 v[144:147], v[72:75], v[44:47], v[144:147]
    ds_read_b128 v[96:99], v26 offset:36864
    v_mfma_f32_16x16x32_bf16 v[148:151], v[76:79], v[44:47], v[148:151]
    ds_read_b128 v[100:103], v27 offset:36864
    v_mfma_f32_16x16x32_bf16 v[160:163], v[72:75], v[52:55], v[160:163]
    ds_read_b128 v[104:107], v26 offset:38912
    v_mfma_f32_16x16x32_bf16 v[164:167], v[76:79], v[52:55], v[164:167]
    ds_read_b128 v[108:111], v27 offset:38912
    v_mfma_f32_16x16x32_bf16 v[176:179], v[72:75], v[60:63], v[176:179]
    v_mfma_f32_16x16x32_bf16 v[180:183], v[76:79], v[60:63], v[180:183]
    v_mfma_f32_16x16x32_bf16 v[192:195], v[72:75], v[208:211], v[192:195]
    v_mfma_f32_16x16x32_bf16 v[196:199], v[76:79], v[208:211], v[196:199]
    s_waitcnt lgkmcnt(0)
    s_waitcnt vmcnt(0)
    s_barrier
    v_mfma_f32_16x16x32_bf16 v[128:131], v[112:115], v[80:83], v[128:131]
    ds_read_b64_tr_b16 v[64:65], v8 offset:16384
    v_mfma_f32_16x16x32_bf16 v[132:135], v[116:119], v[80:83], v[132:135]
    ds_read_b64_tr_b16 v[66:67], v9 offset:16384
    v_mfma_f32_16x16x32_bf16 v[144:147], v[112:115], v[88:91], v[144:147]
    ds_read_b64_tr_b16 v[68:69], v10 offset:16384
    v_mfma_f32_16x16x32_bf16 v[148:151], v[116:119], v[88:91], v[148:151]
    ds_read_b64_tr_b16 v[70:71], v11 offset:16384
    v_mfma_f32_16x16x32_bf16 v[160:163], v[112:115], v[96:99], v[160:163]
    ds_read_b64_tr_b16 v[72:73], v8 offset:24576
    v_mfma_f32_16x16x32_bf16 v[164:167], v[116:119], v[96:99], v[164:167]
    ds_read_b64_tr_b16 v[74:75], v9 offset:24576
    v_mfma_f32_16x16x32_bf16 v[176:179], v[112:115], v[104:107], v[176:179]
    ds_read_b64_tr_b16 v[76:77], v10 offset:24576
    v_mfma_f32_16x16x32_bf16 v[180:183], v[116:119], v[104:107], v[180:183]
    ds_read_b64_tr_b16 v[78:79], v11 offset:24576
    v_mfma_f32_16x16x32_bf16 v[192:195], v[112:115], v[208:211], v[192:195]
    ds_read_b128 v[32:35], v24 offset:0
    v_mfma_f32_16x16x32_bf16 v[196:199], v[116:119], v[208:211], v[196:199]
    ds_read_b128 v[36:39], v25 offset:0
    v_mfma_f32_16x16x32_bf16 v[128:131], v[120:123], v[84:87], v[128:131]
    ds_read_b128 v[40:43], v24 offset:2048
    v_mfma_f32_16x16x32_bf16 v[132:135], v[124:127], v[84:87], v[132:135]
    ds_read_b128 v[44:47], v25 offset:2048
    v_mfma_f32_16x16x32_bf16 v[144:147], v[120:123], v[92:95], v[144:147]
    ds_read_b128 v[48:51], v24 offset:4096
    v_mfma_f32_16x16x32_bf16 v[148:151], v[124:127], v[92:95], v[148:151]
    ds_read_b128 v[52:55], v25 offset:4096
    v_mfma_f32_16x16x32_bf16 v[160:163], v[120:123], v[100:103], v[160:163]
    ds_read_b128 v[56:59], v24 offset:6144
    v_mfma_f32_16x16x32_bf16 v[164:167], v[124:127], v[100:103], v[164:167]
    ds_read_b128 v[60:63], v25 offset:6144
    v_mfma_f32_16x16x32_bf16 v[176:179], v[120:123], v[108:111], v[176:179]
    v_mfma_f32_16x16x32_bf16 v[180:183], v[124:127], v[108:111], v[180:183]
    v_mfma_f32_16x16x32_bf16 v[192:195], v[120:123], v[208:211], v[192:195]
    v_mfma_f32_16x16x32_bf16 v[196:199], v[124:127], v[208:211], v[196:199]
    s_waitcnt lgkmcnt(0)
    v_and_b32 v20, 0xf0, v1
    v_lshrrev_b32 v20, 1, v20
    s_lshl_b32 s30, s26, 9
    s_add_u32 s30, s30, 188743680
    s_mov_b32 s31, 0x40000
    v_and_b32 v21, 1, v4
    v_lshlrev_b32 v21, 10, v21
    v_xor_b32 v8, v21, v8
    v_xor_b32 v9, v21, v9
    v_xor_b32 v10, v21, v10
    v_xor_b32 v11, v21, v11
    v_xor_b32 v12, v21, v12
    v_xor_b32 v13, v21, v13
    v_xor_b32 v14, v21, v14
    v_xor_b32 v15, v21, v15
w_stX:
    buffer_load_dword v22, off, s[64:67], 0 offset:192 sc1
    buffer_load_dwordx2 v[24:25], v20, s[4:7], s30 offen offset:0 sc1
    buffer_load_dwordx2 v[26:27], v20, s[4:7], s30 offen offset:128 sc1
    buffer_load_dwordx2 v[28:29], v20, s[4:7], s30 offen offset:256 sc1
    buffer_load_dwordx2 v[30:31], v20, s[4:7], s30 offen offset:384 sc1
    s_waitcnt vmcnt(0)
    v_readfirstlane_b32 s29, v22
    s_cmp_ge_u32 s29, 32
    s_cbranch_scc1 w_stXok
    s_sleep 4
    s_sub_u32 s31, s31, 1
    s_cbranch_scc0 w_stX
w_stXok:
    buffer_load_dword v22, off, s[64:67], 0 sc1
    v_fma_f32 v128, -v24, v192, v128
    v_fma_f32 v129, -v24, v193, v129
    v_fma_f32 v130, -v24, v194, v130
    v_fma_f32 v131, -v24, v195, v131
    v_fma_f32 v132, -v24, v196, v132
    v_fma_f32 v133, -v24, v197, v133
    v_fma_f32 v134, -v24, v198, v134
    v_fma_f32 v135, -v24, v199, v135
    v_mul_f32 v128, v128, v25
    v_mul_f32 v129, v129, v25
    v_mul_f32 v130, v130, v25
    v_mul_f32 v131, v131, v25
    v_mul_f32 v132, v132, v25
    v_mul_f32 v133, v133, v25
    v_mul_f32 v134, v134, v25
    v_mul_f32 v135, v135, v25
    v_fma_f32 v144, -v26, v192, v144
    v_fma_f32 v145, -v26, v193, v145
    v_fma_f32 v146, -v26, v194, v146
    v_fma_f32 v147, -v26, v195, v147
    v_fma_f32 v148, -v26, v196, v148
    v_fma_f32 v149, -v26, v197, v149
    v_fma_f32 v150, -v26, v198, v150
    v_fma_f32 v151, -v26, v199, v151
    v_mul_f32 v144, v144, v27
    v_mul_f32 v145, v145, v27
    v_mul_f32 v146, v146, v27
    v_mul_f32 v147, v147, v27
    v_mul_f32 v148, v148, v27
    v_mul_f32 v149, v149, v27
    v_mul_f32 v150, v150, v27
    v_mul_f32 v151, v151, v27
    v_fma_f32 v160, -v28, v192, v160
    v_fma_f32 v161, -v28, v193, v161
    v_fma_f32 v162, -v28, v194, v162
    v_fma_f32 v163, -v28, v195, v163
    v_fma_f32 v164, -v28, v196, v164
    v_fma_f32 v165, -v28, v197, v165
    v_fma_f32 v166, -v28, v198, v166
    v_fma_f32 v167, -v28, v199, v167
    v_mul_f32 v160, v160, v29
    v_mul_f32 v161, v161, v29
    v_mul_f32 v162, v162, v29
    v_mul_f32 v163, v163, v29
    v_mul_f32 v164, v164, v29
    v_mul_f32 v165, v165, v29
    v_mul_f32 v166, v166, v29
    v_mul_f32 v167, v167, v29
    v_fma_f32 v176, -v30, v192, v176
    v_fma_f32 v177, -v30, v193, v177
    v_fma_f32 v178, -v30, v194, v178
    v_fma_f32 v179, -v30, v195, v179
    v_fma_f32 v180, -v30, v196, v180
    v_fma_f32 v181, -v30, v197, v181
    v_fma_f32 v182, -v30, v198, v182
    v_fma_f32 v183, -v30, v199, v183
    v_mul_f32 v176, v176, v31
    v_mul_f32 v177, v177, v31
    v_mul_f32 v178, v178, v31
    v_mul_f32 v179, v179, v31
    v_mul_f32 v180, v180, v31
    v_mul_f32 v181, v181, v31
    v_mul_f32 v182, v182, v31
    v_mul_f32 v183, v183, v31
    s_lshl_b32 s30, s27, 10
    s_add_u32 s30, s30, s49
    s_nop 7
    v_cvt_pk_bf16_f32 v80, v128, v129
    v_cvt_pk_bf16_f32 v81, v130, v131
    v_cvt_pk_bf16_f32 v82, v132, v133
    v_cvt_pk_bf16_f32 v83, v134, v135
    buffer_store_dwordx4 v[80:83], v1, s[4:7], s30 offen sc1
    s_add_u32 s30, s30, s50
    v_cvt_pk_bf16_f32 v84, v144, v145
    v_cvt_pk_bf16_f32 v85, v146, v147
    v_cvt_pk_bf16_f32 v86, v148, v149
    v_cvt_pk_bf16_f32 v87, v150, v151
    buffer_store_dwordx4 v[84:87], v1, s[4:7], s30 offen sc1
    s_add_u32 s30, s30, s50
    v_cvt_pk_bf16_f32 v88, v160, v161
    v_cvt_pk_bf16_f32 v89, v162, v163
    v_cvt_pk_bf16_f32 v90, v164, v165
    v_cvt_pk_bf16_f32 v91, v166, v167
    buffer_store_dwordx4 v[88:91], v1, s[4:7], s30 offen sc1
    s_add_u32 s30, s30, s50
    v_cvt_pk_bf16_f32 v92, v176, v177
    v_cvt_pk_bf16_f32 v93, v178, v179
    v_cvt_pk_bf16_f32 v94, v180, v181
    v_cvt_pk_bf16_f32 v95, v182, v183
    buffer_store_dwordx4 v[92:95], v1, s[4:7], s30 offen sc1
    s_add_u32 s30, s30, s50
    s_mov_b32 s28, s51
    s_mov_b32 s57, s53
    s_branch w_drain
w_firstM:
    s_waitcnt vmcnt(6)
    s_barrier
    s_add_u32 m0, s21, 0
    s_nop 0
    buffer_load_dwordx4 v1, s[4:7], s16 offen sc1 lds
    s_add_u32 s16, s16, s62
    s_add_u32 m0, s22, 0
    s_nop 0
    buffer_load_dwordx4 v2, s[8:11], s18 offen lds
    s_add_u32 s18, s18, s20
    s_add_u32 m0, s22, 8192
    s_nop 0
    buffer_load_dwordx4 v2, s[12:15], s19 offen lds
    s_add_u32 s19, s19, s20
    v_mfma_f32_16x16x32_bf16 v[128:131], v[64:67], v[32:35], 0
    ds_read_b64_tr_b16 v[112:113], v8 offset:49152
    v_mfma_f32_16x16x32_bf16 v[132:135], v[68:71], v[32:35], 0
    ds_read_b64_tr_b16 v[114:115], v9 offset:49152
    v_mfma_f32_16x16x32_bf16 v[136:139], v[72:75], v[32:35], 0
    ds_read_b64_tr_b16 v[116:117], v10 offset:49152
    v_mfma_f32_16x16x32_bf16 v[140:143], v[76:79], v[32:35], 0
    ds_read_b64_tr_b16 v[118:119], v11 offset:49152
    v_mfma_f32_16x16x32_bf16 v[144:147], v[64:67], v[40:43], 0
    ds_read_b64_tr_b16 v[120:121], v8 offset:57344
    v_mfma_f32_16x16x32_bf16 v[148:151], v[68:71], v[40:43], 0
    ds_read_b64_tr_b16 v[122:123], v9 offset:57344
    v_mfma_f32_16x16x32_bf16 v[152:155], v[72:75], v[40:43], 0
    ds_read_b64_tr_b16 v[124:125], v10 offset:57344
    v_mfma_f32_16x16x32_bf16 v[156:159], v[76:79], v[40:43], 0
    ds_read_b64_tr_b16 v[126:127], v11 offset:57344
    v_mfma_f32_16x16x32_bf16 v[160:163], v[64:67], v[48:51], 0
    ds_read_b128 v[80:83], v5 offset:32768
    v_mfma_f32_16x16x32_bf16 v[164:167], v[68:71], v[48:51], 0
    ds_read_b128 v[88:91], v5 offset:34816
    v_mfma_f32_16x16x32_bf16 v[168:171], v[72:75], v[48:51], 0
    ds_read_b128 v[96:99], v5 offset:36864
    v_mfma_f32_16x16x32_bf16 v[172:175], v[76:79], v[48:51], 0
    ds_read_b128 v[104:107], v5 offset:38912
    v_mfma_f32_16x16x32_bf16 v[176:179], v[64:67], v[56:59], 0
    v_mfma_f32_16x16x32_bf16 v[180:183], v[68:71], v[56:59], 0
    v_mfma_f32_16x16x32_bf16 v[184:187], v[72:75], v[56:59], 0
    v_mfma_f32_16x16x32_bf16 v[188:191], v[76:79], v[56:59], 0
    s_waitcnt lgkmcnt(0)
    s_waitcnt vmcnt(6)
    s_barrier
    s_add_u32 m0, s21, 32768
    s_nop 0
    buffer_load_dwordx4 v1, s[4:7], s16 offen sc1 lds
    s_add_u32 s16, s16, s62
    s_add_u32 m0, s22, 32768
    s_nop 0
    buffer_load_dwordx4 v2, s[8:11], s18 offen lds
    s_add_u32 s18, s18, s20
    s_add_u32 m0, s22, 40960
    s_nop 0
    buffer_load_dwordx4 v2, s[12:15], s19 offen lds
    s_add_u32 s19, s19, s20
    v_mfma_f32_16x16x32_bf16 v[128:131], v[112:115], v[80:83], v[128:131]
    ds_read_b64_tr_b16 v[64:65], v12 offset:16384
    v_mfma_f32_16x16x32_bf16 v[132:135], v[116:119], v[80:83], v[132:135]
    ds_read_b64_tr_b16 v[66:67], v13 offset:16384
    v_mfma_f32_16x16x32_bf16 v[136:139], v[120:123], v[80:83], v[136:139]
    ds_read_b64_tr_b16 v[68:69], v14 offset:16384
    v_mfma_f32_16x16x32_bf16 v[140:143], v[124:127], v[80:83], v[140:143]
    ds_read_b64_tr_b16 v[70:71], v15 offset:16384
    v_mfma_f32_16x16x32_bf16 v[144:147], v[112:115], v[88:91], v[144:147]
    ds_read_b64_tr_b16 v[72:73], v12 offset:24576
    v_mfma_f32_16x16x32_bf16 v[148:151], v[116:119], v[88:91], v[148:151]
    ds_read_b64_tr_b16 v[74:75], v13 offset:24576
    v_mfma_f32_16x16x32_bf16 v[152:155], v[120:123], v[88:91], v[152:155]
    ds_read_b64_tr_b16 v[76:77], v14 offset:24576
    v_mfma_f32_16x16x32_bf16 v[156:159], v[124:127], v[88:91], v[156:159]
    ds_read_b64_tr_b16 v[78:79], v15 offset:24576
    v_mfma_f32_16x16x32_bf16 v[160:163], v[112:115], v[96:99], v[160:163]
    ds_read_b128 v[32:35], v6 offset:0
    v_mfma_f32_16x16x32_bf16 v[164:167], v[116:119], v[96:99], v[164:167]
    ds_read_b128 v[40:43], v6 offset:2048
    v_mfma_f32_16x16x32_bf16 v[168:171], v[120:123], v[96:99], v[168:171]
    ds_read_b128 v[48:51], v6 offset:4096
    v_mfma_f32_16x16x32_bf16 v[172:175], v[124:127], v[96:99], v[172:175]
    ds_read_b128 v[56:59], v6 offset:6144
    v_mfma_f32_16x16x32_bf16 v[176:179], v[112:115], v[104:107], v[176:179]
    v_mfma_f32_16x16x32_bf16 v[180:183], v[116:119], v[104:107], v[180:183]
    v_mfma_f32_16x16x32_bf16 v[184:187], v[120:123], v[104:107], v[184:187]
    v_mfma_f32_16x16x32_bf16 v[188:191], v[124:127], v[104:107], v[188:191]
    s_waitcnt lgkmcnt(0)
    s_waitcnt vmcnt(6)
    s_barrier
    s_add_u32 m0, s21, 65536
    s_nop 0
    buffer_load_dwordx4 v1, s[4:7], s16 offen sc1 lds
    s_add_u32 s16, s16, s62
    s_add_u32 m0, s22, 65536
    s_nop 0
    buffer_load_dwordx4 v2, s[8:11], s18 offen lds
    s_add_u32 s18, s18, s20
    s_add_u32 m0, s22, 73728
    s_nop 0
    buffer_load_dwordx4 v2, s[12:15], s19 offen lds
    s_add_u32 s19, s19, s20
    v_mfma_f32_16x16x32_bf16 v[128:131], v[64:67], v[32:35], v[128:131]
    ds_read_b64_tr_b16 v[112:113], v12 offset:49152
    v_mfma_f32_16x16x32_bf16 v[132:135], v[68:71], v[32:35], v[132:135]
    ds_read_b64_tr_b16 v[114:115], v13 offset:49152
    v_mfma_f32_16x16x32_bf16 v[136:139], v[72:75], v[32:35], v[136:139]
    ds_read_b64_tr_b16 v[116:117], v14 offset:49152
    v_mfma_f32_16x16x32_bf16 v[140:143], v[76:79], v[32:35], v[140:143]
    ds_read_b64_tr_b16 v[118:119], v15 offset:49152
    v_mfma_f32_16x16x32_bf16 v[144:147], v[64:67], v[40:43], v[144:147]
    ds_read_b64_tr_b16 v[120:121], v12 offset:57344
    v_mfma_f32_16x16x32_bf16 v[148:151], v[68:71], v[40:43], v[148:151]
    ds_read_b64_tr_b16 v[122:123], v13 offset:57344
    v_mfma_f32_16x16x32_bf16 v[152:155], v[72:75], v[40:43], v[152:155]
    ds_read_b64_tr_b16 v[124:125], v14 offset:57344
    v_mfma_f32_16x16x32_bf16 v[156:159], v[76:79], v[40:43], v[156:159]
    ds_read_b64_tr_b16 v[126:127], v15 offset:57344
    v_mfma_f32_16x16x32_bf16 v[160:163], v[64:67], v[48:51], v[160:163]
    ds_read_b128 v[80:83], v6 offset:32768
    v_mfma_f32_16x16x32_bf16 v[164:167], v[68:71], v[48:51], v[164:167]
    ds_read_b128 v[88:91], v6 offset:34816
    v_mfma_f32_16x16x32_bf16 v[168:171], v[72:75], v[48:51], v[168:171]
    ds_read_b128 v[96:99], v6 offset:36864
    v_mfma_f32_16x16x32_bf16 v[172:175], v[76:79], v[48:51], v[172:175]
    ds_read_b128 v[104:107], v6 offset:38912
    v_mfma_f32_16x16x32_bf16 v[176:179], v[64:67], v[56:59], v[176:179]
    v_mfma_f32_16x16x32_bf16 v[180:183], v[68:71], v[56:59], v[180:183]
    v_mfma_f32_16x16x32_bf16 v[184:187], v[72:75], v[56:59], v[184:187]
    v_mfma_f32_16x16x32_bf16 v[188:191], v[76:79], v[56:59], v[188:191]
    s_waitcnt lgkmcnt(0)
    s_waitcnt vmcnt(6)
    s_barrier
    s_add_u32 m0, s21, 98304
    s_nop 0
    buffer_load_dwordx4 v1, s[4:7], s16 offen sc1 lds
    s_add_u32 s16, s16, s62
    s_add_u32 m0, s22, 98304
    s_nop 0
    buffer_load_dwordx4 v2, s[8:11], s18 offen lds
    s_add_u32 s18, s18, s20
    s_add_u32 m0, s22, 106496
    s_nop 0
    buffer_load_dwordx4 v2, s[12:15], s19 offen lds
    s_add_u32 s19, s19, s20
    v_mfma_f32_16x16x32_bf16 v[128:131], v[112:115], v[80:83], v[128:131]
    ds_read_b64_tr_b16 v[64:65], v8 offset:16384
    v_mfma_f32_16x16x32_bf16 v[132:135], v[116:119], v[80:83], v[132:135]
    ds_read_b64_tr_b16 v[66:67], v9 offset:16384
    v_mfma_f32_16x16x32_bf16 v[136:139], v[120:123], v[80:83], v[136:139]
    ds_read_b64_tr_b16 v[68:69], v10 offset:16384
    v_mfma_f32_16x16x32_bf16 v[140:143], v[124:127], v[80:83], v[140:143]
    ds_read_b64_tr_b16 v[70:71], v11 offset:16384
    v_mfma_f32_16x16x32_bf16 v[144:147], v[112:115], v[88:91], v[144:147]
    ds_read_b64_tr_b16 v[72:73], v8 offset:24576
    v_mfma_f32_16x16x32_bf16 v[148:151], v[116:119], v[88:91], v[148:151]
    ds_read_b64_tr_b16 v[74:75], v9 offset:24576
    v_mfma_f32_16x16x32_bf16 v[152:155], v[120:123], v[88:91], v[152:155]
    ds_read_b64_tr_b16 v[76:77], v10 offset:24576
    v_mfma_f32_16x16x32_bf16 v[156:159], v[124:127], v[88:91], v[156:159]
    ds_read_b64_tr_b16 v[78:79], v11 offset:24576
    v_mfma_f32_16x16x32_bf16 v[160:163], v[112:115], v[96:99], v[160:163]
    ds_read_b128 v[32:35], v5 offset:0
    v_mfma_f32_16x16x32_bf16 v[164:167], v[116:119], v[96:99], v[164:167]
    ds_read_b128 v[40:43], v5 offset:2048
    v_mfma_f32_16x16x32_bf16 v[168:171], v[120:123], v[96:99], v[168:171]
    ds_read_b128 v[48:51], v5 offset:4096
    v_mfma_f32_16x16x32_bf16 v[172:175], v[124:127], v[96:99], v[172:175]
    ds_read_b128 v[56:59], v5 offset:6144
    v_mfma_f32_16x16x32_bf16 v[176:179], v[112:115], v[104:107], v[176:179]
    v_mfma_f32_16x16x32_bf16 v[180:183], v[116:119], v[104:107], v[180:183]
    v_mfma_f32_16x16x32_bf16 v[184:187], v[120:123], v[104:107], v[184:187]
    v_mfma_f32_16x16x32_bf16 v[188:191], v[124:127], v[104:107], v[188:191]
    s_waitcnt lgkmcnt(0)
w_loop_chkM:
    s_sub_u32 s23, s23, 1
w_loopM:
    s_cmp_lg_u32 s23, 1
    s_cbranch_scc1 w_bodyM
    v_readfirstlane_b32 s68, v22
    s_cmp_ge_u32 s68, 128
    s_cselect_b32 s70, 0, s70
    v_readfirstlane_b32 s30, v16
    s_cmp_ge_u32 s30, s45
    s_cselect_b32 s30, 0, 1
    s_or_b32 s30, s30, s70
    s_cmp_ge_u32 s32, 4
    s_cselect_b32 s30, 1, s30
    s_cmp_eq_u32 s32, 0
    s_cselect_b32 s30, 1, s30
    v_mov_b32 v20, s30
    ds_write_b32 v7, v20
    s_cbranch_scc1 w_bodyM
    s_load_dwordx2 s[8:9], s[0:1], s33
    s_load_dwordx2 s[12:13], s[0:1], s34
    s_mov_b32 s10, s38
    s_mov_b32 s14, s38
    s_cmp_ge_u32 s32, 4
    s_cselect_b32 s31, 0, 1
    s_lshl_b32 s30, s3, s31
    s_mul_i32 s30, s30, s40
    s_add_u32 s16, s39, s30
    s_cmp_eq_u32 s32, 4
    s_cselect_b32 s30, 1024, s40
    s_cselect_b32 s31, 6, 5
    s_lshl_b32 s62, 32, s31
    s_add_u32 s17, s16, s30
    s_lshl_b32 s30, s3, 2
    s_mul_i32 s30, s30, s35
    s_add_u32 s18, s36, s30
    s_add_u32 s19, s37, s30
    s_lshl_b32 s20, s35, s31
    v_mul_u32_u24 v2, s35, v4
    v_add_u32 v2, v2, v3
    s_waitcnt lgkmcnt(0)
    s_waitcnt vmcnt(6)
    s_barrier
    s_add_u32 m0, s21, 0
    s_nop 0
    buffer_load_dwordx4 v1, s[4:7], s16 offen sc1 lds
    s_add_u32 s16, s16, s62
    s_add_u32 m0, s21, 1024
    s_nop 0
    buffer_load_dwordx4 v1, s[4:7], s17 offen sc1 lds
    s_add_u32 s17, s17, s62
    s_add_u32 m0, s22, 0
    s_nop 0
    buffer_load_dwordx4 v2, s[8:11], s18 offen lds
    s_add_u32 s18, s18, s20
    s_add_u32 m0, s22, 8192
    s_nop 0
    buffer_load_dwordx4 v2, s[12:15], s19 offen lds
    s_add_u32 s19, s19, s20
    v_mfma_f32_16x16x32_bf16 v[128:131], v[64:67], v[32:35], v[128:131]
    ds_read_b64_tr_b16 v[112:113], v8 offset:49152
    v_mfma_f32_16x16x32_bf16 v[132:135], v[68:71], v[32:35], v[132:135]
    ds_read_b64_tr_b16 v[114:115], v9 offset:49152
    v_mfma_f32_16x16x32_bf16 v[136:139], v[72:75], v[32:35], v[136:139]
    ds_read_b64_tr_b16 v[116:117], v10 offset:49152
    v_mfma_f32_16x16x32_bf16 v[140:143], v[76:79], v[32:35], v[140:143]
    ds_read_b64_tr_b16 v[118:119], v11 offset:49152
    v_mfma_f32_16x16x32_bf16 v[144:147], v[64:67], v[40:43], v[144:147]
    ds_read_b64_tr_b16 v[120:121], v8 offset:57344
    v_mfma_f32_16x16x32_bf16 v[148:151], v[68:71], v[40:43], v[148:151]
    ds_read_b64_tr_b16 v[122:123], v9 offset:57344
    v_mfma_f32_16x16x32_bf16 v[152:155], v[72:75], v[40:43], v[152:155]
    ds_read_b64_tr_b16 v[124:125], v10 offset:57344
    v_mfma_f32_16x16x32_bf16 v[156:159], v[76:79], v[40:43], v[156:159]
    ds_read_b64_tr_b16 v[126:127], v11 offset:57344
    v_mfma_f32_16x16x32_bf16 v[160:163], v[64:67], v[48:51], v[160:163]
    ds_read_b128 v[80:83], v5 offset:32768
    v_mfma_f32_16x16x32_bf16 v[164:167], v[68:71], v[48:51], v[164:167]
    ds_read_b128 v[88:91], v5 offset:34816
    v_mfma_f32_16x16x32_bf16 v[168:171], v[72:75], v[48:51], v[168:171]
    ds_read_b128 v[96:99], v5 offset:36864
    v_mfma_f32_16x16x32_bf16 v[172:175], v[76:79], v[48:51], v[172:175]
    ds_read_b128 v[104:107], v5 offset:38912
    v_mfma_f32_16x16x32_bf16 v[176:179], v[64:67], v[56:59], v[176:179]
    v_mfma_f32_16x16x32_bf16 v[180:183], v[68:71], v[56:59], v[180:183]
    v_mfma_f32_16x16x32_bf16 v[184:187], v[72:75], v[56:59], v[184:187]
    v_mfma_f32_16x16x32_bf16 v[188:191], v[76:79], v[56:59], v[188:191]
    s_waitcnt lgkmcnt(0)
    s_waitcnt vmcnt(7)
    s_barrier
    s_add_u32 m0, s21, 32768
    s_nop 0
    buffer_load_dwordx4 v1, s[4:7], s16 offen sc1 lds
    s_add_u32 s16, s16, s62
    s_add_u32 m0, s21, 33792
    s_nop 0
    buffer_load_dwordx4 v1, s[4:7], s17 offen sc1 lds
    s_add_u32 s17, s17, s62
    s_add_u32 m0, s22, 32768
    s_nop 0
    buffer_load_dwordx4 v2, s[8:11], s18 offen lds
    s_add_u32 s18, s18, s20
    s_add_u32 m0, s22, 40960
    s_nop 0
    buffer_load_dwordx4 v2, s[12:15], s19 offen lds
    s_add_u32 s19, s19, s20
    v_mfma_f32_16x16x32_bf16 v[128:131], v[112:115], v[80:83], v[128:131]
    ds_read_b64_tr_b16 v[64:65], v12 offset:16384
    v_mfma_f32_16x16x32_bf16 v[132:135], v[116:119], v[80:83], v[132:135]
    ds_read_b64_tr_b16 v[66:67], v13 offset:16384
    v_mfma_f32_16x16x32_bf16 v[136:139], v[120:123], v[80:83], v[136:139]
    ds_read_b64_tr_b16 v[68:69], v14 offset:16384
    v_mfma_f32_16x16x32_bf16 v[140:143], v[124:127], v[80:83], v[140:143]
    ds_read_b64_tr_b16 v[70:71], v15 offset:16384
    v_mfma_f32_16x16x32_bf16 v[144:147], v[112:115], v[88:91], v[144:147]
    ds_read_b64_tr_b16 v[72:73], v12 offset:24576
    v_mfma_f32_16x16x32_bf16 v[148:151], v[116:119], v[88:91], v[148:151]
    ds_read_b64_tr_b16 v[74:75], v13 offset:24576
    v_mfma_f32_16x16x32_bf16 v[152:155], v[120:123], v[88:91], v[152:155]
    ds_read_b64_tr_b16 v[76:77], v14 offset:24576
    v_mfma_f32_16x16x32_bf16 v[156:159], v[124:127], v[88:91], v[156:159]
    ds_read_b64_tr_b16 v[78:79], v15 offset:24576
    v_mfma_f32_16x16x32_bf16 v[160:163], v[112:115], v[96:99], v[160:163]
    ds_read_b128 v[32:35], v6 offset:0
    v_mfma_f32_16x16x32_bf16 v[164:167], v[116:119], v[96:99], v[164:167]
    ds_read_b128 v[40:43], v6 offset:2048
    v_mfma_f32_16x16x32_bf16 v[168:171], v[120:123], v[96:99], v[168:171]
    ds_read_b128 v[48:51], v6 offset:4096
    v_mfma_f32_16x16x32_bf16 v[172:175], v[124:127], v[96:99], v[172:175]
    ds_read_b128 v[56:59], v6 offset:6144
    v_mfma_f32_16x16x32_bf16 v[176:179], v[112:115], v[104:107], v[176:179]
    v_mfma_f32_16x16x32_bf16 v[180:183], v[116:119], v[104:107], v[180:183]
    v_mfma_f32_16x16x32_bf16 v[184:187], v[120:123], v[104:107], v[184:187]
    v_mfma_f32_16x16x32_bf16 v[188:191], v[124:127], v[104:107], v[188:191]
    s_waitcnt lgkmcnt(0)
    s_waitcnt vmcnt(8)
    s_barrier
    s_add_u32 m0, s21, 65536
    s_nop 0
    buffer_load_dwordx4 v1, s[4:7], s16 offen sc1 lds
    s_add_u32 s16, s16, s62
    s_add_u32 m0, s21, 66560
    s_nop 0
    buffer_load_dwordx4 v1, s[4:7], s17 offen sc1 lds
    s_add_u32 s17, s17, s62
    s_add_u32 m0, s22, 65536
    s_nop 0
    buffer_load_dwordx4 v2, s[8:11], s18 offen lds
    s_add_u32 s18, s18, s20
    s_add_u32 m0, s22, 73728
    s_nop 0
    buffer_load_dwordx4 v2, s[12:15], s19 offen lds
    s_add_u32 s19, s19, s20
    v_mfma_f32_16x16x32_bf16 v[128:131], v[64:67], v[32:35], v[128:131]
    ds_read_b64_tr_b16 v[112:113], v12 offset:49152
    v_mfma_f32_16x16x32_bf16 v[132:135], v[68:71], v[32:35], v[132:135]
    ds_read_b64_tr_b16 v[114:115], v13 offset:49152
    v_mfma_f32_16x16x32_bf16 v[136:139], v[72:75], v[32:35], v[136:139]
    ds_read_b64_tr_b16 v[116:117], v14 offset:49152
    v_mfma_f32_16x16x32_bf16 v[140:143], v[76:79], v[32:35], v[140:143]
    ds_read_b64_tr_b16 v[118:119], v15 offset:49152
    v_mfma_f32_16x16x32_bf16 v[144:147], v[64:67], v[40:43], v[144:147]
    ds_read_b64_tr_b16 v[120:121], v12 offset:57344
    v_mfma_f32_16x16x32_bf16 v[148:151], v[68:71], v[40:43], v[148:151]
    ds_read_b64_tr_b16 v[122:123], v13 offset:57344
    v_mfma_f32_16x16x32_bf16 v[152:155], v[72:75], v[40:43], v[152:155]
    ds_read_b64_tr_b16 v[124:125], v14 offset:57344
    v_mfma_f32_16x16x32_bf16 v[156:159], v[76:79], v[40:43], v[156:159]
    ds_read_b64_tr_b16 v[126:127], v15 offset:57344
    v_mfma_f32_16x16x32_bf16 v[160:163], v[64:67], v[48:51], v[160:163]
    ds_read_b128 v[80:83], v6 offset:32768
    v_mfma_f32_16x16x32_bf16 v[164:167], v[68:71], v[48:51], v[164:167]
    ds_read_b128 v[88:91], v6 offset:34816
    v_mfma_f32_16x16x32_bf16 v[168:171], v[72:75], v[48:51], v[168:171]
    ds_read_b128 v[96:99], v6 offset:36864
    v_mfma_f32_16x16x32_bf16 v[172:175], v[76:79], v[48:51], v[172:175]
    ds_read_b128 v[104:107], v6 offset:38912
    v_mfma_f32_16x16x32_bf16 v[176:179], v[64:67], v[56:59], v[176:179]
    v_mfma_f32_16x16x32_bf16 v[180:183], v[68:71], v[56:59], v[180:183]
    v_mfma_f32_16x16x32_bf16 v[184:187], v[72:75], v[56:59], v[184:187]
    v_mfma_f32_16x16x32_bf16 v[188:191], v[76:79], v[56:59], v[188:191]
    s_waitcnt lgkmcnt(0)
    s_waitcnt vmcnt(8)
    s_barrier
    s_add_u32 m0, s21, 98304
    s_nop 0
    buffer_load_dwordx4 v1, s[4:7], s16 offen sc1 lds
    s_add_u32 s16, s16, s62
    s_add_u32 m0, s21, 99328
    s_nop 0
    buffer_load_dwordx4 v1, s[4:7], s17 offen sc1 lds
    s_add_u32 s17, s17, s62
    s_add_u32 m0, s22, 98304
    s_nop 0
    buffer_load_dwordx4 v2, s[8:11], s18 offen lds
    s_add_u32 s18, s18, s20
    s_add_u32 m0, s22, 106496
    s_nop 0
    buffer_load_dwordx4 v2, s[12:15], s19 offen lds
    s_add_u32 s19, s19, s20
    v_mfma_f32_16x16x32_bf16 v[128:131], v[112:115], v[80:83], v[128:131]
    ds_read_b64_tr_b16 v[64:65], v8 offset:16384
    v_mfma_f32_16x16x32_bf16 v[132:135], v[116:119], v[80:83], v[132:135]
    ds_read_b64_tr_b16 v[66:67], v9 offset:16384
    v_mfma_f32_16x16x32_bf16 v[136:139], v[120:123], v[80:83], v[136:139]
    ds_read_b64_tr_b16 v[68:69], v10 offset:16384
    v_mfma_f32_16x16x32_bf16 v[140:143], v[124:127], v[80:83], v[140:143]
    ds_read_b64_tr_b16 v[70:71], v11 offset:16384
    v_mfma_f32_16x16x32_bf16 v[144:147], v[112:115], v[88:91], v[144:147]
    ds_read_b64_tr_b16 v[72:73], v8 offset:24576
    v_mfma_f32_16x16x32_bf16 v[148:151], v[116:119], v[88:91], v[148:151]
    ds_read_b64_tr_b16 v[74:75], v9 offset:24576
    v_mfma_f32_16x16x32_bf16 v[152:155], v[120:123], v[88:91], v[152:155]
    ds_read_b64_tr_b16 v[76:77], v10 offset:24576
    v_mfma_f32_16x16x32_bf16 v[156:159], v[124:127], v[88:91], v[156:159]
    ds_read_b64_tr_b16 v[78:79], v11 offset:24576
    v_mfma_f32_16x16x32_bf16 v[160:163], v[112:115], v[96:99], v[160:163]
    ds_read_b128 v[32:35], v5 offset:0
    v_mfma_f32_16x16x32_bf16 v[164:167], v[116:119], v[96:99], v[164:167]
    ds_read_b128 v[36:39], v5 offset:1024
    v_mfma_f32_16x16x32_bf16 v[168:171], v[120:123], v[96:99], v[168:171]
    ds_read_b128 v[40:43], v5 offset:2048
    v_mfma_f32_16x16x32_bf16 v[172:175], v[124:127], v[96:99], v[172:175]
    ds_read_b128 v[44:47], v5 offset:3072
    v_mfma_f32_16x16x32_bf16 v[176:179], v[112:115], v[104:107], v[176:179]
    ds_read_b128 v[48:51], v5 offset:4096
    v_mfma_f32_16x16x32_bf16 v[180:183], v[116:119], v[104:107], v[180:183]
    ds_read_b128 v[52:55], v5 offset:5120
    v_mfma_f32_16x16x32_bf16 v[184:187], v[120:123], v[104:107], v[184:187]
    ds_read_b128 v[56:59], v5 offset:6144
    v_mfma_f32_16x16x32_bf16 v[188:191], v[124:127], v[104:107], v[188:191]
    ds_read_b128 v[60:63], v5 offset:7168
    s_waitcnt lgkmcnt(0)
    s_branch w_doneM
w_bodyM:
    buffer_load_dword v22, off, s[64:67], 0 sc1
    s_waitcnt vmcnt(6)
    s_barrier
    s_add_u32 m0, s21, 0
    s_nop 0
    buffer_load_dwordx4 v1, s[4:7], s16 offen sc1 lds
    s_add_u32 s16, s16, s62
    s_add_u32 m0, s22, 0
    s_nop 0
    buffer_load_dwordx4 v2, s[8:11], s18 offen lds
    s_add_u32 s18, s18, s20
    s_add_u32 m0, s22, 8192
    s_nop 0
    buffer_load_dwordx4 v2, s[12:15], s19 offen lds
    s_add_u32 s19, s19, s20
    v_mfma_f32_16x16x32_bf16 v[128:131], v[64:67], v[32:35], v[128:131]
    ds_read_b64_tr_b16 v[112:113], v8 offset:49152
    v_mfma_f32_16x16x32_bf16 v[132:135], v[68:71], v[32:35], v[132:135]
    ds_read_b64_tr_b16 v[114:115], v9 offset:49152
    v_mfma_f32_16x16x32_bf16 v[136:139], v[72:75], v[32:35], v[136:139]
    ds_read_b64_tr_b16 v[116:117], v10 offset:49152
    v_mfma_f32_16x16x32_bf16 v[140:143], v[76:79], v[32:35], v[140:143]
    ds_read_b64_tr_b16 v[118:119], v11 offset:49152
    v_mfma_f32_16x16x32_bf16 v[144:147], v[64:67], v[40:43], v[144:147]
    ds_read_b64_tr_b16 v[120:121], v8 offset:57344
    v_mfma_f32_16x16x32_bf16 v[148:151], v[68:71], v[40:43], v[148:151]
    ds_read_b64_tr_b16 v[122:123], v9 offset:57344
    v_mfma_f32_16x16x32_bf16 v[152:155], v[72:75], v[40:43], v[152:155]
    ds_read_b64_tr_b16 v[124:125], v10 offset:57344
    v_mfma_f32_16x16x32_bf16 v[156:159], v[76:79], v[40:43], v[156:159]
    ds_read_b64_tr_b16 v[126:127], v11 offset:57344
    v_mfma_f32_16x16x32_bf16 v[160:163], v[64:67], v[48:51], v[160:163]
    ds_read_b128 v[80:83], v5 offset:32768
    v_mfma_f32_16x16x32_bf16 v[164:167], v[68:71], v[48:51], v[164:167]
    ds_read_b128 v[88:91], v5 offset:34816
    v_mfma_f32_16x16x32_bf16 v[168:171], v[72:75], v[48:51], v[168:171]
    ds_read_b128 v[96:99], v5 offset:36864
    v_mfma_f32_16x16x32_bf16 v[172:175], v[76:79], v[48:51], v[172:175]
    ds_read_b128 v[104:107], v5 offset:38912
    v_mfma_f32_16x16x32_bf16 v[176:179], v[64:67], v[56:59], v[176:179]
    v_mfma_f32_16x16x32_bf16 v[180:183], v[68:71], v[56:59], v[180:183]
    v_mfma_f32_16x16x32_bf16 v[184:187], v[72:75], v[56:59], v[184:187]
    v_mfma_f32_16x16x32_bf16 v[188:191], v[76:79], v[56:59], v[188:191]
    buffer_load_dword v16, v17, s[4:7], s44 offen sc1
    s_waitcnt lgkmcnt(0)
    s_waitcnt vmcnt(6)
    s_barrier
    s_add_u32 m0, s21, 32768
    s_nop 0
    buffer_load_dwordx4 v1, s[4:7], s16 offen sc1 lds
    s_add_u32 s16, s16, s62
    s_add_u32 m0, s22, 32768
    s_nop 0
    buffer_load_dwordx4 v2, s[8:11], s18 offen lds
    s_add_u32 s18, s18, s20
    s_add_u32 m0, s22, 40960
    s_nop 0
    buffer_load_dwordx4 v2, s[12:15], s19 offen lds
    s_add_u32 s19, s19, s20
    v_mfma_f32_16x16x32_bf16 v[128:131], v[112:115], v[80:83], v[128:131]
    ds_read_b64_tr_b16 v[64:65], v12 offset:16384
    v_mfma_f32_16x16x32_bf16 v[132:135], v[116:119], v[80:83], v[132:135]
    ds_read_b64_tr_b16 v[66:67], v13 offset:16384
    v_mfma_f32_16x16x32_bf16 v[136:139], v[120:123], v[80:83], v[136:139]
    ds_read_b64_tr_b16 v[68:69], v14 offset:16384
    v_mfma_f32_16x16x32_bf16 v[140:143], v[124:127], v[80:83], v[140:143]
    ds_read_b64_tr_b16 v[70:71], v15 offset:16384
    v_mfma_f32_16x16x32_bf16 v[144:147], v[112:115], v[88:91], v[144:147]
    ds_read_b64_tr_b16 v[72:73], v12 offset:24576
    v_mfma_f32_16x16x32_bf16 v[148:151], v[116:119], v[88:91], v[148:151]
    ds_read_b64_tr_b16 v[74:75], v13 offset:24576
    v_mfma_f32_16x16x32_bf16 v[152:155], v[120:123], v[88:91], v[152:155]
    ds_read_b64_tr_b16 v[76:77], v14 offset:24576
    v_mfma_f32_16x16x32_bf16 v[156:159], v[124:127], v[88:91], v[156:159]
    ds_read_b64_tr_b16 v[78:79], v15 offset:24576
    v_mfma_f32_16x16x32_bf16 v[160:163], v[112:115], v[96:99], v[160:163]
    ds_read_b128 v[32:35], v6 offset:0
    v_mfma_f32_16x16x32_bf16 v[164:167], v[116:119], v[96:99], v[164:167]
    ds_read_b128 v[40:43], v6 offset:2048
    v_mfma_f32_16x16x32_bf16 v[168:171], v[120:123], v[96:99], v[168:171]
    ds_read_b128 v[48:51], v6 offset:4096
    v_mfma_f32_16x16x32_bf16 v[172:175], v[124:127], v[96:99], v[172:175]
    ds_read_b128 v[56:59], v6 offset:6144
    v_mfma_f32_16x16x32_bf16 v[176:179], v[112:115], v[104:107], v[176:179]
    v_mfma_f32_16x16x32_bf16 v[180:183], v[116:119], v[104:107], v[180:183]
    v_mfma_f32_16x16x32_bf16 v[184:187], v[120:123], v[104:107], v[184:187]
    v_mfma_f32_16x16x32_bf16 v[188:191], v[124:127], v[104:107], v[188:191]
    s_waitcnt lgkmcnt(0)
    s_waitcnt vmcnt(6)
    s_barrier
    s_add_u32 m0, s21, 65536
    s_nop 0
    buffer_load_dwordx4 v1, s[4:7], s16 offen sc1 lds
    s_add_u32 s16, s16, s62
    s_add_u32 m0, s22, 65536
    s_nop 0
    buffer_load_dwordx4 v2, s[8:11], s18 offen lds
    s_add_u32 s18, s18, s20
    s_add_u32 m0, s22, 73728
    s_nop 0
    buffer_load_dwordx4 v2, s[12:15], s19 offen lds
    s_add_u32 s19, s19, s20
    v_mfma_f32_16x16x32_bf16 v[128:131], v[64:67], v[32:35], v[128:131]
    ds_read_b64_tr_b16 v[112:113], v12 offset:49152
    v_mfma_f32_16x16x32_bf16 v[132:135], v[68:71], v[32:35], v[132:135]
    ds_read_b64_tr_b16 v[114:115], v13 offset:49152
    v_mfma_f32_16x16x32_bf16 v[136:139], v[72:75], v[32:35], v[136:139]
    ds_read_b64_tr_b16 v[116:117], v14 offset:49152
    v_mfma_f32_16x16x32_bf16 v[140:143], v[76:79], v[32:35], v[140:143]
    ds_read_b64_tr_b16 v[118:119], v15 offset:49152
    v_mfma_f32_16x16x32_bf16 v[144:147], v[64:67], v[40:43], v[144:147]
    ds_read_b64_tr_b16 v[120:121], v12 offset:57344
    v_mfma_f32_16x16x32_bf16 v[148:151], v[68:71], v[40:43], v[148:151]
    ds_read_b64_tr_b16 v[122:123], v13 offset:57344
    v_mfma_f32_16x16x32_bf16 v[152:155], v[72:75], v[40:43], v[152:155]
    ds_read_b64_tr_b16 v[124:125], v14 offset:57344
    v_mfma_f32_16x16x32_bf16 v[156:159], v[76:79], v[40:43], v[156:159]
    ds_read_b64_tr_b16 v[126:127], v15 offset:57344
    v_mfma_f32_16x16x32_bf16 v[160:163], v[64:67], v[48:51], v[160:163]
    ds_read_b128 v[80:83], v6 offset:32768
    v_mfma_f32_16x16x32_bf16 v[164:167], v[68:71], v[48:51], v[164:167]
    ds_read_b128 v[88:91], v6 offset:34816
    v_mfma_f32_16x16x32_bf16 v[168:171], v[72:75], v[48:51], v[168:171]
    ds_read_b128 v[96:99], v6 offset:36864
    v_mfma_f32_16x16x32_bf16 v[172:175], v[76:79], v[48:51], v[172:175]
    ds_read_b128 v[104:107], v6 offset:38912
    v_mfma_f32_16x16x32_bf16 v[176:179], v[64:67], v[56:59], v[176:179]
    v_mfma_f32_16x16x32_bf16 v[180:183], v[68:71], v[56:59], v[180:183]
    v_mfma_f32_16x16x32_bf16 v[184:187], v[72:75], v[56:59], v[184:187]
    v_mfma_f32_16x16x32_bf16 v[188:191], v[76:79], v[56:59], v[188:191]
    s_waitcnt lgkmcnt(0)
    s_waitcnt vmcnt(6)
    s_barrier
    s_add_u32 m0, s21, 98304
    s_nop 0
    buffer_load_dwordx4 v1, s[4:7], s16 offen sc1 lds
    s_add_u32 s16, s16, s62
    s_add_u32 m0, s22, 98304
    s_nop 0
    buffer_load_dwordx4 v2, s[8:11], s18 offen lds
    s_add_u32 s18, s18, s20
    s_add_u32 m0, s22, 106496
    s_nop 0
    buffer_load_dwordx4 v2, s[12:15], s19 offen lds
    s_add_u32 s19, s19, s20
    v_mfma_f32_16x16x32_bf16 v[128:131], v[112:115], v[80:83], v[128:131]
    ds_read_b64_tr_b16 v[64:65], v8 offset:16384
    v_mfma_f32_16x16x32_bf16 v[132:135], v[116:119], v[80:83], v[132:135]
    ds_read_b64_tr_b16 v[66:67], v9 offset:16384
    v_mfma_f32_16x16x32_bf16 v[136:139], v[120:123], v[80:83], v[136:139]
    ds_read_b64_tr_b16 v[68:69], v10 offset:16384
    v_mfma_f32_16x16x32_bf16 v[140:143], v[124:127], v[80:83], v[140:143]
    ds_read_b64_tr_b16 v[70:71], v11 offset:16384
    v_mfma_f32_16x16x32_bf16 v[144:147], v[112:115], v[88:91], v[144:147]
    ds_read_b64_tr_b16 v[72:73], v8 offset:24576
    v_mfma_f32_16x16x32_bf16 v[148:151], v[116:119], v[88:91], v[148:151]
    ds_read_b64_tr_b16 v[74:75], v9 offset:24576
    v_mfma_f32_16x16x32_bf16 v[152:155], v[120:123], v[88:91], v[152:155]
    ds_read_b64_tr_b16 v[76:77], v10 offset:24576
    v_mfma_f32_16x16x32_bf16 v[156:159], v[124:127], v[88:91], v[156:159]
    ds_read_b64_tr_b16 v[78:79], v11 offset:24576
    v_mfma_f32_16x16x32_bf16 v[160:163], v[112:115], v[96:99], v[160:163]
    ds_read_b128 v[32:35], v5 offset:0
    v_mfma_f32_16x16x32_bf16 v[164:167], v[116:119], v[96:99], v[164:167]
    ds_read_b128 v[40:43], v5 offset:2048
    v_mfma_f32_16x16x32_bf16 v[168:171], v[120:123], v[96:99], v[168:171]
    ds_read_b128 v[48:51], v5 offset:4096
    v_mfma_f32_16x16x32_bf16 v[172:175], v[124:127], v[96:99], v[172:175]
    ds_read_b128 v[56:59], v5 offset:6144
    v_mfma_f32_16x16x32_bf16 v[176:179], v[112:115], v[104:107], v[176:179]
    v_mfma_f32_16x16x32_bf16 v[180:183], v[116:119], v[104:107], v[180:183]
    v_mfma_f32_16x16x32_bf16 v[184:187], v[120:123], v[104:107], v[184:187]
    v_mfma_f32_16x16x32_bf16 v[188:191], v[124:127], v[104:107], v[188:191]
    s_waitcnt lgkmcnt(0)
    s_sub_u32 s23, s23, 1
    s_cmp_lg_u32 s23, 0
    s_cbranch_scc1 w_loopM
w_doneM:
    v_mov_b32 v20, 131072
    ds_read_b128 v[24:27], v20
    ds_read_b128 v[28:31], v20 offset:16
    s_lshl_b32 s30, s27, 10
    s_add_u32 s30, s30, s49
    s_nop 7
    v_cvt_pk_bf16_f32 v80, v128, v129
    v_cvt_pk_bf16_f32 v81, v130, v131
    v_cvt_pk_bf16_f32 v82, v132, v133
    v_cvt_pk_bf16_f32 v83, v134, v135
    buffer_store_dwordx4 v[80:83], v1, s[4:7], s30 offen sc1
    v_cvt_pk_bf16_f32 v84, v136, v137
    v_cvt_pk_bf16_f32 v85, v138, v139
    v_cvt_pk_bf16_f32 v86, v140, v141
    v_cvt_pk_bf16_f32 v87, v142, v143
    buffer_store_dwordx4 v[84:87], v19, s[4:7], s30 offen sc1
    s_add_u32 s30, s30, s50
    v_cvt_pk_bf16_f32 v88, v144, v145
    v_cvt_pk_bf16_f32 v89, v146, v147
    v_cvt_pk_bf16_f32 v90, v148, v149
    v_cvt_pk_bf16_f32 v91, v150, v151
    buffer_store_dwordx4 v[88:91], v1, s[4:7], s30 offen sc1
    v_cvt_pk_bf16_f32 v92, v152, v153
    v_cvt_pk_bf16_f32 v93, v154, v155
    v_cvt_pk_bf16_f32 v94, v156, v157
    v_cvt_pk_bf16_f32 v95, v158, v159
    buffer_store_dwordx4 v[92:95], v19, s[4:7], s30 offen sc1
    s_add_u32 s30, s30, s50
    v_cvt_pk_bf16_f32 v80, v160, v161
    v_cvt_pk_bf16_f32 v81, v162, v163
    v_cvt_pk_bf16_f32 v82, v164, v165
    v_cvt_pk_bf16_f32 v83, v166, v167
    buffer_store_dwordx4 v[80:83], v1, s[4:7], s30 offen sc1
    v_cvt_pk_bf16_f32 v84, v168, v169
    v_cvt_pk_bf16_f32 v85, v170, v171
    v_cvt_pk_bf16_f32 v86, v172, v173
    v_cvt_pk_bf16_f32 v87, v174, v175
    buffer_store_dwordx4 v[84:87], v19, s[4:7], s30 offen sc1
    s_add_u32 s30, s30, s50
    v_cvt_pk_bf16_f32 v88, v176, v177
    v_cvt_pk_bf16_f32 v89, v178, v179
    v_cvt_pk_bf16_f32 v90, v180, v181
    v_cvt_pk_bf16_f32 v91, v182, v183
    buffer_store_dwordx4 v[88:91], v1, s[4:7], s30 offen sc1
    v_cvt_pk_bf16_f32 v92, v184, v185
    v_cvt_pk_bf16_f32 v93, v186, v187
    v_cvt_pk_bf16_f32 v94, v188, v189
    v_cvt_pk_bf16_f32 v95, v190, v191
    buffer_store_dwordx4 v[92:95], v19, s[4:7], s30 offen sc1
    s_add_u32 s30, s30, s50
    s_waitcnt lgkmcnt(0)
    v_or3_b32 v24, v24, v25, v26
    v_or3_b32 v28, v28, v29, v30
    v_or3_b32 v24, v24, v27, v31
    v_or_b32 v24, v24, v28
    s_mov_b32 s28, s51
    s_mov_b32 s57, s53
    v_readfirstlane_b32 s30, v24
    s_cmp_lg_u32 s30, 0
    s_cbranch_scc1 w_drain
    s_mov_b32 s48, s32
    s_cmp_ge_u32 s32, 4
    s_cselect_b32 s30, 2, 3
    s_lshl_b32 s30, s26, s30
    s_mul_i32 s30, s30, s43
    s_add_u32 s49, s42, s30
    s_mov_b32 s50, s43
    s_mov_b32 s51, s46
    s_mov_b32 s23, s41
    s_mov_b32 s53, s47
    s_nop 0
    s_load_dwordx16 s[32:47], s[24:25], 0
    s_add_u32 s24, s24, 64
    s_addc_u32 s25, s25, 0
    s_branch w_first8
w_drain:
    s_waitcnt vmcnt(0)
    s_barrier
    s_cmp_eq_u32 s28, 0
    s_cbranch_scc1 sig_5
    s_cmp_lg_u32 s3, 0
    s_cbranch_scc1 sig_5
    s_mov_b64 exec, 1
    v_mov_b32 v18, s57
    buffer_atomic_add v18, v17, s[4:7], s28 offen sc1
    s_mov_b64 exec, -1
sig_5:
    s_mov_b32 s28, 0
    s_cmp_eq_u32 s98, 3
    s_cselect_b32 s98, 1, s98
w_hook:
    s_cmp_eq_u32 s70, 0
    s_cbranch_scc1 drw_ok
    s_cmp_lt_u32 s39, 1048576
    s_cbranch_scc1 drw_ok
    s_mov_b32 s70, 0
    s_cmp_lg_u32 s3, 0
    s_cbranch_scc1 drw_ok
    v_readfirstlane_b32 s68, v22
    s_cmp_ge_u32 s68, 128
    s_cbranch_scc1 drw_ok
    s_mov_b32 s69, 65536
drw:
    buffer_load_dword v20, off, s[64:67], 0 offset:0 sc1
    s_waitcnt vmcnt(0)
    v_readfirstlane_b32 s68, v20
    s_cmp_ge_u32 s68, 128
    s_cbranch_scc1 drw_ok
    s_sleep 8
    s_sub_u32 s69, s69, 1
    s_cbranch_scc0 drw
drw_ok:
    s_branch w_cold
fin_entry:
    s_load_dwordx2 s[8:9], s[0:1], 0
    s_load_dwordx2 s[12:13], s[0:1], 88
    v_mbcnt_lo_u32_b32 v1, -1, 0
    v_mbcnt_hi_u32_b32 v1, -1, v1
    s_mov_b32 s10, 4194304
    s_mov_b32 s11, 131072
    s_mov_b32 s14, 4194304
    s_mov_b32 s15, 131072
    v_lshlrev_b32 v3, 4, v1
    v_and_b32 v4, 15, v1
    v_lshrrev_b32 v5, 4, v1
    v_lshlrev_b32 v4, 11, v4
    v_lshl_add_u32 v4, v5, 4, v4
    v_and_b32 v5, 1, v5
    v_cmp_eq_u32 s[20:21], 1, v5
    v_and_b32 v6, 7, v1
    v_lshlrev_b32 v6, 7, v6
    s_lshr_b32 s24, s63, 2
    s_and_b32 s25, s63, 3
    s_lshl_b32 s25, s25, 2
    s_and_b32 s26, s3, 3
    s_add_u32 s25, s25, s26
    s_lshr_b32 s26, s3, 2
    s_mov_b32 s28, 65536
    s_waitcnt lgkmcnt(0)
fin_job:
    s_lshl_b32 s16, s24, 1
    s_add_u32 s16, s16, s26
    s_lshl_b32 s18, s16, 15
    s_lshl_b32 s17, s25, 11
    s_add_u32 s17, s17, s18
    s_lshl_b32 s19, s25, 7
    s_add_u32 s18, s18, s19
    s_add_u32 s22, s17, 167772160
    s_add_u32 s23, s17, 75497472
    s_lshr_b32 s27, s24, 3
    s_lshl_b32 s27, s27, 6
    s_add_u32 s27, s27, 218106368
    s_cmp_ge_u32 s24, 64
    s_cselect_b32 s29, 16, 16
    s_mov_b32 s30, 218112000
    s_add_u32 s32, s24, 1
    s_mov_b32 s33, 0
    s_mov_b32 s34, 255
    s_cmp_lt_u32 s24, 62
    s_cbranch_scc1 fin_tg
    s_mov_b32 s32, 16
    s_add_u32 s30, s30, 4
    s_sub_u32 s33, s24, 62
    s_lshl_b32 s33, s33, 3
fin_tg:
    s_mul_i32 s35, s24, 3
    s_lshr_b32 s35, s35, 4
    s_add_u32 s35, s35, 49
    s_min_u32 s35, s35, 61
    s_max_u32 s32, s32, s35
    buffer_load_dwordx4 v[88:91], v4, s[8:11], s18 offen offset:0
    buffer_load_dwordx4 v[92:95], v4, s[8:11], s18 offen offset:64
    s_cmp_lg_u32 s3, 0
    s_cbranch_scc1 fin_ws_ok
fin_wd:
    buffer_load_dword v7, off, s[4:7], s27 sc1
    s_waitcnt vmcnt(0)
    v_readfirstlane_b32 s31, v7
    s_cmp_ge_u32 s31, s29
    s_cbranch_scc1 fin_wd_ok
    s_sleep 127
    s_sub_u32 s28, s28, 1
    s_cbranch_scc0 fin_wd
    s_mov_b32 s28, 0
fin_wd_ok:
fin_ws:
    buffer_load_dword v7, v6, s[4:7], s30 offen sc1
    s_waitcnt vmcnt(0)
    v_lshrrev_b32 v7, s33, v7
    v_and_b32 v7, s34, v7
    v_cmp_gt_u32 vcc, s32, v7
    s_cbranch_vccz fin_ws_ok
    s_sleep 12
    v_add_u32 v7, 1, v7
    v_cmp_gt_u32 vcc, s32, v7
    s_cbranch_vccz fin_ws_f
    s_sleep 48
    v_add_u32 v7, 3, v7
    v_cmp_gt_u32 vcc, s32, v7
    s_cbranch_vccz fin_ws_f
    s_sleep 127
    s_sleep 127
fin_ws_f:
    s_sub_u32 s28, s28, 1
    s_cbranch_scc0 fin_ws
    s_mov_b32 s28, 0
fin_ws_ok:
    s_barrier
    buffer_load_dwordx4 v[144:147], v3, s[4:7], s22 offen offset:0 sc1
    buffer_load_dwordx4 v[160:163], v3, s[4:7], s22 offen offset:1024 sc1
    s_add_u32 s22, s22, 4194304
    buffer_load_dwordx4 v[148:151], v3, s[4:7], s22 offen offset:0 sc1
    buffer_load_dwordx4 v[164:167], v3, s[4:7], s22 offen offset:1024 sc1
    s_add_u32 s22, s22, 4194304
    buffer_load_dwordx4 v[152:155], v3, s[4:7], s22 offen offset:0 sc1
    buffer_load_dwordx4 v[168:171], v3, s[4:7], s22 offen offset:1024 sc1
    s_add_u32 s22, s22, 4194304
    buffer_load_dwordx4 v[156:159], v3, s[4:7], s22 offen offset:0 sc1
    buffer_load_dwordx4 v[172:175], v3, s[4:7], s22 offen offset:1024 sc1
    buffer_load_dwordx4 v[16:19], v3, s[4:7], s23 offen offset:0 sc1
    buffer_load_dwordx4 v[48:51], v3, s[4:7], s23 offen offset:1024 sc1
    s_add_u32 s23, s23, 4194304
    buffer_load_dwordx4 v[20:23], v3, s[4:7], s23 offen offset:0 sc1
    buffer_load_dwordx4 v[52:55], v3, s[4:7], s23 offen offset:1024 sc1
    s_add_u32 s23, s23, 4194304
    buffer_load_dwordx4 v[24:27], v3, s[4:7], s23 offen offset:0 sc1
    buffer_load_dwordx4 v[56:59], v3, s[4:7], s23 offen offset:1024 sc1
    s_add_u32 s23, s23, 4194304
    buffer_load_dwordx4 v[28:31], v3, s[4:7], s23 offen offset:0 sc1
    buffer_load_dwordx4 v[60:63], v3, s[4:7], s23 offen offset:1024 sc1
    s_add_u32 s23, s23, 4194304
    buffer_load_dwordx4 v[32:35], v3, s[4:7], s23 offen offset:0 sc1
    buffer_load_dwordx4 v[64:67], v3, s[4:7], s23 offen offset:1024 sc1
    s_add_u32 s23, s23, 4194304
    buffer_load_dwordx4 v[36:39], v3, s[4:7], s23 offen offset:0 sc1
    buffer_load_dwordx4 v[68:71], v3, s[4:7], s23 offen offset:1024 sc1
    s_add_u32 s23, s23, 4194304
    buffer_load_dwordx4 v[40:43], v3, s[4:7], s23 offen offset:0 sc1
    buffer_load_dwordx4 v[72:75], v3, s[4:7], s23 offen offset:1024 sc1
    s_add_u32 s23, s23, 4194304
    buffer_load_dwordx4 v[44:47], v3, s[4:7], s23 offen offset:0 sc1
    buffer_load_dwordx4 v[76:79], v3, s[4:7], s23 offen offset:1024 sc1
    s_add_u32 s23, s23, 4194304
    s_waitcnt vmcnt(16)
    v_lshlrev_b32 v96, 16, v144
    v_and_b32 v97, 0xffff0000, v144
    v_lshlrev_b32 v98, 16, v145
    v_and_b32 v99, 0xffff0000, v145
    v_lshlrev_b32 v100, 16, v146
    v_and_b32 v101, 0xffff0000, v146
    v_lshlrev_b32 v102, 16, v147
    v_and_b32 v103, 0xffff0000, v147
    v_lshlrev_b32 v120, 16, v148
    v_and_b32 v121, 0xffff0000, v148
    v_lshlrev_b32 v122, 16, v149
    v_and_b32 v123, 0xffff0000, v149
    v_lshlrev_b32 v124, 16, v150
    v_and_b32 v125, 0xffff0000, v150
    v_lshlrev_b32 v126, 16, v151
    v_and_b32 v127, 0xffff0000, v151
    v_add_f32 v96, v96, v120
    v_add_f32 v97, v97, v121
    v_add_f32 v98, v98, v122
    v_add_f32 v99, v99, v123
    v_add_f32 v100, v100, v124
    v_add_f32 v101, v101, v125
    v_add_f32 v102, v102, v126
    v_add_f32 v103, v103, v127
    v_lshlrev_b32 v120, 16, v152
    v_and_b32 v121, 0xffff0000, v152
    v_lshlrev_b32 v122, 16, v153
    v_and_b32 v123, 0xffff0000, v153
    v_lshlrev_b32 v124, 16, v154
    v_and_b32 v125, 0xffff0000, v154
    v_lshlrev_b32 v126, 16, v155
    v_and_b32 v127, 0xffff0000, v155
    v_add_f32 v96, v96, v120
    v_add_f32 v97, v97, v121
    v_add_f32 v98, v98, v122
    v_add_f32 v99, v99, v123
    v_add_f32 v100, v100, v124
    v_add_f32 v101, v101, v125
    v_add_f32 v102, v102, v126
    v_add_f32 v103, v103, v127
    v_lshlrev_b32 v120, 16, v156
    v_and_b32 v121, 0xffff0000, v156
    v_lshlrev_b32 v122, 16, v157
    v_and_b32 v123, 0xffff0000, v157
    v_lshlrev_b32 v124, 16, v158
    v_and_b32 v125, 0xffff0000, v158
    v_lshlrev_b32 v126, 16, v159
    v_and_b32 v127, 0xffff0000, v159
    v_add_f32 v96, v96, v120
    v_add_f32 v97, v97, v121
    v_add_f32 v98, v98, v122
    v_add_f32 v99, v99, v123
    v_add_f32 v100, v100, v124
    v_add_f32 v101, v101, v125
    v_add_f32 v102, v102, v126
    v_add_f32 v103, v103, v127
    v_cvt_pk_bf16_f32 v120, v96, v97
    v_cvt_pk_bf16_f32 v121, v98, v99
    v_cvt_pk_bf16_f32 v122, v100, v101
    v_cvt_pk_bf16_f32 v123, v102, v103
    v_lshlrev_b32 v96, 16, v120
    v_and_b32 v97, 0xffff0000, v120
    v_lshlrev_b32 v98, 16, v121
    v_and_b32 v99, 0xffff0000, v121
    v_lshlrev_b32 v100, 16, v122
    v_and_b32 v101, 0xffff0000, v122
    v_lshlrev_b32 v102, 16, v123
    v_and_b32 v103, 0xffff0000, v123
    v_mul_f32 v104, 0xbfb8aa3b, v96
    v_mul_f32 v105, 0xbfb8aa3b, v97
    v_mul_f32 v106, 0xbfb8aa3b, v98
    v_mul_f32 v107, 0xbfb8aa3b, v99
    v_mul_f32 v108, 0xbfb8aa3b, v100
    v_mul_f32 v109, 0xbfb8aa3b, v101
    v_mul_f32 v110, 0xbfb8aa3b, v102
    v_mul_f32 v111, 0xbfb8aa3b, v103
    v_exp_f32 v104, v104
    v_exp_f32 v105, v105
    v_exp_f32 v106, v106
    v_exp_f32 v107, v107
    v_exp_f32 v108, v108
    v_exp_f32 v109, v109
    v_exp_f32 v110, v110
    v_exp_f32 v111, v111
    v_add_f32 v104, 1.0, v104
    v_add_f32 v105, 1.0, v105
    v_add_f32 v106, 1.0, v106
    v_add_f32 v107, 1.0, v107
    v_add_f32 v108, 1.0, v108
    v_add_f32 v109, 1.0, v109
    v_add_f32 v110, 1.0, v110
    v_add_f32 v111, 1.0, v111
    v_rcp_f32 v104, v104
    v_rcp_f32 v105, v105
    v_rcp_f32 v106, v106
    v_rcp_f32 v107, v107
    v_rcp_f32 v108, v108
    v_rcp_f32 v109, v109
    v_rcp_f32 v110, v110
    v_rcp_f32 v111, v111
    v_mul_f32 v96, v96, v104
    v_mul_f32 v97, v97, v105
    v_mul_f32 v98, v98, v106
    v_mul_f32 v99, v99, v107
    v_mul_f32 v100, v100, v108
    v_mul_f32 v101, v101, v109
    v_mul_f32 v102, v102, v110
    v_mul_f32 v103, v103, v111
    v_cvt_pk_bf16_f32 v80, v96, v97
    v_cvt_pk_bf16_f32 v81, v98, v99
    v_cvt_pk_bf16_f32 v82, v100, v101
    v_cvt_pk_bf16_f32 v83, v102, v103
    v_lshlrev_b32 v96, 16, v160
    v_and_b32 v97, 0xffff0000, v160
    v_lshlrev_b32 v98, 16, v161
    v_and_b32 v99, 0xffff0000, v161
    v_lshlrev_b32 v100, 16, v162
    v_and_b32 v101, 0xffff0000, v162
    v_lshlrev_b32 v102, 16, v163
    v_and_b32 v103, 0xffff0000, v163
    v_lshlrev_b32 v120, 16, v164
    v_and_b32 v121, 0xffff0000, v164
    v_lshlrev_b32 v122, 16, v165
    v_and_b32 v123, 0xffff0000, v165
    v_lshlrev_b32 v124, 16, v166
    v_and_b32 v125, 0xffff0000, v166
    v_lshlrev_b32 v126, 16, v167
    v_and_b32 v127, 0xffff0000, v167
    v_add_f32 v96, v96, v120
    v_add_f32 v97, v97, v121
    v_add_f32 v98, v98, v122
    v_add_f32 v99, v99, v123
    v_add_f32 v100, v100, v124
    v_add_f32 v101, v101, v125
    v_add_f32 v102, v102, v126
    v_add_f32 v103, v103, v127
    v_lshlrev_b32 v120, 16, v168
    v_and_b32 v121, 0xffff0000, v168
    v_lshlrev_b32 v122, 16, v169
    v_and_b32 v123, 0xffff0000, v169
    v_lshlrev_b32 v124, 16, v170
    v_and_b32 v125, 0xffff0000, v170
    v_lshlrev_b32 v126, 16, v171
    v_and_b32 v127, 0xffff0000, v171
    v_add_f32 v96, v96, v120
    v_add_f32 v97, v97, v121
    v_add_f32 v98, v98, v122
    v_add_f32 v99, v99, v123
    v_add_f32 v100, v100, v124
    v_add_f32 v101, v101, v125
    v_add_f32 v102, v102, v126
    v_add_f32 v103, v103, v127
    v_lshlrev_b32 v120, 16, v172
    v_and_b32 v121, 0xffff0000, v172
    v_lshlrev_b32 v122, 16, v173
    v_and_b32 v123, 0xffff0000, v173
    v_lshlrev_b32 v124, 16, v174
    v_and_b32 v125, 0xffff0000, v174
    v_lshlrev_b32 v126, 16, v175
    v_and_b32 v127, 0xffff0000, v175
    v_add_f32 v96, v96, v120
    v_add_f32 v97, v97, v121
    v_add_f32 v98, v98, v122
    v_add_f32 v99, v99, v123
    v_add_f32 v100, v100, v124
    v_add_f32 v101, v101, v125
    v_add_f32 v102, v102, v126
    v_add_f32 v103, v103, v127
    v_cvt_pk_bf16_f32 v120, v96, v97
    v_cvt_pk_bf16_f32 v121, v98, v99
    v_cvt_pk_bf16_f32 v122, v100, v101
    v_cvt_pk_bf16_f32 v123, v102, v103
    v_lshlrev_b32 v96, 16, v120
    v_and_b32 v97, 0xffff0000, v120
    v_lshlrev_b32 v98, 16, v121
    v_and_b32 v99, 0xffff0000, v121
    v_lshlrev_b32 v100, 16, v122
    v_and_b32 v101, 0xffff0000, v122
    v_lshlrev_b32 v102, 16, v123
    v_and_b32 v103, 0xffff0000, v123
    v_mul_f32 v104, 0xbfb8aa3b, v96
    v_mul_f32 v105, 0xbfb8aa3b, v97
    v_mul_f32 v106, 0xbfb8aa3b, v98
    v_mul_f32 v107, 0xbfb8aa3b, v99
    v_mul_f32 v108, 0xbfb8aa3b, v100
    v_mul_f32 v109, 0xbfb8aa3b, v101
    v_mul_f32 v110, 0xbfb8aa3b, v102
    v_mul_f32 v111, 0xbfb8aa3b, v103
    v_exp_f32 v104, v104
    v_exp_f32 v105, v105
    v_exp_f32 v106, v106
    v_exp_f32 v107, v107
    v_exp_f32 v108, v108
    v_exp_f32 v109, v109
    v_exp_f32 v110, v110
    v_exp_f32 v111, v111
    v_add_f32 v104, 1.0, v104
    v_add_f32 v105, 1.0, v105
    v_add_f32 v106, 1.0, v106
    v_add_f32 v107, 1.0, v107
    v_add_f32 v108, 1.0, v108
    v_add_f32 v109, 1.0, v109
    v_add_f32 v110, 1.0, v110
    v_add_f32 v111, 1.0, v111
    v_rcp_f32 v104, v104
    v_rcp_f32 v105, v105
    v_rcp_f32 v106, v106
    v_rcp_f32 v107, v107
    v_rcp_f32 v108, v108
    v_rcp_f32 v109, v109
    v_rcp_f32 v110, v110
    v_rcp_f32 v111, v111
    v_mul_f32 v96, v96, v104
    v_mul_f32 v97, v97, v105
    v_mul_f32 v98, v98, v106
    v_mul_f32 v99, v99, v107
    v_mul_f32 v100, v100, v108
    v_mul_f32 v101, v101, v109
    v_mul_f32 v102, v102, v110
    v_mul_f32 v103, v103, v111
    v_cvt_pk_bf16_f32 v84, v96, v97
    v_cvt_pk_bf16_f32 v85, v98, v99
    v_cvt_pk_bf16_f32 v86, v100, v101
    v_cvt_pk_bf16_f32 v87, v102, v103
    s_waitcnt vmcnt(0)
    v_lshlrev_b32 v96, 16, v16
    v_and_b32 v97, 0xffff0000, v16
    v_lshlrev_b32 v98, 16, v17
    v_and_b32 v99, 0xffff0000, v17
    v_lshlrev_b32 v100, 16, v18
    v_and_b32 v101, 0xffff0000, v18
    v_lshlrev_b32 v102, 16, v19
    v_and_b32 v103, 0xffff0000, v19
    v_lshlrev_b32 v120, 16, v20
    v_and_b32 v121, 0xffff0000, v20
    v_lshlrev_b32 v122, 16, v21
    v_and_b32 v123, 0xffff0000, v21
    v_lshlrev_b32 v124, 16, v22
    v_and_b32 v125, 0xffff0000, v22
    v_lshlrev_b32 v126, 16, v23
    v_and_b32 v127, 0xffff0000, v23
    v_add_f32 v96, v96, v120
    v_add_f32 v97, v97, v121
    v_add_f32 v98, v98, v122
    v_add_f32 v99, v99, v123
    v_add_f32 v100, v100, v124
    v_add_f32 v101, v101, v125
    v_add_f32 v102, v102, v126
    v_add_f32 v103, v103, v127
    v_lshlrev_b32 v120, 16, v24
    v_and_b32 v121, 0xffff0000, v24
    v_lshlrev_b32 v122, 16, v25
    v_and_b32 v123, 0xffff0000, v25
    v_lshlrev_b32 v124, 16, v26
    v_and_b32 v125, 0xffff0000, v26
    v_lshlrev_b32 v126, 16, v27
    v_and_b32 v127, 0xffff0000, v27
    v_add_f32 v96, v96, v120
    v_add_f32 v97, v97, v121
    v_add_f32 v98, v98, v122
    v_add_f32 v99, v99, v123
    v_add_f32 v100, v100, v124
    v_add_f32 v101, v101, v125
    v_add_f32 v102, v102, v126
    v_add_f32 v103, v103, v127
    v_lshlrev_b32 v120, 16, v28
    v_and_b32 v121, 0xffff0000, v28
    v_lshlrev_b32 v122, 16, v29
    v_and_b32 v123, 0xffff0000, v29
    v_lshlrev_b32 v124, 16, v30
    v_and_b32 v125, 0xffff0000, v30
    v_lshlrev_b32 v126, 16, v31
    v_and_b32 v127, 0xffff0000, v31
    v_add_f32 v96, v96, v120
    v_add_f32 v97, v97, v121
    v_add_f32 v98, v98, v122
    v_add_f32 v99, v99, v123
    v_add_f32 v100, v100, v124
    v_add_f32 v101, v101, v125
    v_add_f32 v102, v102, v126
    v_add_f32 v103, v103, v127
    v_lshlrev_b32 v120, 16, v32
    v_and_b32 v121, 0xffff0000, v32
    v_lshlrev_b32 v122, 16, v33
    v_and_b32 v123, 0xffff0000, v33
    v_lshlrev_b32 v124, 16, v34
    v_and_b32 v125, 0xffff0000, v34
    v_lshlrev_b32 v126, 16, v35
    v_and_b32 v127, 0xffff0000, v35
    v_add_f32 v96, v96, v120
    v_add_f32 v97, v97, v121
    v_add_f32 v98, v98, v122
    v_add_f32 v99, v99, v123
    v_add_f32 v100, v100, v124
    v_add_f32 v101, v101, v125
    v_add_f32 v102, v102, v126
    v_add_f32 v103, v103, v127
    v_lshlrev_b32 v120, 16, v36
    v_and_b32 v121, 0xffff0000, v36
    v_lshlrev_b32 v122, 16, v37
    v_and_b32 v123, 0xffff0000, v37
    v_lshlrev_b32 v124, 16, v38
    v_and_b32 v125, 0xffff0000, v38
    v_lshlrev_b32 v126, 16, v39
    v_and_b32 v127, 0xffff0000, v39
    v_add_f32 v96, v96, v120
    v_add_f32 v97, v97, v121
    v_add_f32 v98, v98, v122
    v_add_f32 v99, v99, v123
    v_add_f32 v100, v100, v124
    v_add_f32 v101, v101, v125
    v_add_f32 v102, v102, v126
    v_add_f32 v103, v103, v127
    v_lshlrev_b32 v120, 16, v40
    v_and_b32 v121, 0xffff0000, v40
    v_lshlrev_b32 v122, 16, v41
    v_and_b32 v123, 0xffff0000, v41
    v_lshlrev_b32 v124, 16, v42
    v_and_b32 v125, 0xffff0000, v42
    v_lshlrev_b32 v126, 16, v43
    v_and_b32 v127, 0xffff0000, v43
    v_add_f32 v96, v96, v120
    v_add_f32 v97, v97, v121
    v_add_f32 v98, v98, v122
    v_add_f32 v99, v99, v123
    v_add_f32 v100, v100, v124
    v_add_f32 v101, v101, v125
    v_add_f32 v102, v102, v126
    v_add_f32 v103, v103, v127
    v_lshlrev_b32 v120, 16, v44
    v_and_b32 v121, 0xffff0000, v44
    v_lshlrev_b32 v122, 16, v45
    v_and_b32 v123, 0xffff0000, v45
    v_lshlrev_b32 v124, 16, v46
    v_and_b32 v125, 0xffff0000, v46
    v_lshlrev_b32 v126, 16, v47
    v_and_b32 v127, 0xffff0000, v47
    v_add_f32 v96, v96, v120
    v_add_f32 v97, v97, v121
    v_add_f32 v98, v98, v122
    v_add_f32 v99, v99, v123
    v_add_f32 v100, v100, v124
    v_add_f32 v101, v101, v125
    v_add_f32 v102, v102, v126
    v_add_f32 v103, v103, v127
    v_cndmask_b32 v108, v88, v90, s[20:21]
    v_cndmask_b32 v109, v89, v91, s[20:21]
    v_cndmask_b32 v110, v90, v88, s[20:21]
    v_cndmask_b32 v111, v91, v89, s[20:21]
    v_cvt_pk_bf16_f32 v104, v96, v97
    v_lshlrev_b32 v96, 16, v104
    v_and_b32 v97, 0xffff0000, v104
    v_lshlrev_b32 v104, 16, v80
    v_and_b32 v105, 0xffff0000, v80
    v_mul_f32 v96, v96, v104
    v_mul_f32 v97, v97, v105
    v_cvt_pk_bf16_f32 v104, v96, v97
    v_lshlrev_b32 v96, 16, v104
    v_and_b32 v97, 0xffff0000, v104
    v_lshlrev_b32 v104, 16, v108
    v_and_b32 v105, 0xffff0000, v108
    v_add_f32 v96, v96, v104
    v_add_f32 v97, v97, v105
    v_cvt_pk_bf16_f32 v112, v96, v97
    v_cvt_pk_bf16_f32 v104, v98, v99
    v_lshlrev_b32 v98, 16, v104
    v_and_b32 v99, 0xffff0000, v104
    v_lshlrev_b32 v104, 16, v81
    v_and_b32 v105, 0xffff0000, v81
    v_mul_f32 v98, v98, v104
    v_mul_f32 v99, v99, v105
    v_cvt_pk_bf16_f32 v104, v98, v99
    v_lshlrev_b32 v98, 16, v104
    v_and_b32 v99, 0xffff0000, v104
    v_lshlrev_b32 v104, 16, v109
    v_and_b32 v105, 0xffff0000, v109
    v_add_f32 v98, v98, v104
    v_add_f32 v99, v99, v105
    v_cvt_pk_bf16_f32 v113, v98, v99
    v_cvt_pk_bf16_f32 v104, v100, v101
    v_lshlrev_b32 v100, 16, v104
    v_and_b32 v101, 0xffff0000, v104
    v_lshlrev_b32 v104, 16, v82
    v_and_b32 v105, 0xffff0000, v82
    v_mul_f32 v100, v100, v104
    v_mul_f32 v101, v101, v105
    v_cvt_pk_bf16_f32 v104, v100, v101
    v_lshlrev_b32 v100, 16, v104
    v_and_b32 v101, 0xffff0000, v104
    v_lshlrev_b32 v104, 16, v110
    v_and_b32 v105, 0xffff0000, v110
    v_add_f32 v100, v100, v104
    v_add_f32 v101, v101, v105
    v_cvt_pk_bf16_f32 v114, v100, v101
    v_cvt_pk_bf16_f32 v104, v102, v103
    v_lshlrev_b32 v102, 16, v104
    v_and_b32 v103, 0xffff0000, v104
    v_lshlrev_b32 v104, 16, v83
    v_and_b32 v105, 0xffff0000, v83
    v_mul_f32 v102, v102, v104
    v_mul_f32 v103, v103, v105
    v_cvt_pk_bf16_f32 v104, v102, v103
    v_lshlrev_b32 v102, 16, v104
    v_and_b32 v103, 0xffff0000, v104
    v_lshlrev_b32 v104, 16, v111
    v_and_b32 v105, 0xffff0000, v111
    v_add_f32 v102, v102, v104
    v_add_f32 v103, v103, v105
    v_cvt_pk_bf16_f32 v115, v102, v103
    v_cndmask_b32 v128, v112, v114, s[20:21]
    v_cndmask_b32 v129, v113, v115, s[20:21]
    v_cndmask_b32 v130, v114, v112, s[20:21]
    v_cndmask_b32 v131, v115, v113, s[20:21]
    buffer_store_dwordx4 v[128:131], v4, s[12:15], s18 offen offset:0
    v_lshlrev_b32 v96, 16, v48
    v_and_b32 v97, 0xffff0000, v48
    v_lshlrev_b32 v98, 16, v49
    v_and_b32 v99, 0xffff0000, v49
    v_lshlrev_b32 v100, 16, v50
    v_and_b32 v101, 0xffff0000, v50
    v_lshlrev_b32 v102, 16, v51
    v_and_b32 v103, 0xffff0000, v51
    v_lshlrev_b32 v120, 16, v52
    v_and_b32 v121, 0xffff0000, v52
    v_lshlrev_b32 v122, 16, v53
    v_and_b32 v123, 0xffff0000, v53
    v_lshlrev_b32 v124, 16, v54
    v_and_b32 v125, 0xffff0000, v54
    v_lshlrev_b32 v126, 16, v55
    v_and_b32 v127, 0xffff0000, v55
    v_add_f32 v96, v96, v120
    v_add_f32 v97, v97, v121
    v_add_f32 v98, v98, v122
    v_add_f32 v99, v99, v123
    v_add_f32 v100, v100, v124
    v_add_f32 v101, v101, v125
    v_add_f32 v102, v102, v126
    v_add_f32 v103, v103, v127
    v_lshlrev_b32 v120, 16, v56
    v_and_b32 v121, 0xffff0000, v56
    v_lshlrev_b32 v122, 16, v57
    v_and_b32 v123, 0xffff0000, v57
    v_lshlrev_b32 v124, 16, v58
    v_and_b32 v125, 0xffff0000, v58
    v_lshlrev_b32 v126, 16, v59
    v_and_b32 v127, 0xffff0000, v59
    v_add_f32 v96, v96, v120
    v_add_f32 v97, v97, v121
    v_add_f32 v98, v98, v122
    v_add_f32 v99, v99, v123
    v_add_f32 v100, v100, v124
    v_add_f32 v101, v101, v125
    v_add_f32 v102, v102, v126
    v_add_f32 v103, v103, v127
    v_lshlrev_b32 v120, 16, v60
    v_and_b32 v121, 0xffff0000, v60
    v_lshlrev_b32 v122, 16, v61
    v_and_b32 v123, 0xffff0000, v61
    v_lshlrev_b32 v124, 16, v62
    v_and_b32 v125, 0xffff0000, v62
    v_lshlrev_b32 v126, 16, v63
    v_and_b32 v127, 0xffff0000, v63
    v_add_f32 v96, v96, v120
    v_add_f32 v97, v97, v121
    v_add_f32 v98, v98, v122
    v_add_f32 v99, v99, v123
    v_add_f32 v100, v100, v124
    v_add_f32 v101, v101, v125
    v_add_f32 v102, v102, v126
    v_add_f32 v103, v103, v127
    v_lshlrev_b32 v120, 16, v64
    v_and_b32 v121, 0xffff0000, v64
    v_lshlrev_b32 v122, 16, v65
    v_and_b32 v123, 0xffff0000, v65
    v_lshlrev_b32 v124, 16, v66
    v_and_b32 v125, 0xffff0000, v66
    v_lshlrev_b32 v126, 16, v67
    v_and_b32 v127, 0xffff0000, v67
    v_add_f32 v96, v96, v120
    v_add_f32 v97, v97, v121
    v_add_f32 v98, v98, v122
    v_add_f32 v99, v99, v123
    v_add_f32 v100, v100, v124
    v_add_f32 v101, v101, v125
    v_add_f32 v102, v102, v126
    v_add_f32 v103, v103, v127
    v_lshlrev_b32 v120, 16, v68
    v_and_b32 v121, 0xffff0000, v68
    v_lshlrev_b32 v122, 16, v69
    v_and_b32 v123, 0xffff0000, v69
    v_lshlrev_b32 v124, 16, v70
    v_and_b32 v125, 0xffff0000, v70
    v_lshlrev_b32 v126, 16, v71
    v_and_b32 v127, 0xffff0000, v71
    v_add_f32 v96, v96, v120
    v_add_f32 v97, v97, v121
    v_add_f32 v98, v98, v122
    v_add_f32 v99, v99, v123
    v_add_f32 v100, v100, v124
    v_add_f32 v101, v101, v125
    v_add_f32 v102, v102, v126
    v_add_f32 v103, v103, v127
    v_lshlrev_b32 v120, 16, v72
    v_and_b32 v121, 0xffff0000, v72
    v_lshlrev_b32 v122, 16, v73
    v_and_b32 v123, 0xffff0000, v73
    v_lshlrev_b32 v124, 16, v74
    v_and_b32 v125, 0xffff0000, v74
    v_lshlrev_b32 v126, 16, v75
    v_and_b32 v127, 0xffff0000, v75
    v_add_f32 v96, v96, v120
    v_add_f32 v97, v97, v121
    v_add_f32 v98, v98, v122
    v_add_f32 v99, v99, v123
    v_add_f32 v100, v100, v124
    v_add_f32 v101, v101, v125
    v_add_f32 v102, v102, v126
    v_add_f32 v103, v103, v127
    v_lshlrev_b32 v120, 16, v76
    v_and_b32 v121, 0xffff0000, v76
    v_lshlrev_b32 v122, 16, v77
    v_and_b32 v123, 0xffff0000, v77
    v_lshlrev_b32 v124, 16, v78
    v_and_b32 v125, 0xffff0000, v78
    v_lshlrev_b32 v126, 16, v79
    v_and_b32 v127, 0xffff0000, v79
    v_add_f32 v96, v96, v120
    v_add_f32 v97, v97, v121
    v_add_f32 v98, v98, v122
    v_add_f32 v99, v99, v123
    v_add_f32 v100, v100, v124
    v_add_f32 v101, v101, v125
    v_add_f32 v102, v102, v126
    v_add_f32 v103, v103, v127
    v_cndmask_b32 v108, v92, v94, s[20:21]
    v_cndmask_b32 v109, v93, v95, s[20:21]
    v_cndmask_b32 v110, v94, v92, s[20:21]
    v_cndmask_b32 v111, v95, v93, s[20:21]
    v_cvt_pk_bf16_f32 v104, v96, v97
    v_lshlrev_b32 v96, 16, v104
    v_and_b32 v97, 0xffff0000, v104
    v_lshlrev_b32 v104, 16, v84
    v_and_b32 v105, 0xffff0000, v84
    v_mul_f32 v96, v96, v104
    v_mul_f32 v97, v97, v105
    v_cvt_pk_bf16_f32 v104, v96, v97
    v_lshlrev_b32 v96, 16, v104
    v_and_b32 v97, 0xffff0000, v104
    v_lshlrev_b32 v104, 16, v108
    v_and_b32 v105, 0xffff0000, v108
    v_add_f32 v96, v96, v104
    v_add_f32 v97, v97, v105
    v_cvt_pk_bf16_f32 v112, v96, v97
    v_cvt_pk_bf16_f32 v104, v98, v99
    v_lshlrev_b32 v98, 16, v104
    v_and_b32 v99, 0xffff0000, v104
    v_lshlrev_b32 v104, 16, v85
    v_and_b32 v105, 0xffff0000, v85
    v_mul_f32 v98, v98, v104
    v_mul_f32 v99, v99, v105
    v_cvt_pk_bf16_f32 v104, v98, v99
    v_lshlrev_b32 v98, 16, v104
    v_and_b32 v99, 0xffff0000, v104
    v_lshlrev_b32 v104, 16, v109
    v_and_b32 v105, 0xffff0000, v109
    v_add_f32 v98, v98, v104
    v_add_f32 v99, v99, v105
    v_cvt_pk_bf16_f32 v113, v98, v99
    v_cvt_pk_bf16_f32 v104, v100, v101
    v_lshlrev_b32 v100, 16, v104
    v_and_b32 v101, 0xffff0000, v104
    v_lshlrev_b32 v104, 16, v86
    v_and_b32 v105, 0xffff0000, v86
    v_mul_f32 v100, v100, v104
    v_mul_f32 v101, v101, v105
    v_cvt_pk_bf16_f32 v104, v100, v101
    v_lshlrev_b32 v100, 16, v104
    v_and_b32 v101, 0xffff0000, v104
    v_lshlrev_b32 v104, 16, v110
    v_and_b32 v105, 0xffff0000, v110
    v_add_f32 v100, v100, v104
    v_add_f32 v101, v101, v105
    v_cvt_pk_bf16_f32 v114, v100, v101
    v_cvt_pk_bf16_f32 v104, v102, v103
    v_lshlrev_b32 v102, 16, v104
    v_and_b32 v103, 0xffff0000, v104
    v_lshlrev_b32 v104, 16, v87
    v_and_b32 v105, 0xffff0000, v87
    v_mul_f32 v102, v102, v104
    v_mul_f32 v103, v103, v105
    v_cvt_pk_bf16_f32 v104, v102, v103
    v_lshlrev_b32 v102, 16, v104
    v_and_b32 v103, 0xffff0000, v104
    v_lshlrev_b32 v104, 16, v111
    v_and_b32 v105, 0xffff0000, v111
    v_add_f32 v102, v102, v104
    v_add_f32 v103, v103, v105
    v_cvt_pk_bf16_f32 v115, v102, v103
    v_cndmask_b32 v132, v112, v114, s[20:21]
    v_cndmask_b32 v133, v113, v115, s[20:21]
    v_cndmask_b32 v134, v114, v112, s[20:21]
    v_cndmask_b32 v135, v115, v113, s[20:21]
    buffer_store_dwordx4 v[132:135], v4, s[12:15], s18 offen offset:64
    s_add_u32 s24, s24, 32
    s_cmp_lt_u32 s24, 61
    s_cbranch_scc1 fin_job
    s_cmp_ge_u32 s63, 48
    s_cbranch_scc1 k_end
    s_lshr_b32 s24, s63, 4
    s_sub_u32 s24, 63, s24
    s_and_b32 s25, s63, 15
    s_lshl_b32 s25, s25, 2
    s_and_b32 s26, s3, 3
    s_add_u32 s25, s25, s26
    s_lshr_b32 s26, s25, 5
    s_and_b32 s25, s25, 31
    s_lshl_b32 s16, s24, 1
    s_add_u32 s16, s16, s26
    s_lshl_b32 s18, s16, 15
    s_lshl_b32 s17, s25, 10
    s_add_u32 s17, s17, s18
    s_lshl_b32 s19, s25, 6
    s_add_u32 s18, s18, s19
    s_add_u32 s22, s17, 167772160
    s_add_u32 s23, s17, 75497472
    s_mov_b32 s27, 218106816
    s_mov_b32 s30, 218112000
    s_mov_b32 s28, 65536
    v_and_b32 v8, 7, v1
    v_lshlrev_b32 v8, 22, v8
    s_cmp_lg_u32 s3, 0
    s_cbranch_scc1 ft_ok
ft_wd:
    buffer_load_dword v7, off, s[4:7], s27 sc1
    s_waitcnt vmcnt(0)
    v_readfirstlane_b32 s31, v7
    s_cmp_ge_u32 s31, 16
    s_cbranch_scc1 ft_ws
    s_sleep 127
    s_sub_u32 s28, s28, 1
    s_cbranch_scc0 ft_wd
    s_mov_b32 s28, 0
ft_ws:
    buffer_load_dword v7, v6, s[4:7], s30 offen sc1
    s_waitcnt vmcnt(0)
    v_cmp_gt_u32 vcc, 61, v7
    s_cbranch_vccz ft_ok
    s_sleep 12
    v_cmp_gt_u32 vcc, 59, v7
    s_cbranch_vccz ft_wsf
    s_sleep 64
    v_cmp_gt_u32 vcc, 56, v7
    s_cbranch_vccz ft_wsf
    s_sleep 127
    s_sleep 127
ft_wsf:
    s_sub_u32 s28, s28, 1
    s_cbranch_scc0 ft_ws
    s_mov_b32 s28, 0
ft_ok:
    s_barrier
    s_cmp_ge_u32 s3, 4
    s_cbranch_scc1 k_end
    buffer_load_dwordx4 v[88:91], v4, s[8:11], s18 offen
    buffer_load_dwordx4 v[144:147], v3, s[4:7], s22 offen offset:0 sc1
    s_add_u32 s22, s22, 4194304
    buffer_load_dwordx4 v[148:151], v3, s[4:7], s22 offen offset:0 sc1
    s_add_u32 s22, s22, 4194304
    buffer_load_dwordx4 v[152:155], v3, s[4:7], s22 offen offset:0 sc1
    s_add_u32 s22, s22, 4194304
    buffer_load_dwordx4 v[156:159], v3, s[4:7], s22 offen offset:0 sc1
    s_waitcnt vmcnt(0)
    v_lshlrev_b32 v96, 16, v144
    v_and_b32 v97, 0xffff0000, v144
    v_lshlrev_b32 v98, 16, v145
    v_and_b32 v99, 0xffff0000, v145
    v_lshlrev_b32 v100, 16, v146
    v_and_b32 v101, 0xffff0000, v146
    v_lshlrev_b32 v102, 16, v147
    v_and_b32 v103, 0xffff0000, v147
    v_lshlrev_b32 v120, 16, v148
    v_and_b32 v121, 0xffff0000, v148
    v_lshlrev_b32 v122, 16, v149
    v_and_b32 v123, 0xffff0000, v149
    v_lshlrev_b32 v124, 16, v150
    v_and_b32 v125, 0xffff0000, v150
    v_lshlrev_b32 v126, 16, v151
    v_and_b32 v127, 0xffff0000, v151
    v_add_f32 v96, v96, v120
    v_add_f32 v97, v97, v121
    v_add_f32 v98, v98, v122
    v_add_f32 v99, v99, v123
    v_add_f32 v100, v100, v124
    v_add_f32 v101, v101, v125
    v_add_f32 v102, v102, v126
    v_add_f32 v103, v103, v127
    v_lshlrev_b32 v120, 16, v152
    v_and_b32 v121, 0xffff0000, v152
    v_lshlrev_b32 v122, 16, v153
    v_and_b32 v123, 0xffff0000, v153
    v_lshlrev_b32 v124, 16, v154
    v_and_b32 v125, 0xffff0000, v154
    v_lshlrev_b32 v126, 16, v155
    v_and_b32 v127, 0xffff0000, v155
    v_add_f32 v96, v96, v120
    v_add_f32 v97, v97, v121
    v_add_f32 v98, v98, v122
    v_add_f32 v99, v99, v123
    v_add_f32 v100, v100, v124
    v_add_f32 v101, v101, v125
    v_add_f32 v102, v102, v126
    v_add_f32 v103, v103, v127
    v_lshlrev_b32 v120, 16, v156
    v_and_b32 v121, 0xffff0000, v156
    v_lshlrev_b32 v122, 16, v157
    v_and_b32 v123, 0xffff0000, v157
    v_lshlrev_b32 v124, 16, v158
    v_and_b32 v125, 0xffff0000, v158
    v_lshlrev_b32 v126, 16, v159
    v_and_b32 v127, 0xffff0000, v159
    v_add_f32 v96, v96, v120
    v_add_f32 v97, v97, v121
    v_add_f32 v98, v98, v122
    v_add_f32 v99, v99, v123
    v_add_f32 v100, v100, v124
    v_add_f32 v101, v101, v125
    v_add_f32 v102, v102, v126
    v_add_f32 v103, v103, v127
    v_cvt_pk_bf16_f32 v120, v96, v97
    v_cvt_pk_bf16_f32 v121, v98, v99
    v_cvt_pk_bf16_f32 v122, v100, v101
    v_cvt_pk_bf16_f32 v123, v102, v103
    v_lshlrev_b32 v96, 16, v120
    v_and_b32 v97, 0xffff0000, v120
    v_lshlrev_b32 v98, 16, v121
    v_and_b32 v99, 0xffff0000, v121
    v_lshlrev_b32 v100, 16, v122
    v_and_b32 v101, 0xffff0000, v122
    v_lshlrev_b32 v102, 16, v123
    v_and_b32 v103, 0xffff0000, v123
    v_mul_f32 v104, 0xbfb8aa3b, v96
    v_mul_f32 v105, 0xbfb8aa3b, v97
    v_mul_f32 v106, 0xbfb8aa3b, v98
    v_mul_f32 v107, 0xbfb8aa3b, v99
    v_mul_f32 v108, 0xbfb8aa3b, v100
    v_mul_f32 v109, 0xbfb8aa3b, v101
    v_mul_f32 v110, 0xbfb8aa3b, v102
    v_mul_f32 v111, 0xbfb8aa3b, v103
    v_exp_f32 v104, v104
    v_exp_f32 v105, v105
    v_exp_f32 v106, v106
    v_exp_f32 v107, v107
    v_exp_f32 v108, v108
    v_exp_f32 v109, v109
    v_exp_f32 v110, v110
    v_exp_f32 v111, v111
    v_add_f32 v104, 1.0, v104
    v_add_f32 v105, 1.0, v105
    v_add_f32 v106, 1.0, v106
    v_add_f32 v107, 1.0, v107
    v_add_f32 v108, 1.0, v108
    v_add_f32 v109, 1.0, v109
    v_add_f32 v110, 1.0, v110
    v_add_f32 v111, 1.0, v111
    v_rcp_f32 v104, v104
    v_rcp_f32 v105, v105
    v_rcp_f32 v106, v106
    v_rcp_f32 v107, v107
    v_rcp_f32 v108, v108
    v_rcp_f32 v109, v109
    v_rcp_f32 v110, v110
    v_rcp_f32 v111, v111
    v_mul_f32 v96, v96, v104
    v_mul_f32 v97, v97, v105
    v_mul_f32 v98, v98, v106
    v_mul_f32 v99, v99, v107
    v_mul_f32 v100, v100, v108
    v_mul_f32 v101, v101, v109
    v_mul_f32 v102, v102, v110
    v_mul_f32 v103, v103, v111
    v_cvt_pk_bf16_f32 v80, v96, v97
    v_cvt_pk_bf16_f32 v81, v98, v99
    v_cvt_pk_bf16_f32 v82, v100, v101
    v_cvt_pk_bf16_f32 v83, v102, v103
    s_cmp_eq_u32 s24, 63
    s_cbranch_scc1 ft_p63
ft_p:
    buffer_load_dword v7, v8, s[4:7], s23 offen offset:1020 sc1
    s_waitcnt vmcnt(0)
    v_cmp_eq_u32 vcc, -1, v7
    s_cbranch_vccz ft_l
    s_sleep 4
    s_sub_u32 s28, s28, 1
    s_cbranch_scc0 ft_p
    s_mov_b32 s28, 0
ft_l:
    s_mov_b32 s31, s23
    buffer_load_dwordx4 v[16:19], v3, s[4:7], s31 offen sc1
    s_add_u32 s31, s31, 4194304
    buffer_load_dwordx4 v[20:23], v3, s[4:7], s31 offen sc1
    s_add_u32 s31, s31, 4194304
    buffer_load_dwordx4 v[24:27], v3, s[4:7], s31 offen sc1
    s_add_u32 s31, s31, 4194304
    buffer_load_dwordx4 v[28:31], v3, s[4:7], s31 offen sc1
    s_add_u32 s31, s31, 4194304
    buffer_load_dwordx4 v[32:35], v3, s[4:7], s31 offen sc1
    s_add_u32 s31, s31, 4194304
    buffer_load_dwordx4 v[36:39], v3, s[4:7], s31 offen sc1
    s_add_u32 s31, s31, 4194304
    buffer_load_dwordx4 v[40:43], v3, s[4:7], s31 offen sc1
    s_add_u32 s31, s31, 4194304
    buffer_load_dwordx4 v[44:47], v3, s[4:7], s31 offen sc1
    s_waitcnt vmcnt(0)
    v_max3_u32 v7, v16, v17, v18
    v_max3_u32 v7, v7, v19, v20
    v_max3_u32 v7, v7, v21, v22
    v_max3_u32 v7, v7, v23, v24
    v_max3_u32 v7, v7, v25, v26
    v_max3_u32 v7, v7, v27, v28
    v_max3_u32 v7, v7, v29, v30
    v_max3_u32 v7, v7, v31, v32
    v_max3_u32 v7, v7, v33, v34
    v_max3_u32 v7, v7, v35, v36
    v_max3_u32 v7, v7, v37, v38
    v_max3_u32 v7, v7, v39, v40
    v_max3_u32 v7, v7, v41, v42
    v_max3_u32 v7, v7, v43, v44
    v_max3_u32 v7, v7, v45, v46
    v_max_u32 v7, v7, v47
    v_cmp_eq_u32 vcc, -1, v7
    s_cbranch_vccz ft_go
    s_sleep 2
    s_sub_u32 s28, s28, 1
    s_cbranch_scc0 ft_l
    s_branch ft_go
ft_p63:
    s_sub_u32 s31, s23, 65536
    buffer_load_dword v7, v8, s[4:7], s31 offen offset:1020 sc1
    s_waitcnt vmcnt(0)
    v_cmp_eq_u32 vcc, -1, v7
    s_cbranch_vccz ft_l
    s_sleep 4
    s_sub_u32 s28, s28, 1
    s_cbranch_scc0 ft_p63
    s_mov_b32 s28, 0
    s_branch ft_l
ft_go:
    v_lshlrev_b32 v96, 16, v16
    v_and_b32 v97, 0xffff0000, v16
    v_lshlrev_b32 v98, 16, v17
    v_and_b32 v99, 0xffff0000, v17
    v_lshlrev_b32 v100, 16, v18
    v_and_b32 v101, 0xffff0000, v18
    v_lshlrev_b32 v102, 16, v19
    v_and_b32 v103, 0xffff0000, v19
    v_lshlrev_b32 v120, 16, v20
    v_and_b32 v121, 0xffff0000, v20
    v_lshlrev_b32 v122, 16, v21
    v_and_b32 v123, 0xffff0000, v21
    v_lshlrev_b32 v124, 16, v22
    v_and_b32 v125, 0xffff0000, v22
    v_lshlrev_b32 v126, 16, v23
    v_and_b32 v127, 0xffff0000, v23
    v_add_f32 v96, v96, v120
    v_add_f32 v97, v97, v121
    v_add_f32 v98, v98, v122
    v_add_f32 v99, v99, v123
    v_add_f32 v100, v100, v124
    v_add_f32 v101, v101, v125
    v_add_f32 v102, v102, v126
    v_add_f32 v103, v103, v127
    v_lshlrev_b32 v120, 16, v24
    v_and_b32 v121, 0xffff0000, v24
    v_lshlrev_b32 v122, 16, v25
    v_and_b32 v123, 0xffff0000, v25
    v_lshlrev_b32 v124, 16, v26
    v_and_b32 v125, 0xffff0000, v26
    v_lshlrev_b32 v126, 16, v27
    v_and_b32 v127, 0xffff0000, v27
    v_add_f32 v96, v96, v120
    v_add_f32 v97, v97, v121
    v_add_f32 v98, v98, v122
    v_add_f32 v99, v99, v123
    v_add_f32 v100, v100, v124
    v_add_f32 v101, v101, v125
    v_add_f32 v102, v102, v126
    v_add_f32 v103, v103, v127
    v_lshlrev_b32 v120, 16, v28
    v_and_b32 v121, 0xffff0000, v28
    v_lshlrev_b32 v122, 16, v29
    v_and_b32 v123, 0xffff0000, v29
    v_lshlrev_b32 v124, 16, v30
    v_and_b32 v125, 0xffff0000, v30
    v_lshlrev_b32 v126, 16, v31
    v_and_b32 v127, 0xffff0000, v31
    v_add_f32 v96, v96, v120
    v_add_f32 v97, v97, v121
    v_add_f32 v98, v98, v122
    v_add_f32 v99, v99, v123
    v_add_f32 v100, v100, v124
    v_add_f32 v101, v101, v125
    v_add_f32 v102, v102, v126
    v_add_f32 v103, v103, v127
    v_lshlrev_b32 v120, 16, v32
    v_and_b32 v121, 0xffff0000, v32
    v_lshlrev_b32 v122, 16, v33
    v_and_b32 v123, 0xffff0000, v33
    v_lshlrev_b32 v124, 16, v34
    v_and_b32 v125, 0xffff0000, v34
    v_lshlrev_b32 v126, 16, v35
    v_and_b32 v127, 0xffff0000, v35
    v_add_f32 v96, v96, v120
    v_add_f32 v97, v97, v121
    v_add_f32 v98, v98, v122
    v_add_f32 v99, v99, v123
    v_add_f32 v100, v100, v124
    v_add_f32 v101, v101, v125
    v_add_f32 v102, v102, v126
    v_add_f32 v103, v103, v127
    v_lshlrev_b32 v120, 16, v36
    v_and_b32 v121, 0xffff0000, v36
    v_lshlrev_b32 v122, 16, v37
    v_and_b32 v123, 0xffff0000, v37
    v_lshlrev_b32 v124, 16, v38
    v_and_b32 v125, 0xffff0000, v38
    v_lshlrev_b32 v126, 16, v39
    v_and_b32 v127, 0xffff0000, v39
    v_add_f32 v96, v96, v120
    v_add_f32 v97, v97, v121
    v_add_f32 v98, v98, v122
    v_add_f32 v99, v99, v123
    v_add_f32 v100, v100, v124
    v_add_f32 v101, v101, v125
    v_add_f32 v102, v102, v126
    v_add_f32 v103, v103, v127
    v_lshlrev_b32 v120, 16, v40
    v_and_b32 v121, 0xffff0000, v40
    v_lshlrev_b32 v122, 16, v41
    v_and_b32 v123, 0xffff0000, v41
    v_lshlrev_b32 v124, 16, v42
    v_and_b32 v125, 0xffff0000, v42
    v_lshlrev_b32 v126, 16, v43
    v_and_b32 v127, 0xffff0000, v43
    v_add_f32 v96, v96, v120
    v_add_f32 v97, v97, v121
    v_add_f32 v98, v98, v122
    v_add_f32 v99, v99, v123
    v_add_f32 v100, v100, v124
    v_add_f32 v101, v101, v125
    v_add_f32 v102, v102, v126
    v_add_f32 v103, v103, v127
    v_lshlrev_b32 v120, 16, v44
    v_and_b32 v121, 0xffff0000, v44
    v_lshlrev_b32 v122, 16, v45
    v_and_b32 v123, 0xffff0000, v45
    v_lshlrev_b32 v124, 16, v46
    v_and_b32 v125, 0xffff0000, v46
    v_lshlrev_b32 v126, 16, v47
    v_and_b32 v127, 0xffff0000, v47
    v_add_f32 v96, v96, v120
    v_add_f32 v97, v97, v121
    v_add_f32 v98, v98, v122
    v_add_f32 v99, v99, v123
    v_add_f32 v100, v100, v124
    v_add_f32 v101, v101, v125
    v_add_f32 v102, v102, v126
    v_add_f32 v103, v103, v127
    v_cndmask_b32 v108, v88, v90, s[20:21]
    v_cndmask_b32 v109, v89, v91, s[20:21]
    v_cndmask_b32 v110, v90, v88, s[20:21]
    v_cndmask_b32 v111, v91, v89, s[20:21]
    v_cvt_pk_bf16_f32 v104, v96, v97
    v_lshlrev_b32 v96, 16, v104
    v_and_b32 v97, 0xffff0000, v104
    v_lshlrev_b32 v104, 16, v80
    v_and_b32 v105, 0xffff0000, v80
    v_mul_f32 v96, v96, v104
    v_mul_f32 v97, v97, v105
    v_cvt_pk_bf16_f32 v104, v96, v97
    v_lshlrev_b32 v96, 16, v104
    v_and_b32 v97, 0xffff0000, v104
    v_lshlrev_b32 v104, 16, v108
    v_and_b32 v105, 0xffff0000, v108
    v_add_f32 v96, v96, v104
    v_add_f32 v97, v97, v105
    v_cvt_pk_bf16_f32 v112, v96, v97
    v_cvt_pk_bf16_f32 v104, v98, v99
    v_lshlrev_b32 v98, 16, v104
    v_and_b32 v99, 0xffff0000, v104
    v_lshlrev_b32 v104, 16, v81
    v_and_b32 v105, 0xffff0000, v81
    v_mul_f32 v98, v98, v104
    v_mul_f32 v99, v99, v105
    v_cvt_pk_bf16_f32 v104, v98, v99
    v_lshlrev_b32 v98, 16, v104
    v_and_b32 v99, 0xffff0000, v104
    v_lshlrev_b32 v104, 16, v109
    v_and_b32 v105, 0xffff0000, v109
    v_add_f32 v98, v98, v104
    v_add_f32 v99, v99, v105
    v_cvt_pk_bf16_f32 v113, v98, v99
    v_cvt_pk_bf16_f32 v104, v100, v101
    v_lshlrev_b32 v100, 16, v104
    v_and_b32 v101, 0xffff0000, v104
    v_lshlrev_b32 v104, 16, v82
    v_and_b32 v105, 0xffff0000, v82
    v_mul_f32 v100, v100, v104
    v_mul_f32 v101, v101, v105
    v_cvt_pk_bf16_f32 v104, v100, v101
    v_lshlrev_b32 v100, 16, v104
    v_and_b32 v101, 0xffff0000, v104
    v_lshlrev_b32 v104, 16, v110
    v_and_b32 v105, 0xffff0000, v110
    v_add_f32 v100, v100, v104
    v_add_f32 v101, v101, v105
    v_cvt_pk_bf16_f32 v114, v100, v101
    v_cvt_pk_bf16_f32 v104, v102, v103
    v_lshlrev_b32 v102, 16, v104
    v_and_b32 v103, 0xffff0000, v104
    v_lshlrev_b32 v104, 16, v83
    v_and_b32 v105, 0xffff0000, v83
    v_mul_f32 v102, v102, v104
    v_mul_f32 v103, v103, v105
    v_cvt_pk_bf16_f32 v104, v102, v103
    v_lshlrev_b32 v102, 16, v104
    v_and_b32 v103, 0xffff0000, v104
    v_lshlrev_b32 v104, 16, v111
    v_and_b32 v105, 0xffff0000, v111
    v_add_f32 v102, v102, v104
    v_add_f32 v103, v103, v105
    v_cvt_pk_bf16_f32 v115, v102, v103
    v_cndmask_b32 v128, v112, v114, s[20:21]
    v_cndmask_b32 v129, v113, v115, s[20:21]
    v_cndmask_b32 v130, v114, v112, s[20:21]
    v_cndmask_b32 v131, v115, v113, s[20:21]
    buffer_store_dwordx4 v[128:131], v4, s[12:15], s18 offen offset:0
    s_branch k_end
chain_map:
    s_and_b32 s14, s12, 1
    s_lshl_b32 s13, s13, 1
    s_lshr_b32 s15, s12, 1
    s_add_u32 s12, s13, s14
    s_mov_b32 s13, s15
    s_lshl_b32 s2, s13, 3
    s_add_u32 s2, s2, s12
    s_lshr_b32 s14, s13, 2
    s_and_b32 s15, s13, 3
    s_mov_b32 s16, 0
    s_mov_b32 s17, 209715200
    s_mov_b32 s18, 209977344
    s_mov_b32 s19, 210239488
    s_mov_b32 s20, 210501632
    s_mov_b32 s26, 131072
    s_mov_b32 s68, 0
    s_getreg_b32 s29, hwreg(HW_REG_XCC_ID)
    s_and_b32 s29, s29, 15
    s_mul_i32 s23, s29, s29
    s_lshl_b32 s23, s23, 18
    s_lshl_b32 s29, s29, 8
    s_add_u32 s29, s29, s23
    s_add_u32 s29, s29, 1
    s_lshr_b32 s28, s12, 1
    s_lshl_b32 s28, s28, 2
    s_add_u32 s28, s28, 128
    s_cmp_ge_u32 s3, 4
    s_cbranch_scc1 ch_a_pro
    s_lshl_b32 s32, s12, 15
    s_lshl_b32 s21, s14, 13
    s_add_u32 s32, s32, s21
    s_lshl_b32 s21, s15, 10
    s_add_u32 s32, s32, s21
    s_add_u32 s32, s32, 2097152
    s_lshr_b32 s33, s12, 1
    s_lshl_b32 s33, s33, 14
    s_add_u32 s33, s33, 1048576
    s_lshl_b32 s21, s13, 10
    s_add_u32 s36, s33, s21
    s_lshl_b32 s21, s3, 12
    s_add_u32 s33, s33, s21
    s_lshl_b32 s34, s13, 14
    s_lshl_b32 s21, s12, 10
    s_add_u32 s35, s34, s21
    s_lshl_b32 s37, s12, 22
    s_lshl_b32 s21, s13, 11
    s_add_u32 s37, s37, s21
    s_and_b32 s21, s3, 1
    s_lshl_b32 s21, s21, 15
    s_add_u32 s37, s37, s21
    s_lshr_b32 s21, s3, 1
    s_lshl_b32 s21, s21, 10
    s_add_u32 s37, s37, s21
    s_add_u32 s37, s37, 75497472
    v_and_b32 v20, 63, v0
    v_lshlrev_b32 v1, 4, v20
    v_mov_b32 v10, -1
    v_mov_b32 v11, -1
    v_lshrrev_b32 v21, 2, v20
    v_and_b32 v22, 3, v20
    v_lshlrev_b32 v21, 13, v21
    v_lshl_add_u32 v21, v22, 4, v21
    s_lshl_b32 s21, s3, 21
    s_lshl_b32 s22, s12, 10
    s_add_u32 s21, s21, s22
    s_lshl_b32 s23, s3, 15
    s_mov_b32 s10, 8388608
    s_mov_b32 s11, 131072
    v_lshrrev_b32 v24, 4, v20
    v_bfe_u32 v25, v20, 2, 2
    v_lshl_add_u32 v24, v24, 4, v25
    v_lshlrev_b32 v24, 6, v24
    v_lshl_add_u32 v24, v22, 3, v24
    v_add_u32 v24, s23, v24
    s_and_b32 s70, s13, 1
    s_lshl_b32 s71, s12, 4
    s_add_u32 s71, s71, s13
    s_cmp_eq_u32 s71, 127
    s_cselect_b32 s70, 1, 0
    s_cmp_eq_u32 s13, 7
    s_cselect_b32 s70, 1, s70
    s_lshl_b32 s72, s70, 20
    s_lshl_b32 s73, s70, 21
    s_lshl_b32 s70, s70, 13
    s_sub_u32 s71, s23, s70
    s_add_u32 s70, s23, s70
    s_load_dwordx2 s[8:9], s[0:1], 16
    s_lshl_b32 s25, s13, 6
    s_add_u32 s24, s21, s25
    s_add_u32 s24, s24, s72
    s_waitcnt lgkmcnt(0)
    s_add_u32 m0, s70, 0
    s_nop 0
    buffer_load_dwordx4 v21, s[8:11], s24 offen lds
    s_add_u32 s24, s24, 131072
    s_add_u32 m0, s70, 1024
    s_nop 0
    buffer_load_dwordx4 v21, s[8:11], s24 offen lds
    s_add_u32 s24, s24, 131072
    s_add_u32 m0, s70, 2048
    s_nop 0
    buffer_load_dwordx4 v21, s[8:11], s24 offen lds
    s_add_u32 s24, s24, 131072
    s_add_u32 m0, s70, 3072
    s_nop 0
    buffer_load_dwordx4 v21, s[8:11], s24 offen lds
    s_add_u32 s24, s24, 131072
    s_add_u32 m0, s70, 4096
    s_nop 0
    buffer_load_dwordx4 v21, s[8:11], s24 offen lds
    s_add_u32 s24, s24, 131072
    s_add_u32 m0, s70, 5120
    s_nop 0
    buffer_load_dwordx4 v21, s[8:11], s24 offen lds
    s_add_u32 s24, s24, 131072
    s_add_u32 m0, s70, 6144
    s_nop 0
    buffer_load_dwordx4 v21, s[8:11], s24 offen lds
    s_add_u32 s24, s24, 131072
    s_add_u32 m0, s70, 7168
    s_nop 0
    buffer_load_dwordx4 v21, s[8:11], s24 offen lds
    s_add_u32 s24, s24, 131072
    s_sub_u32 s24, s24, s73
    s_add_u32 m0, s71, 8192
    s_nop 0
    buffer_load_dwordx4 v21, s[8:11], s24 offen lds
    s_add_u32 s24, s24, 131072
    s_add_u32 m0, s71, 9216
    s_nop 0
    buffer_load_dwordx4 v21, s[8:11], s24 offen lds
    s_add_u32 s24, s24, 131072
    s_add_u32 m0, s71, 10240
    s_nop 0
    buffer_load_dwordx4 v21, s[8:11], s24 offen lds
    s_add_u32 s24, s24, 131072
    s_add_u32 m0, s71, 11264
    s_nop 0
    buffer_load_dwordx4 v21, s[8:11], s24 offen lds
    s_add_u32 s24, s24, 131072
    s_add_u32 m0, s71, 12288
    s_nop 0
    buffer_load_dwordx4 v21, s[8:11], s24 offen lds
    s_add_u32 s24, s24, 131072
    s_add_u32 m0, s71, 13312
    s_nop 0
    buffer_load_dwordx4 v21, s[8:11], s24 offen lds
    s_add_u32 s24, s24, 131072
    s_add_u32 m0, s71, 14336
    s_nop 0
    buffer_load_dwordx4 v21, s[8:11], s24 offen lds
    s_add_u32 s24, s24, 131072
    s_add_u32 m0, s71, 15360
    s_nop 0
    buffer_load_dwordx4 v21, s[8:11], s24 offen lds
    s_add_u32 s24, s24, 131072
    s_load_dwordx2 s[8:9], s[0:1], 24
    s_lshl_b32 s25, s13, 6
    s_add_u32 s24, s21, s25
    s_add_u32 s24, s24, s72
    s_waitcnt lgkmcnt(0)
    s_add_u32 m0, s70, 16384
    s_nop 0
    buffer_load_dwordx4 v21, s[8:11], s24 offen lds
    s_add_u32 s24, s24, 131072
    s_add_u32 m0, s70, 17408
    s_nop 0
    buffer_load_dwordx4 v21, s[8:11], s24 offen lds
    s_add_u32 s24, s24, 131072
    s_add_u32 m0, s70, 18432
    s_nop 0
    buffer_load_dwordx4 v21, s[8:11], s24 offen lds
    s_add_u32 s24, s24, 131072
    s_add_u32 m0, s70, 19456
    s_nop 0
    buffer_load_dwordx4 v21, s[8:11], s24 offen lds
    s_add_u32 s24, s24, 131072
    s_add_u32 m0, s70, 20480
    s_nop 0
    buffer_load_dwordx4 v21, s[8:11], s24 offen lds
    s_add_u32 s24, s24, 131072
    s_add_u32 m0, s70, 21504
    s_nop 0
    buffer_load_dwordx4 v21, s[8:11], s24 offen lds
    s_add_u32 s24, s24, 131072
    s_add_u32 m0, s70, 22528
    s_nop 0
    buffer_load_dwordx4 v21, s[8:11], s24 offen lds
    s_add_u32 s24, s24, 131072
    s_add_u32 m0, s70, 23552
    s_nop 0
    buffer_load_dwordx4 v21, s[8:11], s24 offen lds
    s_add_u32 s24, s24, 131072
    s_sub_u32 s24, s24, s73
    s_add_u32 m0, s71, 24576
    s_nop 0
    buffer_load_dwordx4 v21, s[8:11], s24 offen lds
    s_add_u32 s24, s24, 131072
    s_add_u32 m0, s71, 25600
    s_nop 0
    buffer_load_dwordx4 v21, s[8:11], s24 offen lds
    s_add_u32 s24, s24, 131072
    s_add_u32 m0, s71, 26624
    s_nop 0
    buffer_load_dwordx4 v21, s[8:11], s24 offen lds
    s_add_u32 s24, s24, 131072
    s_add_u32 m0, s71, 27648
    s_nop 0
    buffer_load_dwordx4 v21, s[8:11], s24 offen lds
    s_add_u32 s24, s24, 131072
    s_add_u32 m0, s71, 28672
    s_nop 0
    buffer_load_dwordx4 v21, s[8:11], s24 offen lds
    s_add_u32 s24, s24, 131072
    s_add_u32 m0, s71, 29696
    s_nop 0
    buffer_load_dwordx4 v21, s[8:11], s24 offen lds
    s_add_u32 s24, s24, 131072
    s_add_u32 m0, s71, 30720
    s_nop 0
    buffer_load_dwordx4 v21, s[8:11], s24 offen lds
    s_add_u32 s24, s24, 131072
    s_add_u32 m0, s71, 31744
    s_nop 0
    buffer_load_dwordx4 v21, s[8:11], s24 offen lds
    s_add_u32 s24, s24, 131072
    s_load_dwordx2 s[8:9], s[0:1], 32
    s_lshl_b32 s25, s13, 6
    s_add_u32 s24, s21, s25
    s_add_u32 s24, s24, s72
    s_waitcnt lgkmcnt(0)
    buffer_load_dwordx4 v[96:99], v21, s[8:11], s24 offen
    s_add_u32 s24, s24, 131072
    buffer_load_dwordx4 v[100:103], v21, s[8:11], s24 offen
    s_add_u32 s24, s24, 131072
    buffer_load_dwordx4 v[104:107], v21, s[8:11], s24 offen
    s_add_u32 s24, s24, 131072
    buffer_load_dwordx4 v[108:111], v21, s[8:11], s24 offen
    s_add_u32 s24, s24, 131072
    buffer_load_dwordx4 v[144:147], v21, s[8:11], s24 offen
    s_add_u32 s24, s24, 131072
    buffer_load_dwordx4 v[148:151], v21, s[8:11], s24 offen
    s_add_u32 s24, s24, 131072
    buffer_load_dwordx4 v[152:155], v21, s[8:11], s24 offen
    s_add_u32 s24, s24, 131072
    buffer_load_dwordx4 v[156:159], v21, s[8:11], s24 offen
    s_add_u32 s24, s24, 131072
    s_sub_u32 s24, s24, s73
    buffer_load_dwordx4 v[192:195], v21, s[8:11], s24 offen
    s_add_u32 s24, s24, 131072
    buffer_load_dwordx4 v[196:199], v21, s[8:11], s24 offen
    s_add_u32 s24, s24, 131072
    buffer_load_dwordx4 v[200:203], v21, s[8:11], s24 offen
    s_add_u32 s24, s24, 131072
    buffer_load_dwordx4 v[204:207], v21, s[8:11], s24 offen
    s_add_u32 s24, s24, 131072
    buffer_load_dwordx4 v[240:243], v21, s[8:11], s24 offen
    s_add_u32 s24, s24, 131072
    buffer_load_dwordx4 v[244:247], v21, s[8:11], s24 offen
    s_add_u32 s24, s24, 131072
    buffer_load_dwordx4 v[248:251], v21, s[8:11], s24 offen
    s_add_u32 s24, s24, 131072
    buffer_load_dwordx4 v[252:255], v21, s[8:11], s24 offen
    s_add_u32 s24, s24, 131072
    s_load_dwordx2 s[8:9], s[0:1], 8
    s_mov_b32 s10, 16384
    v_bfe_u32 v57, v20, 4, 1
    v_lshrrev_b32 v58, 5, v20
    v_and_b32 v59, 1, v20
    v_bfe_u32 v60, v20, 1, 3
    v_lshlrev_b32 v60, 11, v60
    v_lshl_add_u32 v60, v57, 6, v60
    v_lshl_add_u32 v60, v58, 4, v60
    v_lshl_add_u32 v15, v59, 2, v60
    s_lshl_b32 s24, s3, 9
    s_waitcnt lgkmcnt(0)
    buffer_load_dword v32, v15, s[8:11], s24 offen offset:0
    buffer_load_dword v33, v15, s[8:11], s24 offen offset:8
    buffer_load_dword v34, v15, s[8:11], s24 offen offset:32
    buffer_load_dword v35, v15, s[8:11], s24 offen offset:40
    buffer_load_dword v36, v15, s[8:11], s24 offen offset:128
    buffer_load_dword v37, v15, s[8:11], s24 offen offset:136
    buffer_load_dword v38, v15, s[8:11], s24 offen offset:160
    buffer_load_dword v39, v15, s[8:11], s24 offen offset:168
    buffer_load_dword v40, v15, s[8:11], s24 offen offset:256
    buffer_load_dword v41, v15, s[8:11], s24 offen offset:264
    buffer_load_dword v42, v15, s[8:11], s24 offen offset:288
    buffer_load_dword v43, v15, s[8:11], s24 offen offset:296
    buffer_load_dword v44, v15, s[8:11], s24 offen offset:384
    buffer_load_dword v45, v15, s[8:11], s24 offen offset:392
    buffer_load_dword v46, v15, s[8:11], s24 offen offset:416
    buffer_load_dword v47, v15, s[8:11], s24 offen offset:424
    s_barrier
    v_add_u32 v56, s70, v1
    s_add_u32 s71, s71, 8192
    v_add_u32 v26, s71, v1
    s_waitcnt vmcnt(48)
    ds_read_b64_tr_b16 v[64:65], v24 offset:0
    ds_read_b64_tr_b16 v[66:67], v24 offset:256
    ds_read_b64_tr_b16 v[68:69], v24 offset:512
    ds_read_b64_tr_b16 v[70:71], v24 offset:768
    ds_read_b64_tr_b16 v[72:73], v24 offset:32
    ds_read_b64_tr_b16 v[74:75], v24 offset:288
    ds_read_b64_tr_b16 v[76:77], v24 offset:544
    ds_read_b64_tr_b16 v[78:79], v24 offset:800
    s_waitcnt lgkmcnt(0)
    ds_read_b64_tr_b16 v[112:113], v24 offset:4096
    ds_read_b64_tr_b16 v[114:115], v24 offset:4352
    ds_read_b64_tr_b16 v[116:117], v24 offset:4608
    ds_read_b64_tr_b16 v[118:119], v24 offset:4864
    ds_read_b64_tr_b16 v[120:121], v24 offset:4128
    ds_read_b64_tr_b16 v[122:123], v24 offset:4384
    ds_read_b64_tr_b16 v[124:125], v24 offset:4640
    ds_read_b64_tr_b16 v[126:127], v24 offset:4896
    s_waitcnt lgkmcnt(0)
    ds_read_b64_tr_b16 v[160:161], v24 offset:8192
    ds_read_b64_tr_b16 v[162:163], v24 offset:8448
    ds_read_b64_tr_b16 v[164:165], v24 offset:8704
    ds_read_b64_tr_b16 v[166:167], v24 offset:8960
    ds_read_b64_tr_b16 v[168:169], v24 offset:8224
    ds_read_b64_tr_b16 v[170:171], v24 offset:8480
    ds_read_b64_tr_b16 v[172:173], v24 offset:8736
    ds_read_b64_tr_b16 v[174:175], v24 offset:8992
    s_waitcnt lgkmcnt(0)
    ds_read_b64_tr_b16 v[208:209], v24 offset:12288
    ds_read_b64_tr_b16 v[210:211], v24 offset:12544
    ds_read_b64_tr_b16 v[212:213], v24 offset:12800
    ds_read_b64_tr_b16 v[214:215], v24 offset:13056
    ds_read_b64_tr_b16 v[216:217], v24 offset:12320
    ds_read_b64_tr_b16 v[218:219], v24 offset:12576
    ds_read_b64_tr_b16 v[220:221], v24 offset:12832
    ds_read_b64_tr_b16 v[222:223], v24 offset:13088
    s_waitcnt lgkmcnt(0)
    s_waitcnt vmcnt(32)
    ds_read_b64_tr_b16 v[80:81], v24 offset:16384
    ds_read_b64_tr_b16 v[82:83], v24 offset:16640
    ds_read_b64_tr_b16 v[84:85], v24 offset:16896
    ds_read_b64_tr_b16 v[86:87], v24 offset:17152
    ds_read_b64_tr_b16 v[88:89], v24 offset:16416
    ds_read_b64_tr_b16 v[90:91], v24 offset:16672
    ds_read_b64_tr_b16 v[92:93], v24 offset:16928
    ds_read_b64_tr_b16 v[94:95], v24 offset:17184
    s_waitcnt lgkmcnt(0)
    ds_read_b64_tr_b16 v[128:129], v24 offset:20480
    ds_read_b64_tr_b16 v[130:131], v24 offset:20736
    ds_read_b64_tr_b16 v[132:133], v24 offset:20992
    ds_read_b64_tr_b16 v[134:135], v24 offset:21248
    ds_read_b64_tr_b16 v[136:137], v24 offset:20512
    ds_read_b64_tr_b16 v[138:139], v24 offset:20768
    ds_read_b64_tr_b16 v[140:141], v24 offset:21024
    ds_read_b64_tr_b16 v[142:143], v24 offset:21280
    s_waitcnt lgkmcnt(0)
    ds_read_b64_tr_b16 v[176:177], v24 offset:24576
    ds_read_b64_tr_b16 v[178:179], v24 offset:24832
    ds_read_b64_tr_b16 v[180:181], v24 offset:25088
    ds_read_b64_tr_b16 v[182:183], v24 offset:25344
    ds_read_b64_tr_b16 v[184:185], v24 offset:24608
    ds_read_b64_tr_b16 v[186:187], v24 offset:24864
    ds_read_b64_tr_b16 v[188:189], v24 offset:25120
    ds_read_b64_tr_b16 v[190:191], v24 offset:25376
    s_waitcnt lgkmcnt(0)
    ds_read_b64_tr_b16 v[224:225], v24 offset:28672
    ds_read_b64_tr_b16 v[226:227], v24 offset:28928
    ds_read_b64_tr_b16 v[228:229], v24 offset:29184
    ds_read_b64_tr_b16 v[230:231], v24 offset:29440
    ds_read_b64_tr_b16 v[232:233], v24 offset:28704
    ds_read_b64_tr_b16 v[234:235], v24 offset:28960
    ds_read_b64_tr_b16 v[236:237], v24 offset:29216
    ds_read_b64_tr_b16 v[238:239], v24 offset:29472
    s_waitcnt lgkmcnt(0)
    s_waitcnt vmcnt(16)
    ds_write_b128 v56, v[96:99] offset:0
    ds_write_b128 v56, v[100:103] offset:1024
    ds_write_b128 v56, v[104:107] offset:2048
    ds_write_b128 v56, v[108:111] offset:3072
    ds_write_b128 v56, v[144:147] offset:4096
    ds_write_b128 v56, v[148:151] offset:5120
    ds_write_b128 v56, v[152:155] offset:6144
    ds_write_b128 v56, v[156:159] offset:7168
    ds_write_b128 v26, v[192:195] offset:0
    ds_write_b128 v26, v[196:199] offset:1024
    ds_write_b128 v26, v[200:203] offset:2048
    ds_write_b128 v26, v[204:207] offset:3072
    ds_write_b128 v26, v[240:243] offset:4096
    ds_write_b128 v26, v[244:247] offset:5120
    ds_write_b128 v26, v[248:251] offset:6144
    ds_write_b128 v26, v[252:255] offset:7168
    s_waitcnt lgkmcnt(0)
    ds_read_b64_tr_b16 v[96:97], v24 offset:0
    ds_read_b64_tr_b16 v[98:99], v24 offset:256
    ds_read_b64_tr_b16 v[100:101], v24 offset:512
    ds_read_b64_tr_b16 v[102:103], v24 offset:768
    ds_read_b64_tr_b16 v[104:105], v24 offset:32
    ds_read_b64_tr_b16 v[106:107], v24 offset:288
    ds_read_b64_tr_b16 v[108:109], v24 offset:544
    ds_read_b64_tr_b16 v[110:111], v24 offset:800
    s_waitcnt lgkmcnt(0)
    ds_read_b64_tr_b16 v[144:145], v24 offset:4096
    ds_read_b64_tr_b16 v[146:147], v24 offset:4352
    ds_read_b64_tr_b16 v[148:149], v24 offset:4608
    ds_read_b64_tr_b16 v[150:151], v24 offset:4864
    ds_read_b64_tr_b16 v[152:153], v24 offset:4128
    ds_read_b64_tr_b16 v[154:155], v24 offset:4384
    ds_read_b64_tr_b16 v[156:157], v24 offset:4640
    ds_read_b64_tr_b16 v[158:159], v24 offset:4896
    s_waitcnt lgkmcnt(0)
    ds_read_b64_tr_b16 v[192:193], v24 offset:8192
    ds_read_b64_tr_b16 v[194:195], v24 offset:8448
    ds_read_b64_tr_b16 v[196:197], v24 offset:8704
    ds_read_b64_tr_b16 v[198:199], v24 offset:8960
    ds_read_b64_tr_b16 v[200:201], v24 offset:8224
    ds_read_b64_tr_b16 v[202:203], v24 offset:8480
    ds_read_b64_tr_b16 v[204:205], v24 offset:8736
    ds_read_b64_tr_b16 v[206:207], v24 offset:8992
    s_waitcnt lgkmcnt(0)
    ds_read_b64_tr_b16 v[240:241], v24 offset:12288
    ds_read_b64_tr_b16 v[242:243], v24 offset:12544
    ds_read_b64_tr_b16 v[244:245], v24 offset:12800
    ds_read_b64_tr_b16 v[246:247], v24 offset:13056
    ds_read_b64_tr_b16 v[248:249], v24 offset:12320
    ds_read_b64_tr_b16 v[250:251], v24 offset:12576
    ds_read_b64_tr_b16 v[252:253], v24 offset:12832
    ds_read_b64_tr_b16 v[254:255], v24 offset:13088
    s_waitcnt lgkmcnt(0)
    v_mov_b32 v21, 0x44444444
    v_mov_b32 v22, 0xeeeeeeee
    v_and_b32 v23, 1, v20
    v_cmp_eq_u32 vcc, 0, v23
    v_and_b32 v27, 255, v0
    v_lshlrev_b32 v2, 2, v27
    v_cndmask_b32 v62, v22, v21, vcc
    s_lshr_b32 s21, s15, 1
    s_sub_u32 s21, s21, s15
    s_add_u32 s21, s21, 4
    s_lshl_b32 s21, s21, 10
    s_and_b32 s22, s15, 1
    s_lshl_b32 s22, s22, 9
    s_add_u32 s21, s21, s22
    s_mov_b32 s28, s21
    s_and_b32 s62, s12, 1
    s_lshl_b32 s62, s62, 9
    s_add_u32 s62, s62, s36
    s_sub_u32 s62, s62, 512
    s_lshl_b32 s22, s3, 7
    s_add_u32 s21, s21, s22
    v_and_b32 v21, 31, v20
    v_lshlrev_b32 v21, 2, v21
    v_add_u32 v3, s21, v21
    v_lshrrev_b32 v21, 4, v20
    v_and_b32 v22, 15, v20
    v_mul_u32_u24 v21, 208, v21
    v_add_lshl_u32 v21, v21, v22, 2
    s_mul_i32 s21, s3, 3328
    v_add_u32 v4, s21, v21
    v_lshrrev_b32 v21, 4, v20
    v_bfe_u32 v22, v20, 2, 1
    v_lshl_add_u32 v21, v21, 1, v22
    v_mul_u32_u24 v21, 104, v21
    v_bfe_u32 v22, v20, 3, 1
    v_xor_b32 v22, 1, v22
    v_lshl_add_u32 v21, v22, 5, v21
    v_and_b32 v22, 3, v20
    v_lshlrev_b32 v22, 1, v22
    s_and_b32 s21, s3, 1
    s_lshl_b32 s21, s21, 2
    v_xor_b32 v22, s21, v22
    v_add_u32 v21, v21, v22
    s_lshl_b32 s21, s3, 3
    v_add_u32 v21, s21, v21
    v_lshlrev_b32 v5, 2, v21
    s_and_b32 s21, s3, 1
    s_lshl_b32 s21, s21, 2
    v_bfe_u32 v21, v20, 3, 2
    v_add_u32 v21, s21, v21
    v_mul_u32_u24 v21, 104, v21
    v_bfe_u32 v22, v20, 1, 1
    v_lshl_add_u32 v21, v22, 3, v21
    v_and_b32 v23, 1, v20
    v_xor_b32 v22, v22, v23
    v_lshl_add_u32 v21, v22, 2, v21
    v_bfe_u32 v22, v20, 2, 1
    v_lshl_add_u32 v21, v22, 1, v21
    s_lshr_b32 s21, s3, 1
    s_lshl_b32 s21, s21, 4
    s_add_u32 s21, s21, 64
    v_add_u32 v21, s21, v21
    v_lshlrev_b32 v6, 2, v21
    v_lshrrev_b32 v21, 6, v27
    v_bfe_u32 v22, v27, 1, 1
    v_lshrrev_b32 v23, 1, v21
    v_lshl_add_u32 v22, v22, 1, v23
    v_xor_b32 v23, v27, v22
    v_and_b32 v23, 1, v23
    v_and_b32 v21, 1, v21
    v_lshl_add_u32 v21, v21, 1, v23
    v_mul_u32_u24 v21, 544, v21
    v_lshl_add_u32 v21, v22, 5, v21
    v_bfe_u32 v23, v27, 4, 2
    v_mul_u32_u24 v23, 136, v23
    v_add_u32 v21, v21, v23
    v_bfe_u32 v24, v27, 3, 1
    v_lshl_add_u32 v21, v24, 2, v21
    v_bfe_u32 v24, v27, 2, 1
    v_lshl_add_u32 v21, v24, 4, v21
    v_add_u32 v7, 16384, v21
    v_lshlrev_b32 v8, 2, v20
    s_and_b32 s21, s12, 1
    s_lshl_b32 s21, s21, 9
    s_lshl_b32 s22, s3, 7
    s_add_u32 s21, s21, s22
    v_and_b32 v21, 7, v20
    v_lshlrev_b32 v21, 4, v21
    v_add_u32 v21, s21, v21
    v_lshrrev_b32 v22, 3, v20
    v_lshl_add_u32 v12, v22, 10, v21
    v_bfe_u32 v22, v20, 4, 1
    v_lshl_add_u32 v13, v22, 3, v21
    s_and_b32 s21, s3, 1
    s_lshl_b32 s21, s21, 12
    s_lshr_b32 s22, s3, 1
    s_lshl_b32 s22, s22, 11
    s_add_u32 s21, s21, s22
    s_add_u32 s21, s21, 18560
    v_add_u32 v61, s21, v1
    s_lshl_b32 s21, s3, 2
    s_add_u32 s21, s21, 13312
    v_mov_b32 v14, s21
    v_and_b32 v21, 15, v20
    v_and_b32 v22, 1, v20
    v_lshlrev_b32 v22, 4, v22
    v_mov_b32 v23, 0x3f80
    v_lshlrev_b32 v22, v22, v23
    v_lshrrev_b32 v21, 1, v21
    v_cmp_eq_u32 vcc, 0, v21
    s_nop 1
    v_cndmask_b32 v56, 0, v22, vcc
    v_cmp_eq_u32 vcc, 1, v21
    s_nop 1
    v_cndmask_b32 v57, 0, v22, vcc
    v_cmp_eq_u32 vcc, 2, v21
    s_nop 1
    v_cndmask_b32 v58, 0, v22, vcc
    v_cmp_eq_u32 vcc, 3, v21
    s_nop 1
    v_cndmask_b32 v59, 0, v22, vcc
    v_and_b32 v21, 7, v20
    v_lshlrev_b32 v21, 7, v21
    v_bfe_u32 v22, v20, 3, 1
    v_lshl_add_u32 v21, v22, 17, v21
    s_lshl_b32 s21, s12, 14
    s_lshl_b32 s22, s13, 10
    s_add_u32 s21, s21, s22
    s_add_u32 s21, s21, 4980736
    v_lshrrev_b32 v22, 4, v20
    v_lshl_add_u32 v21, v22, 24, v21
    v_add_u32 v63, s21, v21
    s_mov_b32 s47, 0x3e0293ee
    s_lshl_b32 s14, s12, 2
    s_add_u32 s14, s14, s3
    s_lshl_b32 s61, s14, 13
    s_add_u32 s61, s61, 2097152
    s_lshl_b32 s14, s14, 12
    s_and_b32 s22, s13, 1
    s_lshl_b32 s69, s22, 17
    s_add_u32 s69, s69, s14
    s_add_u32 s69, s69, 4194304
    s_add_u32 s52, s14, 20971520
    s_lshl_b32 s21, s22, 11
    s_add_u32 s14, s14, s21
    s_add_u32 s14, s14, 1179648
    s_lshr_b32 s21, s13, 1
    s_sub_u32 s21, s21, 0
    s_cmp_eq_u32 s21, s3
    s_cselect_b32 s15, 1, 0
    s_add_u32 s23, s3, 3
    s_and_b32 s23, s23, 3
    s_cmp_eq_u32 s21, s23
    s_cselect_b32 s31, 1, 0
    s_and_b32 s24, s23, 1
    s_and_b32 s25, s3, 1
    s_sub_i32 s24, s24, s25
    s_lshr_b32 s23, s23, 1
    s_lshr_b32 s25, s3, 1
    s_sub_i32 s23, s23, s25
    s_mul_i32 s46, s24, 4096
    s_mul_i32 s25, s23, 2048
    s_add_i32 s46, s46, s25
    s_mul_i32 s27, s24, 32768
    s_mul_i32 s25, s23, 1024
    s_add_i32 s27, s27, s25
    v_lshrrev_b32 v21, 4, v20
    v_and_b32 v23, 15, v20
    v_lshlrev_b32 v21, 2, v21
    v_add_u32 v24, 0, v21
    v_cmp_gt_u32 vcc, v24, v23
    s_cmp_eq_u32 s22, 0
    s_cselect_b64 s[38:39], vcc, 0
    s_cselect_b64 s[48:49], -1, vcc
    v_add_u32 v24, 1, v21
    v_cmp_gt_u32 vcc, v24, v23
    s_cmp_eq_u32 s22, 0
    s_cselect_b64 s[40:41], vcc, 0
    s_cselect_b64 s[50:51], -1, vcc
    v_add_u32 v24, 2, v21
    v_cmp_gt_u32 vcc, v24, v23
    s_cmp_eq_u32 s22, 0
    s_cselect_b64 s[42:43], vcc, 0
    s_cselect_b64 s[54:55], -1, vcc
    v_add_u32 v24, 3, v21
    v_cmp_gt_u32 vcc, v24, v23
    s_cmp_eq_u32 s22, 0
    s_cselect_b64 s[44:45], vcc, 0
    s_cselect_b64 s[56:57], -1, vcc
    s_waitcnt vmcnt(0)
    v_mov_b32 v16, v32
    v_mov_b32 v17, v33
    v_mov_b32 v18, v34
    v_mov_b32 v19, v35
    v_mov_b32 v20, v36
    v_mov_b32 v21, v37
    v_mov_b32 v22, v38
    v_mov_b32 v23, v39
    v_mov_b32 v24, v40
    v_mov_b32 v25, v41
    v_mov_b32 v26, v42
    v_mov_b32 v27, v43
    v_mov_b32 v28, v44
    v_mov_b32 v29, v45
    v_mov_b32 v30, v46
    v_mov_b32 v31, v47
    v_mov_b32 v32, -1
    v_mov_b32 v33, -1
    v_mov_b32 v34, -1
    v_mov_b32 v35, -1
    s_add_u32 s21, s37, 3997696
    buffer_store_dwordx4 v[32:35], v1, s[4:7], s21 offen sc1
    s_add_u32 s21, s37, 4063232
    buffer_store_dwordx4 v[32:35], v1, s[4:7], s21 offen sc1
    s_add_u32 s21, s37, 4128768
    buffer_store_dwordx4 v[32:35], v1, s[4:7], s21 offen sc1
    s_lshl_b32 s29, s29, 5
    s_barrier
    ds_write_b32 v14, v10
    ds_write_b32 v14, v10 offset:16
    ds_write_b32 v14, v10 offset:32
    s_lshl_b32 s53, s3, 13
    s_add_u32 s53, s53, 92160
    v_add_u32 v32, 14336, v1
    ds_write_b128 v32, v[56:59]
    s_lshl_b32 s60, s12, 4
    s_add_u32 s60, s60, 218104320
    v_mov_b32 v15, 0
    s_add_u32 s25, s16, 0
    s_min_u32 s25, s25, 63
    s_cmp_lt_u32 s25, 8
    s_cselect_b32 s59, 12, 24
    s_cselect_b32 s58, -4, -8
    s_and_b32 s25, s25, s58
    s_lshl_b32 s25, s25, 5
    s_add_u32 s58, s25, s60
    v_mov_b32 v32, 131072
    s_waitcnt vmcnt(0) lgkmcnt(0)
    s_barrier
    ds_read_b64 v[32:33], v32
    s_waitcnt lgkmcnt(0)
    v_cmp_ne_u32 vcc, s29, v32
    s_setprio 3
    v_readfirstlane_b32 s63, v33
    s_add_u32 s34, s34, s63
    s_add_u32 s35, s35, s63
    s_cbranch_vccnz ch_p_slow
    v_mov_b32 v32, 0
    v_mov_b32 v33, 0
    v_mov_b32 v34, 0
    v_mov_b32 v35, 0
    v_mov_b32 v36, 0
    v_mov_b32 v37, 0
    v_mov_b32 v38, 0
    v_mov_b32 v39, 0
    v_mov_b32 v40, 0
    v_mov_b32 v41, 0
    v_mov_b32 v42, 0
    v_mov_b32 v43, 0
    v_mov_b32 v44, 0
    v_mov_b32 v45, 0
    v_mov_b32 v46, 0
    v_mov_b32 v47, 0
    v_mov_b32 v48, 0
    v_mov_b32 v49, 0
    v_mov_b32 v50, 0
    v_mov_b32 v51, 0
    v_mov_b32 v52, 0
    v_mov_b32 v53, 0
    v_mov_b32 v54, 0
    v_mov_b32 v55, 0
    v_mov_b32 v0, 1.0
    s_mov_b32 exec_lo, 0xff00ff00
    s_mov_b32 exec_hi, 0xff00ff00
    v_mov_b32 v0, s47
    s_mov_b64 exec, -1
    v_mov_b32 v60, s16
    v_smfmac_f32_16x16x64_bf16 v[32:35], v[16:19], v[64:71], v62
    v_smfmac_f32_16x16x64_bf16 v[36:39], v[16:19], v[72:79], v62
    v_smfmac_f32_16x16x64_bf16 v[40:43], v[16:19], v[80:87], v62
    v_smfmac_f32_16x16x64_bf16 v[44:47], v[16:19], v[88:95], v62
    v_smfmac_f32_16x16x64_bf16 v[48:51], v[16:19], v[96:103], v62
    v_smfmac_f32_16x16x64_bf16 v[52:55], v[16:19], v[104:111], v62
    v_smfmac_f32_16x16x64_bf16 v[32:35], v[20:23], v[112:119], v62
    v_smfmac_f32_16x16x64_bf16 v[36:39], v[20:23], v[120:127], v62
    v_smfmac_f32_16x16x64_bf16 v[40:43], v[20:23], v[128:135], v62
    v_smfmac_f32_16x16x64_bf16 v[44:47], v[20:23], v[136:143], v62
    v_smfmac_f32_16x16x64_bf16 v[48:51], v[20:23], v[144:151], v62
    v_smfmac_f32_16x16x64_bf16 v[52:55], v[20:23], v[152:159], v62
    v_smfmac_f32_16x16x64_bf16 v[32:35], v[24:27], v[160:167], v62
    v_smfmac_f32_16x16x64_bf16 v[36:39], v[24:27], v[168:175], v62
    v_smfmac_f32_16x16x64_bf16 v[40:43], v[24:27], v[176:183], v62
    v_smfmac_f32_16x16x64_bf16 v[44:47], v[24:27], v[184:191], v62
    v_smfmac_f32_16x16x64_bf16 v[48:51], v[24:27], v[192:199], v62
    v_smfmac_f32_16x16x64_bf16 v[52:55], v[24:27], v[200:207], v62
    v_smfmac_f32_16x16x64_bf16 v[32:35], v[28:31], v[208:215], v62
    ds_write_b32 v14, v60
    v_smfmac_f32_16x16x64_bf16 v[36:39], v[28:31], v[216:223], v62
    v_smfmac_f32_16x16x64_bf16 v[40:43], v[28:31], v[224:231], v62
    v_smfmac_f32_16x16x64_bf16 v[44:47], v[28:31], v[232:239], v62
    v_add_f32 v32, v32, v33
    v_add_f32 v34, v34, v35
    v_smfmac_f32_16x16x64_bf16 v[48:51], v[28:31], v[240:247], v62
    v_add_f32 v36, v36, v37
    v_add_f32 v38, v38, v39
    ds_write2_b32 v4, v32, v34 offset0:0 offset1:104
    v_smfmac_f32_16x16x64_bf16 v[52:55], v[28:31], v[248:255], v62
    v_add_f32 v40, v40, v41
    v_add_f32 v42, v42, v43
    ds_write2_b32 v4, v36, v38 offset0:16 offset1:120
    v_add_f32 v44, v44, v45
    v_add_f32 v46, v46, v47
    ds_write2_b32 v4, v40, v42 offset0:32 offset1:136
    v_add_f32 v48, v48, v49
    v_add_f32 v50, v50, v51
    ds_write2_b32 v4, v44, v46 offset0:48 offset1:152
    v_add_f32 v52, v52, v53
    v_add_f32 v54, v54, v55
    ds_write2_b32 v4, v48, v50 offset0:64 offset1:168
    ds_write2_b32 v4, v52, v54 offset0:80 offset1:184
    s_waitcnt vmcnt(0)
    s_branch pnc_7_done
.p2align 6
    s_nop 0
    s_nop 0
    s_nop 0
    s_nop 0
    s_nop 0
    s_nop 0
    s_nop 0
    s_nop 0
ploop_6:
    s_add_u32 s21, s17, s33
    s_nop 15
    s_nop 5
    buffer_load_dwordx4 v[16:19], v1, s[4:7], s21 offen offset:0 sc1
    s_nop 7
    buffer_load_dwordx4 v[20:23], v1, s[4:7], s21 offen offset:1024 sc1
    s_nop 7
    buffer_load_dwordx4 v[24:27], v1, s[4:7], s21 offen offset:2048 sc1
    s_nop 7
    buffer_load_dwordx4 v[28:31], v1, s[4:7], s21 offen offset:3072 sc1
    s_waitcnt vmcnt(3)
    v_max3_u32 v9, v16, v17, v18
    v_max_u32 v9, v9, v19
    v_cmp_eq_u32 vcc, -1, v9
    s_cbranch_vccnz prm_9_0
prm_9_0ok:
    v_smfmac_f32_16x16x64_bf16 v[32:35], v[16:19], v[64:71], v62
    v_smfmac_f32_16x16x64_bf16 v[36:39], v[16:19], v[72:79], v62
    v_smfmac_f32_16x16x64_bf16 v[40:43], v[16:19], v[80:87], v62
    s_waitcnt vmcnt(2)
    v_max3_u32 v9, v20, v21, v22
    v_max_u32 v9, v9, v23
    v_cmp_eq_u32 vcc, -1, v9
    v_smfmac_f32_16x16x64_bf16 v[44:47], v[16:19], v[88:95], v62
    v_smfmac_f32_16x16x64_bf16 v[48:51], v[16:19], v[96:103], v62
    v_smfmac_f32_16x16x64_bf16 v[52:55], v[16:19], v[104:111], v62
    s_cbranch_vccnz prm_9_1
prm_9_1ok:
    v_smfmac_f32_16x16x64_bf16 v[32:35], v[20:23], v[112:119], v62
    v_readfirstlane_b32 s23, v15
    v_smfmac_f32_16x16x64_bf16 v[36:39], v[20:23], v[120:127], v62
    v_smfmac_f32_16x16x64_bf16 v[40:43], v[20:23], v[128:135], v62
    s_waitcnt vmcnt(1)
    v_max3_u32 v9, v24, v25, v26
    v_max_u32 v9, v9, v27
    v_cmp_eq_u32 vcc, -1, v9
    v_smfmac_f32_16x16x64_bf16 v[44:47], v[20:23], v[136:143], v62
    v_smfmac_f32_16x16x64_bf16 v[48:51], v[20:23], v[144:151], v62
    v_smfmac_f32_16x16x64_bf16 v[52:55], v[20:23], v[152:159], v62
    s_cbranch_vccnz prm_9_2
prm_9_2ok:
    v_smfmac_f32_16x16x64_bf16 v[32:35], v[24:27], v[160:167], v62
    v_smfmac_f32_16x16x64_bf16 v[36:39], v[24:27], v[168:175], v62
    v_smfmac_f32_16x16x64_bf16 v[40:43], v[24:27], v[176:183], v62
    s_waitcnt vmcnt(0)
    v_max3_u32 v9, v28, v29, v30
    v_max_u32 v9, v9, v31
    v_cmp_eq_u32 vcc, -1, v9
    v_smfmac_f32_16x16x64_bf16 v[44:47], v[24:27], v[184:191], v62
    v_smfmac_f32_16x16x64_bf16 v[48:51], v[24:27], v[192:199], v62
    v_smfmac_f32_16x16x64_bf16 v[52:55], v[24:27], v[200:207], v62
    s_cbranch_vccnz prm_9_3
prm_9_3ok:
    v_smfmac_f32_16x16x64_bf16 v[32:35], v[28:31], v[208:215], v62
    s_cmp_lt_u32 s23, s59
    s_cbranch_scc1 prm_9_gt
prm_9_gtb:
    ds_write_b32 v14, v60
    v_smfmac_f32_16x16x64_bf16 v[36:39], v[28:31], v[216:223], v62
    v_smfmac_f32_16x16x64_bf16 v[40:43], v[28:31], v[224:231], v62
    v_smfmac_f32_16x16x64_bf16 v[44:47], v[28:31], v[232:239], v62
    v_add_f32 v32, v32, v33
    v_add_f32 v34, v34, v35
    v_smfmac_f32_16x16x64_bf16 v[48:51], v[28:31], v[240:247], v62
    v_add_f32 v36, v36, v37
    v_add_f32 v38, v38, v39
    ds_write2_b32 v4, v32, v34 offset0:0 offset1:104
    v_smfmac_f32_16x16x64_bf16 v[52:55], v[28:31], v[248:255], v62
    v_add_f32 v40, v40, v41
    v_add_f32 v42, v42, v43
    ds_write2_b32 v4, v36, v38 offset0:16 offset1:120
    v_add_f32 v44, v44, v45
    v_add_f32 v46, v46, v47
    ds_write2_b32 v4, v40, v42 offset0:32 offset1:136
    v_add_f32 v48, v48, v49
    v_add_f32 v50, v50, v51
    ds_write2_b32 v4, v44, v46 offset0:48 offset1:152
    v_add_f32 v52, v52, v53
    v_add_f32 v54, v54, v55
    ds_write2_b32 v4, v48, v50 offset0:64 offset1:168
    ds_write2_b32 v4, v52, v54 offset0:80 offset1:184
pnc_7_done:
    s_add_u32 s21, s17, s32
    s_add_u32 s22, s19, s32
    s_add_u32 s24, s19, s35
    s_waitcnt lgkmcnt(0)
    s_barrier
    ds_read_b64 v[32:33], v5 offset:0
    ds_read_b64 v[34:35], v5 offset:3328
    ds_read_b64 v[36:37], v5 offset:6656
    ds_read_b64 v[38:39], v5 offset:9984
    ds_read_b64 v[40:41], v6 offset:0
    ds_read_b64 v[42:43], v6 offset:3328
    ds_read_b64 v[44:45], v6 offset:6656
    ds_read_b64 v[46:47], v6 offset:9984
    s_waitcnt lgkmcnt(6)
    v_add_f32 v32, v32, v34
    v_add_f32 v33, v33, v35
    v_mul_f32 v32, v32, v0
    v_mul_f32 v33, v33, v0
    s_waitcnt lgkmcnt(4)
    v_add_f32 v36, v36, v38
    v_add_f32 v37, v37, v39
    v_fma_f32 v32, v36, v0, v32
    v_fma_f32 v33, v37, v0, v33
    v_cvt_pk_bf16_f32 v32, v32, v33
    v_min_u32 v32, -2, v32
    buffer_store_dword v32, v2, s[4:7], s21 offen
    s_waitcnt lgkmcnt(2)
    v_add_f32 v40, v40, v42
    v_add_f32 v41, v41, v43
    s_waitcnt lgkmcnt(0)
    v_add_f32 v44, v44, v46
    v_add_f32 v45, v45, v47
    v_add_f32 v40, v40, v44
    v_add_f32 v41, v41, v45
    v_cvt_pk_bf16_f32 v40, v40, v41
    v_min_u32 v40, -2, v40
    s_mov_b32 exec_hi, 0
    buffer_store_dword v40, v3, s[4:7], s21 offen
    s_setprio 0
    s_mov_b64 exec, -1
    s_add_u32 s21, s17, s35
    s_add_u32 s30, s17, s34
    s_add_u32 s23, s18, s36
    s_cmp_lg_u32 s16, 0
    s_cbranch_scc1 ploop_6_n0
gate_11:
    v_readfirstlane_b32 s25, v15
    s_cmp_ge_u32 s25, s59
    s_cbranch_scc1 gate_11_ok
    s_sleep 8
    buffer_load_dword v15, off, s[4:7], s58 sc1
    s_waitcnt vmcnt(0)
    s_sub_u32 s26, s26, 1
    s_cbranch_scc0 gate_11
    s_mov_b32 s26, 0
gate_11_ok:
    s_cmp_eq_u32 s15, 0
    s_cbranch_scc1 ploop_6_st_nk
    s_add_u32 m0, s53, 0
    s_add_u32 s22, s52, 0
    buffer_load_dwordx4 v1, s[4:7], s22 offen offset:0 sc1 lds
    buffer_load_dwordx4 v1, s[4:7], s22 offen offset:1024 sc1 lds
    buffer_load_dwordx4 v1, s[4:7], s22 offen offset:2048 sc1 lds
    buffer_load_dwordx4 v1, s[4:7], s22 offen offset:3072 sc1 lds
    s_add_u32 m0, s53, 4096
    s_add_u32 s22, s52, 131072
    buffer_load_dwordx4 v1, s[4:7], s22 offen offset:0 sc1 lds
    buffer_load_dwordx4 v1, s[4:7], s22 offen offset:1024 sc1 lds
    buffer_load_dwordx4 v1, s[4:7], s22 offen offset:2048 sc1 lds
    buffer_load_dwordx4 v1, s[4:7], s22 offen offset:3072 sc1 lds
    s_add_u32 s52, s52, 262144
    s_sub_u32 s52, s52, 262144
ploop_6_st_nk:
    s_add_u32 s52, s52, 262144
    s_cmp_lg_u32 s3, 2
    s_cbranch_scc1 ploop_6_st_npf
    v_subrev_u32 v32, 786432, v63
    s_mov_b32 exec_hi, 0xffff
    s_mov_b32 s22, 262144
    buffer_load_dword v33, v32, s[4:7], s22 offen sc1
    s_mov_b32 s22, 524288
    buffer_load_dword v33, v32, s[4:7], s22 offen sc1
    s_mov_b32 exec_hi, -1
    s_waitcnt vmcnt(0)
ploop_6_st_npf:
    s_cmp_eq_u32 s15, 0
    s_cbranch_scc1 ploop_6_st_p_nd
    s_mov_b32 m0, 124928
    s_nop 0
    buffer_load_dwordx4 v1, s[4:7], s69 offen offset:0 sc1 lds
    buffer_load_dwordx4 v1, s[4:7], s69 offen offset:1024 sc1 lds
    buffer_load_dwordx4 v1, s[4:7], s69 offen offset:2048 sc1 lds
    buffer_load_dwordx4 v1, s[4:7], s69 offen offset:3072 sc1 lds
    s_add_u32 s69, s69, 262144
    s_waitcnt vmcnt(0)
ploop_6_st_p_nd:
ploop_6_n0:
    s_add_u32 s25, s16, 2
    s_min_u32 s25, s25, 63
    s_cmp_lt_u32 s25, 8
    s_cselect_b32 s59, 12, 24
    s_cselect_b32 s58, -4, -8
    s_and_b32 s25, s25, s58
    s_lshl_b32 s25, s25, 5
    s_add_u32 s58, s25, s60
    s_cmp_eq_u32 s15, 0
    s_cbranch_scc1 ploop_6_nd
    v_add_u32 v9, s53, v1
    v_add_u32 v0, 124928, v1
    ds_read_b128 v[16:19], v0 offset:0
    ds_read_b128 v[32:35], v9 offset:0
    ds_read_b128 v[20:23], v0 offset:1024
    ds_read_b128 v[36:39], v9 offset:1024
    ds_read_b128 v[24:27], v0 offset:2048
    ds_read_b128 v[40:43], v9 offset:2048
    ds_read_b128 v[28:31], v0 offset:3072
    ds_read_b128 v[44:47], v9 offset:3072
    s_add_u32 s22, s17, s61
    s_waitcnt lgkmcnt(6)
    v_mfma_f32_16x16x32_bf16 v[48:51], v[32:35], v[16:19], 0
    ds_read_b128 v[32:35], v9 offset:4096
    s_waitcnt lgkmcnt(5)
    v_mfma_f32_16x16x32_bf16 v[48:51], v[36:39], v[20:23], v[48:51]
    ds_read_b128 v[36:39], v9 offset:5120
    s_waitcnt lgkmcnt(4)
    v_mfma_f32_16x16x32_bf16 v[48:51], v[40:43], v[24:27], v[48:51]
    ds_read_b128 v[40:43], v9 offset:6144
    s_waitcnt lgkmcnt(3)
    v_mfma_f32_16x16x32_bf16 v[48:51], v[44:47], v[28:31], v[48:51]
    ds_read_b128 v[44:47], v9 offset:7168
    s_waitcnt lgkmcnt(3)
    v_mfma_f32_16x16x32_bf16 v[52:55], v[32:35], v[16:19], 0
    s_waitcnt lgkmcnt(2)
    v_mfma_f32_16x16x32_bf16 v[52:55], v[36:39], v[20:23], v[52:55]
    s_waitcnt lgkmcnt(1)
    v_mfma_f32_16x16x32_bf16 v[52:55], v[40:43], v[24:27], v[52:55]
    s_waitcnt lgkmcnt(0)
    v_mfma_f32_16x16x32_bf16 v[52:55], v[44:47], v[28:31], v[52:55]
    buffer_load_dwordx4 v[32:35], v1, s[4:7], s22 offen offset:0 sc1
    buffer_load_dwordx4 v[36:39], v1, s[4:7], s22 offen offset:1024 sc1
    buffer_load_dwordx4 v[40:43], v1, s[4:7], s22 offen offset:2048 sc1
    buffer_load_dwordx4 v[44:47], v1, s[4:7], s22 offen offset:3072 sc1
    v_mov_b32 v60, 0xff61b1e6
    s_nop 2
    v_cndmask_b32 v48, v48, v60, s[38:39]
    v_cndmask_b32 v49, v49, v60, s[40:41]
    v_cndmask_b32 v50, v50, v60, s[42:43]
    v_cndmask_b32 v51, v51, v60, s[44:45]
    v_cndmask_b32 v52, v52, v60, s[48:49]
    v_cndmask_b32 v53, v53, v60, s[50:51]
    v_cndmask_b32 v54, v54, v60, s[54:55]
    v_cndmask_b32 v55, v55, v60, s[56:57]
    v_max3_f32 v0, v48, v49, v50
    v_max3_f32 v9, v51, v52, v53
    v_max3_f32 v0, v0, v54, v55
    v_max_f32 v0, v0, v9
    v_mov_b32 v9, v0
    s_nop 1
    v_permlane16_swap_b32 v9, v0
    v_max_f32 v0, v0, v9
    v_mov_b32 v9, v0
    s_nop 1
    v_permlane32_swap_b32 v9, v0
    v_max_f32 v0, v0, v9
    v_mul_f32 v0, s47, v0
    v_fma_f32 v48, v48, s47, -v0
    v_fma_f32 v49, v49, s47, -v0
    v_fma_f32 v50, v50, s47, -v0
    v_fma_f32 v51, v51, s47, -v0
    v_fma_f32 v52, v52, s47, -v0
    v_fma_f32 v53, v53, s47, -v0
    v_fma_f32 v54, v54, s47, -v0
    v_fma_f32 v55, v55, s47, -v0
    v_exp_f32 v48, v48
    v_exp_f32 v49, v49
    v_exp_f32 v50, v50
    v_exp_f32 v51, v51
    v_exp_f32 v52, v52
    v_exp_f32 v53, v53
    v_exp_f32 v54, v54
    v_exp_f32 v55, v55
    v_add_f32 v15, v48, v49
    v_add_f32 v15, v15, v50
    v_add_f32 v15, v15, v51
    v_add_f32 v15, v15, v52
    v_add_f32 v15, v15, v53
    v_add_f32 v15, v15, v54
    v_add_f32 v15, v15, v55
ploop_6_za:
    s_waitcnt vmcnt(0)
    v_max3_u32 v9, v32, v33, v34
    v_max3_u32 v9, v9, v35, v36
    v_max3_u32 v9, v9, v37, v38
    v_max3_u32 v9, v9, v39, v40
    v_max3_u32 v9, v9, v41, v42
    v_max3_u32 v9, v9, v43, v44
    v_max3_u32 v9, v9, v45, v46
    v_max_u32 v9, v9, v47
    v_cmp_eq_u32 vcc, -1, v9
    s_cbranch_vccnz ploop_6_zr
ploop_6_zok:
    v_mfma_f32_16x16x32_bf16 v[56:59], v[32:35], v[16:19], 0
    v_mfma_f32_16x16x32_bf16 v[56:59], v[36:39], v[20:23], v[56:59]
    v_mfma_f32_16x16x32_bf16 v[56:59], v[40:43], v[24:27], v[56:59]
    v_mfma_f32_16x16x32_bf16 v[56:59], v[44:47], v[28:31], v[56:59]
    s_add_u32 s22, s17, s14
    s_nop 6
    v_max_f32 v60, v56, v57
    v_mov_b32 v9, v60
    s_nop 1
    v_permlane16_swap_b32 v9, v60
    v_max_f32 v60, v60, v9
    v_mov_b32 v9, v60
    s_nop 1
    v_permlane32_swap_b32 v9, v60
    v_max_f32 v60, v60, v9
    v_mul_f32 v60, s47, v60
    v_max_f32 v58, v60, v0
    v_sub_f32 v60, v0, v58
    v_fma_f32 v56, v56, s47, -v58
    v_fma_f32 v57, v57, s47, -v58
    v_exp_f32 v60, v60
    v_exp_f32 v56, v56
    v_exp_f32 v57, v57
    v_fma_f32 v15, v15, v60, v56
    v_add_f32 v15, v15, v57
    v_mov_b32 v9, v15
    s_nop 1
    v_permlane16_swap_b32 v9, v15
    v_add_f32 v15, v15, v9
    v_mov_b32 v9, v15
    s_nop 1
    v_permlane32_swap_b32 v9, v15
    v_add_f32 v15, v15, v9
    v_rcp_f32 v15, v15
    s_add_u32 s25, s19, s14
    v_mul_f32 v56, v56, v15
    v_mul_f32 v57, v57, v15
    v_mul_f32 v60, v60, v15
    v_mul_f32 v48, v48, v60
    v_mul_f32 v49, v49, v60
    v_mul_f32 v50, v50, v60
    v_mul_f32 v51, v51, v60
    v_mul_f32 v52, v52, v60
    v_mul_f32 v53, v53, v60
    v_mul_f32 v54, v54, v60
    v_mul_f32 v55, v55, v60
    v_cvt_pk_bf16_f32 v48, v48, v49
    v_cvt_pk_bf16_f32 v49, v50, v51
    v_cvt_pk_bf16_f32 v50, v52, v53
    v_cvt_pk_bf16_f32 v51, v54, v55
    v_min_u32 v48, -2, v48
    v_min_u32 v49, -2, v49
    v_min_u32 v50, -2, v50
    v_min_u32 v51, -2, v51
    v_lshlrev_b32 v54, 1, v8
    v_add_u32 v55, 14336, v1
    v_mov_b32 v53, 1.0
    v_cvt_pk_bf16_f32 v52, v56, v57
    v_min_u32 v53, -2, v53
    v_min_u32 v52, -2, v52
    buffer_store_dwordx4 v[48:51], v1, s[4:7], s22 offen
    buffer_store_dwordx2 v[52:53], v54, s[4:7], s22 offen offset:1024
    ds_read_b128 v[56:59], v55
    s_branch ploop_6_nd2
ploop_6_nd:
    s_cmp_eq_u32 s16, 0
    s_cbranch_scc1 ploop_6_ns
    s_cmp_eq_u32 s31, 0
    s_cbranch_scc1 ploop_6_n2
    s_add_u32 s25, s68, s46
    v_add_u32 v55, s25, v61
    ds_read_b128 v[24:27], v55 offset:0
    ds_read_b128 v[28:31], v55 offset:1024
    ds_read_b128 v[32:35], v55 offset:18560
    ds_read_b128 v[36:39], v55 offset:19584
    ds_read_b128 v[40:43], v55 offset:37120
    ds_read_b128 v[44:47], v55 offset:38144
    ds_read_b128 v[48:51], v55 offset:55680
    ds_read_b128 v[52:55], v55 offset:56704
    s_waitcnt lgkmcnt(4)
    v_add_f32 v24, v24, v32
    v_add_f32 v25, v25, v33
    v_add_f32 v26, v26, v34
    v_add_f32 v27, v27, v35
    v_add_f32 v28, v28, v36
    v_add_f32 v29, v29, v37
    v_add_f32 v30, v30, v38
    v_add_f32 v31, v31, v39
    s_waitcnt lgkmcnt(0)
    v_add_f32 v40, v40, v48
    v_add_f32 v41, v41, v49
    v_add_f32 v42, v42, v50
    v_add_f32 v43, v43, v51
    v_add_f32 v44, v44, v52
    v_add_f32 v45, v45, v53
    v_add_f32 v46, v46, v54
    v_add_f32 v47, v47, v55
    v_add_f32 v24, v24, v40
    v_add_f32 v25, v25, v41
    v_add_f32 v26, v26, v42
    v_add_f32 v27, v27, v43
    v_add_f32 v28, v28, v44
    v_add_f32 v29, v29, v45
    v_add_f32 v30, v30, v46
    v_add_f32 v31, v31, v47
    v_cvt_pk_bf16_f32 v24, v24, v25
    v_cvt_pk_bf16_f32 v25, v26, v27
    v_cvt_pk_bf16_f32 v26, v28, v29
    v_cvt_pk_bf16_f32 v27, v30, v31
    v_min_u32 v24, -2, v24
    v_min_u32 v25, -2, v25
    v_min_u32 v26, -2, v26
    v_min_u32 v27, -2, v27
    v_mov_b32 v16, v24
    v_mov_b32 v17, v25
    v_mov_b32 v18, v26
    v_mov_b32 v19, v27
ploop_6_n2:
    v_add_u32 v55, s68, v61
    ds_read_b128 v[24:27], v55 offset:0
    ds_read_b128 v[28:31], v55 offset:1024
    ds_read_b128 v[32:35], v55 offset:18560
    ds_read_b128 v[36:39], v55 offset:19584
    ds_read_b128 v[40:43], v55 offset:37120
    ds_read_b128 v[44:47], v55 offset:38144
    ds_read_b128 v[48:51], v55 offset:55680
    ds_read_b128 v[52:55], v55 offset:56704
    s_waitcnt lgkmcnt(4)
    v_add_f32 v24, v24, v32
    v_add_f32 v25, v25, v33
    v_add_f32 v26, v26, v34
    v_add_f32 v27, v27, v35
    v_add_f32 v28, v28, v36
    v_add_f32 v29, v29, v37
    v_add_f32 v30, v30, v38
    v_add_f32 v31, v31, v39
    s_waitcnt lgkmcnt(0)
    v_add_f32 v40, v40, v48
    v_add_f32 v41, v41, v49
    v_add_f32 v42, v42, v50
    v_add_f32 v43, v43, v51
    v_add_f32 v44, v44, v52
    v_add_f32 v45, v45, v53
    v_add_f32 v46, v46, v54
    v_add_f32 v47, v47, v55
    v_add_f32 v24, v24, v40
    v_add_f32 v25, v25, v41
    v_add_f32 v26, v26, v42
    v_add_f32 v27, v27, v43
    v_add_f32 v28, v28, v44
    v_add_f32 v29, v29, v45
    v_add_f32 v30, v30, v46
    v_add_f32 v31, v31, v47
    v_cvt_pk_bf16_f32 v24, v24, v25
    v_cvt_pk_bf16_f32 v25, v26, v27
    v_cvt_pk_bf16_f32 v26, v28, v29
    v_cvt_pk_bf16_f32 v27, v30, v31
    v_min_u32 v24, -2, v24
    v_min_u32 v25, -2, v25
    v_min_u32 v26, -2, v26
    v_min_u32 v27, -2, v27
ploop_6_ns:
ploop_6_flag:
    ds_read_b32 v9, v14 offset:16
    s_waitcnt lgkmcnt(0)
    v_readfirstlane_b32 s25, v9
    s_cmp_eq_u32 s25, s16
    s_cbranch_scc0 ploop_6_flag
    s_add_u32 m0, s53, 0
    s_add_u32 s22, s52, 0
    buffer_load_dwordx4 v1, s[4:7], s22 offen offset:0 sc1 lds
    buffer_load_dwordx4 v1, s[4:7], s22 offen offset:1024 sc1 lds
    buffer_load_dwordx4 v1, s[4:7], s22 offen offset:2048 sc1 lds
    buffer_load_dwordx4 v1, s[4:7], s22 offen offset:3072 sc1 lds
    s_add_u32 m0, s53, 4096
    s_add_u32 s22, s52, 131072
    buffer_load_dwordx4 v1, s[4:7], s22 offen offset:0 sc1 lds
    buffer_load_dwordx4 v1, s[4:7], s22 offen offset:1024 sc1 lds
    buffer_load_dwordx4 v1, s[4:7], s22 offen offset:2048 sc1 lds
    buffer_load_dwordx4 v1, s[4:7], s22 offen offset:3072 sc1 lds
    s_add_u32 s52, s52, 262144
ploop_6_nk:
    s_cmp_eq_u32 s16, 0
    s_cbranch_scc1 ploop_6_nd2
    buffer_store_dwordx4 v[24:27], v1, s[4:7], s37 offen sc1
    s_cmp_eq_u32 s31, 0
    s_cbranch_scc1 ploop_6_nd2
    s_add_u32 s25, s37, s27
    buffer_store_dwordx4 v[16:19], v1, s[4:7], s25 offen sc1
ploop_6_nd2:
    s_cmp_eq_u32 s16, 0
    s_cbranch_scc1 ploop_6_nn
    s_add_u32 s37, s37, 65536
    s_xor_b32 s68, s68, 8192
ploop_6_nn:
    s_cmp_lg_u32 s3, 2
    s_cbranch_scc1 ppf_12
    s_lshl_b32 s22, s16, 18
    s_mov_b32 exec_hi, 0xffff
    buffer_load_dword v9, v63, s[4:7], s22 offen sc1
    s_mov_b32 exec_hi, -1
ppf_12:
    v_add_u32 v24, 18560, v7
    v_add_u32 v25, 37120, v7
    v_add_u32 v26, 55680, v7
    s_cmp_eq_u32 s16, 63
    s_setprio 3
    s_barrier
    s_cbranch_scc1 ptail_8
    ds_read2_b32 v[16:17], v7 offset0:0 offset1:2
    ds_read2_b32 v[18:19], v24 offset0:0 offset1:2
    ds_read2_b32 v[20:21], v25 offset0:0 offset1:2
    ds_read2_b32 v[22:23], v26 offset0:0 offset1:2
    s_waitcnt lgkmcnt(2)
    v_add_f32 v16, v16, v18
    v_add_f32 v17, v17, v19
    s_waitcnt lgkmcnt(0)
    v_add_f32 v20, v20, v22
    v_add_f32 v21, v21, v23
    v_add_f32 v16, v16, v20
    v_add_f32 v17, v17, v21
    v_cvt_pk_bf16_f32 v16, v16, v17
    v_min_u32 v16, -2, v16
    buffer_store_dword v16, v2, s[4:7], s21 offen sc1
    buffer_store_dword v10, v2, s[4:7], s24 offen sc1
    s_cmp_eq_u32 s15, 0
    s_cbranch_scc1 ploop_6_pnd
    s_sleep 6
    s_nop 8
    buffer_load_dwordx4 v[16:19], v12, s[4:7], s30 offen sc1
    buffer_load_dword v15, off, s[4:7], s58 sc1
    s_add_u32 s25, s19, s14
    v_mov_b32 v20, -1
    v_mov_b32 v21, -1
    v_mov_b32 v22, -1
    v_mov_b32 v23, -1
    buffer_store_dwordx4 v[20:23], v1, s[4:7], s25 offen
    buffer_store_dwordx2 v[20:21], v54, s[4:7], s25 offen offset:1024
    s_mov_b32 m0, 124928
    s_nop 0
    buffer_load_dwordx4 v1, s[4:7], s69 offen offset:0 sc1 lds
    buffer_load_dwordx4 v1, s[4:7], s69 offen offset:1024 sc1 lds
    buffer_load_dwordx4 v1, s[4:7], s69 offen offset:2048 sc1 lds
    buffer_load_dwordx4 v1, s[4:7], s69 offen offset:3072 sc1 lds
    s_add_u32 s69, s69, 262144
    s_add_u32 m0, s53, 0
    s_add_u32 s22, s52, 0
    buffer_load_dwordx4 v1, s[4:7], s22 offen offset:0 sc1 lds
    buffer_load_dwordx4 v1, s[4:7], s22 offen offset:1024 sc1 lds
    buffer_load_dwordx4 v1, s[4:7], s22 offen offset:2048 sc1 lds
    buffer_load_dwordx4 v1, s[4:7], s22 offen offset:3072 sc1 lds
    s_add_u32 m0, s53, 4096
    s_add_u32 s22, s52, 131072
    buffer_load_dwordx4 v1, s[4:7], s22 offen offset:0 sc1 lds
    buffer_load_dwordx4 v1, s[4:7], s22 offen offset:1024 sc1 lds
    buffer_load_dwordx4 v1, s[4:7], s22 offen offset:2048 sc1 lds
    buffer_load_dwordx4 v1, s[4:7], s22 offen offset:3072 sc1 lds
    s_add_u32 s52, s52, 262144
    s_add_u32 s22, s16, 1
    v_mov_b32 v60, s22
    v_mov_b32 v32, 0
    v_mov_b32 v33, 0
    v_mov_b32 v34, 0
    v_mov_b32 v35, 0
    v_mov_b32 v36, 0
    v_mov_b32 v37, 0
    v_mov_b32 v38, 0
    v_mov_b32 v39, 0
    v_mov_b32 v40, 0
    v_mov_b32 v41, 0
    v_mov_b32 v42, 0
    v_mov_b32 v43, 0
    v_mov_b32 v44, 0
    v_mov_b32 v45, 0
    v_mov_b32 v46, 0
    v_mov_b32 v47, 0
    v_mov_b32 v48, 0
    v_mov_b32 v49, 0
    v_mov_b32 v50, 0
    v_mov_b32 v51, 0
    v_mov_b32 v52, 0
    v_mov_b32 v53, 0
    v_mov_b32 v54, 0
    v_mov_b32 v55, 0
    v_mov_b32 v0, 1.0
    s_mov_b32 exec_lo, 0xff00ff00
    s_mov_b32 exec_hi, 0xff00ff00
    v_mov_b32 v0, s47
    s_mov_b64 exec, -1
    s_waitcnt vmcnt(15) lgkmcnt(0)
    v_mfma_f32_16x16x32_bf16 v[20:23], v[56:59], v[16:19], 0
    v_max3_u32 v9, v16, v17, v18
    v_max_u32 v9, v9, v19
    v_cmp_eq_u32 vcc, -1, v9
    s_cbranch_vccnz prp_10
    s_nop 3
    v_add_f32_dpp v20, v20, v20 row_ror:8 row_mask:0xf bank_mask:0xf
    v_add_f32_dpp v21, v21, v21 row_ror:8 row_mask:0xf bank_mask:0xf
    v_add_f32_dpp v22, v22, v22 row_ror:8 row_mask:0xf bank_mask:0xf
    v_add_f32_dpp v23, v23, v23 row_ror:8 row_mask:0xf bank_mask:0xf
    v_cvt_pk_bf16_f32 v20, v20, v21
    v_cvt_pk_bf16_f32 v21, v22, v23
    s_mov_b32 exec_hi, 0
    v_min_u32 v20, -2, v20
    v_min_u32 v21, -2, v21
    s_mov_b32 exec_lo, 0x00ff00ff
    buffer_store_dwordx2 v[20:21], v13, s[4:7], s23 offen
    s_mov_b64 exec, -1
    s_branch ploop_6_pst
ploop_6_pnd:
    s_sleep 6
    s_nop 8
    buffer_load_dwordx4 v[16:19], v12, s[4:7], s30 offen sc1
    buffer_load_dword v15, off, s[4:7], s58 sc1
    s_add_u32 s22, s16, 1
    v_mov_b32 v60, s22
    v_mov_b32 v32, 0
    v_mov_b32 v33, 0
    v_mov_b32 v34, 0
    v_mov_b32 v35, 0
    v_mov_b32 v36, 0
    v_mov_b32 v37, 0
    v_mov_b32 v38, 0
    v_mov_b32 v39, 0
    v_mov_b32 v40, 0
    v_mov_b32 v41, 0
    v_mov_b32 v42, 0
    v_mov_b32 v43, 0
    v_mov_b32 v44, 0
    v_mov_b32 v45, 0
    v_mov_b32 v46, 0
    v_mov_b32 v47, 0
    v_mov_b32 v48, 0
    v_mov_b32 v49, 0
    v_mov_b32 v50, 0
    v_mov_b32 v51, 0
    v_mov_b32 v52, 0
    v_mov_b32 v53, 0
    v_mov_b32 v54, 0
    v_mov_b32 v55, 0
    v_mov_b32 v0, 1.0
    s_mov_b32 exec_lo, 0xff00ff00
    s_mov_b32 exec_hi, 0xff00ff00
    v_mov_b32 v0, s47
    s_mov_b64 exec, -1
ploop_6_pagain:
    s_waitcnt vmcnt(1) lgkmcnt(0)
    v_mfma_f32_16x16x32_bf16 v[20:23], v[56:59], v[16:19], 0
    v_max3_u32 v9, v16, v17, v18
    v_max_u32 v9, v9, v19
    v_cmp_eq_u32 vcc, -1, v9
    s_cbranch_vccnz prp_10
ploop_6_pgo:
    s_nop 3
    v_add_f32_dpp v20, v20, v20 row_ror:8 row_mask:0xf bank_mask:0xf
    v_add_f32_dpp v21, v21, v21 row_ror:8 row_mask:0xf bank_mask:0xf
    v_add_f32_dpp v22, v22, v22 row_ror:8 row_mask:0xf bank_mask:0xf
    v_add_f32_dpp v23, v23, v23 row_ror:8 row_mask:0xf bank_mask:0xf
    v_cvt_pk_bf16_f32 v20, v20, v21
    v_cvt_pk_bf16_f32 v21, v22, v23
    s_mov_b32 exec_hi, 0
    v_min_u32 v20, -2, v20
    v_min_u32 v21, -2, v21
    s_mov_b32 exec_lo, 0x00ff00ff
    buffer_store_dwordx2 v[20:21], v13, s[4:7], s23 offen
    s_mov_b64 exec, -1
ploop_6_pst:
    s_add_u32 s22, s19, s32
    s_add_u32 s25, s20, s36
    buffer_store_dword v10, v2, s[4:7], s22 offen
    s_mov_b32 exec_hi, 0
    buffer_store_dword v10, v3, s[4:7], s22 offen
    s_mov_b32 exec_lo, 0x00ff00ff
    buffer_store_dwordx2 v[10:11], v13, s[4:7], s25 offen
    s_mov_b64 exec, -1
    s_add_u32 s16, s16, 1
    s_mov_b32 s17, s18
    s_mov_b32 s18, s19
    s_mov_b32 s19, s20
    s_add_u32 s20, s20, 262144
    s_cmp_eq_u32 s20, 210763776
    s_cselect_b32 s20, 209715200, s20
    s_branch ploop_6
prm_9_gt:
gate_13:
    v_readfirstlane_b32 s25, v15
    s_cmp_ge_u32 s25, s59
    s_cbranch_scc1 gate_13_ok
    s_sleep 8
    buffer_load_dword v15, off, s[4:7], s58 sc1
    s_waitcnt vmcnt(0)
    s_sub_u32 s26, s26, 1
    s_cbranch_scc0 gate_13
    s_mov_b32 s26, 0
gate_13_ok:
    s_branch prm_9_gtb
prm_9_0:
    s_sub_u32 s26, s26, 1
    s_cbranch_scc1 prm_9_0_g
    buffer_load_dwordx4 v[16:19], v1, s[4:7], s21 offen offset:0 sc1
    buffer_load_dwordx4 v[20:23], v1, s[4:7], s21 offen offset:1024 sc1
    buffer_load_dwordx4 v[24:27], v1, s[4:7], s21 offen offset:2048 sc1
    buffer_load_dwordx4 v[28:31], v1, s[4:7], s21 offen offset:3072 sc1
    s_waitcnt vmcnt(3)
    v_max3_u32 v9, v16, v17, v18
    v_max_u32 v9, v9, v19
    v_cmp_eq_u32 vcc, -1, v9
    s_cbranch_vccnz prm_9_0
    s_branch prm_9_0ok
prm_9_0_g:
    s_mov_b32 s26, 0
    s_waitcnt vmcnt(0)
    s_branch prm_9_0ok
prm_9_1:
    s_sub_u32 s26, s26, 1
    s_cbranch_scc1 prm_9_1_g
    buffer_load_dwordx4 v[20:23], v1, s[4:7], s21 offen offset:1024 sc1
    buffer_load_dwordx4 v[24:27], v1, s[4:7], s21 offen offset:2048 sc1
    buffer_load_dwordx4 v[28:31], v1, s[4:7], s21 offen offset:3072 sc1
    s_waitcnt vmcnt(2)
    v_max3_u32 v9, v20, v21, v22
    v_max_u32 v9, v9, v23
    v_cmp_eq_u32 vcc, -1, v9
    s_cbranch_vccnz prm_9_1
    s_branch prm_9_1ok
prm_9_1_g:
    s_mov_b32 s26, 0
    s_waitcnt vmcnt(0)
    s_branch prm_9_1ok
prm_9_2:
    s_sub_u32 s26, s26, 1
    s_cbranch_scc1 prm_9_2_g
    buffer_load_dwordx4 v[24:27], v1, s[4:7], s21 offen offset:2048 sc1
    buffer_load_dwordx4 v[28:31], v1, s[4:7], s21 offen offset:3072 sc1
    s_waitcnt vmcnt(1)
    v_max3_u32 v9, v24, v25, v26
    v_max_u32 v9, v9, v27
    v_cmp_eq_u32 vcc, -1, v9
    s_cbranch_vccnz prm_9_2
    s_branch prm_9_2ok
prm_9_2_g:
    s_mov_b32 s26, 0
    s_waitcnt vmcnt(0)
    s_branch prm_9_2ok
prm_9_3:
    s_sub_u32 s26, s26, 1
    s_cbranch_scc1 prm_9_3_g
    buffer_load_dwordx4 v[28:31], v1, s[4:7], s21 offen offset:3072 sc1
    s_waitcnt vmcnt(0)
    v_max3_u32 v9, v28, v29, v30
    v_max_u32 v9, v9, v31
    v_cmp_eq_u32 vcc, -1, v9
    s_cbranch_vccnz prm_9_3
    s_branch prm_9_3ok
prm_9_3_g:
    s_mov_b32 s26, 0
    s_waitcnt vmcnt(0)
    s_branch prm_9_3ok
prm_9_d:
gate_14:
    v_readfirstlane_b32 s25, v15
    s_cmp_ge_u32 s25, s59
    s_cbranch_scc1 gate_14_ok
    s_sleep 8
    buffer_load_dword v15, off, s[4:7], s58 sc1
    s_waitcnt vmcnt(0)
    s_sub_u32 s26, s26, 1
    s_cbranch_scc0 gate_14
    s_mov_b32 s26, 0
gate_14_ok:
    ds_write_b32 v14, v60
    v_add_f32 v32, v32, v33
    v_add_f32 v34, v34, v35
    ds_write2_b32 v4, v32, v34 offset0:0 offset1:104
    v_add_f32 v36, v36, v37
    v_add_f32 v38, v38, v39
    ds_write2_b32 v4, v36, v38 offset0:16 offset1:120
    v_add_f32 v40, v40, v41
    v_add_f32 v42, v42, v43
    ds_write2_b32 v4, v40, v42 offset0:32 offset1:136
    v_add_f32 v44, v44, v45
    v_add_f32 v46, v46, v47
    ds_write2_b32 v4, v44, v46 offset0:48 offset1:152
    v_add_f32 v48, v48, v49
    v_add_f32 v50, v50, v51
    ds_write2_b32 v4, v48, v50 offset0:64 offset1:168
    v_add_f32 v52, v52, v53
    v_add_f32 v54, v54, v55
    ds_write2_b32 v4, v52, v54 offset0:80 offset1:184
    s_branch pnc_7_done
prp_10:
    s_sub_u32 s26, s26, 1
    s_nop 3
    s_cbranch_scc1 prp_10_g
    buffer_load_dwordx4 v[16:19], v12, s[4:7], s30 offen sc1
    buffer_load_dword v15, off, s[4:7], s58 sc1
    s_branch ploop_6_pagain
prp_10_g:
    s_mov_b32 s26, 0
    s_branch ploop_6_pgo
ploop_6_zr:
    s_sub_u32 s26, s26, 1
    s_cbranch_scc1 ploop_6_zg
    buffer_load_dwordx4 v[32:35], v1, s[4:7], s22 offen offset:0 sc1
    buffer_load_dwordx4 v[36:39], v1, s[4:7], s22 offen offset:1024 sc1
    buffer_load_dwordx4 v[40:43], v1, s[4:7], s22 offen offset:2048 sc1
    buffer_load_dwordx4 v[44:47], v1, s[4:7], s22 offen offset:3072 sc1
    s_branch ploop_6_za
ploop_6_zg:
    s_mov_b32 s26, 0
    s_branch ploop_6_zok
ptail_8:
    s_cmp_eq_u32 s15, 0
    s_cbranch_scc1 ptail_8_nd
    s_nop 0
ptail_8_nd:
    s_barrier
    v_add_u32 v55, s68, v61
    ds_read_b128 v[24:27], v55 offset:0
    ds_read_b128 v[28:31], v55 offset:1024
    ds_read_b128 v[32:35], v55 offset:18560
    ds_read_b128 v[36:39], v55 offset:19584
    ds_read_b128 v[40:43], v55 offset:37120
    ds_read_b128 v[44:47], v55 offset:38144
    ds_read_b128 v[48:51], v55 offset:55680
    ds_read_b128 v[52:55], v55 offset:56704
    s_waitcnt lgkmcnt(4)
    v_add_f32 v24, v24, v32
    v_add_f32 v25, v25, v33
    v_add_f32 v26, v26, v34
    v_add_f32 v27, v27, v35
    v_add_f32 v28, v28, v36
    v_add_f32 v29, v29, v37
    v_add_f32 v30, v30, v38
    v_add_f32 v31, v31, v39
    s_waitcnt lgkmcnt(0)
    v_add_f32 v40, v40, v48
    v_add_f32 v41, v41, v49
    v_add_f32 v42, v42, v50
    v_add_f32 v43, v43, v51
    v_add_f32 v44, v44, v52
    v_add_f32 v45, v45, v53
    v_add_f32 v46, v46, v54
    v_add_f32 v47, v47, v55
    v_add_f32 v24, v24, v40
    v_add_f32 v25, v25, v41
    v_add_f32 v26, v26, v42
    v_add_f32 v27, v27, v43
    v_add_f32 v28, v28, v44
    v_add_f32 v29, v29, v45
    v_add_f32 v30, v30, v46
    v_add_f32 v31, v31, v47
    v_cvt_pk_bf16_f32 v24, v24, v25
    v_cvt_pk_bf16_f32 v25, v26, v27
    v_cvt_pk_bf16_f32 v26, v28, v29
    v_cvt_pk_bf16_f32 v27, v30, v31
    v_min_u32 v24, -2, v24
    v_min_u32 v25, -2, v25
    v_min_u32 v26, -2, v26
    v_min_u32 v27, -2, v27
    buffer_store_dwordx4 v[24:27], v1, s[4:7], s37 offen sc1
    s_branch k_end
ch_p_slow:
    v_mov_b32 v32, 0
    v_mov_b32 v33, 0
    v_mov_b32 v34, 0
    v_mov_b32 v35, 0
    v_mov_b32 v36, 0
    v_mov_b32 v37, 0
    v_mov_b32 v38, 0
    v_mov_b32 v39, 0
    v_mov_b32 v40, 0
    v_mov_b32 v41, 0
    v_mov_b32 v42, 0
    v_mov_b32 v43, 0
    v_mov_b32 v44, 0
    v_mov_b32 v45, 0
    v_mov_b32 v46, 0
    v_mov_b32 v47, 0
    v_mov_b32 v48, 0
    v_mov_b32 v49, 0
    v_mov_b32 v50, 0
    v_mov_b32 v51, 0
    v_mov_b32 v52, 0
    v_mov_b32 v53, 0
    v_mov_b32 v54, 0
    v_mov_b32 v55, 0
    v_mov_b32 v0, 1.0
    s_mov_b32 exec_lo, 0xff00ff00
    s_mov_b32 exec_hi, 0xff00ff00
    v_mov_b32 v0, s47
    s_mov_b64 exec, -1
    v_mov_b32 v60, s16
    v_smfmac_f32_16x16x64_bf16 v[32:35], v[16:19], v[64:71], v62
    v_smfmac_f32_16x16x64_bf16 v[36:39], v[16:19], v[72:79], v62
    v_smfmac_f32_16x16x64_bf16 v[40:43], v[16:19], v[80:87], v62
    v_smfmac_f32_16x16x64_bf16 v[44:47], v[16:19], v[88:95], v62
    v_smfmac_f32_16x16x64_bf16 v[48:51], v[16:19], v[96:103], v62
    v_smfmac_f32_16x16x64_bf16 v[52:55], v[16:19], v[104:111], v62
    v_smfmac_f32_16x16x64_bf16 v[32:35], v[20:23], v[112:119], v62
    v_smfmac_f32_16x16x64_bf16 v[36:39], v[20:23], v[120:127], v62
    v_smfmac_f32_16x16x64_bf16 v[40:43], v[20:23], v[128:135], v62
    v_smfmac_f32_16x16x64_bf16 v[44:47], v[20:23], v[136:143], v62
    v_smfmac_f32_16x16x64_bf16 v[48:51], v[20:23], v[144:151], v62
    v_smfmac_f32_16x16x64_bf16 v[52:55], v[20:23], v[152:159], v62
    v_smfmac_f32_16x16x64_bf16 v[32:35], v[24:27], v[160:167], v62
    v_smfmac_f32_16x16x64_bf16 v[36:39], v[24:27], v[168:175], v62
    v_smfmac_f32_16x16x64_bf16 v[40:43], v[24:27], v[176:183], v62
    v_smfmac_f32_16x16x64_bf16 v[44:47], v[24:27], v[184:191], v62
    v_smfmac_f32_16x16x64_bf16 v[48:51], v[24:27], v[192:199], v62
    v_smfmac_f32_16x16x64_bf16 v[52:55], v[24:27], v[200:207], v62
    v_smfmac_f32_16x16x64_bf16 v[32:35], v[28:31], v[208:215], v62
    ds_write_b32 v14, v60
    v_smfmac_f32_16x16x64_bf16 v[36:39], v[28:31], v[216:223], v62
    v_smfmac_f32_16x16x64_bf16 v[40:43], v[28:31], v[224:231], v62
    v_smfmac_f32_16x16x64_bf16 v[44:47], v[28:31], v[232:239], v62
    v_add_f32 v32, v32, v33
    v_add_f32 v34, v34, v35
    v_smfmac_f32_16x16x64_bf16 v[48:51], v[28:31], v[240:247], v62
    v_add_f32 v36, v36, v37
    v_add_f32 v38, v38, v39
    ds_write2_b32 v4, v32, v34 offset0:0 offset1:104
    v_smfmac_f32_16x16x64_bf16 v[52:55], v[28:31], v[248:255], v62
    v_add_f32 v40, v40, v41
    v_add_f32 v42, v42, v43
    ds_write2_b32 v4, v36, v38 offset0:16 offset1:120
    v_add_f32 v44, v44, v45
    v_add_f32 v46, v46, v47
    ds_write2_b32 v4, v40, v42 offset0:32 offset1:136
    v_add_f32 v48, v48, v49
    v_add_f32 v50, v50, v51
    ds_write2_b32 v4, v44, v46 offset0:48 offset1:152
    v_add_f32 v52, v52, v53
    v_add_f32 v54, v54, v55
    ds_write2_b32 v4, v48, v50 offset0:64 offset1:168
    ds_write2_b32 v4, v52, v54 offset0:80 offset1:184
    s_waitcnt vmcnt(0)
    s_branch pnc_16_done
.p2align 6
    s_nop 0
    s_nop 0
    s_nop 0
    s_nop 0
    s_nop 0
    s_nop 0
    s_nop 0
    s_nop 0
ploop_15:
    s_add_u32 s21, s17, s33
    s_nop 15
    s_nop 5
    buffer_load_dwordx4 v[16:19], v1, s[4:7], s21 offen offset:0 sc1
    s_nop 7
    buffer_load_dwordx4 v[20:23], v1, s[4:7], s21 offen offset:1024 sc1
    s_nop 7
    buffer_load_dwordx4 v[24:27], v1, s[4:7], s21 offen offset:2048 sc1
    s_nop 7
    buffer_load_dwordx4 v[28:31], v1, s[4:7], s21 offen offset:3072 sc1
    s_waitcnt vmcnt(3)
    v_max3_u32 v9, v16, v17, v18
    v_max_u32 v9, v9, v19
    v_cmp_eq_u32 vcc, -1, v9
    s_cbranch_vccnz prm_18_0
prm_18_0ok:
    v_smfmac_f32_16x16x64_bf16 v[32:35], v[16:19], v[64:71], v62
    v_smfmac_f32_16x16x64_bf16 v[36:39], v[16:19], v[72:79], v62
    v_smfmac_f32_16x16x64_bf16 v[40:43], v[16:19], v[80:87], v62
    s_waitcnt vmcnt(2)
    v_max3_u32 v9, v20, v21, v22
    v_max_u32 v9, v9, v23
    v_cmp_eq_u32 vcc, -1, v9
    v_smfmac_f32_16x16x64_bf16 v[44:47], v[16:19], v[88:95], v62
    v_smfmac_f32_16x16x64_bf16 v[48:51], v[16:19], v[96:103], v62
    v_smfmac_f32_16x16x64_bf16 v[52:55], v[16:19], v[104:111], v62
    s_cbranch_vccnz prm_18_1
prm_18_1ok:
    v_smfmac_f32_16x16x64_bf16 v[32:35], v[20:23], v[112:119], v62
    v_readfirstlane_b32 s23, v15
    v_smfmac_f32_16x16x64_bf16 v[36:39], v[20:23], v[120:127], v62
    v_smfmac_f32_16x16x64_bf16 v[40:43], v[20:23], v[128:135], v62
    s_waitcnt vmcnt(1)
    v_max3_u32 v9, v24, v25, v26
    v_max_u32 v9, v9, v27
    v_cmp_eq_u32 vcc, -1, v9
    v_smfmac_f32_16x16x64_bf16 v[44:47], v[20:23], v[136:143], v62
    v_smfmac_f32_16x16x64_bf16 v[48:51], v[20:23], v[144:151], v62
    v_smfmac_f32_16x16x64_bf16 v[52:55], v[20:23], v[152:159], v62
    s_cbranch_vccnz prm_18_2
prm_18_2ok:
    v_smfmac_f32_16x16x64_bf16 v[32:35], v[24:27], v[160:167], v62
    v_smfmac_f32_16x16x64_bf16 v[36:39], v[24:27], v[168:175], v62
    v_smfmac_f32_16x16x64_bf16 v[40:43], v[24:27], v[176:183], v62
    s_waitcnt vmcnt(0)
    v_max3_u32 v9, v28, v29, v30
    v_max_u32 v9, v9, v31
    v_cmp_eq_u32 vcc, -1, v9
    v_smfmac_f32_16x16x64_bf16 v[44:47], v[24:27], v[184:191], v62
    v_smfmac_f32_16x16x64_bf16 v[48:51], v[24:27], v[192:199], v62
    v_smfmac_f32_16x16x64_bf16 v[52:55], v[24:27], v[200:207], v62
    s_cbranch_vccnz prm_18_3
prm_18_3ok:
    v_smfmac_f32_16x16x64_bf16 v[32:35], v[28:31], v[208:215], v62
    s_cmp_lt_u32 s23, s59
    s_cbranch_scc1 prm_18_gt
prm_18_gtb:
    ds_write_b32 v14, v60
    v_smfmac_f32_16x16x64_bf16 v[36:39], v[28:31], v[216:223], v62
    v_smfmac_f32_16x16x64_bf16 v[40:43], v[28:31], v[224:231], v62
    v_smfmac_f32_16x16x64_bf16 v[44:47], v[28:31], v[232:239], v62
    v_add_f32 v32, v32, v33
    v_add_f32 v34, v34, v35
    v_smfmac_f32_16x16x64_bf16 v[48:51], v[28:31], v[240:247], v62
    v_add_f32 v36, v36, v37
    v_add_f32 v38, v38, v39
    ds_write2_b32 v4, v32, v34 offset0:0 offset1:104
    v_smfmac_f32_16x16x64_bf16 v[52:55], v[28:31], v[248:255], v62
    v_add_f32 v40, v40, v41
    v_add_f32 v42, v42, v43
    ds_write2_b32 v4, v36, v38 offset0:16 offset1:120
    v_add_f32 v44, v44, v45
    v_add_f32 v46, v46, v47
    ds_write2_b32 v4, v40, v42 offset0:32 offset1:136
    v_add_f32 v48, v48, v49
    v_add_f32 v50, v50, v51
    ds_write2_b32 v4, v44, v46 offset0:48 offset1:152
    v_add_f32 v52, v52, v53
    v_add_f32 v54, v54, v55
    ds_write2_b32 v4, v48, v50 offset0:64 offset1:168
    ds_write2_b32 v4, v52, v54 offset0:80 offset1:184
pnc_16_done:
    s_add_u32 s21, s17, s32
    s_add_u32 s22, s19, s32
    s_add_u32 s24, s19, s35
    s_waitcnt lgkmcnt(0)
    s_barrier
    ds_read_b64 v[32:33], v5 offset:0
    ds_read_b64 v[34:35], v5 offset:3328
    ds_read_b64 v[36:37], v5 offset:6656
    ds_read_b64 v[38:39], v5 offset:9984
    ds_read_b64 v[40:41], v6 offset:0
    ds_read_b64 v[42:43], v6 offset:3328
    ds_read_b64 v[44:45], v6 offset:6656
    ds_read_b64 v[46:47], v6 offset:9984
    s_waitcnt lgkmcnt(6)
    v_add_f32 v32, v32, v34
    v_add_f32 v33, v33, v35
    v_mul_f32 v32, v32, v0
    v_mul_f32 v33, v33, v0
    s_waitcnt lgkmcnt(4)
    v_add_f32 v36, v36, v38
    v_add_f32 v37, v37, v39
    v_fma_f32 v32, v36, v0, v32
    v_fma_f32 v33, v37, v0, v33
    v_cvt_pk_bf16_f32 v32, v32, v33
    v_min_u32 v32, -2, v32
    buffer_store_dword v32, v2, s[4:7], s21 offen sc1
    s_waitcnt lgkmcnt(2)
    v_add_f32 v40, v40, v42
    v_add_f32 v41, v41, v43
    s_waitcnt lgkmcnt(0)
    v_add_f32 v44, v44, v46
    v_add_f32 v45, v45, v47
    v_add_f32 v40, v40, v44
    v_add_f32 v41, v41, v45
    v_cvt_pk_bf16_f32 v40, v40, v41
    v_min_u32 v40, -2, v40
    s_mov_b32 exec_hi, 0
    buffer_store_dword v40, v3, s[4:7], s21 offen sc1
    s_setprio 0
    s_mov_b64 exec, -1
    s_add_u32 s21, s17, s35
    s_add_u32 s30, s17, s34
    s_add_u32 s23, s18, s36
    s_cmp_lg_u32 s16, 0
    s_cbranch_scc1 ploop_15_n0
gate_20:
    v_readfirstlane_b32 s25, v15
    s_cmp_ge_u32 s25, s59
    s_cbranch_scc1 gate_20_ok
    s_sleep 8
    buffer_load_dword v15, off, s[4:7], s58 sc1
    s_waitcnt vmcnt(0)
    s_sub_u32 s26, s26, 1
    s_cbranch_scc0 gate_20
    s_mov_b32 s26, 0
gate_20_ok:
    s_cmp_eq_u32 s15, 0
    s_cbranch_scc1 ploop_15_st_nk
    s_add_u32 m0, s53, 0
    s_add_u32 s22, s52, 0
    buffer_load_dwordx4 v1, s[4:7], s22 offen offset:0 sc1 lds
    buffer_load_dwordx4 v1, s[4:7], s22 offen offset:1024 sc1 lds
    buffer_load_dwordx4 v1, s[4:7], s22 offen offset:2048 sc1 lds
    buffer_load_dwordx4 v1, s[4:7], s22 offen offset:3072 sc1 lds
    s_add_u32 m0, s53, 4096
    s_add_u32 s22, s52, 131072
    buffer_load_dwordx4 v1, s[4:7], s22 offen offset:0 sc1 lds
    buffer_load_dwordx4 v1, s[4:7], s22 offen offset:1024 sc1 lds
    buffer_load_dwordx4 v1, s[4:7], s22 offen offset:2048 sc1 lds
    buffer_load_dwordx4 v1, s[4:7], s22 offen offset:3072 sc1 lds
    s_add_u32 s52, s52, 262144
    s_sub_u32 s52, s52, 262144
ploop_15_st_nk:
    s_add_u32 s52, s52, 262144
    s_cmp_lg_u32 s3, 2
    s_cbranch_scc1 ploop_15_st_npf
    v_subrev_u32 v32, 786432, v63
    s_mov_b32 exec_hi, 0xffff
    s_mov_b32 s22, 262144
    buffer_load_dword v33, v32, s[4:7], s22 offen sc1
    s_mov_b32 s22, 524288
    buffer_load_dword v33, v32, s[4:7], s22 offen sc1
    s_mov_b32 exec_hi, -1
    s_waitcnt vmcnt(0)
ploop_15_st_npf:
    s_cmp_eq_u32 s15, 0
    s_cbranch_scc1 ploop_15_st_p_nd
    s_mov_b32 m0, 124928
    s_nop 0
    buffer_load_dwordx4 v1, s[4:7], s69 offen offset:0 sc1 lds
    buffer_load_dwordx4 v1, s[4:7], s69 offen offset:1024 sc1 lds
    buffer_load_dwordx4 v1, s[4:7], s69 offen offset:2048 sc1 lds
    buffer_load_dwordx4 v1, s[4:7], s69 offen offset:3072 sc1 lds
    s_add_u32 s69, s69, 262144
    s_waitcnt vmcnt(0)
ploop_15_st_p_nd:
ploop_15_n0:
    s_add_u32 s25, s16, 2
    s_min_u32 s25, s25, 63
    s_cmp_lt_u32 s25, 8
    s_cselect_b32 s59, 12, 24
    s_cselect_b32 s58, -4, -8
    s_and_b32 s25, s25, s58
    s_lshl_b32 s25, s25, 5
    s_add_u32 s58, s25, s60
    s_cmp_eq_u32 s15, 0
    s_cbranch_scc1 ploop_15_nd
    v_add_u32 v9, s53, v1
    v_add_u32 v0, 124928, v1
    ds_read_b128 v[16:19], v0 offset:0
    ds_read_b128 v[32:35], v9 offset:0
    ds_read_b128 v[20:23], v0 offset:1024
    ds_read_b128 v[36:39], v9 offset:1024
    ds_read_b128 v[24:27], v0 offset:2048
    ds_read_b128 v[40:43], v9 offset:2048
    ds_read_b128 v[28:31], v0 offset:3072
    ds_read_b128 v[44:47], v9 offset:3072
    s_add_u32 s22, s17, s61
    s_waitcnt lgkmcnt(6)
    v_mfma_f32_16x16x32_bf16 v[48:51], v[32:35], v[16:19], 0
    ds_read_b128 v[32:35], v9 offset:4096
    s_waitcnt lgkmcnt(5)
    v_mfma_f32_16x16x32_bf16 v[48:51], v[36:39], v[20:23], v[48:51]
    ds_read_b128 v[36:39], v9 offset:5120
    s_waitcnt lgkmcnt(4)
    v_mfma_f32_16x16x32_bf16 v[48:51], v[40:43], v[24:27], v[48:51]
    ds_read_b128 v[40:43], v9 offset:6144
    s_waitcnt lgkmcnt(3)
    v_mfma_f32_16x16x32_bf16 v[48:51], v[44:47], v[28:31], v[48:51]
    ds_read_b128 v[44:47], v9 offset:7168
    s_waitcnt lgkmcnt(3)
    v_mfma_f32_16x16x32_bf16 v[52:55], v[32:35], v[16:19], 0
    s_waitcnt lgkmcnt(2)
    v_mfma_f32_16x16x32_bf16 v[52:55], v[36:39], v[20:23], v[52:55]
    s_waitcnt lgkmcnt(1)
    v_mfma_f32_16x16x32_bf16 v[52:55], v[40:43], v[24:27], v[52:55]
    s_waitcnt lgkmcnt(0)
    v_mfma_f32_16x16x32_bf16 v[52:55], v[44:47], v[28:31], v[52:55]
    buffer_load_dwordx4 v[32:35], v1, s[4:7], s22 offen offset:0 sc1
    buffer_load_dwordx4 v[36:39], v1, s[4:7], s22 offen offset:1024 sc1
    buffer_load_dwordx4 v[40:43], v1, s[4:7], s22 offen offset:2048 sc1
    buffer_load_dwordx4 v[44:47], v1, s[4:7], s22 offen offset:3072 sc1
    v_mov_b32 v60, 0xff61b1e6
    s_nop 2
    v_cndmask_b32 v48, v48, v60, s[38:39]
    v_cndmask_b32 v49, v49, v60, s[40:41]
    v_cndmask_b32 v50, v50, v60, s[42:43]
    v_cndmask_b32 v51, v51, v60, s[44:45]
    v_cndmask_b32 v52, v52, v60, s[48:49]
    v_cndmask_b32 v53, v53, v60, s[50:51]
    v_cndmask_b32 v54, v54, v60, s[54:55]
    v_cndmask_b32 v55, v55, v60, s[56:57]
    v_max3_f32 v0, v48, v49, v50
    v_max3_f32 v9, v51, v52, v53
    v_max3_f32 v0, v0, v54, v55
    v_max_f32 v0, v0, v9
    v_mov_b32 v9, v0
    s_nop 1
    v_permlane16_swap_b32 v9, v0
    v_max_f32 v0, v0, v9
    v_mov_b32 v9, v0
    s_nop 1
    v_permlane32_swap_b32 v9, v0
    v_max_f32 v0, v0, v9
    v_mul_f32 v0, s47, v0
    v_fma_f32 v48, v48, s47, -v0
    v_fma_f32 v49, v49, s47, -v0
    v_fma_f32 v50, v50, s47, -v0
    v_fma_f32 v51, v51, s47, -v0
    v_fma_f32 v52, v52, s47, -v0
    v_fma_f32 v53, v53, s47, -v0
    v_fma_f32 v54, v54, s47, -v0
    v_fma_f32 v55, v55, s47, -v0
    v_exp_f32 v48, v48
    v_exp_f32 v49, v49
    v_exp_f32 v50, v50
    v_exp_f32 v51, v51
    v_exp_f32 v52, v52
    v_exp_f32 v53, v53
    v_exp_f32 v54, v54
    v_exp_f32 v55, v55
    v_add_f32 v15, v48, v49
    v_add_f32 v15, v15, v50
    v_add_f32 v15, v15, v51
    v_add_f32 v15, v15, v52
    v_add_f32 v15, v15, v53
    v_add_f32 v15, v15, v54
    v_add_f32 v15, v15, v55
ploop_15_za:
    s_waitcnt vmcnt(0)
    v_max3_u32 v9, v32, v33, v34
    v_max3_u32 v9, v9, v35, v36
    v_max3_u32 v9, v9, v37, v38
    v_max3_u32 v9, v9, v39, v40
    v_max3_u32 v9, v9, v41, v42
    v_max3_u32 v9, v9, v43, v44
    v_max3_u32 v9, v9, v45, v46
    v_max_u32 v9, v9, v47
    v_cmp_eq_u32 vcc, -1, v9
    s_cbranch_vccnz ploop_15_zr
ploop_15_zok:
    v_mfma_f32_16x16x32_bf16 v[56:59], v[32:35], v[16:19], 0
    v_mfma_f32_16x16x32_bf16 v[56:59], v[36:39], v[20:23], v[56:59]
    v_mfma_f32_16x16x32_bf16 v[56:59], v[40:43], v[24:27], v[56:59]
    v_mfma_f32_16x16x32_bf16 v[56:59], v[44:47], v[28:31], v[56:59]
    s_add_u32 s22, s17, s14
    s_nop 6
    v_max_f32 v60, v56, v57
    v_mov_b32 v9, v60
    s_nop 1
    v_permlane16_swap_b32 v9, v60
    v_max_f32 v60, v60, v9
    v_mov_b32 v9, v60
    s_nop 1
    v_permlane32_swap_b32 v9, v60
    v_max_f32 v60, v60, v9
    v_mul_f32 v60, s47, v60
    v_max_f32 v58, v60, v0
    v_sub_f32 v60, v0, v58
    v_fma_f32 v56, v56, s47, -v58
    v_fma_f32 v57, v57, s47, -v58
    v_exp_f32 v60, v60
    v_exp_f32 v56, v56
    v_exp_f32 v57, v57
    v_fma_f32 v15, v15, v60, v56
    v_add_f32 v15, v15, v57
    v_mov_b32 v9, v15
    s_nop 1
    v_permlane16_swap_b32 v9, v15
    v_add_f32 v15, v15, v9
    v_mov_b32 v9, v15
    s_nop 1
    v_permlane32_swap_b32 v9, v15
    v_add_f32 v15, v15, v9
    v_rcp_f32 v15, v15
    s_add_u32 s25, s19, s14
    v_mul_f32 v56, v56, v15
    v_mul_f32 v57, v57, v15
    v_mul_f32 v60, v60, v15
    v_mul_f32 v48, v48, v60
    v_mul_f32 v49, v49, v60
    v_mul_f32 v50, v50, v60
    v_mul_f32 v51, v51, v60
    v_mul_f32 v52, v52, v60
    v_mul_f32 v53, v53, v60
    v_mul_f32 v54, v54, v60
    v_mul_f32 v55, v55, v60
    v_cvt_pk_bf16_f32 v48, v48, v49
    v_cvt_pk_bf16_f32 v49, v50, v51
    v_cvt_pk_bf16_f32 v50, v52, v53
    v_cvt_pk_bf16_f32 v51, v54, v55
    v_min_u32 v48, -2, v48
    v_min_u32 v49, -2, v49
    v_min_u32 v50, -2, v50
    v_min_u32 v51, -2, v51
    v_lshlrev_b32 v54, 1, v8
    v_add_u32 v55, 14336, v1
    v_mov_b32 v53, 1.0
    v_cvt_pk_bf16_f32 v52, v56, v57
    v_min_u32 v53, -2, v53
    v_min_u32 v52, -2, v52
    buffer_store_dwordx4 v[48:51], v1, s[4:7], s22 offen sc1
    buffer_store_dwordx2 v[52:53], v54, s[4:7], s22 offen offset:1024 sc1
    ds_read_b128 v[56:59], v55
    s_branch ploop_15_nd2
ploop_15_nd:
    s_cmp_eq_u32 s16, 0
    s_cbranch_scc1 ploop_15_ns
    s_cmp_eq_u32 s31, 0
    s_cbranch_scc1 ploop_15_n2
    s_add_u32 s25, s68, s46
    v_add_u32 v55, s25, v61
    ds_read_b128 v[24:27], v55 offset:0
    ds_read_b128 v[28:31], v55 offset:1024
    ds_read_b128 v[32:35], v55 offset:18560
    ds_read_b128 v[36:39], v55 offset:19584
    ds_read_b128 v[40:43], v55 offset:37120
    ds_read_b128 v[44:47], v55 offset:38144
    ds_read_b128 v[48:51], v55 offset:55680
    ds_read_b128 v[52:55], v55 offset:56704
    s_waitcnt lgkmcnt(4)
    v_add_f32 v24, v24, v32
    v_add_f32 v25, v25, v33
    v_add_f32 v26, v26, v34
    v_add_f32 v27, v27, v35
    v_add_f32 v28, v28, v36
    v_add_f32 v29, v29, v37
    v_add_f32 v30, v30, v38
    v_add_f32 v31, v31, v39
    s_waitcnt lgkmcnt(0)
    v_add_f32 v40, v40, v48
    v_add_f32 v41, v41, v49
    v_add_f32 v42, v42, v50
    v_add_f32 v43, v43, v51
    v_add_f32 v44, v44, v52
    v_add_f32 v45, v45, v53
    v_add_f32 v46, v46, v54
    v_add_f32 v47, v47, v55
    v_add_f32 v24, v24, v40
    v_add_f32 v25, v25, v41
    v_add_f32 v26, v26, v42
    v_add_f32 v27, v27, v43
    v_add_f32 v28, v28, v44
    v_add_f32 v29, v29, v45
    v_add_f32 v30, v30, v46
    v_add_f32 v31, v31, v47
    v_cvt_pk_bf16_f32 v24, v24, v25
    v_cvt_pk_bf16_f32 v25, v26, v27
    v_cvt_pk_bf16_f32 v26, v28, v29
    v_cvt_pk_bf16_f32 v27, v30, v31
    v_min_u32 v24, -2, v24
    v_min_u32 v25, -2, v25
    v_min_u32 v26, -2, v26
    v_min_u32 v27, -2, v27
    v_mov_b32 v16, v24
    v_mov_b32 v17, v25
    v_mov_b32 v18, v26
    v_mov_b32 v19, v27
ploop_15_n2:
    v_add_u32 v55, s68, v61
    ds_read_b128 v[24:27], v55 offset:0
    ds_read_b128 v[28:31], v55 offset:1024
    ds_read_b128 v[32:35], v55 offset:18560
    ds_read_b128 v[36:39], v55 offset:19584
    ds_read_b128 v[40:43], v55 offset:37120
    ds_read_b128 v[44:47], v55 offset:38144
    ds_read_b128 v[48:51], v55 offset:55680
    ds_read_b128 v[52:55], v55 offset:56704
    s_waitcnt lgkmcnt(4)
    v_add_f32 v24, v24, v32
    v_add_f32 v25, v25, v33
    v_add_f32 v26, v26, v34
    v_add_f32 v27, v27, v35
    v_add_f32 v28, v28, v36
    v_add_f32 v29, v29, v37
    v_add_f32 v30, v30, v38
    v_add_f32 v31, v31, v39
    s_waitcnt lgkmcnt(0)
    v_add_f32 v40, v40, v48
    v_add_f32 v41, v41, v49
    v_add_f32 v42, v42, v50
    v_add_f32 v43, v43, v51
    v_add_f32 v44, v44, v52
    v_add_f32 v45, v45, v53
    v_add_f32 v46, v46, v54
    v_add_f32 v47, v47, v55
    v_add_f32 v24, v24, v40
    v_add_f32 v25, v25, v41
    v_add_f32 v26, v26, v42
    v_add_f32 v27, v27, v43
    v_add_f32 v28, v28, v44
    v_add_f32 v29, v29, v45
    v_add_f32 v30, v30, v46
    v_add_f32 v31, v31, v47
    v_cvt_pk_bf16_f32 v24, v24, v25
    v_cvt_pk_bf16_f32 v25, v26, v27
    v_cvt_pk_bf16_f32 v26, v28, v29
    v_cvt_pk_bf16_f32 v27, v30, v31
    v_min_u32 v24, -2, v24
    v_min_u32 v25, -2, v25
    v_min_u32 v26, -2, v26
    v_min_u32 v27, -2, v27
ploop_15_ns:
ploop_15_flag:
    ds_read_b32 v9, v14 offset:16
    s_waitcnt lgkmcnt(0)
    v_readfirstlane_b32 s25, v9
    s_cmp_eq_u32 s25, s16
    s_cbranch_scc0 ploop_15_flag
    s_add_u32 m0, s53, 0
    s_add_u32 s22, s52, 0
    buffer_load_dwordx4 v1, s[4:7], s22 offen offset:0 sc1 lds
    buffer_load_dwordx4 v1, s[4:7], s22 offen offset:1024 sc1 lds
    buffer_load_dwordx4 v1, s[4:7], s22 offen offset:2048 sc1 lds
    buffer_load_dwordx4 v1, s[4:7], s22 offen offset:3072 sc1 lds
    s_add_u32 m0, s53, 4096
    s_add_u32 s22, s52, 131072
    buffer_load_dwordx4 v1, s[4:7], s22 offen offset:0 sc1 lds
    buffer_load_dwordx4 v1, s[4:7], s22 offen offset:1024 sc1 lds
    buffer_load_dwordx4 v1, s[4:7], s22 offen offset:2048 sc1 lds
    buffer_load_dwordx4 v1, s[4:7], s22 offen offset:3072 sc1 lds
    s_add_u32 s52, s52, 262144
ploop_15_nk:
    s_cmp_eq_u32 s16, 0
    s_cbranch_scc1 ploop_15_nd2
    buffer_store_dwordx4 v[24:27], v1, s[4:7], s37 offen sc1
    s_cmp_eq_u32 s31, 0
    s_cbranch_scc1 ploop_15_nd2
    s_add_u32 s25, s37, s27
    buffer_store_dwordx4 v[16:19], v1, s[4:7], s25 offen sc1
ploop_15_nd2:
    s_cmp_eq_u32 s16, 0
    s_cbranch_scc1 ploop_15_nn
    s_add_u32 s37, s37, 65536
    s_xor_b32 s68, s68, 8192
ploop_15_nn:
    s_cmp_lg_u32 s3, 2
    s_cbranch_scc1 ppf_21
    s_lshl_b32 s22, s16, 18
    s_mov_b32 exec_hi, 0xffff
    buffer_load_dword v9, v63, s[4:7], s22 offen sc1
    s_mov_b32 exec_hi, -1
ppf_21:
    v_add_u32 v24, 18560, v7
    v_add_u32 v25, 37120, v7
    v_add_u32 v26, 55680, v7
    s_cmp_eq_u32 s16, 63
    s_setprio 3
    s_barrier
    s_cbranch_scc1 ptail_17
    ds_read2_b32 v[16:17], v7 offset0:0 offset1:2
    ds_read2_b32 v[18:19], v24 offset0:0 offset1:2
    ds_read2_b32 v[20:21], v25 offset0:0 offset1:2
    ds_read2_b32 v[22:23], v26 offset0:0 offset1:2
    s_waitcnt lgkmcnt(2)
    v_add_f32 v16, v16, v18
    v_add_f32 v17, v17, v19
    s_waitcnt lgkmcnt(0)
    v_add_f32 v20, v20, v22
    v_add_f32 v21, v21, v23
    v_add_f32 v16, v16, v20
    v_add_f32 v17, v17, v21
    v_cvt_pk_bf16_f32 v16, v16, v17
    v_min_u32 v16, -2, v16
    buffer_store_dword v16, v2, s[4:7], s21 offen sc1
    buffer_store_dword v10, v2, s[4:7], s24 offen sc1
    s_cmp_eq_u32 s15, 0
    s_cbranch_scc1 ploop_15_pnd
    s_sleep 6
    s_nop 8
    buffer_load_dwordx4 v[16:19], v12, s[4:7], s30 offen sc1
    buffer_load_dword v15, off, s[4:7], s58 sc1
    s_add_u32 s25, s19, s14
    v_mov_b32 v20, -1
    v_mov_b32 v21, -1
    v_mov_b32 v22, -1
    v_mov_b32 v23, -1
    buffer_store_dwordx4 v[20:23], v1, s[4:7], s25 offen sc1
    buffer_store_dwordx2 v[20:21], v54, s[4:7], s25 offen offset:1024 sc1
    s_mov_b32 m0, 124928
    s_nop 0
    buffer_load_dwordx4 v1, s[4:7], s69 offen offset:0 sc1 lds
    buffer_load_dwordx4 v1, s[4:7], s69 offen offset:1024 sc1 lds
    buffer_load_dwordx4 v1, s[4:7], s69 offen offset:2048 sc1 lds
    buffer_load_dwordx4 v1, s[4:7], s69 offen offset:3072 sc1 lds
    s_add_u32 s69, s69, 262144
    s_add_u32 m0, s53, 0
    s_add_u32 s22, s52, 0
    buffer_load_dwordx4 v1, s[4:7], s22 offen offset:0 sc1 lds
    buffer_load_dwordx4 v1, s[4:7], s22 offen offset:1024 sc1 lds
    buffer_load_dwordx4 v1, s[4:7], s22 offen offset:2048 sc1 lds
    buffer_load_dwordx4 v1, s[4:7], s22 offen offset:3072 sc1 lds
    s_add_u32 m0, s53, 4096
    s_add_u32 s22, s52, 131072
    buffer_load_dwordx4 v1, s[4:7], s22 offen offset:0 sc1 lds
    buffer_load_dwordx4 v1, s[4:7], s22 offen offset:1024 sc1 lds
    buffer_load_dwordx4 v1, s[4:7], s22 offen offset:2048 sc1 lds
    buffer_load_dwordx4 v1, s[4:7], s22 offen offset:3072 sc1 lds
    s_add_u32 s52, s52, 262144
    s_add_u32 s22, s16, 1
    v_mov_b32 v60, s22
    v_mov_b32 v32, 0
    v_mov_b32 v33, 0
    v_mov_b32 v34, 0
    v_mov_b32 v35, 0
    v_mov_b32 v36, 0
    v_mov_b32 v37, 0
    v_mov_b32 v38, 0
    v_mov_b32 v39, 0
    v_mov_b32 v40, 0
    v_mov_b32 v41, 0
    v_mov_b32 v42, 0
    v_mov_b32 v43, 0
    v_mov_b32 v44, 0
    v_mov_b32 v45, 0
    v_mov_b32 v46, 0
    v_mov_b32 v47, 0
    v_mov_b32 v48, 0
    v_mov_b32 v49, 0
    v_mov_b32 v50, 0
    v_mov_b32 v51, 0
    v_mov_b32 v52, 0
    v_mov_b32 v53, 0
    v_mov_b32 v54, 0
    v_mov_b32 v55, 0
    v_mov_b32 v0, 1.0
    s_mov_b32 exec_lo, 0xff00ff00
    s_mov_b32 exec_hi, 0xff00ff00
    v_mov_b32 v0, s47
    s_mov_b64 exec, -1
    s_waitcnt vmcnt(15) lgkmcnt(0)
    v_mfma_f32_16x16x32_bf16 v[20:23], v[56:59], v[16:19], 0
    v_max3_u32 v9, v16, v17, v18
    v_max_u32 v9, v9, v19
    v_cmp_eq_u32 vcc, -1, v9
    s_cbranch_vccnz prp_19
    s_nop 3
    v_add_f32_dpp v20, v20, v20 row_ror:8 row_mask:0xf bank_mask:0xf
    v_add_f32_dpp v21, v21, v21 row_ror:8 row_mask:0xf bank_mask:0xf
    v_add_f32_dpp v22, v22, v22 row_ror:8 row_mask:0xf bank_mask:0xf
    v_add_f32_dpp v23, v23, v23 row_ror:8 row_mask:0xf bank_mask:0xf
    v_cvt_pk_bf16_f32 v20, v20, v21
    v_cvt_pk_bf16_f32 v21, v22, v23
    s_mov_b32 exec_hi, 0
    v_min_u32 v20, -2, v20
    v_min_u32 v21, -2, v21
    s_mov_b32 exec_lo, 0x00ff00ff
    buffer_store_dwordx2 v[20:21], v13, s[4:7], s23 offen sc1
    s_mov_b64 exec, -1
    s_branch ploop_15_pst
ploop_15_pnd:
    s_sleep 6
    s_nop 8
    buffer_load_dwordx4 v[16:19], v12, s[4:7], s30 offen sc1
    buffer_load_dword v15, off, s[4:7], s58 sc1
    s_add_u32 s22, s16, 1
    v_mov_b32 v60, s22
    v_mov_b32 v32, 0
    v_mov_b32 v33, 0
    v_mov_b32 v34, 0
    v_mov_b32 v35, 0
    v_mov_b32 v36, 0
    v_mov_b32 v37, 0
    v_mov_b32 v38, 0
    v_mov_b32 v39, 0
    v_mov_b32 v40, 0
    v_mov_b32 v41, 0
    v_mov_b32 v42, 0
    v_mov_b32 v43, 0
    v_mov_b32 v44, 0
    v_mov_b32 v45, 0
    v_mov_b32 v46, 0
    v_mov_b32 v47, 0
    v_mov_b32 v48, 0
    v_mov_b32 v49, 0
    v_mov_b32 v50, 0
    v_mov_b32 v51, 0
    v_mov_b32 v52, 0
    v_mov_b32 v53, 0
    v_mov_b32 v54, 0
    v_mov_b32 v55, 0
    v_mov_b32 v0, 1.0
    s_mov_b32 exec_lo, 0xff00ff00
    s_mov_b32 exec_hi, 0xff00ff00
    v_mov_b32 v0, s47
    s_mov_b64 exec, -1
ploop_15_pagain:
    s_waitcnt vmcnt(1) lgkmcnt(0)
    v_mfma_f32_16x16x32_bf16 v[20:23], v[56:59], v[16:19], 0
    v_max3_u32 v9, v16, v17, v18
    v_max_u32 v9, v9, v19
    v_cmp_eq_u32 vcc, -1, v9
    s_cbranch_vccnz prp_19
ploop_15_pgo:
    s_nop 3
    v_add_f32_dpp v20, v20, v20 row_ror:8 row_mask:0xf bank_mask:0xf
    v_add_f32_dpp v21, v21, v21 row_ror:8 row_mask:0xf bank_mask:0xf
    v_add_f32_dpp v22, v22, v22 row_ror:8 row_mask:0xf bank_mask:0xf
    v_add_f32_dpp v23, v23, v23 row_ror:8 row_mask:0xf bank_mask:0xf
    v_cvt_pk_bf16_f32 v20, v20, v21
    v_cvt_pk_bf16_f32 v21, v22, v23
    s_mov_b32 exec_hi, 0
    v_min_u32 v20, -2, v20
    v_min_u32 v21, -2, v21
    s_mov_b32 exec_lo, 0x00ff00ff
    buffer_store_dwordx2 v[20:21], v13, s[4:7], s23 offen sc1
    s_mov_b64 exec, -1
ploop_15_pst:
    s_add_u32 s22, s19, s32
    s_add_u32 s25, s20, s36
    buffer_store_dword v10, v2, s[4:7], s22 offen sc1
    s_mov_b32 exec_hi, 0
    buffer_store_dword v10, v3, s[4:7], s22 offen sc1
    s_mov_b32 exec_lo, 0x00ff00ff
    buffer_store_dwordx2 v[10:11], v13, s[4:7], s25 offen sc1
    s_mov_b64 exec, -1
    s_add_u32 s16, s16, 1
    s_mov_b32 s17, s18
    s_mov_b32 s18, s19
    s_mov_b32 s19, s20
    s_add_u32 s20, s20, 262144
    s_cmp_eq_u32 s20, 210763776
    s_cselect_b32 s20, 209715200, s20
    s_branch ploop_15
prm_18_gt:
gate_22:
    v_readfirstlane_b32 s25, v15
    s_cmp_ge_u32 s25, s59
    s_cbranch_scc1 gate_22_ok
    s_sleep 8
    buffer_load_dword v15, off, s[4:7], s58 sc1
    s_waitcnt vmcnt(0)
    s_sub_u32 s26, s26, 1
    s_cbranch_scc0 gate_22
    s_mov_b32 s26, 0
gate_22_ok:
    s_branch prm_18_gtb
prm_18_0:
    s_sub_u32 s26, s26, 1
    s_cbranch_scc1 prm_18_0_g
    buffer_load_dwordx4 v[16:19], v1, s[4:7], s21 offen offset:0 sc1
    buffer_load_dwordx4 v[20:23], v1, s[4:7], s21 offen offset:1024 sc1
    buffer_load_dwordx4 v[24:27], v1, s[4:7], s21 offen offset:2048 sc1
    buffer_load_dwordx4 v[28:31], v1, s[4:7], s21 offen offset:3072 sc1
    s_waitcnt vmcnt(3)
    v_max3_u32 v9, v16, v17, v18
    v_max_u32 v9, v9, v19
    v_cmp_eq_u32 vcc, -1, v9
    s_cbranch_vccnz prm_18_0
    s_branch prm_18_0ok
prm_18_0_g:
    s_mov_b32 s26, 0
    s_waitcnt vmcnt(0)
    s_branch prm_18_0ok
prm_18_1:
    s_sub_u32 s26, s26, 1
    s_cbranch_scc1 prm_18_1_g
    buffer_load_dwordx4 v[20:23], v1, s[4:7], s21 offen offset:1024 sc1
    buffer_load_dwordx4 v[24:27], v1, s[4:7], s21 offen offset:2048 sc1
    buffer_load_dwordx4 v[28:31], v1, s[4:7], s21 offen offset:3072 sc1
    s_waitcnt vmcnt(2)
    v_max3_u32 v9, v20, v21, v22
    v_max_u32 v9, v9, v23
    v_cmp_eq_u32 vcc, -1, v9
    s_cbranch_vccnz prm_18_1
    s_branch prm_18_1ok
prm_18_1_g:
    s_mov_b32 s26, 0
    s_waitcnt vmcnt(0)
    s_branch prm_18_1ok
prm_18_2:
    s_sub_u32 s26, s26, 1
    s_cbranch_scc1 prm_18_2_g
    buffer_load_dwordx4 v[24:27], v1, s[4:7], s21 offen offset:2048 sc1
    buffer_load_dwordx4 v[28:31], v1, s[4:7], s21 offen offset:3072 sc1
    s_waitcnt vmcnt(1)
    v_max3_u32 v9, v24, v25, v26
    v_max_u32 v9, v9, v27
    v_cmp_eq_u32 vcc, -1, v9
    s_cbranch_vccnz prm_18_2
    s_branch prm_18_2ok
prm_18_2_g:
    s_mov_b32 s26, 0
    s_waitcnt vmcnt(0)
    s_branch prm_18_2ok
prm_18_3:
    s_sub_u32 s26, s26, 1
    s_cbranch_scc1 prm_18_3_g
    buffer_load_dwordx4 v[28:31], v1, s[4:7], s21 offen offset:3072 sc1
    s_waitcnt vmcnt(0)
    v_max3_u32 v9, v28, v29, v30
    v_max_u32 v9, v9, v31
    v_cmp_eq_u32 vcc, -1, v9
    s_cbranch_vccnz prm_18_3
    s_branch prm_18_3ok
prm_18_3_g:
    s_mov_b32 s26, 0
    s_waitcnt vmcnt(0)
    s_branch prm_18_3ok
prm_18_d:
gate_23:
    v_readfirstlane_b32 s25, v15
    s_cmp_ge_u32 s25, s59
    s_cbranch_scc1 gate_23_ok
    s_sleep 8
    buffer_load_dword v15, off, s[4:7], s58 sc1
    s_waitcnt vmcnt(0)
    s_sub_u32 s26, s26, 1
    s_cbranch_scc0 gate_23
    s_mov_b32 s26, 0
gate_23_ok:
    ds_write_b32 v14, v60
    v_add_f32 v32, v32, v33
    v_add_f32 v34, v34, v35
    ds_write2_b32 v4, v32, v34 offset0:0 offset1:104
    v_add_f32 v36, v36, v37
    v_add_f32 v38, v38, v39
    ds_write2_b32 v4, v36, v38 offset0:16 offset1:120
    v_add_f32 v40, v40, v41
    v_add_f32 v42, v42, v43
    ds_write2_b32 v4, v40, v42 offset0:32 offset1:136
    v_add_f32 v44, v44, v45
    v_add_f32 v46, v46, v47
    ds_write2_b32 v4, v44, v46 offset0:48 offset1:152
    v_add_f32 v48, v48, v49
    v_add_f32 v50, v50, v51
    ds_write2_b32 v4, v48, v50 offset0:64 offset1:168
    v_add_f32 v52, v52, v53
    v_add_f32 v54, v54, v55
    ds_write2_b32 v4, v52, v54 offset0:80 offset1:184
    s_branch pnc_16_done
prp_19:
    s_sub_u32 s26, s26, 1
    s_nop 3
    s_cbranch_scc1 prp_19_g
    buffer_load_dwordx4 v[16:19], v12, s[4:7], s30 offen sc1
    buffer_load_dword v15, off, s[4:7], s58 sc1
    s_branch ploop_15_pagain
prp_19_g:
    s_mov_b32 s26, 0
    s_branch ploop_15_pgo
ploop_15_zr:
    s_sub_u32 s26, s26, 1
    s_cbranch_scc1 ploop_15_zg
    buffer_load_dwordx4 v[32:35], v1, s[4:7], s22 offen offset:0 sc1
    buffer_load_dwordx4 v[36:39], v1, s[4:7], s22 offen offset:1024 sc1
    buffer_load_dwordx4 v[40:43], v1, s[4:7], s22 offen offset:2048 sc1
    buffer_load_dwordx4 v[44:47], v1, s[4:7], s22 offen offset:3072 sc1
    s_branch ploop_15_za
ploop_15_zg:
    s_mov_b32 s26, 0
    s_branch ploop_15_zok
ptail_17:
    s_cmp_eq_u32 s15, 0
    s_cbranch_scc1 ptail_17_nd
    s_nop 0
ptail_17_nd:
    s_barrier
    v_add_u32 v55, s68, v61
    ds_read_b128 v[24:27], v55 offset:0
    ds_read_b128 v[28:31], v55 offset:1024
    ds_read_b128 v[32:35], v55 offset:18560
    ds_read_b128 v[36:39], v55 offset:19584
    ds_read_b128 v[40:43], v55 offset:37120
    ds_read_b128 v[44:47], v55 offset:38144
    ds_read_b128 v[48:51], v55 offset:55680
    ds_read_b128 v[52:55], v55 offset:56704
    s_waitcnt lgkmcnt(4)
    v_add_f32 v24, v24, v32
    v_add_f32 v25, v25, v33
    v_add_f32 v26, v26, v34
    v_add_f32 v27, v27, v35
    v_add_f32 v28, v28, v36
    v_add_f32 v29, v29, v37
    v_add_f32 v30, v30, v38
    v_add_f32 v31, v31, v39
    s_waitcnt lgkmcnt(0)
    v_add_f32 v40, v40, v48
    v_add_f32 v41, v41, v49
    v_add_f32 v42, v42, v50
    v_add_f32 v43, v43, v51
    v_add_f32 v44, v44, v52
    v_add_f32 v45, v45, v53
    v_add_f32 v46, v46, v54
    v_add_f32 v47, v47, v55
    v_add_f32 v24, v24, v40
    v_add_f32 v25, v25, v41
    v_add_f32 v26, v26, v42
    v_add_f32 v27, v27, v43
    v_add_f32 v28, v28, v44
    v_add_f32 v29, v29, v45
    v_add_f32 v30, v30, v46
    v_add_f32 v31, v31, v47
    v_cvt_pk_bf16_f32 v24, v24, v25
    v_cvt_pk_bf16_f32 v25, v26, v27
    v_cvt_pk_bf16_f32 v26, v28, v29
    v_cvt_pk_bf16_f32 v27, v30, v31
    v_min_u32 v24, -2, v24
    v_min_u32 v25, -2, v25
    v_min_u32 v26, -2, v26
    v_min_u32 v27, -2, v27
    buffer_store_dwordx4 v[24:27], v1, s[4:7], s37 offen sc1
    s_branch k_end
ch_a_pro:
    s_mul_i32 s21, s2, 24576
    s_add_u32 s21, s21, 209711104
    v_lshlrev_b32 v1, 4, v0
    v_mov_b32 v4, -1
    v_mov_b32 v5, -1
    v_mov_b32 v6, -1
    v_mov_b32 v7, -1
    buffer_store_dwordx4 v[4:7], v1, s[4:7], s21 offen sc1
    s_add_u32 s21, s21, 4096
    buffer_store_dwordx4 v[4:7], v1, s[4:7], s21 offen sc1
    s_add_u32 s21, s21, 4096
    buffer_store_dwordx4 v[4:7], v1, s[4:7], s21 offen sc1
    s_add_u32 s21, s21, 4096
    buffer_store_dwordx4 v[4:7], v1, s[4:7], s21 offen sc1
    s_add_u32 s21, s21, 4096
    buffer_store_dwordx4 v[4:7], v1, s[4:7], s21 offen sc1
    s_add_u32 s21, s21, 4096
    buffer_store_dwordx4 v[4:7], v1, s[4:7], s21 offen sc1
    s_add_u32 s21, s21, 4096
    v_mov_b32 v2, s29
    s_waitcnt vmcnt(0)
    s_barrier
    s_cmp_lg_u32 s3, 4
    s_cbranch_scc1 ch_nox
    s_mov_b64 exec, 1
    buffer_atomic_add v2, off, s[64:67], s28 sc1
    s_mov_b64 exec, -1
ch_nox:
    v_and_b32 v20, 63, v0
    v_lshlrev_b32 v0, 4, v20
    s_sub_u32 s25, s3, 4
    s_lshl_b32 s46, s12, 2
    s_add_u32 s46, s46, s25
    s_lshl_b32 s21, s46, 18
    s_lshl_b32 s22, s13, 7
    s_add_u32 s21, s21, s22
    s_lshl_b32 s46, s46, 12
    s_lshl_b32 s23, s25, 13
    s_add_u32 s23, s23, 131072
    s_load_dwordx2 s[8:9], s[0:1], 40
    s_mov_b32 s10, 8388608
    s_mov_b32 s11, 131072
    v_lshrrev_b32 v21, 3, v20
    v_and_b32 v22, 7, v20
    v_lshlrev_b32 v21, 11, v21
    v_lshl_add_u32 v21, v22, 4, v21
    v_lshrrev_b32 v28, 4, v20
    v_and_b32 v29, 1, v28
    v_xor_b32 v29, 0, v29
    v_lshlrev_b32 v29, 2, v29
    v_lshl_add_u32 v29, v28, 3, v29
    v_bfe_u32 v28, v20, 2, 2
    v_add_u32 v29, v29, v28
    v_lshlrev_b32 v29, 7, v29
    v_and_b32 v28, 3, v20
    v_lshl_add_u32 v29, v28, 4, v29
    v_and_b32 v28, 1, v28
    v_xor_b32 v28, 0, v28
    v_lshl_add_u32 v24, v28, 3, v29
    v_add_u32 v24, s23, v24
    v_lshrrev_b32 v28, 4, v20
    v_and_b32 v29, 1, v28
    v_xor_b32 v29, 1, v29
    v_lshlrev_b32 v29, 2, v29
    v_lshl_add_u32 v29, v28, 3, v29
    v_bfe_u32 v28, v20, 2, 2
    v_add_u32 v29, v29, v28
    v_lshlrev_b32 v29, 7, v29
    v_and_b32 v28, 3, v20
    v_lshl_add_u32 v29, v28, 4, v29
    v_and_b32 v28, 1, v28
    v_xor_b32 v28, 0, v28
    v_lshl_add_u32 v25, v28, 3, v29
    v_add_u32 v25, s23, v25
    v_lshrrev_b32 v28, 4, v20
    v_and_b32 v29, 1, v28
    v_xor_b32 v29, 0, v29
    v_lshlrev_b32 v29, 2, v29
    v_lshl_add_u32 v29, v28, 3, v29
    v_bfe_u32 v28, v20, 2, 2
    v_add_u32 v29, v29, v28
    v_lshlrev_b32 v29, 7, v29
    v_and_b32 v28, 3, v20
    v_lshl_add_u32 v29, v28, 4, v29
    v_and_b32 v28, 1, v28
    v_xor_b32 v28, 1, v28
    v_lshl_add_u32 v26, v28, 3, v29
    v_add_u32 v26, s23, v26
    v_lshrrev_b32 v28, 4, v20
    v_and_b32 v29, 1, v28
    v_xor_b32 v29, 1, v29
    v_lshlrev_b32 v29, 2, v29
    v_lshl_add_u32 v29, v28, 3, v29
    v_bfe_u32 v28, v20, 2, 2
    v_add_u32 v29, v29, v28
    v_lshlrev_b32 v29, 7, v29
    v_and_b32 v28, 3, v20
    v_lshl_add_u32 v29, v28, 4, v29
    v_and_b32 v28, 1, v28
    v_xor_b32 v28, 1, v28
    v_lshl_add_u32 v27, v28, 3, v29
    v_add_u32 v27, s23, v27
    s_waitcnt lgkmcnt(0)
    s_add_u32 m0, s23, 0
    s_nop 0
    buffer_load_dwordx4 v21, s[8:11], s21 offen lds
    s_add_u32 s21, s21, 16384
    s_add_u32 m0, s23, 1024
    s_nop 0
    buffer_load_dwordx4 v21, s[8:11], s21 offen lds
    s_add_u32 s21, s21, 16384
    s_add_u32 m0, s23, 2048
    s_nop 0
    buffer_load_dwordx4 v21, s[8:11], s21 offen lds
    s_add_u32 s21, s21, 16384
    s_add_u32 m0, s23, 3072
    s_nop 0
    buffer_load_dwordx4 v21, s[8:11], s21 offen lds
    s_add_u32 s21, s21, 16384
    s_add_u32 m0, s23, 4096
    s_nop 0
    buffer_load_dwordx4 v21, s[8:11], s21 offen lds
    s_add_u32 s21, s21, 16384
    s_add_u32 m0, s23, 5120
    s_nop 0
    buffer_load_dwordx4 v21, s[8:11], s21 offen lds
    s_add_u32 s21, s21, 16384
    s_add_u32 m0, s23, 6144
    s_nop 0
    buffer_load_dwordx4 v21, s[8:11], s21 offen lds
    s_add_u32 s21, s21, 16384
    s_add_u32 m0, s23, 7168
    s_nop 0
    buffer_load_dwordx4 v21, s[8:11], s21 offen lds
    s_add_u32 s21, s21, 16384
    buffer_load_dwordx4 v[98:101], v21, s[8:11], s21 offen
    s_add_u32 s21, s21, 16384
    buffer_load_dwordx4 v[102:105], v21, s[8:11], s21 offen
    s_add_u32 s21, s21, 16384
    buffer_load_dwordx4 v[106:109], v21, s[8:11], s21 offen
    s_add_u32 s21, s21, 16384
    buffer_load_dwordx4 v[110:113], v21, s[8:11], s21 offen
    s_add_u32 s21, s21, 16384
    buffer_load_dwordx4 v[114:117], v21, s[8:11], s21 offen
    s_add_u32 s21, s21, 16384
    buffer_load_dwordx4 v[118:121], v21, s[8:11], s21 offen
    s_add_u32 s21, s21, 16384
    buffer_load_dwordx4 v[122:125], v21, s[8:11], s21 offen
    s_add_u32 s21, s21, 16384
    buffer_load_dwordx4 v[126:129], v21, s[8:11], s21 offen
    s_add_u32 s21, s21, 16384
    v_add_u32 v30, s23, v0
    s_waitcnt vmcnt(8)
    ds_read_b64_tr_b16 v[192:193], v24 offset:0
    ds_read_b64_tr_b16 v[194:195], v25 offset:0
    ds_read_b64_tr_b16 v[200:201], v26 offset:0
    ds_read_b64_tr_b16 v[202:203], v27 offset:0
    ds_read_b64_tr_b16 v[208:209], v24 offset:64
    ds_read_b64_tr_b16 v[210:211], v25 offset:64
    ds_read_b64_tr_b16 v[216:217], v26 offset:64
    ds_read_b64_tr_b16 v[218:219], v27 offset:64
    s_waitcnt lgkmcnt(0)
    ds_read_b64_tr_b16 v[196:197], v24 offset:4096
    ds_read_b64_tr_b16 v[198:199], v25 offset:4096
    ds_read_b64_tr_b16 v[204:205], v26 offset:4096
    ds_read_b64_tr_b16 v[206:207], v27 offset:4096
    ds_read_b64_tr_b16 v[212:213], v24 offset:4160
    ds_read_b64_tr_b16 v[214:215], v25 offset:4160
    ds_read_b64_tr_b16 v[220:221], v26 offset:4160
    ds_read_b64_tr_b16 v[222:223], v27 offset:4160
    s_waitcnt lgkmcnt(0)
    s_waitcnt vmcnt(0)
    ds_write_b128 v30, v[98:101] offset:0
    ds_write_b128 v30, v[102:105] offset:1024
    ds_write_b128 v30, v[106:109] offset:2048
    ds_write_b128 v30, v[110:113] offset:3072
    ds_write_b128 v30, v[114:117] offset:4096
    ds_write_b128 v30, v[118:121] offset:5120
    ds_write_b128 v30, v[122:125] offset:6144
    ds_write_b128 v30, v[126:129] offset:7168
    s_waitcnt lgkmcnt(0)
    ds_read_b64_tr_b16 v[224:225], v24 offset:0
    ds_read_b64_tr_b16 v[226:227], v25 offset:0
    ds_read_b64_tr_b16 v[232:233], v26 offset:0
    ds_read_b64_tr_b16 v[234:235], v27 offset:0
    ds_read_b64_tr_b16 v[240:241], v24 offset:64
    ds_read_b64_tr_b16 v[242:243], v25 offset:64
    ds_read_b64_tr_b16 v[248:249], v26 offset:64
    ds_read_b64_tr_b16 v[250:251], v27 offset:64
    s_waitcnt lgkmcnt(0)
    ds_read_b64_tr_b16 v[228:229], v24 offset:4096
    ds_read_b64_tr_b16 v[230:231], v25 offset:4096
    ds_read_b64_tr_b16 v[236:237], v26 offset:4096
    ds_read_b64_tr_b16 v[238:239], v27 offset:4096
    ds_read_b64_tr_b16 v[244:245], v24 offset:4160
    ds_read_b64_tr_b16 v[246:247], v25 offset:4160
    ds_read_b64_tr_b16 v[252:253], v26 offset:4160
    ds_read_b64_tr_b16 v[254:255], v27 offset:4160
    s_waitcnt lgkmcnt(0)
    v_lshrrev_b32 v21, 4, v20
    s_mul_i32 s21, s25, 18560
    s_add_u32 s21, s21, 16384
    v_add_u32 v1, s21, v0
    v_and_b32 v23, 15, v20
    v_mul_u32_u24 v21, 136, v21
    v_lshl_add_u32 v21, v23, 3, v21
    v_add_u32 v45, s21, v21
    s_lshl_b32 s53, s25, 13
    s_add_u32 s53, s53, 92160
    v_add_u32 v49, s53, v0
    v_mov_b32 v48, 0
    v_mov_b32 v4, 0x3f803f80
    v_mov_b32 v5, 0x3f803f80
    v_mov_b32 v6, 0x3f803f80
    v_mov_b32 v7, 0x3f803f80
    v_mov_b32 v8, 0
    v_mov_b32 v9, 0
    v_mov_b32 v10, 0
    v_mov_b32 v11, 0
    v_lshlrev_b32 v43, 2, v20
    v_mov_b32 v26, 0x44444444
    v_mov_b32 v27, 0xeeeeeeee
    v_and_b32 v28, 1, v20
    v_cmp_eq_u32 vcc, 0, v28
    s_mov_b32 s47, 0x3e0293ee
    s_lshl_b32 s32, s12, 15
    v_cndmask_b32 v41, v27, v26, vcc
    s_lshl_b32 s21, s25, 13
    s_add_u32 s32, s32, s21
    s_add_u32 s32, s32, 2097152
    s_lshl_b32 s21, s25, 2
    s_add_u32 s21, s21, 13312
    v_mov_b32 v47, s21
    s_lshl_b32 s27, s13, 2
    s_add_u32 s27, s27, s25
    s_lshl_b32 s62, s12, 7
    s_add_u32 s62, s62, 218112000
    s_lshl_b32 s33, s12, 14
    s_lshl_b32 s21, s25, 12
    s_add_u32 s33, s33, s21
    s_add_u32 s33, s33, 1179648
    v_mov_b32 v139, 0
    v_mov_b32 v140, 0
    v_mov_b32 v141, 0
    v_mov_b32 v143, 0
    v_mov_b32 v144, 0
    v_mov_b32 v145, 0
    v_mov_b32 v40, 0
    v_mov_b32 v42, 0
    v_mov_b32 v44, 0
    v_mov_b32 v46, 0
    v_mov_b32 v158, 0x7f800000
    s_mov_b32 exec_lo, 0xcccccccc
    s_mov_b32 exec_hi, 0xcccccccc
    v_mov_b32 v158, 0x42700000
    s_mov_b64 exec, -1
    s_cmp_lg_u32 s3, 4
    s_cbranch_scc1 ch_xcc_skip
    v_add_u32 v56, 128, v43
    s_movk_i32 s21, 192
    v_writelane_b32 v56, s21, 4
    v_mov_b32 v59, 63
    v_writelane_b32 v59, -1, 4
    v_mov_b32 v60, 32
    s_mov_b64 exec, 0x1f
ch_xcc:
    buffer_load_dword v57, v56, s[64:67], 0 offen sc1
    s_waitcnt vmcnt(0)
    v_and_b32 v62, v59, v57
    v_cmp_ne_u32 vcc, v62, v60
    s_cbranch_vccz ch_xcc_ok
    s_sleep 16
    s_sub_u32 s26, s26, 1
    s_cbranch_scc0 ch_xcc
    s_mov_b32 s26, 0
ch_xcc_ok:
    s_lshr_b32 s22, s12, 1
    v_readlane_b32 s23, v57, 0
    s_nop 2
    v_readlane_b32 s21, v57, s22
    s_mov_b64 exec, -1
    v_mov_b32 v58, 131072
    v_mov_b32 v57, s21
    ds_write_b32 v58, v57
    s_bfe_u32 s23, s23, 0x1000f
    v_and_b32 v60, 0x70, v0
    v_lshlrev_b32 v60, 3, v60
    s_mov_b32 s22, 218112000
ch_pgv:
    buffer_load_dword v61, v60, s[4:7], s22 offen offset:8 sc1
    s_waitcnt vmcnt(0) lgkmcnt(0)
    v_and_b32 v62, 1, v61
    v_cmp_eq_u32 vcc, 0, v62
    s_cbranch_vccz ch_pgvok
    s_sleep 8
    s_sub_u32 s26, s26, 1
    s_cbranch_scc0 ch_pgv
    s_mov_b32 s26, 0
ch_pgvok:
    v_bfe_u32 v62, v61, 1, 1
    v_ashrrev_i32 v61, 8, v61
    v_sub_u32 v59, 0, v61
    v_cmp_eq_u32 vcc, s23, v62
    s_mov_b32 s21, 0
    s_nop 1
    v_cndmask_b32 v61, v59, v61, vcc
    s_nop 1
    v_readlane_b32 s22, v61, 0
    s_add_i32 s21, s21, s22
    v_readlane_b32 s22, v61, 1
    s_add_i32 s21, s21, s22
    v_readlane_b32 s22, v61, 2
    s_add_i32 s21, s21, s22
    v_readlane_b32 s22, v61, 3
    s_add_i32 s21, s21, s22
    v_readlane_b32 s22, v61, 4
    s_add_i32 s21, s21, s22
    v_readlane_b32 s22, v61, 5
    s_add_i32 s21, s21, s22
    v_readlane_b32 s22, v61, 6
    s_add_i32 s21, s21, s22
    v_readlane_b32 s22, v61, 7
    s_add_i32 s21, s21, s22
    s_cmp_gt_i32 s21, 0
    s_cselect_b32 s21, 0x2000, 0
    v_mov_b32 v59, s21
    ds_write_b32 v58, v59 offset:4
    s_waitcnt lgkmcnt(0)
ch_xcc_skip:
    s_barrier
    s_barrier
    s_lshl_b32 s60, s12, 4
    s_add_u32 s60, s60, 218104320
    s_barrier
ch_g0:
    buffer_load_dword v57, off, s[4:7], s60 sc1
    s_waitcnt vmcnt(0)
    v_readfirstlane_b32 s21, v57
    s_cmp_ge_u32 s21, 12
    s_cbranch_scc1 ch_g0b
    s_sleep 8
    s_sub_u32 s26, s26, 1
    s_cbranch_scc0 ch_g0
    s_mov_b32 s26, 0
ch_g0b:
    s_add_u32 s21, s16, 0
    s_lshl_b32 s21, s21, 18
    s_add_u32 s21, s21, s46
    s_add_u32 s21, s21, 37748736
    s_add_u32 s22, s21, 131072
    buffer_load_dwordx4 v[160:163], v0, s[4:7], s21 offen offset:0 sc1
    buffer_load_dwordx4 v[164:167], v0, s[4:7], s21 offen offset:1024 sc1
    buffer_load_dwordx4 v[168:171], v0, s[4:7], s21 offen offset:2048 sc1
    buffer_load_dwordx4 v[172:175], v0, s[4:7], s21 offen offset:3072 sc1
    buffer_load_dwordx4 v[176:179], v0, s[4:7], s22 offen offset:0 sc1
    buffer_load_dwordx4 v[180:183], v0, s[4:7], s22 offen offset:1024 sc1
    buffer_load_dwordx4 v[184:187], v0, s[4:7], s22 offen offset:2048 sc1
    buffer_load_dwordx4 v[188:191], v0, s[4:7], s22 offen offset:3072 sc1
    s_add_u32 s21, s16, 0
    s_lshl_b32 s21, s21, 18
    s_add_u32 s21, s21, s46
    s_add_u32 s21, s21, 20971520
    s_add_u32 s22, s21, 131072
    buffer_load_dwordx4 v[98:101], v0, s[4:7], s21 offen offset:0 sc1
    buffer_load_dwordx4 v[102:105], v0, s[4:7], s21 offen offset:1024 sc1
    buffer_load_dwordx4 v[106:109], v0, s[4:7], s21 offen offset:2048 sc1
    buffer_load_dwordx4 v[110:113], v0, s[4:7], s21 offen offset:3072 sc1
    buffer_load_dwordx4 v[114:117], v0, s[4:7], s22 offen offset:0 sc1
    buffer_load_dwordx4 v[118:121], v0, s[4:7], s22 offen offset:1024 sc1
    buffer_load_dwordx4 v[122:125], v0, s[4:7], s22 offen offset:2048 sc1
    buffer_load_dwordx4 v[126:129], v0, s[4:7], s22 offen offset:3072 sc1
    s_waitcnt vmcnt(8)
    v_mfma_f32_16x16x32_bf16 v[50:53], v[160:163], v[192:195], 0
    v_mfma_f32_16x16x32_bf16 v[54:57], v[160:163], v[200:203], 0
    v_mfma_f32_16x16x32_bf16 v[58:61], v[160:163], v[208:211], 0
    v_mfma_f32_16x16x32_bf16 v[62:65], v[160:163], v[216:219], 0
    v_mfma_f32_16x16x32_bf16 v[66:69], v[176:179], v[192:195], 0
    v_mfma_f32_16x16x32_bf16 v[70:73], v[176:179], v[200:203], 0
    v_mfma_f32_16x16x32_bf16 v[74:77], v[176:179], v[208:211], 0
    v_mfma_f32_16x16x32_bf16 v[78:81], v[176:179], v[216:219], 0
    v_mfma_f32_16x16x32_bf16 v[50:53], v[164:167], v[196:199], v[50:53]
    v_mfma_f32_16x16x32_bf16 v[54:57], v[164:167], v[204:207], v[54:57]
    v_mfma_f32_16x16x32_bf16 v[58:61], v[164:167], v[212:215], v[58:61]
    v_mfma_f32_16x16x32_bf16 v[62:65], v[164:167], v[220:223], v[62:65]
    v_mfma_f32_16x16x32_bf16 v[66:69], v[180:183], v[196:199], v[66:69]
    v_mfma_f32_16x16x32_bf16 v[70:73], v[180:183], v[204:207], v[70:73]
    v_mfma_f32_16x16x32_bf16 v[74:77], v[180:183], v[212:215], v[74:77]
    v_mfma_f32_16x16x32_bf16 v[78:81], v[180:183], v[220:223], v[78:81]
    v_mfma_f32_16x16x32_bf16 v[50:53], v[168:171], v[224:227], v[50:53]
    v_mfma_f32_16x16x32_bf16 v[54:57], v[168:171], v[232:235], v[54:57]
    v_mfma_f32_16x16x32_bf16 v[58:61], v[168:171], v[240:243], v[58:61]
    v_mfma_f32_16x16x32_bf16 v[62:65], v[168:171], v[248:251], v[62:65]
    v_mfma_f32_16x16x32_bf16 v[66:69], v[184:187], v[224:227], v[66:69]
    v_mfma_f32_16x16x32_bf16 v[70:73], v[184:187], v[232:235], v[70:73]
    v_mfma_f32_16x16x32_bf16 v[74:77], v[184:187], v[240:243], v[74:77]
    v_mfma_f32_16x16x32_bf16 v[78:81], v[184:187], v[248:251], v[78:81]
    v_mfma_f32_16x16x32_bf16 v[50:53], v[172:175], v[228:231], v[50:53]
    v_mfma_f32_16x16x32_bf16 v[54:57], v[172:175], v[236:239], v[54:57]
    v_mfma_f32_16x16x32_bf16 v[58:61], v[172:175], v[244:247], v[58:61]
    v_mfma_f32_16x16x32_bf16 v[62:65], v[172:175], v[252:255], v[62:65]
    v_mfma_f32_16x16x32_bf16 v[66:69], v[188:191], v[228:231], v[66:69]
    v_mfma_f32_16x16x32_bf16 v[70:73], v[188:191], v[236:239], v[70:73]
    v_mfma_f32_16x16x32_bf16 v[74:77], v[188:191], v[244:247], v[74:77]
    v_mfma_f32_16x16x32_bf16 v[78:81], v[188:191], v[252:255], v[78:81]
    s_add_u32 s21, s16, 1
    s_lshl_b32 s21, s21, 18
    s_add_u32 s21, s21, s46
    s_add_u32 s21, s21, 37748736
    s_add_u32 s22, s21, 131072
    buffer_load_dwordx4 v[160:163], v0, s[4:7], s21 offen offset:0 sc1
    buffer_load_dwordx4 v[164:167], v0, s[4:7], s21 offen offset:1024 sc1
    buffer_load_dwordx4 v[168:171], v0, s[4:7], s21 offen offset:2048 sc1
    buffer_load_dwordx4 v[172:175], v0, s[4:7], s21 offen offset:3072 sc1
    buffer_load_dwordx4 v[176:179], v0, s[4:7], s22 offen offset:0 sc1
    buffer_load_dwordx4 v[180:183], v0, s[4:7], s22 offen offset:1024 sc1
    buffer_load_dwordx4 v[184:187], v0, s[4:7], s22 offen offset:2048 sc1
    buffer_load_dwordx4 v[188:191], v0, s[4:7], s22 offen offset:3072 sc1
    s_mov_b32 s34, 1
    s_nop 7
    v_cvt_pk_bf16_f32 v82, v50, v51
    v_cvt_pk_bf16_f32 v83, v52, v53
    v_cvt_pk_bf16_f32 v84, v66, v67
    v_cvt_pk_bf16_f32 v85, v68, v69
    v_cvt_pk_bf16_f32 v86, v54, v55
    v_cvt_pk_bf16_f32 v87, v56, v57
    v_cvt_pk_bf16_f32 v88, v70, v71
    v_cvt_pk_bf16_f32 v89, v72, v73
    v_cvt_pk_bf16_f32 v90, v58, v59
    v_cvt_pk_bf16_f32 v91, v60, v61
    v_cvt_pk_bf16_f32 v92, v74, v75
    v_cvt_pk_bf16_f32 v93, v76, v77
    v_cvt_pk_bf16_f32 v94, v62, v63
    v_cvt_pk_bf16_f32 v95, v64, v65
    v_cvt_pk_bf16_f32 v96, v78, v79
    v_cvt_pk_bf16_f32 v97, v80, v81
    v_mov_b32 v74, 0
    v_mov_b32 v75, 0
    v_mov_b32 v76, 0
    v_mov_b32 v77, 0
    v_mov_b32 v78, 0
    v_mov_b32 v79, 0
    v_mov_b32 v80, 0
    v_mov_b32 v81, 0
    v_mov_b32 v146, 0
    v_mov_b32 v147, 0
    v_mov_b32 v148, 0
    v_mov_b32 v149, 0
    v_mov_b32 v150, 0
    v_mov_b32 v151, 0
    v_mov_b32 v152, 0
    v_mov_b32 v153, 0
    v_mov_b32 v12, 0
    v_mov_b32 v13, 0
    v_mov_b32 v14, 0
    v_mov_b32 v15, 0
    v_mov_b32 v16, 0
    v_mov_b32 v17, 0
    v_mov_b32 v18, 0
    v_mov_b32 v19, 0
    v_mov_b32 v20, 0
    v_mov_b32 v21, 0
    v_mov_b32 v22, 0
    v_mov_b32 v23, 0
    v_mov_b32 v2, 0
    s_add_u32 s21, s17, s32
    s_add_u32 s22, s21, 4096
    s_setprio 2
    s_branch a_zl
.p2align 6
    s_nop 0
    s_nop 0
    s_nop 0
    s_nop 0
    s_nop 0
    s_nop 0
    s_nop 0
    s_nop 0
aloop_24:
    s_add_u32 s21, s17, s32
    s_add_u32 s22, s21, 4096
    v_mov_b32 v74, 0
    v_mov_b32 v75, 0
    v_mov_b32 v76, 0
    v_mov_b32 v77, 0
    v_mov_b32 v78, 0
    v_mov_b32 v79, 0
    v_mov_b32 v80, 0
    v_mov_b32 v81, 0
    v_mov_b32 v146, 0
    v_mov_b32 v147, 0
    v_mov_b32 v148, 0
    v_mov_b32 v149, 0
    v_mov_b32 v150, 0
    v_mov_b32 v151, 0
    v_mov_b32 v152, 0
    v_mov_b32 v153, 0
    s_add_u32 s30, s16, 1
    s_lshl_b32 s30, s30, 18
    s_add_u32 s30, s30, s46
    s_add_u32 s30, s30, 37748736
    s_add_u32 s31, s30, 131072
aloop_24_wm:
    ds_read_b32 v3, v47
    s_waitcnt lgkmcnt(0)
    v_readfirstlane_b32 s23, v3
    s_cmp_eq_u32 s23, s16
    s_cbranch_scc1 aloop_24_wmok
    s_sleep 1
    s_branch aloop_24_wm
aloop_24_wmok:
    buffer_load_dwordx4 v[160:163], v0, s[4:7], s30 offen offset:0 sc1
    buffer_load_dwordx4 v[164:167], v0, s[4:7], s30 offen offset:1024 sc1
    buffer_load_dwordx4 v[168:171], v0, s[4:7], s30 offen offset:2048 sc1
    buffer_load_dwordx4 v[172:175], v0, s[4:7], s30 offen offset:3072 sc1
    buffer_load_dwordx4 v[176:179], v0, s[4:7], s31 offen offset:0 sc1
    buffer_load_dwordx4 v[180:183], v0, s[4:7], s31 offen offset:1024 sc1
    buffer_load_dwordx4 v[184:187], v0, s[4:7], s31 offen offset:2048 sc1
    buffer_load_dwordx4 v[188:191], v0, s[4:7], s31 offen offset:3072 sc1
aloop_24_nv:
    s_setprio 2
    v_mov_b32 v2, s16
    s_barrier
    s_nop 15
    s_nop 13
    ds_read_b128 v[98:101], v49 offset:0
    ds_read_b128 v[102:105], v49 offset:1024
    ds_read_b128 v[106:109], v49 offset:2048
    ds_read_b128 v[110:113], v49 offset:3072
    ds_read_b128 v[114:117], v49 offset:4096
    ds_read_b128 v[118:121], v49 offset:5120
    ds_read_b128 v[122:125], v49 offset:6144
    ds_read_b128 v[126:129], v49 offset:7168
    v_mov_b32 v12, 0
    v_mov_b32 v13, 0
    v_mov_b32 v14, 0
    v_mov_b32 v15, 0
    v_mov_b32 v16, 0
    v_mov_b32 v17, 0
    v_mov_b32 v18, 0
    v_mov_b32 v19, 0
    v_mov_b32 v20, 0
    v_mov_b32 v21, 0
    v_mov_b32 v22, 0
    v_mov_b32 v23, 0
    s_sleep 3
    s_nop 13
a_zl:
    buffer_load_dwordx4 v[50:53], v0, s[4:7], s21 offen offset:0 sc1
    s_nop 7
    buffer_load_dwordx4 v[54:57], v0, s[4:7], s21 offen offset:1024 sc1
    s_nop 7
    buffer_load_dwordx4 v[58:61], v0, s[4:7], s21 offen offset:2048 sc1
    s_nop 7
    buffer_load_dwordx4 v[62:65], v0, s[4:7], s21 offen offset:3072 sc1
    s_nop 7
    buffer_load_dwordx4 v[66:69], v0, s[4:7], s22 offen offset:0 sc1
    s_nop 7
    buffer_load_dwordx4 v[70:73], v0, s[4:7], s22 offen offset:1024 sc1
    s_waitcnt lgkmcnt(0)
    s_waitcnt vmcnt(5)
    v_max3_u32 v3, v50, v51, v52
    v_max_u32 v3, v3, v53
    v_cmp_eq_u32 vcc, -1, v3
    s_cbranch_vccnz arq_25_0
arq_25_0ok:
    v_mfma_f32_16x16x32_bf16 v[12:15], v[98:101], v[50:53], v[12:15]
    v_mfma_f32_16x16x32_bf16 v[16:19], v[114:117], v[50:53], v[16:19]
    s_waitcnt vmcnt(4)
    v_max3_u32 v3, v54, v55, v56
    v_max_u32 v3, v3, v57
    v_cmp_eq_u32 vcc, -1, v3
    v_mfma_f32_16x16x32_bf16 v[20:23], v[50:53], v[50:53], v[20:23]
    s_cbranch_vccnz arq_25_1
arq_25_1ok:
    v_mfma_f32_16x16x32_bf16 v[12:15], v[102:105], v[54:57], v[12:15]
    v_mfma_f32_16x16x32_bf16 v[16:19], v[118:121], v[54:57], v[16:19]
    s_waitcnt vmcnt(3)
    v_max3_u32 v3, v58, v59, v60
    v_max_u32 v3, v3, v61
    v_cmp_eq_u32 vcc, -1, v3
    v_mfma_f32_16x16x32_bf16 v[20:23], v[54:57], v[54:57], v[20:23]
    s_cbranch_vccnz arq_25_2
arq_25_2ok:
    v_mfma_f32_16x16x32_bf16 v[12:15], v[106:109], v[58:61], v[12:15]
    v_mfma_f32_16x16x32_bf16 v[16:19], v[122:125], v[58:61], v[16:19]
    s_waitcnt vmcnt(2)
    v_max3_u32 v3, v62, v63, v64
    v_max_u32 v3, v3, v65
    v_cmp_eq_u32 vcc, -1, v3
    v_mfma_f32_16x16x32_bf16 v[20:23], v[58:61], v[58:61], v[20:23]
    s_cbranch_vccnz arq_25_3
arq_25_3ok:
    v_mfma_f32_16x16x32_bf16 v[12:15], v[110:113], v[62:65], v[12:15]
    ds_write_b32 v47, v2 offset:16
    v_mfma_f32_16x16x32_bf16 v[16:19], v[126:129], v[62:65], v[16:19]
    v_mfma_f32_16x16x32_bf16 v[20:23], v[62:65], v[62:65], v[20:23]
aloop_24_sdone:
    s_nop 0
    s_cmp_eq_u32 s16, 63
    s_cbranch_scc1 aloop_24_lsk
    s_nop 1
    v_exp_f32 v54, v12
    v_exp_f32 v55, v13
    s_waitcnt vmcnt(0)
    v_max3_u32 v24, v66, v67, v68
    v_max3_u32 v24, v24, v69, v70
    v_max3_u32 v24, v24, v71, v72
    v_max_u32 v24, v24, v73
    v_cmp_eq_u32 vcc, -1, v24
    s_cbranch_vccnz arq_25_v
    v_smfmac_f32_16x16x64_bf16 v[74:77], v[66:69], v[192:199], v41
    v_exp_f32 v56, v14
    v_smfmac_f32_16x16x64_bf16 v[78:81], v[66:69], v[200:207], v41
    v_exp_f32 v57, v15
    v_smfmac_f32_16x16x64_bf16 v[146:149], v[66:69], v[208:215], v41
    v_exp_f32 v58, v16
    v_smfmac_f32_16x16x64_bf16 v[150:153], v[66:69], v[216:223], v41
    v_exp_f32 v59, v17
    v_smfmac_f32_16x16x64_bf16 v[74:77], v[70:73], v[224:231], v41
    v_exp_f32 v60, v18
    v_smfmac_f32_16x16x64_bf16 v[78:81], v[70:73], v[232:239], v41
    v_exp_f32 v61, v19
    v_smfmac_f32_16x16x64_bf16 v[146:149], v[70:73], v[240:247], v41
    v_exp_f32 v62, v20
    v_smfmac_f32_16x16x64_bf16 v[150:153], v[70:73], v[248:255], v41
    v_exp_f32 v63, v21
    v_cvt_pk_bf16_f32 v154, v54, v55
    v_cvt_pk_bf16_f32 v155, v56, v57
    v_cvt_pk_bf16_f32 v156, v58, v59
    v_cvt_pk_bf16_f32 v157, v60, v61
    v_cvt_pk_bf16_f32 v8, v62, v63
    v_max3_f32 v2, |v12|, |v13|, |v14|
    v_mfma_f32_16x16x32_bf16 v[50:53], v[154:157], v[4:7], 0
    v_max3_f32 v3, |v15|, |v16|, |v17|
    v_add_f32 v74, v74, v75
    v_mfma_f32_16x16x32_bf16 v[50:53], v[8:11], v[4:7], v[50:53]
    v_add_f32 v76, v76, v77
    v_cvt_pk_bf16_f32 v40, v74, v76
    v_mfma_f32_16x16x32_bf16 v[24:27], v[154:157], v[82:85], 0
    v_add_f32 v78, v78, v79
    v_add_f32 v80, v80, v81
    v_mfma_f32_16x16x32_bf16 v[24:27], v[8:11], v[40:43], v[24:27]
    v_cvt_pk_bf16_f32 v42, v78, v80
    v_add_f32 v146, v146, v147
    v_mfma_f32_16x16x32_bf16 v[28:31], v[154:157], v[86:89], 0
    v_add_f32 v148, v148, v149
    v_cvt_pk_bf16_f32 v44, v146, v148
    v_mfma_f32_16x16x32_bf16 v[28:31], v[8:11], v[42:45], v[28:31]
    v_add_f32 v150, v150, v151
    v_add_f32 v152, v152, v153
    v_mfma_f32_16x16x32_bf16 v[32:35], v[154:157], v[90:93], 0
    v_cvt_pk_bf16_f32 v46, v150, v152
    v_rcp_f32 v52, v52
    v_mfma_f32_16x16x32_bf16 v[32:35], v[8:11], v[44:47], v[32:35]
    v_rcp_f32 v53, v53
    v_max3_f32 v2, v2, |v18|, |v19|
    v_mfma_f32_16x16x32_bf16 v[36:39], v[154:157], v[94:97], 0
    v_max3_f32 v3, v3, |v20|, |v21|
    v_max_f32 v2, v2, v3
    v_mfma_f32_16x16x32_bf16 v[36:39], v[8:11], v[46:49], v[36:39]
    v_cmp_nle_f32 vcc, v2, v158
    v_mul_f32 v26, v26, v52
    v_mul_f32 v27, v27, v53
    s_cbranch_vccnz aloop_24_tm
    v_mul_f32 v30, v30, v52
    v_mul_f32 v31, v31, v53
aloop_24_pvd:
    ds_write_b64 v45, v[26:27] offset:0
    v_mul_f32 v34, v34, v52
    v_mul_f32 v35, v35, v53
    ds_write_b64 v45, v[30:31] offset:544
    v_mul_f32 v38, v38, v52
    v_mul_f32 v39, v39, v53
    ds_write_b64 v45, v[34:35] offset:1088
    ds_write_b64 v45, v[38:39] offset:1632
aloop_24_lskb:
    s_waitcnt lgkmcnt(0)
    s_barrier
    s_setprio 0
    s_cmp_lg_u32 s27, 0
    s_cbranch_scc1 pg_26
    s_sub_u32 s25, s16, 1
    s_cbranch_scc1 pg_26
    v_mov_b32 v3, s25
    s_mov_b64 exec, 1
    buffer_store_dword v3, off, s[4:7], s62 sc1
    s_mov_b64 exec, -1
pg_26:
    s_add_u32 s21, s17, s33
    v_lshlrev_b32 v2, 1, v43
    s_cmp_eq_u32 s16, 63
    s_cbranch_scc1 aloop_24_nvw
    v_mfma_f32_16x16x32_bf16 v[50:53], v[160:163], v[192:195], 0
    v_mfma_f32_16x16x32_bf16 v[54:57], v[160:163], v[200:203], 0
    v_mfma_f32_16x16x32_bf16 v[58:61], v[160:163], v[208:211], 0
    v_mfma_f32_16x16x32_bf16 v[62:65], v[160:163], v[216:219], 0
    v_mfma_f32_16x16x32_bf16 v[66:69], v[176:179], v[192:195], 0
    v_mfma_f32_16x16x32_bf16 v[70:73], v[176:179], v[200:203], 0
    v_mfma_f32_16x16x32_bf16 v[74:77], v[176:179], v[208:211], 0
    v_mfma_f32_16x16x32_bf16 v[78:81], v[176:179], v[216:219], 0
    v_mfma_f32_16x16x32_bf16 v[50:53], v[164:167], v[196:199], v[50:53]
    v_mfma_f32_16x16x32_bf16 v[54:57], v[164:167], v[204:207], v[54:57]
    v_mfma_f32_16x16x32_bf16 v[58:61], v[164:167], v[212:215], v[58:61]
    v_mfma_f32_16x16x32_bf16 v[62:65], v[164:167], v[220:223], v[62:65]
    v_mfma_f32_16x16x32_bf16 v[66:69], v[180:183], v[196:199], v[66:69]
    v_mfma_f32_16x16x32_bf16 v[70:73], v[180:183], v[204:207], v[70:73]
    v_mfma_f32_16x16x32_bf16 v[74:77], v[180:183], v[212:215], v[74:77]
    v_mfma_f32_16x16x32_bf16 v[78:81], v[180:183], v[220:223], v[78:81]
    v_mfma_f32_16x16x32_bf16 v[50:53], v[168:171], v[224:227], v[50:53]
    v_mfma_f32_16x16x32_bf16 v[54:57], v[168:171], v[232:235], v[54:57]
    v_mfma_f32_16x16x32_bf16 v[58:61], v[168:171], v[240:243], v[58:61]
    v_mfma_f32_16x16x32_bf16 v[62:65], v[168:171], v[248:251], v[62:65]
    v_mfma_f32_16x16x32_bf16 v[66:69], v[184:187], v[224:227], v[66:69]
    v_mfma_f32_16x16x32_bf16 v[70:73], v[184:187], v[232:235], v[70:73]
    v_mfma_f32_16x16x32_bf16 v[74:77], v[184:187], v[240:243], v[74:77]
    v_mfma_f32_16x16x32_bf16 v[78:81], v[184:187], v[248:251], v[78:81]
    v_mfma_f32_16x16x32_bf16 v[50:53], v[172:175], v[228:231], v[50:53]
    v_mfma_f32_16x16x32_bf16 v[54:57], v[172:175], v[236:239], v[54:57]
    v_mfma_f32_16x16x32_bf16 v[58:61], v[172:175], v[244:247], v[58:61]
    v_mfma_f32_16x16x32_bf16 v[62:65], v[172:175], v[252:255], v[62:65]
    v_mfma_f32_16x16x32_bf16 v[66:69], v[188:191], v[228:231], v[66:69]
    v_mfma_f32_16x16x32_bf16 v[70:73], v[188:191], v[236:239], v[70:73]
    v_mfma_f32_16x16x32_bf16 v[74:77], v[188:191], v[244:247], v[74:77]
    v_mfma_f32_16x16x32_bf16 v[78:81], v[188:191], v[252:255], v[78:81]
    buffer_load_dwordx4 v[130:133], v0, s[4:7], s21 offen sc1
    buffer_load_dwordx2 v[146:147], v2, s[4:7], s21 offen offset:1024 sc1
    buffer_load_dwordx4 v[134:137], v0, s[4:7], s21 offen offset:2048 sc1
    buffer_load_dwordx2 v[148:149], v2, s[4:7], s21 offen offset:3072 sc1
    s_add_u32 s30, s16, 2
    s_lshl_b32 s30, s30, 18
    s_add_u32 s30, s30, s46
    s_add_u32 s30, s30, 37748736
    s_add_u32 s31, s30, 131072
    s_branch aloop_24_vwd
aloop_24_nvw:
    buffer_load_dwordx4 v[130:133], v0, s[4:7], s21 offen sc1
    buffer_load_dwordx2 v[146:147], v2, s[4:7], s21 offen offset:1024 sc1
    buffer_load_dwordx4 v[134:137], v0, s[4:7], s21 offen offset:2048 sc1
    buffer_load_dwordx2 v[148:149], v2, s[4:7], s21 offen offset:3072 sc1
aloop_24_vwd:
    v_add_u32 v48, s68, v1
    s_xor_b32 s68, s68, 8192
aloop_24_psa:
    s_waitcnt vmcnt(0)
    v_max3_u32 v3, v130, v131, v132
    v_max3_u32 v3, v3, v133, v134
    v_max3_u32 v3, v3, v135, v136
    v_max3_u32 v3, v3, v137, v146
    v_max3_u32 v3, v3, v147, v148
    v_max_u32 v3, v3, v149
    v_cmp_eq_u32 vcc, -1, v3
    s_cbranch_vccnz arq_25_ps
aloop_24_psok:
    v_mfma_f32_16x16x32_bf16 v[24:27], v[82:85], v[130:133], 0
    v_mfma_f32_16x16x32_bf16 v[28:31], v[86:89], v[130:133], 0
    v_mfma_f32_16x16x32_bf16 v[32:35], v[90:93], v[130:133], 0
    v_mfma_f32_16x16x32_bf16 v[36:39], v[94:97], v[130:133], 0
    v_mov_b32 v138, v146
    v_mfma_f32_16x16x32_bf16 v[12:15], v[82:85], v[134:137], 0
    v_mfma_f32_16x16x32_bf16 v[16:19], v[86:89], v[134:137], 0
    v_mfma_f32_16x16x32_bf16 v[20:23], v[90:93], v[134:137], 0
    v_mfma_f32_16x16x32_bf16 v[154:157], v[94:97], v[134:137], 0
    v_mov_b32 v142, v148
    v_mfma_f32_16x16x32_bf16 v[24:27], v[40:43], v[138:141], v[24:27]
    v_mfma_f32_16x16x32_bf16 v[28:31], v[42:45], v[138:141], v[28:31]
    v_mfma_f32_16x16x32_bf16 v[32:35], v[44:47], v[138:141], v[32:35]
    v_mfma_f32_16x16x32_bf16 v[36:39], v[46:49], v[138:141], v[36:39]
    v_mfma_f32_16x16x32_bf16 v[12:15], v[40:43], v[142:145], v[12:15]
    v_mfma_f32_16x16x32_bf16 v[16:19], v[42:45], v[142:145], v[16:19]
    v_mfma_f32_16x16x32_bf16 v[20:23], v[44:47], v[142:145], v[20:23]
    s_nop 1
    v_mfma_f32_16x16x32_bf16 v[154:157], v[46:49], v[142:145], v[154:157]
aloop_24_nev:
    ds_write_b128 v48, v[24:27] offset:2176
    v_cvt_pk_bf16_f32 v82, v50, v51
    v_cvt_pk_bf16_f32 v83, v52, v53
    ds_write_b128 v48, v[28:31] offset:3200
    v_cvt_pk_bf16_f32 v84, v66, v67
    v_cvt_pk_bf16_f32 v85, v68, v69
    ds_write_b128 v48, v[32:35] offset:4224
    v_cvt_pk_bf16_f32 v86, v54, v55
    v_cvt_pk_bf16_f32 v87, v56, v57
    ds_write_b128 v48, v[36:39] offset:5248
    v_cvt_pk_bf16_f32 v88, v70, v71
    v_cvt_pk_bf16_f32 v89, v72, v73
    ds_write_b128 v48, v[12:15] offset:6272
    v_cvt_pk_bf16_f32 v90, v58, v59
    v_cvt_pk_bf16_f32 v91, v60, v61
    ds_write_b128 v48, v[16:19] offset:7296
    v_cvt_pk_bf16_f32 v92, v74, v75
    v_cvt_pk_bf16_f32 v93, v76, v77
    ds_write_b128 v48, v[20:23] offset:8320
    v_cvt_pk_bf16_f32 v94, v62, v63
    v_cvt_pk_bf16_f32 v95, v64, v65
    ds_write_b128 v48, v[154:157] offset:9344
    v_cvt_pk_bf16_f32 v96, v78, v79
    v_cvt_pk_bf16_f32 v97, v80, v81
aloop_24_bgskip:
    s_waitcnt lgkmcnt(0)
    s_cmp_eq_u32 s16, 63
    s_cbranch_scc1 aloop_24_fin
    s_add_u32 s16, s16, 1
    s_mov_b32 s17, s18
    s_mov_b32 s18, s19
    s_mov_b32 s19, s20
    s_add_u32 s20, s20, 262144
    s_cmp_eq_u32 s20, 210763776
    s_cselect_b32 s20, 209715200, s20
    s_branch aloop_24
arq_25_0:
    s_sub_u32 s26, s26, 1
    s_cbranch_scc1 arq_25_0_g
    buffer_load_dwordx4 v[50:53], v0, s[4:7], s21 offen offset:0 sc1
    buffer_load_dwordx4 v[54:57], v0, s[4:7], s21 offen offset:1024 sc1
    buffer_load_dwordx4 v[58:61], v0, s[4:7], s21 offen offset:2048 sc1
    buffer_load_dwordx4 v[62:65], v0, s[4:7], s21 offen offset:3072 sc1
    buffer_load_dwordx4 v[66:69], v0, s[4:7], s22 offen offset:0 sc1
    buffer_load_dwordx4 v[70:73], v0, s[4:7], s22 offen offset:1024 sc1
    s_waitcnt vmcnt(5)
    v_max3_u32 v3, v50, v51, v52
    v_max_u32 v3, v3, v53
    v_cmp_eq_u32 vcc, -1, v3
    s_cbranch_vccnz arq_25_0
    s_branch arq_25_0ok
arq_25_0_g:
    s_mov_b32 s26, 0
    s_waitcnt vmcnt(0)
    s_branch arq_25_0ok
arq_25_1:
    s_sub_u32 s26, s26, 1
    s_cbranch_scc1 arq_25_1_g
    buffer_load_dwordx4 v[54:57], v0, s[4:7], s21 offen offset:1024 sc1
    buffer_load_dwordx4 v[58:61], v0, s[4:7], s21 offen offset:2048 sc1
    buffer_load_dwordx4 v[62:65], v0, s[4:7], s21 offen offset:3072 sc1
    buffer_load_dwordx4 v[66:69], v0, s[4:7], s22 offen offset:0 sc1
    buffer_load_dwordx4 v[70:73], v0, s[4:7], s22 offen offset:1024 sc1
    s_waitcnt vmcnt(4)
    v_max3_u32 v3, v54, v55, v56
    v_max_u32 v3, v3, v57
    v_cmp_eq_u32 vcc, -1, v3
    s_cbranch_vccnz arq_25_1
    s_branch arq_25_1ok
arq_25_1_g:
    s_mov_b32 s26, 0
    s_waitcnt vmcnt(0)
    s_branch arq_25_1ok
arq_25_2:
    s_sub_u32 s26, s26, 1
    s_cbranch_scc1 arq_25_2_g
    buffer_load_dwordx4 v[58:61], v0, s[4:7], s21 offen offset:2048 sc1
    buffer_load_dwordx4 v[62:65], v0, s[4:7], s21 offen offset:3072 sc1
    buffer_load_dwordx4 v[66:69], v0, s[4:7], s22 offen offset:0 sc1
    buffer_load_dwordx4 v[70:73], v0, s[4:7], s22 offen offset:1024 sc1
    s_waitcnt vmcnt(3)
    v_max3_u32 v3, v58, v59, v60
    v_max_u32 v3, v3, v61
    v_cmp_eq_u32 vcc, -1, v3
    s_cbranch_vccnz arq_25_2
    s_branch arq_25_2ok
arq_25_2_g:
    s_mov_b32 s26, 0
    s_waitcnt vmcnt(0)
    s_branch arq_25_2ok
arq_25_3:
    s_sub_u32 s26, s26, 1
    s_cbranch_scc1 arq_25_3_g
    buffer_load_dwordx4 v[62:65], v0, s[4:7], s21 offen offset:3072 sc1
    buffer_load_dwordx4 v[66:69], v0, s[4:7], s22 offen offset:0 sc1
    buffer_load_dwordx4 v[70:73], v0, s[4:7], s22 offen offset:1024 sc1
    s_waitcnt vmcnt(2)
    v_max3_u32 v3, v62, v63, v64
    v_max_u32 v3, v3, v65
    v_cmp_eq_u32 vcc, -1, v3
    s_cbranch_vccnz arq_25_3
    s_branch arq_25_3ok
arq_25_3_g:
    s_mov_b32 s26, 0
    s_waitcnt vmcnt(0)
    s_branch arq_25_3ok
arq_25_v:
    buffer_load_dwordx4 v[66:69], v0, s[4:7], s22 offen offset:0 sc1
    buffer_load_dwordx4 v[70:73], v0, s[4:7], s22 offen offset:1024 sc1
    v_max3_f32 v2, v12, v13, v14
    v_max3_f32 v3, v15, v16, v17
    v_max3_f32 v2, v2, v18, v19
    v_max3_f32 v3, v3, v20, v21
    v_max_f32 v2, v2, v3
    v_mov_b32 v3, v2
    s_nop 1
    v_permlane16_swap_b32 v3, v2
    v_max_f32 v2, v2, v3
    v_mov_b32 v3, v2
    s_nop 1
    v_permlane32_swap_b32 v3, v2
    v_max_f32 v2, v2, v3
    v_sub_f32 v12, v12, v2
    v_sub_f32 v13, v13, v2
    v_sub_f32 v14, v14, v2
    v_sub_f32 v15, v15, v2
    v_sub_f32 v16, v16, v2
    v_sub_f32 v17, v17, v2
    v_sub_f32 v18, v18, v2
    v_sub_f32 v19, v19, v2
    v_sub_f32 v20, v20, v2
    v_sub_f32 v21, v21, v2
    v_exp_f32 v54, v12
    v_exp_f32 v55, v13
    v_exp_f32 v56, v14
    v_exp_f32 v57, v15
    v_exp_f32 v58, v16
    v_exp_f32 v59, v17
    v_exp_f32 v60, v18
    v_exp_f32 v61, v19
    v_exp_f32 v62, v20
    v_exp_f32 v63, v21
    s_nop 0
    v_cvt_pk_bf16_f32 v154, v54, v55
    v_cvt_pk_bf16_f32 v155, v56, v57
    v_cvt_pk_bf16_f32 v156, v58, v59
    v_cvt_pk_bf16_f32 v157, v60, v61
    v_cvt_pk_bf16_f32 v8, v62, v63
    s_nop 0
    v_mfma_f32_16x16x32_bf16 v[50:53], v[154:157], v[4:7], 0
    v_mfma_f32_16x16x32_bf16 v[50:53], v[8:11], v[4:7], v[50:53]
    v_mfma_f32_16x16x32_bf16 v[24:27], v[154:157], v[82:85], 0
    v_mfma_f32_16x16x32_bf16 v[28:31], v[154:157], v[86:89], 0
    v_mfma_f32_16x16x32_bf16 v[32:35], v[154:157], v[90:93], 0
    v_mfma_f32_16x16x32_bf16 v[36:39], v[154:157], v[94:97], 0
arq_25_vs:
    s_waitcnt vmcnt(0)
    v_max3_u32 v3, v66, v67, v68
    v_max3_u32 v3, v3, v69, v70
    v_max3_u32 v3, v3, v71, v72
    v_max_u32 v3, v3, v73
    v_cmp_eq_u32 vcc, -1, v3
    s_cbranch_vccnz arq_25_vsr
    s_branch arq_25_vsok
arq_25_vsr:
    s_sub_u32 s26, s26, 1
    s_cbranch_scc1 arq_25_vsg
    buffer_load_dwordx4 v[66:69], v0, s[4:7], s22 offen offset:0 sc1
    buffer_load_dwordx4 v[70:73], v0, s[4:7], s22 offen offset:1024 sc1
    s_branch arq_25_vs
arq_25_vsg:
    s_mov_b32 s26, 0
arq_25_vsok:
    v_smfmac_f32_16x16x64_bf16 v[74:77], v[66:69], v[192:199], v41
    v_smfmac_f32_16x16x64_bf16 v[78:81], v[66:69], v[200:207], v41
    v_smfmac_f32_16x16x64_bf16 v[146:149], v[66:69], v[208:215], v41
    v_smfmac_f32_16x16x64_bf16 v[150:153], v[66:69], v[216:223], v41
    v_smfmac_f32_16x16x64_bf16 v[74:77], v[70:73], v[224:231], v41
    v_smfmac_f32_16x16x64_bf16 v[78:81], v[70:73], v[232:239], v41
    v_smfmac_f32_16x16x64_bf16 v[146:149], v[70:73], v[240:247], v41
    v_smfmac_f32_16x16x64_bf16 v[150:153], v[70:73], v[248:255], v41
    v_rcp_f32 v52, v52
    v_rcp_f32 v53, v53
    s_nop 2
    v_add_f32 v74, v74, v75
    v_add_f32 v76, v76, v77
    v_cvt_pk_bf16_f32 v40, v74, v76
    v_add_f32 v78, v78, v79
    v_add_f32 v80, v80, v81
    v_cvt_pk_bf16_f32 v42, v78, v80
    v_add_f32 v146, v146, v147
    v_add_f32 v148, v148, v149
    v_cvt_pk_bf16_f32 v44, v146, v148
    v_add_f32 v150, v150, v151
    v_add_f32 v152, v152, v153
    v_cvt_pk_bf16_f32 v46, v150, v152
    s_nop 1
    v_mfma_f32_16x16x32_bf16 v[24:27], v[8:11], v[40:43], v[24:27]
    v_mfma_f32_16x16x32_bf16 v[28:31], v[8:11], v[42:45], v[28:31]
    v_mfma_f32_16x16x32_bf16 v[32:35], v[8:11], v[44:47], v[32:35]
    v_mfma_f32_16x16x32_bf16 v[36:39], v[8:11], v[46:49], v[36:39]
    s_nop 4
    v_mul_f32 v26, v26, v52
    v_mul_f32 v27, v27, v53
    v_mul_f32 v30, v30, v52
    v_mul_f32 v31, v31, v53
    s_branch aloop_24_pvd
aloop_24_tm:
    s_nop 7
    v_max3_f32 v2, v12, v13, v14
    v_max3_f32 v3, v15, v16, v17
    v_max3_f32 v2, v2, v18, v19
    v_max3_f32 v3, v3, v20, v21
    v_max_f32 v2, v2, v3
    v_mov_b32 v3, v2
    s_nop 1
    v_permlane16_swap_b32 v3, v2
    v_max_f32 v2, v2, v3
    v_mov_b32 v3, v2
    s_nop 1
    v_permlane32_swap_b32 v3, v2
    v_max_f32 v2, v2, v3
    v_sub_f32 v12, v12, v2
    v_sub_f32 v13, v13, v2
    v_sub_f32 v14, v14, v2
    v_sub_f32 v15, v15, v2
    v_sub_f32 v16, v16, v2
    v_sub_f32 v17, v17, v2
    v_sub_f32 v18, v18, v2
    v_sub_f32 v19, v19, v2
    v_sub_f32 v20, v20, v2
    v_sub_f32 v21, v21, v2
    v_exp_f32 v54, v12
    v_exp_f32 v55, v13
    v_exp_f32 v56, v14
    v_exp_f32 v57, v15
    v_exp_f32 v58, v16
    v_exp_f32 v59, v17
    v_exp_f32 v60, v18
    v_exp_f32 v61, v19
    v_exp_f32 v62, v20
    v_exp_f32 v63, v21
    s_nop 0
    v_cvt_pk_bf16_f32 v154, v54, v55
    v_cvt_pk_bf16_f32 v155, v56, v57
    v_cvt_pk_bf16_f32 v156, v58, v59
    v_cvt_pk_bf16_f32 v157, v60, v61
    v_cvt_pk_bf16_f32 v8, v62, v63
    s_nop 0
    v_mfma_f32_16x16x32_bf16 v[50:53], v[154:157], v[4:7], 0
    v_mfma_f32_16x16x32_bf16 v[50:53], v[8:11], v[4:7], v[50:53]
    v_mfma_f32_16x16x32_bf16 v[24:27], v[154:157], v[82:85], 0
    v_mfma_f32_16x16x32_bf16 v[28:31], v[154:157], v[86:89], 0
    v_mfma_f32_16x16x32_bf16 v[32:35], v[154:157], v[90:93], 0
    v_mfma_f32_16x16x32_bf16 v[36:39], v[154:157], v[94:97], 0
    v_mfma_f32_16x16x32_bf16 v[24:27], v[8:11], v[40:43], v[24:27]
    v_mfma_f32_16x16x32_bf16 v[28:31], v[8:11], v[42:45], v[28:31]
    v_mfma_f32_16x16x32_bf16 v[32:35], v[8:11], v[44:47], v[32:35]
    v_mfma_f32_16x16x32_bf16 v[36:39], v[8:11], v[46:49], v[36:39]
    v_rcp_f32 v52, v52
    v_rcp_f32 v53, v53
    s_nop 4
    v_mul_f32 v26, v26, v52
    v_mul_f32 v27, v27, v53
    v_mul_f32 v30, v30, v52
    v_mul_f32 v31, v31, v53
    s_branch aloop_24_pvd
aloop_24_lz:
    buffer_load_dwordx4 v[66:69], v0, s[4:7], s22 offen offset:0 sc1
    buffer_load_dwordx4 v[70:73], v0, s[4:7], s22 offen offset:1024 sc1
    ds_write_b32 v47, v2 offset:16
aloop_24_lsk:
arq_25_vl:
    s_waitcnt vmcnt(0)
    v_max3_u32 v3, v66, v67, v68
    v_max3_u32 v3, v3, v69, v70
    v_max3_u32 v3, v3, v71, v72
    v_max_u32 v3, v3, v73
    v_cmp_eq_u32 vcc, -1, v3
    s_cbranch_vccnz arq_25_vlr
    s_branch arq_25_vlok
arq_25_vlr:
    s_sub_u32 s26, s26, 1
    s_cbranch_scc1 arq_25_vlg
    buffer_load_dwordx4 v[66:69], v0, s[4:7], s22 offen offset:0 sc1
    buffer_load_dwordx4 v[70:73], v0, s[4:7], s22 offen offset:1024 sc1
    s_branch arq_25_vl
arq_25_vlg:
    s_mov_b32 s26, 0
arq_25_vlok:
    v_smfmac_f32_16x16x64_bf16 v[74:77], v[66:69], v[192:199], v41
    v_smfmac_f32_16x16x64_bf16 v[78:81], v[66:69], v[200:207], v41
    v_smfmac_f32_16x16x64_bf16 v[146:149], v[66:69], v[208:215], v41
    v_smfmac_f32_16x16x64_bf16 v[150:153], v[66:69], v[216:223], v41
    v_smfmac_f32_16x16x64_bf16 v[74:77], v[70:73], v[224:231], v41
    v_smfmac_f32_16x16x64_bf16 v[78:81], v[70:73], v[232:239], v41
    v_smfmac_f32_16x16x64_bf16 v[146:149], v[70:73], v[240:247], v41
    v_smfmac_f32_16x16x64_bf16 v[150:153], v[70:73], v[248:255], v41
    s_nop 4
    v_add_f32 v74, v74, v75
    v_add_f32 v76, v76, v77
    v_cvt_pk_bf16_f32 v40, v74, v76
    v_add_f32 v78, v78, v79
    v_add_f32 v80, v80, v81
    v_cvt_pk_bf16_f32 v42, v78, v80
    v_add_f32 v146, v146, v147
    v_add_f32 v148, v148, v149
    v_cvt_pk_bf16_f32 v44, v146, v148
    v_add_f32 v150, v150, v151
    v_add_f32 v152, v152, v153
    v_cvt_pk_bf16_f32 v46, v150, v152
    s_branch aloop_24_lskb
arq_25_ps:
    s_sub_u32 s26, s26, 1
    s_cbranch_scc1 arq_25_psg
    s_sleep 2
    buffer_load_dwordx4 v[130:133], v0, s[4:7], s21 offen sc1
    buffer_load_dwordx2 v[146:147], v2, s[4:7], s21 offen offset:1024 sc1
    buffer_load_dwordx4 v[134:137], v0, s[4:7], s21 offen offset:2048 sc1
    buffer_load_dwordx2 v[148:149], v2, s[4:7], s21 offen offset:3072 sc1
    s_branch aloop_24_psa
arq_25_psg:
    s_mov_b32 s26, 0
    s_branch aloop_24_psok
aloop_24_fin:
    s_barrier
    s_branch k_end
k_end:
k_exit:
    s_endpgm
.section .rodata,"a"
.p2align 6
jobtab:
    .long 6, 24, 24, 8192, 0, 262144, 8388608, 0, 32768, 4, 20971520, 131072, 0, 0, 218104320, 1
    .long 4, 24, 24, 8192, 0, 262144, 8388608, 262144, 32768, 4, 22020096, 131072, 0, 0, 218104448, 1
    .long 1, 32, 32, 8192, 0, 256, 8388608, 1048576, 32768, 8, 41943040, 131072, 0, 0, 218104832, 4
    .long 1, 16, 16, 8192, 0, 256, 8388608, 2097152, 32768, 8, 12582912, 131072, 0, 0, 218105344, 4
    .long 1, 32, 32, 8192, 0, 256, 8388608, 3145728, 32768, 8, 50331648, 131072, 0, 0, 218105856, 4
    .long 1, 32, 32, 8192, 0, 256, 8388608, 3670016, 32768, 8, 52428800, 131072, 0, 0, 218106112, 4
    .long 1, 80, 80, 2048, 0, 256, 7340032, 54525952, 114688, 7, 167772160, 32768, 218103808, 7, 218106368, 1
    .long 0, 0, 0, 0, 0, 0, 0, 0, 0, 0, 0, 0, 0, 0, 0, 0
    .long 0, 0, 0, 0, 0, 0, 0, 0, 0, 0, 0, 0, 0, 0, 0, 0
    .long 0, 0, 0, 0, 0, 0, 0, 0, 0, 0, 0, 0, 0, 0, 0, 0
    .long 6, 24, 24, 8192, 2048, 264192, 8388608, 0, 32768, 4, 21004288, 131072, 0, 0, 218104352, 1
    .long 4, 24, 24, 8192, 2048, 264192, 8388608, 262144, 32768, 4, 22052864, 131072, 0, 0, 218104480, 1
    .long 1, 32, 32, 8192, 2048, 2304, 8388608, 1048576, 32768, 8, 41975808, 131072, 0, 0, 218104864, 4
    .long 1, 16, 16, 8192, 2048, 2304, 8388608, 2097152, 32768, 8, 12615680, 131072, 0, 0, 218105376, 4
    .long 1, 32, 32, 8192, 2048, 2304, 8388608, 3145728, 32768, 8, 50364416, 131072, 0, 0, 218105888, 4
    .long 1, 32, 32, 8192, 2048, 2304, 8388608, 3670016, 32768, 8, 52461568, 131072, 0, 0, 218106144, 4
    .long 1, 80, 80, 2048, 1835008, 1835264, 7340032, 54554624, 114688, 7, 171966464, 32768, 218103824, 7, 218106368, 1
    .long 0, 0, 0, 0, 0, 0, 0, 0, 0, 0, 0, 0, 0, 0, 0, 0
    .long 0, 0, 0, 0, 0, 0, 0, 0, 0, 0, 0, 0, 0, 0, 0, 0
    .long 0, 0, 0, 0, 0, 0, 0, 0, 0, 0, 0, 0, 0, 0, 0, 0
    .long 6, 24, 24, 8192, 4096, 266240, 8388608, 0, 32768, 4, 21037056, 131072, 0, 0, 218104384, 1
    .long 4, 24, 24, 8192, 4096, 266240, 8388608, 262144, 32768, 4, 22085632, 131072, 0, 0, 218104512, 1
    .long 1, 32, 32, 8192, 4096, 4352, 8388608, 1048576, 32768, 8, 42008576, 131072, 0, 0, 218104896, 4
    .long 1, 16, 16, 8192, 4096, 4352, 8388608, 2097152, 32768, 8, 12648448, 131072, 0, 0, 218105408, 4
    .long 1, 32, 32, 8192, 4096, 4352, 8388608, 3145728, 32768, 8, 50397184, 131072, 0, 0, 218105920, 4
    .long 1, 32, 32, 8192, 4096, 4352, 8388608, 3670016, 32768, 8, 52494336, 131072, 0, 0, 218106176, 4
    .long 1, 80, 80, 2048, 3670016, 3670272, 7340032, 54583296, 114688, 7, 176160768, 32768, 218103840, 7, 218106368, 1
    .long 0, 0, 0, 0, 0, 0, 0, 0, 0, 0, 0, 0, 0, 0, 0, 0
    .long 0, 0, 0, 0, 0, 0, 0, 0, 0, 0, 0, 0, 0, 0, 0, 0
    .long 0, 0, 0, 0, 0, 0, 0, 0, 0, 0, 0, 0, 0, 0, 0, 0
    .long 6, 24, 24, 8192, 6144, 268288, 8388608, 0, 32768, 4, 21069824, 131072, 0, 0, 218104416, 1
    .long 4, 24, 24, 8192, 6144, 268288, 8388608, 262144, 32768, 4, 22118400, 131072, 0, 0, 218104544, 1
    .long 1, 32, 32, 8192, 6144, 6400, 8388608, 1048576, 32768, 8, 42041344, 131072, 0, 0, 218104928, 4
    .long 1, 16, 16, 8192, 6144, 6400, 8388608, 2097152, 32768, 8, 12681216, 131072, 0, 0, 218105440, 4
    .long 1, 32, 32, 8192, 6144, 6400, 8388608, 3145728, 32768, 8, 50429952, 131072, 0, 0, 218105952, 4
    .long 1, 32, 32, 8192, 6144, 6400, 8388608, 3670016, 32768, 8, 52527104, 131072, 0, 0, 218106208, 4
    .long 1, 80, 80, 2048, 5505024, 5505280, 7340032, 54611968, 114688, 7, 180355072, 32768, 218103856, 7, 218106368, 1
    .long 0, 0, 0, 0, 0, 0, 0, 0, 0, 0, 0, 0, 0, 0, 0, 0
    .long 0, 0, 0, 0, 0, 0, 0, 0, 0, 0, 0, 0, 0, 0, 0, 0
    .long 0, 0, 0, 0, 0, 0, 0, 0, 0, 0, 0, 0, 0, 0, 0, 0
    .long 6, 24, 24, 8192, 256, 262400, 8388608, 0, 32768, 4, 20975616, 131072, 0, 0, 218104320, 1
    .long 4, 24, 24, 8192, 256, 262400, 8388608, 262144, 32768, 4, 22024192, 131072, 0, 0, 218104448, 1
    .long 1, 32, 32, 8192, 512, 768, 8388608, 1048576, 32768, 8, 41951232, 131072, 0, 0, 218104832, 4
    .long 1, 16, 16, 8192, 512, 768, 8388608, 2097152, 32768, 8, 12591104, 131072, 0, 0, 218105344, 4
    .long 1, 32, 32, 8192, 512, 768, 8388608, 3145728, 32768, 8, 50339840, 131072, 0, 0, 218105856, 4
    .long 1, 32, 32, 8192, 512, 768, 8388608, 3670016, 32768, 8, 52436992, 131072, 0, 0, 218106112, 4
    .long 1, 80, 80, 2048, 512, 768, 7340032, 54525952, 114688, 7, 167780352, 32768, 218103808, 7, 218106368, 1
    .long 0, 0, 0, 0, 0, 0, 0, 0, 0, 0, 0, 0, 0, 0, 0, 0
    .long 0, 0, 0, 0, 0, 0, 0, 0, 0, 0, 0, 0, 0, 0, 0, 0
    .long 0, 0, 0, 0, 0, 0, 0, 0, 0, 0, 0, 0, 0, 0, 0, 0
    .long 6, 24, 24, 8192, 2304, 264448, 8388608, 0, 32768, 4, 21008384, 131072, 0, 0, 218104352, 1
    .long 4, 24, 24, 8192, 2304, 264448, 8388608, 262144, 32768, 4, 22056960, 131072, 0, 0, 218104480, 1
    .long 1, 32, 32, 8192, 2560, 2816, 8388608, 1048576, 32768, 8, 41984000, 131072, 0, 0, 218104864, 4
    .long 1, 16, 16, 8192, 2560, 2816, 8388608, 2097152, 32768, 8, 12623872, 131072, 0, 0, 218105376, 4
    .long 1, 32, 32, 8192, 2560, 2816, 8388608, 3145728, 32768, 8, 50372608, 131072, 0, 0, 218105888, 4
    .long 1, 32, 32, 8192, 2560, 2816, 8388608, 3670016, 32768, 8, 52469760, 131072, 0, 0, 218106144, 4
    .long 1, 80, 80, 2048, 1835520, 1835776, 7340032, 54554624, 114688, 7, 171974656, 32768, 218103824, 7, 218106368, 1
    .long 0, 0, 0, 0, 0, 0, 0, 0, 0, 0, 0, 0, 0, 0, 0, 0
    .long 0, 0, 0, 0, 0, 0, 0, 0, 0, 0, 0, 0, 0, 0, 0, 0
    .long 0, 0, 0, 0, 0, 0, 0, 0, 0, 0, 0, 0, 0, 0, 0, 0
    .long 6, 24, 24, 8192, 4352, 266496, 8388608, 0, 32768, 4, 21041152, 131072, 0, 0, 218104384, 1
    .long 4, 24, 24, 8192, 4352, 266496, 8388608, 262144, 32768, 4, 22089728, 131072, 0, 0, 218104512, 1
    .long 1, 32, 32, 8192, 4608, 4864, 8388608, 1048576, 32768, 8, 42016768, 131072, 0, 0, 218104896, 4
    .long 1, 16, 16, 8192, 4608, 4864, 8388608, 2097152, 32768, 8, 12656640, 131072, 0, 0, 218105408, 4
    .long 1, 32, 32, 8192, 4608, 4864, 8388608, 3145728, 32768, 8, 50405376, 131072, 0, 0, 218105920, 4
    .long 1, 32, 32, 8192, 4608, 4864, 8388608, 3670016, 32768, 8, 52502528, 131072, 0, 0, 218106176, 4
    .long 1, 80, 80, 2048, 3670528, 3670784, 7340032, 54583296, 114688, 7, 176168960, 32768, 218103840, 7, 218106368, 1
    .long 0, 0, 0, 0, 0, 0, 0, 0, 0, 0, 0, 0, 0, 0, 0, 0
    .long 0, 0, 0, 0, 0, 0, 0, 0, 0, 0, 0, 0, 0, 0, 0, 0
    .long 0, 0, 0, 0, 0, 0, 0, 0, 0, 0, 0, 0, 0, 0, 0, 0
    .long 6, 24, 24, 8192, 6400, 268544, 8388608, 0, 32768, 4, 21073920, 131072, 0, 0, 218104416, 1
    .long 4, 24, 24, 8192, 6400, 268544, 8388608, 262144, 32768, 4, 22122496, 131072, 0, 0, 218104544, 1
    .long 1, 32, 32, 8192, 6656, 6912, 8388608, 1048576, 32768, 8, 42049536, 131072, 0, 0, 218104928, 4
    .long 1, 16, 16, 8192, 6656, 6912, 8388608, 2097152, 32768, 8, 12689408, 131072, 0, 0, 218105440, 4
    .long 1, 32, 32, 8192, 6656, 6912, 8388608, 3145728, 32768, 8, 50438144, 131072, 0, 0, 218105952, 4
    .long 1, 32, 32, 8192, 6656, 6912, 8388608, 3670016, 32768, 8, 52535296, 131072, 0, 0, 218106208, 4
    .long 1, 80, 80, 2048, 5505536, 5505792, 7340032, 54611968, 114688, 7, 180363264, 32768, 218103856, 7, 218106368, 1
    .long 0, 0, 0, 0, 0, 0, 0, 0, 0, 0, 0, 0, 0, 0, 0, 0
    .long 0, 0, 0, 0, 0, 0, 0, 0, 0, 0, 0, 0, 0, 0, 0, 0
    .long 0, 0, 0, 0, 0, 0, 0, 0, 0, 0, 0, 0, 0, 0, 0, 0
    .long 6, 24, 24, 8192, 512, 262656, 8388608, 0, 32768, 4, 20979712, 131072, 0, 0, 218104320, 1
    .long 4, 24, 24, 8192, 512, 262656, 8388608, 262144, 32768, 4, 22028288, 131072, 0, 0, 218104448, 1
    .long 1, 32, 32, 8192, 1024, 1280, 8388608, 1048576, 32768, 8, 41959424, 131072, 0, 0, 218104848, 4
    .long 1, 16, 16, 8192, 1024, 1280, 8388608, 2097152, 32768, 8, 12599296, 131072, 0, 0, 218105360, 4
    .long 1, 32, 32, 8192, 1024, 1280, 8388608, 3145728, 32768, 8, 50348032, 131072, 0, 0, 218105872, 4
    .long 1, 32, 32, 8192, 1024, 1280, 8388608, 3670016, 32768, 8, 52445184, 131072, 0, 0, 218106128, 4
    .long 1, 80, 80, 2048, 1024, 1280, 7340032, 54525952, 114688, 7, 167788544, 32768, 218103808, 7, 218106368, 1
    .long 0, 0, 0, 0, 0, 0, 0, 0, 0, 0, 0, 0, 0, 0, 0, 0
    .long 0, 0, 0, 0, 0, 0, 0, 0, 0, 0, 0, 0, 0, 0, 0, 0
    .long 0, 0, 0, 0, 0, 0, 0, 0, 0, 0, 0, 0, 0, 0, 0, 0
    .long 6, 24, 24, 8192, 2560, 264704, 8388608, 0, 32768, 4, 21012480, 131072, 0, 0, 218104352, 1
    .long 4, 24, 24, 8192, 2560, 264704, 8388608, 262144, 32768, 4, 22061056, 131072, 0, 0, 218104480, 1
    .long 1, 32, 32, 8192, 3072, 3328, 8388608, 1048576, 32768, 8, 41992192, 131072, 0, 0, 218104880, 4
    .long 1, 16, 16, 8192, 3072, 3328, 8388608, 2097152, 32768, 8, 12632064, 131072, 0, 0, 218105392, 4
    .long 1, 32, 32, 8192, 3072, 3328, 8388608, 3145728, 32768, 8, 50380800, 131072, 0, 0, 218105904, 4
    .long 1, 32, 32, 8192, 3072, 3328, 8388608, 3670016, 32768, 8, 52477952, 131072, 0, 0, 218106160, 4
    .long 1, 80, 80, 2048, 1836032, 1836288, 7340032, 54554624, 114688, 7, 171982848, 32768, 218103824, 7, 218106368, 1
    .long 0, 0, 0, 0, 0, 0, 0, 0, 0, 0, 0, 0, 0, 0, 0, 0
    .long 0, 0, 0, 0, 0, 0, 0, 0, 0, 0, 0, 0, 0, 0, 0, 0
    .long 0, 0, 0, 0, 0, 0, 0, 0, 0, 0, 0, 0, 0, 0, 0, 0
    .long 6, 24, 24, 8192, 4608, 266752, 8388608, 0, 32768, 4, 21045248, 131072, 0, 0, 218104384, 1
    .long 4, 24, 24, 8192, 4608, 266752, 8388608, 262144, 32768, 4, 22093824, 131072, 0, 0, 218104512, 1
    .long 1, 32, 32, 8192, 5120, 5376, 8388608, 1048576, 32768, 8, 42024960, 131072, 0, 0, 218104912, 4
    .long 1, 16, 16, 8192, 5120, 5376, 8388608, 2097152, 32768, 8, 12664832, 131072, 0, 0, 218105424, 4
    .long 1, 32, 32, 8192, 5120, 5376, 8388608, 3145728, 32768, 8, 50413568, 131072, 0, 0, 218105936, 4
    .long 1, 32, 32, 8192, 5120, 5376, 8388608, 3670016, 32768, 8, 52510720, 131072, 0, 0, 218106192, 4
    .long 1, 80, 80, 2048, 3671040, 3671296, 7340032, 54583296, 114688, 7, 176177152, 32768, 218103840, 7, 218106368, 1
    .long 0, 0, 0, 0, 0, 0, 0, 0, 0, 0, 0, 0, 0, 0, 0, 0
    .long 0, 0, 0, 0, 0, 0, 0, 0, 0, 0, 0, 0, 0, 0, 0, 0
    .long 0, 0, 0, 0, 0, 0, 0, 0, 0, 0, 0, 0, 0, 0, 0, 0
    .long 6, 24, 24, 8192, 6656, 268800, 8388608, 0, 32768, 4, 21078016, 131072, 0, 0, 218104416, 1
    .long 4, 24, 24, 8192, 6656, 268800, 8388608, 262144, 32768, 4, 22126592, 131072, 0, 0, 218104544, 1
    .long 1, 32, 32, 8192, 7168, 7424, 8388608, 1048576, 32768, 8, 42057728, 131072, 0, 0, 218104944, 4
    .long 1, 16, 16, 8192, 7168, 7424, 8388608, 2097152, 32768, 8, 12697600, 131072, 0, 0, 218105456, 4
    .long 1, 32, 32, 8192, 7168, 7424, 8388608, 3145728, 32768, 8, 50446336, 131072, 0, 0, 218105968, 4
    .long 1, 32, 32, 8192, 7168, 7424, 8388608, 3670016, 32768, 8, 52543488, 131072, 0, 0, 218106224, 4
    .long 1, 80, 80, 2048, 5506048, 5506304, 7340032, 54611968, 114688, 7, 180371456, 32768, 218103856, 7, 218106368, 1
    .long 0, 0, 0, 0, 0, 0, 0, 0, 0, 0, 0, 0, 0, 0, 0, 0
    .long 0, 0, 0, 0, 0, 0, 0, 0, 0, 0, 0, 0, 0, 0, 0, 0
    .long 0, 0, 0, 0, 0, 0, 0, 0, 0, 0, 0, 0, 0, 0, 0, 0
    .long 6, 24, 24, 8192, 768, 262912, 8388608, 0, 32768, 4, 20983808, 131072, 0, 0, 218104320, 1
    .long 4, 24, 24, 8192, 768, 262912, 8388608, 262144, 32768, 4, 22032384, 131072, 0, 0, 218104448, 1
    .long 1, 32, 32, 8192, 1536, 1792, 8388608, 1048576, 32768, 8, 41967616, 131072, 0, 0, 218104848, 4
    .long 1, 16, 16, 8192, 1536, 1792, 8388608, 2097152, 32768, 8, 12607488, 131072, 0, 0, 218105360, 4
    .long 1, 32, 32, 8192, 1536, 1792, 8388608, 3145728, 32768, 8, 50356224, 131072, 0, 0, 218105872, 4
    .long 1, 32, 32, 8192, 1536, 1792, 8388608, 3670016, 32768, 8, 52453376, 131072, 0, 0, 218106128, 4
    .long 1, 80, 80, 2048, 1536, 1792, 7340032, 54525952, 114688, 7, 167796736, 32768, 218103808, 7, 218106368, 1
    .long 0, 0, 0, 0, 0, 0, 0, 0, 0, 0, 0, 0, 0, 0, 0, 0
    .long 0, 0, 0, 0, 0, 0, 0, 0, 0, 0, 0, 0, 0, 0, 0, 0
    .long 0, 0, 0, 0, 0, 0, 0, 0, 0, 0, 0, 0, 0, 0, 0, 0
    .long 6, 24, 24, 8192, 2816, 264960, 8388608, 0, 32768, 4, 21016576, 131072, 0, 0, 218104352, 1
    .long 4, 24, 24, 8192, 2816, 264960, 8388608, 262144, 32768, 4, 22065152, 131072, 0, 0, 218104480, 1
    .long 1, 32, 32, 8192, 3584, 3840, 8388608, 1048576, 32768, 8, 42000384, 131072, 0, 0, 218104880, 4
    .long 1, 16, 16, 8192, 3584, 3840, 8388608, 2097152, 32768, 8, 12640256, 131072, 0, 0, 218105392, 4
    .long 1, 32, 32, 8192, 3584, 3840, 8388608, 3145728, 32768, 8, 50388992, 131072, 0, 0, 218105904, 4
    .long 1, 32, 32, 8192, 3584, 3840, 8388608, 3670016, 32768, 8, 52486144, 131072, 0, 0, 218106160, 4
    .long 1, 80, 80, 2048, 1836544, 1836800, 7340032, 54554624, 114688, 7, 171991040, 32768, 218103824, 7, 218106368, 1
    .long 0, 0, 0, 0, 0, 0, 0, 0, 0, 0, 0, 0, 0, 0, 0, 0
    .long 0, 0, 0, 0, 0, 0, 0, 0, 0, 0, 0, 0, 0, 0, 0, 0
    .long 0, 0, 0, 0, 0, 0, 0, 0, 0, 0, 0, 0, 0, 0, 0, 0
    .long 6, 24, 24, 8192, 4864, 267008, 8388608, 0, 32768, 4, 21049344, 131072, 0, 0, 218104384, 1
    .long 4, 24, 24, 8192, 4864, 267008, 8388608, 262144, 32768, 4, 22097920, 131072, 0, 0, 218104512, 1
    .long 1, 32, 32, 8192, 5632, 5888, 8388608, 1048576, 32768, 8, 42033152, 131072, 0, 0, 218104912, 4
    .long 1, 16, 16, 8192, 5632, 5888, 8388608, 2097152, 32768, 8, 12673024, 131072, 0, 0, 218105424, 4
    .long 1, 32, 32, 8192, 5632, 5888, 8388608, 3145728, 32768, 8, 50421760, 131072, 0, 0, 218105936, 4
    .long 1, 32, 32, 8192, 5632, 5888, 8388608, 3670016, 32768, 8, 52518912, 131072, 0, 0, 218106192, 4
    .long 1, 80, 80, 2048, 3671552, 3671808, 7340032, 54583296, 114688, 7, 176185344, 32768, 218103840, 7, 218106368, 1
    .long 0, 0, 0, 0, 0, 0, 0, 0, 0, 0, 0, 0, 0, 0, 0, 0
    .long 0, 0, 0, 0, 0, 0, 0, 0, 0, 0, 0, 0, 0, 0, 0, 0
    .long 0, 0, 0, 0, 0, 0, 0, 0, 0, 0, 0, 0, 0, 0, 0, 0
    .long 6, 24, 24, 8192, 6912, 269056, 8388608, 0, 32768, 4, 21082112, 131072, 0, 0, 218104416, 1
    .long 4, 24, 24, 8192, 6912, 269056, 8388608, 262144, 32768, 4, 22130688, 131072, 0, 0, 218104544, 1
    .long 1, 32, 32, 8192, 7680, 7936, 8388608, 1048576, 32768, 8, 42065920, 131072, 0, 0, 218104944, 4
    .long 1, 16, 16, 8192, 7680, 7936, 8388608, 2097152, 32768, 8, 12705792, 131072, 0, 0, 218105456, 4
    .long 1, 32, 32, 8192, 7680, 7936, 8388608, 3145728, 32768, 8, 50454528, 131072, 0, 0, 218105968, 4
    .long 1, 32, 32, 8192, 7680, 7936, 8388608, 3670016, 32768, 8, 52551680, 131072, 0, 0, 218106224, 4
    .long 1, 80, 80, 2048, 5506560, 5506816, 7340032, 54611968, 114688, 7, 180379648, 32768, 218103856, 7, 218106368, 1
    .long 0, 0, 0, 0, 0, 0, 0, 0, 0, 0, 0, 0, 0, 0, 0, 0
    .long 0, 0, 0, 0, 0, 0, 0, 0, 0, 0, 0, 0, 0, 0, 0, 0
    .long 0, 0, 0, 0, 0, 0, 0, 0, 0, 0, 0, 0, 0, 0, 0, 0
    .long 6, 24, 24, 8192, 1024, 263168, 8388608, 0, 32768, 4, 20987904, 131072, 0, 0, 218104336, 1
    .long 4, 24, 24, 8192, 1024, 263168, 8388608, 262144, 32768, 4, 22036480, 131072, 0, 0, 218104464, 1
    .long 1, 24, 24, 8192, 0, 256, 8388608, 1048576, 32768, 8, 25165824, 131072, 0, 0, 218104832, 4
    .long 1, 32, 32, 8192, 0, 256, 8388608, 2621440, 32768, 8, 48234496, 131072, 0, 0, 218105600, 4
    .long 1, 24, 24, 8192, 0, 256, 8388608, 3145728, 32768, 8, 33554432, 131072, 0, 0, 218105856, 4
    .long 1, 24, 24, 8192, 0, 256, 8388608, 3670016, 32768, 8, 35651584, 131072, 0, 0, 218106112, 4
    .long 1, 80, 80, 2048, 0, 256, 7340032, 56360960, 114688, 7, 168296448, 32768, 218103872, 7, 218106432, 1
    .long 0, 0, 0, 0, 0, 0, 0, 0, 0, 0, 0, 0, 0, 0, 0, 0
    .long 0, 0, 0, 0, 0, 0, 0, 0, 0, 0, 0, 0, 0, 0, 0, 0
    .long 0, 0, 0, 0, 0, 0, 0, 0, 0, 0, 0, 0, 0, 0, 0, 0
    .long 6, 24, 24, 8192, 3072, 265216, 8388608, 0, 32768, 4, 21020672, 131072, 0, 0, 218104368, 1
    .long 4, 24, 24, 8192, 3072, 265216, 8388608, 262144, 32768, 4, 22069248, 131072, 0, 0, 218104496, 1
    .long 1, 24, 24, 8192, 2048, 2304, 8388608, 1048576, 32768, 8, 25198592, 131072, 0, 0, 218104864, 4
    .long 1, 32, 32, 8192, 2048, 2304, 8388608, 2621440, 32768, 8, 48267264, 131072, 0, 0, 218105632, 4
    .long 1, 24, 24, 8192, 2048, 2304, 8388608, 3145728, 32768, 8, 33587200, 131072, 0, 0, 218105888, 4
    .long 1, 24, 24, 8192, 2048, 2304, 8388608, 3670016, 32768, 8, 35684352, 131072, 0, 0, 218106144, 4
    .long 1, 80, 80, 2048, 1835008, 1835264, 7340032, 56389632, 114688, 7, 172490752, 32768, 218103888, 7, 218106432, 1
    .long 0, 0, 0, 0, 0, 0, 0, 0, 0, 0, 0, 0, 0, 0, 0, 0
    .long 0, 0, 0, 0, 0, 0, 0, 0, 0, 0, 0, 0, 0, 0, 0, 0
    .long 0, 0, 0, 0, 0, 0, 0, 0, 0, 0, 0, 0, 0, 0, 0, 0
    .long 6, 24, 24, 8192, 5120, 267264, 8388608, 0, 32768, 4, 21053440, 131072, 0, 0, 218104400, 1
    .long 4, 24, 24, 8192, 5120, 267264, 8388608, 262144, 32768, 4, 22102016, 131072, 0, 0, 218104528, 1
    .long 1, 24, 24, 8192, 4096, 4352, 8388608, 1048576, 32768, 8, 25231360, 131072, 0, 0, 218104896, 4
    .long 1, 32, 32, 8192, 4096, 4352, 8388608, 2621440, 32768, 8, 48300032, 131072, 0, 0, 218105664, 4
    .long 1, 24, 24, 8192, 4096, 4352, 8388608, 3145728, 32768, 8, 33619968, 131072, 0, 0, 218105920, 4
    .long 1, 24, 24, 8192, 4096, 4352, 8388608, 3670016, 32768, 8, 35717120, 131072, 0, 0, 218106176, 4
    .long 1, 80, 80, 2048, 3670016, 3670272, 7340032, 56418304, 114688, 7, 176685056, 32768, 218103904, 7, 218106432, 1
    .long 0, 0, 0, 0, 0, 0, 0, 0, 0, 0, 0, 0, 0, 0, 0, 0
    .long 0, 0, 0, 0, 0, 0, 0, 0, 0, 0, 0, 0, 0, 0, 0, 0
    .long 0, 0, 0, 0, 0, 0, 0, 0, 0, 0, 0, 0, 0, 0, 0, 0
    .long 6, 24, 24, 8192, 7168, 269312, 8388608, 0, 32768, 4, 21086208, 131072, 0, 0, 218104432, 1
    .long 4, 24, 24, 8192, 7168, 269312, 8388608, 262144, 32768, 4, 22134784, 131072, 0, 0, 218104560, 1
    .long 1, 24, 24, 8192, 6144, 6400, 8388608, 1048576, 32768, 8, 25264128, 131072, 0, 0, 218104928, 4
    .long 1, 32, 32, 8192, 6144, 6400, 8388608, 2621440, 32768, 8, 48332800, 131072, 0, 0, 218105696, 4
    .long 1, 24, 24, 8192, 6144, 6400, 8388608, 3145728, 32768, 8, 33652736, 131072, 0, 0, 218105952, 4
    .long 1, 24, 24, 8192, 6144, 6400, 8388608, 3670016, 32768, 8, 35749888, 131072, 0, 0, 218106208, 4
    .long 1, 80, 80, 2048, 5505024, 5505280, 7340032, 56446976, 114688, 7, 180879360, 32768, 218103920, 7, 218106432, 1
    .long 0, 0, 0, 0, 0, 0, 0, 0, 0, 0, 0, 0, 0, 0, 0, 0
    .long 0, 0, 0, 0, 0, 0, 0, 0, 0, 0, 0, 0, 0, 0, 0, 0
    .long 0, 0, 0, 0, 0, 0, 0, 0, 0, 0, 0, 0, 0, 0, 0, 0
    .long 6, 24, 24, 8192, 1280, 263424, 8388608, 0, 32768, 4, 20992000, 131072, 0, 0, 218104336, 1
    .long 4, 24, 24, 8192, 1280, 263424, 8388608, 262144, 32768, 4, 22040576, 131072, 0, 0, 218104464, 1
    .long 1, 24, 24, 8192, 512, 768, 8388608, 1048576, 32768, 8, 25174016, 131072, 0, 0, 218104832, 4
    .long 1, 32, 32, 8192, 512, 768, 8388608, 2621440, 32768, 8, 48242688, 131072, 0, 0, 218105600, 4
    .long 1, 24, 24, 8192, 512, 768, 8388608, 3145728, 32768, 8, 33562624, 131072, 0, 0, 218105856, 4
    .long 1, 24, 24, 8192, 512, 768, 8388608, 3670016, 32768, 8, 35659776, 131072, 0, 0, 218106112, 4
    .long 1, 80, 80, 2048, 512, 768, 7340032, 56360960, 114688, 7, 168304640, 32768, 218103872, 7, 218106432, 1
    .long 0, 0, 0, 0, 0, 0, 0, 0, 0, 0, 0, 0, 0, 0, 0, 0
    .long 0, 0, 0, 0, 0, 0, 0, 0, 0, 0, 0, 0, 0, 0, 0, 0
    .long 0, 0, 0, 0, 0, 0, 0, 0, 0, 0, 0, 0, 0, 0, 0, 0
    .long 6, 24, 24, 8192, 3328, 265472, 8388608, 0, 32768, 4, 21024768, 131072, 0, 0, 218104368, 1
    .long 4, 24, 24, 8192, 3328, 265472, 8388608, 262144, 32768, 4, 22073344, 131072, 0, 0, 218104496, 1
    .long 1, 24, 24, 8192, 2560, 2816, 8388608, 1048576, 32768, 8, 25206784, 131072, 0, 0, 218104864, 4
    .long 1, 32, 32, 8192, 2560, 2816, 8388608, 2621440, 32768, 8, 48275456, 131072, 0, 0, 218105632, 4
    .long 1, 24, 24, 8192, 2560, 2816, 8388608, 3145728, 32768, 8, 33595392, 131072, 0, 0, 218105888, 4
    .long 1, 24, 24, 8192, 2560, 2816, 8388608, 3670016, 32768, 8, 35692544, 131072, 0, 0, 218106144, 4
    .long 1, 80, 80, 2048, 1835520, 1835776, 7340032, 56389632, 114688, 7, 172498944, 32768, 218103888, 7, 218106432, 1
    .long 0, 0, 0, 0, 0, 0, 0, 0, 0, 0, 0, 0, 0, 0, 0, 0
    .long 0, 0, 0, 0, 0, 0, 0, 0, 0, 0, 0, 0, 0, 0, 0, 0
    .long 0, 0, 0, 0, 0, 0, 0, 0, 0, 0, 0, 0, 0, 0, 0, 0
    .long 6, 24, 24, 8192, 5376, 267520, 8388608, 0, 32768, 4, 21057536, 131072, 0, 0, 218104400, 1
    .long 4, 24, 24, 8192, 5376, 267520, 8388608, 262144, 32768, 4, 22106112, 131072, 0, 0, 218104528, 1
    .long 1, 24, 24, 8192, 4608, 4864, 8388608, 1048576, 32768, 8, 25239552, 131072, 0, 0, 218104896, 4
    .long 1, 32, 32, 8192, 4608, 4864, 8388608, 2621440, 32768, 8, 48308224, 131072, 0, 0, 218105664, 4
    .long 1, 24, 24, 8192, 4608, 4864, 8388608, 3145728, 32768, 8, 33628160, 131072, 0, 0, 218105920, 4
    .long 1, 24, 24, 8192, 4608, 4864, 8388608, 3670016, 32768, 8, 35725312, 131072, 0, 0, 218106176, 4
    .long 1, 80, 80, 2048, 3670528, 3670784, 7340032, 56418304, 114688, 7, 176693248, 32768, 218103904, 7, 218106432, 1
    .long 0, 0, 0, 0, 0, 0, 0, 0, 0, 0, 0, 0, 0, 0, 0, 0
    .long 0, 0, 0, 0, 0, 0, 0, 0, 0, 0, 0, 0, 0, 0, 0, 0
    .long 0, 0, 0, 0, 0, 0, 0, 0, 0, 0, 0, 0, 0, 0, 0, 0
    .long 6, 24, 24, 8192, 7424, 269568, 8388608, 0, 32768, 4, 21090304, 131072, 0, 0, 218104432, 1
    .long 4, 24, 24, 8192, 7424, 269568, 8388608, 262144, 32768, 4, 22138880, 131072, 0, 0, 218104560, 1
    .long 1, 24, 24, 8192, 6656, 6912, 8388608, 1048576, 32768, 8, 25272320, 131072, 0, 0, 218104928, 4
    .long 1, 32, 32, 8192, 6656, 6912, 8388608, 2621440, 32768, 8, 48340992, 131072, 0, 0, 218105696, 4
    .long 1, 24, 24, 8192, 6656, 6912, 8388608, 3145728, 32768, 8, 33660928, 131072, 0, 0, 218105952, 4
    .long 1, 24, 24, 8192, 6656, 6912, 8388608, 3670016, 32768, 8, 35758080, 131072, 0, 0, 218106208, 4
    .long 1, 80, 80, 2048, 5505536, 5505792, 7340032, 56446976, 114688, 7, 180887552, 32768, 218103920, 7, 218106432, 1
    .long 0, 0, 0, 0, 0, 0, 0, 0, 0, 0, 0, 0, 0, 0, 0, 0
    .long 0, 0, 0, 0, 0, 0, 0, 0, 0, 0, 0, 0, 0, 0, 0, 0
    .long 0, 0, 0, 0, 0, 0, 0, 0, 0, 0, 0, 0, 0, 0, 0, 0
    .long 6, 24, 24, 8192, 1536, 263680, 8388608, 0, 32768, 4, 20996096, 131072, 0, 0, 218104336, 1
    .long 4, 24, 24, 8192, 1536, 263680, 8388608, 262144, 32768, 4, 22044672, 131072, 0, 0, 218104464, 1
    .long 1, 24, 24, 8192, 1024, 1280, 8388608, 1048576, 32768, 8, 25182208, 131072, 0, 0, 218104848, 4
    .long 1, 32, 32, 8192, 1024, 1280, 8388608, 2621440, 32768, 8, 48250880, 131072, 0, 0, 218105616, 4
    .long 1, 24, 24, 8192, 1024, 1280, 8388608, 3145728, 32768, 8, 33570816, 131072, 0, 0, 218105872, 4
    .long 1, 24, 24, 8192, 1024, 1280, 8388608, 3670016, 32768, 8, 35667968, 131072, 0, 0, 218106128, 4
    .long 1, 80, 80, 2048, 1024, 1280, 7340032, 56360960, 114688, 7, 168312832, 32768, 218103872, 7, 218106432, 1
    .long 0, 0, 0, 0, 0, 0, 0, 0, 0, 0, 0, 0, 0, 0, 0, 0
    .long 0, 0, 0, 0, 0, 0, 0, 0, 0, 0, 0, 0, 0, 0, 0, 0
    .long 0, 0, 0, 0, 0, 0, 0, 0, 0, 0, 0, 0, 0, 0, 0, 0
    .long 6, 24, 24, 8192, 3584, 265728, 8388608, 0, 32768, 4, 21028864, 131072, 0, 0, 218104368, 1
    .long 4, 24, 24, 8192, 3584, 265728, 8388608, 262144, 32768, 4, 22077440, 131072, 0, 0, 218104496, 1
    .long 1, 24, 24, 8192, 3072, 3328, 8388608, 1048576, 32768, 8, 25214976, 131072, 0, 0, 218104880, 4
    .long 1, 32, 32, 8192, 3072, 3328, 8388608, 2621440, 32768, 8, 48283648, 131072, 0, 0, 218105648, 4
    .long 1, 24, 24, 8192, 3072, 3328, 8388608, 3145728, 32768, 8, 33603584, 131072, 0, 0, 218105904, 4
    .long 1, 24, 24, 8192, 3072, 3328, 8388608, 3670016, 32768, 8, 35700736, 131072, 0, 0, 218106160, 4
    .long 1, 80, 80, 2048, 1836032, 1836288, 7340032, 56389632, 114688, 7, 172507136, 32768, 218103888, 7, 218106432, 1
    .long 0, 0, 0, 0, 0, 0, 0, 0, 0, 0, 0, 0, 0, 0, 0, 0
    .long 0, 0, 0, 0, 0, 0, 0, 0, 0, 0, 0, 0, 0, 0, 0, 0
    .long 0, 0, 0, 0, 0, 0, 0, 0, 0, 0, 0, 0, 0, 0, 0, 0
    .long 6, 24, 24, 8192, 5632, 267776, 8388608, 0, 32768, 4, 21061632, 131072, 0, 0, 218104400, 1
    .long 4, 24, 24, 8192, 5632, 267776, 8388608, 262144, 32768, 4, 22110208, 131072, 0, 0, 218104528, 1
    .long 1, 24, 24, 8192, 5120, 5376, 8388608, 1048576, 32768, 8, 25247744, 131072, 0, 0, 218104912, 4
    .long 1, 32, 32, 8192, 5120, 5376, 8388608, 2621440, 32768, 8, 48316416, 131072, 0, 0, 218105680, 4
    .long 1, 24, 24, 8192, 5120, 5376, 8388608, 3145728, 32768, 8, 33636352, 131072, 0, 0, 218105936, 4
    .long 1, 24, 24, 8192, 5120, 5376, 8388608, 3670016, 32768, 8, 35733504, 131072, 0, 0, 218106192, 4
    .long 1, 80, 80, 2048, 3671040, 3671296, 7340032, 56418304, 114688, 7, 176701440, 32768, 218103904, 7, 218106432, 1
    .long 0, 0, 0, 0, 0, 0, 0, 0, 0, 0, 0, 0, 0, 0, 0, 0
    .long 0, 0, 0, 0, 0, 0, 0, 0, 0, 0, 0, 0, 0, 0, 0, 0
    .long 0, 0, 0, 0, 0, 0, 0, 0, 0, 0, 0, 0, 0, 0, 0, 0
    .long 6, 24, 24, 8192, 7680, 269824, 8388608, 0, 32768, 4, 21094400, 131072, 0, 0, 218104432, 1
    .long 4, 24, 24, 8192, 7680, 269824, 8388608, 262144, 32768, 4, 22142976, 131072, 0, 0, 218104560, 1
    .long 1, 24, 24, 8192, 7168, 7424, 8388608, 1048576, 32768, 8, 25280512, 131072, 0, 0, 218104944, 4
    .long 1, 32, 32, 8192, 7168, 7424, 8388608, 2621440, 32768, 8, 48349184, 131072, 0, 0, 218105712, 4
    .long 1, 24, 24, 8192, 7168, 7424, 8388608, 3145728, 32768, 8, 33669120, 131072, 0, 0, 218105968, 4
    .long 1, 24, 24, 8192, 7168, 7424, 8388608, 3670016, 32768, 8, 35766272, 131072, 0, 0, 218106224, 4
    .long 1, 80, 80, 2048, 5506048, 5506304, 7340032, 56446976, 114688, 7, 180895744, 32768, 218103920, 7, 218106432, 1
    .long 0, 0, 0, 0, 0, 0, 0, 0, 0, 0, 0, 0, 0, 0, 0, 0
    .long 0, 0, 0, 0, 0, 0, 0, 0, 0, 0, 0, 0, 0, 0, 0, 0
    .long 0, 0, 0, 0, 0, 0, 0, 0, 0, 0, 0, 0, 0, 0, 0, 0
    .long 6, 24, 24, 8192, 1792, 263936, 8388608, 0, 32768, 4, 21000192, 131072, 0, 0, 218104336, 1
    .long 4, 24, 24, 8192, 1792, 263936, 8388608, 262144, 32768, 4, 22048768, 131072, 0, 0, 218104464, 1
    .long 1, 24, 24, 8192, 1536, 1792, 8388608, 1048576, 32768, 8, 25190400, 131072, 0, 0, 218104848, 4
    .long 1, 32, 32, 8192, 1536, 1792, 8388608, 2621440, 32768, 8, 48259072, 131072, 0, 0, 218105616, 4
    .long 1, 24, 24, 8192, 1536, 1792, 8388608, 3145728, 32768, 8, 33579008, 131072, 0, 0, 218105872, 4
    .long 1, 24, 24, 8192, 1536, 1792, 8388608, 3670016, 32768, 8, 35676160, 131072, 0, 0, 218106128, 4
    .long 1, 80, 80, 2048, 1536, 1792, 7340032, 56360960, 114688, 7, 168321024, 32768, 218103872, 7, 218106432, 1
    .long 0, 0, 0, 0, 0, 0, 0, 0, 0, 0, 0, 0, 0, 0, 0, 0
    .long 0, 0, 0, 0, 0, 0, 0, 0, 0, 0, 0, 0, 0, 0, 0, 0
    .long 0, 0, 0, 0, 0, 0, 0, 0, 0, 0, 0, 0, 0, 0, 0, 0
    .long 6, 24, 24, 8192, 3840, 265984, 8388608, 0, 32768, 4, 21032960, 131072, 0, 0, 218104368, 1
    .long 4, 24, 24, 8192, 3840, 265984, 8388608, 262144, 32768, 4, 22081536, 131072, 0, 0, 218104496, 1
    .long 1, 24, 24, 8192, 3584, 3840, 8388608, 1048576, 32768, 8, 25223168, 131072, 0, 0, 218104880, 4
    .long 1, 32, 32, 8192, 3584, 3840, 8388608, 2621440, 32768, 8, 48291840, 131072, 0, 0, 218105648, 4
    .long 1, 24, 24, 8192, 3584, 3840, 8388608, 3145728, 32768, 8, 33611776, 131072, 0, 0, 218105904, 4
    .long 1, 24, 24, 8192, 3584, 3840, 8388608, 3670016, 32768, 8, 35708928, 131072, 0, 0, 218106160, 4
    .long 1, 80, 80, 2048, 1836544, 1836800, 7340032, 56389632, 114688, 7, 172515328, 32768, 218103888, 7, 218106432, 1
    .long 0, 0, 0, 0, 0, 0, 0, 0, 0, 0, 0, 0, 0, 0, 0, 0
    .long 0, 0, 0, 0, 0, 0, 0, 0, 0, 0, 0, 0, 0, 0, 0, 0
    .long 0, 0, 0, 0, 0, 0, 0, 0, 0, 0, 0, 0, 0, 0, 0, 0
    .long 6, 24, 24, 8192, 5888, 268032, 8388608, 0, 32768, 4, 21065728, 131072, 0, 0, 218104400, 1
    .long 4, 24, 24, 8192, 5888, 268032, 8388608, 262144, 32768, 4, 22114304, 131072, 0, 0, 218104528, 1
    .long 1, 24, 24, 8192, 5632, 5888, 8388608, 1048576, 32768, 8, 25255936, 131072, 0, 0, 218104912, 4
    .long 1, 32, 32, 8192, 5632, 5888, 8388608, 2621440, 32768, 8, 48324608, 131072, 0, 0, 218105680, 4
    .long 1, 24, 24, 8192, 5632, 5888, 8388608, 3145728, 32768, 8, 33644544, 131072, 0, 0, 218105936, 4
    .long 1, 24, 24, 8192, 5632, 5888, 8388608, 3670016, 32768, 8, 35741696, 131072, 0, 0, 218106192, 4
    .long 1, 80, 80, 2048, 3671552, 3671808, 7340032, 56418304, 114688, 7, 176709632, 32768, 218103904, 7, 218106432, 1
    .long 0, 0, 0, 0, 0, 0, 0, 0, 0, 0, 0, 0, 0, 0, 0, 0
    .long 0, 0, 0, 0, 0, 0, 0, 0, 0, 0, 0, 0, 0, 0, 0, 0
    .long 0, 0, 0, 0, 0, 0, 0, 0, 0, 0, 0, 0, 0, 0, 0, 0
    .long 6, 24, 24, 8192, 7936, 270080, 8388608, 0, 32768, 4, 21098496, 131072, 0, 0, 218104432, 1
    .long 4, 24, 24, 8192, 7936, 270080, 8388608, 262144, 32768, 4, 22147072, 131072, 0, 0, 218104560, 1
    .long 1, 24, 24, 8192, 7680, 7936, 8388608, 1048576, 32768, 8, 25288704, 131072, 0, 0, 218104944, 4
    .long 1, 32, 32, 8192, 7680, 7936, 8388608, 2621440, 32768, 8, 48357376, 131072, 0, 0, 218105712, 4
    .long 1, 24, 24, 8192, 7680, 7936, 8388608, 3145728, 32768, 8, 33677312, 131072, 0, 0, 218105968, 4
    .long 1, 24, 24, 8192, 7680, 7936, 8388608, 3670016, 32768, 8, 35774464, 131072, 0, 0, 218106224, 4
    .long 1, 80, 80, 2048, 5506560, 5506816, 7340032, 56446976, 114688, 7, 180903936, 32768, 218103920, 7, 218106432, 1
    .long 0, 0, 0, 0, 0, 0, 0, 0, 0, 0, 0, 0, 0, 0, 0, 0
    .long 0, 0, 0, 0, 0, 0, 0, 0, 0, 0, 0, 0, 0, 0, 0, 0
    .long 0, 0, 0, 0, 0, 0, 0, 0, 0, 0, 0, 0, 0, 0, 0, 0
    .long 6, 32, 32, 8192, 0, 262144, 8388608, 0, 32768, 4, 37748736, 131072, 0, 0, 218104320, 1
    .long 4, 32, 32, 8192, 0, 262144, 8388608, 262144, 32768, 4, 38797312, 131072, 0, 0, 218104448, 1
    .long 4, 16, 16, 8192, 1792, 263936, 8388608, 786432, 32768, 4, 7368704, 131072, 0, 0, 218104592, 1
    .long 1, 24, 24, 8192, 0, 256, 8388608, 1572864, 32768, 8, 27262976, 131072, 0, 0, 218105088, 4
    .long 2, 64, 72, 7168, 0, 0, 7340032, 0, 32768, 8, 54525952, 114688, 0, 0, 218103808, 1
    .long 2, 64, 72, 7168, 6144, 6144, 7340032, 1048576, 32768, 8, 58294272, 114688, 0, 0, 218103984, 1
    .long 2, 64, 72, 7168, 5120, 5120, 7340032, 2621440, 32768, 8, 63782912, 114688, 0, 0, 218104160, 1
    .long 1, 80, 80, 2048, 0, 256, 7340032, 61865984, 114688, 7, 169869312, 32768, 218104064, 7, 218106624, 1
    .long 0, 0, 0, 0, 0, 0, 0, 0, 0, 0, 0, 0, 0, 0, 0, 0
    .long 0, 0, 0, 0, 0, 0, 0, 0, 0, 0, 0, 0, 0, 0, 0, 0
    .long 6, 32, 32, 8192, 2048, 264192, 8388608, 0, 32768, 4, 37781504, 131072, 0, 0, 218104352, 1
    .long 4, 32, 32, 8192, 2048, 264192, 8388608, 262144, 32768, 4, 38830080, 131072, 0, 0, 218104480, 1
    .long 4, 16, 16, 8192, 3840, 265984, 8388608, 786432, 32768, 4, 7401472, 131072, 0, 0, 218104624, 1
    .long 1, 24, 24, 8192, 2048, 2304, 8388608, 1572864, 32768, 8, 27295744, 131072, 0, 0, 218105120, 4
    .long 2, 64, 72, 7168, 256, 256, 7340032, 0, 32768, 8, 54530048, 114688, 0, 0, 218103808, 1
    .long 2, 64, 72, 7168, 6400, 6400, 7340032, 1048576, 32768, 8, 58298368, 114688, 0, 0, 218103984, 1
    .long 2, 64, 72, 7168, 5376, 5376, 7340032, 2621440, 32768, 8, 63787008, 114688, 0, 0, 218104176, 1
    .long 1, 80, 80, 2048, 1835008, 1835264, 7340032, 61894656, 114688, 7, 174063616, 32768, 218104080, 7, 218106624, 1
    .long 0, 0, 0, 0, 0, 0, 0, 0, 0, 0, 0, 0, 0, 0, 0, 0
    .long 0, 0, 0, 0, 0, 0, 0, 0, 0, 0, 0, 0, 0, 0, 0, 0
    .long 6, 32, 32, 8192, 4096, 266240, 8388608, 0, 32768, 4, 37814272, 131072, 0, 0, 218104384, 1
    .long 4, 32, 32, 8192, 4096, 266240, 8388608, 262144, 32768, 4, 38862848, 131072, 0, 0, 218104512, 1
    .long 4, 16, 16, 8192, 5888, 268032, 8388608, 786432, 32768, 4, 7434240, 131072, 0, 0, 218104656, 1
    .long 1, 24, 24, 8192, 4096, 4352, 8388608, 1572864, 32768, 8, 27328512, 131072, 0, 0, 218105152, 4
    .long 2, 64, 72, 7168, 512, 512, 7340032, 0, 32768, 8, 54534144, 114688, 0, 0, 218103808, 1
    .long 2, 64, 72, 7168, 6656, 6656, 7340032, 1048576, 32768, 8, 58302464, 114688, 0, 0, 218103984, 1
    .long 2, 64, 72, 7168, 5632, 5632, 7340032, 2621440, 32768, 8, 63791104, 114688, 0, 0, 218104176, 1
    .long 1, 80, 80, 2048, 3670016, 3670272, 7340032, 61923328, 114688, 7, 178257920, 32768, 218104096, 7, 218106624, 1
    .long 0, 0, 0, 0, 0, 0, 0, 0, 0, 0, 0, 0, 0, 0, 0, 0
    .long 0, 0, 0, 0, 0, 0, 0, 0, 0, 0, 0, 0, 0, 0, 0, 0
    .long 6, 32, 32, 8192, 6144, 268288, 8388608, 0, 32768, 4, 37847040, 131072, 0, 0, 218104416, 1
    .long 4, 32, 32, 8192, 6144, 268288, 8388608, 262144, 32768, 4, 38895616, 131072, 0, 0, 218104544, 1
    .long 4, 16, 16, 8192, 7936, 270080, 8388608, 786432, 32768, 4, 7467008, 131072, 0, 0, 218104688, 1
    .long 1, 24, 24, 8192, 6144, 6400, 8388608, 1572864, 32768, 8, 27361280, 131072, 0, 0, 218105184, 4
    .long 2, 64, 72, 7168, 768, 768, 7340032, 0, 32768, 8, 54538240, 114688, 0, 0, 218103808, 1
    .long 2, 64, 72, 7168, 6912, 6912, 7340032, 1048576, 32768, 8, 58306560, 114688, 0, 0, 218103984, 1
    .long 2, 64, 72, 7168, 5888, 5888, 7340032, 2621440, 32768, 8, 63795200, 114688, 0, 0, 218104176, 1
    .long 1, 80, 80, 2048, 5505024, 5505280, 7340032, 61952000, 114688, 7, 182452224, 32768, 218104112, 7, 218106624, 1
    .long 0, 0, 0, 0, 0, 0, 0, 0, 0, 0, 0, 0, 0, 0, 0, 0
    .long 0, 0, 0, 0, 0, 0, 0, 0, 0, 0, 0, 0, 0, 0, 0, 0
    .long 6, 32, 32, 8192, 256, 262400, 8388608, 0, 32768, 4, 37752832, 131072, 0, 0, 218104320, 1
    .long 4, 32, 32, 8192, 256, 262400, 8388608, 262144, 32768, 4, 38801408, 131072, 0, 0, 218104448, 1
    .long 4, 16, 16, 8192, 1792, 263936, 8388608, 524288, 32768, 4, 6320128, 131072, 0, 0, 218104592, 1
    .long 1, 24, 24, 8192, 512, 768, 8388608, 1572864, 32768, 8, 27271168, 131072, 0, 0, 218105088, 4
    .long 2, 64, 72, 7168, 1024, 1024, 7340032, 0, 32768, 8, 54542336, 114688, 0, 0, 218103808, 1
    .long 2, 64, 72, 7168, 0, 0, 7340032, 1572864, 32768, 8, 60030976, 114688, 0, 0, 218104000, 1
    .long 2, 64, 72, 7168, 6144, 6144, 7340032, 2621440, 32768, 8, 63799296, 114688, 0, 0, 218104176, 1
    .long 1, 80, 80, 2048, 512, 768, 7340032, 61865984, 114688, 7, 169877504, 32768, 218104064, 7, 218106624, 1
    .long 0, 0, 0, 0, 0, 0, 0, 0, 0, 0, 0, 0, 0, 0, 0, 0
    .long 0, 0, 0, 0, 0, 0, 0, 0, 0, 0, 0, 0, 0, 0, 0, 0
    .long 6, 32, 32, 8192, 2304, 264448, 8388608, 0, 32768, 4, 37785600, 131072, 0, 0, 218104352, 1
    .long 4, 32, 32, 8192, 2304, 264448, 8388608, 262144, 32768, 4, 38834176, 131072, 0, 0, 218104480, 1
    .long 4, 16, 16, 8192, 3840, 265984, 8388608, 524288, 32768, 4, 6352896, 131072, 0, 0, 218104624, 1
    .long 1, 24, 24, 8192, 2560, 2816, 8388608, 1572864, 32768, 8, 27303936, 131072, 0, 0, 218105120, 4
    .long 2, 64, 72, 7168, 1280, 1280, 7340032, 0, 32768, 8, 54546432, 114688, 0, 0, 218103808, 1
    .long 2, 64, 72, 7168, 256, 256, 7340032, 1572864, 32768, 8, 60035072, 114688, 0, 0, 218104000, 1
    .long 2, 64, 72, 7168, 6400, 6400, 7340032, 2621440, 32768, 8, 63803392, 114688, 0, 0, 218104176, 1
    .long 1, 80, 80, 2048, 1835520, 1835776, 7340032, 61894656, 114688, 7, 174071808, 32768, 218104080, 7, 218106624, 1
    .long 0, 0, 0, 0, 0, 0, 0, 0, 0, 0, 0, 0, 0, 0, 0, 0
    .long 0, 0, 0, 0, 0, 0, 0, 0, 0, 0, 0, 0, 0, 0, 0, 0
    .long 6, 32, 32, 8192, 4352, 266496, 8388608, 0, 32768, 4, 37818368, 131072, 0, 0, 218104384, 1
    .long 4, 32, 32, 8192, 4352, 266496, 8388608, 262144, 32768, 4, 38866944, 131072, 0, 0, 218104512, 1
    .long 4, 16, 16, 8192, 5888, 268032, 8388608, 524288, 32768, 4, 6385664, 131072, 0, 0, 218104656, 1
    .long 1, 24, 24, 8192, 4608, 4864, 8388608, 1572864, 32768, 8, 27336704, 131072, 0, 0, 218105152, 4
    .long 2, 64, 72, 7168, 1536, 1536, 7340032, 0, 32768, 8, 54550528, 114688, 0, 0, 218103808, 1
    .long 2, 64, 72, 7168, 512, 512, 7340032, 1572864, 32768, 8, 60039168, 114688, 0, 0, 218104000, 1
    .long 2, 64, 72, 7168, 6656, 6656, 7340032, 2621440, 32768, 8, 63807488, 114688, 0, 0, 218104176, 1
    .long 1, 80, 80, 2048, 3670528, 3670784, 7340032, 61923328, 114688, 7, 178266112, 32768, 218104096, 7, 218106624, 1
    .long 0, 0, 0, 0, 0, 0, 0, 0, 0, 0, 0, 0, 0, 0, 0, 0
    .long 0, 0, 0, 0, 0, 0, 0, 0, 0, 0, 0, 0, 0, 0, 0, 0
    .long 6, 32, 32, 8192, 6400, 268544, 8388608, 0, 32768, 4, 37851136, 131072, 0, 0, 218104416, 1
    .long 4, 32, 32, 8192, 6400, 268544, 8388608, 262144, 32768, 4, 38899712, 131072, 0, 0, 218104544, 1
    .long 4, 16, 16, 8192, 7936, 270080, 8388608, 524288, 32768, 4, 6418432, 131072, 0, 0, 218104688, 1
    .long 1, 24, 24, 8192, 6656, 6912, 8388608, 1572864, 32768, 8, 27369472, 131072, 0, 0, 218105184, 4
    .long 2, 64, 72, 7168, 1792, 1792, 7340032, 0, 32768, 8, 54554624, 114688, 0, 0, 218103824, 1
    .long 2, 64, 72, 7168, 768, 768, 7340032, 1572864, 32768, 8, 60043264, 114688, 0, 0, 218104000, 1
    .long 2, 64, 72, 7168, 6912, 6912, 7340032, 2621440, 32768, 8, 63811584, 114688, 0, 0, 218104176, 1
    .long 1, 80, 80, 2048, 5505536, 5505792, 7340032, 61952000, 114688, 7, 182460416, 32768, 218104112, 7, 218106624, 1
    .long 0, 0, 0, 0, 0, 0, 0, 0, 0, 0, 0, 0, 0, 0, 0, 0
    .long 0, 0, 0, 0, 0, 0, 0, 0, 0, 0, 0, 0, 0, 0, 0, 0
    .long 6, 32, 32, 8192, 512, 262656, 8388608, 0, 32768, 4, 37756928, 131072, 0, 0, 218104320, 1
    .long 4, 32, 32, 8192, 512, 262656, 8388608, 262144, 32768, 4, 38805504, 131072, 0, 0, 218104448, 1
    .long 4, 16, 16, 8192, 1536, 263680, 8388608, 786432, 32768, 4, 7364608, 131072, 0, 0, 218104592, 1
    .long 1, 24, 24, 8192, 1024, 1280, 8388608, 1572864, 32768, 8, 27279360, 131072, 0, 0, 218105104, 4
    .long 2, 64, 72, 7168, 2048, 2048, 7340032, 0, 32768, 8, 54558720, 114688, 0, 0, 218103824, 1
    .long 2, 64, 72, 7168, 1024, 1024, 7340032, 1572864, 32768, 8, 60047360, 114688, 0, 0, 218104000, 1
    .long 2, 64, 72, 7168, 0, 0, 7340032, 3145728, 32768, 8, 65536000, 114688, 0, 0, 218104192, 1
    .long 1, 80, 80, 2048, 1024, 1280, 7340032, 61865984, 114688, 7, 169885696, 32768, 218104064, 7, 218106624, 1
    .long 0, 0, 0, 0, 0, 0, 0, 0, 0, 0, 0, 0, 0, 0, 0, 0
    .long 0, 0, 0, 0, 0, 0, 0, 0, 0, 0, 0, 0, 0, 0, 0, 0
    .long 6, 32, 32, 8192, 2560, 264704, 8388608, 0, 32768, 4, 37789696, 131072, 0, 0, 218104352, 1
    .long 4, 32, 32, 8192, 2560, 264704, 8388608, 262144, 32768, 4, 38838272, 131072, 0, 0, 218104480, 1
    .long 4, 16, 16, 8192, 3584, 265728, 8388608, 786432, 32768, 4, 7397376, 131072, 0, 0, 218104624, 1
    .long 1, 24, 24, 8192, 3072, 3328, 8388608, 1572864, 32768, 8, 27312128, 131072, 0, 0, 218105136, 4
    .long 2, 64, 72, 7168, 2304, 2304, 7340032, 0, 32768, 8, 54562816, 114688, 0, 0, 218103824, 1
    .long 2, 64, 72, 7168, 1280, 1280, 7340032, 1572864, 32768, 8, 60051456, 114688, 0, 0, 218104000, 1
    .long 2, 64, 72, 7168, 256, 256, 7340032, 3145728, 32768, 8, 65540096, 114688, 0, 0, 218104192, 1
    .long 1, 80, 80, 2048, 1836032, 1836288, 7340032, 61894656, 114688, 7, 174080000, 32768, 218104080, 7, 218106624, 1
    .long 0, 0, 0, 0, 0, 0, 0, 0, 0, 0, 0, 0, 0, 0, 0, 0
    .long 0, 0, 0, 0, 0, 0, 0, 0, 0, 0, 0, 0, 0, 0, 0, 0
    .long 6, 32, 32, 8192, 4608, 266752, 8388608, 0, 32768, 4, 37822464, 131072, 0, 0, 218104384, 1
    .long 4, 32, 32, 8192, 4608, 266752, 8388608, 262144, 32768, 4, 38871040, 131072, 0, 0, 218104512, 1
    .long 4, 16, 16, 8192, 5632, 267776, 8388608, 786432, 32768, 4, 7430144, 131072, 0, 0, 218104656, 1
    .long 1, 24, 24, 8192, 5120, 5376, 8388608, 1572864, 32768, 8, 27344896, 131072, 0, 0, 218105168, 4
    .long 2, 64, 72, 7168, 2560, 2560, 7340032, 0, 32768, 8, 54566912, 114688, 0, 0, 218103824, 1
    .long 2, 64, 72, 7168, 1536, 1536, 7340032, 1572864, 32768, 8, 60055552, 114688, 0, 0, 218104000, 1
    .long 2, 64, 72, 7168, 512, 512, 7340032, 3145728, 32768, 8, 65544192, 114688, 0, 0, 218104192, 1
    .long 1, 80, 80, 2048, 3671040, 3671296, 7340032, 61923328, 114688, 7, 178274304, 32768, 218104096, 7, 218106624, 1
    .long 0, 0, 0, 0, 0, 0, 0, 0, 0, 0, 0, 0, 0, 0, 0, 0
    .long 0, 0, 0, 0, 0, 0, 0, 0, 0, 0, 0, 0, 0, 0, 0, 0
    .long 6, 32, 32, 8192, 6656, 268800, 8388608, 0, 32768, 4, 37855232, 131072, 0, 0, 218104416, 1
    .long 4, 32, 32, 8192, 6656, 268800, 8388608, 262144, 32768, 4, 38903808, 131072, 0, 0, 218104544, 1
    .long 4, 16, 16, 8192, 7680, 269824, 8388608, 786432, 32768, 4, 7462912, 131072, 0, 0, 218104688, 1
    .long 1, 24, 24, 8192, 7168, 7424, 8388608, 1572864, 32768, 8, 27377664, 131072, 0, 0, 218105200, 4
    .long 2, 64, 72, 7168, 2816, 2816, 7340032, 0, 32768, 8, 54571008, 114688, 0, 0, 218103824, 1
    .long 2, 64, 72, 7168, 1792, 1792, 7340032, 1572864, 32768, 8, 60059648, 114688, 0, 0, 218104016, 1
    .long 2, 64, 72, 7168, 768, 768, 7340032, 3145728, 32768, 8, 65548288, 114688, 0, 0, 218104192, 1
    .long 1, 80, 80, 2048, 5506048, 5506304, 7340032, 61952000, 114688, 7, 182468608, 32768, 218104112, 7, 218106624, 1
    .long 0, 0, 0, 0, 0, 0, 0, 0, 0, 0, 0, 0, 0, 0, 0, 0
    .long 0, 0, 0, 0, 0, 0, 0, 0, 0, 0, 0, 0, 0, 0, 0, 0
    .long 6, 32, 32, 8192, 768, 262912, 8388608, 0, 32768, 4, 37761024, 131072, 0, 0, 218104320, 1
    .long 4, 32, 32, 8192, 768, 262912, 8388608, 262144, 32768, 4, 38809600, 131072, 0, 0, 218104448, 1
    .long 4, 16, 16, 8192, 1536, 263680, 8388608, 524288, 32768, 4, 6316032, 131072, 0, 0, 218104592, 1
    .long 1, 24, 24, 8192, 1536, 1792, 8388608, 1572864, 32768, 8, 27287552, 131072, 0, 0, 218105104, 4
    .long 2, 64, 72, 7168, 3072, 3072, 7340032, 0, 32768, 8, 54575104, 114688, 0, 0, 218103824, 1
    .long 2, 64, 72, 7168, 2048, 2048, 7340032, 1572864, 32768, 8, 60063744, 114688, 0, 0, 218104016, 1
    .long 2, 64, 72, 7168, 1024, 1024, 7340032, 3145728, 32768, 8, 65552384, 114688, 0, 0, 218104192, 1
    .long 1, 80, 80, 2048, 1536, 1792, 7340032, 61865984, 114688, 7, 169893888, 32768, 218104064, 7, 218106624, 1
    .long 0, 0, 0, 0, 0, 0, 0, 0, 0, 0, 0, 0, 0, 0, 0, 0
    .long 0, 0, 0, 0, 0, 0, 0, 0, 0, 0, 0, 0, 0, 0, 0, 0
    .long 6, 32, 32, 8192, 2816, 264960, 8388608, 0, 32768, 4, 37793792, 131072, 0, 0, 218104352, 1
    .long 4, 32, 32, 8192, 2816, 264960, 8388608, 262144, 32768, 4, 38842368, 131072, 0, 0, 218104480, 1
    .long 4, 16, 16, 8192, 3584, 265728, 8388608, 524288, 32768, 4, 6348800, 131072, 0, 0, 218104624, 1
    .long 1, 24, 24, 8192, 3584, 3840, 8388608, 1572864, 32768, 8, 27320320, 131072, 0, 0, 218105136, 4
    .long 2, 64, 72, 7168, 3328, 3328, 7340032, 0, 32768, 8, 54579200, 114688, 0, 0, 218103824, 1
    .long 2, 64, 72, 7168, 2304, 2304, 7340032, 1572864, 32768, 8, 60067840, 114688, 0, 0, 218104016, 1
    .long 2, 64, 72, 7168, 1280, 1280, 7340032, 3145728, 32768, 8, 65556480, 114688, 0, 0, 218104192, 1
    .long 1, 80, 80, 2048, 1836544, 1836800, 7340032, 61894656, 114688, 7, 174088192, 32768, 218104080, 7, 218106624, 1
    .long 0, 0, 0, 0, 0, 0, 0, 0, 0, 0, 0, 0, 0, 0, 0, 0
    .long 0, 0, 0, 0, 0, 0, 0, 0, 0, 0, 0, 0, 0, 0, 0, 0
    .long 6, 32, 32, 8192, 4864, 267008, 8388608, 0, 32768, 4, 37826560, 131072, 0, 0, 218104384, 1
    .long 4, 32, 32, 8192, 4864, 267008, 8388608, 262144, 32768, 4, 38875136, 131072, 0, 0, 218104512, 1
    .long 4, 16, 16, 8192, 5632, 267776, 8388608, 524288, 32768, 4, 6381568, 131072, 0, 0, 218104656, 1
    .long 1, 24, 24, 8192, 5632, 5888, 8388608, 1572864, 32768, 8, 27353088, 131072, 0, 0, 218105168, 4
    .long 2, 64, 72, 7168, 3584, 3584, 7340032, 0, 32768, 8, 54583296, 114688, 0, 0, 218103840, 1
    .long 2, 64, 72, 7168, 2560, 2560, 7340032, 1572864, 32768, 8, 60071936, 114688, 0, 0, 218104016, 1
    .long 2, 64, 72, 7168, 1536, 1536, 7340032, 3145728, 32768, 8, 65560576, 114688, 0, 0, 218104192, 1
    .long 1, 80, 80, 2048, 3671552, 3671808, 7340032, 61923328, 114688, 7, 178282496, 32768, 218104096, 7, 218106624, 1
    .long 0, 0, 0, 0, 0, 0, 0, 0, 0, 0, 0, 0, 0, 0, 0, 0
    .long 0, 0, 0, 0, 0, 0, 0, 0, 0, 0, 0, 0, 0, 0, 0, 0
    .long 6, 32, 32, 8192, 6912, 269056, 8388608, 0, 32768, 4, 37859328, 131072, 0, 0, 218104416, 1
    .long 4, 32, 32, 8192, 6912, 269056, 8388608, 262144, 32768, 4, 38907904, 131072, 0, 0, 218104544, 1
    .long 4, 16, 16, 8192, 7680, 269824, 8388608, 524288, 32768, 4, 6414336, 131072, 0, 0, 218104688, 1
    .long 1, 24, 24, 8192, 7680, 7936, 8388608, 1572864, 32768, 8, 27385856, 131072, 0, 0, 218105200, 4
    .long 2, 64, 72, 7168, 3840, 3840, 7340032, 0, 32768, 8, 54587392, 114688, 0, 0, 218103840, 1
    .long 2, 64, 72, 7168, 2816, 2816, 7340032, 1572864, 32768, 8, 60076032, 114688, 0, 0, 218104016, 1
    .long 2, 64, 72, 7168, 1792, 1792, 7340032, 3145728, 32768, 8, 65564672, 114688, 0, 0, 218104208, 1
    .long 1, 80, 80, 2048, 5506560, 5506816, 7340032, 61952000, 114688, 7, 182476800, 32768, 218104112, 7, 218106624, 1
    .long 0, 0, 0, 0, 0, 0, 0, 0, 0, 0, 0, 0, 0, 0, 0, 0
    .long 0, 0, 0, 0, 0, 0, 0, 0, 0, 0, 0, 0, 0, 0, 0, 0
    .long 6, 32, 32, 8192, 1024, 263168, 8388608, 0, 32768, 4, 37765120, 131072, 0, 0, 218104336, 1
    .long 4, 32, 32, 8192, 1024, 263168, 8388608, 262144, 32768, 4, 38813696, 131072, 0, 0, 218104464, 1
    .long 4, 16, 16, 8192, 1280, 263424, 8388608, 786432, 32768, 4, 7360512, 131072, 0, 0, 218104592, 1
    .long 1, 16, 16, 8192, 0, 256, 8388608, 1572864, 32768, 8, 10485760, 131072, 0, 0, 218105088, 4
    .long 2, 64, 72, 7168, 4096, 4096, 7340032, 0, 32768, 8, 54591488, 114688, 0, 0, 218103840, 1
    .long 2, 64, 72, 7168, 3072, 3072, 7340032, 1572864, 32768, 8, 60080128, 114688, 0, 0, 218104016, 1
    .long 2, 64, 72, 7168, 2048, 2048, 7340032, 3145728, 32768, 8, 65568768, 114688, 0, 0, 218104208, 1
    .long 1, 80, 80, 2048, 0, 256, 7340032, 63700992, 114688, 7, 170393600, 32768, 218104128, 7, 218106688, 1
    .long 0, 0, 0, 0, 0, 0, 0, 0, 0, 0, 0, 0, 0, 0, 0, 0
    .long 0, 0, 0, 0, 0, 0, 0, 0, 0, 0, 0, 0, 0, 0, 0, 0
    .long 6, 32, 32, 8192, 3072, 265216, 8388608, 0, 32768, 4, 37797888, 131072, 0, 0, 218104368, 1
    .long 4, 32, 32, 8192, 3072, 265216, 8388608, 262144, 32768, 4, 38846464, 131072, 0, 0, 218104496, 1
    .long 4, 16, 16, 8192, 3328, 265472, 8388608, 786432, 32768, 4, 7393280, 131072, 0, 0, 218104624, 1
    .long 1, 16, 16, 8192, 2048, 2304, 8388608, 1572864, 32768, 8, 10518528, 131072, 0, 0, 218105120, 4
    .long 2, 64, 72, 7168, 4352, 4352, 7340032, 0, 32768, 8, 54595584, 114688, 0, 0, 218103840, 1
    .long 2, 64, 72, 7168, 3328, 3328, 7340032, 1572864, 32768, 8, 60084224, 114688, 0, 0, 218104016, 1
    .long 2, 64, 72, 7168, 2304, 2304, 7340032, 3145728, 32768, 8, 65572864, 114688, 0, 0, 218104208, 1
    .long 1, 80, 80, 2048, 1835008, 1835264, 7340032, 63729664, 114688, 7, 174587904, 32768, 218104144, 7, 218106688, 1
    .long 0, 0, 0, 0, 0, 0, 0, 0, 0, 0, 0, 0, 0, 0, 0, 0
    .long 0, 0, 0, 0, 0, 0, 0, 0, 0, 0, 0, 0, 0, 0, 0, 0
    .long 6, 32, 32, 8192, 5120, 267264, 8388608, 0, 32768, 4, 37830656, 131072, 0, 0, 218104400, 1
    .long 4, 32, 32, 8192, 5120, 267264, 8388608, 262144, 32768, 4, 38879232, 131072, 0, 0, 218104528, 1
    .long 4, 16, 16, 8192, 5376, 267520, 8388608, 786432, 32768, 4, 7426048, 131072, 0, 0, 218104656, 1
    .long 1, 16, 16, 8192, 4096, 4352, 8388608, 1572864, 32768, 8, 10551296, 131072, 0, 0, 218105152, 4
    .long 2, 64, 72, 7168, 4608, 4608, 7340032, 0, 32768, 8, 54599680, 114688, 0, 0, 218103840, 1
    .long 2, 64, 72, 7168, 3584, 3584, 7340032, 1572864, 32768, 8, 60088320, 114688, 0, 0, 218104032, 1
    .long 2, 64, 72, 7168, 2560, 2560, 7340032, 3145728, 32768, 8, 65576960, 114688, 0, 0, 218104208, 1
    .long 1, 80, 80, 2048, 3670016, 3670272, 7340032, 63758336, 114688, 7, 178782208, 32768, 218104160, 7, 218106688, 1
    .long 0, 0, 0, 0, 0, 0, 0, 0, 0, 0, 0, 0, 0, 0, 0, 0
    .long 0, 0, 0, 0, 0, 0, 0, 0, 0, 0, 0, 0, 0, 0, 0, 0
    .long 6, 32, 32, 8192, 7168, 269312, 8388608, 0, 32768, 4, 37863424, 131072, 0, 0, 218104432, 1
    .long 4, 32, 32, 8192, 7168, 269312, 8388608, 262144, 32768, 4, 38912000, 131072, 0, 0, 218104560, 1
    .long 4, 16, 16, 8192, 7424, 269568, 8388608, 786432, 32768, 4, 7458816, 131072, 0, 0, 218104688, 1
    .long 1, 16, 16, 8192, 6144, 6400, 8388608, 1572864, 32768, 8, 10584064, 131072, 0, 0, 218105184, 4
    .long 2, 64, 72, 7168, 4864, 4864, 7340032, 0, 32768, 8, 54603776, 114688, 0, 0, 218103840, 1
    .long 2, 64, 72, 7168, 3840, 3840, 7340032, 1572864, 32768, 8, 60092416, 114688, 0, 0, 218104032, 1
    .long 2, 64, 72, 7168, 2816, 2816, 7340032, 3145728, 32768, 8, 65581056, 114688, 0, 0, 218104208, 1
    .long 1, 80, 80, 2048, 5505024, 5505280, 7340032, 63787008, 114688, 7, 182976512, 32768, 218104176, 7, 218106688, 1
    .long 0, 0, 0, 0, 0, 0, 0, 0, 0, 0, 0, 0, 0, 0, 0, 0
    .long 0, 0, 0, 0, 0, 0, 0, 0, 0, 0, 0, 0, 0, 0, 0, 0
    .long 6, 32, 32, 8192, 1280, 263424, 8388608, 0, 32768, 4, 37769216, 131072, 0, 0, 218104336, 1
    .long 4, 32, 32, 8192, 1280, 263424, 8388608, 262144, 32768, 4, 38817792, 131072, 0, 0, 218104464, 1
    .long 4, 16, 16, 8192, 1280, 263424, 8388608, 524288, 32768, 4, 6311936, 131072, 0, 0, 218104592, 1
    .long 1, 16, 16, 8192, 512, 768, 8388608, 1572864, 32768, 8, 10493952, 131072, 0, 0, 218105088, 4
    .long 2, 64, 72, 7168, 5120, 5120, 7340032, 0, 32768, 8, 54607872, 114688, 0, 0, 218103840, 1
    .long 2, 64, 72, 7168, 4096, 4096, 7340032, 1572864, 32768, 8, 60096512, 114688, 0, 0, 218104032, 1
    .long 2, 64, 72, 7168, 3072, 3072, 7340032, 3145728, 32768, 8, 65585152, 114688, 0, 0, 218104208, 1
    .long 1, 80, 80, 2048, 512, 768, 7340032, 63700992, 114688, 7, 170401792, 32768, 218104128, 7, 218106688, 1
    .long 0, 0, 0, 0, 0, 0, 0, 0, 0, 0, 0, 0, 0, 0, 0, 0
    .long 0, 0, 0, 0, 0, 0, 0, 0, 0, 0, 0, 0, 0, 0, 0, 0
    .long 6, 32, 32, 8192, 3328, 265472, 8388608, 0, 32768, 4, 37801984, 131072, 0, 0, 218104368, 1
    .long 4, 32, 32, 8192, 3328, 265472, 8388608, 262144, 32768, 4, 38850560, 131072, 0, 0, 218104496, 1
    .long 4, 16, 16, 8192, 3328, 265472, 8388608, 524288, 32768, 4, 6344704, 131072, 0, 0, 218104624, 1
    .long 1, 16, 16, 8192, 2560, 2816, 8388608, 1572864, 32768, 8, 10526720, 131072, 0, 0, 218105120, 4
    .long 2, 64, 72, 7168, 5376, 5376, 7340032, 0, 32768, 8, 54611968, 114688, 0, 0, 218103856, 1
    .long 2, 64, 72, 7168, 4352, 4352, 7340032, 1572864, 32768, 8, 60100608, 114688, 0, 0, 218104032, 1
    .long 2, 64, 72, 7168, 3328, 3328, 7340032, 3145728, 32768, 8, 65589248, 114688, 0, 0, 218104208, 1
    .long 1, 80, 80, 2048, 1835520, 1835776, 7340032, 63729664, 114688, 7, 174596096, 32768, 218104144, 7, 218106688, 1
    .long 0, 0, 0, 0, 0, 0, 0, 0, 0, 0, 0, 0, 0, 0, 0, 0
    .long 0, 0, 0, 0, 0, 0, 0, 0, 0, 0, 0, 0, 0, 0, 0, 0
    .long 6, 32, 32, 8192, 5376, 267520, 8388608, 0, 32768, 4, 37834752, 131072, 0, 0, 218104400, 1
    .long 4, 32, 32, 8192, 5376, 267520, 8388608, 262144, 32768, 4, 38883328, 131072, 0, 0, 218104528, 1
    .long 4, 16, 16, 8192, 5376, 267520, 8388608, 524288, 32768, 4, 6377472, 131072, 0, 0, 218104656, 1
    .long 1, 16, 16, 8192, 4608, 4864, 8388608, 1572864, 32768, 8, 10559488, 131072, 0, 0, 218105152, 4
    .long 2, 64, 72, 7168, 5632, 5632, 7340032, 0, 32768, 8, 54616064, 114688, 0, 0, 218103856, 1
    .long 2, 64, 72, 7168, 4608, 4608, 7340032, 1572864, 32768, 8, 60104704, 114688, 0, 0, 218104032, 1
    .long 2, 64, 72, 7168, 3584, 3584, 7340032, 3145728, 32768, 8, 65593344, 114688, 0, 0, 218104224, 1
    .long 1, 80, 80, 2048, 3670528, 3670784, 7340032, 63758336, 114688, 7, 178790400, 32768, 218104160, 7, 218106688, 1
    .long 0, 0, 0, 0, 0, 0, 0, 0, 0, 0, 0, 0, 0, 0, 0, 0
    .long 0, 0, 0, 0, 0, 0, 0, 0, 0, 0, 0, 0, 0, 0, 0, 0
    .long 6, 32, 32, 8192, 7424, 269568, 8388608, 0, 32768, 4, 37867520, 131072, 0, 0, 218104432, 1
    .long 4, 32, 32, 8192, 7424, 269568, 8388608, 262144, 32768, 4, 38916096, 131072, 0, 0, 218104560, 1
    .long 4, 16, 16, 8192, 7424, 269568, 8388608, 524288, 32768, 4, 6410240, 131072, 0, 0, 218104688, 1
    .long 1, 16, 16, 8192, 6656, 6912, 8388608, 1572864, 32768, 8, 10592256, 131072, 0, 0, 218105184, 4
    .long 2, 64, 72, 7168, 5888, 5888, 7340032, 0, 32768, 8, 54620160, 114688, 0, 0, 218103856, 1
    .long 2, 64, 72, 7168, 4864, 4864, 7340032, 1572864, 32768, 8, 60108800, 114688, 0, 0, 218104032, 1
    .long 2, 64, 72, 7168, 3840, 3840, 7340032, 3145728, 32768, 8, 65597440, 114688, 0, 0, 218104224, 1
    .long 1, 80, 80, 2048, 5505536, 5505792, 7340032, 63787008, 114688, 7, 182984704, 32768, 218104176, 7, 218106688, 1
    .long 0, 0, 0, 0, 0, 0, 0, 0, 0, 0, 0, 0, 0, 0, 0, 0
    .long 0, 0, 0, 0, 0, 0, 0, 0, 0, 0, 0, 0, 0, 0, 0, 0
    .long 6, 32, 32, 8192, 1536, 263680, 8388608, 0, 32768, 4, 37773312, 131072, 0, 0, 218104336, 1
    .long 4, 32, 32, 8192, 1536, 263680, 8388608, 262144, 32768, 4, 38821888, 131072, 0, 0, 218104464, 1
    .long 4, 16, 16, 8192, 1024, 263168, 8388608, 786432, 32768, 4, 7356416, 131072, 0, 0, 218104592, 1
    .long 1, 16, 16, 8192, 1024, 1280, 8388608, 1572864, 32768, 8, 10502144, 131072, 0, 0, 218105104, 4
    .long 2, 64, 72, 7168, 6144, 6144, 7340032, 0, 32768, 8, 54624256, 114688, 0, 0, 218103856, 1
    .long 2, 64, 72, 7168, 5120, 5120, 7340032, 1572864, 32768, 8, 60112896, 114688, 0, 0, 218104032, 1
    .long 2, 64, 72, 7168, 4096, 4096, 7340032, 3145728, 32768, 8, 65601536, 114688, 0, 0, 218104224, 1
    .long 1, 80, 80, 2048, 1024, 1280, 7340032, 63700992, 114688, 7, 170409984, 32768, 218104128, 7, 218106688, 1
    .long 0, 0, 0, 0, 0, 0, 0, 0, 0, 0, 0, 0, 0, 0, 0, 0
    .long 0, 0, 0, 0, 0, 0, 0, 0, 0, 0, 0, 0, 0, 0, 0, 0
    .long 6, 32, 32, 8192, 3584, 265728, 8388608, 0, 32768, 4, 37806080, 131072, 0, 0, 218104368, 1
    .long 4, 32, 32, 8192, 3584, 265728, 8388608, 262144, 32768, 4, 38854656, 131072, 0, 0, 218104496, 1
    .long 4, 16, 16, 8192, 3072, 265216, 8388608, 786432, 32768, 4, 7389184, 131072, 0, 0, 218104624, 1
    .long 1, 16, 16, 8192, 3072, 3328, 8388608, 1572864, 32768, 8, 10534912, 131072, 0, 0, 218105136, 4
    .long 2, 64, 72, 7168, 6400, 6400, 7340032, 0, 32768, 8, 54628352, 114688, 0, 0, 218103856, 1
    .long 2, 64, 72, 7168, 5376, 5376, 7340032, 1572864, 32768, 8, 60116992, 114688, 0, 0, 218104048, 1
    .long 2, 64, 72, 7168, 4352, 4352, 7340032, 3145728, 32768, 8, 65605632, 114688, 0, 0, 218104224, 1
    .long 1, 80, 80, 2048, 1836032, 1836288, 7340032, 63729664, 114688, 7, 174604288, 32768, 218104144, 7, 218106688, 1
    .long 0, 0, 0, 0, 0, 0, 0, 0, 0, 0, 0, 0, 0, 0, 0, 0
    .long 0, 0, 0, 0, 0, 0, 0, 0, 0, 0, 0, 0, 0, 0, 0, 0
    .long 6, 32, 32, 8192, 5632, 267776, 8388608, 0, 32768, 4, 37838848, 131072, 0, 0, 218104400, 1
    .long 4, 32, 32, 8192, 5632, 267776, 8388608, 262144, 32768, 4, 38887424, 131072, 0, 0, 218104528, 1
    .long 4, 16, 16, 8192, 5120, 267264, 8388608, 786432, 32768, 4, 7421952, 131072, 0, 0, 218104656, 1
    .long 1, 16, 16, 8192, 5120, 5376, 8388608, 1572864, 32768, 8, 10567680, 131072, 0, 0, 218105168, 4
    .long 2, 64, 72, 7168, 6656, 6656, 7340032, 0, 32768, 8, 54632448, 114688, 0, 0, 218103856, 1
    .long 2, 64, 72, 7168, 5632, 5632, 7340032, 1572864, 32768, 8, 60121088, 114688, 0, 0, 218104048, 1
    .long 2, 64, 72, 7168, 4608, 4608, 7340032, 3145728, 32768, 8, 65609728, 114688, 0, 0, 218104224, 1
    .long 1, 80, 80, 2048, 3671040, 3671296, 7340032, 63758336, 114688, 7, 178798592, 32768, 218104160, 7, 218106688, 1
    .long 0, 0, 0, 0, 0, 0, 0, 0, 0, 0, 0, 0, 0, 0, 0, 0
    .long 0, 0, 0, 0, 0, 0, 0, 0, 0, 0, 0, 0, 0, 0, 0, 0
    .long 6, 32, 32, 8192, 7680, 269824, 8388608, 0, 32768, 4, 37871616, 131072, 0, 0, 218104432, 1
    .long 4, 32, 32, 8192, 7680, 269824, 8388608, 262144, 32768, 4, 38920192, 131072, 0, 0, 218104560, 1
    .long 4, 16, 16, 8192, 7168, 269312, 8388608, 786432, 32768, 4, 7454720, 131072, 0, 0, 218104688, 1
    .long 1, 16, 16, 8192, 7168, 7424, 8388608, 1572864, 32768, 8, 10600448, 131072, 0, 0, 218105200, 4
    .long 2, 64, 72, 7168, 6912, 6912, 7340032, 0, 32768, 8, 54636544, 114688, 0, 0, 218103856, 1
    .long 2, 64, 72, 7168, 5888, 5888, 7340032, 1572864, 32768, 8, 60125184, 114688, 0, 0, 218104048, 1
    .long 2, 64, 72, 7168, 4864, 4864, 7340032, 3145728, 32768, 8, 65613824, 114688, 0, 0, 218104224, 1
    .long 1, 80, 80, 2048, 5506048, 5506304, 7340032, 63787008, 114688, 7, 182992896, 32768, 218104176, 7, 218106688, 1
    .long 0, 0, 0, 0, 0, 0, 0, 0, 0, 0, 0, 0, 0, 0, 0, 0
    .long 0, 0, 0, 0, 0, 0, 0, 0, 0, 0, 0, 0, 0, 0, 0, 0
    .long 6, 32, 32, 8192, 1792, 263936, 8388608, 0, 32768, 4, 37777408, 131072, 0, 0, 218104336, 1
    .long 4, 32, 32, 8192, 1792, 263936, 8388608, 262144, 32768, 4, 38825984, 131072, 0, 0, 218104464, 1
    .long 4, 16, 16, 8192, 1024, 263168, 8388608, 524288, 32768, 4, 6307840, 131072, 0, 0, 218104592, 1
    .long 1, 16, 16, 8192, 1536, 1792, 8388608, 1572864, 32768, 8, 10510336, 131072, 0, 0, 218105104, 4
    .long 2, 64, 72, 7168, 0, 0, 7340032, 524288, 32768, 8, 56360960, 114688, 0, 0, 218103872, 1
    .long 2, 64, 72, 7168, 6144, 6144, 7340032, 1572864, 32768, 8, 60129280, 114688, 0, 0, 218104048, 1
    .long 2, 64, 72, 7168, 5120, 5120, 7340032, 3145728, 32768, 8, 65617920, 114688, 0, 0, 218104224, 1
    .long 1, 80, 80, 2048, 1536, 1792, 7340032, 63700992, 114688, 7, 170418176, 32768, 218104128, 7, 218106688, 1
    .long 0, 0, 0, 0, 0, 0, 0, 0, 0, 0, 0, 0, 0, 0, 0, 0
    .long 0, 0, 0, 0, 0, 0, 0, 0, 0, 0, 0, 0, 0, 0, 0, 0
    .long 6, 32, 32, 8192, 3840, 265984, 8388608, 0, 32768, 4, 37810176, 131072, 0, 0, 218104368, 1
    .long 4, 32, 32, 8192, 3840, 265984, 8388608, 262144, 32768, 4, 38858752, 131072, 0, 0, 218104496, 1
    .long 4, 16, 16, 8192, 3072, 265216, 8388608, 524288, 32768, 4, 6340608, 131072, 0, 0, 218104624, 1
    .long 1, 16, 16, 8192, 3584, 3840, 8388608, 1572864, 32768, 8, 10543104, 131072, 0, 0, 218105136, 4
    .long 2, 64, 72, 7168, 256, 256, 7340032, 524288, 32768, 8, 56365056, 114688, 0, 0, 218103872, 1
    .long 2, 64, 72, 7168, 6400, 6400, 7340032, 1572864, 32768, 8, 60133376, 114688, 0, 0, 218104048, 1
    .long 2, 64, 72, 7168, 5376, 5376, 7340032, 3145728, 32768, 8, 65622016, 114688, 0, 0, 218104240, 1
    .long 1, 80, 80, 2048, 1836544, 1836800, 7340032, 63729664, 114688, 7, 174612480, 32768, 218104144, 7, 218106688, 1
    .long 0, 0, 0, 0, 0, 0, 0, 0, 0, 0, 0, 0, 0, 0, 0, 0
    .long 0, 0, 0, 0, 0, 0, 0, 0, 0, 0, 0, 0, 0, 0, 0, 0
    .long 6, 32, 32, 8192, 5888, 268032, 8388608, 0, 32768, 4, 37842944, 131072, 0, 0, 218104400, 1
    .long 4, 32, 32, 8192, 5888, 268032, 8388608, 262144, 32768, 4, 38891520, 131072, 0, 0, 218104528, 1
    .long 4, 16, 16, 8192, 5120, 267264, 8388608, 524288, 32768, 4, 6373376, 131072, 0, 0, 218104656, 1
    .long 1, 16, 16, 8192, 5632, 5888, 8388608, 1572864, 32768, 8, 10575872, 131072, 0, 0, 218105168, 4
    .long 2, 64, 72, 7168, 512, 512, 7340032, 524288, 32768, 8, 56369152, 114688, 0, 0, 218103872, 1
    .long 2, 64, 72, 7168, 6656, 6656, 7340032, 1572864, 32768, 8, 60137472, 114688, 0, 0, 218104048, 1
    .long 2, 64, 72, 7168, 5632, 5632, 7340032, 3145728, 32768, 8, 65626112, 114688, 0, 0, 218104240, 1
    .long 1, 80, 80, 2048, 3671552, 3671808, 7340032, 63758336, 114688, 7, 178806784, 32768, 218104160, 7, 218106688, 1
    .long 0, 0, 0, 0, 0, 0, 0, 0, 0, 0, 0, 0, 0, 0, 0, 0
    .long 0, 0, 0, 0, 0, 0, 0, 0, 0, 0, 0, 0, 0, 0, 0, 0
    .long 6, 32, 32, 8192, 7936, 270080, 8388608, 0, 32768, 4, 37875712, 131072, 0, 0, 218104432, 1
    .long 4, 32, 32, 8192, 7936, 270080, 8388608, 262144, 32768, 4, 38924288, 131072, 0, 0, 218104560, 1
    .long 4, 16, 16, 8192, 7168, 269312, 8388608, 524288, 32768, 4, 6406144, 131072, 0, 0, 218104688, 1
    .long 1, 16, 16, 8192, 7680, 7936, 8388608, 1572864, 32768, 8, 10608640, 131072, 0, 0, 218105200, 4
    .long 2, 64, 72, 7168, 768, 768, 7340032, 524288, 32768, 8, 56373248, 114688, 0, 0, 218103872, 1
    .long 2, 64, 72, 7168, 6912, 6912, 7340032, 1572864, 32768, 8, 60141568, 114688, 0, 0, 218104048, 1
    .long 2, 64, 72, 7168, 5888, 5888, 7340032, 3145728, 32768, 8, 65630208, 114688, 0, 0, 218104240, 1
    .long 1, 80, 80, 2048, 5506560, 5506816, 7340032, 63787008, 114688, 7, 183001088, 32768, 218104176, 7, 218106688, 1
    .long 0, 0, 0, 0, 0, 0, 0, 0, 0, 0, 0, 0, 0, 0, 0, 0
    .long 0, 0, 0, 0, 0, 0, 0, 0, 0, 0, 0, 0, 0, 0, 0, 0
    .long 6, 16, 16, 8192, 0, 262144, 8388608, 0, 32768, 4, 4194304, 131072, 0, 0, 218104320, 1
    .long 4, 16, 16, 8192, 0, 262144, 8388608, 262144, 32768, 4, 5242880, 131072, 0, 0, 218104448, 1
    .long 4, 16, 16, 8192, 0, 262144, 8388608, 524288, 32768, 4, 6291456, 131072, 0, 0, 218104576, 1
    .long 1, 32, 32, 8192, 0, 256, 8388608, 2097152, 32768, 8, 46137344, 131072, 0, 0, 218105344, 4
    .long 2, 64, 72, 7168, 1024, 1024, 7340032, 524288, 32768, 8, 56377344, 114688, 0, 0, 218103872, 1
    .long 2, 64, 72, 7168, 0, 0, 7340032, 2097152, 32768, 8, 61865984, 114688, 0, 0, 218104064, 1
    .long 2, 64, 72, 7168, 6144, 6144, 7340032, 3145728, 32768, 8, 65634304, 114688, 0, 0, 218104240, 1
    .long 1, 80, 80, 2048, 0, 256, 7340032, 65536000, 114688, 7, 170917888, 32768, 218104192, 7, 218106752, 1
    .long 0, 0, 0, 0, 0, 0, 0, 0, 0, 0, 0, 0, 0, 0, 0, 0
    .long 0, 0, 0, 0, 0, 0, 0, 0, 0, 0, 0, 0, 0, 0, 0, 0
    .long 6, 16, 16, 8192, 2048, 264192, 8388608, 0, 32768, 4, 4227072, 131072, 0, 0, 218104352, 1
    .long 4, 16, 16, 8192, 2048, 264192, 8388608, 262144, 32768, 4, 5275648, 131072, 0, 0, 218104480, 1
    .long 4, 16, 16, 8192, 2048, 264192, 8388608, 524288, 32768, 4, 6324224, 131072, 0, 0, 218104608, 1
    .long 1, 32, 32, 8192, 2048, 2304, 8388608, 2097152, 32768, 8, 46170112, 131072, 0, 0, 218105376, 4
    .long 2, 64, 72, 7168, 1280, 1280, 7340032, 524288, 32768, 8, 56381440, 114688, 0, 0, 218103872, 1
    .long 2, 64, 72, 7168, 256, 256, 7340032, 2097152, 32768, 8, 61870080, 114688, 0, 0, 218104064, 1
    .long 2, 64, 72, 7168, 6400, 6400, 7340032, 3145728, 32768, 8, 65638400, 114688, 0, 0, 218104240, 1
    .long 1, 80, 80, 2048, 1835008, 1835264, 7340032, 65564672, 114688, 7, 175112192, 32768, 218104208, 7, 218106752, 1
    .long 0, 0, 0, 0, 0, 0, 0, 0, 0, 0, 0, 0, 0, 0, 0, 0
    .long 0, 0, 0, 0, 0, 0, 0, 0, 0, 0, 0, 0, 0, 0, 0, 0
    .long 6, 16, 16, 8192, 4096, 266240, 8388608, 0, 32768, 4, 4259840, 131072, 0, 0, 218104384, 1
    .long 4, 16, 16, 8192, 4096, 266240, 8388608, 262144, 32768, 4, 5308416, 131072, 0, 0, 218104512, 1
    .long 4, 16, 16, 8192, 4096, 266240, 8388608, 524288, 32768, 4, 6356992, 131072, 0, 0, 218104640, 1
    .long 1, 32, 32, 8192, 4096, 4352, 8388608, 2097152, 32768, 8, 46202880, 131072, 0, 0, 218105408, 4
    .long 2, 64, 72, 7168, 1536, 1536, 7340032, 524288, 32768, 8, 56385536, 114688, 0, 0, 218103872, 1
    .long 2, 64, 72, 7168, 512, 512, 7340032, 2097152, 32768, 8, 61874176, 114688, 0, 0, 218104064, 1
    .long 2, 64, 72, 7168, 6656, 6656, 7340032, 3145728, 32768, 8, 65642496, 114688, 0, 0, 218104240, 1
    .long 1, 80, 80, 2048, 3670016, 3670272, 7340032, 65593344, 114688, 7, 179306496, 32768, 218104224, 7, 218106752, 1
    .long 0, 0, 0, 0, 0, 0, 0, 0, 0, 0, 0, 0, 0, 0, 0, 0
    .long 0, 0, 0, 0, 0, 0, 0, 0, 0, 0, 0, 0, 0, 0, 0, 0
    .long 6, 16, 16, 8192, 6144, 268288, 8388608, 0, 32768, 4, 4292608, 131072, 0, 0, 218104416, 1
    .long 4, 16, 16, 8192, 6144, 268288, 8388608, 262144, 32768, 4, 5341184, 131072, 0, 0, 218104544, 1
    .long 4, 16, 16, 8192, 6144, 268288, 8388608, 524288, 32768, 4, 6389760, 131072, 0, 0, 218104672, 1
    .long 1, 32, 32, 8192, 6144, 6400, 8388608, 2097152, 32768, 8, 46235648, 131072, 0, 0, 218105440, 4
    .long 2, 64, 72, 7168, 1792, 1792, 7340032, 524288, 32768, 8, 56389632, 114688, 0, 0, 218103888, 1
    .long 2, 64, 72, 7168, 768, 768, 7340032, 2097152, 32768, 8, 61878272, 114688, 0, 0, 218104064, 1
    .long 2, 64, 72, 7168, 6912, 6912, 7340032, 3145728, 32768, 8, 65646592, 114688, 0, 0, 218104240, 1
    .long 1, 80, 80, 2048, 5505024, 5505280, 7340032, 65622016, 114688, 7, 183500800, 32768, 218104240, 7, 218106752, 1
    .long 0, 0, 0, 0, 0, 0, 0, 0, 0, 0, 0, 0, 0, 0, 0, 0
    .long 0, 0, 0, 0, 0, 0, 0, 0, 0, 0, 0, 0, 0, 0, 0, 0
    .long 6, 16, 16, 8192, 256, 262400, 8388608, 0, 32768, 4, 4198400, 131072, 0, 0, 218104320, 1
    .long 4, 16, 16, 8192, 256, 262400, 8388608, 262144, 32768, 4, 5246976, 131072, 0, 0, 218104448, 1
    .long 4, 16, 16, 8192, 256, 262400, 8388608, 524288, 32768, 4, 6295552, 131072, 0, 0, 218104576, 1
    .long 1, 32, 32, 8192, 512, 768, 8388608, 2097152, 32768, 8, 46145536, 131072, 0, 0, 218105344, 4
    .long 2, 64, 72, 7168, 2048, 2048, 7340032, 524288, 32768, 8, 56393728, 114688, 0, 0, 218103888, 1
    .long 2, 64, 72, 7168, 1024, 1024, 7340032, 2097152, 32768, 8, 61882368, 114688, 0, 0, 218104064, 1
    .long 2, 64, 72, 7168, 0, 0, 7340032, 3670016, 32768, 8, 67371008, 114688, 0, 0, 218104256, 1
    .long 1, 80, 80, 2048, 512, 768, 7340032, 65536000, 114688, 7, 170926080, 32768, 218104192, 7, 218106752, 1
    .long 0, 0, 0, 0, 0, 0, 0, 0, 0, 0, 0, 0, 0, 0, 0, 0
    .long 0, 0, 0, 0, 0, 0, 0, 0, 0, 0, 0, 0, 0, 0, 0, 0
    .long 6, 16, 16, 8192, 2304, 264448, 8388608, 0, 32768, 4, 4231168, 131072, 0, 0, 218104352, 1
    .long 4, 16, 16, 8192, 2304, 264448, 8388608, 262144, 32768, 4, 5279744, 131072, 0, 0, 218104480, 1
    .long 4, 16, 16, 8192, 2304, 264448, 8388608, 524288, 32768, 4, 6328320, 131072, 0, 0, 218104608, 1
    .long 1, 32, 32, 8192, 2560, 2816, 8388608, 2097152, 32768, 8, 46178304, 131072, 0, 0, 218105376, 4
    .long 2, 64, 72, 7168, 2304, 2304, 7340032, 524288, 32768, 8, 56397824, 114688, 0, 0, 218103888, 1
    .long 2, 64, 72, 7168, 1280, 1280, 7340032, 2097152, 32768, 8, 61886464, 114688, 0, 0, 218104064, 1
    .long 2, 64, 72, 7168, 256, 256, 7340032, 3670016, 32768, 8, 67375104, 114688, 0, 0, 218104256, 1
    .long 1, 80, 80, 2048, 1835520, 1835776, 7340032, 65564672, 114688, 7, 175120384, 32768, 218104208, 7, 218106752, 1
    .long 0, 0, 0, 0, 0, 0, 0, 0, 0, 0, 0, 0, 0, 0, 0, 0
    .long 0, 0, 0, 0, 0, 0, 0, 0, 0, 0, 0, 0, 0, 0, 0, 0
    .long 6, 16, 16, 8192, 4352, 266496, 8388608, 0, 32768, 4, 4263936, 131072, 0, 0, 218104384, 1
    .long 4, 16, 16, 8192, 4352, 266496, 8388608, 262144, 32768, 4, 5312512, 131072, 0, 0, 218104512, 1
    .long 4, 16, 16, 8192, 4352, 266496, 8388608, 524288, 32768, 4, 6361088, 131072, 0, 0, 218104640, 1
    .long 1, 32, 32, 8192, 4608, 4864, 8388608, 2097152, 32768, 8, 46211072, 131072, 0, 0, 218105408, 4
    .long 2, 64, 72, 7168, 2560, 2560, 7340032, 524288, 32768, 8, 56401920, 114688, 0, 0, 218103888, 1
    .long 2, 64, 72, 7168, 1536, 1536, 7340032, 2097152, 32768, 8, 61890560, 114688, 0, 0, 218104064, 1
    .long 2, 64, 72, 7168, 512, 512, 7340032, 3670016, 32768, 8, 67379200, 114688, 0, 0, 218104256, 1
    .long 1, 80, 80, 2048, 3670528, 3670784, 7340032, 65593344, 114688, 7, 179314688, 32768, 218104224, 7, 218106752, 1
    .long 0, 0, 0, 0, 0, 0, 0, 0, 0, 0, 0, 0, 0, 0, 0, 0
    .long 0, 0, 0, 0, 0, 0, 0, 0, 0, 0, 0, 0, 0, 0, 0, 0
    .long 6, 16, 16, 8192, 6400, 268544, 8388608, 0, 32768, 4, 4296704, 131072, 0, 0, 218104416, 1
    .long 4, 16, 16, 8192, 6400, 268544, 8388608, 262144, 32768, 4, 5345280, 131072, 0, 0, 218104544, 1
    .long 4, 16, 16, 8192, 6400, 268544, 8388608, 524288, 32768, 4, 6393856, 131072, 0, 0, 218104672, 1
    .long 1, 32, 32, 8192, 6656, 6912, 8388608, 2097152, 32768, 8, 46243840, 131072, 0, 0, 218105440, 4
    .long 2, 64, 72, 7168, 2816, 2816, 7340032, 524288, 32768, 8, 56406016, 114688, 0, 0, 218103888, 1
    .long 2, 64, 72, 7168, 1792, 1792, 7340032, 2097152, 32768, 8, 61894656, 114688, 0, 0, 218104080, 1
    .long 2, 64, 72, 7168, 768, 768, 7340032, 3670016, 32768, 8, 67383296, 114688, 0, 0, 218104256, 1
    .long 1, 80, 80, 2048, 5505536, 5505792, 7340032, 65622016, 114688, 7, 183508992, 32768, 218104240, 7, 218106752, 1
    .long 0, 0, 0, 0, 0, 0, 0, 0, 0, 0, 0, 0, 0, 0, 0, 0
    .long 0, 0, 0, 0, 0, 0, 0, 0, 0, 0, 0, 0, 0, 0, 0, 0
    .long 6, 16, 16, 8192, 512, 262656, 8388608, 0, 32768, 4, 4202496, 131072, 0, 0, 218104320, 1
    .long 4, 16, 16, 8192, 512, 262656, 8388608, 262144, 32768, 4, 5251072, 131072, 0, 0, 218104448, 1
    .long 4, 16, 16, 8192, 512, 262656, 8388608, 524288, 32768, 4, 6299648, 131072, 0, 0, 218104576, 1
    .long 1, 32, 32, 8192, 1024, 1280, 8388608, 2097152, 32768, 8, 46153728, 131072, 0, 0, 218105360, 4
    .long 2, 64, 72, 7168, 3072, 3072, 7340032, 524288, 32768, 8, 56410112, 114688, 0, 0, 218103888, 1
    .long 2, 64, 72, 7168, 2048, 2048, 7340032, 2097152, 32768, 8, 61898752, 114688, 0, 0, 218104080, 1
    .long 2, 64, 72, 7168, 1024, 1024, 7340032, 3670016, 32768, 8, 67387392, 114688, 0, 0, 218104256, 1
    .long 1, 80, 80, 2048, 1024, 1280, 7340032, 65536000, 114688, 7, 170934272, 32768, 218104192, 7, 218106752, 1
    .long 0, 0, 0, 0, 0, 0, 0, 0, 0, 0, 0, 0, 0, 0, 0, 0
    .long 0, 0, 0, 0, 0, 0, 0, 0, 0, 0, 0, 0, 0, 0, 0, 0
    .long 6, 16, 16, 8192, 2560, 264704, 8388608, 0, 32768, 4, 4235264, 131072, 0, 0, 218104352, 1
    .long 4, 16, 16, 8192, 2560, 264704, 8388608, 262144, 32768, 4, 5283840, 131072, 0, 0, 218104480, 1
    .long 4, 16, 16, 8192, 2560, 264704, 8388608, 524288, 32768, 4, 6332416, 131072, 0, 0, 218104608, 1
    .long 1, 32, 32, 8192, 3072, 3328, 8388608, 2097152, 32768, 8, 46186496, 131072, 0, 0, 218105392, 4
    .long 2, 64, 72, 7168, 3328, 3328, 7340032, 524288, 32768, 8, 56414208, 114688, 0, 0, 218103888, 1
    .long 2, 64, 72, 7168, 2304, 2304, 7340032, 2097152, 32768, 8, 61902848, 114688, 0, 0, 218104080, 1
    .long 2, 64, 72, 7168, 1280, 1280, 7340032, 3670016, 32768, 8, 67391488, 114688, 0, 0, 218104256, 1
    .long 1, 80, 80, 2048, 1836032, 1836288, 7340032, 65564672, 114688, 7, 175128576, 32768, 218104208, 7, 218106752, 1
    .long 0, 0, 0, 0, 0, 0, 0, 0, 0, 0, 0, 0, 0, 0, 0, 0
    .long 0, 0, 0, 0, 0, 0, 0, 0, 0, 0, 0, 0, 0, 0, 0, 0
    .long 6, 16, 16, 8192, 4608, 266752, 8388608, 0, 32768, 4, 4268032, 131072, 0, 0, 218104384, 1
    .long 4, 16, 16, 8192, 4608, 266752, 8388608, 262144, 32768, 4, 5316608, 131072, 0, 0, 218104512, 1
    .long 4, 16, 16, 8192, 4608, 266752, 8388608, 524288, 32768, 4, 6365184, 131072, 0, 0, 218104640, 1
    .long 1, 32, 32, 8192, 5120, 5376, 8388608, 2097152, 32768, 8, 46219264, 131072, 0, 0, 218105424, 4
    .long 2, 64, 72, 7168, 3584, 3584, 7340032, 524288, 32768, 8, 56418304, 114688, 0, 0, 218103904, 1
    .long 2, 64, 72, 7168, 2560, 2560, 7340032, 2097152, 32768, 8, 61906944, 114688, 0, 0, 218104080, 1
    .long 2, 64, 72, 7168, 1536, 1536, 7340032, 3670016, 32768, 8, 67395584, 114688, 0, 0, 218104256, 1
    .long 1, 80, 80, 2048, 3671040, 3671296, 7340032, 65593344, 114688, 7, 179322880, 32768, 218104224, 7, 218106752, 1
    .long 0, 0, 0, 0, 0, 0, 0, 0, 0, 0, 0, 0, 0, 0, 0, 0
    .long 0, 0, 0, 0, 0, 0, 0, 0, 0, 0, 0, 0, 0, 0, 0, 0
    .long 6, 16, 16, 8192, 6656, 268800, 8388608, 0, 32768, 4, 4300800, 131072, 0, 0, 218104416, 1
    .long 4, 16, 16, 8192, 6656, 268800, 8388608, 262144, 32768, 4, 5349376, 131072, 0, 0, 218104544, 1
    .long 4, 16, 16, 8192, 6656, 268800, 8388608, 524288, 32768, 4, 6397952, 131072, 0, 0, 218104672, 1
    .long 1, 32, 32, 8192, 7168, 7424, 8388608, 2097152, 32768, 8, 46252032, 131072, 0, 0, 218105456, 4
    .long 2, 64, 72, 7168, 3840, 3840, 7340032, 524288, 32768, 8, 56422400, 114688, 0, 0, 218103904, 1
    .long 2, 64, 72, 7168, 2816, 2816, 7340032, 2097152, 32768, 8, 61911040, 114688, 0, 0, 218104080, 1
    .long 2, 64, 72, 7168, 1792, 1792, 7340032, 3670016, 32768, 8, 67399680, 114688, 0, 0, 218104272, 1
    .long 1, 80, 80, 2048, 5506048, 5506304, 7340032, 65622016, 114688, 7, 183517184, 32768, 218104240, 7, 218106752, 1
    .long 0, 0, 0, 0, 0, 0, 0, 0, 0, 0, 0, 0, 0, 0, 0, 0
    .long 0, 0, 0, 0, 0, 0, 0, 0, 0, 0, 0, 0, 0, 0, 0, 0
    .long 6, 16, 16, 8192, 768, 262912, 8388608, 0, 32768, 4, 4206592, 131072, 0, 0, 218104320, 1
    .long 4, 16, 16, 8192, 768, 262912, 8388608, 262144, 32768, 4, 5255168, 131072, 0, 0, 218104448, 1
    .long 4, 16, 16, 8192, 768, 262912, 8388608, 524288, 32768, 4, 6303744, 131072, 0, 0, 218104576, 1
    .long 1, 32, 32, 8192, 1536, 1792, 8388608, 2097152, 32768, 8, 46161920, 131072, 0, 0, 218105360, 4
    .long 2, 64, 72, 7168, 4096, 4096, 7340032, 524288, 32768, 8, 56426496, 114688, 0, 0, 218103904, 1
    .long 2, 64, 72, 7168, 3072, 3072, 7340032, 2097152, 32768, 8, 61915136, 114688, 0, 0, 218104080, 1
    .long 2, 64, 72, 7168, 2048, 2048, 7340032, 3670016, 32768, 8, 67403776, 114688, 0, 0, 218104272, 1
    .long 1, 80, 80, 2048, 1536, 1792, 7340032, 65536000, 114688, 7, 170942464, 32768, 218104192, 7, 218106752, 1
    .long 0, 0, 0, 0, 0, 0, 0, 0, 0, 0, 0, 0, 0, 0, 0, 0
    .long 0, 0, 0, 0, 0, 0, 0, 0, 0, 0, 0, 0, 0, 0, 0, 0
    .long 6, 16, 16, 8192, 2816, 264960, 8388608, 0, 32768, 4, 4239360, 131072, 0, 0, 218104352, 1
    .long 4, 16, 16, 8192, 2816, 264960, 8388608, 262144, 32768, 4, 5287936, 131072, 0, 0, 218104480, 1
    .long 4, 16, 16, 8192, 2816, 264960, 8388608, 524288, 32768, 4, 6336512, 131072, 0, 0, 218104608, 1
    .long 1, 32, 32, 8192, 3584, 3840, 8388608, 2097152, 32768, 8, 46194688, 131072, 0, 0, 218105392, 4
    .long 2, 64, 72, 7168, 4352, 4352, 7340032, 524288, 32768, 8, 56430592, 114688, 0, 0, 218103904, 1
    .long 2, 64, 72, 7168, 3328, 3328, 7340032, 2097152, 32768, 8, 61919232, 114688, 0, 0, 218104080, 1
    .long 2, 64, 72, 7168, 2304, 2304, 7340032, 3670016, 32768, 8, 67407872, 114688, 0, 0, 218104272, 1
    .long 1, 80, 80, 2048, 1836544, 1836800, 7340032, 65564672, 114688, 7, 175136768, 32768, 218104208, 7, 218106752, 1
    .long 0, 0, 0, 0, 0, 0, 0, 0, 0, 0, 0, 0, 0, 0, 0, 0
    .long 0, 0, 0, 0, 0, 0, 0, 0, 0, 0, 0, 0, 0, 0, 0, 0
    .long 6, 16, 16, 8192, 4864, 267008, 8388608, 0, 32768, 4, 4272128, 131072, 0, 0, 218104384, 1
    .long 4, 16, 16, 8192, 4864, 267008, 8388608, 262144, 32768, 4, 5320704, 131072, 0, 0, 218104512, 1
    .long 4, 16, 16, 8192, 4864, 267008, 8388608, 524288, 32768, 4, 6369280, 131072, 0, 0, 218104640, 1
    .long 1, 32, 32, 8192, 5632, 5888, 8388608, 2097152, 32768, 8, 46227456, 131072, 0, 0, 218105424, 4
    .long 2, 64, 72, 7168, 4608, 4608, 7340032, 524288, 32768, 8, 56434688, 114688, 0, 0, 218103904, 1
    .long 2, 64, 72, 7168, 3584, 3584, 7340032, 2097152, 32768, 8, 61923328, 114688, 0, 0, 218104096, 1
    .long 2, 64, 72, 7168, 2560, 2560, 7340032, 3670016, 32768, 8, 67411968, 114688, 0, 0, 218104272, 1
    .long 1, 80, 80, 2048, 3671552, 3671808, 7340032, 65593344, 114688, 7, 179331072, 32768, 218104224, 7, 218106752, 1
    .long 0, 0, 0, 0, 0, 0, 0, 0, 0, 0, 0, 0, 0, 0, 0, 0
    .long 0, 0, 0, 0, 0, 0, 0, 0, 0, 0, 0, 0, 0, 0, 0, 0
    .long 6, 16, 16, 8192, 6912, 269056, 8388608, 0, 32768, 4, 4304896, 131072, 0, 0, 218104416, 1
    .long 4, 16, 16, 8192, 6912, 269056, 8388608, 262144, 32768, 4, 5353472, 131072, 0, 0, 218104544, 1
    .long 4, 16, 16, 8192, 6912, 269056, 8388608, 524288, 32768, 4, 6402048, 131072, 0, 0, 218104672, 1
    .long 1, 32, 32, 8192, 7680, 7936, 8388608, 2097152, 32768, 8, 46260224, 131072, 0, 0, 218105456, 4
    .long 2, 64, 72, 7168, 4864, 4864, 7340032, 524288, 32768, 8, 56438784, 114688, 0, 0, 218103904, 1
    .long 2, 64, 72, 7168, 3840, 3840, 7340032, 2097152, 32768, 8, 61927424, 114688, 0, 0, 218104096, 1
    .long 2, 64, 72, 7168, 2816, 2816, 7340032, 3670016, 32768, 8, 67416064, 114688, 0, 0, 218104272, 1
    .long 1, 80, 80, 2048, 5506560, 5506816, 7340032, 65622016, 114688, 7, 183525376, 32768, 218104240, 7, 218106752, 1
    .long 0, 0, 0, 0, 0, 0, 0, 0, 0, 0, 0, 0, 0, 0, 0, 0
    .long 0, 0, 0, 0, 0, 0, 0, 0, 0, 0, 0, 0, 0, 0, 0, 0
    .long 6, 16, 16, 8192, 1024, 263168, 8388608, 0, 32768, 4, 4210688, 131072, 0, 0, 218104336, 1
    .long 4, 16, 16, 8192, 1024, 263168, 8388608, 262144, 32768, 4, 5259264, 131072, 0, 0, 218104464, 1
    .long 4, 16, 16, 8192, 768, 262912, 8388608, 786432, 32768, 4, 7352320, 131072, 0, 0, 218104576, 1
    .long 1, 24, 24, 8192, 0, 256, 8388608, 2097152, 32768, 8, 29360128, 131072, 0, 0, 218105344, 4
    .long 2, 64, 72, 7168, 5120, 5120, 7340032, 524288, 32768, 8, 56442880, 114688, 0, 0, 218103904, 1
    .long 2, 64, 72, 7168, 4096, 4096, 7340032, 2097152, 32768, 8, 61931520, 114688, 0, 0, 218104096, 1
    .long 2, 64, 72, 7168, 3072, 3072, 7340032, 3670016, 32768, 8, 67420160, 114688, 0, 0, 218104272, 1
    .long 1, 80, 80, 2048, 0, 256, 7340032, 67371008, 114688, 7, 171442176, 32768, 218104256, 7, 218106816, 1
    .long 0, 0, 0, 0, 0, 0, 0, 0, 0, 0, 0, 0, 0, 0, 0, 0
    .long 0, 0, 0, 0, 0, 0, 0, 0, 0, 0, 0, 0, 0, 0, 0, 0
    .long 6, 16, 16, 8192, 3072, 265216, 8388608, 0, 32768, 4, 4243456, 131072, 0, 0, 218104368, 1
    .long 4, 16, 16, 8192, 3072, 265216, 8388608, 262144, 32768, 4, 5292032, 131072, 0, 0, 218104496, 1
    .long 4, 16, 16, 8192, 2816, 264960, 8388608, 786432, 32768, 4, 7385088, 131072, 0, 0, 218104608, 1
    .long 1, 24, 24, 8192, 2048, 2304, 8388608, 2097152, 32768, 8, 29392896, 131072, 0, 0, 218105376, 4
    .long 2, 64, 72, 7168, 5376, 5376, 7340032, 524288, 32768, 8, 56446976, 114688, 0, 0, 218103920, 1
    .long 2, 64, 72, 7168, 4352, 4352, 7340032, 2097152, 32768, 8, 61935616, 114688, 0, 0, 218104096, 1
    .long 2, 64, 72, 7168, 3328, 3328, 7340032, 3670016, 32768, 8, 67424256, 114688, 0, 0, 218104272, 1
    .long 1, 80, 80, 2048, 1835008, 1835264, 7340032, 67399680, 114688, 7, 175636480, 32768, 218104272, 7, 218106816, 1
    .long 0, 0, 0, 0, 0, 0, 0, 0, 0, 0, 0, 0, 0, 0, 0, 0
    .long 0, 0, 0, 0, 0, 0, 0, 0, 0, 0, 0, 0, 0, 0, 0, 0
    .long 6, 16, 16, 8192, 5120, 267264, 8388608, 0, 32768, 4, 4276224, 131072, 0, 0, 218104400, 1
    .long 4, 16, 16, 8192, 5120, 267264, 8388608, 262144, 32768, 4, 5324800, 131072, 0, 0, 218104528, 1
    .long 4, 16, 16, 8192, 4864, 267008, 8388608, 786432, 32768, 4, 7417856, 131072, 0, 0, 218104640, 1
    .long 1, 24, 24, 8192, 4096, 4352, 8388608, 2097152, 32768, 8, 29425664, 131072, 0, 0, 218105408, 4
    .long 2, 64, 72, 7168, 5632, 5632, 7340032, 524288, 32768, 8, 56451072, 114688, 0, 0, 218103920, 1
    .long 2, 64, 72, 7168, 4608, 4608, 7340032, 2097152, 32768, 8, 61939712, 114688, 0, 0, 218104096, 1
    .long 2, 64, 72, 7168, 3584, 3584, 7340032, 3670016, 32768, 8, 67428352, 114688, 0, 0, 218104288, 1
    .long 1, 80, 80, 2048, 3670016, 3670272, 7340032, 67428352, 114688, 7, 179830784, 32768, 218104288, 7, 218106816, 1
    .long 0, 0, 0, 0, 0, 0, 0, 0, 0, 0, 0, 0, 0, 0, 0, 0
    .long 0, 0, 0, 0, 0, 0, 0, 0, 0, 0, 0, 0, 0, 0, 0, 0
    .long 6, 16, 16, 8192, 7168, 269312, 8388608, 0, 32768, 4, 4308992, 131072, 0, 0, 218104432, 1
    .long 4, 16, 16, 8192, 7168, 269312, 8388608, 262144, 32768, 4, 5357568, 131072, 0, 0, 218104560, 1
    .long 4, 16, 16, 8192, 6912, 269056, 8388608, 786432, 32768, 4, 7450624, 131072, 0, 0, 218104672, 1
    .long 1, 24, 24, 8192, 6144, 6400, 8388608, 2097152, 32768, 8, 29458432, 131072, 0, 0, 218105440, 4
    .long 2, 64, 72, 7168, 5888, 5888, 7340032, 524288, 32768, 8, 56455168, 114688, 0, 0, 218103920, 1
    .long 2, 64, 72, 7168, 4864, 4864, 7340032, 2097152, 32768, 8, 61943808, 114688, 0, 0, 218104096, 1
    .long 2, 64, 72, 7168, 3840, 3840, 7340032, 3670016, 32768, 8, 67432448, 114688, 0, 0, 218104288, 1
    .long 1, 80, 80, 2048, 5505024, 5505280, 7340032, 67457024, 114688, 7, 184025088, 32768, 218104304, 7, 218106816, 1
    .long 0, 0, 0, 0, 0, 0, 0, 0, 0, 0, 0, 0, 0, 0, 0, 0
    .long 0, 0, 0, 0, 0, 0, 0, 0, 0, 0, 0, 0, 0, 0, 0, 0
    .long 6, 16, 16, 8192, 1280, 263424, 8388608, 0, 32768, 4, 4214784, 131072, 0, 0, 218104336, 1
    .long 4, 16, 16, 8192, 1280, 263424, 8388608, 262144, 32768, 4, 5263360, 131072, 0, 0, 218104464, 1
    .long 4, 16, 16, 8192, 512, 262656, 8388608, 786432, 32768, 4, 7348224, 131072, 0, 0, 218104576, 1
    .long 1, 24, 24, 8192, 512, 768, 8388608, 2097152, 32768, 8, 29368320, 131072, 0, 0, 218105344, 4
    .long 2, 64, 72, 7168, 6144, 6144, 7340032, 524288, 32768, 8, 56459264, 114688, 0, 0, 218103920, 1
    .long 2, 64, 72, 7168, 5120, 5120, 7340032, 2097152, 32768, 8, 61947904, 114688, 0, 0, 218104096, 1
    .long 2, 64, 72, 7168, 4096, 4096, 7340032, 3670016, 32768, 8, 67436544, 114688, 0, 0, 218104288, 1
    .long 1, 80, 80, 2048, 512, 768, 7340032, 67371008, 114688, 7, 171450368, 32768, 218104256, 7, 218106816, 1
    .long 0, 0, 0, 0, 0, 0, 0, 0, 0, 0, 0, 0, 0, 0, 0, 0
    .long 0, 0, 0, 0, 0, 0, 0, 0, 0, 0, 0, 0, 0, 0, 0, 0
    .long 6, 16, 16, 8192, 3328, 265472, 8388608, 0, 32768, 4, 4247552, 131072, 0, 0, 218104368, 1
    .long 4, 16, 16, 8192, 3328, 265472, 8388608, 262144, 32768, 4, 5296128, 131072, 0, 0, 218104496, 1
    .long 4, 16, 16, 8192, 2560, 264704, 8388608, 786432, 32768, 4, 7380992, 131072, 0, 0, 218104608, 1
    .long 1, 24, 24, 8192, 2560, 2816, 8388608, 2097152, 32768, 8, 29401088, 131072, 0, 0, 218105376, 4
    .long 2, 64, 72, 7168, 6400, 6400, 7340032, 524288, 32768, 8, 56463360, 114688, 0, 0, 218103920, 1
    .long 2, 64, 72, 7168, 5376, 5376, 7340032, 2097152, 32768, 8, 61952000, 114688, 0, 0, 218104112, 1
    .long 2, 64, 72, 7168, 4352, 4352, 7340032, 3670016, 32768, 8, 67440640, 114688, 0, 0, 218104288, 1
    .long 1, 80, 80, 2048, 1835520, 1835776, 7340032, 67399680, 114688, 7, 175644672, 32768, 218104272, 7, 218106816, 1
    .long 0, 0, 0, 0, 0, 0, 0, 0, 0, 0, 0, 0, 0, 0, 0, 0
    .long 0, 0, 0, 0, 0, 0, 0, 0, 0, 0, 0, 0, 0, 0, 0, 0
    .long 6, 16, 16, 8192, 5376, 267520, 8388608, 0, 32768, 4, 4280320, 131072, 0, 0, 218104400, 1
    .long 4, 16, 16, 8192, 5376, 267520, 8388608, 262144, 32768, 4, 5328896, 131072, 0, 0, 218104528, 1
    .long 4, 16, 16, 8192, 4608, 266752, 8388608, 786432, 32768, 4, 7413760, 131072, 0, 0, 218104640, 1
    .long 1, 24, 24, 8192, 4608, 4864, 8388608, 2097152, 32768, 8, 29433856, 131072, 0, 0, 218105408, 4
    .long 2, 64, 72, 7168, 6656, 6656, 7340032, 524288, 32768, 8, 56467456, 114688, 0, 0, 218103920, 1
    .long 2, 64, 72, 7168, 5632, 5632, 7340032, 2097152, 32768, 8, 61956096, 114688, 0, 0, 218104112, 1
    .long 2, 64, 72, 7168, 4608, 4608, 7340032, 3670016, 32768, 8, 67444736, 114688, 0, 0, 218104288, 1
    .long 1, 80, 80, 2048, 3670528, 3670784, 7340032, 67428352, 114688, 7, 179838976, 32768, 218104288, 7, 218106816, 1
    .long 0, 0, 0, 0, 0, 0, 0, 0, 0, 0, 0, 0, 0, 0, 0, 0
    .long 0, 0, 0, 0, 0, 0, 0, 0, 0, 0, 0, 0, 0, 0, 0, 0
    .long 6, 16, 16, 8192, 7424, 269568, 8388608, 0, 32768, 4, 4313088, 131072, 0, 0, 218104432, 1
    .long 4, 16, 16, 8192, 7424, 269568, 8388608, 262144, 32768, 4, 5361664, 131072, 0, 0, 218104560, 1
    .long 4, 16, 16, 8192, 6656, 268800, 8388608, 786432, 32768, 4, 7446528, 131072, 0, 0, 218104672, 1
    .long 1, 24, 24, 8192, 6656, 6912, 8388608, 2097152, 32768, 8, 29466624, 131072, 0, 0, 218105440, 4
    .long 2, 64, 72, 7168, 6912, 6912, 7340032, 524288, 32768, 8, 56471552, 114688, 0, 0, 218103920, 1
    .long 2, 64, 72, 7168, 5888, 5888, 7340032, 2097152, 32768, 8, 61960192, 114688, 0, 0, 218104112, 1
    .long 2, 64, 72, 7168, 4864, 4864, 7340032, 3670016, 32768, 8, 67448832, 114688, 0, 0, 218104288, 1
    .long 1, 80, 80, 2048, 5505536, 5505792, 7340032, 67457024, 114688, 7, 184033280, 32768, 218104304, 7, 218106816, 1
    .long 0, 0, 0, 0, 0, 0, 0, 0, 0, 0, 0, 0, 0, 0, 0, 0
    .long 0, 0, 0, 0, 0, 0, 0, 0, 0, 0, 0, 0, 0, 0, 0, 0
    .long 6, 16, 16, 8192, 1536, 263680, 8388608, 0, 32768, 4, 4218880, 131072, 0, 0, 218104336, 1
    .long 4, 16, 16, 8192, 1536, 263680, 8388608, 262144, 32768, 4, 5267456, 131072, 0, 0, 218104464, 1
    .long 4, 16, 16, 8192, 256, 262400, 8388608, 786432, 32768, 4, 7344128, 131072, 0, 0, 218104576, 1
    .long 1, 24, 24, 8192, 1024, 1280, 8388608, 2097152, 32768, 8, 29376512, 131072, 0, 0, 218105360, 4
    .long 2, 64, 72, 7168, 0, 0, 7340032, 1048576, 32768, 8, 58195968, 114688, 0, 0, 218103936, 1
    .long 2, 64, 72, 7168, 6144, 6144, 7340032, 2097152, 32768, 8, 61964288, 114688, 0, 0, 218104112, 1
    .long 2, 64, 72, 7168, 5120, 5120, 7340032, 3670016, 32768, 8, 67452928, 114688, 0, 0, 218104288, 1
    .long 1, 80, 80, 2048, 1024, 1280, 7340032, 67371008, 114688, 7, 171458560, 32768, 218104256, 7, 218106816, 1
    .long 0, 0, 0, 0, 0, 0, 0, 0, 0, 0, 0, 0, 0, 0, 0, 0
    .long 0, 0, 0, 0, 0, 0, 0, 0, 0, 0, 0, 0, 0, 0, 0, 0
    .long 6, 16, 16, 8192, 3584, 265728, 8388608, 0, 32768, 4, 4251648, 131072, 0, 0, 218104368, 1
    .long 4, 16, 16, 8192, 3584, 265728, 8388608, 262144, 32768, 4, 5300224, 131072, 0, 0, 218104496, 1
    .long 4, 16, 16, 8192, 2304, 264448, 8388608, 786432, 32768, 4, 7376896, 131072, 0, 0, 218104608, 1
    .long 1, 24, 24, 8192, 3072, 3328, 8388608, 2097152, 32768, 8, 29409280, 131072, 0, 0, 218105392, 4
    .long 2, 64, 72, 7168, 256, 256, 7340032, 1048576, 32768, 8, 58200064, 114688, 0, 0, 218103936, 1
    .long 2, 64, 72, 7168, 6400, 6400, 7340032, 2097152, 32768, 8, 61968384, 114688, 0, 0, 218104112, 1
    .long 2, 64, 72, 7168, 5376, 5376, 7340032, 3670016, 32768, 8, 67457024, 114688, 0, 0, 218104304, 1
    .long 1, 80, 80, 2048, 1836032, 1836288, 7340032, 67399680, 114688, 7, 175652864, 32768, 218104272, 7, 218106816, 1
    .long 0, 0, 0, 0, 0, 0, 0, 0, 0, 0, 0, 0, 0, 0, 0, 0
    .long 0, 0, 0, 0, 0, 0, 0, 0, 0, 0, 0, 0, 0, 0, 0, 0
    .long 6, 16, 16, 8192, 5632, 267776, 8388608, 0, 32768, 4, 4284416, 131072, 0, 0, 218104400, 1
    .long 4, 16, 16, 8192, 5632, 267776, 8388608, 262144, 32768, 4, 5332992, 131072, 0, 0, 218104528, 1
    .long 4, 16, 16, 8192, 4352, 266496, 8388608, 786432, 32768, 4, 7409664, 131072, 0, 0, 218104640, 1
    .long 1, 24, 24, 8192, 5120, 5376, 8388608, 2097152, 32768, 8, 29442048, 131072, 0, 0, 218105424, 4
    .long 2, 64, 72, 7168, 512, 512, 7340032, 1048576, 32768, 8, 58204160, 114688, 0, 0, 218103936, 1
    .long 2, 64, 72, 7168, 6656, 6656, 7340032, 2097152, 32768, 8, 61972480, 114688, 0, 0, 218104112, 1
    .long 2, 64, 72, 7168, 5632, 5632, 7340032, 3670016, 32768, 8, 67461120, 114688, 0, 0, 218104304, 1
    .long 1, 80, 80, 2048, 3671040, 3671296, 7340032, 67428352, 114688, 7, 179847168, 32768, 218104288, 7, 218106816, 1
    .long 0, 0, 0, 0, 0, 0, 0, 0, 0, 0, 0, 0, 0, 0, 0, 0
    .long 0, 0, 0, 0, 0, 0, 0, 0, 0, 0, 0, 0, 0, 0, 0, 0
    .long 6, 16, 16, 8192, 7680, 269824, 8388608, 0, 32768, 4, 4317184, 131072, 0, 0, 218104432, 1
    .long 4, 16, 16, 8192, 7680, 269824, 8388608, 262144, 32768, 4, 5365760, 131072, 0, 0, 218104560, 1
    .long 4, 16, 16, 8192, 6400, 268544, 8388608, 786432, 32768, 4, 7442432, 131072, 0, 0, 218104672, 1
    .long 1, 24, 24, 8192, 7168, 7424, 8388608, 2097152, 32768, 8, 29474816, 131072, 0, 0, 218105456, 4
    .long 2, 64, 72, 7168, 768, 768, 7340032, 1048576, 32768, 8, 58208256, 114688, 0, 0, 218103936, 1
    .long 2, 64, 72, 7168, 6912, 6912, 7340032, 2097152, 32768, 8, 61976576, 114688, 0, 0, 218104112, 1
    .long 2, 64, 72, 7168, 5888, 5888, 7340032, 3670016, 32768, 8, 67465216, 114688, 0, 0, 218104304, 1
    .long 1, 80, 80, 2048, 5506048, 5506304, 7340032, 67457024, 114688, 7, 184041472, 32768, 218104304, 7, 218106816, 1
    .long 0, 0, 0, 0, 0, 0, 0, 0, 0, 0, 0, 0, 0, 0, 0, 0
    .long 0, 0, 0, 0, 0, 0, 0, 0, 0, 0, 0, 0, 0, 0, 0, 0
    .long 6, 16, 16, 8192, 1792, 263936, 8388608, 0, 32768, 4, 4222976, 131072, 0, 0, 218104336, 1
    .long 4, 16, 16, 8192, 1792, 263936, 8388608, 262144, 32768, 4, 5271552, 131072, 0, 0, 218104464, 1
    .long 4, 16, 16, 8192, 0, 262144, 8388608, 786432, 32768, 4, 7340032, 131072, 0, 0, 218104576, 1
    .long 1, 24, 24, 8192, 1536, 1792, 8388608, 2097152, 32768, 8, 29384704, 131072, 0, 0, 218105360, 4
    .long 2, 64, 72, 7168, 1024, 1024, 7340032, 1048576, 32768, 8, 58212352, 114688, 0, 0, 218103936, 1
    .long 2, 64, 72, 7168, 0, 0, 7340032, 2621440, 32768, 8, 63700992, 114688, 0, 0, 218104128, 1
    .long 2, 64, 72, 7168, 6144, 6144, 7340032, 3670016, 32768, 8, 67469312, 114688, 0, 0, 218104304, 1
    .long 1, 80, 80, 2048, 1536, 1792, 7340032, 67371008, 114688, 7, 171466752, 32768, 218104256, 7, 218106816, 1
    .long 0, 0, 0, 0, 0, 0, 0, 0, 0, 0, 0, 0, 0, 0, 0, 0
    .long 0, 0, 0, 0, 0, 0, 0, 0, 0, 0, 0, 0, 0, 0, 0, 0
    .long 6, 16, 16, 8192, 3840, 265984, 8388608, 0, 32768, 4, 4255744, 131072, 0, 0, 218104368, 1
    .long 4, 16, 16, 8192, 3840, 265984, 8388608, 262144, 32768, 4, 5304320, 131072, 0, 0, 218104496, 1
    .long 4, 16, 16, 8192, 2048, 264192, 8388608, 786432, 32768, 4, 7372800, 131072, 0, 0, 218104608, 1
    .long 1, 24, 24, 8192, 3584, 3840, 8388608, 2097152, 32768, 8, 29417472, 131072, 0, 0, 218105392, 4
    .long 2, 64, 72, 7168, 1280, 1280, 7340032, 1048576, 32768, 8, 58216448, 114688, 0, 0, 218103936, 1
    .long 2, 64, 72, 7168, 256, 256, 7340032, 2621440, 32768, 8, 63705088, 114688, 0, 0, 218104128, 1
    .long 2, 64, 72, 7168, 6400, 6400, 7340032, 3670016, 32768, 8, 67473408, 114688, 0, 0, 218104304, 1
    .long 1, 80, 80, 2048, 1836544, 1836800, 7340032, 67399680, 114688, 7, 175661056, 32768, 218104272, 7, 218106816, 1
    .long 0, 0, 0, 0, 0, 0, 0, 0, 0, 0, 0, 0, 0, 0, 0, 0
    .long 0, 0, 0, 0, 0, 0, 0, 0, 0, 0, 0, 0, 0, 0, 0, 0
    .long 6, 16, 16, 8192, 5888, 268032, 8388608, 0, 32768, 4, 4288512, 131072, 0, 0, 218104400, 1
    .long 4, 16, 16, 8192, 5888, 268032, 8388608, 262144, 32768, 4, 5337088, 131072, 0, 0, 218104528, 1
    .long 4, 16, 16, 8192, 4096, 266240, 8388608, 786432, 32768, 4, 7405568, 131072, 0, 0, 218104640, 1
    .long 1, 24, 24, 8192, 5632, 5888, 8388608, 2097152, 32768, 8, 29450240, 131072, 0, 0, 218105424, 4
    .long 2, 64, 72, 7168, 1536, 1536, 7340032, 1048576, 32768, 8, 58220544, 114688, 0, 0, 218103936, 1
    .long 2, 64, 72, 7168, 512, 512, 7340032, 2621440, 32768, 8, 63709184, 114688, 0, 0, 218104128, 1
    .long 2, 64, 72, 7168, 6656, 6656, 7340032, 3670016, 32768, 8, 67477504, 114688, 0, 0, 218104304, 1
    .long 1, 80, 80, 2048, 3671552, 3671808, 7340032, 67428352, 114688, 7, 179855360, 32768, 218104288, 7, 218106816, 1
    .long 0, 0, 0, 0, 0, 0, 0, 0, 0, 0, 0, 0, 0, 0, 0, 0
    .long 0, 0, 0, 0, 0, 0, 0, 0, 0, 0, 0, 0, 0, 0, 0, 0
    .long 6, 16, 16, 8192, 7936, 270080, 8388608, 0, 32768, 4, 4321280, 131072, 0, 0, 218104432, 1
    .long 4, 16, 16, 8192, 7936, 270080, 8388608, 262144, 32768, 4, 5369856, 131072, 0, 0, 218104560, 1
    .long 4, 16, 16, 8192, 6144, 268288, 8388608, 786432, 32768, 4, 7438336, 131072, 0, 0, 218104672, 1
    .long 1, 24, 24, 8192, 7680, 7936, 8388608, 2097152, 32768, 8, 29483008, 131072, 0, 0, 218105456, 4
    .long 2, 64, 72, 7168, 1792, 1792, 7340032, 1048576, 32768, 8, 58224640, 114688, 0, 0, 218103952, 1
    .long 2, 64, 72, 7168, 768, 768, 7340032, 2621440, 32768, 8, 63713280, 114688, 0, 0, 218104128, 1
    .long 2, 64, 72, 7168, 6912, 6912, 7340032, 3670016, 32768, 8, 67481600, 114688, 0, 0, 218104304, 1
    .long 1, 80, 80, 2048, 5506560, 5506816, 7340032, 67457024, 114688, 7, 184049664, 32768, 218104304, 7, 218106816, 1
    .long 0, 0, 0, 0, 0, 0, 0, 0, 0, 0, 0, 0, 0, 0, 0, 0
    .long 0, 0, 0, 0, 0, 0, 0, 0, 0, 0, 0, 0, 0, 0, 0, 0
    .long 1, 32, 32, 8192, 0, 256, 8388608, 524288, 32768, 8, 39845888, 131072, 0, 0, 218104576, 4
    .long 1, 16, 16, 8192, 0, 256, 8388608, 1048576, 32768, 8, 8388608, 131072, 0, 0, 218104832, 4
    .long 1, 24, 24, 8192, 0, 256, 8388608, 2621440, 32768, 8, 31457280, 131072, 0, 0, 218105600, 4
    .long 1, 16, 16, 8192, 0, 256, 8388608, 3145728, 32768, 8, 16777216, 131072, 0, 0, 218105856, 4
    .long 1, 16, 16, 8192, 0, 256, 8388608, 3670016, 32768, 8, 18874368, 131072, 0, 0, 218106112, 4
    .long 1, 80, 80, 2048, 0, 256, 7340032, 58195968, 114688, 7, 168820736, 32768, 218103936, 7, 218106496, 1
    .long 0, 0, 0, 0, 0, 0, 0, 0, 0, 0, 0, 0, 0, 0, 0, 0
    .long 0, 0, 0, 0, 0, 0, 0, 0, 0, 0, 0, 0, 0, 0, 0, 0
    .long 0, 0, 0, 0, 0, 0, 0, 0, 0, 0, 0, 0, 0, 0, 0, 0
    .long 0, 0, 0, 0, 0, 0, 0, 0, 0, 0, 0, 0, 0, 0, 0, 0
    .long 1, 32, 32, 8192, 2048, 2304, 8388608, 524288, 32768, 8, 39878656, 131072, 0, 0, 218104608, 4
    .long 1, 16, 16, 8192, 2048, 2304, 8388608, 1048576, 32768, 8, 8421376, 131072, 0, 0, 218104864, 4
    .long 1, 24, 24, 8192, 2048, 2304, 8388608, 2621440, 32768, 8, 31490048, 131072, 0, 0, 218105632, 4
    .long 1, 16, 16, 8192, 2048, 2304, 8388608, 3145728, 32768, 8, 16809984, 131072, 0, 0, 218105888, 4
    .long 1, 16, 16, 8192, 2048, 2304, 8388608, 3670016, 32768, 8, 18907136, 131072, 0, 0, 218106144, 4
    .long 1, 80, 80, 2048, 1835008, 1835264, 7340032, 58224640, 114688, 7, 173015040, 32768, 218103952, 7, 218106496, 1
    .long 0, 0, 0, 0, 0, 0, 0, 0, 0, 0, 0, 0, 0, 0, 0, 0
    .long 0, 0, 0, 0, 0, 0, 0, 0, 0, 0, 0, 0, 0, 0, 0, 0
    .long 0, 0, 0, 0, 0, 0, 0, 0, 0, 0, 0, 0, 0, 0, 0, 0
    .long 0, 0, 0, 0, 0, 0, 0, 0, 0, 0, 0, 0, 0, 0, 0, 0
    .long 1, 32, 32, 8192, 4096, 4352, 8388608, 524288, 32768, 8, 39911424, 131072, 0, 0, 218104640, 4
    .long 1, 16, 16, 8192, 4096, 4352, 8388608, 1048576, 32768, 8, 8454144, 131072, 0, 0, 218104896, 4
    .long 1, 24, 24, 8192, 4096, 4352, 8388608, 2621440, 32768, 8, 31522816, 131072, 0, 0, 218105664, 4
    .long 1, 16, 16, 8192, 4096, 4352, 8388608, 3145728, 32768, 8, 16842752, 131072, 0, 0, 218105920, 4
    .long 1, 16, 16, 8192, 4096, 4352, 8388608, 3670016, 32768, 8, 18939904, 131072, 0, 0, 218106176, 4
    .long 1, 80, 80, 2048, 3670016, 3670272, 7340032, 58253312, 114688, 7, 177209344, 32768, 218103968, 7, 218106496, 1
    .long 0, 0, 0, 0, 0, 0, 0, 0, 0, 0, 0, 0, 0, 0, 0, 0
    .long 0, 0, 0, 0, 0, 0, 0, 0, 0, 0, 0, 0, 0, 0, 0, 0
    .long 0, 0, 0, 0, 0, 0, 0, 0, 0, 0, 0, 0, 0, 0, 0, 0
    .long 0, 0, 0, 0, 0, 0, 0, 0, 0, 0, 0, 0, 0, 0, 0, 0
    .long 1, 32, 32, 8192, 6144, 6400, 8388608, 524288, 32768, 8, 39944192, 131072, 0, 0, 218104672, 4
    .long 1, 16, 16, 8192, 6144, 6400, 8388608, 1048576, 32768, 8, 8486912, 131072, 0, 0, 218104928, 4
    .long 1, 24, 24, 8192, 6144, 6400, 8388608, 2621440, 32768, 8, 31555584, 131072, 0, 0, 218105696, 4
    .long 1, 16, 16, 8192, 6144, 6400, 8388608, 3145728, 32768, 8, 16875520, 131072, 0, 0, 218105952, 4
    .long 1, 16, 16, 8192, 6144, 6400, 8388608, 3670016, 32768, 8, 18972672, 131072, 0, 0, 218106208, 4
    .long 1, 80, 80, 2048, 5505024, 5505280, 7340032, 58281984, 114688, 7, 181403648, 32768, 218103984, 7, 218106496, 1
    .long 0, 0, 0, 0, 0, 0, 0, 0, 0, 0, 0, 0, 0, 0, 0, 0
    .long 0, 0, 0, 0, 0, 0, 0, 0, 0, 0, 0, 0, 0, 0, 0, 0
    .long 0, 0, 0, 0, 0, 0, 0, 0, 0, 0, 0, 0, 0, 0, 0, 0
    .long 0, 0, 0, 0, 0, 0, 0, 0, 0, 0, 0, 0, 0, 0, 0, 0
    .long 1, 32, 32, 8192, 512, 768, 8388608, 524288, 32768, 8, 39854080, 131072, 0, 0, 218104576, 4
    .long 1, 16, 16, 8192, 512, 768, 8388608, 1048576, 32768, 8, 8396800, 131072, 0, 0, 218104832, 4
    .long 1, 24, 24, 8192, 512, 768, 8388608, 2621440, 32768, 8, 31465472, 131072, 0, 0, 218105600, 4
    .long 1, 16, 16, 8192, 512, 768, 8388608, 3145728, 32768, 8, 16785408, 131072, 0, 0, 218105856, 4
    .long 1, 16, 16, 8192, 512, 768, 8388608, 3670016, 32768, 8, 18882560, 131072, 0, 0, 218106112, 4
    .long 1, 80, 80, 2048, 512, 768, 7340032, 58195968, 114688, 7, 168828928, 32768, 218103936, 7, 218106496, 1
    .long 0, 0, 0, 0, 0, 0, 0, 0, 0, 0, 0, 0, 0, 0, 0, 0
    .long 0, 0, 0, 0, 0, 0, 0, 0, 0, 0, 0, 0, 0, 0, 0, 0
    .long 0, 0, 0, 0, 0, 0, 0, 0, 0, 0, 0, 0, 0, 0, 0, 0
    .long 0, 0, 0, 0, 0, 0, 0, 0, 0, 0, 0, 0, 0, 0, 0, 0
    .long 1, 32, 32, 8192, 2560, 2816, 8388608, 524288, 32768, 8, 39886848, 131072, 0, 0, 218104608, 4
    .long 1, 16, 16, 8192, 2560, 2816, 8388608, 1048576, 32768, 8, 8429568, 131072, 0, 0, 218104864, 4
    .long 1, 24, 24, 8192, 2560, 2816, 8388608, 2621440, 32768, 8, 31498240, 131072, 0, 0, 218105632, 4
    .long 1, 16, 16, 8192, 2560, 2816, 8388608, 3145728, 32768, 8, 16818176, 131072, 0, 0, 218105888, 4
    .long 1, 16, 16, 8192, 2560, 2816, 8388608, 3670016, 32768, 8, 18915328, 131072, 0, 0, 218106144, 4
    .long 1, 80, 80, 2048, 1835520, 1835776, 7340032, 58224640, 114688, 7, 173023232, 32768, 218103952, 7, 218106496, 1
    .long 0, 0, 0, 0, 0, 0, 0, 0, 0, 0, 0, 0, 0, 0, 0, 0
    .long 0, 0, 0, 0, 0, 0, 0, 0, 0, 0, 0, 0, 0, 0, 0, 0
    .long 0, 0, 0, 0, 0, 0, 0, 0, 0, 0, 0, 0, 0, 0, 0, 0
    .long 0, 0, 0, 0, 0, 0, 0, 0, 0, 0, 0, 0, 0, 0, 0, 0
    .long 1, 32, 32, 8192, 4608, 4864, 8388608, 524288, 32768, 8, 39919616, 131072, 0, 0, 218104640, 4
    .long 1, 16, 16, 8192, 4608, 4864, 8388608, 1048576, 32768, 8, 8462336, 131072, 0, 0, 218104896, 4
    .long 1, 24, 24, 8192, 4608, 4864, 8388608, 2621440, 32768, 8, 31531008, 131072, 0, 0, 218105664, 4
    .long 1, 16, 16, 8192, 4608, 4864, 8388608, 3145728, 32768, 8, 16850944, 131072, 0, 0, 218105920, 4
    .long 1, 16, 16, 8192, 4608, 4864, 8388608, 3670016, 32768, 8, 18948096, 131072, 0, 0, 218106176, 4
    .long 1, 80, 80, 2048, 3670528, 3670784, 7340032, 58253312, 114688, 7, 177217536, 32768, 218103968, 7, 218106496, 1
    .long 0, 0, 0, 0, 0, 0, 0, 0, 0, 0, 0, 0, 0, 0, 0, 0
    .long 0, 0, 0, 0, 0, 0, 0, 0, 0, 0, 0, 0, 0, 0, 0, 0
    .long 0, 0, 0, 0, 0, 0, 0, 0, 0, 0, 0, 0, 0, 0, 0, 0
    .long 0, 0, 0, 0, 0, 0, 0, 0, 0, 0, 0, 0, 0, 0, 0, 0
    .long 1, 32, 32, 8192, 6656, 6912, 8388608, 524288, 32768, 8, 39952384, 131072, 0, 0, 218104672, 4
    .long 1, 16, 16, 8192, 6656, 6912, 8388608, 1048576, 32768, 8, 8495104, 131072, 0, 0, 218104928, 4
    .long 1, 24, 24, 8192, 6656, 6912, 8388608, 2621440, 32768, 8, 31563776, 131072, 0, 0, 218105696, 4
    .long 1, 16, 16, 8192, 6656, 6912, 8388608, 3145728, 32768, 8, 16883712, 131072, 0, 0, 218105952, 4
    .long 1, 16, 16, 8192, 6656, 6912, 8388608, 3670016, 32768, 8, 18980864, 131072, 0, 0, 218106208, 4
    .long 1, 80, 80, 2048, 5505536, 5505792, 7340032, 58281984, 114688, 7, 181411840, 32768, 218103984, 7, 218106496, 1
    .long 0, 0, 0, 0, 0, 0, 0, 0, 0, 0, 0, 0, 0, 0, 0, 0
    .long 0, 0, 0, 0, 0, 0, 0, 0, 0, 0, 0, 0, 0, 0, 0, 0
    .long 0, 0, 0, 0, 0, 0, 0, 0, 0, 0, 0, 0, 0, 0, 0, 0
    .long 0, 0, 0, 0, 0, 0, 0, 0, 0, 0, 0, 0, 0, 0, 0, 0
    .long 1, 32, 32, 8192, 1024, 1280, 8388608, 524288, 32768, 8, 39862272, 131072, 0, 0, 218104592, 4
    .long 1, 16, 16, 8192, 1024, 1280, 8388608, 1048576, 32768, 8, 8404992, 131072, 0, 0, 218104848, 4
    .long 1, 24, 24, 8192, 1024, 1280, 8388608, 2621440, 32768, 8, 31473664, 131072, 0, 0, 218105616, 4
    .long 1, 16, 16, 8192, 1024, 1280, 8388608, 3145728, 32768, 8, 16793600, 131072, 0, 0, 218105872, 4
    .long 1, 16, 16, 8192, 1024, 1280, 8388608, 3670016, 32768, 8, 18890752, 131072, 0, 0, 218106128, 4
    .long 1, 80, 80, 2048, 1024, 1280, 7340032, 58195968, 114688, 7, 168837120, 32768, 218103936, 7, 218106496, 1
    .long 0, 0, 0, 0, 0, 0, 0, 0, 0, 0, 0, 0, 0, 0, 0, 0
    .long 0, 0, 0, 0, 0, 0, 0, 0, 0, 0, 0, 0, 0, 0, 0, 0
    .long 0, 0, 0, 0, 0, 0, 0, 0, 0, 0, 0, 0, 0, 0, 0, 0
    .long 0, 0, 0, 0, 0, 0, 0, 0, 0, 0, 0, 0, 0, 0, 0, 0
    .long 1, 32, 32, 8192, 3072, 3328, 8388608, 524288, 32768, 8, 39895040, 131072, 0, 0, 218104624, 4
    .long 1, 16, 16, 8192, 3072, 3328, 8388608, 1048576, 32768, 8, 8437760, 131072, 0, 0, 218104880, 4
    .long 1, 24, 24, 8192, 3072, 3328, 8388608, 2621440, 32768, 8, 31506432, 131072, 0, 0, 218105648, 4
    .long 1, 16, 16, 8192, 3072, 3328, 8388608, 3145728, 32768, 8, 16826368, 131072, 0, 0, 218105904, 4
    .long 1, 16, 16, 8192, 3072, 3328, 8388608, 3670016, 32768, 8, 18923520, 131072, 0, 0, 218106160, 4
    .long 1, 80, 80, 2048, 1836032, 1836288, 7340032, 58224640, 114688, 7, 173031424, 32768, 218103952, 7, 218106496, 1
    .long 0, 0, 0, 0, 0, 0, 0, 0, 0, 0, 0, 0, 0, 0, 0, 0
    .long 0, 0, 0, 0, 0, 0, 0, 0, 0, 0, 0, 0, 0, 0, 0, 0
    .long 0, 0, 0, 0, 0, 0, 0, 0, 0, 0, 0, 0, 0, 0, 0, 0
    .long 0, 0, 0, 0, 0, 0, 0, 0, 0, 0, 0, 0, 0, 0, 0, 0
    .long 1, 32, 32, 8192, 5120, 5376, 8388608, 524288, 32768, 8, 39927808, 131072, 0, 0, 218104656, 4
    .long 1, 16, 16, 8192, 5120, 5376, 8388608, 1048576, 32768, 8, 8470528, 131072, 0, 0, 218104912, 4
    .long 1, 24, 24, 8192, 5120, 5376, 8388608, 2621440, 32768, 8, 31539200, 131072, 0, 0, 218105680, 4
    .long 1, 16, 16, 8192, 5120, 5376, 8388608, 3145728, 32768, 8, 16859136, 131072, 0, 0, 218105936, 4
    .long 1, 16, 16, 8192, 5120, 5376, 8388608, 3670016, 32768, 8, 18956288, 131072, 0, 0, 218106192, 4
    .long 1, 80, 80, 2048, 3671040, 3671296, 7340032, 58253312, 114688, 7, 177225728, 32768, 218103968, 7, 218106496, 1
    .long 0, 0, 0, 0, 0, 0, 0, 0, 0, 0, 0, 0, 0, 0, 0, 0
    .long 0, 0, 0, 0, 0, 0, 0, 0, 0, 0, 0, 0, 0, 0, 0, 0
    .long 0, 0, 0, 0, 0, 0, 0, 0, 0, 0, 0, 0, 0, 0, 0, 0
    .long 0, 0, 0, 0, 0, 0, 0, 0, 0, 0, 0, 0, 0, 0, 0, 0
    .long 1, 32, 32, 8192, 7168, 7424, 8388608, 524288, 32768, 8, 39960576, 131072, 0, 0, 218104688, 4
    .long 1, 16, 16, 8192, 7168, 7424, 8388608, 1048576, 32768, 8, 8503296, 131072, 0, 0, 218104944, 4
    .long 1, 24, 24, 8192, 7168, 7424, 8388608, 2621440, 32768, 8, 31571968, 131072, 0, 0, 218105712, 4
    .long 1, 16, 16, 8192, 7168, 7424, 8388608, 3145728, 32768, 8, 16891904, 131072, 0, 0, 218105968, 4
    .long 1, 16, 16, 8192, 7168, 7424, 8388608, 3670016, 32768, 8, 18989056, 131072, 0, 0, 218106224, 4
    .long 1, 80, 80, 2048, 5506048, 5506304, 7340032, 58281984, 114688, 7, 181420032, 32768, 218103984, 7, 218106496, 1
    .long 0, 0, 0, 0, 0, 0, 0, 0, 0, 0, 0, 0, 0, 0, 0, 0
    .long 0, 0, 0, 0, 0, 0, 0, 0, 0, 0, 0, 0, 0, 0, 0, 0
    .long 0, 0, 0, 0, 0, 0, 0, 0, 0, 0, 0, 0, 0, 0, 0, 0
    .long 0, 0, 0, 0, 0, 0, 0, 0, 0, 0, 0, 0, 0, 0, 0, 0
    .long 1, 32, 32, 8192, 1536, 1792, 8388608, 524288, 32768, 8, 39870464, 131072, 0, 0, 218104592, 4
    .long 1, 16, 16, 8192, 1536, 1792, 8388608, 1048576, 32768, 8, 8413184, 131072, 0, 0, 218104848, 4
    .long 1, 24, 24, 8192, 1536, 1792, 8388608, 2621440, 32768, 8, 31481856, 131072, 0, 0, 218105616, 4
    .long 1, 16, 16, 8192, 1536, 1792, 8388608, 3145728, 32768, 8, 16801792, 131072, 0, 0, 218105872, 4
    .long 1, 16, 16, 8192, 1536, 1792, 8388608, 3670016, 32768, 8, 18898944, 131072, 0, 0, 218106128, 4
    .long 1, 80, 80, 2048, 1536, 1792, 7340032, 58195968, 114688, 7, 168845312, 32768, 218103936, 7, 218106496, 1
    .long 0, 0, 0, 0, 0, 0, 0, 0, 0, 0, 0, 0, 0, 0, 0, 0
    .long 0, 0, 0, 0, 0, 0, 0, 0, 0, 0, 0, 0, 0, 0, 0, 0
    .long 0, 0, 0, 0, 0, 0, 0, 0, 0, 0, 0, 0, 0, 0, 0, 0
    .long 0, 0, 0, 0, 0, 0, 0, 0, 0, 0, 0, 0, 0, 0, 0, 0
    .long 1, 32, 32, 8192, 3584, 3840, 8388608, 524288, 32768, 8, 39903232, 131072, 0, 0, 218104624, 4
    .long 1, 16, 16, 8192, 3584, 3840, 8388608, 1048576, 32768, 8, 8445952, 131072, 0, 0, 218104880, 4
    .long 1, 24, 24, 8192, 3584, 3840, 8388608, 2621440, 32768, 8, 31514624, 131072, 0, 0, 218105648, 4
    .long 1, 16, 16, 8192, 3584, 3840, 8388608, 3145728, 32768, 8, 16834560, 131072, 0, 0, 218105904, 4
    .long 1, 16, 16, 8192, 3584, 3840, 8388608, 3670016, 32768, 8, 18931712, 131072, 0, 0, 218106160, 4
    .long 1, 80, 80, 2048, 1836544, 1836800, 7340032, 58224640, 114688, 7, 173039616, 32768, 218103952, 7, 218106496, 1
    .long 0, 0, 0, 0, 0, 0, 0, 0, 0, 0, 0, 0, 0, 0, 0, 0
    .long 0, 0, 0, 0, 0, 0, 0, 0, 0, 0, 0, 0, 0, 0, 0, 0
    .long 0, 0, 0, 0, 0, 0, 0, 0, 0, 0, 0, 0, 0, 0, 0, 0
    .long 0, 0, 0, 0, 0, 0, 0, 0, 0, 0, 0, 0, 0, 0, 0, 0
    .long 1, 32, 32, 8192, 5632, 5888, 8388608, 524288, 32768, 8, 39936000, 131072, 0, 0, 218104656, 4
    .long 1, 16, 16, 8192, 5632, 5888, 8388608, 1048576, 32768, 8, 8478720, 131072, 0, 0, 218104912, 4
    .long 1, 24, 24, 8192, 5632, 5888, 8388608, 2621440, 32768, 8, 31547392, 131072, 0, 0, 218105680, 4
    .long 1, 16, 16, 8192, 5632, 5888, 8388608, 3145728, 32768, 8, 16867328, 131072, 0, 0, 218105936, 4
    .long 1, 16, 16, 8192, 5632, 5888, 8388608, 3670016, 32768, 8, 18964480, 131072, 0, 0, 218106192, 4
    .long 1, 80, 80, 2048, 3671552, 3671808, 7340032, 58253312, 114688, 7, 177233920, 32768, 218103968, 7, 218106496, 1
    .long 0, 0, 0, 0, 0, 0, 0, 0, 0, 0, 0, 0, 0, 0, 0, 0
    .long 0, 0, 0, 0, 0, 0, 0, 0, 0, 0, 0, 0, 0, 0, 0, 0
    .long 0, 0, 0, 0, 0, 0, 0, 0, 0, 0, 0, 0, 0, 0, 0, 0
    .long 0, 0, 0, 0, 0, 0, 0, 0, 0, 0, 0, 0, 0, 0, 0, 0
    .long 1, 32, 32, 8192, 7680, 7936, 8388608, 524288, 32768, 8, 39968768, 131072, 0, 0, 218104688, 4
    .long 1, 16, 16, 8192, 7680, 7936, 8388608, 1048576, 32768, 8, 8511488, 131072, 0, 0, 218104944, 4
    .long 1, 24, 24, 8192, 7680, 7936, 8388608, 2621440, 32768, 8, 31580160, 131072, 0, 0, 218105712, 4
    .long 1, 16, 16, 8192, 7680, 7936, 8388608, 3145728, 32768, 8, 16900096, 131072, 0, 0, 218105968, 4
    .long 1, 16, 16, 8192, 7680, 7936, 8388608, 3670016, 32768, 8, 18997248, 131072, 0, 0, 218106224, 4
    .long 1, 80, 80, 2048, 5506560, 5506816, 7340032, 58281984, 114688, 7, 181428224, 32768, 218103984, 7, 218106496, 1
    .long 0, 0, 0, 0, 0, 0, 0, 0, 0, 0, 0, 0, 0, 0, 0, 0
    .long 0, 0, 0, 0, 0, 0, 0, 0, 0, 0, 0, 0, 0, 0, 0, 0
    .long 0, 0, 0, 0, 0, 0, 0, 0, 0, 0, 0, 0, 0, 0, 0, 0
    .long 0, 0, 0, 0, 0, 0, 0, 0, 0, 0, 0, 0, 0, 0, 0, 0
    .long 1, 24, 24, 8192, 0, 256, 8388608, 524288, 32768, 8, 23068672, 131072, 0, 0, 218104576, 4
    .long 1, 32, 32, 8192, 0, 256, 8388608, 1572864, 32768, 8, 44040192, 131072, 0, 0, 218105088, 4
    .long 1, 16, 16, 8192, 0, 256, 8388608, 2621440, 32768, 8, 14680064, 131072, 0, 0, 218105600, 4
    .long 2, 64, 72, 7168, 2048, 2048, 7340032, 1048576, 32768, 8, 58228736, 114688, 0, 0, 218103952, 1
    .long 2, 64, 72, 7168, 1024, 1024, 7340032, 2621440, 32768, 8, 63717376, 114688, 0, 0, 218104128, 1
    .long 1, 80, 80, 2048, 0, 256, 7340032, 60030976, 114688, 7, 169345024, 32768, 218104000, 7, 218106560, 1
    .long 0, 0, 0, 0, 0, 0, 0, 0, 0, 0, 0, 0, 0, 0, 0, 0
    .long 0, 0, 0, 0, 0, 0, 0, 0, 0, 0, 0, 0, 0, 0, 0, 0
    .long 0, 0, 0, 0, 0, 0, 0, 0, 0, 0, 0, 0, 0, 0, 0, 0
    .long 0, 0, 0, 0, 0, 0, 0, 0, 0, 0, 0, 0, 0, 0, 0, 0
    .long 1, 24, 24, 8192, 2048, 2304, 8388608, 524288, 32768, 8, 23101440, 131072, 0, 0, 218104608, 4
    .long 1, 32, 32, 8192, 2048, 2304, 8388608, 1572864, 32768, 8, 44072960, 131072, 0, 0, 218105120, 4
    .long 1, 16, 16, 8192, 2048, 2304, 8388608, 2621440, 32768, 8, 14712832, 131072, 0, 0, 218105632, 4
    .long 2, 64, 72, 7168, 2304, 2304, 7340032, 1048576, 32768, 8, 58232832, 114688, 0, 0, 218103952, 1
    .long 2, 64, 72, 7168, 1280, 1280, 7340032, 2621440, 32768, 8, 63721472, 114688, 0, 0, 218104128, 1
    .long 1, 80, 80, 2048, 1835008, 1835264, 7340032, 60059648, 114688, 7, 173539328, 32768, 218104016, 7, 218106560, 1
    .long 0, 0, 0, 0, 0, 0, 0, 0, 0, 0, 0, 0, 0, 0, 0, 0
    .long 0, 0, 0, 0, 0, 0, 0, 0, 0, 0, 0, 0, 0, 0, 0, 0
    .long 0, 0, 0, 0, 0, 0, 0, 0, 0, 0, 0, 0, 0, 0, 0, 0
    .long 0, 0, 0, 0, 0, 0, 0, 0, 0, 0, 0, 0, 0, 0, 0, 0
    .long 1, 24, 24, 8192, 4096, 4352, 8388608, 524288, 32768, 8, 23134208, 131072, 0, 0, 218104640, 4
    .long 1, 32, 32, 8192, 4096, 4352, 8388608, 1572864, 32768, 8, 44105728, 131072, 0, 0, 218105152, 4
    .long 1, 16, 16, 8192, 4096, 4352, 8388608, 2621440, 32768, 8, 14745600, 131072, 0, 0, 218105664, 4
    .long 2, 64, 72, 7168, 2560, 2560, 7340032, 1048576, 32768, 8, 58236928, 114688, 0, 0, 218103952, 1
    .long 2, 64, 72, 7168, 1536, 1536, 7340032, 2621440, 32768, 8, 63725568, 114688, 0, 0, 218104128, 1
    .long 1, 80, 80, 2048, 3670016, 3670272, 7340032, 60088320, 114688, 7, 177733632, 32768, 218104032, 7, 218106560, 1
    .long 0, 0, 0, 0, 0, 0, 0, 0, 0, 0, 0, 0, 0, 0, 0, 0
    .long 0, 0, 0, 0, 0, 0, 0, 0, 0, 0, 0, 0, 0, 0, 0, 0
    .long 0, 0, 0, 0, 0, 0, 0, 0, 0, 0, 0, 0, 0, 0, 0, 0
    .long 0, 0, 0, 0, 0, 0, 0, 0, 0, 0, 0, 0, 0, 0, 0, 0
    .long 1, 24, 24, 8192, 6144, 6400, 8388608, 524288, 32768, 8, 23166976, 131072, 0, 0, 218104672, 4
    .long 1, 32, 32, 8192, 6144, 6400, 8388608, 1572864, 32768, 8, 44138496, 131072, 0, 0, 218105184, 4
    .long 1, 16, 16, 8192, 6144, 6400, 8388608, 2621440, 32768, 8, 14778368, 131072, 0, 0, 218105696, 4
    .long 2, 64, 72, 7168, 2816, 2816, 7340032, 1048576, 32768, 8, 58241024, 114688, 0, 0, 218103952, 1
    .long 2, 64, 72, 7168, 1792, 1792, 7340032, 2621440, 32768, 8, 63729664, 114688, 0, 0, 218104144, 1
    .long 1, 80, 80, 2048, 5505024, 5505280, 7340032, 60116992, 114688, 7, 181927936, 32768, 218104048, 7, 218106560, 1
    .long 0, 0, 0, 0, 0, 0, 0, 0, 0, 0, 0, 0, 0, 0, 0, 0
    .long 0, 0, 0, 0, 0, 0, 0, 0, 0, 0, 0, 0, 0, 0, 0, 0
    .long 0, 0, 0, 0, 0, 0, 0, 0, 0, 0, 0, 0, 0, 0, 0, 0
    .long 0, 0, 0, 0, 0, 0, 0, 0, 0, 0, 0, 0, 0, 0, 0, 0
    .long 1, 24, 24, 8192, 512, 768, 8388608, 524288, 32768, 8, 23076864, 131072, 0, 0, 218104576, 4
    .long 1, 32, 32, 8192, 512, 768, 8388608, 1572864, 32768, 8, 44048384, 131072, 0, 0, 218105088, 4
    .long 1, 16, 16, 8192, 512, 768, 8388608, 2621440, 32768, 8, 14688256, 131072, 0, 0, 218105600, 4
    .long 2, 64, 72, 7168, 3072, 3072, 7340032, 1048576, 32768, 8, 58245120, 114688, 0, 0, 218103952, 1
    .long 2, 64, 72, 7168, 2048, 2048, 7340032, 2621440, 32768, 8, 63733760, 114688, 0, 0, 218104144, 1
    .long 1, 80, 80, 2048, 512, 768, 7340032, 60030976, 114688, 7, 169353216, 32768, 218104000, 7, 218106560, 1
    .long 0, 0, 0, 0, 0, 0, 0, 0, 0, 0, 0, 0, 0, 0, 0, 0
    .long 0, 0, 0, 0, 0, 0, 0, 0, 0, 0, 0, 0, 0, 0, 0, 0
    .long 0, 0, 0, 0, 0, 0, 0, 0, 0, 0, 0, 0, 0, 0, 0, 0
    .long 0, 0, 0, 0, 0, 0, 0, 0, 0, 0, 0, 0, 0, 0, 0, 0
    .long 1, 24, 24, 8192, 2560, 2816, 8388608, 524288, 32768, 8, 23109632, 131072, 0, 0, 218104608, 4
    .long 1, 32, 32, 8192, 2560, 2816, 8388608, 1572864, 32768, 8, 44081152, 131072, 0, 0, 218105120, 4
    .long 1, 16, 16, 8192, 2560, 2816, 8388608, 2621440, 32768, 8, 14721024, 131072, 0, 0, 218105632, 4
    .long 2, 64, 72, 7168, 3328, 3328, 7340032, 1048576, 32768, 8, 58249216, 114688, 0, 0, 218103952, 1
    .long 2, 64, 72, 7168, 2304, 2304, 7340032, 2621440, 32768, 8, 63737856, 114688, 0, 0, 218104144, 1
    .long 1, 80, 80, 2048, 1835520, 1835776, 7340032, 60059648, 114688, 7, 173547520, 32768, 218104016, 7, 218106560, 1
    .long 0, 0, 0, 0, 0, 0, 0, 0, 0, 0, 0, 0, 0, 0, 0, 0
    .long 0, 0, 0, 0, 0, 0, 0, 0, 0, 0, 0, 0, 0, 0, 0, 0
    .long 0, 0, 0, 0, 0, 0, 0, 0, 0, 0, 0, 0, 0, 0, 0, 0
    .long 0, 0, 0, 0, 0, 0, 0, 0, 0, 0, 0, 0, 0, 0, 0, 0
    .long 1, 24, 24, 8192, 4608, 4864, 8388608, 524288, 32768, 8, 23142400, 131072, 0, 0, 218104640, 4
    .long 1, 32, 32, 8192, 4608, 4864, 8388608, 1572864, 32768, 8, 44113920, 131072, 0, 0, 218105152, 4
    .long 1, 16, 16, 8192, 4608, 4864, 8388608, 2621440, 32768, 8, 14753792, 131072, 0, 0, 218105664, 4
    .long 2, 64, 72, 7168, 3584, 3584, 7340032, 1048576, 32768, 8, 58253312, 114688, 0, 0, 218103968, 1
    .long 2, 64, 72, 7168, 2560, 2560, 7340032, 2621440, 32768, 8, 63741952, 114688, 0, 0, 218104144, 1
    .long 1, 80, 80, 2048, 3670528, 3670784, 7340032, 60088320, 114688, 7, 177741824, 32768, 218104032, 7, 218106560, 1
    .long 0, 0, 0, 0, 0, 0, 0, 0, 0, 0, 0, 0, 0, 0, 0, 0
    .long 0, 0, 0, 0, 0, 0, 0, 0, 0, 0, 0, 0, 0, 0, 0, 0
    .long 0, 0, 0, 0, 0, 0, 0, 0, 0, 0, 0, 0, 0, 0, 0, 0
    .long 0, 0, 0, 0, 0, 0, 0, 0, 0, 0, 0, 0, 0, 0, 0, 0
    .long 1, 24, 24, 8192, 6656, 6912, 8388608, 524288, 32768, 8, 23175168, 131072, 0, 0, 218104672, 4
    .long 1, 32, 32, 8192, 6656, 6912, 8388608, 1572864, 32768, 8, 44146688, 131072, 0, 0, 218105184, 4
    .long 1, 16, 16, 8192, 6656, 6912, 8388608, 2621440, 32768, 8, 14786560, 131072, 0, 0, 218105696, 4
    .long 2, 64, 72, 7168, 3840, 3840, 7340032, 1048576, 32768, 8, 58257408, 114688, 0, 0, 218103968, 1
    .long 2, 64, 72, 7168, 2816, 2816, 7340032, 2621440, 32768, 8, 63746048, 114688, 0, 0, 218104144, 1
    .long 1, 80, 80, 2048, 5505536, 5505792, 7340032, 60116992, 114688, 7, 181936128, 32768, 218104048, 7, 218106560, 1
    .long 0, 0, 0, 0, 0, 0, 0, 0, 0, 0, 0, 0, 0, 0, 0, 0
    .long 0, 0, 0, 0, 0, 0, 0, 0, 0, 0, 0, 0, 0, 0, 0, 0
    .long 0, 0, 0, 0, 0, 0, 0, 0, 0, 0, 0, 0, 0, 0, 0, 0
    .long 0, 0, 0, 0, 0, 0, 0, 0, 0, 0, 0, 0, 0, 0, 0, 0
    .long 1, 24, 24, 8192, 1024, 1280, 8388608, 524288, 32768, 8, 23085056, 131072, 0, 0, 218104592, 4
    .long 1, 32, 32, 8192, 1024, 1280, 8388608, 1572864, 32768, 8, 44056576, 131072, 0, 0, 218105104, 4
    .long 1, 16, 16, 8192, 1024, 1280, 8388608, 2621440, 32768, 8, 14696448, 131072, 0, 0, 218105616, 4
    .long 2, 64, 72, 7168, 4096, 4096, 7340032, 1048576, 32768, 8, 58261504, 114688, 0, 0, 218103968, 1
    .long 2, 64, 72, 7168, 3072, 3072, 7340032, 2621440, 32768, 8, 63750144, 114688, 0, 0, 218104144, 1
    .long 1, 80, 80, 2048, 1024, 1280, 7340032, 60030976, 114688, 7, 169361408, 32768, 218104000, 7, 218106560, 1
    .long 0, 0, 0, 0, 0, 0, 0, 0, 0, 0, 0, 0, 0, 0, 0, 0
    .long 0, 0, 0, 0, 0, 0, 0, 0, 0, 0, 0, 0, 0, 0, 0, 0
    .long 0, 0, 0, 0, 0, 0, 0, 0, 0, 0, 0, 0, 0, 0, 0, 0
    .long 0, 0, 0, 0, 0, 0, 0, 0, 0, 0, 0, 0, 0, 0, 0, 0
    .long 1, 24, 24, 8192, 3072, 3328, 8388608, 524288, 32768, 8, 23117824, 131072, 0, 0, 218104624, 4
    .long 1, 32, 32, 8192, 3072, 3328, 8388608, 1572864, 32768, 8, 44089344, 131072, 0, 0, 218105136, 4
    .long 1, 16, 16, 8192, 3072, 3328, 8388608, 2621440, 32768, 8, 14729216, 131072, 0, 0, 218105648, 4
    .long 2, 64, 72, 7168, 4352, 4352, 7340032, 1048576, 32768, 8, 58265600, 114688, 0, 0, 218103968, 1
    .long 2, 64, 72, 7168, 3328, 3328, 7340032, 2621440, 32768, 8, 63754240, 114688, 0, 0, 218104144, 1
    .long 1, 80, 80, 2048, 1836032, 1836288, 7340032, 60059648, 114688, 7, 173555712, 32768, 218104016, 7, 218106560, 1
    .long 0, 0, 0, 0, 0, 0, 0, 0, 0, 0, 0, 0, 0, 0, 0, 0
    .long 0, 0, 0, 0, 0, 0, 0, 0, 0, 0, 0, 0, 0, 0, 0, 0
    .long 0, 0, 0, 0, 0, 0, 0, 0, 0, 0, 0, 0, 0, 0, 0, 0
    .long 0, 0, 0, 0, 0, 0, 0, 0, 0, 0, 0, 0, 0, 0, 0, 0
    .long 1, 24, 24, 8192, 5120, 5376, 8388608, 524288, 32768, 8, 23150592, 131072, 0, 0, 218104656, 4
    .long 1, 32, 32, 8192, 5120, 5376, 8388608, 1572864, 32768, 8, 44122112, 131072, 0, 0, 218105168, 4
    .long 1, 16, 16, 8192, 5120, 5376, 8388608, 2621440, 32768, 8, 14761984, 131072, 0, 0, 218105680, 4
    .long 2, 64, 72, 7168, 4608, 4608, 7340032, 1048576, 32768, 8, 58269696, 114688, 0, 0, 218103968, 1
    .long 2, 64, 72, 7168, 3584, 3584, 7340032, 2621440, 32768, 8, 63758336, 114688, 0, 0, 218104160, 1
    .long 1, 80, 80, 2048, 3671040, 3671296, 7340032, 60088320, 114688, 7, 177750016, 32768, 218104032, 7, 218106560, 1
    .long 0, 0, 0, 0, 0, 0, 0, 0, 0, 0, 0, 0, 0, 0, 0, 0
    .long 0, 0, 0, 0, 0, 0, 0, 0, 0, 0, 0, 0, 0, 0, 0, 0
    .long 0, 0, 0, 0, 0, 0, 0, 0, 0, 0, 0, 0, 0, 0, 0, 0
    .long 0, 0, 0, 0, 0, 0, 0, 0, 0, 0, 0, 0, 0, 0, 0, 0
    .long 1, 24, 24, 8192, 7168, 7424, 8388608, 524288, 32768, 8, 23183360, 131072, 0, 0, 218104688, 4
    .long 1, 32, 32, 8192, 7168, 7424, 8388608, 1572864, 32768, 8, 44154880, 131072, 0, 0, 218105200, 4
    .long 1, 16, 16, 8192, 7168, 7424, 8388608, 2621440, 32768, 8, 14794752, 131072, 0, 0, 218105712, 4
    .long 2, 64, 72, 7168, 4864, 4864, 7340032, 1048576, 32768, 8, 58273792, 114688, 0, 0, 218103968, 1
    .long 2, 64, 72, 7168, 3840, 3840, 7340032, 2621440, 32768, 8, 63762432, 114688, 0, 0, 218104160, 1
    .long 1, 80, 80, 2048, 5506048, 5506304, 7340032, 60116992, 114688, 7, 181944320, 32768, 218104048, 7, 218106560, 1
    .long 0, 0, 0, 0, 0, 0, 0, 0, 0, 0, 0, 0, 0, 0, 0, 0
    .long 0, 0, 0, 0, 0, 0, 0, 0, 0, 0, 0, 0, 0, 0, 0, 0
    .long 0, 0, 0, 0, 0, 0, 0, 0, 0, 0, 0, 0, 0, 0, 0, 0
    .long 0, 0, 0, 0, 0, 0, 0, 0, 0, 0, 0, 0, 0, 0, 0, 0
    .long 1, 24, 24, 8192, 1536, 1792, 8388608, 524288, 32768, 8, 23093248, 131072, 0, 0, 218104592, 4
    .long 1, 32, 32, 8192, 1536, 1792, 8388608, 1572864, 32768, 8, 44064768, 131072, 0, 0, 218105104, 4
    .long 1, 16, 16, 8192, 1536, 1792, 8388608, 2621440, 32768, 8, 14704640, 131072, 0, 0, 218105616, 4
    .long 2, 64, 72, 7168, 5120, 5120, 7340032, 1048576, 32768, 8, 58277888, 114688, 0, 0, 218103968, 1
    .long 2, 64, 72, 7168, 4096, 4096, 7340032, 2621440, 32768, 8, 63766528, 114688, 0, 0, 218104160, 1
    .long 1, 80, 80, 2048, 1536, 1792, 7340032, 60030976, 114688, 7, 169369600, 32768, 218104000, 7, 218106560, 1
    .long 0, 0, 0, 0, 0, 0, 0, 0, 0, 0, 0, 0, 0, 0, 0, 0
    .long 0, 0, 0, 0, 0, 0, 0, 0, 0, 0, 0, 0, 0, 0, 0, 0
    .long 0, 0, 0, 0, 0, 0, 0, 0, 0, 0, 0, 0, 0, 0, 0, 0
    .long 0, 0, 0, 0, 0, 0, 0, 0, 0, 0, 0, 0, 0, 0, 0, 0
    .long 1, 24, 24, 8192, 3584, 3840, 8388608, 524288, 32768, 8, 23126016, 131072, 0, 0, 218104624, 4
    .long 1, 32, 32, 8192, 3584, 3840, 8388608, 1572864, 32768, 8, 44097536, 131072, 0, 0, 218105136, 4
    .long 1, 16, 16, 8192, 3584, 3840, 8388608, 2621440, 32768, 8, 14737408, 131072, 0, 0, 218105648, 4
    .long 2, 64, 72, 7168, 5376, 5376, 7340032, 1048576, 32768, 8, 58281984, 114688, 0, 0, 218103984, 1
    .long 2, 64, 72, 7168, 4352, 4352, 7340032, 2621440, 32768, 8, 63770624, 114688, 0, 0, 218104160, 1
    .long 1, 80, 80, 2048, 1836544, 1836800, 7340032, 60059648, 114688, 7, 173563904, 32768, 218104016, 7, 218106560, 1
    .long 0, 0, 0, 0, 0, 0, 0, 0, 0, 0, 0, 0, 0, 0, 0, 0
    .long 0, 0, 0, 0, 0, 0, 0, 0, 0, 0, 0, 0, 0, 0, 0, 0
    .long 0, 0, 0, 0, 0, 0, 0, 0, 0, 0, 0, 0, 0, 0, 0, 0
    .long 0, 0, 0, 0, 0, 0, 0, 0, 0, 0, 0, 0, 0, 0, 0, 0
    .long 1, 24, 24, 8192, 5632, 5888, 8388608, 524288, 32768, 8, 23158784, 131072, 0, 0, 218104656, 4
    .long 1, 32, 32, 8192, 5632, 5888, 8388608, 1572864, 32768, 8, 44130304, 131072, 0, 0, 218105168, 4
    .long 1, 16, 16, 8192, 5632, 5888, 8388608, 2621440, 32768, 8, 14770176, 131072, 0, 0, 218105680, 4
    .long 2, 64, 72, 7168, 5632, 5632, 7340032, 1048576, 32768, 8, 58286080, 114688, 0, 0, 218103984, 1
    .long 2, 64, 72, 7168, 4608, 4608, 7340032, 2621440, 32768, 8, 63774720, 114688, 0, 0, 218104160, 1
    .long 1, 80, 80, 2048, 3671552, 3671808, 7340032, 60088320, 114688, 7, 177758208, 32768, 218104032, 7, 218106560, 1
    .long 0, 0, 0, 0, 0, 0, 0, 0, 0, 0, 0, 0, 0, 0, 0, 0
    .long 0, 0, 0, 0, 0, 0, 0, 0, 0, 0, 0, 0, 0, 0, 0, 0
    .long 0, 0, 0, 0, 0, 0, 0, 0, 0, 0, 0, 0, 0, 0, 0, 0
    .long 0, 0, 0, 0, 0, 0, 0, 0, 0, 0, 0, 0, 0, 0, 0, 0
    .long 1, 24, 24, 8192, 7680, 7936, 8388608, 524288, 32768, 8, 23191552, 131072, 0, 0, 218104688, 4
    .long 1, 32, 32, 8192, 7680, 7936, 8388608, 1572864, 32768, 8, 44163072, 131072, 0, 0, 218105200, 4
    .long 1, 16, 16, 8192, 7680, 7936, 8388608, 2621440, 32768, 8, 14802944, 131072, 0, 0, 218105712, 4
    .long 2, 64, 72, 7168, 5888, 5888, 7340032, 1048576, 32768, 8, 58290176, 114688, 0, 0, 218103984, 1
    .long 2, 64, 72, 7168, 4864, 4864, 7340032, 2621440, 32768, 8, 63778816, 114688, 0, 0, 218104160, 1
    .long 1, 80, 80, 2048, 5506560, 5506816, 7340032, 60116992, 114688, 7, 181952512, 32768, 218104048, 7, 218106560, 1
    .long 0, 0, 0, 0, 0, 0, 0, 0, 0, 0, 0, 0, 0, 0, 0, 0
    .long 0, 0, 0, 0, 0, 0, 0, 0, 0, 0, 0, 0, 0, 0, 0, 0
    .long 0, 0, 0, 0, 0, 0, 0, 0, 0, 0, 0, 0, 0, 0, 0, 0
    .long 0, 0, 0, 0, 0, 0, 0, 0, 0, 0, 0, 0, 0, 0, 0, 0
.p2align 6
.amdhsa_kernel recurrent_scan__memory_aug_recurrent_mem_tr__glu_gated_glu__prompt_kernel
  .amdhsa_next_free_vgpr 256
  .amdhsa_next_free_sgpr 102
  .amdhsa_accum_offset 256
  .amdhsa_group_segment_fixed_size 0
  .amdhsa_kernarg_size 112
  .amdhsa_user_sgpr_count 2
  .amdhsa_user_sgpr_kernarg_segment_ptr 1
  .amdhsa_system_sgpr_workgroup_id_x 1
  .amdhsa_float_denorm_mode_32 3
.end_amdhsa_kernel
```

```asm
; @launch grid=(256,1,1) block=(512,1,1) lds=163840
.amdgcn_target "amdgcn-amd-amdhsa--gfx950"
.text
.globl recurrent_scan__memory_aug_recurrent_mem_tr__glu_gated_glu__prompt_kernel
.p2align 8
.type recurrent_scan__memory_aug_recurrent_mem_tr__glu_gated_glu__prompt_kernel,@function
recurrent_scan__memory_aug_recurrent_mem_tr__glu_gated_glu__prompt_kernel:
    s_cmp_ge_u32 s2, 256
    s_cbranch_scc1 k_exit
    s_mov_b32 s99, s2
    s_load_dwordx2 s[4:5], s[0:1], 104
    s_load_dwordx2 s[64:65], s[0:1], 96
    v_lshrrev_b32 v2, 6, v0
    s_mov_b32 s6, 268435456
    s_mov_b32 s7, 131072
    s_mov_b32 s66, 256
    s_mov_b32 s67, 131072
    v_readfirstlane_b32 s3, v2
    s_lshr_b32 s12, s2, 3
    s_and_b32 s13, s2, 3
    s_waitcnt lgkmcnt(0)
    s_bitcmp0_b32 s2, 2
    s_cbranch_scc1 chain_map
    s_lshl_b32 s63, s12, 2
    s_add_u32 s63, s63, s13
    s_mov_b32 s29, s63
    v_and_b32 v20, 63, v0
    v_lshlrev_b32 v1, 4, v20
    v_add_u32 v19, 0x1000, v1
    v_lshrrev_b32 v4, 4, v20
    v_mov_b32 v17, 0
    v_mov_b32 v18, 1
    s_lshr_b32 s26, s3, 2
    s_and_b32 s27, s3, 3
    s_lshl_b32 s21, s3, 11
    s_lshl_b32 s22, s3, 10
    s_add_u32 s22, s22, 16384
    s_mov_b32 s11, 131072
    s_mov_b32 s15, 131072
    s_mov_b32 s28, 0
    v_and_b32 v21, 15, v20
    v_lshlrev_b32 v22, 2, v4
    v_xor_b32 v21, v21, v22
    s_lshr_b32 s30, s3, 1
    s_and_b32 s30, s30, 1
    v_xor_b32 v21, s30, v21
    v_lshlrev_b32 v3, 4, v21
    s_lshl_b32 s30, s26, 13
    v_add_u32 v5, s30, v1
    v_add_u32 v6, 0x10000, v5
    v_bfe_u32 v21, v20, 2, 2
    v_and_b32 v22, 3, v20
    v_and_b32 v23, 1, v4
    v_xor_b32 v24, s27, v21
    v_xor_b32 v25, v22, v23
    v_lshl_add_u32 v24, v24, 2, v25
    v_lshlrev_b32 v24, 4, v24
    v_lshl_add_u32 v25, v4, 3, v21
    v_lshl_add_u32 v24, v25, 8, v24
    v_and_b32 v22, 1, v22
    v_xor_b32 v25, 0, v23
    v_lshl_add_u32 v8, v25, 10, v24
    v_xor_b32 v25, 0, v22
    v_lshl_add_u32 v8, v25, 3, v8
    v_add_u32 v12, 0x10000, v8
    v_xor_b32 v25, 1, v23
    v_lshl_add_u32 v9, v25, 10, v24
    v_xor_b32 v25, 0, v22
    v_lshl_add_u32 v9, v25, 3, v9
    v_add_u32 v13, 0x10000, v9
    v_xor_b32 v25, 0, v23
    v_lshl_add_u32 v10, v25, 10, v24
    v_xor_b32 v25, 1, v22
    v_lshl_add_u32 v10, v25, 3, v10
    v_add_u32 v14, 0x10000, v10
    v_xor_b32 v25, 1, v23
    v_lshl_add_u32 v11, v25, 10, v24
    v_xor_b32 v25, 1, v22
    v_lshl_add_u32 v11, v25, 3, v11
    v_add_u32 v15, 0x10000, v11
    s_lshl_b32 s30, s3, 2
    s_add_u32 s30, s30, 131072
    v_mov_b32 v7, s30
    s_getpc_b64 s[24:25]
    s_add_u32 s24, s24, jobtab@rel32@lo+4
    s_addc_u32 s25, s25, jobtab@rel32@hi+12
    s_mul_i32 s30, s29, 640
    s_add_u32 s24, s24, s30
    s_addc_u32 s25, s25, 0
    s_load_dwordx16 s[32:47], s[24:25], 0
    s_add_u32 s24, s24, 64
    s_addc_u32 s25, s25, 0
    s_waitcnt lgkmcnt(0)
    s_mov_b32 s8, s4
    s_mov_b32 s9, s5
    s_mov_b32 s10, 0
    s_mov_b32 s12, s4
    s_mov_b32 s13, s5
    s_mov_b32 s14, 0
    s_load_dwordx2 s[88:89], s[0:1], 0
    s_mov_b32 s90, 4194304
    s_mov_b32 s91, 131072
    s_mov_b32 s98, 0
    v_mov_b32 v22, 0
    s_mov_b32 s70, 1
    v_and_b32 v245, 15, v0
    v_lshlrev_b32 v246, 11, v245
    v_lshl_add_u32 v246, v4, 4, v246
    s_add_u32 s71, s63, 32
    s_and_b32 s71, s71, 127
    s_lshl_b32 s72, s71, 15
    s_lshl_b32 s73, s3, 8
    s_add_u32 s72, s72, s73
    s_waitcnt lgkmcnt(0)
    buffer_load_dwordx4 v[228:231], v246, s[88:91], s72 offen offset:0
    buffer_load_dwordx4 v[232:235], v246, s[88:91], s72 offen offset:64
    buffer_load_dwordx4 v[236:239], v246, s[88:91], s72 offen offset:128
    buffer_load_dwordx4 v[240:243], v246, s[88:91], s72 offen offset:192
    s_cmp_lg_u32 s32, 6
    s_cbranch_scc1 ln_nx
    s_mov_b32 s98, 3
    s_cmp_lg_u32 s32, 6
    s_cbranch_scc1 xs_1
    s_load_dwordx2 s[8:9], s[0:1], s33
    s_load_dwordx2 s[12:13], s[0:1], s34
    s_mov_b32 s10, s38
    s_mov_b32 s14, s38
    s_cmp_ge_u32 s32, 4
    s_cselect_b32 s31, 0, 1
    s_lshl_b32 s30, s3, s31
    s_mul_i32 s30, s30, s40
    s_add_u32 s16, s39, s30
    s_cmp_eq_u32 s32, 4
    s_cselect_b32 s30, 1024, s40
    s_cselect_b32 s31, 6, 5
    s_lshl_b32 s62, 32, s31
    s_add_u32 s17, s16, s30
    s_lshl_b32 s30, s3, 2
    s_mul_i32 s30, s30, s35
    s_add_u32 s18, s36, s30
    s_add_u32 s19, s37, s30
    s_lshl_b32 s20, s35, s31
    v_mul_u32_u24 v2, s35, v4
    v_add_u32 v2, v2, v3
    s_waitcnt lgkmcnt(0)
    s_lshl_b32 s16, s3, 15
    s_add_u32 s16, s16, s39
    s_add_u32 s92, s16, 2048
    s_lshl_b32 s93, s35, 10
    s_lshr_b32 s94, s63, 2
    s_mul_i32 s94, s94, 1
    s_and_b32 s94, s94, 15
    s_lshl_b32 s95, s94, 7
    s_add_u32 s16, s16, s95
    s_lshl_b32 s95, s35, 6
    s_mul_i32 s94, s95, s94
    s_add_u32 s95, s18, s93
    s_add_u32 s18, s18, s94
    s_add_u32 s19, s19, s94
    s_add_u32 s17, s16, 16384
    s_mov_b32 s62, 128
    s_lshl_b32 s20, s35, 6
    v_lshrrev_b32 v21, 7, v1
    v_bfe_u32 v23, v1, 4, 3
    v_xor_b32 v23, v21, v23
    v_lshlrev_b32 v23, 4, v23
    v_lshl_add_u32 v23, v21, 11, v23
    s_add_u32 m0, s21, 0
    s_nop 0
    buffer_load_dwordx4 v23, s[88:91], s16 offen lds
    s_add_u32 s16, s16, s62
    s_add_u32 m0, s21, 1024
    s_nop 0
    buffer_load_dwordx4 v23, s[88:91], s17 offen lds
    s_add_u32 s17, s17, s62
    s_cmp_ge_u32 s16, s92
    s_cselect_b32 s94, 2048, 0
    s_sub_u32 s16, s16, s94
    s_sub_u32 s17, s17, s94
    s_add_u32 m0, s22, 0
    s_nop 0
    buffer_load_dwordx4 v2, s[8:11], s18 offen lds
    s_add_u32 s18, s18, s20
    s_add_u32 m0, s22, 8192
    s_nop 0
    buffer_load_dwordx4 v2, s[12:15], s19 offen lds
    s_add_u32 s19, s19, s20
    s_cmp_ge_u32 s18, s95
    s_cselect_b32 s94, s93, 0
    s_sub_u32 s18, s18, s94
    s_sub_u32 s19, s19, s94
    s_add_u32 m0, s21, 32768
    s_nop 0
    buffer_load_dwordx4 v23, s[88:91], s16 offen lds
    s_add_u32 s16, s16, s62
    s_add_u32 m0, s21, 33792
    s_nop 0
    buffer_load_dwordx4 v23, s[88:91], s17 offen lds
    s_add_u32 s17, s17, s62
    s_cmp_ge_u32 s16, s92
    s_cselect_b32 s94, 2048, 0
    s_sub_u32 s16, s16, s94
    s_sub_u32 s17, s17, s94
    s_add_u32 m0, s22, 32768
    s_nop 0
    buffer_load_dwordx4 v2, s[8:11], s18 offen lds
    s_add_u32 s18, s18, s20
    s_add_u32 m0, s22, 40960
    s_nop 0
    buffer_load_dwordx4 v2, s[12:15], s19 offen lds
    s_add_u32 s19, s19, s20
    s_cmp_ge_u32 s18, s95
    s_cselect_b32 s94, s93, 0
    s_sub_u32 s18, s18, s94
    s_sub_u32 s19, s19, s94
    s_add_u32 m0, s21, 65536
    s_nop 0
    buffer_load_dwordx4 v23, s[88:91], s16 offen lds
    s_add_u32 s16, s16, s62
    s_add_u32 m0, s21, 66560
    s_nop 0
    buffer_load_dwordx4 v23, s[88:91], s17 offen lds
    s_add_u32 s17, s17, s62
    s_cmp_ge_u32 s16, s92
    s_cselect_b32 s94, 2048, 0
    s_sub_u32 s16, s16, s94
    s_sub_u32 s17, s17, s94
    s_add_u32 m0, s22, 65536
    s_nop 0
    buffer_load_dwordx4 v2, s[8:11], s18 offen lds
    s_add_u32 s18, s18, s20
    s_add_u32 m0, s22, 73728
    s_nop 0
    buffer_load_dwordx4 v2, s[12:15], s19 offen lds
    s_add_u32 s19, s19, s20
    s_cmp_ge_u32 s18, s95
    s_cselect_b32 s94, s93, 0
    s_sub_u32 s18, s18, s94
    s_sub_u32 s19, s19, s94
    s_add_u32 m0, s21, 98304
    s_nop 0
    buffer_load_dwordx4 v23, s[88:91], s16 offen lds
    s_add_u32 s16, s16, s62
    s_add_u32 m0, s21, 99328
    s_nop 0
    buffer_load_dwordx4 v23, s[88:91], s17 offen lds
    s_add_u32 s17, s17, s62
    s_cmp_ge_u32 s16, s92
    s_cselect_b32 s94, 2048, 0
    s_sub_u32 s16, s16, s94
    s_sub_u32 s17, s17, s94
    s_add_u32 m0, s22, 98304
    s_nop 0
    buffer_load_dwordx4 v2, s[8:11], s18 offen lds
    s_add_u32 s18, s18, s20
    s_add_u32 m0, s22, 106496
    s_nop 0
    buffer_load_dwordx4 v2, s[12:15], s19 offen lds
    s_add_u32 s19, s19, s20
    s_cmp_ge_u32 s18, s95
    s_cselect_b32 s94, s93, 0
    s_sub_u32 s18, s18, s94
    s_sub_u32 s19, s19, s94
    v_and_b32 v21, 1, v4
    v_lshlrev_b32 v21, 10, v21
    v_xor_b32 v8, v21, v8
    v_xor_b32 v9, v21, v9
    v_xor_b32 v10, v21, v10
    v_xor_b32 v11, v21, v11
    v_xor_b32 v12, v21, v12
    v_xor_b32 v13, v21, v13
    v_xor_b32 v14, v21, v14
    v_xor_b32 v15, v21, v15
xs_1:
    s_branch w_adopt
ln_nx:
    s_lshl_b32 s73, s71, 9
    s_add_u32 s73, s73, 218103808
    v_lshlrev_b32 v252, 2, v0
    s_cmp_ge_u32 s71, 32
    s_cbranch_scc1 ln_nz
    s_cmp_ge_u32 s3, 2
    s_cbranch_scc1 ln_nz
    buffer_store_dword v17, v252, s[4:7], s73 offen sc1
ln_nz:
    s_waitcnt vmcnt(0)
ln_entry:
    v_lshlrev_b32 v247, 5, v245
    v_add_u32 v247, 135168, v247
    s_lshl_b32 s74, s3, 2
    v_add_u32 v248, s74, v247
    s_lshl_b32 s75, s71, 15
    s_lshl_b32 s76, s3, 12
    s_add_u32 s75, s75, s76
    v_and_b32 v249, 1, v4
    v_cmp_eq_u32 s[80:81], 1, v249
    v_lshlrev_b32 v56, 16, v228
    v_and_b32 v57, 0xffff0000, v228
    v_lshlrev_b32 v58, 16, v229
    v_and_b32 v59, 0xffff0000, v229
    v_lshlrev_b32 v60, 16, v230
    v_and_b32 v61, 0xffff0000, v230
    v_lshlrev_b32 v62, 16, v231
    v_and_b32 v63, 0xffff0000, v231
    v_lshlrev_b32 v64, 16, v232
    v_and_b32 v65, 0xffff0000, v232
    v_lshlrev_b32 v66, 16, v233
    v_and_b32 v67, 0xffff0000, v233
    v_lshlrev_b32 v68, 16, v234
    v_and_b32 v69, 0xffff0000, v234
    v_lshlrev_b32 v70, 16, v235
    v_and_b32 v71, 0xffff0000, v235
    v_lshlrev_b32 v72, 16, v236
    v_and_b32 v73, 0xffff0000, v236
    v_lshlrev_b32 v74, 16, v237
    v_and_b32 v75, 0xffff0000, v237
    v_lshlrev_b32 v76, 16, v238
    v_and_b32 v77, 0xffff0000, v238
    v_lshlrev_b32 v78, 16, v239
    v_and_b32 v79, 0xffff0000, v239
    v_lshlrev_b32 v80, 16, v240
    v_and_b32 v81, 0xffff0000, v240
    v_lshlrev_b32 v82, 16, v241
    v_and_b32 v83, 0xffff0000, v241
    v_lshlrev_b32 v84, 16, v242
    v_and_b32 v85, 0xffff0000, v242
    v_lshlrev_b32 v86, 16, v243
    v_and_b32 v87, 0xffff0000, v243
    v_add_f32 v120, v56, v72
    v_add_f32 v121, v57, v73
    v_add_f32 v122, v58, v74
    v_add_f32 v123, v59, v75
    v_add_f32 v124, v60, v76
    v_add_f32 v125, v61, v77
    v_add_f32 v126, v62, v78
    v_add_f32 v127, v63, v79
    v_add_f32 v128, v64, v80
    v_add_f32 v129, v65, v81
    v_add_f32 v130, v66, v82
    v_add_f32 v131, v67, v83
    v_add_f32 v132, v68, v84
    v_add_f32 v133, v69, v85
    v_add_f32 v134, v70, v86
    v_add_f32 v135, v71, v87
    v_add_f32 v120, v120, v128
    v_add_f32 v121, v121, v129
    v_add_f32 v122, v122, v130
    v_add_f32 v123, v123, v131
    v_add_f32 v124, v124, v132
    v_add_f32 v125, v125, v133
    v_add_f32 v126, v126, v134
    v_add_f32 v127, v127, v135
    v_add_f32 v120, v120, v124
    v_add_f32 v121, v121, v125
    v_add_f32 v122, v122, v126
    v_add_f32 v123, v123, v127
    v_add_f32 v120, v120, v122
    v_add_f32 v121, v121, v123
    v_add_f32 v120, v120, v121
    v_mov_b32 v121, v120
    s_nop 1
    v_permlane16_swap_b32 v121, v120
    v_add_f32 v120, v120, v121
    v_mov_b32 v121, v120
    s_nop 1
    v_permlane32_swap_b32 v121, v120
    v_add_f32 v120, v120, v121
    ds_write_b32 v248, v120 offset:0
    s_waitcnt lgkmcnt(0)
    s_barrier
    ds_read_b128 v[120:123], v247 offset:0
    ds_read_b128 v[124:127], v247 offset:16
    s_waitcnt lgkmcnt(0)
    v_add_f32 v120, v120, v124
    v_add_f32 v121, v121, v125
    v_add_f32 v122, v122, v126
    v_add_f32 v123, v123, v127
    v_add_f32 v120, v120, v122
    v_add_f32 v121, v121, v123
    v_add_f32 v120, v120, v121
    v_mul_f32 v250, 0x3a800000, v120
    v_sub_f32 v152, v56, v250
    v_sub_f32 v153, v57, v250
    v_sub_f32 v154, v58, v250
    v_sub_f32 v155, v59, v250
    v_sub_f32 v156, v60, v250
    v_sub_f32 v157, v61, v250
    v_sub_f32 v158, v62, v250
    v_sub_f32 v159, v63, v250
    v_sub_f32 v160, v64, v250
    v_sub_f32 v161, v65, v250
    v_sub_f32 v162, v66, v250
    v_sub_f32 v163, v67, v250
    v_sub_f32 v164, v68, v250
    v_sub_f32 v165, v69, v250
    v_sub_f32 v166, v70, v250
    v_sub_f32 v167, v71, v250
    v_sub_f32 v168, v72, v250
    v_sub_f32 v169, v73, v250
    v_sub_f32 v170, v74, v250
    v_sub_f32 v171, v75, v250
    v_sub_f32 v172, v76, v250
    v_sub_f32 v173, v77, v250
    v_sub_f32 v174, v78, v250
    v_sub_f32 v175, v79, v250
    v_sub_f32 v176, v80, v250
    v_sub_f32 v177, v81, v250
    v_sub_f32 v178, v82, v250
    v_sub_f32 v179, v83, v250
    v_sub_f32 v180, v84, v250
    v_sub_f32 v181, v85, v250
    v_sub_f32 v182, v86, v250
    v_sub_f32 v183, v87, v250
    v_mul_f32 v120, v152, v152
    v_fmac_f32 v120, v168, v168
    v_mul_f32 v121, v153, v153
    v_fmac_f32 v121, v169, v169
    v_mul_f32 v122, v154, v154
    v_fmac_f32 v122, v170, v170
    v_mul_f32 v123, v155, v155
    v_fmac_f32 v123, v171, v171
    v_mul_f32 v124, v156, v156
    v_fmac_f32 v124, v172, v172
    v_mul_f32 v125, v157, v157
    v_fmac_f32 v125, v173, v173
    v_mul_f32 v126, v158, v158
    v_fmac_f32 v126, v174, v174
    v_mul_f32 v127, v159, v159
    v_fmac_f32 v127, v175, v175
    v_mul_f32 v128, v160, v160
    v_fmac_f32 v128, v176, v176
    v_mul_f32 v129, v161, v161
    v_fmac_f32 v129, v177, v177
    v_mul_f32 v130, v162, v162
    v_fmac_f32 v130, v178, v178
    v_mul_f32 v131, v163, v163
    v_fmac_f32 v131, v179, v179
    v_mul_f32 v132, v164, v164
    v_fmac_f32 v132, v180, v180
    v_mul_f32 v133, v165, v165
    v_fmac_f32 v133, v181, v181
    v_mul_f32 v134, v166, v166
    v_fmac_f32 v134, v182, v182
    v_mul_f32 v135, v167, v167
    v_fmac_f32 v135, v183, v183
    v_add_f32 v120, v120, v128
    v_add_f32 v121, v121, v129
    v_add_f32 v122, v122, v130
    v_add_f32 v123, v123, v131
    v_add_f32 v124, v124, v132
    v_add_f32 v125, v125, v133
    v_add_f32 v126, v126, v134
    v_add_f32 v127, v127, v135
    v_add_f32 v120, v120, v124
    v_add_f32 v121, v121, v125
    v_add_f32 v122, v122, v126
    v_add_f32 v123, v123, v127
    v_add_f32 v120, v120, v122
    v_add_f32 v121, v121, v123
    v_add_f32 v120, v120, v121
    v_mov_b32 v121, v120
    s_nop 1
    v_permlane16_swap_b32 v121, v120
    v_add_f32 v120, v120, v121
    v_mov_b32 v121, v120
    s_nop 1
    v_permlane32_swap_b32 v121, v120
    v_add_f32 v120, v120, v121
    ds_write_b32 v248, v120 offset:512
    s_waitcnt lgkmcnt(0)
    s_barrier
    ds_read_b128 v[120:123], v247 offset:512
    ds_read_b128 v[124:127], v247 offset:528
    s_waitcnt lgkmcnt(0)
    v_add_f32 v120, v120, v124
    v_add_f32 v121, v121, v125
    v_add_f32 v122, v122, v126
    v_add_f32 v123, v123, v127
    v_add_f32 v120, v120, v122
    v_add_f32 v121, v121, v123
    v_add_f32 v120, v120, v121
    v_mul_f32 v251, 0x3a800000, v120
    v_cvt_pk_bf16_f32 v250, v250, v250
    v_lshlrev_b32 v250, 16, v250
    v_cvt_pk_bf16_f32 v251, v251, v251
    v_lshlrev_b32 v251, 16, v251
    v_add_f32 v251, 0x3727c5ac, v251
    v_cvt_pk_bf16_f32 v251, v251, v251
    v_lshlrev_b32 v251, 16, v251
    v_sqrt_f32 v251, v251
    s_nop 0
    v_cvt_pk_bf16_f32 v251, v251, v251
    v_lshlrev_b32 v251, 16, v251
    v_rcp_f32 v251, v251
    s_nop 0
    s_cmp_lg_u32 s3, 0
    s_cbranch_scc1 ln_nst
    s_lshl_b32 s77, s71, 7
    s_add_u32 s77, s77, 188743680
    v_lshlrev_b32 v249, 3, v245
    s_mov_b64 exec, 0xffff
    buffer_store_dwordx2 v[250:251], v249, s[4:7], s77 offen sc1
    s_mov_b64 exec, -1
ln_nst:
    v_sub_f32 v56, v56, v250
    v_sub_f32 v57, v57, v250
    v_cvt_pk_bf16_f32 v228, v56, v57
    v_lshlrev_b32 v56, 16, v228
    v_and_b32 v57, 0xffff0000, v228
    v_mul_f32 v56, v56, v251
    v_mul_f32 v57, v57, v251
    v_cvt_pk_bf16_f32 v228, v56, v57
    v_sub_f32 v58, v58, v250
    v_sub_f32 v59, v59, v250
    v_cvt_pk_bf16_f32 v229, v58, v59
    v_lshlrev_b32 v58, 16, v229
    v_and_b32 v59, 0xffff0000, v229
    v_mul_f32 v58, v58, v251
    v_mul_f32 v59, v59, v251
    v_cvt_pk_bf16_f32 v229, v58, v59
    v_sub_f32 v60, v60, v250
    v_sub_f32 v61, v61, v250
    v_cvt_pk_bf16_f32 v230, v60, v61
    v_lshlrev_b32 v60, 16, v230
    v_and_b32 v61, 0xffff0000, v230
    v_mul_f32 v60, v60, v251
    v_mul_f32 v61, v61, v251
    v_cvt_pk_bf16_f32 v230, v60, v61
    v_sub_f32 v62, v62, v250
    v_sub_f32 v63, v63, v250
    v_cvt_pk_bf16_f32 v231, v62, v63
    v_lshlrev_b32 v62, 16, v231
    v_and_b32 v63, 0xffff0000, v231
    v_mul_f32 v62, v62, v251
    v_mul_f32 v63, v63, v251
    v_cvt_pk_bf16_f32 v231, v62, v63
    v_cndmask_b32 v120, v228, v230, s[80:81]
    v_cndmask_b32 v121, v229, v231, s[80:81]
    v_cndmask_b32 v122, v230, v228, s[80:81]
    v_cndmask_b32 v123, v231, v229, s[80:81]
    buffer_store_dwordx4 v[120:123], v1, s[4:7], s75 offen offset:0 sc1
    v_sub_f32 v64, v64, v250
    v_sub_f32 v65, v65, v250
    v_cvt_pk_bf16_f32 v232, v64, v65
    v_lshlrev_b32 v64, 16, v232
    v_and_b32 v65, 0xffff0000, v232
    v_mul_f32 v64, v64, v251
    v_mul_f32 v65, v65, v251
    v_cvt_pk_bf16_f32 v232, v64, v65
    v_sub_f32 v66, v66, v250
    v_sub_f32 v67, v67, v250
    v_cvt_pk_bf16_f32 v233, v66, v67
    v_lshlrev_b32 v66, 16, v233
    v_and_b32 v67, 0xffff0000, v233
    v_mul_f32 v66, v66, v251
    v_mul_f32 v67, v67, v251
    v_cvt_pk_bf16_f32 v233, v66, v67
    v_sub_f32 v68, v68, v250
    v_sub_f32 v69, v69, v250
    v_cvt_pk_bf16_f32 v234, v68, v69
    v_lshlrev_b32 v68, 16, v234
    v_and_b32 v69, 0xffff0000, v234
    v_mul_f32 v68, v68, v251
    v_mul_f32 v69, v69, v251
    v_cvt_pk_bf16_f32 v234, v68, v69
    v_sub_f32 v70, v70, v250
    v_sub_f32 v71, v71, v250
    v_cvt_pk_bf16_f32 v235, v70, v71
    v_lshlrev_b32 v70, 16, v235
    v_and_b32 v71, 0xffff0000, v235
    v_mul_f32 v70, v70, v251
    v_mul_f32 v71, v71, v251
    v_cvt_pk_bf16_f32 v235, v70, v71
    v_cndmask_b32 v124, v232, v234, s[80:81]
    v_cndmask_b32 v125, v233, v235, s[80:81]
    v_cndmask_b32 v126, v234, v232, s[80:81]
    v_cndmask_b32 v127, v235, v233, s[80:81]
    buffer_store_dwordx4 v[124:127], v1, s[4:7], s75 offen offset:1024 sc1
    v_sub_f32 v72, v72, v250
    v_sub_f32 v73, v73, v250
    v_cvt_pk_bf16_f32 v236, v72, v73
    v_lshlrev_b32 v72, 16, v236
    v_and_b32 v73, 0xffff0000, v236
    v_mul_f32 v72, v72, v251
    v_mul_f32 v73, v73, v251
    v_cvt_pk_bf16_f32 v236, v72, v73
    v_sub_f32 v74, v74, v250
    v_sub_f32 v75, v75, v250
    v_cvt_pk_bf16_f32 v237, v74, v75
    v_lshlrev_b32 v74, 16, v237
    v_and_b32 v75, 0xffff0000, v237
    v_mul_f32 v74, v74, v251
    v_mul_f32 v75, v75, v251
    v_cvt_pk_bf16_f32 v237, v74, v75
    v_sub_f32 v76, v76, v250
    v_sub_f32 v77, v77, v250
    v_cvt_pk_bf16_f32 v238, v76, v77
    v_lshlrev_b32 v76, 16, v238
    v_and_b32 v77, 0xffff0000, v238
    v_mul_f32 v76, v76, v251
    v_mul_f32 v77, v77, v251
    v_cvt_pk_bf16_f32 v238, v76, v77
    v_sub_f32 v78, v78, v250
    v_sub_f32 v79, v79, v250
    v_cvt_pk_bf16_f32 v239, v78, v79
    v_lshlrev_b32 v78, 16, v239
    v_and_b32 v79, 0xffff0000, v239
    v_mul_f32 v78, v78, v251
    v_mul_f32 v79, v79, v251
    v_cvt_pk_bf16_f32 v239, v78, v79
    v_cndmask_b32 v128, v236, v238, s[80:81]
    v_cndmask_b32 v129, v237, v239, s[80:81]
    v_cndmask_b32 v130, v238, v236, s[80:81]
    v_cndmask_b32 v131, v239, v237, s[80:81]
    buffer_store_dwordx4 v[128:131], v1, s[4:7], s75 offen offset:2048 sc1
    v_sub_f32 v80, v80, v250
    v_sub_f32 v81, v81, v250
    v_cvt_pk_bf16_f32 v240, v80, v81
    v_lshlrev_b32 v80, 16, v240
    v_and_b32 v81, 0xffff0000, v240
    v_mul_f32 v80, v80, v251
    v_mul_f32 v81, v81, v251
    v_cvt_pk_bf16_f32 v240, v80, v81
    v_sub_f32 v82, v82, v250
    v_sub_f32 v83, v83, v250
    v_cvt_pk_bf16_f32 v241, v82, v83
    v_lshlrev_b32 v82, 16, v241
    v_and_b32 v83, 0xffff0000, v241
    v_mul_f32 v82, v82, v251
    v_mul_f32 v83, v83, v251
    v_cvt_pk_bf16_f32 v241, v82, v83
    v_sub_f32 v84, v84, v250
    v_sub_f32 v85, v85, v250
    v_cvt_pk_bf16_f32 v242, v84, v85
    v_lshlrev_b32 v84, 16, v242
    v_and_b32 v85, 0xffff0000, v242
    v_mul_f32 v84, v84, v251
    v_mul_f32 v85, v85, v251
    v_cvt_pk_bf16_f32 v242, v84, v85
    v_sub_f32 v86, v86, v250
    v_sub_f32 v87, v87, v250
    v_cvt_pk_bf16_f32 v243, v86, v87
    v_lshlrev_b32 v86, 16, v243
    v_and_b32 v87, 0xffff0000, v243
    v_mul_f32 v86, v86, v251
    v_mul_f32 v87, v87, v251
    v_cvt_pk_bf16_f32 v243, v86, v87
    v_cndmask_b32 v132, v240, v242, s[80:81]
    v_cndmask_b32 v133, v241, v243, s[80:81]
    v_cndmask_b32 v134, v242, v240, s[80:81]
    v_cndmask_b32 v135, v243, v241, s[80:81]
    buffer_store_dwordx4 v[132:135], v1, s[4:7], s75 offen offset:3072 sc1
    s_cmp_lg_u32 s98, 1
    s_cbranch_scc1 ln_now
    s_mov_b32 s98, 2
    s_branch w_adopt2
ln_now:
    v_mov_b32 v18, 1
    s_waitcnt vmcnt(0)
    s_barrier
    s_cmp_lg_u32 s3, 0
    s_cbranch_scc1 ln_sig
    s_mov_b64 exec, 1
    s_cmp_ge_u32 s71, 32
    s_cbranch_scc1 ln_sb
    buffer_atomic_add v18, off, s[64:67], 0 offset:192 sc1
ln_sb:
    buffer_atomic_add v18, off, s[64:67], 0 offset:0 sc1
    s_mov_b64 exec, -1
ln_sig:
    s_cmp_lt_u32 s63, 120
    s_cbranch_scc1 prb_done
    s_cmp_lg_u32 s3, 0
    s_cbranch_scc1 prb_bar
    s_sub_u32 s82, s63, 120
    s_lshl_b32 s83, s82, 7
    s_add_u32 s83, s83, 218112000
    s_lshl_b32 s84, s82, 10
    s_add_u32 s84, s84, 209715200
    s_mov_b32 s80, -1
    s_mov_b32 s81, -1
    s_mov_b64 exec, 1
    s_memtime s[74:75]
    s_add_u32 s87, s84, 0
    s_waitcnt lgkmcnt(0)
    buffer_load_dword v20, off, s[4:7], s87 sc1
    s_waitcnt vmcnt(0)
    s_memtime s[76:77]
    s_waitcnt lgkmcnt(0)
    s_sub_u32 s87, s76, s74
    s_min_u32 s80, s80, s87
    s_memtime s[74:75]
    s_add_u32 s87, s84, 8192
    s_waitcnt lgkmcnt(0)
    buffer_load_dword v20, off, s[4:7], s87 sc1
    s_waitcnt vmcnt(0)
    s_memtime s[76:77]
    s_waitcnt lgkmcnt(0)
    s_sub_u32 s87, s76, s74
    s_min_u32 s81, s81, s87
    s_memtime s[74:75]
    s_add_u32 s87, s84, 16384
    s_waitcnt lgkmcnt(0)
    buffer_load_dword v20, off, s[4:7], s87 sc1
    s_waitcnt vmcnt(0)
    s_memtime s[76:77]
    s_waitcnt lgkmcnt(0)
    s_sub_u32 s87, s76, s74
    s_min_u32 s80, s80, s87
    s_memtime s[74:75]
    s_add_u32 s87, s84, 24576
    s_waitcnt lgkmcnt(0)
    buffer_load_dword v20, off, s[4:7], s87 sc1
    s_waitcnt vmcnt(0)
    s_memtime s[76:77]
    s_waitcnt lgkmcnt(0)
    s_sub_u32 s87, s76, s74
    s_min_u32 s81, s81, s87
    s_memtime s[74:75]
    s_add_u32 s87, s84, 32768
    s_waitcnt lgkmcnt(0)
    buffer_load_dword v20, off, s[4:7], s87 sc1
    s_waitcnt vmcnt(0)
    s_memtime s[76:77]
    s_waitcnt lgkmcnt(0)
    s_sub_u32 s87, s76, s74
    s_min_u32 s80, s80, s87
    s_memtime s[74:75]
    s_add_u32 s87, s84, 40960
    s_waitcnt lgkmcnt(0)
    buffer_load_dword v20, off, s[4:7], s87 sc1
    s_waitcnt vmcnt(0)
    s_memtime s[76:77]
    s_waitcnt lgkmcnt(0)
    s_sub_u32 s87, s76, s74
    s_min_u32 s81, s81, s87
    s_memtime s[74:75]
    s_add_u32 s87, s84, 49152
    s_waitcnt lgkmcnt(0)
    buffer_load_dword v20, off, s[4:7], s87 sc1
    s_waitcnt vmcnt(0)
    s_memtime s[76:77]
    s_waitcnt lgkmcnt(0)
    s_sub_u32 s87, s76, s74
    s_min_u32 s80, s80, s87
    s_memtime s[74:75]
    s_add_u32 s87, s84, 57344
    s_waitcnt lgkmcnt(0)
    buffer_load_dword v20, off, s[4:7], s87 sc1
    s_waitcnt vmcnt(0)
    s_memtime s[76:77]
    s_waitcnt lgkmcnt(0)
    s_sub_u32 s87, s76, s74
    s_min_u32 s81, s81, s87
    s_memtime s[74:75]
    s_add_u32 s87, s84, 65536
    s_waitcnt lgkmcnt(0)
    buffer_load_dword v20, off, s[4:7], s87 sc1
    s_waitcnt vmcnt(0)
    s_memtime s[76:77]
    s_waitcnt lgkmcnt(0)
    s_sub_u32 s87, s76, s74
    s_min_u32 s80, s80, s87
    s_memtime s[74:75]
    s_add_u32 s87, s84, 73728
    s_waitcnt lgkmcnt(0)
    buffer_load_dword v20, off, s[4:7], s87 sc1
    s_waitcnt vmcnt(0)
    s_memtime s[76:77]
    s_waitcnt lgkmcnt(0)
    s_sub_u32 s87, s76, s74
    s_min_u32 s81, s81, s87
    s_memtime s[74:75]
    s_add_u32 s87, s84, 81920
    s_waitcnt lgkmcnt(0)
    buffer_load_dword v20, off, s[4:7], s87 sc1
    s_waitcnt vmcnt(0)
    s_memtime s[76:77]
    s_waitcnt lgkmcnt(0)
    s_sub_u32 s87, s76, s74
    s_min_u32 s80, s80, s87
    s_memtime s[74:75]
    s_add_u32 s87, s84, 90112
    s_waitcnt lgkmcnt(0)
    buffer_load_dword v20, off, s[4:7], s87 sc1
    s_waitcnt vmcnt(0)
    s_memtime s[76:77]
    s_waitcnt lgkmcnt(0)
    s_sub_u32 s87, s76, s74
    s_min_u32 s81, s81, s87
    s_sub_i32 s85, s80, s81
    s_min_i32 s85, s85, 400
    s_max_i32 s85, s85, -400
    s_lshl_b32 s85, s85, 8
    s_getreg_b32 s86, hwreg(HW_REG_XCC_ID)
    s_bfe_u32 s86, s86, 0x10002
    s_lshl_b32 s86, s86, 1
    s_or_b32 s85, s85, s86
    s_or_b32 s85, s85, 1
    s_mov_b32 s86, 65536
prb_i:
    buffer_load_dword v20, off, s[64:67], 0 offset:192 sc1
    s_waitcnt vmcnt(0)
    v_readfirstlane_b32 s84, v20
    s_cmp_ge_u32 s84, 32
    s_cbranch_scc1 prb_i_ok
    s_sleep 8
    s_sub_u32 s86, s86, 1
    s_cbranch_scc0 prb_i
prb_i_ok:
    v_mov_b32 v20, s85
    buffer_store_dword v20, off, s[4:7], s83 offset:8 sc1
    s_mov_b64 exec, -1
prb_bar:
    s_barrier
prb_done:
    s_cmp_lt_u32 s32, 4
    s_cbranch_scc1 w_nopre
    s_load_dwordx2 s[8:9], s[0:1], s33
    s_load_dwordx2 s[12:13], s[0:1], s34
    s_mov_b32 s10, s38
    s_mov_b32 s14, s38
    s_cmp_ge_u32 s32, 4
    s_cselect_b32 s31, 0, 1
    s_lshl_b32 s30, s3, s31
    s_mul_i32 s30, s30, s40
    s_add_u32 s16, s39, s30
    s_cmp_eq_u32 s32, 4
    s_cselect_b32 s30, 1024, s40
    s_cselect_b32 s31, 6, 5
    s_lshl_b32 s62, 32, s31
    s_add_u32 s17, s16, s30
    s_lshl_b32 s30, s3, 2
    s_mul_i32 s30, s30, s35
    s_add_u32 s18, s36, s30
    s_add_u32 s19, s37, s30
    s_lshl_b32 s20, s35, s31
    v_mul_u32_u24 v2, s35, v4
    v_add_u32 v2, v2, v3
    s_waitcnt lgkmcnt(0)
    s_add_u32 m0, s22, 0
    s_nop 0
    buffer_load_dwordx4 v2, s[8:11], s18 offen lds
    s_add_u32 s18, s18, s20
    s_add_u32 m0, s22, 8192
    s_nop 0
    buffer_load_dwordx4 v2, s[12:15], s19 offen lds
    s_add_u32 s19, s19, s20
    s_add_u32 m0, s22, 32768
    s_nop 0
    buffer_load_dwordx4 v2, s[8:11], s18 offen lds
    s_add_u32 s18, s18, s20
    s_add_u32 m0, s22, 40960
    s_nop 0
    buffer_load_dwordx4 v2, s[12:15], s19 offen lds
    s_add_u32 s19, s19, s20
    s_add_u32 m0, s22, 65536
    s_nop 0
    buffer_load_dwordx4 v2, s[8:11], s18 offen lds
    s_add_u32 s18, s18, s20
    s_add_u32 m0, s22, 73728
    s_nop 0
    buffer_load_dwordx4 v2, s[12:15], s19 offen lds
    s_add_u32 s19, s19, s20
    s_add_u32 m0, s22, 98304
    s_nop 0
    buffer_load_dwordx4 v2, s[8:11], s18 offen lds
    s_add_u32 s18, s18, s20
    s_add_u32 m0, s22, 106496
    s_nop 0
    buffer_load_dwordx4 v2, s[12:15], s19 offen lds
    s_add_u32 s19, s19, s20
    s_mov_b32 s70, 1
    s_cmp_lt_u32 s39, 1048576
    s_cselect_b32 s70, s70, 0
    s_cmp_lg_u32 s3, 0
    s_cbranch_scc1 lnwp_ok
    s_cmp_eq_u32 s70, 0
    s_cbranch_scc1 lnwp_full
    s_mov_b32 s69, 65536
lnwap:
    buffer_load_dword v20, off, s[64:67], 0 offset:192 sc1
    s_waitcnt vmcnt(0)
    v_readfirstlane_b32 s68, v20
    s_cmp_ge_u32 s68, 32
    s_cbranch_scc1 lnwap_ok
    s_sleep 8
    s_sub_u32 s69, s69, 1
    s_cbranch_scc0 lnwap
lnwap_ok:
    s_branch lnwp_ok
lnwp_full:
    s_mov_b32 s69, 65536
lnwp:
    buffer_load_dword v20, off, s[64:67], 0 offset:0 sc1
    s_waitcnt vmcnt(0)
    v_readfirstlane_b32 s68, v20
    s_cmp_ge_u32 s68, 128
    s_cbranch_scc1 lnwp_ok
    s_sleep 8
    s_sub_u32 s69, s69, 1
    s_cbranch_scc0 lnwp
lnwp_ok:
    s_barrier
    s_add_u32 m0, s21, 0
    s_nop 0
    buffer_load_dwordx4 v1, s[4:7], s16 offen sc1 lds
    s_add_u32 s16, s16, s62
    s_add_u32 m0, s21, 1024
    s_nop 0
    buffer_load_dwordx4 v1, s[4:7], s17 offen sc1 lds
    s_add_u32 s17, s17, s62
    s_add_u32 m0, s21, 32768
    s_nop 0
    buffer_load_dwordx4 v1, s[4:7], s16 offen sc1 lds
    s_add_u32 s16, s16, s62
    s_add_u32 m0, s21, 33792
    s_nop 0
    buffer_load_dwordx4 v1, s[4:7], s17 offen sc1 lds
    s_add_u32 s17, s17, s62
    s_add_u32 m0, s21, 65536
    s_nop 0
    buffer_load_dwordx4 v1, s[4:7], s16 offen sc1 lds
    s_add_u32 s16, s16, s62
    s_add_u32 m0, s21, 66560
    s_nop 0
    buffer_load_dwordx4 v1, s[4:7], s17 offen sc1 lds
    s_add_u32 s17, s17, s62
    s_add_u32 m0, s21, 98304
    s_nop 0
    buffer_load_dwordx4 v1, s[4:7], s16 offen sc1 lds
    s_add_u32 s16, s16, s62
    s_add_u32 m0, s21, 99328
    s_nop 0
    buffer_load_dwordx4 v1, s[4:7], s17 offen sc1 lds
    s_add_u32 s17, s17, s62
    s_branch w_adopt
w_nopre:
    s_mov_b32 s70, 1
    s_cmp_lt_u32 s39, 1048576
    s_cselect_b32 s70, s70, 0
    s_cmp_lg_u32 s3, 0
    s_cbranch_scc1 lnw_ok
    s_cmp_eq_u32 s70, 0
    s_cbranch_scc1 lnw_full
    s_mov_b32 s69, 65536
lnwa:
    buffer_load_dword v20, off, s[64:67], 0 offset:192 sc1
    s_waitcnt vmcnt(0)
    v_readfirstlane_b32 s68, v20
    s_cmp_ge_u32 s68, 32
    s_cbranch_scc1 lnwa_ok
    s_sleep 8
    s_sub_u32 s69, s69, 1
    s_cbranch_scc0 lnwa
lnwa_ok:
    s_branch lnw_ok
lnw_full:
    s_mov_b32 s69, 65536
lnw:
    buffer_load_dword v20, off, s[64:67], 0 offset:0 sc1
    s_waitcnt vmcnt(0)
    v_readfirstlane_b32 s68, v20
    s_cmp_ge_u32 s68, 128
    s_cbranch_scc1 lnw_ok
    s_sleep 8
    s_sub_u32 s69, s69, 1
    s_cbranch_scc0 lnw
lnw_ok:
    s_barrier
w_cold:
    s_cmp_eq_u32 s32, 0
    s_cbranch_scc1 fin_entry
    s_cmp_lg_u32 s3, 0
    s_cbranch_scc1 w_depok
    s_cmp_eq_u32 s45, 0
    s_cbranch_scc1 w_depok
    s_mov_b32 s31, 0x40000
w_waitdep:
    buffer_load_dword v16, v17, s[4:7], s44 offen sc1
    s_waitcnt vmcnt(0)
    v_readfirstlane_b32 s30, v16
    s_cmp_ge_u32 s30, s45
    s_cbranch_scc1 w_depok
    s_sleep 16
    s_sub_u32 s31, s31, 1
    s_cbranch_scc0 w_waitdep
w_depok:
    s_load_dwordx2 s[8:9], s[0:1], s33
    s_load_dwordx2 s[12:13], s[0:1], s34
    s_mov_b32 s10, s38
    s_mov_b32 s14, s38
    s_cmp_ge_u32 s32, 4
    s_cselect_b32 s31, 0, 1
    s_lshl_b32 s30, s3, s31
    s_mul_i32 s30, s30, s40
    s_add_u32 s16, s39, s30
    s_cmp_eq_u32 s32, 4
    s_cselect_b32 s30, 1024, s40
    s_cselect_b32 s31, 6, 5
    s_lshl_b32 s62, 32, s31
    s_add_u32 s17, s16, s30
    s_lshl_b32 s30, s3, 2
    s_mul_i32 s30, s30, s35
    s_add_u32 s18, s36, s30
    s_add_u32 s19, s37, s30
    s_lshl_b32 s20, s35, s31
    v_mul_u32_u24 v2, s35, v4
    v_add_u32 v2, v2, v3
    s_waitcnt lgkmcnt(0)
    s_barrier
    s_add_u32 m0, s21, 0
    s_nop 0
    buffer_load_dwordx4 v1, s[4:7], s16 offen sc1 lds
    s_add_u32 s16, s16, s62
    s_add_u32 m0, s21, 1024
    s_nop 0
    buffer_load_dwordx4 v1, s[4:7], s17 offen sc1 lds
    s_add_u32 s17, s17, s62
    s_add_u32 m0, s22, 0
    s_nop 0
    buffer_load_dwordx4 v2, s[8:11], s18 offen lds
    s_add_u32 s18, s18, s20
    s_add_u32 m0, s22, 8192
    s_nop 0
    buffer_load_dwordx4 v2, s[12:15], s19 offen lds
    s_add_u32 s19, s19, s20
    s_add_u32 m0, s21, 32768
    s_nop 0
    buffer_load_dwordx4 v1, s[4:7], s16 offen sc1 lds
    s_add_u32 s16, s16, s62
    s_add_u32 m0, s21, 33792
    s_nop 0
    buffer_load_dwordx4 v1, s[4:7], s17 offen sc1 lds
    s_add_u32 s17, s17, s62
    s_add_u32 m0, s22, 32768
    s_nop 0
    buffer_load_dwordx4 v2, s[8:11], s18 offen lds
    s_add_u32 s18, s18, s20
    s_add_u32 m0, s22, 40960
    s_nop 0
    buffer_load_dwordx4 v2, s[12:15], s19 offen lds
    s_add_u32 s19, s19, s20
    s_add_u32 m0, s21, 65536
    s_nop 0
    buffer_load_dwordx4 v1, s[4:7], s16 offen sc1 lds
    s_add_u32 s16, s16, s62
    s_add_u32 m0, s21, 66560
    s_nop 0
    buffer_load_dwordx4 v1, s[4:7], s17 offen sc1 lds
    s_add_u32 s17, s17, s62
    s_add_u32 m0, s22, 65536
    s_nop 0
    buffer_load_dwordx4 v2, s[8:11], s18 offen lds
    s_add_u32 s18, s18, s20
    s_add_u32 m0, s22, 73728
    s_nop 0
    buffer_load_dwordx4 v2, s[12:15], s19 offen lds
    s_add_u32 s19, s19, s20
    s_add_u32 m0, s21, 98304
    s_nop 0
    buffer_load_dwordx4 v1, s[4:7], s16 offen sc1 lds
    s_add_u32 s16, s16, s62
    s_add_u32 m0, s21, 99328
    s_nop 0
    buffer_load_dwordx4 v1, s[4:7], s17 offen sc1 lds
    s_add_u32 s17, s17, s62
    s_add_u32 m0, s22, 98304
    s_nop 0
    buffer_load_dwordx4 v2, s[8:11], s18 offen lds
    s_add_u32 s18, s18, s20
    s_add_u32 m0, s22, 106496
    s_nop 0
    buffer_load_dwordx4 v2, s[12:15], s19 offen lds
    s_add_u32 s19, s19, s20
w_adopt:
    s_cmp_eq_u32 s98, 1
    s_cbranch_scc1 ln_entry
w_adopt2:
    s_mov_b32 s48, s32
    s_cmp_ge_u32 s32, 4
    s_cselect_b32 s30, 2, 3
    s_lshl_b32 s30, s26, s30
    s_mul_i32 s30, s30, s43
    s_add_u32 s49, s42, s30
    s_mov_b32 s50, s43
    s_mov_b32 s51, s46
    s_mov_b32 s23, s41
    s_mov_b32 s53, s47
    s_nop 0
    s_load_dwordx16 s[32:47], s[24:25], 0
    s_add_u32 s24, s24, 64
    s_addc_u32 s25, s25, 0
    s_cmp_eq_u32 s48, 6
    s_cbranch_scc1 w_firstX
    s_waitcnt vmcnt(0)
    s_barrier
    s_cmp_lg_u32 s98, 2
    s_cbranch_scc1 lls_done
    s_mov_b32 s98, 0
    s_cmp_lg_u32 s3, 0
    s_cbranch_scc1 lls_done
    v_mov_b32 v20, 1
    s_mov_b64 exec, 1
    buffer_atomic_add v20, off, s[64:67], 0 offset:0 sc1
    s_mov_b64 exec, -1
lls_done:
    ds_read_b64_tr_b16 v[64:65], v8 offset:16384
    ds_read_b64_tr_b16 v[66:67], v9 offset:16384
    ds_read_b64_tr_b16 v[68:69], v10 offset:16384
    ds_read_b64_tr_b16 v[70:71], v11 offset:16384
    ds_read_b64_tr_b16 v[72:73], v8 offset:24576
    ds_read_b64_tr_b16 v[74:75], v9 offset:24576
    ds_read_b64_tr_b16 v[76:77], v10 offset:24576
    ds_read_b64_tr_b16 v[78:79], v11 offset:24576
    ds_read_b128 v[32:35], v5 offset:0
    ds_read_b128 v[36:39], v5 offset:1024
    ds_read_b128 v[40:43], v5 offset:2048
    ds_read_b128 v[44:47], v5 offset:3072
    ds_read_b128 v[48:51], v5 offset:4096
    ds_read_b128 v[52:55], v5 offset:5120
    ds_read_b128 v[56:59], v5 offset:6144
    ds_read_b128 v[60:63], v5 offset:7168
    s_waitcnt lgkmcnt(0)
    s_cmp_eq_u32 s48, 4
    s_cbranch_scc1 w_firstH
    s_cmp_eq_u32 s48, 5
    s_cbranch_scc1 w_firstM
    s_branch w_first16
w_first4:
    s_waitcnt vmcnt(12)
    s_barrier
    v_mfma_f32_16x16x32_bf16 v[128:131], v[64:67], v[32:35], 0
    ds_read_b64_tr_b16 v[112:113], v8 offset:49152
    v_mfma_f32_16x16x32_bf16 v[132:135], v[68:71], v[32:35], 0
    ds_read_b64_tr_b16 v[114:115], v9 offset:49152
    v_mfma_f32_16x16x32_bf16 v[136:139], v[72:75], v[32:35], 0
    ds_read_b64_tr_b16 v[116:117], v10 offset:49152
    v_mfma_f32_16x16x32_bf16 v[140:143], v[76:79], v[32:35], 0
    ds_read_b64_tr_b16 v[118:119], v11 offset:49152
    v_mfma_f32_16x16x32_bf16 v[144:147], v[64:67], v[36:39], 0
    ds_read_b64_tr_b16 v[120:121], v8 offset:57344
    v_mfma_f32_16x16x32_bf16 v[148:151], v[68:71], v[36:39], 0
    ds_read_b64_tr_b16 v[122:123], v9 offset:57344
    v_mfma_f32_16x16x32_bf16 v[152:155], v[72:75], v[36:39], 0
    ds_read_b64_tr_b16 v[124:125], v10 offset:57344
    v_mfma_f32_16x16x32_bf16 v[156:159], v[76:79], v[36:39], 0
    ds_read_b64_tr_b16 v[126:127], v11 offset:57344
    v_mfma_f32_16x16x32_bf16 v[160:163], v[64:67], v[40:43], 0
    ds_read_b128 v[80:83], v5 offset:32768
    v_mfma_f32_16x16x32_bf16 v[164:167], v[68:71], v[40:43], 0
    ds_read_b128 v[84:87], v5 offset:33792
    v_mfma_f32_16x16x32_bf16 v[168:171], v[72:75], v[40:43], 0
    ds_read_b128 v[88:91], v5 offset:34816
    v_mfma_f32_16x16x32_bf16 v[172:175], v[76:79], v[40:43], 0
    ds_read_b128 v[92:95], v5 offset:35840
    v_mfma_f32_16x16x32_bf16 v[176:179], v[64:67], v[44:47], 0
    ds_read_b128 v[96:99], v5 offset:36864
    v_mfma_f32_16x16x32_bf16 v[180:183], v[68:71], v[44:47], 0
    ds_read_b128 v[100:103], v5 offset:37888
    v_mfma_f32_16x16x32_bf16 v[184:187], v[72:75], v[44:47], 0
    ds_read_b128 v[104:107], v5 offset:38912
    v_mfma_f32_16x16x32_bf16 v[188:191], v[76:79], v[44:47], 0
    ds_read_b128 v[108:111], v5 offset:39936
    v_mfma_f32_16x16x32_bf16 v[192:195], v[64:67], v[48:51], 0
    v_mfma_f32_16x16x32_bf16 v[196:199], v[68:71], v[48:51], 0
    s_add_u32 m0, s21, 0
    s_nop 0
    buffer_load_dwordx4 v1, s[4:7], s16 offen sc1 lds
    s_add_u32 s16, s16, s62
    v_mfma_f32_16x16x32_bf16 v[200:203], v[72:75], v[48:51], 0
    v_mfma_f32_16x16x32_bf16 v[204:207], v[76:79], v[48:51], 0
    v_mfma_f32_16x16x32_bf16 v[208:211], v[64:67], v[52:55], 0
    s_add_u32 m0, s21, 1024
    s_nop 0
    buffer_load_dwordx4 v1, s[4:7], s17 offen sc1 lds
    s_add_u32 s17, s17, s62
    v_mfma_f32_16x16x32_bf16 v[212:215], v[68:71], v[52:55], 0
    v_mfma_f32_16x16x32_bf16 v[216:219], v[72:75], v[52:55], 0
    v_mfma_f32_16x16x32_bf16 v[220:223], v[76:79], v[52:55], 0
    s_add_u32 m0, s22, 0
    s_nop 0
    buffer_load_dwordx4 v2, s[8:11], s18 offen lds
    s_add_u32 s18, s18, s20
    v_mfma_f32_16x16x32_bf16 v[224:227], v[64:67], v[56:59], 0
    v_mfma_f32_16x16x32_bf16 v[228:231], v[68:71], v[56:59], 0
    v_mfma_f32_16x16x32_bf16 v[232:235], v[72:75], v[56:59], 0
    s_add_u32 m0, s22, 8192
    s_nop 0
    buffer_load_dwordx4 v2, s[12:15], s19 offen lds
    s_add_u32 s19, s19, s20
    v_mfma_f32_16x16x32_bf16 v[236:239], v[76:79], v[56:59], 0
    v_mfma_f32_16x16x32_bf16 v[240:243], v[64:67], v[60:63], 0
    v_mfma_f32_16x16x32_bf16 v[244:247], v[68:71], v[60:63], 0
    v_mfma_f32_16x16x32_bf16 v[248:251], v[72:75], v[60:63], 0
    v_mfma_f32_16x16x32_bf16 v[252:255], v[76:79], v[60:63], 0
    s_waitcnt lgkmcnt(0)
    s_waitcnt vmcnt(12)
    s_barrier
    v_mfma_f32_16x16x32_bf16 v[128:131], v[112:115], v[80:83], v[128:131]
    ds_read_b64_tr_b16 v[64:65], v12 offset:16384
    v_mfma_f32_16x16x32_bf16 v[132:135], v[116:119], v[80:83], v[132:135]
    ds_read_b64_tr_b16 v[66:67], v13 offset:16384
    v_mfma_f32_16x16x32_bf16 v[136:139], v[120:123], v[80:83], v[136:139]
    ds_read_b64_tr_b16 v[68:69], v14 offset:16384
    v_mfma_f32_16x16x32_bf16 v[140:143], v[124:127], v[80:83], v[140:143]
    ds_read_b64_tr_b16 v[70:71], v15 offset:16384
    v_mfma_f32_16x16x32_bf16 v[144:147], v[112:115], v[84:87], v[144:147]
    ds_read_b64_tr_b16 v[72:73], v12 offset:24576
    v_mfma_f32_16x16x32_bf16 v[148:151], v[116:119], v[84:87], v[148:151]
    ds_read_b64_tr_b16 v[74:75], v13 offset:24576
    v_mfma_f32_16x16x32_bf16 v[152:155], v[120:123], v[84:87], v[152:155]
    ds_read_b64_tr_b16 v[76:77], v14 offset:24576
    v_mfma_f32_16x16x32_bf16 v[156:159], v[124:127], v[84:87], v[156:159]
    ds_read_b64_tr_b16 v[78:79], v15 offset:24576
    v_mfma_f32_16x16x32_bf16 v[160:163], v[112:115], v[88:91], v[160:163]
    ds_read_b128 v[32:35], v6 offset:0
    v_mfma_f32_16x16x32_bf16 v[164:167], v[116:119], v[88:91], v[164:167]
    ds_read_b128 v[36:39], v6 offset:1024
    v_mfma_f32_16x16x32_bf16 v[168:171], v[120:123], v[88:91], v[168:171]
    ds_read_b128 v[40:43], v6 offset:2048
    v_mfma_f32_16x16x32_bf16 v[172:175], v[124:127], v[88:91], v[172:175]
    ds_read_b128 v[44:47], v6 offset:3072
    v_mfma_f32_16x16x32_bf16 v[176:179], v[112:115], v[92:95], v[176:179]
    ds_read_b128 v[48:51], v6 offset:4096
    v_mfma_f32_16x16x32_bf16 v[180:183], v[116:119], v[92:95], v[180:183]
    ds_read_b128 v[52:55], v6 offset:5120
    v_mfma_f32_16x16x32_bf16 v[184:187], v[120:123], v[92:95], v[184:187]
    ds_read_b128 v[56:59], v6 offset:6144
    v_mfma_f32_16x16x32_bf16 v[188:191], v[124:127], v[92:95], v[188:191]
    ds_read_b128 v[60:63], v6 offset:7168
    v_mfma_f32_16x16x32_bf16 v[192:195], v[112:115], v[96:99], v[192:195]
    v_mfma_f32_16x16x32_bf16 v[196:199], v[116:119], v[96:99], v[196:199]
    s_add_u32 m0, s21, 32768
    s_nop 0
    buffer_load_dwordx4 v1, s[4:7], s16 offen sc1 lds
    s_add_u32 s16, s16, s62
    v_mfma_f32_16x16x32_bf16 v[200:203], v[120:123], v[96:99], v[200:203]
    v_mfma_f32_16x16x32_bf16 v[204:207], v[124:127], v[96:99], v[204:207]
    v_mfma_f32_16x16x32_bf16 v[208:211], v[112:115], v[100:103], v[208:211]
    s_add_u32 m0, s21, 33792
    s_nop 0
    buffer_load_dwordx4 v1, s[4:7], s17 offen sc1 lds
    s_add_u32 s17, s17, s62
    v_mfma_f32_16x16x32_bf16 v[212:215], v[116:119], v[100:103], v[212:215]
    v_mfma_f32_16x16x32_bf16 v[216:219], v[120:123], v[100:103], v[216:219]
    v_mfma_f32_16x16x32_bf16 v[220:223], v[124:127], v[100:103], v[220:223]
    s_add_u32 m0, s22, 32768
    s_nop 0
    buffer_load_dwordx4 v2, s[8:11], s18 offen lds
    s_add_u32 s18, s18, s20
    v_mfma_f32_16x16x32_bf16 v[224:227], v[112:115], v[104:107], v[224:227]
    v_mfma_f32_16x16x32_bf16 v[228:231], v[116:119], v[104:107], v[228:231]
    v_mfma_f32_16x16x32_bf16 v[232:235], v[120:123], v[104:107], v[232:235]
    s_add_u32 m0, s22, 40960
    s_nop 0
    buffer_load_dwordx4 v2, s[12:15], s19 offen lds
    s_add_u32 s19, s19, s20
    v_mfma_f32_16x16x32_bf16 v[236:239], v[124:127], v[104:107], v[236:239]
    v_mfma_f32_16x16x32_bf16 v[240:243], v[112:115], v[108:111], v[240:243]
    v_mfma_f32_16x16x32_bf16 v[244:247], v[116:119], v[108:111], v[244:247]
    v_mfma_f32_16x16x32_bf16 v[248:251], v[120:123], v[108:111], v[248:251]
    v_mfma_f32_16x16x32_bf16 v[252:255], v[124:127], v[108:111], v[252:255]
    s_waitcnt lgkmcnt(0)
    s_waitcnt vmcnt(12)
    s_barrier
    v_mfma_f32_16x16x32_bf16 v[128:131], v[64:67], v[32:35], v[128:131]
    ds_read_b64_tr_b16 v[112:113], v12 offset:49152
    v_mfma_f32_16x16x32_bf16 v[132:135], v[68:71], v[32:35], v[132:135]
    ds_read_b64_tr_b16 v[114:115], v13 offset:49152
    v_mfma_f32_16x16x32_bf16 v[136:139], v[72:75], v[32:35], v[136:139]
    ds_read_b64_tr_b16 v[116:117], v14 offset:49152
    v_mfma_f32_16x16x32_bf16 v[140:143], v[76:79], v[32:35], v[140:143]
    ds_read_b64_tr_b16 v[118:119], v15 offset:49152
    v_mfma_f32_16x16x32_bf16 v[144:147], v[64:67], v[36:39], v[144:147]
    ds_read_b64_tr_b16 v[120:121], v12 offset:57344
    v_mfma_f32_16x16x32_bf16 v[148:151], v[68:71], v[36:39], v[148:151]
    ds_read_b64_tr_b16 v[122:123], v13 offset:57344
    v_mfma_f32_16x16x32_bf16 v[152:155], v[72:75], v[36:39], v[152:155]
    ds_read_b64_tr_b16 v[124:125], v14 offset:57344
    v_mfma_f32_16x16x32_bf16 v[156:159], v[76:79], v[36:39], v[156:159]
    ds_read_b64_tr_b16 v[126:127], v15 offset:57344
    v_mfma_f32_16x16x32_bf16 v[160:163], v[64:67], v[40:43], v[160:163]
    ds_read_b128 v[80:83], v6 offset:32768
    v_mfma_f32_16x16x32_bf16 v[164:167], v[68:71], v[40:43], v[164:167]
    ds_read_b128 v[84:87], v6 offset:33792
    v_mfma_f32_16x16x32_bf16 v[168:171], v[72:75], v[40:43], v[168:171]
    ds_read_b128 v[88:91], v6 offset:34816
    v_mfma_f32_16x16x32_bf16 v[172:175], v[76:79], v[40:43], v[172:175]
    ds_read_b128 v[92:95], v6 offset:35840
    v_mfma_f32_16x16x32_bf16 v[176:179], v[64:67], v[44:47], v[176:179]
    ds_read_b128 v[96:99], v6 offset:36864
    v_mfma_f32_16x16x32_bf16 v[180:183], v[68:71], v[44:47], v[180:183]
    ds_read_b128 v[100:103], v6 offset:37888
    v_mfma_f32_16x16x32_bf16 v[184:187], v[72:75], v[44:47], v[184:187]
    ds_read_b128 v[104:107], v6 offset:38912
    v_mfma_f32_16x16x32_bf16 v[188:191], v[76:79], v[44:47], v[188:191]
    ds_read_b128 v[108:111], v6 offset:39936
    v_mfma_f32_16x16x32_bf16 v[192:195], v[64:67], v[48:51], v[192:195]
    v_mfma_f32_16x16x32_bf16 v[196:199], v[68:71], v[48:51], v[196:199]
    s_add_u32 m0, s21, 65536
    s_nop 0
    buffer_load_dwordx4 v1, s[4:7], s16 offen sc1 lds
    s_add_u32 s16, s16, s62
    v_mfma_f32_16x16x32_bf16 v[200:203], v[72:75], v[48:51], v[200:203]
    v_mfma_f32_16x16x32_bf16 v[204:207], v[76:79], v[48:51], v[204:207]
    v_mfma_f32_16x16x32_bf16 v[208:211], v[64:67], v[52:55], v[208:211]
    s_add_u32 m0, s21, 66560
    s_nop 0
    buffer_load_dwordx4 v1, s[4:7], s17 offen sc1 lds
    s_add_u32 s17, s17, s62
    v_mfma_f32_16x16x32_bf16 v[212:215], v[68:71], v[52:55], v[212:215]
    v_mfma_f32_16x16x32_bf16 v[216:219], v[72:75], v[52:55], v[216:219]
    v_mfma_f32_16x16x32_bf16 v[220:223], v[76:79], v[52:55], v[220:223]
    s_add_u32 m0, s22, 65536
    s_nop 0
    buffer_load_dwordx4 v2, s[8:11], s18 offen lds
    s_add_u32 s18, s18, s20
    v_mfma_f32_16x16x32_bf16 v[224:227], v[64:67], v[56:59], v[224:227]
    v_mfma_f32_16x16x32_bf16 v[228:231], v[68:71], v[56:59], v[228:231]
    v_mfma_f32_16x16x32_bf16 v[232:235], v[72:75], v[56:59], v[232:235]
    s_add_u32 m0, s22, 73728
    s_nop 0
    buffer_load_dwordx4 v2, s[12:15], s19 offen lds
    s_add_u32 s19, s19, s20
    v_mfma_f32_16x16x32_bf16 v[236:239], v[76:79], v[56:59], v[236:239]
    v_mfma_f32_16x16x32_bf16 v[240:243], v[64:67], v[60:63], v[240:243]
    v_mfma_f32_16x16x32_bf16 v[244:247], v[68:71], v[60:63], v[244:247]
    v_mfma_f32_16x16x32_bf16 v[248:251], v[72:75], v[60:63], v[248:251]
    v_mfma_f32_16x16x32_bf16 v[252:255], v[76:79], v[60:63], v[252:255]
    s_waitcnt lgkmcnt(0)
    s_waitcnt vmcnt(8)
    s_barrier
    s_cmp_eq_u32 s28, 0
    s_cbranch_scc1 sig_2
    s_cmp_lg_u32 s3, 0
    s_cbranch_scc1 sig_2
    s_mov_b64 exec, 1
    v_mov_b32 v18, s57
    buffer_atomic_add v18, v17, s[4:7], s28 offen sc1
    s_mov_b64 exec, -1
sig_2:
    s_mov_b32 s28, 0
    v_mfma_f32_16x16x32_bf16 v[128:131], v[112:115], v[80:83], v[128:131]
    ds_read_b64_tr_b16 v[64:65], v8 offset:16384
    v_mfma_f32_16x16x32_bf16 v[132:135], v[116:119], v[80:83], v[132:135]
    ds_read_b64_tr_b16 v[66:67], v9 offset:16384
    v_mfma_f32_16x16x32_bf16 v[136:139], v[120:123], v[80:83], v[136:139]
    ds_read_b64_tr_b16 v[68:69], v10 offset:16384
    v_mfma_f32_16x16x32_bf16 v[140:143], v[124:127], v[80:83], v[140:143]
    ds_read_b64_tr_b16 v[70:71], v11 offset:16384
    v_mfma_f32_16x16x32_bf16 v[144:147], v[112:115], v[84:87], v[144:147]
    ds_read_b64_tr_b16 v[72:73], v8 offset:24576
    v_mfma_f32_16x16x32_bf16 v[148:151], v[116:119], v[84:87], v[148:151]
    ds_read_b64_tr_b16 v[74:75], v9 offset:24576
    v_mfma_f32_16x16x32_bf16 v[152:155], v[120:123], v[84:87], v[152:155]
    ds_read_b64_tr_b16 v[76:77], v10 offset:24576
    v_mfma_f32_16x16x32_bf16 v[156:159], v[124:127], v[84:87], v[156:159]
    ds_read_b64_tr_b16 v[78:79], v11 offset:24576
    v_mfma_f32_16x16x32_bf16 v[160:163], v[112:115], v[88:91], v[160:163]
    ds_read_b128 v[32:35], v5 offset:0
    v_mfma_f32_16x16x32_bf16 v[164:167], v[116:119], v[88:91], v[164:167]
    ds_read_b128 v[36:39], v5 offset:1024
    v_mfma_f32_16x16x32_bf16 v[168:171], v[120:123], v[88:91], v[168:171]
    ds_read_b128 v[40:43], v5 offset:2048
    v_mfma_f32_16x16x32_bf16 v[172:175], v[124:127], v[88:91], v[172:175]
    ds_read_b128 v[44:47], v5 offset:3072
    v_mfma_f32_16x16x32_bf16 v[176:179], v[112:115], v[92:95], v[176:179]
    ds_read_b128 v[48:51], v5 offset:4096
    v_mfma_f32_16x16x32_bf16 v[180:183], v[116:119], v[92:95], v[180:183]
    ds_read_b128 v[52:55], v5 offset:5120
    v_mfma_f32_16x16x32_bf16 v[184:187], v[120:123], v[92:95], v[184:187]
    ds_read_b128 v[56:59], v5 offset:6144
    v_mfma_f32_16x16x32_bf16 v[188:191], v[124:127], v[92:95], v[188:191]
    ds_read_b128 v[60:63], v5 offset:7168
    v_mfma_f32_16x16x32_bf16 v[192:195], v[112:115], v[96:99], v[192:195]
    v_mfma_f32_16x16x32_bf16 v[196:199], v[116:119], v[96:99], v[196:199]
    s_add_u32 m0, s21, 98304
    s_nop 0
    buffer_load_dwordx4 v1, s[4:7], s16 offen sc1 lds
    s_add_u32 s16, s16, s62
    v_mfma_f32_16x16x32_bf16 v[200:203], v[120:123], v[96:99], v[200:203]
    v_mfma_f32_16x16x32_bf16 v[204:207], v[124:127], v[96:99], v[204:207]
    v_mfma_f32_16x16x32_bf16 v[208:211], v[112:115], v[100:103], v[208:211]
    s_add_u32 m0, s21, 99328
    s_nop 0
    buffer_load_dwordx4 v1, s[4:7], s17 offen sc1 lds
    s_add_u32 s17, s17, s62
    v_mfma_f32_16x16x32_bf16 v[212:215], v[116:119], v[100:103], v[212:215]
    v_mfma_f32_16x16x32_bf16 v[216:219], v[120:123], v[100:103], v[216:219]
    v_mfma_f32_16x16x32_bf16 v[220:223], v[124:127], v[100:103], v[220:223]
    s_add_u32 m0, s22, 98304
    s_nop 0
    buffer_load_dwordx4 v2, s[8:11], s18 offen lds
    s_add_u32 s18, s18, s20
    v_mfma_f32_16x16x32_bf16 v[224:227], v[112:115], v[104:107], v[224:227]
    v_mfma_f32_16x16x32_bf16 v[228:231], v[116:119], v[104:107], v[228:231]
    v_mfma_f32_16x16x32_bf16 v[232:235], v[120:123], v[104:107], v[232:235]
    s_add_u32 m0, s22, 106496
    s_nop 0
    buffer_load_dwordx4 v2, s[12:15], s19 offen lds
    s_add_u32 s19, s19, s20
    v_mfma_f32_16x16x32_bf16 v[236:239], v[124:127], v[104:107], v[236:239]
    v_mfma_f32_16x16x32_bf16 v[240:243], v[112:115], v[108:111], v[240:243]
    v_mfma_f32_16x16x32_bf16 v[244:247], v[116:119], v[108:111], v[244:247]
    v_mfma_f32_16x16x32_bf16 v[248:251], v[120:123], v[108:111], v[248:251]
    v_mfma_f32_16x16x32_bf16 v[252:255], v[124:127], v[108:111], v[252:255]
    s_waitcnt lgkmcnt(0)
    s_branch w_loop_chk
w_first8:
    s_waitcnt vmcnt(16)
    s_barrier
    v_mfma_f32_16x16x32_bf16 v[128:131], v[64:67], v[32:35], 0
    ds_read_b64_tr_b16 v[112:113], v8 offset:49152
    v_mfma_f32_16x16x32_bf16 v[132:135], v[68:71], v[32:35], 0
    ds_read_b64_tr_b16 v[114:115], v9 offset:49152
    v_mfma_f32_16x16x32_bf16 v[136:139], v[72:75], v[32:35], 0
    ds_read_b64_tr_b16 v[116:117], v10 offset:49152
    v_mfma_f32_16x16x32_bf16 v[140:143], v[76:79], v[32:35], 0
    ds_read_b64_tr_b16 v[118:119], v11 offset:49152
    v_mfma_f32_16x16x32_bf16 v[144:147], v[64:67], v[36:39], 0
    ds_read_b64_tr_b16 v[120:121], v8 offset:57344
    v_mfma_f32_16x16x32_bf16 v[148:151], v[68:71], v[36:39], 0
    ds_read_b64_tr_b16 v[122:123], v9 offset:57344
    v_mfma_f32_16x16x32_bf16 v[152:155], v[72:75], v[36:39], 0
    ds_read_b64_tr_b16 v[124:125], v10 offset:57344
    v_mfma_f32_16x16x32_bf16 v[156:159], v[76:79], v[36:39], 0
    ds_read_b64_tr_b16 v[126:127], v11 offset:57344
    v_mfma_f32_16x16x32_bf16 v[160:163], v[64:67], v[40:43], 0
    ds_read_b128 v[80:83], v5 offset:32768
    v_mfma_f32_16x16x32_bf16 v[164:167], v[68:71], v[40:43], 0
    ds_read_b128 v[84:87], v5 offset:33792
    v_mfma_f32_16x16x32_bf16 v[168:171], v[72:75], v[40:43], 0
    ds_read_b128 v[88:91], v5 offset:34816
    v_mfma_f32_16x16x32_bf16 v[172:175], v[76:79], v[40:43], 0
    ds_read_b128 v[92:95], v5 offset:35840
    v_mfma_f32_16x16x32_bf16 v[176:179], v[64:67], v[44:47], 0
    ds_read_b128 v[96:99], v5 offset:36864
    v_mfma_f32_16x16x32_bf16 v[180:183], v[68:71], v[44:47], 0
    ds_read_b128 v[100:103], v5 offset:37888
    v_mfma_f32_16x16x32_bf16 v[184:187], v[72:75], v[44:47], 0
    ds_read_b128 v[104:107], v5 offset:38912
    v_mfma_f32_16x16x32_bf16 v[188:191], v[76:79], v[44:47], 0
    ds_read_b128 v[108:111], v5 offset:39936
    v_mfma_f32_16x16x32_bf16 v[192:195], v[64:67], v[48:51], 0
    v_mfma_f32_16x16x32_bf16 v[196:199], v[68:71], v[48:51], 0
    s_add_u32 m0, s21, 0
    s_nop 0
    buffer_load_dwordx4 v1, s[4:7], s16 offen sc1 lds
    s_add_u32 s16, s16, s62
    v_mfma_f32_16x16x32_bf16 v[200:203], v[72:75], v[48:51], 0
    v_mfma_f32_16x16x32_bf16 v[204:207], v[76:79], v[48:51], 0
    v_mfma_f32_16x16x32_bf16 v[208:211], v[64:67], v[52:55], 0
    s_add_u32 m0, s21, 1024
    s_nop 0
    buffer_load_dwordx4 v1, s[4:7], s17 offen sc1 lds
    s_add_u32 s17, s17, s62
    v_mfma_f32_16x16x32_bf16 v[212:215], v[68:71], v[52:55], 0
    v_mfma_f32_16x16x32_bf16 v[216:219], v[72:75], v[52:55], 0
    v_mfma_f32_16x16x32_bf16 v[220:223], v[76:79], v[52:55], 0
    s_add_u32 m0, s22, 0
    s_nop 0
    buffer_load_dwordx4 v2, s[8:11], s18 offen lds
    s_add_u32 s18, s18, s20
    v_mfma_f32_16x16x32_bf16 v[224:227], v[64:67], v[56:59], 0
    v_mfma_f32_16x16x32_bf16 v[228:231], v[68:71], v[56:59], 0
    v_mfma_f32_16x16x32_bf16 v[232:235], v[72:75], v[56:59], 0
    s_add_u32 m0, s22, 8192
    s_nop 0
    buffer_load_dwordx4 v2, s[12:15], s19 offen lds
    s_add_u32 s19, s19, s20
    v_mfma_f32_16x16x32_bf16 v[236:239], v[76:79], v[56:59], 0
    v_mfma_f32_16x16x32_bf16 v[240:243], v[64:67], v[60:63], 0
    v_mfma_f32_16x16x32_bf16 v[244:247], v[68:71], v[60:63], 0
    v_mfma_f32_16x16x32_bf16 v[248:251], v[72:75], v[60:63], 0
    v_mfma_f32_16x16x32_bf16 v[252:255], v[76:79], v[60:63], 0
    s_waitcnt lgkmcnt(0)
    s_waitcnt vmcnt(16)
    s_barrier
    v_mfma_f32_16x16x32_bf16 v[128:131], v[112:115], v[80:83], v[128:131]
    ds_read_b64_tr_b16 v[64:65], v12 offset:16384
    v_mfma_f32_16x16x32_bf16 v[132:135], v[116:119], v[80:83], v[132:135]
    ds_read_b64_tr_b16 v[66:67], v13 offset:16384
    v_mfma_f32_16x16x32_bf16 v[136:139], v[120:123], v[80:83], v[136:139]
    ds_read_b64_tr_b16 v[68:69], v14 offset:16384
    v_mfma_f32_16x16x32_bf16 v[140:143], v[124:127], v[80:83], v[140:143]
    ds_read_b64_tr_b16 v[70:71], v15 offset:16384
    v_mfma_f32_16x16x32_bf16 v[144:147], v[112:115], v[84:87], v[144:147]
    ds_read_b64_tr_b16 v[72:73], v12 offset:24576
    v_mfma_f32_16x16x32_bf16 v[148:151], v[116:119], v[84:87], v[148:151]
    ds_read_b64_tr_b16 v[74:75], v13 offset:24576
    v_mfma_f32_16x16x32_bf16 v[152:155], v[120:123], v[84:87], v[152:155]
    ds_read_b64_tr_b16 v[76:77], v14 offset:24576
    v_mfma_f32_16x16x32_bf16 v[156:159], v[124:127], v[84:87], v[156:159]
    ds_read_b64_tr_b16 v[78:79], v15 offset:24576
    v_mfma_f32_16x16x32_bf16 v[160:163], v[112:115], v[88:91], v[160:163]
    ds_read_b128 v[32:35], v6 offset:0
    v_mfma_f32_16x16x32_bf16 v[164:167], v[116:119], v[88:91], v[164:167]
    ds_read_b128 v[36:39], v6 offset:1024
    v_mfma_f32_16x16x32_bf16 v[168:171], v[120:123], v[88:91], v[168:171]
    ds_read_b128 v[40:43], v6 offset:2048
    v_mfma_f32_16x16x32_bf16 v[172:175], v[124:127], v[88:91], v[172:175]
    ds_read_b128 v[44:47], v6 offset:3072
    v_mfma_f32_16x16x32_bf16 v[176:179], v[112:115], v[92:95], v[176:179]
    ds_read_b128 v[48:51], v6 offset:4096
    v_mfma_f32_16x16x32_bf16 v[180:183], v[116:119], v[92:95], v[180:183]
    ds_read_b128 v[52:55], v6 offset:5120
    v_mfma_f32_16x16x32_bf16 v[184:187], v[120:123], v[92:95], v[184:187]
    ds_read_b128 v[56:59], v6 offset:6144
    v_mfma_f32_16x16x32_bf16 v[188:191], v[124:127], v[92:95], v[188:191]
    ds_read_b128 v[60:63], v6 offset:7168
    v_mfma_f32_16x16x32_bf16 v[192:195], v[112:115], v[96:99], v[192:195]
    v_mfma_f32_16x16x32_bf16 v[196:199], v[116:119], v[96:99], v[196:199]
    s_add_u32 m0, s21, 32768
    s_nop 0
    buffer_load_dwordx4 v1, s[4:7], s16 offen sc1 lds
    s_add_u32 s16, s16, s62
    v_mfma_f32_16x16x32_bf16 v[200:203], v[120:123], v[96:99], v[200:203]
    v_mfma_f32_16x16x32_bf16 v[204:207], v[124:127], v[96:99], v[204:207]
    v_mfma_f32_16x16x32_bf16 v[208:211], v[112:115], v[100:103], v[208:211]
    s_add_u32 m0, s21, 33792
    s_nop 0
    buffer_load_dwordx4 v1, s[4:7], s17 offen sc1 lds
    s_add_u32 s17, s17, s62
    v_mfma_f32_16x16x32_bf16 v[212:215], v[116:119], v[100:103], v[212:215]
    v_mfma_f32_16x16x32_bf16 v[216:219], v[120:123], v[100:103], v[216:219]
    v_mfma_f32_16x16x32_bf16 v[220:223], v[124:127], v[100:103], v[220:223]
    s_add_u32 m0, s22, 32768
    s_nop 0
    buffer_load_dwordx4 v2, s[8:11], s18 offen lds
    s_add_u32 s18, s18, s20
    v_mfma_f32_16x16x32_bf16 v[224:227], v[112:115], v[104:107], v[224:227]
    v_mfma_f32_16x16x32_bf16 v[228:231], v[116:119], v[104:107], v[228:231]
    v_mfma_f32_16x16x32_bf16 v[232:235], v[120:123], v[104:107], v[232:235]
    s_add_u32 m0, s22, 40960
    s_nop 0
    buffer_load_dwordx4 v2, s[12:15], s19 offen lds
    s_add_u32 s19, s19, s20
    v_mfma_f32_16x16x32_bf16 v[236:239], v[124:127], v[104:107], v[236:239]
    v_mfma_f32_16x16x32_bf16 v[240:243], v[112:115], v[108:111], v[240:243]
    v_mfma_f32_16x16x32_bf16 v[244:247], v[116:119], v[108:111], v[244:247]
    v_mfma_f32_16x16x32_bf16 v[248:251], v[120:123], v[108:111], v[248:251]
    v_mfma_f32_16x16x32_bf16 v[252:255], v[124:127], v[108:111], v[252:255]
    s_waitcnt lgkmcnt(0)
    s_waitcnt vmcnt(16)
    s_barrier
    v_mfma_f32_16x16x32_bf16 v[128:131], v[64:67], v[32:35], v[128:131]
    ds_read_b64_tr_b16 v[112:113], v12 offset:49152
    v_mfma_f32_16x16x32_bf16 v[132:135], v[68:71], v[32:35], v[132:135]
    ds_read_b64_tr_b16 v[114:115], v13 offset:49152
    v_mfma_f32_16x16x32_bf16 v[136:139], v[72:75], v[32:35], v[136:139]
    ds_read_b64_tr_b16 v[116:117], v14 offset:49152
    v_mfma_f32_16x16x32_bf16 v[140:143], v[76:79], v[32:35], v[140:143]
    ds_read_b64_tr_b16 v[118:119], v15 offset:49152
    v_mfma_f32_16x16x32_bf16 v[144:147], v[64:67], v[36:39], v[144:147]
    ds_read_b64_tr_b16 v[120:121], v12 offset:57344
    v_mfma_f32_16x16x32_bf16 v[148:151], v[68:71], v[36:39], v[148:151]
    ds_read_b64_tr_b16 v[122:123], v13 offset:57344
    v_mfma_f32_16x16x32_bf16 v[152:155], v[72:75], v[36:39], v[152:155]
    ds_read_b64_tr_b16 v[124:125], v14 offset:57344
    v_mfma_f32_16x16x32_bf16 v[156:159], v[76:79], v[36:39], v[156:159]
    ds_read_b64_tr_b16 v[126:127], v15 offset:57344
    v_mfma_f32_16x16x32_bf16 v[160:163], v[64:67], v[40:43], v[160:163]
    ds_read_b128 v[80:83], v6 offset:32768
    v_mfma_f32_16x16x32_bf16 v[164:167], v[68:71], v[40:43], v[164:167]
    ds_read_b128 v[84:87], v6 offset:33792
    v_mfma_f32_16x16x32_bf16 v[168:171], v[72:75], v[40:43], v[168:171]
    ds_read_b128 v[88:91], v6 offset:34816
    v_mfma_f32_16x16x32_bf16 v[172:175], v[76:79], v[40:43], v[172:175]
    ds_read_b128 v[92:95], v6 offset:35840
    v_mfma_f32_16x16x32_bf16 v[176:179], v[64:67], v[44:47], v[176:179]
    ds_read_b128 v[96:99], v6 offset:36864
    v_mfma_f32_16x16x32_bf16 v[180:183], v[68:71], v[44:47], v[180:183]
    ds_read_b128 v[100:103], v6 offset:37888
    v_mfma_f32_16x16x32_bf16 v[184:187], v[72:75], v[44:47], v[184:187]
    ds_read_b128 v[104:107], v6 offset:38912
    v_mfma_f32_16x16x32_bf16 v[188:191], v[76:79], v[44:47], v[188:191]
    ds_read_b128 v[108:111], v6 offset:39936
    v_mfma_f32_16x16x32_bf16 v[192:195], v[64:67], v[48:51], v[192:195]
    v_mfma_f32_16x16x32_bf16 v[196:199], v[68:71], v[48:51], v[196:199]
    s_add_u32 m0, s21, 65536
    s_nop 0
    buffer_load_dwordx4 v1, s[4:7], s16 offen sc1 lds
    s_add_u32 s16, s16, s62
    v_mfma_f32_16x16x32_bf16 v[200:203], v[72:75], v[48:51], v[200:203]
    v_mfma_f32_16x16x32_bf16 v[204:207], v[76:79], v[48:51], v[204:207]
    v_mfma_f32_16x16x32_bf16 v[208:211], v[64:67], v[52:55], v[208:211]
    s_add_u32 m0, s21, 66560
    s_nop 0
    buffer_load_dwordx4 v1, s[4:7], s17 offen sc1 lds
    s_add_u32 s17, s17, s62
    v_mfma_f32_16x16x32_bf16 v[212:215], v[68:71], v[52:55], v[212:215]
    v_mfma_f32_16x16x32_bf16 v[216:219], v[72:75], v[52:55], v[216:219]
    v_mfma_f32_16x16x32_bf16 v[220:223], v[76:79], v[52:55], v[220:223]
    s_add_u32 m0, s22, 65536
    s_nop 0
    buffer_load_dwordx4 v2, s[8:11], s18 offen lds
    s_add_u32 s18, s18, s20
    v_mfma_f32_16x16x32_bf16 v[224:227], v[64:67], v[56:59], v[224:227]
    v_mfma_f32_16x16x32_bf16 v[228:231], v[68:71], v[56:59], v[228:231]
    v_mfma_f32_16x16x32_bf16 v[232:235], v[72:75], v[56:59], v[232:235]
    s_add_u32 m0, s22, 73728
    s_nop 0
    buffer_load_dwordx4 v2, s[12:15], s19 offen lds
    s_add_u32 s19, s19, s20
    v_mfma_f32_16x16x32_bf16 v[236:239], v[76:79], v[56:59], v[236:239]
    v_mfma_f32_16x16x32_bf16 v[240:243], v[64:67], v[60:63], v[240:243]
    v_mfma_f32_16x16x32_bf16 v[244:247], v[68:71], v[60:63], v[244:247]
    v_mfma_f32_16x16x32_bf16 v[248:251], v[72:75], v[60:63], v[248:251]
    v_mfma_f32_16x16x32_bf16 v[252:255], v[76:79], v[60:63], v[252:255]
    s_waitcnt lgkmcnt(0)
    s_waitcnt vmcnt(8)
    s_barrier
    s_cmp_eq_u32 s28, 0
    s_cbranch_scc1 sig_3
    s_cmp_lg_u32 s3, 0
    s_cbranch_scc1 sig_3
    s_mov_b64 exec, 1
    v_mov_b32 v18, s57
    buffer_atomic_add v18, v17, s[4:7], s28 offen sc1
    s_mov_b64 exec, -1
sig_3:
    s_mov_b32 s28, 0
    v_mfma_f32_16x16x32_bf16 v[128:131], v[112:115], v[80:83], v[128:131]
    ds_read_b64_tr_b16 v[64:65], v8 offset:16384
    v_mfma_f32_16x16x32_bf16 v[132:135], v[116:119], v[80:83], v[132:135]
    ds_read_b64_tr_b16 v[66:67], v9 offset:16384
    v_mfma_f32_16x16x32_bf16 v[136:139], v[120:123], v[80:83], v[136:139]
    ds_read_b64_tr_b16 v[68:69], v10 offset:16384
    v_mfma_f32_16x16x32_bf16 v[140:143], v[124:127], v[80:83], v[140:143]
    ds_read_b64_tr_b16 v[70:71], v11 offset:16384
    v_mfma_f32_16x16x32_bf16 v[144:147], v[112:115], v[84:87], v[144:147]
    ds_read_b64_tr_b16 v[72:73], v8 offset:24576
    v_mfma_f32_16x16x32_bf16 v[148:151], v[116:119], v[84:87], v[148:151]
    ds_read_b64_tr_b16 v[74:75], v9 offset:24576
    v_mfma_f32_16x16x32_bf16 v[152:155], v[120:123], v[84:87], v[152:155]
    ds_read_b64_tr_b16 v[76:77], v10 offset:24576
    v_mfma_f32_16x16x32_bf16 v[156:159], v[124:127], v[84:87], v[156:159]
    ds_read_b64_tr_b16 v[78:79], v11 offset:24576
    v_mfma_f32_16x16x32_bf16 v[160:163], v[112:115], v[88:91], v[160:163]
    ds_read_b128 v[32:35], v5 offset:0
    v_mfma_f32_16x16x32_bf16 v[164:167], v[116:119], v[88:91], v[164:167]
    ds_read_b128 v[36:39], v5 offset:1024
    v_mfma_f32_16x16x32_bf16 v[168:171], v[120:123], v[88:91], v[168:171]
    ds_read_b128 v[40:43], v5 offset:2048
    v_mfma_f32_16x16x32_bf16 v[172:175], v[124:127], v[88:91], v[172:175]
    ds_read_b128 v[44:47], v5 offset:3072
    v_mfma_f32_16x16x32_bf16 v[176:179], v[112:115], v[92:95], v[176:179]
    ds_read_b128 v[48:51], v5 offset:4096
    v_mfma_f32_16x16x32_bf16 v[180:183], v[116:119], v[92:95], v[180:183]
    ds_read_b128 v[52:55], v5 offset:5120
    v_mfma_f32_16x16x32_bf16 v[184:187], v[120:123], v[92:95], v[184:187]
    ds_read_b128 v[56:59], v5 offset:6144
    v_mfma_f32_16x16x32_bf16 v[188:191], v[124:127], v[92:95], v[188:191]
    ds_read_b128 v[60:63], v5 offset:7168
    v_mfma_f32_16x16x32_bf16 v[192:195], v[112:115], v[96:99], v[192:195]
    v_mfma_f32_16x16x32_bf16 v[196:199], v[116:119], v[96:99], v[196:199]
    s_add_u32 m0, s21, 98304
    s_nop 0
    buffer_load_dwordx4 v1, s[4:7], s16 offen sc1 lds
    s_add_u32 s16, s16, s62
    v_mfma_f32_16x16x32_bf16 v[200:203], v[120:123], v[96:99], v[200:203]
    v_mfma_f32_16x16x32_bf16 v[204:207], v[124:127], v[96:99], v[204:207]
    v_mfma_f32_16x16x32_bf16 v[208:211], v[112:115], v[100:103], v[208:211]
    s_add_u32 m0, s21, 99328
    s_nop 0
    buffer_load_dwordx4 v1, s[4:7], s17 offen sc1 lds
    s_add_u32 s17, s17, s62
    v_mfma_f32_16x16x32_bf16 v[212:215], v[116:119], v[100:103], v[212:215]
    v_mfma_f32_16x16x32_bf16 v[216:219], v[120:123], v[100:103], v[216:219]
    v_mfma_f32_16x16x32_bf16 v[220:223], v[124:127], v[100:103], v[220:223]
    s_add_u32 m0, s22, 98304
    s_nop 0
    buffer_load_dwordx4 v2, s[8:11], s18 offen lds
    s_add_u32 s18, s18, s20
    v_mfma_f32_16x16x32_bf16 v[224:227], v[112:115], v[104:107], v[224:227]
    v_mfma_f32_16x16x32_bf16 v[228:231], v[116:119], v[104:107], v[228:231]
    v_mfma_f32_16x16x32_bf16 v[232:235], v[120:123], v[104:107], v[232:235]
    s_add_u32 m0, s22, 106496
    s_nop 0
    buffer_load_dwordx4 v2, s[12:15], s19 offen lds
    s_add_u32 s19, s19, s20
    v_mfma_f32_16x16x32_bf16 v[236:239], v[124:127], v[104:107], v[236:239]
    v_mfma_f32_16x16x32_bf16 v[240:243], v[112:115], v[108:111], v[240:243]
    v_mfma_f32_16x16x32_bf16 v[244:247], v[116:119], v[108:111], v[244:247]
    v_mfma_f32_16x16x32_bf16 v[248:251], v[120:123], v[108:111], v[248:251]
    v_mfma_f32_16x16x32_bf16 v[252:255], v[124:127], v[108:111], v[252:255]
    s_waitcnt lgkmcnt(0)
    s_branch w_loop_chk
w_first16:
    s_waitcnt vmcnt(24)
    s_barrier
    v_mfma_f32_16x16x32_bf16 v[128:131], v[64:67], v[32:35], 0
    ds_read_b64_tr_b16 v[112:113], v8 offset:49152
    v_mfma_f32_16x16x32_bf16 v[132:135], v[68:71], v[32:35], 0
    ds_read_b64_tr_b16 v[114:115], v9 offset:49152
    v_mfma_f32_16x16x32_bf16 v[136:139], v[72:75], v[32:35], 0
    ds_read_b64_tr_b16 v[116:117], v10 offset:49152
    v_mfma_f32_16x16x32_bf16 v[140:143], v[76:79], v[32:35], 0
    ds_read_b64_tr_b16 v[118:119], v11 offset:49152
    v_mfma_f32_16x16x32_bf16 v[144:147], v[64:67], v[36:39], 0
    ds_read_b64_tr_b16 v[120:121], v8 offset:57344
    v_mfma_f32_16x16x32_bf16 v[148:151], v[68:71], v[36:39], 0
    ds_read_b64_tr_b16 v[122:123], v9 offset:57344
    v_mfma_f32_16x16x32_bf16 v[152:155], v[72:75], v[36:39], 0
    ds_read_b64_tr_b16 v[124:125], v10 offset:57344
    v_mfma_f32_16x16x32_bf16 v[156:159], v[76:79], v[36:39], 0
    ds_read_b64_tr_b16 v[126:127], v11 offset:57344
    v_mfma_f32_16x16x32_bf16 v[160:163], v[64:67], v[40:43], 0
    ds_read_b128 v[80:83], v5 offset:32768
    v_mfma_f32_16x16x32_bf16 v[164:167], v[68:71], v[40:43], 0
    ds_read_b128 v[84:87], v5 offset:33792
    v_mfma_f32_16x16x32_bf16 v[168:171], v[72:75], v[40:43], 0
    ds_read_b128 v[88:91], v5 offset:34816
    v_mfma_f32_16x16x32_bf16 v[172:175], v[76:79], v[40:43], 0
    ds_read_b128 v[92:95], v5 offset:35840
    v_mfma_f32_16x16x32_bf16 v[176:179], v[64:67], v[44:47], 0
    ds_read_b128 v[96:99], v5 offset:36864
    v_mfma_f32_16x16x32_bf16 v[180:183], v[68:71], v[44:47], 0
    ds_read_b128 v[100:103], v5 offset:37888
    v_mfma_f32_16x16x32_bf16 v[184:187], v[72:75], v[44:47], 0
    ds_read_b128 v[104:107], v5 offset:38912
    v_mfma_f32_16x16x32_bf16 v[188:191], v[76:79], v[44:47], 0
    ds_read_b128 v[108:111], v5 offset:39936
    v_mfma_f32_16x16x32_bf16 v[192:195], v[64:67], v[48:51], 0
    v_mfma_f32_16x16x32_bf16 v[196:199], v[68:71], v[48:51], 0
    s_add_u32 m0, s21, 0
    s_nop 0
    buffer_load_dwordx4 v1, s[4:7], s16 offen sc1 lds
    s_add_u32 s16, s16, s62
    v_mfma_f32_16x16x32_bf16 v[200:203], v[72:75], v[48:51], 0
    v_mfma_f32_16x16x32_bf16 v[204:207], v[76:79], v[48:51], 0
    v_mfma_f32_16x16x32_bf16 v[208:211], v[64:67], v[52:55], 0
    s_add_u32 m0, s21, 1024
    s_nop 0
    buffer_load_dwordx4 v1, s[4:7], s17 offen sc1 lds
    s_add_u32 s17, s17, s62
    v_mfma_f32_16x16x32_bf16 v[212:215], v[68:71], v[52:55], 0
    v_mfma_f32_16x16x32_bf16 v[216:219], v[72:75], v[52:55], 0
    v_mfma_f32_16x16x32_bf16 v[220:223], v[76:79], v[52:55], 0
    s_add_u32 m0, s22, 0
    s_nop 0
    buffer_load_dwordx4 v2, s[8:11], s18 offen lds
    s_add_u32 s18, s18, s20
    v_mfma_f32_16x16x32_bf16 v[224:227], v[64:67], v[56:59], 0
    v_mfma_f32_16x16x32_bf16 v[228:231], v[68:71], v[56:59], 0
    v_mfma_f32_16x16x32_bf16 v[232:235], v[72:75], v[56:59], 0
    s_add_u32 m0, s22, 8192
    s_nop 0
    buffer_load_dwordx4 v2, s[12:15], s19 offen lds
    s_add_u32 s19, s19, s20
    v_mfma_f32_16x16x32_bf16 v[236:239], v[76:79], v[56:59], 0
    v_mfma_f32_16x16x32_bf16 v[240:243], v[64:67], v[60:63], 0
    v_mfma_f32_16x16x32_bf16 v[244:247], v[68:71], v[60:63], 0
    v_mfma_f32_16x16x32_bf16 v[248:251], v[72:75], v[60:63], 0
    v_mfma_f32_16x16x32_bf16 v[252:255], v[76:79], v[60:63], 0
    s_waitcnt lgkmcnt(0)
    s_waitcnt vmcnt(24)
    s_barrier
    v_mfma_f32_16x16x32_bf16 v[128:131], v[112:115], v[80:83], v[128:131]
    ds_read_b64_tr_b16 v[64:65], v12 offset:16384
    v_mfma_f32_16x16x32_bf16 v[132:135], v[116:119], v[80:83], v[132:135]
    ds_read_b64_tr_b16 v[66:67], v13 offset:16384
    v_mfma_f32_16x16x32_bf16 v[136:139], v[120:123], v[80:83], v[136:139]
    ds_read_b64_tr_b16 v[68:69], v14 offset:16384
    v_mfma_f32_16x16x32_bf16 v[140:143], v[124:127], v[80:83], v[140:143]
    ds_read_b64_tr_b16 v[70:71], v15 offset:16384
    v_mfma_f32_16x16x32_bf16 v[144:147], v[112:115], v[84:87], v[144:147]
    ds_read_b64_tr_b16 v[72:73], v12 offset:24576
    v_mfma_f32_16x16x32_bf16 v[148:151], v[116:119], v[84:87], v[148:151]
    ds_read_b64_tr_b16 v[74:75], v13 offset:24576
    v_mfma_f32_16x16x32_bf16 v[152:155], v[120:123], v[84:87], v[152:155]
    ds_read_b64_tr_b16 v[76:77], v14 offset:24576
    v_mfma_f32_16x16x32_bf16 v[156:159], v[124:127], v[84:87], v[156:159]
    ds_read_b64_tr_b16 v[78:79], v15 offset:24576
    v_mfma_f32_16x16x32_bf16 v[160:163], v[112:115], v[88:91], v[160:163]
    ds_read_b128 v[32:35], v6 offset:0
    v_mfma_f32_16x16x32_bf16 v[164:167], v[116:119], v[88:91], v[164:167]
    ds_read_b128 v[36:39], v6 offset:1024
    v_mfma_f32_16x16x32_bf16 v[168:171], v[120:123], v[88:91], v[168:171]
    ds_read_b128 v[40:43], v6 offset:2048
    v_mfma_f32_16x16x32_bf16 v[172:175], v[124:127], v[88:91], v[172:175]
    ds_read_b128 v[44:47], v6 offset:3072
    v_mfma_f32_16x16x32_bf16 v[176:179], v[112:115], v[92:95], v[176:179]
    ds_read_b128 v[48:51], v6 offset:4096
    v_mfma_f32_16x16x32_bf16 v[180:183], v[116:119], v[92:95], v[180:183]
    ds_read_b128 v[52:55], v6 offset:5120
    v_mfma_f32_16x16x32_bf16 v[184:187], v[120:123], v[92:95], v[184:187]
    ds_read_b128 v[56:59], v6 offset:6144
    v_mfma_f32_16x16x32_bf16 v[188:191], v[124:127], v[92:95], v[188:191]
    ds_read_b128 v[60:63], v6 offset:7168
    v_mfma_f32_16x16x32_bf16 v[192:195], v[112:115], v[96:99], v[192:195]
    v_mfma_f32_16x16x32_bf16 v[196:199], v[116:119], v[96:99], v[196:199]
    s_add_u32 m0, s21, 32768
    s_nop 0
    buffer_load_dwordx4 v1, s[4:7], s16 offen sc1 lds
    s_add_u32 s16, s16, s62
    v_mfma_f32_16x16x32_bf16 v[200:203], v[120:123], v[96:99], v[200:203]
    v_mfma_f32_16x16x32_bf16 v[204:207], v[124:127], v[96:99], v[204:207]
    v_mfma_f32_16x16x32_bf16 v[208:211], v[112:115], v[100:103], v[208:211]
    s_add_u32 m0, s21, 33792
    s_nop 0
    buffer_load_dwordx4 v1, s[4:7], s17 offen sc1 lds
    s_add_u32 s17, s17, s62
    v_mfma_f32_16x16x32_bf16 v[212:215], v[116:119], v[100:103], v[212:215]
    v_mfma_f32_16x16x32_bf16 v[216:219], v[120:123], v[100:103], v[216:219]
    v_mfma_f32_16x16x32_bf16 v[220:223], v[124:127], v[100:103], v[220:223]
    s_add_u32 m0, s22, 32768
    s_nop 0
    buffer_load_dwordx4 v2, s[8:11], s18 offen lds
    s_add_u32 s18, s18, s20
    v_mfma_f32_16x16x32_bf16 v[224:227], v[112:115], v[104:107], v[224:227]
    v_mfma_f32_16x16x32_bf16 v[228:231], v[116:119], v[104:107], v[228:231]
    v_mfma_f32_16x16x32_bf16 v[232:235], v[120:123], v[104:107], v[232:235]
    s_add_u32 m0, s22, 40960
    s_nop 0
    buffer_load_dwordx4 v2, s[12:15], s19 offen lds
    s_add_u32 s19, s19, s20
    v_mfma_f32_16x16x32_bf16 v[236:239], v[124:127], v[104:107], v[236:239]
    v_mfma_f32_16x16x32_bf16 v[240:243], v[112:115], v[108:111], v[240:243]
    v_mfma_f32_16x16x32_bf16 v[244:247], v[116:119], v[108:111], v[244:247]
    v_mfma_f32_16x16x32_bf16 v[248:251], v[120:123], v[108:111], v[248:251]
    v_mfma_f32_16x16x32_bf16 v[252:255], v[124:127], v[108:111], v[252:255]
    s_waitcnt lgkmcnt(0)
    s_waitcnt vmcnt(24)
    s_barrier
    v_mfma_f32_16x16x32_bf16 v[128:131], v[64:67], v[32:35], v[128:131]
    ds_read_b64_tr_b16 v[112:113], v12 offset:49152
    v_mfma_f32_16x16x32_bf16 v[132:135], v[68:71], v[32:35], v[132:135]
    ds_read_b64_tr_b16 v[114:115], v13 offset:49152
    v_mfma_f32_16x16x32_bf16 v[136:139], v[72:75], v[32:35], v[136:139]
    ds_read_b64_tr_b16 v[116:117], v14 offset:49152
    v_mfma_f32_16x16x32_bf16 v[140:143], v[76:79], v[32:35], v[140:143]
    ds_read_b64_tr_b16 v[118:119], v15 offset:49152
    v_mfma_f32_16x16x32_bf16 v[144:147], v[64:67], v[36:39], v[144:147]
    ds_read_b64_tr_b16 v[120:121], v12 offset:57344
    v_mfma_f32_16x16x32_bf16 v[148:151], v[68:71], v[36:39], v[148:151]
    ds_read_b64_tr_b16 v[122:123], v13 offset:57344
    v_mfma_f32_16x16x32_bf16 v[152:155], v[72:75], v[36:39], v[152:155]
    ds_read_b64_tr_b16 v[124:125], v14 offset:57344
    v_mfma_f32_16x16x32_bf16 v[156:159], v[76:79], v[36:39], v[156:159]
    ds_read_b64_tr_b16 v[126:127], v15 offset:57344
    v_mfma_f32_16x16x32_bf16 v[160:163], v[64:67], v[40:43], v[160:163]
    ds_read_b128 v[80:83], v6 offset:32768
    v_mfma_f32_16x16x32_bf16 v[164:167], v[68:71], v[40:43], v[164:167]
    ds_read_b128 v[84:87], v6 offset:33792
    v_mfma_f32_16x16x32_bf16 v[168:171], v[72:75], v[40:43], v[168:171]
    ds_read_b128 v[88:91], v6 offset:34816
    v_mfma_f32_16x16x32_bf16 v[172:175], v[76:79], v[40:43], v[172:175]
    ds_read_b128 v[92:95], v6 offset:35840
    v_mfma_f32_16x16x32_bf16 v[176:179], v[64:67], v[44:47], v[176:179]
    ds_read_b128 v[96:99], v6 offset:36864
    v_mfma_f32_16x16x32_bf16 v[180:183], v[68:71], v[44:47], v[180:183]
    ds_read_b128 v[100:103], v6 offset:37888
    v_mfma_f32_16x16x32_bf16 v[184:187], v[72:75], v[44:47], v[184:187]
    ds_read_b128 v[104:107], v6 offset:38912
    v_mfma_f32_16x16x32_bf16 v[188:191], v[76:79], v[44:47], v[188:191]
    ds_read_b128 v[108:111], v6 offset:39936
    v_mfma_f32_16x16x32_bf16 v[192:195], v[64:67], v[48:51], v[192:195]
    v_mfma_f32_16x16x32_bf16 v[196:199], v[68:71], v[48:51], v[196:199]
    s_add_u32 m0, s21, 65536
    s_nop 0
    buffer_load_dwordx4 v1, s[4:7], s16 offen sc1 lds
    s_add_u32 s16, s16, s62
    v_mfma_f32_16x16x32_bf16 v[200:203], v[72:75], v[48:51], v[200:203]
    v_mfma_f32_16x16x32_bf16 v[204:207], v[76:79], v[48:51], v[204:207]
    v_mfma_f32_16x16x32_bf16 v[208:211], v[64:67], v[52:55], v[208:211]
    s_add_u32 m0, s21, 66560
    s_nop 0
    buffer_load_dwordx4 v1, s[4:7], s17 offen sc1 lds
    s_add_u32 s17, s17, s62
    v_mfma_f32_16x16x32_bf16 v[212:215], v[68:71], v[52:55], v[212:215]
    v_mfma_f32_16x16x32_bf16 v[216:219], v[72:75], v[52:55], v[216:219]
    v_mfma_f32_16x16x32_bf16 v[220:223], v[76:79], v[52:55], v[220:223]
    s_add_u32 m0, s22, 65536
    s_nop 0
    buffer_load_dwordx4 v2, s[8:11], s18 offen lds
    s_add_u32 s18, s18, s20
    v_mfma_f32_16x16x32_bf16 v[224:227], v[64:67], v[56:59], v[224:227]
    v_mfma_f32_16x16x32_bf16 v[228:231], v[68:71], v[56:59], v[228:231]
    v_mfma_f32_16x16x32_bf16 v[232:235], v[72:75], v[56:59], v[232:235]
    s_add_u32 m0, s22, 73728
    s_nop 0
    buffer_load_dwordx4 v2, s[12:15], s19 offen lds
    s_add_u32 s19, s19, s20
    v_mfma_f32_16x16x32_bf16 v[236:239], v[76:79], v[56:59], v[236:239]
    v_mfma_f32_16x16x32_bf16 v[240:243], v[64:67], v[60:63], v[240:243]
    v_mfma_f32_16x16x32_bf16 v[244:247], v[68:71], v[60:63], v[244:247]
    v_mfma_f32_16x16x32_bf16 v[248:251], v[72:75], v[60:63], v[248:251]
    v_mfma_f32_16x16x32_bf16 v[252:255], v[76:79], v[60:63], v[252:255]
    s_waitcnt lgkmcnt(0)
    s_waitcnt vmcnt(8)
    s_barrier
    s_cmp_eq_u32 s28, 0
    s_cbranch_scc1 sig_4
    s_cmp_lg_u32 s3, 0
    s_cbranch_scc1 sig_4
    s_mov_b64 exec, 1
    v_mov_b32 v18, s57
    buffer_atomic_add v18, v17, s[4:7], s28 offen sc1
    s_mov_b64 exec, -1
sig_4:
    s_mov_b32 s28, 0
    v_mfma_f32_16x16x32_bf16 v[128:131], v[112:115], v[80:83], v[128:131]
    ds_read_b64_tr_b16 v[64:65], v8 offset:16384
    v_mfma_f32_16x16x32_bf16 v[132:135], v[116:119], v[80:83], v[132:135]
    ds_read_b64_tr_b16 v[66:67], v9 offset:16384
    v_mfma_f32_16x16x32_bf16 v[136:139], v[120:123], v[80:83], v[136:139]
    ds_read_b64_tr_b16 v[68:69], v10 offset:16384
    v_mfma_f32_16x16x32_bf16 v[140:143], v[124:127], v[80:83], v[140:143]
    ds_read_b64_tr_b16 v[70:71], v11 offset:16384
    v_mfma_f32_16x16x32_bf16 v[144:147], v[112:115], v[84:87], v[144:147]
    ds_read_b64_tr_b16 v[72:73], v8 offset:24576
    v_mfma_f32_16x16x32_bf16 v[148:151], v[116:119], v[84:87], v[148:151]
    ds_read_b64_tr_b16 v[74:75], v9 offset:24576
    v_mfma_f32_16x16x32_bf16 v[152:155], v[120:123], v[84:87], v[152:155]
    ds_read_b64_tr_b16 v[76:77], v10 offset:24576
    v_mfma_f32_16x16x32_bf16 v[156:159], v[124:127], v[84:87], v[156:159]
    ds_read_b64_tr_b16 v[78:79], v11 offset:24576
    v_mfma_f32_16x16x32_bf16 v[160:163], v[112:115], v[88:91], v[160:163]
    ds_read_b128 v[32:35], v5 offset:0
    v_mfma_f32_16x16x32_bf16 v[164:167], v[116:119], v[88:91], v[164:167]
    ds_read_b128 v[36:39], v5 offset:1024
    v_mfma_f32_16x16x32_bf16 v[168:171], v[120:123], v[88:91], v[168:171]
    ds_read_b128 v[40:43], v5 offset:2048
    v_mfma_f32_16x16x32_bf16 v[172:175], v[124:127], v[88:91], v[172:175]
    ds_read_b128 v[44:47], v5 offset:3072
    v_mfma_f32_16x16x32_bf16 v[176:179], v[112:115], v[92:95], v[176:179]
    ds_read_b128 v[48:51], v5 offset:4096
    v_mfma_f32_16x16x32_bf16 v[180:183], v[116:119], v[92:95], v[180:183]
    ds_read_b128 v[52:55], v5 offset:5120
    v_mfma_f32_16x16x32_bf16 v[184:187], v[120:123], v[92:95], v[184:187]
    ds_read_b128 v[56:59], v5 offset:6144
    v_mfma_f32_16x16x32_bf16 v[188:191], v[124:127], v[92:95], v[188:191]
    ds_read_b128 v[60:63], v5 offset:7168
    v_mfma_f32_16x16x32_bf16 v[192:195], v[112:115], v[96:99], v[192:195]
    v_mfma_f32_16x16x32_bf16 v[196:199], v[116:119], v[96:99], v[196:199]
    s_add_u32 m0, s21, 98304
    s_nop 0
    buffer_load_dwordx4 v1, s[4:7], s16 offen sc1 lds
    s_add_u32 s16, s16, s62
    v_mfma_f32_16x16x32_bf16 v[200:203], v[120:123], v[96:99], v[200:203]
    v_mfma_f32_16x16x32_bf16 v[204:207], v[124:127], v[96:99], v[204:207]
    v_mfma_f32_16x16x32_bf16 v[208:211], v[112:115], v[100:103], v[208:211]
    s_add_u32 m0, s21, 99328
    s_nop 0
    buffer_load_dwordx4 v1, s[4:7], s17 offen sc1 lds
    s_add_u32 s17, s17, s62
    v_mfma_f32_16x16x32_bf16 v[212:215], v[116:119], v[100:103], v[212:215]
    v_mfma_f32_16x16x32_bf16 v[216:219], v[120:123], v[100:103], v[216:219]
    v_mfma_f32_16x16x32_bf16 v[220:223], v[124:127], v[100:103], v[220:223]
    s_add_u32 m0, s22, 98304
    s_nop 0
    buffer_load_dwordx4 v2, s[8:11], s18 offen lds
    s_add_u32 s18, s18, s20
    v_mfma_f32_16x16x32_bf16 v[224:227], v[112:115], v[104:107], v[224:227]
    v_mfma_f32_16x16x32_bf16 v[228:231], v[116:119], v[104:107], v[228:231]
    v_mfma_f32_16x16x32_bf16 v[232:235], v[120:123], v[104:107], v[232:235]
    s_add_u32 m0, s22, 106496
    s_nop 0
    buffer_load_dwordx4 v2, s[12:15], s19 offen lds
    s_add_u32 s19, s19, s20
    v_mfma_f32_16x16x32_bf16 v[236:239], v[124:127], v[104:107], v[236:239]
    v_mfma_f32_16x16x32_bf16 v[240:243], v[112:115], v[108:111], v[240:243]
    v_mfma_f32_16x16x32_bf16 v[244:247], v[116:119], v[108:111], v[244:247]
    v_mfma_f32_16x16x32_bf16 v[248:251], v[120:123], v[108:111], v[248:251]
    v_mfma_f32_16x16x32_bf16 v[252:255], v[124:127], v[108:111], v[252:255]
    s_waitcnt lgkmcnt(0)
w_loop_chk:
    s_sub_u32 s23, s23, 1
w_loop:
    s_cmp_lg_u32 s23, 1
    s_cbranch_scc1 w_body
    v_readfirstlane_b32 s30, v16
    s_cmp_ge_u32 s30, s45
    s_cselect_b32 s30, 0, 1
    s_or_b32 s30, s30, s70
    s_cmp_ge_u32 s32, 4
    s_cselect_b32 s30, 1, s30
    s_cmp_eq_u32 s32, 0
    s_cselect_b32 s30, 1, s30
    v_mov_b32 v20, s30
    ds_write_b32 v7, v20
    s_cbranch_scc1 w_nd
    s_cmp_ge_u32 s32, 4
    s_cbranch_scc1 w_nd
    s_cmp_lg_u32 s70, 0
    s_cbranch_scc1 w_nd
    s_load_dwordx2 s[8:9], s[0:1], s33
    s_load_dwordx2 s[12:13], s[0:1], s34
    s_mov_b32 s10, s38
    s_mov_b32 s14, s38
    s_cmp_ge_u32 s32, 4
    s_cselect_b32 s31, 0, 1
    s_lshl_b32 s30, s3, s31
    s_mul_i32 s30, s30, s40
    s_add_u32 s16, s39, s30
    s_cmp_eq_u32 s32, 4
    s_cselect_b32 s30, 1024, s40
    s_cselect_b32 s31, 6, 5
    s_lshl_b32 s62, 32, s31
    s_add_u32 s17, s16, s30
    s_lshl_b32 s30, s3, 2
    s_mul_i32 s30, s30, s35
    s_add_u32 s18, s36, s30
    s_add_u32 s19, s37, s30
    s_lshl_b32 s20, s35, s31
    v_mul_u32_u24 v2, s35, v4
    v_add_u32 v2, v2, v3
    s_waitcnt lgkmcnt(0)
w_body:
    s_waitcnt vmcnt(8)
    s_barrier
    v_mfma_f32_16x16x32_bf16 v[128:131], v[64:67], v[32:35], v[128:131]
    ds_read_b64_tr_b16 v[112:113], v8 offset:49152
    v_mfma_f32_16x16x32_bf16 v[132:135], v[68:71], v[32:35], v[132:135]
    ds_read_b64_tr_b16 v[114:115], v9 offset:49152
    v_mfma_f32_16x16x32_bf16 v[136:139], v[72:75], v[32:35], v[136:139]
    ds_read_b64_tr_b16 v[116:117], v10 offset:49152
    v_mfma_f32_16x16x32_bf16 v[140:143], v[76:79], v[32:35], v[140:143]
    ds_read_b64_tr_b16 v[118:119], v11 offset:49152
    v_mfma_f32_16x16x32_bf16 v[144:147], v[64:67], v[36:39], v[144:147]
    ds_read_b64_tr_b16 v[120:121], v8 offset:57344
    v_mfma_f32_16x16x32_bf16 v[148:151], v[68:71], v[36:39], v[148:151]
    ds_read_b64_tr_b16 v[122:123], v9 offset:57344
    v_mfma_f32_16x16x32_bf16 v[152:155], v[72:75], v[36:39], v[152:155]
    ds_read_b64_tr_b16 v[124:125], v10 offset:57344
    v_mfma_f32_16x16x32_bf16 v[156:159], v[76:79], v[36:39], v[156:159]
    ds_read_b64_tr_b16 v[126:127], v11 offset:57344
    v_mfma_f32_16x16x32_bf16 v[160:163], v[64:67], v[40:43], v[160:163]
    ds_read_b128 v[80:83], v5 offset:32768
    v_mfma_f32_16x16x32_bf16 v[164:167], v[68:71], v[40:43], v[164:167]
    ds_read_b128 v[84:87], v5 offset:33792
    v_mfma_f32_16x16x32_bf16 v[168:171], v[72:75], v[40:43], v[168:171]
    ds_read_b128 v[88:91], v5 offset:34816
    v_mfma_f32_16x16x32_bf16 v[172:175], v[76:79], v[40:43], v[172:175]
    ds_read_b128 v[92:95], v5 offset:35840
    v_mfma_f32_16x16x32_bf16 v[176:179], v[64:67], v[44:47], v[176:179]
    ds_read_b128 v[96:99], v5 offset:36864
    v_mfma_f32_16x16x32_bf16 v[180:183], v[68:71], v[44:47], v[180:183]
    ds_read_b128 v[100:103], v5 offset:37888
    v_mfma_f32_16x16x32_bf16 v[184:187], v[72:75], v[44:47], v[184:187]
    ds_read_b128 v[104:107], v5 offset:38912
    v_mfma_f32_16x16x32_bf16 v[188:191], v[76:79], v[44:47], v[188:191]
    ds_read_b128 v[108:111], v5 offset:39936
    v_mfma_f32_16x16x32_bf16 v[192:195], v[64:67], v[48:51], v[192:195]
    v_mfma_f32_16x16x32_bf16 v[196:199], v[68:71], v[48:51], v[196:199]
    s_add_u32 m0, s21, 0
    s_nop 0
    buffer_load_dwordx4 v1, s[4:7], s16 offen sc1 lds
    s_add_u32 s16, s16, s62
    v_mfma_f32_16x16x32_bf16 v[200:203], v[72:75], v[48:51], v[200:203]
    v_mfma_f32_16x16x32_bf16 v[204:207], v[76:79], v[48:51], v[204:207]
    v_mfma_f32_16x16x32_bf16 v[208:211], v[64:67], v[52:55], v[208:211]
    s_add_u32 m0, s21, 1024
    s_nop 0
    buffer_load_dwordx4 v1, s[4:7], s17 offen sc1 lds
    s_add_u32 s17, s17, s62
    v_mfma_f32_16x16x32_bf16 v[212:215], v[68:71], v[52:55], v[212:215]
    v_mfma_f32_16x16x32_bf16 v[216:219], v[72:75], v[52:55], v[216:219]
    v_mfma_f32_16x16x32_bf16 v[220:223], v[76:79], v[52:55], v[220:223]
    s_add_u32 m0, s22, 0
    s_nop 0
    buffer_load_dwordx4 v2, s[8:11], s18 offen lds
    s_add_u32 s18, s18, s20
    v_mfma_f32_16x16x32_bf16 v[224:227], v[64:67], v[56:59], v[224:227]
    v_mfma_f32_16x16x32_bf16 v[228:231], v[68:71], v[56:59], v[228:231]
    v_mfma_f32_16x16x32_bf16 v[232:235], v[72:75], v[56:59], v[232:235]
    s_add_u32 m0, s22, 8192
    s_nop 0
    buffer_load_dwordx4 v2, s[12:15], s19 offen lds
    s_add_u32 s19, s19, s20
    v_mfma_f32_16x16x32_bf16 v[236:239], v[76:79], v[56:59], v[236:239]
    v_mfma_f32_16x16x32_bf16 v[240:243], v[64:67], v[60:63], v[240:243]
    v_mfma_f32_16x16x32_bf16 v[244:247], v[68:71], v[60:63], v[244:247]
    buffer_load_dword v16, v17, s[4:7], s44 offen sc1
    v_mfma_f32_16x16x32_bf16 v[248:251], v[72:75], v[60:63], v[248:251]
    v_mfma_f32_16x16x32_bf16 v[252:255], v[76:79], v[60:63], v[252:255]
    s_waitcnt lgkmcnt(0)
    s_waitcnt vmcnt(8)
    s_barrier
    v_mfma_f32_16x16x32_bf16 v[128:131], v[112:115], v[80:83], v[128:131]
    ds_read_b64_tr_b16 v[64:65], v12 offset:16384
    v_mfma_f32_16x16x32_bf16 v[132:135], v[116:119], v[80:83], v[132:135]
    ds_read_b64_tr_b16 v[66:67], v13 offset:16384
    v_mfma_f32_16x16x32_bf16 v[136:139], v[120:123], v[80:83], v[136:139]
    ds_read_b64_tr_b16 v[68:69], v14 offset:16384
    v_mfma_f32_16x16x32_bf16 v[140:143], v[124:127], v[80:83], v[140:143]
    ds_read_b64_tr_b16 v[70:71], v15 offset:16384
    v_mfma_f32_16x16x32_bf16 v[144:147], v[112:115], v[84:87], v[144:147]
    ds_read_b64_tr_b16 v[72:73], v12 offset:24576
    v_mfma_f32_16x16x32_bf16 v[148:151], v[116:119], v[84:87], v[148:151]
    ds_read_b64_tr_b16 v[74:75], v13 offset:24576
    v_mfma_f32_16x16x32_bf16 v[152:155], v[120:123], v[84:87], v[152:155]
    ds_read_b64_tr_b16 v[76:77], v14 offset:24576
    v_mfma_f32_16x16x32_bf16 v[156:159], v[124:127], v[84:87], v[156:159]
    ds_read_b64_tr_b16 v[78:79], v15 offset:24576
    v_mfma_f32_16x16x32_bf16 v[160:163], v[112:115], v[88:91], v[160:163]
    ds_read_b128 v[32:35], v6 offset:0
    v_mfma_f32_16x16x32_bf16 v[164:167], v[116:119], v[88:91], v[164:167]
    ds_read_b128 v[36:39], v6 offset:1024
    v_mfma_f32_16x16x32_bf16 v[168:171], v[120:123], v[88:91], v[168:171]
    ds_read_b128 v[40:43], v6 offset:2048
    v_mfma_f32_16x16x32_bf16 v[172:175], v[124:127], v[88:91], v[172:175]
    ds_read_b128 v[44:47], v6 offset:3072
    v_mfma_f32_16x16x32_bf16 v[176:179], v[112:115], v[92:95], v[176:179]
    ds_read_b128 v[48:51], v6 offset:4096
    v_mfma_f32_16x16x32_bf16 v[180:183], v[116:119], v[92:95], v[180:183]
    ds_read_b128 v[52:55], v6 offset:5120
    v_mfma_f32_16x16x32_bf16 v[184:187], v[120:123], v[92:95], v[184:187]
    ds_read_b128 v[56:59], v6 offset:6144
    v_mfma_f32_16x16x32_bf16 v[188:191], v[124:127], v[92:95], v[188:191]
    ds_read_b128 v[60:63], v6 offset:7168
    v_mfma_f32_16x16x32_bf16 v[192:195], v[112:115], v[96:99], v[192:195]
    v_mfma_f32_16x16x32_bf16 v[196:199], v[116:119], v[96:99], v[196:199]
    s_add_u32 m0, s21, 32768
    s_nop 0
    buffer_load_dwordx4 v1, s[4:7], s16 offen sc1 lds
    s_add_u32 s16, s16, s62
    v_mfma_f32_16x16x32_bf16 v[200:203], v[120:123], v[96:99], v[200:203]
    v_mfma_f32_16x16x32_bf16 v[204:207], v[124:127], v[96:99], v[204:207]
    v_mfma_f32_16x16x32_bf16 v[208:211], v[112:115], v[100:103], v[208:211]
    s_add_u32 m0, s21, 33792
    s_nop 0
    buffer_load_dwordx4 v1, s[4:7], s17 offen sc1 lds
    s_add_u32 s17, s17, s62
    v_mfma_f32_16x16x32_bf16 v[212:215], v[116:119], v[100:103], v[212:215]
    v_mfma_f32_16x16x32_bf16 v[216:219], v[120:123], v[100:103], v[216:219]
    v_mfma_f32_16x16x32_bf16 v[220:223], v[124:127], v[100:103], v[220:223]
    s_add_u32 m0, s22, 32768
    s_nop 0
    buffer_load_dwordx4 v2, s[8:11], s18 offen lds
    s_add_u32 s18, s18, s20
    v_mfma_f32_16x16x32_bf16 v[224:227], v[112:115], v[104:107], v[224:227]
    v_mfma_f32_16x16x32_bf16 v[228:231], v[116:119], v[104:107], v[228:231]
    v_mfma_f32_16x16x32_bf16 v[232:235], v[120:123], v[104:107], v[232:235]
    s_add_u32 m0, s22, 40960
    s_nop 0
    buffer_load_dwordx4 v2, s[12:15], s19 offen lds
    s_add_u32 s19, s19, s20
    v_mfma_f32_16x16x32_bf16 v[236:239], v[124:127], v[104:107], v[236:239]
    v_mfma_f32_16x16x32_bf16 v[240:243], v[112:115], v[108:111], v[240:243]
    v_mfma_f32_16x16x32_bf16 v[244:247], v[116:119], v[108:111], v[244:247]
    v_mfma_f32_16x16x32_bf16 v[248:251], v[120:123], v[108:111], v[248:251]
    v_mfma_f32_16x16x32_bf16 v[252:255], v[124:127], v[108:111], v[252:255]
    s_waitcnt lgkmcnt(0)
    s_waitcnt vmcnt(8)
    s_barrier
    v_mfma_f32_16x16x32_bf16 v[128:131], v[64:67], v[32:35], v[128:131]
    ds_read_b64_tr_b16 v[112:113], v12 offset:49152
    v_mfma_f32_16x16x32_bf16 v[132:135], v[68:71], v[32:35], v[132:135]
    ds_read_b64_tr_b16 v[114:115], v13 offset:49152
    v_mfma_f32_16x16x32_bf16 v[136:139], v[72:75], v[32:35], v[136:139]
    ds_read_b64_tr_b16 v[116:117], v14 offset:49152
    v_mfma_f32_16x16x32_bf16 v[140:143], v[76:79], v[32:35], v[140:143]
    ds_read_b64_tr_b16 v[118:119], v15 offset:49152
    v_mfma_f32_16x16x32_bf16 v[144:147], v[64:67], v[36:39], v[144:147]
    ds_read_b64_tr_b16 v[120:121], v12 offset:57344
    v_mfma_f32_16x16x32_bf16 v[148:151], v[68:71], v[36:39], v[148:151]
    ds_read_b64_tr_b16 v[122:123], v13 offset:57344
    v_mfma_f32_16x16x32_bf16 v[152:155], v[72:75], v[36:39], v[152:155]
    ds_read_b64_tr_b16 v[124:125], v14 offset:57344
    v_mfma_f32_16x16x32_bf16 v[156:159], v[76:79], v[36:39], v[156:159]
    ds_read_b64_tr_b16 v[126:127], v15 offset:57344
    v_mfma_f32_16x16x32_bf16 v[160:163], v[64:67], v[40:43], v[160:163]
    ds_read_b128 v[80:83], v6 offset:32768
    v_mfma_f32_16x16x32_bf16 v[164:167], v[68:71], v[40:43], v[164:167]
    ds_read_b128 v[84:87], v6 offset:33792
    v_mfma_f32_16x16x32_bf16 v[168:171], v[72:75], v[40:43], v[168:171]
    ds_read_b128 v[88:91], v6 offset:34816
    v_mfma_f32_16x16x32_bf16 v[172:175], v[76:79], v[40:43], v[172:175]
    ds_read_b128 v[92:95], v6 offset:35840
    v_mfma_f32_16x16x32_bf16 v[176:179], v[64:67], v[44:47], v[176:179]
    ds_read_b128 v[96:99], v6 offset:36864
    v_mfma_f32_16x16x32_bf16 v[180:183], v[68:71], v[44:47], v[180:183]
    ds_read_b128 v[100:103], v6 offset:37888
    v_mfma_f32_16x16x32_bf16 v[184:187], v[72:75], v[44:47], v[184:187]
    ds_read_b128 v[104:107], v6 offset:38912
    v_mfma_f32_16x16x32_bf16 v[188:191], v[76:79], v[44:47], v[188:191]
    ds_read_b128 v[108:111], v6 offset:39936
    v_mfma_f32_16x16x32_bf16 v[192:195], v[64:67], v[48:51], v[192:195]
    v_mfma_f32_16x16x32_bf16 v[196:199], v[68:71], v[48:51], v[196:199]
    s_add_u32 m0, s21, 65536
    s_nop 0
    buffer_load_dwordx4 v1, s[4:7], s16 offen sc1 lds
    s_add_u32 s16, s16, s62
    v_mfma_f32_16x16x32_bf16 v[200:203], v[72:75], v[48:51], v[200:203]
    v_mfma_f32_16x16x32_bf16 v[204:207], v[76:79], v[48:51], v[204:207]
    v_mfma_f32_16x16x32_bf16 v[208:211], v[64:67], v[52:55], v[208:211]
    s_add_u32 m0, s21, 66560
    s_nop 0
    buffer_load_dwordx4 v1, s[4:7], s17 offen sc1 lds
    s_add_u32 s17, s17, s62
    v_mfma_f32_16x16x32_bf16 v[212:215], v[68:71], v[52:55], v[212:215]
    v_mfma_f32_16x16x32_bf16 v[216:219], v[72:75], v[52:55], v[216:219]
    v_mfma_f32_16x16x32_bf16 v[220:223], v[76:79], v[52:55], v[220:223]
    s_add_u32 m0, s22, 65536
    s_nop 0
    buffer_load_dwordx4 v2, s[8:11], s18 offen lds
    s_add_u32 s18, s18, s20
    v_mfma_f32_16x16x32_bf16 v[224:227], v[64:67], v[56:59], v[224:227]
    v_mfma_f32_16x16x32_bf16 v[228:231], v[68:71], v[56:59], v[228:231]
    v_mfma_f32_16x16x32_bf16 v[232:235], v[72:75], v[56:59], v[232:235]
    s_add_u32 m0, s22, 73728
    s_nop 0
    buffer_load_dwordx4 v2, s[12:15], s19 offen lds
    s_add_u32 s19, s19, s20
    v_mfma_f32_16x16x32_bf16 v[236:239], v[76:79], v[56:59], v[236:239]
    v_mfma_f32_16x16x32_bf16 v[240:243], v[64:67], v[60:63], v[240:243]
    v_mfma_f32_16x16x32_bf16 v[244:247], v[68:71], v[60:63], v[244:247]
    v_mfma_f32_16x16x32_bf16 v[248:251], v[72:75], v[60:63], v[248:251]
    v_mfma_f32_16x16x32_bf16 v[252:255], v[76:79], v[60:63], v[252:255]
    s_waitcnt lgkmcnt(0)
    s_waitcnt vmcnt(8)
    s_barrier
    v_mfma_f32_16x16x32_bf16 v[128:131], v[112:115], v[80:83], v[128:131]
    ds_read_b64_tr_b16 v[64:65], v8 offset:16384
    v_mfma_f32_16x16x32_bf16 v[132:135], v[116:119], v[80:83], v[132:135]
    ds_read_b64_tr_b16 v[66:67], v9 offset:16384
    v_mfma_f32_16x16x32_bf16 v[136:139], v[120:123], v[80:83], v[136:139]
    ds_read_b64_tr_b16 v[68:69], v10 offset:16384
    v_mfma_f32_16x16x32_bf16 v[140:143], v[124:127], v[80:83], v[140:143]
    ds_read_b64_tr_b16 v[70:71], v11 offset:16384
    v_mfma_f32_16x16x32_bf16 v[144:147], v[112:115], v[84:87], v[144:147]
    ds_read_b64_tr_b16 v[72:73], v8 offset:24576
    v_mfma_f32_16x16x32_bf16 v[148:151], v[116:119], v[84:87], v[148:151]
    ds_read_b64_tr_b16 v[74:75], v9 offset:24576
    v_mfma_f32_16x16x32_bf16 v[152:155], v[120:123], v[84:87], v[152:155]
    ds_read_b64_tr_b16 v[76:77], v10 offset:24576
    v_mfma_f32_16x16x32_bf16 v[156:159], v[124:127], v[84:87], v[156:159]
    ds_read_b64_tr_b16 v[78:79], v11 offset:24576
    v_mfma_f32_16x16x32_bf16 v[160:163], v[112:115], v[88:91], v[160:163]
    ds_read_b128 v[32:35], v5 offset:0
    v_mfma_f32_16x16x32_bf16 v[164:167], v[116:119], v[88:91], v[164:167]
    ds_read_b128 v[36:39], v5 offset:1024
    v_mfma_f32_16x16x32_bf16 v[168:171], v[120:123], v[88:91], v[168:171]
    ds_read_b128 v[40:43], v5 offset:2048
    v_mfma_f32_16x16x32_bf16 v[172:175], v[124:127], v[88:91], v[172:175]
    ds_read_b128 v[44:47], v5 offset:3072
    v_mfma_f32_16x16x32_bf16 v[176:179], v[112:115], v[92:95], v[176:179]
    ds_read_b128 v[48:51], v5 offset:4096
    v_mfma_f32_16x16x32_bf16 v[180:183], v[116:119], v[92:95], v[180:183]
    ds_read_b128 v[52:55], v5 offset:5120
    v_mfma_f32_16x16x32_bf16 v[184:187], v[120:123], v[92:95], v[184:187]
    ds_read_b128 v[56:59], v5 offset:6144
    v_mfma_f32_16x16x32_bf16 v[188:191], v[124:127], v[92:95], v[188:191]
    ds_read_b128 v[60:63], v5 offset:7168
    v_mfma_f32_16x16x32_bf16 v[192:195], v[112:115], v[96:99], v[192:195]
    v_mfma_f32_16x16x32_bf16 v[196:199], v[116:119], v[96:99], v[196:199]
    s_add_u32 m0, s21, 98304
    s_nop 0
    buffer_load_dwordx4 v1, s[4:7], s16 offen sc1 lds
    s_add_u32 s16, s16, s62
    v_mfma_f32_16x16x32_bf16 v[200:203], v[120:123], v[96:99], v[200:203]
    v_mfma_f32_16x16x32_bf16 v[204:207], v[124:127], v[96:99], v[204:207]
    v_mfma_f32_16x16x32_bf16 v[208:211], v[112:115], v[100:103], v[208:211]
    s_add_u32 m0, s21, 99328
    s_nop 0
    buffer_load_dwordx4 v1, s[4:7], s17 offen sc1 lds
    s_add_u32 s17, s17, s62
    v_mfma_f32_16x16x32_bf16 v[212:215], v[116:119], v[100:103], v[212:215]
    v_mfma_f32_16x16x32_bf16 v[216:219], v[120:123], v[100:103], v[216:219]
    v_mfma_f32_16x16x32_bf16 v[220:223], v[124:127], v[100:103], v[220:223]
    s_add_u32 m0, s22, 98304
    s_nop 0
    buffer_load_dwordx4 v2, s[8:11], s18 offen lds
    s_add_u32 s18, s18, s20
    v_mfma_f32_16x16x32_bf16 v[224:227], v[112:115], v[104:107], v[224:227]
    v_mfma_f32_16x16x32_bf16 v[228:231], v[116:119], v[104:107], v[228:231]
    v_mfma_f32_16x16x32_bf16 v[232:235], v[120:123], v[104:107], v[232:235]
    s_add_u32 m0, s22, 106496
    s_nop 0
    buffer_load_dwordx4 v2, s[12:15], s19 offen lds
    s_add_u32 s19, s19, s20
    v_mfma_f32_16x16x32_bf16 v[236:239], v[124:127], v[104:107], v[236:239]
    v_mfma_f32_16x16x32_bf16 v[240:243], v[112:115], v[108:111], v[240:243]
    v_mfma_f32_16x16x32_bf16 v[244:247], v[116:119], v[108:111], v[244:247]
    v_mfma_f32_16x16x32_bf16 v[248:251], v[120:123], v[108:111], v[248:251]
    v_mfma_f32_16x16x32_bf16 v[252:255], v[124:127], v[108:111], v[252:255]
    s_waitcnt lgkmcnt(0)
    s_sub_u32 s23, s23, 1
    s_cmp_lg_u32 s23, 0
    s_cbranch_scc1 w_loop
    s_branch w_end
w_nd:
    s_waitcnt vmcnt(8)
    s_barrier
    v_mfma_f32_16x16x32_bf16 v[128:131], v[64:67], v[32:35], v[128:131]
    ds_read_b64_tr_b16 v[112:113], v8 offset:49152
    v_mfma_f32_16x16x32_bf16 v[132:135], v[68:71], v[32:35], v[132:135]
    ds_read_b64_tr_b16 v[114:115], v9 offset:49152
    v_mfma_f32_16x16x32_bf16 v[136:139], v[72:75], v[32:35], v[136:139]
    ds_read_b64_tr_b16 v[116:117], v10 offset:49152
    v_mfma_f32_16x16x32_bf16 v[140:143], v[76:79], v[32:35], v[140:143]
    ds_read_b64_tr_b16 v[118:119], v11 offset:49152
    v_mfma_f32_16x16x32_bf16 v[144:147], v[64:67], v[36:39], v[144:147]
    ds_read_b64_tr_b16 v[120:121], v8 offset:57344
    v_mfma_f32_16x16x32_bf16 v[148:151], v[68:71], v[36:39], v[148:151]
    ds_read_b64_tr_b16 v[122:123], v9 offset:57344
    v_mfma_f32_16x16x32_bf16 v[152:155], v[72:75], v[36:39], v[152:155]
    ds_read_b64_tr_b16 v[124:125], v10 offset:57344
    v_mfma_f32_16x16x32_bf16 v[156:159], v[76:79], v[36:39], v[156:159]
    ds_read_b64_tr_b16 v[126:127], v11 offset:57344
    v_mfma_f32_16x16x32_bf16 v[160:163], v[64:67], v[40:43], v[160:163]
    ds_read_b128 v[80:83], v5 offset:32768
    v_mfma_f32_16x16x32_bf16 v[164:167], v[68:71], v[40:43], v[164:167]
    ds_read_b128 v[84:87], v5 offset:33792
    v_mfma_f32_16x16x32_bf16 v[168:171], v[72:75], v[40:43], v[168:171]
    ds_read_b128 v[88:91], v5 offset:34816
    v_mfma_f32_16x16x32_bf16 v[172:175], v[76:79], v[40:43], v[172:175]
    ds_read_b128 v[92:95], v5 offset:35840
    v_mfma_f32_16x16x32_bf16 v[176:179], v[64:67], v[44:47], v[176:179]
    ds_read_b128 v[96:99], v5 offset:36864
    v_mfma_f32_16x16x32_bf16 v[180:183], v[68:71], v[44:47], v[180:183]
    ds_read_b128 v[100:103], v5 offset:37888
    v_mfma_f32_16x16x32_bf16 v[184:187], v[72:75], v[44:47], v[184:187]
    ds_read_b128 v[104:107], v5 offset:38912
    v_mfma_f32_16x16x32_bf16 v[188:191], v[76:79], v[44:47], v[188:191]
    ds_read_b128 v[108:111], v5 offset:39936
    v_mfma_f32_16x16x32_bf16 v[192:195], v[64:67], v[48:51], v[192:195]
    v_mfma_f32_16x16x32_bf16 v[196:199], v[68:71], v[48:51], v[196:199]
    v_mfma_f32_16x16x32_bf16 v[200:203], v[72:75], v[48:51], v[200:203]
    v_mfma_f32_16x16x32_bf16 v[204:207], v[76:79], v[48:51], v[204:207]
    v_mfma_f32_16x16x32_bf16 v[208:211], v[64:67], v[52:55], v[208:211]
    v_mfma_f32_16x16x32_bf16 v[212:215], v[68:71], v[52:55], v[212:215]
    v_mfma_f32_16x16x32_bf16 v[216:219], v[72:75], v[52:55], v[216:219]
    v_mfma_f32_16x16x32_bf16 v[220:223], v[76:79], v[52:55], v[220:223]
    v_mfma_f32_16x16x32_bf16 v[224:227], v[64:67], v[56:59], v[224:227]
    v_mfma_f32_16x16x32_bf16 v[228:231], v[68:71], v[56:59], v[228:231]
    v_mfma_f32_16x16x32_bf16 v[232:235], v[72:75], v[56:59], v[232:235]
    v_mfma_f32_16x16x32_bf16 v[236:239], v[76:79], v[56:59], v[236:239]
    v_mfma_f32_16x16x32_bf16 v[240:243], v[64:67], v[60:63], v[240:243]
    v_mfma_f32_16x16x32_bf16 v[244:247], v[68:71], v[60:63], v[244:247]
    v_mfma_f32_16x16x32_bf16 v[248:251], v[72:75], v[60:63], v[248:251]
    v_mfma_f32_16x16x32_bf16 v[252:255], v[76:79], v[60:63], v[252:255]
    s_waitcnt lgkmcnt(0)
    s_waitcnt vmcnt(4)
    s_barrier
    v_mfma_f32_16x16x32_bf16 v[128:131], v[112:115], v[80:83], v[128:131]
    ds_read_b64_tr_b16 v[64:65], v12 offset:16384
    v_mfma_f32_16x16x32_bf16 v[132:135], v[116:119], v[80:83], v[132:135]
    ds_read_b64_tr_b16 v[66:67], v13 offset:16384
    v_mfma_f32_16x16x32_bf16 v[136:139], v[120:123], v[80:83], v[136:139]
    ds_read_b64_tr_b16 v[68:69], v14 offset:16384
    v_mfma_f32_16x16x32_bf16 v[140:143], v[124:127], v[80:83], v[140:143]
    ds_read_b64_tr_b16 v[70:71], v15 offset:16384
    v_mfma_f32_16x16x32_bf16 v[144:147], v[112:115], v[84:87], v[144:147]
    ds_read_b64_tr_b16 v[72:73], v12 offset:24576
    v_mfma_f32_16x16x32_bf16 v[148:151], v[116:119], v[84:87], v[148:151]
    ds_read_b64_tr_b16 v[74:75], v13 offset:24576
    v_mfma_f32_16x16x32_bf16 v[152:155], v[120:123], v[84:87], v[152:155]
    ds_read_b64_tr_b16 v[76:77], v14 offset:24576
    v_mfma_f32_16x16x32_bf16 v[156:159], v[124:127], v[84:87], v[156:159]
    ds_read_b64_tr_b16 v[78:79], v15 offset:24576
    v_mfma_f32_16x16x32_bf16 v[160:163], v[112:115], v[88:91], v[160:163]
    ds_read_b128 v[32:35], v6 offset:0
    v_mfma_f32_16x16x32_bf16 v[164:167], v[116:119], v[88:91], v[164:167]
    ds_read_b128 v[36:39], v6 offset:1024
    v_mfma_f32_16x16x32_bf16 v[168:171], v[120:123], v[88:91], v[168:171]
    ds_read_b128 v[40:43], v6 offset:2048
    v_mfma_f32_16x16x32_bf16 v[172:175], v[124:127], v[88:91], v[172:175]
    ds_read_b128 v[44:47], v6 offset:3072
    v_mfma_f32_16x16x32_bf16 v[176:179], v[112:115], v[92:95], v[176:179]
    ds_read_b128 v[48:51], v6 offset:4096
    v_mfma_f32_16x16x32_bf16 v[180:183], v[116:119], v[92:95], v[180:183]
    ds_read_b128 v[52:55], v6 offset:5120
    v_mfma_f32_16x16x32_bf16 v[184:187], v[120:123], v[92:95], v[184:187]
    ds_read_b128 v[56:59], v6 offset:6144
    v_mfma_f32_16x16x32_bf16 v[188:191], v[124:127], v[92:95], v[188:191]
    ds_read_b128 v[60:63], v6 offset:7168
    v_mfma_f32_16x16x32_bf16 v[192:195], v[112:115], v[96:99], v[192:195]
    v_mfma_f32_16x16x32_bf16 v[196:199], v[116:119], v[96:99], v[196:199]
    v_mfma_f32_16x16x32_bf16 v[200:203], v[120:123], v[96:99], v[200:203]
    v_mfma_f32_16x16x32_bf16 v[204:207], v[124:127], v[96:99], v[204:207]
    v_mfma_f32_16x16x32_bf16 v[208:211], v[112:115], v[100:103], v[208:211]
    v_mfma_f32_16x16x32_bf16 v[212:215], v[116:119], v[100:103], v[212:215]
    v_mfma_f32_16x16x32_bf16 v[216:219], v[120:123], v[100:103], v[216:219]
    v_mfma_f32_16x16x32_bf16 v[220:223], v[124:127], v[100:103], v[220:223]
    v_mfma_f32_16x16x32_bf16 v[224:227], v[112:115], v[104:107], v[224:227]
    v_mfma_f32_16x16x32_bf16 v[228:231], v[116:119], v[104:107], v[228:231]
    v_mfma_f32_16x16x32_bf16 v[232:235], v[120:123], v[104:107], v[232:235]
    v_mfma_f32_16x16x32_bf16 v[236:239], v[124:127], v[104:107], v[236:239]
    v_mfma_f32_16x16x32_bf16 v[240:243], v[112:115], v[108:111], v[240:243]
    v_mfma_f32_16x16x32_bf16 v[244:247], v[116:119], v[108:111], v[244:247]
    v_mfma_f32_16x16x32_bf16 v[248:251], v[120:123], v[108:111], v[248:251]
    v_mfma_f32_16x16x32_bf16 v[252:255], v[124:127], v[108:111], v[252:255]
    s_waitcnt lgkmcnt(0)
    s_waitcnt vmcnt(0)
    s_barrier
    v_mfma_f32_16x16x32_bf16 v[128:131], v[64:67], v[32:35], v[128:131]
    ds_read_b64_tr_b16 v[112:113], v12 offset:49152
    v_mfma_f32_16x16x32_bf16 v[132:135], v[68:71], v[32:35], v[132:135]
    ds_read_b64_tr_b16 v[114:115], v13 offset:49152
    v_mfma_f32_16x16x32_bf16 v[136:139], v[72:75], v[32:35], v[136:139]
    ds_read_b64_tr_b16 v[116:117], v14 offset:49152
    v_mfma_f32_16x16x32_bf16 v[140:143], v[76:79], v[32:35], v[140:143]
    ds_read_b64_tr_b16 v[118:119], v15 offset:49152
    v_mfma_f32_16x16x32_bf16 v[144:147], v[64:67], v[36:39], v[144:147]
    ds_read_b64_tr_b16 v[120:121], v12 offset:57344
    v_mfma_f32_16x16x32_bf16 v[148:151], v[68:71], v[36:39], v[148:151]
    ds_read_b64_tr_b16 v[122:123], v13 offset:57344
    v_mfma_f32_16x16x32_bf16 v[152:155], v[72:75], v[36:39], v[152:155]
    ds_read_b64_tr_b16 v[124:125], v14 offset:57344
    v_mfma_f32_16x16x32_bf16 v[156:159], v[76:79], v[36:39], v[156:159]
    ds_read_b64_tr_b16 v[126:127], v15 offset:57344
    v_mfma_f32_16x16x32_bf16 v[160:163], v[64:67], v[40:43], v[160:163]
    ds_read_b128 v[80:83], v6 offset:32768
    v_mfma_f32_16x16x32_bf16 v[164:167], v[68:71], v[40:43], v[164:167]
    ds_read_b128 v[84:87], v6 offset:33792
    v_mfma_f32_16x16x32_bf16 v[168:171], v[72:75], v[40:43], v[168:171]
    ds_read_b128 v[88:91], v6 offset:34816
    v_mfma_f32_16x16x32_bf16 v[172:175], v[76:79], v[40:43], v[172:175]
    ds_read_b128 v[92:95], v6 offset:35840
    v_mfma_f32_16x16x32_bf16 v[176:179], v[64:67], v[44:47], v[176:179]
    ds_read_b128 v[96:99], v6 offset:36864
    v_mfma_f32_16x16x32_bf16 v[180:183], v[68:71], v[44:47], v[180:183]
    ds_read_b128 v[100:103], v6 offset:37888
    v_mfma_f32_16x16x32_bf16 v[184:187], v[72:75], v[44:47], v[184:187]
    ds_read_b128 v[104:107], v6 offset:38912
    v_mfma_f32_16x16x32_bf16 v[188:191], v[76:79], v[44:47], v[188:191]
    ds_read_b128 v[108:111], v6 offset:39936
    v_mfma_f32_16x16x32_bf16 v[192:195], v[64:67], v[48:51], v[192:195]
    v_mfma_f32_16x16x32_bf16 v[196:199], v[68:71], v[48:51], v[196:199]
    v_mfma_f32_16x16x32_bf16 v[200:203], v[72:75], v[48:51], v[200:203]
    v_mfma_f32_16x16x32_bf16 v[204:207], v[76:79], v[48:51], v[204:207]
    v_mfma_f32_16x16x32_bf16 v[208:211], v[64:67], v[52:55], v[208:211]
    v_mfma_f32_16x16x32_bf16 v[212:215], v[68:71], v[52:55], v[212:215]
    v_mfma_f32_16x16x32_bf16 v[216:219], v[72:75], v[52:55], v[216:219]
    v_mfma_f32_16x16x32_bf16 v[220:223], v[76:79], v[52:55], v[220:223]
    v_mfma_f32_16x16x32_bf16 v[224:227], v[64:67], v[56:59], v[224:227]
    v_mfma_f32_16x16x32_bf16 v[228:231], v[68:71], v[56:59], v[228:231]
    v_mfma_f32_16x16x32_bf16 v[232:235], v[72:75], v[56:59], v[232:235]
    v_mfma_f32_16x16x32_bf16 v[236:239], v[76:79], v[56:59], v[236:239]
    v_mfma_f32_16x16x32_bf16 v[240:243], v[64:67], v[60:63], v[240:243]
    v_mfma_f32_16x16x32_bf16 v[244:247], v[68:71], v[60:63], v[244:247]
    v_mfma_f32_16x16x32_bf16 v[248:251], v[72:75], v[60:63], v[248:251]
    v_mfma_f32_16x16x32_bf16 v[252:255], v[76:79], v[60:63], v[252:255]
    s_waitcnt lgkmcnt(0)
    s_waitcnt vmcnt(0)
    s_barrier
    v_mfma_f32_16x16x32_bf16 v[128:131], v[112:115], v[80:83], v[128:131]
    ds_read_b64_tr_b16 v[64:65], v8 offset:16384
    v_mfma_f32_16x16x32_bf16 v[132:135], v[116:119], v[80:83], v[132:135]
    ds_read_b64_tr_b16 v[66:67], v9 offset:16384
    v_mfma_f32_16x16x32_bf16 v[136:139], v[120:123], v[80:83], v[136:139]
    ds_read_b64_tr_b16 v[68:69], v10 offset:16384
    v_mfma_f32_16x16x32_bf16 v[140:143], v[124:127], v[80:83], v[140:143]
    ds_read_b64_tr_b16 v[70:71], v11 offset:16384
    v_mfma_f32_16x16x32_bf16 v[144:147], v[112:115], v[84:87], v[144:147]
    ds_read_b64_tr_b16 v[72:73], v8 offset:24576
    v_mfma_f32_16x16x32_bf16 v[148:151], v[116:119], v[84:87], v[148:151]
    ds_read_b64_tr_b16 v[74:75], v9 offset:24576
    v_mfma_f32_16x16x32_bf16 v[152:155], v[120:123], v[84:87], v[152:155]
    ds_read_b64_tr_b16 v[76:77], v10 offset:24576
    v_mfma_f32_16x16x32_bf16 v[156:159], v[124:127], v[84:87], v[156:159]
    ds_read_b64_tr_b16 v[78:79], v11 offset:24576
    v_mfma_f32_16x16x32_bf16 v[160:163], v[112:115], v[88:91], v[160:163]
    ds_read_b128 v[32:35], v5 offset:0
    v_mfma_f32_16x16x32_bf16 v[164:167], v[116:119], v[88:91], v[164:167]
    ds_read_b128 v[36:39], v5 offset:1024
    v_mfma_f32_16x16x32_bf16 v[168:171], v[120:123], v[88:91], v[168:171]
    ds_read_b128 v[40:43], v5 offset:2048
    v_mfma_f32_16x16x32_bf16 v[172:175], v[124:127], v[88:91], v[172:175]
    ds_read_b128 v[44:47], v5 offset:3072
    v_mfma_f32_16x16x32_bf16 v[176:179], v[112:115], v[92:95], v[176:179]
    ds_read_b128 v[48:51], v5 offset:4096
    v_mfma_f32_16x16x32_bf16 v[180:183], v[116:119], v[92:95], v[180:183]
    ds_read_b128 v[52:55], v5 offset:5120
    v_mfma_f32_16x16x32_bf16 v[184:187], v[120:123], v[92:95], v[184:187]
    ds_read_b128 v[56:59], v5 offset:6144
    v_mfma_f32_16x16x32_bf16 v[188:191], v[124:127], v[92:95], v[188:191]
    ds_read_b128 v[60:63], v5 offset:7168
    v_mfma_f32_16x16x32_bf16 v[192:195], v[112:115], v[96:99], v[192:195]
    v_mfma_f32_16x16x32_bf16 v[196:199], v[116:119], v[96:99], v[196:199]
    v_mfma_f32_16x16x32_bf16 v[200:203], v[120:123], v[96:99], v[200:203]
    v_mfma_f32_16x16x32_bf16 v[204:207], v[124:127], v[96:99], v[204:207]
    v_mfma_f32_16x16x32_bf16 v[208:211], v[112:115], v[100:103], v[208:211]
    v_mfma_f32_16x16x32_bf16 v[212:215], v[116:119], v[100:103], v[212:215]
    v_mfma_f32_16x16x32_bf16 v[216:219], v[120:123], v[100:103], v[216:219]
    v_mfma_f32_16x16x32_bf16 v[220:223], v[124:127], v[100:103], v[220:223]
    v_mfma_f32_16x16x32_bf16 v[224:227], v[112:115], v[104:107], v[224:227]
    v_mfma_f32_16x16x32_bf16 v[228:231], v[116:119], v[104:107], v[228:231]
    v_mfma_f32_16x16x32_bf16 v[232:235], v[120:123], v[104:107], v[232:235]
    v_mfma_f32_16x16x32_bf16 v[236:239], v[124:127], v[104:107], v[236:239]
    v_mfma_f32_16x16x32_bf16 v[240:243], v[112:115], v[108:111], v[240:243]
    v_mfma_f32_16x16x32_bf16 v[244:247], v[116:119], v[108:111], v[244:247]
    v_mfma_f32_16x16x32_bf16 v[248:251], v[120:123], v[108:111], v[248:251]
    v_mfma_f32_16x16x32_bf16 v[252:255], v[124:127], v[108:111], v[252:255]
    s_waitcnt lgkmcnt(0)
w_end:
    v_mov_b32 v20, 131072
    ds_read_b128 v[24:27], v20
    ds_read_b128 v[28:31], v20 offset:16
    s_cmp_eq_u32 s48, 2
    s_cbranch_scc1 w_epi_glu
    s_cmp_eq_u32 s48, 3
    s_cbranch_scc1 w_epi_silu
    s_lshl_b32 s30, s27, 10
    s_add_u32 s30, s30, s49
    s_nop 7
    v_cvt_pk_bf16_f32 v80, v128, v129
    v_cvt_pk_bf16_f32 v81, v130, v131
    v_cvt_pk_bf16_f32 v82, v132, v133
    v_cvt_pk_bf16_f32 v83, v134, v135
    buffer_store_dwordx4 v[80:83], v1, s[4:7], s30 offen sc1
    v_cvt_pk_bf16_f32 v84, v136, v137
    v_cvt_pk_bf16_f32 v85, v138, v139
    v_cvt_pk_bf16_f32 v86, v140, v141
    v_cvt_pk_bf16_f32 v87, v142, v143
    buffer_store_dwordx4 v[84:87], v19, s[4:7], s30 offen sc1
    s_add_u32 s30, s30, s50
    v_cvt_pk_bf16_f32 v88, v144, v145
    v_cvt_pk_bf16_f32 v89, v146, v147
    v_cvt_pk_bf16_f32 v90, v148, v149
    v_cvt_pk_bf16_f32 v91, v150, v151
    buffer_store_dwordx4 v[88:91], v1, s[4:7], s30 offen sc1
    v_cvt_pk_bf16_f32 v92, v152, v153
    v_cvt_pk_bf16_f32 v93, v154, v155
    v_cvt_pk_bf16_f32 v94, v156, v157
    v_cvt_pk_bf16_f32 v95, v158, v159
    buffer_store_dwordx4 v[92:95], v19, s[4:7], s30 offen sc1
    s_add_u32 s30, s30, s50
    v_cvt_pk_bf16_f32 v80, v160, v161
    v_cvt_pk_bf16_f32 v81, v162, v163
    v_cvt_pk_bf16_f32 v82, v164, v165
    v_cvt_pk_bf16_f32 v83, v166, v167
    buffer_store_dwordx4 v[80:83], v1, s[4:7], s30 offen sc1
    v_cvt_pk_bf16_f32 v84, v168, v169
    v_cvt_pk_bf16_f32 v85, v170, v171
    v_cvt_pk_bf16_f32 v86, v172, v173
    v_cvt_pk_bf16_f32 v87, v174, v175
    buffer_store_dwordx4 v[84:87], v19, s[4:7], s30 offen sc1
    s_add_u32 s30, s30, s50
    v_cvt_pk_bf16_f32 v88, v176, v177
    v_cvt_pk_bf16_f32 v89, v178, v179
    v_cvt_pk_bf16_f32 v90, v180, v181
    v_cvt_pk_bf16_f32 v91, v182, v183
    buffer_store_dwordx4 v[88:91], v1, s[4:7], s30 offen sc1
    v_cvt_pk_bf16_f32 v92, v184, v185
    v_cvt_pk_bf16_f32 v93, v186, v187
    v_cvt_pk_bf16_f32 v94, v188, v189
    v_cvt_pk_bf16_f32 v95, v190, v191
    buffer_store_dwordx4 v[92:95], v19, s[4:7], s30 offen sc1
    s_add_u32 s30, s30, s50
    v_cvt_pk_bf16_f32 v80, v192, v193
    v_cvt_pk_bf16_f32 v81, v194, v195
    v_cvt_pk_bf16_f32 v82, v196, v197
    v_cvt_pk_bf16_f32 v83, v198, v199
    buffer_store_dwordx4 v[80:83], v1, s[4:7], s30 offen sc1
    v_cvt_pk_bf16_f32 v84, v200, v201
    v_cvt_pk_bf16_f32 v85, v202, v203
    v_cvt_pk_bf16_f32 v86, v204, v205
    v_cvt_pk_bf16_f32 v87, v206, v207
    buffer_store_dwordx4 v[84:87], v19, s[4:7], s30 offen sc1
    s_add_u32 s30, s30, s50
    v_cvt_pk_bf16_f32 v88, v208, v209
    v_cvt_pk_bf16_f32 v89, v210, v211
    v_cvt_pk_bf16_f32 v90, v212, v213
    v_cvt_pk_bf16_f32 v91, v214, v215
    buffer_store_dwordx4 v[88:91], v1, s[4:7], s30 offen sc1
    v_cvt_pk_bf16_f32 v92, v216, v217
    v_cvt_pk_bf16_f32 v93, v218, v219
    v_cvt_pk_bf16_f32 v94, v220, v221
    v_cvt_pk_bf16_f32 v95, v222, v223
    buffer_store_dwordx4 v[92:95], v19, s[4:7], s30 offen sc1
    s_add_u32 s30, s30, s50
    v_cvt_pk_bf16_f32 v80, v224, v225
    v_cvt_pk_bf16_f32 v81, v226, v227
    v_cvt_pk_bf16_f32 v82, v228, v229
    v_cvt_pk_bf16_f32 v83, v230, v231
    buffer_store_dwordx4 v[80:83], v1, s[4:7], s30 offen sc1
    v_cvt_pk_bf16_f32 v84, v232, v233
    v_cvt_pk_bf16_f32 v85, v234, v235
    v_cvt_pk_bf16_f32 v86, v236, v237
    v_cvt_pk_bf16_f32 v87, v238, v239
    buffer_store_dwordx4 v[84:87], v19, s[4:7], s30 offen sc1
    s_add_u32 s30, s30, s50
    v_cvt_pk_bf16_f32 v88, v240, v241
    v_cvt_pk_bf16_f32 v89, v242, v243
    v_cvt_pk_bf16_f32 v90, v244, v245
    v_cvt_pk_bf16_f32 v91, v246, v247
    buffer_store_dwordx4 v[88:91], v1, s[4:7], s30 offen sc1
    v_cvt_pk_bf16_f32 v92, v248, v249
    v_cvt_pk_bf16_f32 v93, v250, v251
    v_cvt_pk_bf16_f32 v94, v252, v253
    v_cvt_pk_bf16_f32 v95, v254, v255
    buffer_store_dwordx4 v[92:95], v19, s[4:7], s30 offen sc1
    s_waitcnt lgkmcnt(0)
    v_or3_b32 v24, v24, v25, v26
    v_or3_b32 v28, v28, v29, v30
    v_or3_b32 v24, v24, v27, v31
    v_or_b32 v24, v24, v28
    s_mov_b32 s28, s51
    s_mov_b32 s57, s53
    v_readfirstlane_b32 s30, v24
    s_cmp_lg_u32 s30, 0
    s_cbranch_scc1 w_drain
    s_mov_b32 s48, s32
    s_cmp_ge_u32 s32, 4
    s_cselect_b32 s30, 2, 3
    s_lshl_b32 s30, s26, s30
    s_mul_i32 s30, s30, s43
    s_add_u32 s49, s42, s30
    s_mov_b32 s50, s43
    s_mov_b32 s51, s46
    s_mov_b32 s23, s41
    s_mov_b32 s53, s47
    s_nop 0
    s_load_dwordx16 s[32:47], s[24:25], 0
    s_add_u32 s24, s24, 64
    s_addc_u32 s25, s25, 0
    s_branch w_first16
w_epi_glu:
    s_lshl_b32 s30, s27, 10
    s_add_u32 s30, s30, s49
    s_mov_b32 s54, 0xbfb8aa3b
    s_nop 7
    v_cvt_pk_bf16_f32 v80, v128, v129
    v_cvt_pk_bf16_f32 v81, v130, v131
    v_cvt_pk_bf16_f32 v82, v132, v133
    v_cvt_pk_bf16_f32 v83, v134, v135
    v_lshlrev_b32 v96, 16, v80
    v_and_b32 v97, 0xffff0000, v80
    v_lshlrev_b32 v98, 16, v81
    v_and_b32 v99, 0xffff0000, v81
    v_lshlrev_b32 v100, 16, v82
    v_and_b32 v101, 0xffff0000, v82
    v_lshlrev_b32 v102, 16, v83
    v_and_b32 v103, 0xffff0000, v83
    v_mul_f32 v96, s54, v96
    v_mul_f32 v97, s54, v97
    v_mul_f32 v98, s54, v98
    v_mul_f32 v99, s54, v99
    v_mul_f32 v100, s54, v100
    v_mul_f32 v101, s54, v101
    v_mul_f32 v102, s54, v102
    v_mul_f32 v103, s54, v103
    v_exp_f32 v96, v96
    v_exp_f32 v97, v97
    v_exp_f32 v98, v98
    v_exp_f32 v99, v99
    v_exp_f32 v100, v100
    v_exp_f32 v101, v101
    v_exp_f32 v102, v102
    v_exp_f32 v103, v103
    v_add_f32 v96, 1.0, v96
    v_add_f32 v97, 1.0, v97
    v_add_f32 v98, 1.0, v98
    v_add_f32 v99, 1.0, v99
    v_add_f32 v100, 1.0, v100
    v_add_f32 v101, 1.0, v101
    v_add_f32 v102, 1.0, v102
    v_add_f32 v103, 1.0, v103
    v_rcp_f32 v96, v96
    v_rcp_f32 v97, v97
    v_rcp_f32 v98, v98
    v_rcp_f32 v99, v99
    v_rcp_f32 v100, v100
    v_rcp_f32 v101, v101
    v_rcp_f32 v102, v102
    v_rcp_f32 v103, v103
    v_mul_f32 v96, v96, v136
    v_mul_f32 v97, v97, v137
    v_mul_f32 v98, v98, v138
    v_mul_f32 v99, v99, v139
    v_mul_f32 v100, v100, v140
    v_mul_f32 v101, v101, v141
    v_mul_f32 v102, v102, v142
    v_mul_f32 v103, v103, v143
    v_cvt_pk_bf16_f32 v80, v96, v97
    v_cvt_pk_bf16_f32 v81, v98, v99
    v_cvt_pk_bf16_f32 v82, v100, v101
    v_cvt_pk_bf16_f32 v83, v102, v103
    buffer_store_dwordx4 v[80:83], v1, s[4:7], s30 offen sc1
    s_add_u32 s30, s30, s50
    v_cvt_pk_bf16_f32 v84, v144, v145
    v_cvt_pk_bf16_f32 v85, v146, v147
    v_cvt_pk_bf16_f32 v86, v148, v149
    v_cvt_pk_bf16_f32 v87, v150, v151
    v_lshlrev_b32 v104, 16, v84
    v_and_b32 v105, 0xffff0000, v84
    v_lshlrev_b32 v106, 16, v85
    v_and_b32 v107, 0xffff0000, v85
    v_lshlrev_b32 v108, 16, v86
    v_and_b32 v109, 0xffff0000, v86
    v_lshlrev_b32 v110, 16, v87
    v_and_b32 v111, 0xffff0000, v87
    v_mul_f32 v104, s54, v104
    v_mul_f32 v105, s54, v105
    v_mul_f32 v106, s54, v106
    v_mul_f32 v107, s54, v107
    v_mul_f32 v108, s54, v108
    v_mul_f32 v109, s54, v109
    v_mul_f32 v110, s54, v110
    v_mul_f32 v111, s54, v111
    v_exp_f32 v104, v104
    v_exp_f32 v105, v105
    v_exp_f32 v106, v106
    v_exp_f32 v107, v107
    v_exp_f32 v108, v108
    v_exp_f32 v109, v109
    v_exp_f32 v110, v110
    v_exp_f32 v111, v111
    v_add_f32 v104, 1.0, v104
    v_add_f32 v105, 1.0, v105
    v_add_f32 v106, 1.0, v106
    v_add_f32 v107, 1.0, v107
    v_add_f32 v108, 1.0, v108
    v_add_f32 v109, 1.0, v109
    v_add_f32 v110, 1.0, v110
    v_add_f32 v111, 1.0, v111
    v_rcp_f32 v104, v104
    v_rcp_f32 v105, v105
    v_rcp_f32 v106, v106
    v_rcp_f32 v107, v107
    v_rcp_f32 v108, v108
    v_rcp_f32 v109, v109
    v_rcp_f32 v110, v110
    v_rcp_f32 v111, v111
    v_mul_f32 v104, v104, v152
    v_mul_f32 v105, v105, v153
    v_mul_f32 v106, v106, v154
    v_mul_f32 v107, v107, v155
    v_mul_f32 v108, v108, v156
    v_mul_f32 v109, v109, v157
    v_mul_f32 v110, v110, v158
    v_mul_f32 v111, v111, v159
    v_cvt_pk_bf16_f32 v84, v104, v105
    v_cvt_pk_bf16_f32 v85, v106, v107
    v_cvt_pk_bf16_f32 v86, v108, v109
    v_cvt_pk_bf16_f32 v87, v110, v111
    buffer_store_dwordx4 v[84:87], v1, s[4:7], s30 offen sc1
    s_add_u32 s30, s30, s50
    v_cvt_pk_bf16_f32 v88, v160, v161
    v_cvt_pk_bf16_f32 v89, v162, v163
    v_cvt_pk_bf16_f32 v90, v164, v165
    v_cvt_pk_bf16_f32 v91, v166, v167
    v_lshlrev_b32 v96, 16, v88
    v_and_b32 v97, 0xffff0000, v88
    v_lshlrev_b32 v98, 16, v89
    v_and_b32 v99, 0xffff0000, v89
    v_lshlrev_b32 v100, 16, v90
    v_and_b32 v101, 0xffff0000, v90
    v_lshlrev_b32 v102, 16, v91
    v_and_b32 v103, 0xffff0000, v91
    v_mul_f32 v96, s54, v96
    v_mul_f32 v97, s54, v97
    v_mul_f32 v98, s54, v98
    v_mul_f32 v99, s54, v99
    v_mul_f32 v100, s54, v100
    v_mul_f32 v101, s54, v101
    v_mul_f32 v102, s54, v102
    v_mul_f32 v103, s54, v103
    v_exp_f32 v96, v96
    v_exp_f32 v97, v97
    v_exp_f32 v98, v98
    v_exp_f32 v99, v99
    v_exp_f32 v100, v100
    v_exp_f32 v101, v101
    v_exp_f32 v102, v102
    v_exp_f32 v103, v103
    v_add_f32 v96, 1.0, v96
    v_add_f32 v97, 1.0, v97
    v_add_f32 v98, 1.0, v98
    v_add_f32 v99, 1.0, v99
    v_add_f32 v100, 1.0, v100
    v_add_f32 v101, 1.0, v101
    v_add_f32 v102, 1.0, v102
    v_add_f32 v103, 1.0, v103
    v_rcp_f32 v96, v96
    v_rcp_f32 v97, v97
    v_rcp_f32 v98, v98
    v_rcp_f32 v99, v99
    v_rcp_f32 v100, v100
    v_rcp_f32 v101, v101
    v_rcp_f32 v102, v102
    v_rcp_f32 v103, v103
    v_mul_f32 v96, v96, v168
    v_mul_f32 v97, v97, v169
    v_mul_f32 v98, v98, v170
    v_mul_f32 v99, v99, v171
    v_mul_f32 v100, v100, v172
    v_mul_f32 v101, v101, v173
    v_mul_f32 v102, v102, v174
    v_mul_f32 v103, v103, v175
    v_cvt_pk_bf16_f32 v88, v96, v97
    v_cvt_pk_bf16_f32 v89, v98, v99
    v_cvt_pk_bf16_f32 v90, v100, v101
    v_cvt_pk_bf16_f32 v91, v102, v103
    buffer_store_dwordx4 v[88:91], v1, s[4:7], s30 offen sc1
    s_add_u32 s30, s30, s50
    v_cvt_pk_bf16_f32 v92, v176, v177
    v_cvt_pk_bf16_f32 v93, v178, v179
    v_cvt_pk_bf16_f32 v94, v180, v181
    v_cvt_pk_bf16_f32 v95, v182, v183
    v_lshlrev_b32 v104, 16, v92
    v_and_b32 v105, 0xffff0000, v92
    v_lshlrev_b32 v106, 16, v93
    v_and_b32 v107, 0xffff0000, v93
    v_lshlrev_b32 v108, 16, v94
    v_and_b32 v109, 0xffff0000, v94
    v_lshlrev_b32 v110, 16, v95
    v_and_b32 v111, 0xffff0000, v95
    v_mul_f32 v104, s54, v104
    v_mul_f32 v105, s54, v105
    v_mul_f32 v106, s54, v106
    v_mul_f32 v107, s54, v107
    v_mul_f32 v108, s54, v108
    v_mul_f32 v109, s54, v109
    v_mul_f32 v110, s54, v110
    v_mul_f32 v111, s54, v111
    v_exp_f32 v104, v104
    v_exp_f32 v105, v105
    v_exp_f32 v106, v106
    v_exp_f32 v107, v107
    v_exp_f32 v108, v108
    v_exp_f32 v109, v109
    v_exp_f32 v110, v110
    v_exp_f32 v111, v111
    v_add_f32 v104, 1.0, v104
    v_add_f32 v105, 1.0, v105
    v_add_f32 v106, 1.0, v106
    v_add_f32 v107, 1.0, v107
    v_add_f32 v108, 1.0, v108
    v_add_f32 v109, 1.0, v109
    v_add_f32 v110, 1.0, v110
    v_add_f32 v111, 1.0, v111
    v_rcp_f32 v104, v104
    v_rcp_f32 v105, v105
    v_rcp_f32 v106, v106
    v_rcp_f32 v107, v107
    v_rcp_f32 v108, v108
    v_rcp_f32 v109, v109
    v_rcp_f32 v110, v110
    v_rcp_f32 v111, v111
    v_mul_f32 v104, v104, v184
    v_mul_f32 v105, v105, v185
    v_mul_f32 v106, v106, v186
    v_mul_f32 v107, v107, v187
    v_mul_f32 v108, v108, v188
    v_mul_f32 v109, v109, v189
    v_mul_f32 v110, v110, v190
    v_mul_f32 v111, v111, v191
    v_cvt_pk_bf16_f32 v92, v104, v105
    v_cvt_pk_bf16_f32 v93, v106, v107
    v_cvt_pk_bf16_f32 v94, v108, v109
    v_cvt_pk_bf16_f32 v95, v110, v111
    buffer_store_dwordx4 v[92:95], v1, s[4:7], s30 offen sc1
    s_add_u32 s30, s30, s50
    v_cvt_pk_bf16_f32 v80, v192, v193
    v_cvt_pk_bf16_f32 v81, v194, v195
    v_cvt_pk_bf16_f32 v82, v196, v197
    v_cvt_pk_bf16_f32 v83, v198, v199
    v_lshlrev_b32 v96, 16, v80
    v_and_b32 v97, 0xffff0000, v80
    v_lshlrev_b32 v98, 16, v81
    v_and_b32 v99, 0xffff0000, v81
    v_lshlrev_b32 v100, 16, v82
    v_and_b32 v101, 0xffff0000, v82
    v_lshlrev_b32 v102, 16, v83
    v_and_b32 v103, 0xffff0000, v83
    v_mul_f32 v96, s54, v96
    v_mul_f32 v97, s54, v97
    v_mul_f32 v98, s54, v98
    v_mul_f32 v99, s54, v99
    v_mul_f32 v100, s54, v100
    v_mul_f32 v101, s54, v101
    v_mul_f32 v102, s54, v102
    v_mul_f32 v103, s54, v103
    v_exp_f32 v96, v96
    v_exp_f32 v97, v97
    v_exp_f32 v98, v98
    v_exp_f32 v99, v99
    v_exp_f32 v100, v100
    v_exp_f32 v101, v101
    v_exp_f32 v102, v102
    v_exp_f32 v103, v103
    v_add_f32 v96, 1.0, v96
    v_add_f32 v97, 1.0, v97
    v_add_f32 v98, 1.0, v98
    v_add_f32 v99, 1.0, v99
    v_add_f32 v100, 1.0, v100
    v_add_f32 v101, 1.0, v101
    v_add_f32 v102, 1.0, v102
    v_add_f32 v103, 1.0, v103
    v_rcp_f32 v96, v96
    v_rcp_f32 v97, v97
    v_rcp_f32 v98, v98
    v_rcp_f32 v99, v99
    v_rcp_f32 v100, v100
    v_rcp_f32 v101, v101
    v_rcp_f32 v102, v102
    v_rcp_f32 v103, v103
    v_mul_f32 v96, v96, v200
    v_mul_f32 v97, v97, v201
    v_mul_f32 v98, v98, v202
    v_mul_f32 v99, v99, v203
    v_mul_f32 v100, v100, v204
    v_mul_f32 v101, v101, v205
    v_mul_f32 v102, v102, v206
    v_mul_f32 v103, v103, v207
    v_cvt_pk_bf16_f32 v80, v96, v97
    v_cvt_pk_bf16_f32 v81, v98, v99
    v_cvt_pk_bf16_f32 v82, v100, v101
    v_cvt_pk_bf16_f32 v83, v102, v103
    buffer_store_dwordx4 v[80:83], v1, s[4:7], s30 offen sc1
    s_add_u32 s30, s30, s50
    v_cvt_pk_bf16_f32 v84, v208, v209
    v_cvt_pk_bf16_f32 v85, v210, v211
    v_cvt_pk_bf16_f32 v86, v212, v213
    v_cvt_pk_bf16_f32 v87, v214, v215
    v_lshlrev_b32 v104, 16, v84
    v_and_b32 v105, 0xffff0000, v84
    v_lshlrev_b32 v106, 16, v85
    v_and_b32 v107, 0xffff0000, v85
    v_lshlrev_b32 v108, 16, v86
    v_and_b32 v109, 0xffff0000, v86
    v_lshlrev_b32 v110, 16, v87
    v_and_b32 v111, 0xffff0000, v87
    v_mul_f32 v104, s54, v104
    v_mul_f32 v105, s54, v105
    v_mul_f32 v106, s54, v106
    v_mul_f32 v107, s54, v107
    v_mul_f32 v108, s54, v108
    v_mul_f32 v109, s54, v109
    v_mul_f32 v110, s54, v110
    v_mul_f32 v111, s54, v111
    v_exp_f32 v104, v104
    v_exp_f32 v105, v105
    v_exp_f32 v106, v106
    v_exp_f32 v107, v107
    v_exp_f32 v108, v108
    v_exp_f32 v109, v109
    v_exp_f32 v110, v110
    v_exp_f32 v111, v111
    v_add_f32 v104, 1.0, v104
    v_add_f32 v105, 1.0, v105
    v_add_f32 v106, 1.0, v106
    v_add_f32 v107, 1.0, v107
    v_add_f32 v108, 1.0, v108
    v_add_f32 v109, 1.0, v109
    v_add_f32 v110, 1.0, v110
    v_add_f32 v111, 1.0, v111
    v_rcp_f32 v104, v104
    v_rcp_f32 v105, v105
    v_rcp_f32 v106, v106
    v_rcp_f32 v107, v107
    v_rcp_f32 v108, v108
    v_rcp_f32 v109, v109
    v_rcp_f32 v110, v110
    v_rcp_f32 v111, v111
    v_mul_f32 v104, v104, v216
    v_mul_f32 v105, v105, v217
    v_mul_f32 v106, v106, v218
    v_mul_f32 v107, v107, v219
    v_mul_f32 v108, v108, v220
    v_mul_f32 v109, v109, v221
    v_mul_f32 v110, v110, v222
    v_mul_f32 v111, v111, v223
    v_cvt_pk_bf16_f32 v84, v104, v105
    v_cvt_pk_bf16_f32 v85, v106, v107
    v_cvt_pk_bf16_f32 v86, v108, v109
    v_cvt_pk_bf16_f32 v87, v110, v111
    buffer_store_dwordx4 v[84:87], v1, s[4:7], s30 offen sc1
    s_add_u32 s30, s30, s50
    v_cvt_pk_bf16_f32 v88, v224, v225
    v_cvt_pk_bf16_f32 v89, v226, v227
    v_cvt_pk_bf16_f32 v90, v228, v229
    v_cvt_pk_bf16_f32 v91, v230, v231
    v_lshlrev_b32 v96, 16, v88
    v_and_b32 v97, 0xffff0000, v88
    v_lshlrev_b32 v98, 16, v89
    v_and_b32 v99, 0xffff0000, v89
    v_lshlrev_b32 v100, 16, v90
    v_and_b32 v101, 0xffff0000, v90
    v_lshlrev_b32 v102, 16, v91
    v_and_b32 v103, 0xffff0000, v91
    v_mul_f32 v96, s54, v96
    v_mul_f32 v97, s54, v97
    v_mul_f32 v98, s54, v98
    v_mul_f32 v99, s54, v99
    v_mul_f32 v100, s54, v100
    v_mul_f32 v101, s54, v101
    v_mul_f32 v102, s54, v102
    v_mul_f32 v103, s54, v103
    v_exp_f32 v96, v96
    v_exp_f32 v97, v97
    v_exp_f32 v98, v98
    v_exp_f32 v99, v99
    v_exp_f32 v100, v100
    v_exp_f32 v101, v101
    v_exp_f32 v102, v102
    v_exp_f32 v103, v103
    v_add_f32 v96, 1.0, v96
    v_add_f32 v97, 1.0, v97
    v_add_f32 v98, 1.0, v98
    v_add_f32 v99, 1.0, v99
    v_add_f32 v100, 1.0, v100
    v_add_f32 v101, 1.0, v101
    v_add_f32 v102, 1.0, v102
    v_add_f32 v103, 1.0, v103
    v_rcp_f32 v96, v96
    v_rcp_f32 v97, v97
    v_rcp_f32 v98, v98
    v_rcp_f32 v99, v99
    v_rcp_f32 v100, v100
    v_rcp_f32 v101, v101
    v_rcp_f32 v102, v102
    v_rcp_f32 v103, v103
    v_mul_f32 v96, v96, v232
    v_mul_f32 v97, v97, v233
    v_mul_f32 v98, v98, v234
    v_mul_f32 v99, v99, v235
    v_mul_f32 v100, v100, v236
    v_mul_f32 v101, v101, v237
    v_mul_f32 v102, v102, v238
    v_mul_f32 v103, v103, v239
    v_cvt_pk_bf16_f32 v88, v96, v97
    v_cvt_pk_bf16_f32 v89, v98, v99
    v_cvt_pk_bf16_f32 v90, v100, v101
    v_cvt_pk_bf16_f32 v91, v102, v103
    buffer_store_dwordx4 v[88:91], v1, s[4:7], s30 offen sc1
    s_add_u32 s30, s30, s50
    v_cvt_pk_bf16_f32 v92, v240, v241
    v_cvt_pk_bf16_f32 v93, v242, v243
    v_cvt_pk_bf16_f32 v94, v244, v245
    v_cvt_pk_bf16_f32 v95, v246, v247
    v_lshlrev_b32 v104, 16, v92
    v_and_b32 v105, 0xffff0000, v92
    v_lshlrev_b32 v106, 16, v93
    v_and_b32 v107, 0xffff0000, v93
    v_lshlrev_b32 v108, 16, v94
    v_and_b32 v109, 0xffff0000, v94
    v_lshlrev_b32 v110, 16, v95
    v_and_b32 v111, 0xffff0000, v95
    v_mul_f32 v104, s54, v104
    v_mul_f32 v105, s54, v105
    v_mul_f32 v106, s54, v106
    v_mul_f32 v107, s54, v107
    v_mul_f32 v108, s54, v108
    v_mul_f32 v109, s54, v109
    v_mul_f32 v110, s54, v110
    v_mul_f32 v111, s54, v111
    v_exp_f32 v104, v104
    v_exp_f32 v105, v105
    v_exp_f32 v106, v106
    v_exp_f32 v107, v107
    v_exp_f32 v108, v108
    v_exp_f32 v109, v109
    v_exp_f32 v110, v110
    v_exp_f32 v111, v111
    v_add_f32 v104, 1.0, v104
    v_add_f32 v105, 1.0, v105
    v_add_f32 v106, 1.0, v106
    v_add_f32 v107, 1.0, v107
    v_add_f32 v108, 1.0, v108
    v_add_f32 v109, 1.0, v109
    v_add_f32 v110, 1.0, v110
    v_add_f32 v111, 1.0, v111
    v_rcp_f32 v104, v104
    v_rcp_f32 v105, v105
    v_rcp_f32 v106, v106
    v_rcp_f32 v107, v107
    v_rcp_f32 v108, v108
    v_rcp_f32 v109, v109
    v_rcp_f32 v110, v110
    v_rcp_f32 v111, v111
    v_mul_f32 v104, v104, v248
    v_mul_f32 v105, v105, v249
    v_mul_f32 v106, v106, v250
    v_mul_f32 v107, v107, v251
    v_mul_f32 v108, v108, v252
    v_mul_f32 v109, v109, v253
    v_mul_f32 v110, v110, v254
    v_mul_f32 v111, v111, v255
    v_cvt_pk_bf16_f32 v92, v104, v105
    v_cvt_pk_bf16_f32 v93, v106, v107
    v_cvt_pk_bf16_f32 v94, v108, v109
    v_cvt_pk_bf16_f32 v95, v110, v111
    buffer_store_dwordx4 v[92:95], v1, s[4:7], s30 offen sc1
    s_waitcnt lgkmcnt(0)
    v_or3_b32 v24, v24, v25, v26
    v_or3_b32 v28, v28, v29, v30
    v_or3_b32 v24, v24, v27, v31
    v_or_b32 v24, v24, v28
    s_mov_b32 s28, s51
    s_mov_b32 s57, s53
    v_readfirstlane_b32 s30, v24
    s_cmp_lg_u32 s30, 0
    s_cbranch_scc1 w_drain
    s_mov_b32 s48, s32
    s_cmp_ge_u32 s32, 4
    s_cselect_b32 s30, 2, 3
    s_lshl_b32 s30, s26, s30
    s_mul_i32 s30, s30, s43
    s_add_u32 s49, s42, s30
    s_mov_b32 s50, s43
    s_mov_b32 s51, s46
    s_mov_b32 s23, s41
    s_mov_b32 s53, s47
    s_nop 0
    s_load_dwordx16 s[32:47], s[24:25], 0
    s_add_u32 s24, s24, 64
    s_addc_u32 s25, s25, 0
    s_branch w_first8
w_epi_silu:
    s_lshl_b32 s30, s27, 10
    s_add_u32 s30, s30, s49
    s_mov_b32 s54, 0xbfb8aa3b
    s_nop 7
    v_cvt_pk_bf16_f32 v80, v128, v129
    v_cvt_pk_bf16_f32 v81, v130, v131
    v_cvt_pk_bf16_f32 v82, v132, v133
    v_cvt_pk_bf16_f32 v83, v134, v135
    v_lshlrev_b32 v128, 16, v80
    v_and_b32 v129, 0xffff0000, v80
    v_lshlrev_b32 v130, 16, v81
    v_and_b32 v131, 0xffff0000, v81
    v_lshlrev_b32 v132, 16, v82
    v_and_b32 v133, 0xffff0000, v82
    v_lshlrev_b32 v134, 16, v83
    v_and_b32 v135, 0xffff0000, v83
    v_mul_f32 v104, s54, v128
    v_mul_f32 v105, s54, v129
    v_mul_f32 v106, s54, v130
    v_mul_f32 v107, s54, v131
    v_mul_f32 v108, s54, v132
    v_mul_f32 v109, s54, v133
    v_mul_f32 v110, s54, v134
    v_mul_f32 v111, s54, v135
    v_exp_f32 v104, v104
    v_exp_f32 v105, v105
    v_exp_f32 v106, v106
    v_exp_f32 v107, v107
    v_exp_f32 v108, v108
    v_exp_f32 v109, v109
    v_exp_f32 v110, v110
    v_exp_f32 v111, v111
    v_add_f32 v104, 1.0, v104
    v_add_f32 v105, 1.0, v105
    v_add_f32 v106, 1.0, v106
    v_add_f32 v107, 1.0, v107
    v_add_f32 v108, 1.0, v108
    v_add_f32 v109, 1.0, v109
    v_add_f32 v110, 1.0, v110
    v_add_f32 v111, 1.0, v111
    v_rcp_f32 v104, v104
    v_rcp_f32 v105, v105
    v_rcp_f32 v106, v106
    v_rcp_f32 v107, v107
    v_rcp_f32 v108, v108
    v_rcp_f32 v109, v109
    v_rcp_f32 v110, v110
    v_rcp_f32 v111, v111
    v_mul_f32 v128, v128, v104
    v_mul_f32 v129, v129, v105
    v_mul_f32 v130, v130, v106
    v_mul_f32 v131, v131, v107
    v_mul_f32 v132, v132, v108
    v_mul_f32 v133, v133, v109
    v_mul_f32 v134, v134, v110
    v_mul_f32 v135, v135, v111
    v_cvt_pk_bf16_f32 v80, v128, v129
    v_cvt_pk_bf16_f32 v81, v130, v131
    v_cvt_pk_bf16_f32 v82, v132, v133
    v_cvt_pk_bf16_f32 v83, v134, v135
    buffer_store_dwordx4 v[80:83], v1, s[4:7], s30 offen sc1
    v_cvt_pk_bf16_f32 v84, v136, v137
    v_cvt_pk_bf16_f32 v85, v138, v139
    v_cvt_pk_bf16_f32 v86, v140, v141
    v_cvt_pk_bf16_f32 v87, v142, v143
    v_lshlrev_b32 v136, 16, v84
    v_and_b32 v137, 0xffff0000, v84
    v_lshlrev_b32 v138, 16, v85
    v_and_b32 v139, 0xffff0000, v85
    v_lshlrev_b32 v140, 16, v86
    v_and_b32 v141, 0xffff0000, v86
    v_lshlrev_b32 v142, 16, v87
    v_and_b32 v143, 0xffff0000, v87
    v_mul_f32 v96, s54, v136
    v_mul_f32 v97, s54, v137
    v_mul_f32 v98, s54, v138
    v_mul_f32 v99, s54, v139
    v_mul_f32 v100, s54, v140
    v_mul_f32 v101, s54, v141
    v_mul_f32 v102, s54, v142
    v_mul_f32 v103, s54, v143
    v_exp_f32 v96, v96
    v_exp_f32 v97, v97
    v_exp_f32 v98, v98
    v_exp_f32 v99, v99
    v_exp_f32 v100, v100
    v_exp_f32 v101, v101
    v_exp_f32 v102, v102
    v_exp_f32 v103, v103
    v_add_f32 v96, 1.0, v96
    v_add_f32 v97, 1.0, v97
    v_add_f32 v98, 1.0, v98
    v_add_f32 v99, 1.0, v99
    v_add_f32 v100, 1.0, v100
    v_add_f32 v101, 1.0, v101
    v_add_f32 v102, 1.0, v102
    v_add_f32 v103, 1.0, v103
    v_rcp_f32 v96, v96
    v_rcp_f32 v97, v97
    v_rcp_f32 v98, v98
    v_rcp_f32 v99, v99
    v_rcp_f32 v100, v100
    v_rcp_f32 v101, v101
    v_rcp_f32 v102, v102
    v_rcp_f32 v103, v103
    v_mul_f32 v136, v136, v96
    v_mul_f32 v137, v137, v97
    v_mul_f32 v138, v138, v98
    v_mul_f32 v139, v139, v99
    v_mul_f32 v140, v140, v100
    v_mul_f32 v141, v141, v101
    v_mul_f32 v142, v142, v102
    v_mul_f32 v143, v143, v103
    v_cvt_pk_bf16_f32 v84, v136, v137
    v_cvt_pk_bf16_f32 v85, v138, v139
    v_cvt_pk_bf16_f32 v86, v140, v141
    v_cvt_pk_bf16_f32 v87, v142, v143
    buffer_store_dwordx4 v[84:87], v19, s[4:7], s30 offen sc1
    s_add_u32 s30, s30, s50
    v_cvt_pk_bf16_f32 v88, v144, v145
    v_cvt_pk_bf16_f32 v89, v146, v147
    v_cvt_pk_bf16_f32 v90, v148, v149
    v_cvt_pk_bf16_f32 v91, v150, v151
    v_lshlrev_b32 v144, 16, v88
    v_and_b32 v145, 0xffff0000, v88
    v_lshlrev_b32 v146, 16, v89
    v_and_b32 v147, 0xffff0000, v89
    v_lshlrev_b32 v148, 16, v90
    v_and_b32 v149, 0xffff0000, v90
    v_lshlrev_b32 v150, 16, v91
    v_and_b32 v151, 0xffff0000, v91
    v_mul_f32 v104, s54, v144
    v_mul_f32 v105, s54, v145
    v_mul_f32 v106, s54, v146
    v_mul_f32 v107, s54, v147
    v_mul_f32 v108, s54, v148
    v_mul_f32 v109, s54, v149
    v_mul_f32 v110, s54, v150
    v_mul_f32 v111, s54, v151
    v_exp_f32 v104, v104
    v_exp_f32 v105, v105
    v_exp_f32 v106, v106
    v_exp_f32 v107, v107
    v_exp_f32 v108, v108
    v_exp_f32 v109, v109
    v_exp_f32 v110, v110
    v_exp_f32 v111, v111
    v_add_f32 v104, 1.0, v104
    v_add_f32 v105, 1.0, v105
    v_add_f32 v106, 1.0, v106
    v_add_f32 v107, 1.0, v107
    v_add_f32 v108, 1.0, v108
    v_add_f32 v109, 1.0, v109
    v_add_f32 v110, 1.0, v110
    v_add_f32 v111, 1.0, v111
    v_rcp_f32 v104, v104
    v_rcp_f32 v105, v105
    v_rcp_f32 v106, v106
    v_rcp_f32 v107, v107
    v_rcp_f32 v108, v108
    v_rcp_f32 v109, v109
    v_rcp_f32 v110, v110
    v_rcp_f32 v111, v111
    v_mul_f32 v144, v144, v104
    v_mul_f32 v145, v145, v105
    v_mul_f32 v146, v146, v106
    v_mul_f32 v147, v147, v107
    v_mul_f32 v148, v148, v108
    v_mul_f32 v149, v149, v109
    v_mul_f32 v150, v150, v110
    v_mul_f32 v151, v151, v111
    v_cvt_pk_bf16_f32 v88, v144, v145
    v_cvt_pk_bf16_f32 v89, v146, v147
    v_cvt_pk_bf16_f32 v90, v148, v149
    v_cvt_pk_bf16_f32 v91, v150, v151
    buffer_store_dwordx4 v[88:91], v1, s[4:7], s30 offen sc1
    v_cvt_pk_bf16_f32 v92, v152, v153
    v_cvt_pk_bf16_f32 v93, v154, v155
    v_cvt_pk_bf16_f32 v94, v156, v157
    v_cvt_pk_bf16_f32 v95, v158, v159
    v_lshlrev_b32 v152, 16, v92
    v_and_b32 v153, 0xffff0000, v92
    v_lshlrev_b32 v154, 16, v93
    v_and_b32 v155, 0xffff0000, v93
    v_lshlrev_b32 v156, 16, v94
    v_and_b32 v157, 0xffff0000, v94
    v_lshlrev_b32 v158, 16, v95
    v_and_b32 v159, 0xffff0000, v95
    v_mul_f32 v96, s54, v152
    v_mul_f32 v97, s54, v153
    v_mul_f32 v98, s54, v154
    v_mul_f32 v99, s54, v155
    v_mul_f32 v100, s54, v156
    v_mul_f32 v101, s54, v157
    v_mul_f32 v102, s54, v158
    v_mul_f32 v103, s54, v159
    v_exp_f32 v96, v96
    v_exp_f32 v97, v97
    v_exp_f32 v98, v98
    v_exp_f32 v99, v99
    v_exp_f32 v100, v100
    v_exp_f32 v101, v101
    v_exp_f32 v102, v102
    v_exp_f32 v103, v103
    v_add_f32 v96, 1.0, v96
    v_add_f32 v97, 1.0, v97
    v_add_f32 v98, 1.0, v98
    v_add_f32 v99, 1.0, v99
    v_add_f32 v100, 1.0, v100
    v_add_f32 v101, 1.0, v101
    v_add_f32 v102, 1.0, v102
    v_add_f32 v103, 1.0, v103
    v_rcp_f32 v96, v96
    v_rcp_f32 v97, v97
    v_rcp_f32 v98, v98
    v_rcp_f32 v99, v99
    v_rcp_f32 v100, v100
    v_rcp_f32 v101, v101
    v_rcp_f32 v102, v102
    v_rcp_f32 v103, v103
    v_mul_f32 v152, v152, v96
    v_mul_f32 v153, v153, v97
    v_mul_f32 v154, v154, v98
    v_mul_f32 v155, v155, v99
    v_mul_f32 v156, v156, v100
    v_mul_f32 v157, v157, v101
    v_mul_f32 v158, v158, v102
    v_mul_f32 v159, v159, v103
    v_cvt_pk_bf16_f32 v92, v152, v153
    v_cvt_pk_bf16_f32 v93, v154, v155
    v_cvt_pk_bf16_f32 v94, v156, v157
    v_cvt_pk_bf16_f32 v95, v158, v159
    buffer_store_dwordx4 v[92:95], v19, s[4:7], s30 offen sc1
    s_add_u32 s30, s30, s50
    v_cvt_pk_bf16_f32 v80, v160, v161
    v_cvt_pk_bf16_f32 v81, v162, v163
    v_cvt_pk_bf16_f32 v82, v164, v165
    v_cvt_pk_bf16_f32 v83, v166, v167
    v_lshlrev_b32 v160, 16, v80
    v_and_b32 v161, 0xffff0000, v80
    v_lshlrev_b32 v162, 16, v81
    v_and_b32 v163, 0xffff0000, v81
    v_lshlrev_b32 v164, 16, v82
    v_and_b32 v165, 0xffff0000, v82
    v_lshlrev_b32 v166, 16, v83
    v_and_b32 v167, 0xffff0000, v83
    v_mul_f32 v104, s54, v160
    v_mul_f32 v105, s54, v161
    v_mul_f32 v106, s54, v162
    v_mul_f32 v107, s54, v163
    v_mul_f32 v108, s54, v164
    v_mul_f32 v109, s54, v165
    v_mul_f32 v110, s54, v166
    v_mul_f32 v111, s54, v167
    v_exp_f32 v104, v104
    v_exp_f32 v105, v105
    v_exp_f32 v106, v106
    v_exp_f32 v107, v107
    v_exp_f32 v108, v108
    v_exp_f32 v109, v109
    v_exp_f32 v110, v110
    v_exp_f32 v111, v111
    v_add_f32 v104, 1.0, v104
    v_add_f32 v105, 1.0, v105
    v_add_f32 v106, 1.0, v106
    v_add_f32 v107, 1.0, v107
    v_add_f32 v108, 1.0, v108
    v_add_f32 v109, 1.0, v109
    v_add_f32 v110, 1.0, v110
    v_add_f32 v111, 1.0, v111
    v_rcp_f32 v104, v104
    v_rcp_f32 v105, v105
    v_rcp_f32 v106, v106
    v_rcp_f32 v107, v107
    v_rcp_f32 v108, v108
    v_rcp_f32 v109, v109
    v_rcp_f32 v110, v110
    v_rcp_f32 v111, v111
    v_mul_f32 v160, v160, v104
    v_mul_f32 v161, v161, v105
    v_mul_f32 v162, v162, v106
    v_mul_f32 v163, v163, v107
    v_mul_f32 v164, v164, v108
    v_mul_f32 v165, v165, v109
    v_mul_f32 v166, v166, v110
    v_mul_f32 v167, v167, v111
    v_cvt_pk_bf16_f32 v80, v160, v161
    v_cvt_pk_bf16_f32 v81, v162, v163
    v_cvt_pk_bf16_f32 v82, v164, v165
    v_cvt_pk_bf16_f32 v83, v166, v167
    buffer_store_dwordx4 v[80:83], v1, s[4:7], s30 offen sc1
    v_cvt_pk_bf16_f32 v84, v168, v169
    v_cvt_pk_bf16_f32 v85, v170, v171
    v_cvt_pk_bf16_f32 v86, v172, v173
    v_cvt_pk_bf16_f32 v87, v174, v175
    v_lshlrev_b32 v168, 16, v84
    v_and_b32 v169, 0xffff0000, v84
    v_lshlrev_b32 v170, 16, v85
    v_and_b32 v171, 0xffff0000, v85
    v_lshlrev_b32 v172, 16, v86
    v_and_b32 v173, 0xffff0000, v86
    v_lshlrev_b32 v174, 16, v87
    v_and_b32 v175, 0xffff0000, v87
    v_mul_f32 v96, s54, v168
    v_mul_f32 v97, s54, v169
    v_mul_f32 v98, s54, v170
    v_mul_f32 v99, s54, v171
    v_mul_f32 v100, s54, v172
    v_mul_f32 v101, s54, v173
    v_mul_f32 v102, s54, v174
    v_mul_f32 v103, s54, v175
    v_exp_f32 v96, v96
    v_exp_f32 v97, v97
    v_exp_f32 v98, v98
    v_exp_f32 v99, v99
    v_exp_f32 v100, v100
    v_exp_f32 v101, v101
    v_exp_f32 v102, v102
    v_exp_f32 v103, v103
    v_add_f32 v96, 1.0, v96
    v_add_f32 v97, 1.0, v97
    v_add_f32 v98, 1.0, v98
    v_add_f32 v99, 1.0, v99
    v_add_f32 v100, 1.0, v100
    v_add_f32 v101, 1.0, v101
    v_add_f32 v102, 1.0, v102
    v_add_f32 v103, 1.0, v103
    v_rcp_f32 v96, v96
    v_rcp_f32 v97, v97
    v_rcp_f32 v98, v98
    v_rcp_f32 v99, v99
    v_rcp_f32 v100, v100
    v_rcp_f32 v101, v101
    v_rcp_f32 v102, v102
    v_rcp_f32 v103, v103
    v_mul_f32 v168, v168, v96
    v_mul_f32 v169, v169, v97
    v_mul_f32 v170, v170, v98
    v_mul_f32 v171, v171, v99
    v_mul_f32 v172, v172, v100
    v_mul_f32 v173, v173, v101
    v_mul_f32 v174, v174, v102
    v_mul_f32 v175, v175, v103
    v_cvt_pk_bf16_f32 v84, v168, v169
    v_cvt_pk_bf16_f32 v85, v170, v171
    v_cvt_pk_bf16_f32 v86, v172, v173
    v_cvt_pk_bf16_f32 v87, v174, v175
    buffer_store_dwordx4 v[84:87], v19, s[4:7], s30 offen sc1
    s_add_u32 s30, s30, s50
    v_cvt_pk_bf16_f32 v88, v176, v177
    v_cvt_pk_bf16_f32 v89, v178, v179
    v_cvt_pk_bf16_f32 v90, v180, v181
    v_cvt_pk_bf16_f32 v91, v182, v183
    v_lshlrev_b32 v176, 16, v88
    v_and_b32 v177, 0xffff0000, v88
    v_lshlrev_b32 v178, 16, v89
    v_and_b32 v179, 0xffff0000, v89
    v_lshlrev_b32 v180, 16, v90
    v_and_b32 v181, 0xffff0000, v90
    v_lshlrev_b32 v182, 16, v91
    v_and_b32 v183, 0xffff0000, v91
    v_mul_f32 v104, s54, v176
    v_mul_f32 v105, s54, v177
    v_mul_f32 v106, s54, v178
    v_mul_f32 v107, s54, v179
    v_mul_f32 v108, s54, v180
    v_mul_f32 v109, s54, v181
    v_mul_f32 v110, s54, v182
    v_mul_f32 v111, s54, v183
    v_exp_f32 v104, v104
    v_exp_f32 v105, v105
    v_exp_f32 v106, v106
    v_exp_f32 v107, v107
    v_exp_f32 v108, v108
    v_exp_f32 v109, v109
    v_exp_f32 v110, v110
    v_exp_f32 v111, v111
    v_add_f32 v104, 1.0, v104
    v_add_f32 v105, 1.0, v105
    v_add_f32 v106, 1.0, v106
    v_add_f32 v107, 1.0, v107
    v_add_f32 v108, 1.0, v108
    v_add_f32 v109, 1.0, v109
    v_add_f32 v110, 1.0, v110
    v_add_f32 v111, 1.0, v111
    v_rcp_f32 v104, v104
    v_rcp_f32 v105, v105
    v_rcp_f32 v106, v106
    v_rcp_f32 v107, v107
    v_rcp_f32 v108, v108
    v_rcp_f32 v109, v109
    v_rcp_f32 v110, v110
    v_rcp_f32 v111, v111
    v_mul_f32 v176, v176, v104
    v_mul_f32 v177, v177, v105
    v_mul_f32 v178, v178, v106
    v_mul_f32 v179, v179, v107
    v_mul_f32 v180, v180, v108
    v_mul_f32 v181, v181, v109
    v_mul_f32 v182, v182, v110
    v_mul_f32 v183, v183, v111
    v_cvt_pk_bf16_f32 v88, v176, v177
    v_cvt_pk_bf16_f32 v89, v178, v179
    v_cvt_pk_bf16_f32 v90, v180, v181
    v_cvt_pk_bf16_f32 v91, v182, v183
    buffer_store_dwordx4 v[88:91], v1, s[4:7], s30 offen sc1
    v_cvt_pk_bf16_f32 v92, v184, v185
    v_cvt_pk_bf16_f32 v93, v186, v187
    v_cvt_pk_bf16_f32 v94, v188, v189
    v_cvt_pk_bf16_f32 v95, v190, v191
    v_lshlrev_b32 v184, 16, v92
    v_and_b32 v185, 0xffff0000, v92
    v_lshlrev_b32 v186, 16, v93
    v_and_b32 v187, 0xffff0000, v93
    v_lshlrev_b32 v188, 16, v94
    v_and_b32 v189, 0xffff0000, v94
    v_lshlrev_b32 v190, 16, v95
    v_and_b32 v191, 0xffff0000, v95
    v_mul_f32 v96, s54, v184
    v_mul_f32 v97, s54, v185
    v_mul_f32 v98, s54, v186
    v_mul_f32 v99, s54, v187
    v_mul_f32 v100, s54, v188
    v_mul_f32 v101, s54, v189
    v_mul_f32 v102, s54, v190
    v_mul_f32 v103, s54, v191
    v_exp_f32 v96, v96
    v_exp_f32 v97, v97
    v_exp_f32 v98, v98
    v_exp_f32 v99, v99
    v_exp_f32 v100, v100
    v_exp_f32 v101, v101
    v_exp_f32 v102, v102
    v_exp_f32 v103, v103
    v_add_f32 v96, 1.0, v96
    v_add_f32 v97, 1.0, v97
    v_add_f32 v98, 1.0, v98
    v_add_f32 v99, 1.0, v99
    v_add_f32 v100, 1.0, v100
    v_add_f32 v101, 1.0, v101
    v_add_f32 v102, 1.0, v102
    v_add_f32 v103, 1.0, v103
    v_rcp_f32 v96, v96
    v_rcp_f32 v97, v97
    v_rcp_f32 v98, v98
    v_rcp_f32 v99, v99
    v_rcp_f32 v100, v100
    v_rcp_f32 v101, v101
    v_rcp_f32 v102, v102
    v_rcp_f32 v103, v103
    v_mul_f32 v184, v184, v96
    v_mul_f32 v185, v185, v97
    v_mul_f32 v186, v186, v98
    v_mul_f32 v187, v187, v99
    v_mul_f32 v188, v188, v100
    v_mul_f32 v189, v189, v101
    v_mul_f32 v190, v190, v102
    v_mul_f32 v191, v191, v103
    v_cvt_pk_bf16_f32 v92, v184, v185
    v_cvt_pk_bf16_f32 v93, v186, v187
    v_cvt_pk_bf16_f32 v94, v188, v189
    v_cvt_pk_bf16_f32 v95, v190, v191
    buffer_store_dwordx4 v[92:95], v19, s[4:7], s30 offen sc1
    s_add_u32 s30, s30, s50
    v_cvt_pk_bf16_f32 v80, v192, v193
    v_cvt_pk_bf16_f32 v81, v194, v195
    v_cvt_pk_bf16_f32 v82, v196, v197
    v_cvt_pk_bf16_f32 v83, v198, v199
    v_lshlrev_b32 v192, 16, v80
    v_and_b32 v193, 0xffff0000, v80
    v_lshlrev_b32 v194, 16, v81
    v_and_b32 v195, 0xffff0000, v81
    v_lshlrev_b32 v196, 16, v82
    v_and_b32 v197, 0xffff0000, v82
    v_lshlrev_b32 v198, 16, v83
    v_and_b32 v199, 0xffff0000, v83
    v_mul_f32 v104, s54, v192
    v_mul_f32 v105, s54, v193
    v_mul_f32 v106, s54, v194
    v_mul_f32 v107, s54, v195
    v_mul_f32 v108, s54, v196
    v_mul_f32 v109, s54, v197
    v_mul_f32 v110, s54, v198
    v_mul_f32 v111, s54, v199
    v_exp_f32 v104, v104
    v_exp_f32 v105, v105
    v_exp_f32 v106, v106
    v_exp_f32 v107, v107
    v_exp_f32 v108, v108
    v_exp_f32 v109, v109
    v_exp_f32 v110, v110
    v_exp_f32 v111, v111
    v_add_f32 v104, 1.0, v104
    v_add_f32 v105, 1.0, v105
    v_add_f32 v106, 1.0, v106
    v_add_f32 v107, 1.0, v107
    v_add_f32 v108, 1.0, v108
    v_add_f32 v109, 1.0, v109
    v_add_f32 v110, 1.0, v110
    v_add_f32 v111, 1.0, v111
    v_rcp_f32 v104, v104
    v_rcp_f32 v105, v105
    v_rcp_f32 v106, v106
    v_rcp_f32 v107, v107
    v_rcp_f32 v108, v108
    v_rcp_f32 v109, v109
    v_rcp_f32 v110, v110
    v_rcp_f32 v111, v111
    v_mul_f32 v192, v192, v104
    v_mul_f32 v193, v193, v105
    v_mul_f32 v194, v194, v106
    v_mul_f32 v195, v195, v107
    v_mul_f32 v196, v196, v108
    v_mul_f32 v197, v197, v109
    v_mul_f32 v198, v198, v110
    v_mul_f32 v199, v199, v111
    v_cvt_pk_bf16_f32 v80, v192, v193
    v_cvt_pk_bf16_f32 v81, v194, v195
    v_cvt_pk_bf16_f32 v82, v196, v197
    v_cvt_pk_bf16_f32 v83, v198, v199
    buffer_store_dwordx4 v[80:83], v1, s[4:7], s30 offen sc1
    v_cvt_pk_bf16_f32 v84, v200, v201
    v_cvt_pk_bf16_f32 v85, v202, v203
    v_cvt_pk_bf16_f32 v86, v204, v205
    v_cvt_pk_bf16_f32 v87, v206, v207
    v_lshlrev_b32 v200, 16, v84
    v_and_b32 v201, 0xffff0000, v84
    v_lshlrev_b32 v202, 16, v85
    v_and_b32 v203, 0xffff0000, v85
    v_lshlrev_b32 v204, 16, v86
    v_and_b32 v205, 0xffff0000, v86
    v_lshlrev_b32 v206, 16, v87
    v_and_b32 v207, 0xffff0000, v87
    v_mul_f32 v96, s54, v200
    v_mul_f32 v97, s54, v201
    v_mul_f32 v98, s54, v202
    v_mul_f32 v99, s54, v203
    v_mul_f32 v100, s54, v204
    v_mul_f32 v101, s54, v205
    v_mul_f32 v102, s54, v206
    v_mul_f32 v103, s54, v207
    v_exp_f32 v96, v96
    v_exp_f32 v97, v97
    v_exp_f32 v98, v98
    v_exp_f32 v99, v99
    v_exp_f32 v100, v100
    v_exp_f32 v101, v101
    v_exp_f32 v102, v102
    v_exp_f32 v103, v103
    v_add_f32 v96, 1.0, v96
    v_add_f32 v97, 1.0, v97
    v_add_f32 v98, 1.0, v98
    v_add_f32 v99, 1.0, v99
    v_add_f32 v100, 1.0, v100
    v_add_f32 v101, 1.0, v101
    v_add_f32 v102, 1.0, v102
    v_add_f32 v103, 1.0, v103
    v_rcp_f32 v96, v96
    v_rcp_f32 v97, v97
    v_rcp_f32 v98, v98
    v_rcp_f32 v99, v99
    v_rcp_f32 v100, v100
    v_rcp_f32 v101, v101
    v_rcp_f32 v102, v102
    v_rcp_f32 v103, v103
    v_mul_f32 v200, v200, v96
    v_mul_f32 v201, v201, v97
    v_mul_f32 v202, v202, v98
    v_mul_f32 v203, v203, v99
    v_mul_f32 v204, v204, v100
    v_mul_f32 v205, v205, v101
    v_mul_f32 v206, v206, v102
    v_mul_f32 v207, v207, v103
    v_cvt_pk_bf16_f32 v84, v200, v201
    v_cvt_pk_bf16_f32 v85, v202, v203
    v_cvt_pk_bf16_f32 v86, v204, v205
    v_cvt_pk_bf16_f32 v87, v206, v207
    buffer_store_dwordx4 v[84:87], v19, s[4:7], s30 offen sc1
    s_add_u32 s30, s30, s50
    v_cvt_pk_bf16_f32 v88, v208, v209
    v_cvt_pk_bf16_f32 v89, v210, v211
    v_cvt_pk_bf16_f32 v90, v212, v213
    v_cvt_pk_bf16_f32 v91, v214, v215
    v_lshlrev_b32 v208, 16, v88
    v_and_b32 v209, 0xffff0000, v88
    v_lshlrev_b32 v210, 16, v89
    v_and_b32 v211, 0xffff0000, v89
    v_lshlrev_b32 v212, 16, v90
    v_and_b32 v213, 0xffff0000, v90
    v_lshlrev_b32 v214, 16, v91
    v_and_b32 v215, 0xffff0000, v91
    v_mul_f32 v104, s54, v208
    v_mul_f32 v105, s54, v209
    v_mul_f32 v106, s54, v210
    v_mul_f32 v107, s54, v211
    v_mul_f32 v108, s54, v212
    v_mul_f32 v109, s54, v213
    v_mul_f32 v110, s54, v214
    v_mul_f32 v111, s54, v215
    v_exp_f32 v104, v104
    v_exp_f32 v105, v105
    v_exp_f32 v106, v106
    v_exp_f32 v107, v107
    v_exp_f32 v108, v108
    v_exp_f32 v109, v109
    v_exp_f32 v110, v110
    v_exp_f32 v111, v111
    v_add_f32 v104, 1.0, v104
    v_add_f32 v105, 1.0, v105
    v_add_f32 v106, 1.0, v106
    v_add_f32 v107, 1.0, v107
    v_add_f32 v108, 1.0, v108
    v_add_f32 v109, 1.0, v109
    v_add_f32 v110, 1.0, v110
    v_add_f32 v111, 1.0, v111
    v_rcp_f32 v104, v104
    v_rcp_f32 v105, v105
    v_rcp_f32 v106, v106
    v_rcp_f32 v107, v107
    v_rcp_f32 v108, v108
    v_rcp_f32 v109, v109
    v_rcp_f32 v110, v110
    v_rcp_f32 v111, v111
    v_mul_f32 v208, v208, v104
    v_mul_f32 v209, v209, v105
    v_mul_f32 v210, v210, v106
    v_mul_f32 v211, v211, v107
    v_mul_f32 v212, v212, v108
    v_mul_f32 v213, v213, v109
    v_mul_f32 v214, v214, v110
    v_mul_f32 v215, v215, v111
    v_cvt_pk_bf16_f32 v88, v208, v209
    v_cvt_pk_bf16_f32 v89, v210, v211
    v_cvt_pk_bf16_f32 v90, v212, v213
    v_cvt_pk_bf16_f32 v91, v214, v215
    buffer_store_dwordx4 v[88:91], v1, s[4:7], s30 offen sc1
    v_cvt_pk_bf16_f32 v92, v216, v217
    v_cvt_pk_bf16_f32 v93, v218, v219
    v_cvt_pk_bf16_f32 v94, v220, v221
    v_cvt_pk_bf16_f32 v95, v222, v223
    v_lshlrev_b32 v216, 16, v92
    v_and_b32 v217, 0xffff0000, v92
    v_lshlrev_b32 v218, 16, v93
    v_and_b32 v219, 0xffff0000, v93
    v_lshlrev_b32 v220, 16, v94
    v_and_b32 v221, 0xffff0000, v94
    v_lshlrev_b32 v222, 16, v95
    v_and_b32 v223, 0xffff0000, v95
    v_mul_f32 v96, s54, v216
    v_mul_f32 v97, s54, v217
    v_mul_f32 v98, s54, v218
    v_mul_f32 v99, s54, v219
    v_mul_f32 v100, s54, v220
    v_mul_f32 v101, s54, v221
    v_mul_f32 v102, s54, v222
    v_mul_f32 v103, s54, v223
    v_exp_f32 v96, v96
    v_exp_f32 v97, v97
    v_exp_f32 v98, v98
    v_exp_f32 v99, v99
    v_exp_f32 v100, v100
    v_exp_f32 v101, v101
    v_exp_f32 v102, v102
    v_exp_f32 v103, v103
    v_add_f32 v96, 1.0, v96
    v_add_f32 v97, 1.0, v97
    v_add_f32 v98, 1.0, v98
    v_add_f32 v99, 1.0, v99
    v_add_f32 v100, 1.0, v100
    v_add_f32 v101, 1.0, v101
    v_add_f32 v102, 1.0, v102
    v_add_f32 v103, 1.0, v103
    v_rcp_f32 v96, v96
    v_rcp_f32 v97, v97
    v_rcp_f32 v98, v98
    v_rcp_f32 v99, v99
    v_rcp_f32 v100, v100
    v_rcp_f32 v101, v101
    v_rcp_f32 v102, v102
    v_rcp_f32 v103, v103
    v_mul_f32 v216, v216, v96
    v_mul_f32 v217, v217, v97
    v_mul_f32 v218, v218, v98
    v_mul_f32 v219, v219, v99
    v_mul_f32 v220, v220, v100
    v_mul_f32 v221, v221, v101
    v_mul_f32 v222, v222, v102
    v_mul_f32 v223, v223, v103
    v_cvt_pk_bf16_f32 v92, v216, v217
    v_cvt_pk_bf16_f32 v93, v218, v219
    v_cvt_pk_bf16_f32 v94, v220, v221
    v_cvt_pk_bf16_f32 v95, v222, v223
    buffer_store_dwordx4 v[92:95], v19, s[4:7], s30 offen sc1
    s_add_u32 s30, s30, s50
    v_cvt_pk_bf16_f32 v80, v224, v225
    v_cvt_pk_bf16_f32 v81, v226, v227
    v_cvt_pk_bf16_f32 v82, v228, v229
    v_cvt_pk_bf16_f32 v83, v230, v231
    v_lshlrev_b32 v224, 16, v80
    v_and_b32 v225, 0xffff0000, v80
    v_lshlrev_b32 v226, 16, v81
    v_and_b32 v227, 0xffff0000, v81
    v_lshlrev_b32 v228, 16, v82
    v_and_b32 v229, 0xffff0000, v82
    v_lshlrev_b32 v230, 16, v83
    v_and_b32 v231, 0xffff0000, v83
    v_mul_f32 v104, s54, v224
    v_mul_f32 v105, s54, v225
    v_mul_f32 v106, s54, v226
    v_mul_f32 v107, s54, v227
    v_mul_f32 v108, s54, v228
    v_mul_f32 v109, s54, v229
    v_mul_f32 v110, s54, v230
    v_mul_f32 v111, s54, v231
    v_exp_f32 v104, v104
    v_exp_f32 v105, v105
    v_exp_f32 v106, v106
    v_exp_f32 v107, v107
    v_exp_f32 v108, v108
    v_exp_f32 v109, v109
    v_exp_f32 v110, v110
    v_exp_f32 v111, v111
    v_add_f32 v104, 1.0, v104
    v_add_f32 v105, 1.0, v105
    v_add_f32 v106, 1.0, v106
    v_add_f32 v107, 1.0, v107
    v_add_f32 v108, 1.0, v108
    v_add_f32 v109, 1.0, v109
    v_add_f32 v110, 1.0, v110
    v_add_f32 v111, 1.0, v111
    v_rcp_f32 v104, v104
    v_rcp_f32 v105, v105
    v_rcp_f32 v106, v106
    v_rcp_f32 v107, v107
    v_rcp_f32 v108, v108
    v_rcp_f32 v109, v109
    v_rcp_f32 v110, v110
    v_rcp_f32 v111, v111
    v_mul_f32 v224, v224, v104
    v_mul_f32 v225, v225, v105
    v_mul_f32 v226, v226, v106
    v_mul_f32 v227, v227, v107
    v_mul_f32 v228, v228, v108
    v_mul_f32 v229, v229, v109
    v_mul_f32 v230, v230, v110
    v_mul_f32 v231, v231, v111
    v_cvt_pk_bf16_f32 v80, v224, v225
    v_cvt_pk_bf16_f32 v81, v226, v227
    v_cvt_pk_bf16_f32 v82, v228, v229
    v_cvt_pk_bf16_f32 v83, v230, v231
    buffer_store_dwordx4 v[80:83], v1, s[4:7], s30 offen sc1
    v_cvt_pk_bf16_f32 v84, v232, v233
    v_cvt_pk_bf16_f32 v85, v234, v235
    v_cvt_pk_bf16_f32 v86, v236, v237
    v_cvt_pk_bf16_f32 v87, v238, v239
    v_lshlrev_b32 v232, 16, v84
    v_and_b32 v233, 0xffff0000, v84
    v_lshlrev_b32 v234, 16, v85
    v_and_b32 v235, 0xffff0000, v85
    v_lshlrev_b32 v236, 16, v86
    v_and_b32 v237, 0xffff0000, v86
    v_lshlrev_b32 v238, 16, v87
    v_and_b32 v239, 0xffff0000, v87
    v_mul_f32 v96, s54, v232
    v_mul_f32 v97, s54, v233
    v_mul_f32 v98, s54, v234
    v_mul_f32 v99, s54, v235
    v_mul_f32 v100, s54, v236
    v_mul_f32 v101, s54, v237
    v_mul_f32 v102, s54, v238
    v_mul_f32 v103, s54, v239
    v_exp_f32 v96, v96
    v_exp_f32 v97, v97
    v_exp_f32 v98, v98
    v_exp_f32 v99, v99
    v_exp_f32 v100, v100
    v_exp_f32 v101, v101
    v_exp_f32 v102, v102
    v_exp_f32 v103, v103
    v_add_f32 v96, 1.0, v96
    v_add_f32 v97, 1.0, v97
    v_add_f32 v98, 1.0, v98
    v_add_f32 v99, 1.0, v99
    v_add_f32 v100, 1.0, v100
    v_add_f32 v101, 1.0, v101
    v_add_f32 v102, 1.0, v102
    v_add_f32 v103, 1.0, v103
    v_rcp_f32 v96, v96
    v_rcp_f32 v97, v97
    v_rcp_f32 v98, v98
    v_rcp_f32 v99, v99
    v_rcp_f32 v100, v100
    v_rcp_f32 v101, v101
    v_rcp_f32 v102, v102
    v_rcp_f32 v103, v103
    v_mul_f32 v232, v232, v96
    v_mul_f32 v233, v233, v97
    v_mul_f32 v234, v234, v98
    v_mul_f32 v235, v235, v99
    v_mul_f32 v236, v236, v100
    v_mul_f32 v237, v237, v101
    v_mul_f32 v238, v238, v102
    v_mul_f32 v239, v239, v103
    v_cvt_pk_bf16_f32 v84, v232, v233
    v_cvt_pk_bf16_f32 v85, v234, v235
    v_cvt_pk_bf16_f32 v86, v236, v237
    v_cvt_pk_bf16_f32 v87, v238, v239
    buffer_store_dwordx4 v[84:87], v19, s[4:7], s30 offen sc1
    s_add_u32 s30, s30, s50
    v_cvt_pk_bf16_f32 v88, v240, v241
    v_cvt_pk_bf16_f32 v89, v242, v243
    v_cvt_pk_bf16_f32 v90, v244, v245
    v_cvt_pk_bf16_f32 v91, v246, v247
    v_lshlrev_b32 v240, 16, v88
    v_and_b32 v241, 0xffff0000, v88
    v_lshlrev_b32 v242, 16, v89
    v_and_b32 v243, 0xffff0000, v89
    v_lshlrev_b32 v244, 16, v90
    v_and_b32 v245, 0xffff0000, v90
    v_lshlrev_b32 v246, 16, v91
    v_and_b32 v247, 0xffff0000, v91
    v_mul_f32 v104, s54, v240
    v_mul_f32 v105, s54, v241
    v_mul_f32 v106, s54, v242
    v_mul_f32 v107, s54, v243
    v_mul_f32 v108, s54, v244
    v_mul_f32 v109, s54, v245
    v_mul_f32 v110, s54, v246
    v_mul_f32 v111, s54, v247
    v_exp_f32 v104, v104
    v_exp_f32 v105, v105
    v_exp_f32 v106, v106
    v_exp_f32 v107, v107
    v_exp_f32 v108, v108
    v_exp_f32 v109, v109
    v_exp_f32 v110, v110
    v_exp_f32 v111, v111
    v_add_f32 v104, 1.0, v104
    v_add_f32 v105, 1.0, v105
    v_add_f32 v106, 1.0, v106
    v_add_f32 v107, 1.0, v107
    v_add_f32 v108, 1.0, v108
    v_add_f32 v109, 1.0, v109
    v_add_f32 v110, 1.0, v110
    v_add_f32 v111, 1.0, v111
    v_rcp_f32 v104, v104
    v_rcp_f32 v105, v105
    v_rcp_f32 v106, v106
    v_rcp_f32 v107, v107
    v_rcp_f32 v108, v108
    v_rcp_f32 v109, v109
    v_rcp_f32 v110, v110
    v_rcp_f32 v111, v111
    v_mul_f32 v240, v240, v104
    v_mul_f32 v241, v241, v105
    v_mul_f32 v242, v242, v106
    v_mul_f32 v243, v243, v107
    v_mul_f32 v244, v244, v108
    v_mul_f32 v245, v245, v109
    v_mul_f32 v246, v246, v110
    v_mul_f32 v247, v247, v111
    v_cvt_pk_bf16_f32 v88, v240, v241
    v_cvt_pk_bf16_f32 v89, v242, v243
    v_cvt_pk_bf16_f32 v90, v244, v245
    v_cvt_pk_bf16_f32 v91, v246, v247
    buffer_store_dwordx4 v[88:91], v1, s[4:7], s30 offen sc1
    v_cvt_pk_bf16_f32 v92, v248, v249
    v_cvt_pk_bf16_f32 v93, v250, v251
    v_cvt_pk_bf16_f32 v94, v252, v253
    v_cvt_pk_bf16_f32 v95, v254, v255
    v_lshlrev_b32 v248, 16, v92
    v_and_b32 v249, 0xffff0000, v92
    v_lshlrev_b32 v250, 16, v93
    v_and_b32 v251, 0xffff0000, v93
    v_lshlrev_b32 v252, 16, v94
    v_and_b32 v253, 0xffff0000, v94
    v_lshlrev_b32 v254, 16, v95
    v_and_b32 v255, 0xffff0000, v95
    v_mul_f32 v96, s54, v248
    v_mul_f32 v97, s54, v249
    v_mul_f32 v98, s54, v250
    v_mul_f32 v99, s54, v251
    v_mul_f32 v100, s54, v252
    v_mul_f32 v101, s54, v253
    v_mul_f32 v102, s54, v254
    v_mul_f32 v103, s54, v255
    v_exp_f32 v96, v96
    v_exp_f32 v97, v97
    v_exp_f32 v98, v98
    v_exp_f32 v99, v99
    v_exp_f32 v100, v100
    v_exp_f32 v101, v101
    v_exp_f32 v102, v102
    v_exp_f32 v103, v103
    v_add_f32 v96, 1.0, v96
    v_add_f32 v97, 1.0, v97
    v_add_f32 v98, 1.0, v98
    v_add_f32 v99, 1.0, v99
    v_add_f32 v100, 1.0, v100
    v_add_f32 v101, 1.0, v101
    v_add_f32 v102, 1.0, v102
    v_add_f32 v103, 1.0, v103
    v_rcp_f32 v96, v96
    v_rcp_f32 v97, v97
    v_rcp_f32 v98, v98
    v_rcp_f32 v99, v99
    v_rcp_f32 v100, v100
    v_rcp_f32 v101, v101
    v_rcp_f32 v102, v102
    v_rcp_f32 v103, v103
    v_mul_f32 v248, v248, v96
    v_mul_f32 v249, v249, v97
    v_mul_f32 v250, v250, v98
    v_mul_f32 v251, v251, v99
    v_mul_f32 v252, v252, v100
    v_mul_f32 v253, v253, v101
    v_mul_f32 v254, v254, v102
    v_mul_f32 v255, v255, v103
    v_cvt_pk_bf16_f32 v92, v248, v249
    v_cvt_pk_bf16_f32 v93, v250, v251
    v_cvt_pk_bf16_f32 v94, v252, v253
    v_cvt_pk_bf16_f32 v95, v254, v255
    buffer_store_dwordx4 v[92:95], v19, s[4:7], s30 offen sc1
    s_waitcnt lgkmcnt(0)
    v_or3_b32 v24, v24, v25, v26
    v_or3_b32 v28, v28, v29, v30
    v_or3_b32 v24, v24, v27, v31
    v_or_b32 v24, v24, v28
    s_mov_b32 s28, s51
    s_mov_b32 s57, s53
    v_readfirstlane_b32 s30, v24
    s_cmp_lg_u32 s30, 0
    s_cbranch_scc1 w_drain
    s_mov_b32 s48, s32
    s_cmp_ge_u32 s32, 4
    s_cselect_b32 s30, 2, 3
    s_lshl_b32 s30, s26, s30
    s_mul_i32 s30, s30, s43
    s_add_u32 s49, s42, s30
    s_mov_b32 s50, s43
    s_mov_b32 s51, s46
    s_mov_b32 s23, s41
    s_mov_b32 s53, s47
    s_nop 0
    s_load_dwordx16 s[32:47], s[24:25], 0
    s_add_u32 s24, s24, 64
    s_addc_u32 s25, s25, 0
    s_branch w_first16
w_firstH:
    s_waitcnt vmcnt(8)
    s_barrier
    s_add_u32 m0, s21, 0
    s_nop 0
    buffer_load_dwordx4 v1, s[4:7], s16 offen sc1 lds
    s_add_u32 s16, s16, s62
    s_add_u32 m0, s21, 1024
    s_nop 0
    buffer_load_dwordx4 v1, s[4:7], s17 offen sc1 lds
    s_add_u32 s17, s17, s62
    s_add_u32 m0, s22, 0
    s_nop 0
    buffer_load_dwordx4 v2, s[8:11], s18 offen lds
    s_add_u32 s18, s18, s20
    s_add_u32 m0, s22, 8192
    s_nop 0
    buffer_load_dwordx4 v2, s[12:15], s19 offen lds
    s_add_u32 s19, s19, s20
    v_mfma_f32_16x16x32_bf16 v[128:131], v[64:67], v[32:35], 0
    ds_read_b64_tr_b16 v[112:113], v8 offset:49152
    v_mfma_f32_16x16x32_bf16 v[132:135], v[68:71], v[32:35], 0
    ds_read_b64_tr_b16 v[114:115], v9 offset:49152
    v_mfma_f32_16x16x32_bf16 v[144:147], v[64:67], v[40:43], 0
    ds_read_b64_tr_b16 v[116:117], v10 offset:49152
    v_mfma_f32_16x16x32_bf16 v[148:151], v[68:71], v[40:43], 0
    ds_read_b64_tr_b16 v[118:119], v11 offset:49152
    v_mfma_f32_16x16x32_bf16 v[160:163], v[64:67], v[48:51], 0
    ds_read_b64_tr_b16 v[120:121], v8 offset:57344
    v_mfma_f32_16x16x32_bf16 v[164:167], v[68:71], v[48:51], 0
    ds_read_b64_tr_b16 v[122:123], v9 offset:57344
    v_mfma_f32_16x16x32_bf16 v[176:179], v[64:67], v[56:59], 0
    ds_read_b64_tr_b16 v[124:125], v10 offset:57344
    v_mfma_f32_16x16x32_bf16 v[180:183], v[68:71], v[56:59], 0
    ds_read_b64_tr_b16 v[126:127], v11 offset:57344
    v_mfma_f32_16x16x32_bf16 v[128:131], v[72:75], v[36:39], v[128:131]
    ds_read_b128 v[80:83], v5 offset:32768
    v_mfma_f32_16x16x32_bf16 v[132:135], v[76:79], v[36:39], v[132:135]
    ds_read_b128 v[84:87], v5 offset:33792
    v_mfma_f32_16x16x32_bf16 v[144:147], v[72:75], v[44:47], v[144:147]
    ds_read_b128 v[88:91], v5 offset:34816
    v_mfma_f32_16x16x32_bf16 v[148:151], v[76:79], v[44:47], v[148:151]
    ds_read_b128 v[92:95], v5 offset:35840
    v_mfma_f32_16x16x32_bf16 v[160:163], v[72:75], v[52:55], v[160:163]
    ds_read_b128 v[96:99], v5 offset:36864
    v_mfma_f32_16x16x32_bf16 v[164:167], v[76:79], v[52:55], v[164:167]
    ds_read_b128 v[100:103], v5 offset:37888
    v_mfma_f32_16x16x32_bf16 v[176:179], v[72:75], v[60:63], v[176:179]
    ds_read_b128 v[104:107], v5 offset:38912
    v_mfma_f32_16x16x32_bf16 v[180:183], v[76:79], v[60:63], v[180:183]
    ds_read_b128 v[108:111], v5 offset:39936
    s_waitcnt lgkmcnt(0)
    s_waitcnt vmcnt(8)
    s_barrier
    s_add_u32 m0, s21, 32768
    s_nop 0
    buffer_load_dwordx4 v1, s[4:7], s16 offen sc1 lds
    s_add_u32 s16, s16, s62
    s_add_u32 m0, s21, 33792
    s_nop 0
    buffer_load_dwordx4 v1, s[4:7], s17 offen sc1 lds
    s_add_u32 s17, s17, s62
    s_add_u32 m0, s22, 32768
    s_nop 0
    buffer_load_dwordx4 v2, s[8:11], s18 offen lds
    s_add_u32 s18, s18, s20
    s_add_u32 m0, s22, 40960
    s_nop 0
    buffer_load_dwordx4 v2, s[12:15], s19 offen lds
    s_add_u32 s19, s19, s20
    v_mfma_f32_16x16x32_bf16 v[128:131], v[112:115], v[80:83], v[128:131]
    ds_read_b64_tr_b16 v[64:65], v12 offset:16384
    v_mfma_f32_16x16x32_bf16 v[132:135], v[116:119], v[80:83], v[132:135]
    ds_read_b64_tr_b16 v[66:67], v13 offset:16384
    v_mfma_f32_16x16x32_bf16 v[144:147], v[112:115], v[88:91], v[144:147]
    ds_read_b64_tr_b16 v[68:69], v14 offset:16384
    v_mfma_f32_16x16x32_bf16 v[148:151], v[116:119], v[88:91], v[148:151]
    ds_read_b64_tr_b16 v[70:71], v15 offset:16384
    v_mfma_f32_16x16x32_bf16 v[160:163], v[112:115], v[96:99], v[160:163]
    ds_read_b64_tr_b16 v[72:73], v12 offset:24576
    v_mfma_f32_16x16x32_bf16 v[164:167], v[116:119], v[96:99], v[164:167]
    ds_read_b64_tr_b16 v[74:75], v13 offset:24576
    v_mfma_f32_16x16x32_bf16 v[176:179], v[112:115], v[104:107], v[176:179]
    ds_read_b64_tr_b16 v[76:77], v14 offset:24576
    v_mfma_f32_16x16x32_bf16 v[180:183], v[116:119], v[104:107], v[180:183]
    ds_read_b64_tr_b16 v[78:79], v15 offset:24576
    v_mfma_f32_16x16x32_bf16 v[128:131], v[120:123], v[84:87], v[128:131]
    ds_read_b128 v[32:35], v6 offset:0
    v_mfma_f32_16x16x32_bf16 v[132:135], v[124:127], v[84:87], v[132:135]
    ds_read_b128 v[36:39], v6 offset:1024
    v_mfma_f32_16x16x32_bf16 v[144:147], v[120:123], v[92:95], v[144:147]
    ds_read_b128 v[40:43], v6 offset:2048
    v_mfma_f32_16x16x32_bf16 v[148:151], v[124:127], v[92:95], v[148:151]
    ds_read_b128 v[44:47], v6 offset:3072
    v_mfma_f32_16x16x32_bf16 v[160:163], v[120:123], v[100:103], v[160:163]
    ds_read_b128 v[48:51], v6 offset:4096
    v_mfma_f32_16x16x32_bf16 v[164:167], v[124:127], v[100:103], v[164:167]
    ds_read_b128 v[52:55], v6 offset:5120
    v_mfma_f32_16x16x32_bf16 v[176:179], v[120:123], v[108:111], v[176:179]
    ds_read_b128 v[56:59], v6 offset:6144
    v_mfma_f32_16x16x32_bf16 v[180:183], v[124:127], v[108:111], v[180:183]
    ds_read_b128 v[60:63], v6 offset:7168
    s_waitcnt lgkmcnt(0)
    s_waitcnt vmcnt(8)
    s_barrier
    s_add_u32 m0, s21, 65536
    s_nop 0
    buffer_load_dwordx4 v1, s[4:7], s16 offen sc1 lds
    s_add_u32 s16, s16, s62
    s_add_u32 m0, s21, 66560
    s_nop 0
    buffer_load_dwordx4 v1, s[4:7], s17 offen sc1 lds
    s_add_u32 s17, s17, s62
    s_add_u32 m0, s22, 65536
    s_nop 0
    buffer_load_dwordx4 v2, s[8:11], s18 offen lds
    s_add_u32 s18, s18, s20
    s_add_u32 m0, s22, 73728
    s_nop 0
    buffer_load_dwordx4 v2, s[12:15], s19 offen lds
    s_add_u32 s19, s19, s20
    v_mfma_f32_16x16x32_bf16 v[128:131], v[64:67], v[32:35], v[128:131]
    ds_read_b64_tr_b16 v[112:113], v12 offset:49152
    v_mfma_f32_16x16x32_bf16 v[132:135], v[68:71], v[32:35], v[132:135]
    ds_read_b64_tr_b16 v[114:115], v13 offset:49152
    v_mfma_f32_16x16x32_bf16 v[144:147], v[64:67], v[40:43], v[144:147]
    ds_read_b64_tr_b16 v[116:117], v14 offset:49152
    v_mfma_f32_16x16x32_bf16 v[148:151], v[68:71], v[40:43], v[148:151]
    ds_read_b64_tr_b16 v[118:119], v15 offset:49152
    v_mfma_f32_16x16x32_bf16 v[160:163], v[64:67], v[48:51], v[160:163]
    ds_read_b64_tr_b16 v[120:121], v12 offset:57344
    v_mfma_f32_16x16x32_bf16 v[164:167], v[68:71], v[48:51], v[164:167]
    ds_read_b64_tr_b16 v[122:123], v13 offset:57344
    v_mfma_f32_16x16x32_bf16 v[176:179], v[64:67], v[56:59], v[176:179]
    ds_read_b64_tr_b16 v[124:125], v14 offset:57344
    v_mfma_f32_16x16x32_bf16 v[180:183], v[68:71], v[56:59], v[180:183]
    ds_read_b64_tr_b16 v[126:127], v15 offset:57344
    v_mfma_f32_16x16x32_bf16 v[128:131], v[72:75], v[36:39], v[128:131]
    ds_read_b128 v[80:83], v6 offset:32768
    v_mfma_f32_16x16x32_bf16 v[132:135], v[76:79], v[36:39], v[132:135]
    ds_read_b128 v[84:87], v6 offset:33792
    v_mfma_f32_16x16x32_bf16 v[144:147], v[72:75], v[44:47], v[144:147]
    ds_read_b128 v[88:91], v6 offset:34816
    v_mfma_f32_16x16x32_bf16 v[148:151], v[76:79], v[44:47], v[148:151]
    ds_read_b128 v[92:95], v6 offset:35840
    v_mfma_f32_16x16x32_bf16 v[160:163], v[72:75], v[52:55], v[160:163]
    ds_read_b128 v[96:99], v6 offset:36864
    v_mfma_f32_16x16x32_bf16 v[164:167], v[76:79], v[52:55], v[164:167]
    ds_read_b128 v[100:103], v6 offset:37888
    v_mfma_f32_16x16x32_bf16 v[176:179], v[72:75], v[60:63], v[176:179]
    ds_read_b128 v[104:107], v6 offset:38912
    v_mfma_f32_16x16x32_bf16 v[180:183], v[76:79], v[60:63], v[180:183]
    ds_read_b128 v[108:111], v6 offset:39936
    s_waitcnt lgkmcnt(0)
    s_waitcnt vmcnt(8)
    s_barrier
    s_add_u32 m0, s21, 98304
    s_nop 0
    buffer_load_dwordx4 v1, s[4:7], s16 offen sc1 lds
    s_add_u32 s16, s16, s62
    s_add_u32 m0, s21, 99328
    s_nop 0
    buffer_load_dwordx4 v1, s[4:7], s17 offen sc1 lds
    s_add_u32 s17, s17, s62
    s_add_u32 m0, s22, 98304
    s_nop 0
    buffer_load_dwordx4 v2, s[8:11], s18 offen lds
    s_add_u32 s18, s18, s20
    s_add_u32 m0, s22, 106496
    s_nop 0
    buffer_load_dwordx4 v2, s[12:15], s19 offen lds
    s_add_u32 s19, s19, s20
    v_mfma_f32_16x16x32_bf16 v[128:131], v[112:115], v[80:83], v[128:131]
    ds_read_b64_tr_b16 v[64:65], v8 offset:16384
    v_mfma_f32_16x16x32_bf16 v[132:135], v[116:119], v[80:83], v[132:135]
    ds_read_b64_tr_b16 v[66:67], v9 offset:16384
    v_mfma_f32_16x16x32_bf16 v[144:147], v[112:115], v[88:91], v[144:147]
    ds_read_b64_tr_b16 v[68:69], v10 offset:16384
    v_mfma_f32_16x16x32_bf16 v[148:151], v[116:119], v[88:91], v[148:151]
    ds_read_b64_tr_b16 v[70:71], v11 offset:16384
    v_mfma_f32_16x16x32_bf16 v[160:163], v[112:115], v[96:99], v[160:163]
    ds_read_b64_tr_b16 v[72:73], v8 offset:24576
    v_mfma_f32_16x16x32_bf16 v[164:167], v[116:119], v[96:99], v[164:167]
    ds_read_b64_tr_b16 v[74:75], v9 offset:24576
    v_mfma_f32_16x16x32_bf16 v[176:179], v[112:115], v[104:107], v[176:179]
    ds_read_b64_tr_b16 v[76:77], v10 offset:24576
    v_mfma_f32_16x16x32_bf16 v[180:183], v[116:119], v[104:107], v[180:183]
    ds_read_b64_tr_b16 v[78:79], v11 offset:24576
    v_mfma_f32_16x16x32_bf16 v[128:131], v[120:123], v[84:87], v[128:131]
    ds_read_b128 v[32:35], v5 offset:0
    v_mfma_f32_16x16x32_bf16 v[132:135], v[124:127], v[84:87], v[132:135]
    ds_read_b128 v[36:39], v5 offset:1024
    v_mfma_f32_16x16x32_bf16 v[144:147], v[120:123], v[92:95], v[144:147]
    ds_read_b128 v[40:43], v5 offset:2048
    v_mfma_f32_16x16x32_bf16 v[148:151], v[124:127], v[92:95], v[148:151]
    ds_read_b128 v[44:47], v5 offset:3072
    v_mfma_f32_16x16x32_bf16 v[160:163], v[120:123], v[100:103], v[160:163]
    ds_read_b128 v[48:51], v5 offset:4096
    v_mfma_f32_16x16x32_bf16 v[164:167], v[124:127], v[100:103], v[164:167]
    ds_read_b128 v[52:55], v5 offset:5120
    v_mfma_f32_16x16x32_bf16 v[176:179], v[120:123], v[108:111], v[176:179]
    ds_read_b128 v[56:59], v5 offset:6144
    v_mfma_f32_16x16x32_bf16 v[180:183], v[124:127], v[108:111], v[180:183]
    ds_read_b128 v[60:63], v5 offset:7168
    s_waitcnt lgkmcnt(0)
w_loop_chkH:
    s_sub_u32 s23, s23, 1
w_loopH:
    s_cmp_lg_u32 s23, 1
    s_cbranch_scc1 w_bodyH
    buffer_load_dword v22, off, s[64:67], 0 sc1
    v_readfirstlane_b32 s30, v16
    s_cmp_ge_u32 s30, s45
    s_cselect_b32 s30, 0, 1
    s_or_b32 s30, s30, s70
    s_cmp_ge_u32 s32, 4
    s_cselect_b32 s30, 1, s30
    s_cmp_eq_u32 s32, 0
    s_cselect_b32 s30, 1, s30
    v_mov_b32 v20, s30
    ds_write_b32 v7, v20
    s_cbranch_scc1 w_ndH
    s_cmp_ge_u32 s32, 4
    s_cbranch_scc1 w_ndH
    s_cmp_lg_u32 s70, 0
    s_cbranch_scc1 w_ndH
    s_load_dwordx2 s[8:9], s[0:1], s33
    s_load_dwordx2 s[12:13], s[0:1], s34
    s_mov_b32 s10, s38
    s_mov_b32 s14, s38
    s_cmp_ge_u32 s32, 4
    s_cselect_b32 s31, 0, 1
    s_lshl_b32 s30, s3, s31
    s_mul_i32 s30, s30, s40
    s_add_u32 s16, s39, s30
    s_cmp_eq_u32 s32, 4
    s_cselect_b32 s30, 1024, s40
    s_cselect_b32 s31, 6, 5
    s_lshl_b32 s62, 32, s31
    s_add_u32 s17, s16, s30
    s_lshl_b32 s30, s3, 2
    s_mul_i32 s30, s30, s35
    s_add_u32 s18, s36, s30
    s_add_u32 s19, s37, s30
    s_lshl_b32 s20, s35, s31
    v_mul_u32_u24 v2, s35, v4
    v_add_u32 v2, v2, v3
    s_waitcnt lgkmcnt(0)
w_bodyH:
    s_waitcnt vmcnt(8)
    s_barrier
    s_add_u32 m0, s21, 0
    s_nop 0
    buffer_load_dwordx4 v1, s[4:7], s16 offen sc1 lds
    s_add_u32 s16, s16, s62
    s_add_u32 m0, s21, 1024
    s_nop 0
    buffer_load_dwordx4 v1, s[4:7], s17 offen sc1 lds
    s_add_u32 s17, s17, s62
    s_add_u32 m0, s22, 0
    s_nop 0
    buffer_load_dwordx4 v2, s[8:11], s18 offen lds
    s_add_u32 s18, s18, s20
    s_add_u32 m0, s22, 8192
    s_nop 0
    buffer_load_dwordx4 v2, s[12:15], s19 offen lds
    s_add_u32 s19, s19, s20
    v_mfma_f32_16x16x32_bf16 v[128:131], v[64:67], v[32:35], v[128:131]
    ds_read_b64_tr_b16 v[112:113], v8 offset:49152
    v_mfma_f32_16x16x32_bf16 v[132:135], v[68:71], v[32:35], v[132:135]
    ds_read_b64_tr_b16 v[114:115], v9 offset:49152
    v_mfma_f32_16x16x32_bf16 v[144:147], v[64:67], v[40:43], v[144:147]
    ds_read_b64_tr_b16 v[116:117], v10 offset:49152
    v_mfma_f32_16x16x32_bf16 v[148:151], v[68:71], v[40:43], v[148:151]
    ds_read_b64_tr_b16 v[118:119], v11 offset:49152
    v_mfma_f32_16x16x32_bf16 v[160:163], v[64:67], v[48:51], v[160:163]
    ds_read_b64_tr_b16 v[120:121], v8 offset:57344
    v_mfma_f32_16x16x32_bf16 v[164:167], v[68:71], v[48:51], v[164:167]
    ds_read_b64_tr_b16 v[122:123], v9 offset:57344
    v_mfma_f32_16x16x32_bf16 v[176:179], v[64:67], v[56:59], v[176:179]
    ds_read_b64_tr_b16 v[124:125], v10 offset:57344
    v_mfma_f32_16x16x32_bf16 v[180:183], v[68:71], v[56:59], v[180:183]
    ds_read_b64_tr_b16 v[126:127], v11 offset:57344
    v_mfma_f32_16x16x32_bf16 v[128:131], v[72:75], v[36:39], v[128:131]
    ds_read_b128 v[80:83], v5 offset:32768
    v_mfma_f32_16x16x32_bf16 v[132:135], v[76:79], v[36:39], v[132:135]
    ds_read_b128 v[84:87], v5 offset:33792
    v_mfma_f32_16x16x32_bf16 v[144:147], v[72:75], v[44:47], v[144:147]
    ds_read_b128 v[88:91], v5 offset:34816
    v_mfma_f32_16x16x32_bf16 v[148:151], v[76:79], v[44:47], v[148:151]
    ds_read_b128 v[92:95], v5 offset:35840
    v_mfma_f32_16x16x32_bf16 v[160:163], v[72:75], v[52:55], v[160:163]
    ds_read_b128 v[96:99], v5 offset:36864
    v_mfma_f32_16x16x32_bf16 v[164:167], v[76:79], v[52:55], v[164:167]
    ds_read_b128 v[100:103], v5 offset:37888
    v_mfma_f32_16x16x32_bf16 v[176:179], v[72:75], v[60:63], v[176:179]
    ds_read_b128 v[104:107], v5 offset:38912
    v_mfma_f32_16x16x32_bf16 v[180:183], v[76:79], v[60:63], v[180:183]
    ds_read_b128 v[108:111], v5 offset:39936
    buffer_load_dword v16, v17, s[4:7], s44 offen sc1
    s_waitcnt lgkmcnt(0)
    s_waitcnt vmcnt(8)
    s_barrier
    s_add_u32 m0, s21, 32768
    s_nop 0
    buffer_load_dwordx4 v1, s[4:7], s16 offen sc1 lds
    s_add_u32 s16, s16, s62
    s_add_u32 m0, s21, 33792
    s_nop 0
    buffer_load_dwordx4 v1, s[4:7], s17 offen sc1 lds
    s_add_u32 s17, s17, s62
    s_add_u32 m0, s22, 32768
    s_nop 0
    buffer_load_dwordx4 v2, s[8:11], s18 offen lds
    s_add_u32 s18, s18, s20
    s_add_u32 m0, s22, 40960
    s_nop 0
    buffer_load_dwordx4 v2, s[12:15], s19 offen lds
    s_add_u32 s19, s19, s20
    v_mfma_f32_16x16x32_bf16 v[128:131], v[112:115], v[80:83], v[128:131]
    ds_read_b64_tr_b16 v[64:65], v12 offset:16384
    v_mfma_f32_16x16x32_bf16 v[132:135], v[116:119], v[80:83], v[132:135]
    ds_read_b64_tr_b16 v[66:67], v13 offset:16384
    v_mfma_f32_16x16x32_bf16 v[144:147], v[112:115], v[88:91], v[144:147]
    ds_read_b64_tr_b16 v[68:69], v14 offset:16384
    v_mfma_f32_16x16x32_bf16 v[148:151], v[116:119], v[88:91], v[148:151]
    ds_read_b64_tr_b16 v[70:71], v15 offset:16384
    v_mfma_f32_16x16x32_bf16 v[160:163], v[112:115], v[96:99], v[160:163]
    ds_read_b64_tr_b16 v[72:73], v12 offset:24576
    v_mfma_f32_16x16x32_bf16 v[164:167], v[116:119], v[96:99], v[164:167]
    ds_read_b64_tr_b16 v[74:75], v13 offset:24576
    v_mfma_f32_16x16x32_bf16 v[176:179], v[112:115], v[104:107], v[176:179]
    ds_read_b64_tr_b16 v[76:77], v14 offset:24576
    v_mfma_f32_16x16x32_bf16 v[180:183], v[116:119], v[104:107], v[180:183]
    ds_read_b64_tr_b16 v[78:79], v15 offset:24576
    v_mfma_f32_16x16x32_bf16 v[128:131], v[120:123], v[84:87], v[128:131]
    ds_read_b128 v[32:35], v6 offset:0
    v_mfma_f32_16x16x32_bf16 v[132:135], v[124:127], v[84:87], v[132:135]
    ds_read_b128 v[36:39], v6 offset:1024
    v_mfma_f32_16x16x32_bf16 v[144:147], v[120:123], v[92:95], v[144:147]
    ds_read_b128 v[40:43], v6 offset:2048
    v_mfma_f32_16x16x32_bf16 v[148:151], v[124:127], v[92:95], v[148:151]
    ds_read_b128 v[44:47], v6 offset:3072
    v_mfma_f32_16x16x32_bf16 v[160:163], v[120:123], v[100:103], v[160:163]
    ds_read_b128 v[48:51], v6 offset:4096
    v_mfma_f32_16x16x32_bf16 v[164:167], v[124:127], v[100:103], v[164:167]
    ds_read_b128 v[52:55], v6 offset:5120
    v_mfma_f32_16x16x32_bf16 v[176:179], v[120:123], v[108:111], v[176:179]
    ds_read_b128 v[56:59], v6 offset:6144
    v_mfma_f32_16x16x32_bf16 v[180:183], v[124:127], v[108:111], v[180:183]
    ds_read_b128 v[60:63], v6 offset:7168
    s_waitcnt lgkmcnt(0)
    s_waitcnt vmcnt(8)
    s_barrier
    s_add_u32 m0, s21, 65536
    s_nop 0
    buffer_load_dwordx4 v1, s[4:7], s16 offen sc1 lds
    s_add_u32 s16, s16, s62
    s_add_u32 m0, s21, 66560
    s_nop 0
    buffer_load_dwordx4 v1, s[4:7], s17 offen sc1 lds
    s_add_u32 s17, s17, s62
    s_add_u32 m0, s22, 65536
    s_nop 0
    buffer_load_dwordx4 v2, s[8:11], s18 offen lds
    s_add_u32 s18, s18, s20
    s_add_u32 m0, s22, 73728
    s_nop 0
    buffer_load_dwordx4 v2, s[12:15], s19 offen lds
    s_add_u32 s19, s19, s20
    v_mfma_f32_16x16x32_bf16 v[128:131], v[64:67], v[32:35], v[128:131]
    ds_read_b64_tr_b16 v[112:113], v12 offset:49152
    v_mfma_f32_16x16x32_bf16 v[132:135], v[68:71], v[32:35], v[132:135]
    ds_read_b64_tr_b16 v[114:115], v13 offset:49152
    v_mfma_f32_16x16x32_bf16 v[144:147], v[64:67], v[40:43], v[144:147]
    ds_read_b64_tr_b16 v[116:117], v14 offset:49152
    v_mfma_f32_16x16x32_bf16 v[148:151], v[68:71], v[40:43], v[148:151]
    ds_read_b64_tr_b16 v[118:119], v15 offset:49152
    v_mfma_f32_16x16x32_bf16 v[160:163], v[64:67], v[48:51], v[160:163]
    ds_read_b64_tr_b16 v[120:121], v12 offset:57344
    v_mfma_f32_16x16x32_bf16 v[164:167], v[68:71], v[48:51], v[164:167]
    ds_read_b64_tr_b16 v[122:123], v13 offset:57344
    v_mfma_f32_16x16x32_bf16 v[176:179], v[64:67], v[56:59], v[176:179]
    ds_read_b64_tr_b16 v[124:125], v14 offset:57344
    v_mfma_f32_16x16x32_bf16 v[180:183], v[68:71], v[56:59], v[180:183]
    ds_read_b64_tr_b16 v[126:127], v15 offset:57344
    v_mfma_f32_16x16x32_bf16 v[128:131], v[72:75], v[36:39], v[128:131]
    ds_read_b128 v[80:83], v6 offset:32768
    v_mfma_f32_16x16x32_bf16 v[132:135], v[76:79], v[36:39], v[132:135]
    ds_read_b128 v[84:87], v6 offset:33792
    v_mfma_f32_16x16x32_bf16 v[144:147], v[72:75], v[44:47], v[144:147]
    ds_read_b128 v[88:91], v6 offset:34816
    v_mfma_f32_16x16x32_bf16 v[148:151], v[76:79], v[44:47], v[148:151]
    ds_read_b128 v[92:95], v6 offset:35840
    v_mfma_f32_16x16x32_bf16 v[160:163], v[72:75], v[52:55], v[160:163]
    ds_read_b128 v[96:99], v6 offset:36864
    v_mfma_f32_16x16x32_bf16 v[164:167], v[76:79], v[52:55], v[164:167]
    ds_read_b128 v[100:103], v6 offset:37888
    v_mfma_f32_16x16x32_bf16 v[176:179], v[72:75], v[60:63], v[176:179]
    ds_read_b128 v[104:107], v6 offset:38912
    v_mfma_f32_16x16x32_bf16 v[180:183], v[76:79], v[60:63], v[180:183]
    ds_read_b128 v[108:111], v6 offset:39936
    s_waitcnt lgkmcnt(0)
    s_waitcnt vmcnt(8)
    s_barrier
    s_add_u32 m0, s21, 98304
    s_nop 0
    buffer_load_dwordx4 v1, s[4:7], s16 offen sc1 lds
    s_add_u32 s16, s16, s62
    s_add_u32 m0, s21, 99328
    s_nop 0
    buffer_load_dwordx4 v1, s[4:7], s17 offen sc1 lds
    s_add_u32 s17, s17, s62
    s_add_u32 m0, s22, 98304
    s_nop 0
    buffer_load_dwordx4 v2, s[8:11], s18 offen lds
    s_add_u32 s18, s18, s20
    s_add_u32 m0, s22, 106496
    s_nop 0
    buffer_load_dwordx4 v2, s[12:15], s19 offen lds
    s_add_u32 s19, s19, s20
    v_mfma_f32_16x16x32_bf16 v[128:131], v[112:115], v[80:83], v[128:131]
    ds_read_b64_tr_b16 v[64:65], v8 offset:16384
    v_mfma_f32_16x16x32_bf16 v[132:135], v[116:119], v[80:83], v[132:135]
    ds_read_b64_tr_b16 v[66:67], v9 offset:16384
    v_mfma_f32_16x16x32_bf16 v[144:147], v[112:115], v[88:91], v[144:147]
    ds_read_b64_tr_b16 v[68:69], v10 offset:16384
    v_mfma_f32_16x16x32_bf16 v[148:151], v[116:119], v[88:91], v[148:151]
    ds_read_b64_tr_b16 v[70:71], v11 offset:16384
    v_mfma_f32_16x16x32_bf16 v[160:163], v[112:115], v[96:99], v[160:163]
    ds_read_b64_tr_b16 v[72:73], v8 offset:24576
    v_mfma_f32_16x16x32_bf16 v[164:167], v[116:119], v[96:99], v[164:167]
    ds_read_b64_tr_b16 v[74:75], v9 offset:24576
    v_mfma_f32_16x16x32_bf16 v[176:179], v[112:115], v[104:107], v[176:179]
    ds_read_b64_tr_b16 v[76:77], v10 offset:24576
    v_mfma_f32_16x16x32_bf16 v[180:183], v[116:119], v[104:107], v[180:183]
    ds_read_b64_tr_b16 v[78:79], v11 offset:24576
    v_mfma_f32_16x16x32_bf16 v[128:131], v[120:123], v[84:87], v[128:131]
    ds_read_b128 v[32:35], v5 offset:0
    v_mfma_f32_16x16x32_bf16 v[132:135], v[124:127], v[84:87], v[132:135]
    ds_read_b128 v[36:39], v5 offset:1024
    v_mfma_f32_16x16x32_bf16 v[144:147], v[120:123], v[92:95], v[144:147]
    ds_read_b128 v[40:43], v5 offset:2048
    v_mfma_f32_16x16x32_bf16 v[148:151], v[124:127], v[92:95], v[148:151]
    ds_read_b128 v[44:47], v5 offset:3072
    v_mfma_f32_16x16x32_bf16 v[160:163], v[120:123], v[100:103], v[160:163]
    ds_read_b128 v[48:51], v5 offset:4096
    v_mfma_f32_16x16x32_bf16 v[164:167], v[124:127], v[100:103], v[164:167]
    ds_read_b128 v[52:55], v5 offset:5120
    v_mfma_f32_16x16x32_bf16 v[176:179], v[120:123], v[108:111], v[176:179]
    ds_read_b128 v[56:59], v5 offset:6144
    v_mfma_f32_16x16x32_bf16 v[180:183], v[124:127], v[108:111], v[180:183]
    ds_read_b128 v[60:63], v5 offset:7168
    s_waitcnt lgkmcnt(0)
    s_sub_u32 s23, s23, 1
    s_cmp_lg_u32 s23, 0
    s_cbranch_scc1 w_loopH
    s_branch w_endH
w_ndH:
    s_waitcnt vmcnt(8)
    s_barrier
    v_mfma_f32_16x16x32_bf16 v[128:131], v[64:67], v[32:35], v[128:131]
    ds_read_b64_tr_b16 v[112:113], v8 offset:49152
    v_mfma_f32_16x16x32_bf16 v[132:135], v[68:71], v[32:35], v[132:135]
    ds_read_b64_tr_b16 v[114:115], v9 offset:49152
    v_mfma_f32_16x16x32_bf16 v[144:147], v[64:67], v[40:43], v[144:147]
    ds_read_b64_tr_b16 v[116:117], v10 offset:49152
    v_mfma_f32_16x16x32_bf16 v[148:151], v[68:71], v[40:43], v[148:151]
    ds_read_b64_tr_b16 v[118:119], v11 offset:49152
    v_mfma_f32_16x16x32_bf16 v[160:163], v[64:67], v[48:51], v[160:163]
    ds_read_b64_tr_b16 v[120:121], v8 offset:57344
    v_mfma_f32_16x16x32_bf16 v[164:167], v[68:71], v[48:51], v[164:167]
    ds_read_b64_tr_b16 v[122:123], v9 offset:57344
    v_mfma_f32_16x16x32_bf16 v[176:179], v[64:67], v[56:59], v[176:179]
    ds_read_b64_tr_b16 v[124:125], v10 offset:57344
    v_mfma_f32_16x16x32_bf16 v[180:183], v[68:71], v[56:59], v[180:183]
    ds_read_b64_tr_b16 v[126:127], v11 offset:57344
    v_mfma_f32_16x16x32_bf16 v[128:131], v[72:75], v[36:39], v[128:131]
    ds_read_b128 v[80:83], v5 offset:32768
    v_mfma_f32_16x16x32_bf16 v[132:135], v[76:79], v[36:39], v[132:135]
    ds_read_b128 v[84:87], v5 offset:33792
    v_mfma_f32_16x16x32_bf16 v[144:147], v[72:75], v[44:47], v[144:147]
    ds_read_b128 v[88:91], v5 offset:34816
    v_mfma_f32_16x16x32_bf16 v[148:151], v[76:79], v[44:47], v[148:151]
    ds_read_b128 v[92:95], v5 offset:35840
    v_mfma_f32_16x16x32_bf16 v[160:163], v[72:75], v[52:55], v[160:163]
    ds_read_b128 v[96:99], v5 offset:36864
    v_mfma_f32_16x16x32_bf16 v[164:167], v[76:79], v[52:55], v[164:167]
    ds_read_b128 v[100:103], v5 offset:37888
    v_mfma_f32_16x16x32_bf16 v[176:179], v[72:75], v[60:63], v[176:179]
    ds_read_b128 v[104:107], v5 offset:38912
    v_mfma_f32_16x16x32_bf16 v[180:183], v[76:79], v[60:63], v[180:183]
    ds_read_b128 v[108:111], v5 offset:39936
    s_waitcnt lgkmcnt(0)
    s_waitcnt vmcnt(4)
    s_barrier
    v_mfma_f32_16x16x32_bf16 v[128:131], v[112:115], v[80:83], v[128:131]
    ds_read_b64_tr_b16 v[64:65], v12 offset:16384
    v_mfma_f32_16x16x32_bf16 v[132:135], v[116:119], v[80:83], v[132:135]
    ds_read_b64_tr_b16 v[66:67], v13 offset:16384
    v_mfma_f32_16x16x32_bf16 v[144:147], v[112:115], v[88:91], v[144:147]
    ds_read_b64_tr_b16 v[68:69], v14 offset:16384
    v_mfma_f32_16x16x32_bf16 v[148:151], v[116:119], v[88:91], v[148:151]
    ds_read_b64_tr_b16 v[70:71], v15 offset:16384
    v_mfma_f32_16x16x32_bf16 v[160:163], v[112:115], v[96:99], v[160:163]
    ds_read_b64_tr_b16 v[72:73], v12 offset:24576
    v_mfma_f32_16x16x32_bf16 v[164:167], v[116:119], v[96:99], v[164:167]
    ds_read_b64_tr_b16 v[74:75], v13 offset:24576
    v_mfma_f32_16x16x32_bf16 v[176:179], v[112:115], v[104:107], v[176:179]
    ds_read_b64_tr_b16 v[76:77], v14 offset:24576
    v_mfma_f32_16x16x32_bf16 v[180:183], v[116:119], v[104:107], v[180:183]
    ds_read_b64_tr_b16 v[78:79], v15 offset:24576
    v_mfma_f32_16x16x32_bf16 v[128:131], v[120:123], v[84:87], v[128:131]
    ds_read_b128 v[32:35], v6 offset:0
    v_mfma_f32_16x16x32_bf16 v[132:135], v[124:127], v[84:87], v[132:135]
    ds_read_b128 v[36:39], v6 offset:1024
    v_mfma_f32_16x16x32_bf16 v[144:147], v[120:123], v[92:95], v[144:147]
    ds_read_b128 v[40:43], v6 offset:2048
    v_mfma_f32_16x16x32_bf16 v[148:151], v[124:127], v[92:95], v[148:151]
    ds_read_b128 v[44:47], v6 offset:3072
    v_mfma_f32_16x16x32_bf16 v[160:163], v[120:123], v[100:103], v[160:163]
    ds_read_b128 v[48:51], v6 offset:4096
    v_mfma_f32_16x16x32_bf16 v[164:167], v[124:127], v[100:103], v[164:167]
    ds_read_b128 v[52:55], v6 offset:5120
    v_mfma_f32_16x16x32_bf16 v[176:179], v[120:123], v[108:111], v[176:179]
    ds_read_b128 v[56:59], v6 offset:6144
    v_mfma_f32_16x16x32_bf16 v[180:183], v[124:127], v[108:111], v[180:183]
    ds_read_b128 v[60:63], v6 offset:7168
    s_waitcnt lgkmcnt(0)
    s_waitcnt vmcnt(0)
    s_barrier
    v_mfma_f32_16x16x32_bf16 v[128:131], v[64:67], v[32:35], v[128:131]
    ds_read_b64_tr_b16 v[112:113], v12 offset:49152
    v_mfma_f32_16x16x32_bf16 v[132:135], v[68:71], v[32:35], v[132:135]
    ds_read_b64_tr_b16 v[114:115], v13 offset:49152
    v_mfma_f32_16x16x32_bf16 v[144:147], v[64:67], v[40:43], v[144:147]
    ds_read_b64_tr_b16 v[116:117], v14 offset:49152
    v_mfma_f32_16x16x32_bf16 v[148:151], v[68:71], v[40:43], v[148:151]
    ds_read_b64_tr_b16 v[118:119], v15 offset:49152
    v_mfma_f32_16x16x32_bf16 v[160:163], v[64:67], v[48:51], v[160:163]
    ds_read_b64_tr_b16 v[120:121], v12 offset:57344
    v_mfma_f32_16x16x32_bf16 v[164:167], v[68:71], v[48:51], v[164:167]
    ds_read_b64_tr_b16 v[122:123], v13 offset:57344
    v_mfma_f32_16x16x32_bf16 v[176:179], v[64:67], v[56:59], v[176:179]
    ds_read_b64_tr_b16 v[124:125], v14 offset:57344
    v_mfma_f32_16x16x32_bf16 v[180:183], v[68:71], v[56:59], v[180:183]
    ds_read_b64_tr_b16 v[126:127], v15 offset:57344
    v_mfma_f32_16x16x32_bf16 v[128:131], v[72:75], v[36:39], v[128:131]
    ds_read_b128 v[80:83], v6 offset:32768
    v_mfma_f32_16x16x32_bf16 v[132:135], v[76:79], v[36:39], v[132:135]
    ds_read_b128 v[84:87], v6 offset:33792
    v_mfma_f32_16x16x32_bf16 v[144:147], v[72:75], v[44:47], v[144:147]
    ds_read_b128 v[88:91], v6 offset:34816
    v_mfma_f32_16x16x32_bf16 v[148:151], v[76:79], v[44:47], v[148:151]
    ds_read_b128 v[92:95], v6 offset:35840
    v_mfma_f32_16x16x32_bf16 v[160:163], v[72:75], v[52:55], v[160:163]
    ds_read_b128 v[96:99], v6 offset:36864
    v_mfma_f32_16x16x32_bf16 v[164:167], v[76:79], v[52:55], v[164:167]
    ds_read_b128 v[100:103], v6 offset:37888
    v_mfma_f32_16x16x32_bf16 v[176:179], v[72:75], v[60:63], v[176:179]
    ds_read_b128 v[104:107], v6 offset:38912
    v_mfma_f32_16x16x32_bf16 v[180:183], v[76:79], v[60:63], v[180:183]
    ds_read_b128 v[108:111], v6 offset:39936
    s_waitcnt lgkmcnt(0)
    s_waitcnt vmcnt(0)
    s_barrier
    v_mfma_f32_16x16x32_bf16 v[128:131], v[112:115], v[80:83], v[128:131]
    ds_read_b64_tr_b16 v[64:65], v8 offset:16384
    v_mfma_f32_16x16x32_bf16 v[132:135], v[116:119], v[80:83], v[132:135]
    ds_read_b64_tr_b16 v[66:67], v9 offset:16384
    v_mfma_f32_16x16x32_bf16 v[144:147], v[112:115], v[88:91], v[144:147]
    ds_read_b64_tr_b16 v[68:69], v10 offset:16384
    v_mfma_f32_16x16x32_bf16 v[148:151], v[116:119], v[88:91], v[148:151]
    ds_read_b64_tr_b16 v[70:71], v11 offset:16384
    v_mfma_f32_16x16x32_bf16 v[160:163], v[112:115], v[96:99], v[160:163]
    ds_read_b64_tr_b16 v[72:73], v8 offset:24576
    v_mfma_f32_16x16x32_bf16 v[164:167], v[116:119], v[96:99], v[164:167]
    ds_read_b64_tr_b16 v[74:75], v9 offset:24576
    v_mfma_f32_16x16x32_bf16 v[176:179], v[112:115], v[104:107], v[176:179]
    ds_read_b64_tr_b16 v[76:77], v10 offset:24576
    v_mfma_f32_16x16x32_bf16 v[180:183], v[116:119], v[104:107], v[180:183]
    ds_read_b64_tr_b16 v[78:79], v11 offset:24576
    v_mfma_f32_16x16x32_bf16 v[128:131], v[120:123], v[84:87], v[128:131]
    ds_read_b128 v[32:35], v5 offset:0
    v_mfma_f32_16x16x32_bf16 v[132:135], v[124:127], v[84:87], v[132:135]
    ds_read_b128 v[36:39], v5 offset:1024
    v_mfma_f32_16x16x32_bf16 v[144:147], v[120:123], v[92:95], v[144:147]
    ds_read_b128 v[40:43], v5 offset:2048
    v_mfma_f32_16x16x32_bf16 v[148:151], v[124:127], v[92:95], v[148:151]
    ds_read_b128 v[44:47], v5 offset:3072
    v_mfma_f32_16x16x32_bf16 v[160:163], v[120:123], v[100:103], v[160:163]
    ds_read_b128 v[48:51], v5 offset:4096
    v_mfma_f32_16x16x32_bf16 v[164:167], v[124:127], v[100:103], v[164:167]
    ds_read_b128 v[52:55], v5 offset:5120
    v_mfma_f32_16x16x32_bf16 v[176:179], v[120:123], v[108:111], v[176:179]
    ds_read_b128 v[56:59], v5 offset:6144
    v_mfma_f32_16x16x32_bf16 v[180:183], v[124:127], v[108:111], v[180:183]
    ds_read_b128 v[60:63], v5 offset:7168
    s_waitcnt lgkmcnt(0)
w_endH:
    v_mov_b32 v20, 131072
    ds_read_b128 v[24:27], v20
    ds_read_b128 v[28:31], v20 offset:16
    s_cmp_lg_u32 s53, s53
    s_cbranch_scc1 w_epi_siluH
    s_lshl_b32 s30, s27, 10
    s_add_u32 s30, s30, s49
    s_nop 7
    v_cvt_pk_bf16_f32 v80, v128, v129
    v_cvt_pk_bf16_f32 v81, v130, v131
    v_cvt_pk_bf16_f32 v82, v132, v133
    v_cvt_pk_bf16_f32 v83, v134, v135
    buffer_store_dwordx4 v[80:83], v1, s[4:7], s30 offen sc1
    s_add_u32 s30, s30, s50
    v_cvt_pk_bf16_f32 v84, v144, v145
    v_cvt_pk_bf16_f32 v85, v146, v147
    v_cvt_pk_bf16_f32 v86, v148, v149
    v_cvt_pk_bf16_f32 v87, v150, v151
    buffer_store_dwordx4 v[84:87], v1, s[4:7], s30 offen sc1
    s_add_u32 s30, s30, s50
    v_cvt_pk_bf16_f32 v88, v160, v161
    v_cvt_pk_bf16_f32 v89, v162, v163
    v_cvt_pk_bf16_f32 v90, v164, v165
    v_cvt_pk_bf16_f32 v91, v166, v167
    buffer_store_dwordx4 v[88:91], v1, s[4:7], s30 offen sc1
    s_add_u32 s30, s30, s50
    v_cvt_pk_bf16_f32 v92, v176, v177
    v_cvt_pk_bf16_f32 v93, v178, v179
    v_cvt_pk_bf16_f32 v94, v180, v181
    v_cvt_pk_bf16_f32 v95, v182, v183
    buffer_store_dwordx4 v[92:95], v1, s[4:7], s30 offen sc1
    s_add_u32 s30, s30, s50
    s_waitcnt lgkmcnt(0)
    v_or3_b32 v24, v24, v25, v26
    v_or3_b32 v28, v28, v29, v30
    v_or3_b32 v24, v24, v27, v31
    v_or_b32 v24, v24, v28
    s_mov_b32 s28, s51
    s_mov_b32 s57, s53
    v_readfirstlane_b32 s30, v24
    s_cmp_lg_u32 s30, 0
    s_cbranch_scc1 w_drain
    s_mov_b32 s48, s32
    s_cmp_ge_u32 s32, 4
    s_cselect_b32 s30, 2, 3
    s_lshl_b32 s30, s26, s30
    s_mul_i32 s30, s30, s43
    s_add_u32 s49, s42, s30
    s_mov_b32 s50, s43
    s_mov_b32 s51, s46
    s_mov_b32 s23, s41
    s_mov_b32 s53, s47
    s_nop 0
    s_load_dwordx16 s[32:47], s[24:25], 0
    s_add_u32 s24, s24, 64
    s_addc_u32 s25, s25, 0
    s_branch w_first4
w_epi_siluH:
    s_lshl_b32 s30, s27, 10
    s_add_u32 s30, s30, s49
    s_mov_b32 s54, 0xbfb8aa3b
    s_nop 7
    v_cvt_pk_bf16_f32 v80, v128, v129
    v_cvt_pk_bf16_f32 v81, v130, v131
    v_cvt_pk_bf16_f32 v82, v132, v133
    v_cvt_pk_bf16_f32 v83, v134, v135
    v_lshlrev_b32 v128, 16, v80
    v_and_b32 v129, 0xffff0000, v80
    v_lshlrev_b32 v130, 16, v81
    v_and_b32 v131, 0xffff0000, v81
    v_lshlrev_b32 v132, 16, v82
    v_and_b32 v133, 0xffff0000, v82
    v_lshlrev_b32 v134, 16, v83
    v_and_b32 v135, 0xffff0000, v83
    v_mul_f32 v104, s54, v128
    v_mul_f32 v105, s54, v129
    v_mul_f32 v106, s54, v130
    v_mul_f32 v107, s54, v131
    v_mul_f32 v108, s54, v132
    v_mul_f32 v109, s54, v133
    v_mul_f32 v110, s54, v134
    v_mul_f32 v111, s54, v135
    v_exp_f32 v104, v104
    v_exp_f32 v105, v105
    v_exp_f32 v106, v106
    v_exp_f32 v107, v107
    v_exp_f32 v108, v108
    v_exp_f32 v109, v109
    v_exp_f32 v110, v110
    v_exp_f32 v111, v111
    v_add_f32 v104, 1.0, v104
    v_add_f32 v105, 1.0, v105
    v_add_f32 v106, 1.0, v106
    v_add_f32 v107, 1.0, v107
    v_add_f32 v108, 1.0, v108
    v_add_f32 v109, 1.0, v109
    v_add_f32 v110, 1.0, v110
    v_add_f32 v111, 1.0, v111
    v_rcp_f32 v104, v104
    v_rcp_f32 v105, v105
    v_rcp_f32 v106, v106
    v_rcp_f32 v107, v107
    v_rcp_f32 v108, v108
    v_rcp_f32 v109, v109
    v_rcp_f32 v110, v110
    v_rcp_f32 v111, v111
    v_mul_f32 v128, v128, v104
    v_mul_f32 v129, v129, v105
    v_mul_f32 v130, v130, v106
    v_mul_f32 v131, v131, v107
    v_mul_f32 v132, v132, v108
    v_mul_f32 v133, v133, v109
    v_mul_f32 v134, v134, v110
    v_mul_f32 v135, v135, v111
    v_cvt_pk_bf16_f32 v80, v128, v129
    v_cvt_pk_bf16_f32 v81, v130, v131
    v_cvt_pk_bf16_f32 v82, v132, v133
    v_cvt_pk_bf16_f32 v83, v134, v135
    buffer_store_dwordx4 v[80:83], v1, s[4:7], s30 offen sc1
    s_add_u32 s30, s30, s50
    v_cvt_pk_bf16_f32 v84, v144, v145
    v_cvt_pk_bf16_f32 v85, v146, v147
    v_cvt_pk_bf16_f32 v86, v148, v149
    v_cvt_pk_bf16_f32 v87, v150, v151
    v_lshlrev_b32 v144, 16, v84
    v_and_b32 v145, 0xffff0000, v84
    v_lshlrev_b32 v146, 16, v85
    v_and_b32 v147, 0xffff0000, v85
    v_lshlrev_b32 v148, 16, v86
    v_and_b32 v149, 0xffff0000, v86
    v_lshlrev_b32 v150, 16, v87
    v_and_b32 v151, 0xffff0000, v87
    v_mul_f32 v96, s54, v144
    v_mul_f32 v97, s54, v145
    v_mul_f32 v98, s54, v146
    v_mul_f32 v99, s54, v147
    v_mul_f32 v100, s54, v148
    v_mul_f32 v101, s54, v149
    v_mul_f32 v102, s54, v150
    v_mul_f32 v103, s54, v151
    v_exp_f32 v96, v96
    v_exp_f32 v97, v97
    v_exp_f32 v98, v98
    v_exp_f32 v99, v99
    v_exp_f32 v100, v100
    v_exp_f32 v101, v101
    v_exp_f32 v102, v102
    v_exp_f32 v103, v103
    v_add_f32 v96, 1.0, v96
    v_add_f32 v97, 1.0, v97
    v_add_f32 v98, 1.0, v98
    v_add_f32 v99, 1.0, v99
    v_add_f32 v100, 1.0, v100
    v_add_f32 v101, 1.0, v101
    v_add_f32 v102, 1.0, v102
    v_add_f32 v103, 1.0, v103
    v_rcp_f32 v96, v96
    v_rcp_f32 v97, v97
    v_rcp_f32 v98, v98
    v_rcp_f32 v99, v99
    v_rcp_f32 v100, v100
    v_rcp_f32 v101, v101
    v_rcp_f32 v102, v102
    v_rcp_f32 v103, v103
    v_mul_f32 v144, v144, v96
    v_mul_f32 v145, v145, v97
    v_mul_f32 v146, v146, v98
    v_mul_f32 v147, v147, v99
    v_mul_f32 v148, v148, v100
    v_mul_f32 v149, v149, v101
    v_mul_f32 v150, v150, v102
    v_mul_f32 v151, v151, v103
    v_cvt_pk_bf16_f32 v84, v144, v145
    v_cvt_pk_bf16_f32 v85, v146, v147
    v_cvt_pk_bf16_f32 v86, v148, v149
    v_cvt_pk_bf16_f32 v87, v150, v151
    buffer_store_dwordx4 v[84:87], v1, s[4:7], s30 offen sc1
    s_add_u32 s30, s30, s50
    v_cvt_pk_bf16_f32 v88, v160, v161
    v_cvt_pk_bf16_f32 v89, v162, v163
    v_cvt_pk_bf16_f32 v90, v164, v165
    v_cvt_pk_bf16_f32 v91, v166, v167
    v_lshlrev_b32 v160, 16, v88
    v_and_b32 v161, 0xffff0000, v88
    v_lshlrev_b32 v162, 16, v89
    v_and_b32 v163, 0xffff0000, v89
    v_lshlrev_b32 v164, 16, v90
    v_and_b32 v165, 0xffff0000, v90
    v_lshlrev_b32 v166, 16, v91
    v_and_b32 v167, 0xffff0000, v91
    v_mul_f32 v104, s54, v160
    v_mul_f32 v105, s54, v161
    v_mul_f32 v106, s54, v162
    v_mul_f32 v107, s54, v163
    v_mul_f32 v108, s54, v164
    v_mul_f32 v109, s54, v165
    v_mul_f32 v110, s54, v166
    v_mul_f32 v111, s54, v167
    v_exp_f32 v104, v104
    v_exp_f32 v105, v105
    v_exp_f32 v106, v106
    v_exp_f32 v107, v107
    v_exp_f32 v108, v108
    v_exp_f32 v109, v109
    v_exp_f32 v110, v110
    v_exp_f32 v111, v111
    v_add_f32 v104, 1.0, v104
    v_add_f32 v105, 1.0, v105
    v_add_f32 v106, 1.0, v106
    v_add_f32 v107, 1.0, v107
    v_add_f32 v108, 1.0, v108
    v_add_f32 v109, 1.0, v109
    v_add_f32 v110, 1.0, v110
    v_add_f32 v111, 1.0, v111
    v_rcp_f32 v104, v104
    v_rcp_f32 v105, v105
    v_rcp_f32 v106, v106
    v_rcp_f32 v107, v107
    v_rcp_f32 v108, v108
    v_rcp_f32 v109, v109
    v_rcp_f32 v110, v110
    v_rcp_f32 v111, v111
    v_mul_f32 v160, v160, v104
    v_mul_f32 v161, v161, v105
    v_mul_f32 v162, v162, v106
    v_mul_f32 v163, v163, v107
    v_mul_f32 v164, v164, v108
    v_mul_f32 v165, v165, v109
    v_mul_f32 v166, v166, v110
    v_mul_f32 v167, v167, v111
    v_cvt_pk_bf16_f32 v88, v160, v161
    v_cvt_pk_bf16_f32 v89, v162, v163
    v_cvt_pk_bf16_f32 v90, v164, v165
    v_cvt_pk_bf16_f32 v91, v166, v167
    buffer_store_dwordx4 v[88:91], v1, s[4:7], s30 offen sc1
    s_add_u32 s30, s30, s50
    v_cvt_pk_bf16_f32 v92, v176, v177
    v_cvt_pk_bf16_f32 v93, v178, v179
    v_cvt_pk_bf16_f32 v94, v180, v181
    v_cvt_pk_bf16_f32 v95, v182, v183
    v_lshlrev_b32 v176, 16, v92
    v_and_b32 v177, 0xffff0000, v92
    v_lshlrev_b32 v178, 16, v93
    v_and_b32 v179, 0xffff0000, v93
    v_lshlrev_b32 v180, 16, v94
    v_and_b32 v181, 0xffff0000, v94
    v_lshlrev_b32 v182, 16, v95
    v_and_b32 v183, 0xffff0000, v95
    v_mul_f32 v96, s54, v176
    v_mul_f32 v97, s54, v177
    v_mul_f32 v98, s54, v178
    v_mul_f32 v99, s54, v179
    v_mul_f32 v100, s54, v180
    v_mul_f32 v101, s54, v181
    v_mul_f32 v102, s54, v182
    v_mul_f32 v103, s54, v183
    v_exp_f32 v96, v96
    v_exp_f32 v97, v97
    v_exp_f32 v98, v98
    v_exp_f32 v99, v99
    v_exp_f32 v100, v100
    v_exp_f32 v101, v101
    v_exp_f32 v102, v102
    v_exp_f32 v103, v103
    v_add_f32 v96, 1.0, v96
    v_add_f32 v97, 1.0, v97
    v_add_f32 v98, 1.0, v98
    v_add_f32 v99, 1.0, v99
    v_add_f32 v100, 1.0, v100
    v_add_f32 v101, 1.0, v101
    v_add_f32 v102, 1.0, v102
    v_add_f32 v103, 1.0, v103
    v_rcp_f32 v96, v96
    v_rcp_f32 v97, v97
    v_rcp_f32 v98, v98
    v_rcp_f32 v99, v99
    v_rcp_f32 v100, v100
    v_rcp_f32 v101, v101
    v_rcp_f32 v102, v102
    v_rcp_f32 v103, v103
    v_mul_f32 v176, v176, v96
    v_mul_f32 v177, v177, v97
    v_mul_f32 v178, v178, v98
    v_mul_f32 v179, v179, v99
    v_mul_f32 v180, v180, v100
    v_mul_f32 v181, v181, v101
    v_mul_f32 v182, v182, v102
    v_mul_f32 v183, v183, v103
    v_cvt_pk_bf16_f32 v92, v176, v177
    v_cvt_pk_bf16_f32 v93, v178, v179
    v_cvt_pk_bf16_f32 v94, v180, v181
    v_cvt_pk_bf16_f32 v95, v182, v183
    buffer_store_dwordx4 v[92:95], v1, s[4:7], s30 offen sc1
    s_add_u32 s30, s30, s50
    s_waitcnt lgkmcnt(0)
    v_or3_b32 v24, v24, v25, v26
    v_or3_b32 v28, v28, v29, v30
    v_or3_b32 v24, v24, v27, v31
    v_or_b32 v24, v24, v28
    s_mov_b32 s28, s51
    s_mov_b32 s57, s53
    v_readfirstlane_b32 s30, v24
    s_cmp_lg_u32 s30, 0
    s_cbranch_scc1 w_drain
    s_mov_b32 s48, s32
    s_cmp_ge_u32 s32, 4
    s_cselect_b32 s30, 2, 3
    s_lshl_b32 s30, s26, s30
    s_mul_i32 s30, s30, s43
    s_add_u32 s49, s42, s30
    s_mov_b32 s50, s43
    s_mov_b32 s51, s46
    s_mov_b32 s23, s41
    s_mov_b32 s53, s47
    s_nop 0
    s_load_dwordx16 s[32:47], s[24:25], 0
    s_add_u32 s24, s24, 64
    s_addc_u32 s25, s25, 0
    s_branch w_first4
w_firstX:
    s_waitcnt vmcnt(0)
    s_barrier
    v_bfe_u32 v20, v1, 4, 3
    v_xor_b32 v21, v4, v20
    v_lshlrev_b32 v21, 4, v21
    v_lshl_add_u32 v21, v20, 7, v21
    v_bfe_u32 v20, v1, 7, 1
    v_lshl_add_u32 v21, v20, 10, v21
    s_lshl_b32 s30, s26, 13
    v_add_u32 v24, s30, v21
    v_xor_b32 v25, 64, v24
    v_add_u32 v26, 0x10000, v24
    v_add_u32 v27, 0x10000, v25
    v_add_u32 v28, s22, v1
    v_add_u32 v29, 0x10000, v28
    ds_read_b64_tr_b16 v[64:65], v8 offset:16384
    ds_read_b64_tr_b16 v[66:67], v9 offset:16384
    ds_read_b64_tr_b16 v[68:69], v10 offset:16384
    ds_read_b64_tr_b16 v[70:71], v11 offset:16384
    ds_read_b64_tr_b16 v[72:73], v8 offset:24576
    ds_read_b64_tr_b16 v[74:75], v9 offset:24576
    ds_read_b64_tr_b16 v[76:77], v10 offset:24576
    ds_read_b64_tr_b16 v[78:79], v11 offset:24576
    ds_read_b128 v[32:35], v24 offset:0
    ds_read_b128 v[36:39], v25 offset:0
    ds_read_b128 v[40:43], v24 offset:2048
    ds_read_b128 v[44:47], v25 offset:2048
    ds_read_b128 v[48:51], v24 offset:4096
    ds_read_b128 v[52:55], v25 offset:4096
    ds_read_b128 v[56:59], v24 offset:6144
    ds_read_b128 v[60:63], v25 offset:6144
    v_mov_b32 v208, 0x3f803f80
    v_mov_b32 v209, 0x3f803f80
    v_mov_b32 v210, 0x3f803f80
    v_mov_b32 v211, 0x3f803f80
    s_waitcnt lgkmcnt(0)
    s_waitcnt vmcnt(8)
    s_barrier
    s_add_u32 m0, s21, 0
    s_nop 0
    buffer_load_dwordx4 v23, s[88:91], s16 offen lds
    s_add_u32 s16, s16, s62
    s_add_u32 m0, s21, 1024
    s_nop 0
    buffer_load_dwordx4 v23, s[88:91], s17 offen lds
    s_add_u32 s17, s17, s62
    s_cmp_ge_u32 s16, s92
    s_cselect_b32 s94, 2048, 0
    s_sub_u32 s16, s16, s94
    s_sub_u32 s17, s17, s94
    s_add_u32 m0, s22, 0
    s_nop 0
    buffer_load_dwordx4 v2, s[8:11], s18 offen lds
    s_add_u32 s18, s18, s20
    s_add_u32 m0, s22, 8192
    s_nop 0
    buffer_load_dwordx4 v2, s[12:15], s19 offen lds
    s_add_u32 s19, s19, s20
    s_cmp_ge_u32 s18, s95
    s_cselect_b32 s94, s93, 0
    s_sub_u32 s18, s18, s94
    s_sub_u32 s19, s19, s94
    v_mfma_f32_16x16x32_bf16 v[128:131], v[64:67], v[32:35], 0
    ds_read_b64_tr_b16 v[112:113], v8 offset:49152
    v_mfma_f32_16x16x32_bf16 v[132:135], v[68:71], v[32:35], 0
    ds_read_b64_tr_b16 v[114:115], v9 offset:49152
    v_mfma_f32_16x16x32_bf16 v[144:147], v[64:67], v[40:43], 0
    ds_read_b64_tr_b16 v[116:117], v10 offset:49152
    v_mfma_f32_16x16x32_bf16 v[148:151], v[68:71], v[40:43], 0
    ds_read_b64_tr_b16 v[118:119], v11 offset:49152
    v_mfma_f32_16x16x32_bf16 v[160:163], v[64:67], v[48:51], 0
    ds_read_b64_tr_b16 v[120:121], v8 offset:57344
    v_mfma_f32_16x16x32_bf16 v[164:167], v[68:71], v[48:51], 0
    ds_read_b64_tr_b16 v[122:123], v9 offset:57344
    v_mfma_f32_16x16x32_bf16 v[176:179], v[64:67], v[56:59], 0
    ds_read_b64_tr_b16 v[124:125], v10 offset:57344
    v_mfma_f32_16x16x32_bf16 v[180:183], v[68:71], v[56:59], 0
    ds_read_b64_tr_b16 v[126:127], v11 offset:57344
    v_mfma_f32_16x16x32_bf16 v[192:195], v[64:67], v[208:211], 0
    ds_read_b128 v[80:83], v24 offset:32768
    v_mfma_f32_16x16x32_bf16 v[196:199], v[68:71], v[208:211], 0
    ds_read_b128 v[84:87], v25 offset:32768
    v_mfma_f32_16x16x32_bf16 v[128:131], v[72:75], v[36:39], v[128:131]
    ds_read_b128 v[88:91], v24 offset:34816
    v_mfma_f32_16x16x32_bf16 v[132:135], v[76:79], v[36:39], v[132:135]
    ds_read_b128 v[92:95], v25 offset:34816
    v_mfma_f32_16x16x32_bf16 v[144:147], v[72:75], v[44:47], v[144:147]
    ds_read_b128 v[96:99], v24 offset:36864
    v_mfma_f32_16x16x32_bf16 v[148:151], v[76:79], v[44:47], v[148:151]
    ds_read_b128 v[100:103], v25 offset:36864
    v_mfma_f32_16x16x32_bf16 v[160:163], v[72:75], v[52:55], v[160:163]
    ds_read_b128 v[104:107], v24 offset:38912
    v_mfma_f32_16x16x32_bf16 v[164:167], v[76:79], v[52:55], v[164:167]
    ds_read_b128 v[108:111], v25 offset:38912
    v_mfma_f32_16x16x32_bf16 v[176:179], v[72:75], v[60:63], v[176:179]
    v_mfma_f32_16x16x32_bf16 v[180:183], v[76:79], v[60:63], v[180:183]
    v_mfma_f32_16x16x32_bf16 v[192:195], v[72:75], v[208:211], v[192:195]
    v_mfma_f32_16x16x32_bf16 v[196:199], v[76:79], v[208:211], v[196:199]
    s_waitcnt lgkmcnt(0)
    s_waitcnt vmcnt(8)
    s_barrier
    s_add_u32 m0, s21, 32768
    s_nop 0
    buffer_load_dwordx4 v23, s[88:91], s16 offen lds
    s_add_u32 s16, s16, s62
    s_add_u32 m0, s21, 33792
    s_nop 0
    buffer_load_dwordx4 v23, s[88:91], s17 offen lds
    s_add_u32 s17, s17, s62
    s_cmp_ge_u32 s16, s92
    s_cselect_b32 s94, 2048, 0
    s_sub_u32 s16, s16, s94
    s_sub_u32 s17, s17, s94
    s_add_u32 m0, s22, 32768
    s_nop 0
    buffer_load_dwordx4 v2, s[8:11], s18 offen lds
    s_add_u32 s18, s18, s20
    s_add_u32 m0, s22, 40960
    s_nop 0
    buffer_load_dwordx4 v2, s[12:15], s19 offen lds
    s_add_u32 s19, s19, s20
    s_cmp_ge_u32 s18, s95
    s_cselect_b32 s94, s93, 0
    s_sub_u32 s18, s18, s94
    s_sub_u32 s19, s19, s94
    v_mfma_f32_16x16x32_bf16 v[128:131], v[112:115], v[80:83], v[128:131]
    ds_read_b64_tr_b16 v[64:65], v12 offset:16384
    v_mfma_f32_16x16x32_bf16 v[132:135], v[116:119], v[80:83], v[132:135]
    ds_read_b64_tr_b16 v[66:67], v13 offset:16384
    v_mfma_f32_16x16x32_bf16 v[144:147], v[112:115], v[88:91], v[144:147]
    ds_read_b64_tr_b16 v[68:69], v14 offset:16384
    v_mfma_f32_16x16x32_bf16 v[148:151], v[116:119], v[88:91], v[148:151]
    ds_read_b64_tr_b16 v[70:71], v15 offset:16384
    v_mfma_f32_16x16x32_bf16 v[160:163], v[112:115], v[96:99], v[160:163]
    ds_read_b64_tr_b16 v[72:73], v12 offset:24576
    v_mfma_f32_16x16x32_bf16 v[164:167], v[116:119], v[96:99], v[164:167]
    ds_read_b64_tr_b16 v[74:75], v13 offset:24576
    v_mfma_f32_16x16x32_bf16 v[176:179], v[112:115], v[104:107], v[176:179]
    ds_read_b64_tr_b16 v[76:77], v14 offset:24576
    v_mfma_f32_16x16x32_bf16 v[180:183], v[116:119], v[104:107], v[180:183]
    ds_read_b64_tr_b16 v[78:79], v15 offset:24576
    v_mfma_f32_16x16x32_bf16 v[192:195], v[112:115], v[208:211], v[192:195]
    ds_read_b128 v[32:35], v26 offset:0
    v_mfma_f32_16x16x32_bf16 v[196:199], v[116:119], v[208:211], v[196:199]
    ds_read_b128 v[36:39], v27 offset:0
    v_mfma_f32_16x16x32_bf16 v[128:131], v[120:123], v[84:87], v[128:131]
    ds_read_b128 v[40:43], v26 offset:2048
    v_mfma_f32_16x16x32_bf16 v[132:135], v[124:127], v[84:87], v[132:135]
    ds_read_b128 v[44:47], v27 offset:2048
    v_mfma_f32_16x16x32_bf16 v[144:147], v[120:123], v[92:95], v[144:147]
    ds_read_b128 v[48:51], v26 offset:4096
    v_mfma_f32_16x16x32_bf16 v[148:151], v[124:127], v[92:95], v[148:151]
    ds_read_b128 v[52:55], v27 offset:4096
    v_mfma_f32_16x16x32_bf16 v[160:163], v[120:123], v[100:103], v[160:163]
    ds_read_b128 v[56:59], v26 offset:6144
    v_mfma_f32_16x16x32_bf16 v[164:167], v[124:127], v[100:103], v[164:167]
    ds_read_b128 v[60:63], v27 offset:6144
    v_mfma_f32_16x16x32_bf16 v[176:179], v[120:123], v[108:111], v[176:179]
    v_mfma_f32_16x16x32_bf16 v[180:183], v[124:127], v[108:111], v[180:183]
    v_mfma_f32_16x16x32_bf16 v[192:195], v[120:123], v[208:211], v[192:195]
    v_mfma_f32_16x16x32_bf16 v[196:199], v[124:127], v[208:211], v[196:199]
    s_waitcnt lgkmcnt(0)
    s_waitcnt vmcnt(8)
    s_barrier
    s_add_u32 m0, s21, 65536
    s_nop 0
    buffer_load_dwordx4 v23, s[88:91], s16 offen lds
    s_add_u32 s16, s16, s62
    s_add_u32 m0, s21, 66560
    s_nop 0
    buffer_load_dwordx4 v23, s[88:91], s17 offen lds
    s_add_u32 s17, s17, s62
    s_cmp_ge_u32 s16, s92
    s_cselect_b32 s94, 2048, 0
    s_sub_u32 s16, s16, s94
    s_sub_u32 s17, s17, s94
    s_add_u32 m0, s22, 65536
    s_nop 0
    buffer_load_dwordx4 v2, s[8:11], s18 offen lds
    s_add_u32 s18, s18, s20
    s_add_u32 m0, s22, 73728
    s_nop 0
    buffer_load_dwordx4 v2, s[12:15], s19 offen lds
    s_add_u32 s19, s19, s20
    s_cmp_ge_u32 s18, s95
    s_cselect_b32 s94, s93, 0
    s_sub_u32 s18, s18, s94
    s_sub_u32 s19, s19, s94
    v_mfma_f32_16x16x32_bf16 v[128:131], v[64:67], v[32:35], v[128:131]
    ds_read_b64_tr_b16 v[112:113], v12 offset:49152
    v_mfma_f32_16x16x32_bf16 v[132:135], v[68:71], v[32:35], v[132:135]
    ds_read_b64_tr_b16 v[114:115], v13 offset:49152
    v_mfma_f32_16x16x32_bf16 v[144:147], v[64:67], v[40:43], v[144:147]
    ds_read_b64_tr_b16 v[116:117], v14 offset:49152
    v_mfma_f32_16x16x32_bf16 v[148:151], v[68:71], v[40:43], v[148:151]
    ds_read_b64_tr_b16 v[118:119], v15 offset:49152
    v_mfma_f32_16x16x32_bf16 v[160:163], v[64:67], v[48:51], v[160:163]
    ds_read_b64_tr_b16 v[120:121], v12 offset:57344
    v_mfma_f32_16x16x32_bf16 v[164:167], v[68:71], v[48:51], v[164:167]
    ds_read_b64_tr_b16 v[122:123], v13 offset:57344
    v_mfma_f32_16x16x32_bf16 v[176:179], v[64:67], v[56:59], v[176:179]
    ds_read_b64_tr_b16 v[124:125], v14 offset:57344
    v_mfma_f32_16x16x32_bf16 v[180:183], v[68:71], v[56:59], v[180:183]
    ds_read_b64_tr_b16 v[126:127], v15 offset:57344
    v_mfma_f32_16x16x32_bf16 v[192:195], v[64:67], v[208:211], v[192:195]
    ds_read_b128 v[80:83], v26 offset:32768
    v_mfma_f32_16x16x32_bf16 v[196:199], v[68:71], v[208:211], v[196:199]
    ds_read_b128 v[84:87], v27 offset:32768
    v_mfma_f32_16x16x32_bf16 v[128:131], v[72:75], v[36:39], v[128:131]
    ds_read_b128 v[88:91], v26 offset:34816
    v_mfma_f32_16x16x32_bf16 v[132:135], v[76:79], v[36:39], v[132:135]
    ds_read_b128 v[92:95], v27 offset:34816
    v_mfma_f32_16x16x32_bf16 v[144:147], v[72:75], v[44:47], v[144:147]
    ds_read_b128 v[96:99], v26 offset:36864
    v_mfma_f32_16x16x32_bf16 v[148:151], v[76:79], v[44:47], v[148:151]
    ds_read_b128 v[100:103], v27 offset:36864
    v_mfma_f32_16x16x32_bf16 v[160:163], v[72:75], v[52:55], v[160:163]
    ds_read_b128 v[104:107], v26 offset:38912
    v_mfma_f32_16x16x32_bf16 v[164:167], v[76:79], v[52:55], v[164:167]
    ds_read_b128 v[108:111], v27 offset:38912
    v_mfma_f32_16x16x32_bf16 v[176:179], v[72:75], v[60:63], v[176:179]
    v_mfma_f32_16x16x32_bf16 v[180:183], v[76:79], v[60:63], v[180:183]
    v_mfma_f32_16x16x32_bf16 v[192:195], v[72:75], v[208:211], v[192:195]
    v_mfma_f32_16x16x32_bf16 v[196:199], v[76:79], v[208:211], v[196:199]
    s_waitcnt lgkmcnt(0)
    s_waitcnt vmcnt(8)
    s_barrier
    s_add_u32 m0, s21, 98304
    s_nop 0
    buffer_load_dwordx4 v23, s[88:91], s16 offen lds
    s_add_u32 s16, s16, s62
    s_add_u32 m0, s21, 99328
    s_nop 0
    buffer_load_dwordx4 v23, s[88:91], s17 offen lds
    s_add_u32 s17, s17, s62
    s_cmp_ge_u32 s16, s92
    s_cselect_b32 s94, 2048, 0
    s_sub_u32 s16, s16, s94
    s_sub_u32 s17, s17, s94
    s_add_u32 m0, s22, 98304
    s_nop 0
    buffer_load_dwordx4 v2, s[8:11], s18 offen lds
    s_add_u32 s18, s18, s20
    s_add_u32 m0, s22, 106496
    s_nop 0
    buffer_load_dwordx4 v2, s[12:15], s19 offen lds
    s_add_u32 s19, s19, s20
    s_cmp_ge_u32 s18, s95
    s_cselect_b32 s94, s93, 0
    s_sub_u32 s18, s18, s94
    s_sub_u32 s19, s19, s94
    v_mfma_f32_16x16x32_bf16 v[128:131], v[112:115], v[80:83], v[128:131]
    ds_read_b64_tr_b16 v[64:65], v8 offset:16384
    v_mfma_f32_16x16x32_bf16 v[132:135], v[116:119], v[80:83], v[132:135]
    ds_read_b64_tr_b16 v[66:67], v9 offset:16384
    v_mfma_f32_16x16x32_bf16 v[144:147], v[112:115], v[88:91], v[144:147]
    ds_read_b64_tr_b16 v[68:69], v10 offset:16384
    v_mfma_f32_16x16x32_bf16 v[148:151], v[116:119], v[88:91], v[148:151]
    ds_read_b64_tr_b16 v[70:71], v11 offset:16384
    v_mfma_f32_16x16x32_bf16 v[160:163], v[112:115], v[96:99], v[160:163]
    ds_read_b64_tr_b16 v[72:73], v8 offset:24576
    v_mfma_f32_16x16x32_bf16 v[164:167], v[116:119], v[96:99], v[164:167]
    ds_read_b64_tr_b16 v[74:75], v9 offset:24576
    v_mfma_f32_16x16x32_bf16 v[176:179], v[112:115], v[104:107], v[176:179]
    ds_read_b64_tr_b16 v[76:77], v10 offset:24576
    v_mfma_f32_16x16x32_bf16 v[180:183], v[116:119], v[104:107], v[180:183]
    ds_read_b64_tr_b16 v[78:79], v11 offset:24576
    v_mfma_f32_16x16x32_bf16 v[192:195], v[112:115], v[208:211], v[192:195]
    ds_read_b128 v[32:35], v24 offset:0
    v_mfma_f32_16x16x32_bf16 v[196:199], v[116:119], v[208:211], v[196:199]
    ds_read_b128 v[36:39], v25 offset:0
    v_mfma_f32_16x16x32_bf16 v[128:131], v[120:123], v[84:87], v[128:131]
    ds_read_b128 v[40:43], v24 offset:2048
    v_mfma_f32_16x16x32_bf16 v[132:135], v[124:127], v[84:87], v[132:135]
    ds_read_b128 v[44:47], v25 offset:2048
    v_mfma_f32_16x16x32_bf16 v[144:147], v[120:123], v[92:95], v[144:147]
    ds_read_b128 v[48:51], v24 offset:4096
    v_mfma_f32_16x16x32_bf16 v[148:151], v[124:127], v[92:95], v[148:151]
    ds_read_b128 v[52:55], v25 offset:4096
    v_mfma_f32_16x16x32_bf16 v[160:163], v[120:123], v[100:103], v[160:163]
    ds_read_b128 v[56:59], v24 offset:6144
    v_mfma_f32_16x16x32_bf16 v[164:167], v[124:127], v[100:103], v[164:167]
    ds_read_b128 v[60:63], v25 offset:6144
    v_mfma_f32_16x16x32_bf16 v[176:179], v[120:123], v[108:111], v[176:179]
    v_mfma_f32_16x16x32_bf16 v[180:183], v[124:127], v[108:111], v[180:183]
    v_mfma_f32_16x16x32_bf16 v[192:195], v[120:123], v[208:211], v[192:195]
    v_mfma_f32_16x16x32_bf16 v[196:199], v[124:127], v[208:211], v[196:199]
    s_waitcnt lgkmcnt(0)
    s_waitcnt vmcnt(8)
    s_barrier
    s_add_u32 m0, s21, 0
    s_nop 0
    buffer_load_dwordx4 v23, s[88:91], s16 offen lds
    s_add_u32 s16, s16, s62
    s_add_u32 m0, s21, 1024
    s_nop 0
    buffer_load_dwordx4 v23, s[88:91], s17 offen lds
    s_add_u32 s17, s17, s62
    s_cmp_ge_u32 s16, s92
    s_cselect_b32 s94, 2048, 0
    s_sub_u32 s16, s16, s94
    s_sub_u32 s17, s17, s94
    s_add_u32 m0, s22, 0
    s_nop 0
    buffer_load_dwordx4 v2, s[8:11], s18 offen lds
    s_add_u32 s18, s18, s20
    s_add_u32 m0, s22, 8192
    s_nop 0
    buffer_load_dwordx4 v2, s[12:15], s19 offen lds
    s_add_u32 s19, s19, s20
    s_cmp_ge_u32 s18, s95
    s_cselect_b32 s94, s93, 0
    s_sub_u32 s18, s18, s94
    s_sub_u32 s19, s19, s94
    v_mfma_f32_16x16x32_bf16 v[128:131], v[64:67], v[32:35], v[128:131]
    ds_read_b64_tr_b16 v[112:113], v8 offset:49152
    v_mfma_f32_16x16x32_bf16 v[132:135], v[68:71], v[32:35], v[132:135]
    ds_read_b64_tr_b16 v[114:115], v9 offset:49152
    v_mfma_f32_16x16x32_bf16 v[144:147], v[64:67], v[40:43], v[144:147]
    ds_read_b64_tr_b16 v[116:117], v10 offset:49152
    v_mfma_f32_16x16x32_bf16 v[148:151], v[68:71], v[40:43], v[148:151]
    ds_read_b64_tr_b16 v[118:119], v11 offset:49152
    v_mfma_f32_16x16x32_bf16 v[160:163], v[64:67], v[48:51], v[160:163]
    ds_read_b64_tr_b16 v[120:121], v8 offset:57344
    v_mfma_f32_16x16x32_bf16 v[164:167], v[68:71], v[48:51], v[164:167]
    ds_read_b64_tr_b16 v[122:123], v9 offset:57344
    v_mfma_f32_16x16x32_bf16 v[176:179], v[64:67], v[56:59], v[176:179]
    ds_read_b64_tr_b16 v[124:125], v10 offset:57344
    v_mfma_f32_16x16x32_bf16 v[180:183], v[68:71], v[56:59], v[180:183]
    ds_read_b64_tr_b16 v[126:127], v11 offset:57344
    v_mfma_f32_16x16x32_bf16 v[192:195], v[64:67], v[208:211], v[192:195]
    ds_read_b128 v[80:83], v24 offset:32768
    v_mfma_f32_16x16x32_bf16 v[196:199], v[68:71], v[208:211], v[196:199]
    ds_read_b128 v[84:87], v25 offset:32768
    v_mfma_f32_16x16x32_bf16 v[128:131], v[72:75], v[36:39], v[128:131]
    ds_read_b128 v[88:91], v24 offset:34816
    v_mfma_f32_16x16x32_bf16 v[132:135], v[76:79], v[36:39], v[132:135]
    ds_read_b128 v[92:95], v25 offset:34816
    v_mfma_f32_16x16x32_bf16 v[144:147], v[72:75], v[44:47], v[144:147]
    ds_read_b128 v[96:99], v24 offset:36864
    v_mfma_f32_16x16x32_bf16 v[148:151], v[76:79], v[44:47], v[148:151]
    ds_read_b128 v[100:103], v25 offset:36864
    v_mfma_f32_16x16x32_bf16 v[160:163], v[72:75], v[52:55], v[160:163]
    ds_read_b128 v[104:107], v24 offset:38912
    v_mfma_f32_16x16x32_bf16 v[164:167], v[76:79], v[52:55], v[164:167]
    ds_read_b128 v[108:111], v25 offset:38912
    v_mfma_f32_16x16x32_bf16 v[176:179], v[72:75], v[60:63], v[176:179]
    v_mfma_f32_16x16x32_bf16 v[180:183], v[76:79], v[60:63], v[180:183]
    v_mfma_f32_16x16x32_bf16 v[192:195], v[72:75], v[208:211], v[192:195]
    v_mfma_f32_16x16x32_bf16 v[196:199], v[76:79], v[208:211], v[196:199]
    s_waitcnt lgkmcnt(0)
    s_waitcnt vmcnt(8)
    s_barrier
    s_add_u32 m0, s21, 32768
    s_nop 0
    buffer_load_dwordx4 v23, s[88:91], s16 offen lds
    s_add_u32 s16, s16, s62
    s_add_u32 m0, s21, 33792
    s_nop 0
    buffer_load_dwordx4 v23, s[88:91], s17 offen lds
    s_add_u32 s17, s17, s62
    s_cmp_ge_u32 s16, s92
    s_cselect_b32 s94, 2048, 0
    s_sub_u32 s16, s16, s94
    s_sub_u32 s17, s17, s94
    s_add_u32 m0, s22, 32768
    s_nop 0
    buffer_load_dwordx4 v2, s[8:11], s18 offen lds
    s_add_u32 s18, s18, s20
    s_add_u32 m0, s22, 40960
    s_nop 0
    buffer_load_dwordx4 v2, s[12:15], s19 offen lds
    s_add_u32 s19, s19, s20
    s_cmp_ge_u32 s18, s95
    s_cselect_b32 s94, s93, 0
    s_sub_u32 s18, s18, s94
    s_sub_u32 s19, s19, s94
    v_mfma_f32_16x16x32_bf16 v[128:131], v[112:115], v[80:83], v[128:131]
    ds_read_b64_tr_b16 v[64:65], v12 offset:16384
    v_mfma_f32_16x16x32_bf16 v[132:135], v[116:119], v[80:83], v[132:135]
    ds_read_b64_tr_b16 v[66:67], v13 offset:16384
    v_mfma_f32_16x16x32_bf16 v[144:147], v[112:115], v[88:91], v[144:147]
    ds_read_b64_tr_b16 v[68:69], v14 offset:16384
    v_mfma_f32_16x16x32_bf16 v[148:151], v[116:119], v[88:91], v[148:151]
    ds_read_b64_tr_b16 v[70:71], v15 offset:16384
    v_mfma_f32_16x16x32_bf16 v[160:163], v[112:115], v[96:99], v[160:163]
    ds_read_b64_tr_b16 v[72:73], v12 offset:24576
    v_mfma_f32_16x16x32_bf16 v[164:167], v[116:119], v[96:99], v[164:167]
    ds_read_b64_tr_b16 v[74:75], v13 offset:24576
    v_mfma_f32_16x16x32_bf16 v[176:179], v[112:115], v[104:107], v[176:179]
    ds_read_b64_tr_b16 v[76:77], v14 offset:24576
    v_mfma_f32_16x16x32_bf16 v[180:183], v[116:119], v[104:107], v[180:183]
    ds_read_b64_tr_b16 v[78:79], v15 offset:24576
    v_mfma_f32_16x16x32_bf16 v[192:195], v[112:115], v[208:211], v[192:195]
    ds_read_b128 v[32:35], v26 offset:0
    v_mfma_f32_16x16x32_bf16 v[196:199], v[116:119], v[208:211], v[196:199]
    ds_read_b128 v[36:39], v27 offset:0
    v_mfma_f32_16x16x32_bf16 v[128:131], v[120:123], v[84:87], v[128:131]
    ds_read_b128 v[40:43], v26 offset:2048
    v_mfma_f32_16x16x32_bf16 v[132:135], v[124:127], v[84:87], v[132:135]
    ds_read_b128 v[44:47], v27 offset:2048
    v_mfma_f32_16x16x32_bf16 v[144:147], v[120:123], v[92:95], v[144:147]
    ds_read_b128 v[48:51], v26 offset:4096
    v_mfma_f32_16x16x32_bf16 v[148:151], v[124:127], v[92:95], v[148:151]
    ds_read_b128 v[52:55], v27 offset:4096
    v_mfma_f32_16x16x32_bf16 v[160:163], v[120:123], v[100:103], v[160:163]
    ds_read_b128 v[56:59], v26 offset:6144
    v_mfma_f32_16x16x32_bf16 v[164:167], v[124:127], v[100:103], v[164:167]
    ds_read_b128 v[60:63], v27 offset:6144
    v_mfma_f32_16x16x32_bf16 v[176:179], v[120:123], v[108:111], v[176:179]
    v_mfma_f32_16x16x32_bf16 v[180:183], v[124:127], v[108:111], v[180:183]
    v_mfma_f32_16x16x32_bf16 v[192:195], v[120:123], v[208:211], v[192:195]
    v_mfma_f32_16x16x32_bf16 v[196:199], v[124:127], v[208:211], v[196:199]
    s_waitcnt lgkmcnt(0)
    s_waitcnt vmcnt(8)
    s_barrier
    s_add_u32 m0, s21, 65536
    s_nop 0
    buffer_load_dwordx4 v23, s[88:91], s16 offen lds
    s_add_u32 s16, s16, s62
    s_add_u32 m0, s21, 66560
    s_nop 0
    buffer_load_dwordx4 v23, s[88:91], s17 offen lds
    s_add_u32 s17, s17, s62
    s_cmp_ge_u32 s16, s92
    s_cselect_b32 s94, 2048, 0
    s_sub_u32 s16, s16, s94
    s_sub_u32 s17, s17, s94
    s_add_u32 m0, s22, 65536
    s_nop 0
    buffer_load_dwordx4 v2, s[8:11], s18 offen lds
    s_add_u32 s18, s18, s20
    s_add_u32 m0, s22, 73728
    s_nop 0
    buffer_load_dwordx4 v2, s[12:15], s19 offen lds
    s_add_u32 s19, s19, s20
    s_cmp_ge_u32 s18, s95
    s_cselect_b32 s94, s93, 0
    s_sub_u32 s18, s18, s94
    s_sub_u32 s19, s19, s94
    v_mfma_f32_16x16x32_bf16 v[128:131], v[64:67], v[32:35], v[128:131]
    ds_read_b64_tr_b16 v[112:113], v12 offset:49152
    v_mfma_f32_16x16x32_bf16 v[132:135], v[68:71], v[32:35], v[132:135]
    ds_read_b64_tr_b16 v[114:115], v13 offset:49152
    v_mfma_f32_16x16x32_bf16 v[144:147], v[64:67], v[40:43], v[144:147]
    ds_read_b64_tr_b16 v[116:117], v14 offset:49152
    v_mfma_f32_16x16x32_bf16 v[148:151], v[68:71], v[40:43], v[148:151]
    ds_read_b64_tr_b16 v[118:119], v15 offset:49152
    v_mfma_f32_16x16x32_bf16 v[160:163], v[64:67], v[48:51], v[160:163]
    ds_read_b64_tr_b16 v[120:121], v12 offset:57344
    v_mfma_f32_16x16x32_bf16 v[164:167], v[68:71], v[48:51], v[164:167]
    ds_read_b64_tr_b16 v[122:123], v13 offset:57344
    v_mfma_f32_16x16x32_bf16 v[176:179], v[64:67], v[56:59], v[176:179]
    ds_read_b64_tr_b16 v[124:125], v14 offset:57344
    v_mfma_f32_16x16x32_bf16 v[180:183], v[68:71], v[56:59], v[180:183]
    ds_read_b64_tr_b16 v[126:127], v15 offset:57344
    v_mfma_f32_16x16x32_bf16 v[192:195], v[64:67], v[208:211], v[192:195]
    ds_read_b128 v[80:83], v26 offset:32768
    v_mfma_f32_16x16x32_bf16 v[196:199], v[68:71], v[208:211], v[196:199]
    ds_read_b128 v[84:87], v27 offset:32768
    v_mfma_f32_16x16x32_bf16 v[128:131], v[72:75], v[36:39], v[128:131]
    ds_read_b128 v[88:91], v26 offset:34816
    v_mfma_f32_16x16x32_bf16 v[132:135], v[76:79], v[36:39], v[132:135]
    ds_read_b128 v[92:95], v27 offset:34816
    v_mfma_f32_16x16x32_bf16 v[144:147], v[72:75], v[44:47], v[144:147]
    ds_read_b128 v[96:99], v26 offset:36864
    v_mfma_f32_16x16x32_bf16 v[148:151], v[76:79], v[44:47], v[148:151]
    ds_read_b128 v[100:103], v27 offset:36864
    v_mfma_f32_16x16x32_bf16 v[160:163], v[72:75], v[52:55], v[160:163]
    ds_read_b128 v[104:107], v26 offset:38912
    v_mfma_f32_16x16x32_bf16 v[164:167], v[76:79], v[52:55], v[164:167]
    ds_read_b128 v[108:111], v27 offset:38912
    v_mfma_f32_16x16x32_bf16 v[176:179], v[72:75], v[60:63], v[176:179]
    v_mfma_f32_16x16x32_bf16 v[180:183], v[76:79], v[60:63], v[180:183]
    v_mfma_f32_16x16x32_bf16 v[192:195], v[72:75], v[208:211], v[192:195]
    v_mfma_f32_16x16x32_bf16 v[196:199], v[76:79], v[208:211], v[196:199]
    s_waitcnt lgkmcnt(0)
    s_waitcnt vmcnt(8)
    s_barrier
    s_add_u32 m0, s21, 98304
    s_nop 0
    buffer_load_dwordx4 v23, s[88:91], s16 offen lds
    s_add_u32 s16, s16, s62
    s_add_u32 m0, s21, 99328
    s_nop 0
    buffer_load_dwordx4 v23, s[88:91], s17 offen lds
    s_add_u32 s17, s17, s62
    s_cmp_ge_u32 s16, s92
    s_cselect_b32 s94, 2048, 0
    s_sub_u32 s16, s16, s94
    s_sub_u32 s17, s17, s94
    s_add_u32 m0, s22, 98304
    s_nop 0
    buffer_load_dwordx4 v2, s[8:11], s18 offen lds
    s_add_u32 s18, s18, s20
    s_add_u32 m0, s22, 106496
    s_nop 0
    buffer_load_dwordx4 v2, s[12:15], s19 offen lds
    s_add_u32 s19, s19, s20
    s_cmp_ge_u32 s18, s95
    s_cselect_b32 s94, s93, 0
    s_sub_u32 s18, s18, s94
    s_sub_u32 s19, s19, s94
    v_mfma_f32_16x16x32_bf16 v[128:131], v[112:115], v[80:83], v[128:131]
    ds_read_b64_tr_b16 v[64:65], v8 offset:16384
    v_mfma_f32_16x16x32_bf16 v[132:135], v[116:119], v[80:83], v[132:135]
    ds_read_b64_tr_b16 v[66:67], v9 offset:16384
    v_mfma_f32_16x16x32_bf16 v[144:147], v[112:115], v[88:91], v[144:147]
    ds_read_b64_tr_b16 v[68:69], v10 offset:16384
    v_mfma_f32_16x16x32_bf16 v[148:151], v[116:119], v[88:91], v[148:151]
    ds_read_b64_tr_b16 v[70:71], v11 offset:16384
    v_mfma_f32_16x16x32_bf16 v[160:163], v[112:115], v[96:99], v[160:163]
    ds_read_b64_tr_b16 v[72:73], v8 offset:24576
    v_mfma_f32_16x16x32_bf16 v[164:167], v[116:119], v[96:99], v[164:167]
    ds_read_b64_tr_b16 v[74:75], v9 offset:24576
    v_mfma_f32_16x16x32_bf16 v[176:179], v[112:115], v[104:107], v[176:179]
    ds_read_b64_tr_b16 v[76:77], v10 offset:24576
    v_mfma_f32_16x16x32_bf16 v[180:183], v[116:119], v[104:107], v[180:183]
    ds_read_b64_tr_b16 v[78:79], v11 offset:24576
    v_mfma_f32_16x16x32_bf16 v[192:195], v[112:115], v[208:211], v[192:195]
    ds_read_b128 v[32:35], v24 offset:0
    v_mfma_f32_16x16x32_bf16 v[196:199], v[116:119], v[208:211], v[196:199]
    ds_read_b128 v[36:39], v25 offset:0
    v_mfma_f32_16x16x32_bf16 v[128:131], v[120:123], v[84:87], v[128:131]
    ds_read_b128 v[40:43], v24 offset:2048
    v_mfma_f32_16x16x32_bf16 v[132:135], v[124:127], v[84:87], v[132:135]
    ds_read_b128 v[44:47], v25 offset:2048
    v_mfma_f32_16x16x32_bf16 v[144:147], v[120:123], v[92:95], v[144:147]
    ds_read_b128 v[48:51], v24 offset:4096
    v_mfma_f32_16x16x32_bf16 v[148:151], v[124:127], v[92:95], v[148:151]
    ds_read_b128 v[52:55], v25 offset:4096
    v_mfma_f32_16x16x32_bf16 v[160:163], v[120:123], v[100:103], v[160:163]
    ds_read_b128 v[56:59], v24 offset:6144
    v_mfma_f32_16x16x32_bf16 v[164:167], v[124:127], v[100:103], v[164:167]
    ds_read_b128 v[60:63], v25 offset:6144
    v_mfma_f32_16x16x32_bf16 v[176:179], v[120:123], v[108:111], v[176:179]
    v_mfma_f32_16x16x32_bf16 v[180:183], v[124:127], v[108:111], v[180:183]
    v_mfma_f32_16x16x32_bf16 v[192:195], v[120:123], v[208:211], v[192:195]
    v_mfma_f32_16x16x32_bf16 v[196:199], v[124:127], v[208:211], v[196:199]
    s_waitcnt lgkmcnt(0)
    s_waitcnt vmcnt(8)
    s_barrier
    s_add_u32 m0, s21, 0
    s_nop 0
    buffer_load_dwordx4 v23, s[88:91], s16 offen lds
    s_add_u32 s16, s16, s62
    s_add_u32 m0, s21, 1024
    s_nop 0
    buffer_load_dwordx4 v23, s[88:91], s17 offen lds
    s_add_u32 s17, s17, s62
    s_cmp_ge_u32 s16, s92
    s_cselect_b32 s94, 2048, 0
    s_sub_u32 s16, s16, s94
    s_sub_u32 s17, s17, s94
    s_add_u32 m0, s22, 0
    s_nop 0
    buffer_load_dwordx4 v2, s[8:11], s18 offen lds
    s_add_u32 s18, s18, s20
    s_add_u32 m0, s22, 8192
    s_nop 0
    buffer_load_dwordx4 v2, s[12:15], s19 offen lds
    s_add_u32 s19, s19, s20
    s_cmp_ge_u32 s18, s95
    s_cselect_b32 s94, s93, 0
    s_sub_u32 s18, s18, s94
    s_sub_u32 s19, s19, s94
    v_mfma_f32_16x16x32_bf16 v[128:131], v[64:67], v[32:35], v[128:131]
    ds_read_b64_tr_b16 v[112:113], v8 offset:49152
    v_mfma_f32_16x16x32_bf16 v[132:135], v[68:71], v[32:35], v[132:135]
    ds_read_b64_tr_b16 v[114:115], v9 offset:49152
    v_mfma_f32_16x16x32_bf16 v[144:147], v[64:67], v[40:43], v[144:147]
    ds_read_b64_tr_b16 v[116:117], v10 offset:49152
    v_mfma_f32_16x16x32_bf16 v[148:151], v[68:71], v[40:43], v[148:151]
    ds_read_b64_tr_b16 v[118:119], v11 offset:49152
    v_mfma_f32_16x16x32_bf16 v[160:163], v[64:67], v[48:51], v[160:163]
    ds_read_b64_tr_b16 v[120:121], v8 offset:57344
    v_mfma_f32_16x16x32_bf16 v[164:167], v[68:71], v[48:51], v[164:167]
    ds_read_b64_tr_b16 v[122:123], v9 offset:57344
    v_mfma_f32_16x16x32_bf16 v[176:179], v[64:67], v[56:59], v[176:179]
    ds_read_b64_tr_b16 v[124:125], v10 offset:57344
    v_mfma_f32_16x16x32_bf16 v[180:183], v[68:71], v[56:59], v[180:183]
    ds_read_b64_tr_b16 v[126:127], v11 offset:57344
    v_mfma_f32_16x16x32_bf16 v[192:195], v[64:67], v[208:211], v[192:195]
    ds_read_b128 v[80:83], v24 offset:32768
    v_mfma_f32_16x16x32_bf16 v[196:199], v[68:71], v[208:211], v[196:199]
    ds_read_b128 v[84:87], v25 offset:32768
    v_mfma_f32_16x16x32_bf16 v[128:131], v[72:75], v[36:39], v[128:131]
    ds_read_b128 v[88:91], v24 offset:34816
    v_mfma_f32_16x16x32_bf16 v[132:135], v[76:79], v[36:39], v[132:135]
    ds_read_b128 v[92:95], v25 offset:34816
    v_mfma_f32_16x16x32_bf16 v[144:147], v[72:75], v[44:47], v[144:147]
    ds_read_b128 v[96:99], v24 offset:36864
    v_mfma_f32_16x16x32_bf16 v[148:151], v[76:79], v[44:47], v[148:151]
    ds_read_b128 v[100:103], v25 offset:36864
    v_mfma_f32_16x16x32_bf16 v[160:163], v[72:75], v[52:55], v[160:163]
    ds_read_b128 v[104:107], v24 offset:38912
    v_mfma_f32_16x16x32_bf16 v[164:167], v[76:79], v[52:55], v[164:167]
    ds_read_b128 v[108:111], v25 offset:38912
    v_mfma_f32_16x16x32_bf16 v[176:179], v[72:75], v[60:63], v[176:179]
    v_mfma_f32_16x16x32_bf16 v[180:183], v[76:79], v[60:63], v[180:183]
    v_mfma_f32_16x16x32_bf16 v[192:195], v[72:75], v[208:211], v[192:195]
    v_mfma_f32_16x16x32_bf16 v[196:199], v[76:79], v[208:211], v[196:199]
    s_waitcnt lgkmcnt(0)
    s_waitcnt vmcnt(8)
    s_barrier
    s_add_u32 m0, s21, 32768
    s_nop 0
    buffer_load_dwordx4 v23, s[88:91], s16 offen lds
    s_add_u32 s16, s16, s62
    s_add_u32 m0, s21, 33792
    s_nop 0
    buffer_load_dwordx4 v23, s[88:91], s17 offen lds
    s_add_u32 s17, s17, s62
    s_cmp_ge_u32 s16, s92
    s_cselect_b32 s94, 2048, 0
    s_sub_u32 s16, s16, s94
    s_sub_u32 s17, s17, s94
    s_add_u32 m0, s22, 32768
    s_nop 0
    buffer_load_dwordx4 v2, s[8:11], s18 offen lds
    s_add_u32 s18, s18, s20
    s_add_u32 m0, s22, 40960
    s_nop 0
    buffer_load_dwordx4 v2, s[12:15], s19 offen lds
    s_add_u32 s19, s19, s20
    s_cmp_ge_u32 s18, s95
    s_cselect_b32 s94, s93, 0
    s_sub_u32 s18, s18, s94
    s_sub_u32 s19, s19, s94
    v_mfma_f32_16x16x32_bf16 v[128:131], v[112:115], v[80:83], v[128:131]
    ds_read_b64_tr_b16 v[64:65], v12 offset:16384
    v_mfma_f32_16x16x32_bf16 v[132:135], v[116:119], v[80:83], v[132:135]
    ds_read_b64_tr_b16 v[66:67], v13 offset:16384
    v_mfma_f32_16x16x32_bf16 v[144:147], v[112:115], v[88:91], v[144:147]
    ds_read_b64_tr_b16 v[68:69], v14 offset:16384
    v_mfma_f32_16x16x32_bf16 v[148:151], v[116:119], v[88:91], v[148:151]
    ds_read_b64_tr_b16 v[70:71], v15 offset:16384
    v_mfma_f32_16x16x32_bf16 v[160:163], v[112:115], v[96:99], v[160:163]
    ds_read_b64_tr_b16 v[72:73], v12 offset:24576
    v_mfma_f32_16x16x32_bf16 v[164:167], v[116:119], v[96:99], v[164:167]
    ds_read_b64_tr_b16 v[74:75], v13 offset:24576
    v_mfma_f32_16x16x32_bf16 v[176:179], v[112:115], v[104:107], v[176:179]
    ds_read_b64_tr_b16 v[76:77], v14 offset:24576
    v_mfma_f32_16x16x32_bf16 v[180:183], v[116:119], v[104:107], v[180:183]
    ds_read_b64_tr_b16 v[78:79], v15 offset:24576
    v_mfma_f32_16x16x32_bf16 v[192:195], v[112:115], v[208:211], v[192:195]
    ds_read_b128 v[32:35], v26 offset:0
    v_mfma_f32_16x16x32_bf16 v[196:199], v[116:119], v[208:211], v[196:199]
    ds_read_b128 v[36:39], v27 offset:0
    v_mfma_f32_16x16x32_bf16 v[128:131], v[120:123], v[84:87], v[128:131]
    ds_read_b128 v[40:43], v26 offset:2048
    v_mfma_f32_16x16x32_bf16 v[132:135], v[124:127], v[84:87], v[132:135]
    ds_read_b128 v[44:47], v27 offset:2048
    v_mfma_f32_16x16x32_bf16 v[144:147], v[120:123], v[92:95], v[144:147]
    ds_read_b128 v[48:51], v26 offset:4096
    v_mfma_f32_16x16x32_bf16 v[148:151], v[124:127], v[92:95], v[148:151]
    ds_read_b128 v[52:55], v27 offset:4096
    v_mfma_f32_16x16x32_bf16 v[160:163], v[120:123], v[100:103], v[160:163]
    ds_read_b128 v[56:59], v26 offset:6144
    v_mfma_f32_16x16x32_bf16 v[164:167], v[124:127], v[100:103], v[164:167]
    ds_read_b128 v[60:63], v27 offset:6144
    v_mfma_f32_16x16x32_bf16 v[176:179], v[120:123], v[108:111], v[176:179]
    v_mfma_f32_16x16x32_bf16 v[180:183], v[124:127], v[108:111], v[180:183]
    v_mfma_f32_16x16x32_bf16 v[192:195], v[120:123], v[208:211], v[192:195]
    v_mfma_f32_16x16x32_bf16 v[196:199], v[124:127], v[208:211], v[196:199]
    s_waitcnt lgkmcnt(0)
    s_waitcnt vmcnt(8)
    s_barrier
    s_add_u32 m0, s21, 65536
    s_nop 0
    buffer_load_dwordx4 v23, s[88:91], s16 offen lds
    s_add_u32 s16, s16, s62
    s_add_u32 m0, s21, 66560
    s_nop 0
    buffer_load_dwordx4 v23, s[88:91], s17 offen lds
    s_add_u32 s17, s17, s62
    s_cmp_ge_u32 s16, s92
    s_cselect_b32 s94, 2048, 0
    s_sub_u32 s16, s16, s94
    s_sub_u32 s17, s17, s94
    s_add_u32 m0, s22, 65536
    s_nop 0
    buffer_load_dwordx4 v2, s[8:11], s18 offen lds
    s_add_u32 s18, s18, s20
    s_add_u32 m0, s22, 73728
    s_nop 0
    buffer_load_dwordx4 v2, s[12:15], s19 offen lds
    s_add_u32 s19, s19, s20
    s_cmp_ge_u32 s18, s95
    s_cselect_b32 s94, s93, 0
    s_sub_u32 s18, s18, s94
    s_sub_u32 s19, s19, s94
    v_mfma_f32_16x16x32_bf16 v[128:131], v[64:67], v[32:35], v[128:131]
    ds_read_b64_tr_b16 v[112:113], v12 offset:49152
    v_mfma_f32_16x16x32_bf16 v[132:135], v[68:71], v[32:35], v[132:135]
    ds_read_b64_tr_b16 v[114:115], v13 offset:49152
    v_mfma_f32_16x16x32_bf16 v[144:147], v[64:67], v[40:43], v[144:147]
    ds_read_b64_tr_b16 v[116:117], v14 offset:49152
    v_mfma_f32_16x16x32_bf16 v[148:151], v[68:71], v[40:43], v[148:151]
    ds_read_b64_tr_b16 v[118:119], v15 offset:49152
    v_mfma_f32_16x16x32_bf16 v[160:163], v[64:67], v[48:51], v[160:163]
    ds_read_b64_tr_b16 v[120:121], v12 offset:57344
    v_mfma_f32_16x16x32_bf16 v[164:167], v[68:71], v[48:51], v[164:167]
    ds_read_b64_tr_b16 v[122:123], v13 offset:57344
    v_mfma_f32_16x16x32_bf16 v[176:179], v[64:67], v[56:59], v[176:179]
    ds_read_b64_tr_b16 v[124:125], v14 offset:57344
    v_mfma_f32_16x16x32_bf16 v[180:183], v[68:71], v[56:59], v[180:183]
    ds_read_b64_tr_b16 v[126:127], v15 offset:57344
    v_mfma_f32_16x16x32_bf16 v[192:195], v[64:67], v[208:211], v[192:195]
    ds_read_b128 v[80:83], v26 offset:32768
    v_mfma_f32_16x16x32_bf16 v[196:199], v[68:71], v[208:211], v[196:199]
    ds_read_b128 v[84:87], v27 offset:32768
    v_mfma_f32_16x16x32_bf16 v[128:131], v[72:75], v[36:39], v[128:131]
    ds_read_b128 v[88:91], v26 offset:34816
    v_mfma_f32_16x16x32_bf16 v[132:135], v[76:79], v[36:39], v[132:135]
    ds_read_b128 v[92:95], v27 offset:34816
    v_mfma_f32_16x16x32_bf16 v[144:147], v[72:75], v[44:47], v[144:147]
    ds_read_b128 v[96:99], v26 offset:36864
    v_mfma_f32_16x16x32_bf16 v[148:151], v[76:79], v[44:47], v[148:151]
    ds_read_b128 v[100:103], v27 offset:36864
    v_mfma_f32_16x16x32_bf16 v[160:163], v[72:75], v[52:55], v[160:163]
    ds_read_b128 v[104:107], v26 offset:38912
    v_mfma_f32_16x16x32_bf16 v[164:167], v[76:79], v[52:55], v[164:167]
    ds_read_b128 v[108:111], v27 offset:38912
    v_mfma_f32_16x16x32_bf16 v[176:179], v[72:75], v[60:63], v[176:179]
    v_mfma_f32_16x16x32_bf16 v[180:183], v[76:79], v[60:63], v[180:183]
    v_mfma_f32_16x16x32_bf16 v[192:195], v[72:75], v[208:211], v[192:195]
    v_mfma_f32_16x16x32_bf16 v[196:199], v[76:79], v[208:211], v[196:199]
    s_waitcnt lgkmcnt(0)
    s_waitcnt vmcnt(8)
    s_barrier
    s_add_u32 m0, s21, 98304
    s_nop 0
    buffer_load_dwordx4 v23, s[88:91], s16 offen lds
    s_add_u32 s16, s16, s62
    s_add_u32 m0, s21, 99328
    s_nop 0
    buffer_load_dwordx4 v23, s[88:91], s17 offen lds
    s_add_u32 s17, s17, s62
    s_cmp_ge_u32 s16, s92
    s_cselect_b32 s94, 2048, 0
    s_sub_u32 s16, s16, s94
    s_sub_u32 s17, s17, s94
    s_add_u32 m0, s22, 98304
    s_nop 0
    buffer_load_dwordx4 v2, s[8:11], s18 offen lds
    s_add_u32 s18, s18, s20
    s_add_u32 m0, s22, 106496
    s_nop 0
    buffer_load_dwordx4 v2, s[12:15], s19 offen lds
    s_add_u32 s19, s19, s20
    s_cmp_ge_u32 s18, s95
    s_cselect_b32 s94, s93, 0
    s_sub_u32 s18, s18, s94
    s_sub_u32 s19, s19, s94
    v_mfma_f32_16x16x32_bf16 v[128:131], v[112:115], v[80:83], v[128:131]
    ds_read_b64_tr_b16 v[64:65], v8 offset:16384
    v_mfma_f32_16x16x32_bf16 v[132:135], v[116:119], v[80:83], v[132:135]
    ds_read_b64_tr_b16 v[66:67], v9 offset:16384
    v_mfma_f32_16x16x32_bf16 v[144:147], v[112:115], v[88:91], v[144:147]
    ds_read_b64_tr_b16 v[68:69], v10 offset:16384
    v_mfma_f32_16x16x32_bf16 v[148:151], v[116:119], v[88:91], v[148:151]
    ds_read_b64_tr_b16 v[70:71], v11 offset:16384
    v_mfma_f32_16x16x32_bf16 v[160:163], v[112:115], v[96:99], v[160:163]
    ds_read_b64_tr_b16 v[72:73], v8 offset:24576
    v_mfma_f32_16x16x32_bf16 v[164:167], v[116:119], v[96:99], v[164:167]
    ds_read_b64_tr_b16 v[74:75], v9 offset:24576
    v_mfma_f32_16x16x32_bf16 v[176:179], v[112:115], v[104:107], v[176:179]
    ds_read_b64_tr_b16 v[76:77], v10 offset:24576
    v_mfma_f32_16x16x32_bf16 v[180:183], v[116:119], v[104:107], v[180:183]
    ds_read_b64_tr_b16 v[78:79], v11 offset:24576
    v_mfma_f32_16x16x32_bf16 v[192:195], v[112:115], v[208:211], v[192:195]
    ds_read_b128 v[32:35], v24 offset:0
    v_mfma_f32_16x16x32_bf16 v[196:199], v[116:119], v[208:211], v[196:199]
    ds_read_b128 v[36:39], v25 offset:0
    v_mfma_f32_16x16x32_bf16 v[128:131], v[120:123], v[84:87], v[128:131]
    ds_read_b128 v[40:43], v24 offset:2048
    v_mfma_f32_16x16x32_bf16 v[132:135], v[124:127], v[84:87], v[132:135]
    ds_read_b128 v[44:47], v25 offset:2048
    v_mfma_f32_16x16x32_bf16 v[144:147], v[120:123], v[92:95], v[144:147]
    ds_read_b128 v[48:51], v24 offset:4096
    v_mfma_f32_16x16x32_bf16 v[148:151], v[124:127], v[92:95], v[148:151]
    ds_read_b128 v[52:55], v25 offset:4096
    v_mfma_f32_16x16x32_bf16 v[160:163], v[120:123], v[100:103], v[160:163]
    ds_read_b128 v[56:59], v24 offset:6144
    v_mfma_f32_16x16x32_bf16 v[164:167], v[124:127], v[100:103], v[164:167]
    ds_read_b128 v[60:63], v25 offset:6144
    v_mfma_f32_16x16x32_bf16 v[176:179], v[120:123], v[108:111], v[176:179]
    v_mfma_f32_16x16x32_bf16 v[180:183], v[124:127], v[108:111], v[180:183]
    v_mfma_f32_16x16x32_bf16 v[192:195], v[120:123], v[208:211], v[192:195]
    v_mfma_f32_16x16x32_bf16 v[196:199], v[124:127], v[208:211], v[196:199]
    s_waitcnt lgkmcnt(0)
    s_waitcnt vmcnt(8)
    s_barrier
    v_mfma_f32_16x16x32_bf16 v[128:131], v[64:67], v[32:35], v[128:131]
    ds_read_b64_tr_b16 v[112:113], v8 offset:49152
    v_mfma_f32_16x16x32_bf16 v[132:135], v[68:71], v[32:35], v[132:135]
    ds_read_b64_tr_b16 v[114:115], v9 offset:49152
    v_mfma_f32_16x16x32_bf16 v[144:147], v[64:67], v[40:43], v[144:147]
    ds_read_b64_tr_b16 v[116:117], v10 offset:49152
    v_mfma_f32_16x16x32_bf16 v[148:151], v[68:71], v[40:43], v[148:151]
    ds_read_b64_tr_b16 v[118:119], v11 offset:49152
    v_mfma_f32_16x16x32_bf16 v[160:163], v[64:67], v[48:51], v[160:163]
    ds_read_b64_tr_b16 v[120:121], v8 offset:57344
    v_mfma_f32_16x16x32_bf16 v[164:167], v[68:71], v[48:51], v[164:167]
    ds_read_b64_tr_b16 v[122:123], v9 offset:57344
    v_mfma_f32_16x16x32_bf16 v[176:179], v[64:67], v[56:59], v[176:179]
    ds_read_b64_tr_b16 v[124:125], v10 offset:57344
    v_mfma_f32_16x16x32_bf16 v[180:183], v[68:71], v[56:59], v[180:183]
    ds_read_b64_tr_b16 v[126:127], v11 offset:57344
    v_mfma_f32_16x16x32_bf16 v[192:195], v[64:67], v[208:211], v[192:195]
    ds_read_b128 v[80:83], v24 offset:32768
    v_mfma_f32_16x16x32_bf16 v[196:199], v[68:71], v[208:211], v[196:199]
    ds_read_b128 v[84:87], v25 offset:32768
    v_mfma_f32_16x16x32_bf16 v[128:131], v[72:75], v[36:39], v[128:131]
    ds_read_b128 v[88:91], v24 offset:34816
    v_mfma_f32_16x16x32_bf16 v[132:135], v[76:79], v[36:39], v[132:135]
    ds_read_b128 v[92:95], v25 offset:34816
    v_mfma_f32_16x16x32_bf16 v[144:147], v[72:75], v[44:47], v[144:147]
    ds_read_b128 v[96:99], v24 offset:36864
    v_mfma_f32_16x16x32_bf16 v[148:151], v[76:79], v[44:47], v[148:151]
    ds_read_b128 v[100:103], v25 offset:36864
    v_mfma_f32_16x16x32_bf16 v[160:163], v[72:75], v[52:55], v[160:163]
    ds_read_b128 v[104:107], v24 offset:38912
    v_mfma_f32_16x16x32_bf16 v[164:167], v[76:79], v[52:55], v[164:167]
    ds_read_b128 v[108:111], v25 offset:38912
    v_mfma_f32_16x16x32_bf16 v[176:179], v[72:75], v[60:63], v[176:179]
    v_mfma_f32_16x16x32_bf16 v[180:183], v[76:79], v[60:63], v[180:183]
    v_mfma_f32_16x16x32_bf16 v[192:195], v[72:75], v[208:211], v[192:195]
    v_mfma_f32_16x16x32_bf16 v[196:199], v[76:79], v[208:211], v[196:199]
    s_waitcnt lgkmcnt(0)
    s_waitcnt vmcnt(4)
    s_barrier
    v_mfma_f32_16x16x32_bf16 v[128:131], v[112:115], v[80:83], v[128:131]
    ds_read_b64_tr_b16 v[64:65], v12 offset:16384
    v_mfma_f32_16x16x32_bf16 v[132:135], v[116:119], v[80:83], v[132:135]
    ds_read_b64_tr_b16 v[66:67], v13 offset:16384
    v_mfma_f32_16x16x32_bf16 v[144:147], v[112:115], v[88:91], v[144:147]
    ds_read_b64_tr_b16 v[68:69], v14 offset:16384
    v_mfma_f32_16x16x32_bf16 v[148:151], v[116:119], v[88:91], v[148:151]
    ds_read_b64_tr_b16 v[70:71], v15 offset:16384
    v_mfma_f32_16x16x32_bf16 v[160:163], v[112:115], v[96:99], v[160:163]
    ds_read_b64_tr_b16 v[72:73], v12 offset:24576
    v_mfma_f32_16x16x32_bf16 v[164:167], v[116:119], v[96:99], v[164:167]
    ds_read_b64_tr_b16 v[74:75], v13 offset:24576
    v_mfma_f32_16x16x32_bf16 v[176:179], v[112:115], v[104:107], v[176:179]
    ds_read_b64_tr_b16 v[76:77], v14 offset:24576
    v_mfma_f32_16x16x32_bf16 v[180:183], v[116:119], v[104:107], v[180:183]
    ds_read_b64_tr_b16 v[78:79], v15 offset:24576
    v_mfma_f32_16x16x32_bf16 v[192:195], v[112:115], v[208:211], v[192:195]
    ds_read_b128 v[32:35], v26 offset:0
    v_mfma_f32_16x16x32_bf16 v[196:199], v[116:119], v[208:211], v[196:199]
    ds_read_b128 v[36:39], v27 offset:0
    v_mfma_f32_16x16x32_bf16 v[128:131], v[120:123], v[84:87], v[128:131]
    ds_read_b128 v[40:43], v26 offset:2048
    v_mfma_f32_16x16x32_bf16 v[132:135], v[124:127], v[84:87], v[132:135]
    ds_read_b128 v[44:47], v27 offset:2048
    v_mfma_f32_16x16x32_bf16 v[144:147], v[120:123], v[92:95], v[144:147]
    ds_read_b128 v[48:51], v26 offset:4096
    v_mfma_f32_16x16x32_bf16 v[148:151], v[124:127], v[92:95], v[148:151]
    ds_read_b128 v[52:55], v27 offset:4096
    v_mfma_f32_16x16x32_bf16 v[160:163], v[120:123], v[100:103], v[160:163]
    ds_read_b128 v[56:59], v26 offset:6144
    v_mfma_f32_16x16x32_bf16 v[164:167], v[124:127], v[100:103], v[164:167]
    ds_read_b128 v[60:63], v27 offset:6144
    v_mfma_f32_16x16x32_bf16 v[176:179], v[120:123], v[108:111], v[176:179]
    v_mfma_f32_16x16x32_bf16 v[180:183], v[124:127], v[108:111], v[180:183]
    v_mfma_f32_16x16x32_bf16 v[192:195], v[120:123], v[208:211], v[192:195]
    v_mfma_f32_16x16x32_bf16 v[196:199], v[124:127], v[208:211], v[196:199]
    s_waitcnt lgkmcnt(0)
    s_waitcnt vmcnt(0)
    s_barrier
    v_mfma_f32_16x16x32_bf16 v[128:131], v[64:67], v[32:35], v[128:131]
    ds_read_b64_tr_b16 v[112:113], v12 offset:49152
    v_mfma_f32_16x16x32_bf16 v[132:135], v[68:71], v[32:35], v[132:135]
    ds_read_b64_tr_b16 v[114:115], v13 offset:49152
    v_mfma_f32_16x16x32_bf16 v[144:147], v[64:67], v[40:43], v[144:147]
    ds_read_b64_tr_b16 v[116:117], v14 offset:49152
    v_mfma_f32_16x16x32_bf16 v[148:151], v[68:71], v[40:43], v[148:151]
    ds_read_b64_tr_b16 v[118:119], v15 offset:49152
    v_mfma_f32_16x16x32_bf16 v[160:163], v[64:67], v[48:51], v[160:163]
    ds_read_b64_tr_b16 v[120:121], v12 offset:57344
    v_mfma_f32_16x16x32_bf16 v[164:167], v[68:71], v[48:51], v[164:167]
    ds_read_b64_tr_b16 v[122:123], v13 offset:57344
    v_mfma_f32_16x16x32_bf16 v[176:179], v[64:67], v[56:59], v[176:179]
    ds_read_b64_tr_b16 v[124:125], v14 offset:57344
    v_mfma_f32_16x16x32_bf16 v[180:183], v[68:71], v[56:59], v[180:183]
    ds_read_b64_tr_b16 v[126:127], v15 offset:57344
    v_mfma_f32_16x16x32_bf16 v[192:195], v[64:67], v[208:211], v[192:195]
    ds_read_b128 v[80:83], v26 offset:32768
    v_mfma_f32_16x16x32_bf16 v[196:199], v[68:71], v[208:211], v[196:199]
    ds_read_b128 v[84:87], v27 offset:32768
    v_mfma_f32_16x16x32_bf16 v[128:131], v[72:75], v[36:39], v[128:131]
    ds_read_b128 v[88:91], v26 offset:34816
    v_mfma_f32_16x16x32_bf16 v[132:135], v[76:79], v[36:39], v[132:135]
    ds_read_b128 v[92:95], v27 offset:34816
    v_mfma_f32_16x16x32_bf16 v[144:147], v[72:75], v[44:47], v[144:147]
    ds_read_b128 v[96:99], v26 offset:36864
    v_mfma_f32_16x16x32_bf16 v[148:151], v[76:79], v[44:47], v[148:151]
    ds_read_b128 v[100:103], v27 offset:36864
    v_mfma_f32_16x16x32_bf16 v[160:163], v[72:75], v[52:55], v[160:163]
    ds_read_b128 v[104:107], v26 offset:38912
    v_mfma_f32_16x16x32_bf16 v[164:167], v[76:79], v[52:55], v[164:167]
    ds_read_b128 v[108:111], v27 offset:38912
    v_mfma_f32_16x16x32_bf16 v[176:179], v[72:75], v[60:63], v[176:179]
    v_mfma_f32_16x16x32_bf16 v[180:183], v[76:79], v[60:63], v[180:183]
    v_mfma_f32_16x16x32_bf16 v[192:195], v[72:75], v[208:211], v[192:195]
    v_mfma_f32_16x16x32_bf16 v[196:199], v[76:79], v[208:211], v[196:199]
    s_waitcnt lgkmcnt(0)
    s_waitcnt vmcnt(0)
    s_barrier
    v_mfma_f32_16x16x32_bf16 v[128:131], v[112:115], v[80:83], v[128:131]
    ds_read_b64_tr_b16 v[64:65], v8 offset:16384
    v_mfma_f32_16x16x32_bf16 v[132:135], v[116:119], v[80:83], v[132:135]
    ds_read_b64_tr_b16 v[66:67], v9 offset:16384
    v_mfma_f32_16x16x32_bf16 v[144:147], v[112:115], v[88:91], v[144:147]
    ds_read_b64_tr_b16 v[68:69], v10 offset:16384
    v_mfma_f32_16x16x32_bf16 v[148:151], v[116:119], v[88:91], v[148:151]
    ds_read_b64_tr_b16 v[70:71], v11 offset:16384
    v_mfma_f32_16x16x32_bf16 v[160:163], v[112:115], v[96:99], v[160:163]
    ds_read_b64_tr_b16 v[72:73], v8 offset:24576
    v_mfma_f32_16x16x32_bf16 v[164:167], v[116:119], v[96:99], v[164:167]
    ds_read_b64_tr_b16 v[74:75], v9 offset:24576
    v_mfma_f32_16x16x32_bf16 v[176:179], v[112:115], v[104:107], v[176:179]
    ds_read_b64_tr_b16 v[76:77], v10 offset:24576
    v_mfma_f32_16x16x32_bf16 v[180:183], v[116:119], v[104:107], v[180:183]
    ds_read_b64_tr_b16 v[78:79], v11 offset:24576
    v_mfma_f32_16x16x32_bf16 v[192:195], v[112:115], v[208:211], v[192:195]
    ds_read_b128 v[32:35], v24 offset:0
    v_mfma_f32_16x16x32_bf16 v[196:199], v[116:119], v[208:211], v[196:199]
    ds_read_b128 v[36:39], v25 offset:0
    v_mfma_f32_16x16x32_bf16 v[128:131], v[120:123], v[84:87], v[128:131]
    ds_read_b128 v[40:43], v24 offset:2048
    v_mfma_f32_16x16x32_bf16 v[132:135], v[124:127], v[84:87], v[132:135]
    ds_read_b128 v[44:47], v25 offset:2048
    v_mfma_f32_16x16x32_bf16 v[144:147], v[120:123], v[92:95], v[144:147]
    ds_read_b128 v[48:51], v24 offset:4096
    v_mfma_f32_16x16x32_bf16 v[148:151], v[124:127], v[92:95], v[148:151]
    ds_read_b128 v[52:55], v25 offset:4096
    v_mfma_f32_16x16x32_bf16 v[160:163], v[120:123], v[100:103], v[160:163]
    ds_read_b128 v[56:59], v24 offset:6144
    v_mfma_f32_16x16x32_bf16 v[164:167], v[124:127], v[100:103], v[164:167]
    ds_read_b128 v[60:63], v25 offset:6144
    v_mfma_f32_16x16x32_bf16 v[176:179], v[120:123], v[108:111], v[176:179]
    v_mfma_f32_16x16x32_bf16 v[180:183], v[124:127], v[108:111], v[180:183]
    v_mfma_f32_16x16x32_bf16 v[192:195], v[120:123], v[208:211], v[192:195]
    v_mfma_f32_16x16x32_bf16 v[196:199], v[124:127], v[208:211], v[196:199]
    s_waitcnt lgkmcnt(0)
    v_and_b32 v20, 0xf0, v1
    v_lshrrev_b32 v20, 1, v20
    s_lshl_b32 s30, s26, 9
    s_add_u32 s30, s30, 188743680
    s_mov_b32 s31, 0x40000
    v_and_b32 v21, 1, v4
    v_lshlrev_b32 v21, 10, v21
    v_xor_b32 v8, v21, v8
    v_xor_b32 v9, v21, v9
    v_xor_b32 v10, v21, v10
    v_xor_b32 v11, v21, v11
    v_xor_b32 v12, v21, v12
    v_xor_b32 v13, v21, v13
    v_xor_b32 v14, v21, v14
    v_xor_b32 v15, v21, v15
w_stX:
    buffer_load_dword v22, off, s[64:67], 0 offset:192 sc1
    buffer_load_dwordx2 v[24:25], v20, s[4:7], s30 offen offset:0 sc1
    buffer_load_dwordx2 v[26:27], v20, s[4:7], s30 offen offset:128 sc1
    buffer_load_dwordx2 v[28:29], v20, s[4:7], s30 offen offset:256 sc1
    buffer_load_dwordx2 v[30:31], v20, s[4:7], s30 offen offset:384 sc1
    s_waitcnt vmcnt(0)
    v_readfirstlane_b32 s29, v22
    s_cmp_ge_u32 s29, 32
    s_cbranch_scc1 w_stXok
    s_sleep 4
    s_sub_u32 s31, s31, 1
    s_cbranch_scc0 w_stX
w_stXok:
    buffer_load_dword v22, off, s[64:67], 0 sc1
    v_fma_f32 v128, -v24, v192, v128
    v_fma_f32 v129, -v24, v193, v129
    v_fma_f32 v130, -v24, v194, v130
    v_fma_f32 v131, -v24, v195, v131
    v_fma_f32 v132, -v24, v196, v132
    v_fma_f32 v133, -v24, v197, v133
    v_fma_f32 v134, -v24, v198, v134
    v_fma_f32 v135, -v24, v199, v135
    v_mul_f32 v128, v128, v25
    v_mul_f32 v129, v129, v25
    v_mul_f32 v130, v130, v25
    v_mul_f32 v131, v131, v25
    v_mul_f32 v132, v132, v25
    v_mul_f32 v133, v133, v25
    v_mul_f32 v134, v134, v25
    v_mul_f32 v135, v135, v25
    v_fma_f32 v144, -v26, v192, v144
    v_fma_f32 v145, -v26, v193, v145
    v_fma_f32 v146, -v26, v194, v146
    v_fma_f32 v147, -v26, v195, v147
    v_fma_f32 v148, -v26, v196, v148
    v_fma_f32 v149, -v26, v197, v149
    v_fma_f32 v150, -v26, v198, v150
    v_fma_f32 v151, -v26, v199, v151
    v_mul_f32 v144, v144, v27
    v_mul_f32 v145, v145, v27
    v_mul_f32 v146, v146, v27
    v_mul_f32 v147, v147, v27
    v_mul_f32 v148, v148, v27
    v_mul_f32 v149, v149, v27
    v_mul_f32 v150, v150, v27
    v_mul_f32 v151, v151, v27
    v_fma_f32 v160, -v28, v192, v160
    v_fma_f32 v161, -v28, v193, v161
    v_fma_f32 v162, -v28, v194, v162
    v_fma_f32 v163, -v28, v195, v163
    v_fma_f32 v164, -v28, v196, v164
    v_fma_f32 v165, -v28, v197, v165
    v_fma_f32 v166, -v28, v198, v166
    v_fma_f32 v167, -v28, v199, v167
    v_mul_f32 v160, v160, v29
    v_mul_f32 v161, v161, v29
    v_mul_f32 v162, v162, v29
    v_mul_f32 v163, v163, v29
    v_mul_f32 v164, v164, v29
    v_mul_f32 v165, v165, v29
    v_mul_f32 v166, v166, v29
    v_mul_f32 v167, v167, v29
    v_fma_f32 v176, -v30, v192, v176
    v_fma_f32 v177, -v30, v193, v177
    v_fma_f32 v178, -v30, v194, v178
    v_fma_f32 v179, -v30, v195, v179
    v_fma_f32 v180, -v30, v196, v180
    v_fma_f32 v181, -v30, v197, v181
    v_fma_f32 v182, -v30, v198, v182
    v_fma_f32 v183, -v30, v199, v183
    v_mul_f32 v176, v176, v31
    v_mul_f32 v177, v177, v31
    v_mul_f32 v178, v178, v31
    v_mul_f32 v179, v179, v31
    v_mul_f32 v180, v180, v31
    v_mul_f32 v181, v181, v31
    v_mul_f32 v182, v182, v31
    v_mul_f32 v183, v183, v31
    s_lshl_b32 s30, s27, 10
    s_add_u32 s30, s30, s49
    s_nop 7
    v_cvt_pk_bf16_f32 v80, v128, v129
    v_cvt_pk_bf16_f32 v81, v130, v131
    v_cvt_pk_bf16_f32 v82, v132, v133
    v_cvt_pk_bf16_f32 v83, v134, v135
    buffer_store_dwordx4 v[80:83], v1, s[4:7], s30 offen sc1
    s_add_u32 s30, s30, s50
    v_cvt_pk_bf16_f32 v84, v144, v145
    v_cvt_pk_bf16_f32 v85, v146, v147
    v_cvt_pk_bf16_f32 v86, v148, v149
    v_cvt_pk_bf16_f32 v87, v150, v151
    buffer_store_dwordx4 v[84:87], v1, s[4:7], s30 offen sc1
    s_add_u32 s30, s30, s50
    v_cvt_pk_bf16_f32 v88, v160, v161
    v_cvt_pk_bf16_f32 v89, v162, v163
    v_cvt_pk_bf16_f32 v90, v164, v165
    v_cvt_pk_bf16_f32 v91, v166, v167
    buffer_store_dwordx4 v[88:91], v1, s[4:7], s30 offen sc1
    s_add_u32 s30, s30, s50
    v_cvt_pk_bf16_f32 v92, v176, v177
    v_cvt_pk_bf16_f32 v93, v178, v179
    v_cvt_pk_bf16_f32 v94, v180, v181
    v_cvt_pk_bf16_f32 v95, v182, v183
    buffer_store_dwordx4 v[92:95], v1, s[4:7], s30 offen sc1
    s_add_u32 s30, s30, s50
    s_mov_b32 s28, s51
    s_mov_b32 s57, s53
    s_branch w_drain
w_firstM:
    s_waitcnt vmcnt(6)
    s_barrier
    s_add_u32 m0, s21, 0
    s_nop 0
    buffer_load_dwordx4 v1, s[4:7], s16 offen sc1 lds
    s_add_u32 s16, s16, s62
    s_add_u32 m0, s22, 0
    s_nop 0
    buffer_load_dwordx4 v2, s[8:11], s18 offen lds
    s_add_u32 s18, s18, s20
    s_add_u32 m0, s22, 8192
    s_nop 0
    buffer_load_dwordx4 v2, s[12:15], s19 offen lds
    s_add_u32 s19, s19, s20
    v_mfma_f32_16x16x32_bf16 v[128:131], v[64:67], v[32:35], 0
    ds_read_b64_tr_b16 v[112:113], v8 offset:49152
    v_mfma_f32_16x16x32_bf16 v[132:135], v[68:71], v[32:35], 0
    ds_read_b64_tr_b16 v[114:115], v9 offset:49152
    v_mfma_f32_16x16x32_bf16 v[136:139], v[72:75], v[32:35], 0
    ds_read_b64_tr_b16 v[116:117], v10 offset:49152
    v_mfma_f32_16x16x32_bf16 v[140:143], v[76:79], v[32:35], 0
    ds_read_b64_tr_b16 v[118:119], v11 offset:49152
    v_mfma_f32_16x16x32_bf16 v[144:147], v[64:67], v[40:43], 0
    ds_read_b64_tr_b16 v[120:121], v8 offset:57344
    v_mfma_f32_16x16x32_bf16 v[148:151], v[68:71], v[40:43], 0
    ds_read_b64_tr_b16 v[122:123], v9 offset:57344
    v_mfma_f32_16x16x32_bf16 v[152:155], v[72:75], v[40:43], 0
    ds_read_b64_tr_b16 v[124:125], v10 offset:57344
    v_mfma_f32_16x16x32_bf16 v[156:159], v[76:79], v[40:43], 0
    ds_read_b64_tr_b16 v[126:127], v11 offset:57344
    v_mfma_f32_16x16x32_bf16 v[160:163], v[64:67], v[48:51], 0
    ds_read_b128 v[80:83], v5 offset:32768
    v_mfma_f32_16x16x32_bf16 v[164:167], v[68:71], v[48:51], 0
    ds_read_b128 v[88:91], v5 offset:34816
    v_mfma_f32_16x16x32_bf16 v[168:171], v[72:75], v[48:51], 0
    ds_read_b128 v[96:99], v5 offset:36864
    v_mfma_f32_16x16x32_bf16 v[172:175], v[76:79], v[48:51], 0
    ds_read_b128 v[104:107], v5 offset:38912
    v_mfma_f32_16x16x32_bf16 v[176:179], v[64:67], v[56:59], 0
    v_mfma_f32_16x16x32_bf16 v[180:183], v[68:71], v[56:59], 0
    v_mfma_f32_16x16x32_bf16 v[184:187], v[72:75], v[56:59], 0
    v_mfma_f32_16x16x32_bf16 v[188:191], v[76:79], v[56:59], 0
    s_waitcnt lgkmcnt(0)
    s_waitcnt vmcnt(6)
    s_barrier
    s_add_u32 m0, s21, 32768
    s_nop 0
    buffer_load_dwordx4 v1, s[4:7], s16 offen sc1 lds
    s_add_u32 s16, s16, s62
    s_add_u32 m0, s22, 32768
    s_nop 0
    buffer_load_dwordx4 v2, s[8:11], s18 offen lds
    s_add_u32 s18, s18, s20
    s_add_u32 m0, s22, 40960
    s_nop 0
    buffer_load_dwordx4 v2, s[12:15], s19 offen lds
    s_add_u32 s19, s19, s20
    v_mfma_f32_16x16x32_bf16 v[128:131], v[112:115], v[80:83], v[128:131]
    ds_read_b64_tr_b16 v[64:65], v12 offset:16384
    v_mfma_f32_16x16x32_bf16 v[132:135], v[116:119], v[80:83], v[132:135]
    ds_read_b64_tr_b16 v[66:67], v13 offset:16384
    v_mfma_f32_16x16x32_bf16 v[136:139], v[120:123], v[80:83], v[136:139]
    ds_read_b64_tr_b16 v[68:69], v14 offset:16384
    v_mfma_f32_16x16x32_bf16 v[140:143], v[124:127], v[80:83], v[140:143]
    ds_read_b64_tr_b16 v[70:71], v15 offset:16384
    v_mfma_f32_16x16x32_bf16 v[144:147], v[112:115], v[88:91], v[144:147]
    ds_read_b64_tr_b16 v[72:73], v12 offset:24576
    v_mfma_f32_16x16x32_bf16 v[148:151], v[116:119], v[88:91], v[148:151]
    ds_read_b64_tr_b16 v[74:75], v13 offset:24576
    v_mfma_f32_16x16x32_bf16 v[152:155], v[120:123], v[88:91], v[152:155]
    ds_read_b64_tr_b16 v[76:77], v14 offset:24576
    v_mfma_f32_16x16x32_bf16 v[156:159], v[124:127], v[88:91], v[156:159]
    ds_read_b64_tr_b16 v[78:79], v15 offset:24576
    v_mfma_f32_16x16x32_bf16 v[160:163], v[112:115], v[96:99], v[160:163]
    ds_read_b128 v[32:35], v6 offset:0
    v_mfma_f32_16x16x32_bf16 v[164:167], v[116:119], v[96:99], v[164:167]
    ds_read_b128 v[40:43], v6 offset:2048
    v_mfma_f32_16x16x32_bf16 v[168:171], v[120:123], v[96:99], v[168:171]
    ds_read_b128 v[48:51], v6 offset:4096
    v_mfma_f32_16x16x32_bf16 v[172:175], v[124:127], v[96:99], v[172:175]
    ds_read_b128 v[56:59], v6 offset:6144
    v_mfma_f32_16x16x32_bf16 v[176:179], v[112:115], v[104:107], v[176:179]
    v_mfma_f32_16x16x32_bf16 v[180:183], v[116:119], v[104:107], v[180:183]
    v_mfma_f32_16x16x32_bf16 v[184:187], v[120:123], v[104:107], v[184:187]
    v_mfma_f32_16x16x32_bf16 v[188:191], v[124:127], v[104:107], v[188:191]
    s_waitcnt lgkmcnt(0)
    s_waitcnt vmcnt(6)
    s_barrier
    s_add_u32 m0, s21, 65536
    s_nop 0
    buffer_load_dwordx4 v1, s[4:7], s16 offen sc1 lds
    s_add_u32 s16, s16, s62
    s_add_u32 m0, s22, 65536
    s_nop 0
    buffer_load_dwordx4 v2, s[8:11], s18 offen lds
    s_add_u32 s18, s18, s20
    s_add_u32 m0, s22, 73728
    s_nop 0
    buffer_load_dwordx4 v2, s[12:15], s19 offen lds
    s_add_u32 s19, s19, s20
    v_mfma_f32_16x16x32_bf16 v[128:131], v[64:67], v[32:35], v[128:131]
    ds_read_b64_tr_b16 v[112:113], v12 offset:49152
    v_mfma_f32_16x16x32_bf16 v[132:135], v[68:71], v[32:35], v[132:135]
    ds_read_b64_tr_b16 v[114:115], v13 offset:49152
    v_mfma_f32_16x16x32_bf16 v[136:139], v[72:75], v[32:35], v[136:139]
    ds_read_b64_tr_b16 v[116:117], v14 offset:49152
    v_mfma_f32_16x16x32_bf16 v[140:143], v[76:79], v[32:35], v[140:143]
    ds_read_b64_tr_b16 v[118:119], v15 offset:49152
    v_mfma_f32_16x16x32_bf16 v[144:147], v[64:67], v[40:43], v[144:147]
    ds_read_b64_tr_b16 v[120:121], v12 offset:57344
    v_mfma_f32_16x16x32_bf16 v[148:151], v[68:71], v[40:43], v[148:151]
    ds_read_b64_tr_b16 v[122:123], v13 offset:57344
    v_mfma_f32_16x16x32_bf16 v[152:155], v[72:75], v[40:43], v[152:155]
    ds_read_b64_tr_b16 v[124:125], v14 offset:57344
    v_mfma_f32_16x16x32_bf16 v[156:159], v[76:79], v[40:43], v[156:159]
    ds_read_b64_tr_b16 v[126:127], v15 offset:57344
    v_mfma_f32_16x16x32_bf16 v[160:163], v[64:67], v[48:51], v[160:163]
    ds_read_b128 v[80:83], v6 offset:32768
    v_mfma_f32_16x16x32_bf16 v[164:167], v[68:71], v[48:51], v[164:167]
    ds_read_b128 v[88:91], v6 offset:34816
    v_mfma_f32_16x16x32_bf16 v[168:171], v[72:75], v[48:51], v[168:171]
    ds_read_b128 v[96:99], v6 offset:36864
    v_mfma_f32_16x16x32_bf16 v[172:175], v[76:79], v[48:51], v[172:175]
    ds_read_b128 v[104:107], v6 offset:38912
    v_mfma_f32_16x16x32_bf16 v[176:179], v[64:67], v[56:59], v[176:179]
    v_mfma_f32_16x16x32_bf16 v[180:183], v[68:71], v[56:59], v[180:183]
    v_mfma_f32_16x16x32_bf16 v[184:187], v[72:75], v[56:59], v[184:187]
    v_mfma_f32_16x16x32_bf16 v[188:191], v[76:79], v[56:59], v[188:191]
    s_waitcnt lgkmcnt(0)
    s_waitcnt vmcnt(6)
    s_barrier
    s_add_u32 m0, s21, 98304
    s_nop 0
    buffer_load_dwordx4 v1, s[4:7], s16 offen sc1 lds
    s_add_u32 s16, s16, s62
    s_add_u32 m0, s22, 98304
    s_nop 0
    buffer_load_dwordx4 v2, s[8:11], s18 offen lds
    s_add_u32 s18, s18, s20
    s_add_u32 m0, s22, 106496
    s_nop 0
    buffer_load_dwordx4 v2, s[12:15], s19 offen lds
    s_add_u32 s19, s19, s20
    v_mfma_f32_16x16x32_bf16 v[128:131], v[112:115], v[80:83], v[128:131]
    ds_read_b64_tr_b16 v[64:65], v8 offset:16384
    v_mfma_f32_16x16x32_bf16 v[132:135], v[116:119], v[80:83], v[132:135]
    ds_read_b64_tr_b16 v[66:67], v9 offset:16384
    v_mfma_f32_16x16x32_bf16 v[136:139], v[120:123], v[80:83], v[136:139]
    ds_read_b64_tr_b16 v[68:69], v10 offset:16384
    v_mfma_f32_16x16x32_bf16 v[140:143], v[124:127], v[80:83], v[140:143]
    ds_read_b64_tr_b16 v[70:71], v11 offset:16384
    v_mfma_f32_16x16x32_bf16 v[144:147], v[112:115], v[88:91], v[144:147]
    ds_read_b64_tr_b16 v[72:73], v8 offset:24576
    v_mfma_f32_16x16x32_bf16 v[148:151], v[116:119], v[88:91], v[148:151]
    ds_read_b64_tr_b16 v[74:75], v9 offset:24576
    v_mfma_f32_16x16x32_bf16 v[152:155], v[120:123], v[88:91], v[152:155]
    ds_read_b64_tr_b16 v[76:77], v10 offset:24576
    v_mfma_f32_16x16x32_bf16 v[156:159], v[124:127], v[88:91], v[156:159]
    ds_read_b64_tr_b16 v[78:79], v11 offset:24576
    v_mfma_f32_16x16x32_bf16 v[160:163], v[112:115], v[96:99], v[160:163]
    ds_read_b128 v[32:35], v5 offset:0
    v_mfma_f32_16x16x32_bf16 v[164:167], v[116:119], v[96:99], v[164:167]
    ds_read_b128 v[40:43], v5 offset:2048
    v_mfma_f32_16x16x32_bf16 v[168:171], v[120:123], v[96:99], v[168:171]
    ds_read_b128 v[48:51], v5 offset:4096
    v_mfma_f32_16x16x32_bf16 v[172:175], v[124:127], v[96:99], v[172:175]
    ds_read_b128 v[56:59], v5 offset:6144
    v_mfma_f32_16x16x32_bf16 v[176:179], v[112:115], v[104:107], v[176:179]
    v_mfma_f32_16x16x32_bf16 v[180:183], v[116:119], v[104:107], v[180:183]
    v_mfma_f32_16x16x32_bf16 v[184:187], v[120:123], v[104:107], v[184:187]
    v_mfma_f32_16x16x32_bf16 v[188:191], v[124:127], v[104:107], v[188:191]
    s_waitcnt lgkmcnt(0)
w_loop_chkM:
    s_sub_u32 s23, s23, 1
w_loopM:
    s_cmp_lg_u32 s23, 1
    s_cbranch_scc1 w_bodyM
    v_readfirstlane_b32 s68, v22
    s_cmp_ge_u32 s68, 128
    s_cselect_b32 s70, 0, s70
    v_readfirstlane_b32 s30, v16
    s_cmp_ge_u32 s30, s45
    s_cselect_b32 s30, 0, 1
    s_or_b32 s30, s30, s70
    s_cmp_ge_u32 s32, 4
    s_cselect_b32 s30, 1, s30
    s_cmp_eq_u32 s32, 0
    s_cselect_b32 s30, 1, s30
    v_mov_b32 v20, s30
    ds_write_b32 v7, v20
    s_cbranch_scc1 w_bodyM
    s_load_dwordx2 s[8:9], s[0:1], s33
    s_load_dwordx2 s[12:13], s[0:1], s34
    s_mov_b32 s10, s38
    s_mov_b32 s14, s38
    s_cmp_ge_u32 s32, 4
    s_cselect_b32 s31, 0, 1
    s_lshl_b32 s30, s3, s31
    s_mul_i32 s30, s30, s40
    s_add_u32 s16, s39, s30
    s_cmp_eq_u32 s32, 4
    s_cselect_b32 s30, 1024, s40
    s_cselect_b32 s31, 6, 5
    s_lshl_b32 s62, 32, s31
    s_add_u32 s17, s16, s30
    s_lshl_b32 s30, s3, 2
    s_mul_i32 s30, s30, s35
    s_add_u32 s18, s36, s30
    s_add_u32 s19, s37, s30
    s_lshl_b32 s20, s35, s31
    v_mul_u32_u24 v2, s35, v4
    v_add_u32 v2, v2, v3
    s_waitcnt lgkmcnt(0)
    s_waitcnt vmcnt(6)
    s_barrier
    s_add_u32 m0, s21, 0
    s_nop 0
    buffer_load_dwordx4 v1, s[4:7], s16 offen sc1 lds
    s_add_u32 s16, s16, s62
    s_add_u32 m0, s21, 1024
    s_nop 0
    buffer_load_dwordx4 v1, s[4:7], s17 offen sc1 lds
    s_add_u32 s17, s17, s62
    s_add_u32 m0, s22, 0
    s_nop 0
    buffer_load_dwordx4 v2, s[8:11], s18 offen lds
    s_add_u32 s18, s18, s20
    s_add_u32 m0, s22, 8192
    s_nop 0
    buffer_load_dwordx4 v2, s[12:15], s19 offen lds
    s_add_u32 s19, s19, s20
    v_mfma_f32_16x16x32_bf16 v[128:131], v[64:67], v[32:35], v[128:131]
    ds_read_b64_tr_b16 v[112:113], v8 offset:49152
    v_mfma_f32_16x16x32_bf16 v[132:135], v[68:71], v[32:35], v[132:135]
    ds_read_b64_tr_b16 v[114:115], v9 offset:49152
    v_mfma_f32_16x16x32_bf16 v[136:139], v[72:75], v[32:35], v[136:139]
    ds_read_b64_tr_b16 v[116:117], v10 offset:49152
    v_mfma_f32_16x16x32_bf16 v[140:143], v[76:79], v[32:35], v[140:143]
    ds_read_b64_tr_b16 v[118:119], v11 offset:49152
    v_mfma_f32_16x16x32_bf16 v[144:147], v[64:67], v[40:43], v[144:147]
    ds_read_b64_tr_b16 v[120:121], v8 offset:57344
    v_mfma_f32_16x16x32_bf16 v[148:151], v[68:71], v[40:43], v[148:151]
    ds_read_b64_tr_b16 v[122:123], v9 offset:57344
    v_mfma_f32_16x16x32_bf16 v[152:155], v[72:75], v[40:43], v[152:155]
    ds_read_b64_tr_b16 v[124:125], v10 offset:57344
    v_mfma_f32_16x16x32_bf16 v[156:159], v[76:79], v[40:43], v[156:159]
    ds_read_b64_tr_b16 v[126:127], v11 offset:57344
    v_mfma_f32_16x16x32_bf16 v[160:163], v[64:67], v[48:51], v[160:163]
    ds_read_b128 v[80:83], v5 offset:32768
    v_mfma_f32_16x16x32_bf16 v[164:167], v[68:71], v[48:51], v[164:167]
    ds_read_b128 v[88:91], v5 offset:34816
    v_mfma_f32_16x16x32_bf16 v[168:171], v[72:75], v[48:51], v[168:171]
    ds_read_b128 v[96:99], v5 offset:36864
    v_mfma_f32_16x16x32_bf16 v[172:175], v[76:79], v[48:51], v[172:175]
    ds_read_b128 v[104:107], v5 offset:38912
    v_mfma_f32_16x16x32_bf16 v[176:179], v[64:67], v[56:59], v[176:179]
    v_mfma_f32_16x16x32_bf16 v[180:183], v[68:71], v[56:59], v[180:183]
    v_mfma_f32_16x16x32_bf16 v[184:187], v[72:75], v[56:59], v[184:187]
    v_mfma_f32_16x16x32_bf16 v[188:191], v[76:79], v[56:59], v[188:191]
    s_waitcnt lgkmcnt(0)
    s_waitcnt vmcnt(7)
    s_barrier
    s_add_u32 m0, s21, 32768
    s_nop 0
    buffer_load_dwordx4 v1, s[4:7], s16 offen sc1 lds
    s_add_u32 s16, s16, s62
    s_add_u32 m0, s21, 33792
    s_nop 0
    buffer_load_dwordx4 v1, s[4:7], s17 offen sc1 lds
    s_add_u32 s17, s17, s62
    s_add_u32 m0, s22, 32768
    s_nop 0
    buffer_load_dwordx4 v2, s[8:11], s18 offen lds
    s_add_u32 s18, s18, s20
    s_add_u32 m0, s22, 40960
    s_nop 0
    buffer_load_dwordx4 v2, s[12:15], s19 offen lds
    s_add_u32 s19, s19, s20
    v_mfma_f32_16x16x32_bf16 v[128:131], v[112:115], v[80:83], v[128:131]
    ds_read_b64_tr_b16 v[64:65], v12 offset:16384
    v_mfma_f32_16x16x32_bf16 v[132:135], v[116:119], v[80:83], v[132:135]
    ds_read_b64_tr_b16 v[66:67], v13 offset:16384
    v_mfma_f32_16x16x32_bf16 v[136:139], v[120:123], v[80:83], v[136:139]
    ds_read_b64_tr_b16 v[68:69], v14 offset:16384
    v_mfma_f32_16x16x32_bf16 v[140:143], v[124:127], v[80:83], v[140:143]
    ds_read_b64_tr_b16 v[70:71], v15 offset:16384
    v_mfma_f32_16x16x32_bf16 v[144:147], v[112:115], v[88:91], v[144:147]
    ds_read_b64_tr_b16 v[72:73], v12 offset:24576
    v_mfma_f32_16x16x32_bf16 v[148:151], v[116:119], v[88:91], v[148:151]
    ds_read_b64_tr_b16 v[74:75], v13 offset:24576
    v_mfma_f32_16x16x32_bf16 v[152:155], v[120:123], v[88:91], v[152:155]
    ds_read_b64_tr_b16 v[76:77], v14 offset:24576
    v_mfma_f32_16x16x32_bf16 v[156:159], v[124:127], v[88:91], v[156:159]
    ds_read_b64_tr_b16 v[78:79], v15 offset:24576
    v_mfma_f32_16x16x32_bf16 v[160:163], v[112:115], v[96:99], v[160:163]
    ds_read_b128 v[32:35], v6 offset:0
    v_mfma_f32_16x16x32_bf16 v[164:167], v[116:119], v[96:99], v[164:167]
    ds_read_b128 v[40:43], v6 offset:2048
    v_mfma_f32_16x16x32_bf16 v[168:171], v[120:123], v[96:99], v[168:171]
    ds_read_b128 v[48:51], v6 offset:4096
    v_mfma_f32_16x16x32_bf16 v[172:175], v[124:127], v[96:99], v[172:175]
    ds_read_b128 v[56:59], v6 offset:6144
    v_mfma_f32_16x16x32_bf16 v[176:179], v[112:115], v[104:107], v[176:179]
    v_mfma_f32_16x16x32_bf16 v[180:183], v[116:119], v[104:107], v[180:183]
    v_mfma_f32_16x16x32_bf16 v[184:187], v[120:123], v[104:107], v[184:187]
    v_mfma_f32_16x16x32_bf16 v[188:191], v[124:127], v[104:107], v[188:191]
    s_waitcnt lgkmcnt(0)
    s_waitcnt vmcnt(8)
    s_barrier
    s_add_u32 m0, s21, 65536
    s_nop 0
    buffer_load_dwordx4 v1, s[4:7], s16 offen sc1 lds
    s_add_u32 s16, s16, s62
    s_add_u32 m0, s21, 66560
    s_nop 0
    buffer_load_dwordx4 v1, s[4:7], s17 offen sc1 lds
    s_add_u32 s17, s17, s62
    s_add_u32 m0, s22, 65536
    s_nop 0
    buffer_load_dwordx4 v2, s[8:11], s18 offen lds
    s_add_u32 s18, s18, s20
    s_add_u32 m0, s22, 73728
    s_nop 0
    buffer_load_dwordx4 v2, s[12:15], s19 offen lds
    s_add_u32 s19, s19, s20
    v_mfma_f32_16x16x32_bf16 v[128:131], v[64:67], v[32:35], v[128:131]
    ds_read_b64_tr_b16 v[112:113], v12 offset:49152
    v_mfma_f32_16x16x32_bf16 v[132:135], v[68:71], v[32:35], v[132:135]
    ds_read_b64_tr_b16 v[114:115], v13 offset:49152
    v_mfma_f32_16x16x32_bf16 v[136:139], v[72:75], v[32:35], v[136:139]
    ds_read_b64_tr_b16 v[116:117], v14 offset:49152
    v_mfma_f32_16x16x32_bf16 v[140:143], v[76:79], v[32:35], v[140:143]
    ds_read_b64_tr_b16 v[118:119], v15 offset:49152
    v_mfma_f32_16x16x32_bf16 v[144:147], v[64:67], v[40:43], v[144:147]
    ds_read_b64_tr_b16 v[120:121], v12 offset:57344
    v_mfma_f32_16x16x32_bf16 v[148:151], v[68:71], v[40:43], v[148:151]
    ds_read_b64_tr_b16 v[122:123], v13 offset:57344
    v_mfma_f32_16x16x32_bf16 v[152:155], v[72:75], v[40:43], v[152:155]
    ds_read_b64_tr_b16 v[124:125], v14 offset:57344
    v_mfma_f32_16x16x32_bf16 v[156:159], v[76:79], v[40:43], v[156:159]
    ds_read_b64_tr_b16 v[126:127], v15 offset:57344
    v_mfma_f32_16x16x32_bf16 v[160:163], v[64:67], v[48:51], v[160:163]
    ds_read_b128 v[80:83], v6 offset:32768
    v_mfma_f32_16x16x32_bf16 v[164:167], v[68:71], v[48:51], v[164:167]
    ds_read_b128 v[88:91], v6 offset:34816
    v_mfma_f32_16x16x32_bf16 v[168:171], v[72:75], v[48:51], v[168:171]
    ds_read_b128 v[96:99], v6 offset:36864
    v_mfma_f32_16x16x32_bf16 v[172:175], v[76:79], v[48:51], v[172:175]
    ds_read_b128 v[104:107], v6 offset:38912
    v_mfma_f32_16x16x32_bf16 v[176:179], v[64:67], v[56:59], v[176:179]
    v_mfma_f32_16x16x32_bf16 v[180:183], v[68:71], v[56:59], v[180:183]
    v_mfma_f32_16x16x32_bf16 v[184:187], v[72:75], v[56:59], v[184:187]
    v_mfma_f32_16x16x32_bf16 v[188:191], v[76:79], v[56:59], v[188:191]
    s_waitcnt lgkmcnt(0)
    s_waitcnt vmcnt(8)
    s_barrier
    s_add_u32 m0, s21, 98304
    s_nop 0
    buffer_load_dwordx4 v1, s[4:7], s16 offen sc1 lds
    s_add_u32 s16, s16, s62
    s_add_u32 m0, s21, 99328
    s_nop 0
    buffer_load_dwordx4 v1, s[4:7], s17 offen sc1 lds
    s_add_u32 s17, s17, s62
    s_add_u32 m0, s22, 98304
    s_nop 0
    buffer_load_dwordx4 v2, s[8:11], s18 offen lds
    s_add_u32 s18, s18, s20
    s_add_u32 m0, s22, 106496
    s_nop 0
    buffer_load_dwordx4 v2, s[12:15], s19 offen lds
    s_add_u32 s19, s19, s20
    v_mfma_f32_16x16x32_bf16 v[128:131], v[112:115], v[80:83], v[128:131]
    ds_read_b64_tr_b16 v[64:65], v8 offset:16384
    v_mfma_f32_16x16x32_bf16 v[132:135], v[116:119], v[80:83], v[132:135]
    ds_read_b64_tr_b16 v[66:67], v9 offset:16384
    v_mfma_f32_16x16x32_bf16 v[136:139], v[120:123], v[80:83], v[136:139]
    ds_read_b64_tr_b16 v[68:69], v10 offset:16384
    v_mfma_f32_16x16x32_bf16 v[140:143], v[124:127], v[80:83], v[140:143]
    ds_read_b64_tr_b16 v[70:71], v11 offset:16384
    v_mfma_f32_16x16x32_bf16 v[144:147], v[112:115], v[88:91], v[144:147]
    ds_read_b64_tr_b16 v[72:73], v8 offset:24576
    v_mfma_f32_16x16x32_bf16 v[148:151], v[116:119], v[88:91], v[148:151]
    ds_read_b64_tr_b16 v[74:75], v9 offset:24576
    v_mfma_f32_16x16x32_bf16 v[152:155], v[120:123], v[88:91], v[152:155]
    ds_read_b64_tr_b16 v[76:77], v10 offset:24576
    v_mfma_f32_16x16x32_bf16 v[156:159], v[124:127], v[88:91], v[156:159]
    ds_read_b64_tr_b16 v[78:79], v11 offset:24576
    v_mfma_f32_16x16x32_bf16 v[160:163], v[112:115], v[96:99], v[160:163]
    ds_read_b128 v[32:35], v5 offset:0
    v_mfma_f32_16x16x32_bf16 v[164:167], v[116:119], v[96:99], v[164:167]
    ds_read_b128 v[36:39], v5 offset:1024
    v_mfma_f32_16x16x32_bf16 v[168:171], v[120:123], v[96:99], v[168:171]
    ds_read_b128 v[40:43], v5 offset:2048
    v_mfma_f32_16x16x32_bf16 v[172:175], v[124:127], v[96:99], v[172:175]
    ds_read_b128 v[44:47], v5 offset:3072
    v_mfma_f32_16x16x32_bf16 v[176:179], v[112:115], v[104:107], v[176:179]
    ds_read_b128 v[48:51], v5 offset:4096
    v_mfma_f32_16x16x32_bf16 v[180:183], v[116:119], v[104:107], v[180:183]
    ds_read_b128 v[52:55], v5 offset:5120
    v_mfma_f32_16x16x32_bf16 v[184:187], v[120:123], v[104:107], v[184:187]
    ds_read_b128 v[56:59], v5 offset:6144
    v_mfma_f32_16x16x32_bf16 v[188:191], v[124:127], v[104:107], v[188:191]
    ds_read_b128 v[60:63], v5 offset:7168
    s_waitcnt lgkmcnt(0)
    s_branch w_doneM
w_bodyM:
    buffer_load_dword v22, off, s[64:67], 0 sc1
    s_waitcnt vmcnt(6)
    s_barrier
    s_add_u32 m0, s21, 0
    s_nop 0
    buffer_load_dwordx4 v1, s[4:7], s16 offen sc1 lds
    s_add_u32 s16, s16, s62
    s_add_u32 m0, s22, 0
    s_nop 0
    buffer_load_dwordx4 v2, s[8:11], s18 offen lds
    s_add_u32 s18, s18, s20
    s_add_u32 m0, s22, 8192
    s_nop 0
    buffer_load_dwordx4 v2, s[12:15], s19 offen lds
    s_add_u32 s19, s19, s20
    v_mfma_f32_16x16x32_bf16 v[128:131], v[64:67], v[32:35], v[128:131]
    ds_read_b64_tr_b16 v[112:113], v8 offset:49152
    v_mfma_f32_16x16x32_bf16 v[132:135], v[68:71], v[32:35], v[132:135]
    ds_read_b64_tr_b16 v[114:115], v9 offset:49152
    v_mfma_f32_16x16x32_bf16 v[136:139], v[72:75], v[32:35], v[136:139]
    ds_read_b64_tr_b16 v[116:117], v10 offset:49152
    v_mfma_f32_16x16x32_bf16 v[140:143], v[76:79], v[32:35], v[140:143]
    ds_read_b64_tr_b16 v[118:119], v11 offset:49152
    v_mfma_f32_16x16x32_bf16 v[144:147], v[64:67], v[40:43], v[144:147]
    ds_read_b64_tr_b16 v[120:121], v8 offset:57344
    v_mfma_f32_16x16x32_bf16 v[148:151], v[68:71], v[40:43], v[148:151]
    ds_read_b64_tr_b16 v[122:123], v9 offset:57344
    v_mfma_f32_16x16x32_bf16 v[152:155], v[72:75], v[40:43], v[152:155]
    ds_read_b64_tr_b16 v[124:125], v10 offset:57344
    v_mfma_f32_16x16x32_bf16 v[156:159], v[76:79], v[40:43], v[156:159]
    ds_read_b64_tr_b16 v[126:127], v11 offset:57344
    v_mfma_f32_16x16x32_bf16 v[160:163], v[64:67], v[48:51], v[160:163]
    ds_read_b128 v[80:83], v5 offset:32768
    v_mfma_f32_16x16x32_bf16 v[164:167], v[68:71], v[48:51], v[164:167]
    ds_read_b128 v[88:91], v5 offset:34816
    v_mfma_f32_16x16x32_bf16 v[168:171], v[72:75], v[48:51], v[168:171]
    ds_read_b128 v[96:99], v5 offset:36864
    v_mfma_f32_16x16x32_bf16 v[172:175], v[76:79], v[48:51], v[172:175]
    ds_read_b128 v[104:107], v5 offset:38912
    v_mfma_f32_16x16x32_bf16 v[176:179], v[64:67], v[56:59], v[176:179]
    v_mfma_f32_16x16x32_bf16 v[180:183], v[68:71], v[56:59], v[180:183]
    v_mfma_f32_16x16x32_bf16 v[184:187], v[72:75], v[56:59], v[184:187]
    v_mfma_f32_16x16x32_bf16 v[188:191], v[76:79], v[56:59], v[188:191]
    buffer_load_dword v16, v17, s[4:7], s44 offen sc1
    s_waitcnt lgkmcnt(0)
    s_waitcnt vmcnt(6)
    s_barrier
    s_add_u32 m0, s21, 32768
    s_nop 0
    buffer_load_dwordx4 v1, s[4:7], s16 offen sc1 lds
    s_add_u32 s16, s16, s62
    s_add_u32 m0, s22, 32768
    s_nop 0
    buffer_load_dwordx4 v2, s[8:11], s18 offen lds
    s_add_u32 s18, s18, s20
    s_add_u32 m0, s22, 40960
    s_nop 0
    buffer_load_dwordx4 v2, s[12:15], s19 offen lds
    s_add_u32 s19, s19, s20
    v_mfma_f32_16x16x32_bf16 v[128:131], v[112:115], v[80:83], v[128:131]
    ds_read_b64_tr_b16 v[64:65], v12 offset:16384
    v_mfma_f32_16x16x32_bf16 v[132:135], v[116:119], v[80:83], v[132:135]
    ds_read_b64_tr_b16 v[66:67], v13 offset:16384
    v_mfma_f32_16x16x32_bf16 v[136:139], v[120:123], v[80:83], v[136:139]
    ds_read_b64_tr_b16 v[68:69], v14 offset:16384
    v_mfma_f32_16x16x32_bf16 v[140:143], v[124:127], v[80:83], v[140:143]
    ds_read_b64_tr_b16 v[70:71], v15 offset:16384
    v_mfma_f32_16x16x32_bf16 v[144:147], v[112:115], v[88:91], v[144:147]
    ds_read_b64_tr_b16 v[72:73], v12 offset:24576
    v_mfma_f32_16x16x32_bf16 v[148:151], v[116:119], v[88:91], v[148:151]
    ds_read_b64_tr_b16 v[74:75], v13 offset:24576
    v_mfma_f32_16x16x32_bf16 v[152:155], v[120:123], v[88:91], v[152:155]
    ds_read_b64_tr_b16 v[76:77], v14 offset:24576
    v_mfma_f32_16x16x32_bf16 v[156:159], v[124:127], v[88:91], v[156:159]
    ds_read_b64_tr_b16 v[78:79], v15 offset:24576
    v_mfma_f32_16x16x32_bf16 v[160:163], v[112:115], v[96:99], v[160:163]
    ds_read_b128 v[32:35], v6 offset:0
    v_mfma_f32_16x16x32_bf16 v[164:167], v[116:119], v[96:99], v[164:167]
    ds_read_b128 v[40:43], v6 offset:2048
    v_mfma_f32_16x16x32_bf16 v[168:171], v[120:123], v[96:99], v[168:171]
    ds_read_b128 v[48:51], v6 offset:4096
    v_mfma_f32_16x16x32_bf16 v[172:175], v[124:127], v[96:99], v[172:175]
    ds_read_b128 v[56:59], v6 offset:6144
    v_mfma_f32_16x16x32_bf16 v[176:179], v[112:115], v[104:107], v[176:179]
    v_mfma_f32_16x16x32_bf16 v[180:183], v[116:119], v[104:107], v[180:183]
    v_mfma_f32_16x16x32_bf16 v[184:187], v[120:123], v[104:107], v[184:187]
    v_mfma_f32_16x16x32_bf16 v[188:191], v[124:127], v[104:107], v[188:191]
    s_waitcnt lgkmcnt(0)
    s_waitcnt vmcnt(6)
    s_barrier
    s_add_u32 m0, s21, 65536
    s_nop 0
    buffer_load_dwordx4 v1, s[4:7], s16 offen sc1 lds
    s_add_u32 s16, s16, s62
    s_add_u32 m0, s22, 65536
    s_nop 0
    buffer_load_dwordx4 v2, s[8:11], s18 offen lds
    s_add_u32 s18, s18, s20
    s_add_u32 m0, s22, 73728
    s_nop 0
    buffer_load_dwordx4 v2, s[12:15], s19 offen lds
    s_add_u32 s19, s19, s20
    v_mfma_f32_16x16x32_bf16 v[128:131], v[64:67], v[32:35], v[128:131]
    ds_read_b64_tr_b16 v[112:113], v12 offset:49152
    v_mfma_f32_16x16x32_bf16 v[132:135], v[68:71], v[32:35], v[132:135]
    ds_read_b64_tr_b16 v[114:115], v13 offset:49152
    v_mfma_f32_16x16x32_bf16 v[136:139], v[72:75], v[32:35], v[136:139]
    ds_read_b64_tr_b16 v[116:117], v14 offset:49152
    v_mfma_f32_16x16x32_bf16 v[140:143], v[76:79], v[32:35], v[140:143]
    ds_read_b64_tr_b16 v[118:119], v15 offset:49152
    v_mfma_f32_16x16x32_bf16 v[144:147], v[64:67], v[40:43], v[144:147]
    ds_read_b64_tr_b16 v[120:121], v12 offset:57344
    v_mfma_f32_16x16x32_bf16 v[148:151], v[68:71], v[40:43], v[148:151]
    ds_read_b64_tr_b16 v[122:123], v13 offset:57344
    v_mfma_f32_16x16x32_bf16 v[152:155], v[72:75], v[40:43], v[152:155]
    ds_read_b64_tr_b16 v[124:125], v14 offset:57344
    v_mfma_f32_16x16x32_bf16 v[156:159], v[76:79], v[40:43], v[156:159]
    ds_read_b64_tr_b16 v[126:127], v15 offset:57344
    v_mfma_f32_16x16x32_bf16 v[160:163], v[64:67], v[48:51], v[160:163]
    ds_read_b128 v[80:83], v6 offset:32768
    v_mfma_f32_16x16x32_bf16 v[164:167], v[68:71], v[48:51], v[164:167]
    ds_read_b128 v[88:91], v6 offset:34816
    v_mfma_f32_16x16x32_bf16 v[168:171], v[72:75], v[48:51], v[168:171]
    ds_read_b128 v[96:99], v6 offset:36864
    v_mfma_f32_16x16x32_bf16 v[172:175], v[76:79], v[48:51], v[172:175]
    ds_read_b128 v[104:107], v6 offset:38912
    v_mfma_f32_16x16x32_bf16 v[176:179], v[64:67], v[56:59], v[176:179]
    v_mfma_f32_16x16x32_bf16 v[180:183], v[68:71], v[56:59], v[180:183]
    v_mfma_f32_16x16x32_bf16 v[184:187], v[72:75], v[56:59], v[184:187]
    v_mfma_f32_16x16x32_bf16 v[188:191], v[76:79], v[56:59], v[188:191]
    s_waitcnt lgkmcnt(0)
    s_waitcnt vmcnt(6)
    s_barrier
    s_add_u32 m0, s21, 98304
    s_nop 0
    buffer_load_dwordx4 v1, s[4:7], s16 offen sc1 lds
    s_add_u32 s16, s16, s62
    s_add_u32 m0, s22, 98304
    s_nop 0
    buffer_load_dwordx4 v2, s[8:11], s18 offen lds
    s_add_u32 s18, s18, s20
    s_add_u32 m0, s22, 106496
    s_nop 0
    buffer_load_dwordx4 v2, s[12:15], s19 offen lds
    s_add_u32 s19, s19, s20
    v_mfma_f32_16x16x32_bf16 v[128:131], v[112:115], v[80:83], v[128:131]
    ds_read_b64_tr_b16 v[64:65], v8 offset:16384
    v_mfma_f32_16x16x32_bf16 v[132:135], v[116:119], v[80:83], v[132:135]
    ds_read_b64_tr_b16 v[66:67], v9 offset:16384
    v_mfma_f32_16x16x32_bf16 v[136:139], v[120:123], v[80:83], v[136:139]
    ds_read_b64_tr_b16 v[68:69], v10 offset:16384
    v_mfma_f32_16x16x32_bf16 v[140:143], v[124:127], v[80:83], v[140:143]
    ds_read_b64_tr_b16 v[70:71], v11 offset:16384
    v_mfma_f32_16x16x32_bf16 v[144:147], v[112:115], v[88:91], v[144:147]
    ds_read_b64_tr_b16 v[72:73], v8 offset:24576
    v_mfma_f32_16x16x32_bf16 v[148:151], v[116:119], v[88:91], v[148:151]
    ds_read_b64_tr_b16 v[74:75], v9 offset:24576
    v_mfma_f32_16x16x32_bf16 v[152:155], v[120:123], v[88:91], v[152:155]
    ds_read_b64_tr_b16 v[76:77], v10 offset:24576
    v_mfma_f32_16x16x32_bf16 v[156:159], v[124:127], v[88:91], v[156:159]
    ds_read_b64_tr_b16 v[78:79], v11 offset:24576
    v_mfma_f32_16x16x32_bf16 v[160:163], v[112:115], v[96:99], v[160:163]
    ds_read_b128 v[32:35], v5 offset:0
    v_mfma_f32_16x16x32_bf16 v[164:167], v[116:119], v[96:99], v[164:167]
    ds_read_b128 v[40:43], v5 offset:2048
    v_mfma_f32_16x16x32_bf16 v[168:171], v[120:123], v[96:99], v[168:171]
    ds_read_b128 v[48:51], v5 offset:4096
    v_mfma_f32_16x16x32_bf16 v[172:175], v[124:127], v[96:99], v[172:175]
    ds_read_b128 v[56:59], v5 offset:6144
    v_mfma_f32_16x16x32_bf16 v[176:179], v[112:115], v[104:107], v[176:179]
    v_mfma_f32_16x16x32_bf16 v[180:183], v[116:119], v[104:107], v[180:183]
    v_mfma_f32_16x16x32_bf16 v[184:187], v[120:123], v[104:107], v[184:187]
    v_mfma_f32_16x16x32_bf16 v[188:191], v[124:127], v[104:107], v[188:191]
    s_waitcnt lgkmcnt(0)
    s_sub_u32 s23, s23, 1
    s_cmp_lg_u32 s23, 0
    s_cbranch_scc1 w_loopM
w_doneM:
    v_mov_b32 v20, 131072
    ds_read_b128 v[24:27], v20
    ds_read_b128 v[28:31], v20 offset:16
    s_lshl_b32 s30, s27, 10
    s_add_u32 s30, s30, s49
    s_nop 7
    v_cvt_pk_bf16_f32 v80, v128, v129
    v_cvt_pk_bf16_f32 v81, v130, v131
    v_cvt_pk_bf16_f32 v82, v132, v133
    v_cvt_pk_bf16_f32 v83, v134, v135
    buffer_store_dwordx4 v[80:83], v1, s[4:7], s30 offen sc1
    v_cvt_pk_bf16_f32 v84, v136, v137
    v_cvt_pk_bf16_f32 v85, v138, v139
    v_cvt_pk_bf16_f32 v86, v140, v141
    v_cvt_pk_bf16_f32 v87, v142, v143
    buffer_store_dwordx4 v[84:87], v19, s[4:7], s30 offen sc1
    s_add_u32 s30, s30, s50
    v_cvt_pk_bf16_f32 v88, v144, v145
    v_cvt_pk_bf16_f32 v89, v146, v147
    v_cvt_pk_bf16_f32 v90, v148, v149
    v_cvt_pk_bf16_f32 v91, v150, v151
    buffer_store_dwordx4 v[88:91], v1, s[4:7], s30 offen sc1
    v_cvt_pk_bf16_f32 v92, v152, v153
    v_cvt_pk_bf16_f32 v93, v154, v155
    v_cvt_pk_bf16_f32 v94, v156, v157
    v_cvt_pk_bf16_f32 v95, v158, v159
    buffer_store_dwordx4 v[92:95], v19, s[4:7], s30 offen sc1
    s_add_u32 s30, s30, s50
    v_cvt_pk_bf16_f32 v80, v160, v161
    v_cvt_pk_bf16_f32 v81, v162, v163
    v_cvt_pk_bf16_f32 v82, v164, v165
    v_cvt_pk_bf16_f32 v83, v166, v167
    buffer_store_dwordx4 v[80:83], v1, s[4:7], s30 offen sc1
    v_cvt_pk_bf16_f32 v84, v168, v169
    v_cvt_pk_bf16_f32 v85, v170, v171
    v_cvt_pk_bf16_f32 v86, v172, v173
    v_cvt_pk_bf16_f32 v87, v174, v175
    buffer_store_dwordx4 v[84:87], v19, s[4:7], s30 offen sc1
    s_add_u32 s30, s30, s50
    v_cvt_pk_bf16_f32 v88, v176, v177
    v_cvt_pk_bf16_f32 v89, v178, v179
    v_cvt_pk_bf16_f32 v90, v180, v181
    v_cvt_pk_bf16_f32 v91, v182, v183
    buffer_store_dwordx4 v[88:91], v1, s[4:7], s30 offen sc1
    v_cvt_pk_bf16_f32 v92, v184, v185
    v_cvt_pk_bf16_f32 v93, v186, v187
    v_cvt_pk_bf16_f32 v94, v188, v189
    v_cvt_pk_bf16_f32 v95, v190, v191
    buffer_store_dwordx4 v[92:95], v19, s[4:7], s30 offen sc1
    s_add_u32 s30, s30, s50
    s_waitcnt lgkmcnt(0)
    v_or3_b32 v24, v24, v25, v26
    v_or3_b32 v28, v28, v29, v30
    v_or3_b32 v24, v24, v27, v31
    v_or_b32 v24, v24, v28
    s_mov_b32 s28, s51
    s_mov_b32 s57, s53
    v_readfirstlane_b32 s30, v24
    s_cmp_lg_u32 s30, 0
    s_cbranch_scc1 w_drain
    s_mov_b32 s48, s32
    s_cmp_ge_u32 s32, 4
    s_cselect_b32 s30, 2, 3
    s_lshl_b32 s30, s26, s30
    s_mul_i32 s30, s30, s43
    s_add_u32 s49, s42, s30
    s_mov_b32 s50, s43
    s_mov_b32 s51, s46
    s_mov_b32 s23, s41
    s_mov_b32 s53, s47
    s_nop 0
    s_load_dwordx16 s[32:47], s[24:25], 0
    s_add_u32 s24, s24, 64
    s_addc_u32 s25, s25, 0
    s_branch w_first8
w_drain:
    s_waitcnt vmcnt(0)
    s_barrier
    s_cmp_eq_u32 s28, 0
    s_cbranch_scc1 sig_5
    s_cmp_lg_u32 s3, 0
    s_cbranch_scc1 sig_5
    s_mov_b64 exec, 1
    v_mov_b32 v18, s57
    buffer_atomic_add v18, v17, s[4:7], s28 offen sc1
    s_mov_b64 exec, -1
sig_5:
    s_mov_b32 s28, 0
    s_cmp_eq_u32 s98, 3
    s_cselect_b32 s98, 1, s98
w_hook:
    s_cmp_eq_u32 s70, 0
    s_cbranch_scc1 drw_ok
    s_cmp_lt_u32 s39, 1048576
    s_cbranch_scc1 drw_ok
    s_mov_b32 s70, 0
    s_cmp_lg_u32 s3, 0
    s_cbranch_scc1 drw_ok
    v_readfirstlane_b32 s68, v22
    s_cmp_ge_u32 s68, 128
    s_cbranch_scc1 drw_ok
    s_mov_b32 s69, 65536
drw:
    buffer_load_dword v20, off, s[64:67], 0 offset:0 sc1
    s_waitcnt vmcnt(0)
    v_readfirstlane_b32 s68, v20
    s_cmp_ge_u32 s68, 128
    s_cbranch_scc1 drw_ok
    s_sleep 8
    s_sub_u32 s69, s69, 1
    s_cbranch_scc0 drw
drw_ok:
    s_branch w_cold
fin_entry:
    s_load_dwordx2 s[8:9], s[0:1], 0
    s_load_dwordx2 s[12:13], s[0:1], 88
    v_mbcnt_lo_u32_b32 v1, -1, 0
    v_mbcnt_hi_u32_b32 v1, -1, v1
    s_mov_b32 s10, 4194304
    s_mov_b32 s11, 131072
    s_mov_b32 s14, 4194304
    s_mov_b32 s15, 131072
    v_lshlrev_b32 v3, 4, v1
    v_and_b32 v4, 15, v1
    v_lshrrev_b32 v5, 4, v1
    v_lshlrev_b32 v4, 11, v4
    v_lshl_add_u32 v4, v5, 4, v4
    v_and_b32 v5, 1, v5
    v_cmp_eq_u32 s[20:21], 1, v5
    v_and_b32 v6, 7, v1
    v_lshlrev_b32 v6, 7, v6
    s_lshr_b32 s24, s63, 2
    s_and_b32 s25, s63, 3
    s_lshl_b32 s25, s25, 2
    s_and_b32 s26, s3, 3
    s_add_u32 s25, s25, s26
    s_lshr_b32 s26, s3, 2
    s_mov_b32 s28, 65536
    s_waitcnt lgkmcnt(0)
fin_job:
    s_lshl_b32 s16, s24, 1
    s_add_u32 s16, s16, s26
    s_lshl_b32 s18, s16, 15
    s_lshl_b32 s17, s25, 11
    s_add_u32 s17, s17, s18
    s_lshl_b32 s19, s25, 7
    s_add_u32 s18, s18, s19
    s_add_u32 s22, s17, 167772160
    s_add_u32 s23, s17, 75497472
    s_lshr_b32 s27, s24, 3
    s_lshl_b32 s27, s27, 6
    s_add_u32 s27, s27, 218106368
    s_cmp_ge_u32 s24, 64
    s_cselect_b32 s29, 16, 16
    s_mov_b32 s30, 218112000
    s_add_u32 s32, s24, 1
    s_mov_b32 s33, 0
    s_mov_b32 s34, 255
    s_cmp_lt_u32 s24, 62
    s_cbranch_scc1 fin_tg
    s_mov_b32 s32, 16
    s_add_u32 s30, s30, 4
    s_sub_u32 s33, s24, 62
    s_lshl_b32 s33, s33, 3
fin_tg:
    s_mul_i32 s35, s24, 3
    s_lshr_b32 s35, s35, 4
    s_add_u32 s35, s35, 49
    s_min_u32 s35, s35, 61
    s_max_u32 s32, s32, s35
    buffer_load_dwordx4 v[88:91], v4, s[8:11], s18 offen offset:0
    buffer_load_dwordx4 v[92:95], v4, s[8:11], s18 offen offset:64
    s_cmp_lg_u32 s3, 0
    s_cbranch_scc1 fin_ws_ok
fin_wd:
    buffer_load_dword v7, off, s[4:7], s27 sc1
    s_waitcnt vmcnt(0)
    v_readfirstlane_b32 s31, v7
    s_cmp_ge_u32 s31, s29
    s_cbranch_scc1 fin_wd_ok
    s_sleep 127
    s_sub_u32 s28, s28, 1
    s_cbranch_scc0 fin_wd
    s_mov_b32 s28, 0
fin_wd_ok:
fin_ws:
    buffer_load_dword v7, v6, s[4:7], s30 offen sc1
    s_waitcnt vmcnt(0)
    v_lshrrev_b32 v7, s33, v7
    v_and_b32 v7, s34, v7
    v_cmp_gt_u32 vcc, s32, v7
    s_cbranch_vccz fin_ws_ok
    s_sleep 12
    v_add_u32 v7, 1, v7
    v_cmp_gt_u32 vcc, s32, v7
    s_cbranch_vccz fin_ws_f
    s_sleep 48
    v_add_u32 v7, 3, v7
    v_cmp_gt_u32 vcc, s32, v7
    s_cbranch_vccz fin_ws_f
    s_sleep 127
    s_sleep 127
fin_ws_f:
    s_sub_u32 s28, s28, 1
    s_cbranch_scc0 fin_ws
    s_mov_b32 s28, 0
fin_ws_ok:
    s_barrier
    buffer_load_dwordx4 v[144:147], v3, s[4:7], s22 offen offset:0 sc1
    buffer_load_dwordx4 v[160:163], v3, s[4:7], s22 offen offset:1024 sc1
    s_add_u32 s22, s22, 4194304
    buffer_load_dwordx4 v[148:151], v3, s[4:7], s22 offen offset:0 sc1
    buffer_load_dwordx4 v[164:167], v3, s[4:7], s22 offen offset:1024 sc1
    s_add_u32 s22, s22, 4194304
    buffer_load_dwordx4 v[152:155], v3, s[4:7], s22 offen offset:0 sc1
    buffer_load_dwordx4 v[168:171], v3, s[4:7], s22 offen offset:1024 sc1
    s_add_u32 s22, s22, 4194304
    buffer_load_dwordx4 v[156:159], v3, s[4:7], s22 offen offset:0 sc1
    buffer_load_dwordx4 v[172:175], v3, s[4:7], s22 offen offset:1024 sc1
    buffer_load_dwordx4 v[16:19], v3, s[4:7], s23 offen offset:0 sc1
    buffer_load_dwordx4 v[48:51], v3, s[4:7], s23 offen offset:1024 sc1
    s_add_u32 s23, s23, 4194304
    buffer_load_dwordx4 v[20:23], v3, s[4:7], s23 offen offset:0 sc1
    buffer_load_dwordx4 v[52:55], v3, s[4:7], s23 offen offset:1024 sc1
    s_add_u32 s23, s23, 4194304
    buffer_load_dwordx4 v[24:27], v3, s[4:7], s23 offen offset:0 sc1
    buffer_load_dwordx4 v[56:59], v3, s[4:7], s23 offen offset:1024 sc1
    s_add_u32 s23, s23, 4194304
    buffer_load_dwordx4 v[28:31], v3, s[4:7], s23 offen offset:0 sc1
    buffer_load_dwordx4 v[60:63], v3, s[4:7], s23 offen offset:1024 sc1
    s_add_u32 s23, s23, 4194304
    buffer_load_dwordx4 v[32:35], v3, s[4:7], s23 offen offset:0 sc1
    buffer_load_dwordx4 v[64:67], v3, s[4:7], s23 offen offset:1024 sc1
    s_add_u32 s23, s23, 4194304
    buffer_load_dwordx4 v[36:39], v3, s[4:7], s23 offen offset:0 sc1
    buffer_load_dwordx4 v[68:71], v3, s[4:7], s23 offen offset:1024 sc1
    s_add_u32 s23, s23, 4194304
    buffer_load_dwordx4 v[40:43], v3, s[4:7], s23 offen offset:0 sc1
    buffer_load_dwordx4 v[72:75], v3, s[4:7], s23 offen offset:1024 sc1
    s_add_u32 s23, s23, 4194304
    buffer_load_dwordx4 v[44:47], v3, s[4:7], s23 offen offset:0 sc1
    buffer_load_dwordx4 v[76:79], v3, s[4:7], s23 offen offset:1024 sc1
    s_add_u32 s23, s23, 4194304
    s_waitcnt vmcnt(16)
    v_lshlrev_b32 v96, 16, v144
    v_and_b32 v97, 0xffff0000, v144
    v_lshlrev_b32 v98, 16, v145
    v_and_b32 v99, 0xffff0000, v145
    v_lshlrev_b32 v100, 16, v146
    v_and_b32 v101, 0xffff0000, v146
    v_lshlrev_b32 v102, 16, v147
    v_and_b32 v103, 0xffff0000, v147
    v_lshlrev_b32 v120, 16, v148
    v_and_b32 v121, 0xffff0000, v148
    v_lshlrev_b32 v122, 16, v149
    v_and_b32 v123, 0xffff0000, v149
    v_lshlrev_b32 v124, 16, v150
    v_and_b32 v125, 0xffff0000, v150
    v_lshlrev_b32 v126, 16, v151
    v_and_b32 v127, 0xffff0000, v151
    v_add_f32 v96, v96, v120
    v_add_f32 v97, v97, v121
    v_add_f32 v98, v98, v122
    v_add_f32 v99, v99, v123
    v_add_f32 v100, v100, v124
    v_add_f32 v101, v101, v125
    v_add_f32 v102, v102, v126
    v_add_f32 v103, v103, v127
    v_lshlrev_b32 v120, 16, v152
    v_and_b32 v121, 0xffff0000, v152
    v_lshlrev_b32 v122, 16, v153
    v_and_b32 v123, 0xffff0000, v153
    v_lshlrev_b32 v124, 16, v154
    v_and_b32 v125, 0xffff0000, v154
    v_lshlrev_b32 v126, 16, v155
    v_and_b32 v127, 0xffff0000, v155
    v_add_f32 v96, v96, v120
    v_add_f32 v97, v97, v121
    v_add_f32 v98, v98, v122
    v_add_f32 v99, v99, v123
    v_add_f32 v100, v100, v124
    v_add_f32 v101, v101, v125
    v_add_f32 v102, v102, v126
    v_add_f32 v103, v103, v127
    v_lshlrev_b32 v120, 16, v156
    v_and_b32 v121, 0xffff0000, v156
    v_lshlrev_b32 v122, 16, v157
    v_and_b32 v123, 0xffff0000, v157
    v_lshlrev_b32 v124, 16, v158
    v_and_b32 v125, 0xffff0000, v158
    v_lshlrev_b32 v126, 16, v159
    v_and_b32 v127, 0xffff0000, v159
    v_add_f32 v96, v96, v120
    v_add_f32 v97, v97, v121
    v_add_f32 v98, v98, v122
    v_add_f32 v99, v99, v123
    v_add_f32 v100, v100, v124
    v_add_f32 v101, v101, v125
    v_add_f32 v102, v102, v126
    v_add_f32 v103, v103, v127
    v_cvt_pk_bf16_f32 v120, v96, v97
    v_cvt_pk_bf16_f32 v121, v98, v99
    v_cvt_pk_bf16_f32 v122, v100, v101
    v_cvt_pk_bf16_f32 v123, v102, v103
    v_lshlrev_b32 v96, 16, v120
    v_and_b32 v97, 0xffff0000, v120
    v_lshlrev_b32 v98, 16, v121
    v_and_b32 v99, 0xffff0000, v121
    v_lshlrev_b32 v100, 16, v122
    v_and_b32 v101, 0xffff0000, v122
    v_lshlrev_b32 v102, 16, v123
    v_and_b32 v103, 0xffff0000, v123
    v_mul_f32 v104, 0xbfb8aa3b, v96
    v_mul_f32 v105, 0xbfb8aa3b, v97
    v_mul_f32 v106, 0xbfb8aa3b, v98
    v_mul_f32 v107, 0xbfb8aa3b, v99
    v_mul_f32 v108, 0xbfb8aa3b, v100
    v_mul_f32 v109, 0xbfb8aa3b, v101
    v_mul_f32 v110, 0xbfb8aa3b, v102
    v_mul_f32 v111, 0xbfb8aa3b, v103
    v_exp_f32 v104, v104
    v_exp_f32 v105, v105
    v_exp_f32 v106, v106
    v_exp_f32 v107, v107
    v_exp_f32 v108, v108
    v_exp_f32 v109, v109
    v_exp_f32 v110, v110
    v_exp_f32 v111, v111
    v_add_f32 v104, 1.0, v104
    v_add_f32 v105, 1.0, v105
    v_add_f32 v106, 1.0, v106
    v_add_f32 v107, 1.0, v107
    v_add_f32 v108, 1.0, v108
    v_add_f32 v109, 1.0, v109
    v_add_f32 v110, 1.0, v110
    v_add_f32 v111, 1.0, v111
    v_rcp_f32 v104, v104
    v_rcp_f32 v105, v105
    v_rcp_f32 v106, v106
    v_rcp_f32 v107, v107
    v_rcp_f32 v108, v108
    v_rcp_f32 v109, v109
    v_rcp_f32 v110, v110
    v_rcp_f32 v111, v111
    v_mul_f32 v96, v96, v104
    v_mul_f32 v97, v97, v105
    v_mul_f32 v98, v98, v106
    v_mul_f32 v99, v99, v107
    v_mul_f32 v100, v100, v108
    v_mul_f32 v101, v101, v109
    v_mul_f32 v102, v102, v110
    v_mul_f32 v103, v103, v111
    v_cvt_pk_bf16_f32 v80, v96, v97
    v_cvt_pk_bf16_f32 v81, v98, v99
    v_cvt_pk_bf16_f32 v82, v100, v101
    v_cvt_pk_bf16_f32 v83, v102, v103
    v_lshlrev_b32 v96, 16, v160
    v_and_b32 v97, 0xffff0000, v160
    v_lshlrev_b32 v98, 16, v161
    v_and_b32 v99, 0xffff0000, v161
    v_lshlrev_b32 v100, 16, v162
    v_and_b32 v101, 0xffff0000, v162
    v_lshlrev_b32 v102, 16, v163
    v_and_b32 v103, 0xffff0000, v163
    v_lshlrev_b32 v120, 16, v164
    v_and_b32 v121, 0xffff0000, v164
    v_lshlrev_b32 v122, 16, v165
    v_and_b32 v123, 0xffff0000, v165
    v_lshlrev_b32 v124, 16, v166
    v_and_b32 v125, 0xffff0000, v166
    v_lshlrev_b32 v126, 16, v167
    v_and_b32 v127, 0xffff0000, v167
    v_add_f32 v96, v96, v120
    v_add_f32 v97, v97, v121
    v_add_f32 v98, v98, v122
    v_add_f32 v99, v99, v123
    v_add_f32 v100, v100, v124
    v_add_f32 v101, v101, v125
    v_add_f32 v102, v102, v126
    v_add_f32 v103, v103, v127
    v_lshlrev_b32 v120, 16, v168
    v_and_b32 v121, 0xffff0000, v168
    v_lshlrev_b32 v122, 16, v169
    v_and_b32 v123, 0xffff0000, v169
    v_lshlrev_b32 v124, 16, v170
    v_and_b32 v125, 0xffff0000, v170
    v_lshlrev_b32 v126, 16, v171
    v_and_b32 v127, 0xffff0000, v171
    v_add_f32 v96, v96, v120
    v_add_f32 v97, v97, v121
    v_add_f32 v98, v98, v122
    v_add_f32 v99, v99, v123
    v_add_f32 v100, v100, v124
    v_add_f32 v101, v101, v125
    v_add_f32 v102, v102, v126
    v_add_f32 v103, v103, v127
    v_lshlrev_b32 v120, 16, v172
    v_and_b32 v121, 0xffff0000, v172
    v_lshlrev_b32 v122, 16, v173
    v_and_b32 v123, 0xffff0000, v173
    v_lshlrev_b32 v124, 16, v174
    v_and_b32 v125, 0xffff0000, v174
    v_lshlrev_b32 v126, 16, v175
    v_and_b32 v127, 0xffff0000, v175
    v_add_f32 v96, v96, v120
    v_add_f32 v97, v97, v121
    v_add_f32 v98, v98, v122
    v_add_f32 v99, v99, v123
    v_add_f32 v100, v100, v124
    v_add_f32 v101, v101, v125
    v_add_f32 v102, v102, v126
    v_add_f32 v103, v103, v127
    v_cvt_pk_bf16_f32 v120, v96, v97
    v_cvt_pk_bf16_f32 v121, v98, v99
    v_cvt_pk_bf16_f32 v122, v100, v101
    v_cvt_pk_bf16_f32 v123, v102, v103
    v_lshlrev_b32 v96, 16, v120
    v_and_b32 v97, 0xffff0000, v120
    v_lshlrev_b32 v98, 16, v121
    v_and_b32 v99, 0xffff0000, v121
    v_lshlrev_b32 v100, 16, v122
    v_and_b32 v101, 0xffff0000, v122
    v_lshlrev_b32 v102, 16, v123
    v_and_b32 v103, 0xffff0000, v123
    v_mul_f32 v104, 0xbfb8aa3b, v96
    v_mul_f32 v105, 0xbfb8aa3b, v97
    v_mul_f32 v106, 0xbfb8aa3b, v98
    v_mul_f32 v107, 0xbfb8aa3b, v99
    v_mul_f32 v108, 0xbfb8aa3b, v100
    v_mul_f32 v109, 0xbfb8aa3b, v101
    v_mul_f32 v110, 0xbfb8aa3b, v102
    v_mul_f32 v111, 0xbfb8aa3b, v103
    v_exp_f32 v104, v104
    v_exp_f32 v105, v105
    v_exp_f32 v106, v106
    v_exp_f32 v107, v107
    v_exp_f32 v108, v108
    v_exp_f32 v109, v109
    v_exp_f32 v110, v110
    v_exp_f32 v111, v111
    v_add_f32 v104, 1.0, v104
    v_add_f32 v105, 1.0, v105
    v_add_f32 v106, 1.0, v106
    v_add_f32 v107, 1.0, v107
    v_add_f32 v108, 1.0, v108
    v_add_f32 v109, 1.0, v109
    v_add_f32 v110, 1.0, v110
    v_add_f32 v111, 1.0, v111
    v_rcp_f32 v104, v104
    v_rcp_f32 v105, v105
    v_rcp_f32 v106, v106
    v_rcp_f32 v107, v107
    v_rcp_f32 v108, v108
    v_rcp_f32 v109, v109
    v_rcp_f32 v110, v110
    v_rcp_f32 v111, v111
    v_mul_f32 v96, v96, v104
    v_mul_f32 v97, v97, v105
    v_mul_f32 v98, v98, v106
    v_mul_f32 v99, v99, v107
    v_mul_f32 v100, v100, v108
    v_mul_f32 v101, v101, v109
    v_mul_f32 v102, v102, v110
    v_mul_f32 v103, v103, v111
    v_cvt_pk_bf16_f32 v84, v96, v97
    v_cvt_pk_bf16_f32 v85, v98, v99
    v_cvt_pk_bf16_f32 v86, v100, v101
    v_cvt_pk_bf16_f32 v87, v102, v103
    s_waitcnt vmcnt(0)
    v_lshlrev_b32 v96, 16, v16
    v_and_b32 v97, 0xffff0000, v16
    v_lshlrev_b32 v98, 16, v17
    v_and_b32 v99, 0xffff0000, v17
    v_lshlrev_b32 v100, 16, v18
    v_and_b32 v101, 0xffff0000, v18
    v_lshlrev_b32 v102, 16, v19
    v_and_b32 v103, 0xffff0000, v19
    v_lshlrev_b32 v120, 16, v20
    v_and_b32 v121, 0xffff0000, v20
    v_lshlrev_b32 v122, 16, v21
    v_and_b32 v123, 0xffff0000, v21
    v_lshlrev_b32 v124, 16, v22
    v_and_b32 v125, 0xffff0000, v22
    v_lshlrev_b32 v126, 16, v23
    v_and_b32 v127, 0xffff0000, v23
    v_add_f32 v96, v96, v120
    v_add_f32 v97, v97, v121
    v_add_f32 v98, v98, v122
    v_add_f32 v99, v99, v123
    v_add_f32 v100, v100, v124
    v_add_f32 v101, v101, v125
    v_add_f32 v102, v102, v126
    v_add_f32 v103, v103, v127
    v_lshlrev_b32 v120, 16, v24
    v_and_b32 v121, 0xffff0000, v24
    v_lshlrev_b32 v122, 16, v25
    v_and_b32 v123, 0xffff0000, v25
    v_lshlrev_b32 v124, 16, v26
    v_and_b32 v125, 0xffff0000, v26
    v_lshlrev_b32 v126, 16, v27
    v_and_b32 v127, 0xffff0000, v27
    v_add_f32 v96, v96, v120
    v_add_f32 v97, v97, v121
    v_add_f32 v98, v98, v122
    v_add_f32 v99, v99, v123
    v_add_f32 v100, v100, v124
    v_add_f32 v101, v101, v125
    v_add_f32 v102, v102, v126
    v_add_f32 v103, v103, v127
    v_lshlrev_b32 v120, 16, v28
    v_and_b32 v121, 0xffff0000, v28
    v_lshlrev_b32 v122, 16, v29
    v_and_b32 v123, 0xffff0000, v29
    v_lshlrev_b32 v124, 16, v30
    v_and_b32 v125, 0xffff0000, v30
    v_lshlrev_b32 v126, 16, v31
    v_and_b32 v127, 0xffff0000, v31
    v_add_f32 v96, v96, v120
    v_add_f32 v97, v97, v121
    v_add_f32 v98, v98, v122
    v_add_f32 v99, v99, v123
    v_add_f32 v100, v100, v124
    v_add_f32 v101, v101, v125
    v_add_f32 v102, v102, v126
    v_add_f32 v103, v103, v127
    v_lshlrev_b32 v120, 16, v32
    v_and_b32 v121, 0xffff0000, v32
    v_lshlrev_b32 v122, 16, v33
    v_and_b32 v123, 0xffff0000, v33
    v_lshlrev_b32 v124, 16, v34
    v_and_b32 v125, 0xffff0000, v34
    v_lshlrev_b32 v126, 16, v35
    v_and_b32 v127, 0xffff0000, v35
    v_add_f32 v96, v96, v120
    v_add_f32 v97, v97, v121
    v_add_f32 v98, v98, v122
    v_add_f32 v99, v99, v123
    v_add_f32 v100, v100, v124
    v_add_f32 v101, v101, v125
    v_add_f32 v102, v102, v126
    v_add_f32 v103, v103, v127
    v_lshlrev_b32 v120, 16, v36
    v_and_b32 v121, 0xffff0000, v36
    v_lshlrev_b32 v122, 16, v37
    v_and_b32 v123, 0xffff0000, v37
    v_lshlrev_b32 v124, 16, v38
    v_and_b32 v125, 0xffff0000, v38
    v_lshlrev_b32 v126, 16, v39
    v_and_b32 v127, 0xffff0000, v39
    v_add_f32 v96, v96, v120
    v_add_f32 v97, v97, v121
    v_add_f32 v98, v98, v122
    v_add_f32 v99, v99, v123
    v_add_f32 v100, v100, v124
    v_add_f32 v101, v101, v125
    v_add_f32 v102, v102, v126
    v_add_f32 v103, v103, v127
    v_lshlrev_b32 v120, 16, v40
    v_and_b32 v121, 0xffff0000, v40
    v_lshlrev_b32 v122, 16, v41
    v_and_b32 v123, 0xffff0000, v41
    v_lshlrev_b32 v124, 16, v42
    v_and_b32 v125, 0xffff0000, v42
    v_lshlrev_b32 v126, 16, v43
    v_and_b32 v127, 0xffff0000, v43
    v_add_f32 v96, v96, v120
    v_add_f32 v97, v97, v121
    v_add_f32 v98, v98, v122
    v_add_f32 v99, v99, v123
    v_add_f32 v100, v100, v124
    v_add_f32 v101, v101, v125
    v_add_f32 v102, v102, v126
    v_add_f32 v103, v103, v127
    v_lshlrev_b32 v120, 16, v44
    v_and_b32 v121, 0xffff0000, v44
    v_lshlrev_b32 v122, 16, v45
    v_and_b32 v123, 0xffff0000, v45
    v_lshlrev_b32 v124, 16, v46
    v_and_b32 v125, 0xffff0000, v46
    v_lshlrev_b32 v126, 16, v47
    v_and_b32 v127, 0xffff0000, v47
    v_add_f32 v96, v96, v120
    v_add_f32 v97, v97, v121
    v_add_f32 v98, v98, v122
    v_add_f32 v99, v99, v123
    v_add_f32 v100, v100, v124
    v_add_f32 v101, v101, v125
    v_add_f32 v102, v102, v126
    v_add_f32 v103, v103, v127
    v_cndmask_b32 v108, v88, v90, s[20:21]
    v_cndmask_b32 v109, v89, v91, s[20:21]
    v_cndmask_b32 v110, v90, v88, s[20:21]
    v_cndmask_b32 v111, v91, v89, s[20:21]
    v_cvt_pk_bf16_f32 v104, v96, v97
    v_lshlrev_b32 v96, 16, v104
    v_and_b32 v97, 0xffff0000, v104
    v_lshlrev_b32 v104, 16, v80
    v_and_b32 v105, 0xffff0000, v80
    v_mul_f32 v96, v96, v104
    v_mul_f32 v97, v97, v105
    v_cvt_pk_bf16_f32 v104, v96, v97
    v_lshlrev_b32 v96, 16, v104
    v_and_b32 v97, 0xffff0000, v104
    v_lshlrev_b32 v104, 16, v108
    v_and_b32 v105, 0xffff0000, v108
    v_add_f32 v96, v96, v104
    v_add_f32 v97, v97, v105
    v_cvt_pk_bf16_f32 v112, v96, v97
    v_cvt_pk_bf16_f32 v104, v98, v99
    v_lshlrev_b32 v98, 16, v104
    v_and_b32 v99, 0xffff0000, v104
    v_lshlrev_b32 v104, 16, v81
    v_and_b32 v105, 0xffff0000, v81
    v_mul_f32 v98, v98, v104
    v_mul_f32 v99, v99, v105
    v_cvt_pk_bf16_f32 v104, v98, v99
    v_lshlrev_b32 v98, 16, v104
    v_and_b32 v99, 0xffff0000, v104
    v_lshlrev_b32 v104, 16, v109
    v_and_b32 v105, 0xffff0000, v109
    v_add_f32 v98, v98, v104
    v_add_f32 v99, v99, v105
    v_cvt_pk_bf16_f32 v113, v98, v99
    v_cvt_pk_bf16_f32 v104, v100, v101
    v_lshlrev_b32 v100, 16, v104
    v_and_b32 v101, 0xffff0000, v104
    v_lshlrev_b32 v104, 16, v82
    v_and_b32 v105, 0xffff0000, v82
    v_mul_f32 v100, v100, v104
    v_mul_f32 v101, v101, v105
    v_cvt_pk_bf16_f32 v104, v100, v101
    v_lshlrev_b32 v100, 16, v104
    v_and_b32 v101, 0xffff0000, v104
    v_lshlrev_b32 v104, 16, v110
    v_and_b32 v105, 0xffff0000, v110
    v_add_f32 v100, v100, v104
    v_add_f32 v101, v101, v105
    v_cvt_pk_bf16_f32 v114, v100, v101
    v_cvt_pk_bf16_f32 v104, v102, v103
    v_lshlrev_b32 v102, 16, v104
    v_and_b32 v103, 0xffff0000, v104
    v_lshlrev_b32 v104, 16, v83
    v_and_b32 v105, 0xffff0000, v83
    v_mul_f32 v102, v102, v104
    v_mul_f32 v103, v103, v105
    v_cvt_pk_bf16_f32 v104, v102, v103
    v_lshlrev_b32 v102, 16, v104
    v_and_b32 v103, 0xffff0000, v104
    v_lshlrev_b32 v104, 16, v111
    v_and_b32 v105, 0xffff0000, v111
    v_add_f32 v102, v102, v104
    v_add_f32 v103, v103, v105
    v_cvt_pk_bf16_f32 v115, v102, v103
    v_cndmask_b32 v128, v112, v114, s[20:21]
    v_cndmask_b32 v129, v113, v115, s[20:21]
    v_cndmask_b32 v130, v114, v112, s[20:21]
    v_cndmask_b32 v131, v115, v113, s[20:21]
    buffer_store_dwordx4 v[128:131], v4, s[12:15], s18 offen offset:0
    v_lshlrev_b32 v96, 16, v48
    v_and_b32 v97, 0xffff0000, v48
    v_lshlrev_b32 v98, 16, v49
    v_and_b32 v99, 0xffff0000, v49
    v_lshlrev_b32 v100, 16, v50
    v_and_b32 v101, 0xffff0000, v50
    v_lshlrev_b32 v102, 16, v51
    v_and_b32 v103, 0xffff0000, v51
    v_lshlrev_b32 v120, 16, v52
    v_and_b32 v121, 0xffff0000, v52
    v_lshlrev_b32 v122, 16, v53
    v_and_b32 v123, 0xffff0000, v53
    v_lshlrev_b32 v124, 16, v54
    v_and_b32 v125, 0xffff0000, v54
    v_lshlrev_b32 v126, 16, v55
    v_and_b32 v127, 0xffff0000, v55
    v_add_f32 v96, v96, v120
    v_add_f32 v97, v97, v121
    v_add_f32 v98, v98, v122
    v_add_f32 v99, v99, v123
    v_add_f32 v100, v100, v124
    v_add_f32 v101, v101, v125
    v_add_f32 v102, v102, v126
    v_add_f32 v103, v103, v127
    v_lshlrev_b32 v120, 16, v56
    v_and_b32 v121, 0xffff0000, v56
    v_lshlrev_b32 v122, 16, v57
    v_and_b32 v123, 0xffff0000, v57
    v_lshlrev_b32 v124, 16, v58
    v_and_b32 v125, 0xffff0000, v58
    v_lshlrev_b32 v126, 16, v59
    v_and_b32 v127, 0xffff0000, v59
    v_add_f32 v96, v96, v120
    v_add_f32 v97, v97, v121
    v_add_f32 v98, v98, v122
    v_add_f32 v99, v99, v123
    v_add_f32 v100, v100, v124
    v_add_f32 v101, v101, v125
    v_add_f32 v102, v102, v126
    v_add_f32 v103, v103, v127
    v_lshlrev_b32 v120, 16, v60
    v_and_b32 v121, 0xffff0000, v60
    v_lshlrev_b32 v122, 16, v61
    v_and_b32 v123, 0xffff0000, v61
    v_lshlrev_b32 v124, 16, v62
    v_and_b32 v125, 0xffff0000, v62
    v_lshlrev_b32 v126, 16, v63
    v_and_b32 v127, 0xffff0000, v63
    v_add_f32 v96, v96, v120
    v_add_f32 v97, v97, v121
    v_add_f32 v98, v98, v122
    v_add_f32 v99, v99, v123
    v_add_f32 v100, v100, v124
    v_add_f32 v101, v101, v125
    v_add_f32 v102, v102, v126
    v_add_f32 v103, v103, v127
    v_lshlrev_b32 v120, 16, v64
    v_and_b32 v121, 0xffff0000, v64
    v_lshlrev_b32 v122, 16, v65
    v_and_b32 v123, 0xffff0000, v65
    v_lshlrev_b32 v124, 16, v66
    v_and_b32 v125, 0xffff0000, v66
    v_lshlrev_b32 v126, 16, v67
    v_and_b32 v127, 0xffff0000, v67
    v_add_f32 v96, v96, v120
    v_add_f32 v97, v97, v121
    v_add_f32 v98, v98, v122
    v_add_f32 v99, v99, v123
    v_add_f32 v100, v100, v124
    v_add_f32 v101, v101, v125
    v_add_f32 v102, v102, v126
    v_add_f32 v103, v103, v127
    v_lshlrev_b32 v120, 16, v68
    v_and_b32 v121, 0xffff0000, v68
    v_lshlrev_b32 v122, 16, v69
    v_and_b32 v123, 0xffff0000, v69
    v_lshlrev_b32 v124, 16, v70
    v_and_b32 v125, 0xffff0000, v70
    v_lshlrev_b32 v126, 16, v71
    v_and_b32 v127, 0xffff0000, v71
    v_add_f32 v96, v96, v120
    v_add_f32 v97, v97, v121
    v_add_f32 v98, v98, v122
    v_add_f32 v99, v99, v123
    v_add_f32 v100, v100, v124
    v_add_f32 v101, v101, v125
    v_add_f32 v102, v102, v126
    v_add_f32 v103, v103, v127
    v_lshlrev_b32 v120, 16, v72
    v_and_b32 v121, 0xffff0000, v72
    v_lshlrev_b32 v122, 16, v73
    v_and_b32 v123, 0xffff0000, v73
    v_lshlrev_b32 v124, 16, v74
    v_and_b32 v125, 0xffff0000, v74
    v_lshlrev_b32 v126, 16, v75
    v_and_b32 v127, 0xffff0000, v75
    v_add_f32 v96, v96, v120
    v_add_f32 v97, v97, v121
    v_add_f32 v98, v98, v122
    v_add_f32 v99, v99, v123
    v_add_f32 v100, v100, v124
    v_add_f32 v101, v101, v125
    v_add_f32 v102, v102, v126
    v_add_f32 v103, v103, v127
    v_lshlrev_b32 v120, 16, v76
    v_and_b32 v121, 0xffff0000, v76
    v_lshlrev_b32 v122, 16, v77
    v_and_b32 v123, 0xffff0000, v77
    v_lshlrev_b32 v124, 16, v78
    v_and_b32 v125, 0xffff0000, v78
    v_lshlrev_b32 v126, 16, v79
    v_and_b32 v127, 0xffff0000, v79
    v_add_f32 v96, v96, v120
    v_add_f32 v97, v97, v121
    v_add_f32 v98, v98, v122
    v_add_f32 v99, v99, v123
    v_add_f32 v100, v100, v124
    v_add_f32 v101, v101, v125
    v_add_f32 v102, v102, v126
    v_add_f32 v103, v103, v127
    v_cndmask_b32 v108, v92, v94, s[20:21]
    v_cndmask_b32 v109, v93, v95, s[20:21]
    v_cndmask_b32 v110, v94, v92, s[20:21]
    v_cndmask_b32 v111, v95, v93, s[20:21]
    v_cvt_pk_bf16_f32 v104, v96, v97
    v_lshlrev_b32 v96, 16, v104
    v_and_b32 v97, 0xffff0000, v104
    v_lshlrev_b32 v104, 16, v84
    v_and_b32 v105, 0xffff0000, v84
    v_mul_f32 v96, v96, v104
    v_mul_f32 v97, v97, v105
    v_cvt_pk_bf16_f32 v104, v96, v97
    v_lshlrev_b32 v96, 16, v104
    v_and_b32 v97, 0xffff0000, v104
    v_lshlrev_b32 v104, 16, v108
    v_and_b32 v105, 0xffff0000, v108
    v_add_f32 v96, v96, v104
    v_add_f32 v97, v97, v105
    v_cvt_pk_bf16_f32 v112, v96, v97
    v_cvt_pk_bf16_f32 v104, v98, v99
    v_lshlrev_b32 v98, 16, v104
    v_and_b32 v99, 0xffff0000, v104
    v_lshlrev_b32 v104, 16, v85
    v_and_b32 v105, 0xffff0000, v85
    v_mul_f32 v98, v98, v104
    v_mul_f32 v99, v99, v105
    v_cvt_pk_bf16_f32 v104, v98, v99
    v_lshlrev_b32 v98, 16, v104
    v_and_b32 v99, 0xffff0000, v104
    v_lshlrev_b32 v104, 16, v109
    v_and_b32 v105, 0xffff0000, v109
    v_add_f32 v98, v98, v104
    v_add_f32 v99, v99, v105
    v_cvt_pk_bf16_f32 v113, v98, v99
    v_cvt_pk_bf16_f32 v104, v100, v101
    v_lshlrev_b32 v100, 16, v104
    v_and_b32 v101, 0xffff0000, v104
    v_lshlrev_b32 v104, 16, v86
    v_and_b32 v105, 0xffff0000, v86
    v_mul_f32 v100, v100, v104
    v_mul_f32 v101, v101, v105
    v_cvt_pk_bf16_f32 v104, v100, v101
    v_lshlrev_b32 v100, 16, v104
    v_and_b32 v101, 0xffff0000, v104
    v_lshlrev_b32 v104, 16, v110
    v_and_b32 v105, 0xffff0000, v110
    v_add_f32 v100, v100, v104
    v_add_f32 v101, v101, v105
    v_cvt_pk_bf16_f32 v114, v100, v101
    v_cvt_pk_bf16_f32 v104, v102, v103
    v_lshlrev_b32 v102, 16, v104
    v_and_b32 v103, 0xffff0000, v104
    v_lshlrev_b32 v104, 16, v87
    v_and_b32 v105, 0xffff0000, v87
    v_mul_f32 v102, v102, v104
    v_mul_f32 v103, v103, v105
    v_cvt_pk_bf16_f32 v104, v102, v103
    v_lshlrev_b32 v102, 16, v104
    v_and_b32 v103, 0xffff0000, v104
    v_lshlrev_b32 v104, 16, v111
    v_and_b32 v105, 0xffff0000, v111
    v_add_f32 v102, v102, v104
    v_add_f32 v103, v103, v105
    v_cvt_pk_bf16_f32 v115, v102, v103
    v_cndmask_b32 v132, v112, v114, s[20:21]
    v_cndmask_b32 v133, v113, v115, s[20:21]
    v_cndmask_b32 v134, v114, v112, s[20:21]
    v_cndmask_b32 v135, v115, v113, s[20:21]
    buffer_store_dwordx4 v[132:135], v4, s[12:15], s18 offen offset:64
    s_add_u32 s24, s24, 32
    s_cmp_lt_u32 s24, 61
    s_cbranch_scc1 fin_job
    s_cmp_ge_u32 s63, 48
    s_cbranch_scc1 k_end
    s_lshr_b32 s24, s63, 4
    s_sub_u32 s24, 63, s24
    s_and_b32 s25, s63, 15
    s_lshl_b32 s25, s25, 2
    s_and_b32 s26, s3, 3
    s_add_u32 s25, s25, s26
    s_lshr_b32 s26, s25, 5
    s_and_b32 s25, s25, 31
    s_lshl_b32 s16, s24, 1
    s_add_u32 s16, s16, s26
    s_lshl_b32 s18, s16, 15
    s_lshl_b32 s17, s25, 10
    s_add_u32 s17, s17, s18
    s_lshl_b32 s19, s25, 6
    s_add_u32 s18, s18, s19
    s_add_u32 s22, s17, 167772160
    s_add_u32 s23, s17, 75497472
    s_mov_b32 s27, 218106816
    s_mov_b32 s30, 218112000
    s_mov_b32 s28, 65536
    v_and_b32 v8, 7, v1
    v_lshlrev_b32 v8, 22, v8
    s_cmp_lg_u32 s3, 0
    s_cbranch_scc1 ft_ok
ft_wd:
    buffer_load_dword v7, off, s[4:7], s27 sc1
    s_waitcnt vmcnt(0)
    v_readfirstlane_b32 s31, v7
    s_cmp_ge_u32 s31, 16
    s_cbranch_scc1 ft_ws
    s_sleep 127
    s_sub_u32 s28, s28, 1
    s_cbranch_scc0 ft_wd
    s_mov_b32 s28, 0
ft_ws:
    buffer_load_dword v7, v6, s[4:7], s30 offen sc1
    s_waitcnt vmcnt(0)
    v_cmp_gt_u32 vcc, 61, v7
    s_cbranch_vccz ft_ok
    s_sleep 12
    v_cmp_gt_u32 vcc, 59, v7
    s_cbranch_vccz ft_wsf
    s_sleep 64
    v_cmp_gt_u32 vcc, 56, v7
    s_cbranch_vccz ft_wsf
    s_sleep 127
    s_sleep 127
ft_wsf:
    s_sub_u32 s28, s28, 1
    s_cbranch_scc0 ft_ws
    s_mov_b32 s28, 0
ft_ok:
    s_barrier
    s_cmp_ge_u32 s3, 4
    s_cbranch_scc1 k_end
    buffer_load_dwordx4 v[88:91], v4, s[8:11], s18 offen
    buffer_load_dwordx4 v[144:147], v3, s[4:7], s22 offen offset:0 sc1
    s_add_u32 s22, s22, 4194304
    buffer_load_dwordx4 v[148:151], v3, s[4:7], s22 offen offset:0 sc1
    s_add_u32 s22, s22, 4194304
    buffer_load_dwordx4 v[152:155], v3, s[4:7], s22 offen offset:0 sc1
    s_add_u32 s22, s22, 4194304
    buffer_load_dwordx4 v[156:159], v3, s[4:7], s22 offen offset:0 sc1
    s_waitcnt vmcnt(0)
    v_lshlrev_b32 v96, 16, v144
    v_and_b32 v97, 0xffff0000, v144
    v_lshlrev_b32 v98, 16, v145
    v_and_b32 v99, 0xffff0000, v145
    v_lshlrev_b32 v100, 16, v146
    v_and_b32 v101, 0xffff0000, v146
    v_lshlrev_b32 v102, 16, v147
    v_and_b32 v103, 0xffff0000, v147
    v_lshlrev_b32 v120, 16, v148
    v_and_b32 v121, 0xffff0000, v148
    v_lshlrev_b32 v122, 16, v149
    v_and_b32 v123, 0xffff0000, v149
    v_lshlrev_b32 v124, 16, v150
    v_and_b32 v125, 0xffff0000, v150
    v_lshlrev_b32 v126, 16, v151
    v_and_b32 v127, 0xffff0000, v151
    v_add_f32 v96, v96, v120
    v_add_f32 v97, v97, v121
    v_add_f32 v98, v98, v122
    v_add_f32 v99, v99, v123
    v_add_f32 v100, v100, v124
    v_add_f32 v101, v101, v125
    v_add_f32 v102, v102, v126
    v_add_f32 v103, v103, v127
    v_lshlrev_b32 v120, 16, v152
    v_and_b32 v121, 0xffff0000, v152
    v_lshlrev_b32 v122, 16, v153
    v_and_b32 v123, 0xffff0000, v153
    v_lshlrev_b32 v124, 16, v154
    v_and_b32 v125, 0xffff0000, v154
    v_lshlrev_b32 v126, 16, v155
    v_and_b32 v127, 0xffff0000, v155
    v_add_f32 v96, v96, v120
    v_add_f32 v97, v97, v121
    v_add_f32 v98, v98, v122
    v_add_f32 v99, v99, v123
    v_add_f32 v100, v100, v124
    v_add_f32 v101, v101, v125
    v_add_f32 v102, v102, v126
    v_add_f32 v103, v103, v127
    v_lshlrev_b32 v120, 16, v156
    v_and_b32 v121, 0xffff0000, v156
    v_lshlrev_b32 v122, 16, v157
    v_and_b32 v123, 0xffff0000, v157
    v_lshlrev_b32 v124, 16, v158
    v_and_b32 v125, 0xffff0000, v158
    v_lshlrev_b32 v126, 16, v159
    v_and_b32 v127, 0xffff0000, v159
    v_add_f32 v96, v96, v120
    v_add_f32 v97, v97, v121
    v_add_f32 v98, v98, v122
    v_add_f32 v99, v99, v123
    v_add_f32 v100, v100, v124
    v_add_f32 v101, v101, v125
    v_add_f32 v102, v102, v126
    v_add_f32 v103, v103, v127
    v_cvt_pk_bf16_f32 v120, v96, v97
    v_cvt_pk_bf16_f32 v121, v98, v99
    v_cvt_pk_bf16_f32 v122, v100, v101
    v_cvt_pk_bf16_f32 v123, v102, v103
    v_lshlrev_b32 v96, 16, v120
    v_and_b32 v97, 0xffff0000, v120
    v_lshlrev_b32 v98, 16, v121
    v_and_b32 v99, 0xffff0000, v121
    v_lshlrev_b32 v100, 16, v122
    v_and_b32 v101, 0xffff0000, v122
    v_lshlrev_b32 v102, 16, v123
    v_and_b32 v103, 0xffff0000, v123
    v_mul_f32 v104, 0xbfb8aa3b, v96
    v_mul_f32 v105, 0xbfb8aa3b, v97
    v_mul_f32 v106, 0xbfb8aa3b, v98
    v_mul_f32 v107, 0xbfb8aa3b, v99
    v_mul_f32 v108, 0xbfb8aa3b, v100
    v_mul_f32 v109, 0xbfb8aa3b, v101
    v_mul_f32 v110, 0xbfb8aa3b, v102
    v_mul_f32 v111, 0xbfb8aa3b, v103
    v_exp_f32 v104, v104
    v_exp_f32 v105, v105
    v_exp_f32 v106, v106
    v_exp_f32 v107, v107
    v_exp_f32 v108, v108
    v_exp_f32 v109, v109
    v_exp_f32 v110, v110
    v_exp_f32 v111, v111
    v_add_f32 v104, 1.0, v104
    v_add_f32 v105, 1.0, v105
    v_add_f32 v106, 1.0, v106
    v_add_f32 v107, 1.0, v107
    v_add_f32 v108, 1.0, v108
    v_add_f32 v109, 1.0, v109
    v_add_f32 v110, 1.0, v110
    v_add_f32 v111, 1.0, v111
    v_rcp_f32 v104, v104
    v_rcp_f32 v105, v105
    v_rcp_f32 v106, v106
    v_rcp_f32 v107, v107
    v_rcp_f32 v108, v108
    v_rcp_f32 v109, v109
    v_rcp_f32 v110, v110
    v_rcp_f32 v111, v111
    v_mul_f32 v96, v96, v104
    v_mul_f32 v97, v97, v105
    v_mul_f32 v98, v98, v106
    v_mul_f32 v99, v99, v107
    v_mul_f32 v100, v100, v108
    v_mul_f32 v101, v101, v109
    v_mul_f32 v102, v102, v110
    v_mul_f32 v103, v103, v111
    v_cvt_pk_bf16_f32 v80, v96, v97
    v_cvt_pk_bf16_f32 v81, v98, v99
    v_cvt_pk_bf16_f32 v82, v100, v101
    v_cvt_pk_bf16_f32 v83, v102, v103
    s_cmp_eq_u32 s24, 63
    s_cbranch_scc1 ft_p63
ft_p:
    buffer_load_dword v7, v8, s[4:7], s23 offen offset:1020 sc1
    s_waitcnt vmcnt(0)
    v_cmp_eq_u32 vcc, -1, v7
    s_cbranch_vccz ft_l
    s_sleep 4
    s_sub_u32 s28, s28, 1
    s_cbranch_scc0 ft_p
    s_mov_b32 s28, 0
ft_l:
    s_mov_b32 s31, s23
    buffer_load_dwordx4 v[16:19], v3, s[4:7], s31 offen sc1
    s_add_u32 s31, s31, 4194304
    buffer_load_dwordx4 v[20:23], v3, s[4:7], s31 offen sc1
    s_add_u32 s31, s31, 4194304
    buffer_load_dwordx4 v[24:27], v3, s[4:7], s31 offen sc1
    s_add_u32 s31, s31, 4194304
    buffer_load_dwordx4 v[28:31], v3, s[4:7], s31 offen sc1
    s_add_u32 s31, s31, 4194304
    buffer_load_dwordx4 v[32:35], v3, s[4:7], s31 offen sc1
    s_add_u32 s31, s31, 4194304
    buffer_load_dwordx4 v[36:39], v3, s[4:7], s31 offen sc1
    s_add_u32 s31, s31, 4194304
    buffer_load_dwordx4 v[40:43], v3, s[4:7], s31 offen sc1
    s_add_u32 s31, s31, 4194304
    buffer_load_dwordx4 v[44:47], v3, s[4:7], s31 offen sc1
    s_waitcnt vmcnt(0)
    v_max3_u32 v7, v16, v17, v18
    v_max3_u32 v7, v7, v19, v20
    v_max3_u32 v7, v7, v21, v22
    v_max3_u32 v7, v7, v23, v24
    v_max3_u32 v7, v7, v25, v26
    v_max3_u32 v7, v7, v27, v28
    v_max3_u32 v7, v7, v29, v30
    v_max3_u32 v7, v7, v31, v32
    v_max3_u32 v7, v7, v33, v34
    v_max3_u32 v7, v7, v35, v36
    v_max3_u32 v7, v7, v37, v38
    v_max3_u32 v7, v7, v39, v40
    v_max3_u32 v7, v7, v41, v42
    v_max3_u32 v7, v7, v43, v44
    v_max3_u32 v7, v7, v45, v46
    v_max_u32 v7, v7, v47
    v_cmp_eq_u32 vcc, -1, v7
    s_cbranch_vccz ft_go
    s_sleep 2
    s_sub_u32 s28, s28, 1
    s_cbranch_scc0 ft_l
    s_branch ft_go
ft_p63:
    s_sub_u32 s31, s23, 65536
    buffer_load_dword v7, v8, s[4:7], s31 offen offset:1020 sc1
    s_waitcnt vmcnt(0)
    v_cmp_eq_u32 vcc, -1, v7
    s_cbranch_vccz ft_l
    s_sleep 4
    s_sub_u32 s28, s28, 1
    s_cbranch_scc0 ft_p63
    s_mov_b32 s28, 0
    s_branch ft_l
ft_go:
    v_lshlrev_b32 v96, 16, v16
    v_and_b32 v97, 0xffff0000, v16
    v_lshlrev_b32 v98, 16, v17
    v_and_b32 v99, 0xffff0000, v17
    v_lshlrev_b32 v100, 16, v18
    v_and_b32 v101, 0xffff0000, v18
    v_lshlrev_b32 v102, 16, v19
    v_and_b32 v103, 0xffff0000, v19
    v_lshlrev_b32 v120, 16, v20
    v_and_b32 v121, 0xffff0000, v20
    v_lshlrev_b32 v122, 16, v21
    v_and_b32 v123, 0xffff0000, v21
    v_lshlrev_b32 v124, 16, v22
    v_and_b32 v125, 0xffff0000, v22
    v_lshlrev_b32 v126, 16, v23
    v_and_b32 v127, 0xffff0000, v23
    v_add_f32 v96, v96, v120
    v_add_f32 v97, v97, v121
    v_add_f32 v98, v98, v122
    v_add_f32 v99, v99, v123
    v_add_f32 v100, v100, v124
    v_add_f32 v101, v101, v125
    v_add_f32 v102, v102, v126
    v_add_f32 v103, v103, v127
    v_lshlrev_b32 v120, 16, v24
    v_and_b32 v121, 0xffff0000, v24
    v_lshlrev_b32 v122, 16, v25
    v_and_b32 v123, 0xffff0000, v25
    v_lshlrev_b32 v124, 16, v26
    v_and_b32 v125, 0xffff0000, v26
    v_lshlrev_b32 v126, 16, v27
    v_and_b32 v127, 0xffff0000, v27
    v_add_f32 v96, v96, v120
    v_add_f32 v97, v97, v121
    v_add_f32 v98, v98, v122
    v_add_f32 v99, v99, v123
    v_add_f32 v100, v100, v124
    v_add_f32 v101, v101, v125
    v_add_f32 v102, v102, v126
    v_add_f32 v103, v103, v127
    v_lshlrev_b32 v120, 16, v28
    v_and_b32 v121, 0xffff0000, v28
    v_lshlrev_b32 v122, 16, v29
    v_and_b32 v123, 0xffff0000, v29
    v_lshlrev_b32 v124, 16, v30
    v_and_b32 v125, 0xffff0000, v30
    v_lshlrev_b32 v126, 16, v31
    v_and_b32 v127, 0xffff0000, v31
    v_add_f32 v96, v96, v120
    v_add_f32 v97, v97, v121
    v_add_f32 v98, v98, v122
    v_add_f32 v99, v99, v123
    v_add_f32 v100, v100, v124
    v_add_f32 v101, v101, v125
    v_add_f32 v102, v102, v126
    v_add_f32 v103, v103, v127
    v_lshlrev_b32 v120, 16, v32
    v_and_b32 v121, 0xffff0000, v32
    v_lshlrev_b32 v122, 16, v33
    v_and_b32 v123, 0xffff0000, v33
    v_lshlrev_b32 v124, 16, v34
    v_and_b32 v125, 0xffff0000, v34
    v_lshlrev_b32 v126, 16, v35
    v_and_b32 v127, 0xffff0000, v35
    v_add_f32 v96, v96, v120
    v_add_f32 v97, v97, v121
    v_add_f32 v98, v98, v122
    v_add_f32 v99, v99, v123
    v_add_f32 v100, v100, v124
    v_add_f32 v101, v101, v125
    v_add_f32 v102, v102, v126
    v_add_f32 v103, v103, v127
    v_lshlrev_b32 v120, 16, v36
    v_and_b32 v121, 0xffff0000, v36
    v_lshlrev_b32 v122, 16, v37
    v_and_b32 v123, 0xffff0000, v37
    v_lshlrev_b32 v124, 16, v38
    v_and_b32 v125, 0xffff0000, v38
    v_lshlrev_b32 v126, 16, v39
    v_and_b32 v127, 0xffff0000, v39
    v_add_f32 v96, v96, v120
    v_add_f32 v97, v97, v121
    v_add_f32 v98, v98, v122
    v_add_f32 v99, v99, v123
    v_add_f32 v100, v100, v124
    v_add_f32 v101, v101, v125
    v_add_f32 v102, v102, v126
    v_add_f32 v103, v103, v127
    v_lshlrev_b32 v120, 16, v40
    v_and_b32 v121, 0xffff0000, v40
    v_lshlrev_b32 v122, 16, v41
    v_and_b32 v123, 0xffff0000, v41
    v_lshlrev_b32 v124, 16, v42
    v_and_b32 v125, 0xffff0000, v42
    v_lshlrev_b32 v126, 16, v43
    v_and_b32 v127, 0xffff0000, v43
    v_add_f32 v96, v96, v120
    v_add_f32 v97, v97, v121
    v_add_f32 v98, v98, v122
    v_add_f32 v99, v99, v123
    v_add_f32 v100, v100, v124
    v_add_f32 v101, v101, v125
    v_add_f32 v102, v102, v126
    v_add_f32 v103, v103, v127
    v_lshlrev_b32 v120, 16, v44
    v_and_b32 v121, 0xffff0000, v44
    v_lshlrev_b32 v122, 16, v45
    v_and_b32 v123, 0xffff0000, v45
    v_lshlrev_b32 v124, 16, v46
    v_and_b32 v125, 0xffff0000, v46
    v_lshlrev_b32 v126, 16, v47
    v_and_b32 v127, 0xffff0000, v47
    v_add_f32 v96, v96, v120
    v_add_f32 v97, v97, v121
    v_add_f32 v98, v98, v122
    v_add_f32 v99, v99, v123
    v_add_f32 v100, v100, v124
    v_add_f32 v101, v101, v125
    v_add_f32 v102, v102, v126
    v_add_f32 v103, v103, v127
    v_cndmask_b32 v108, v88, v90, s[20:21]
    v_cndmask_b32 v109, v89, v91, s[20:21]
    v_cndmask_b32 v110, v90, v88, s[20:21]
    v_cndmask_b32 v111, v91, v89, s[20:21]
    v_cvt_pk_bf16_f32 v104, v96, v97
    v_lshlrev_b32 v96, 16, v104
    v_and_b32 v97, 0xffff0000, v104
    v_lshlrev_b32 v104, 16, v80
    v_and_b32 v105, 0xffff0000, v80
    v_mul_f32 v96, v96, v104
    v_mul_f32 v97, v97, v105
    v_cvt_pk_bf16_f32 v104, v96, v97
    v_lshlrev_b32 v96, 16, v104
    v_and_b32 v97, 0xffff0000, v104
    v_lshlrev_b32 v104, 16, v108
    v_and_b32 v105, 0xffff0000, v108
    v_add_f32 v96, v96, v104
    v_add_f32 v97, v97, v105
    v_cvt_pk_bf16_f32 v112, v96, v97
    v_cvt_pk_bf16_f32 v104, v98, v99
    v_lshlrev_b32 v98, 16, v104
    v_and_b32 v99, 0xffff0000, v104
    v_lshlrev_b32 v104, 16, v81
    v_and_b32 v105, 0xffff0000, v81
    v_mul_f32 v98, v98, v104
    v_mul_f32 v99, v99, v105
    v_cvt_pk_bf16_f32 v104, v98, v99
    v_lshlrev_b32 v98, 16, v104
    v_and_b32 v99, 0xffff0000, v104
    v_lshlrev_b32 v104, 16, v109
    v_and_b32 v105, 0xffff0000, v109
    v_add_f32 v98, v98, v104
    v_add_f32 v99, v99, v105
    v_cvt_pk_bf16_f32 v113, v98, v99
    v_cvt_pk_bf16_f32 v104, v100, v101
    v_lshlrev_b32 v100, 16, v104
    v_and_b32 v101, 0xffff0000, v104
    v_lshlrev_b32 v104, 16, v82
    v_and_b32 v105, 0xffff0000, v82
    v_mul_f32 v100, v100, v104
    v_mul_f32 v101, v101, v105
    v_cvt_pk_bf16_f32 v104, v100, v101
    v_lshlrev_b32 v100, 16, v104
    v_and_b32 v101, 0xffff0000, v104
    v_lshlrev_b32 v104, 16, v110
    v_and_b32 v105, 0xffff0000, v110
    v_add_f32 v100, v100, v104
    v_add_f32 v101, v101, v105
    v_cvt_pk_bf16_f32 v114, v100, v101
    v_cvt_pk_bf16_f32 v104, v102, v103
    v_lshlrev_b32 v102, 16, v104
    v_and_b32 v103, 0xffff0000, v104
    v_lshlrev_b32 v104, 16, v83
    v_and_b32 v105, 0xffff0000, v83
    v_mul_f32 v102, v102, v104
    v_mul_f32 v103, v103, v105
    v_cvt_pk_bf16_f32 v104, v102, v103
    v_lshlrev_b32 v102, 16, v104
    v_and_b32 v103, 0xffff0000, v104
    v_lshlrev_b32 v104, 16, v111
    v_and_b32 v105, 0xffff0000, v111
    v_add_f32 v102, v102, v104
    v_add_f32 v103, v103, v105
    v_cvt_pk_bf16_f32 v115, v102, v103
    v_cndmask_b32 v128, v112, v114, s[20:21]
    v_cndmask_b32 v129, v113, v115, s[20:21]
    v_cndmask_b32 v130, v114, v112, s[20:21]
    v_cndmask_b32 v131, v115, v113, s[20:21]
    buffer_store_dwordx4 v[128:131], v4, s[12:15], s18 offen offset:0
    s_branch k_end
chain_map:
    s_and_b32 s14, s12, 1
    s_lshl_b32 s13, s13, 1
    s_lshr_b32 s15, s12, 1
    s_add_u32 s12, s13, s14
    s_mov_b32 s13, s15
    s_lshl_b32 s2, s13, 3
    s_add_u32 s2, s2, s12
    s_lshr_b32 s14, s13, 2
    s_and_b32 s15, s13, 3
    s_mov_b32 s16, 0
    s_mov_b32 s17, 209715200
    s_mov_b32 s18, 209977344
    s_mov_b32 s19, 210239488
    s_mov_b32 s20, 210501632
    s_mov_b32 s26, 131072
    s_mov_b32 s68, 0
    s_getreg_b32 s29, hwreg(HW_REG_XCC_ID)
    s_and_b32 s29, s29, 15
    s_mul_i32 s23, s29, s29
    s_lshl_b32 s23, s23, 18
    s_lshl_b32 s29, s29, 8
    s_add_u32 s29, s29, s23
    s_add_u32 s29, s29, 1
    s_lshr_b32 s28, s12, 1
    s_lshl_b32 s28, s28, 2
    s_add_u32 s28, s28, 128
    s_cmp_ge_u32 s3, 4
    s_cbranch_scc1 ch_a_pro
    s_lshl_b32 s32, s12, 15
    s_lshl_b32 s21, s14, 13
    s_add_u32 s32, s32, s21
    s_lshl_b32 s21, s15, 10
    s_add_u32 s32, s32, s21
    s_add_u32 s32, s32, 2097152
    s_lshr_b32 s33, s12, 1
    s_lshl_b32 s33, s33, 14
    s_add_u32 s33, s33, 1048576
    s_lshl_b32 s21, s13, 10
    s_add_u32 s36, s33, s21
    s_lshl_b32 s21, s3, 12
    s_add_u32 s33, s33, s21
    s_lshl_b32 s34, s13, 14
    s_lshl_b32 s21, s12, 10
    s_add_u32 s35, s34, s21
    s_lshl_b32 s37, s12, 22
    s_lshl_b32 s21, s13, 11
    s_add_u32 s37, s37, s21
    s_and_b32 s21, s3, 1
    s_lshl_b32 s21, s21, 15
    s_add_u32 s37, s37, s21
    s_lshr_b32 s21, s3, 1
    s_lshl_b32 s21, s21, 10
    s_add_u32 s37, s37, s21
    s_add_u32 s37, s37, 75497472
    v_and_b32 v20, 63, v0
    v_lshlrev_b32 v1, 4, v20
    v_mov_b32 v10, -1
    v_mov_b32 v11, -1
    v_lshrrev_b32 v21, 2, v20
    v_and_b32 v22, 3, v20
    v_lshlrev_b32 v21, 13, v21
    v_lshl_add_u32 v21, v22, 4, v21
    s_lshl_b32 s21, s3, 21
    s_lshl_b32 s22, s12, 10
    s_add_u32 s21, s21, s22
    s_lshl_b32 s23, s3, 15
    s_mov_b32 s10, 8388608
    s_mov_b32 s11, 131072
    v_lshrrev_b32 v24, 4, v20
    v_bfe_u32 v25, v20, 2, 2
    v_lshl_add_u32 v24, v24, 4, v25
    v_lshlrev_b32 v24, 6, v24
    v_lshl_add_u32 v24, v22, 3, v24
    v_add_u32 v24, s23, v24
    s_and_b32 s70, s13, 1
    s_lshl_b32 s71, s12, 4
    s_add_u32 s71, s71, s13
    s_cmp_eq_u32 s71, 127
    s_cselect_b32 s70, 1, 0
    s_cmp_eq_u32 s13, 7
    s_cselect_b32 s70, 1, s70
    s_lshl_b32 s72, s70, 20
    s_lshl_b32 s73, s70, 21
    s_lshl_b32 s70, s70, 13
    s_sub_u32 s71, s23, s70
    s_add_u32 s70, s23, s70
    s_load_dwordx2 s[8:9], s[0:1], 16
    s_lshl_b32 s25, s13, 6
    s_add_u32 s24, s21, s25
    s_add_u32 s24, s24, s72
    s_waitcnt lgkmcnt(0)
    s_add_u32 m0, s70, 0
    s_nop 0
    buffer_load_dwordx4 v21, s[8:11], s24 offen lds
    s_add_u32 s24, s24, 131072
    s_add_u32 m0, s70, 1024
    s_nop 0
    buffer_load_dwordx4 v21, s[8:11], s24 offen lds
    s_add_u32 s24, s24, 131072
    s_add_u32 m0, s70, 2048
    s_nop 0
    buffer_load_dwordx4 v21, s[8:11], s24 offen lds
    s_add_u32 s24, s24, 131072
    s_add_u32 m0, s70, 3072
    s_nop 0
    buffer_load_dwordx4 v21, s[8:11], s24 offen lds
    s_add_u32 s24, s24, 131072
    s_add_u32 m0, s70, 4096
    s_nop 0
    buffer_load_dwordx4 v21, s[8:11], s24 offen lds
    s_add_u32 s24, s24, 131072
    s_add_u32 m0, s70, 5120
    s_nop 0
    buffer_load_dwordx4 v21, s[8:11], s24 offen lds
    s_add_u32 s24, s24, 131072
    s_add_u32 m0, s70, 6144
    s_nop 0
    buffer_load_dwordx4 v21, s[8:11], s24 offen lds
    s_add_u32 s24, s24, 131072
    s_add_u32 m0, s70, 7168
    s_nop 0
    buffer_load_dwordx4 v21, s[8:11], s24 offen lds
    s_add_u32 s24, s24, 131072
    s_sub_u32 s24, s24, s73
    s_add_u32 m0, s71, 8192
    s_nop 0
    buffer_load_dwordx4 v21, s[8:11], s24 offen lds
    s_add_u32 s24, s24, 131072
    s_add_u32 m0, s71, 9216
    s_nop 0
    buffer_load_dwordx4 v21, s[8:11], s24 offen lds
    s_add_u32 s24, s24, 131072
    s_add_u32 m0, s71, 10240
    s_nop 0
    buffer_load_dwordx4 v21, s[8:11], s24 offen lds
    s_add_u32 s24, s24, 131072
    s_add_u32 m0, s71, 11264
    s_nop 0
    buffer_load_dwordx4 v21, s[8:11], s24 offen lds
    s_add_u32 s24, s24, 131072
    s_add_u32 m0, s71, 12288
    s_nop 0
    buffer_load_dwordx4 v21, s[8:11], s24 offen lds
    s_add_u32 s24, s24, 131072
    s_add_u32 m0, s71, 13312
    s_nop 0
    buffer_load_dwordx4 v21, s[8:11], s24 offen lds
    s_add_u32 s24, s24, 131072
    s_add_u32 m0, s71, 14336
    s_nop 0
    buffer_load_dwordx4 v21, s[8:11], s24 offen lds
    s_add_u32 s24, s24, 131072
    s_add_u32 m0, s71, 15360
    s_nop 0
    buffer_load_dwordx4 v21, s[8:11], s24 offen lds
    s_add_u32 s24, s24, 131072
    s_load_dwordx2 s[8:9], s[0:1], 24
    s_lshl_b32 s25, s13, 6
    s_add_u32 s24, s21, s25
    s_add_u32 s24, s24, s72
    s_waitcnt lgkmcnt(0)
    s_add_u32 m0, s70, 16384
    s_nop 0
    buffer_load_dwordx4 v21, s[8:11], s24 offen lds
    s_add_u32 s24, s24, 131072
    s_add_u32 m0, s70, 17408
    s_nop 0
    buffer_load_dwordx4 v21, s[8:11], s24 offen lds
    s_add_u32 s24, s24, 131072
    s_add_u32 m0, s70, 18432
    s_nop 0
    buffer_load_dwordx4 v21, s[8:11], s24 offen lds
    s_add_u32 s24, s24, 131072
    s_add_u32 m0, s70, 19456
    s_nop 0
    buffer_load_dwordx4 v21, s[8:11], s24 offen lds
    s_add_u32 s24, s24, 131072
    s_add_u32 m0, s70, 20480
    s_nop 0
    buffer_load_dwordx4 v21, s[8:11], s24 offen lds
    s_add_u32 s24, s24, 131072
    s_add_u32 m0, s70, 21504
    s_nop 0
    buffer_load_dwordx4 v21, s[8:11], s24 offen lds
    s_add_u32 s24, s24, 131072
    s_add_u32 m0, s70, 22528
    s_nop 0
    buffer_load_dwordx4 v21, s[8:11], s24 offen lds
    s_add_u32 s24, s24, 131072
    s_add_u32 m0, s70, 23552
    s_nop 0
    buffer_load_dwordx4 v21, s[8:11], s24 offen lds
    s_add_u32 s24, s24, 131072
    s_sub_u32 s24, s24, s73
    s_add_u32 m0, s71, 24576
    s_nop 0
    buffer_load_dwordx4 v21, s[8:11], s24 offen lds
    s_add_u32 s24, s24, 131072
    s_add_u32 m0, s71, 25600
    s_nop 0
    buffer_load_dwordx4 v21, s[8:11], s24 offen lds
    s_add_u32 s24, s24, 131072
    s_add_u32 m0, s71, 26624
    s_nop 0
    buffer_load_dwordx4 v21, s[8:11], s24 offen lds
    s_add_u32 s24, s24, 131072
    s_add_u32 m0, s71, 27648
    s_nop 0
    buffer_load_dwordx4 v21, s[8:11], s24 offen lds
    s_add_u32 s24, s24, 131072
    s_add_u32 m0, s71, 28672
    s_nop 0
    buffer_load_dwordx4 v21, s[8:11], s24 offen lds
    s_add_u32 s24, s24, 131072
    s_add_u32 m0, s71, 29696
    s_nop 0
    buffer_load_dwordx4 v21, s[8:11], s24 offen lds
    s_add_u32 s24, s24, 131072
    s_add_u32 m0, s71, 30720
    s_nop 0
    buffer_load_dwordx4 v21, s[8:11], s24 offen lds
    s_add_u32 s24, s24, 131072
    s_add_u32 m0, s71, 31744
    s_nop 0
    buffer_load_dwordx4 v21, s[8:11], s24 offen lds
    s_add_u32 s24, s24, 131072
    s_load_dwordx2 s[8:9], s[0:1], 32
    s_lshl_b32 s25, s13, 6
    s_add_u32 s24, s21, s25
    s_add_u32 s24, s24, s72
    s_waitcnt lgkmcnt(0)
    buffer_load_dwordx4 v[96:99], v21, s[8:11], s24 offen
    s_add_u32 s24, s24, 131072
    buffer_load_dwordx4 v[100:103], v21, s[8:11], s24 offen
    s_add_u32 s24, s24, 131072
    buffer_load_dwordx4 v[104:107], v21, s[8:11], s24 offen
    s_add_u32 s24, s24, 131072
    buffer_load_dwordx4 v[108:111], v21, s[8:11], s24 offen
    s_add_u32 s24, s24, 131072
    buffer_load_dwordx4 v[144:147], v21, s[8:11], s24 offen
    s_add_u32 s24, s24, 131072
    buffer_load_dwordx4 v[148:151], v21, s[8:11], s24 offen
    s_add_u32 s24, s24, 131072
    buffer_load_dwordx4 v[152:155], v21, s[8:11], s24 offen
    s_add_u32 s24, s24, 131072
    buffer_load_dwordx4 v[156:159], v21, s[8:11], s24 offen
    s_add_u32 s24, s24, 131072
    s_sub_u32 s24, s24, s73
    buffer_load_dwordx4 v[192:195], v21, s[8:11], s24 offen
    s_add_u32 s24, s24, 131072
    buffer_load_dwordx4 v[196:199], v21, s[8:11], s24 offen
    s_add_u32 s24, s24, 131072
    buffer_load_dwordx4 v[200:203], v21, s[8:11], s24 offen
    s_add_u32 s24, s24, 131072
    buffer_load_dwordx4 v[204:207], v21, s[8:11], s24 offen
    s_add_u32 s24, s24, 131072
    buffer_load_dwordx4 v[240:243], v21, s[8:11], s24 offen
    s_add_u32 s24, s24, 131072
    buffer_load_dwordx4 v[244:247], v21, s[8:11], s24 offen
    s_add_u32 s24, s24, 131072
    buffer_load_dwordx4 v[248:251], v21, s[8:11], s24 offen
    s_add_u32 s24, s24, 131072
    buffer_load_dwordx4 v[252:255], v21, s[8:11], s24 offen
    s_add_u32 s24, s24, 131072
    s_load_dwordx2 s[8:9], s[0:1], 8
    s_mov_b32 s10, 16384
    v_bfe_u32 v57, v20, 4, 1
    v_lshrrev_b32 v58, 5, v20
    v_and_b32 v59, 1, v20
    v_bfe_u32 v60, v20, 1, 3
    v_lshlrev_b32 v60, 11, v60
    v_lshl_add_u32 v60, v57, 6, v60
    v_lshl_add_u32 v60, v58, 4, v60
    v_lshl_add_u32 v15, v59, 2, v60
    s_lshl_b32 s24, s3, 9
    s_waitcnt lgkmcnt(0)
    buffer_load_dword v32, v15, s[8:11], s24 offen offset:0
    buffer_load_dword v33, v15, s[8:11], s24 offen offset:8
    buffer_load_dword v34, v15, s[8:11], s24 offen offset:32
    buffer_load_dword v35, v15, s[8:11], s24 offen offset:40
    buffer_load_dword v36, v15, s[8:11], s24 offen offset:128
    buffer_load_dword v37, v15, s[8:11], s24 offen offset:136
    buffer_load_dword v38, v15, s[8:11], s24 offen offset:160
    buffer_load_dword v39, v15, s[8:11], s24 offen offset:168
    buffer_load_dword v40, v15, s[8:11], s24 offen offset:256
    buffer_load_dword v41, v15, s[8:11], s24 offen offset:264
    buffer_load_dword v42, v15, s[8:11], s24 offen offset:288
    buffer_load_dword v43, v15, s[8:11], s24 offen offset:296
    buffer_load_dword v44, v15, s[8:11], s24 offen offset:384
    buffer_load_dword v45, v15, s[8:11], s24 offen offset:392
    buffer_load_dword v46, v15, s[8:11], s24 offen offset:416
    buffer_load_dword v47, v15, s[8:11], s24 offen offset:424
    s_barrier
    v_add_u32 v56, s70, v1
    s_add_u32 s71, s71, 8192
    v_add_u32 v26, s71, v1
    s_waitcnt vmcnt(48)
    ds_read_b64_tr_b16 v[64:65], v24 offset:0
    ds_read_b64_tr_b16 v[66:67], v24 offset:256
    ds_read_b64_tr_b16 v[68:69], v24 offset:512
    ds_read_b64_tr_b16 v[70:71], v24 offset:768
    ds_read_b64_tr_b16 v[72:73], v24 offset:32
    ds_read_b64_tr_b16 v[74:75], v24 offset:288
    ds_read_b64_tr_b16 v[76:77], v24 offset:544
    ds_read_b64_tr_b16 v[78:79], v24 offset:800
    s_waitcnt lgkmcnt(0)
    ds_read_b64_tr_b16 v[112:113], v24 offset:4096
    ds_read_b64_tr_b16 v[114:115], v24 offset:4352
    ds_read_b64_tr_b16 v[116:117], v24 offset:4608
    ds_read_b64_tr_b16 v[118:119], v24 offset:4864
    ds_read_b64_tr_b16 v[120:121], v24 offset:4128
    ds_read_b64_tr_b16 v[122:123], v24 offset:4384
    ds_read_b64_tr_b16 v[124:125], v24 offset:4640
    ds_read_b64_tr_b16 v[126:127], v24 offset:4896
    s_waitcnt lgkmcnt(0)
    ds_read_b64_tr_b16 v[160:161], v24 offset:8192
    ds_read_b64_tr_b16 v[162:163], v24 offset:8448
    ds_read_b64_tr_b16 v[164:165], v24 offset:8704
    ds_read_b64_tr_b16 v[166:167], v24 offset:8960
    ds_read_b64_tr_b16 v[168:169], v24 offset:8224
    ds_read_b64_tr_b16 v[170:171], v24 offset:8480
    ds_read_b64_tr_b16 v[172:173], v24 offset:8736
    ds_read_b64_tr_b16 v[174:175], v24 offset:8992
    s_waitcnt lgkmcnt(0)
    ds_read_b64_tr_b16 v[208:209], v24 offset:12288
    ds_read_b64_tr_b16 v[210:211], v24 offset:12544
    ds_read_b64_tr_b16 v[212:213], v24 offset:12800
    ds_read_b64_tr_b16 v[214:215], v24 offset:13056
    ds_read_b64_tr_b16 v[216:217], v24 offset:12320
    ds_read_b64_tr_b16 v[218:219], v24 offset:12576
    ds_read_b64_tr_b16 v[220:221], v24 offset:12832
    ds_read_b64_tr_b16 v[222:223], v24 offset:13088
    s_waitcnt lgkmcnt(0)
    s_waitcnt vmcnt(32)
    ds_read_b64_tr_b16 v[80:81], v24 offset:16384
    ds_read_b64_tr_b16 v[82:83], v24 offset:16640
    ds_read_b64_tr_b16 v[84:85], v24 offset:16896
    ds_read_b64_tr_b16 v[86:87], v24 offset:17152
    ds_read_b64_tr_b16 v[88:89], v24 offset:16416
    ds_read_b64_tr_b16 v[90:91], v24 offset:16672
    ds_read_b64_tr_b16 v[92:93], v24 offset:16928
    ds_read_b64_tr_b16 v[94:95], v24 offset:17184
    s_waitcnt lgkmcnt(0)
    ds_read_b64_tr_b16 v[128:129], v24 offset:20480
    ds_read_b64_tr_b16 v[130:131], v24 offset:20736
    ds_read_b64_tr_b16 v[132:133], v24 offset:20992
    ds_read_b64_tr_b16 v[134:135], v24 offset:21248
    ds_read_b64_tr_b16 v[136:137], v24 offset:20512
    ds_read_b64_tr_b16 v[138:139], v24 offset:20768
    ds_read_b64_tr_b16 v[140:141], v24 offset:21024
    ds_read_b64_tr_b16 v[142:143], v24 offset:21280
    s_waitcnt lgkmcnt(0)
    ds_read_b64_tr_b16 v[176:177], v24 offset:24576
    ds_read_b64_tr_b16 v[178:179], v24 offset:24832
    ds_read_b64_tr_b16 v[180:181], v24 offset:25088
    ds_read_b64_tr_b16 v[182:183], v24 offset:25344
    ds_read_b64_tr_b16 v[184:185], v24 offset:24608
    ds_read_b64_tr_b16 v[186:187], v24 offset:24864
    ds_read_b64_tr_b16 v[188:189], v24 offset:25120
    ds_read_b64_tr_b16 v[190:191], v24 offset:25376
    s_waitcnt lgkmcnt(0)
    ds_read_b64_tr_b16 v[224:225], v24 offset:28672
    ds_read_b64_tr_b16 v[226:227], v24 offset:28928
    ds_read_b64_tr_b16 v[228:229], v24 offset:29184
    ds_read_b64_tr_b16 v[230:231], v24 offset:29440
    ds_read_b64_tr_b16 v[232:233], v24 offset:28704
    ds_read_b64_tr_b16 v[234:235], v24 offset:28960
    ds_read_b64_tr_b16 v[236:237], v24 offset:29216
    ds_read_b64_tr_b16 v[238:239], v24 offset:29472
    s_waitcnt lgkmcnt(0)
    s_waitcnt vmcnt(16)
    ds_write_b128 v56, v[96:99] offset:0
    ds_write_b128 v56, v[100:103] offset:1024
    ds_write_b128 v56, v[104:107] offset:2048
    ds_write_b128 v56, v[108:111] offset:3072
    ds_write_b128 v56, v[144:147] offset:4096
    ds_write_b128 v56, v[148:151] offset:5120
    ds_write_b128 v56, v[152:155] offset:6144
    ds_write_b128 v56, v[156:159] offset:7168
    ds_write_b128 v26, v[192:195] offset:0
    ds_write_b128 v26, v[196:199] offset:1024
    ds_write_b128 v26, v[200:203] offset:2048
    ds_write_b128 v26, v[204:207] offset:3072
    ds_write_b128 v26, v[240:243] offset:4096
    ds_write_b128 v26, v[244:247] offset:5120
    ds_write_b128 v26, v[248:251] offset:6144
    ds_write_b128 v26, v[252:255] offset:7168
    s_waitcnt lgkmcnt(0)
    ds_read_b64_tr_b16 v[96:97], v24 offset:0
    ds_read_b64_tr_b16 v[98:99], v24 offset:256
    ds_read_b64_tr_b16 v[100:101], v24 offset:512
    ds_read_b64_tr_b16 v[102:103], v24 offset:768
    ds_read_b64_tr_b16 v[104:105], v24 offset:32
    ds_read_b64_tr_b16 v[106:107], v24 offset:288
    ds_read_b64_tr_b16 v[108:109], v24 offset:544
    ds_read_b64_tr_b16 v[110:111], v24 offset:800
    s_waitcnt lgkmcnt(0)
    ds_read_b64_tr_b16 v[144:145], v24 offset:4096
    ds_read_b64_tr_b16 v[146:147], v24 offset:4352
    ds_read_b64_tr_b16 v[148:149], v24 offset:4608
    ds_read_b64_tr_b16 v[150:151], v24 offset:4864
    ds_read_b64_tr_b16 v[152:153], v24 offset:4128
    ds_read_b64_tr_b16 v[154:155], v24 offset:4384
    ds_read_b64_tr_b16 v[156:157], v24 offset:4640
    ds_read_b64_tr_b16 v[158:159], v24 offset:4896
    s_waitcnt lgkmcnt(0)
    ds_read_b64_tr_b16 v[192:193], v24 offset:8192
    ds_read_b64_tr_b16 v[194:195], v24 offset:8448
    ds_read_b64_tr_b16 v[196:197], v24 offset:8704
    ds_read_b64_tr_b16 v[198:199], v24 offset:8960
    ds_read_b64_tr_b16 v[200:201], v24 offset:8224
    ds_read_b64_tr_b16 v[202:203], v24 offset:8480
    ds_read_b64_tr_b16 v[204:205], v24 offset:8736
    ds_read_b64_tr_b16 v[206:207], v24 offset:8992
    s_waitcnt lgkmcnt(0)
    ds_read_b64_tr_b16 v[240:241], v24 offset:12288
    ds_read_b64_tr_b16 v[242:243], v24 offset:12544
    ds_read_b64_tr_b16 v[244:245], v24 offset:12800
    ds_read_b64_tr_b16 v[246:247], v24 offset:13056
    ds_read_b64_tr_b16 v[248:249], v24 offset:12320
    ds_read_b64_tr_b16 v[250:251], v24 offset:12576
    ds_read_b64_tr_b16 v[252:253], v24 offset:12832
    ds_read_b64_tr_b16 v[254:255], v24 offset:13088
    s_waitcnt lgkmcnt(0)
    v_mov_b32 v21, 0x44444444
    v_mov_b32 v22, 0xeeeeeeee
    v_and_b32 v23, 1, v20
    v_cmp_eq_u32 vcc, 0, v23
    v_and_b32 v27, 255, v0
    v_lshlrev_b32 v2, 2, v27
    v_cndmask_b32 v62, v22, v21, vcc
    s_lshr_b32 s21, s15, 1
    s_sub_u32 s21, s21, s15
    s_add_u32 s21, s21, 4
    s_lshl_b32 s21, s21, 10
    s_and_b32 s22, s15, 1
    s_lshl_b32 s22, s22, 9
    s_add_u32 s21, s21, s22
    s_mov_b32 s28, s21
    s_and_b32 s62, s12, 1
    s_lshl_b32 s62, s62, 9
    s_add_u32 s62, s62, s36
    s_sub_u32 s62, s62, 512
    s_lshl_b32 s22, s3, 7
    s_add_u32 s21, s21, s22
    v_and_b32 v21, 31, v20
    v_lshlrev_b32 v21, 2, v21
    v_add_u32 v3, s21, v21
    v_lshrrev_b32 v21, 4, v20
    v_and_b32 v22, 15, v20
    v_mul_u32_u24 v21, 208, v21
    v_add_lshl_u32 v21, v21, v22, 2
    s_mul_i32 s21, s3, 3328
    v_add_u32 v4, s21, v21
    v_lshrrev_b32 v21, 4, v20
    v_bfe_u32 v22, v20, 2, 1
    v_lshl_add_u32 v21, v21, 1, v22
    v_mul_u32_u24 v21, 104, v21
    v_bfe_u32 v22, v20, 3, 1
    v_xor_b32 v22, 1, v22
    v_lshl_add_u32 v21, v22, 5, v21
    v_and_b32 v22, 3, v20
    v_lshlrev_b32 v22, 1, v22
    s_and_b32 s21, s3, 1
    s_lshl_b32 s21, s21, 2
    v_xor_b32 v22, s21, v22
    v_add_u32 v21, v21, v22
    s_lshl_b32 s21, s3, 3
    v_add_u32 v21, s21, v21
    v_lshlrev_b32 v5, 2, v21
    s_and_b32 s21, s3, 1
    s_lshl_b32 s21, s21, 2
    v_bfe_u32 v21, v20, 3, 2
    v_add_u32 v21, s21, v21
    v_mul_u32_u24 v21, 104, v21
    v_bfe_u32 v22, v20, 1, 1
    v_lshl_add_u32 v21, v22, 3, v21
    v_and_b32 v23, 1, v20
    v_xor_b32 v22, v22, v23
    v_lshl_add_u32 v21, v22, 2, v21
    v_bfe_u32 v22, v20, 2, 1
    v_lshl_add_u32 v21, v22, 1, v21
    s_lshr_b32 s21, s3, 1
    s_lshl_b32 s21, s21, 4
    s_add_u32 s21, s21, 64
    v_add_u32 v21, s21, v21
    v_lshlrev_b32 v6, 2, v21
    v_lshrrev_b32 v21, 6, v27
    v_bfe_u32 v22, v27, 1, 1
    v_lshrrev_b32 v23, 1, v21
    v_lshl_add_u32 v22, v22, 1, v23
    v_xor_b32 v23, v27, v22
    v_and_b32 v23, 1, v23
    v_and_b32 v21, 1, v21
    v_lshl_add_u32 v21, v21, 1, v23
    v_mul_u32_u24 v21, 544, v21
    v_lshl_add_u32 v21, v22, 5, v21
    v_bfe_u32 v23, v27, 4, 2
    v_mul_u32_u24 v23, 136, v23
    v_add_u32 v21, v21, v23
    v_bfe_u32 v24, v27, 3, 1
    v_lshl_add_u32 v21, v24, 2, v21
    v_bfe_u32 v24, v27, 2, 1
    v_lshl_add_u32 v21, v24, 4, v21
    v_add_u32 v7, 16384, v21
    v_lshlrev_b32 v8, 2, v20
    s_and_b32 s21, s12, 1
    s_lshl_b32 s21, s21, 9
    s_lshl_b32 s22, s3, 7
    s_add_u32 s21, s21, s22
    v_and_b32 v21, 7, v20
    v_lshlrev_b32 v21, 4, v21
    v_add_u32 v21, s21, v21
    v_lshrrev_b32 v22, 3, v20
    v_lshl_add_u32 v12, v22, 10, v21
    v_bfe_u32 v22, v20, 4, 1
    v_lshl_add_u32 v13, v22, 3, v21
    s_and_b32 s21, s3, 1
    s_lshl_b32 s21, s21, 12
    s_lshr_b32 s22, s3, 1
    s_lshl_b32 s22, s22, 11
    s_add_u32 s21, s21, s22
    s_add_u32 s21, s21, 18560
    v_add_u32 v61, s21, v1
    s_lshl_b32 s21, s3, 2
    s_add_u32 s21, s21, 13312
    v_mov_b32 v14, s21
    v_and_b32 v21, 15, v20
    v_and_b32 v22, 1, v20
    v_lshlrev_b32 v22, 4, v22
    v_mov_b32 v23, 0x3f80
    v_lshlrev_b32 v22, v22, v23
    v_lshrrev_b32 v21, 1, v21
    v_cmp_eq_u32 vcc, 0, v21
    s_nop 1
    v_cndmask_b32 v56, 0, v22, vcc
    v_cmp_eq_u32 vcc, 1, v21
    s_nop 1
    v_cndmask_b32 v57, 0, v22, vcc
    v_cmp_eq_u32 vcc, 2, v21
    s_nop 1
    v_cndmask_b32 v58, 0, v22, vcc
    v_cmp_eq_u32 vcc, 3, v21
    s_nop 1
    v_cndmask_b32 v59, 0, v22, vcc
    v_and_b32 v21, 7, v20
    v_lshlrev_b32 v21, 7, v21
    v_bfe_u32 v22, v20, 3, 1
    v_lshl_add_u32 v21, v22, 17, v21
    s_lshl_b32 s21, s12, 14
    s_lshl_b32 s22, s13, 10
    s_add_u32 s21, s21, s22
    s_add_u32 s21, s21, 4718592
    v_lshrrev_b32 v22, 4, v20
    v_lshl_add_u32 v21, v22, 24, v21
    v_add_u32 v63, s21, v21
    s_mov_b32 s47, 0x3e0293ee
    s_lshl_b32 s14, s12, 2
    s_add_u32 s14, s14, s3
    s_lshl_b32 s61, s14, 13
    s_add_u32 s61, s61, 2097152
    s_lshl_b32 s14, s14, 12
    s_and_b32 s22, s13, 1
    s_lshl_b32 s69, s22, 17
    s_add_u32 s69, s69, s14
    s_add_u32 s69, s69, 4194304
    s_add_u32 s52, s14, 20971520
    s_lshl_b32 s21, s22, 11
    s_add_u32 s14, s14, s21
    s_add_u32 s14, s14, 1179648
    s_lshr_b32 s21, s13, 1
    s_sub_u32 s21, s21, 0
    s_cmp_eq_u32 s21, s3
    s_cselect_b32 s15, 1, 0
    s_add_u32 s23, s3, 3
    s_and_b32 s23, s23, 3
    s_cmp_eq_u32 s21, s23
    s_cselect_b32 s31, 1, 0
    s_and_b32 s24, s23, 1
    s_and_b32 s25, s3, 1
    s_sub_i32 s24, s24, s25
    s_lshr_b32 s23, s23, 1
    s_lshr_b32 s25, s3, 1
    s_sub_i32 s23, s23, s25
    s_mul_i32 s46, s24, 4096
    s_mul_i32 s25, s23, 2048
    s_add_i32 s46, s46, s25
    s_mul_i32 s27, s24, 32768
    s_mul_i32 s25, s23, 1024
    s_add_i32 s27, s27, s25
    v_lshrrev_b32 v21, 4, v20
    v_and_b32 v23, 15, v20
    v_lshlrev_b32 v21, 2, v21
    v_add_u32 v24, 0, v21
    v_cmp_gt_u32 vcc, v24, v23
    s_cmp_eq_u32 s22, 0
    s_cselect_b64 s[38:39], vcc, 0
    s_cselect_b64 s[48:49], -1, vcc
    v_add_u32 v24, 1, v21
    v_cmp_gt_u32 vcc, v24, v23
    s_cmp_eq_u32 s22, 0
    s_cselect_b64 s[40:41], vcc, 0
    s_cselect_b64 s[50:51], -1, vcc
    v_add_u32 v24, 2, v21
    v_cmp_gt_u32 vcc, v24, v23
    s_cmp_eq_u32 s22, 0
    s_cselect_b64 s[42:43], vcc, 0
    s_cselect_b64 s[54:55], -1, vcc
    v_add_u32 v24, 3, v21
    v_cmp_gt_u32 vcc, v24, v23
    s_cmp_eq_u32 s22, 0
    s_cselect_b64 s[44:45], vcc, 0
    s_cselect_b64 s[56:57], -1, vcc
    s_waitcnt vmcnt(0)
    v_mov_b32 v16, v32
    v_mov_b32 v17, v33
    v_mov_b32 v18, v34
    v_mov_b32 v19, v35
    v_mov_b32 v20, v36
    v_mov_b32 v21, v37
    v_mov_b32 v22, v38
    v_mov_b32 v23, v39
    v_mov_b32 v24, v40
    v_mov_b32 v25, v41
    v_mov_b32 v26, v42
    v_mov_b32 v27, v43
    v_mov_b32 v28, v44
    v_mov_b32 v29, v45
    v_mov_b32 v30, v46
    v_mov_b32 v31, v47
    v_mov_b32 v32, -1
    v_mov_b32 v33, -1
    v_mov_b32 v34, -1
    v_mov_b32 v35, -1
    s_add_u32 s21, s37, 3997696
    buffer_store_dwordx4 v[32:35], v1, s[4:7], s21 offen sc1
    s_add_u32 s21, s37, 4063232
    buffer_store_dwordx4 v[32:35], v1, s[4:7], s21 offen sc1
    s_add_u32 s21, s37, 4128768
    buffer_store_dwordx4 v[32:35], v1, s[4:7], s21 offen sc1
    s_lshl_b32 s29, s29, 5
    s_barrier
    ds_write_b32 v14, v10
    ds_write_b32 v14, v10 offset:16
    ds_write_b32 v14, v10 offset:32
    s_lshl_b32 s53, s3, 13
    s_add_u32 s53, s53, 92160
    v_add_u32 v32, 14336, v1
    ds_write_b128 v32, v[56:59]
    s_lshl_b32 s60, s12, 4
    s_add_u32 s60, s60, 218104320
    v_mov_b32 v15, 0
    s_add_u32 s25, s16, 0
    s_min_u32 s25, s25, 63
    s_cmp_lt_u32 s25, 8
    s_cselect_b32 s59, 12, 24
    s_cselect_b32 s58, -4, -8
    s_and_b32 s25, s25, s58
    s_lshl_b32 s25, s25, 5
    s_add_u32 s58, s25, s60
    v_mov_b32 v32, 131072
    s_waitcnt vmcnt(0) lgkmcnt(0)
    s_barrier
    ds_read_b64 v[32:33], v32
    s_waitcnt lgkmcnt(0)
    v_cmp_ne_u32 vcc, s29, v32
    s_setprio 3
    v_readfirstlane_b32 s63, v33
    s_add_u32 s34, s34, s63
    s_add_u32 s35, s35, s63
    s_cbranch_vccnz ch_p_slow
    v_mov_b32 v32, 0
    v_mov_b32 v33, 0
    v_mov_b32 v34, 0
    v_mov_b32 v35, 0
    v_mov_b32 v36, 0
    v_mov_b32 v37, 0
    v_mov_b32 v38, 0
    v_mov_b32 v39, 0
    v_mov_b32 v40, 0
    v_mov_b32 v41, 0
    v_mov_b32 v42, 0
    v_mov_b32 v43, 0
    v_mov_b32 v44, 0
    v_mov_b32 v45, 0
    v_mov_b32 v46, 0
    v_mov_b32 v47, 0
    v_mov_b32 v48, 0
    v_mov_b32 v49, 0
    v_mov_b32 v50, 0
    v_mov_b32 v51, 0
    v_mov_b32 v52, 0
    v_mov_b32 v53, 0
    v_mov_b32 v54, 0
    v_mov_b32 v55, 0
    v_mov_b32 v0, 1.0
    s_mov_b32 exec_lo, 0xff00ff00
    s_mov_b32 exec_hi, 0xff00ff00
    v_mov_b32 v0, s47
    s_mov_b64 exec, -1
    v_mov_b32 v60, s16
    v_smfmac_f32_16x16x64_bf16 v[32:35], v[16:19], v[64:71], v62
    v_smfmac_f32_16x16x64_bf16 v[36:39], v[16:19], v[72:79], v62
    v_smfmac_f32_16x16x64_bf16 v[40:43], v[16:19], v[80:87], v62
    v_smfmac_f32_16x16x64_bf16 v[44:47], v[16:19], v[88:95], v62
    v_smfmac_f32_16x16x64_bf16 v[48:51], v[16:19], v[96:103], v62
    v_smfmac_f32_16x16x64_bf16 v[52:55], v[16:19], v[104:111], v62
    v_smfmac_f32_16x16x64_bf16 v[32:35], v[20:23], v[112:119], v62
    v_smfmac_f32_16x16x64_bf16 v[36:39], v[20:23], v[120:127], v62
    v_smfmac_f32_16x16x64_bf16 v[40:43], v[20:23], v[128:135], v62
    v_smfmac_f32_16x16x64_bf16 v[44:47], v[20:23], v[136:143], v62
    v_smfmac_f32_16x16x64_bf16 v[48:51], v[20:23], v[144:151], v62
    v_smfmac_f32_16x16x64_bf16 v[52:55], v[20:23], v[152:159], v62
    v_smfmac_f32_16x16x64_bf16 v[32:35], v[24:27], v[160:167], v62
    v_smfmac_f32_16x16x64_bf16 v[36:39], v[24:27], v[168:175], v62
    v_smfmac_f32_16x16x64_bf16 v[40:43], v[24:27], v[176:183], v62
    v_smfmac_f32_16x16x64_bf16 v[44:47], v[24:27], v[184:191], v62
    v_smfmac_f32_16x16x64_bf16 v[48:51], v[24:27], v[192:199], v62
    v_smfmac_f32_16x16x64_bf16 v[52:55], v[24:27], v[200:207], v62
    v_smfmac_f32_16x16x64_bf16 v[32:35], v[28:31], v[208:215], v62
    ds_write_b32 v14, v60
    v_smfmac_f32_16x16x64_bf16 v[36:39], v[28:31], v[216:223], v62
    v_smfmac_f32_16x16x64_bf16 v[40:43], v[28:31], v[224:231], v62
    v_smfmac_f32_16x16x64_bf16 v[44:47], v[28:31], v[232:239], v62
    v_add_f32 v32, v32, v33
    v_add_f32 v34, v34, v35
    v_smfmac_f32_16x16x64_bf16 v[48:51], v[28:31], v[240:247], v62
    v_add_f32 v36, v36, v37
    v_add_f32 v38, v38, v39
    ds_write2_b32 v4, v32, v34 offset0:0 offset1:104
    v_smfmac_f32_16x16x64_bf16 v[52:55], v[28:31], v[248:255], v62
    v_add_f32 v40, v40, v41
    v_add_f32 v42, v42, v43
    ds_write2_b32 v4, v36, v38 offset0:16 offset1:120
    v_add_f32 v44, v44, v45
    v_add_f32 v46, v46, v47
    ds_write2_b32 v4, v40, v42 offset0:32 offset1:136
    v_add_f32 v48, v48, v49
    v_add_f32 v50, v50, v51
    ds_write2_b32 v4, v44, v46 offset0:48 offset1:152
    v_add_f32 v52, v52, v53
    v_add_f32 v54, v54, v55
    ds_write2_b32 v4, v48, v50 offset0:64 offset1:168
    ds_write2_b32 v4, v52, v54 offset0:80 offset1:184
    s_waitcnt vmcnt(0)
    s_branch pnc_7_done
.p2align 6
    s_nop 0
    s_nop 0
    s_nop 0
    s_nop 0
    s_nop 0
    s_nop 0
    s_nop 0
    s_nop 0
ploop_6:
    s_add_u32 s21, s17, s33
    s_nop 15
    s_nop 5
    buffer_load_dwordx4 v[16:19], v1, s[4:7], s21 offen offset:0 sc1
    s_nop 7
    buffer_load_dwordx4 v[20:23], v1, s[4:7], s21 offen offset:1024 sc1
    s_nop 7
    buffer_load_dwordx4 v[24:27], v1, s[4:7], s21 offen offset:2048 sc1
    s_nop 7
    buffer_load_dwordx4 v[28:31], v1, s[4:7], s21 offen offset:3072 sc1
    s_waitcnt vmcnt(3)
    v_max3_u32 v9, v16, v17, v18
    v_max_u32 v9, v9, v19
    v_cmp_eq_u32 vcc, -1, v9
    s_cbranch_vccnz prm_9_0
prm_9_0ok:
    v_smfmac_f32_16x16x64_bf16 v[32:35], v[16:19], v[64:71], v62
    v_smfmac_f32_16x16x64_bf16 v[36:39], v[16:19], v[72:79], v62
    v_smfmac_f32_16x16x64_bf16 v[40:43], v[16:19], v[80:87], v62
    s_waitcnt vmcnt(2)
    v_max3_u32 v9, v20, v21, v22
    v_max_u32 v9, v9, v23
    v_cmp_eq_u32 vcc, -1, v9
    v_smfmac_f32_16x16x64_bf16 v[44:47], v[16:19], v[88:95], v62
    v_smfmac_f32_16x16x64_bf16 v[48:51], v[16:19], v[96:103], v62
    v_smfmac_f32_16x16x64_bf16 v[52:55], v[16:19], v[104:111], v62
    s_cbranch_vccnz prm_9_1
prm_9_1ok:
    v_smfmac_f32_16x16x64_bf16 v[32:35], v[20:23], v[112:119], v62
    v_readfirstlane_b32 s23, v15
    v_smfmac_f32_16x16x64_bf16 v[36:39], v[20:23], v[120:127], v62
    v_smfmac_f32_16x16x64_bf16 v[40:43], v[20:23], v[128:135], v62
    s_waitcnt vmcnt(1)
    v_max3_u32 v9, v24, v25, v26
    v_max_u32 v9, v9, v27
    v_cmp_eq_u32 vcc, -1, v9
    v_smfmac_f32_16x16x64_bf16 v[44:47], v[20:23], v[136:143], v62
    v_smfmac_f32_16x16x64_bf16 v[48:51], v[20:23], v[144:151], v62
    v_smfmac_f32_16x16x64_bf16 v[52:55], v[20:23], v[152:159], v62
    s_cbranch_vccnz prm_9_2
prm_9_2ok:
    v_smfmac_f32_16x16x64_bf16 v[32:35], v[24:27], v[160:167], v62
    v_smfmac_f32_16x16x64_bf16 v[36:39], v[24:27], v[168:175], v62
    v_smfmac_f32_16x16x64_bf16 v[40:43], v[24:27], v[176:183], v62
    s_waitcnt vmcnt(0)
    v_max3_u32 v9, v28, v29, v30
    v_max_u32 v9, v9, v31
    v_cmp_eq_u32 vcc, -1, v9
    v_smfmac_f32_16x16x64_bf16 v[44:47], v[24:27], v[184:191], v62
    v_smfmac_f32_16x16x64_bf16 v[48:51], v[24:27], v[192:199], v62
    v_smfmac_f32_16x16x64_bf16 v[52:55], v[24:27], v[200:207], v62
    s_cbranch_vccnz prm_9_3
prm_9_3ok:
    v_smfmac_f32_16x16x64_bf16 v[32:35], v[28:31], v[208:215], v62
    s_cmp_lt_u32 s23, s59
    s_cbranch_scc1 prm_9_gt
prm_9_gtb:
    ds_write_b32 v14, v60
    v_smfmac_f32_16x16x64_bf16 v[36:39], v[28:31], v[216:223], v62
    v_smfmac_f32_16x16x64_bf16 v[40:43], v[28:31], v[224:231], v62
    v_smfmac_f32_16x16x64_bf16 v[44:47], v[28:31], v[232:239], v62
    v_add_f32 v32, v32, v33
    v_add_f32 v34, v34, v35
    v_smfmac_f32_16x16x64_bf16 v[48:51], v[28:31], v[240:247], v62
    v_add_f32 v36, v36, v37
    v_add_f32 v38, v38, v39
    ds_write2_b32 v4, v32, v34 offset0:0 offset1:104
    v_smfmac_f32_16x16x64_bf16 v[52:55], v[28:31], v[248:255], v62
    v_add_f32 v40, v40, v41
    v_add_f32 v42, v42, v43
    ds_write2_b32 v4, v36, v38 offset0:16 offset1:120
    v_add_f32 v44, v44, v45
    v_add_f32 v46, v46, v47
    ds_write2_b32 v4, v40, v42 offset0:32 offset1:136
    v_add_f32 v48, v48, v49
    v_add_f32 v50, v50, v51
    ds_write2_b32 v4, v44, v46 offset0:48 offset1:152
    v_add_f32 v52, v52, v53
    v_add_f32 v54, v54, v55
    ds_write2_b32 v4, v48, v50 offset0:64 offset1:168
    ds_write2_b32 v4, v52, v54 offset0:80 offset1:184
pnc_7_done:
    s_add_u32 s21, s17, s32
    s_add_u32 s22, s19, s32
    s_add_u32 s24, s19, s35
    s_waitcnt lgkmcnt(0)
    s_barrier
    ds_read_b64 v[32:33], v5 offset:0
    ds_read_b64 v[34:35], v5 offset:3328
    ds_read_b64 v[36:37], v5 offset:6656
    ds_read_b64 v[38:39], v5 offset:9984
    ds_read_b64 v[40:41], v6 offset:0
    ds_read_b64 v[42:43], v6 offset:3328
    ds_read_b64 v[44:45], v6 offset:6656
    ds_read_b64 v[46:47], v6 offset:9984
    s_waitcnt lgkmcnt(6)
    v_add_f32 v32, v32, v34
    v_add_f32 v33, v33, v35
    v_mul_f32 v32, v32, v0
    v_mul_f32 v33, v33, v0
    s_waitcnt lgkmcnt(4)
    v_add_f32 v36, v36, v38
    v_add_f32 v37, v37, v39
    v_fma_f32 v32, v36, v0, v32
    v_fma_f32 v33, v37, v0, v33
    v_cvt_pk_bf16_f32 v32, v32, v33
    v_min_u32 v32, -2, v32
    buffer_store_dword v32, v2, s[4:7], s21 offen
    s_waitcnt lgkmcnt(2)
    v_add_f32 v40, v40, v42
    v_add_f32 v41, v41, v43
    s_waitcnt lgkmcnt(0)
    v_add_f32 v44, v44, v46
    v_add_f32 v45, v45, v47
    v_add_f32 v40, v40, v44
    v_add_f32 v41, v41, v45
    v_cvt_pk_bf16_f32 v40, v40, v41
    v_min_u32 v40, -2, v40
    s_mov_b32 exec_hi, 0
    buffer_store_dword v40, v3, s[4:7], s21 offen
    s_setprio 0
    s_mov_b64 exec, -1
    s_add_u32 s21, s17, s35
    s_add_u32 s30, s17, s34
    s_add_u32 s23, s18, s36
    s_cmp_lg_u32 s16, 0
    s_cbranch_scc1 ploop_6_n0
gate_11:
    v_readfirstlane_b32 s25, v15
    s_cmp_ge_u32 s25, s59
    s_cbranch_scc1 gate_11_ok
    s_sleep 8
    buffer_load_dword v15, off, s[4:7], s58 sc1
    s_waitcnt vmcnt(0)
    s_sub_u32 s26, s26, 1
    s_cbranch_scc0 gate_11
    s_mov_b32 s26, 0
gate_11_ok:
    s_cmp_eq_u32 s15, 0
    s_cbranch_scc1 ploop_6_st_nk
    s_add_u32 m0, s53, 0
    s_add_u32 s22, s52, 0
    buffer_load_dwordx4 v1, s[4:7], s22 offen offset:0 sc1 lds
    buffer_load_dwordx4 v1, s[4:7], s22 offen offset:1024 sc1 lds
    buffer_load_dwordx4 v1, s[4:7], s22 offen offset:2048 sc1 lds
    buffer_load_dwordx4 v1, s[4:7], s22 offen offset:3072 sc1 lds
    s_add_u32 m0, s53, 4096
    s_add_u32 s22, s52, 131072
    buffer_load_dwordx4 v1, s[4:7], s22 offen offset:0 sc1 lds
    buffer_load_dwordx4 v1, s[4:7], s22 offen offset:1024 sc1 lds
    buffer_load_dwordx4 v1, s[4:7], s22 offen offset:2048 sc1 lds
    buffer_load_dwordx4 v1, s[4:7], s22 offen offset:3072 sc1 lds
    s_add_u32 s52, s52, 262144
    s_sub_u32 s52, s52, 262144
ploop_6_st_nk:
    s_add_u32 s52, s52, 262144
    s_cmp_lg_u32 s3, 2
    s_cbranch_scc1 ploop_6_st_npf
    v_subrev_u32 v32, 524288, v63
    s_mov_b32 exec_hi, 0xffff
    s_mov_b32 s22, 262144
    buffer_load_dword v33, v32, s[4:7], s22 offen sc1
    s_mov_b32 exec_hi, -1
    s_waitcnt vmcnt(0)
ploop_6_st_npf:
    s_cmp_eq_u32 s15, 0
    s_cbranch_scc1 ploop_6_st_p_nd
    s_mov_b32 m0, 124928
    s_nop 0
    buffer_load_dwordx4 v1, s[4:7], s69 offen offset:0 sc1 lds
    buffer_load_dwordx4 v1, s[4:7], s69 offen offset:1024 sc1 lds
    buffer_load_dwordx4 v1, s[4:7], s69 offen offset:2048 sc1 lds
    buffer_load_dwordx4 v1, s[4:7], s69 offen offset:3072 sc1 lds
    s_add_u32 s69, s69, 262144
    s_waitcnt vmcnt(0)
ploop_6_st_p_nd:
ploop_6_n0:
    s_add_u32 s25, s16, 2
    s_min_u32 s25, s25, 63
    s_cmp_lt_u32 s25, 8
    s_cselect_b32 s59, 12, 24
    s_cselect_b32 s58, -4, -8
    s_and_b32 s25, s25, s58
    s_lshl_b32 s25, s25, 5
    s_add_u32 s58, s25, s60
    s_cmp_eq_u32 s15, 0
    s_cbranch_scc1 ploop_6_nd
    v_add_u32 v9, s53, v1
    v_add_u32 v0, 124928, v1
    ds_read_b128 v[16:19], v0 offset:0
    ds_read_b128 v[32:35], v9 offset:0
    ds_read_b128 v[20:23], v0 offset:1024
    ds_read_b128 v[36:39], v9 offset:1024
    ds_read_b128 v[24:27], v0 offset:2048
    ds_read_b128 v[40:43], v9 offset:2048
    ds_read_b128 v[28:31], v0 offset:3072
    ds_read_b128 v[44:47], v9 offset:3072
    s_add_u32 s22, s17, s61
    s_waitcnt lgkmcnt(6)
    v_mfma_f32_16x16x32_bf16 v[48:51], v[32:35], v[16:19], 0
    ds_read_b128 v[32:35], v9 offset:4096
    s_waitcnt lgkmcnt(5)
    v_mfma_f32_16x16x32_bf16 v[48:51], v[36:39], v[20:23], v[48:51]
    ds_read_b128 v[36:39], v9 offset:5120
    s_waitcnt lgkmcnt(4)
    v_mfma_f32_16x16x32_bf16 v[48:51], v[40:43], v[24:27], v[48:51]
    ds_read_b128 v[40:43], v9 offset:6144
    s_waitcnt lgkmcnt(3)
    v_mfma_f32_16x16x32_bf16 v[48:51], v[44:47], v[28:31], v[48:51]
    ds_read_b128 v[44:47], v9 offset:7168
    s_waitcnt lgkmcnt(3)
    v_mfma_f32_16x16x32_bf16 v[52:55], v[32:35], v[16:19], 0
    s_waitcnt lgkmcnt(2)
    v_mfma_f32_16x16x32_bf16 v[52:55], v[36:39], v[20:23], v[52:55]
    s_waitcnt lgkmcnt(1)
    v_mfma_f32_16x16x32_bf16 v[52:55], v[40:43], v[24:27], v[52:55]
    s_waitcnt lgkmcnt(0)
    v_mfma_f32_16x16x32_bf16 v[52:55], v[44:47], v[28:31], v[52:55]
    buffer_load_dwordx4 v[32:35], v1, s[4:7], s22 offen offset:0 sc1
    buffer_load_dwordx4 v[36:39], v1, s[4:7], s22 offen offset:1024 sc1
    buffer_load_dwordx4 v[40:43], v1, s[4:7], s22 offen offset:2048 sc1
    buffer_load_dwordx4 v[44:47], v1, s[4:7], s22 offen offset:3072 sc1
    v_mov_b32 v60, 0xff61b1e6
    s_nop 2
    v_cndmask_b32 v48, v48, v60, s[38:39]
    v_cndmask_b32 v49, v49, v60, s[40:41]
    v_cndmask_b32 v50, v50, v60, s[42:43]
    v_cndmask_b32 v51, v51, v60, s[44:45]
    v_cndmask_b32 v52, v52, v60, s[48:49]
    v_cndmask_b32 v53, v53, v60, s[50:51]
    v_cndmask_b32 v54, v54, v60, s[54:55]
    v_cndmask_b32 v55, v55, v60, s[56:57]
    v_max3_f32 v0, v48, v49, v50
    v_max3_f32 v9, v51, v52, v53
    v_max3_f32 v0, v0, v54, v55
    v_max_f32 v0, v0, v9
    v_mov_b32 v9, v0
    s_nop 1
    v_permlane16_swap_b32 v9, v0
    v_max_f32 v0, v0, v9
    v_mov_b32 v9, v0
    s_nop 1
    v_permlane32_swap_b32 v9, v0
    v_max_f32 v0, v0, v9
    v_mul_f32 v0, s47, v0
    v_fma_f32 v48, v48, s47, -v0
    v_fma_f32 v49, v49, s47, -v0
    v_fma_f32 v50, v50, s47, -v0
    v_fma_f32 v51, v51, s47, -v0
    v_fma_f32 v52, v52, s47, -v0
    v_fma_f32 v53, v53, s47, -v0
    v_fma_f32 v54, v54, s47, -v0
    v_fma_f32 v55, v55, s47, -v0
    v_exp_f32 v48, v48
    v_exp_f32 v49, v49
    v_exp_f32 v50, v50
    v_exp_f32 v51, v51
    v_exp_f32 v52, v52
    v_exp_f32 v53, v53
    v_exp_f32 v54, v54
    v_exp_f32 v55, v55
    v_add_f32 v15, v48, v49
    v_add_f32 v15, v15, v50
    v_add_f32 v15, v15, v51
    v_add_f32 v15, v15, v52
    v_add_f32 v15, v15, v53
    v_add_f32 v15, v15, v54
    v_add_f32 v15, v15, v55
ploop_6_za:
    s_waitcnt vmcnt(0)
    v_max3_u32 v9, v32, v33, v34
    v_max3_u32 v9, v9, v35, v36
    v_max3_u32 v9, v9, v37, v38
    v_max3_u32 v9, v9, v39, v40
    v_max3_u32 v9, v9, v41, v42
    v_max3_u32 v9, v9, v43, v44
    v_max3_u32 v9, v9, v45, v46
    v_max_u32 v9, v9, v47
    v_cmp_eq_u32 vcc, -1, v9
    s_cbranch_vccnz ploop_6_zr
ploop_6_zok:
    s_setprio 1
    v_mfma_f32_16x16x32_bf16 v[56:59], v[32:35], v[16:19], 0
    v_mfma_f32_16x16x32_bf16 v[56:59], v[36:39], v[20:23], v[56:59]
    v_mfma_f32_16x16x32_bf16 v[56:59], v[40:43], v[24:27], v[56:59]
    v_mfma_f32_16x16x32_bf16 v[56:59], v[44:47], v[28:31], v[56:59]
    s_add_u32 s22, s17, s14
    s_nop 6
    v_max_f32 v60, v56, v57
    v_mov_b32 v9, v60
    s_nop 1
    v_permlane16_swap_b32 v9, v60
    v_max_f32 v60, v60, v9
    v_mov_b32 v9, v60
    s_nop 1
    v_permlane32_swap_b32 v9, v60
    v_max_f32 v60, v60, v9
    v_mul_f32 v60, s47, v60
    v_max_f32 v58, v60, v0
    v_sub_f32 v60, v0, v58
    v_fma_f32 v56, v56, s47, -v58
    v_fma_f32 v57, v57, s47, -v58
    v_exp_f32 v60, v60
    v_exp_f32 v56, v56
    v_exp_f32 v57, v57
    v_fma_f32 v15, v15, v60, v56
    v_add_f32 v15, v15, v57
    v_mov_b32 v9, v15
    s_nop 1
    v_permlane16_swap_b32 v9, v15
    v_add_f32 v15, v15, v9
    v_mov_b32 v9, v15
    s_nop 1
    v_permlane32_swap_b32 v9, v15
    v_add_f32 v15, v15, v9
    v_rcp_f32 v15, v15
    s_add_u32 s25, s19, s14
    v_mul_f32 v56, v56, v15
    v_mul_f32 v57, v57, v15
    v_mul_f32 v60, v60, v15
    v_mul_f32 v48, v48, v60
    v_mul_f32 v49, v49, v60
    v_mul_f32 v50, v50, v60
    v_mul_f32 v51, v51, v60
    v_mul_f32 v52, v52, v60
    v_mul_f32 v53, v53, v60
    v_mul_f32 v54, v54, v60
    v_mul_f32 v55, v55, v60
    v_cvt_pk_bf16_f32 v48, v48, v49
    v_cvt_pk_bf16_f32 v49, v50, v51
    v_cvt_pk_bf16_f32 v50, v52, v53
    v_cvt_pk_bf16_f32 v51, v54, v55
    v_min_u32 v48, -2, v48
    v_min_u32 v49, -2, v49
    v_min_u32 v50, -2, v50
    v_min_u32 v51, -2, v51
    v_lshlrev_b32 v54, 1, v8
    v_add_u32 v55, 14336, v1
    v_mov_b32 v53, 1.0
    v_cvt_pk_bf16_f32 v52, v56, v57
    v_min_u32 v53, -2, v53
    v_min_u32 v52, -2, v52
    buffer_store_dwordx4 v[48:51], v1, s[4:7], s22 offen
    buffer_store_dwordx2 v[52:53], v54, s[4:7], s22 offen offset:1024
    ds_read_b128 v[56:59], v55
    s_branch ploop_6_nd2
ploop_6_nd:
    s_cmp_eq_u32 s16, 0
    s_cbranch_scc1 ploop_6_ns
    s_cmp_eq_u32 s31, 0
    s_cbranch_scc1 ploop_6_n2
    s_add_u32 s25, s68, s46
    v_add_u32 v55, s25, v61
    ds_read_b128 v[24:27], v55 offset:0
    ds_read_b128 v[28:31], v55 offset:1024
    ds_read_b128 v[32:35], v55 offset:18560
    ds_read_b128 v[36:39], v55 offset:19584
    ds_read_b128 v[40:43], v55 offset:37120
    ds_read_b128 v[44:47], v55 offset:38144
    ds_read_b128 v[48:51], v55 offset:55680
    ds_read_b128 v[52:55], v55 offset:56704
    s_waitcnt lgkmcnt(4)
    v_add_f32 v24, v24, v32
    v_add_f32 v25, v25, v33
    v_add_f32 v26, v26, v34
    v_add_f32 v27, v27, v35
    v_add_f32 v28, v28, v36
    v_add_f32 v29, v29, v37
    v_add_f32 v30, v30, v38
    v_add_f32 v31, v31, v39
    s_waitcnt lgkmcnt(0)
    v_add_f32 v40, v40, v48
    v_add_f32 v41, v41, v49
    v_add_f32 v42, v42, v50
    v_add_f32 v43, v43, v51
    v_add_f32 v44, v44, v52
    v_add_f32 v45, v45, v53
    v_add_f32 v46, v46, v54
    v_add_f32 v47, v47, v55
    v_add_f32 v24, v24, v40
    v_add_f32 v25, v25, v41
    v_add_f32 v26, v26, v42
    v_add_f32 v27, v27, v43
    v_add_f32 v28, v28, v44
    v_add_f32 v29, v29, v45
    v_add_f32 v30, v30, v46
    v_add_f32 v31, v31, v47
    v_cvt_pk_bf16_f32 v24, v24, v25
    v_cvt_pk_bf16_f32 v25, v26, v27
    v_cvt_pk_bf16_f32 v26, v28, v29
    v_cvt_pk_bf16_f32 v27, v30, v31
    v_min_u32 v24, -2, v24
    v_min_u32 v25, -2, v25
    v_min_u32 v26, -2, v26
    v_min_u32 v27, -2, v27
    v_mov_b32 v16, v24
    v_mov_b32 v17, v25
    v_mov_b32 v18, v26
    v_mov_b32 v19, v27
ploop_6_n2:
    v_add_u32 v55, s68, v61
    ds_read_b128 v[24:27], v55 offset:0
    ds_read_b128 v[28:31], v55 offset:1024
    ds_read_b128 v[32:35], v55 offset:18560
    ds_read_b128 v[36:39], v55 offset:19584
    ds_read_b128 v[40:43], v55 offset:37120
    ds_read_b128 v[44:47], v55 offset:38144
    ds_read_b128 v[48:51], v55 offset:55680
    ds_read_b128 v[52:55], v55 offset:56704
    s_waitcnt lgkmcnt(4)
    v_add_f32 v24, v24, v32
    v_add_f32 v25, v25, v33
    v_add_f32 v26, v26, v34
    v_add_f32 v27, v27, v35
    v_add_f32 v28, v28, v36
    v_add_f32 v29, v29, v37
    v_add_f32 v30, v30, v38
    v_add_f32 v31, v31, v39
    s_waitcnt lgkmcnt(0)
    v_add_f32 v40, v40, v48
    v_add_f32 v41, v41, v49
    v_add_f32 v42, v42, v50
    v_add_f32 v43, v43, v51
    v_add_f32 v44, v44, v52
    v_add_f32 v45, v45, v53
    v_add_f32 v46, v46, v54
    v_add_f32 v47, v47, v55
    v_add_f32 v24, v24, v40
    v_add_f32 v25, v25, v41
    v_add_f32 v26, v26, v42
    v_add_f32 v27, v27, v43
    v_add_f32 v28, v28, v44
    v_add_f32 v29, v29, v45
    v_add_f32 v30, v30, v46
    v_add_f32 v31, v31, v47
    v_cvt_pk_bf16_f32 v24, v24, v25
    v_cvt_pk_bf16_f32 v25, v26, v27
    v_cvt_pk_bf16_f32 v26, v28, v29
    v_cvt_pk_bf16_f32 v27, v30, v31
    v_min_u32 v24, -2, v24
    v_min_u32 v25, -2, v25
    v_min_u32 v26, -2, v26
    v_min_u32 v27, -2, v27
ploop_6_ns:
ploop_6_flag:
    ds_read_b32 v9, v14 offset:16
    s_waitcnt lgkmcnt(0)
    v_readfirstlane_b32 s25, v9
    s_cmp_eq_u32 s25, s16
    s_cbranch_scc0 ploop_6_flag
    s_add_u32 m0, s53, 0
    s_add_u32 s22, s52, 0
    buffer_load_dwordx4 v1, s[4:7], s22 offen offset:0 sc1 lds
    buffer_load_dwordx4 v1, s[4:7], s22 offen offset:1024 sc1 lds
    buffer_load_dwordx4 v1, s[4:7], s22 offen offset:2048 sc1 lds
    buffer_load_dwordx4 v1, s[4:7], s22 offen offset:3072 sc1 lds
    s_add_u32 m0, s53, 4096
    s_add_u32 s22, s52, 131072
    buffer_load_dwordx4 v1, s[4:7], s22 offen offset:0 sc1 lds
    buffer_load_dwordx4 v1, s[4:7], s22 offen offset:1024 sc1 lds
    buffer_load_dwordx4 v1, s[4:7], s22 offen offset:2048 sc1 lds
    buffer_load_dwordx4 v1, s[4:7], s22 offen offset:3072 sc1 lds
    s_add_u32 s52, s52, 262144
ploop_6_nk:
    s_cmp_eq_u32 s16, 0
    s_cbranch_scc1 ploop_6_nd2
    buffer_store_dwordx4 v[24:27], v1, s[4:7], s37 offen sc1
    s_cmp_eq_u32 s31, 0
    s_cbranch_scc1 ploop_6_nd2
    s_add_u32 s25, s37, s27
    buffer_store_dwordx4 v[16:19], v1, s[4:7], s25 offen sc1
ploop_6_nd2:
    s_cmp_eq_u32 s16, 0
    s_cbranch_scc1 ploop_6_nn
    s_add_u32 s37, s37, 65536
    s_xor_b32 s68, s68, 8192
ploop_6_nn:
    s_cmp_lg_u32 s3, 2
    s_cbranch_scc1 ppf_12
    s_lshl_b32 s22, s16, 18
    s_mov_b32 exec_hi, 0xffff
    buffer_load_dword v9, v63, s[4:7], s22 offen sc1
    s_mov_b32 exec_hi, -1
ppf_12:
    v_add_u32 v24, 18560, v7
    v_add_u32 v25, 37120, v7
    v_add_u32 v26, 55680, v7
    s_cmp_eq_u32 s16, 63
    s_setprio 3
    s_barrier
    s_cbranch_scc1 ptail_8
    ds_read2_b32 v[16:17], v7 offset0:0 offset1:2
    ds_read2_b32 v[18:19], v24 offset0:0 offset1:2
    ds_read2_b32 v[20:21], v25 offset0:0 offset1:2
    ds_read2_b32 v[22:23], v26 offset0:0 offset1:2
    s_waitcnt lgkmcnt(2)
    v_add_f32 v16, v16, v18
    v_add_f32 v17, v17, v19
    s_waitcnt lgkmcnt(0)
    v_add_f32 v20, v20, v22
    v_add_f32 v21, v21, v23
    v_add_f32 v16, v16, v20
    v_add_f32 v17, v17, v21
    v_cvt_pk_bf16_f32 v16, v16, v17
    v_min_u32 v16, -2, v16
    buffer_store_dword v16, v2, s[4:7], s21 offen sc1
    buffer_store_dword v10, v2, s[4:7], s24 offen sc1
    s_cmp_eq_u32 s15, 0
    s_cbranch_scc1 ploop_6_pnd
    s_sleep 6
    s_nop 8
    buffer_load_dwordx4 v[16:19], v12, s[4:7], s30 offen sc1
    buffer_load_dword v15, off, s[4:7], s58 sc1
    s_add_u32 s25, s19, s14
    v_mov_b32 v20, -1
    v_mov_b32 v21, -1
    v_mov_b32 v22, -1
    v_mov_b32 v23, -1
    buffer_store_dwordx4 v[20:23], v1, s[4:7], s25 offen
    buffer_store_dwordx2 v[20:21], v54, s[4:7], s25 offen offset:1024
    s_mov_b32 m0, 124928
    s_nop 0
    buffer_load_dwordx4 v1, s[4:7], s69 offen offset:0 sc1 lds
    buffer_load_dwordx4 v1, s[4:7], s69 offen offset:1024 sc1 lds
    buffer_load_dwordx4 v1, s[4:7], s69 offen offset:2048 sc1 lds
    buffer_load_dwordx4 v1, s[4:7], s69 offen offset:3072 sc1 lds
    s_add_u32 s69, s69, 262144
    s_add_u32 m0, s53, 0
    s_add_u32 s22, s52, 0
    buffer_load_dwordx4 v1, s[4:7], s22 offen offset:0 sc1 lds
    buffer_load_dwordx4 v1, s[4:7], s22 offen offset:1024 sc1 lds
    buffer_load_dwordx4 v1, s[4:7], s22 offen offset:2048 sc1 lds
    buffer_load_dwordx4 v1, s[4:7], s22 offen offset:3072 sc1 lds
    s_add_u32 m0, s53, 4096
    s_add_u32 s22, s52, 131072
    buffer_load_dwordx4 v1, s[4:7], s22 offen offset:0 sc1 lds
    buffer_load_dwordx4 v1, s[4:7], s22 offen offset:1024 sc1 lds
    buffer_load_dwordx4 v1, s[4:7], s22 offen offset:2048 sc1 lds
    buffer_load_dwordx4 v1, s[4:7], s22 offen offset:3072 sc1 lds
    s_add_u32 s52, s52, 262144
    s_add_u32 s22, s16, 1
    v_mov_b32 v60, s22
    v_mov_b32 v32, 0
    v_mov_b32 v33, 0
    v_mov_b32 v34, 0
    v_mov_b32 v35, 0
    v_mov_b32 v36, 0
    v_mov_b32 v37, 0
    v_mov_b32 v38, 0
    v_mov_b32 v39, 0
    v_mov_b32 v40, 0
    v_mov_b32 v41, 0
    v_mov_b32 v42, 0
    v_mov_b32 v43, 0
    v_mov_b32 v44, 0
    v_mov_b32 v45, 0
    v_mov_b32 v46, 0
    v_mov_b32 v47, 0
    v_mov_b32 v48, 0
    v_mov_b32 v49, 0
    v_mov_b32 v50, 0
    v_mov_b32 v51, 0
    v_mov_b32 v52, 0
    v_mov_b32 v53, 0
    v_mov_b32 v54, 0
    v_mov_b32 v55, 0
    v_mov_b32 v0, 1.0
    s_mov_b32 exec_lo, 0xff00ff00
    s_mov_b32 exec_hi, 0xff00ff00
    v_mov_b32 v0, s47
    s_mov_b64 exec, -1
    s_waitcnt vmcnt(15) lgkmcnt(0)
    v_mfma_f32_16x16x32_bf16 v[20:23], v[56:59], v[16:19], 0
    v_max3_u32 v9, v16, v17, v18
    v_max_u32 v9, v9, v19
    v_cmp_eq_u32 vcc, -1, v9
    s_cbranch_vccnz prp_10
    s_nop 3
    v_add_f32_dpp v20, v20, v20 row_ror:8 row_mask:0xf bank_mask:0xf
    v_add_f32_dpp v21, v21, v21 row_ror:8 row_mask:0xf bank_mask:0xf
    v_add_f32_dpp v22, v22, v22 row_ror:8 row_mask:0xf bank_mask:0xf
    v_add_f32_dpp v23, v23, v23 row_ror:8 row_mask:0xf bank_mask:0xf
    v_cvt_pk_bf16_f32 v20, v20, v21
    v_cvt_pk_bf16_f32 v21, v22, v23
    s_mov_b32 exec_hi, 0
    v_min_u32 v20, -2, v20
    v_min_u32 v21, -2, v21
    s_mov_b32 exec_lo, 0x00ff00ff
    buffer_store_dwordx2 v[20:21], v13, s[4:7], s23 offen
    s_mov_b64 exec, -1
    s_branch ploop_6_pst
ploop_6_pnd:
    s_sleep 6
    s_nop 8
    buffer_load_dwordx4 v[16:19], v12, s[4:7], s30 offen sc1
    buffer_load_dword v15, off, s[4:7], s58 sc1
    s_add_u32 s22, s16, 1
    v_mov_b32 v60, s22
    v_mov_b32 v32, 0
    v_mov_b32 v33, 0
    v_mov_b32 v34, 0
    v_mov_b32 v35, 0
    v_mov_b32 v36, 0
    v_mov_b32 v37, 0
    v_mov_b32 v38, 0
    v_mov_b32 v39, 0
    v_mov_b32 v40, 0
    v_mov_b32 v41, 0
    v_mov_b32 v42, 0
    v_mov_b32 v43, 0
    v_mov_b32 v44, 0
    v_mov_b32 v45, 0
    v_mov_b32 v46, 0
    v_mov_b32 v47, 0
    v_mov_b32 v48, 0
    v_mov_b32 v49, 0
    v_mov_b32 v50, 0
    v_mov_b32 v51, 0
    v_mov_b32 v52, 0
    v_mov_b32 v53, 0
    v_mov_b32 v54, 0
    v_mov_b32 v55, 0
    v_mov_b32 v0, 1.0
    s_mov_b32 exec_lo, 0xff00ff00
    s_mov_b32 exec_hi, 0xff00ff00
    v_mov_b32 v0, s47
    s_mov_b64 exec, -1
ploop_6_pagain:
    s_waitcnt vmcnt(1) lgkmcnt(0)
    v_mfma_f32_16x16x32_bf16 v[20:23], v[56:59], v[16:19], 0
    v_max3_u32 v9, v16, v17, v18
    v_max_u32 v9, v9, v19
    v_cmp_eq_u32 vcc, -1, v9
    s_cbranch_vccnz prp_10
ploop_6_pgo:
    s_nop 3
    v_add_f32_dpp v20, v20, v20 row_ror:8 row_mask:0xf bank_mask:0xf
    v_add_f32_dpp v21, v21, v21 row_ror:8 row_mask:0xf bank_mask:0xf
    v_add_f32_dpp v22, v22, v22 row_ror:8 row_mask:0xf bank_mask:0xf
    v_add_f32_dpp v23, v23, v23 row_ror:8 row_mask:0xf bank_mask:0xf
    v_cvt_pk_bf16_f32 v20, v20, v21
    v_cvt_pk_bf16_f32 v21, v22, v23
    s_mov_b32 exec_hi, 0
    v_min_u32 v20, -2, v20
    v_min_u32 v21, -2, v21
    s_mov_b32 exec_lo, 0x00ff00ff
    buffer_store_dwordx2 v[20:21], v13, s[4:7], s23 offen
    s_mov_b64 exec, -1
ploop_6_pst:
    s_add_u32 s22, s19, s32
    s_add_u32 s25, s20, s36
    buffer_store_dword v10, v2, s[4:7], s22 offen
    s_mov_b32 exec_hi, 0
    buffer_store_dword v10, v3, s[4:7], s22 offen
    s_mov_b32 exec_lo, 0x00ff00ff
    buffer_store_dwordx2 v[10:11], v13, s[4:7], s25 offen
    s_mov_b64 exec, -1
    s_add_u32 s16, s16, 1
    s_mov_b32 s17, s18
    s_mov_b32 s18, s19
    s_mov_b32 s19, s20
    s_add_u32 s20, s20, 262144
    s_cmp_eq_u32 s20, 210763776
    s_cselect_b32 s20, 209715200, s20
    s_branch ploop_6
prm_9_gt:
gate_13:
    v_readfirstlane_b32 s25, v15
    s_cmp_ge_u32 s25, s59
    s_cbranch_scc1 gate_13_ok
    s_sleep 8
    buffer_load_dword v15, off, s[4:7], s58 sc1
    s_waitcnt vmcnt(0)
    s_sub_u32 s26, s26, 1
    s_cbranch_scc0 gate_13
    s_mov_b32 s26, 0
gate_13_ok:
    s_branch prm_9_gtb
prm_9_0:
    s_sub_u32 s26, s26, 1
    s_cbranch_scc1 prm_9_0_g
    buffer_load_dwordx4 v[16:19], v1, s[4:7], s21 offen offset:0 sc1
    buffer_load_dwordx4 v[20:23], v1, s[4:7], s21 offen offset:1024 sc1
    buffer_load_dwordx4 v[24:27], v1, s[4:7], s21 offen offset:2048 sc1
    buffer_load_dwordx4 v[28:31], v1, s[4:7], s21 offen offset:3072 sc1
    s_waitcnt vmcnt(3)
    v_max3_u32 v9, v16, v17, v18
    v_max_u32 v9, v9, v19
    v_cmp_eq_u32 vcc, -1, v9
    s_cbranch_vccnz prm_9_0
    s_branch prm_9_0ok
prm_9_0_g:
    s_mov_b32 s26, 0
    s_waitcnt vmcnt(0)
    s_branch prm_9_0ok
prm_9_1:
    s_sub_u32 s26, s26, 1
    s_cbranch_scc1 prm_9_1_g
    buffer_load_dwordx4 v[20:23], v1, s[4:7], s21 offen offset:1024 sc1
    buffer_load_dwordx4 v[24:27], v1, s[4:7], s21 offen offset:2048 sc1
    buffer_load_dwordx4 v[28:31], v1, s[4:7], s21 offen offset:3072 sc1
    s_waitcnt vmcnt(2)
    v_max3_u32 v9, v20, v21, v22
    v_max_u32 v9, v9, v23
    v_cmp_eq_u32 vcc, -1, v9
    s_cbranch_vccnz prm_9_1
    s_branch prm_9_1ok
prm_9_1_g:
    s_mov_b32 s26, 0
    s_waitcnt vmcnt(0)
    s_branch prm_9_1ok
prm_9_2:
    s_sub_u32 s26, s26, 1
    s_cbranch_scc1 prm_9_2_g
    buffer_load_dwordx4 v[24:27], v1, s[4:7], s21 offen offset:2048 sc1
    buffer_load_dwordx4 v[28:31], v1, s[4:7], s21 offen offset:3072 sc1
    s_waitcnt vmcnt(1)
    v_max3_u32 v9, v24, v25, v26
    v_max_u32 v9, v9, v27
    v_cmp_eq_u32 vcc, -1, v9
    s_cbranch_vccnz prm_9_2
    s_branch prm_9_2ok
prm_9_2_g:
    s_mov_b32 s26, 0
    s_waitcnt vmcnt(0)
    s_branch prm_9_2ok
prm_9_3:
    s_sub_u32 s26, s26, 1
    s_cbranch_scc1 prm_9_3_g
    buffer_load_dwordx4 v[28:31], v1, s[4:7], s21 offen offset:3072 sc1
    s_waitcnt vmcnt(0)
    v_max3_u32 v9, v28, v29, v30
    v_max_u32 v9, v9, v31
    v_cmp_eq_u32 vcc, -1, v9
    s_cbranch_vccnz prm_9_3
    s_branch prm_9_3ok
prm_9_3_g:
    s_mov_b32 s26, 0
    s_waitcnt vmcnt(0)
    s_branch prm_9_3ok
prm_9_d:
gate_14:
    v_readfirstlane_b32 s25, v15
    s_cmp_ge_u32 s25, s59
    s_cbranch_scc1 gate_14_ok
    s_sleep 8
    buffer_load_dword v15, off, s[4:7], s58 sc1
    s_waitcnt vmcnt(0)
    s_sub_u32 s26, s26, 1
    s_cbranch_scc0 gate_14
    s_mov_b32 s26, 0
gate_14_ok:
    ds_write_b32 v14, v60
    v_add_f32 v32, v32, v33
    v_add_f32 v34, v34, v35
    ds_write2_b32 v4, v32, v34 offset0:0 offset1:104
    v_add_f32 v36, v36, v37
    v_add_f32 v38, v38, v39
    ds_write2_b32 v4, v36, v38 offset0:16 offset1:120
    v_add_f32 v40, v40, v41
    v_add_f32 v42, v42, v43
    ds_write2_b32 v4, v40, v42 offset0:32 offset1:136
    v_add_f32 v44, v44, v45
    v_add_f32 v46, v46, v47
    ds_write2_b32 v4, v44, v46 offset0:48 offset1:152
    v_add_f32 v48, v48, v49
    v_add_f32 v50, v50, v51
    ds_write2_b32 v4, v48, v50 offset0:64 offset1:168
    v_add_f32 v52, v52, v53
    v_add_f32 v54, v54, v55
    ds_write2_b32 v4, v52, v54 offset0:80 offset1:184
    s_branch pnc_7_done
prp_10:
    s_sub_u32 s26, s26, 1
    s_nop 3
    s_cbranch_scc1 prp_10_g
    buffer_load_dwordx4 v[16:19], v12, s[4:7], s30 offen sc1
    buffer_load_dword v15, off, s[4:7], s58 sc1
    s_branch ploop_6_pagain
prp_10_g:
    s_mov_b32 s26, 0
    s_branch ploop_6_pgo
ploop_6_zr:
    s_sub_u32 s26, s26, 1
    s_cbranch_scc1 ploop_6_zg
    buffer_load_dwordx4 v[32:35], v1, s[4:7], s22 offen offset:0 sc1
    buffer_load_dwordx4 v[36:39], v1, s[4:7], s22 offen offset:1024 sc1
    buffer_load_dwordx4 v[40:43], v1, s[4:7], s22 offen offset:2048 sc1
    buffer_load_dwordx4 v[44:47], v1, s[4:7], s22 offen offset:3072 sc1
    s_branch ploop_6_za
ploop_6_zg:
    s_mov_b32 s26, 0
    s_branch ploop_6_zok
ptail_8:
    s_cmp_eq_u32 s15, 0
    s_cbranch_scc1 ptail_8_nd
    s_nop 0
ptail_8_nd:
    s_barrier
    v_add_u32 v55, s68, v61
    ds_read_b128 v[24:27], v55 offset:0
    ds_read_b128 v[28:31], v55 offset:1024
    ds_read_b128 v[32:35], v55 offset:18560
    ds_read_b128 v[36:39], v55 offset:19584
    ds_read_b128 v[40:43], v55 offset:37120
    ds_read_b128 v[44:47], v55 offset:38144
    ds_read_b128 v[48:51], v55 offset:55680
    ds_read_b128 v[52:55], v55 offset:56704
    s_waitcnt lgkmcnt(4)
    v_add_f32 v24, v24, v32
    v_add_f32 v25, v25, v33
    v_add_f32 v26, v26, v34
    v_add_f32 v27, v27, v35
    v_add_f32 v28, v28, v36
    v_add_f32 v29, v29, v37
    v_add_f32 v30, v30, v38
    v_add_f32 v31, v31, v39
    s_waitcnt lgkmcnt(0)
    v_add_f32 v40, v40, v48
    v_add_f32 v41, v41, v49
    v_add_f32 v42, v42, v50
    v_add_f32 v43, v43, v51
    v_add_f32 v44, v44, v52
    v_add_f32 v45, v45, v53
    v_add_f32 v46, v46, v54
    v_add_f32 v47, v47, v55
    v_add_f32 v24, v24, v40
    v_add_f32 v25, v25, v41
    v_add_f32 v26, v26, v42
    v_add_f32 v27, v27, v43
    v_add_f32 v28, v28, v44
    v_add_f32 v29, v29, v45
    v_add_f32 v30, v30, v46
    v_add_f32 v31, v31, v47
    v_cvt_pk_bf16_f32 v24, v24, v25
    v_cvt_pk_bf16_f32 v25, v26, v27
    v_cvt_pk_bf16_f32 v26, v28, v29
    v_cvt_pk_bf16_f32 v27, v30, v31
    v_min_u32 v24, -2, v24
    v_min_u32 v25, -2, v25
    v_min_u32 v26, -2, v26
    v_min_u32 v27, -2, v27
    buffer_store_dwordx4 v[24:27], v1, s[4:7], s37 offen sc1
    s_branch k_end
ch_p_slow:
    v_mov_b32 v32, 0
    v_mov_b32 v33, 0
    v_mov_b32 v34, 0
    v_mov_b32 v35, 0
    v_mov_b32 v36, 0
    v_mov_b32 v37, 0
    v_mov_b32 v38, 0
    v_mov_b32 v39, 0
    v_mov_b32 v40, 0
    v_mov_b32 v41, 0
    v_mov_b32 v42, 0
    v_mov_b32 v43, 0
    v_mov_b32 v44, 0
    v_mov_b32 v45, 0
    v_mov_b32 v46, 0
    v_mov_b32 v47, 0
    v_mov_b32 v48, 0
    v_mov_b32 v49, 0
    v_mov_b32 v50, 0
    v_mov_b32 v51, 0
    v_mov_b32 v52, 0
    v_mov_b32 v53, 0
    v_mov_b32 v54, 0
    v_mov_b32 v55, 0
    v_mov_b32 v0, 1.0
    s_mov_b32 exec_lo, 0xff00ff00
    s_mov_b32 exec_hi, 0xff00ff00
    v_mov_b32 v0, s47
    s_mov_b64 exec, -1
    v_mov_b32 v60, s16
    v_smfmac_f32_16x16x64_bf16 v[32:35], v[16:19], v[64:71], v62
    v_smfmac_f32_16x16x64_bf16 v[36:39], v[16:19], v[72:79], v62
    v_smfmac_f32_16x16x64_bf16 v[40:43], v[16:19], v[80:87], v62
    v_smfmac_f32_16x16x64_bf16 v[44:47], v[16:19], v[88:95], v62
    v_smfmac_f32_16x16x64_bf16 v[48:51], v[16:19], v[96:103], v62
    v_smfmac_f32_16x16x64_bf16 v[52:55], v[16:19], v[104:111], v62
    v_smfmac_f32_16x16x64_bf16 v[32:35], v[20:23], v[112:119], v62
    v_smfmac_f32_16x16x64_bf16 v[36:39], v[20:23], v[120:127], v62
    v_smfmac_f32_16x16x64_bf16 v[40:43], v[20:23], v[128:135], v62
    v_smfmac_f32_16x16x64_bf16 v[44:47], v[20:23], v[136:143], v62
    v_smfmac_f32_16x16x64_bf16 v[48:51], v[20:23], v[144:151], v62
    v_smfmac_f32_16x16x64_bf16 v[52:55], v[20:23], v[152:159], v62
    v_smfmac_f32_16x16x64_bf16 v[32:35], v[24:27], v[160:167], v62
    v_smfmac_f32_16x16x64_bf16 v[36:39], v[24:27], v[168:175], v62
    v_smfmac_f32_16x16x64_bf16 v[40:43], v[24:27], v[176:183], v62
    v_smfmac_f32_16x16x64_bf16 v[44:47], v[24:27], v[184:191], v62
    v_smfmac_f32_16x16x64_bf16 v[48:51], v[24:27], v[192:199], v62
    v_smfmac_f32_16x16x64_bf16 v[52:55], v[24:27], v[200:207], v62
    v_smfmac_f32_16x16x64_bf16 v[32:35], v[28:31], v[208:215], v62
    ds_write_b32 v14, v60
    v_smfmac_f32_16x16x64_bf16 v[36:39], v[28:31], v[216:223], v62
    v_smfmac_f32_16x16x64_bf16 v[40:43], v[28:31], v[224:231], v62
    v_smfmac_f32_16x16x64_bf16 v[44:47], v[28:31], v[232:239], v62
    v_add_f32 v32, v32, v33
    v_add_f32 v34, v34, v35
    v_smfmac_f32_16x16x64_bf16 v[48:51], v[28:31], v[240:247], v62
    v_add_f32 v36, v36, v37
    v_add_f32 v38, v38, v39
    ds_write2_b32 v4, v32, v34 offset0:0 offset1:104
    v_smfmac_f32_16x16x64_bf16 v[52:55], v[28:31], v[248:255], v62
    v_add_f32 v40, v40, v41
    v_add_f32 v42, v42, v43
    ds_write2_b32 v4, v36, v38 offset0:16 offset1:120
    v_add_f32 v44, v44, v45
    v_add_f32 v46, v46, v47
    ds_write2_b32 v4, v40, v42 offset0:32 offset1:136
    v_add_f32 v48, v48, v49
    v_add_f32 v50, v50, v51
    ds_write2_b32 v4, v44, v46 offset0:48 offset1:152
    v_add_f32 v52, v52, v53
    v_add_f32 v54, v54, v55
    ds_write2_b32 v4, v48, v50 offset0:64 offset1:168
    ds_write2_b32 v4, v52, v54 offset0:80 offset1:184
    s_waitcnt vmcnt(0)
    s_branch pnc_16_done
.p2align 6
    s_nop 0
    s_nop 0
    s_nop 0
    s_nop 0
    s_nop 0
    s_nop 0
    s_nop 0
    s_nop 0
ploop_15:
    s_add_u32 s21, s17, s33
    s_nop 15
    s_nop 5
    buffer_load_dwordx4 v[16:19], v1, s[4:7], s21 offen offset:0 sc1
    s_nop 7
    buffer_load_dwordx4 v[20:23], v1, s[4:7], s21 offen offset:1024 sc1
    s_nop 7
    buffer_load_dwordx4 v[24:27], v1, s[4:7], s21 offen offset:2048 sc1
    s_nop 7
    buffer_load_dwordx4 v[28:31], v1, s[4:7], s21 offen offset:3072 sc1
    s_waitcnt vmcnt(3)
    v_max3_u32 v9, v16, v17, v18
    v_max_u32 v9, v9, v19
    v_cmp_eq_u32 vcc, -1, v9
    s_cbranch_vccnz prm_18_0
prm_18_0ok:
    v_smfmac_f32_16x16x64_bf16 v[32:35], v[16:19], v[64:71], v62
    v_smfmac_f32_16x16x64_bf16 v[36:39], v[16:19], v[72:79], v62
    v_smfmac_f32_16x16x64_bf16 v[40:43], v[16:19], v[80:87], v62
    s_waitcnt vmcnt(2)
    v_max3_u32 v9, v20, v21, v22
    v_max_u32 v9, v9, v23
    v_cmp_eq_u32 vcc, -1, v9
    v_smfmac_f32_16x16x64_bf16 v[44:47], v[16:19], v[88:95], v62
    v_smfmac_f32_16x16x64_bf16 v[48:51], v[16:19], v[96:103], v62
    v_smfmac_f32_16x16x64_bf16 v[52:55], v[16:19], v[104:111], v62
    s_cbranch_vccnz prm_18_1
prm_18_1ok:
    v_smfmac_f32_16x16x64_bf16 v[32:35], v[20:23], v[112:119], v62
    v_readfirstlane_b32 s23, v15
    v_smfmac_f32_16x16x64_bf16 v[36:39], v[20:23], v[120:127], v62
    v_smfmac_f32_16x16x64_bf16 v[40:43], v[20:23], v[128:135], v62
    s_waitcnt vmcnt(1)
    v_max3_u32 v9, v24, v25, v26
    v_max_u32 v9, v9, v27
    v_cmp_eq_u32 vcc, -1, v9
    v_smfmac_f32_16x16x64_bf16 v[44:47], v[20:23], v[136:143], v62
    v_smfmac_f32_16x16x64_bf16 v[48:51], v[20:23], v[144:151], v62
    v_smfmac_f32_16x16x64_bf16 v[52:55], v[20:23], v[152:159], v62
    s_cbranch_vccnz prm_18_2
prm_18_2ok:
    v_smfmac_f32_16x16x64_bf16 v[32:35], v[24:27], v[160:167], v62
    v_smfmac_f32_16x16x64_bf16 v[36:39], v[24:27], v[168:175], v62
    v_smfmac_f32_16x16x64_bf16 v[40:43], v[24:27], v[176:183], v62
    s_waitcnt vmcnt(0)
    v_max3_u32 v9, v28, v29, v30
    v_max_u32 v9, v9, v31
    v_cmp_eq_u32 vcc, -1, v9
    v_smfmac_f32_16x16x64_bf16 v[44:47], v[24:27], v[184:191], v62
    v_smfmac_f32_16x16x64_bf16 v[48:51], v[24:27], v[192:199], v62
    v_smfmac_f32_16x16x64_bf16 v[52:55], v[24:27], v[200:207], v62
    s_cbranch_vccnz prm_18_3
prm_18_3ok:
    v_smfmac_f32_16x16x64_bf16 v[32:35], v[28:31], v[208:215], v62
    s_cmp_lt_u32 s23, s59
    s_cbranch_scc1 prm_18_gt
prm_18_gtb:
    ds_write_b32 v14, v60
    v_smfmac_f32_16x16x64_bf16 v[36:39], v[28:31], v[216:223], v62
    v_smfmac_f32_16x16x64_bf16 v[40:43], v[28:31], v[224:231], v62
    v_smfmac_f32_16x16x64_bf16 v[44:47], v[28:31], v[232:239], v62
    v_add_f32 v32, v32, v33
    v_add_f32 v34, v34, v35
    v_smfmac_f32_16x16x64_bf16 v[48:51], v[28:31], v[240:247], v62
    v_add_f32 v36, v36, v37
    v_add_f32 v38, v38, v39
    ds_write2_b32 v4, v32, v34 offset0:0 offset1:104
    v_smfmac_f32_16x16x64_bf16 v[52:55], v[28:31], v[248:255], v62
    v_add_f32 v40, v40, v41
    v_add_f32 v42, v42, v43
    ds_write2_b32 v4, v36, v38 offset0:16 offset1:120
    v_add_f32 v44, v44, v45
    v_add_f32 v46, v46, v47
    ds_write2_b32 v4, v40, v42 offset0:32 offset1:136
    v_add_f32 v48, v48, v49
    v_add_f32 v50, v50, v51
    ds_write2_b32 v4, v44, v46 offset0:48 offset1:152
    v_add_f32 v52, v52, v53
    v_add_f32 v54, v54, v55
    ds_write2_b32 v4, v48, v50 offset0:64 offset1:168
    ds_write2_b32 v4, v52, v54 offset0:80 offset1:184
pnc_16_done:
    s_add_u32 s21, s17, s32
    s_add_u32 s22, s19, s32
    s_add_u32 s24, s19, s35
    s_waitcnt lgkmcnt(0)
    s_barrier
    ds_read_b64 v[32:33], v5 offset:0
    ds_read_b64 v[34:35], v5 offset:3328
    ds_read_b64 v[36:37], v5 offset:6656
    ds_read_b64 v[38:39], v5 offset:9984
    ds_read_b64 v[40:41], v6 offset:0
    ds_read_b64 v[42:43], v6 offset:3328
    ds_read_b64 v[44:45], v6 offset:6656
    ds_read_b64 v[46:47], v6 offset:9984
    s_waitcnt lgkmcnt(6)
    v_add_f32 v32, v32, v34
    v_add_f32 v33, v33, v35
    v_mul_f32 v32, v32, v0
    v_mul_f32 v33, v33, v0
    s_waitcnt lgkmcnt(4)
    v_add_f32 v36, v36, v38
    v_add_f32 v37, v37, v39
    v_fma_f32 v32, v36, v0, v32
    v_fma_f32 v33, v37, v0, v33
    v_cvt_pk_bf16_f32 v32, v32, v33
    v_min_u32 v32, -2, v32
    buffer_store_dword v32, v2, s[4:7], s21 offen sc1
    s_waitcnt lgkmcnt(2)
    v_add_f32 v40, v40, v42
    v_add_f32 v41, v41, v43
    s_waitcnt lgkmcnt(0)
    v_add_f32 v44, v44, v46
    v_add_f32 v45, v45, v47
    v_add_f32 v40, v40, v44
    v_add_f32 v41, v41, v45
    v_cvt_pk_bf16_f32 v40, v40, v41
    v_min_u32 v40, -2, v40
    s_mov_b32 exec_hi, 0
    buffer_store_dword v40, v3, s[4:7], s21 offen sc1
    s_setprio 0
    s_mov_b64 exec, -1
    s_add_u32 s21, s17, s35
    s_add_u32 s30, s17, s34
    s_add_u32 s23, s18, s36
    s_cmp_lg_u32 s16, 0
    s_cbranch_scc1 ploop_15_n0
gate_20:
    v_readfirstlane_b32 s25, v15
    s_cmp_ge_u32 s25, s59
    s_cbranch_scc1 gate_20_ok
    s_sleep 8
    buffer_load_dword v15, off, s[4:7], s58 sc1
    s_waitcnt vmcnt(0)
    s_sub_u32 s26, s26, 1
    s_cbranch_scc0 gate_20
    s_mov_b32 s26, 0
gate_20_ok:
    s_cmp_eq_u32 s15, 0
    s_cbranch_scc1 ploop_15_st_nk
    s_add_u32 m0, s53, 0
    s_add_u32 s22, s52, 0
    buffer_load_dwordx4 v1, s[4:7], s22 offen offset:0 sc1 lds
    buffer_load_dwordx4 v1, s[4:7], s22 offen offset:1024 sc1 lds
    buffer_load_dwordx4 v1, s[4:7], s22 offen offset:2048 sc1 lds
    buffer_load_dwordx4 v1, s[4:7], s22 offen offset:3072 sc1 lds
    s_add_u32 m0, s53, 4096
    s_add_u32 s22, s52, 131072
    buffer_load_dwordx4 v1, s[4:7], s22 offen offset:0 sc1 lds
    buffer_load_dwordx4 v1, s[4:7], s22 offen offset:1024 sc1 lds
    buffer_load_dwordx4 v1, s[4:7], s22 offen offset:2048 sc1 lds
    buffer_load_dwordx4 v1, s[4:7], s22 offen offset:3072 sc1 lds
    s_add_u32 s52, s52, 262144
    s_sub_u32 s52, s52, 262144
ploop_15_st_nk:
    s_add_u32 s52, s52, 262144
    s_cmp_lg_u32 s3, 2
    s_cbranch_scc1 ploop_15_st_npf
    v_subrev_u32 v32, 524288, v63
    s_mov_b32 exec_hi, 0xffff
    s_mov_b32 s22, 262144
    buffer_load_dword v33, v32, s[4:7], s22 offen sc1
    s_mov_b32 exec_hi, -1
    s_waitcnt vmcnt(0)
ploop_15_st_npf:
    s_cmp_eq_u32 s15, 0
    s_cbranch_scc1 ploop_15_st_p_nd
    s_mov_b32 m0, 124928
    s_nop 0
    buffer_load_dwordx4 v1, s[4:7], s69 offen offset:0 sc1 lds
    buffer_load_dwordx4 v1, s[4:7], s69 offen offset:1024 sc1 lds
    buffer_load_dwordx4 v1, s[4:7], s69 offen offset:2048 sc1 lds
    buffer_load_dwordx4 v1, s[4:7], s69 offen offset:3072 sc1 lds
    s_add_u32 s69, s69, 262144
    s_waitcnt vmcnt(0)
ploop_15_st_p_nd:
ploop_15_n0:
    s_add_u32 s25, s16, 2
    s_min_u32 s25, s25, 63
    s_cmp_lt_u32 s25, 8
    s_cselect_b32 s59, 12, 24
    s_cselect_b32 s58, -4, -8
    s_and_b32 s25, s25, s58
    s_lshl_b32 s25, s25, 5
    s_add_u32 s58, s25, s60
    s_cmp_eq_u32 s15, 0
    s_cbranch_scc1 ploop_15_nd
    v_add_u32 v9, s53, v1
    v_add_u32 v0, 124928, v1
    ds_read_b128 v[16:19], v0 offset:0
    ds_read_b128 v[32:35], v9 offset:0
    ds_read_b128 v[20:23], v0 offset:1024
    ds_read_b128 v[36:39], v9 offset:1024
    ds_read_b128 v[24:27], v0 offset:2048
    ds_read_b128 v[40:43], v9 offset:2048
    ds_read_b128 v[28:31], v0 offset:3072
    ds_read_b128 v[44:47], v9 offset:3072
    s_add_u32 s22, s17, s61
    s_waitcnt lgkmcnt(6)
    v_mfma_f32_16x16x32_bf16 v[48:51], v[32:35], v[16:19], 0
    ds_read_b128 v[32:35], v9 offset:4096
    s_waitcnt lgkmcnt(5)
    v_mfma_f32_16x16x32_bf16 v[48:51], v[36:39], v[20:23], v[48:51]
    ds_read_b128 v[36:39], v9 offset:5120
    s_waitcnt lgkmcnt(4)
    v_mfma_f32_16x16x32_bf16 v[48:51], v[40:43], v[24:27], v[48:51]
    ds_read_b128 v[40:43], v9 offset:6144
    s_waitcnt lgkmcnt(3)
    v_mfma_f32_16x16x32_bf16 v[48:51], v[44:47], v[28:31], v[48:51]
    ds_read_b128 v[44:47], v9 offset:7168
    s_waitcnt lgkmcnt(3)
    v_mfma_f32_16x16x32_bf16 v[52:55], v[32:35], v[16:19], 0
    s_waitcnt lgkmcnt(2)
    v_mfma_f32_16x16x32_bf16 v[52:55], v[36:39], v[20:23], v[52:55]
    s_waitcnt lgkmcnt(1)
    v_mfma_f32_16x16x32_bf16 v[52:55], v[40:43], v[24:27], v[52:55]
    s_waitcnt lgkmcnt(0)
    v_mfma_f32_16x16x32_bf16 v[52:55], v[44:47], v[28:31], v[52:55]
    buffer_load_dwordx4 v[32:35], v1, s[4:7], s22 offen offset:0 sc1
    buffer_load_dwordx4 v[36:39], v1, s[4:7], s22 offen offset:1024 sc1
    buffer_load_dwordx4 v[40:43], v1, s[4:7], s22 offen offset:2048 sc1
    buffer_load_dwordx4 v[44:47], v1, s[4:7], s22 offen offset:3072 sc1
    v_mov_b32 v60, 0xff61b1e6
    s_nop 2
    v_cndmask_b32 v48, v48, v60, s[38:39]
    v_cndmask_b32 v49, v49, v60, s[40:41]
    v_cndmask_b32 v50, v50, v60, s[42:43]
    v_cndmask_b32 v51, v51, v60, s[44:45]
    v_cndmask_b32 v52, v52, v60, s[48:49]
    v_cndmask_b32 v53, v53, v60, s[50:51]
    v_cndmask_b32 v54, v54, v60, s[54:55]
    v_cndmask_b32 v55, v55, v60, s[56:57]
    v_max3_f32 v0, v48, v49, v50
    v_max3_f32 v9, v51, v52, v53
    v_max3_f32 v0, v0, v54, v55
    v_max_f32 v0, v0, v9
    v_mov_b32 v9, v0
    s_nop 1
    v_permlane16_swap_b32 v9, v0
    v_max_f32 v0, v0, v9
    v_mov_b32 v9, v0
    s_nop 1
    v_permlane32_swap_b32 v9, v0
    v_max_f32 v0, v0, v9
    v_mul_f32 v0, s47, v0
    v_fma_f32 v48, v48, s47, -v0
    v_fma_f32 v49, v49, s47, -v0
    v_fma_f32 v50, v50, s47, -v0
    v_fma_f32 v51, v51, s47, -v0
    v_fma_f32 v52, v52, s47, -v0
    v_fma_f32 v53, v53, s47, -v0
    v_fma_f32 v54, v54, s47, -v0
    v_fma_f32 v55, v55, s47, -v0
    v_exp_f32 v48, v48
    v_exp_f32 v49, v49
    v_exp_f32 v50, v50
    v_exp_f32 v51, v51
    v_exp_f32 v52, v52
    v_exp_f32 v53, v53
    v_exp_f32 v54, v54
    v_exp_f32 v55, v55
    v_add_f32 v15, v48, v49
    v_add_f32 v15, v15, v50
    v_add_f32 v15, v15, v51
    v_add_f32 v15, v15, v52
    v_add_f32 v15, v15, v53
    v_add_f32 v15, v15, v54
    v_add_f32 v15, v15, v55
ploop_15_za:
    s_waitcnt vmcnt(0)
    v_max3_u32 v9, v32, v33, v34
    v_max3_u32 v9, v9, v35, v36
    v_max3_u32 v9, v9, v37, v38
    v_max3_u32 v9, v9, v39, v40
    v_max3_u32 v9, v9, v41, v42
    v_max3_u32 v9, v9, v43, v44
    v_max3_u32 v9, v9, v45, v46
    v_max_u32 v9, v9, v47
    v_cmp_eq_u32 vcc, -1, v9
    s_cbranch_vccnz ploop_15_zr
ploop_15_zok:
    s_setprio 1
    v_mfma_f32_16x16x32_bf16 v[56:59], v[32:35], v[16:19], 0
    v_mfma_f32_16x16x32_bf16 v[56:59], v[36:39], v[20:23], v[56:59]
    v_mfma_f32_16x16x32_bf16 v[56:59], v[40:43], v[24:27], v[56:59]
    v_mfma_f32_16x16x32_bf16 v[56:59], v[44:47], v[28:31], v[56:59]
    s_add_u32 s22, s17, s14
    s_nop 6
    v_max_f32 v60, v56, v57
    v_mov_b32 v9, v60
    s_nop 1
    v_permlane16_swap_b32 v9, v60
    v_max_f32 v60, v60, v9
    v_mov_b32 v9, v60
    s_nop 1
    v_permlane32_swap_b32 v9, v60
    v_max_f32 v60, v60, v9
    v_mul_f32 v60, s47, v60
    v_max_f32 v58, v60, v0
    v_sub_f32 v60, v0, v58
    v_fma_f32 v56, v56, s47, -v58
    v_fma_f32 v57, v57, s47, -v58
    v_exp_f32 v60, v60
    v_exp_f32 v56, v56
    v_exp_f32 v57, v57
    v_fma_f32 v15, v15, v60, v56
    v_add_f32 v15, v15, v57
    v_mov_b32 v9, v15
    s_nop 1
    v_permlane16_swap_b32 v9, v15
    v_add_f32 v15, v15, v9
    v_mov_b32 v9, v15
    s_nop 1
    v_permlane32_swap_b32 v9, v15
    v_add_f32 v15, v15, v9
    v_rcp_f32 v15, v15
    s_add_u32 s25, s19, s14
    v_mul_f32 v56, v56, v15
    v_mul_f32 v57, v57, v15
    v_mul_f32 v60, v60, v15
    v_mul_f32 v48, v48, v60
    v_mul_f32 v49, v49, v60
    v_mul_f32 v50, v50, v60
    v_mul_f32 v51, v51, v60
    v_mul_f32 v52, v52, v60
    v_mul_f32 v53, v53, v60
    v_mul_f32 v54, v54, v60
    v_mul_f32 v55, v55, v60
    v_cvt_pk_bf16_f32 v48, v48, v49
    v_cvt_pk_bf16_f32 v49, v50, v51
    v_cvt_pk_bf16_f32 v50, v52, v53
    v_cvt_pk_bf16_f32 v51, v54, v55
    v_min_u32 v48, -2, v48
    v_min_u32 v49, -2, v49
    v_min_u32 v50, -2, v50
    v_min_u32 v51, -2, v51
    v_lshlrev_b32 v54, 1, v8
    v_add_u32 v55, 14336, v1
    v_mov_b32 v53, 1.0
    v_cvt_pk_bf16_f32 v52, v56, v57
    v_min_u32 v53, -2, v53
    v_min_u32 v52, -2, v52
    buffer_store_dwordx4 v[48:51], v1, s[4:7], s22 offen sc1
    buffer_store_dwordx2 v[52:53], v54, s[4:7], s22 offen offset:1024 sc1
    ds_read_b128 v[56:59], v55
    s_branch ploop_15_nd2
ploop_15_nd:
    s_cmp_eq_u32 s16, 0
    s_cbranch_scc1 ploop_15_ns
    s_cmp_eq_u32 s31, 0
    s_cbranch_scc1 ploop_15_n2
    s_add_u32 s25, s68, s46
    v_add_u32 v55, s25, v61
    ds_read_b128 v[24:27], v55 offset:0
    ds_read_b128 v[28:31], v55 offset:1024
    ds_read_b128 v[32:35], v55 offset:18560
    ds_read_b128 v[36:39], v55 offset:19584
    ds_read_b128 v[40:43], v55 offset:37120
    ds_read_b128 v[44:47], v55 offset:38144
    ds_read_b128 v[48:51], v55 offset:55680
    ds_read_b128 v[52:55], v55 offset:56704
    s_waitcnt lgkmcnt(4)
    v_add_f32 v24, v24, v32
    v_add_f32 v25, v25, v33
    v_add_f32 v26, v26, v34
    v_add_f32 v27, v27, v35
    v_add_f32 v28, v28, v36
    v_add_f32 v29, v29, v37
    v_add_f32 v30, v30, v38
    v_add_f32 v31, v31, v39
    s_waitcnt lgkmcnt(0)
    v_add_f32 v40, v40, v48
    v_add_f32 v41, v41, v49
    v_add_f32 v42, v42, v50
    v_add_f32 v43, v43, v51
    v_add_f32 v44, v44, v52
    v_add_f32 v45, v45, v53
    v_add_f32 v46, v46, v54
    v_add_f32 v47, v47, v55
    v_add_f32 v24, v24, v40
    v_add_f32 v25, v25, v41
    v_add_f32 v26, v26, v42
    v_add_f32 v27, v27, v43
    v_add_f32 v28, v28, v44
    v_add_f32 v29, v29, v45
    v_add_f32 v30, v30, v46
    v_add_f32 v31, v31, v47
    v_cvt_pk_bf16_f32 v24, v24, v25
    v_cvt_pk_bf16_f32 v25, v26, v27
    v_cvt_pk_bf16_f32 v26, v28, v29
    v_cvt_pk_bf16_f32 v27, v30, v31
    v_min_u32 v24, -2, v24
    v_min_u32 v25, -2, v25
    v_min_u32 v26, -2, v26
    v_min_u32 v27, -2, v27
    v_mov_b32 v16, v24
    v_mov_b32 v17, v25
    v_mov_b32 v18, v26
    v_mov_b32 v19, v27
ploop_15_n2:
    v_add_u32 v55, s68, v61
    ds_read_b128 v[24:27], v55 offset:0
    ds_read_b128 v[28:31], v55 offset:1024
    ds_read_b128 v[32:35], v55 offset:18560
    ds_read_b128 v[36:39], v55 offset:19584
    ds_read_b128 v[40:43], v55 offset:37120
    ds_read_b128 v[44:47], v55 offset:38144
    ds_read_b128 v[48:51], v55 offset:55680
    ds_read_b128 v[52:55], v55 offset:56704
    s_waitcnt lgkmcnt(4)
    v_add_f32 v24, v24, v32
    v_add_f32 v25, v25, v33
    v_add_f32 v26, v26, v34
    v_add_f32 v27, v27, v35
    v_add_f32 v28, v28, v36
    v_add_f32 v29, v29, v37
    v_add_f32 v30, v30, v38
    v_add_f32 v31, v31, v39
    s_waitcnt lgkmcnt(0)
    v_add_f32 v40, v40, v48
    v_add_f32 v41, v41, v49
    v_add_f32 v42, v42, v50
    v_add_f32 v43, v43, v51
    v_add_f32 v44, v44, v52
    v_add_f32 v45, v45, v53
    v_add_f32 v46, v46, v54
    v_add_f32 v47, v47, v55
    v_add_f32 v24, v24, v40
    v_add_f32 v25, v25, v41
    v_add_f32 v26, v26, v42
    v_add_f32 v27, v27, v43
    v_add_f32 v28, v28, v44
    v_add_f32 v29, v29, v45
    v_add_f32 v30, v30, v46
    v_add_f32 v31, v31, v47
    v_cvt_pk_bf16_f32 v24, v24, v25
    v_cvt_pk_bf16_f32 v25, v26, v27
    v_cvt_pk_bf16_f32 v26, v28, v29
    v_cvt_pk_bf16_f32 v27, v30, v31
    v_min_u32 v24, -2, v24
    v_min_u32 v25, -2, v25
    v_min_u32 v26, -2, v26
    v_min_u32 v27, -2, v27
ploop_15_ns:
ploop_15_flag:
    ds_read_b32 v9, v14 offset:16
    s_waitcnt lgkmcnt(0)
    v_readfirstlane_b32 s25, v9
    s_cmp_eq_u32 s25, s16
    s_cbranch_scc0 ploop_15_flag
    s_add_u32 m0, s53, 0
    s_add_u32 s22, s52, 0
    buffer_load_dwordx4 v1, s[4:7], s22 offen offset:0 sc1 lds
    buffer_load_dwordx4 v1, s[4:7], s22 offen offset:1024 sc1 lds
    buffer_load_dwordx4 v1, s[4:7], s22 offen offset:2048 sc1 lds
    buffer_load_dwordx4 v1, s[4:7], s22 offen offset:3072 sc1 lds
    s_add_u32 m0, s53, 4096
    s_add_u32 s22, s52, 131072
    buffer_load_dwordx4 v1, s[4:7], s22 offen offset:0 sc1 lds
    buffer_load_dwordx4 v1, s[4:7], s22 offen offset:1024 sc1 lds
    buffer_load_dwordx4 v1, s[4:7], s22 offen offset:2048 sc1 lds
    buffer_load_dwordx4 v1, s[4:7], s22 offen offset:3072 sc1 lds
    s_add_u32 s52, s52, 262144
ploop_15_nk:
    s_cmp_eq_u32 s16, 0
    s_cbranch_scc1 ploop_15_nd2
    buffer_store_dwordx4 v[24:27], v1, s[4:7], s37 offen sc1
    s_cmp_eq_u32 s31, 0
    s_cbranch_scc1 ploop_15_nd2
    s_add_u32 s25, s37, s27
    buffer_store_dwordx4 v[16:19], v1, s[4:7], s25 offen sc1
ploop_15_nd2:
    s_cmp_eq_u32 s16, 0
    s_cbranch_scc1 ploop_15_nn
    s_add_u32 s37, s37, 65536
    s_xor_b32 s68, s68, 8192
ploop_15_nn:
    s_cmp_lg_u32 s3, 2
    s_cbranch_scc1 ppf_21
    s_lshl_b32 s22, s16, 18
    s_mov_b32 exec_hi, 0xffff
    buffer_load_dword v9, v63, s[4:7], s22 offen sc1
    s_mov_b32 exec_hi, -1
ppf_21:
    v_add_u32 v24, 18560, v7
    v_add_u32 v25, 37120, v7
    v_add_u32 v26, 55680, v7
    s_cmp_eq_u32 s16, 63
    s_setprio 3
    s_barrier
    s_cbranch_scc1 ptail_17
    ds_read2_b32 v[16:17], v7 offset0:0 offset1:2
    ds_read2_b32 v[18:19], v24 offset0:0 offset1:2
    ds_read2_b32 v[20:21], v25 offset0:0 offset1:2
    ds_read2_b32 v[22:23], v26 offset0:0 offset1:2
    s_waitcnt lgkmcnt(2)
    v_add_f32 v16, v16, v18
    v_add_f32 v17, v17, v19
    s_waitcnt lgkmcnt(0)
    v_add_f32 v20, v20, v22
    v_add_f32 v21, v21, v23
    v_add_f32 v16, v16, v20
    v_add_f32 v17, v17, v21
    v_cvt_pk_bf16_f32 v16, v16, v17
    v_min_u32 v16, -2, v16
    buffer_store_dword v16, v2, s[4:7], s21 offen sc1
    buffer_store_dword v10, v2, s[4:7], s24 offen sc1
    s_cmp_eq_u32 s15, 0
    s_cbranch_scc1 ploop_15_pnd
    s_sleep 6
    s_nop 8
    buffer_load_dwordx4 v[16:19], v12, s[4:7], s30 offen sc1
    buffer_load_dword v15, off, s[4:7], s58 sc1
    s_add_u32 s25, s19, s14
    v_mov_b32 v20, -1
    v_mov_b32 v21, -1
    v_mov_b32 v22, -1
    v_mov_b32 v23, -1
    buffer_store_dwordx4 v[20:23], v1, s[4:7], s25 offen sc1
    buffer_store_dwordx2 v[20:21], v54, s[4:7], s25 offen offset:1024 sc1
    s_mov_b32 m0, 124928
    s_nop 0
    buffer_load_dwordx4 v1, s[4:7], s69 offen offset:0 sc1 lds
    buffer_load_dwordx4 v1, s[4:7], s69 offen offset:1024 sc1 lds
    buffer_load_dwordx4 v1, s[4:7], s69 offen offset:2048 sc1 lds
    buffer_load_dwordx4 v1, s[4:7], s69 offen offset:3072 sc1 lds
    s_add_u32 s69, s69, 262144
    s_add_u32 m0, s53, 0
    s_add_u32 s22, s52, 0
    buffer_load_dwordx4 v1, s[4:7], s22 offen offset:0 sc1 lds
    buffer_load_dwordx4 v1, s[4:7], s22 offen offset:1024 sc1 lds
    buffer_load_dwordx4 v1, s[4:7], s22 offen offset:2048 sc1 lds
    buffer_load_dwordx4 v1, s[4:7], s22 offen offset:3072 sc1 lds
    s_add_u32 m0, s53, 4096
    s_add_u32 s22, s52, 131072
    buffer_load_dwordx4 v1, s[4:7], s22 offen offset:0 sc1 lds
    buffer_load_dwordx4 v1, s[4:7], s22 offen offset:1024 sc1 lds
    buffer_load_dwordx4 v1, s[4:7], s22 offen offset:2048 sc1 lds
    buffer_load_dwordx4 v1, s[4:7], s22 offen offset:3072 sc1 lds
    s_add_u32 s52, s52, 262144
    s_add_u32 s22, s16, 1
    v_mov_b32 v60, s22
    v_mov_b32 v32, 0
    v_mov_b32 v33, 0
    v_mov_b32 v34, 0
    v_mov_b32 v35, 0
    v_mov_b32 v36, 0
    v_mov_b32 v37, 0
    v_mov_b32 v38, 0
    v_mov_b32 v39, 0
    v_mov_b32 v40, 0
    v_mov_b32 v41, 0
    v_mov_b32 v42, 0
    v_mov_b32 v43, 0
    v_mov_b32 v44, 0
    v_mov_b32 v45, 0
    v_mov_b32 v46, 0
    v_mov_b32 v47, 0
    v_mov_b32 v48, 0
    v_mov_b32 v49, 0
    v_mov_b32 v50, 0
    v_mov_b32 v51, 0
    v_mov_b32 v52, 0
    v_mov_b32 v53, 0
    v_mov_b32 v54, 0
    v_mov_b32 v55, 0
    v_mov_b32 v0, 1.0
    s_mov_b32 exec_lo, 0xff00ff00
    s_mov_b32 exec_hi, 0xff00ff00
    v_mov_b32 v0, s47
    s_mov_b64 exec, -1
    s_waitcnt vmcnt(15) lgkmcnt(0)
    v_mfma_f32_16x16x32_bf16 v[20:23], v[56:59], v[16:19], 0
    v_max3_u32 v9, v16, v17, v18
    v_max_u32 v9, v9, v19
    v_cmp_eq_u32 vcc, -1, v9
    s_cbranch_vccnz prp_19
    s_nop 3
    v_add_f32_dpp v20, v20, v20 row_ror:8 row_mask:0xf bank_mask:0xf
    v_add_f32_dpp v21, v21, v21 row_ror:8 row_mask:0xf bank_mask:0xf
    v_add_f32_dpp v22, v22, v22 row_ror:8 row_mask:0xf bank_mask:0xf
    v_add_f32_dpp v23, v23, v23 row_ror:8 row_mask:0xf bank_mask:0xf
    v_cvt_pk_bf16_f32 v20, v20, v21
    v_cvt_pk_bf16_f32 v21, v22, v23
    s_mov_b32 exec_hi, 0
    v_min_u32 v20, -2, v20
    v_min_u32 v21, -2, v21
    s_mov_b32 exec_lo, 0x00ff00ff
    buffer_store_dwordx2 v[20:21], v13, s[4:7], s23 offen sc1
    s_mov_b64 exec, -1
    s_branch ploop_15_pst
ploop_15_pnd:
    s_sleep 6
    s_nop 8
    buffer_load_dwordx4 v[16:19], v12, s[4:7], s30 offen sc1
    buffer_load_dword v15, off, s[4:7], s58 sc1
    s_add_u32 s22, s16, 1
    v_mov_b32 v60, s22
    v_mov_b32 v32, 0
    v_mov_b32 v33, 0
    v_mov_b32 v34, 0
    v_mov_b32 v35, 0
    v_mov_b32 v36, 0
    v_mov_b32 v37, 0
    v_mov_b32 v38, 0
    v_mov_b32 v39, 0
    v_mov_b32 v40, 0
    v_mov_b32 v41, 0
    v_mov_b32 v42, 0
    v_mov_b32 v43, 0
    v_mov_b32 v44, 0
    v_mov_b32 v45, 0
    v_mov_b32 v46, 0
    v_mov_b32 v47, 0
    v_mov_b32 v48, 0
    v_mov_b32 v49, 0
    v_mov_b32 v50, 0
    v_mov_b32 v51, 0
    v_mov_b32 v52, 0
    v_mov_b32 v53, 0
    v_mov_b32 v54, 0
    v_mov_b32 v55, 0
    v_mov_b32 v0, 1.0
    s_mov_b32 exec_lo, 0xff00ff00
    s_mov_b32 exec_hi, 0xff00ff00
    v_mov_b32 v0, s47
    s_mov_b64 exec, -1
ploop_15_pagain:
    s_waitcnt vmcnt(1) lgkmcnt(0)
    v_mfma_f32_16x16x32_bf16 v[20:23], v[56:59], v[16:19], 0
    v_max3_u32 v9, v16, v17, v18
    v_max_u32 v9, v9, v19
    v_cmp_eq_u32 vcc, -1, v9
    s_cbranch_vccnz prp_19
ploop_15_pgo:
    s_nop 3
    v_add_f32_dpp v20, v20, v20 row_ror:8 row_mask:0xf bank_mask:0xf
    v_add_f32_dpp v21, v21, v21 row_ror:8 row_mask:0xf bank_mask:0xf
    v_add_f32_dpp v22, v22, v22 row_ror:8 row_mask:0xf bank_mask:0xf
    v_add_f32_dpp v23, v23, v23 row_ror:8 row_mask:0xf bank_mask:0xf
    v_cvt_pk_bf16_f32 v20, v20, v21
    v_cvt_pk_bf16_f32 v21, v22, v23
    s_mov_b32 exec_hi, 0
    v_min_u32 v20, -2, v20
    v_min_u32 v21, -2, v21
    s_mov_b32 exec_lo, 0x00ff00ff
    buffer_store_dwordx2 v[20:21], v13, s[4:7], s23 offen sc1
    s_mov_b64 exec, -1
ploop_15_pst:
    s_add_u32 s22, s19, s32
    s_add_u32 s25, s20, s36
    buffer_store_dword v10, v2, s[4:7], s22 offen sc1
    s_mov_b32 exec_hi, 0
    buffer_store_dword v10, v3, s[4:7], s22 offen sc1
    s_mov_b32 exec_lo, 0x00ff00ff
    buffer_store_dwordx2 v[10:11], v13, s[4:7], s25 offen sc1
    s_mov_b64 exec, -1
    s_add_u32 s16, s16, 1
    s_mov_b32 s17, s18
    s_mov_b32 s18, s19
    s_mov_b32 s19, s20
    s_add_u32 s20, s20, 262144
    s_cmp_eq_u32 s20, 210763776
    s_cselect_b32 s20, 209715200, s20
    s_branch ploop_15
prm_18_gt:
gate_22:
    v_readfirstlane_b32 s25, v15
    s_cmp_ge_u32 s25, s59
    s_cbranch_scc1 gate_22_ok
    s_sleep 8
    buffer_load_dword v15, off, s[4:7], s58 sc1
    s_waitcnt vmcnt(0)
    s_sub_u32 s26, s26, 1
    s_cbranch_scc0 gate_22
    s_mov_b32 s26, 0
gate_22_ok:
    s_branch prm_18_gtb
prm_18_0:
    s_sub_u32 s26, s26, 1
    s_cbranch_scc1 prm_18_0_g
    buffer_load_dwordx4 v[16:19], v1, s[4:7], s21 offen offset:0 sc1
    buffer_load_dwordx4 v[20:23], v1, s[4:7], s21 offen offset:1024 sc1
    buffer_load_dwordx4 v[24:27], v1, s[4:7], s21 offen offset:2048 sc1
    buffer_load_dwordx4 v[28:31], v1, s[4:7], s21 offen offset:3072 sc1
    s_waitcnt vmcnt(3)
    v_max3_u32 v9, v16, v17, v18
    v_max_u32 v9, v9, v19
    v_cmp_eq_u32 vcc, -1, v9
    s_cbranch_vccnz prm_18_0
    s_branch prm_18_0ok
prm_18_0_g:
    s_mov_b32 s26, 0
    s_waitcnt vmcnt(0)
    s_branch prm_18_0ok
prm_18_1:
    s_sub_u32 s26, s26, 1
    s_cbranch_scc1 prm_18_1_g
    buffer_load_dwordx4 v[20:23], v1, s[4:7], s21 offen offset:1024 sc1
    buffer_load_dwordx4 v[24:27], v1, s[4:7], s21 offen offset:2048 sc1
    buffer_load_dwordx4 v[28:31], v1, s[4:7], s21 offen offset:3072 sc1
    s_waitcnt vmcnt(2)
    v_max3_u32 v9, v20, v21, v22
    v_max_u32 v9, v9, v23
    v_cmp_eq_u32 vcc, -1, v9
    s_cbranch_vccnz prm_18_1
    s_branch prm_18_1ok
prm_18_1_g:
    s_mov_b32 s26, 0
    s_waitcnt vmcnt(0)
    s_branch prm_18_1ok
prm_18_2:
    s_sub_u32 s26, s26, 1
    s_cbranch_scc1 prm_18_2_g
    buffer_load_dwordx4 v[24:27], v1, s[4:7], s21 offen offset:2048 sc1
    buffer_load_dwordx4 v[28:31], v1, s[4:7], s21 offen offset:3072 sc1
    s_waitcnt vmcnt(1)
    v_max3_u32 v9, v24, v25, v26
    v_max_u32 v9, v9, v27
    v_cmp_eq_u32 vcc, -1, v9
    s_cbranch_vccnz prm_18_2
    s_branch prm_18_2ok
prm_18_2_g:
    s_mov_b32 s26, 0
    s_waitcnt vmcnt(0)
    s_branch prm_18_2ok
prm_18_3:
    s_sub_u32 s26, s26, 1
    s_cbranch_scc1 prm_18_3_g
    buffer_load_dwordx4 v[28:31], v1, s[4:7], s21 offen offset:3072 sc1
    s_waitcnt vmcnt(0)
    v_max3_u32 v9, v28, v29, v30
    v_max_u32 v9, v9, v31
    v_cmp_eq_u32 vcc, -1, v9
    s_cbranch_vccnz prm_18_3
    s_branch prm_18_3ok
prm_18_3_g:
    s_mov_b32 s26, 0
    s_waitcnt vmcnt(0)
    s_branch prm_18_3ok
prm_18_d:
gate_23:
    v_readfirstlane_b32 s25, v15
    s_cmp_ge_u32 s25, s59
    s_cbranch_scc1 gate_23_ok
    s_sleep 8
    buffer_load_dword v15, off, s[4:7], s58 sc1
    s_waitcnt vmcnt(0)
    s_sub_u32 s26, s26, 1
    s_cbranch_scc0 gate_23
    s_mov_b32 s26, 0
gate_23_ok:
    ds_write_b32 v14, v60
    v_add_f32 v32, v32, v33
    v_add_f32 v34, v34, v35
    ds_write2_b32 v4, v32, v34 offset0:0 offset1:104
    v_add_f32 v36, v36, v37
    v_add_f32 v38, v38, v39
    ds_write2_b32 v4, v36, v38 offset0:16 offset1:120
    v_add_f32 v40, v40, v41
    v_add_f32 v42, v42, v43
    ds_write2_b32 v4, v40, v42 offset0:32 offset1:136
    v_add_f32 v44, v44, v45
    v_add_f32 v46, v46, v47
    ds_write2_b32 v4, v44, v46 offset0:48 offset1:152
    v_add_f32 v48, v48, v49
    v_add_f32 v50, v50, v51
    ds_write2_b32 v4, v48, v50 offset0:64 offset1:168
    v_add_f32 v52, v52, v53
    v_add_f32 v54, v54, v55
    ds_write2_b32 v4, v52, v54 offset0:80 offset1:184
    s_branch pnc_16_done
prp_19:
    s_sub_u32 s26, s26, 1
    s_nop 3
    s_cbranch_scc1 prp_19_g
    buffer_load_dwordx4 v[16:19], v12, s[4:7], s30 offen sc1
    buffer_load_dword v15, off, s[4:7], s58 sc1
    s_branch ploop_15_pagain
prp_19_g:
    s_mov_b32 s26, 0
    s_branch ploop_15_pgo
ploop_15_zr:
    s_sub_u32 s26, s26, 1
    s_cbranch_scc1 ploop_15_zg
    buffer_load_dwordx4 v[32:35], v1, s[4:7], s22 offen offset:0 sc1
    buffer_load_dwordx4 v[36:39], v1, s[4:7], s22 offen offset:1024 sc1
    buffer_load_dwordx4 v[40:43], v1, s[4:7], s22 offen offset:2048 sc1
    buffer_load_dwordx4 v[44:47], v1, s[4:7], s22 offen offset:3072 sc1
    s_branch ploop_15_za
ploop_15_zg:
    s_mov_b32 s26, 0
    s_branch ploop_15_zok
ptail_17:
    s_cmp_eq_u32 s15, 0
    s_cbranch_scc1 ptail_17_nd
    s_nop 0
ptail_17_nd:
    s_barrier
    v_add_u32 v55, s68, v61
    ds_read_b128 v[24:27], v55 offset:0
    ds_read_b128 v[28:31], v55 offset:1024
    ds_read_b128 v[32:35], v55 offset:18560
    ds_read_b128 v[36:39], v55 offset:19584
    ds_read_b128 v[40:43], v55 offset:37120
    ds_read_b128 v[44:47], v55 offset:38144
    ds_read_b128 v[48:51], v55 offset:55680
    ds_read_b128 v[52:55], v55 offset:56704
    s_waitcnt lgkmcnt(4)
    v_add_f32 v24, v24, v32
    v_add_f32 v25, v25, v33
    v_add_f32 v26, v26, v34
    v_add_f32 v27, v27, v35
    v_add_f32 v28, v28, v36
    v_add_f32 v29, v29, v37
    v_add_f32 v30, v30, v38
    v_add_f32 v31, v31, v39
    s_waitcnt lgkmcnt(0)
    v_add_f32 v40, v40, v48
    v_add_f32 v41, v41, v49
    v_add_f32 v42, v42, v50
    v_add_f32 v43, v43, v51
    v_add_f32 v44, v44, v52
    v_add_f32 v45, v45, v53
    v_add_f32 v46, v46, v54
    v_add_f32 v47, v47, v55
    v_add_f32 v24, v24, v40
    v_add_f32 v25, v25, v41
    v_add_f32 v26, v26, v42
    v_add_f32 v27, v27, v43
    v_add_f32 v28, v28, v44
    v_add_f32 v29, v29, v45
    v_add_f32 v30, v30, v46
    v_add_f32 v31, v31, v47
    v_cvt_pk_bf16_f32 v24, v24, v25
    v_cvt_pk_bf16_f32 v25, v26, v27
    v_cvt_pk_bf16_f32 v26, v28, v29
    v_cvt_pk_bf16_f32 v27, v30, v31
    v_min_u32 v24, -2, v24
    v_min_u32 v25, -2, v25
    v_min_u32 v26, -2, v26
    v_min_u32 v27, -2, v27
    buffer_store_dwordx4 v[24:27], v1, s[4:7], s37 offen sc1
    s_branch k_end
ch_a_pro:
    s_mul_i32 s21, s2, 24576
    s_add_u32 s21, s21, 209711104
    v_lshlrev_b32 v1, 4, v0
    v_mov_b32 v4, -1
    v_mov_b32 v5, -1
    v_mov_b32 v6, -1
    v_mov_b32 v7, -1
    buffer_store_dwordx4 v[4:7], v1, s[4:7], s21 offen sc1
    s_add_u32 s21, s21, 4096
    buffer_store_dwordx4 v[4:7], v1, s[4:7], s21 offen sc1
    s_add_u32 s21, s21, 4096
    buffer_store_dwordx4 v[4:7], v1, s[4:7], s21 offen sc1
    s_add_u32 s21, s21, 4096
    buffer_store_dwordx4 v[4:7], v1, s[4:7], s21 offen sc1
    s_add_u32 s21, s21, 4096
    buffer_store_dwordx4 v[4:7], v1, s[4:7], s21 offen sc1
    s_add_u32 s21, s21, 4096
    buffer_store_dwordx4 v[4:7], v1, s[4:7], s21 offen sc1
    s_add_u32 s21, s21, 4096
    v_mov_b32 v2, s29
    s_waitcnt vmcnt(0)
    s_barrier
    s_cmp_lg_u32 s3, 4
    s_cbranch_scc1 ch_nox
    s_mov_b64 exec, 1
    buffer_atomic_add v2, off, s[64:67], s28 sc1
    s_mov_b64 exec, -1
ch_nox:
    v_and_b32 v20, 63, v0
    v_lshlrev_b32 v0, 4, v20
    s_sub_u32 s25, s3, 4
    s_lshl_b32 s46, s12, 2
    s_add_u32 s46, s46, s25
    s_lshl_b32 s21, s46, 18
    s_lshl_b32 s22, s13, 7
    s_add_u32 s21, s21, s22
    s_lshl_b32 s46, s46, 12
    s_lshl_b32 s23, s25, 13
    s_add_u32 s23, s23, 131072
    s_load_dwordx2 s[8:9], s[0:1], 40
    s_mov_b32 s10, 8388608
    s_mov_b32 s11, 131072
    v_lshrrev_b32 v21, 3, v20
    v_and_b32 v22, 7, v20
    v_lshlrev_b32 v21, 11, v21
    v_lshl_add_u32 v21, v22, 4, v21
    v_lshrrev_b32 v28, 4, v20
    v_and_b32 v29, 1, v28
    v_xor_b32 v29, 0, v29
    v_lshlrev_b32 v29, 2, v29
    v_lshl_add_u32 v29, v28, 3, v29
    v_bfe_u32 v28, v20, 2, 2
    v_add_u32 v29, v29, v28
    v_lshlrev_b32 v29, 7, v29
    v_and_b32 v28, 3, v20
    v_lshl_add_u32 v29, v28, 4, v29
    v_and_b32 v28, 1, v28
    v_xor_b32 v28, 0, v28
    v_lshl_add_u32 v24, v28, 3, v29
    v_add_u32 v24, s23, v24
    v_lshrrev_b32 v28, 4, v20
    v_and_b32 v29, 1, v28
    v_xor_b32 v29, 1, v29
    v_lshlrev_b32 v29, 2, v29
    v_lshl_add_u32 v29, v28, 3, v29
    v_bfe_u32 v28, v20, 2, 2
    v_add_u32 v29, v29, v28
    v_lshlrev_b32 v29, 7, v29
    v_and_b32 v28, 3, v20
    v_lshl_add_u32 v29, v28, 4, v29
    v_and_b32 v28, 1, v28
    v_xor_b32 v28, 0, v28
    v_lshl_add_u32 v25, v28, 3, v29
    v_add_u32 v25, s23, v25
    v_lshrrev_b32 v28, 4, v20
    v_and_b32 v29, 1, v28
    v_xor_b32 v29, 0, v29
    v_lshlrev_b32 v29, 2, v29
    v_lshl_add_u32 v29, v28, 3, v29
    v_bfe_u32 v28, v20, 2, 2
    v_add_u32 v29, v29, v28
    v_lshlrev_b32 v29, 7, v29
    v_and_b32 v28, 3, v20
    v_lshl_add_u32 v29, v28, 4, v29
    v_and_b32 v28, 1, v28
    v_xor_b32 v28, 1, v28
    v_lshl_add_u32 v26, v28, 3, v29
    v_add_u32 v26, s23, v26
    v_lshrrev_b32 v28, 4, v20
    v_and_b32 v29, 1, v28
    v_xor_b32 v29, 1, v29
    v_lshlrev_b32 v29, 2, v29
    v_lshl_add_u32 v29, v28, 3, v29
    v_bfe_u32 v28, v20, 2, 2
    v_add_u32 v29, v29, v28
    v_lshlrev_b32 v29, 7, v29
    v_and_b32 v28, 3, v20
    v_lshl_add_u32 v29, v28, 4, v29
    v_and_b32 v28, 1, v28
    v_xor_b32 v28, 1, v28
    v_lshl_add_u32 v27, v28, 3, v29
    v_add_u32 v27, s23, v27
    s_waitcnt lgkmcnt(0)
    s_add_u32 m0, s23, 0
    s_nop 0
    buffer_load_dwordx4 v21, s[8:11], s21 offen lds
    s_add_u32 s21, s21, 16384
    s_add_u32 m0, s23, 1024
    s_nop 0
    buffer_load_dwordx4 v21, s[8:11], s21 offen lds
    s_add_u32 s21, s21, 16384
    s_add_u32 m0, s23, 2048
    s_nop 0
    buffer_load_dwordx4 v21, s[8:11], s21 offen lds
    s_add_u32 s21, s21, 16384
    s_add_u32 m0, s23, 3072
    s_nop 0
    buffer_load_dwordx4 v21, s[8:11], s21 offen lds
    s_add_u32 s21, s21, 16384
    s_add_u32 m0, s23, 4096
    s_nop 0
    buffer_load_dwordx4 v21, s[8:11], s21 offen lds
    s_add_u32 s21, s21, 16384
    s_add_u32 m0, s23, 5120
    s_nop 0
    buffer_load_dwordx4 v21, s[8:11], s21 offen lds
    s_add_u32 s21, s21, 16384
    s_add_u32 m0, s23, 6144
    s_nop 0
    buffer_load_dwordx4 v21, s[8:11], s21 offen lds
    s_add_u32 s21, s21, 16384
    s_add_u32 m0, s23, 7168
    s_nop 0
    buffer_load_dwordx4 v21, s[8:11], s21 offen lds
    s_add_u32 s21, s21, 16384
    buffer_load_dwordx4 v[98:101], v21, s[8:11], s21 offen
    s_add_u32 s21, s21, 16384
    buffer_load_dwordx4 v[102:105], v21, s[8:11], s21 offen
    s_add_u32 s21, s21, 16384
    buffer_load_dwordx4 v[106:109], v21, s[8:11], s21 offen
    s_add_u32 s21, s21, 16384
    buffer_load_dwordx4 v[110:113], v21, s[8:11], s21 offen
    s_add_u32 s21, s21, 16384
    buffer_load_dwordx4 v[114:117], v21, s[8:11], s21 offen
    s_add_u32 s21, s21, 16384
    buffer_load_dwordx4 v[118:121], v21, s[8:11], s21 offen
    s_add_u32 s21, s21, 16384
    buffer_load_dwordx4 v[122:125], v21, s[8:11], s21 offen
    s_add_u32 s21, s21, 16384
    buffer_load_dwordx4 v[126:129], v21, s[8:11], s21 offen
    s_add_u32 s21, s21, 16384
    v_add_u32 v30, s23, v0
    s_waitcnt vmcnt(8)
    ds_read_b64_tr_b16 v[192:193], v24 offset:0
    ds_read_b64_tr_b16 v[194:195], v25 offset:0
    ds_read_b64_tr_b16 v[200:201], v26 offset:0
    ds_read_b64_tr_b16 v[202:203], v27 offset:0
    ds_read_b64_tr_b16 v[208:209], v24 offset:64
    ds_read_b64_tr_b16 v[210:211], v25 offset:64
    ds_read_b64_tr_b16 v[216:217], v26 offset:64
    ds_read_b64_tr_b16 v[218:219], v27 offset:64
    s_waitcnt lgkmcnt(0)
    ds_read_b64_tr_b16 v[196:197], v24 offset:4096
    ds_read_b64_tr_b16 v[198:199], v25 offset:4096
    ds_read_b64_tr_b16 v[204:205], v26 offset:4096
    ds_read_b64_tr_b16 v[206:207], v27 offset:4096
    ds_read_b64_tr_b16 v[212:213], v24 offset:4160
    ds_read_b64_tr_b16 v[214:215], v25 offset:4160
    ds_read_b64_tr_b16 v[220:221], v26 offset:4160
    ds_read_b64_tr_b16 v[222:223], v27 offset:4160
    s_waitcnt lgkmcnt(0)
    s_waitcnt vmcnt(0)
    ds_write_b128 v30, v[98:101] offset:0
    ds_write_b128 v30, v[102:105] offset:1024
    ds_write_b128 v30, v[106:109] offset:2048
    ds_write_b128 v30, v[110:113] offset:3072
    ds_write_b128 v30, v[114:117] offset:4096
    ds_write_b128 v30, v[118:121] offset:5120
    ds_write_b128 v30, v[122:125] offset:6144
    ds_write_b128 v30, v[126:129] offset:7168
    s_waitcnt lgkmcnt(0)
    ds_read_b64_tr_b16 v[224:225], v24 offset:0
    ds_read_b64_tr_b16 v[226:227], v25 offset:0
    ds_read_b64_tr_b16 v[232:233], v26 offset:0
    ds_read_b64_tr_b16 v[234:235], v27 offset:0
    ds_read_b64_tr_b16 v[240:241], v24 offset:64
    ds_read_b64_tr_b16 v[242:243], v25 offset:64
    ds_read_b64_tr_b16 v[248:249], v26 offset:64
    ds_read_b64_tr_b16 v[250:251], v27 offset:64
    s_waitcnt lgkmcnt(0)
    ds_read_b64_tr_b16 v[228:229], v24 offset:4096
    ds_read_b64_tr_b16 v[230:231], v25 offset:4096
    ds_read_b64_tr_b16 v[236:237], v26 offset:4096
    ds_read_b64_tr_b16 v[238:239], v27 offset:4096
    ds_read_b64_tr_b16 v[244:245], v24 offset:4160
    ds_read_b64_tr_b16 v[246:247], v25 offset:4160
    ds_read_b64_tr_b16 v[252:253], v26 offset:4160
    ds_read_b64_tr_b16 v[254:255], v27 offset:4160
    s_waitcnt lgkmcnt(0)
    v_lshrrev_b32 v21, 4, v20
    s_mul_i32 s21, s25, 18560
    s_add_u32 s21, s21, 16384
    v_add_u32 v1, s21, v0
    v_and_b32 v23, 15, v20
    v_mul_u32_u24 v21, 136, v21
    v_lshl_add_u32 v21, v23, 3, v21
    v_add_u32 v45, s21, v21
    s_lshl_b32 s53, s25, 13
    s_add_u32 s53, s53, 92160
    v_add_u32 v49, s53, v0
    v_mov_b32 v48, 0
    v_mov_b32 v4, 0x3f803f80
    v_mov_b32 v5, 0x3f803f80
    v_mov_b32 v6, 0x3f803f80
    v_mov_b32 v7, 0x3f803f80
    v_mov_b32 v8, 0
    v_mov_b32 v9, 0
    v_mov_b32 v10, 0
    v_mov_b32 v11, 0
    v_lshlrev_b32 v43, 2, v20
    v_mov_b32 v26, 0x44444444
    v_mov_b32 v27, 0xeeeeeeee
    v_and_b32 v28, 1, v20
    v_cmp_eq_u32 vcc, 0, v28
    s_mov_b32 s47, 0x3e0293ee
    s_lshl_b32 s32, s12, 15
    v_cndmask_b32 v41, v27, v26, vcc
    s_lshl_b32 s21, s25, 13
    s_add_u32 s32, s32, s21
    s_add_u32 s32, s32, 2097152
    s_lshl_b32 s21, s25, 2
    s_add_u32 s21, s21, 13312
    v_mov_b32 v47, s21
    s_lshl_b32 s27, s13, 2
    s_add_u32 s27, s27, s25
    s_lshl_b32 s62, s12, 7
    s_add_u32 s62, s62, 218112000
    s_lshl_b32 s33, s12, 14
    s_lshl_b32 s21, s25, 12
    s_add_u32 s33, s33, s21
    s_add_u32 s33, s33, 1179648
    v_mov_b32 v139, 0
    v_mov_b32 v140, 0
    v_mov_b32 v141, 0
    v_mov_b32 v143, 0
    v_mov_b32 v144, 0
    v_mov_b32 v145, 0
    v_mov_b32 v40, 0
    v_mov_b32 v42, 0
    v_mov_b32 v44, 0
    v_mov_b32 v46, 0
    v_mov_b32 v158, 0x7f800000
    s_mov_b32 exec_lo, 0xcccccccc
    s_mov_b32 exec_hi, 0xcccccccc
    v_mov_b32 v158, 0x42700000
    s_mov_b64 exec, -1
    s_cmp_lg_u32 s3, 4
    s_cbranch_scc1 ch_xcc_skip
    v_add_u32 v56, 128, v43
    s_movk_i32 s21, 192
    v_writelane_b32 v56, s21, 4
    v_mov_b32 v59, 63
    v_writelane_b32 v59, -1, 4
    v_mov_b32 v60, 32
    s_mov_b64 exec, 0x1f
ch_xcc:
    buffer_load_dword v57, v56, s[64:67], 0 offen sc1
    s_waitcnt vmcnt(0)
    v_and_b32 v62, v59, v57
    v_cmp_ne_u32 vcc, v62, v60
    s_cbranch_vccz ch_xcc_ok
    s_sleep 16
    s_sub_u32 s26, s26, 1
    s_cbranch_scc0 ch_xcc
    s_mov_b32 s26, 0
ch_xcc_ok:
    s_lshr_b32 s22, s12, 1
    v_readlane_b32 s23, v57, 0
    s_nop 2
    v_readlane_b32 s21, v57, s22
    s_mov_b64 exec, -1
    v_mov_b32 v58, 131072
    v_mov_b32 v57, s21
    ds_write_b32 v58, v57
    s_bfe_u32 s23, s23, 0x1000f
    v_and_b32 v60, 0x70, v0
    v_lshlrev_b32 v60, 3, v60
    s_mov_b32 s22, 218112000
ch_pgv:
    buffer_load_dword v61, v60, s[4:7], s22 offen offset:8 sc1
    s_waitcnt vmcnt(0) lgkmcnt(0)
    v_and_b32 v62, 1, v61
    v_cmp_eq_u32 vcc, 0, v62
    s_cbranch_vccz ch_pgvok
    s_sleep 8
    s_sub_u32 s26, s26, 1
    s_cbranch_scc0 ch_pgv
    s_mov_b32 s26, 0
ch_pgvok:
    v_bfe_u32 v62, v61, 1, 1
    v_ashrrev_i32 v61, 8, v61
    v_sub_u32 v59, 0, v61
    v_cmp_eq_u32 vcc, s23, v62
    s_mov_b32 s21, 0
    s_nop 1
    v_cndmask_b32 v61, v59, v61, vcc
    s_nop 1
    v_readlane_b32 s22, v61, 0
    s_add_i32 s21, s21, s22
    v_readlane_b32 s22, v61, 1
    s_add_i32 s21, s21, s22
    v_readlane_b32 s22, v61, 2
    s_add_i32 s21, s21, s22
    v_readlane_b32 s22, v61, 3
    s_add_i32 s21, s21, s22
    v_readlane_b32 s22, v61, 4
    s_add_i32 s21, s21, s22
    v_readlane_b32 s22, v61, 5
    s_add_i32 s21, s21, s22
    v_readlane_b32 s22, v61, 6
    s_add_i32 s21, s21, s22
    v_readlane_b32 s22, v61, 7
    s_add_i32 s21, s21, s22
    s_cmp_gt_i32 s21, 0
    s_cselect_b32 s21, 0x2000, 0
    v_mov_b32 v59, s21
    ds_write_b32 v58, v59 offset:4
    s_waitcnt lgkmcnt(0)
ch_xcc_skip:
    s_barrier
    s_barrier
    s_lshl_b32 s60, s12, 4
    s_add_u32 s60, s60, 218104320
    s_barrier
ch_g0:
    buffer_load_dword v57, off, s[4:7], s60 sc1
    s_waitcnt vmcnt(0)
    v_readfirstlane_b32 s21, v57
    s_cmp_ge_u32 s21, 12
    s_cbranch_scc1 ch_g0b
    s_sleep 8
    s_sub_u32 s26, s26, 1
    s_cbranch_scc0 ch_g0
    s_mov_b32 s26, 0
ch_g0b:
    s_add_u32 s21, s16, 0
    s_lshl_b32 s21, s21, 18
    s_add_u32 s21, s21, s46
    s_add_u32 s21, s21, 37748736
    s_add_u32 s22, s21, 131072
    buffer_load_dwordx4 v[160:163], v0, s[4:7], s21 offen offset:0 sc1
    buffer_load_dwordx4 v[164:167], v0, s[4:7], s21 offen offset:1024 sc1
    buffer_load_dwordx4 v[168:171], v0, s[4:7], s21 offen offset:2048 sc1
    buffer_load_dwordx4 v[172:175], v0, s[4:7], s21 offen offset:3072 sc1
    buffer_load_dwordx4 v[176:179], v0, s[4:7], s22 offen offset:0 sc1
    buffer_load_dwordx4 v[180:183], v0, s[4:7], s22 offen offset:1024 sc1
    buffer_load_dwordx4 v[184:187], v0, s[4:7], s22 offen offset:2048 sc1
    buffer_load_dwordx4 v[188:191], v0, s[4:7], s22 offen offset:3072 sc1
    s_add_u32 s21, s16, 0
    s_lshl_b32 s21, s21, 18
    s_add_u32 s21, s21, s46
    s_add_u32 s21, s21, 20971520
    s_add_u32 s22, s21, 131072
    buffer_load_dwordx4 v[98:101], v0, s[4:7], s21 offen offset:0 sc1
    buffer_load_dwordx4 v[102:105], v0, s[4:7], s21 offen offset:1024 sc1
    buffer_load_dwordx4 v[106:109], v0, s[4:7], s21 offen offset:2048 sc1
    buffer_load_dwordx4 v[110:113], v0, s[4:7], s21 offen offset:3072 sc1
    buffer_load_dwordx4 v[114:117], v0, s[4:7], s22 offen offset:0 sc1
    buffer_load_dwordx4 v[118:121], v0, s[4:7], s22 offen offset:1024 sc1
    buffer_load_dwordx4 v[122:125], v0, s[4:7], s22 offen offset:2048 sc1
    buffer_load_dwordx4 v[126:129], v0, s[4:7], s22 offen offset:3072 sc1
    s_waitcnt vmcnt(8)
    v_mfma_f32_16x16x32_bf16 v[50:53], v[160:163], v[192:195], 0
    v_mfma_f32_16x16x32_bf16 v[54:57], v[160:163], v[200:203], 0
    v_mfma_f32_16x16x32_bf16 v[58:61], v[160:163], v[208:211], 0
    v_mfma_f32_16x16x32_bf16 v[62:65], v[160:163], v[216:219], 0
    v_mfma_f32_16x16x32_bf16 v[66:69], v[176:179], v[192:195], 0
    v_mfma_f32_16x16x32_bf16 v[70:73], v[176:179], v[200:203], 0
    v_mfma_f32_16x16x32_bf16 v[74:77], v[176:179], v[208:211], 0
    v_mfma_f32_16x16x32_bf16 v[78:81], v[176:179], v[216:219], 0
    v_mfma_f32_16x16x32_bf16 v[50:53], v[164:167], v[196:199], v[50:53]
    v_mfma_f32_16x16x32_bf16 v[54:57], v[164:167], v[204:207], v[54:57]
    v_mfma_f32_16x16x32_bf16 v[58:61], v[164:167], v[212:215], v[58:61]
    v_mfma_f32_16x16x32_bf16 v[62:65], v[164:167], v[220:223], v[62:65]
    v_mfma_f32_16x16x32_bf16 v[66:69], v[180:183], v[196:199], v[66:69]
    v_mfma_f32_16x16x32_bf16 v[70:73], v[180:183], v[204:207], v[70:73]
    v_mfma_f32_16x16x32_bf16 v[74:77], v[180:183], v[212:215], v[74:77]
    v_mfma_f32_16x16x32_bf16 v[78:81], v[180:183], v[220:223], v[78:81]
    v_mfma_f32_16x16x32_bf16 v[50:53], v[168:171], v[224:227], v[50:53]
    v_mfma_f32_16x16x32_bf16 v[54:57], v[168:171], v[232:235], v[54:57]
    v_mfma_f32_16x16x32_bf16 v[58:61], v[168:171], v[240:243], v[58:61]
    v_mfma_f32_16x16x32_bf16 v[62:65], v[168:171], v[248:251], v[62:65]
    v_mfma_f32_16x16x32_bf16 v[66:69], v[184:187], v[224:227], v[66:69]
    v_mfma_f32_16x16x32_bf16 v[70:73], v[184:187], v[232:235], v[70:73]
    v_mfma_f32_16x16x32_bf16 v[74:77], v[184:187], v[240:243], v[74:77]
    v_mfma_f32_16x16x32_bf16 v[78:81], v[184:187], v[248:251], v[78:81]
    v_mfma_f32_16x16x32_bf16 v[50:53], v[172:175], v[228:231], v[50:53]
    v_mfma_f32_16x16x32_bf16 v[54:57], v[172:175], v[236:239], v[54:57]
    v_mfma_f32_16x16x32_bf16 v[58:61], v[172:175], v[244:247], v[58:61]
    v_mfma_f32_16x16x32_bf16 v[62:65], v[172:175], v[252:255], v[62:65]
    v_mfma_f32_16x16x32_bf16 v[66:69], v[188:191], v[228:231], v[66:69]
    v_mfma_f32_16x16x32_bf16 v[70:73], v[188:191], v[236:239], v[70:73]
    v_mfma_f32_16x16x32_bf16 v[74:77], v[188:191], v[244:247], v[74:77]
    v_mfma_f32_16x16x32_bf16 v[78:81], v[188:191], v[252:255], v[78:81]
    s_add_u32 s21, s16, 1
    s_lshl_b32 s21, s21, 18
    s_add_u32 s21, s21, s46
    s_add_u32 s21, s21, 37748736
    s_add_u32 s22, s21, 131072
    buffer_load_dwordx4 v[160:163], v0, s[4:7], s21 offen offset:0 sc1
    buffer_load_dwordx4 v[164:167], v0, s[4:7], s21 offen offset:1024 sc1
    buffer_load_dwordx4 v[168:171], v0, s[4:7], s21 offen offset:2048 sc1
    buffer_load_dwordx4 v[172:175], v0, s[4:7], s21 offen offset:3072 sc1
    buffer_load_dwordx4 v[176:179], v0, s[4:7], s22 offen offset:0 sc1
    buffer_load_dwordx4 v[180:183], v0, s[4:7], s22 offen offset:1024 sc1
    buffer_load_dwordx4 v[184:187], v0, s[4:7], s22 offen offset:2048 sc1
    buffer_load_dwordx4 v[188:191], v0, s[4:7], s22 offen offset:3072 sc1
    s_mov_b32 s34, 1
    s_nop 7
    v_cvt_pk_bf16_f32 v82, v50, v51
    v_cvt_pk_bf16_f32 v83, v52, v53
    v_cvt_pk_bf16_f32 v84, v66, v67
    v_cvt_pk_bf16_f32 v85, v68, v69
    v_cvt_pk_bf16_f32 v86, v54, v55
    v_cvt_pk_bf16_f32 v87, v56, v57
    v_cvt_pk_bf16_f32 v88, v70, v71
    v_cvt_pk_bf16_f32 v89, v72, v73
    v_cvt_pk_bf16_f32 v90, v58, v59
    v_cvt_pk_bf16_f32 v91, v60, v61
    v_cvt_pk_bf16_f32 v92, v74, v75
    v_cvt_pk_bf16_f32 v93, v76, v77
    v_cvt_pk_bf16_f32 v94, v62, v63
    v_cvt_pk_bf16_f32 v95, v64, v65
    v_cvt_pk_bf16_f32 v96, v78, v79
    v_cvt_pk_bf16_f32 v97, v80, v81
    v_mov_b32 v74, 0
    v_mov_b32 v75, 0
    v_mov_b32 v76, 0
    v_mov_b32 v77, 0
    v_mov_b32 v78, 0
    v_mov_b32 v79, 0
    v_mov_b32 v80, 0
    v_mov_b32 v81, 0
    v_mov_b32 v146, 0
    v_mov_b32 v147, 0
    v_mov_b32 v148, 0
    v_mov_b32 v149, 0
    v_mov_b32 v150, 0
    v_mov_b32 v151, 0
    v_mov_b32 v152, 0
    v_mov_b32 v153, 0
    v_mov_b32 v12, 0
    v_mov_b32 v13, 0
    v_mov_b32 v14, 0
    v_mov_b32 v15, 0
    v_mov_b32 v16, 0
    v_mov_b32 v17, 0
    v_mov_b32 v18, 0
    v_mov_b32 v19, 0
    v_mov_b32 v20, 0
    v_mov_b32 v21, 0
    v_mov_b32 v22, 0
    v_mov_b32 v23, 0
    v_mov_b32 v2, 0
    s_add_u32 s21, s17, s32
    s_add_u32 s22, s21, 4096
    s_setprio 2
    s_branch a_zl
.p2align 6
    s_nop 0
    s_nop 0
    s_nop 0
    s_nop 0
    s_nop 0
    s_nop 0
    s_nop 0
    s_nop 0
aloop_24:
    s_add_u32 s21, s17, s32
    s_add_u32 s22, s21, 4096
    v_mov_b32 v74, 0
    v_mov_b32 v75, 0
    v_mov_b32 v76, 0
    v_mov_b32 v77, 0
    v_mov_b32 v78, 0
    v_mov_b32 v79, 0
    v_mov_b32 v80, 0
    v_mov_b32 v81, 0
    v_mov_b32 v146, 0
    v_mov_b32 v147, 0
    v_mov_b32 v148, 0
    v_mov_b32 v149, 0
    v_mov_b32 v150, 0
    v_mov_b32 v151, 0
    v_mov_b32 v152, 0
    v_mov_b32 v153, 0
    s_add_u32 s30, s16, 1
    s_lshl_b32 s30, s30, 18
    s_add_u32 s30, s30, s46
    s_add_u32 s30, s30, 37748736
    s_add_u32 s31, s30, 131072
aloop_24_wm:
    ds_read_b32 v3, v47
    s_waitcnt lgkmcnt(0)
    v_readfirstlane_b32 s23, v3
    s_cmp_eq_u32 s23, s16
    s_cbranch_scc1 aloop_24_wmok
    s_sleep 1
    s_branch aloop_24_wm
aloop_24_wmok:
    buffer_load_dwordx4 v[160:163], v0, s[4:7], s30 offen offset:0 sc1
    buffer_load_dwordx4 v[164:167], v0, s[4:7], s30 offen offset:1024 sc1
    buffer_load_dwordx4 v[168:171], v0, s[4:7], s30 offen offset:2048 sc1
    buffer_load_dwordx4 v[172:175], v0, s[4:7], s30 offen offset:3072 sc1
    buffer_load_dwordx4 v[176:179], v0, s[4:7], s31 offen offset:0 sc1
    buffer_load_dwordx4 v[180:183], v0, s[4:7], s31 offen offset:1024 sc1
    buffer_load_dwordx4 v[184:187], v0, s[4:7], s31 offen offset:2048 sc1
    buffer_load_dwordx4 v[188:191], v0, s[4:7], s31 offen offset:3072 sc1
aloop_24_nv:
    s_setprio 2
    v_mov_b32 v2, s16
    s_barrier
    s_nop 15
    s_nop 13
    ds_read_b128 v[98:101], v49 offset:0
    ds_read_b128 v[102:105], v49 offset:1024
    ds_read_b128 v[106:109], v49 offset:2048
    ds_read_b128 v[110:113], v49 offset:3072
    ds_read_b128 v[114:117], v49 offset:4096
    ds_read_b128 v[118:121], v49 offset:5120
    ds_read_b128 v[122:125], v49 offset:6144
    ds_read_b128 v[126:129], v49 offset:7168
    v_mov_b32 v12, 0
    v_mov_b32 v13, 0
    v_mov_b32 v14, 0
    v_mov_b32 v15, 0
    v_mov_b32 v16, 0
    v_mov_b32 v17, 0
    v_mov_b32 v18, 0
    v_mov_b32 v19, 0
    v_mov_b32 v20, 0
    v_mov_b32 v21, 0
    v_mov_b32 v22, 0
    v_mov_b32 v23, 0
    s_sleep 3
    s_nop 13
a_zl:
    buffer_load_dwordx4 v[50:53], v0, s[4:7], s21 offen offset:0 sc1
    s_nop 7
    buffer_load_dwordx4 v[54:57], v0, s[4:7], s21 offen offset:1024 sc1
    s_nop 7
    buffer_load_dwordx4 v[58:61], v0, s[4:7], s21 offen offset:2048 sc1
    s_nop 7
    buffer_load_dwordx4 v[62:65], v0, s[4:7], s21 offen offset:3072 sc1
    s_nop 7
    buffer_load_dwordx4 v[66:69], v0, s[4:7], s22 offen offset:0 sc1
    s_nop 7
    buffer_load_dwordx4 v[70:73], v0, s[4:7], s22 offen offset:1024 sc1
    s_waitcnt lgkmcnt(0)
    s_waitcnt vmcnt(5)
    v_max3_u32 v3, v50, v51, v52
    v_max_u32 v3, v3, v53
    v_cmp_eq_u32 vcc, -1, v3
    s_cbranch_vccnz arq_25_0
arq_25_0ok:
    v_mfma_f32_16x16x32_bf16 v[12:15], v[98:101], v[50:53], v[12:15]
    v_mfma_f32_16x16x32_bf16 v[16:19], v[114:117], v[50:53], v[16:19]
    s_waitcnt vmcnt(4)
    v_max3_u32 v3, v54, v55, v56
    v_max_u32 v3, v3, v57
    v_cmp_eq_u32 vcc, -1, v3
    v_mfma_f32_16x16x32_bf16 v[20:23], v[50:53], v[50:53], v[20:23]
    s_cbranch_vccnz arq_25_1
arq_25_1ok:
    v_mfma_f32_16x16x32_bf16 v[12:15], v[102:105], v[54:57], v[12:15]
    v_mfma_f32_16x16x32_bf16 v[16:19], v[118:121], v[54:57], v[16:19]
    s_waitcnt vmcnt(3)
    v_max3_u32 v3, v58, v59, v60
    v_max_u32 v3, v3, v61
    v_cmp_eq_u32 vcc, -1, v3
    v_mfma_f32_16x16x32_bf16 v[20:23], v[54:57], v[54:57], v[20:23]
    s_cbranch_vccnz arq_25_2
arq_25_2ok:
    v_mfma_f32_16x16x32_bf16 v[12:15], v[106:109], v[58:61], v[12:15]
    v_mfma_f32_16x16x32_bf16 v[16:19], v[122:125], v[58:61], v[16:19]
    s_waitcnt vmcnt(2)
    v_max3_u32 v3, v62, v63, v64
    v_max_u32 v3, v3, v65
    v_cmp_eq_u32 vcc, -1, v3
    v_mfma_f32_16x16x32_bf16 v[20:23], v[58:61], v[58:61], v[20:23]
    s_cbranch_vccnz arq_25_3
arq_25_3ok:
    v_mfma_f32_16x16x32_bf16 v[12:15], v[110:113], v[62:65], v[12:15]
    ds_write_b32 v47, v2 offset:16
    v_mfma_f32_16x16x32_bf16 v[16:19], v[126:129], v[62:65], v[16:19]
    v_mfma_f32_16x16x32_bf16 v[20:23], v[62:65], v[62:65], v[20:23]
aloop_24_sdone:
    s_nop 0
    s_cmp_eq_u32 s16, 63
    s_cbranch_scc1 aloop_24_lsk
    s_nop 1
    v_exp_f32 v54, v12
    v_exp_f32 v55, v13
    s_waitcnt vmcnt(0)
    v_max3_u32 v24, v66, v67, v68
    v_max3_u32 v24, v24, v69, v70
    v_max3_u32 v24, v24, v71, v72
    v_max_u32 v24, v24, v73
    v_cmp_eq_u32 vcc, -1, v24
    s_cbranch_vccnz arq_25_v
    v_smfmac_f32_16x16x64_bf16 v[74:77], v[66:69], v[192:199], v41
    v_exp_f32 v56, v14
    v_smfmac_f32_16x16x64_bf16 v[78:81], v[66:69], v[200:207], v41
    v_exp_f32 v57, v15
    v_smfmac_f32_16x16x64_bf16 v[146:149], v[66:69], v[208:215], v41
    v_exp_f32 v58, v16
    v_smfmac_f32_16x16x64_bf16 v[150:153], v[66:69], v[216:223], v41
    v_exp_f32 v59, v17
    v_smfmac_f32_16x16x64_bf16 v[74:77], v[70:73], v[224:231], v41
    v_exp_f32 v60, v18
    v_smfmac_f32_16x16x64_bf16 v[78:81], v[70:73], v[232:239], v41
    v_exp_f32 v61, v19
    v_smfmac_f32_16x16x64_bf16 v[146:149], v[70:73], v[240:247], v41
    v_exp_f32 v62, v20
    v_smfmac_f32_16x16x64_bf16 v[150:153], v[70:73], v[248:255], v41
    v_exp_f32 v63, v21
    v_cvt_pk_bf16_f32 v154, v54, v55
    v_cvt_pk_bf16_f32 v155, v56, v57
    v_cvt_pk_bf16_f32 v156, v58, v59
    v_cvt_pk_bf16_f32 v157, v60, v61
    v_cvt_pk_bf16_f32 v8, v62, v63
    v_max3_f32 v2, |v12|, |v13|, |v14|
    v_mfma_f32_16x16x32_bf16 v[50:53], v[154:157], v[4:7], 0
    v_max3_f32 v3, |v15|, |v16|, |v17|
    v_add_f32 v74, v74, v75
    v_mfma_f32_16x16x32_bf16 v[50:53], v[8:11], v[4:7], v[50:53]
    v_add_f32 v76, v76, v77
    v_cvt_pk_bf16_f32 v40, v74, v76
    v_mfma_f32_16x16x32_bf16 v[24:27], v[154:157], v[82:85], 0
    v_add_f32 v78, v78, v79
    v_add_f32 v80, v80, v81
    v_mfma_f32_16x16x32_bf16 v[24:27], v[8:11], v[40:43], v[24:27]
    v_cvt_pk_bf16_f32 v42, v78, v80
    v_add_f32 v146, v146, v147
    v_mfma_f32_16x16x32_bf16 v[28:31], v[154:157], v[86:89], 0
    v_add_f32 v148, v148, v149
    v_cvt_pk_bf16_f32 v44, v146, v148
    v_mfma_f32_16x16x32_bf16 v[28:31], v[8:11], v[42:45], v[28:31]
    v_add_f32 v150, v150, v151
    v_add_f32 v152, v152, v153
    v_mfma_f32_16x16x32_bf16 v[32:35], v[154:157], v[90:93], 0
    v_cvt_pk_bf16_f32 v46, v150, v152
    v_rcp_f32 v52, v52
    v_mfma_f32_16x16x32_bf16 v[32:35], v[8:11], v[44:47], v[32:35]
    v_rcp_f32 v53, v53
    v_max3_f32 v2, v2, |v18|, |v19|
    v_mfma_f32_16x16x32_bf16 v[36:39], v[154:157], v[94:97], 0
    v_max3_f32 v3, v3, |v20|, |v21|
    v_max_f32 v2, v2, v3
    v_mfma_f32_16x16x32_bf16 v[36:39], v[8:11], v[46:49], v[36:39]
    v_cmp_nle_f32 vcc, v2, v158
    v_mul_f32 v26, v26, v52
    v_mul_f32 v27, v27, v53
    s_cbranch_vccnz aloop_24_tm
    v_mul_f32 v30, v30, v52
    v_mul_f32 v31, v31, v53
aloop_24_pvd:
    ds_write_b64 v45, v[26:27] offset:0
    v_mul_f32 v34, v34, v52
    v_mul_f32 v35, v35, v53
    ds_write_b64 v45, v[30:31] offset:544
    v_mul_f32 v38, v38, v52
    v_mul_f32 v39, v39, v53
    ds_write_b64 v45, v[34:35] offset:1088
    ds_write_b64 v45, v[38:39] offset:1632
aloop_24_lskb:
    s_waitcnt lgkmcnt(0)
    s_barrier
    s_setprio 0
    s_cmp_lg_u32 s27, 0
    s_cbranch_scc1 pg_26
    s_sub_u32 s25, s16, 1
    s_cbranch_scc1 pg_26
    v_mov_b32 v3, s25
    s_mov_b64 exec, 1
    buffer_store_dword v3, off, s[4:7], s62 sc1
    s_mov_b64 exec, -1
pg_26:
    s_add_u32 s21, s17, s33
    v_lshlrev_b32 v2, 1, v43
    s_cmp_eq_u32 s16, 63
    s_cbranch_scc1 aloop_24_nvw
    v_mfma_f32_16x16x32_bf16 v[50:53], v[160:163], v[192:195], 0
    v_mfma_f32_16x16x32_bf16 v[54:57], v[160:163], v[200:203], 0
    v_mfma_f32_16x16x32_bf16 v[58:61], v[160:163], v[208:211], 0
    v_mfma_f32_16x16x32_bf16 v[62:65], v[160:163], v[216:219], 0
    v_mfma_f32_16x16x32_bf16 v[66:69], v[176:179], v[192:195], 0
    v_mfma_f32_16x16x32_bf16 v[70:73], v[176:179], v[200:203], 0
    v_mfma_f32_16x16x32_bf16 v[74:77], v[176:179], v[208:211], 0
    v_mfma_f32_16x16x32_bf16 v[78:81], v[176:179], v[216:219], 0
    v_mfma_f32_16x16x32_bf16 v[50:53], v[164:167], v[196:199], v[50:53]
    v_mfma_f32_16x16x32_bf16 v[54:57], v[164:167], v[204:207], v[54:57]
    v_mfma_f32_16x16x32_bf16 v[58:61], v[164:167], v[212:215], v[58:61]
    v_mfma_f32_16x16x32_bf16 v[62:65], v[164:167], v[220:223], v[62:65]
    v_mfma_f32_16x16x32_bf16 v[66:69], v[180:183], v[196:199], v[66:69]
    v_mfma_f32_16x16x32_bf16 v[70:73], v[180:183], v[204:207], v[70:73]
    v_mfma_f32_16x16x32_bf16 v[74:77], v[180:183], v[212:215], v[74:77]
    v_mfma_f32_16x16x32_bf16 v[78:81], v[180:183], v[220:223], v[78:81]
    v_mfma_f32_16x16x32_bf16 v[50:53], v[168:171], v[224:227], v[50:53]
    v_mfma_f32_16x16x32_bf16 v[54:57], v[168:171], v[232:235], v[54:57]
    v_mfma_f32_16x16x32_bf16 v[58:61], v[168:171], v[240:243], v[58:61]
    v_mfma_f32_16x16x32_bf16 v[62:65], v[168:171], v[248:251], v[62:65]
    v_mfma_f32_16x16x32_bf16 v[66:69], v[184:187], v[224:227], v[66:69]
    v_mfma_f32_16x16x32_bf16 v[70:73], v[184:187], v[232:235], v[70:73]
    v_mfma_f32_16x16x32_bf16 v[74:77], v[184:187], v[240:243], v[74:77]
    v_mfma_f32_16x16x32_bf16 v[78:81], v[184:187], v[248:251], v[78:81]
    v_mfma_f32_16x16x32_bf16 v[50:53], v[172:175], v[228:231], v[50:53]
    v_mfma_f32_16x16x32_bf16 v[54:57], v[172:175], v[236:239], v[54:57]
    v_mfma_f32_16x16x32_bf16 v[58:61], v[172:175], v[244:247], v[58:61]
    v_mfma_f32_16x16x32_bf16 v[62:65], v[172:175], v[252:255], v[62:65]
    v_mfma_f32_16x16x32_bf16 v[66:69], v[188:191], v[228:231], v[66:69]
    v_mfma_f32_16x16x32_bf16 v[70:73], v[188:191], v[236:239], v[70:73]
    v_mfma_f32_16x16x32_bf16 v[74:77], v[188:191], v[244:247], v[74:77]
    v_mfma_f32_16x16x32_bf16 v[78:81], v[188:191], v[252:255], v[78:81]
    buffer_load_dwordx4 v[130:133], v0, s[4:7], s21 offen sc1
    buffer_load_dwordx2 v[146:147], v2, s[4:7], s21 offen offset:1024 sc1
    buffer_load_dwordx4 v[134:137], v0, s[4:7], s21 offen offset:2048 sc1
    buffer_load_dwordx2 v[148:149], v2, s[4:7], s21 offen offset:3072 sc1
    s_add_u32 s30, s16, 2
    s_lshl_b32 s30, s30, 18
    s_add_u32 s30, s30, s46
    s_add_u32 s30, s30, 37748736
    s_add_u32 s31, s30, 131072
    s_branch aloop_24_vwd
aloop_24_nvw:
    buffer_load_dwordx4 v[130:133], v0, s[4:7], s21 offen sc1
    buffer_load_dwordx2 v[146:147], v2, s[4:7], s21 offen offset:1024 sc1
    buffer_load_dwordx4 v[134:137], v0, s[4:7], s21 offen offset:2048 sc1
    buffer_load_dwordx2 v[148:149], v2, s[4:7], s21 offen offset:3072 sc1
aloop_24_vwd:
    v_add_u32 v48, s68, v1
    s_xor_b32 s68, s68, 8192
aloop_24_psa:
    s_waitcnt vmcnt(0)
    v_max3_u32 v3, v130, v131, v132
    v_max3_u32 v3, v3, v133, v134
    v_max3_u32 v3, v3, v135, v136
    v_max3_u32 v3, v3, v137, v146
    v_max3_u32 v3, v3, v147, v148
    v_max_u32 v3, v3, v149
    v_cmp_eq_u32 vcc, -1, v3
    s_cbranch_vccnz arq_25_ps
aloop_24_psok:
    v_mfma_f32_16x16x32_bf16 v[24:27], v[82:85], v[130:133], 0
    v_mfma_f32_16x16x32_bf16 v[28:31], v[86:89], v[130:133], 0
    v_mfma_f32_16x16x32_bf16 v[32:35], v[90:93], v[130:133], 0
    v_mfma_f32_16x16x32_bf16 v[36:39], v[94:97], v[130:133], 0
    v_mov_b32 v138, v146
    v_mfma_f32_16x16x32_bf16 v[12:15], v[82:85], v[134:137], 0
    v_mfma_f32_16x16x32_bf16 v[16:19], v[86:89], v[134:137], 0
    v_mfma_f32_16x16x32_bf16 v[20:23], v[90:93], v[134:137], 0
    v_mfma_f32_16x16x32_bf16 v[154:157], v[94:97], v[134:137], 0
    v_mov_b32 v142, v148
    v_mfma_f32_16x16x32_bf16 v[24:27], v[40:43], v[138:141], v[24:27]
    v_mfma_f32_16x16x32_bf16 v[28:31], v[42:45], v[138:141], v[28:31]
    v_mfma_f32_16x16x32_bf16 v[32:35], v[44:47], v[138:141], v[32:35]
    v_mfma_f32_16x16x32_bf16 v[36:39], v[46:49], v[138:141], v[36:39]
    v_mfma_f32_16x16x32_bf16 v[12:15], v[40:43], v[142:145], v[12:15]
    v_mfma_f32_16x16x32_bf16 v[16:19], v[42:45], v[142:145], v[16:19]
    v_mfma_f32_16x16x32_bf16 v[20:23], v[44:47], v[142:145], v[20:23]
    s_nop 1
    v_mfma_f32_16x16x32_bf16 v[154:157], v[46:49], v[142:145], v[154:157]
aloop_24_nev:
    ds_write_b128 v48, v[24:27] offset:2176
    v_cvt_pk_bf16_f32 v82, v50, v51
    v_cvt_pk_bf16_f32 v83, v52, v53
    ds_write_b128 v48, v[28:31] offset:3200
    v_cvt_pk_bf16_f32 v84, v66, v67
    v_cvt_pk_bf16_f32 v85, v68, v69
    ds_write_b128 v48, v[32:35] offset:4224
    v_cvt_pk_bf16_f32 v86, v54, v55
    v_cvt_pk_bf16_f32 v87, v56, v57
    ds_write_b128 v48, v[36:39] offset:5248
    v_cvt_pk_bf16_f32 v88, v70, v71
    v_cvt_pk_bf16_f32 v89, v72, v73
    ds_write_b128 v48, v[12:15] offset:6272
    v_cvt_pk_bf16_f32 v90, v58, v59
    v_cvt_pk_bf16_f32 v91, v60, v61
    ds_write_b128 v48, v[16:19] offset:7296
    v_cvt_pk_bf16_f32 v92, v74, v75
    v_cvt_pk_bf16_f32 v93, v76, v77
    ds_write_b128 v48, v[20:23] offset:8320
    v_cvt_pk_bf16_f32 v94, v62, v63
    v_cvt_pk_bf16_f32 v95, v64, v65
    ds_write_b128 v48, v[154:157] offset:9344
    v_cvt_pk_bf16_f32 v96, v78, v79
    v_cvt_pk_bf16_f32 v97, v80, v81
aloop_24_bgskip:
    s_waitcnt lgkmcnt(0)
    s_cmp_eq_u32 s16, 63
    s_cbranch_scc1 aloop_24_fin
    s_add_u32 s16, s16, 1
    s_mov_b32 s17, s18
    s_mov_b32 s18, s19
    s_mov_b32 s19, s20
    s_add_u32 s20, s20, 262144
    s_cmp_eq_u32 s20, 210763776
    s_cselect_b32 s20, 209715200, s20
    s_branch aloop_24
arq_25_0:
    s_sub_u32 s26, s26, 1
    s_cbranch_scc1 arq_25_0_g
    buffer_load_dwordx4 v[50:53], v0, s[4:7], s21 offen offset:0 sc1
    buffer_load_dwordx4 v[54:57], v0, s[4:7], s21 offen offset:1024 sc1
    buffer_load_dwordx4 v[58:61], v0, s[4:7], s21 offen offset:2048 sc1
    buffer_load_dwordx4 v[62:65], v0, s[4:7], s21 offen offset:3072 sc1
    buffer_load_dwordx4 v[66:69], v0, s[4:7], s22 offen offset:0 sc1
    buffer_load_dwordx4 v[70:73], v0, s[4:7], s22 offen offset:1024 sc1
    s_waitcnt vmcnt(5)
    v_max3_u32 v3, v50, v51, v52
    v_max_u32 v3, v3, v53
    v_cmp_eq_u32 vcc, -1, v3
    s_cbranch_vccnz arq_25_0
    s_branch arq_25_0ok
arq_25_0_g:
    s_mov_b32 s26, 0
    s_waitcnt vmcnt(0)
    s_branch arq_25_0ok
arq_25_1:
    s_sub_u32 s26, s26, 1
    s_cbranch_scc1 arq_25_1_g
    buffer_load_dwordx4 v[54:57], v0, s[4:7], s21 offen offset:1024 sc1
    buffer_load_dwordx4 v[58:61], v0, s[4:7], s21 offen offset:2048 sc1
    buffer_load_dwordx4 v[62:65], v0, s[4:7], s21 offen offset:3072 sc1
    buffer_load_dwordx4 v[66:69], v0, s[4:7], s22 offen offset:0 sc1
    buffer_load_dwordx4 v[70:73], v0, s[4:7], s22 offen offset:1024 sc1
    s_waitcnt vmcnt(4)
    v_max3_u32 v3, v54, v55, v56
    v_max_u32 v3, v3, v57
    v_cmp_eq_u32 vcc, -1, v3
    s_cbranch_vccnz arq_25_1
    s_branch arq_25_1ok
arq_25_1_g:
    s_mov_b32 s26, 0
    s_waitcnt vmcnt(0)
    s_branch arq_25_1ok
arq_25_2:
    s_sub_u32 s26, s26, 1
    s_cbranch_scc1 arq_25_2_g
    buffer_load_dwordx4 v[58:61], v0, s[4:7], s21 offen offset:2048 sc1
    buffer_load_dwordx4 v[62:65], v0, s[4:7], s21 offen offset:3072 sc1
    buffer_load_dwordx4 v[66:69], v0, s[4:7], s22 offen offset:0 sc1
    buffer_load_dwordx4 v[70:73], v0, s[4:7], s22 offen offset:1024 sc1
    s_waitcnt vmcnt(3)
    v_max3_u32 v3, v58, v59, v60
    v_max_u32 v3, v3, v61
    v_cmp_eq_u32 vcc, -1, v3
    s_cbranch_vccnz arq_25_2
    s_branch arq_25_2ok
arq_25_2_g:
    s_mov_b32 s26, 0
    s_waitcnt vmcnt(0)
    s_branch arq_25_2ok
arq_25_3:
    s_sub_u32 s26, s26, 1
    s_cbranch_scc1 arq_25_3_g
    buffer_load_dwordx4 v[62:65], v0, s[4:7], s21 offen offset:3072 sc1
    buffer_load_dwordx4 v[66:69], v0, s[4:7], s22 offen offset:0 sc1
    buffer_load_dwordx4 v[70:73], v0, s[4:7], s22 offen offset:1024 sc1
    s_waitcnt vmcnt(2)
    v_max3_u32 v3, v62, v63, v64
    v_max_u32 v3, v3, v65
    v_cmp_eq_u32 vcc, -1, v3
    s_cbranch_vccnz arq_25_3
    s_branch arq_25_3ok
arq_25_3_g:
    s_mov_b32 s26, 0
    s_waitcnt vmcnt(0)
    s_branch arq_25_3ok
arq_25_v:
    buffer_load_dwordx4 v[66:69], v0, s[4:7], s22 offen offset:0 sc1
    buffer_load_dwordx4 v[70:73], v0, s[4:7], s22 offen offset:1024 sc1
    v_max3_f32 v2, v12, v13, v14
    v_max3_f32 v3, v15, v16, v17
    v_max3_f32 v2, v2, v18, v19
    v_max3_f32 v3, v3, v20, v21
    v_max_f32 v2, v2, v3
    v_mov_b32 v3, v2
    s_nop 1
    v_permlane16_swap_b32 v3, v2
    v_max_f32 v2, v2, v3
    v_mov_b32 v3, v2
    s_nop 1
    v_permlane32_swap_b32 v3, v2
    v_max_f32 v2, v2, v3
    v_sub_f32 v12, v12, v2
    v_sub_f32 v13, v13, v2
    v_sub_f32 v14, v14, v2
    v_sub_f32 v15, v15, v2
    v_sub_f32 v16, v16, v2
    v_sub_f32 v17, v17, v2
    v_sub_f32 v18, v18, v2
    v_sub_f32 v19, v19, v2
    v_sub_f32 v20, v20, v2
    v_sub_f32 v21, v21, v2
    v_exp_f32 v54, v12
    v_exp_f32 v55, v13
    v_exp_f32 v56, v14
    v_exp_f32 v57, v15
    v_exp_f32 v58, v16
    v_exp_f32 v59, v17
    v_exp_f32 v60, v18
    v_exp_f32 v61, v19
    v_exp_f32 v62, v20
    v_exp_f32 v63, v21
    s_nop 0
    v_cvt_pk_bf16_f32 v154, v54, v55
    v_cvt_pk_bf16_f32 v155, v56, v57
    v_cvt_pk_bf16_f32 v156, v58, v59
    v_cvt_pk_bf16_f32 v157, v60, v61
    v_cvt_pk_bf16_f32 v8, v62, v63
    s_nop 0
    v_mfma_f32_16x16x32_bf16 v[50:53], v[154:157], v[4:7], 0
    v_mfma_f32_16x16x32_bf16 v[50:53], v[8:11], v[4:7], v[50:53]
    v_mfma_f32_16x16x32_bf16 v[24:27], v[154:157], v[82:85], 0
    v_mfma_f32_16x16x32_bf16 v[28:31], v[154:157], v[86:89], 0
    v_mfma_f32_16x16x32_bf16 v[32:35], v[154:157], v[90:93], 0
    v_mfma_f32_16x16x32_bf16 v[36:39], v[154:157], v[94:97], 0
arq_25_vs:
    s_waitcnt vmcnt(0)
    v_max3_u32 v3, v66, v67, v68
    v_max3_u32 v3, v3, v69, v70
    v_max3_u32 v3, v3, v71, v72
    v_max_u32 v3, v3, v73
    v_cmp_eq_u32 vcc, -1, v3
    s_cbranch_vccnz arq_25_vsr
    s_branch arq_25_vsok
arq_25_vsr:
    s_sub_u32 s26, s26, 1
    s_cbranch_scc1 arq_25_vsg
    buffer_load_dwordx4 v[66:69], v0, s[4:7], s22 offen offset:0 sc1
    buffer_load_dwordx4 v[70:73], v0, s[4:7], s22 offen offset:1024 sc1
    s_branch arq_25_vs
arq_25_vsg:
    s_mov_b32 s26, 0
arq_25_vsok:
    v_smfmac_f32_16x16x64_bf16 v[74:77], v[66:69], v[192:199], v41
    v_smfmac_f32_16x16x64_bf16 v[78:81], v[66:69], v[200:207], v41
    v_smfmac_f32_16x16x64_bf16 v[146:149], v[66:69], v[208:215], v41
    v_smfmac_f32_16x16x64_bf16 v[150:153], v[66:69], v[216:223], v41
    v_smfmac_f32_16x16x64_bf16 v[74:77], v[70:73], v[224:231], v41
    v_smfmac_f32_16x16x64_bf16 v[78:81], v[70:73], v[232:239], v41
    v_smfmac_f32_16x16x64_bf16 v[146:149], v[70:73], v[240:247], v41
    v_smfmac_f32_16x16x64_bf16 v[150:153], v[70:73], v[248:255], v41
    v_rcp_f32 v52, v52
    v_rcp_f32 v53, v53
    s_nop 2
    v_add_f32 v74, v74, v75
    v_add_f32 v76, v76, v77
    v_cvt_pk_bf16_f32 v40, v74, v76
    v_add_f32 v78, v78, v79
    v_add_f32 v80, v80, v81
    v_cvt_pk_bf16_f32 v42, v78, v80
    v_add_f32 v146, v146, v147
    v_add_f32 v148, v148, v149
    v_cvt_pk_bf16_f32 v44, v146, v148
    v_add_f32 v150, v150, v151
    v_add_f32 v152, v152, v153
    v_cvt_pk_bf16_f32 v46, v150, v152
    s_nop 1
    v_mfma_f32_16x16x32_bf16 v[24:27], v[8:11], v[40:43], v[24:27]
    v_mfma_f32_16x16x32_bf16 v[28:31], v[8:11], v[42:45], v[28:31]
    v_mfma_f32_16x16x32_bf16 v[32:35], v[8:11], v[44:47], v[32:35]
    v_mfma_f32_16x16x32_bf16 v[36:39], v[8:11], v[46:49], v[36:39]
    s_nop 4
    v_mul_f32 v26, v26, v52
    v_mul_f32 v27, v27, v53
    v_mul_f32 v30, v30, v52
    v_mul_f32 v31, v31, v53
    s_branch aloop_24_pvd
aloop_24_tm:
    s_nop 7
    v_max3_f32 v2, v12, v13, v14
    v_max3_f32 v3, v15, v16, v17
    v_max3_f32 v2, v2, v18, v19
    v_max3_f32 v3, v3, v20, v21
    v_max_f32 v2, v2, v3
    v_mov_b32 v3, v2
    s_nop 1
    v_permlane16_swap_b32 v3, v2
    v_max_f32 v2, v2, v3
    v_mov_b32 v3, v2
    s_nop 1
    v_permlane32_swap_b32 v3, v2
    v_max_f32 v2, v2, v3
    v_sub_f32 v12, v12, v2
    v_sub_f32 v13, v13, v2
    v_sub_f32 v14, v14, v2
    v_sub_f32 v15, v15, v2
    v_sub_f32 v16, v16, v2
    v_sub_f32 v17, v17, v2
    v_sub_f32 v18, v18, v2
    v_sub_f32 v19, v19, v2
    v_sub_f32 v20, v20, v2
    v_sub_f32 v21, v21, v2
    v_exp_f32 v54, v12
    v_exp_f32 v55, v13
    v_exp_f32 v56, v14
    v_exp_f32 v57, v15
    v_exp_f32 v58, v16
    v_exp_f32 v59, v17
    v_exp_f32 v60, v18
    v_exp_f32 v61, v19
    v_exp_f32 v62, v20
    v_exp_f32 v63, v21
    s_nop 0
    v_cvt_pk_bf16_f32 v154, v54, v55
    v_cvt_pk_bf16_f32 v155, v56, v57
    v_cvt_pk_bf16_f32 v156, v58, v59
    v_cvt_pk_bf16_f32 v157, v60, v61
    v_cvt_pk_bf16_f32 v8, v62, v63
    s_nop 0
    v_mfma_f32_16x16x32_bf16 v[50:53], v[154:157], v[4:7], 0
    v_mfma_f32_16x16x32_bf16 v[50:53], v[8:11], v[4:7], v[50:53]
    v_mfma_f32_16x16x32_bf16 v[24:27], v[154:157], v[82:85], 0
    v_mfma_f32_16x16x32_bf16 v[28:31], v[154:157], v[86:89], 0
    v_mfma_f32_16x16x32_bf16 v[32:35], v[154:157], v[90:93], 0
    v_mfma_f32_16x16x32_bf16 v[36:39], v[154:157], v[94:97], 0
    v_mfma_f32_16x16x32_bf16 v[24:27], v[8:11], v[40:43], v[24:27]
    v_mfma_f32_16x16x32_bf16 v[28:31], v[8:11], v[42:45], v[28:31]
    v_mfma_f32_16x16x32_bf16 v[32:35], v[8:11], v[44:47], v[32:35]
    v_mfma_f32_16x16x32_bf16 v[36:39], v[8:11], v[46:49], v[36:39]
    v_rcp_f32 v52, v52
    v_rcp_f32 v53, v53
    s_nop 4
    v_mul_f32 v26, v26, v52
    v_mul_f32 v27, v27, v53
    v_mul_f32 v30, v30, v52
    v_mul_f32 v31, v31, v53
    s_branch aloop_24_pvd
aloop_24_lz:
    buffer_load_dwordx4 v[66:69], v0, s[4:7], s22 offen offset:0 sc1
    buffer_load_dwordx4 v[70:73], v0, s[4:7], s22 offen offset:1024 sc1
    ds_write_b32 v47, v2 offset:16
aloop_24_lsk:
arq_25_vl:
    s_waitcnt vmcnt(0)
    v_max3_u32 v3, v66, v67, v68
    v_max3_u32 v3, v3, v69, v70
    v_max3_u32 v3, v3, v71, v72
    v_max_u32 v3, v3, v73
    v_cmp_eq_u32 vcc, -1, v3
    s_cbranch_vccnz arq_25_vlr
    s_branch arq_25_vlok
arq_25_vlr:
    s_sub_u32 s26, s26, 1
    s_cbranch_scc1 arq_25_vlg
    buffer_load_dwordx4 v[66:69], v0, s[4:7], s22 offen offset:0 sc1
    buffer_load_dwordx4 v[70:73], v0, s[4:7], s22 offen offset:1024 sc1
    s_branch arq_25_vl
arq_25_vlg:
    s_mov_b32 s26, 0
arq_25_vlok:
    v_smfmac_f32_16x16x64_bf16 v[74:77], v[66:69], v[192:199], v41
    v_smfmac_f32_16x16x64_bf16 v[78:81], v[66:69], v[200:207], v41
    v_smfmac_f32_16x16x64_bf16 v[146:149], v[66:69], v[208:215], v41
    v_smfmac_f32_16x16x64_bf16 v[150:153], v[66:69], v[216:223], v41
    v_smfmac_f32_16x16x64_bf16 v[74:77], v[70:73], v[224:231], v41
    v_smfmac_f32_16x16x64_bf16 v[78:81], v[70:73], v[232:239], v41
    v_smfmac_f32_16x16x64_bf16 v[146:149], v[70:73], v[240:247], v41
    v_smfmac_f32_16x16x64_bf16 v[150:153], v[70:73], v[248:255], v41
    s_nop 4
    v_add_f32 v74, v74, v75
    v_add_f32 v76, v76, v77
    v_cvt_pk_bf16_f32 v40, v74, v76
    v_add_f32 v78, v78, v79
    v_add_f32 v80, v80, v81
    v_cvt_pk_bf16_f32 v42, v78, v80
    v_add_f32 v146, v146, v147
    v_add_f32 v148, v148, v149
    v_cvt_pk_bf16_f32 v44, v146, v148
    v_add_f32 v150, v150, v151
    v_add_f32 v152, v152, v153
    v_cvt_pk_bf16_f32 v46, v150, v152
    s_branch aloop_24_lskb
arq_25_ps:
    s_sub_u32 s26, s26, 1
    s_cbranch_scc1 arq_25_psg
    s_sleep 2
    buffer_load_dwordx4 v[130:133], v0, s[4:7], s21 offen sc1
    buffer_load_dwordx2 v[146:147], v2, s[4:7], s21 offen offset:1024 sc1
    buffer_load_dwordx4 v[134:137], v0, s[4:7], s21 offen offset:2048 sc1
    buffer_load_dwordx2 v[148:149], v2, s[4:7], s21 offen offset:3072 sc1
    s_branch aloop_24_psa
arq_25_psg:
    s_mov_b32 s26, 0
    s_branch aloop_24_psok
aloop_24_fin:
    s_barrier
    s_branch k_end
k_end:
k_exit:
    s_endpgm
.section .rodata,"a"
.p2align 6
jobtab:
    .long 6, 24, 24, 8192, 0, 262144, 8388608, 0, 32768, 4, 20971520, 131072, 0, 0, 218104320, 1
    .long 4, 24, 24, 8192, 0, 262144, 8388608, 262144, 32768, 4, 22020096, 131072, 0, 0, 218104448, 1
    .long 1, 32, 32, 8192, 0, 256, 8388608, 1048576, 32768, 8, 41943040, 131072, 0, 0, 218104832, 4
    .long 1, 16, 16, 8192, 0, 256, 8388608, 2097152, 32768, 8, 12582912, 131072, 0, 0, 218105344, 4
    .long 1, 32, 32, 8192, 0, 256, 8388608, 3145728, 32768, 8, 50331648, 131072, 0, 0, 218105856, 4
    .long 1, 32, 32, 8192, 0, 256, 8388608, 3670016, 32768, 8, 52428800, 131072, 0, 0, 218106112, 4
    .long 1, 80, 80, 2048, 0, 256, 7340032, 54525952, 114688, 7, 167772160, 32768, 218103808, 7, 218106368, 1
    .long 0, 0, 0, 0, 0, 0, 0, 0, 0, 0, 0, 0, 0, 0, 0, 0
    .long 0, 0, 0, 0, 0, 0, 0, 0, 0, 0, 0, 0, 0, 0, 0, 0
    .long 0, 0, 0, 0, 0, 0, 0, 0, 0, 0, 0, 0, 0, 0, 0, 0
    .long 6, 24, 24, 8192, 2048, 264192, 8388608, 0, 32768, 4, 21004288, 131072, 0, 0, 218104352, 1
    .long 4, 24, 24, 8192, 2048, 264192, 8388608, 262144, 32768, 4, 22052864, 131072, 0, 0, 218104480, 1
    .long 1, 32, 32, 8192, 2048, 2304, 8388608, 1048576, 32768, 8, 41975808, 131072, 0, 0, 218104864, 4
    .long 1, 16, 16, 8192, 2048, 2304, 8388608, 2097152, 32768, 8, 12615680, 131072, 0, 0, 218105376, 4
    .long 1, 32, 32, 8192, 2048, 2304, 8388608, 3145728, 32768, 8, 50364416, 131072, 0, 0, 218105888, 4
    .long 1, 32, 32, 8192, 2048, 2304, 8388608, 3670016, 32768, 8, 52461568, 131072, 0, 0, 218106144, 4
    .long 1, 80, 80, 2048, 1835008, 1835264, 7340032, 54554624, 114688, 7, 171966464, 32768, 218103824, 7, 218106368, 1
    .long 0, 0, 0, 0, 0, 0, 0, 0, 0, 0, 0, 0, 0, 0, 0, 0
    .long 0, 0, 0, 0, 0, 0, 0, 0, 0, 0, 0, 0, 0, 0, 0, 0
    .long 0, 0, 0, 0, 0, 0, 0, 0, 0, 0, 0, 0, 0, 0, 0, 0
    .long 6, 24, 24, 8192, 4096, 266240, 8388608, 0, 32768, 4, 21037056, 131072, 0, 0, 218104384, 1
    .long 4, 24, 24, 8192, 4096, 266240, 8388608, 262144, 32768, 4, 22085632, 131072, 0, 0, 218104512, 1
    .long 1, 32, 32, 8192, 4096, 4352, 8388608, 1048576, 32768, 8, 42008576, 131072, 0, 0, 218104896, 4
    .long 1, 16, 16, 8192, 4096, 4352, 8388608, 2097152, 32768, 8, 12648448, 131072, 0, 0, 218105408, 4
    .long 1, 32, 32, 8192, 4096, 4352, 8388608, 3145728, 32768, 8, 50397184, 131072, 0, 0, 218105920, 4
    .long 1, 32, 32, 8192, 4096, 4352, 8388608, 3670016, 32768, 8, 52494336, 131072, 0, 0, 218106176, 4
    .long 1, 80, 80, 2048, 3670016, 3670272, 7340032, 54583296, 114688, 7, 176160768, 32768, 218103840, 7, 218106368, 1
    .long 0, 0, 0, 0, 0, 0, 0, 0, 0, 0, 0, 0, 0, 0, 0, 0
    .long 0, 0, 0, 0, 0, 0, 0, 0, 0, 0, 0, 0, 0, 0, 0, 0
    .long 0, 0, 0, 0, 0, 0, 0, 0, 0, 0, 0, 0, 0, 0, 0, 0
    .long 6, 24, 24, 8192, 6144, 268288, 8388608, 0, 32768, 4, 21069824, 131072, 0, 0, 218104416, 1
    .long 4, 24, 24, 8192, 6144, 268288, 8388608, 262144, 32768, 4, 22118400, 131072, 0, 0, 218104544, 1
    .long 1, 32, 32, 8192, 6144, 6400, 8388608, 1048576, 32768, 8, 42041344, 131072, 0, 0, 218104928, 4
    .long 1, 16, 16, 8192, 6144, 6400, 8388608, 2097152, 32768, 8, 12681216, 131072, 0, 0, 218105440, 4
    .long 1, 32, 32, 8192, 6144, 6400, 8388608, 3145728, 32768, 8, 50429952, 131072, 0, 0, 218105952, 4
    .long 1, 32, 32, 8192, 6144, 6400, 8388608, 3670016, 32768, 8, 52527104, 131072, 0, 0, 218106208, 4
    .long 1, 80, 80, 2048, 5505024, 5505280, 7340032, 54611968, 114688, 7, 180355072, 32768, 218103856, 7, 218106368, 1
    .long 0, 0, 0, 0, 0, 0, 0, 0, 0, 0, 0, 0, 0, 0, 0, 0
    .long 0, 0, 0, 0, 0, 0, 0, 0, 0, 0, 0, 0, 0, 0, 0, 0
    .long 0, 0, 0, 0, 0, 0, 0, 0, 0, 0, 0, 0, 0, 0, 0, 0
    .long 6, 24, 24, 8192, 256, 262400, 8388608, 0, 32768, 4, 20975616, 131072, 0, 0, 218104320, 1
    .long 4, 24, 24, 8192, 256, 262400, 8388608, 262144, 32768, 4, 22024192, 131072, 0, 0, 218104448, 1
    .long 1, 32, 32, 8192, 512, 768, 8388608, 1048576, 32768, 8, 41951232, 131072, 0, 0, 218104832, 4
    .long 1, 16, 16, 8192, 512, 768, 8388608, 2097152, 32768, 8, 12591104, 131072, 0, 0, 218105344, 4
    .long 1, 32, 32, 8192, 512, 768, 8388608, 3145728, 32768, 8, 50339840, 131072, 0, 0, 218105856, 4
    .long 1, 32, 32, 8192, 512, 768, 8388608, 3670016, 32768, 8, 52436992, 131072, 0, 0, 218106112, 4
    .long 1, 80, 80, 2048, 512, 768, 7340032, 54525952, 114688, 7, 167780352, 32768, 218103808, 7, 218106368, 1
    .long 0, 0, 0, 0, 0, 0, 0, 0, 0, 0, 0, 0, 0, 0, 0, 0
    .long 0, 0, 0, 0, 0, 0, 0, 0, 0, 0, 0, 0, 0, 0, 0, 0
    .long 0, 0, 0, 0, 0, 0, 0, 0, 0, 0, 0, 0, 0, 0, 0, 0
    .long 6, 24, 24, 8192, 2304, 264448, 8388608, 0, 32768, 4, 21008384, 131072, 0, 0, 218104352, 1
    .long 4, 24, 24, 8192, 2304, 264448, 8388608, 262144, 32768, 4, 22056960, 131072, 0, 0, 218104480, 1
    .long 1, 32, 32, 8192, 2560, 2816, 8388608, 1048576, 32768, 8, 41984000, 131072, 0, 0, 218104864, 4
    .long 1, 16, 16, 8192, 2560, 2816, 8388608, 2097152, 32768, 8, 12623872, 131072, 0, 0, 218105376, 4
    .long 1, 32, 32, 8192, 2560, 2816, 8388608, 3145728, 32768, 8, 50372608, 131072, 0, 0, 218105888, 4
    .long 1, 32, 32, 8192, 2560, 2816, 8388608, 3670016, 32768, 8, 52469760, 131072, 0, 0, 218106144, 4
    .long 1, 80, 80, 2048, 1835520, 1835776, 7340032, 54554624, 114688, 7, 171974656, 32768, 218103824, 7, 218106368, 1
    .long 0, 0, 0, 0, 0, 0, 0, 0, 0, 0, 0, 0, 0, 0, 0, 0
    .long 0, 0, 0, 0, 0, 0, 0, 0, 0, 0, 0, 0, 0, 0, 0, 0
    .long 0, 0, 0, 0, 0, 0, 0, 0, 0, 0, 0, 0, 0, 0, 0, 0
    .long 6, 24, 24, 8192, 4352, 266496, 8388608, 0, 32768, 4, 21041152, 131072, 0, 0, 218104384, 1
    .long 4, 24, 24, 8192, 4352, 266496, 8388608, 262144, 32768, 4, 22089728, 131072, 0, 0, 218104512, 1
    .long 1, 32, 32, 8192, 4608, 4864, 8388608, 1048576, 32768, 8, 42016768, 131072, 0, 0, 218104896, 4
    .long 1, 16, 16, 8192, 4608, 4864, 8388608, 2097152, 32768, 8, 12656640, 131072, 0, 0, 218105408, 4
    .long 1, 32, 32, 8192, 4608, 4864, 8388608, 3145728, 32768, 8, 50405376, 131072, 0, 0, 218105920, 4
    .long 1, 32, 32, 8192, 4608, 4864, 8388608, 3670016, 32768, 8, 52502528, 131072, 0, 0, 218106176, 4
    .long 1, 80, 80, 2048, 3670528, 3670784, 7340032, 54583296, 114688, 7, 176168960, 32768, 218103840, 7, 218106368, 1
    .long 0, 0, 0, 0, 0, 0, 0, 0, 0, 0, 0, 0, 0, 0, 0, 0
    .long 0, 0, 0, 0, 0, 0, 0, 0, 0, 0, 0, 0, 0, 0, 0, 0
    .long 0, 0, 0, 0, 0, 0, 0, 0, 0, 0, 0, 0, 0, 0, 0, 0
    .long 6, 24, 24, 8192, 6400, 268544, 8388608, 0, 32768, 4, 21073920, 131072, 0, 0, 218104416, 1
    .long 4, 24, 24, 8192, 6400, 268544, 8388608, 262144, 32768, 4, 22122496, 131072, 0, 0, 218104544, 1
    .long 1, 32, 32, 8192, 6656, 6912, 8388608, 1048576, 32768, 8, 42049536, 131072, 0, 0, 218104928, 4
    .long 1, 16, 16, 8192, 6656, 6912, 8388608, 2097152, 32768, 8, 12689408, 131072, 0, 0, 218105440, 4
    .long 1, 32, 32, 8192, 6656, 6912, 8388608, 3145728, 32768, 8, 50438144, 131072, 0, 0, 218105952, 4
    .long 1, 32, 32, 8192, 6656, 6912, 8388608, 3670016, 32768, 8, 52535296, 131072, 0, 0, 218106208, 4
    .long 1, 80, 80, 2048, 5505536, 5505792, 7340032, 54611968, 114688, 7, 180363264, 32768, 218103856, 7, 218106368, 1
    .long 0, 0, 0, 0, 0, 0, 0, 0, 0, 0, 0, 0, 0, 0, 0, 0
    .long 0, 0, 0, 0, 0, 0, 0, 0, 0, 0, 0, 0, 0, 0, 0, 0
    .long 0, 0, 0, 0, 0, 0, 0, 0, 0, 0, 0, 0, 0, 0, 0, 0
    .long 6, 24, 24, 8192, 512, 262656, 8388608, 0, 32768, 4, 20979712, 131072, 0, 0, 218104320, 1
    .long 4, 24, 24, 8192, 512, 262656, 8388608, 262144, 32768, 4, 22028288, 131072, 0, 0, 218104448, 1
    .long 1, 32, 32, 8192, 1024, 1280, 8388608, 1048576, 32768, 8, 41959424, 131072, 0, 0, 218104848, 4
    .long 1, 16, 16, 8192, 1024, 1280, 8388608, 2097152, 32768, 8, 12599296, 131072, 0, 0, 218105360, 4
    .long 1, 32, 32, 8192, 1024, 1280, 8388608, 3145728, 32768, 8, 50348032, 131072, 0, 0, 218105872, 4
    .long 1, 32, 32, 8192, 1024, 1280, 8388608, 3670016, 32768, 8, 52445184, 131072, 0, 0, 218106128, 4
    .long 1, 80, 80, 2048, 1024, 1280, 7340032, 54525952, 114688, 7, 167788544, 32768, 218103808, 7, 218106368, 1
    .long 0, 0, 0, 0, 0, 0, 0, 0, 0, 0, 0, 0, 0, 0, 0, 0
    .long 0, 0, 0, 0, 0, 0, 0, 0, 0, 0, 0, 0, 0, 0, 0, 0
    .long 0, 0, 0, 0, 0, 0, 0, 0, 0, 0, 0, 0, 0, 0, 0, 0
    .long 6, 24, 24, 8192, 2560, 264704, 8388608, 0, 32768, 4, 21012480, 131072, 0, 0, 218104352, 1
    .long 4, 24, 24, 8192, 2560, 264704, 8388608, 262144, 32768, 4, 22061056, 131072, 0, 0, 218104480, 1
    .long 1, 32, 32, 8192, 3072, 3328, 8388608, 1048576, 32768, 8, 41992192, 131072, 0, 0, 218104880, 4
    .long 1, 16, 16, 8192, 3072, 3328, 8388608, 2097152, 32768, 8, 12632064, 131072, 0, 0, 218105392, 4
    .long 1, 32, 32, 8192, 3072, 3328, 8388608, 3145728, 32768, 8, 50380800, 131072, 0, 0, 218105904, 4
    .long 1, 32, 32, 8192, 3072, 3328, 8388608, 3670016, 32768, 8, 52477952, 131072, 0, 0, 218106160, 4
    .long 1, 80, 80, 2048, 1836032, 1836288, 7340032, 54554624, 114688, 7, 171982848, 32768, 218103824, 7, 218106368, 1
    .long 0, 0, 0, 0, 0, 0, 0, 0, 0, 0, 0, 0, 0, 0, 0, 0
    .long 0, 0, 0, 0, 0, 0, 0, 0, 0, 0, 0, 0, 0, 0, 0, 0
    .long 0, 0, 0, 0, 0, 0, 0, 0, 0, 0, 0, 0, 0, 0, 0, 0
    .long 6, 24, 24, 8192, 4608, 266752, 8388608, 0, 32768, 4, 21045248, 131072, 0, 0, 218104384, 1
    .long 4, 24, 24, 8192, 4608, 266752, 8388608, 262144, 32768, 4, 22093824, 131072, 0, 0, 218104512, 1
    .long 1, 32, 32, 8192, 5120, 5376, 8388608, 1048576, 32768, 8, 42024960, 131072, 0, 0, 218104912, 4
    .long 1, 16, 16, 8192, 5120, 5376, 8388608, 2097152, 32768, 8, 12664832, 131072, 0, 0, 218105424, 4
    .long 1, 32, 32, 8192, 5120, 5376, 8388608, 3145728, 32768, 8, 50413568, 131072, 0, 0, 218105936, 4
    .long 1, 32, 32, 8192, 5120, 5376, 8388608, 3670016, 32768, 8, 52510720, 131072, 0, 0, 218106192, 4
    .long 1, 80, 80, 2048, 3671040, 3671296, 7340032, 54583296, 114688, 7, 176177152, 32768, 218103840, 7, 218106368, 1
    .long 0, 0, 0, 0, 0, 0, 0, 0, 0, 0, 0, 0, 0, 0, 0, 0
    .long 0, 0, 0, 0, 0, 0, 0, 0, 0, 0, 0, 0, 0, 0, 0, 0
    .long 0, 0, 0, 0, 0, 0, 0, 0, 0, 0, 0, 0, 0, 0, 0, 0
    .long 6, 24, 24, 8192, 6656, 268800, 8388608, 0, 32768, 4, 21078016, 131072, 0, 0, 218104416, 1
    .long 4, 24, 24, 8192, 6656, 268800, 8388608, 262144, 32768, 4, 22126592, 131072, 0, 0, 218104544, 1
    .long 1, 32, 32, 8192, 7168, 7424, 8388608, 1048576, 32768, 8, 42057728, 131072, 0, 0, 218104944, 4
    .long 1, 16, 16, 8192, 7168, 7424, 8388608, 2097152, 32768, 8, 12697600, 131072, 0, 0, 218105456, 4
    .long 1, 32, 32, 8192, 7168, 7424, 8388608, 3145728, 32768, 8, 50446336, 131072, 0, 0, 218105968, 4
    .long 1, 32, 32, 8192, 7168, 7424, 8388608, 3670016, 32768, 8, 52543488, 131072, 0, 0, 218106224, 4
    .long 1, 80, 80, 2048, 5506048, 5506304, 7340032, 54611968, 114688, 7, 180371456, 32768, 218103856, 7, 218106368, 1
    .long 0, 0, 0, 0, 0, 0, 0, 0, 0, 0, 0, 0, 0, 0, 0, 0
    .long 0, 0, 0, 0, 0, 0, 0, 0, 0, 0, 0, 0, 0, 0, 0, 0
    .long 0, 0, 0, 0, 0, 0, 0, 0, 0, 0, 0, 0, 0, 0, 0, 0
    .long 6, 24, 24, 8192, 768, 262912, 8388608, 0, 32768, 4, 20983808, 131072, 0, 0, 218104320, 1
    .long 4, 24, 24, 8192, 768, 262912, 8388608, 262144, 32768, 4, 22032384, 131072, 0, 0, 218104448, 1
    .long 1, 32, 32, 8192, 1536, 1792, 8388608, 1048576, 32768, 8, 41967616, 131072, 0, 0, 218104848, 4
    .long 1, 16, 16, 8192, 1536, 1792, 8388608, 2097152, 32768, 8, 12607488, 131072, 0, 0, 218105360, 4
    .long 1, 32, 32, 8192, 1536, 1792, 8388608, 3145728, 32768, 8, 50356224, 131072, 0, 0, 218105872, 4
    .long 1, 32, 32, 8192, 1536, 1792, 8388608, 3670016, 32768, 8, 52453376, 131072, 0, 0, 218106128, 4
    .long 1, 80, 80, 2048, 1536, 1792, 7340032, 54525952, 114688, 7, 167796736, 32768, 218103808, 7, 218106368, 1
    .long 0, 0, 0, 0, 0, 0, 0, 0, 0, 0, 0, 0, 0, 0, 0, 0
    .long 0, 0, 0, 0, 0, 0, 0, 0, 0, 0, 0, 0, 0, 0, 0, 0
    .long 0, 0, 0, 0, 0, 0, 0, 0, 0, 0, 0, 0, 0, 0, 0, 0
    .long 6, 24, 24, 8192, 2816, 264960, 8388608, 0, 32768, 4, 21016576, 131072, 0, 0, 218104352, 1
    .long 4, 24, 24, 8192, 2816, 264960, 8388608, 262144, 32768, 4, 22065152, 131072, 0, 0, 218104480, 1
    .long 1, 32, 32, 8192, 3584, 3840, 8388608, 1048576, 32768, 8, 42000384, 131072, 0, 0, 218104880, 4
    .long 1, 16, 16, 8192, 3584, 3840, 8388608, 2097152, 32768, 8, 12640256, 131072, 0, 0, 218105392, 4
    .long 1, 32, 32, 8192, 3584, 3840, 8388608, 3145728, 32768, 8, 50388992, 131072, 0, 0, 218105904, 4
    .long 1, 32, 32, 8192, 3584, 3840, 8388608, 3670016, 32768, 8, 52486144, 131072, 0, 0, 218106160, 4
    .long 1, 80, 80, 2048, 1836544, 1836800, 7340032, 54554624, 114688, 7, 171991040, 32768, 218103824, 7, 218106368, 1
    .long 0, 0, 0, 0, 0, 0, 0, 0, 0, 0, 0, 0, 0, 0, 0, 0
    .long 0, 0, 0, 0, 0, 0, 0, 0, 0, 0, 0, 0, 0, 0, 0, 0
    .long 0, 0, 0, 0, 0, 0, 0, 0, 0, 0, 0, 0, 0, 0, 0, 0
    .long 6, 24, 24, 8192, 4864, 267008, 8388608, 0, 32768, 4, 21049344, 131072, 0, 0, 218104384, 1
    .long 4, 24, 24, 8192, 4864, 267008, 8388608, 262144, 32768, 4, 22097920, 131072, 0, 0, 218104512, 1
    .long 1, 32, 32, 8192, 5632, 5888, 8388608, 1048576, 32768, 8, 42033152, 131072, 0, 0, 218104912, 4
    .long 1, 16, 16, 8192, 5632, 5888, 8388608, 2097152, 32768, 8, 12673024, 131072, 0, 0, 218105424, 4
    .long 1, 32, 32, 8192, 5632, 5888, 8388608, 3145728, 32768, 8, 50421760, 131072, 0, 0, 218105936, 4
    .long 1, 32, 32, 8192, 5632, 5888, 8388608, 3670016, 32768, 8, 52518912, 131072, 0, 0, 218106192, 4
    .long 1, 80, 80, 2048, 3671552, 3671808, 7340032, 54583296, 114688, 7, 176185344, 32768, 218103840, 7, 218106368, 1
    .long 0, 0, 0, 0, 0, 0, 0, 0, 0, 0, 0, 0, 0, 0, 0, 0
    .long 0, 0, 0, 0, 0, 0, 0, 0, 0, 0, 0, 0, 0, 0, 0, 0
    .long 0, 0, 0, 0, 0, 0, 0, 0, 0, 0, 0, 0, 0, 0, 0, 0
    .long 6, 24, 24, 8192, 6912, 269056, 8388608, 0, 32768, 4, 21082112, 131072, 0, 0, 218104416, 1
    .long 4, 24, 24, 8192, 6912, 269056, 8388608, 262144, 32768, 4, 22130688, 131072, 0, 0, 218104544, 1
    .long 1, 32, 32, 8192, 7680, 7936, 8388608, 1048576, 32768, 8, 42065920, 131072, 0, 0, 218104944, 4
    .long 1, 16, 16, 8192, 7680, 7936, 8388608, 2097152, 32768, 8, 12705792, 131072, 0, 0, 218105456, 4
    .long 1, 32, 32, 8192, 7680, 7936, 8388608, 3145728, 32768, 8, 50454528, 131072, 0, 0, 218105968, 4
    .long 1, 32, 32, 8192, 7680, 7936, 8388608, 3670016, 32768, 8, 52551680, 131072, 0, 0, 218106224, 4
    .long 1, 80, 80, 2048, 5506560, 5506816, 7340032, 54611968, 114688, 7, 180379648, 32768, 218103856, 7, 218106368, 1
    .long 0, 0, 0, 0, 0, 0, 0, 0, 0, 0, 0, 0, 0, 0, 0, 0
    .long 0, 0, 0, 0, 0, 0, 0, 0, 0, 0, 0, 0, 0, 0, 0, 0
    .long 0, 0, 0, 0, 0, 0, 0, 0, 0, 0, 0, 0, 0, 0, 0, 0
    .long 6, 24, 24, 8192, 1024, 263168, 8388608, 0, 32768, 4, 20987904, 131072, 0, 0, 218104336, 1
    .long 4, 24, 24, 8192, 1024, 263168, 8388608, 262144, 32768, 4, 22036480, 131072, 0, 0, 218104464, 1
    .long 1, 24, 24, 8192, 0, 256, 8388608, 1048576, 32768, 8, 25165824, 131072, 0, 0, 218104832, 4
    .long 1, 32, 32, 8192, 0, 256, 8388608, 2621440, 32768, 8, 48234496, 131072, 0, 0, 218105600, 4
    .long 1, 24, 24, 8192, 0, 256, 8388608, 3145728, 32768, 8, 33554432, 131072, 0, 0, 218105856, 4
    .long 1, 24, 24, 8192, 0, 256, 8388608, 3670016, 32768, 8, 35651584, 131072, 0, 0, 218106112, 4
    .long 1, 80, 80, 2048, 0, 256, 7340032, 56360960, 114688, 7, 168296448, 32768, 218103872, 7, 218106432, 1
    .long 0, 0, 0, 0, 0, 0, 0, 0, 0, 0, 0, 0, 0, 0, 0, 0
    .long 0, 0, 0, 0, 0, 0, 0, 0, 0, 0, 0, 0, 0, 0, 0, 0
    .long 0, 0, 0, 0, 0, 0, 0, 0, 0, 0, 0, 0, 0, 0, 0, 0
    .long 6, 24, 24, 8192, 3072, 265216, 8388608, 0, 32768, 4, 21020672, 131072, 0, 0, 218104368, 1
    .long 4, 24, 24, 8192, 3072, 265216, 8388608, 262144, 32768, 4, 22069248, 131072, 0, 0, 218104496, 1
    .long 1, 24, 24, 8192, 2048, 2304, 8388608, 1048576, 32768, 8, 25198592, 131072, 0, 0, 218104864, 4
    .long 1, 32, 32, 8192, 2048, 2304, 8388608, 2621440, 32768, 8, 48267264, 131072, 0, 0, 218105632, 4
    .long 1, 24, 24, 8192, 2048, 2304, 8388608, 3145728, 32768, 8, 33587200, 131072, 0, 0, 218105888, 4
    .long 1, 24, 24, 8192, 2048, 2304, 8388608, 3670016, 32768, 8, 35684352, 131072, 0, 0, 218106144, 4
    .long 1, 80, 80, 2048, 1835008, 1835264, 7340032, 56389632, 114688, 7, 172490752, 32768, 218103888, 7, 218106432, 1
    .long 0, 0, 0, 0, 0, 0, 0, 0, 0, 0, 0, 0, 0, 0, 0, 0
    .long 0, 0, 0, 0, 0, 0, 0, 0, 0, 0, 0, 0, 0, 0, 0, 0
    .long 0, 0, 0, 0, 0, 0, 0, 0, 0, 0, 0, 0, 0, 0, 0, 0
    .long 6, 24, 24, 8192, 5120, 267264, 8388608, 0, 32768, 4, 21053440, 131072, 0, 0, 218104400, 1
    .long 4, 24, 24, 8192, 5120, 267264, 8388608, 262144, 32768, 4, 22102016, 131072, 0, 0, 218104528, 1
    .long 1, 24, 24, 8192, 4096, 4352, 8388608, 1048576, 32768, 8, 25231360, 131072, 0, 0, 218104896, 4
    .long 1, 32, 32, 8192, 4096, 4352, 8388608, 2621440, 32768, 8, 48300032, 131072, 0, 0, 218105664, 4
    .long 1, 24, 24, 8192, 4096, 4352, 8388608, 3145728, 32768, 8, 33619968, 131072, 0, 0, 218105920, 4
    .long 1, 24, 24, 8192, 4096, 4352, 8388608, 3670016, 32768, 8, 35717120, 131072, 0, 0, 218106176, 4
    .long 1, 80, 80, 2048, 3670016, 3670272, 7340032, 56418304, 114688, 7, 176685056, 32768, 218103904, 7, 218106432, 1
    .long 0, 0, 0, 0, 0, 0, 0, 0, 0, 0, 0, 0, 0, 0, 0, 0
    .long 0, 0, 0, 0, 0, 0, 0, 0, 0, 0, 0, 0, 0, 0, 0, 0
    .long 0, 0, 0, 0, 0, 0, 0, 0, 0, 0, 0, 0, 0, 0, 0, 0
    .long 6, 24, 24, 8192, 7168, 269312, 8388608, 0, 32768, 4, 21086208, 131072, 0, 0, 218104432, 1
    .long 4, 24, 24, 8192, 7168, 269312, 8388608, 262144, 32768, 4, 22134784, 131072, 0, 0, 218104560, 1
    .long 1, 24, 24, 8192, 6144, 6400, 8388608, 1048576, 32768, 8, 25264128, 131072, 0, 0, 218104928, 4
    .long 1, 32, 32, 8192, 6144, 6400, 8388608, 2621440, 32768, 8, 48332800, 131072, 0, 0, 218105696, 4
    .long 1, 24, 24, 8192, 6144, 6400, 8388608, 3145728, 32768, 8, 33652736, 131072, 0, 0, 218105952, 4
    .long 1, 24, 24, 8192, 6144, 6400, 8388608, 3670016, 32768, 8, 35749888, 131072, 0, 0, 218106208, 4
    .long 1, 80, 80, 2048, 5505024, 5505280, 7340032, 56446976, 114688, 7, 180879360, 32768, 218103920, 7, 218106432, 1
    .long 0, 0, 0, 0, 0, 0, 0, 0, 0, 0, 0, 0, 0, 0, 0, 0
    .long 0, 0, 0, 0, 0, 0, 0, 0, 0, 0, 0, 0, 0, 0, 0, 0
    .long 0, 0, 0, 0, 0, 0, 0, 0, 0, 0, 0, 0, 0, 0, 0, 0
    .long 6, 24, 24, 8192, 1280, 263424, 8388608, 0, 32768, 4, 20992000, 131072, 0, 0, 218104336, 1
    .long 4, 24, 24, 8192, 1280, 263424, 8388608, 262144, 32768, 4, 22040576, 131072, 0, 0, 218104464, 1
    .long 1, 24, 24, 8192, 512, 768, 8388608, 1048576, 32768, 8, 25174016, 131072, 0, 0, 218104832, 4
    .long 1, 32, 32, 8192, 512, 768, 8388608, 2621440, 32768, 8, 48242688, 131072, 0, 0, 218105600, 4
    .long 1, 24, 24, 8192, 512, 768, 8388608, 3145728, 32768, 8, 33562624, 131072, 0, 0, 218105856, 4
    .long 1, 24, 24, 8192, 512, 768, 8388608, 3670016, 32768, 8, 35659776, 131072, 0, 0, 218106112, 4
    .long 1, 80, 80, 2048, 512, 768, 7340032, 56360960, 114688, 7, 168304640, 32768, 218103872, 7, 218106432, 1
    .long 0, 0, 0, 0, 0, 0, 0, 0, 0, 0, 0, 0, 0, 0, 0, 0
    .long 0, 0, 0, 0, 0, 0, 0, 0, 0, 0, 0, 0, 0, 0, 0, 0
    .long 0, 0, 0, 0, 0, 0, 0, 0, 0, 0, 0, 0, 0, 0, 0, 0
    .long 6, 24, 24, 8192, 3328, 265472, 8388608, 0, 32768, 4, 21024768, 131072, 0, 0, 218104368, 1
    .long 4, 24, 24, 8192, 3328, 265472, 8388608, 262144, 32768, 4, 22073344, 131072, 0, 0, 218104496, 1
    .long 1, 24, 24, 8192, 2560, 2816, 8388608, 1048576, 32768, 8, 25206784, 131072, 0, 0, 218104864, 4
    .long 1, 32, 32, 8192, 2560, 2816, 8388608, 2621440, 32768, 8, 48275456, 131072, 0, 0, 218105632, 4
    .long 1, 24, 24, 8192, 2560, 2816, 8388608, 3145728, 32768, 8, 33595392, 131072, 0, 0, 218105888, 4
    .long 1, 24, 24, 8192, 2560, 2816, 8388608, 3670016, 32768, 8, 35692544, 131072, 0, 0, 218106144, 4
    .long 1, 80, 80, 2048, 1835520, 1835776, 7340032, 56389632, 114688, 7, 172498944, 32768, 218103888, 7, 218106432, 1
    .long 0, 0, 0, 0, 0, 0, 0, 0, 0, 0, 0, 0, 0, 0, 0, 0
    .long 0, 0, 0, 0, 0, 0, 0, 0, 0, 0, 0, 0, 0, 0, 0, 0
    .long 0, 0, 0, 0, 0, 0, 0, 0, 0, 0, 0, 0, 0, 0, 0, 0
    .long 6, 24, 24, 8192, 5376, 267520, 8388608, 0, 32768, 4, 21057536, 131072, 0, 0, 218104400, 1
    .long 4, 24, 24, 8192, 5376, 267520, 8388608, 262144, 32768, 4, 22106112, 131072, 0, 0, 218104528, 1
    .long 1, 24, 24, 8192, 4608, 4864, 8388608, 1048576, 32768, 8, 25239552, 131072, 0, 0, 218104896, 4
    .long 1, 32, 32, 8192, 4608, 4864, 8388608, 2621440, 32768, 8, 48308224, 131072, 0, 0, 218105664, 4
    .long 1, 24, 24, 8192, 4608, 4864, 8388608, 3145728, 32768, 8, 33628160, 131072, 0, 0, 218105920, 4
    .long 1, 24, 24, 8192, 4608, 4864, 8388608, 3670016, 32768, 8, 35725312, 131072, 0, 0, 218106176, 4
    .long 1, 80, 80, 2048, 3670528, 3670784, 7340032, 56418304, 114688, 7, 176693248, 32768, 218103904, 7, 218106432, 1
    .long 0, 0, 0, 0, 0, 0, 0, 0, 0, 0, 0, 0, 0, 0, 0, 0
    .long 0, 0, 0, 0, 0, 0, 0, 0, 0, 0, 0, 0, 0, 0, 0, 0
    .long 0, 0, 0, 0, 0, 0, 0, 0, 0, 0, 0, 0, 0, 0, 0, 0
    .long 6, 24, 24, 8192, 7424, 269568, 8388608, 0, 32768, 4, 21090304, 131072, 0, 0, 218104432, 1
    .long 4, 24, 24, 8192, 7424, 269568, 8388608, 262144, 32768, 4, 22138880, 131072, 0, 0, 218104560, 1
    .long 1, 24, 24, 8192, 6656, 6912, 8388608, 1048576, 32768, 8, 25272320, 131072, 0, 0, 218104928, 4
    .long 1, 32, 32, 8192, 6656, 6912, 8388608, 2621440, 32768, 8, 48340992, 131072, 0, 0, 218105696, 4
    .long 1, 24, 24, 8192, 6656, 6912, 8388608, 3145728, 32768, 8, 33660928, 131072, 0, 0, 218105952, 4
    .long 1, 24, 24, 8192, 6656, 6912, 8388608, 3670016, 32768, 8, 35758080, 131072, 0, 0, 218106208, 4
    .long 1, 80, 80, 2048, 5505536, 5505792, 7340032, 56446976, 114688, 7, 180887552, 32768, 218103920, 7, 218106432, 1
    .long 0, 0, 0, 0, 0, 0, 0, 0, 0, 0, 0, 0, 0, 0, 0, 0
    .long 0, 0, 0, 0, 0, 0, 0, 0, 0, 0, 0, 0, 0, 0, 0, 0
    .long 0, 0, 0, 0, 0, 0, 0, 0, 0, 0, 0, 0, 0, 0, 0, 0
    .long 6, 24, 24, 8192, 1536, 263680, 8388608, 0, 32768, 4, 20996096, 131072, 0, 0, 218104336, 1
    .long 4, 24, 24, 8192, 1536, 263680, 8388608, 262144, 32768, 4, 22044672, 131072, 0, 0, 218104464, 1
    .long 1, 24, 24, 8192, 1024, 1280, 8388608, 1048576, 32768, 8, 25182208, 131072, 0, 0, 218104848, 4
    .long 1, 32, 32, 8192, 1024, 1280, 8388608, 2621440, 32768, 8, 48250880, 131072, 0, 0, 218105616, 4
    .long 1, 24, 24, 8192, 1024, 1280, 8388608, 3145728, 32768, 8, 33570816, 131072, 0, 0, 218105872, 4
    .long 1, 24, 24, 8192, 1024, 1280, 8388608, 3670016, 32768, 8, 35667968, 131072, 0, 0, 218106128, 4
    .long 1, 80, 80, 2048, 1024, 1280, 7340032, 56360960, 114688, 7, 168312832, 32768, 218103872, 7, 218106432, 1
    .long 0, 0, 0, 0, 0, 0, 0, 0, 0, 0, 0, 0, 0, 0, 0, 0
    .long 0, 0, 0, 0, 0, 0, 0, 0, 0, 0, 0, 0, 0, 0, 0, 0
    .long 0, 0, 0, 0, 0, 0, 0, 0, 0, 0, 0, 0, 0, 0, 0, 0
    .long 6, 24, 24, 8192, 3584, 265728, 8388608, 0, 32768, 4, 21028864, 131072, 0, 0, 218104368, 1
    .long 4, 24, 24, 8192, 3584, 265728, 8388608, 262144, 32768, 4, 22077440, 131072, 0, 0, 218104496, 1
    .long 1, 24, 24, 8192, 3072, 3328, 8388608, 1048576, 32768, 8, 25214976, 131072, 0, 0, 218104880, 4
    .long 1, 32, 32, 8192, 3072, 3328, 8388608, 2621440, 32768, 8, 48283648, 131072, 0, 0, 218105648, 4
    .long 1, 24, 24, 8192, 3072, 3328, 8388608, 3145728, 32768, 8, 33603584, 131072, 0, 0, 218105904, 4
    .long 1, 24, 24, 8192, 3072, 3328, 8388608, 3670016, 32768, 8, 35700736, 131072, 0, 0, 218106160, 4
    .long 1, 80, 80, 2048, 1836032, 1836288, 7340032, 56389632, 114688, 7, 172507136, 32768, 218103888, 7, 218106432, 1
    .long 0, 0, 0, 0, 0, 0, 0, 0, 0, 0, 0, 0, 0, 0, 0, 0
    .long 0, 0, 0, 0, 0, 0, 0, 0, 0, 0, 0, 0, 0, 0, 0, 0
    .long 0, 0, 0, 0, 0, 0, 0, 0, 0, 0, 0, 0, 0, 0, 0, 0
    .long 6, 24, 24, 8192, 5632, 267776, 8388608, 0, 32768, 4, 21061632, 131072, 0, 0, 218104400, 1
    .long 4, 24, 24, 8192, 5632, 267776, 8388608, 262144, 32768, 4, 22110208, 131072, 0, 0, 218104528, 1
    .long 1, 24, 24, 8192, 5120, 5376, 8388608, 1048576, 32768, 8, 25247744, 131072, 0, 0, 218104912, 4
    .long 1, 32, 32, 8192, 5120, 5376, 8388608, 2621440, 32768, 8, 48316416, 131072, 0, 0, 218105680, 4
    .long 1, 24, 24, 8192, 5120, 5376, 8388608, 3145728, 32768, 8, 33636352, 131072, 0, 0, 218105936, 4
    .long 1, 24, 24, 8192, 5120, 5376, 8388608, 3670016, 32768, 8, 35733504, 131072, 0, 0, 218106192, 4
    .long 1, 80, 80, 2048, 3671040, 3671296, 7340032, 56418304, 114688, 7, 176701440, 32768, 218103904, 7, 218106432, 1
    .long 0, 0, 0, 0, 0, 0, 0, 0, 0, 0, 0, 0, 0, 0, 0, 0
    .long 0, 0, 0, 0, 0, 0, 0, 0, 0, 0, 0, 0, 0, 0, 0, 0
    .long 0, 0, 0, 0, 0, 0, 0, 0, 0, 0, 0, 0, 0, 0, 0, 0
    .long 6, 24, 24, 8192, 7680, 269824, 8388608, 0, 32768, 4, 21094400, 131072, 0, 0, 218104432, 1
    .long 4, 24, 24, 8192, 7680, 269824, 8388608, 262144, 32768, 4, 22142976, 131072, 0, 0, 218104560, 1
    .long 1, 24, 24, 8192, 7168, 7424, 8388608, 1048576, 32768, 8, 25280512, 131072, 0, 0, 218104944, 4
    .long 1, 32, 32, 8192, 7168, 7424, 8388608, 2621440, 32768, 8, 48349184, 131072, 0, 0, 218105712, 4
    .long 1, 24, 24, 8192, 7168, 7424, 8388608, 3145728, 32768, 8, 33669120, 131072, 0, 0, 218105968, 4
    .long 1, 24, 24, 8192, 7168, 7424, 8388608, 3670016, 32768, 8, 35766272, 131072, 0, 0, 218106224, 4
    .long 1, 80, 80, 2048, 5506048, 5506304, 7340032, 56446976, 114688, 7, 180895744, 32768, 218103920, 7, 218106432, 1
    .long 0, 0, 0, 0, 0, 0, 0, 0, 0, 0, 0, 0, 0, 0, 0, 0
    .long 0, 0, 0, 0, 0, 0, 0, 0, 0, 0, 0, 0, 0, 0, 0, 0
    .long 0, 0, 0, 0, 0, 0, 0, 0, 0, 0, 0, 0, 0, 0, 0, 0
    .long 6, 24, 24, 8192, 1792, 263936, 8388608, 0, 32768, 4, 21000192, 131072, 0, 0, 218104336, 1
    .long 4, 24, 24, 8192, 1792, 263936, 8388608, 262144, 32768, 4, 22048768, 131072, 0, 0, 218104464, 1
    .long 1, 24, 24, 8192, 1536, 1792, 8388608, 1048576, 32768, 8, 25190400, 131072, 0, 0, 218104848, 4
    .long 1, 32, 32, 8192, 1536, 1792, 8388608, 2621440, 32768, 8, 48259072, 131072, 0, 0, 218105616, 4
    .long 1, 24, 24, 8192, 1536, 1792, 8388608, 3145728, 32768, 8, 33579008, 131072, 0, 0, 218105872, 4
    .long 1, 24, 24, 8192, 1536, 1792, 8388608, 3670016, 32768, 8, 35676160, 131072, 0, 0, 218106128, 4
    .long 1, 80, 80, 2048, 1536, 1792, 7340032, 56360960, 114688, 7, 168321024, 32768, 218103872, 7, 218106432, 1
    .long 0, 0, 0, 0, 0, 0, 0, 0, 0, 0, 0, 0, 0, 0, 0, 0
    .long 0, 0, 0, 0, 0, 0, 0, 0, 0, 0, 0, 0, 0, 0, 0, 0
    .long 0, 0, 0, 0, 0, 0, 0, 0, 0, 0, 0, 0, 0, 0, 0, 0
    .long 6, 24, 24, 8192, 3840, 265984, 8388608, 0, 32768, 4, 21032960, 131072, 0, 0, 218104368, 1
    .long 4, 24, 24, 8192, 3840, 265984, 8388608, 262144, 32768, 4, 22081536, 131072, 0, 0, 218104496, 1
    .long 1, 24, 24, 8192, 3584, 3840, 8388608, 1048576, 32768, 8, 25223168, 131072, 0, 0, 218104880, 4
    .long 1, 32, 32, 8192, 3584, 3840, 8388608, 2621440, 32768, 8, 48291840, 131072, 0, 0, 218105648, 4
    .long 1, 24, 24, 8192, 3584, 3840, 8388608, 3145728, 32768, 8, 33611776, 131072, 0, 0, 218105904, 4
    .long 1, 24, 24, 8192, 3584, 3840, 8388608, 3670016, 32768, 8, 35708928, 131072, 0, 0, 218106160, 4
    .long 1, 80, 80, 2048, 1836544, 1836800, 7340032, 56389632, 114688, 7, 172515328, 32768, 218103888, 7, 218106432, 1
    .long 0, 0, 0, 0, 0, 0, 0, 0, 0, 0, 0, 0, 0, 0, 0, 0
    .long 0, 0, 0, 0, 0, 0, 0, 0, 0, 0, 0, 0, 0, 0, 0, 0
    .long 0, 0, 0, 0, 0, 0, 0, 0, 0, 0, 0, 0, 0, 0, 0, 0
    .long 6, 24, 24, 8192, 5888, 268032, 8388608, 0, 32768, 4, 21065728, 131072, 0, 0, 218104400, 1
    .long 4, 24, 24, 8192, 5888, 268032, 8388608, 262144, 32768, 4, 22114304, 131072, 0, 0, 218104528, 1
    .long 1, 24, 24, 8192, 5632, 5888, 8388608, 1048576, 32768, 8, 25255936, 131072, 0, 0, 218104912, 4
    .long 1, 32, 32, 8192, 5632, 5888, 8388608, 2621440, 32768, 8, 48324608, 131072, 0, 0, 218105680, 4
    .long 1, 24, 24, 8192, 5632, 5888, 8388608, 3145728, 32768, 8, 33644544, 131072, 0, 0, 218105936, 4
    .long 1, 24, 24, 8192, 5632, 5888, 8388608, 3670016, 32768, 8, 35741696, 131072, 0, 0, 218106192, 4
    .long 1, 80, 80, 2048, 3671552, 3671808, 7340032, 56418304, 114688, 7, 176709632, 32768, 218103904, 7, 218106432, 1
    .long 0, 0, 0, 0, 0, 0, 0, 0, 0, 0, 0, 0, 0, 0, 0, 0
    .long 0, 0, 0, 0, 0, 0, 0, 0, 0, 0, 0, 0, 0, 0, 0, 0
    .long 0, 0, 0, 0, 0, 0, 0, 0, 0, 0, 0, 0, 0, 0, 0, 0
    .long 6, 24, 24, 8192, 7936, 270080, 8388608, 0, 32768, 4, 21098496, 131072, 0, 0, 218104432, 1
    .long 4, 24, 24, 8192, 7936, 270080, 8388608, 262144, 32768, 4, 22147072, 131072, 0, 0, 218104560, 1
    .long 1, 24, 24, 8192, 7680, 7936, 8388608, 1048576, 32768, 8, 25288704, 131072, 0, 0, 218104944, 4
    .long 1, 32, 32, 8192, 7680, 7936, 8388608, 2621440, 32768, 8, 48357376, 131072, 0, 0, 218105712, 4
    .long 1, 24, 24, 8192, 7680, 7936, 8388608, 3145728, 32768, 8, 33677312, 131072, 0, 0, 218105968, 4
    .long 1, 24, 24, 8192, 7680, 7936, 8388608, 3670016, 32768, 8, 35774464, 131072, 0, 0, 218106224, 4
    .long 1, 80, 80, 2048, 5506560, 5506816, 7340032, 56446976, 114688, 7, 180903936, 32768, 218103920, 7, 218106432, 1
    .long 0, 0, 0, 0, 0, 0, 0, 0, 0, 0, 0, 0, 0, 0, 0, 0
    .long 0, 0, 0, 0, 0, 0, 0, 0, 0, 0, 0, 0, 0, 0, 0, 0
    .long 0, 0, 0, 0, 0, 0, 0, 0, 0, 0, 0, 0, 0, 0, 0, 0
    .long 6, 32, 32, 8192, 0, 262144, 8388608, 0, 32768, 4, 37748736, 131072, 0, 0, 218104320, 1
    .long 4, 32, 32, 8192, 0, 262144, 8388608, 262144, 32768, 4, 38797312, 131072, 0, 0, 218104448, 1
    .long 4, 16, 16, 8192, 1792, 263936, 8388608, 786432, 32768, 4, 7368704, 131072, 0, 0, 218104592, 1
    .long 1, 24, 24, 8192, 0, 256, 8388608, 1572864, 32768, 8, 27262976, 131072, 0, 0, 218105088, 4
    .long 2, 64, 72, 7168, 0, 0, 7340032, 0, 32768, 8, 54525952, 114688, 0, 0, 218103808, 1
    .long 2, 64, 72, 7168, 6144, 6144, 7340032, 1048576, 32768, 8, 58294272, 114688, 0, 0, 218103984, 1
    .long 2, 64, 72, 7168, 5120, 5120, 7340032, 2621440, 32768, 8, 63782912, 114688, 0, 0, 218104160, 1
    .long 1, 80, 80, 2048, 0, 256, 7340032, 61865984, 114688, 7, 169869312, 32768, 218104064, 7, 218106624, 1
    .long 0, 0, 0, 0, 0, 0, 0, 0, 0, 0, 0, 0, 0, 0, 0, 0
    .long 0, 0, 0, 0, 0, 0, 0, 0, 0, 0, 0, 0, 0, 0, 0, 0
    .long 6, 32, 32, 8192, 2048, 264192, 8388608, 0, 32768, 4, 37781504, 131072, 0, 0, 218104352, 1
    .long 4, 32, 32, 8192, 2048, 264192, 8388608, 262144, 32768, 4, 38830080, 131072, 0, 0, 218104480, 1
    .long 4, 16, 16, 8192, 3840, 265984, 8388608, 786432, 32768, 4, 7401472, 131072, 0, 0, 218104624, 1
    .long 1, 24, 24, 8192, 2048, 2304, 8388608, 1572864, 32768, 8, 27295744, 131072, 0, 0, 218105120, 4
    .long 2, 64, 72, 7168, 256, 256, 7340032, 0, 32768, 8, 54530048, 114688, 0, 0, 218103808, 1
    .long 2, 64, 72, 7168, 6400, 6400, 7340032, 1048576, 32768, 8, 58298368, 114688, 0, 0, 218103984, 1
    .long 2, 64, 72, 7168, 5376, 5376, 7340032, 2621440, 32768, 8, 63787008, 114688, 0, 0, 218104176, 1
    .long 1, 80, 80, 2048, 1835008, 1835264, 7340032, 61894656, 114688, 7, 174063616, 32768, 218104080, 7, 218106624, 1
    .long 0, 0, 0, 0, 0, 0, 0, 0, 0, 0, 0, 0, 0, 0, 0, 0
    .long 0, 0, 0, 0, 0, 0, 0, 0, 0, 0, 0, 0, 0, 0, 0, 0
    .long 6, 32, 32, 8192, 4096, 266240, 8388608, 0, 32768, 4, 37814272, 131072, 0, 0, 218104384, 1
    .long 4, 32, 32, 8192, 4096, 266240, 8388608, 262144, 32768, 4, 38862848, 131072, 0, 0, 218104512, 1
    .long 4, 16, 16, 8192, 5888, 268032, 8388608, 786432, 32768, 4, 7434240, 131072, 0, 0, 218104656, 1
    .long 1, 24, 24, 8192, 4096, 4352, 8388608, 1572864, 32768, 8, 27328512, 131072, 0, 0, 218105152, 4
    .long 2, 64, 72, 7168, 512, 512, 7340032, 0, 32768, 8, 54534144, 114688, 0, 0, 218103808, 1
    .long 2, 64, 72, 7168, 6656, 6656, 7340032, 1048576, 32768, 8, 58302464, 114688, 0, 0, 218103984, 1
    .long 2, 64, 72, 7168, 5632, 5632, 7340032, 2621440, 32768, 8, 63791104, 114688, 0, 0, 218104176, 1
    .long 1, 80, 80, 2048, 3670016, 3670272, 7340032, 61923328, 114688, 7, 178257920, 32768, 218104096, 7, 218106624, 1
    .long 0, 0, 0, 0, 0, 0, 0, 0, 0, 0, 0, 0, 0, 0, 0, 0
    .long 0, 0, 0, 0, 0, 0, 0, 0, 0, 0, 0, 0, 0, 0, 0, 0
    .long 6, 32, 32, 8192, 6144, 268288, 8388608, 0, 32768, 4, 37847040, 131072, 0, 0, 218104416, 1
    .long 4, 32, 32, 8192, 6144, 268288, 8388608, 262144, 32768, 4, 38895616, 131072, 0, 0, 218104544, 1
    .long 4, 16, 16, 8192, 7936, 270080, 8388608, 786432, 32768, 4, 7467008, 131072, 0, 0, 218104688, 1
    .long 1, 24, 24, 8192, 6144, 6400, 8388608, 1572864, 32768, 8, 27361280, 131072, 0, 0, 218105184, 4
    .long 2, 64, 72, 7168, 768, 768, 7340032, 0, 32768, 8, 54538240, 114688, 0, 0, 218103808, 1
    .long 2, 64, 72, 7168, 6912, 6912, 7340032, 1048576, 32768, 8, 58306560, 114688, 0, 0, 218103984, 1
    .long 2, 64, 72, 7168, 5888, 5888, 7340032, 2621440, 32768, 8, 63795200, 114688, 0, 0, 218104176, 1
    .long 1, 80, 80, 2048, 5505024, 5505280, 7340032, 61952000, 114688, 7, 182452224, 32768, 218104112, 7, 218106624, 1
    .long 0, 0, 0, 0, 0, 0, 0, 0, 0, 0, 0, 0, 0, 0, 0, 0
    .long 0, 0, 0, 0, 0, 0, 0, 0, 0, 0, 0, 0, 0, 0, 0, 0
    .long 6, 32, 32, 8192, 256, 262400, 8388608, 0, 32768, 4, 37752832, 131072, 0, 0, 218104320, 1
    .long 4, 32, 32, 8192, 256, 262400, 8388608, 262144, 32768, 4, 38801408, 131072, 0, 0, 218104448, 1
    .long 4, 16, 16, 8192, 1792, 263936, 8388608, 524288, 32768, 4, 6320128, 131072, 0, 0, 218104592, 1
    .long 1, 24, 24, 8192, 512, 768, 8388608, 1572864, 32768, 8, 27271168, 131072, 0, 0, 218105088, 4
    .long 2, 64, 72, 7168, 1024, 1024, 7340032, 0, 32768, 8, 54542336, 114688, 0, 0, 218103808, 1
    .long 2, 64, 72, 7168, 0, 0, 7340032, 1572864, 32768, 8, 60030976, 114688, 0, 0, 218104000, 1
    .long 2, 64, 72, 7168, 6144, 6144, 7340032, 2621440, 32768, 8, 63799296, 114688, 0, 0, 218104176, 1
    .long 1, 80, 80, 2048, 512, 768, 7340032, 61865984, 114688, 7, 169877504, 32768, 218104064, 7, 218106624, 1
    .long 0, 0, 0, 0, 0, 0, 0, 0, 0, 0, 0, 0, 0, 0, 0, 0
    .long 0, 0, 0, 0, 0, 0, 0, 0, 0, 0, 0, 0, 0, 0, 0, 0
    .long 6, 32, 32, 8192, 2304, 264448, 8388608, 0, 32768, 4, 37785600, 131072, 0, 0, 218104352, 1
    .long 4, 32, 32, 8192, 2304, 264448, 8388608, 262144, 32768, 4, 38834176, 131072, 0, 0, 218104480, 1
    .long 4, 16, 16, 8192, 3840, 265984, 8388608, 524288, 32768, 4, 6352896, 131072, 0, 0, 218104624, 1
    .long 1, 24, 24, 8192, 2560, 2816, 8388608, 1572864, 32768, 8, 27303936, 131072, 0, 0, 218105120, 4
    .long 2, 64, 72, 7168, 1280, 1280, 7340032, 0, 32768, 8, 54546432, 114688, 0, 0, 218103808, 1
    .long 2, 64, 72, 7168, 256, 256, 7340032, 1572864, 32768, 8, 60035072, 114688, 0, 0, 218104000, 1
    .long 2, 64, 72, 7168, 6400, 6400, 7340032, 2621440, 32768, 8, 63803392, 114688, 0, 0, 218104176, 1
    .long 1, 80, 80, 2048, 1835520, 1835776, 7340032, 61894656, 114688, 7, 174071808, 32768, 218104080, 7, 218106624, 1
    .long 0, 0, 0, 0, 0, 0, 0, 0, 0, 0, 0, 0, 0, 0, 0, 0
    .long 0, 0, 0, 0, 0, 0, 0, 0, 0, 0, 0, 0, 0, 0, 0, 0
    .long 6, 32, 32, 8192, 4352, 266496, 8388608, 0, 32768, 4, 37818368, 131072, 0, 0, 218104384, 1
    .long 4, 32, 32, 8192, 4352, 266496, 8388608, 262144, 32768, 4, 38866944, 131072, 0, 0, 218104512, 1
    .long 4, 16, 16, 8192, 5888, 268032, 8388608, 524288, 32768, 4, 6385664, 131072, 0, 0, 218104656, 1
    .long 1, 24, 24, 8192, 4608, 4864, 8388608, 1572864, 32768, 8, 27336704, 131072, 0, 0, 218105152, 4
    .long 2, 64, 72, 7168, 1536, 1536, 7340032, 0, 32768, 8, 54550528, 114688, 0, 0, 218103808, 1
    .long 2, 64, 72, 7168, 512, 512, 7340032, 1572864, 32768, 8, 60039168, 114688, 0, 0, 218104000, 1
    .long 2, 64, 72, 7168, 6656, 6656, 7340032, 2621440, 32768, 8, 63807488, 114688, 0, 0, 218104176, 1
    .long 1, 80, 80, 2048, 3670528, 3670784, 7340032, 61923328, 114688, 7, 178266112, 32768, 218104096, 7, 218106624, 1
    .long 0, 0, 0, 0, 0, 0, 0, 0, 0, 0, 0, 0, 0, 0, 0, 0
    .long 0, 0, 0, 0, 0, 0, 0, 0, 0, 0, 0, 0, 0, 0, 0, 0
    .long 6, 32, 32, 8192, 6400, 268544, 8388608, 0, 32768, 4, 37851136, 131072, 0, 0, 218104416, 1
    .long 4, 32, 32, 8192, 6400, 268544, 8388608, 262144, 32768, 4, 38899712, 131072, 0, 0, 218104544, 1
    .long 4, 16, 16, 8192, 7936, 270080, 8388608, 524288, 32768, 4, 6418432, 131072, 0, 0, 218104688, 1
    .long 1, 24, 24, 8192, 6656, 6912, 8388608, 1572864, 32768, 8, 27369472, 131072, 0, 0, 218105184, 4
    .long 2, 64, 72, 7168, 1792, 1792, 7340032, 0, 32768, 8, 54554624, 114688, 0, 0, 218103824, 1
    .long 2, 64, 72, 7168, 768, 768, 7340032, 1572864, 32768, 8, 60043264, 114688, 0, 0, 218104000, 1
    .long 2, 64, 72, 7168, 6912, 6912, 7340032, 2621440, 32768, 8, 63811584, 114688, 0, 0, 218104176, 1
    .long 1, 80, 80, 2048, 5505536, 5505792, 7340032, 61952000, 114688, 7, 182460416, 32768, 218104112, 7, 218106624, 1
    .long 0, 0, 0, 0, 0, 0, 0, 0, 0, 0, 0, 0, 0, 0, 0, 0
    .long 0, 0, 0, 0, 0, 0, 0, 0, 0, 0, 0, 0, 0, 0, 0, 0
    .long 6, 32, 32, 8192, 512, 262656, 8388608, 0, 32768, 4, 37756928, 131072, 0, 0, 218104320, 1
    .long 4, 32, 32, 8192, 512, 262656, 8388608, 262144, 32768, 4, 38805504, 131072, 0, 0, 218104448, 1
    .long 4, 16, 16, 8192, 1536, 263680, 8388608, 786432, 32768, 4, 7364608, 131072, 0, 0, 218104592, 1
    .long 1, 24, 24, 8192, 1024, 1280, 8388608, 1572864, 32768, 8, 27279360, 131072, 0, 0, 218105104, 4
    .long 2, 64, 72, 7168, 2048, 2048, 7340032, 0, 32768, 8, 54558720, 114688, 0, 0, 218103824, 1
    .long 2, 64, 72, 7168, 1024, 1024, 7340032, 1572864, 32768, 8, 60047360, 114688, 0, 0, 218104000, 1
    .long 2, 64, 72, 7168, 0, 0, 7340032, 3145728, 32768, 8, 65536000, 114688, 0, 0, 218104192, 1
    .long 1, 80, 80, 2048, 1024, 1280, 7340032, 61865984, 114688, 7, 169885696, 32768, 218104064, 7, 218106624, 1
    .long 0, 0, 0, 0, 0, 0, 0, 0, 0, 0, 0, 0, 0, 0, 0, 0
    .long 0, 0, 0, 0, 0, 0, 0, 0, 0, 0, 0, 0, 0, 0, 0, 0
    .long 6, 32, 32, 8192, 2560, 264704, 8388608, 0, 32768, 4, 37789696, 131072, 0, 0, 218104352, 1
    .long 4, 32, 32, 8192, 2560, 264704, 8388608, 262144, 32768, 4, 38838272, 131072, 0, 0, 218104480, 1
    .long 4, 16, 16, 8192, 3584, 265728, 8388608, 786432, 32768, 4, 7397376, 131072, 0, 0, 218104624, 1
    .long 1, 24, 24, 8192, 3072, 3328, 8388608, 1572864, 32768, 8, 27312128, 131072, 0, 0, 218105136, 4
    .long 2, 64, 72, 7168, 2304, 2304, 7340032, 0, 32768, 8, 54562816, 114688, 0, 0, 218103824, 1
    .long 2, 64, 72, 7168, 1280, 1280, 7340032, 1572864, 32768, 8, 60051456, 114688, 0, 0, 218104000, 1
    .long 2, 64, 72, 7168, 256, 256, 7340032, 3145728, 32768, 8, 65540096, 114688, 0, 0, 218104192, 1
    .long 1, 80, 80, 2048, 1836032, 1836288, 7340032, 61894656, 114688, 7, 174080000, 32768, 218104080, 7, 218106624, 1
    .long 0, 0, 0, 0, 0, 0, 0, 0, 0, 0, 0, 0, 0, 0, 0, 0
    .long 0, 0, 0, 0, 0, 0, 0, 0, 0, 0, 0, 0, 0, 0, 0, 0
    .long 6, 32, 32, 8192, 4608, 266752, 8388608, 0, 32768, 4, 37822464, 131072, 0, 0, 218104384, 1
    .long 4, 32, 32, 8192, 4608, 266752, 8388608, 262144, 32768, 4, 38871040, 131072, 0, 0, 218104512, 1
    .long 4, 16, 16, 8192, 5632, 267776, 8388608, 786432, 32768, 4, 7430144, 131072, 0, 0, 218104656, 1
    .long 1, 24, 24, 8192, 5120, 5376, 8388608, 1572864, 32768, 8, 27344896, 131072, 0, 0, 218105168, 4
    .long 2, 64, 72, 7168, 2560, 2560, 7340032, 0, 32768, 8, 54566912, 114688, 0, 0, 218103824, 1
    .long 2, 64, 72, 7168, 1536, 1536, 7340032, 1572864, 32768, 8, 60055552, 114688, 0, 0, 218104000, 1
    .long 2, 64, 72, 7168, 512, 512, 7340032, 3145728, 32768, 8, 65544192, 114688, 0, 0, 218104192, 1
    .long 1, 80, 80, 2048, 3671040, 3671296, 7340032, 61923328, 114688, 7, 178274304, 32768, 218104096, 7, 218106624, 1
    .long 0, 0, 0, 0, 0, 0, 0, 0, 0, 0, 0, 0, 0, 0, 0, 0
    .long 0, 0, 0, 0, 0, 0, 0, 0, 0, 0, 0, 0, 0, 0, 0, 0
    .long 6, 32, 32, 8192, 6656, 268800, 8388608, 0, 32768, 4, 37855232, 131072, 0, 0, 218104416, 1
    .long 4, 32, 32, 8192, 6656, 268800, 8388608, 262144, 32768, 4, 38903808, 131072, 0, 0, 218104544, 1
    .long 4, 16, 16, 8192, 7680, 269824, 8388608, 786432, 32768, 4, 7462912, 131072, 0, 0, 218104688, 1
    .long 1, 24, 24, 8192, 7168, 7424, 8388608, 1572864, 32768, 8, 27377664, 131072, 0, 0, 218105200, 4
    .long 2, 64, 72, 7168, 2816, 2816, 7340032, 0, 32768, 8, 54571008, 114688, 0, 0, 218103824, 1
    .long 2, 64, 72, 7168, 1792, 1792, 7340032, 1572864, 32768, 8, 60059648, 114688, 0, 0, 218104016, 1
    .long 2, 64, 72, 7168, 768, 768, 7340032, 3145728, 32768, 8, 65548288, 114688, 0, 0, 218104192, 1
    .long 1, 80, 80, 2048, 5506048, 5506304, 7340032, 61952000, 114688, 7, 182468608, 32768, 218104112, 7, 218106624, 1
    .long 0, 0, 0, 0, 0, 0, 0, 0, 0, 0, 0, 0, 0, 0, 0, 0
    .long 0, 0, 0, 0, 0, 0, 0, 0, 0, 0, 0, 0, 0, 0, 0, 0
    .long 6, 32, 32, 8192, 768, 262912, 8388608, 0, 32768, 4, 37761024, 131072, 0, 0, 218104320, 1
    .long 4, 32, 32, 8192, 768, 262912, 8388608, 262144, 32768, 4, 38809600, 131072, 0, 0, 218104448, 1
    .long 4, 16, 16, 8192, 1536, 263680, 8388608, 524288, 32768, 4, 6316032, 131072, 0, 0, 218104592, 1
    .long 1, 24, 24, 8192, 1536, 1792, 8388608, 1572864, 32768, 8, 27287552, 131072, 0, 0, 218105104, 4
    .long 2, 64, 72, 7168, 3072, 3072, 7340032, 0, 32768, 8, 54575104, 114688, 0, 0, 218103824, 1
    .long 2, 64, 72, 7168, 2048, 2048, 7340032, 1572864, 32768, 8, 60063744, 114688, 0, 0, 218104016, 1
    .long 2, 64, 72, 7168, 1024, 1024, 7340032, 3145728, 32768, 8, 65552384, 114688, 0, 0, 218104192, 1
    .long 1, 80, 80, 2048, 1536, 1792, 7340032, 61865984, 114688, 7, 169893888, 32768, 218104064, 7, 218106624, 1
    .long 0, 0, 0, 0, 0, 0, 0, 0, 0, 0, 0, 0, 0, 0, 0, 0
    .long 0, 0, 0, 0, 0, 0, 0, 0, 0, 0, 0, 0, 0, 0, 0, 0
    .long 6, 32, 32, 8192, 2816, 264960, 8388608, 0, 32768, 4, 37793792, 131072, 0, 0, 218104352, 1
    .long 4, 32, 32, 8192, 2816, 264960, 8388608, 262144, 32768, 4, 38842368, 131072, 0, 0, 218104480, 1
    .long 4, 16, 16, 8192, 3584, 265728, 8388608, 524288, 32768, 4, 6348800, 131072, 0, 0, 218104624, 1
    .long 1, 24, 24, 8192, 3584, 3840, 8388608, 1572864, 32768, 8, 27320320, 131072, 0, 0, 218105136, 4
    .long 2, 64, 72, 7168, 3328, 3328, 7340032, 0, 32768, 8, 54579200, 114688, 0, 0, 218103824, 1
    .long 2, 64, 72, 7168, 2304, 2304, 7340032, 1572864, 32768, 8, 60067840, 114688, 0, 0, 218104016, 1
    .long 2, 64, 72, 7168, 1280, 1280, 7340032, 3145728, 32768, 8, 65556480, 114688, 0, 0, 218104192, 1
    .long 1, 80, 80, 2048, 1836544, 1836800, 7340032, 61894656, 114688, 7, 174088192, 32768, 218104080, 7, 218106624, 1
    .long 0, 0, 0, 0, 0, 0, 0, 0, 0, 0, 0, 0, 0, 0, 0, 0
    .long 0, 0, 0, 0, 0, 0, 0, 0, 0, 0, 0, 0, 0, 0, 0, 0
    .long 6, 32, 32, 8192, 4864, 267008, 8388608, 0, 32768, 4, 37826560, 131072, 0, 0, 218104384, 1
    .long 4, 32, 32, 8192, 4864, 267008, 8388608, 262144, 32768, 4, 38875136, 131072, 0, 0, 218104512, 1
    .long 4, 16, 16, 8192, 5632, 267776, 8388608, 524288, 32768, 4, 6381568, 131072, 0, 0, 218104656, 1
    .long 1, 24, 24, 8192, 5632, 5888, 8388608, 1572864, 32768, 8, 27353088, 131072, 0, 0, 218105168, 4
    .long 2, 64, 72, 7168, 3584, 3584, 7340032, 0, 32768, 8, 54583296, 114688, 0, 0, 218103840, 1
    .long 2, 64, 72, 7168, 2560, 2560, 7340032, 1572864, 32768, 8, 60071936, 114688, 0, 0, 218104016, 1
    .long 2, 64, 72, 7168, 1536, 1536, 7340032, 3145728, 32768, 8, 65560576, 114688, 0, 0, 218104192, 1
    .long 1, 80, 80, 2048, 3671552, 3671808, 7340032, 61923328, 114688, 7, 178282496, 32768, 218104096, 7, 218106624, 1
    .long 0, 0, 0, 0, 0, 0, 0, 0, 0, 0, 0, 0, 0, 0, 0, 0
    .long 0, 0, 0, 0, 0, 0, 0, 0, 0, 0, 0, 0, 0, 0, 0, 0
    .long 6, 32, 32, 8192, 6912, 269056, 8388608, 0, 32768, 4, 37859328, 131072, 0, 0, 218104416, 1
    .long 4, 32, 32, 8192, 6912, 269056, 8388608, 262144, 32768, 4, 38907904, 131072, 0, 0, 218104544, 1
    .long 4, 16, 16, 8192, 7680, 269824, 8388608, 524288, 32768, 4, 6414336, 131072, 0, 0, 218104688, 1
    .long 1, 24, 24, 8192, 7680, 7936, 8388608, 1572864, 32768, 8, 27385856, 131072, 0, 0, 218105200, 4
    .long 2, 64, 72, 7168, 3840, 3840, 7340032, 0, 32768, 8, 54587392, 114688, 0, 0, 218103840, 1
    .long 2, 64, 72, 7168, 2816, 2816, 7340032, 1572864, 32768, 8, 60076032, 114688, 0, 0, 218104016, 1
    .long 2, 64, 72, 7168, 1792, 1792, 7340032, 3145728, 32768, 8, 65564672, 114688, 0, 0, 218104208, 1
    .long 1, 80, 80, 2048, 5506560, 5506816, 7340032, 61952000, 114688, 7, 182476800, 32768, 218104112, 7, 218106624, 1
    .long 0, 0, 0, 0, 0, 0, 0, 0, 0, 0, 0, 0, 0, 0, 0, 0
    .long 0, 0, 0, 0, 0, 0, 0, 0, 0, 0, 0, 0, 0, 0, 0, 0
    .long 6, 32, 32, 8192, 1024, 263168, 8388608, 0, 32768, 4, 37765120, 131072, 0, 0, 218104336, 1
    .long 4, 32, 32, 8192, 1024, 263168, 8388608, 262144, 32768, 4, 38813696, 131072, 0, 0, 218104464, 1
    .long 4, 16, 16, 8192, 1280, 263424, 8388608, 786432, 32768, 4, 7360512, 131072, 0, 0, 218104592, 1
    .long 1, 16, 16, 8192, 0, 256, 8388608, 1572864, 32768, 8, 10485760, 131072, 0, 0, 218105088, 4
    .long 2, 64, 72, 7168, 4096, 4096, 7340032, 0, 32768, 8, 54591488, 114688, 0, 0, 218103840, 1
    .long 2, 64, 72, 7168, 3072, 3072, 7340032, 1572864, 32768, 8, 60080128, 114688, 0, 0, 218104016, 1
    .long 2, 64, 72, 7168, 2048, 2048, 7340032, 3145728, 32768, 8, 65568768, 114688, 0, 0, 218104208, 1
    .long 1, 80, 80, 2048, 0, 256, 7340032, 63700992, 114688, 7, 170393600, 32768, 218104128, 7, 218106688, 1
    .long 0, 0, 0, 0, 0, 0, 0, 0, 0, 0, 0, 0, 0, 0, 0, 0
    .long 0, 0, 0, 0, 0, 0, 0, 0, 0, 0, 0, 0, 0, 0, 0, 0
    .long 6, 32, 32, 8192, 3072, 265216, 8388608, 0, 32768, 4, 37797888, 131072, 0, 0, 218104368, 1
    .long 4, 32, 32, 8192, 3072, 265216, 8388608, 262144, 32768, 4, 38846464, 131072, 0, 0, 218104496, 1
    .long 4, 16, 16, 8192, 3328, 265472, 8388608, 786432, 32768, 4, 7393280, 131072, 0, 0, 218104624, 1
    .long 1, 16, 16, 8192, 2048, 2304, 8388608, 1572864, 32768, 8, 10518528, 131072, 0, 0, 218105120, 4
    .long 2, 64, 72, 7168, 4352, 4352, 7340032, 0, 32768, 8, 54595584, 114688, 0, 0, 218103840, 1
    .long 2, 64, 72, 7168, 3328, 3328, 7340032, 1572864, 32768, 8, 60084224, 114688, 0, 0, 218104016, 1
    .long 2, 64, 72, 7168, 2304, 2304, 7340032, 3145728, 32768, 8, 65572864, 114688, 0, 0, 218104208, 1
    .long 1, 80, 80, 2048, 1835008, 1835264, 7340032, 63729664, 114688, 7, 174587904, 32768, 218104144, 7, 218106688, 1
    .long 0, 0, 0, 0, 0, 0, 0, 0, 0, 0, 0, 0, 0, 0, 0, 0
    .long 0, 0, 0, 0, 0, 0, 0, 0, 0, 0, 0, 0, 0, 0, 0, 0
    .long 6, 32, 32, 8192, 5120, 267264, 8388608, 0, 32768, 4, 37830656, 131072, 0, 0, 218104400, 1
    .long 4, 32, 32, 8192, 5120, 267264, 8388608, 262144, 32768, 4, 38879232, 131072, 0, 0, 218104528, 1
    .long 4, 16, 16, 8192, 5376, 267520, 8388608, 786432, 32768, 4, 7426048, 131072, 0, 0, 218104656, 1
    .long 1, 16, 16, 8192, 4096, 4352, 8388608, 1572864, 32768, 8, 10551296, 131072, 0, 0, 218105152, 4
    .long 2, 64, 72, 7168, 4608, 4608, 7340032, 0, 32768, 8, 54599680, 114688, 0, 0, 218103840, 1
    .long 2, 64, 72, 7168, 3584, 3584, 7340032, 1572864, 32768, 8, 60088320, 114688, 0, 0, 218104032, 1
    .long 2, 64, 72, 7168, 2560, 2560, 7340032, 3145728, 32768, 8, 65576960, 114688, 0, 0, 218104208, 1
    .long 1, 80, 80, 2048, 3670016, 3670272, 7340032, 63758336, 114688, 7, 178782208, 32768, 218104160, 7, 218106688, 1
    .long 0, 0, 0, 0, 0, 0, 0, 0, 0, 0, 0, 0, 0, 0, 0, 0
    .long 0, 0, 0, 0, 0, 0, 0, 0, 0, 0, 0, 0, 0, 0, 0, 0
    .long 6, 32, 32, 8192, 7168, 269312, 8388608, 0, 32768, 4, 37863424, 131072, 0, 0, 218104432, 1
    .long 4, 32, 32, 8192, 7168, 269312, 8388608, 262144, 32768, 4, 38912000, 131072, 0, 0, 218104560, 1
    .long 4, 16, 16, 8192, 7424, 269568, 8388608, 786432, 32768, 4, 7458816, 131072, 0, 0, 218104688, 1
    .long 1, 16, 16, 8192, 6144, 6400, 8388608, 1572864, 32768, 8, 10584064, 131072, 0, 0, 218105184, 4
    .long 2, 64, 72, 7168, 4864, 4864, 7340032, 0, 32768, 8, 54603776, 114688, 0, 0, 218103840, 1
    .long 2, 64, 72, 7168, 3840, 3840, 7340032, 1572864, 32768, 8, 60092416, 114688, 0, 0, 218104032, 1
    .long 2, 64, 72, 7168, 2816, 2816, 7340032, 3145728, 32768, 8, 65581056, 114688, 0, 0, 218104208, 1
    .long 1, 80, 80, 2048, 5505024, 5505280, 7340032, 63787008, 114688, 7, 182976512, 32768, 218104176, 7, 218106688, 1
    .long 0, 0, 0, 0, 0, 0, 0, 0, 0, 0, 0, 0, 0, 0, 0, 0
    .long 0, 0, 0, 0, 0, 0, 0, 0, 0, 0, 0, 0, 0, 0, 0, 0
    .long 6, 32, 32, 8192, 1280, 263424, 8388608, 0, 32768, 4, 37769216, 131072, 0, 0, 218104336, 1
    .long 4, 32, 32, 8192, 1280, 263424, 8388608, 262144, 32768, 4, 38817792, 131072, 0, 0, 218104464, 1
    .long 4, 16, 16, 8192, 1280, 263424, 8388608, 524288, 32768, 4, 6311936, 131072, 0, 0, 218104592, 1
    .long 1, 16, 16, 8192, 512, 768, 8388608, 1572864, 32768, 8, 10493952, 131072, 0, 0, 218105088, 4
    .long 2, 64, 72, 7168, 5120, 5120, 7340032, 0, 32768, 8, 54607872, 114688, 0, 0, 218103840, 1
    .long 2, 64, 72, 7168, 4096, 4096, 7340032, 1572864, 32768, 8, 60096512, 114688, 0, 0, 218104032, 1
    .long 2, 64, 72, 7168, 3072, 3072, 7340032, 3145728, 32768, 8, 65585152, 114688, 0, 0, 218104208, 1
    .long 1, 80, 80, 2048, 512, 768, 7340032, 63700992, 114688, 7, 170401792, 32768, 218104128, 7, 218106688, 1
    .long 0, 0, 0, 0, 0, 0, 0, 0, 0, 0, 0, 0, 0, 0, 0, 0
    .long 0, 0, 0, 0, 0, 0, 0, 0, 0, 0, 0, 0, 0, 0, 0, 0
    .long 6, 32, 32, 8192, 3328, 265472, 8388608, 0, 32768, 4, 37801984, 131072, 0, 0, 218104368, 1
    .long 4, 32, 32, 8192, 3328, 265472, 8388608, 262144, 32768, 4, 38850560, 131072, 0, 0, 218104496, 1
    .long 4, 16, 16, 8192, 3328, 265472, 8388608, 524288, 32768, 4, 6344704, 131072, 0, 0, 218104624, 1
    .long 1, 16, 16, 8192, 2560, 2816, 8388608, 1572864, 32768, 8, 10526720, 131072, 0, 0, 218105120, 4
    .long 2, 64, 72, 7168, 5376, 5376, 7340032, 0, 32768, 8, 54611968, 114688, 0, 0, 218103856, 1
    .long 2, 64, 72, 7168, 4352, 4352, 7340032, 1572864, 32768, 8, 60100608, 114688, 0, 0, 218104032, 1
    .long 2, 64, 72, 7168, 3328, 3328, 7340032, 3145728, 32768, 8, 65589248, 114688, 0, 0, 218104208, 1
    .long 1, 80, 80, 2048, 1835520, 1835776, 7340032, 63729664, 114688, 7, 174596096, 32768, 218104144, 7, 218106688, 1
    .long 0, 0, 0, 0, 0, 0, 0, 0, 0, 0, 0, 0, 0, 0, 0, 0
    .long 0, 0, 0, 0, 0, 0, 0, 0, 0, 0, 0, 0, 0, 0, 0, 0
    .long 6, 32, 32, 8192, 5376, 267520, 8388608, 0, 32768, 4, 37834752, 131072, 0, 0, 218104400, 1
    .long 4, 32, 32, 8192, 5376, 267520, 8388608, 262144, 32768, 4, 38883328, 131072, 0, 0, 218104528, 1
    .long 4, 16, 16, 8192, 5376, 267520, 8388608, 524288, 32768, 4, 6377472, 131072, 0, 0, 218104656, 1
    .long 1, 16, 16, 8192, 4608, 4864, 8388608, 1572864, 32768, 8, 10559488, 131072, 0, 0, 218105152, 4
    .long 2, 64, 72, 7168, 5632, 5632, 7340032, 0, 32768, 8, 54616064, 114688, 0, 0, 218103856, 1
    .long 2, 64, 72, 7168, 4608, 4608, 7340032, 1572864, 32768, 8, 60104704, 114688, 0, 0, 218104032, 1
    .long 2, 64, 72, 7168, 3584, 3584, 7340032, 3145728, 32768, 8, 65593344, 114688, 0, 0, 218104224, 1
    .long 1, 80, 80, 2048, 3670528, 3670784, 7340032, 63758336, 114688, 7, 178790400, 32768, 218104160, 7, 218106688, 1
    .long 0, 0, 0, 0, 0, 0, 0, 0, 0, 0, 0, 0, 0, 0, 0, 0
    .long 0, 0, 0, 0, 0, 0, 0, 0, 0, 0, 0, 0, 0, 0, 0, 0
    .long 6, 32, 32, 8192, 7424, 269568, 8388608, 0, 32768, 4, 37867520, 131072, 0, 0, 218104432, 1
    .long 4, 32, 32, 8192, 7424, 269568, 8388608, 262144, 32768, 4, 38916096, 131072, 0, 0, 218104560, 1
    .long 4, 16, 16, 8192, 7424, 269568, 8388608, 524288, 32768, 4, 6410240, 131072, 0, 0, 218104688, 1
    .long 1, 16, 16, 8192, 6656, 6912, 8388608, 1572864, 32768, 8, 10592256, 131072, 0, 0, 218105184, 4
    .long 2, 64, 72, 7168, 5888, 5888, 7340032, 0, 32768, 8, 54620160, 114688, 0, 0, 218103856, 1
    .long 2, 64, 72, 7168, 4864, 4864, 7340032, 1572864, 32768, 8, 60108800, 114688, 0, 0, 218104032, 1
    .long 2, 64, 72, 7168, 3840, 3840, 7340032, 3145728, 32768, 8, 65597440, 114688, 0, 0, 218104224, 1
    .long 1, 80, 80, 2048, 5505536, 5505792, 7340032, 63787008, 114688, 7, 182984704, 32768, 218104176, 7, 218106688, 1
    .long 0, 0, 0, 0, 0, 0, 0, 0, 0, 0, 0, 0, 0, 0, 0, 0
    .long 0, 0, 0, 0, 0, 0, 0, 0, 0, 0, 0, 0, 0, 0, 0, 0
    .long 6, 32, 32, 8192, 1536, 263680, 8388608, 0, 32768, 4, 37773312, 131072, 0, 0, 218104336, 1
    .long 4, 32, 32, 8192, 1536, 263680, 8388608, 262144, 32768, 4, 38821888, 131072, 0, 0, 218104464, 1
    .long 4, 16, 16, 8192, 1024, 263168, 8388608, 786432, 32768, 4, 7356416, 131072, 0, 0, 218104592, 1
    .long 1, 16, 16, 8192, 1024, 1280, 8388608, 1572864, 32768, 8, 10502144, 131072, 0, 0, 218105104, 4
    .long 2, 64, 72, 7168, 6144, 6144, 7340032, 0, 32768, 8, 54624256, 114688, 0, 0, 218103856, 1
    .long 2, 64, 72, 7168, 5120, 5120, 7340032, 1572864, 32768, 8, 60112896, 114688, 0, 0, 218104032, 1
    .long 2, 64, 72, 7168, 4096, 4096, 7340032, 3145728, 32768, 8, 65601536, 114688, 0, 0, 218104224, 1
    .long 1, 80, 80, 2048, 1024, 1280, 7340032, 63700992, 114688, 7, 170409984, 32768, 218104128, 7, 218106688, 1
    .long 0, 0, 0, 0, 0, 0, 0, 0, 0, 0, 0, 0, 0, 0, 0, 0
    .long 0, 0, 0, 0, 0, 0, 0, 0, 0, 0, 0, 0, 0, 0, 0, 0
    .long 6, 32, 32, 8192, 3584, 265728, 8388608, 0, 32768, 4, 37806080, 131072, 0, 0, 218104368, 1
    .long 4, 32, 32, 8192, 3584, 265728, 8388608, 262144, 32768, 4, 38854656, 131072, 0, 0, 218104496, 1
    .long 4, 16, 16, 8192, 3072, 265216, 8388608, 786432, 32768, 4, 7389184, 131072, 0, 0, 218104624, 1
    .long 1, 16, 16, 8192, 3072, 3328, 8388608, 1572864, 32768, 8, 10534912, 131072, 0, 0, 218105136, 4
    .long 2, 64, 72, 7168, 6400, 6400, 7340032, 0, 32768, 8, 54628352, 114688, 0, 0, 218103856, 1
    .long 2, 64, 72, 7168, 5376, 5376, 7340032, 1572864, 32768, 8, 60116992, 114688, 0, 0, 218104048, 1
    .long 2, 64, 72, 7168, 4352, 4352, 7340032, 3145728, 32768, 8, 65605632, 114688, 0, 0, 218104224, 1
    .long 1, 80, 80, 2048, 1836032, 1836288, 7340032, 63729664, 114688, 7, 174604288, 32768, 218104144, 7, 218106688, 1
    .long 0, 0, 0, 0, 0, 0, 0, 0, 0, 0, 0, 0, 0, 0, 0, 0
    .long 0, 0, 0, 0, 0, 0, 0, 0, 0, 0, 0, 0, 0, 0, 0, 0
    .long 6, 32, 32, 8192, 5632, 267776, 8388608, 0, 32768, 4, 37838848, 131072, 0, 0, 218104400, 1
    .long 4, 32, 32, 8192, 5632, 267776, 8388608, 262144, 32768, 4, 38887424, 131072, 0, 0, 218104528, 1
    .long 4, 16, 16, 8192, 5120, 267264, 8388608, 786432, 32768, 4, 7421952, 131072, 0, 0, 218104656, 1
    .long 1, 16, 16, 8192, 5120, 5376, 8388608, 1572864, 32768, 8, 10567680, 131072, 0, 0, 218105168, 4
    .long 2, 64, 72, 7168, 6656, 6656, 7340032, 0, 32768, 8, 54632448, 114688, 0, 0, 218103856, 1
    .long 2, 64, 72, 7168, 5632, 5632, 7340032, 1572864, 32768, 8, 60121088, 114688, 0, 0, 218104048, 1
    .long 2, 64, 72, 7168, 4608, 4608, 7340032, 3145728, 32768, 8, 65609728, 114688, 0, 0, 218104224, 1
    .long 1, 80, 80, 2048, 3671040, 3671296, 7340032, 63758336, 114688, 7, 178798592, 32768, 218104160, 7, 218106688, 1
    .long 0, 0, 0, 0, 0, 0, 0, 0, 0, 0, 0, 0, 0, 0, 0, 0
    .long 0, 0, 0, 0, 0, 0, 0, 0, 0, 0, 0, 0, 0, 0, 0, 0
    .long 6, 32, 32, 8192, 7680, 269824, 8388608, 0, 32768, 4, 37871616, 131072, 0, 0, 218104432, 1
    .long 4, 32, 32, 8192, 7680, 269824, 8388608, 262144, 32768, 4, 38920192, 131072, 0, 0, 218104560, 1
    .long 4, 16, 16, 8192, 7168, 269312, 8388608, 786432, 32768, 4, 7454720, 131072, 0, 0, 218104688, 1
    .long 1, 16, 16, 8192, 7168, 7424, 8388608, 1572864, 32768, 8, 10600448, 131072, 0, 0, 218105200, 4
    .long 2, 64, 72, 7168, 6912, 6912, 7340032, 0, 32768, 8, 54636544, 114688, 0, 0, 218103856, 1
    .long 2, 64, 72, 7168, 5888, 5888, 7340032, 1572864, 32768, 8, 60125184, 114688, 0, 0, 218104048, 1
    .long 2, 64, 72, 7168, 4864, 4864, 7340032, 3145728, 32768, 8, 65613824, 114688, 0, 0, 218104224, 1
    .long 1, 80, 80, 2048, 5506048, 5506304, 7340032, 63787008, 114688, 7, 182992896, 32768, 218104176, 7, 218106688, 1
    .long 0, 0, 0, 0, 0, 0, 0, 0, 0, 0, 0, 0, 0, 0, 0, 0
    .long 0, 0, 0, 0, 0, 0, 0, 0, 0, 0, 0, 0, 0, 0, 0, 0
    .long 6, 32, 32, 8192, 1792, 263936, 8388608, 0, 32768, 4, 37777408, 131072, 0, 0, 218104336, 1
    .long 4, 32, 32, 8192, 1792, 263936, 8388608, 262144, 32768, 4, 38825984, 131072, 0, 0, 218104464, 1
    .long 4, 16, 16, 8192, 1024, 263168, 8388608, 524288, 32768, 4, 6307840, 131072, 0, 0, 218104592, 1
    .long 1, 16, 16, 8192, 1536, 1792, 8388608, 1572864, 32768, 8, 10510336, 131072, 0, 0, 218105104, 4
    .long 2, 64, 72, 7168, 0, 0, 7340032, 524288, 32768, 8, 56360960, 114688, 0, 0, 218103872, 1
    .long 2, 64, 72, 7168, 6144, 6144, 7340032, 1572864, 32768, 8, 60129280, 114688, 0, 0, 218104048, 1
    .long 2, 64, 72, 7168, 5120, 5120, 7340032, 3145728, 32768, 8, 65617920, 114688, 0, 0, 218104224, 1
    .long 1, 80, 80, 2048, 1536, 1792, 7340032, 63700992, 114688, 7, 170418176, 32768, 218104128, 7, 218106688, 1
    .long 0, 0, 0, 0, 0, 0, 0, 0, 0, 0, 0, 0, 0, 0, 0, 0
    .long 0, 0, 0, 0, 0, 0, 0, 0, 0, 0, 0, 0, 0, 0, 0, 0
    .long 6, 32, 32, 8192, 3840, 265984, 8388608, 0, 32768, 4, 37810176, 131072, 0, 0, 218104368, 1
    .long 4, 32, 32, 8192, 3840, 265984, 8388608, 262144, 32768, 4, 38858752, 131072, 0, 0, 218104496, 1
    .long 4, 16, 16, 8192, 3072, 265216, 8388608, 524288, 32768, 4, 6340608, 131072, 0, 0, 218104624, 1
    .long 1, 16, 16, 8192, 3584, 3840, 8388608, 1572864, 32768, 8, 10543104, 131072, 0, 0, 218105136, 4
    .long 2, 64, 72, 7168, 256, 256, 7340032, 524288, 32768, 8, 56365056, 114688, 0, 0, 218103872, 1
    .long 2, 64, 72, 7168, 6400, 6400, 7340032, 1572864, 32768, 8, 60133376, 114688, 0, 0, 218104048, 1
    .long 2, 64, 72, 7168, 5376, 5376, 7340032, 3145728, 32768, 8, 65622016, 114688, 0, 0, 218104240, 1
    .long 1, 80, 80, 2048, 1836544, 1836800, 7340032, 63729664, 114688, 7, 174612480, 32768, 218104144, 7, 218106688, 1
    .long 0, 0, 0, 0, 0, 0, 0, 0, 0, 0, 0, 0, 0, 0, 0, 0
    .long 0, 0, 0, 0, 0, 0, 0, 0, 0, 0, 0, 0, 0, 0, 0, 0
    .long 6, 32, 32, 8192, 5888, 268032, 8388608, 0, 32768, 4, 37842944, 131072, 0, 0, 218104400, 1
    .long 4, 32, 32, 8192, 5888, 268032, 8388608, 262144, 32768, 4, 38891520, 131072, 0, 0, 218104528, 1
    .long 4, 16, 16, 8192, 5120, 267264, 8388608, 524288, 32768, 4, 6373376, 131072, 0, 0, 218104656, 1
    .long 1, 16, 16, 8192, 5632, 5888, 8388608, 1572864, 32768, 8, 10575872, 131072, 0, 0, 218105168, 4
    .long 2, 64, 72, 7168, 512, 512, 7340032, 524288, 32768, 8, 56369152, 114688, 0, 0, 218103872, 1
    .long 2, 64, 72, 7168, 6656, 6656, 7340032, 1572864, 32768, 8, 60137472, 114688, 0, 0, 218104048, 1
    .long 2, 64, 72, 7168, 5632, 5632, 7340032, 3145728, 32768, 8, 65626112, 114688, 0, 0, 218104240, 1
    .long 1, 80, 80, 2048, 3671552, 3671808, 7340032, 63758336, 114688, 7, 178806784, 32768, 218104160, 7, 218106688, 1
    .long 0, 0, 0, 0, 0, 0, 0, 0, 0, 0, 0, 0, 0, 0, 0, 0
    .long 0, 0, 0, 0, 0, 0, 0, 0, 0, 0, 0, 0, 0, 0, 0, 0
    .long 6, 32, 32, 8192, 7936, 270080, 8388608, 0, 32768, 4, 37875712, 131072, 0, 0, 218104432, 1
    .long 4, 32, 32, 8192, 7936, 270080, 8388608, 262144, 32768, 4, 38924288, 131072, 0, 0, 218104560, 1
    .long 4, 16, 16, 8192, 7168, 269312, 8388608, 524288, 32768, 4, 6406144, 131072, 0, 0, 218104688, 1
    .long 1, 16, 16, 8192, 7680, 7936, 8388608, 1572864, 32768, 8, 10608640, 131072, 0, 0, 218105200, 4
    .long 2, 64, 72, 7168, 768, 768, 7340032, 524288, 32768, 8, 56373248, 114688, 0, 0, 218103872, 1
    .long 2, 64, 72, 7168, 6912, 6912, 7340032, 1572864, 32768, 8, 60141568, 114688, 0, 0, 218104048, 1
    .long 2, 64, 72, 7168, 5888, 5888, 7340032, 3145728, 32768, 8, 65630208, 114688, 0, 0, 218104240, 1
    .long 1, 80, 80, 2048, 5506560, 5506816, 7340032, 63787008, 114688, 7, 183001088, 32768, 218104176, 7, 218106688, 1
    .long 0, 0, 0, 0, 0, 0, 0, 0, 0, 0, 0, 0, 0, 0, 0, 0
    .long 0, 0, 0, 0, 0, 0, 0, 0, 0, 0, 0, 0, 0, 0, 0, 0
    .long 6, 16, 16, 8192, 0, 262144, 8388608, 0, 32768, 4, 4194304, 131072, 0, 0, 218104320, 1
    .long 4, 16, 16, 8192, 0, 262144, 8388608, 262144, 32768, 4, 5242880, 131072, 0, 0, 218104448, 1
    .long 4, 16, 16, 8192, 0, 262144, 8388608, 524288, 32768, 4, 6291456, 131072, 0, 0, 218104576, 1
    .long 1, 32, 32, 8192, 0, 256, 8388608, 2097152, 32768, 8, 46137344, 131072, 0, 0, 218105344, 4
    .long 2, 64, 72, 7168, 1024, 1024, 7340032, 524288, 32768, 8, 56377344, 114688, 0, 0, 218103872, 1
    .long 2, 64, 72, 7168, 0, 0, 7340032, 2097152, 32768, 8, 61865984, 114688, 0, 0, 218104064, 1
    .long 2, 64, 72, 7168, 6144, 6144, 7340032, 3145728, 32768, 8, 65634304, 114688, 0, 0, 218104240, 1
    .long 1, 80, 80, 2048, 0, 256, 7340032, 65536000, 114688, 7, 170917888, 32768, 218104192, 7, 218106752, 1
    .long 0, 0, 0, 0, 0, 0, 0, 0, 0, 0, 0, 0, 0, 0, 0, 0
    .long 0, 0, 0, 0, 0, 0, 0, 0, 0, 0, 0, 0, 0, 0, 0, 0
    .long 6, 16, 16, 8192, 2048, 264192, 8388608, 0, 32768, 4, 4227072, 131072, 0, 0, 218104352, 1
    .long 4, 16, 16, 8192, 2048, 264192, 8388608, 262144, 32768, 4, 5275648, 131072, 0, 0, 218104480, 1
    .long 4, 16, 16, 8192, 2048, 264192, 8388608, 524288, 32768, 4, 6324224, 131072, 0, 0, 218104608, 1
    .long 1, 32, 32, 8192, 2048, 2304, 8388608, 2097152, 32768, 8, 46170112, 131072, 0, 0, 218105376, 4
    .long 2, 64, 72, 7168, 1280, 1280, 7340032, 524288, 32768, 8, 56381440, 114688, 0, 0, 218103872, 1
    .long 2, 64, 72, 7168, 256, 256, 7340032, 2097152, 32768, 8, 61870080, 114688, 0, 0, 218104064, 1
    .long 2, 64, 72, 7168, 6400, 6400, 7340032, 3145728, 32768, 8, 65638400, 114688, 0, 0, 218104240, 1
    .long 1, 80, 80, 2048, 1835008, 1835264, 7340032, 65564672, 114688, 7, 175112192, 32768, 218104208, 7, 218106752, 1
    .long 0, 0, 0, 0, 0, 0, 0, 0, 0, 0, 0, 0, 0, 0, 0, 0
    .long 0, 0, 0, 0, 0, 0, 0, 0, 0, 0, 0, 0, 0, 0, 0, 0
    .long 6, 16, 16, 8192, 4096, 266240, 8388608, 0, 32768, 4, 4259840, 131072, 0, 0, 218104384, 1
    .long 4, 16, 16, 8192, 4096, 266240, 8388608, 262144, 32768, 4, 5308416, 131072, 0, 0, 218104512, 1
    .long 4, 16, 16, 8192, 4096, 266240, 8388608, 524288, 32768, 4, 6356992, 131072, 0, 0, 218104640, 1
    .long 1, 32, 32, 8192, 4096, 4352, 8388608, 2097152, 32768, 8, 46202880, 131072, 0, 0, 218105408, 4
    .long 2, 64, 72, 7168, 1536, 1536, 7340032, 524288, 32768, 8, 56385536, 114688, 0, 0, 218103872, 1
    .long 2, 64, 72, 7168, 512, 512, 7340032, 2097152, 32768, 8, 61874176, 114688, 0, 0, 218104064, 1
    .long 2, 64, 72, 7168, 6656, 6656, 7340032, 3145728, 32768, 8, 65642496, 114688, 0, 0, 218104240, 1
    .long 1, 80, 80, 2048, 3670016, 3670272, 7340032, 65593344, 114688, 7, 179306496, 32768, 218104224, 7, 218106752, 1
    .long 0, 0, 0, 0, 0, 0, 0, 0, 0, 0, 0, 0, 0, 0, 0, 0
    .long 0, 0, 0, 0, 0, 0, 0, 0, 0, 0, 0, 0, 0, 0, 0, 0
    .long 6, 16, 16, 8192, 6144, 268288, 8388608, 0, 32768, 4, 4292608, 131072, 0, 0, 218104416, 1
    .long 4, 16, 16, 8192, 6144, 268288, 8388608, 262144, 32768, 4, 5341184, 131072, 0, 0, 218104544, 1
    .long 4, 16, 16, 8192, 6144, 268288, 8388608, 524288, 32768, 4, 6389760, 131072, 0, 0, 218104672, 1
    .long 1, 32, 32, 8192, 6144, 6400, 8388608, 2097152, 32768, 8, 46235648, 131072, 0, 0, 218105440, 4
    .long 2, 64, 72, 7168, 1792, 1792, 7340032, 524288, 32768, 8, 56389632, 114688, 0, 0, 218103888, 1
    .long 2, 64, 72, 7168, 768, 768, 7340032, 2097152, 32768, 8, 61878272, 114688, 0, 0, 218104064, 1
    .long 2, 64, 72, 7168, 6912, 6912, 7340032, 3145728, 32768, 8, 65646592, 114688, 0, 0, 218104240, 1
    .long 1, 80, 80, 2048, 5505024, 5505280, 7340032, 65622016, 114688, 7, 183500800, 32768, 218104240, 7, 218106752, 1
    .long 0, 0, 0, 0, 0, 0, 0, 0, 0, 0, 0, 0, 0, 0, 0, 0
    .long 0, 0, 0, 0, 0, 0, 0, 0, 0, 0, 0, 0, 0, 0, 0, 0
    .long 6, 16, 16, 8192, 256, 262400, 8388608, 0, 32768, 4, 4198400, 131072, 0, 0, 218104320, 1
    .long 4, 16, 16, 8192, 256, 262400, 8388608, 262144, 32768, 4, 5246976, 131072, 0, 0, 218104448, 1
    .long 4, 16, 16, 8192, 256, 262400, 8388608, 524288, 32768, 4, 6295552, 131072, 0, 0, 218104576, 1
    .long 1, 32, 32, 8192, 512, 768, 8388608, 2097152, 32768, 8, 46145536, 131072, 0, 0, 218105344, 4
    .long 2, 64, 72, 7168, 2048, 2048, 7340032, 524288, 32768, 8, 56393728, 114688, 0, 0, 218103888, 1
    .long 2, 64, 72, 7168, 1024, 1024, 7340032, 2097152, 32768, 8, 61882368, 114688, 0, 0, 218104064, 1
    .long 2, 64, 72, 7168, 0, 0, 7340032, 3670016, 32768, 8, 67371008, 114688, 0, 0, 218104256, 1
    .long 1, 80, 80, 2048, 512, 768, 7340032, 65536000, 114688, 7, 170926080, 32768, 218104192, 7, 218106752, 1
    .long 0, 0, 0, 0, 0, 0, 0, 0, 0, 0, 0, 0, 0, 0, 0, 0
    .long 0, 0, 0, 0, 0, 0, 0, 0, 0, 0, 0, 0, 0, 0, 0, 0
    .long 6, 16, 16, 8192, 2304, 264448, 8388608, 0, 32768, 4, 4231168, 131072, 0, 0, 218104352, 1
    .long 4, 16, 16, 8192, 2304, 264448, 8388608, 262144, 32768, 4, 5279744, 131072, 0, 0, 218104480, 1
    .long 4, 16, 16, 8192, 2304, 264448, 8388608, 524288, 32768, 4, 6328320, 131072, 0, 0, 218104608, 1
    .long 1, 32, 32, 8192, 2560, 2816, 8388608, 2097152, 32768, 8, 46178304, 131072, 0, 0, 218105376, 4
    .long 2, 64, 72, 7168, 2304, 2304, 7340032, 524288, 32768, 8, 56397824, 114688, 0, 0, 218103888, 1
    .long 2, 64, 72, 7168, 1280, 1280, 7340032, 2097152, 32768, 8, 61886464, 114688, 0, 0, 218104064, 1
    .long 2, 64, 72, 7168, 256, 256, 7340032, 3670016, 32768, 8, 67375104, 114688, 0, 0, 218104256, 1
    .long 1, 80, 80, 2048, 1835520, 1835776, 7340032, 65564672, 114688, 7, 175120384, 32768, 218104208, 7, 218106752, 1
    .long 0, 0, 0, 0, 0, 0, 0, 0, 0, 0, 0, 0, 0, 0, 0, 0
    .long 0, 0, 0, 0, 0, 0, 0, 0, 0, 0, 0, 0, 0, 0, 0, 0
    .long 6, 16, 16, 8192, 4352, 266496, 8388608, 0, 32768, 4, 4263936, 131072, 0, 0, 218104384, 1
    .long 4, 16, 16, 8192, 4352, 266496, 8388608, 262144, 32768, 4, 5312512, 131072, 0, 0, 218104512, 1
    .long 4, 16, 16, 8192, 4352, 266496, 8388608, 524288, 32768, 4, 6361088, 131072, 0, 0, 218104640, 1
    .long 1, 32, 32, 8192, 4608, 4864, 8388608, 2097152, 32768, 8, 46211072, 131072, 0, 0, 218105408, 4
    .long 2, 64, 72, 7168, 2560, 2560, 7340032, 524288, 32768, 8, 56401920, 114688, 0, 0, 218103888, 1
    .long 2, 64, 72, 7168, 1536, 1536, 7340032, 2097152, 32768, 8, 61890560, 114688, 0, 0, 218104064, 1
    .long 2, 64, 72, 7168, 512, 512, 7340032, 3670016, 32768, 8, 67379200, 114688, 0, 0, 218104256, 1
    .long 1, 80, 80, 2048, 3670528, 3670784, 7340032, 65593344, 114688, 7, 179314688, 32768, 218104224, 7, 218106752, 1
    .long 0, 0, 0, 0, 0, 0, 0, 0, 0, 0, 0, 0, 0, 0, 0, 0
    .long 0, 0, 0, 0, 0, 0, 0, 0, 0, 0, 0, 0, 0, 0, 0, 0
    .long 6, 16, 16, 8192, 6400, 268544, 8388608, 0, 32768, 4, 4296704, 131072, 0, 0, 218104416, 1
    .long 4, 16, 16, 8192, 6400, 268544, 8388608, 262144, 32768, 4, 5345280, 131072, 0, 0, 218104544, 1
    .long 4, 16, 16, 8192, 6400, 268544, 8388608, 524288, 32768, 4, 6393856, 131072, 0, 0, 218104672, 1
    .long 1, 32, 32, 8192, 6656, 6912, 8388608, 2097152, 32768, 8, 46243840, 131072, 0, 0, 218105440, 4
    .long 2, 64, 72, 7168, 2816, 2816, 7340032, 524288, 32768, 8, 56406016, 114688, 0, 0, 218103888, 1
    .long 2, 64, 72, 7168, 1792, 1792, 7340032, 2097152, 32768, 8, 61894656, 114688, 0, 0, 218104080, 1
    .long 2, 64, 72, 7168, 768, 768, 7340032, 3670016, 32768, 8, 67383296, 114688, 0, 0, 218104256, 1
    .long 1, 80, 80, 2048, 5505536, 5505792, 7340032, 65622016, 114688, 7, 183508992, 32768, 218104240, 7, 218106752, 1
    .long 0, 0, 0, 0, 0, 0, 0, 0, 0, 0, 0, 0, 0, 0, 0, 0
    .long 0, 0, 0, 0, 0, 0, 0, 0, 0, 0, 0, 0, 0, 0, 0, 0
    .long 6, 16, 16, 8192, 512, 262656, 8388608, 0, 32768, 4, 4202496, 131072, 0, 0, 218104320, 1
    .long 4, 16, 16, 8192, 512, 262656, 8388608, 262144, 32768, 4, 5251072, 131072, 0, 0, 218104448, 1
    .long 4, 16, 16, 8192, 512, 262656, 8388608, 524288, 32768, 4, 6299648, 131072, 0, 0, 218104576, 1
    .long 1, 32, 32, 8192, 1024, 1280, 8388608, 2097152, 32768, 8, 46153728, 131072, 0, 0, 218105360, 4
    .long 2, 64, 72, 7168, 3072, 3072, 7340032, 524288, 32768, 8, 56410112, 114688, 0, 0, 218103888, 1
    .long 2, 64, 72, 7168, 2048, 2048, 7340032, 2097152, 32768, 8, 61898752, 114688, 0, 0, 218104080, 1
    .long 2, 64, 72, 7168, 1024, 1024, 7340032, 3670016, 32768, 8, 67387392, 114688, 0, 0, 218104256, 1
    .long 1, 80, 80, 2048, 1024, 1280, 7340032, 65536000, 114688, 7, 170934272, 32768, 218104192, 7, 218106752, 1
    .long 0, 0, 0, 0, 0, 0, 0, 0, 0, 0, 0, 0, 0, 0, 0, 0
    .long 0, 0, 0, 0, 0, 0, 0, 0, 0, 0, 0, 0, 0, 0, 0, 0
    .long 6, 16, 16, 8192, 2560, 264704, 8388608, 0, 32768, 4, 4235264, 131072, 0, 0, 218104352, 1
    .long 4, 16, 16, 8192, 2560, 264704, 8388608, 262144, 32768, 4, 5283840, 131072, 0, 0, 218104480, 1
    .long 4, 16, 16, 8192, 2560, 264704, 8388608, 524288, 32768, 4, 6332416, 131072, 0, 0, 218104608, 1
    .long 1, 32, 32, 8192, 3072, 3328, 8388608, 2097152, 32768, 8, 46186496, 131072, 0, 0, 218105392, 4
    .long 2, 64, 72, 7168, 3328, 3328, 7340032, 524288, 32768, 8, 56414208, 114688, 0, 0, 218103888, 1
    .long 2, 64, 72, 7168, 2304, 2304, 7340032, 2097152, 32768, 8, 61902848, 114688, 0, 0, 218104080, 1
    .long 2, 64, 72, 7168, 1280, 1280, 7340032, 3670016, 32768, 8, 67391488, 114688, 0, 0, 218104256, 1
    .long 1, 80, 80, 2048, 1836032, 1836288, 7340032, 65564672, 114688, 7, 175128576, 32768, 218104208, 7, 218106752, 1
    .long 0, 0, 0, 0, 0, 0, 0, 0, 0, 0, 0, 0, 0, 0, 0, 0
    .long 0, 0, 0, 0, 0, 0, 0, 0, 0, 0, 0, 0, 0, 0, 0, 0
    .long 6, 16, 16, 8192, 4608, 266752, 8388608, 0, 32768, 4, 4268032, 131072, 0, 0, 218104384, 1
    .long 4, 16, 16, 8192, 4608, 266752, 8388608, 262144, 32768, 4, 5316608, 131072, 0, 0, 218104512, 1
    .long 4, 16, 16, 8192, 4608, 266752, 8388608, 524288, 32768, 4, 6365184, 131072, 0, 0, 218104640, 1
    .long 1, 32, 32, 8192, 5120, 5376, 8388608, 2097152, 32768, 8, 46219264, 131072, 0, 0, 218105424, 4
    .long 2, 64, 72, 7168, 3584, 3584, 7340032, 524288, 32768, 8, 56418304, 114688, 0, 0, 218103904, 1
    .long 2, 64, 72, 7168, 2560, 2560, 7340032, 2097152, 32768, 8, 61906944, 114688, 0, 0, 218104080, 1
    .long 2, 64, 72, 7168, 1536, 1536, 7340032, 3670016, 32768, 8, 67395584, 114688, 0, 0, 218104256, 1
    .long 1, 80, 80, 2048, 3671040, 3671296, 7340032, 65593344, 114688, 7, 179322880, 32768, 218104224, 7, 218106752, 1
    .long 0, 0, 0, 0, 0, 0, 0, 0, 0, 0, 0, 0, 0, 0, 0, 0
    .long 0, 0, 0, 0, 0, 0, 0, 0, 0, 0, 0, 0, 0, 0, 0, 0
    .long 6, 16, 16, 8192, 6656, 268800, 8388608, 0, 32768, 4, 4300800, 131072, 0, 0, 218104416, 1
    .long 4, 16, 16, 8192, 6656, 268800, 8388608, 262144, 32768, 4, 5349376, 131072, 0, 0, 218104544, 1
    .long 4, 16, 16, 8192, 6656, 268800, 8388608, 524288, 32768, 4, 6397952, 131072, 0, 0, 218104672, 1
    .long 1, 32, 32, 8192, 7168, 7424, 8388608, 2097152, 32768, 8, 46252032, 131072, 0, 0, 218105456, 4
    .long 2, 64, 72, 7168, 3840, 3840, 7340032, 524288, 32768, 8, 56422400, 114688, 0, 0, 218103904, 1
    .long 2, 64, 72, 7168, 2816, 2816, 7340032, 2097152, 32768, 8, 61911040, 114688, 0, 0, 218104080, 1
    .long 2, 64, 72, 7168, 1792, 1792, 7340032, 3670016, 32768, 8, 67399680, 114688, 0, 0, 218104272, 1
    .long 1, 80, 80, 2048, 5506048, 5506304, 7340032, 65622016, 114688, 7, 183517184, 32768, 218104240, 7, 218106752, 1
    .long 0, 0, 0, 0, 0, 0, 0, 0, 0, 0, 0, 0, 0, 0, 0, 0
    .long 0, 0, 0, 0, 0, 0, 0, 0, 0, 0, 0, 0, 0, 0, 0, 0
    .long 6, 16, 16, 8192, 768, 262912, 8388608, 0, 32768, 4, 4206592, 131072, 0, 0, 218104320, 1
    .long 4, 16, 16, 8192, 768, 262912, 8388608, 262144, 32768, 4, 5255168, 131072, 0, 0, 218104448, 1
    .long 4, 16, 16, 8192, 768, 262912, 8388608, 524288, 32768, 4, 6303744, 131072, 0, 0, 218104576, 1
    .long 1, 32, 32, 8192, 1536, 1792, 8388608, 2097152, 32768, 8, 46161920, 131072, 0, 0, 218105360, 4
    .long 2, 64, 72, 7168, 4096, 4096, 7340032, 524288, 32768, 8, 56426496, 114688, 0, 0, 218103904, 1
    .long 2, 64, 72, 7168, 3072, 3072, 7340032, 2097152, 32768, 8, 61915136, 114688, 0, 0, 218104080, 1
    .long 2, 64, 72, 7168, 2048, 2048, 7340032, 3670016, 32768, 8, 67403776, 114688, 0, 0, 218104272, 1
    .long 1, 80, 80, 2048, 1536, 1792, 7340032, 65536000, 114688, 7, 170942464, 32768, 218104192, 7, 218106752, 1
    .long 0, 0, 0, 0, 0, 0, 0, 0, 0, 0, 0, 0, 0, 0, 0, 0
    .long 0, 0, 0, 0, 0, 0, 0, 0, 0, 0, 0, 0, 0, 0, 0, 0
    .long 6, 16, 16, 8192, 2816, 264960, 8388608, 0, 32768, 4, 4239360, 131072, 0, 0, 218104352, 1
    .long 4, 16, 16, 8192, 2816, 264960, 8388608, 262144, 32768, 4, 5287936, 131072, 0, 0, 218104480, 1
    .long 4, 16, 16, 8192, 2816, 264960, 8388608, 524288, 32768, 4, 6336512, 131072, 0, 0, 218104608, 1
    .long 1, 32, 32, 8192, 3584, 3840, 8388608, 2097152, 32768, 8, 46194688, 131072, 0, 0, 218105392, 4
    .long 2, 64, 72, 7168, 4352, 4352, 7340032, 524288, 32768, 8, 56430592, 114688, 0, 0, 218103904, 1
    .long 2, 64, 72, 7168, 3328, 3328, 7340032, 2097152, 32768, 8, 61919232, 114688, 0, 0, 218104080, 1
    .long 2, 64, 72, 7168, 2304, 2304, 7340032, 3670016, 32768, 8, 67407872, 114688, 0, 0, 218104272, 1
    .long 1, 80, 80, 2048, 1836544, 1836800, 7340032, 65564672, 114688, 7, 175136768, 32768, 218104208, 7, 218106752, 1
    .long 0, 0, 0, 0, 0, 0, 0, 0, 0, 0, 0, 0, 0, 0, 0, 0
    .long 0, 0, 0, 0, 0, 0, 0, 0, 0, 0, 0, 0, 0, 0, 0, 0
    .long 6, 16, 16, 8192, 4864, 267008, 8388608, 0, 32768, 4, 4272128, 131072, 0, 0, 218104384, 1
    .long 4, 16, 16, 8192, 4864, 267008, 8388608, 262144, 32768, 4, 5320704, 131072, 0, 0, 218104512, 1
    .long 4, 16, 16, 8192, 4864, 267008, 8388608, 524288, 32768, 4, 6369280, 131072, 0, 0, 218104640, 1
    .long 1, 32, 32, 8192, 5632, 5888, 8388608, 2097152, 32768, 8, 46227456, 131072, 0, 0, 218105424, 4
    .long 2, 64, 72, 7168, 4608, 4608, 7340032, 524288, 32768, 8, 56434688, 114688, 0, 0, 218103904, 1
    .long 2, 64, 72, 7168, 3584, 3584, 7340032, 2097152, 32768, 8, 61923328, 114688, 0, 0, 218104096, 1
    .long 2, 64, 72, 7168, 2560, 2560, 7340032, 3670016, 32768, 8, 67411968, 114688, 0, 0, 218104272, 1
    .long 1, 80, 80, 2048, 3671552, 3671808, 7340032, 65593344, 114688, 7, 179331072, 32768, 218104224, 7, 218106752, 1
    .long 0, 0, 0, 0, 0, 0, 0, 0, 0, 0, 0, 0, 0, 0, 0, 0
    .long 0, 0, 0, 0, 0, 0, 0, 0, 0, 0, 0, 0, 0, 0, 0, 0
    .long 6, 16, 16, 8192, 6912, 269056, 8388608, 0, 32768, 4, 4304896, 131072, 0, 0, 218104416, 1
    .long 4, 16, 16, 8192, 6912, 269056, 8388608, 262144, 32768, 4, 5353472, 131072, 0, 0, 218104544, 1
    .long 4, 16, 16, 8192, 6912, 269056, 8388608, 524288, 32768, 4, 6402048, 131072, 0, 0, 218104672, 1
    .long 1, 32, 32, 8192, 7680, 7936, 8388608, 2097152, 32768, 8, 46260224, 131072, 0, 0, 218105456, 4
    .long 2, 64, 72, 7168, 4864, 4864, 7340032, 524288, 32768, 8, 56438784, 114688, 0, 0, 218103904, 1
    .long 2, 64, 72, 7168, 3840, 3840, 7340032, 2097152, 32768, 8, 61927424, 114688, 0, 0, 218104096, 1
    .long 2, 64, 72, 7168, 2816, 2816, 7340032, 3670016, 32768, 8, 67416064, 114688, 0, 0, 218104272, 1
    .long 1, 80, 80, 2048, 5506560, 5506816, 7340032, 65622016, 114688, 7, 183525376, 32768, 218104240, 7, 218106752, 1
    .long 0, 0, 0, 0, 0, 0, 0, 0, 0, 0, 0, 0, 0, 0, 0, 0
    .long 0, 0, 0, 0, 0, 0, 0, 0, 0, 0, 0, 0, 0, 0, 0, 0
    .long 6, 16, 16, 8192, 1024, 263168, 8388608, 0, 32768, 4, 4210688, 131072, 0, 0, 218104336, 1
    .long 4, 16, 16, 8192, 1024, 263168, 8388608, 262144, 32768, 4, 5259264, 131072, 0, 0, 218104464, 1
    .long 4, 16, 16, 8192, 768, 262912, 8388608, 786432, 32768, 4, 7352320, 131072, 0, 0, 218104576, 1
    .long 1, 24, 24, 8192, 0, 256, 8388608, 2097152, 32768, 8, 29360128, 131072, 0, 0, 218105344, 4
    .long 2, 64, 72, 7168, 5120, 5120, 7340032, 524288, 32768, 8, 56442880, 114688, 0, 0, 218103904, 1
    .long 2, 64, 72, 7168, 4096, 4096, 7340032, 2097152, 32768, 8, 61931520, 114688, 0, 0, 218104096, 1
    .long 2, 64, 72, 7168, 3072, 3072, 7340032, 3670016, 32768, 8, 67420160, 114688, 0, 0, 218104272, 1
    .long 1, 80, 80, 2048, 0, 256, 7340032, 67371008, 114688, 7, 171442176, 32768, 218104256, 7, 218106816, 1
    .long 0, 0, 0, 0, 0, 0, 0, 0, 0, 0, 0, 0, 0, 0, 0, 0
    .long 0, 0, 0, 0, 0, 0, 0, 0, 0, 0, 0, 0, 0, 0, 0, 0
    .long 6, 16, 16, 8192, 3072, 265216, 8388608, 0, 32768, 4, 4243456, 131072, 0, 0, 218104368, 1
    .long 4, 16, 16, 8192, 3072, 265216, 8388608, 262144, 32768, 4, 5292032, 131072, 0, 0, 218104496, 1
    .long 4, 16, 16, 8192, 2816, 264960, 8388608, 786432, 32768, 4, 7385088, 131072, 0, 0, 218104608, 1
    .long 1, 24, 24, 8192, 2048, 2304, 8388608, 2097152, 32768, 8, 29392896, 131072, 0, 0, 218105376, 4
    .long 2, 64, 72, 7168, 5376, 5376, 7340032, 524288, 32768, 8, 56446976, 114688, 0, 0, 218103920, 1
    .long 2, 64, 72, 7168, 4352, 4352, 7340032, 2097152, 32768, 8, 61935616, 114688, 0, 0, 218104096, 1
    .long 2, 64, 72, 7168, 3328, 3328, 7340032, 3670016, 32768, 8, 67424256, 114688, 0, 0, 218104272, 1
    .long 1, 80, 80, 2048, 1835008, 1835264, 7340032, 67399680, 114688, 7, 175636480, 32768, 218104272, 7, 218106816, 1
    .long 0, 0, 0, 0, 0, 0, 0, 0, 0, 0, 0, 0, 0, 0, 0, 0
    .long 0, 0, 0, 0, 0, 0, 0, 0, 0, 0, 0, 0, 0, 0, 0, 0
    .long 6, 16, 16, 8192, 5120, 267264, 8388608, 0, 32768, 4, 4276224, 131072, 0, 0, 218104400, 1
    .long 4, 16, 16, 8192, 5120, 267264, 8388608, 262144, 32768, 4, 5324800, 131072, 0, 0, 218104528, 1
    .long 4, 16, 16, 8192, 4864, 267008, 8388608, 786432, 32768, 4, 7417856, 131072, 0, 0, 218104640, 1
    .long 1, 24, 24, 8192, 4096, 4352, 8388608, 2097152, 32768, 8, 29425664, 131072, 0, 0, 218105408, 4
    .long 2, 64, 72, 7168, 5632, 5632, 7340032, 524288, 32768, 8, 56451072, 114688, 0, 0, 218103920, 1
    .long 2, 64, 72, 7168, 4608, 4608, 7340032, 2097152, 32768, 8, 61939712, 114688, 0, 0, 218104096, 1
    .long 2, 64, 72, 7168, 3584, 3584, 7340032, 3670016, 32768, 8, 67428352, 114688, 0, 0, 218104288, 1
    .long 1, 80, 80, 2048, 3670016, 3670272, 7340032, 67428352, 114688, 7, 179830784, 32768, 218104288, 7, 218106816, 1
    .long 0, 0, 0, 0, 0, 0, 0, 0, 0, 0, 0, 0, 0, 0, 0, 0
    .long 0, 0, 0, 0, 0, 0, 0, 0, 0, 0, 0, 0, 0, 0, 0, 0
    .long 6, 16, 16, 8192, 7168, 269312, 8388608, 0, 32768, 4, 4308992, 131072, 0, 0, 218104432, 1
    .long 4, 16, 16, 8192, 7168, 269312, 8388608, 262144, 32768, 4, 5357568, 131072, 0, 0, 218104560, 1
    .long 4, 16, 16, 8192, 6912, 269056, 8388608, 786432, 32768, 4, 7450624, 131072, 0, 0, 218104672, 1
    .long 1, 24, 24, 8192, 6144, 6400, 8388608, 2097152, 32768, 8, 29458432, 131072, 0, 0, 218105440, 4
    .long 2, 64, 72, 7168, 5888, 5888, 7340032, 524288, 32768, 8, 56455168, 114688, 0, 0, 218103920, 1
    .long 2, 64, 72, 7168, 4864, 4864, 7340032, 2097152, 32768, 8, 61943808, 114688, 0, 0, 218104096, 1
    .long 2, 64, 72, 7168, 3840, 3840, 7340032, 3670016, 32768, 8, 67432448, 114688, 0, 0, 218104288, 1
    .long 1, 80, 80, 2048, 5505024, 5505280, 7340032, 67457024, 114688, 7, 184025088, 32768, 218104304, 7, 218106816, 1
    .long 0, 0, 0, 0, 0, 0, 0, 0, 0, 0, 0, 0, 0, 0, 0, 0
    .long 0, 0, 0, 0, 0, 0, 0, 0, 0, 0, 0, 0, 0, 0, 0, 0
    .long 6, 16, 16, 8192, 1280, 263424, 8388608, 0, 32768, 4, 4214784, 131072, 0, 0, 218104336, 1
    .long 4, 16, 16, 8192, 1280, 263424, 8388608, 262144, 32768, 4, 5263360, 131072, 0, 0, 218104464, 1
    .long 4, 16, 16, 8192, 512, 262656, 8388608, 786432, 32768, 4, 7348224, 131072, 0, 0, 218104576, 1
    .long 1, 24, 24, 8192, 512, 768, 8388608, 2097152, 32768, 8, 29368320, 131072, 0, 0, 218105344, 4
    .long 2, 64, 72, 7168, 6144, 6144, 7340032, 524288, 32768, 8, 56459264, 114688, 0, 0, 218103920, 1
    .long 2, 64, 72, 7168, 5120, 5120, 7340032, 2097152, 32768, 8, 61947904, 114688, 0, 0, 218104096, 1
    .long 2, 64, 72, 7168, 4096, 4096, 7340032, 3670016, 32768, 8, 67436544, 114688, 0, 0, 218104288, 1
    .long 1, 80, 80, 2048, 512, 768, 7340032, 67371008, 114688, 7, 171450368, 32768, 218104256, 7, 218106816, 1
    .long 0, 0, 0, 0, 0, 0, 0, 0, 0, 0, 0, 0, 0, 0, 0, 0
    .long 0, 0, 0, 0, 0, 0, 0, 0, 0, 0, 0, 0, 0, 0, 0, 0
    .long 6, 16, 16, 8192, 3328, 265472, 8388608, 0, 32768, 4, 4247552, 131072, 0, 0, 218104368, 1
    .long 4, 16, 16, 8192, 3328, 265472, 8388608, 262144, 32768, 4, 5296128, 131072, 0, 0, 218104496, 1
    .long 4, 16, 16, 8192, 2560, 264704, 8388608, 786432, 32768, 4, 7380992, 131072, 0, 0, 218104608, 1
    .long 1, 24, 24, 8192, 2560, 2816, 8388608, 2097152, 32768, 8, 29401088, 131072, 0, 0, 218105376, 4
    .long 2, 64, 72, 7168, 6400, 6400, 7340032, 524288, 32768, 8, 56463360, 114688, 0, 0, 218103920, 1
    .long 2, 64, 72, 7168, 5376, 5376, 7340032, 2097152, 32768, 8, 61952000, 114688, 0, 0, 218104112, 1
    .long 2, 64, 72, 7168, 4352, 4352, 7340032, 3670016, 32768, 8, 67440640, 114688, 0, 0, 218104288, 1
    .long 1, 80, 80, 2048, 1835520, 1835776, 7340032, 67399680, 114688, 7, 175644672, 32768, 218104272, 7, 218106816, 1
    .long 0, 0, 0, 0, 0, 0, 0, 0, 0, 0, 0, 0, 0, 0, 0, 0
    .long 0, 0, 0, 0, 0, 0, 0, 0, 0, 0, 0, 0, 0, 0, 0, 0
    .long 6, 16, 16, 8192, 5376, 267520, 8388608, 0, 32768, 4, 4280320, 131072, 0, 0, 218104400, 1
    .long 4, 16, 16, 8192, 5376, 267520, 8388608, 262144, 32768, 4, 5328896, 131072, 0, 0, 218104528, 1
    .long 4, 16, 16, 8192, 4608, 266752, 8388608, 786432, 32768, 4, 7413760, 131072, 0, 0, 218104640, 1
    .long 1, 24, 24, 8192, 4608, 4864, 8388608, 2097152, 32768, 8, 29433856, 131072, 0, 0, 218105408, 4
    .long 2, 64, 72, 7168, 6656, 6656, 7340032, 524288, 32768, 8, 56467456, 114688, 0, 0, 218103920, 1
    .long 2, 64, 72, 7168, 5632, 5632, 7340032, 2097152, 32768, 8, 61956096, 114688, 0, 0, 218104112, 1
    .long 2, 64, 72, 7168, 4608, 4608, 7340032, 3670016, 32768, 8, 67444736, 114688, 0, 0, 218104288, 1
    .long 1, 80, 80, 2048, 3670528, 3670784, 7340032, 67428352, 114688, 7, 179838976, 32768, 218104288, 7, 218106816, 1
    .long 0, 0, 0, 0, 0, 0, 0, 0, 0, 0, 0, 0, 0, 0, 0, 0
    .long 0, 0, 0, 0, 0, 0, 0, 0, 0, 0, 0, 0, 0, 0, 0, 0
    .long 6, 16, 16, 8192, 7424, 269568, 8388608, 0, 32768, 4, 4313088, 131072, 0, 0, 218104432, 1
    .long 4, 16, 16, 8192, 7424, 269568, 8388608, 262144, 32768, 4, 5361664, 131072, 0, 0, 218104560, 1
    .long 4, 16, 16, 8192, 6656, 268800, 8388608, 786432, 32768, 4, 7446528, 131072, 0, 0, 218104672, 1
    .long 1, 24, 24, 8192, 6656, 6912, 8388608, 2097152, 32768, 8, 29466624, 131072, 0, 0, 218105440, 4
    .long 2, 64, 72, 7168, 6912, 6912, 7340032, 524288, 32768, 8, 56471552, 114688, 0, 0, 218103920, 1
    .long 2, 64, 72, 7168, 5888, 5888, 7340032, 2097152, 32768, 8, 61960192, 114688, 0, 0, 218104112, 1
    .long 2, 64, 72, 7168, 4864, 4864, 7340032, 3670016, 32768, 8, 67448832, 114688, 0, 0, 218104288, 1
    .long 1, 80, 80, 2048, 5505536, 5505792, 7340032, 67457024, 114688, 7, 184033280, 32768, 218104304, 7, 218106816, 1
    .long 0, 0, 0, 0, 0, 0, 0, 0, 0, 0, 0, 0, 0, 0, 0, 0
    .long 0, 0, 0, 0, 0, 0, 0, 0, 0, 0, 0, 0, 0, 0, 0, 0
    .long 6, 16, 16, 8192, 1536, 263680, 8388608, 0, 32768, 4, 4218880, 131072, 0, 0, 218104336, 1
    .long 4, 16, 16, 8192, 1536, 263680, 8388608, 262144, 32768, 4, 5267456, 131072, 0, 0, 218104464, 1
    .long 4, 16, 16, 8192, 256, 262400, 8388608, 786432, 32768, 4, 7344128, 131072, 0, 0, 218104576, 1
    .long 1, 24, 24, 8192, 1024, 1280, 8388608, 2097152, 32768, 8, 29376512, 131072, 0, 0, 218105360, 4
    .long 2, 64, 72, 7168, 0, 0, 7340032, 1048576, 32768, 8, 58195968, 114688, 0, 0, 218103936, 1
    .long 2, 64, 72, 7168, 6144, 6144, 7340032, 2097152, 32768, 8, 61964288, 114688, 0, 0, 218104112, 1
    .long 2, 64, 72, 7168, 5120, 5120, 7340032, 3670016, 32768, 8, 67452928, 114688, 0, 0, 218104288, 1
    .long 1, 80, 80, 2048, 1024, 1280, 7340032, 67371008, 114688, 7, 171458560, 32768, 218104256, 7, 218106816, 1
    .long 0, 0, 0, 0, 0, 0, 0, 0, 0, 0, 0, 0, 0, 0, 0, 0
    .long 0, 0, 0, 0, 0, 0, 0, 0, 0, 0, 0, 0, 0, 0, 0, 0
    .long 6, 16, 16, 8192, 3584, 265728, 8388608, 0, 32768, 4, 4251648, 131072, 0, 0, 218104368, 1
    .long 4, 16, 16, 8192, 3584, 265728, 8388608, 262144, 32768, 4, 5300224, 131072, 0, 0, 218104496, 1
    .long 4, 16, 16, 8192, 2304, 264448, 8388608, 786432, 32768, 4, 7376896, 131072, 0, 0, 218104608, 1
    .long 1, 24, 24, 8192, 3072, 3328, 8388608, 2097152, 32768, 8, 29409280, 131072, 0, 0, 218105392, 4
    .long 2, 64, 72, 7168, 256, 256, 7340032, 1048576, 32768, 8, 58200064, 114688, 0, 0, 218103936, 1
    .long 2, 64, 72, 7168, 6400, 6400, 7340032, 2097152, 32768, 8, 61968384, 114688, 0, 0, 218104112, 1
    .long 2, 64, 72, 7168, 5376, 5376, 7340032, 3670016, 32768, 8, 67457024, 114688, 0, 0, 218104304, 1
    .long 1, 80, 80, 2048, 1836032, 1836288, 7340032, 67399680, 114688, 7, 175652864, 32768, 218104272, 7, 218106816, 1
    .long 0, 0, 0, 0, 0, 0, 0, 0, 0, 0, 0, 0, 0, 0, 0, 0
    .long 0, 0, 0, 0, 0, 0, 0, 0, 0, 0, 0, 0, 0, 0, 0, 0
    .long 6, 16, 16, 8192, 5632, 267776, 8388608, 0, 32768, 4, 4284416, 131072, 0, 0, 218104400, 1
    .long 4, 16, 16, 8192, 5632, 267776, 8388608, 262144, 32768, 4, 5332992, 131072, 0, 0, 218104528, 1
    .long 4, 16, 16, 8192, 4352, 266496, 8388608, 786432, 32768, 4, 7409664, 131072, 0, 0, 218104640, 1
    .long 1, 24, 24, 8192, 5120, 5376, 8388608, 2097152, 32768, 8, 29442048, 131072, 0, 0, 218105424, 4
    .long 2, 64, 72, 7168, 512, 512, 7340032, 1048576, 32768, 8, 58204160, 114688, 0, 0, 218103936, 1
    .long 2, 64, 72, 7168, 6656, 6656, 7340032, 2097152, 32768, 8, 61972480, 114688, 0, 0, 218104112, 1
    .long 2, 64, 72, 7168, 5632, 5632, 7340032, 3670016, 32768, 8, 67461120, 114688, 0, 0, 218104304, 1
    .long 1, 80, 80, 2048, 3671040, 3671296, 7340032, 67428352, 114688, 7, 179847168, 32768, 218104288, 7, 218106816, 1
    .long 0, 0, 0, 0, 0, 0, 0, 0, 0, 0, 0, 0, 0, 0, 0, 0
    .long 0, 0, 0, 0, 0, 0, 0, 0, 0, 0, 0, 0, 0, 0, 0, 0
    .long 6, 16, 16, 8192, 7680, 269824, 8388608, 0, 32768, 4, 4317184, 131072, 0, 0, 218104432, 1
    .long 4, 16, 16, 8192, 7680, 269824, 8388608, 262144, 32768, 4, 5365760, 131072, 0, 0, 218104560, 1
    .long 4, 16, 16, 8192, 6400, 268544, 8388608, 786432, 32768, 4, 7442432, 131072, 0, 0, 218104672, 1
    .long 1, 24, 24, 8192, 7168, 7424, 8388608, 2097152, 32768, 8, 29474816, 131072, 0, 0, 218105456, 4
    .long 2, 64, 72, 7168, 768, 768, 7340032, 1048576, 32768, 8, 58208256, 114688, 0, 0, 218103936, 1
    .long 2, 64, 72, 7168, 6912, 6912, 7340032, 2097152, 32768, 8, 61976576, 114688, 0, 0, 218104112, 1
    .long 2, 64, 72, 7168, 5888, 5888, 7340032, 3670016, 32768, 8, 67465216, 114688, 0, 0, 218104304, 1
    .long 1, 80, 80, 2048, 5506048, 5506304, 7340032, 67457024, 114688, 7, 184041472, 32768, 218104304, 7, 218106816, 1
    .long 0, 0, 0, 0, 0, 0, 0, 0, 0, 0, 0, 0, 0, 0, 0, 0
    .long 0, 0, 0, 0, 0, 0, 0, 0, 0, 0, 0, 0, 0, 0, 0, 0
    .long 6, 16, 16, 8192, 1792, 263936, 8388608, 0, 32768, 4, 4222976, 131072, 0, 0, 218104336, 1
    .long 4, 16, 16, 8192, 1792, 263936, 8388608, 262144, 32768, 4, 5271552, 131072, 0, 0, 218104464, 1
    .long 4, 16, 16, 8192, 0, 262144, 8388608, 786432, 32768, 4, 7340032, 131072, 0, 0, 218104576, 1
    .long 1, 24, 24, 8192, 1536, 1792, 8388608, 2097152, 32768, 8, 29384704, 131072, 0, 0, 218105360, 4
    .long 2, 64, 72, 7168, 1024, 1024, 7340032, 1048576, 32768, 8, 58212352, 114688, 0, 0, 218103936, 1
    .long 2, 64, 72, 7168, 0, 0, 7340032, 2621440, 32768, 8, 63700992, 114688, 0, 0, 218104128, 1
    .long 2, 64, 72, 7168, 6144, 6144, 7340032, 3670016, 32768, 8, 67469312, 114688, 0, 0, 218104304, 1
    .long 1, 80, 80, 2048, 1536, 1792, 7340032, 67371008, 114688, 7, 171466752, 32768, 218104256, 7, 218106816, 1
    .long 0, 0, 0, 0, 0, 0, 0, 0, 0, 0, 0, 0, 0, 0, 0, 0
    .long 0, 0, 0, 0, 0, 0, 0, 0, 0, 0, 0, 0, 0, 0, 0, 0
    .long 6, 16, 16, 8192, 3840, 265984, 8388608, 0, 32768, 4, 4255744, 131072, 0, 0, 218104368, 1
    .long 4, 16, 16, 8192, 3840, 265984, 8388608, 262144, 32768, 4, 5304320, 131072, 0, 0, 218104496, 1
    .long 4, 16, 16, 8192, 2048, 264192, 8388608, 786432, 32768, 4, 7372800, 131072, 0, 0, 218104608, 1
    .long 1, 24, 24, 8192, 3584, 3840, 8388608, 2097152, 32768, 8, 29417472, 131072, 0, 0, 218105392, 4
    .long 2, 64, 72, 7168, 1280, 1280, 7340032, 1048576, 32768, 8, 58216448, 114688, 0, 0, 218103936, 1
    .long 2, 64, 72, 7168, 256, 256, 7340032, 2621440, 32768, 8, 63705088, 114688, 0, 0, 218104128, 1
    .long 2, 64, 72, 7168, 6400, 6400, 7340032, 3670016, 32768, 8, 67473408, 114688, 0, 0, 218104304, 1
    .long 1, 80, 80, 2048, 1836544, 1836800, 7340032, 67399680, 114688, 7, 175661056, 32768, 218104272, 7, 218106816, 1
    .long 0, 0, 0, 0, 0, 0, 0, 0, 0, 0, 0, 0, 0, 0, 0, 0
    .long 0, 0, 0, 0, 0, 0, 0, 0, 0, 0, 0, 0, 0, 0, 0, 0
    .long 6, 16, 16, 8192, 5888, 268032, 8388608, 0, 32768, 4, 4288512, 131072, 0, 0, 218104400, 1
    .long 4, 16, 16, 8192, 5888, 268032, 8388608, 262144, 32768, 4, 5337088, 131072, 0, 0, 218104528, 1
    .long 4, 16, 16, 8192, 4096, 266240, 8388608, 786432, 32768, 4, 7405568, 131072, 0, 0, 218104640, 1
    .long 1, 24, 24, 8192, 5632, 5888, 8388608, 2097152, 32768, 8, 29450240, 131072, 0, 0, 218105424, 4
    .long 2, 64, 72, 7168, 1536, 1536, 7340032, 1048576, 32768, 8, 58220544, 114688, 0, 0, 218103936, 1
    .long 2, 64, 72, 7168, 512, 512, 7340032, 2621440, 32768, 8, 63709184, 114688, 0, 0, 218104128, 1
    .long 2, 64, 72, 7168, 6656, 6656, 7340032, 3670016, 32768, 8, 67477504, 114688, 0, 0, 218104304, 1
    .long 1, 80, 80, 2048, 3671552, 3671808, 7340032, 67428352, 114688, 7, 179855360, 32768, 218104288, 7, 218106816, 1
    .long 0, 0, 0, 0, 0, 0, 0, 0, 0, 0, 0, 0, 0, 0, 0, 0
    .long 0, 0, 0, 0, 0, 0, 0, 0, 0, 0, 0, 0, 0, 0, 0, 0
    .long 6, 16, 16, 8192, 7936, 270080, 8388608, 0, 32768, 4, 4321280, 131072, 0, 0, 218104432, 1
    .long 4, 16, 16, 8192, 7936, 270080, 8388608, 262144, 32768, 4, 5369856, 131072, 0, 0, 218104560, 1
    .long 4, 16, 16, 8192, 6144, 268288, 8388608, 786432, 32768, 4, 7438336, 131072, 0, 0, 218104672, 1
    .long 1, 24, 24, 8192, 7680, 7936, 8388608, 2097152, 32768, 8, 29483008, 131072, 0, 0, 218105456, 4
    .long 2, 64, 72, 7168, 1792, 1792, 7340032, 1048576, 32768, 8, 58224640, 114688, 0, 0, 218103952, 1
    .long 2, 64, 72, 7168, 768, 768, 7340032, 2621440, 32768, 8, 63713280, 114688, 0, 0, 218104128, 1
    .long 2, 64, 72, 7168, 6912, 6912, 7340032, 3670016, 32768, 8, 67481600, 114688, 0, 0, 218104304, 1
    .long 1, 80, 80, 2048, 5506560, 5506816, 7340032, 67457024, 114688, 7, 184049664, 32768, 218104304, 7, 218106816, 1
    .long 0, 0, 0, 0, 0, 0, 0, 0, 0, 0, 0, 0, 0, 0, 0, 0
    .long 0, 0, 0, 0, 0, 0, 0, 0, 0, 0, 0, 0, 0, 0, 0, 0
    .long 1, 32, 32, 8192, 0, 256, 8388608, 524288, 32768, 8, 39845888, 131072, 0, 0, 218104576, 4
    .long 1, 16, 16, 8192, 0, 256, 8388608, 1048576, 32768, 8, 8388608, 131072, 0, 0, 218104832, 4
    .long 1, 24, 24, 8192, 0, 256, 8388608, 2621440, 32768, 8, 31457280, 131072, 0, 0, 218105600, 4
    .long 1, 16, 16, 8192, 0, 256, 8388608, 3145728, 32768, 8, 16777216, 131072, 0, 0, 218105856, 4
    .long 1, 16, 16, 8192, 0, 256, 8388608, 3670016, 32768, 8, 18874368, 131072, 0, 0, 218106112, 4
    .long 1, 80, 80, 2048, 0, 256, 7340032, 58195968, 114688, 7, 168820736, 32768, 218103936, 7, 218106496, 1
    .long 0, 0, 0, 0, 0, 0, 0, 0, 0, 0, 0, 0, 0, 0, 0, 0
    .long 0, 0, 0, 0, 0, 0, 0, 0, 0, 0, 0, 0, 0, 0, 0, 0
    .long 0, 0, 0, 0, 0, 0, 0, 0, 0, 0, 0, 0, 0, 0, 0, 0
    .long 0, 0, 0, 0, 0, 0, 0, 0, 0, 0, 0, 0, 0, 0, 0, 0
    .long 1, 32, 32, 8192, 2048, 2304, 8388608, 524288, 32768, 8, 39878656, 131072, 0, 0, 218104608, 4
    .long 1, 16, 16, 8192, 2048, 2304, 8388608, 1048576, 32768, 8, 8421376, 131072, 0, 0, 218104864, 4
    .long 1, 24, 24, 8192, 2048, 2304, 8388608, 2621440, 32768, 8, 31490048, 131072, 0, 0, 218105632, 4
    .long 1, 16, 16, 8192, 2048, 2304, 8388608, 3145728, 32768, 8, 16809984, 131072, 0, 0, 218105888, 4
    .long 1, 16, 16, 8192, 2048, 2304, 8388608, 3670016, 32768, 8, 18907136, 131072, 0, 0, 218106144, 4
    .long 1, 80, 80, 2048, 1835008, 1835264, 7340032, 58224640, 114688, 7, 173015040, 32768, 218103952, 7, 218106496, 1
    .long 0, 0, 0, 0, 0, 0, 0, 0, 0, 0, 0, 0, 0, 0, 0, 0
    .long 0, 0, 0, 0, 0, 0, 0, 0, 0, 0, 0, 0, 0, 0, 0, 0
    .long 0, 0, 0, 0, 0, 0, 0, 0, 0, 0, 0, 0, 0, 0, 0, 0
    .long 0, 0, 0, 0, 0, 0, 0, 0, 0, 0, 0, 0, 0, 0, 0, 0
    .long 1, 32, 32, 8192, 4096, 4352, 8388608, 524288, 32768, 8, 39911424, 131072, 0, 0, 218104640, 4
    .long 1, 16, 16, 8192, 4096, 4352, 8388608, 1048576, 32768, 8, 8454144, 131072, 0, 0, 218104896, 4
    .long 1, 24, 24, 8192, 4096, 4352, 8388608, 2621440, 32768, 8, 31522816, 131072, 0, 0, 218105664, 4
    .long 1, 16, 16, 8192, 4096, 4352, 8388608, 3145728, 32768, 8, 16842752, 131072, 0, 0, 218105920, 4
    .long 1, 16, 16, 8192, 4096, 4352, 8388608, 3670016, 32768, 8, 18939904, 131072, 0, 0, 218106176, 4
    .long 1, 80, 80, 2048, 3670016, 3670272, 7340032, 58253312, 114688, 7, 177209344, 32768, 218103968, 7, 218106496, 1
    .long 0, 0, 0, 0, 0, 0, 0, 0, 0, 0, 0, 0, 0, 0, 0, 0
    .long 0, 0, 0, 0, 0, 0, 0, 0, 0, 0, 0, 0, 0, 0, 0, 0
    .long 0, 0, 0, 0, 0, 0, 0, 0, 0, 0, 0, 0, 0, 0, 0, 0
    .long 0, 0, 0, 0, 0, 0, 0, 0, 0, 0, 0, 0, 0, 0, 0, 0
    .long 1, 32, 32, 8192, 6144, 6400, 8388608, 524288, 32768, 8, 39944192, 131072, 0, 0, 218104672, 4
    .long 1, 16, 16, 8192, 6144, 6400, 8388608, 1048576, 32768, 8, 8486912, 131072, 0, 0, 218104928, 4
    .long 1, 24, 24, 8192, 6144, 6400, 8388608, 2621440, 32768, 8, 31555584, 131072, 0, 0, 218105696, 4
    .long 1, 16, 16, 8192, 6144, 6400, 8388608, 3145728, 32768, 8, 16875520, 131072, 0, 0, 218105952, 4
    .long 1, 16, 16, 8192, 6144, 6400, 8388608, 3670016, 32768, 8, 18972672, 131072, 0, 0, 218106208, 4
    .long 1, 80, 80, 2048, 5505024, 5505280, 7340032, 58281984, 114688, 7, 181403648, 32768, 218103984, 7, 218106496, 1
    .long 0, 0, 0, 0, 0, 0, 0, 0, 0, 0, 0, 0, 0, 0, 0, 0
    .long 0, 0, 0, 0, 0, 0, 0, 0, 0, 0, 0, 0, 0, 0, 0, 0
    .long 0, 0, 0, 0, 0, 0, 0, 0, 0, 0, 0, 0, 0, 0, 0, 0
    .long 0, 0, 0, 0, 0, 0, 0, 0, 0, 0, 0, 0, 0, 0, 0, 0
    .long 1, 32, 32, 8192, 512, 768, 8388608, 524288, 32768, 8, 39854080, 131072, 0, 0, 218104576, 4
    .long 1, 16, 16, 8192, 512, 768, 8388608, 1048576, 32768, 8, 8396800, 131072, 0, 0, 218104832, 4
    .long 1, 24, 24, 8192, 512, 768, 8388608, 2621440, 32768, 8, 31465472, 131072, 0, 0, 218105600, 4
    .long 1, 16, 16, 8192, 512, 768, 8388608, 3145728, 32768, 8, 16785408, 131072, 0, 0, 218105856, 4
    .long 1, 16, 16, 8192, 512, 768, 8388608, 3670016, 32768, 8, 18882560, 131072, 0, 0, 218106112, 4
    .long 1, 80, 80, 2048, 512, 768, 7340032, 58195968, 114688, 7, 168828928, 32768, 218103936, 7, 218106496, 1
    .long 0, 0, 0, 0, 0, 0, 0, 0, 0, 0, 0, 0, 0, 0, 0, 0
    .long 0, 0, 0, 0, 0, 0, 0, 0, 0, 0, 0, 0, 0, 0, 0, 0
    .long 0, 0, 0, 0, 0, 0, 0, 0, 0, 0, 0, 0, 0, 0, 0, 0
    .long 0, 0, 0, 0, 0, 0, 0, 0, 0, 0, 0, 0, 0, 0, 0, 0
    .long 1, 32, 32, 8192, 2560, 2816, 8388608, 524288, 32768, 8, 39886848, 131072, 0, 0, 218104608, 4
    .long 1, 16, 16, 8192, 2560, 2816, 8388608, 1048576, 32768, 8, 8429568, 131072, 0, 0, 218104864, 4
    .long 1, 24, 24, 8192, 2560, 2816, 8388608, 2621440, 32768, 8, 31498240, 131072, 0, 0, 218105632, 4
    .long 1, 16, 16, 8192, 2560, 2816, 8388608, 3145728, 32768, 8, 16818176, 131072, 0, 0, 218105888, 4
    .long 1, 16, 16, 8192, 2560, 2816, 8388608, 3670016, 32768, 8, 18915328, 131072, 0, 0, 218106144, 4
    .long 1, 80, 80, 2048, 1835520, 1835776, 7340032, 58224640, 114688, 7, 173023232, 32768, 218103952, 7, 218106496, 1
    .long 0, 0, 0, 0, 0, 0, 0, 0, 0, 0, 0, 0, 0, 0, 0, 0
    .long 0, 0, 0, 0, 0, 0, 0, 0, 0, 0, 0, 0, 0, 0, 0, 0
    .long 0, 0, 0, 0, 0, 0, 0, 0, 0, 0, 0, 0, 0, 0, 0, 0
    .long 0, 0, 0, 0, 0, 0, 0, 0, 0, 0, 0, 0, 0, 0, 0, 0
    .long 1, 32, 32, 8192, 4608, 4864, 8388608, 524288, 32768, 8, 39919616, 131072, 0, 0, 218104640, 4
    .long 1, 16, 16, 8192, 4608, 4864, 8388608, 1048576, 32768, 8, 8462336, 131072, 0, 0, 218104896, 4
    .long 1, 24, 24, 8192, 4608, 4864, 8388608, 2621440, 32768, 8, 31531008, 131072, 0, 0, 218105664, 4
    .long 1, 16, 16, 8192, 4608, 4864, 8388608, 3145728, 32768, 8, 16850944, 131072, 0, 0, 218105920, 4
    .long 1, 16, 16, 8192, 4608, 4864, 8388608, 3670016, 32768, 8, 18948096, 131072, 0, 0, 218106176, 4
    .long 1, 80, 80, 2048, 3670528, 3670784, 7340032, 58253312, 114688, 7, 177217536, 32768, 218103968, 7, 218106496, 1
    .long 0, 0, 0, 0, 0, 0, 0, 0, 0, 0, 0, 0, 0, 0, 0, 0
    .long 0, 0, 0, 0, 0, 0, 0, 0, 0, 0, 0, 0, 0, 0, 0, 0
    .long 0, 0, 0, 0, 0, 0, 0, 0, 0, 0, 0, 0, 0, 0, 0, 0
    .long 0, 0, 0, 0, 0, 0, 0, 0, 0, 0, 0, 0, 0, 0, 0, 0
    .long 1, 32, 32, 8192, 6656, 6912, 8388608, 524288, 32768, 8, 39952384, 131072, 0, 0, 218104672, 4
    .long 1, 16, 16, 8192, 6656, 6912, 8388608, 1048576, 32768, 8, 8495104, 131072, 0, 0, 218104928, 4
    .long 1, 24, 24, 8192, 6656, 6912, 8388608, 2621440, 32768, 8, 31563776, 131072, 0, 0, 218105696, 4
    .long 1, 16, 16, 8192, 6656, 6912, 8388608, 3145728, 32768, 8, 16883712, 131072, 0, 0, 218105952, 4
    .long 1, 16, 16, 8192, 6656, 6912, 8388608, 3670016, 32768, 8, 18980864, 131072, 0, 0, 218106208, 4
    .long 1, 80, 80, 2048, 5505536, 5505792, 7340032, 58281984, 114688, 7, 181411840, 32768, 218103984, 7, 218106496, 1
    .long 0, 0, 0, 0, 0, 0, 0, 0, 0, 0, 0, 0, 0, 0, 0, 0
    .long 0, 0, 0, 0, 0, 0, 0, 0, 0, 0, 0, 0, 0, 0, 0, 0
    .long 0, 0, 0, 0, 0, 0, 0, 0, 0, 0, 0, 0, 0, 0, 0, 0
    .long 0, 0, 0, 0, 0, 0, 0, 0, 0, 0, 0, 0, 0, 0, 0, 0
    .long 1, 32, 32, 8192, 1024, 1280, 8388608, 524288, 32768, 8, 39862272, 131072, 0, 0, 218104592, 4
    .long 1, 16, 16, 8192, 1024, 1280, 8388608, 1048576, 32768, 8, 8404992, 131072, 0, 0, 218104848, 4
    .long 1, 24, 24, 8192, 1024, 1280, 8388608, 2621440, 32768, 8, 31473664, 131072, 0, 0, 218105616, 4
    .long 1, 16, 16, 8192, 1024, 1280, 8388608, 3145728, 32768, 8, 16793600, 131072, 0, 0, 218105872, 4
    .long 1, 16, 16, 8192, 1024, 1280, 8388608, 3670016, 32768, 8, 18890752, 131072, 0, 0, 218106128, 4
    .long 1, 80, 80, 2048, 1024, 1280, 7340032, 58195968, 114688, 7, 168837120, 32768, 218103936, 7, 218106496, 1
    .long 0, 0, 0, 0, 0, 0, 0, 0, 0, 0, 0, 0, 0, 0, 0, 0
    .long 0, 0, 0, 0, 0, 0, 0, 0, 0, 0, 0, 0, 0, 0, 0, 0
    .long 0, 0, 0, 0, 0, 0, 0, 0, 0, 0, 0, 0, 0, 0, 0, 0
    .long 0, 0, 0, 0, 0, 0, 0, 0, 0, 0, 0, 0, 0, 0, 0, 0
    .long 1, 32, 32, 8192, 3072, 3328, 8388608, 524288, 32768, 8, 39895040, 131072, 0, 0, 218104624, 4
    .long 1, 16, 16, 8192, 3072, 3328, 8388608, 1048576, 32768, 8, 8437760, 131072, 0, 0, 218104880, 4
    .long 1, 24, 24, 8192, 3072, 3328, 8388608, 2621440, 32768, 8, 31506432, 131072, 0, 0, 218105648, 4
    .long 1, 16, 16, 8192, 3072, 3328, 8388608, 3145728, 32768, 8, 16826368, 131072, 0, 0, 218105904, 4
    .long 1, 16, 16, 8192, 3072, 3328, 8388608, 3670016, 32768, 8, 18923520, 131072, 0, 0, 218106160, 4
    .long 1, 80, 80, 2048, 1836032, 1836288, 7340032, 58224640, 114688, 7, 173031424, 32768, 218103952, 7, 218106496, 1
    .long 0, 0, 0, 0, 0, 0, 0, 0, 0, 0, 0, 0, 0, 0, 0, 0
    .long 0, 0, 0, 0, 0, 0, 0, 0, 0, 0, 0, 0, 0, 0, 0, 0
    .long 0, 0, 0, 0, 0, 0, 0, 0, 0, 0, 0, 0, 0, 0, 0, 0
    .long 0, 0, 0, 0, 0, 0, 0, 0, 0, 0, 0, 0, 0, 0, 0, 0
    .long 1, 32, 32, 8192, 5120, 5376, 8388608, 524288, 32768, 8, 39927808, 131072, 0, 0, 218104656, 4
    .long 1, 16, 16, 8192, 5120, 5376, 8388608, 1048576, 32768, 8, 8470528, 131072, 0, 0, 218104912, 4
    .long 1, 24, 24, 8192, 5120, 5376, 8388608, 2621440, 32768, 8, 31539200, 131072, 0, 0, 218105680, 4
    .long 1, 16, 16, 8192, 5120, 5376, 8388608, 3145728, 32768, 8, 16859136, 131072, 0, 0, 218105936, 4
    .long 1, 16, 16, 8192, 5120, 5376, 8388608, 3670016, 32768, 8, 18956288, 131072, 0, 0, 218106192, 4
    .long 1, 80, 80, 2048, 3671040, 3671296, 7340032, 58253312, 114688, 7, 177225728, 32768, 218103968, 7, 218106496, 1
    .long 0, 0, 0, 0, 0, 0, 0, 0, 0, 0, 0, 0, 0, 0, 0, 0
    .long 0, 0, 0, 0, 0, 0, 0, 0, 0, 0, 0, 0, 0, 0, 0, 0
    .long 0, 0, 0, 0, 0, 0, 0, 0, 0, 0, 0, 0, 0, 0, 0, 0
    .long 0, 0, 0, 0, 0, 0, 0, 0, 0, 0, 0, 0, 0, 0, 0, 0
    .long 1, 32, 32, 8192, 7168, 7424, 8388608, 524288, 32768, 8, 39960576, 131072, 0, 0, 218104688, 4
    .long 1, 16, 16, 8192, 7168, 7424, 8388608, 1048576, 32768, 8, 8503296, 131072, 0, 0, 218104944, 4
    .long 1, 24, 24, 8192, 7168, 7424, 8388608, 2621440, 32768, 8, 31571968, 131072, 0, 0, 218105712, 4
    .long 1, 16, 16, 8192, 7168, 7424, 8388608, 3145728, 32768, 8, 16891904, 131072, 0, 0, 218105968, 4
    .long 1, 16, 16, 8192, 7168, 7424, 8388608, 3670016, 32768, 8, 18989056, 131072, 0, 0, 218106224, 4
    .long 1, 80, 80, 2048, 5506048, 5506304, 7340032, 58281984, 114688, 7, 181420032, 32768, 218103984, 7, 218106496, 1
    .long 0, 0, 0, 0, 0, 0, 0, 0, 0, 0, 0, 0, 0, 0, 0, 0
    .long 0, 0, 0, 0, 0, 0, 0, 0, 0, 0, 0, 0, 0, 0, 0, 0
    .long 0, 0, 0, 0, 0, 0, 0, 0, 0, 0, 0, 0, 0, 0, 0, 0
    .long 0, 0, 0, 0, 0, 0, 0, 0, 0, 0, 0, 0, 0, 0, 0, 0
    .long 1, 32, 32, 8192, 1536, 1792, 8388608, 524288, 32768, 8, 39870464, 131072, 0, 0, 218104592, 4
    .long 1, 16, 16, 8192, 1536, 1792, 8388608, 1048576, 32768, 8, 8413184, 131072, 0, 0, 218104848, 4
    .long 1, 24, 24, 8192, 1536, 1792, 8388608, 2621440, 32768, 8, 31481856, 131072, 0, 0, 218105616, 4
    .long 1, 16, 16, 8192, 1536, 1792, 8388608, 3145728, 32768, 8, 16801792, 131072, 0, 0, 218105872, 4
    .long 1, 16, 16, 8192, 1536, 1792, 8388608, 3670016, 32768, 8, 18898944, 131072, 0, 0, 218106128, 4
    .long 1, 80, 80, 2048, 1536, 1792, 7340032, 58195968, 114688, 7, 168845312, 32768, 218103936, 7, 218106496, 1
    .long 0, 0, 0, 0, 0, 0, 0, 0, 0, 0, 0, 0, 0, 0, 0, 0
    .long 0, 0, 0, 0, 0, 0, 0, 0, 0, 0, 0, 0, 0, 0, 0, 0
    .long 0, 0, 0, 0, 0, 0, 0, 0, 0, 0, 0, 0, 0, 0, 0, 0
    .long 0, 0, 0, 0, 0, 0, 0, 0, 0, 0, 0, 0, 0, 0, 0, 0
    .long 1, 32, 32, 8192, 3584, 3840, 8388608, 524288, 32768, 8, 39903232, 131072, 0, 0, 218104624, 4
    .long 1, 16, 16, 8192, 3584, 3840, 8388608, 1048576, 32768, 8, 8445952, 131072, 0, 0, 218104880, 4
    .long 1, 24, 24, 8192, 3584, 3840, 8388608, 2621440, 32768, 8, 31514624, 131072, 0, 0, 218105648, 4
    .long 1, 16, 16, 8192, 3584, 3840, 8388608, 3145728, 32768, 8, 16834560, 131072, 0, 0, 218105904, 4
    .long 1, 16, 16, 8192, 3584, 3840, 8388608, 3670016, 32768, 8, 18931712, 131072, 0, 0, 218106160, 4
    .long 1, 80, 80, 2048, 1836544, 1836800, 7340032, 58224640, 114688, 7, 173039616, 32768, 218103952, 7, 218106496, 1
    .long 0, 0, 0, 0, 0, 0, 0, 0, 0, 0, 0, 0, 0, 0, 0, 0
    .long 0, 0, 0, 0, 0, 0, 0, 0, 0, 0, 0, 0, 0, 0, 0, 0
    .long 0, 0, 0, 0, 0, 0, 0, 0, 0, 0, 0, 0, 0, 0, 0, 0
    .long 0, 0, 0, 0, 0, 0, 0, 0, 0, 0, 0, 0, 0, 0, 0, 0
    .long 1, 32, 32, 8192, 5632, 5888, 8388608, 524288, 32768, 8, 39936000, 131072, 0, 0, 218104656, 4
    .long 1, 16, 16, 8192, 5632, 5888, 8388608, 1048576, 32768, 8, 8478720, 131072, 0, 0, 218104912, 4
    .long 1, 24, 24, 8192, 5632, 5888, 8388608, 2621440, 32768, 8, 31547392, 131072, 0, 0, 218105680, 4
    .long 1, 16, 16, 8192, 5632, 5888, 8388608, 3145728, 32768, 8, 16867328, 131072, 0, 0, 218105936, 4
    .long 1, 16, 16, 8192, 5632, 5888, 8388608, 3670016, 32768, 8, 18964480, 131072, 0, 0, 218106192, 4
    .long 1, 80, 80, 2048, 3671552, 3671808, 7340032, 58253312, 114688, 7, 177233920, 32768, 218103968, 7, 218106496, 1
    .long 0, 0, 0, 0, 0, 0, 0, 0, 0, 0, 0, 0, 0, 0, 0, 0
    .long 0, 0, 0, 0, 0, 0, 0, 0, 0, 0, 0, 0, 0, 0, 0, 0
    .long 0, 0, 0, 0, 0, 0, 0, 0, 0, 0, 0, 0, 0, 0, 0, 0
    .long 0, 0, 0, 0, 0, 0, 0, 0, 0, 0, 0, 0, 0, 0, 0, 0
    .long 1, 32, 32, 8192, 7680, 7936, 8388608, 524288, 32768, 8, 39968768, 131072, 0, 0, 218104688, 4
    .long 1, 16, 16, 8192, 7680, 7936, 8388608, 1048576, 32768, 8, 8511488, 131072, 0, 0, 218104944, 4
    .long 1, 24, 24, 8192, 7680, 7936, 8388608, 2621440, 32768, 8, 31580160, 131072, 0, 0, 218105712, 4
    .long 1, 16, 16, 8192, 7680, 7936, 8388608, 3145728, 32768, 8, 16900096, 131072, 0, 0, 218105968, 4
    .long 1, 16, 16, 8192, 7680, 7936, 8388608, 3670016, 32768, 8, 18997248, 131072, 0, 0, 218106224, 4
    .long 1, 80, 80, 2048, 5506560, 5506816, 7340032, 58281984, 114688, 7, 181428224, 32768, 218103984, 7, 218106496, 1
    .long 0, 0, 0, 0, 0, 0, 0, 0, 0, 0, 0, 0, 0, 0, 0, 0
    .long 0, 0, 0, 0, 0, 0, 0, 0, 0, 0, 0, 0, 0, 0, 0, 0
    .long 0, 0, 0, 0, 0, 0, 0, 0, 0, 0, 0, 0, 0, 0, 0, 0
    .long 0, 0, 0, 0, 0, 0, 0, 0, 0, 0, 0, 0, 0, 0, 0, 0
    .long 1, 24, 24, 8192, 0, 256, 8388608, 524288, 32768, 8, 23068672, 131072, 0, 0, 218104576, 4
    .long 1, 32, 32, 8192, 0, 256, 8388608, 1572864, 32768, 8, 44040192, 131072, 0, 0, 218105088, 4
    .long 1, 16, 16, 8192, 0, 256, 8388608, 2621440, 32768, 8, 14680064, 131072, 0, 0, 218105600, 4
    .long 2, 64, 72, 7168, 2048, 2048, 7340032, 1048576, 32768, 8, 58228736, 114688, 0, 0, 218103952, 1
    .long 2, 64, 72, 7168, 1024, 1024, 7340032, 2621440, 32768, 8, 63717376, 114688, 0, 0, 218104128, 1
    .long 1, 80, 80, 2048, 0, 256, 7340032, 60030976, 114688, 7, 169345024, 32768, 218104000, 7, 218106560, 1
    .long 0, 0, 0, 0, 0, 0, 0, 0, 0, 0, 0, 0, 0, 0, 0, 0
    .long 0, 0, 0, 0, 0, 0, 0, 0, 0, 0, 0, 0, 0, 0, 0, 0
    .long 0, 0, 0, 0, 0, 0, 0, 0, 0, 0, 0, 0, 0, 0, 0, 0
    .long 0, 0, 0, 0, 0, 0, 0, 0, 0, 0, 0, 0, 0, 0, 0, 0
    .long 1, 24, 24, 8192, 2048, 2304, 8388608, 524288, 32768, 8, 23101440, 131072, 0, 0, 218104608, 4
    .long 1, 32, 32, 8192, 2048, 2304, 8388608, 1572864, 32768, 8, 44072960, 131072, 0, 0, 218105120, 4
    .long 1, 16, 16, 8192, 2048, 2304, 8388608, 2621440, 32768, 8, 14712832, 131072, 0, 0, 218105632, 4
    .long 2, 64, 72, 7168, 2304, 2304, 7340032, 1048576, 32768, 8, 58232832, 114688, 0, 0, 218103952, 1
    .long 2, 64, 72, 7168, 1280, 1280, 7340032, 2621440, 32768, 8, 63721472, 114688, 0, 0, 218104128, 1
    .long 1, 80, 80, 2048, 1835008, 1835264, 7340032, 60059648, 114688, 7, 173539328, 32768, 218104016, 7, 218106560, 1
    .long 0, 0, 0, 0, 0, 0, 0, 0, 0, 0, 0, 0, 0, 0, 0, 0
    .long 0, 0, 0, 0, 0, 0, 0, 0, 0, 0, 0, 0, 0, 0, 0, 0
    .long 0, 0, 0, 0, 0, 0, 0, 0, 0, 0, 0, 0, 0, 0, 0, 0
    .long 0, 0, 0, 0, 0, 0, 0, 0, 0, 0, 0, 0, 0, 0, 0, 0
    .long 1, 24, 24, 8192, 4096, 4352, 8388608, 524288, 32768, 8, 23134208, 131072, 0, 0, 218104640, 4
    .long 1, 32, 32, 8192, 4096, 4352, 8388608, 1572864, 32768, 8, 44105728, 131072, 0, 0, 218105152, 4
    .long 1, 16, 16, 8192, 4096, 4352, 8388608, 2621440, 32768, 8, 14745600, 131072, 0, 0, 218105664, 4
    .long 2, 64, 72, 7168, 2560, 2560, 7340032, 1048576, 32768, 8, 58236928, 114688, 0, 0, 218103952, 1
    .long 2, 64, 72, 7168, 1536, 1536, 7340032, 2621440, 32768, 8, 63725568, 114688, 0, 0, 218104128, 1
    .long 1, 80, 80, 2048, 3670016, 3670272, 7340032, 60088320, 114688, 7, 177733632, 32768, 218104032, 7, 218106560, 1
    .long 0, 0, 0, 0, 0, 0, 0, 0, 0, 0, 0, 0, 0, 0, 0, 0
    .long 0, 0, 0, 0, 0, 0, 0, 0, 0, 0, 0, 0, 0, 0, 0, 0
    .long 0, 0, 0, 0, 0, 0, 0, 0, 0, 0, 0, 0, 0, 0, 0, 0
    .long 0, 0, 0, 0, 0, 0, 0, 0, 0, 0, 0, 0, 0, 0, 0, 0
    .long 1, 24, 24, 8192, 6144, 6400, 8388608, 524288, 32768, 8, 23166976, 131072, 0, 0, 218104672, 4
    .long 1, 32, 32, 8192, 6144, 6400, 8388608, 1572864, 32768, 8, 44138496, 131072, 0, 0, 218105184, 4
    .long 1, 16, 16, 8192, 6144, 6400, 8388608, 2621440, 32768, 8, 14778368, 131072, 0, 0, 218105696, 4
    .long 2, 64, 72, 7168, 2816, 2816, 7340032, 1048576, 32768, 8, 58241024, 114688, 0, 0, 218103952, 1
    .long 2, 64, 72, 7168, 1792, 1792, 7340032, 2621440, 32768, 8, 63729664, 114688, 0, 0, 218104144, 1
    .long 1, 80, 80, 2048, 5505024, 5505280, 7340032, 60116992, 114688, 7, 181927936, 32768, 218104048, 7, 218106560, 1
    .long 0, 0, 0, 0, 0, 0, 0, 0, 0, 0, 0, 0, 0, 0, 0, 0
    .long 0, 0, 0, 0, 0, 0, 0, 0, 0, 0, 0, 0, 0, 0, 0, 0
    .long 0, 0, 0, 0, 0, 0, 0, 0, 0, 0, 0, 0, 0, 0, 0, 0
    .long 0, 0, 0, 0, 0, 0, 0, 0, 0, 0, 0, 0, 0, 0, 0, 0
    .long 1, 24, 24, 8192, 512, 768, 8388608, 524288, 32768, 8, 23076864, 131072, 0, 0, 218104576, 4
    .long 1, 32, 32, 8192, 512, 768, 8388608, 1572864, 32768, 8, 44048384, 131072, 0, 0, 218105088, 4
    .long 1, 16, 16, 8192, 512, 768, 8388608, 2621440, 32768, 8, 14688256, 131072, 0, 0, 218105600, 4
    .long 2, 64, 72, 7168, 3072, 3072, 7340032, 1048576, 32768, 8, 58245120, 114688, 0, 0, 218103952, 1
    .long 2, 64, 72, 7168, 2048, 2048, 7340032, 2621440, 32768, 8, 63733760, 114688, 0, 0, 218104144, 1
    .long 1, 80, 80, 2048, 512, 768, 7340032, 60030976, 114688, 7, 169353216, 32768, 218104000, 7, 218106560, 1
    .long 0, 0, 0, 0, 0, 0, 0, 0, 0, 0, 0, 0, 0, 0, 0, 0
    .long 0, 0, 0, 0, 0, 0, 0, 0, 0, 0, 0, 0, 0, 0, 0, 0
    .long 0, 0, 0, 0, 0, 0, 0, 0, 0, 0, 0, 0, 0, 0, 0, 0
    .long 0, 0, 0, 0, 0, 0, 0, 0, 0, 0, 0, 0, 0, 0, 0, 0
    .long 1, 24, 24, 8192, 2560, 2816, 8388608, 524288, 32768, 8, 23109632, 131072, 0, 0, 218104608, 4
    .long 1, 32, 32, 8192, 2560, 2816, 8388608, 1572864, 32768, 8, 44081152, 131072, 0, 0, 218105120, 4
    .long 1, 16, 16, 8192, 2560, 2816, 8388608, 2621440, 32768, 8, 14721024, 131072, 0, 0, 218105632, 4
    .long 2, 64, 72, 7168, 3328, 3328, 7340032, 1048576, 32768, 8, 58249216, 114688, 0, 0, 218103952, 1
    .long 2, 64, 72, 7168, 2304, 2304, 7340032, 2621440, 32768, 8, 63737856, 114688, 0, 0, 218104144, 1
    .long 1, 80, 80, 2048, 1835520, 1835776, 7340032, 60059648, 114688, 7, 173547520, 32768, 218104016, 7, 218106560, 1
    .long 0, 0, 0, 0, 0, 0, 0, 0, 0, 0, 0, 0, 0, 0, 0, 0
    .long 0, 0, 0, 0, 0, 0, 0, 0, 0, 0, 0, 0, 0, 0, 0, 0
    .long 0, 0, 0, 0, 0, 0, 0, 0, 0, 0, 0, 0, 0, 0, 0, 0
    .long 0, 0, 0, 0, 0, 0, 0, 0, 0, 0, 0, 0, 0, 0, 0, 0
    .long 1, 24, 24, 8192, 4608, 4864, 8388608, 524288, 32768, 8, 23142400, 131072, 0, 0, 218104640, 4
    .long 1, 32, 32, 8192, 4608, 4864, 8388608, 1572864, 32768, 8, 44113920, 131072, 0, 0, 218105152, 4
    .long 1, 16, 16, 8192, 4608, 4864, 8388608, 2621440, 32768, 8, 14753792, 131072, 0, 0, 218105664, 4
    .long 2, 64, 72, 7168, 3584, 3584, 7340032, 1048576, 32768, 8, 58253312, 114688, 0, 0, 218103968, 1
    .long 2, 64, 72, 7168, 2560, 2560, 7340032, 2621440, 32768, 8, 63741952, 114688, 0, 0, 218104144, 1
    .long 1, 80, 80, 2048, 3670528, 3670784, 7340032, 60088320, 114688, 7, 177741824, 32768, 218104032, 7, 218106560, 1
    .long 0, 0, 0, 0, 0, 0, 0, 0, 0, 0, 0, 0, 0, 0, 0, 0
    .long 0, 0, 0, 0, 0, 0, 0, 0, 0, 0, 0, 0, 0, 0, 0, 0
    .long 0, 0, 0, 0, 0, 0, 0, 0, 0, 0, 0, 0, 0, 0, 0, 0
    .long 0, 0, 0, 0, 0, 0, 0, 0, 0, 0, 0, 0, 0, 0, 0, 0
    .long 1, 24, 24, 8192, 6656, 6912, 8388608, 524288, 32768, 8, 23175168, 131072, 0, 0, 218104672, 4
    .long 1, 32, 32, 8192, 6656, 6912, 8388608, 1572864, 32768, 8, 44146688, 131072, 0, 0, 218105184, 4
    .long 1, 16, 16, 8192, 6656, 6912, 8388608, 2621440, 32768, 8, 14786560, 131072, 0, 0, 218105696, 4
    .long 2, 64, 72, 7168, 3840, 3840, 7340032, 1048576, 32768, 8, 58257408, 114688, 0, 0, 218103968, 1
    .long 2, 64, 72, 7168, 2816, 2816, 7340032, 2621440, 32768, 8, 63746048, 114688, 0, 0, 218104144, 1
    .long 1, 80, 80, 2048, 5505536, 5505792, 7340032, 60116992, 114688, 7, 181936128, 32768, 218104048, 7, 218106560, 1
    .long 0, 0, 0, 0, 0, 0, 0, 0, 0, 0, 0, 0, 0, 0, 0, 0
    .long 0, 0, 0, 0, 0, 0, 0, 0, 0, 0, 0, 0, 0, 0, 0, 0
    .long 0, 0, 0, 0, 0, 0, 0, 0, 0, 0, 0, 0, 0, 0, 0, 0
    .long 0, 0, 0, 0, 0, 0, 0, 0, 0, 0, 0, 0, 0, 0, 0, 0
    .long 1, 24, 24, 8192, 1024, 1280, 8388608, 524288, 32768, 8, 23085056, 131072, 0, 0, 218104592, 4
    .long 1, 32, 32, 8192, 1024, 1280, 8388608, 1572864, 32768, 8, 44056576, 131072, 0, 0, 218105104, 4
    .long 1, 16, 16, 8192, 1024, 1280, 8388608, 2621440, 32768, 8, 14696448, 131072, 0, 0, 218105616, 4
    .long 2, 64, 72, 7168, 4096, 4096, 7340032, 1048576, 32768, 8, 58261504, 114688, 0, 0, 218103968, 1
    .long 2, 64, 72, 7168, 3072, 3072, 7340032, 2621440, 32768, 8, 63750144, 114688, 0, 0, 218104144, 1
    .long 1, 80, 80, 2048, 1024, 1280, 7340032, 60030976, 114688, 7, 169361408, 32768, 218104000, 7, 218106560, 1
    .long 0, 0, 0, 0, 0, 0, 0, 0, 0, 0, 0, 0, 0, 0, 0, 0
    .long 0, 0, 0, 0, 0, 0, 0, 0, 0, 0, 0, 0, 0, 0, 0, 0
    .long 0, 0, 0, 0, 0, 0, 0, 0, 0, 0, 0, 0, 0, 0, 0, 0
    .long 0, 0, 0, 0, 0, 0, 0, 0, 0, 0, 0, 0, 0, 0, 0, 0
    .long 1, 24, 24, 8192, 3072, 3328, 8388608, 524288, 32768, 8, 23117824, 131072, 0, 0, 218104624, 4
    .long 1, 32, 32, 8192, 3072, 3328, 8388608, 1572864, 32768, 8, 44089344, 131072, 0, 0, 218105136, 4
    .long 1, 16, 16, 8192, 3072, 3328, 8388608, 2621440, 32768, 8, 14729216, 131072, 0, 0, 218105648, 4
    .long 2, 64, 72, 7168, 4352, 4352, 7340032, 1048576, 32768, 8, 58265600, 114688, 0, 0, 218103968, 1
    .long 2, 64, 72, 7168, 3328, 3328, 7340032, 2621440, 32768, 8, 63754240, 114688, 0, 0, 218104144, 1
    .long 1, 80, 80, 2048, 1836032, 1836288, 7340032, 60059648, 114688, 7, 173555712, 32768, 218104016, 7, 218106560, 1
    .long 0, 0, 0, 0, 0, 0, 0, 0, 0, 0, 0, 0, 0, 0, 0, 0
    .long 0, 0, 0, 0, 0, 0, 0, 0, 0, 0, 0, 0, 0, 0, 0, 0
    .long 0, 0, 0, 0, 0, 0, 0, 0, 0, 0, 0, 0, 0, 0, 0, 0
    .long 0, 0, 0, 0, 0, 0, 0, 0, 0, 0, 0, 0, 0, 0, 0, 0
    .long 1, 24, 24, 8192, 5120, 5376, 8388608, 524288, 32768, 8, 23150592, 131072, 0, 0, 218104656, 4
    .long 1, 32, 32, 8192, 5120, 5376, 8388608, 1572864, 32768, 8, 44122112, 131072, 0, 0, 218105168, 4
    .long 1, 16, 16, 8192, 5120, 5376, 8388608, 2621440, 32768, 8, 14761984, 131072, 0, 0, 218105680, 4
    .long 2, 64, 72, 7168, 4608, 4608, 7340032, 1048576, 32768, 8, 58269696, 114688, 0, 0, 218103968, 1
    .long 2, 64, 72, 7168, 3584, 3584, 7340032, 2621440, 32768, 8, 63758336, 114688, 0, 0, 218104160, 1
    .long 1, 80, 80, 2048, 3671040, 3671296, 7340032, 60088320, 114688, 7, 177750016, 32768, 218104032, 7, 218106560, 1
    .long 0, 0, 0, 0, 0, 0, 0, 0, 0, 0, 0, 0, 0, 0, 0, 0
    .long 0, 0, 0, 0, 0, 0, 0, 0, 0, 0, 0, 0, 0, 0, 0, 0
    .long 0, 0, 0, 0, 0, 0, 0, 0, 0, 0, 0, 0, 0, 0, 0, 0
    .long 0, 0, 0, 0, 0, 0, 0, 0, 0, 0, 0, 0, 0, 0, 0, 0
    .long 1, 24, 24, 8192, 7168, 7424, 8388608, 524288, 32768, 8, 23183360, 131072, 0, 0, 218104688, 4
    .long 1, 32, 32, 8192, 7168, 7424, 8388608, 1572864, 32768, 8, 44154880, 131072, 0, 0, 218105200, 4
    .long 1, 16, 16, 8192, 7168, 7424, 8388608, 2621440, 32768, 8, 14794752, 131072, 0, 0, 218105712, 4
    .long 2, 64, 72, 7168, 4864, 4864, 7340032, 1048576, 32768, 8, 58273792, 114688, 0, 0, 218103968, 1
    .long 2, 64, 72, 7168, 3840, 3840, 7340032, 2621440, 32768, 8, 63762432, 114688, 0, 0, 218104160, 1
    .long 1, 80, 80, 2048, 5506048, 5506304, 7340032, 60116992, 114688, 7, 181944320, 32768, 218104048, 7, 218106560, 1
    .long 0, 0, 0, 0, 0, 0, 0, 0, 0, 0, 0, 0, 0, 0, 0, 0
    .long 0, 0, 0, 0, 0, 0, 0, 0, 0, 0, 0, 0, 0, 0, 0, 0
    .long 0, 0, 0, 0, 0, 0, 0, 0, 0, 0, 0, 0, 0, 0, 0, 0
    .long 0, 0, 0, 0, 0, 0, 0, 0, 0, 0, 0, 0, 0, 0, 0, 0
    .long 1, 24, 24, 8192, 1536, 1792, 8388608, 524288, 32768, 8, 23093248, 131072, 0, 0, 218104592, 4
    .long 1, 32, 32, 8192, 1536, 1792, 8388608, 1572864, 32768, 8, 44064768, 131072, 0, 0, 218105104, 4
    .long 1, 16, 16, 8192, 1536, 1792, 8388608, 2621440, 32768, 8, 14704640, 131072, 0, 0, 218105616, 4
    .long 2, 64, 72, 7168, 5120, 5120, 7340032, 1048576, 32768, 8, 58277888, 114688, 0, 0, 218103968, 1
    .long 2, 64, 72, 7168, 4096, 4096, 7340032, 2621440, 32768, 8, 63766528, 114688, 0, 0, 218104160, 1
    .long 1, 80, 80, 2048, 1536, 1792, 7340032, 60030976, 114688, 7, 169369600, 32768, 218104000, 7, 218106560, 1
    .long 0, 0, 0, 0, 0, 0, 0, 0, 0, 0, 0, 0, 0, 0, 0, 0
    .long 0, 0, 0, 0, 0, 0, 0, 0, 0, 0, 0, 0, 0, 0, 0, 0
    .long 0, 0, 0, 0, 0, 0, 0, 0, 0, 0, 0, 0, 0, 0, 0, 0
    .long 0, 0, 0, 0, 0, 0, 0, 0, 0, 0, 0, 0, 0, 0, 0, 0
    .long 1, 24, 24, 8192, 3584, 3840, 8388608, 524288, 32768, 8, 23126016, 131072, 0, 0, 218104624, 4
    .long 1, 32, 32, 8192, 3584, 3840, 8388608, 1572864, 32768, 8, 44097536, 131072, 0, 0, 218105136, 4
    .long 1, 16, 16, 8192, 3584, 3840, 8388608, 2621440, 32768, 8, 14737408, 131072, 0, 0, 218105648, 4
    .long 2, 64, 72, 7168, 5376, 5376, 7340032, 1048576, 32768, 8, 58281984, 114688, 0, 0, 218103984, 1
    .long 2, 64, 72, 7168, 4352, 4352, 7340032, 2621440, 32768, 8, 63770624, 114688, 0, 0, 218104160, 1
    .long 1, 80, 80, 2048, 1836544, 1836800, 7340032, 60059648, 114688, 7, 173563904, 32768, 218104016, 7, 218106560, 1
    .long 0, 0, 0, 0, 0, 0, 0, 0, 0, 0, 0, 0, 0, 0, 0, 0
    .long 0, 0, 0, 0, 0, 0, 0, 0, 0, 0, 0, 0, 0, 0, 0, 0
    .long 0, 0, 0, 0, 0, 0, 0, 0, 0, 0, 0, 0, 0, 0, 0, 0
    .long 0, 0, 0, 0, 0, 0, 0, 0, 0, 0, 0, 0, 0, 0, 0, 0
    .long 1, 24, 24, 8192, 5632, 5888, 8388608, 524288, 32768, 8, 23158784, 131072, 0, 0, 218104656, 4
    .long 1, 32, 32, 8192, 5632, 5888, 8388608, 1572864, 32768, 8, 44130304, 131072, 0, 0, 218105168, 4
    .long 1, 16, 16, 8192, 5632, 5888, 8388608, 2621440, 32768, 8, 14770176, 131072, 0, 0, 218105680, 4
    .long 2, 64, 72, 7168, 5632, 5632, 7340032, 1048576, 32768, 8, 58286080, 114688, 0, 0, 218103984, 1
    .long 2, 64, 72, 7168, 4608, 4608, 7340032, 2621440, 32768, 8, 63774720, 114688, 0, 0, 218104160, 1
    .long 1, 80, 80, 2048, 3671552, 3671808, 7340032, 60088320, 114688, 7, 177758208, 32768, 218104032, 7, 218106560, 1
    .long 0, 0, 0, 0, 0, 0, 0, 0, 0, 0, 0, 0, 0, 0, 0, 0
    .long 0, 0, 0, 0, 0, 0, 0, 0, 0, 0, 0, 0, 0, 0, 0, 0
    .long 0, 0, 0, 0, 0, 0, 0, 0, 0, 0, 0, 0, 0, 0, 0, 0
    .long 0, 0, 0, 0, 0, 0, 0, 0, 0, 0, 0, 0, 0, 0, 0, 0
    .long 1, 24, 24, 8192, 7680, 7936, 8388608, 524288, 32768, 8, 23191552, 131072, 0, 0, 218104688, 4
    .long 1, 32, 32, 8192, 7680, 7936, 8388608, 1572864, 32768, 8, 44163072, 131072, 0, 0, 218105200, 4
    .long 1, 16, 16, 8192, 7680, 7936, 8388608, 2621440, 32768, 8, 14802944, 131072, 0, 0, 218105712, 4
    .long 2, 64, 72, 7168, 5888, 5888, 7340032, 1048576, 32768, 8, 58290176, 114688, 0, 0, 218103984, 1
    .long 2, 64, 72, 7168, 4864, 4864, 7340032, 2621440, 32768, 8, 63778816, 114688, 0, 0, 218104160, 1
    .long 1, 80, 80, 2048, 5506560, 5506816, 7340032, 60116992, 114688, 7, 181952512, 32768, 218104048, 7, 218106560, 1
    .long 0, 0, 0, 0, 0, 0, 0, 0, 0, 0, 0, 0, 0, 0, 0, 0
    .long 0, 0, 0, 0, 0, 0, 0, 0, 0, 0, 0, 0, 0, 0, 0, 0
    .long 0, 0, 0, 0, 0, 0, 0, 0, 0, 0, 0, 0, 0, 0, 0, 0
    .long 0, 0, 0, 0, 0, 0, 0, 0, 0, 0, 0, 0, 0, 0, 0, 0
.p2align 6
.amdhsa_kernel recurrent_scan__memory_aug_recurrent_mem_tr__glu_gated_glu__prompt_kernel
  .amdhsa_next_free_vgpr 256
  .amdhsa_next_free_sgpr 102
  .amdhsa_accum_offset 256
  .amdhsa_group_segment_fixed_size 0
  .amdhsa_kernarg_size 112
  .amdhsa_user_sgpr_count 2
  .amdhsa_user_sgpr_kernarg_segment_ptr 1
  .amdhsa_system_sgpr_workgroup_id_x 1
  .amdhsa_float_denorm_mode_32 3
.end_amdhsa_kernel
```

```asm
; @launch grid=(256,1,1) block=(512,1,1) lds=163840
.amdgcn_target "amdgcn-amd-amdhsa--gfx950"
.text
.globl recurrent_scan__memory_aug_recurrent_mem_tr__glu_gated_glu__prompt_kernel
.p2align 8
.type recurrent_scan__memory_aug_recurrent_mem_tr__glu_gated_glu__prompt_kernel,@function
recurrent_scan__memory_aug_recurrent_mem_tr__glu_gated_glu__prompt_kernel:
    s_cmp_ge_u32 s2, 256
    s_cbranch_scc1 k_exit
    s_mov_b32 s99, s2
    s_load_dwordx2 s[4:5], s[0:1], 104
    s_load_dwordx2 s[64:65], s[0:1], 96
    v_lshrrev_b32 v2, 6, v0
    s_mov_b32 s6, 268435456
    s_mov_b32 s7, 131072
    s_mov_b32 s66, 256
    s_mov_b32 s67, 131072
    v_readfirstlane_b32 s3, v2
    s_lshr_b32 s12, s2, 3
    s_and_b32 s13, s2, 3
    s_waitcnt lgkmcnt(0)
    s_bitcmp0_b32 s2, 2
    s_cbranch_scc1 chain_map
    s_lshl_b32 s63, s12, 2
    s_add_u32 s63, s63, s13
    s_mov_b32 s29, s63
    v_and_b32 v20, 63, v0
    v_lshlrev_b32 v1, 4, v20
    v_add_u32 v19, 0x1000, v1
    v_lshrrev_b32 v4, 4, v20
    v_mov_b32 v17, 0
    v_mov_b32 v18, 1
    s_lshr_b32 s26, s3, 2
    s_and_b32 s27, s3, 3
    s_lshl_b32 s21, s3, 11
    s_lshl_b32 s22, s3, 10
    s_add_u32 s22, s22, 16384
    s_mov_b32 s11, 131072
    s_mov_b32 s15, 131072
    s_mov_b32 s28, 0
    v_and_b32 v21, 15, v20
    v_lshlrev_b32 v22, 2, v4
    v_xor_b32 v21, v21, v22
    s_lshr_b32 s30, s3, 1
    s_and_b32 s30, s30, 1
    v_xor_b32 v21, s30, v21
    v_lshlrev_b32 v3, 4, v21
    s_lshl_b32 s30, s26, 13
    v_add_u32 v5, s30, v1
    v_add_u32 v6, 0x10000, v5
    v_bfe_u32 v21, v20, 2, 2
    v_and_b32 v22, 3, v20
    v_and_b32 v23, 1, v4
    v_xor_b32 v24, s27, v21
    v_xor_b32 v25, v22, v23
    v_lshl_add_u32 v24, v24, 2, v25
    v_lshlrev_b32 v24, 4, v24
    v_lshl_add_u32 v25, v4, 3, v21
    v_lshl_add_u32 v24, v25, 8, v24
    v_and_b32 v22, 1, v22
    v_xor_b32 v25, 0, v23
    v_lshl_add_u32 v8, v25, 10, v24
    v_xor_b32 v25, 0, v22
    v_lshl_add_u32 v8, v25, 3, v8
    v_add_u32 v12, 0x10000, v8
    v_xor_b32 v25, 1, v23
    v_lshl_add_u32 v9, v25, 10, v24
    v_xor_b32 v25, 0, v22
    v_lshl_add_u32 v9, v25, 3, v9
    v_add_u32 v13, 0x10000, v9
    v_xor_b32 v25, 0, v23
    v_lshl_add_u32 v10, v25, 10, v24
    v_xor_b32 v25, 1, v22
    v_lshl_add_u32 v10, v25, 3, v10
    v_add_u32 v14, 0x10000, v10
    v_xor_b32 v25, 1, v23
    v_lshl_add_u32 v11, v25, 10, v24
    v_xor_b32 v25, 1, v22
    v_lshl_add_u32 v11, v25, 3, v11
    v_add_u32 v15, 0x10000, v11
    s_lshl_b32 s30, s3, 2
    s_add_u32 s30, s30, 131072
    v_mov_b32 v7, s30
    s_getpc_b64 s[24:25]
    s_add_u32 s24, s24, jobtab@rel32@lo+4
    s_addc_u32 s25, s25, jobtab@rel32@hi+12
    s_mul_i32 s30, s29, 640
    s_add_u32 s24, s24, s30
    s_addc_u32 s25, s25, 0
    s_load_dwordx16 s[32:47], s[24:25], 0
    s_add_u32 s24, s24, 64
    s_addc_u32 s25, s25, 0
    s_waitcnt lgkmcnt(0)
    s_mov_b32 s8, s4
    s_mov_b32 s9, s5
    s_mov_b32 s10, 0
    s_mov_b32 s12, s4
    s_mov_b32 s13, s5
    s_mov_b32 s14, 0
    s_load_dwordx2 s[88:89], s[0:1], 0
    s_mov_b32 s90, 4194304
    s_mov_b32 s91, 131072
    s_mov_b32 s98, 0
    v_mov_b32 v22, 0
    s_mov_b32 s70, 1
    v_and_b32 v245, 15, v0
    v_lshlrev_b32 v246, 11, v245
    v_lshl_add_u32 v246, v4, 4, v246
    s_add_u32 s71, s63, 32
    s_and_b32 s71, s71, 127
    s_lshl_b32 s72, s71, 15
    s_lshl_b32 s73, s3, 8
    s_add_u32 s72, s72, s73
    s_waitcnt lgkmcnt(0)
    buffer_load_dwordx4 v[228:231], v246, s[88:91], s72 offen offset:0
    buffer_load_dwordx4 v[232:235], v246, s[88:91], s72 offen offset:64
    buffer_load_dwordx4 v[236:239], v246, s[88:91], s72 offen offset:128
    buffer_load_dwordx4 v[240:243], v246, s[88:91], s72 offen offset:192
    s_cmp_lg_u32 s32, 6
    s_cbranch_scc1 ln_nx
    s_mov_b32 s98, 3
    s_cmp_lg_u32 s32, 6
    s_cbranch_scc1 xs_1
    s_load_dwordx2 s[8:9], s[0:1], s33
    s_load_dwordx2 s[12:13], s[0:1], s34
    s_mov_b32 s10, s38
    s_mov_b32 s14, s38
    s_cmp_ge_u32 s32, 4
    s_cselect_b32 s31, 0, 1
    s_lshl_b32 s30, s3, s31
    s_mul_i32 s30, s30, s40
    s_add_u32 s16, s39, s30
    s_cmp_eq_u32 s32, 4
    s_cselect_b32 s30, 1024, s40
    s_cselect_b32 s31, 6, 5
    s_lshl_b32 s62, 32, s31
    s_add_u32 s17, s16, s30
    s_lshl_b32 s30, s3, 2
    s_mul_i32 s30, s30, s35
    s_add_u32 s18, s36, s30
    s_add_u32 s19, s37, s30
    s_lshl_b32 s20, s35, s31
    v_mul_u32_u24 v2, s35, v4
    v_add_u32 v2, v2, v3
    s_waitcnt lgkmcnt(0)
    s_lshl_b32 s16, s3, 15
    s_add_u32 s16, s16, s39
    s_add_u32 s92, s16, 2048
    s_lshl_b32 s93, s35, 10
    s_lshr_b32 s94, s63, 2
    s_mul_i32 s94, s94, 1
    s_and_b32 s94, s94, 15
    s_lshl_b32 s95, s94, 7
    s_add_u32 s16, s16, s95
    s_lshl_b32 s95, s35, 6
    s_mul_i32 s94, s95, s94
    s_add_u32 s95, s18, s93
    s_add_u32 s18, s18, s94
    s_add_u32 s19, s19, s94
    s_add_u32 s17, s16, 16384
    s_mov_b32 s62, 128
    s_lshl_b32 s20, s35, 6
    v_lshrrev_b32 v21, 7, v1
    v_bfe_u32 v23, v1, 4, 3
    v_xor_b32 v23, v21, v23
    v_lshlrev_b32 v23, 4, v23
    v_lshl_add_u32 v23, v21, 11, v23
    s_add_u32 m0, s21, 0
    s_nop 0
    buffer_load_dwordx4 v23, s[88:91], s16 offen lds
    s_add_u32 s16, s16, s62
    s_add_u32 m0, s21, 1024
    s_nop 0
    buffer_load_dwordx4 v23, s[88:91], s17 offen lds
    s_add_u32 s17, s17, s62
    s_cmp_ge_u32 s16, s92
    s_cselect_b32 s94, 2048, 0
    s_sub_u32 s16, s16, s94
    s_sub_u32 s17, s17, s94
    s_add_u32 m0, s22, 0
    s_nop 0
    buffer_load_dwordx4 v2, s[8:11], s18 offen lds
    s_add_u32 s18, s18, s20
    s_add_u32 m0, s22, 8192
    s_nop 0
    buffer_load_dwordx4 v2, s[12:15], s19 offen lds
    s_add_u32 s19, s19, s20
    s_cmp_ge_u32 s18, s95
    s_cselect_b32 s94, s93, 0
    s_sub_u32 s18, s18, s94
    s_sub_u32 s19, s19, s94
    s_add_u32 m0, s21, 32768
    s_nop 0
    buffer_load_dwordx4 v23, s[88:91], s16 offen lds
    s_add_u32 s16, s16, s62
    s_add_u32 m0, s21, 33792
    s_nop 0
    buffer_load_dwordx4 v23, s[88:91], s17 offen lds
    s_add_u32 s17, s17, s62
    s_cmp_ge_u32 s16, s92
    s_cselect_b32 s94, 2048, 0
    s_sub_u32 s16, s16, s94
    s_sub_u32 s17, s17, s94
    s_add_u32 m0, s22, 32768
    s_nop 0
    buffer_load_dwordx4 v2, s[8:11], s18 offen lds
    s_add_u32 s18, s18, s20
    s_add_u32 m0, s22, 40960
    s_nop 0
    buffer_load_dwordx4 v2, s[12:15], s19 offen lds
    s_add_u32 s19, s19, s20
    s_cmp_ge_u32 s18, s95
    s_cselect_b32 s94, s93, 0
    s_sub_u32 s18, s18, s94
    s_sub_u32 s19, s19, s94
    s_add_u32 m0, s21, 65536
    s_nop 0
    buffer_load_dwordx4 v23, s[88:91], s16 offen lds
    s_add_u32 s16, s16, s62
    s_add_u32 m0, s21, 66560
    s_nop 0
    buffer_load_dwordx4 v23, s[88:91], s17 offen lds
    s_add_u32 s17, s17, s62
    s_cmp_ge_u32 s16, s92
    s_cselect_b32 s94, 2048, 0
    s_sub_u32 s16, s16, s94
    s_sub_u32 s17, s17, s94
    s_add_u32 m0, s22, 65536
    s_nop 0
    buffer_load_dwordx4 v2, s[8:11], s18 offen lds
    s_add_u32 s18, s18, s20
    s_add_u32 m0, s22, 73728
    s_nop 0
    buffer_load_dwordx4 v2, s[12:15], s19 offen lds
    s_add_u32 s19, s19, s20
    s_cmp_ge_u32 s18, s95
    s_cselect_b32 s94, s93, 0
    s_sub_u32 s18, s18, s94
    s_sub_u32 s19, s19, s94
    s_add_u32 m0, s21, 98304
    s_nop 0
    buffer_load_dwordx4 v23, s[88:91], s16 offen lds
    s_add_u32 s16, s16, s62
    s_add_u32 m0, s21, 99328
    s_nop 0
    buffer_load_dwordx4 v23, s[88:91], s17 offen lds
    s_add_u32 s17, s17, s62
    s_cmp_ge_u32 s16, s92
    s_cselect_b32 s94, 2048, 0
    s_sub_u32 s16, s16, s94
    s_sub_u32 s17, s17, s94
    s_add_u32 m0, s22, 98304
    s_nop 0
    buffer_load_dwordx4 v2, s[8:11], s18 offen lds
    s_add_u32 s18, s18, s20
    s_add_u32 m0, s22, 106496
    s_nop 0
    buffer_load_dwordx4 v2, s[12:15], s19 offen lds
    s_add_u32 s19, s19, s20
    s_cmp_ge_u32 s18, s95
    s_cselect_b32 s94, s93, 0
    s_sub_u32 s18, s18, s94
    s_sub_u32 s19, s19, s94
    v_and_b32 v21, 1, v4
    v_lshlrev_b32 v21, 10, v21
    v_xor_b32 v8, v21, v8
    v_xor_b32 v9, v21, v9
    v_xor_b32 v10, v21, v10
    v_xor_b32 v11, v21, v11
    v_xor_b32 v12, v21, v12
    v_xor_b32 v13, v21, v13
    v_xor_b32 v14, v21, v14
    v_xor_b32 v15, v21, v15
xs_1:
    s_branch w_adopt
ln_nx:
    s_lshl_b32 s73, s71, 9
    s_add_u32 s73, s73, 218103808
    v_lshlrev_b32 v252, 2, v0
    s_cmp_ge_u32 s71, 32
    s_cbranch_scc1 ln_nz
    s_cmp_ge_u32 s3, 2
    s_cbranch_scc1 ln_nz
    buffer_store_dword v17, v252, s[4:7], s73 offen sc1
ln_nz:
    s_waitcnt vmcnt(0)
ln_entry:
    v_lshlrev_b32 v247, 5, v245
    v_add_u32 v247, 135168, v247
    s_lshl_b32 s74, s3, 2
    v_add_u32 v248, s74, v247
    s_lshl_b32 s75, s71, 15
    s_lshl_b32 s76, s3, 12
    s_add_u32 s75, s75, s76
    v_and_b32 v249, 1, v4
    v_cmp_eq_u32 s[80:81], 1, v249
    v_lshlrev_b32 v56, 16, v228
    v_and_b32 v57, 0xffff0000, v228
    v_lshlrev_b32 v58, 16, v229
    v_and_b32 v59, 0xffff0000, v229
    v_lshlrev_b32 v60, 16, v230
    v_and_b32 v61, 0xffff0000, v230
    v_lshlrev_b32 v62, 16, v231
    v_and_b32 v63, 0xffff0000, v231
    v_lshlrev_b32 v64, 16, v232
    v_and_b32 v65, 0xffff0000, v232
    v_lshlrev_b32 v66, 16, v233
    v_and_b32 v67, 0xffff0000, v233
    v_lshlrev_b32 v68, 16, v234
    v_and_b32 v69, 0xffff0000, v234
    v_lshlrev_b32 v70, 16, v235
    v_and_b32 v71, 0xffff0000, v235
    v_lshlrev_b32 v72, 16, v236
    v_and_b32 v73, 0xffff0000, v236
    v_lshlrev_b32 v74, 16, v237
    v_and_b32 v75, 0xffff0000, v237
    v_lshlrev_b32 v76, 16, v238
    v_and_b32 v77, 0xffff0000, v238
    v_lshlrev_b32 v78, 16, v239
    v_and_b32 v79, 0xffff0000, v239
    v_lshlrev_b32 v80, 16, v240
    v_and_b32 v81, 0xffff0000, v240
    v_lshlrev_b32 v82, 16, v241
    v_and_b32 v83, 0xffff0000, v241
    v_lshlrev_b32 v84, 16, v242
    v_and_b32 v85, 0xffff0000, v242
    v_lshlrev_b32 v86, 16, v243
    v_and_b32 v87, 0xffff0000, v243
    v_add_f32 v120, v56, v72
    v_add_f32 v121, v57, v73
    v_add_f32 v122, v58, v74
    v_add_f32 v123, v59, v75
    v_add_f32 v124, v60, v76
    v_add_f32 v125, v61, v77
    v_add_f32 v126, v62, v78
    v_add_f32 v127, v63, v79
    v_add_f32 v128, v64, v80
    v_add_f32 v129, v65, v81
    v_add_f32 v130, v66, v82
    v_add_f32 v131, v67, v83
    v_add_f32 v132, v68, v84
    v_add_f32 v133, v69, v85
    v_add_f32 v134, v70, v86
    v_add_f32 v135, v71, v87
    v_add_f32 v120, v120, v128
    v_add_f32 v121, v121, v129
    v_add_f32 v122, v122, v130
    v_add_f32 v123, v123, v131
    v_add_f32 v124, v124, v132
    v_add_f32 v125, v125, v133
    v_add_f32 v126, v126, v134
    v_add_f32 v127, v127, v135
    v_add_f32 v120, v120, v124
    v_add_f32 v121, v121, v125
    v_add_f32 v122, v122, v126
    v_add_f32 v123, v123, v127
    v_add_f32 v120, v120, v122
    v_add_f32 v121, v121, v123
    v_add_f32 v120, v120, v121
    v_mov_b32 v121, v120
    s_nop 1
    v_permlane16_swap_b32 v121, v120
    v_add_f32 v120, v120, v121
    v_mov_b32 v121, v120
    s_nop 1
    v_permlane32_swap_b32 v121, v120
    v_add_f32 v120, v120, v121
    ds_write_b32 v248, v120 offset:0
    s_waitcnt lgkmcnt(0)
    s_barrier
    ds_read_b128 v[120:123], v247 offset:0
    ds_read_b128 v[124:127], v247 offset:16
    s_waitcnt lgkmcnt(0)
    v_add_f32 v120, v120, v124
    v_add_f32 v121, v121, v125
    v_add_f32 v122, v122, v126
    v_add_f32 v123, v123, v127
    v_add_f32 v120, v120, v122
    v_add_f32 v121, v121, v123
    v_add_f32 v120, v120, v121
    v_mul_f32 v250, 0x3a800000, v120
    v_sub_f32 v152, v56, v250
    v_sub_f32 v153, v57, v250
    v_sub_f32 v154, v58, v250
    v_sub_f32 v155, v59, v250
    v_sub_f32 v156, v60, v250
    v_sub_f32 v157, v61, v250
    v_sub_f32 v158, v62, v250
    v_sub_f32 v159, v63, v250
    v_sub_f32 v160, v64, v250
    v_sub_f32 v161, v65, v250
    v_sub_f32 v162, v66, v250
    v_sub_f32 v163, v67, v250
    v_sub_f32 v164, v68, v250
    v_sub_f32 v165, v69, v250
    v_sub_f32 v166, v70, v250
    v_sub_f32 v167, v71, v250
    v_sub_f32 v168, v72, v250
    v_sub_f32 v169, v73, v250
    v_sub_f32 v170, v74, v250
    v_sub_f32 v171, v75, v250
    v_sub_f32 v172, v76, v250
    v_sub_f32 v173, v77, v250
    v_sub_f32 v174, v78, v250
    v_sub_f32 v175, v79, v250
    v_sub_f32 v176, v80, v250
    v_sub_f32 v177, v81, v250
    v_sub_f32 v178, v82, v250
    v_sub_f32 v179, v83, v250
    v_sub_f32 v180, v84, v250
    v_sub_f32 v181, v85, v250
    v_sub_f32 v182, v86, v250
    v_sub_f32 v183, v87, v250
    v_mul_f32 v120, v152, v152
    v_fmac_f32 v120, v168, v168
    v_mul_f32 v121, v153, v153
    v_fmac_f32 v121, v169, v169
    v_mul_f32 v122, v154, v154
    v_fmac_f32 v122, v170, v170
    v_mul_f32 v123, v155, v155
    v_fmac_f32 v123, v171, v171
    v_mul_f32 v124, v156, v156
    v_fmac_f32 v124, v172, v172
    v_mul_f32 v125, v157, v157
    v_fmac_f32 v125, v173, v173
    v_mul_f32 v126, v158, v158
    v_fmac_f32 v126, v174, v174
    v_mul_f32 v127, v159, v159
    v_fmac_f32 v127, v175, v175
    v_mul_f32 v128, v160, v160
    v_fmac_f32 v128, v176, v176
    v_mul_f32 v129, v161, v161
    v_fmac_f32 v129, v177, v177
    v_mul_f32 v130, v162, v162
    v_fmac_f32 v130, v178, v178
    v_mul_f32 v131, v163, v163
    v_fmac_f32 v131, v179, v179
    v_mul_f32 v132, v164, v164
    v_fmac_f32 v132, v180, v180
    v_mul_f32 v133, v165, v165
    v_fmac_f32 v133, v181, v181
    v_mul_f32 v134, v166, v166
    v_fmac_f32 v134, v182, v182
    v_mul_f32 v135, v167, v167
    v_fmac_f32 v135, v183, v183
    v_add_f32 v120, v120, v128
    v_add_f32 v121, v121, v129
    v_add_f32 v122, v122, v130
    v_add_f32 v123, v123, v131
    v_add_f32 v124, v124, v132
    v_add_f32 v125, v125, v133
    v_add_f32 v126, v126, v134
    v_add_f32 v127, v127, v135
    v_add_f32 v120, v120, v124
    v_add_f32 v121, v121, v125
    v_add_f32 v122, v122, v126
    v_add_f32 v123, v123, v127
    v_add_f32 v120, v120, v122
    v_add_f32 v121, v121, v123
    v_add_f32 v120, v120, v121
    v_mov_b32 v121, v120
    s_nop 1
    v_permlane16_swap_b32 v121, v120
    v_add_f32 v120, v120, v121
    v_mov_b32 v121, v120
    s_nop 1
    v_permlane32_swap_b32 v121, v120
    v_add_f32 v120, v120, v121
    ds_write_b32 v248, v120 offset:512
    s_waitcnt lgkmcnt(0)
    s_barrier
    ds_read_b128 v[120:123], v247 offset:512
    ds_read_b128 v[124:127], v247 offset:528
    s_waitcnt lgkmcnt(0)
    v_add_f32 v120, v120, v124
    v_add_f32 v121, v121, v125
    v_add_f32 v122, v122, v126
    v_add_f32 v123, v123, v127
    v_add_f32 v120, v120, v122
    v_add_f32 v121, v121, v123
    v_add_f32 v120, v120, v121
    v_mul_f32 v251, 0x3a800000, v120
    v_cvt_pk_bf16_f32 v250, v250, v250
    v_lshlrev_b32 v250, 16, v250
    v_cvt_pk_bf16_f32 v251, v251, v251
    v_lshlrev_b32 v251, 16, v251
    v_add_f32 v251, 0x3727c5ac, v251
    v_cvt_pk_bf16_f32 v251, v251, v251
    v_lshlrev_b32 v251, 16, v251
    v_sqrt_f32 v251, v251
    s_nop 0
    v_cvt_pk_bf16_f32 v251, v251, v251
    v_lshlrev_b32 v251, 16, v251
    v_rcp_f32 v251, v251
    s_nop 0
    s_cmp_lg_u32 s3, 0
    s_cbranch_scc1 ln_nst
    s_lshl_b32 s77, s71, 7
    s_add_u32 s77, s77, 188743680
    v_lshlrev_b32 v249, 3, v245
    s_mov_b64 exec, 0xffff
    buffer_store_dwordx2 v[250:251], v249, s[4:7], s77 offen sc1
    s_mov_b64 exec, -1
ln_nst:
    v_sub_f32 v56, v56, v250
    v_sub_f32 v57, v57, v250
    v_cvt_pk_bf16_f32 v228, v56, v57
    v_lshlrev_b32 v56, 16, v228
    v_and_b32 v57, 0xffff0000, v228
    v_mul_f32 v56, v56, v251
    v_mul_f32 v57, v57, v251
    v_cvt_pk_bf16_f32 v228, v56, v57
    v_sub_f32 v58, v58, v250
    v_sub_f32 v59, v59, v250
    v_cvt_pk_bf16_f32 v229, v58, v59
    v_lshlrev_b32 v58, 16, v229
    v_and_b32 v59, 0xffff0000, v229
    v_mul_f32 v58, v58, v251
    v_mul_f32 v59, v59, v251
    v_cvt_pk_bf16_f32 v229, v58, v59
    v_sub_f32 v60, v60, v250
    v_sub_f32 v61, v61, v250
    v_cvt_pk_bf16_f32 v230, v60, v61
    v_lshlrev_b32 v60, 16, v230
    v_and_b32 v61, 0xffff0000, v230
    v_mul_f32 v60, v60, v251
    v_mul_f32 v61, v61, v251
    v_cvt_pk_bf16_f32 v230, v60, v61
    v_sub_f32 v62, v62, v250
    v_sub_f32 v63, v63, v250
    v_cvt_pk_bf16_f32 v231, v62, v63
    v_lshlrev_b32 v62, 16, v231
    v_and_b32 v63, 0xffff0000, v231
    v_mul_f32 v62, v62, v251
    v_mul_f32 v63, v63, v251
    v_cvt_pk_bf16_f32 v231, v62, v63
    v_cndmask_b32 v120, v228, v230, s[80:81]
    v_cndmask_b32 v121, v229, v231, s[80:81]
    v_cndmask_b32 v122, v230, v228, s[80:81]
    v_cndmask_b32 v123, v231, v229, s[80:81]
    buffer_store_dwordx4 v[120:123], v1, s[4:7], s75 offen offset:0 sc1
    v_sub_f32 v64, v64, v250
    v_sub_f32 v65, v65, v250
    v_cvt_pk_bf16_f32 v232, v64, v65
    v_lshlrev_b32 v64, 16, v232
    v_and_b32 v65, 0xffff0000, v232
    v_mul_f32 v64, v64, v251
    v_mul_f32 v65, v65, v251
    v_cvt_pk_bf16_f32 v232, v64, v65
    v_sub_f32 v66, v66, v250
    v_sub_f32 v67, v67, v250
    v_cvt_pk_bf16_f32 v233, v66, v67
    v_lshlrev_b32 v66, 16, v233
    v_and_b32 v67, 0xffff0000, v233
    v_mul_f32 v66, v66, v251
    v_mul_f32 v67, v67, v251
    v_cvt_pk_bf16_f32 v233, v66, v67
    v_sub_f32 v68, v68, v250
    v_sub_f32 v69, v69, v250
    v_cvt_pk_bf16_f32 v234, v68, v69
    v_lshlrev_b32 v68, 16, v234
    v_and_b32 v69, 0xffff0000, v234
    v_mul_f32 v68, v68, v251
    v_mul_f32 v69, v69, v251
    v_cvt_pk_bf16_f32 v234, v68, v69
    v_sub_f32 v70, v70, v250
    v_sub_f32 v71, v71, v250
    v_cvt_pk_bf16_f32 v235, v70, v71
    v_lshlrev_b32 v70, 16, v235
    v_and_b32 v71, 0xffff0000, v235
    v_mul_f32 v70, v70, v251
    v_mul_f32 v71, v71, v251
    v_cvt_pk_bf16_f32 v235, v70, v71
    v_cndmask_b32 v124, v232, v234, s[80:81]
    v_cndmask_b32 v125, v233, v235, s[80:81]
    v_cndmask_b32 v126, v234, v232, s[80:81]
    v_cndmask_b32 v127, v235, v233, s[80:81]
    buffer_store_dwordx4 v[124:127], v1, s[4:7], s75 offen offset:1024 sc1
    v_sub_f32 v72, v72, v250
    v_sub_f32 v73, v73, v250
    v_cvt_pk_bf16_f32 v236, v72, v73
    v_lshlrev_b32 v72, 16, v236
    v_and_b32 v73, 0xffff0000, v236
    v_mul_f32 v72, v72, v251
    v_mul_f32 v73, v73, v251
    v_cvt_pk_bf16_f32 v236, v72, v73
    v_sub_f32 v74, v74, v250
    v_sub_f32 v75, v75, v250
    v_cvt_pk_bf16_f32 v237, v74, v75
    v_lshlrev_b32 v74, 16, v237
    v_and_b32 v75, 0xffff0000, v237
    v_mul_f32 v74, v74, v251
    v_mul_f32 v75, v75, v251
    v_cvt_pk_bf16_f32 v237, v74, v75
    v_sub_f32 v76, v76, v250
    v_sub_f32 v77, v77, v250
    v_cvt_pk_bf16_f32 v238, v76, v77
    v_lshlrev_b32 v76, 16, v238
    v_and_b32 v77, 0xffff0000, v238
    v_mul_f32 v76, v76, v251
    v_mul_f32 v77, v77, v251
    v_cvt_pk_bf16_f32 v238, v76, v77
    v_sub_f32 v78, v78, v250
    v_sub_f32 v79, v79, v250
    v_cvt_pk_bf16_f32 v239, v78, v79
    v_lshlrev_b32 v78, 16, v239
    v_and_b32 v79, 0xffff0000, v239
    v_mul_f32 v78, v78, v251
    v_mul_f32 v79, v79, v251
    v_cvt_pk_bf16_f32 v239, v78, v79
    v_cndmask_b32 v128, v236, v238, s[80:81]
    v_cndmask_b32 v129, v237, v239, s[80:81]
    v_cndmask_b32 v130, v238, v236, s[80:81]
    v_cndmask_b32 v131, v239, v237, s[80:81]
    buffer_store_dwordx4 v[128:131], v1, s[4:7], s75 offen offset:2048 sc1
    v_sub_f32 v80, v80, v250
    v_sub_f32 v81, v81, v250
    v_cvt_pk_bf16_f32 v240, v80, v81
    v_lshlrev_b32 v80, 16, v240
    v_and_b32 v81, 0xffff0000, v240
    v_mul_f32 v80, v80, v251
    v_mul_f32 v81, v81, v251
    v_cvt_pk_bf16_f32 v240, v80, v81
    v_sub_f32 v82, v82, v250
    v_sub_f32 v83, v83, v250
    v_cvt_pk_bf16_f32 v241, v82, v83
    v_lshlrev_b32 v82, 16, v241
    v_and_b32 v83, 0xffff0000, v241
    v_mul_f32 v82, v82, v251
    v_mul_f32 v83, v83, v251
    v_cvt_pk_bf16_f32 v241, v82, v83
    v_sub_f32 v84, v84, v250
    v_sub_f32 v85, v85, v250
    v_cvt_pk_bf16_f32 v242, v84, v85
    v_lshlrev_b32 v84, 16, v242
    v_and_b32 v85, 0xffff0000, v242
    v_mul_f32 v84, v84, v251
    v_mul_f32 v85, v85, v251
    v_cvt_pk_bf16_f32 v242, v84, v85
    v_sub_f32 v86, v86, v250
    v_sub_f32 v87, v87, v250
    v_cvt_pk_bf16_f32 v243, v86, v87
    v_lshlrev_b32 v86, 16, v243
    v_and_b32 v87, 0xffff0000, v243
    v_mul_f32 v86, v86, v251
    v_mul_f32 v87, v87, v251
    v_cvt_pk_bf16_f32 v243, v86, v87
    v_cndmask_b32 v132, v240, v242, s[80:81]
    v_cndmask_b32 v133, v241, v243, s[80:81]
    v_cndmask_b32 v134, v242, v240, s[80:81]
    v_cndmask_b32 v135, v243, v241, s[80:81]
    buffer_store_dwordx4 v[132:135], v1, s[4:7], s75 offen offset:3072 sc1
    s_cmp_lg_u32 s98, 1
    s_cbranch_scc1 ln_now
    s_mov_b32 s98, 2
    s_branch w_adopt2
ln_now:
    v_mov_b32 v18, 1
    s_waitcnt vmcnt(0)
    s_barrier
    s_cmp_lg_u32 s3, 0
    s_cbranch_scc1 ln_sig
    s_mov_b64 exec, 1
    s_cmp_ge_u32 s71, 32
    s_cbranch_scc1 ln_sb
    buffer_atomic_add v18, off, s[64:67], 0 offset:192 sc1
ln_sb:
    buffer_atomic_add v18, off, s[64:67], 0 offset:0 sc1
    s_mov_b64 exec, -1
ln_sig:
    s_cmp_eq_u32 s98, 4
    s_cselect_b32 s98, 0, s98
    s_cbranch_scc1 w_hook
    s_cmp_lt_u32 s63, 120
    s_cbranch_scc1 prb_done
    s_cmp_lg_u32 s3, 0
    s_cbranch_scc1 prb_bar
    s_sub_u32 s82, s63, 120
    s_lshl_b32 s83, s82, 7
    s_add_u32 s83, s83, 218112000
    s_lshl_b32 s84, s82, 10
    s_add_u32 s84, s84, 209715200
    s_mov_b32 s80, -1
    s_mov_b32 s81, -1
    s_mov_b64 exec, 1
    s_memtime s[74:75]
    s_add_u32 s87, s84, 0
    s_waitcnt lgkmcnt(0)
    buffer_load_dword v20, off, s[4:7], s87 sc1
    s_waitcnt vmcnt(0)
    s_memtime s[76:77]
    s_waitcnt lgkmcnt(0)
    s_sub_u32 s87, s76, s74
    s_min_u32 s80, s80, s87
    s_memtime s[74:75]
    s_add_u32 s87, s84, 8192
    s_waitcnt lgkmcnt(0)
    buffer_load_dword v20, off, s[4:7], s87 sc1
    s_waitcnt vmcnt(0)
    s_memtime s[76:77]
    s_waitcnt lgkmcnt(0)
    s_sub_u32 s87, s76, s74
    s_min_u32 s81, s81, s87
    s_memtime s[74:75]
    s_add_u32 s87, s84, 16384
    s_waitcnt lgkmcnt(0)
    buffer_load_dword v20, off, s[4:7], s87 sc1
    s_waitcnt vmcnt(0)
    s_memtime s[76:77]
    s_waitcnt lgkmcnt(0)
    s_sub_u32 s87, s76, s74
    s_min_u32 s80, s80, s87
    s_memtime s[74:75]
    s_add_u32 s87, s84, 24576
    s_waitcnt lgkmcnt(0)
    buffer_load_dword v20, off, s[4:7], s87 sc1
    s_waitcnt vmcnt(0)
    s_memtime s[76:77]
    s_waitcnt lgkmcnt(0)
    s_sub_u32 s87, s76, s74
    s_min_u32 s81, s81, s87
    s_memtime s[74:75]
    s_add_u32 s87, s84, 32768
    s_waitcnt lgkmcnt(0)
    buffer_load_dword v20, off, s[4:7], s87 sc1
    s_waitcnt vmcnt(0)
    s_memtime s[76:77]
    s_waitcnt lgkmcnt(0)
    s_sub_u32 s87, s76, s74
    s_min_u32 s80, s80, s87
    s_memtime s[74:75]
    s_add_u32 s87, s84, 40960
    s_waitcnt lgkmcnt(0)
    buffer_load_dword v20, off, s[4:7], s87 sc1
    s_waitcnt vmcnt(0)
    s_memtime s[76:77]
    s_waitcnt lgkmcnt(0)
    s_sub_u32 s87, s76, s74
    s_min_u32 s81, s81, s87
    s_memtime s[74:75]
    s_add_u32 s87, s84, 49152
    s_waitcnt lgkmcnt(0)
    buffer_load_dword v20, off, s[4:7], s87 sc1
    s_waitcnt vmcnt(0)
    s_memtime s[76:77]
    s_waitcnt lgkmcnt(0)
    s_sub_u32 s87, s76, s74
    s_min_u32 s80, s80, s87
    s_memtime s[74:75]
    s_add_u32 s87, s84, 57344
    s_waitcnt lgkmcnt(0)
    buffer_load_dword v20, off, s[4:7], s87 sc1
    s_waitcnt vmcnt(0)
    s_memtime s[76:77]
    s_waitcnt lgkmcnt(0)
    s_sub_u32 s87, s76, s74
    s_min_u32 s81, s81, s87
    s_memtime s[74:75]
    s_add_u32 s87, s84, 65536
    s_waitcnt lgkmcnt(0)
    buffer_load_dword v20, off, s[4:7], s87 sc1
    s_waitcnt vmcnt(0)
    s_memtime s[76:77]
    s_waitcnt lgkmcnt(0)
    s_sub_u32 s87, s76, s74
    s_min_u32 s80, s80, s87
    s_memtime s[74:75]
    s_add_u32 s87, s84, 73728
    s_waitcnt lgkmcnt(0)
    buffer_load_dword v20, off, s[4:7], s87 sc1
    s_waitcnt vmcnt(0)
    s_memtime s[76:77]
    s_waitcnt lgkmcnt(0)
    s_sub_u32 s87, s76, s74
    s_min_u32 s81, s81, s87
    s_memtime s[74:75]
    s_add_u32 s87, s84, 81920
    s_waitcnt lgkmcnt(0)
    buffer_load_dword v20, off, s[4:7], s87 sc1
    s_waitcnt vmcnt(0)
    s_memtime s[76:77]
    s_waitcnt lgkmcnt(0)
    s_sub_u32 s87, s76, s74
    s_min_u32 s80, s80, s87
    s_memtime s[74:75]
    s_add_u32 s87, s84, 90112
    s_waitcnt lgkmcnt(0)
    buffer_load_dword v20, off, s[4:7], s87 sc1
    s_waitcnt vmcnt(0)
    s_memtime s[76:77]
    s_waitcnt lgkmcnt(0)
    s_sub_u32 s87, s76, s74
    s_min_u32 s81, s81, s87
    s_sub_i32 s85, s80, s81
    s_min_i32 s85, s85, 400
    s_max_i32 s85, s85, -400
    s_lshl_b32 s85, s85, 8
    s_getreg_b32 s86, hwreg(HW_REG_XCC_ID)
    s_bfe_u32 s86, s86, 0x10002
    s_lshl_b32 s86, s86, 1
    s_or_b32 s85, s85, s86
    s_or_b32 s85, s85, 1
    s_mov_b32 s86, 65536
prb_i:
    buffer_load_dword v20, off, s[64:67], 0 offset:192 sc1
    s_waitcnt vmcnt(0)
    v_readfirstlane_b32 s84, v20
    s_cmp_ge_u32 s84, 32
    s_cbranch_scc1 prb_i_ok
    s_sleep 8
    s_sub_u32 s86, s86, 1
    s_cbranch_scc0 prb_i
prb_i_ok:
    v_mov_b32 v20, s85
    buffer_store_dword v20, off, s[4:7], s83 offset:8 sc1
    s_mov_b64 exec, -1
prb_bar:
    s_barrier
prb_done:
    s_cmp_lt_u32 s32, 4
    s_cbranch_scc1 w_nopre
    s_load_dwordx2 s[8:9], s[0:1], s33
    s_load_dwordx2 s[12:13], s[0:1], s34
    s_mov_b32 s10, s38
    s_mov_b32 s14, s38
    s_cmp_ge_u32 s32, 4
    s_cselect_b32 s31, 0, 1
    s_lshl_b32 s30, s3, s31
    s_mul_i32 s30, s30, s40
    s_add_u32 s16, s39, s30
    s_cmp_eq_u32 s32, 4
    s_cselect_b32 s30, 1024, s40
    s_cselect_b32 s31, 6, 5
    s_lshl_b32 s62, 32, s31
    s_add_u32 s17, s16, s30
    s_lshl_b32 s30, s3, 2
    s_mul_i32 s30, s30, s35
    s_add_u32 s18, s36, s30
    s_add_u32 s19, s37, s30
    s_lshl_b32 s20, s35, s31
    v_mul_u32_u24 v2, s35, v4
    v_add_u32 v2, v2, v3
    s_waitcnt lgkmcnt(0)
    s_add_u32 m0, s22, 0
    s_nop 0
    buffer_load_dwordx4 v2, s[8:11], s18 offen lds
    s_add_u32 s18, s18, s20
    s_add_u32 m0, s22, 8192
    s_nop 0
    buffer_load_dwordx4 v2, s[12:15], s19 offen lds
    s_add_u32 s19, s19, s20
    s_add_u32 m0, s22, 32768
    s_nop 0
    buffer_load_dwordx4 v2, s[8:11], s18 offen lds
    s_add_u32 s18, s18, s20
    s_add_u32 m0, s22, 40960
    s_nop 0
    buffer_load_dwordx4 v2, s[12:15], s19 offen lds
    s_add_u32 s19, s19, s20
    s_add_u32 m0, s22, 65536
    s_nop 0
    buffer_load_dwordx4 v2, s[8:11], s18 offen lds
    s_add_u32 s18, s18, s20
    s_add_u32 m0, s22, 73728
    s_nop 0
    buffer_load_dwordx4 v2, s[12:15], s19 offen lds
    s_add_u32 s19, s19, s20
    s_add_u32 m0, s22, 98304
    s_nop 0
    buffer_load_dwordx4 v2, s[8:11], s18 offen lds
    s_add_u32 s18, s18, s20
    s_add_u32 m0, s22, 106496
    s_nop 0
    buffer_load_dwordx4 v2, s[12:15], s19 offen lds
    s_add_u32 s19, s19, s20
    s_mov_b32 s70, 1
    s_cmp_lt_u32 s39, 1048576
    s_cselect_b32 s70, s70, 0
    s_cmp_lg_u32 s3, 0
    s_cbranch_scc1 lnwp_ok
    s_cmp_eq_u32 s70, 0
    s_cbranch_scc1 lnwp_full
    s_mov_b32 s69, 65536
lnwap:
    buffer_load_dword v20, off, s[64:67], 0 offset:192 sc1
    s_waitcnt vmcnt(0)
    v_readfirstlane_b32 s68, v20
    s_cmp_ge_u32 s68, 32
    s_cbranch_scc1 lnwap_ok
    s_sleep 8
    s_sub_u32 s69, s69, 1
    s_cbranch_scc0 lnwap
lnwap_ok:
    s_branch lnwp_ok
lnwp_full:
    s_mov_b32 s69, 65536
lnwp:
    buffer_load_dword v20, off, s[64:67], 0 offset:0 sc1
    s_waitcnt vmcnt(0)
    v_readfirstlane_b32 s68, v20
    s_cmp_ge_u32 s68, 128
    s_cbranch_scc1 lnwp_ok
    s_sleep 8
    s_sub_u32 s69, s69, 1
    s_cbranch_scc0 lnwp
lnwp_ok:
    s_barrier
    s_add_u32 m0, s21, 0
    s_nop 0
    buffer_load_dwordx4 v1, s[4:7], s16 offen sc1 lds
    s_add_u32 s16, s16, s62
    s_add_u32 m0, s21, 1024
    s_nop 0
    buffer_load_dwordx4 v1, s[4:7], s17 offen sc1 lds
    s_add_u32 s17, s17, s62
    s_add_u32 m0, s21, 32768
    s_nop 0
    buffer_load_dwordx4 v1, s[4:7], s16 offen sc1 lds
    s_add_u32 s16, s16, s62
    s_add_u32 m0, s21, 33792
    s_nop 0
    buffer_load_dwordx4 v1, s[4:7], s17 offen sc1 lds
    s_add_u32 s17, s17, s62
    s_add_u32 m0, s21, 65536
    s_nop 0
    buffer_load_dwordx4 v1, s[4:7], s16 offen sc1 lds
    s_add_u32 s16, s16, s62
    s_add_u32 m0, s21, 66560
    s_nop 0
    buffer_load_dwordx4 v1, s[4:7], s17 offen sc1 lds
    s_add_u32 s17, s17, s62
    s_add_u32 m0, s21, 98304
    s_nop 0
    buffer_load_dwordx4 v1, s[4:7], s16 offen sc1 lds
    s_add_u32 s16, s16, s62
    s_add_u32 m0, s21, 99328
    s_nop 0
    buffer_load_dwordx4 v1, s[4:7], s17 offen sc1 lds
    s_add_u32 s17, s17, s62
    s_branch w_adopt
w_nopre:
    s_mov_b32 s70, 1
    s_cmp_lt_u32 s39, 1048576
    s_cselect_b32 s70, s70, 0
    s_cmp_lg_u32 s3, 0
    s_cbranch_scc1 lnw_ok
    s_cmp_eq_u32 s70, 0
    s_cbranch_scc1 lnw_full
    s_mov_b32 s69, 65536
lnwa:
    buffer_load_dword v20, off, s[64:67], 0 offset:192 sc1
    s_waitcnt vmcnt(0)
    v_readfirstlane_b32 s68, v20
    s_cmp_ge_u32 s68, 32
    s_cbranch_scc1 lnwa_ok
    s_sleep 8
    s_sub_u32 s69, s69, 1
    s_cbranch_scc0 lnwa
lnwa_ok:
    s_branch lnw_ok
lnw_full:
    s_mov_b32 s69, 65536
lnw:
    buffer_load_dword v20, off, s[64:67], 0 offset:0 sc1
    s_waitcnt vmcnt(0)
    v_readfirstlane_b32 s68, v20
    s_cmp_ge_u32 s68, 128
    s_cbranch_scc1 lnw_ok
    s_sleep 8
    s_sub_u32 s69, s69, 1
    s_cbranch_scc0 lnw
lnw_ok:
    s_barrier
w_cold:
    s_cmp_eq_u32 s32, 0
    s_cbranch_scc1 fin_entry
    s_cmp_lg_u32 s3, 0
    s_cbranch_scc1 w_depok
    s_cmp_eq_u32 s45, 0
    s_cbranch_scc1 w_depok
    s_mov_b32 s31, 0x40000
w_waitdep:
    buffer_load_dword v16, v17, s[4:7], s44 offen sc1
    s_waitcnt vmcnt(0)
    v_readfirstlane_b32 s30, v16
    s_cmp_ge_u32 s30, s45
    s_cbranch_scc1 w_depok
    s_sleep 16
    s_sub_u32 s31, s31, 1
    s_cbranch_scc0 w_waitdep
w_depok:
    s_load_dwordx2 s[8:9], s[0:1], s33
    s_load_dwordx2 s[12:13], s[0:1], s34
    s_mov_b32 s10, s38
    s_mov_b32 s14, s38
    s_cmp_ge_u32 s32, 4
    s_cselect_b32 s31, 0, 1
    s_lshl_b32 s30, s3, s31
    s_mul_i32 s30, s30, s40
    s_add_u32 s16, s39, s30
    s_cmp_eq_u32 s32, 4
    s_cselect_b32 s30, 1024, s40
    s_cselect_b32 s31, 6, 5
    s_lshl_b32 s62, 32, s31
    s_add_u32 s17, s16, s30
    s_lshl_b32 s30, s3, 2
    s_mul_i32 s30, s30, s35
    s_add_u32 s18, s36, s30
    s_add_u32 s19, s37, s30
    s_lshl_b32 s20, s35, s31
    v_mul_u32_u24 v2, s35, v4
    v_add_u32 v2, v2, v3
    s_waitcnt lgkmcnt(0)
    s_barrier
    s_add_u32 m0, s21, 0
    s_nop 0
    buffer_load_dwordx4 v1, s[4:7], s16 offen sc1 lds
    s_add_u32 s16, s16, s62
    s_add_u32 m0, s21, 1024
    s_nop 0
    buffer_load_dwordx4 v1, s[4:7], s17 offen sc1 lds
    s_add_u32 s17, s17, s62
    s_add_u32 m0, s22, 0
    s_nop 0
    buffer_load_dwordx4 v2, s[8:11], s18 offen lds
    s_add_u32 s18, s18, s20
    s_add_u32 m0, s22, 8192
    s_nop 0
    buffer_load_dwordx4 v2, s[12:15], s19 offen lds
    s_add_u32 s19, s19, s20
    s_add_u32 m0, s21, 32768
    s_nop 0
    buffer_load_dwordx4 v1, s[4:7], s16 offen sc1 lds
    s_add_u32 s16, s16, s62
    s_add_u32 m0, s21, 33792
    s_nop 0
    buffer_load_dwordx4 v1, s[4:7], s17 offen sc1 lds
    s_add_u32 s17, s17, s62
    s_add_u32 m0, s22, 32768
    s_nop 0
    buffer_load_dwordx4 v2, s[8:11], s18 offen lds
    s_add_u32 s18, s18, s20
    s_add_u32 m0, s22, 40960
    s_nop 0
    buffer_load_dwordx4 v2, s[12:15], s19 offen lds
    s_add_u32 s19, s19, s20
    s_add_u32 m0, s21, 65536
    s_nop 0
    buffer_load_dwordx4 v1, s[4:7], s16 offen sc1 lds
    s_add_u32 s16, s16, s62
    s_add_u32 m0, s21, 66560
    s_nop 0
    buffer_load_dwordx4 v1, s[4:7], s17 offen sc1 lds
    s_add_u32 s17, s17, s62
    s_add_u32 m0, s22, 65536
    s_nop 0
    buffer_load_dwordx4 v2, s[8:11], s18 offen lds
    s_add_u32 s18, s18, s20
    s_add_u32 m0, s22, 73728
    s_nop 0
    buffer_load_dwordx4 v2, s[12:15], s19 offen lds
    s_add_u32 s19, s19, s20
    s_add_u32 m0, s21, 98304
    s_nop 0
    buffer_load_dwordx4 v1, s[4:7], s16 offen sc1 lds
    s_add_u32 s16, s16, s62
    s_add_u32 m0, s21, 99328
    s_nop 0
    buffer_load_dwordx4 v1, s[4:7], s17 offen sc1 lds
    s_add_u32 s17, s17, s62
    s_add_u32 m0, s22, 98304
    s_nop 0
    buffer_load_dwordx4 v2, s[8:11], s18 offen lds
    s_add_u32 s18, s18, s20
    s_add_u32 m0, s22, 106496
    s_nop 0
    buffer_load_dwordx4 v2, s[12:15], s19 offen lds
    s_add_u32 s19, s19, s20
w_adopt:
    s_cmp_eq_u32 s98, 1
    s_cbranch_scc1 ln_entry
w_adopt2:
    s_mov_b32 s48, s32
    s_cmp_ge_u32 s32, 4
    s_cselect_b32 s30, 2, 3
    s_lshl_b32 s30, s26, s30
    s_mul_i32 s30, s30, s43
    s_add_u32 s49, s42, s30
    s_mov_b32 s50, s43
    s_mov_b32 s51, s46
    s_mov_b32 s23, s41
    s_mov_b32 s53, s47
    s_nop 0
    s_load_dwordx16 s[32:47], s[24:25], 0
    s_add_u32 s24, s24, 64
    s_addc_u32 s25, s25, 0
    s_cmp_eq_u32 s48, 6
    s_cbranch_scc1 w_firstX
    s_waitcnt vmcnt(0)
    s_barrier
    s_cmp_lg_u32 s98, 2
    s_cbranch_scc1 lls_done
    s_mov_b32 s98, 0
    s_cmp_lg_u32 s3, 0
    s_cbranch_scc1 lls_done
    v_mov_b32 v20, 1
    s_mov_b64 exec, 1
    buffer_atomic_add v20, off, s[64:67], 0 offset:0 sc1
    s_mov_b64 exec, -1
lls_done:
    ds_read_b64_tr_b16 v[64:65], v8 offset:16384
    ds_read_b64_tr_b16 v[66:67], v9 offset:16384
    ds_read_b64_tr_b16 v[68:69], v10 offset:16384
    ds_read_b64_tr_b16 v[70:71], v11 offset:16384
    ds_read_b64_tr_b16 v[72:73], v8 offset:24576
    ds_read_b64_tr_b16 v[74:75], v9 offset:24576
    ds_read_b64_tr_b16 v[76:77], v10 offset:24576
    ds_read_b64_tr_b16 v[78:79], v11 offset:24576
    ds_read_b128 v[32:35], v5 offset:0
    ds_read_b128 v[36:39], v5 offset:1024
    ds_read_b128 v[40:43], v5 offset:2048
    ds_read_b128 v[44:47], v5 offset:3072
    ds_read_b128 v[48:51], v5 offset:4096
    ds_read_b128 v[52:55], v5 offset:5120
    ds_read_b128 v[56:59], v5 offset:6144
    ds_read_b128 v[60:63], v5 offset:7168
    s_waitcnt lgkmcnt(0)
    s_cmp_eq_u32 s48, 4
    s_cbranch_scc1 w_firstH
    s_cmp_eq_u32 s48, 5
    s_cbranch_scc1 w_firstM
    s_branch w_first16
w_first4:
    s_waitcnt vmcnt(12)
    s_barrier
    v_mfma_f32_16x16x32_bf16 v[128:131], v[64:67], v[32:35], 0
    ds_read_b64_tr_b16 v[112:113], v8 offset:49152
    v_mfma_f32_16x16x32_bf16 v[132:135], v[68:71], v[32:35], 0
    ds_read_b64_tr_b16 v[114:115], v9 offset:49152
    v_mfma_f32_16x16x32_bf16 v[136:139], v[72:75], v[32:35], 0
    ds_read_b64_tr_b16 v[116:117], v10 offset:49152
    v_mfma_f32_16x16x32_bf16 v[140:143], v[76:79], v[32:35], 0
    ds_read_b64_tr_b16 v[118:119], v11 offset:49152
    v_mfma_f32_16x16x32_bf16 v[144:147], v[64:67], v[36:39], 0
    ds_read_b64_tr_b16 v[120:121], v8 offset:57344
    v_mfma_f32_16x16x32_bf16 v[148:151], v[68:71], v[36:39], 0
    ds_read_b64_tr_b16 v[122:123], v9 offset:57344
    v_mfma_f32_16x16x32_bf16 v[152:155], v[72:75], v[36:39], 0
    ds_read_b64_tr_b16 v[124:125], v10 offset:57344
    v_mfma_f32_16x16x32_bf16 v[156:159], v[76:79], v[36:39], 0
    ds_read_b64_tr_b16 v[126:127], v11 offset:57344
    v_mfma_f32_16x16x32_bf16 v[160:163], v[64:67], v[40:43], 0
    ds_read_b128 v[80:83], v5 offset:32768
    v_mfma_f32_16x16x32_bf16 v[164:167], v[68:71], v[40:43], 0
    ds_read_b128 v[84:87], v5 offset:33792
    v_mfma_f32_16x16x32_bf16 v[168:171], v[72:75], v[40:43], 0
    ds_read_b128 v[88:91], v5 offset:34816
    v_mfma_f32_16x16x32_bf16 v[172:175], v[76:79], v[40:43], 0
    ds_read_b128 v[92:95], v5 offset:35840
    v_mfma_f32_16x16x32_bf16 v[176:179], v[64:67], v[44:47], 0
    ds_read_b128 v[96:99], v5 offset:36864
    v_mfma_f32_16x16x32_bf16 v[180:183], v[68:71], v[44:47], 0
    ds_read_b128 v[100:103], v5 offset:37888
    v_mfma_f32_16x16x32_bf16 v[184:187], v[72:75], v[44:47], 0
    ds_read_b128 v[104:107], v5 offset:38912
    v_mfma_f32_16x16x32_bf16 v[188:191], v[76:79], v[44:47], 0
    ds_read_b128 v[108:111], v5 offset:39936
    v_mfma_f32_16x16x32_bf16 v[192:195], v[64:67], v[48:51], 0
    v_mfma_f32_16x16x32_bf16 v[196:199], v[68:71], v[48:51], 0
    s_add_u32 m0, s21, 0
    s_nop 0
    buffer_load_dwordx4 v1, s[4:7], s16 offen sc1 lds
    s_add_u32 s16, s16, s62
    v_mfma_f32_16x16x32_bf16 v[200:203], v[72:75], v[48:51], 0
    v_mfma_f32_16x16x32_bf16 v[204:207], v[76:79], v[48:51], 0
    v_mfma_f32_16x16x32_bf16 v[208:211], v[64:67], v[52:55], 0
    s_add_u32 m0, s21, 1024
    s_nop 0
    buffer_load_dwordx4 v1, s[4:7], s17 offen sc1 lds
    s_add_u32 s17, s17, s62
    v_mfma_f32_16x16x32_bf16 v[212:215], v[68:71], v[52:55], 0
    v_mfma_f32_16x16x32_bf16 v[216:219], v[72:75], v[52:55], 0
    v_mfma_f32_16x16x32_bf16 v[220:223], v[76:79], v[52:55], 0
    s_add_u32 m0, s22, 0
    s_nop 0
    buffer_load_dwordx4 v2, s[8:11], s18 offen lds
    s_add_u32 s18, s18, s20
    v_mfma_f32_16x16x32_bf16 v[224:227], v[64:67], v[56:59], 0
    v_mfma_f32_16x16x32_bf16 v[228:231], v[68:71], v[56:59], 0
    v_mfma_f32_16x16x32_bf16 v[232:235], v[72:75], v[56:59], 0
    s_add_u32 m0, s22, 8192
    s_nop 0
    buffer_load_dwordx4 v2, s[12:15], s19 offen lds
    s_add_u32 s19, s19, s20
    v_mfma_f32_16x16x32_bf16 v[236:239], v[76:79], v[56:59], 0
    v_mfma_f32_16x16x32_bf16 v[240:243], v[64:67], v[60:63], 0
    v_mfma_f32_16x16x32_bf16 v[244:247], v[68:71], v[60:63], 0
    v_mfma_f32_16x16x32_bf16 v[248:251], v[72:75], v[60:63], 0
    v_mfma_f32_16x16x32_bf16 v[252:255], v[76:79], v[60:63], 0
    s_waitcnt lgkmcnt(0)
    s_waitcnt vmcnt(12)
    s_barrier
    v_mfma_f32_16x16x32_bf16 v[128:131], v[112:115], v[80:83], v[128:131]
    ds_read_b64_tr_b16 v[64:65], v12 offset:16384
    v_mfma_f32_16x16x32_bf16 v[132:135], v[116:119], v[80:83], v[132:135]
    ds_read_b64_tr_b16 v[66:67], v13 offset:16384
    v_mfma_f32_16x16x32_bf16 v[136:139], v[120:123], v[80:83], v[136:139]
    ds_read_b64_tr_b16 v[68:69], v14 offset:16384
    v_mfma_f32_16x16x32_bf16 v[140:143], v[124:127], v[80:83], v[140:143]
    ds_read_b64_tr_b16 v[70:71], v15 offset:16384
    v_mfma_f32_16x16x32_bf16 v[144:147], v[112:115], v[84:87], v[144:147]
    ds_read_b64_tr_b16 v[72:73], v12 offset:24576
    v_mfma_f32_16x16x32_bf16 v[148:151], v[116:119], v[84:87], v[148:151]
    ds_read_b64_tr_b16 v[74:75], v13 offset:24576
    v_mfma_f32_16x16x32_bf16 v[152:155], v[120:123], v[84:87], v[152:155]
    ds_read_b64_tr_b16 v[76:77], v14 offset:24576
    v_mfma_f32_16x16x32_bf16 v[156:159], v[124:127], v[84:87], v[156:159]
    ds_read_b64_tr_b16 v[78:79], v15 offset:24576
    v_mfma_f32_16x16x32_bf16 v[160:163], v[112:115], v[88:91], v[160:163]
    ds_read_b128 v[32:35], v6 offset:0
    v_mfma_f32_16x16x32_bf16 v[164:167], v[116:119], v[88:91], v[164:167]
    ds_read_b128 v[36:39], v6 offset:1024
    v_mfma_f32_16x16x32_bf16 v[168:171], v[120:123], v[88:91], v[168:171]
    ds_read_b128 v[40:43], v6 offset:2048
    v_mfma_f32_16x16x32_bf16 v[172:175], v[124:127], v[88:91], v[172:175]
    ds_read_b128 v[44:47], v6 offset:3072
    v_mfma_f32_16x16x32_bf16 v[176:179], v[112:115], v[92:95], v[176:179]
    ds_read_b128 v[48:51], v6 offset:4096
    v_mfma_f32_16x16x32_bf16 v[180:183], v[116:119], v[92:95], v[180:183]
    ds_read_b128 v[52:55], v6 offset:5120
    v_mfma_f32_16x16x32_bf16 v[184:187], v[120:123], v[92:95], v[184:187]
    ds_read_b128 v[56:59], v6 offset:6144
    v_mfma_f32_16x16x32_bf16 v[188:191], v[124:127], v[92:95], v[188:191]
    ds_read_b128 v[60:63], v6 offset:7168
    v_mfma_f32_16x16x32_bf16 v[192:195], v[112:115], v[96:99], v[192:195]
    v_mfma_f32_16x16x32_bf16 v[196:199], v[116:119], v[96:99], v[196:199]
    s_add_u32 m0, s21, 32768
    s_nop 0
    buffer_load_dwordx4 v1, s[4:7], s16 offen sc1 lds
    s_add_u32 s16, s16, s62
    v_mfma_f32_16x16x32_bf16 v[200:203], v[120:123], v[96:99], v[200:203]
    v_mfma_f32_16x16x32_bf16 v[204:207], v[124:127], v[96:99], v[204:207]
    v_mfma_f32_16x16x32_bf16 v[208:211], v[112:115], v[100:103], v[208:211]
    s_add_u32 m0, s21, 33792
    s_nop 0
    buffer_load_dwordx4 v1, s[4:7], s17 offen sc1 lds
    s_add_u32 s17, s17, s62
    v_mfma_f32_16x16x32_bf16 v[212:215], v[116:119], v[100:103], v[212:215]
    v_mfma_f32_16x16x32_bf16 v[216:219], v[120:123], v[100:103], v[216:219]
    v_mfma_f32_16x16x32_bf16 v[220:223], v[124:127], v[100:103], v[220:223]
    s_add_u32 m0, s22, 32768
    s_nop 0
    buffer_load_dwordx4 v2, s[8:11], s18 offen lds
    s_add_u32 s18, s18, s20
    v_mfma_f32_16x16x32_bf16 v[224:227], v[112:115], v[104:107], v[224:227]
    v_mfma_f32_16x16x32_bf16 v[228:231], v[116:119], v[104:107], v[228:231]
    v_mfma_f32_16x16x32_bf16 v[232:235], v[120:123], v[104:107], v[232:235]
    s_add_u32 m0, s22, 40960
    s_nop 0
    buffer_load_dwordx4 v2, s[12:15], s19 offen lds
    s_add_u32 s19, s19, s20
    v_mfma_f32_16x16x32_bf16 v[236:239], v[124:127], v[104:107], v[236:239]
    v_mfma_f32_16x16x32_bf16 v[240:243], v[112:115], v[108:111], v[240:243]
    v_mfma_f32_16x16x32_bf16 v[244:247], v[116:119], v[108:111], v[244:247]
    v_mfma_f32_16x16x32_bf16 v[248:251], v[120:123], v[108:111], v[248:251]
    v_mfma_f32_16x16x32_bf16 v[252:255], v[124:127], v[108:111], v[252:255]
    s_waitcnt lgkmcnt(0)
    s_waitcnt vmcnt(12)
    s_barrier
    v_mfma_f32_16x16x32_bf16 v[128:131], v[64:67], v[32:35], v[128:131]
    ds_read_b64_tr_b16 v[112:113], v12 offset:49152
    v_mfma_f32_16x16x32_bf16 v[132:135], v[68:71], v[32:35], v[132:135]
    ds_read_b64_tr_b16 v[114:115], v13 offset:49152
    v_mfma_f32_16x16x32_bf16 v[136:139], v[72:75], v[32:35], v[136:139]
    ds_read_b64_tr_b16 v[116:117], v14 offset:49152
    v_mfma_f32_16x16x32_bf16 v[140:143], v[76:79], v[32:35], v[140:143]
    ds_read_b64_tr_b16 v[118:119], v15 offset:49152
    v_mfma_f32_16x16x32_bf16 v[144:147], v[64:67], v[36:39], v[144:147]
    ds_read_b64_tr_b16 v[120:121], v12 offset:57344
    v_mfma_f32_16x16x32_bf16 v[148:151], v[68:71], v[36:39], v[148:151]
    ds_read_b64_tr_b16 v[122:123], v13 offset:57344
    v_mfma_f32_16x16x32_bf16 v[152:155], v[72:75], v[36:39], v[152:155]
    ds_read_b64_tr_b16 v[124:125], v14 offset:57344
    v_mfma_f32_16x16x32_bf16 v[156:159], v[76:79], v[36:39], v[156:159]
    ds_read_b64_tr_b16 v[126:127], v15 offset:57344
    v_mfma_f32_16x16x32_bf16 v[160:163], v[64:67], v[40:43], v[160:163]
    ds_read_b128 v[80:83], v6 offset:32768
    v_mfma_f32_16x16x32_bf16 v[164:167], v[68:71], v[40:43], v[164:167]
    ds_read_b128 v[84:87], v6 offset:33792
    v_mfma_f32_16x16x32_bf16 v[168:171], v[72:75], v[40:43], v[168:171]
    ds_read_b128 v[88:91], v6 offset:34816
    v_mfma_f32_16x16x32_bf16 v[172:175], v[76:79], v[40:43], v[172:175]
    ds_read_b128 v[92:95], v6 offset:35840
    v_mfma_f32_16x16x32_bf16 v[176:179], v[64:67], v[44:47], v[176:179]
    ds_read_b128 v[96:99], v6 offset:36864
    v_mfma_f32_16x16x32_bf16 v[180:183], v[68:71], v[44:47], v[180:183]
    ds_read_b128 v[100:103], v6 offset:37888
    v_mfma_f32_16x16x32_bf16 v[184:187], v[72:75], v[44:47], v[184:187]
    ds_read_b128 v[104:107], v6 offset:38912
    v_mfma_f32_16x16x32_bf16 v[188:191], v[76:79], v[44:47], v[188:191]
    ds_read_b128 v[108:111], v6 offset:39936
    v_mfma_f32_16x16x32_bf16 v[192:195], v[64:67], v[48:51], v[192:195]
    v_mfma_f32_16x16x32_bf16 v[196:199], v[68:71], v[48:51], v[196:199]
    s_add_u32 m0, s21, 65536
    s_nop 0
    buffer_load_dwordx4 v1, s[4:7], s16 offen sc1 lds
    s_add_u32 s16, s16, s62
    v_mfma_f32_16x16x32_bf16 v[200:203], v[72:75], v[48:51], v[200:203]
    v_mfma_f32_16x16x32_bf16 v[204:207], v[76:79], v[48:51], v[204:207]
    v_mfma_f32_16x16x32_bf16 v[208:211], v[64:67], v[52:55], v[208:211]
    s_add_u32 m0, s21, 66560
    s_nop 0
    buffer_load_dwordx4 v1, s[4:7], s17 offen sc1 lds
    s_add_u32 s17, s17, s62
    v_mfma_f32_16x16x32_bf16 v[212:215], v[68:71], v[52:55], v[212:215]
    v_mfma_f32_16x16x32_bf16 v[216:219], v[72:75], v[52:55], v[216:219]
    v_mfma_f32_16x16x32_bf16 v[220:223], v[76:79], v[52:55], v[220:223]
    s_add_u32 m0, s22, 65536
    s_nop 0
    buffer_load_dwordx4 v2, s[8:11], s18 offen lds
    s_add_u32 s18, s18, s20
    v_mfma_f32_16x16x32_bf16 v[224:227], v[64:67], v[56:59], v[224:227]
    v_mfma_f32_16x16x32_bf16 v[228:231], v[68:71], v[56:59], v[228:231]
    v_mfma_f32_16x16x32_bf16 v[232:235], v[72:75], v[56:59], v[232:235]
    s_add_u32 m0, s22, 73728
    s_nop 0
    buffer_load_dwordx4 v2, s[12:15], s19 offen lds
    s_add_u32 s19, s19, s20
    v_mfma_f32_16x16x32_bf16 v[236:239], v[76:79], v[56:59], v[236:239]
    v_mfma_f32_16x16x32_bf16 v[240:243], v[64:67], v[60:63], v[240:243]
    v_mfma_f32_16x16x32_bf16 v[244:247], v[68:71], v[60:63], v[244:247]
    v_mfma_f32_16x16x32_bf16 v[248:251], v[72:75], v[60:63], v[248:251]
    v_mfma_f32_16x16x32_bf16 v[252:255], v[76:79], v[60:63], v[252:255]
    s_waitcnt lgkmcnt(0)
    s_waitcnt vmcnt(8)
    s_barrier
    s_cmp_eq_u32 s28, 0
    s_cbranch_scc1 sig_2
    s_cmp_lg_u32 s3, 0
    s_cbranch_scc1 sig_2
    s_mov_b64 exec, 1
    v_mov_b32 v18, s57
    buffer_atomic_add v18, v17, s[4:7], s28 offen sc1
    s_mov_b64 exec, -1
sig_2:
    s_mov_b32 s28, 0
    v_mfma_f32_16x16x32_bf16 v[128:131], v[112:115], v[80:83], v[128:131]
    ds_read_b64_tr_b16 v[64:65], v8 offset:16384
    v_mfma_f32_16x16x32_bf16 v[132:135], v[116:119], v[80:83], v[132:135]
    ds_read_b64_tr_b16 v[66:67], v9 offset:16384
    v_mfma_f32_16x16x32_bf16 v[136:139], v[120:123], v[80:83], v[136:139]
    ds_read_b64_tr_b16 v[68:69], v10 offset:16384
    v_mfma_f32_16x16x32_bf16 v[140:143], v[124:127], v[80:83], v[140:143]
    ds_read_b64_tr_b16 v[70:71], v11 offset:16384
    v_mfma_f32_16x16x32_bf16 v[144:147], v[112:115], v[84:87], v[144:147]
    ds_read_b64_tr_b16 v[72:73], v8 offset:24576
    v_mfma_f32_16x16x32_bf16 v[148:151], v[116:119], v[84:87], v[148:151]
    ds_read_b64_tr_b16 v[74:75], v9 offset:24576
    v_mfma_f32_16x16x32_bf16 v[152:155], v[120:123], v[84:87], v[152:155]
    ds_read_b64_tr_b16 v[76:77], v10 offset:24576
    v_mfma_f32_16x16x32_bf16 v[156:159], v[124:127], v[84:87], v[156:159]
    ds_read_b64_tr_b16 v[78:79], v11 offset:24576
    v_mfma_f32_16x16x32_bf16 v[160:163], v[112:115], v[88:91], v[160:163]
    ds_read_b128 v[32:35], v5 offset:0
    v_mfma_f32_16x16x32_bf16 v[164:167], v[116:119], v[88:91], v[164:167]
    ds_read_b128 v[36:39], v5 offset:1024
    v_mfma_f32_16x16x32_bf16 v[168:171], v[120:123], v[88:91], v[168:171]
    ds_read_b128 v[40:43], v5 offset:2048
    v_mfma_f32_16x16x32_bf16 v[172:175], v[124:127], v[88:91], v[172:175]
    ds_read_b128 v[44:47], v5 offset:3072
    v_mfma_f32_16x16x32_bf16 v[176:179], v[112:115], v[92:95], v[176:179]
    ds_read_b128 v[48:51], v5 offset:4096
    v_mfma_f32_16x16x32_bf16 v[180:183], v[116:119], v[92:95], v[180:183]
    ds_read_b128 v[52:55], v5 offset:5120
    v_mfma_f32_16x16x32_bf16 v[184:187], v[120:123], v[92:95], v[184:187]
    ds_read_b128 v[56:59], v5 offset:6144
    v_mfma_f32_16x16x32_bf16 v[188:191], v[124:127], v[92:95], v[188:191]
    ds_read_b128 v[60:63], v5 offset:7168
    v_mfma_f32_16x16x32_bf16 v[192:195], v[112:115], v[96:99], v[192:195]
    v_mfma_f32_16x16x32_bf16 v[196:199], v[116:119], v[96:99], v[196:199]
    s_add_u32 m0, s21, 98304
    s_nop 0
    buffer_load_dwordx4 v1, s[4:7], s16 offen sc1 lds
    s_add_u32 s16, s16, s62
    v_mfma_f32_16x16x32_bf16 v[200:203], v[120:123], v[96:99], v[200:203]
    v_mfma_f32_16x16x32_bf16 v[204:207], v[124:127], v[96:99], v[204:207]
    v_mfma_f32_16x16x32_bf16 v[208:211], v[112:115], v[100:103], v[208:211]
    s_add_u32 m0, s21, 99328
    s_nop 0
    buffer_load_dwordx4 v1, s[4:7], s17 offen sc1 lds
    s_add_u32 s17, s17, s62
    v_mfma_f32_16x16x32_bf16 v[212:215], v[116:119], v[100:103], v[212:215]
    v_mfma_f32_16x16x32_bf16 v[216:219], v[120:123], v[100:103], v[216:219]
    v_mfma_f32_16x16x32_bf16 v[220:223], v[124:127], v[100:103], v[220:223]
    s_add_u32 m0, s22, 98304
    s_nop 0
    buffer_load_dwordx4 v2, s[8:11], s18 offen lds
    s_add_u32 s18, s18, s20
    v_mfma_f32_16x16x32_bf16 v[224:227], v[112:115], v[104:107], v[224:227]
    v_mfma_f32_16x16x32_bf16 v[228:231], v[116:119], v[104:107], v[228:231]
    v_mfma_f32_16x16x32_bf16 v[232:235], v[120:123], v[104:107], v[232:235]
    s_add_u32 m0, s22, 106496
    s_nop 0
    buffer_load_dwordx4 v2, s[12:15], s19 offen lds
    s_add_u32 s19, s19, s20
    v_mfma_f32_16x16x32_bf16 v[236:239], v[124:127], v[104:107], v[236:239]
    v_mfma_f32_16x16x32_bf16 v[240:243], v[112:115], v[108:111], v[240:243]
    v_mfma_f32_16x16x32_bf16 v[244:247], v[116:119], v[108:111], v[244:247]
    v_mfma_f32_16x16x32_bf16 v[248:251], v[120:123], v[108:111], v[248:251]
    v_mfma_f32_16x16x32_bf16 v[252:255], v[124:127], v[108:111], v[252:255]
    s_waitcnt lgkmcnt(0)
    s_branch w_loop_chk
w_first8:
    s_waitcnt vmcnt(16)
    s_barrier
    v_mfma_f32_16x16x32_bf16 v[128:131], v[64:67], v[32:35], 0
    ds_read_b64_tr_b16 v[112:113], v8 offset:49152
    v_mfma_f32_16x16x32_bf16 v[132:135], v[68:71], v[32:35], 0
    ds_read_b64_tr_b16 v[114:115], v9 offset:49152
    v_mfma_f32_16x16x32_bf16 v[136:139], v[72:75], v[32:35], 0
    ds_read_b64_tr_b16 v[116:117], v10 offset:49152
    v_mfma_f32_16x16x32_bf16 v[140:143], v[76:79], v[32:35], 0
    ds_read_b64_tr_b16 v[118:119], v11 offset:49152
    v_mfma_f32_16x16x32_bf16 v[144:147], v[64:67], v[36:39], 0
    ds_read_b64_tr_b16 v[120:121], v8 offset:57344
    v_mfma_f32_16x16x32_bf16 v[148:151], v[68:71], v[36:39], 0
    ds_read_b64_tr_b16 v[122:123], v9 offset:57344
    v_mfma_f32_16x16x32_bf16 v[152:155], v[72:75], v[36:39], 0
    ds_read_b64_tr_b16 v[124:125], v10 offset:57344
    v_mfma_f32_16x16x32_bf16 v[156:159], v[76:79], v[36:39], 0
    ds_read_b64_tr_b16 v[126:127], v11 offset:57344
    v_mfma_f32_16x16x32_bf16 v[160:163], v[64:67], v[40:43], 0
    ds_read_b128 v[80:83], v5 offset:32768
    v_mfma_f32_16x16x32_bf16 v[164:167], v[68:71], v[40:43], 0
    ds_read_b128 v[84:87], v5 offset:33792
    v_mfma_f32_16x16x32_bf16 v[168:171], v[72:75], v[40:43], 0
    ds_read_b128 v[88:91], v5 offset:34816
    v_mfma_f32_16x16x32_bf16 v[172:175], v[76:79], v[40:43], 0
    ds_read_b128 v[92:95], v5 offset:35840
    v_mfma_f32_16x16x32_bf16 v[176:179], v[64:67], v[44:47], 0
    ds_read_b128 v[96:99], v5 offset:36864
    v_mfma_f32_16x16x32_bf16 v[180:183], v[68:71], v[44:47], 0
    ds_read_b128 v[100:103], v5 offset:37888
    v_mfma_f32_16x16x32_bf16 v[184:187], v[72:75], v[44:47], 0
    ds_read_b128 v[104:107], v5 offset:38912
    v_mfma_f32_16x16x32_bf16 v[188:191], v[76:79], v[44:47], 0
    ds_read_b128 v[108:111], v5 offset:39936
    v_mfma_f32_16x16x32_bf16 v[192:195], v[64:67], v[48:51], 0
    v_mfma_f32_16x16x32_bf16 v[196:199], v[68:71], v[48:51], 0
    s_add_u32 m0, s21, 0
    s_nop 0
    buffer_load_dwordx4 v1, s[4:7], s16 offen sc1 lds
    s_add_u32 s16, s16, s62
    v_mfma_f32_16x16x32_bf16 v[200:203], v[72:75], v[48:51], 0
    v_mfma_f32_16x16x32_bf16 v[204:207], v[76:79], v[48:51], 0
    v_mfma_f32_16x16x32_bf16 v[208:211], v[64:67], v[52:55], 0
    s_add_u32 m0, s21, 1024
    s_nop 0
    buffer_load_dwordx4 v1, s[4:7], s17 offen sc1 lds
    s_add_u32 s17, s17, s62
    v_mfma_f32_16x16x32_bf16 v[212:215], v[68:71], v[52:55], 0
    v_mfma_f32_16x16x32_bf16 v[216:219], v[72:75], v[52:55], 0
    v_mfma_f32_16x16x32_bf16 v[220:223], v[76:79], v[52:55], 0
    s_add_u32 m0, s22, 0
    s_nop 0
    buffer_load_dwordx4 v2, s[8:11], s18 offen lds
    s_add_u32 s18, s18, s20
    v_mfma_f32_16x16x32_bf16 v[224:227], v[64:67], v[56:59], 0
    v_mfma_f32_16x16x32_bf16 v[228:231], v[68:71], v[56:59], 0
    v_mfma_f32_16x16x32_bf16 v[232:235], v[72:75], v[56:59], 0
    s_add_u32 m0, s22, 8192
    s_nop 0
    buffer_load_dwordx4 v2, s[12:15], s19 offen lds
    s_add_u32 s19, s19, s20
    v_mfma_f32_16x16x32_bf16 v[236:239], v[76:79], v[56:59], 0
    v_mfma_f32_16x16x32_bf16 v[240:243], v[64:67], v[60:63], 0
    v_mfma_f32_16x16x32_bf16 v[244:247], v[68:71], v[60:63], 0
    v_mfma_f32_16x16x32_bf16 v[248:251], v[72:75], v[60:63], 0
    v_mfma_f32_16x16x32_bf16 v[252:255], v[76:79], v[60:63], 0
    s_waitcnt lgkmcnt(0)
    s_waitcnt vmcnt(16)
    s_barrier
    v_mfma_f32_16x16x32_bf16 v[128:131], v[112:115], v[80:83], v[128:131]
    ds_read_b64_tr_b16 v[64:65], v12 offset:16384
    v_mfma_f32_16x16x32_bf16 v[132:135], v[116:119], v[80:83], v[132:135]
    ds_read_b64_tr_b16 v[66:67], v13 offset:16384
    v_mfma_f32_16x16x32_bf16 v[136:139], v[120:123], v[80:83], v[136:139]
    ds_read_b64_tr_b16 v[68:69], v14 offset:16384
    v_mfma_f32_16x16x32_bf16 v[140:143], v[124:127], v[80:83], v[140:143]
    ds_read_b64_tr_b16 v[70:71], v15 offset:16384
    v_mfma_f32_16x16x32_bf16 v[144:147], v[112:115], v[84:87], v[144:147]
    ds_read_b64_tr_b16 v[72:73], v12 offset:24576
    v_mfma_f32_16x16x32_bf16 v[148:151], v[116:119], v[84:87], v[148:151]
    ds_read_b64_tr_b16 v[74:75], v13 offset:24576
    v_mfma_f32_16x16x32_bf16 v[152:155], v[120:123], v[84:87], v[152:155]
    ds_read_b64_tr_b16 v[76:77], v14 offset:24576
    v_mfma_f32_16x16x32_bf16 v[156:159], v[124:127], v[84:87], v[156:159]
    ds_read_b64_tr_b16 v[78:79], v15 offset:24576
    v_mfma_f32_16x16x32_bf16 v[160:163], v[112:115], v[88:91], v[160:163]
    ds_read_b128 v[32:35], v6 offset:0
    v_mfma_f32_16x16x32_bf16 v[164:167], v[116:119], v[88:91], v[164:167]
    ds_read_b128 v[36:39], v6 offset:1024
    v_mfma_f32_16x16x32_bf16 v[168:171], v[120:123], v[88:91], v[168:171]
    ds_read_b128 v[40:43], v6 offset:2048
    v_mfma_f32_16x16x32_bf16 v[172:175], v[124:127], v[88:91], v[172:175]
    ds_read_b128 v[44:47], v6 offset:3072
    v_mfma_f32_16x16x32_bf16 v[176:179], v[112:115], v[92:95], v[176:179]
    ds_read_b128 v[48:51], v6 offset:4096
    v_mfma_f32_16x16x32_bf16 v[180:183], v[116:119], v[92:95], v[180:183]
    ds_read_b128 v[52:55], v6 offset:5120
    v_mfma_f32_16x16x32_bf16 v[184:187], v[120:123], v[92:95], v[184:187]
    ds_read_b128 v[56:59], v6 offset:6144
    v_mfma_f32_16x16x32_bf16 v[188:191], v[124:127], v[92:95], v[188:191]
    ds_read_b128 v[60:63], v6 offset:7168
    v_mfma_f32_16x16x32_bf16 v[192:195], v[112:115], v[96:99], v[192:195]
    v_mfma_f32_16x16x32_bf16 v[196:199], v[116:119], v[96:99], v[196:199]
    s_add_u32 m0, s21, 32768
    s_nop 0
    buffer_load_dwordx4 v1, s[4:7], s16 offen sc1 lds
    s_add_u32 s16, s16, s62
    v_mfma_f32_16x16x32_bf16 v[200:203], v[120:123], v[96:99], v[200:203]
    v_mfma_f32_16x16x32_bf16 v[204:207], v[124:127], v[96:99], v[204:207]
    v_mfma_f32_16x16x32_bf16 v[208:211], v[112:115], v[100:103], v[208:211]
    s_add_u32 m0, s21, 33792
    s_nop 0
    buffer_load_dwordx4 v1, s[4:7], s17 offen sc1 lds
    s_add_u32 s17, s17, s62
    v_mfma_f32_16x16x32_bf16 v[212:215], v[116:119], v[100:103], v[212:215]
    v_mfma_f32_16x16x32_bf16 v[216:219], v[120:123], v[100:103], v[216:219]
    v_mfma_f32_16x16x32_bf16 v[220:223], v[124:127], v[100:103], v[220:223]
    s_add_u32 m0, s22, 32768
    s_nop 0
    buffer_load_dwordx4 v2, s[8:11], s18 offen lds
    s_add_u32 s18, s18, s20
    v_mfma_f32_16x16x32_bf16 v[224:227], v[112:115], v[104:107], v[224:227]
    v_mfma_f32_16x16x32_bf16 v[228:231], v[116:119], v[104:107], v[228:231]
    v_mfma_f32_16x16x32_bf16 v[232:235], v[120:123], v[104:107], v[232:235]
    s_add_u32 m0, s22, 40960
    s_nop 0
    buffer_load_dwordx4 v2, s[12:15], s19 offen lds
    s_add_u32 s19, s19, s20
    v_mfma_f32_16x16x32_bf16 v[236:239], v[124:127], v[104:107], v[236:239]
    v_mfma_f32_16x16x32_bf16 v[240:243], v[112:115], v[108:111], v[240:243]
    v_mfma_f32_16x16x32_bf16 v[244:247], v[116:119], v[108:111], v[244:247]
    v_mfma_f32_16x16x32_bf16 v[248:251], v[120:123], v[108:111], v[248:251]
    v_mfma_f32_16x16x32_bf16 v[252:255], v[124:127], v[108:111], v[252:255]
    s_waitcnt lgkmcnt(0)
    s_waitcnt vmcnt(16)
    s_barrier
    v_mfma_f32_16x16x32_bf16 v[128:131], v[64:67], v[32:35], v[128:131]
    ds_read_b64_tr_b16 v[112:113], v12 offset:49152
    v_mfma_f32_16x16x32_bf16 v[132:135], v[68:71], v[32:35], v[132:135]
    ds_read_b64_tr_b16 v[114:115], v13 offset:49152
    v_mfma_f32_16x16x32_bf16 v[136:139], v[72:75], v[32:35], v[136:139]
    ds_read_b64_tr_b16 v[116:117], v14 offset:49152
    v_mfma_f32_16x16x32_bf16 v[140:143], v[76:79], v[32:35], v[140:143]
    ds_read_b64_tr_b16 v[118:119], v15 offset:49152
    v_mfma_f32_16x16x32_bf16 v[144:147], v[64:67], v[36:39], v[144:147]
    ds_read_b64_tr_b16 v[120:121], v12 offset:57344
    v_mfma_f32_16x16x32_bf16 v[148:151], v[68:71], v[36:39], v[148:151]
    ds_read_b64_tr_b16 v[122:123], v13 offset:57344
    v_mfma_f32_16x16x32_bf16 v[152:155], v[72:75], v[36:39], v[152:155]
    ds_read_b64_tr_b16 v[124:125], v14 offset:57344
    v_mfma_f32_16x16x32_bf16 v[156:159], v[76:79], v[36:39], v[156:159]
    ds_read_b64_tr_b16 v[126:127], v15 offset:57344
    v_mfma_f32_16x16x32_bf16 v[160:163], v[64:67], v[40:43], v[160:163]
    ds_read_b128 v[80:83], v6 offset:32768
    v_mfma_f32_16x16x32_bf16 v[164:167], v[68:71], v[40:43], v[164:167]
    ds_read_b128 v[84:87], v6 offset:33792
    v_mfma_f32_16x16x32_bf16 v[168:171], v[72:75], v[40:43], v[168:171]
    ds_read_b128 v[88:91], v6 offset:34816
    v_mfma_f32_16x16x32_bf16 v[172:175], v[76:79], v[40:43], v[172:175]
    ds_read_b128 v[92:95], v6 offset:35840
    v_mfma_f32_16x16x32_bf16 v[176:179], v[64:67], v[44:47], v[176:179]
    ds_read_b128 v[96:99], v6 offset:36864
    v_mfma_f32_16x16x32_bf16 v[180:183], v[68:71], v[44:47], v[180:183]
    ds_read_b128 v[100:103], v6 offset:37888
    v_mfma_f32_16x16x32_bf16 v[184:187], v[72:75], v[44:47], v[184:187]
    ds_read_b128 v[104:107], v6 offset:38912
    v_mfma_f32_16x16x32_bf16 v[188:191], v[76:79], v[44:47], v[188:191]
    ds_read_b128 v[108:111], v6 offset:39936
    v_mfma_f32_16x16x32_bf16 v[192:195], v[64:67], v[48:51], v[192:195]
    v_mfma_f32_16x16x32_bf16 v[196:199], v[68:71], v[48:51], v[196:199]
    s_add_u32 m0, s21, 65536
    s_nop 0
    buffer_load_dwordx4 v1, s[4:7], s16 offen sc1 lds
    s_add_u32 s16, s16, s62
    v_mfma_f32_16x16x32_bf16 v[200:203], v[72:75], v[48:51], v[200:203]
    v_mfma_f32_16x16x32_bf16 v[204:207], v[76:79], v[48:51], v[204:207]
    v_mfma_f32_16x16x32_bf16 v[208:211], v[64:67], v[52:55], v[208:211]
    s_add_u32 m0, s21, 66560
    s_nop 0
    buffer_load_dwordx4 v1, s[4:7], s17 offen sc1 lds
    s_add_u32 s17, s17, s62
    v_mfma_f32_16x16x32_bf16 v[212:215], v[68:71], v[52:55], v[212:215]
    v_mfma_f32_16x16x32_bf16 v[216:219], v[72:75], v[52:55], v[216:219]
    v_mfma_f32_16x16x32_bf16 v[220:223], v[76:79], v[52:55], v[220:223]
    s_add_u32 m0, s22, 65536
    s_nop 0
    buffer_load_dwordx4 v2, s[8:11], s18 offen lds
    s_add_u32 s18, s18, s20
    v_mfma_f32_16x16x32_bf16 v[224:227], v[64:67], v[56:59], v[224:227]
    v_mfma_f32_16x16x32_bf16 v[228:231], v[68:71], v[56:59], v[228:231]
    v_mfma_f32_16x16x32_bf16 v[232:235], v[72:75], v[56:59], v[232:235]
    s_add_u32 m0, s22, 73728
    s_nop 0
    buffer_load_dwordx4 v2, s[12:15], s19 offen lds
    s_add_u32 s19, s19, s20
    v_mfma_f32_16x16x32_bf16 v[236:239], v[76:79], v[56:59], v[236:239]
    v_mfma_f32_16x16x32_bf16 v[240:243], v[64:67], v[60:63], v[240:243]
    v_mfma_f32_16x16x32_bf16 v[244:247], v[68:71], v[60:63], v[244:247]
    v_mfma_f32_16x16x32_bf16 v[248:251], v[72:75], v[60:63], v[248:251]
    v_mfma_f32_16x16x32_bf16 v[252:255], v[76:79], v[60:63], v[252:255]
    s_waitcnt lgkmcnt(0)
    s_waitcnt vmcnt(8)
    s_barrier
    s_cmp_eq_u32 s28, 0
    s_cbranch_scc1 sig_3
    s_cmp_lg_u32 s3, 0
    s_cbranch_scc1 sig_3
    s_mov_b64 exec, 1
    v_mov_b32 v18, s57
    buffer_atomic_add v18, v17, s[4:7], s28 offen sc1
    s_mov_b64 exec, -1
sig_3:
    s_mov_b32 s28, 0
    v_mfma_f32_16x16x32_bf16 v[128:131], v[112:115], v[80:83], v[128:131]
    ds_read_b64_tr_b16 v[64:65], v8 offset:16384
    v_mfma_f32_16x16x32_bf16 v[132:135], v[116:119], v[80:83], v[132:135]
    ds_read_b64_tr_b16 v[66:67], v9 offset:16384
    v_mfma_f32_16x16x32_bf16 v[136:139], v[120:123], v[80:83], v[136:139]
    ds_read_b64_tr_b16 v[68:69], v10 offset:16384
    v_mfma_f32_16x16x32_bf16 v[140:143], v[124:127], v[80:83], v[140:143]
    ds_read_b64_tr_b16 v[70:71], v11 offset:16384
    v_mfma_f32_16x16x32_bf16 v[144:147], v[112:115], v[84:87], v[144:147]
    ds_read_b64_tr_b16 v[72:73], v8 offset:24576
    v_mfma_f32_16x16x32_bf16 v[148:151], v[116:119], v[84:87], v[148:151]
    ds_read_b64_tr_b16 v[74:75], v9 offset:24576
    v_mfma_f32_16x16x32_bf16 v[152:155], v[120:123], v[84:87], v[152:155]
    ds_read_b64_tr_b16 v[76:77], v10 offset:24576
    v_mfma_f32_16x16x32_bf16 v[156:159], v[124:127], v[84:87], v[156:159]
    ds_read_b64_tr_b16 v[78:79], v11 offset:24576
    v_mfma_f32_16x16x32_bf16 v[160:163], v[112:115], v[88:91], v[160:163]
    ds_read_b128 v[32:35], v5 offset:0
    v_mfma_f32_16x16x32_bf16 v[164:167], v[116:119], v[88:91], v[164:167]
    ds_read_b128 v[36:39], v5 offset:1024
    v_mfma_f32_16x16x32_bf16 v[168:171], v[120:123], v[88:91], v[168:171]
    ds_read_b128 v[40:43], v5 offset:2048
    v_mfma_f32_16x16x32_bf16 v[172:175], v[124:127], v[88:91], v[172:175]
    ds_read_b128 v[44:47], v5 offset:3072
    v_mfma_f32_16x16x32_bf16 v[176:179], v[112:115], v[92:95], v[176:179]
    ds_read_b128 v[48:51], v5 offset:4096
    v_mfma_f32_16x16x32_bf16 v[180:183], v[116:119], v[92:95], v[180:183]
    ds_read_b128 v[52:55], v5 offset:5120
    v_mfma_f32_16x16x32_bf16 v[184:187], v[120:123], v[92:95], v[184:187]
    ds_read_b128 v[56:59], v5 offset:6144
    v_mfma_f32_16x16x32_bf16 v[188:191], v[124:127], v[92:95], v[188:191]
    ds_read_b128 v[60:63], v5 offset:7168
    v_mfma_f32_16x16x32_bf16 v[192:195], v[112:115], v[96:99], v[192:195]
    v_mfma_f32_16x16x32_bf16 v[196:199], v[116:119], v[96:99], v[196:199]
    s_add_u32 m0, s21, 98304
    s_nop 0
    buffer_load_dwordx4 v1, s[4:7], s16 offen sc1 lds
    s_add_u32 s16, s16, s62
    v_mfma_f32_16x16x32_bf16 v[200:203], v[120:123], v[96:99], v[200:203]
    v_mfma_f32_16x16x32_bf16 v[204:207], v[124:127], v[96:99], v[204:207]
    v_mfma_f32_16x16x32_bf16 v[208:211], v[112:115], v[100:103], v[208:211]
    s_add_u32 m0, s21, 99328
    s_nop 0
    buffer_load_dwordx4 v1, s[4:7], s17 offen sc1 lds
    s_add_u32 s17, s17, s62
    v_mfma_f32_16x16x32_bf16 v[212:215], v[116:119], v[100:103], v[212:215]
    v_mfma_f32_16x16x32_bf16 v[216:219], v[120:123], v[100:103], v[216:219]
    v_mfma_f32_16x16x32_bf16 v[220:223], v[124:127], v[100:103], v[220:223]
    s_add_u32 m0, s22, 98304
    s_nop 0
    buffer_load_dwordx4 v2, s[8:11], s18 offen lds
    s_add_u32 s18, s18, s20
    v_mfma_f32_16x16x32_bf16 v[224:227], v[112:115], v[104:107], v[224:227]
    v_mfma_f32_16x16x32_bf16 v[228:231], v[116:119], v[104:107], v[228:231]
    v_mfma_f32_16x16x32_bf16 v[232:235], v[120:123], v[104:107], v[232:235]
    s_add_u32 m0, s22, 106496
    s_nop 0
    buffer_load_dwordx4 v2, s[12:15], s19 offen lds
    s_add_u32 s19, s19, s20
    v_mfma_f32_16x16x32_bf16 v[236:239], v[124:127], v[104:107], v[236:239]
    v_mfma_f32_16x16x32_bf16 v[240:243], v[112:115], v[108:111], v[240:243]
    v_mfma_f32_16x16x32_bf16 v[244:247], v[116:119], v[108:111], v[244:247]
    v_mfma_f32_16x16x32_bf16 v[248:251], v[120:123], v[108:111], v[248:251]
    v_mfma_f32_16x16x32_bf16 v[252:255], v[124:127], v[108:111], v[252:255]
    s_waitcnt lgkmcnt(0)
    s_branch w_loop_chk
w_first16:
    s_waitcnt vmcnt(24)
    s_barrier
    v_mfma_f32_16x16x32_bf16 v[128:131], v[64:67], v[32:35], 0
    ds_read_b64_tr_b16 v[112:113], v8 offset:49152
    v_mfma_f32_16x16x32_bf16 v[132:135], v[68:71], v[32:35], 0
    ds_read_b64_tr_b16 v[114:115], v9 offset:49152
    v_mfma_f32_16x16x32_bf16 v[136:139], v[72:75], v[32:35], 0
    ds_read_b64_tr_b16 v[116:117], v10 offset:49152
    v_mfma_f32_16x16x32_bf16 v[140:143], v[76:79], v[32:35], 0
    ds_read_b64_tr_b16 v[118:119], v11 offset:49152
    v_mfma_f32_16x16x32_bf16 v[144:147], v[64:67], v[36:39], 0
    ds_read_b64_tr_b16 v[120:121], v8 offset:57344
    v_mfma_f32_16x16x32_bf16 v[148:151], v[68:71], v[36:39], 0
    ds_read_b64_tr_b16 v[122:123], v9 offset:57344
    v_mfma_f32_16x16x32_bf16 v[152:155], v[72:75], v[36:39], 0
    ds_read_b64_tr_b16 v[124:125], v10 offset:57344
    v_mfma_f32_16x16x32_bf16 v[156:159], v[76:79], v[36:39], 0
    ds_read_b64_tr_b16 v[126:127], v11 offset:57344
    v_mfma_f32_16x16x32_bf16 v[160:163], v[64:67], v[40:43], 0
    ds_read_b128 v[80:83], v5 offset:32768
    v_mfma_f32_16x16x32_bf16 v[164:167], v[68:71], v[40:43], 0
    ds_read_b128 v[84:87], v5 offset:33792
    v_mfma_f32_16x16x32_bf16 v[168:171], v[72:75], v[40:43], 0
    ds_read_b128 v[88:91], v5 offset:34816
    v_mfma_f32_16x16x32_bf16 v[172:175], v[76:79], v[40:43], 0
    ds_read_b128 v[92:95], v5 offset:35840
    v_mfma_f32_16x16x32_bf16 v[176:179], v[64:67], v[44:47], 0
    ds_read_b128 v[96:99], v5 offset:36864
    v_mfma_f32_16x16x32_bf16 v[180:183], v[68:71], v[44:47], 0
    ds_read_b128 v[100:103], v5 offset:37888
    v_mfma_f32_16x16x32_bf16 v[184:187], v[72:75], v[44:47], 0
    ds_read_b128 v[104:107], v5 offset:38912
    v_mfma_f32_16x16x32_bf16 v[188:191], v[76:79], v[44:47], 0
    ds_read_b128 v[108:111], v5 offset:39936
    v_mfma_f32_16x16x32_bf16 v[192:195], v[64:67], v[48:51], 0
    v_mfma_f32_16x16x32_bf16 v[196:199], v[68:71], v[48:51], 0
    s_add_u32 m0, s21, 0
    s_nop 0
    buffer_load_dwordx4 v1, s[4:7], s16 offen sc1 lds
    s_add_u32 s16, s16, s62
    v_mfma_f32_16x16x32_bf16 v[200:203], v[72:75], v[48:51], 0
    v_mfma_f32_16x16x32_bf16 v[204:207], v[76:79], v[48:51], 0
    v_mfma_f32_16x16x32_bf16 v[208:211], v[64:67], v[52:55], 0
    s_add_u32 m0, s21, 1024
    s_nop 0
    buffer_load_dwordx4 v1, s[4:7], s17 offen sc1 lds
    s_add_u32 s17, s17, s62
    v_mfma_f32_16x16x32_bf16 v[212:215], v[68:71], v[52:55], 0
    v_mfma_f32_16x16x32_bf16 v[216:219], v[72:75], v[52:55], 0
    v_mfma_f32_16x16x32_bf16 v[220:223], v[76:79], v[52:55], 0
    s_add_u32 m0, s22, 0
    s_nop 0
    buffer_load_dwordx4 v2, s[8:11], s18 offen lds
    s_add_u32 s18, s18, s20
    v_mfma_f32_16x16x32_bf16 v[224:227], v[64:67], v[56:59], 0
    v_mfma_f32_16x16x32_bf16 v[228:231], v[68:71], v[56:59], 0
    v_mfma_f32_16x16x32_bf16 v[232:235], v[72:75], v[56:59], 0
    s_add_u32 m0, s22, 8192
    s_nop 0
    buffer_load_dwordx4 v2, s[12:15], s19 offen lds
    s_add_u32 s19, s19, s20
    v_mfma_f32_16x16x32_bf16 v[236:239], v[76:79], v[56:59], 0
    v_mfma_f32_16x16x32_bf16 v[240:243], v[64:67], v[60:63], 0
    v_mfma_f32_16x16x32_bf16 v[244:247], v[68:71], v[60:63], 0
    v_mfma_f32_16x16x32_bf16 v[248:251], v[72:75], v[60:63], 0
    v_mfma_f32_16x16x32_bf16 v[252:255], v[76:79], v[60:63], 0
    s_waitcnt lgkmcnt(0)
    s_waitcnt vmcnt(24)
    s_barrier
    v_mfma_f32_16x16x32_bf16 v[128:131], v[112:115], v[80:83], v[128:131]
    ds_read_b64_tr_b16 v[64:65], v12 offset:16384
    v_mfma_f32_16x16x32_bf16 v[132:135], v[116:119], v[80:83], v[132:135]
    ds_read_b64_tr_b16 v[66:67], v13 offset:16384
    v_mfma_f32_16x16x32_bf16 v[136:139], v[120:123], v[80:83], v[136:139]
    ds_read_b64_tr_b16 v[68:69], v14 offset:16384
    v_mfma_f32_16x16x32_bf16 v[140:143], v[124:127], v[80:83], v[140:143]
    ds_read_b64_tr_b16 v[70:71], v15 offset:16384
    v_mfma_f32_16x16x32_bf16 v[144:147], v[112:115], v[84:87], v[144:147]
    ds_read_b64_tr_b16 v[72:73], v12 offset:24576
    v_mfma_f32_16x16x32_bf16 v[148:151], v[116:119], v[84:87], v[148:151]
    ds_read_b64_tr_b16 v[74:75], v13 offset:24576
    v_mfma_f32_16x16x32_bf16 v[152:155], v[120:123], v[84:87], v[152:155]
    ds_read_b64_tr_b16 v[76:77], v14 offset:24576
    v_mfma_f32_16x16x32_bf16 v[156:159], v[124:127], v[84:87], v[156:159]
    ds_read_b64_tr_b16 v[78:79], v15 offset:24576
    v_mfma_f32_16x16x32_bf16 v[160:163], v[112:115], v[88:91], v[160:163]
    ds_read_b128 v[32:35], v6 offset:0
    v_mfma_f32_16x16x32_bf16 v[164:167], v[116:119], v[88:91], v[164:167]
    ds_read_b128 v[36:39], v6 offset:1024
    v_mfma_f32_16x16x32_bf16 v[168:171], v[120:123], v[88:91], v[168:171]
    ds_read_b128 v[40:43], v6 offset:2048
    v_mfma_f32_16x16x32_bf16 v[172:175], v[124:127], v[88:91], v[172:175]
    ds_read_b128 v[44:47], v6 offset:3072
    v_mfma_f32_16x16x32_bf16 v[176:179], v[112:115], v[92:95], v[176:179]
    ds_read_b128 v[48:51], v6 offset:4096
    v_mfma_f32_16x16x32_bf16 v[180:183], v[116:119], v[92:95], v[180:183]
    ds_read_b128 v[52:55], v6 offset:5120
    v_mfma_f32_16x16x32_bf16 v[184:187], v[120:123], v[92:95], v[184:187]
    ds_read_b128 v[56:59], v6 offset:6144
    v_mfma_f32_16x16x32_bf16 v[188:191], v[124:127], v[92:95], v[188:191]
    ds_read_b128 v[60:63], v6 offset:7168
    v_mfma_f32_16x16x32_bf16 v[192:195], v[112:115], v[96:99], v[192:195]
    v_mfma_f32_16x16x32_bf16 v[196:199], v[116:119], v[96:99], v[196:199]
    s_add_u32 m0, s21, 32768
    s_nop 0
    buffer_load_dwordx4 v1, s[4:7], s16 offen sc1 lds
    s_add_u32 s16, s16, s62
    v_mfma_f32_16x16x32_bf16 v[200:203], v[120:123], v[96:99], v[200:203]
    v_mfma_f32_16x16x32_bf16 v[204:207], v[124:127], v[96:99], v[204:207]
    v_mfma_f32_16x16x32_bf16 v[208:211], v[112:115], v[100:103], v[208:211]
    s_add_u32 m0, s21, 33792
    s_nop 0
    buffer_load_dwordx4 v1, s[4:7], s17 offen sc1 lds
    s_add_u32 s17, s17, s62
    v_mfma_f32_16x16x32_bf16 v[212:215], v[116:119], v[100:103], v[212:215]
    v_mfma_f32_16x16x32_bf16 v[216:219], v[120:123], v[100:103], v[216:219]
    v_mfma_f32_16x16x32_bf16 v[220:223], v[124:127], v[100:103], v[220:223]
    s_add_u32 m0, s22, 32768
    s_nop 0
    buffer_load_dwordx4 v2, s[8:11], s18 offen lds
    s_add_u32 s18, s18, s20
    v_mfma_f32_16x16x32_bf16 v[224:227], v[112:115], v[104:107], v[224:227]
    v_mfma_f32_16x16x32_bf16 v[228:231], v[116:119], v[104:107], v[228:231]
    v_mfma_f32_16x16x32_bf16 v[232:235], v[120:123], v[104:107], v[232:235]
    s_add_u32 m0, s22, 40960
    s_nop 0
    buffer_load_dwordx4 v2, s[12:15], s19 offen lds
    s_add_u32 s19, s19, s20
    v_mfma_f32_16x16x32_bf16 v[236:239], v[124:127], v[104:107], v[236:239]
    v_mfma_f32_16x16x32_bf16 v[240:243], v[112:115], v[108:111], v[240:243]
    v_mfma_f32_16x16x32_bf16 v[244:247], v[116:119], v[108:111], v[244:247]
    v_mfma_f32_16x16x32_bf16 v[248:251], v[120:123], v[108:111], v[248:251]
    v_mfma_f32_16x16x32_bf16 v[252:255], v[124:127], v[108:111], v[252:255]
    s_waitcnt lgkmcnt(0)
    s_waitcnt vmcnt(24)
    s_barrier
    v_mfma_f32_16x16x32_bf16 v[128:131], v[64:67], v[32:35], v[128:131]
    ds_read_b64_tr_b16 v[112:113], v12 offset:49152
    v_mfma_f32_16x16x32_bf16 v[132:135], v[68:71], v[32:35], v[132:135]
    ds_read_b64_tr_b16 v[114:115], v13 offset:49152
    v_mfma_f32_16x16x32_bf16 v[136:139], v[72:75], v[32:35], v[136:139]
    ds_read_b64_tr_b16 v[116:117], v14 offset:49152
    v_mfma_f32_16x16x32_bf16 v[140:143], v[76:79], v[32:35], v[140:143]
    ds_read_b64_tr_b16 v[118:119], v15 offset:49152
    v_mfma_f32_16x16x32_bf16 v[144:147], v[64:67], v[36:39], v[144:147]
    ds_read_b64_tr_b16 v[120:121], v12 offset:57344
    v_mfma_f32_16x16x32_bf16 v[148:151], v[68:71], v[36:39], v[148:151]
    ds_read_b64_tr_b16 v[122:123], v13 offset:57344
    v_mfma_f32_16x16x32_bf16 v[152:155], v[72:75], v[36:39], v[152:155]
    ds_read_b64_tr_b16 v[124:125], v14 offset:57344
    v_mfma_f32_16x16x32_bf16 v[156:159], v[76:79], v[36:39], v[156:159]
    ds_read_b64_tr_b16 v[126:127], v15 offset:57344
    v_mfma_f32_16x16x32_bf16 v[160:163], v[64:67], v[40:43], v[160:163]
    ds_read_b128 v[80:83], v6 offset:32768
    v_mfma_f32_16x16x32_bf16 v[164:167], v[68:71], v[40:43], v[164:167]
    ds_read_b128 v[84:87], v6 offset:33792
    v_mfma_f32_16x16x32_bf16 v[168:171], v[72:75], v[40:43], v[168:171]
    ds_read_b128 v[88:91], v6 offset:34816
    v_mfma_f32_16x16x32_bf16 v[172:175], v[76:79], v[40:43], v[172:175]
    ds_read_b128 v[92:95], v6 offset:35840
    v_mfma_f32_16x16x32_bf16 v[176:179], v[64:67], v[44:47], v[176:179]
    ds_read_b128 v[96:99], v6 offset:36864
    v_mfma_f32_16x16x32_bf16 v[180:183], v[68:71], v[44:47], v[180:183]
    ds_read_b128 v[100:103], v6 offset:37888
    v_mfma_f32_16x16x32_bf16 v[184:187], v[72:75], v[44:47], v[184:187]
    ds_read_b128 v[104:107], v6 offset:38912
    v_mfma_f32_16x16x32_bf16 v[188:191], v[76:79], v[44:47], v[188:191]
    ds_read_b128 v[108:111], v6 offset:39936
    v_mfma_f32_16x16x32_bf16 v[192:195], v[64:67], v[48:51], v[192:195]
    v_mfma_f32_16x16x32_bf16 v[196:199], v[68:71], v[48:51], v[196:199]
    s_add_u32 m0, s21, 65536
    s_nop 0
    buffer_load_dwordx4 v1, s[4:7], s16 offen sc1 lds
    s_add_u32 s16, s16, s62
    v_mfma_f32_16x16x32_bf16 v[200:203], v[72:75], v[48:51], v[200:203]
    v_mfma_f32_16x16x32_bf16 v[204:207], v[76:79], v[48:51], v[204:207]
    v_mfma_f32_16x16x32_bf16 v[208:211], v[64:67], v[52:55], v[208:211]
    s_add_u32 m0, s21, 66560
    s_nop 0
    buffer_load_dwordx4 v1, s[4:7], s17 offen sc1 lds
    s_add_u32 s17, s17, s62
    v_mfma_f32_16x16x32_bf16 v[212:215], v[68:71], v[52:55], v[212:215]
    v_mfma_f32_16x16x32_bf16 v[216:219], v[72:75], v[52:55], v[216:219]
    v_mfma_f32_16x16x32_bf16 v[220:223], v[76:79], v[52:55], v[220:223]
    s_add_u32 m0, s22, 65536
    s_nop 0
    buffer_load_dwordx4 v2, s[8:11], s18 offen lds
    s_add_u32 s18, s18, s20
    v_mfma_f32_16x16x32_bf16 v[224:227], v[64:67], v[56:59], v[224:227]
    v_mfma_f32_16x16x32_bf16 v[228:231], v[68:71], v[56:59], v[228:231]
    v_mfma_f32_16x16x32_bf16 v[232:235], v[72:75], v[56:59], v[232:235]
    s_add_u32 m0, s22, 73728
    s_nop 0
    buffer_load_dwordx4 v2, s[12:15], s19 offen lds
    s_add_u32 s19, s19, s20
    v_mfma_f32_16x16x32_bf16 v[236:239], v[76:79], v[56:59], v[236:239]
    v_mfma_f32_16x16x32_bf16 v[240:243], v[64:67], v[60:63], v[240:243]
    v_mfma_f32_16x16x32_bf16 v[244:247], v[68:71], v[60:63], v[244:247]
    v_mfma_f32_16x16x32_bf16 v[248:251], v[72:75], v[60:63], v[248:251]
    v_mfma_f32_16x16x32_bf16 v[252:255], v[76:79], v[60:63], v[252:255]
    s_waitcnt lgkmcnt(0)
    s_waitcnt vmcnt(8)
    s_barrier
    s_cmp_eq_u32 s28, 0
    s_cbranch_scc1 sig_4
    s_cmp_lg_u32 s3, 0
    s_cbranch_scc1 sig_4
    s_mov_b64 exec, 1
    v_mov_b32 v18, s57
    buffer_atomic_add v18, v17, s[4:7], s28 offen sc1
    s_mov_b64 exec, -1
sig_4:
    s_mov_b32 s28, 0
    v_mfma_f32_16x16x32_bf16 v[128:131], v[112:115], v[80:83], v[128:131]
    ds_read_b64_tr_b16 v[64:65], v8 offset:16384
    v_mfma_f32_16x16x32_bf16 v[132:135], v[116:119], v[80:83], v[132:135]
    ds_read_b64_tr_b16 v[66:67], v9 offset:16384
    v_mfma_f32_16x16x32_bf16 v[136:139], v[120:123], v[80:83], v[136:139]
    ds_read_b64_tr_b16 v[68:69], v10 offset:16384
    v_mfma_f32_16x16x32_bf16 v[140:143], v[124:127], v[80:83], v[140:143]
    ds_read_b64_tr_b16 v[70:71], v11 offset:16384
    v_mfma_f32_16x16x32_bf16 v[144:147], v[112:115], v[84:87], v[144:147]
    ds_read_b64_tr_b16 v[72:73], v8 offset:24576
    v_mfma_f32_16x16x32_bf16 v[148:151], v[116:119], v[84:87], v[148:151]
    ds_read_b64_tr_b16 v[74:75], v9 offset:24576
    v_mfma_f32_16x16x32_bf16 v[152:155], v[120:123], v[84:87], v[152:155]
    ds_read_b64_tr_b16 v[76:77], v10 offset:24576
    v_mfma_f32_16x16x32_bf16 v[156:159], v[124:127], v[84:87], v[156:159]
    ds_read_b64_tr_b16 v[78:79], v11 offset:24576
    v_mfma_f32_16x16x32_bf16 v[160:163], v[112:115], v[88:91], v[160:163]
    ds_read_b128 v[32:35], v5 offset:0
    v_mfma_f32_16x16x32_bf16 v[164:167], v[116:119], v[88:91], v[164:167]
    ds_read_b128 v[36:39], v5 offset:1024
    v_mfma_f32_16x16x32_bf16 v[168:171], v[120:123], v[88:91], v[168:171]
    ds_read_b128 v[40:43], v5 offset:2048
    v_mfma_f32_16x16x32_bf16 v[172:175], v[124:127], v[88:91], v[172:175]
    ds_read_b128 v[44:47], v5 offset:3072
    v_mfma_f32_16x16x32_bf16 v[176:179], v[112:115], v[92:95], v[176:179]
    ds_read_b128 v[48:51], v5 offset:4096
    v_mfma_f32_16x16x32_bf16 v[180:183], v[116:119], v[92:95], v[180:183]
    ds_read_b128 v[52:55], v5 offset:5120
    v_mfma_f32_16x16x32_bf16 v[184:187], v[120:123], v[92:95], v[184:187]
    ds_read_b128 v[56:59], v5 offset:6144
    v_mfma_f32_16x16x32_bf16 v[188:191], v[124:127], v[92:95], v[188:191]
    ds_read_b128 v[60:63], v5 offset:7168
    v_mfma_f32_16x16x32_bf16 v[192:195], v[112:115], v[96:99], v[192:195]
    v_mfma_f32_16x16x32_bf16 v[196:199], v[116:119], v[96:99], v[196:199]
    s_add_u32 m0, s21, 98304
    s_nop 0
    buffer_load_dwordx4 v1, s[4:7], s16 offen sc1 lds
    s_add_u32 s16, s16, s62
    v_mfma_f32_16x16x32_bf16 v[200:203], v[120:123], v[96:99], v[200:203]
    v_mfma_f32_16x16x32_bf16 v[204:207], v[124:127], v[96:99], v[204:207]
    v_mfma_f32_16x16x32_bf16 v[208:211], v[112:115], v[100:103], v[208:211]
    s_add_u32 m0, s21, 99328
    s_nop 0
    buffer_load_dwordx4 v1, s[4:7], s17 offen sc1 lds
    s_add_u32 s17, s17, s62
    v_mfma_f32_16x16x32_bf16 v[212:215], v[116:119], v[100:103], v[212:215]
    v_mfma_f32_16x16x32_bf16 v[216:219], v[120:123], v[100:103], v[216:219]
    v_mfma_f32_16x16x32_bf16 v[220:223], v[124:127], v[100:103], v[220:223]
    s_add_u32 m0, s22, 98304
    s_nop 0
    buffer_load_dwordx4 v2, s[8:11], s18 offen lds
    s_add_u32 s18, s18, s20
    v_mfma_f32_16x16x32_bf16 v[224:227], v[112:115], v[104:107], v[224:227]
    v_mfma_f32_16x16x32_bf16 v[228:231], v[116:119], v[104:107], v[228:231]
    v_mfma_f32_16x16x32_bf16 v[232:235], v[120:123], v[104:107], v[232:235]
    s_add_u32 m0, s22, 106496
    s_nop 0
    buffer_load_dwordx4 v2, s[12:15], s19 offen lds
    s_add_u32 s19, s19, s20
    v_mfma_f32_16x16x32_bf16 v[236:239], v[124:127], v[104:107], v[236:239]
    v_mfma_f32_16x16x32_bf16 v[240:243], v[112:115], v[108:111], v[240:243]
    v_mfma_f32_16x16x32_bf16 v[244:247], v[116:119], v[108:111], v[244:247]
    v_mfma_f32_16x16x32_bf16 v[248:251], v[120:123], v[108:111], v[248:251]
    v_mfma_f32_16x16x32_bf16 v[252:255], v[124:127], v[108:111], v[252:255]
    s_waitcnt lgkmcnt(0)
w_loop_chk:
    s_sub_u32 s23, s23, 1
w_loop:
    s_cmp_lg_u32 s23, 1
    s_cbranch_scc1 w_body
    v_readfirstlane_b32 s30, v16
    s_cmp_ge_u32 s30, s45
    s_cselect_b32 s30, 0, 1
    s_or_b32 s30, s30, s70
    s_cmp_ge_u32 s32, 4
    s_cselect_b32 s30, 1, s30
    s_cmp_eq_u32 s32, 0
    s_cselect_b32 s30, 1, s30
    v_mov_b32 v20, s30
    ds_write_b32 v7, v20
    s_cbranch_scc1 w_nd
    s_cmp_ge_u32 s32, 4
    s_cbranch_scc1 w_nd
    s_cmp_lg_u32 s70, 0
    s_cbranch_scc1 w_nd
    s_load_dwordx2 s[8:9], s[0:1], s33
    s_load_dwordx2 s[12:13], s[0:1], s34
    s_mov_b32 s10, s38
    s_mov_b32 s14, s38
    s_cmp_ge_u32 s32, 4
    s_cselect_b32 s31, 0, 1
    s_lshl_b32 s30, s3, s31
    s_mul_i32 s30, s30, s40
    s_add_u32 s16, s39, s30
    s_cmp_eq_u32 s32, 4
    s_cselect_b32 s30, 1024, s40
    s_cselect_b32 s31, 6, 5
    s_lshl_b32 s62, 32, s31
    s_add_u32 s17, s16, s30
    s_lshl_b32 s30, s3, 2
    s_mul_i32 s30, s30, s35
    s_add_u32 s18, s36, s30
    s_add_u32 s19, s37, s30
    s_lshl_b32 s20, s35, s31
    v_mul_u32_u24 v2, s35, v4
    v_add_u32 v2, v2, v3
    s_waitcnt lgkmcnt(0)
w_body:
    s_waitcnt vmcnt(8)
    s_barrier
    v_mfma_f32_16x16x32_bf16 v[128:131], v[64:67], v[32:35], v[128:131]
    ds_read_b64_tr_b16 v[112:113], v8 offset:49152
    v_mfma_f32_16x16x32_bf16 v[132:135], v[68:71], v[32:35], v[132:135]
    ds_read_b64_tr_b16 v[114:115], v9 offset:49152
    v_mfma_f32_16x16x32_bf16 v[136:139], v[72:75], v[32:35], v[136:139]
    ds_read_b64_tr_b16 v[116:117], v10 offset:49152
    v_mfma_f32_16x16x32_bf16 v[140:143], v[76:79], v[32:35], v[140:143]
    ds_read_b64_tr_b16 v[118:119], v11 offset:49152
    v_mfma_f32_16x16x32_bf16 v[144:147], v[64:67], v[36:39], v[144:147]
    ds_read_b64_tr_b16 v[120:121], v8 offset:57344
    v_mfma_f32_16x16x32_bf16 v[148:151], v[68:71], v[36:39], v[148:151]
    ds_read_b64_tr_b16 v[122:123], v9 offset:57344
    v_mfma_f32_16x16x32_bf16 v[152:155], v[72:75], v[36:39], v[152:155]
    ds_read_b64_tr_b16 v[124:125], v10 offset:57344
    v_mfma_f32_16x16x32_bf16 v[156:159], v[76:79], v[36:39], v[156:159]
    ds_read_b64_tr_b16 v[126:127], v11 offset:57344
    v_mfma_f32_16x16x32_bf16 v[160:163], v[64:67], v[40:43], v[160:163]
    ds_read_b128 v[80:83], v5 offset:32768
    v_mfma_f32_16x16x32_bf16 v[164:167], v[68:71], v[40:43], v[164:167]
    ds_read_b128 v[84:87], v5 offset:33792
    v_mfma_f32_16x16x32_bf16 v[168:171], v[72:75], v[40:43], v[168:171]
    ds_read_b128 v[88:91], v5 offset:34816
    v_mfma_f32_16x16x32_bf16 v[172:175], v[76:79], v[40:43], v[172:175]
    ds_read_b128 v[92:95], v5 offset:35840
    v_mfma_f32_16x16x32_bf16 v[176:179], v[64:67], v[44:47], v[176:179]
    ds_read_b128 v[96:99], v5 offset:36864
    v_mfma_f32_16x16x32_bf16 v[180:183], v[68:71], v[44:47], v[180:183]
    ds_read_b128 v[100:103], v5 offset:37888
    v_mfma_f32_16x16x32_bf16 v[184:187], v[72:75], v[44:47], v[184:187]
    ds_read_b128 v[104:107], v5 offset:38912
    v_mfma_f32_16x16x32_bf16 v[188:191], v[76:79], v[44:47], v[188:191]
    ds_read_b128 v[108:111], v5 offset:39936
    v_mfma_f32_16x16x32_bf16 v[192:195], v[64:67], v[48:51], v[192:195]
    v_mfma_f32_16x16x32_bf16 v[196:199], v[68:71], v[48:51], v[196:199]
    s_add_u32 m0, s21, 0
    s_nop 0
    buffer_load_dwordx4 v1, s[4:7], s16 offen sc1 lds
    s_add_u32 s16, s16, s62
    v_mfma_f32_16x16x32_bf16 v[200:203], v[72:75], v[48:51], v[200:203]
    v_mfma_f32_16x16x32_bf16 v[204:207], v[76:79], v[48:51], v[204:207]
    v_mfma_f32_16x16x32_bf16 v[208:211], v[64:67], v[52:55], v[208:211]
    s_add_u32 m0, s21, 1024
    s_nop 0
    buffer_load_dwordx4 v1, s[4:7], s17 offen sc1 lds
    s_add_u32 s17, s17, s62
    v_mfma_f32_16x16x32_bf16 v[212:215], v[68:71], v[52:55], v[212:215]
    v_mfma_f32_16x16x32_bf16 v[216:219], v[72:75], v[52:55], v[216:219]
    v_mfma_f32_16x16x32_bf16 v[220:223], v[76:79], v[52:55], v[220:223]
    s_add_u32 m0, s22, 0
    s_nop 0
    buffer_load_dwordx4 v2, s[8:11], s18 offen lds
    s_add_u32 s18, s18, s20
    v_mfma_f32_16x16x32_bf16 v[224:227], v[64:67], v[56:59], v[224:227]
    v_mfma_f32_16x16x32_bf16 v[228:231], v[68:71], v[56:59], v[228:231]
    v_mfma_f32_16x16x32_bf16 v[232:235], v[72:75], v[56:59], v[232:235]
    s_add_u32 m0, s22, 8192
    s_nop 0
    buffer_load_dwordx4 v2, s[12:15], s19 offen lds
    s_add_u32 s19, s19, s20
    v_mfma_f32_16x16x32_bf16 v[236:239], v[76:79], v[56:59], v[236:239]
    v_mfma_f32_16x16x32_bf16 v[240:243], v[64:67], v[60:63], v[240:243]
    v_mfma_f32_16x16x32_bf16 v[244:247], v[68:71], v[60:63], v[244:247]
    buffer_load_dword v16, v17, s[4:7], s44 offen sc1
    v_mfma_f32_16x16x32_bf16 v[248:251], v[72:75], v[60:63], v[248:251]
    v_mfma_f32_16x16x32_bf16 v[252:255], v[76:79], v[60:63], v[252:255]
    s_waitcnt lgkmcnt(0)
    s_waitcnt vmcnt(8)
    s_barrier
    v_mfma_f32_16x16x32_bf16 v[128:131], v[112:115], v[80:83], v[128:131]
    ds_read_b64_tr_b16 v[64:65], v12 offset:16384
    v_mfma_f32_16x16x32_bf16 v[132:135], v[116:119], v[80:83], v[132:135]
    ds_read_b64_tr_b16 v[66:67], v13 offset:16384
    v_mfma_f32_16x16x32_bf16 v[136:139], v[120:123], v[80:83], v[136:139]
    ds_read_b64_tr_b16 v[68:69], v14 offset:16384
    v_mfma_f32_16x16x32_bf16 v[140:143], v[124:127], v[80:83], v[140:143]
    ds_read_b64_tr_b16 v[70:71], v15 offset:16384
    v_mfma_f32_16x16x32_bf16 v[144:147], v[112:115], v[84:87], v[144:147]
    ds_read_b64_tr_b16 v[72:73], v12 offset:24576
    v_mfma_f32_16x16x32_bf16 v[148:151], v[116:119], v[84:87], v[148:151]
    ds_read_b64_tr_b16 v[74:75], v13 offset:24576
    v_mfma_f32_16x16x32_bf16 v[152:155], v[120:123], v[84:87], v[152:155]
    ds_read_b64_tr_b16 v[76:77], v14 offset:24576
    v_mfma_f32_16x16x32_bf16 v[156:159], v[124:127], v[84:87], v[156:159]
    ds_read_b64_tr_b16 v[78:79], v15 offset:24576
    v_mfma_f32_16x16x32_bf16 v[160:163], v[112:115], v[88:91], v[160:163]
    ds_read_b128 v[32:35], v6 offset:0
    v_mfma_f32_16x16x32_bf16 v[164:167], v[116:119], v[88:91], v[164:167]
    ds_read_b128 v[36:39], v6 offset:1024
    v_mfma_f32_16x16x32_bf16 v[168:171], v[120:123], v[88:91], v[168:171]
    ds_read_b128 v[40:43], v6 offset:2048
    v_mfma_f32_16x16x32_bf16 v[172:175], v[124:127], v[88:91], v[172:175]
    ds_read_b128 v[44:47], v6 offset:3072
    v_mfma_f32_16x16x32_bf16 v[176:179], v[112:115], v[92:95], v[176:179]
    ds_read_b128 v[48:51], v6 offset:4096
    v_mfma_f32_16x16x32_bf16 v[180:183], v[116:119], v[92:95], v[180:183]
    ds_read_b128 v[52:55], v6 offset:5120
    v_mfma_f32_16x16x32_bf16 v[184:187], v[120:123], v[92:95], v[184:187]
    ds_read_b128 v[56:59], v6 offset:6144
    v_mfma_f32_16x16x32_bf16 v[188:191], v[124:127], v[92:95], v[188:191]
    ds_read_b128 v[60:63], v6 offset:7168
    v_mfma_f32_16x16x32_bf16 v[192:195], v[112:115], v[96:99], v[192:195]
    v_mfma_f32_16x16x32_bf16 v[196:199], v[116:119], v[96:99], v[196:199]
    s_add_u32 m0, s21, 32768
    s_nop 0
    buffer_load_dwordx4 v1, s[4:7], s16 offen sc1 lds
    s_add_u32 s16, s16, s62
    v_mfma_f32_16x16x32_bf16 v[200:203], v[120:123], v[96:99], v[200:203]
    v_mfma_f32_16x16x32_bf16 v[204:207], v[124:127], v[96:99], v[204:207]
    v_mfma_f32_16x16x32_bf16 v[208:211], v[112:115], v[100:103], v[208:211]
    s_add_u32 m0, s21, 33792
    s_nop 0
    buffer_load_dwordx4 v1, s[4:7], s17 offen sc1 lds
    s_add_u32 s17, s17, s62
    v_mfma_f32_16x16x32_bf16 v[212:215], v[116:119], v[100:103], v[212:215]
    v_mfma_f32_16x16x32_bf16 v[216:219], v[120:123], v[100:103], v[216:219]
    v_mfma_f32_16x16x32_bf16 v[220:223], v[124:127], v[100:103], v[220:223]
    s_add_u32 m0, s22, 32768
    s_nop 0
    buffer_load_dwordx4 v2, s[8:11], s18 offen lds
    s_add_u32 s18, s18, s20
    v_mfma_f32_16x16x32_bf16 v[224:227], v[112:115], v[104:107], v[224:227]
    v_mfma_f32_16x16x32_bf16 v[228:231], v[116:119], v[104:107], v[228:231]
    v_mfma_f32_16x16x32_bf16 v[232:235], v[120:123], v[104:107], v[232:235]
    s_add_u32 m0, s22, 40960
    s_nop 0
    buffer_load_dwordx4 v2, s[12:15], s19 offen lds
    s_add_u32 s19, s19, s20
    v_mfma_f32_16x16x32_bf16 v[236:239], v[124:127], v[104:107], v[236:239]
    v_mfma_f32_16x16x32_bf16 v[240:243], v[112:115], v[108:111], v[240:243]
    v_mfma_f32_16x16x32_bf16 v[244:247], v[116:119], v[108:111], v[244:247]
    v_mfma_f32_16x16x32_bf16 v[248:251], v[120:123], v[108:111], v[248:251]
    v_mfma_f32_16x16x32_bf16 v[252:255], v[124:127], v[108:111], v[252:255]
    s_waitcnt lgkmcnt(0)
    s_waitcnt vmcnt(8)
    s_barrier
    v_mfma_f32_16x16x32_bf16 v[128:131], v[64:67], v[32:35], v[128:131]
    ds_read_b64_tr_b16 v[112:113], v12 offset:49152
    v_mfma_f32_16x16x32_bf16 v[132:135], v[68:71], v[32:35], v[132:135]
    ds_read_b64_tr_b16 v[114:115], v13 offset:49152
    v_mfma_f32_16x16x32_bf16 v[136:139], v[72:75], v[32:35], v[136:139]
    ds_read_b64_tr_b16 v[116:117], v14 offset:49152
    v_mfma_f32_16x16x32_bf16 v[140:143], v[76:79], v[32:35], v[140:143]
    ds_read_b64_tr_b16 v[118:119], v15 offset:49152
    v_mfma_f32_16x16x32_bf16 v[144:147], v[64:67], v[36:39], v[144:147]
    ds_read_b64_tr_b16 v[120:121], v12 offset:57344
    v_mfma_f32_16x16x32_bf16 v[148:151], v[68:71], v[36:39], v[148:151]
    ds_read_b64_tr_b16 v[122:123], v13 offset:57344
    v_mfma_f32_16x16x32_bf16 v[152:155], v[72:75], v[36:39], v[152:155]
    ds_read_b64_tr_b16 v[124:125], v14 offset:57344
    v_mfma_f32_16x16x32_bf16 v[156:159], v[76:79], v[36:39], v[156:159]
    ds_read_b64_tr_b16 v[126:127], v15 offset:57344
    v_mfma_f32_16x16x32_bf16 v[160:163], v[64:67], v[40:43], v[160:163]
    ds_read_b128 v[80:83], v6 offset:32768
    v_mfma_f32_16x16x32_bf16 v[164:167], v[68:71], v[40:43], v[164:167]
    ds_read_b128 v[84:87], v6 offset:33792
    v_mfma_f32_16x16x32_bf16 v[168:171], v[72:75], v[40:43], v[168:171]
    ds_read_b128 v[88:91], v6 offset:34816
    v_mfma_f32_16x16x32_bf16 v[172:175], v[76:79], v[40:43], v[172:175]
    ds_read_b128 v[92:95], v6 offset:35840
    v_mfma_f32_16x16x32_bf16 v[176:179], v[64:67], v[44:47], v[176:179]
    ds_read_b128 v[96:99], v6 offset:36864
    v_mfma_f32_16x16x32_bf16 v[180:183], v[68:71], v[44:47], v[180:183]
    ds_read_b128 v[100:103], v6 offset:37888
    v_mfma_f32_16x16x32_bf16 v[184:187], v[72:75], v[44:47], v[184:187]
    ds_read_b128 v[104:107], v6 offset:38912
    v_mfma_f32_16x16x32_bf16 v[188:191], v[76:79], v[44:47], v[188:191]
    ds_read_b128 v[108:111], v6 offset:39936
    v_mfma_f32_16x16x32_bf16 v[192:195], v[64:67], v[48:51], v[192:195]
    v_mfma_f32_16x16x32_bf16 v[196:199], v[68:71], v[48:51], v[196:199]
    s_add_u32 m0, s21, 65536
    s_nop 0
    buffer_load_dwordx4 v1, s[4:7], s16 offen sc1 lds
    s_add_u32 s16, s16, s62
    v_mfma_f32_16x16x32_bf16 v[200:203], v[72:75], v[48:51], v[200:203]
    v_mfma_f32_16x16x32_bf16 v[204:207], v[76:79], v[48:51], v[204:207]
    v_mfma_f32_16x16x32_bf16 v[208:211], v[64:67], v[52:55], v[208:211]
    s_add_u32 m0, s21, 66560
    s_nop 0
    buffer_load_dwordx4 v1, s[4:7], s17 offen sc1 lds
    s_add_u32 s17, s17, s62
    v_mfma_f32_16x16x32_bf16 v[212:215], v[68:71], v[52:55], v[212:215]
    v_mfma_f32_16x16x32_bf16 v[216:219], v[72:75], v[52:55], v[216:219]
    v_mfma_f32_16x16x32_bf16 v[220:223], v[76:79], v[52:55], v[220:223]
    s_add_u32 m0, s22, 65536
    s_nop 0
    buffer_load_dwordx4 v2, s[8:11], s18 offen lds
    s_add_u32 s18, s18, s20
    v_mfma_f32_16x16x32_bf16 v[224:227], v[64:67], v[56:59], v[224:227]
    v_mfma_f32_16x16x32_bf16 v[228:231], v[68:71], v[56:59], v[228:231]
    v_mfma_f32_16x16x32_bf16 v[232:235], v[72:75], v[56:59], v[232:235]
    s_add_u32 m0, s22, 73728
    s_nop 0
    buffer_load_dwordx4 v2, s[12:15], s19 offen lds
    s_add_u32 s19, s19, s20
    v_mfma_f32_16x16x32_bf16 v[236:239], v[76:79], v[56:59], v[236:239]
    v_mfma_f32_16x16x32_bf16 v[240:243], v[64:67], v[60:63], v[240:243]
    v_mfma_f32_16x16x32_bf16 v[244:247], v[68:71], v[60:63], v[244:247]
    v_mfma_f32_16x16x32_bf16 v[248:251], v[72:75], v[60:63], v[248:251]
    v_mfma_f32_16x16x32_bf16 v[252:255], v[76:79], v[60:63], v[252:255]
    s_waitcnt lgkmcnt(0)
    s_waitcnt vmcnt(8)
    s_barrier
    v_mfma_f32_16x16x32_bf16 v[128:131], v[112:115], v[80:83], v[128:131]
    ds_read_b64_tr_b16 v[64:65], v8 offset:16384
    v_mfma_f32_16x16x32_bf16 v[132:135], v[116:119], v[80:83], v[132:135]
    ds_read_b64_tr_b16 v[66:67], v9 offset:16384
    v_mfma_f32_16x16x32_bf16 v[136:139], v[120:123], v[80:83], v[136:139]
    ds_read_b64_tr_b16 v[68:69], v10 offset:16384
    v_mfma_f32_16x16x32_bf16 v[140:143], v[124:127], v[80:83], v[140:143]
    ds_read_b64_tr_b16 v[70:71], v11 offset:16384
    v_mfma_f32_16x16x32_bf16 v[144:147], v[112:115], v[84:87], v[144:147]
    ds_read_b64_tr_b16 v[72:73], v8 offset:24576
    v_mfma_f32_16x16x32_bf16 v[148:151], v[116:119], v[84:87], v[148:151]
    ds_read_b64_tr_b16 v[74:75], v9 offset:24576
    v_mfma_f32_16x16x32_bf16 v[152:155], v[120:123], v[84:87], v[152:155]
    ds_read_b64_tr_b16 v[76:77], v10 offset:24576
    v_mfma_f32_16x16x32_bf16 v[156:159], v[124:127], v[84:87], v[156:159]
    ds_read_b64_tr_b16 v[78:79], v11 offset:24576
    v_mfma_f32_16x16x32_bf16 v[160:163], v[112:115], v[88:91], v[160:163]
    ds_read_b128 v[32:35], v5 offset:0
    v_mfma_f32_16x16x32_bf16 v[164:167], v[116:119], v[88:91], v[164:167]
    ds_read_b128 v[36:39], v5 offset:1024
    v_mfma_f32_16x16x32_bf16 v[168:171], v[120:123], v[88:91], v[168:171]
    ds_read_b128 v[40:43], v5 offset:2048
    v_mfma_f32_16x16x32_bf16 v[172:175], v[124:127], v[88:91], v[172:175]
    ds_read_b128 v[44:47], v5 offset:3072
    v_mfma_f32_16x16x32_bf16 v[176:179], v[112:115], v[92:95], v[176:179]
    ds_read_b128 v[48:51], v5 offset:4096
    v_mfma_f32_16x16x32_bf16 v[180:183], v[116:119], v[92:95], v[180:183]
    ds_read_b128 v[52:55], v5 offset:5120
    v_mfma_f32_16x16x32_bf16 v[184:187], v[120:123], v[92:95], v[184:187]
    ds_read_b128 v[56:59], v5 offset:6144
    v_mfma_f32_16x16x32_bf16 v[188:191], v[124:127], v[92:95], v[188:191]
    ds_read_b128 v[60:63], v5 offset:7168
    v_mfma_f32_16x16x32_bf16 v[192:195], v[112:115], v[96:99], v[192:195]
    v_mfma_f32_16x16x32_bf16 v[196:199], v[116:119], v[96:99], v[196:199]
    s_add_u32 m0, s21, 98304
    s_nop 0
    buffer_load_dwordx4 v1, s[4:7], s16 offen sc1 lds
    s_add_u32 s16, s16, s62
    v_mfma_f32_16x16x32_bf16 v[200:203], v[120:123], v[96:99], v[200:203]
    v_mfma_f32_16x16x32_bf16 v[204:207], v[124:127], v[96:99], v[204:207]
    v_mfma_f32_16x16x32_bf16 v[208:211], v[112:115], v[100:103], v[208:211]
    s_add_u32 m0, s21, 99328
    s_nop 0
    buffer_load_dwordx4 v1, s[4:7], s17 offen sc1 lds
    s_add_u32 s17, s17, s62
    v_mfma_f32_16x16x32_bf16 v[212:215], v[116:119], v[100:103], v[212:215]
    v_mfma_f32_16x16x32_bf16 v[216:219], v[120:123], v[100:103], v[216:219]
    v_mfma_f32_16x16x32_bf16 v[220:223], v[124:127], v[100:103], v[220:223]
    s_add_u32 m0, s22, 98304
    s_nop 0
    buffer_load_dwordx4 v2, s[8:11], s18 offen lds
    s_add_u32 s18, s18, s20
    v_mfma_f32_16x16x32_bf16 v[224:227], v[112:115], v[104:107], v[224:227]
    v_mfma_f32_16x16x32_bf16 v[228:231], v[116:119], v[104:107], v[228:231]
    v_mfma_f32_16x16x32_bf16 v[232:235], v[120:123], v[104:107], v[232:235]
    s_add_u32 m0, s22, 106496
    s_nop 0
    buffer_load_dwordx4 v2, s[12:15], s19 offen lds
    s_add_u32 s19, s19, s20
    v_mfma_f32_16x16x32_bf16 v[236:239], v[124:127], v[104:107], v[236:239]
    v_mfma_f32_16x16x32_bf16 v[240:243], v[112:115], v[108:111], v[240:243]
    v_mfma_f32_16x16x32_bf16 v[244:247], v[116:119], v[108:111], v[244:247]
    v_mfma_f32_16x16x32_bf16 v[248:251], v[120:123], v[108:111], v[248:251]
    v_mfma_f32_16x16x32_bf16 v[252:255], v[124:127], v[108:111], v[252:255]
    s_waitcnt lgkmcnt(0)
    s_sub_u32 s23, s23, 1
    s_cmp_lg_u32 s23, 0
    s_cbranch_scc1 w_loop
    s_branch w_end
w_nd:
    s_waitcnt vmcnt(8)
    s_barrier
    v_mfma_f32_16x16x32_bf16 v[128:131], v[64:67], v[32:35], v[128:131]
    ds_read_b64_tr_b16 v[112:113], v8 offset:49152
    v_mfma_f32_16x16x32_bf16 v[132:135], v[68:71], v[32:35], v[132:135]
    ds_read_b64_tr_b16 v[114:115], v9 offset:49152
    v_mfma_f32_16x16x32_bf16 v[136:139], v[72:75], v[32:35], v[136:139]
    ds_read_b64_tr_b16 v[116:117], v10 offset:49152
    v_mfma_f32_16x16x32_bf16 v[140:143], v[76:79], v[32:35], v[140:143]
    ds_read_b64_tr_b16 v[118:119], v11 offset:49152
    v_mfma_f32_16x16x32_bf16 v[144:147], v[64:67], v[36:39], v[144:147]
    ds_read_b64_tr_b16 v[120:121], v8 offset:57344
    v_mfma_f32_16x16x32_bf16 v[148:151], v[68:71], v[36:39], v[148:151]
    ds_read_b64_tr_b16 v[122:123], v9 offset:57344
    v_mfma_f32_16x16x32_bf16 v[152:155], v[72:75], v[36:39], v[152:155]
    ds_read_b64_tr_b16 v[124:125], v10 offset:57344
    v_mfma_f32_16x16x32_bf16 v[156:159], v[76:79], v[36:39], v[156:159]
    ds_read_b64_tr_b16 v[126:127], v11 offset:57344
    v_mfma_f32_16x16x32_bf16 v[160:163], v[64:67], v[40:43], v[160:163]
    ds_read_b128 v[80:83], v5 offset:32768
    v_mfma_f32_16x16x32_bf16 v[164:167], v[68:71], v[40:43], v[164:167]
    ds_read_b128 v[84:87], v5 offset:33792
    v_mfma_f32_16x16x32_bf16 v[168:171], v[72:75], v[40:43], v[168:171]
    ds_read_b128 v[88:91], v5 offset:34816
    v_mfma_f32_16x16x32_bf16 v[172:175], v[76:79], v[40:43], v[172:175]
    ds_read_b128 v[92:95], v5 offset:35840
    v_mfma_f32_16x16x32_bf16 v[176:179], v[64:67], v[44:47], v[176:179]
    ds_read_b128 v[96:99], v5 offset:36864
    v_mfma_f32_16x16x32_bf16 v[180:183], v[68:71], v[44:47], v[180:183]
    ds_read_b128 v[100:103], v5 offset:37888
    v_mfma_f32_16x16x32_bf16 v[184:187], v[72:75], v[44:47], v[184:187]
    ds_read_b128 v[104:107], v5 offset:38912
    v_mfma_f32_16x16x32_bf16 v[188:191], v[76:79], v[44:47], v[188:191]
    ds_read_b128 v[108:111], v5 offset:39936
    v_mfma_f32_16x16x32_bf16 v[192:195], v[64:67], v[48:51], v[192:195]
    v_mfma_f32_16x16x32_bf16 v[196:199], v[68:71], v[48:51], v[196:199]
    v_mfma_f32_16x16x32_bf16 v[200:203], v[72:75], v[48:51], v[200:203]
    v_mfma_f32_16x16x32_bf16 v[204:207], v[76:79], v[48:51], v[204:207]
    v_mfma_f32_16x16x32_bf16 v[208:211], v[64:67], v[52:55], v[208:211]
    v_mfma_f32_16x16x32_bf16 v[212:215], v[68:71], v[52:55], v[212:215]
    v_mfma_f32_16x16x32_bf16 v[216:219], v[72:75], v[52:55], v[216:219]
    v_mfma_f32_16x16x32_bf16 v[220:223], v[76:79], v[52:55], v[220:223]
    v_mfma_f32_16x16x32_bf16 v[224:227], v[64:67], v[56:59], v[224:227]
    v_mfma_f32_16x16x32_bf16 v[228:231], v[68:71], v[56:59], v[228:231]
    v_mfma_f32_16x16x32_bf16 v[232:235], v[72:75], v[56:59], v[232:235]
    v_mfma_f32_16x16x32_bf16 v[236:239], v[76:79], v[56:59], v[236:239]
    v_mfma_f32_16x16x32_bf16 v[240:243], v[64:67], v[60:63], v[240:243]
    v_mfma_f32_16x16x32_bf16 v[244:247], v[68:71], v[60:63], v[244:247]
    v_mfma_f32_16x16x32_bf16 v[248:251], v[72:75], v[60:63], v[248:251]
    v_mfma_f32_16x16x32_bf16 v[252:255], v[76:79], v[60:63], v[252:255]
    s_waitcnt lgkmcnt(0)
    s_waitcnt vmcnt(4)
    s_barrier
    v_mfma_f32_16x16x32_bf16 v[128:131], v[112:115], v[80:83], v[128:131]
    ds_read_b64_tr_b16 v[64:65], v12 offset:16384
    v_mfma_f32_16x16x32_bf16 v[132:135], v[116:119], v[80:83], v[132:135]
    ds_read_b64_tr_b16 v[66:67], v13 offset:16384
    v_mfma_f32_16x16x32_bf16 v[136:139], v[120:123], v[80:83], v[136:139]
    ds_read_b64_tr_b16 v[68:69], v14 offset:16384
    v_mfma_f32_16x16x32_bf16 v[140:143], v[124:127], v[80:83], v[140:143]
    ds_read_b64_tr_b16 v[70:71], v15 offset:16384
    v_mfma_f32_16x16x32_bf16 v[144:147], v[112:115], v[84:87], v[144:147]
    ds_read_b64_tr_b16 v[72:73], v12 offset:24576
    v_mfma_f32_16x16x32_bf16 v[148:151], v[116:119], v[84:87], v[148:151]
    ds_read_b64_tr_b16 v[74:75], v13 offset:24576
    v_mfma_f32_16x16x32_bf16 v[152:155], v[120:123], v[84:87], v[152:155]
    ds_read_b64_tr_b16 v[76:77], v14 offset:24576
    v_mfma_f32_16x16x32_bf16 v[156:159], v[124:127], v[84:87], v[156:159]
    ds_read_b64_tr_b16 v[78:79], v15 offset:24576
    v_mfma_f32_16x16x32_bf16 v[160:163], v[112:115], v[88:91], v[160:163]
    ds_read_b128 v[32:35], v6 offset:0
    v_mfma_f32_16x16x32_bf16 v[164:167], v[116:119], v[88:91], v[164:167]
    ds_read_b128 v[36:39], v6 offset:1024
    v_mfma_f32_16x16x32_bf16 v[168:171], v[120:123], v[88:91], v[168:171]
    ds_read_b128 v[40:43], v6 offset:2048
    v_mfma_f32_16x16x32_bf16 v[172:175], v[124:127], v[88:91], v[172:175]
    ds_read_b128 v[44:47], v6 offset:3072
    v_mfma_f32_16x16x32_bf16 v[176:179], v[112:115], v[92:95], v[176:179]
    ds_read_b128 v[48:51], v6 offset:4096
    v_mfma_f32_16x16x32_bf16 v[180:183], v[116:119], v[92:95], v[180:183]
    ds_read_b128 v[52:55], v6 offset:5120
    v_mfma_f32_16x16x32_bf16 v[184:187], v[120:123], v[92:95], v[184:187]
    ds_read_b128 v[56:59], v6 offset:6144
    v_mfma_f32_16x16x32_bf16 v[188:191], v[124:127], v[92:95], v[188:191]
    ds_read_b128 v[60:63], v6 offset:7168
    v_mfma_f32_16x16x32_bf16 v[192:195], v[112:115], v[96:99], v[192:195]
    v_mfma_f32_16x16x32_bf16 v[196:199], v[116:119], v[96:99], v[196:199]
    v_mfma_f32_16x16x32_bf16 v[200:203], v[120:123], v[96:99], v[200:203]
    v_mfma_f32_16x16x32_bf16 v[204:207], v[124:127], v[96:99], v[204:207]
    v_mfma_f32_16x16x32_bf16 v[208:211], v[112:115], v[100:103], v[208:211]
    v_mfma_f32_16x16x32_bf16 v[212:215], v[116:119], v[100:103], v[212:215]
    v_mfma_f32_16x16x32_bf16 v[216:219], v[120:123], v[100:103], v[216:219]
    v_mfma_f32_16x16x32_bf16 v[220:223], v[124:127], v[100:103], v[220:223]
    v_mfma_f32_16x16x32_bf16 v[224:227], v[112:115], v[104:107], v[224:227]
    v_mfma_f32_16x16x32_bf16 v[228:231], v[116:119], v[104:107], v[228:231]
    v_mfma_f32_16x16x32_bf16 v[232:235], v[120:123], v[104:107], v[232:235]
    v_mfma_f32_16x16x32_bf16 v[236:239], v[124:127], v[104:107], v[236:239]
    v_mfma_f32_16x16x32_bf16 v[240:243], v[112:115], v[108:111], v[240:243]
    v_mfma_f32_16x16x32_bf16 v[244:247], v[116:119], v[108:111], v[244:247]
    v_mfma_f32_16x16x32_bf16 v[248:251], v[120:123], v[108:111], v[248:251]
    v_mfma_f32_16x16x32_bf16 v[252:255], v[124:127], v[108:111], v[252:255]
    s_waitcnt lgkmcnt(0)
    s_waitcnt vmcnt(0)
    s_barrier
    v_mfma_f32_16x16x32_bf16 v[128:131], v[64:67], v[32:35], v[128:131]
    ds_read_b64_tr_b16 v[112:113], v12 offset:49152
    v_mfma_f32_16x16x32_bf16 v[132:135], v[68:71], v[32:35], v[132:135]
    ds_read_b64_tr_b16 v[114:115], v13 offset:49152
    v_mfma_f32_16x16x32_bf16 v[136:139], v[72:75], v[32:35], v[136:139]
    ds_read_b64_tr_b16 v[116:117], v14 offset:49152
    v_mfma_f32_16x16x32_bf16 v[140:143], v[76:79], v[32:35], v[140:143]
    ds_read_b64_tr_b16 v[118:119], v15 offset:49152
    v_mfma_f32_16x16x32_bf16 v[144:147], v[64:67], v[36:39], v[144:147]
    ds_read_b64_tr_b16 v[120:121], v12 offset:57344
    v_mfma_f32_16x16x32_bf16 v[148:151], v[68:71], v[36:39], v[148:151]
    ds_read_b64_tr_b16 v[122:123], v13 offset:57344
    v_mfma_f32_16x16x32_bf16 v[152:155], v[72:75], v[36:39], v[152:155]
    ds_read_b64_tr_b16 v[124:125], v14 offset:57344
    v_mfma_f32_16x16x32_bf16 v[156:159], v[76:79], v[36:39], v[156:159]
    ds_read_b64_tr_b16 v[126:127], v15 offset:57344
    v_mfma_f32_16x16x32_bf16 v[160:163], v[64:67], v[40:43], v[160:163]
    ds_read_b128 v[80:83], v6 offset:32768
    v_mfma_f32_16x16x32_bf16 v[164:167], v[68:71], v[40:43], v[164:167]
    ds_read_b128 v[84:87], v6 offset:33792
    v_mfma_f32_16x16x32_bf16 v[168:171], v[72:75], v[40:43], v[168:171]
    ds_read_b128 v[88:91], v6 offset:34816
    v_mfma_f32_16x16x32_bf16 v[172:175], v[76:79], v[40:43], v[172:175]
    ds_read_b128 v[92:95], v6 offset:35840
    v_mfma_f32_16x16x32_bf16 v[176:179], v[64:67], v[44:47], v[176:179]
    ds_read_b128 v[96:99], v6 offset:36864
    v_mfma_f32_16x16x32_bf16 v[180:183], v[68:71], v[44:47], v[180:183]
    ds_read_b128 v[100:103], v6 offset:37888
    v_mfma_f32_16x16x32_bf16 v[184:187], v[72:75], v[44:47], v[184:187]
    ds_read_b128 v[104:107], v6 offset:38912
    v_mfma_f32_16x16x32_bf16 v[188:191], v[76:79], v[44:47], v[188:191]
    ds_read_b128 v[108:111], v6 offset:39936
    v_mfma_f32_16x16x32_bf16 v[192:195], v[64:67], v[48:51], v[192:195]
    v_mfma_f32_16x16x32_bf16 v[196:199], v[68:71], v[48:51], v[196:199]
    v_mfma_f32_16x16x32_bf16 v[200:203], v[72:75], v[48:51], v[200:203]
    v_mfma_f32_16x16x32_bf16 v[204:207], v[76:79], v[48:51], v[204:207]
    v_mfma_f32_16x16x32_bf16 v[208:211], v[64:67], v[52:55], v[208:211]
    v_mfma_f32_16x16x32_bf16 v[212:215], v[68:71], v[52:55], v[212:215]
    v_mfma_f32_16x16x32_bf16 v[216:219], v[72:75], v[52:55], v[216:219]
    v_mfma_f32_16x16x32_bf16 v[220:223], v[76:79], v[52:55], v[220:223]
    v_mfma_f32_16x16x32_bf16 v[224:227], v[64:67], v[56:59], v[224:227]
    v_mfma_f32_16x16x32_bf16 v[228:231], v[68:71], v[56:59], v[228:231]
    v_mfma_f32_16x16x32_bf16 v[232:235], v[72:75], v[56:59], v[232:235]
    v_mfma_f32_16x16x32_bf16 v[236:239], v[76:79], v[56:59], v[236:239]
    v_mfma_f32_16x16x32_bf16 v[240:243], v[64:67], v[60:63], v[240:243]
    v_mfma_f32_16x16x32_bf16 v[244:247], v[68:71], v[60:63], v[244:247]
    v_mfma_f32_16x16x32_bf16 v[248:251], v[72:75], v[60:63], v[248:251]
    v_mfma_f32_16x16x32_bf16 v[252:255], v[76:79], v[60:63], v[252:255]
    s_waitcnt lgkmcnt(0)
    s_waitcnt vmcnt(0)
    s_barrier
    v_mfma_f32_16x16x32_bf16 v[128:131], v[112:115], v[80:83], v[128:131]
    ds_read_b64_tr_b16 v[64:65], v8 offset:16384
    v_mfma_f32_16x16x32_bf16 v[132:135], v[116:119], v[80:83], v[132:135]
    ds_read_b64_tr_b16 v[66:67], v9 offset:16384
    v_mfma_f32_16x16x32_bf16 v[136:139], v[120:123], v[80:83], v[136:139]
    ds_read_b64_tr_b16 v[68:69], v10 offset:16384
    v_mfma_f32_16x16x32_bf16 v[140:143], v[124:127], v[80:83], v[140:143]
    ds_read_b64_tr_b16 v[70:71], v11 offset:16384
    v_mfma_f32_16x16x32_bf16 v[144:147], v[112:115], v[84:87], v[144:147]
    ds_read_b64_tr_b16 v[72:73], v8 offset:24576
    v_mfma_f32_16x16x32_bf16 v[148:151], v[116:119], v[84:87], v[148:151]
    ds_read_b64_tr_b16 v[74:75], v9 offset:24576
    v_mfma_f32_16x16x32_bf16 v[152:155], v[120:123], v[84:87], v[152:155]
    ds_read_b64_tr_b16 v[76:77], v10 offset:24576
    v_mfma_f32_16x16x32_bf16 v[156:159], v[124:127], v[84:87], v[156:159]
    ds_read_b64_tr_b16 v[78:79], v11 offset:24576
    v_mfma_f32_16x16x32_bf16 v[160:163], v[112:115], v[88:91], v[160:163]
    ds_read_b128 v[32:35], v5 offset:0
    v_mfma_f32_16x16x32_bf16 v[164:167], v[116:119], v[88:91], v[164:167]
    ds_read_b128 v[36:39], v5 offset:1024
    v_mfma_f32_16x16x32_bf16 v[168:171], v[120:123], v[88:91], v[168:171]
    ds_read_b128 v[40:43], v5 offset:2048
    v_mfma_f32_16x16x32_bf16 v[172:175], v[124:127], v[88:91], v[172:175]
    ds_read_b128 v[44:47], v5 offset:3072
    v_mfma_f32_16x16x32_bf16 v[176:179], v[112:115], v[92:95], v[176:179]
    ds_read_b128 v[48:51], v5 offset:4096
    v_mfma_f32_16x16x32_bf16 v[180:183], v[116:119], v[92:95], v[180:183]
    ds_read_b128 v[52:55], v5 offset:5120
    v_mfma_f32_16x16x32_bf16 v[184:187], v[120:123], v[92:95], v[184:187]
    ds_read_b128 v[56:59], v5 offset:6144
    v_mfma_f32_16x16x32_bf16 v[188:191], v[124:127], v[92:95], v[188:191]
    ds_read_b128 v[60:63], v5 offset:7168
    v_mfma_f32_16x16x32_bf16 v[192:195], v[112:115], v[96:99], v[192:195]
    v_mfma_f32_16x16x32_bf16 v[196:199], v[116:119], v[96:99], v[196:199]
    v_mfma_f32_16x16x32_bf16 v[200:203], v[120:123], v[96:99], v[200:203]
    v_mfma_f32_16x16x32_bf16 v[204:207], v[124:127], v[96:99], v[204:207]
    v_mfma_f32_16x16x32_bf16 v[208:211], v[112:115], v[100:103], v[208:211]
    v_mfma_f32_16x16x32_bf16 v[212:215], v[116:119], v[100:103], v[212:215]
    v_mfma_f32_16x16x32_bf16 v[216:219], v[120:123], v[100:103], v[216:219]
    v_mfma_f32_16x16x32_bf16 v[220:223], v[124:127], v[100:103], v[220:223]
    v_mfma_f32_16x16x32_bf16 v[224:227], v[112:115], v[104:107], v[224:227]
    v_mfma_f32_16x16x32_bf16 v[228:231], v[116:119], v[104:107], v[228:231]
    v_mfma_f32_16x16x32_bf16 v[232:235], v[120:123], v[104:107], v[232:235]
    v_mfma_f32_16x16x32_bf16 v[236:239], v[124:127], v[104:107], v[236:239]
    v_mfma_f32_16x16x32_bf16 v[240:243], v[112:115], v[108:111], v[240:243]
    v_mfma_f32_16x16x32_bf16 v[244:247], v[116:119], v[108:111], v[244:247]
    v_mfma_f32_16x16x32_bf16 v[248:251], v[120:123], v[108:111], v[248:251]
    v_mfma_f32_16x16x32_bf16 v[252:255], v[124:127], v[108:111], v[252:255]
    s_waitcnt lgkmcnt(0)
w_end:
    v_mov_b32 v20, 131072
    ds_read_b128 v[24:27], v20
    ds_read_b128 v[28:31], v20 offset:16
    s_cmp_eq_u32 s48, 2
    s_cbranch_scc1 w_epi_glu
    s_cmp_eq_u32 s48, 3
    s_cbranch_scc1 w_epi_silu
    s_lshl_b32 s30, s27, 10
    s_add_u32 s30, s30, s49
    s_nop 7
    v_cvt_pk_bf16_f32 v80, v128, v129
    v_cvt_pk_bf16_f32 v81, v130, v131
    v_cvt_pk_bf16_f32 v82, v132, v133
    v_cvt_pk_bf16_f32 v83, v134, v135
    buffer_store_dwordx4 v[80:83], v1, s[4:7], s30 offen sc1
    v_cvt_pk_bf16_f32 v84, v136, v137
    v_cvt_pk_bf16_f32 v85, v138, v139
    v_cvt_pk_bf16_f32 v86, v140, v141
    v_cvt_pk_bf16_f32 v87, v142, v143
    buffer_store_dwordx4 v[84:87], v19, s[4:7], s30 offen sc1
    s_add_u32 s30, s30, s50
    v_cvt_pk_bf16_f32 v88, v144, v145
    v_cvt_pk_bf16_f32 v89, v146, v147
    v_cvt_pk_bf16_f32 v90, v148, v149
    v_cvt_pk_bf16_f32 v91, v150, v151
    buffer_store_dwordx4 v[88:91], v1, s[4:7], s30 offen sc1
    v_cvt_pk_bf16_f32 v92, v152, v153
    v_cvt_pk_bf16_f32 v93, v154, v155
    v_cvt_pk_bf16_f32 v94, v156, v157
    v_cvt_pk_bf16_f32 v95, v158, v159
    buffer_store_dwordx4 v[92:95], v19, s[4:7], s30 offen sc1
    s_add_u32 s30, s30, s50
    v_cvt_pk_bf16_f32 v80, v160, v161
    v_cvt_pk_bf16_f32 v81, v162, v163
    v_cvt_pk_bf16_f32 v82, v164, v165
    v_cvt_pk_bf16_f32 v83, v166, v167
    buffer_store_dwordx4 v[80:83], v1, s[4:7], s30 offen sc1
    v_cvt_pk_bf16_f32 v84, v168, v169
    v_cvt_pk_bf16_f32 v85, v170, v171
    v_cvt_pk_bf16_f32 v86, v172, v173
    v_cvt_pk_bf16_f32 v87, v174, v175
    buffer_store_dwordx4 v[84:87], v19, s[4:7], s30 offen sc1
    s_add_u32 s30, s30, s50
    v_cvt_pk_bf16_f32 v88, v176, v177
    v_cvt_pk_bf16_f32 v89, v178, v179
    v_cvt_pk_bf16_f32 v90, v180, v181
    v_cvt_pk_bf16_f32 v91, v182, v183
    buffer_store_dwordx4 v[88:91], v1, s[4:7], s30 offen sc1
    v_cvt_pk_bf16_f32 v92, v184, v185
    v_cvt_pk_bf16_f32 v93, v186, v187
    v_cvt_pk_bf16_f32 v94, v188, v189
    v_cvt_pk_bf16_f32 v95, v190, v191
    buffer_store_dwordx4 v[92:95], v19, s[4:7], s30 offen sc1
    s_add_u32 s30, s30, s50
    v_cvt_pk_bf16_f32 v80, v192, v193
    v_cvt_pk_bf16_f32 v81, v194, v195
    v_cvt_pk_bf16_f32 v82, v196, v197
    v_cvt_pk_bf16_f32 v83, v198, v199
    buffer_store_dwordx4 v[80:83], v1, s[4:7], s30 offen sc1
    v_cvt_pk_bf16_f32 v84, v200, v201
    v_cvt_pk_bf16_f32 v85, v202, v203
    v_cvt_pk_bf16_f32 v86, v204, v205
    v_cvt_pk_bf16_f32 v87, v206, v207
    buffer_store_dwordx4 v[84:87], v19, s[4:7], s30 offen sc1
    s_add_u32 s30, s30, s50
    v_cvt_pk_bf16_f32 v88, v208, v209
    v_cvt_pk_bf16_f32 v89, v210, v211
    v_cvt_pk_bf16_f32 v90, v212, v213
    v_cvt_pk_bf16_f32 v91, v214, v215
    buffer_store_dwordx4 v[88:91], v1, s[4:7], s30 offen sc1
    v_cvt_pk_bf16_f32 v92, v216, v217
    v_cvt_pk_bf16_f32 v93, v218, v219
    v_cvt_pk_bf16_f32 v94, v220, v221
    v_cvt_pk_bf16_f32 v95, v222, v223
    buffer_store_dwordx4 v[92:95], v19, s[4:7], s30 offen sc1
    s_add_u32 s30, s30, s50
    v_cvt_pk_bf16_f32 v80, v224, v225
    v_cvt_pk_bf16_f32 v81, v226, v227
    v_cvt_pk_bf16_f32 v82, v228, v229
    v_cvt_pk_bf16_f32 v83, v230, v231
    buffer_store_dwordx4 v[80:83], v1, s[4:7], s30 offen sc1
    v_cvt_pk_bf16_f32 v84, v232, v233
    v_cvt_pk_bf16_f32 v85, v234, v235
    v_cvt_pk_bf16_f32 v86, v236, v237
    v_cvt_pk_bf16_f32 v87, v238, v239
    buffer_store_dwordx4 v[84:87], v19, s[4:7], s30 offen sc1
    s_add_u32 s30, s30, s50
    v_cvt_pk_bf16_f32 v88, v240, v241
    v_cvt_pk_bf16_f32 v89, v242, v243
    v_cvt_pk_bf16_f32 v90, v244, v245
    v_cvt_pk_bf16_f32 v91, v246, v247
    buffer_store_dwordx4 v[88:91], v1, s[4:7], s30 offen sc1
    v_cvt_pk_bf16_f32 v92, v248, v249
    v_cvt_pk_bf16_f32 v93, v250, v251
    v_cvt_pk_bf16_f32 v94, v252, v253
    v_cvt_pk_bf16_f32 v95, v254, v255
    buffer_store_dwordx4 v[92:95], v19, s[4:7], s30 offen sc1
    s_waitcnt lgkmcnt(0)
    v_or3_b32 v24, v24, v25, v26
    v_or3_b32 v28, v28, v29, v30
    v_or3_b32 v24, v24, v27, v31
    v_or_b32 v24, v24, v28
    s_mov_b32 s28, s51
    s_mov_b32 s57, s53
    v_readfirstlane_b32 s30, v24
    s_cmp_lg_u32 s30, 0
    s_cbranch_scc1 w_drain
    s_mov_b32 s48, s32
    s_cmp_ge_u32 s32, 4
    s_cselect_b32 s30, 2, 3
    s_lshl_b32 s30, s26, s30
    s_mul_i32 s30, s30, s43
    s_add_u32 s49, s42, s30
    s_mov_b32 s50, s43
    s_mov_b32 s51, s46
    s_mov_b32 s23, s41
    s_mov_b32 s53, s47
    s_nop 0
    s_load_dwordx16 s[32:47], s[24:25], 0
    s_add_u32 s24, s24, 64
    s_addc_u32 s25, s25, 0
    s_branch w_first16
w_epi_glu:
    s_lshl_b32 s30, s27, 10
    s_add_u32 s30, s30, s49
    s_mov_b32 s54, 0xbfb8aa3b
    s_nop 7
    v_cvt_pk_bf16_f32 v80, v128, v129
    v_cvt_pk_bf16_f32 v81, v130, v131
    v_cvt_pk_bf16_f32 v82, v132, v133
    v_cvt_pk_bf16_f32 v83, v134, v135
    v_lshlrev_b32 v96, 16, v80
    v_and_b32 v97, 0xffff0000, v80
    v_lshlrev_b32 v98, 16, v81
    v_and_b32 v99, 0xffff0000, v81
    v_lshlrev_b32 v100, 16, v82
    v_and_b32 v101, 0xffff0000, v82
    v_lshlrev_b32 v102, 16, v83
    v_and_b32 v103, 0xffff0000, v83
    v_mul_f32 v96, s54, v96
    v_mul_f32 v97, s54, v97
    v_mul_f32 v98, s54, v98
    v_mul_f32 v99, s54, v99
    v_mul_f32 v100, s54, v100
    v_mul_f32 v101, s54, v101
    v_mul_f32 v102, s54, v102
    v_mul_f32 v103, s54, v103
    v_exp_f32 v96, v96
    v_exp_f32 v97, v97
    v_exp_f32 v98, v98
    v_exp_f32 v99, v99
    v_exp_f32 v100, v100
    v_exp_f32 v101, v101
    v_exp_f32 v102, v102
    v_exp_f32 v103, v103
    v_add_f32 v96, 1.0, v96
    v_add_f32 v97, 1.0, v97
    v_add_f32 v98, 1.0, v98
    v_add_f32 v99, 1.0, v99
    v_add_f32 v100, 1.0, v100
    v_add_f32 v101, 1.0, v101
    v_add_f32 v102, 1.0, v102
    v_add_f32 v103, 1.0, v103
    v_rcp_f32 v96, v96
    v_rcp_f32 v97, v97
    v_rcp_f32 v98, v98
    v_rcp_f32 v99, v99
    v_rcp_f32 v100, v100
    v_rcp_f32 v101, v101
    v_rcp_f32 v102, v102
    v_rcp_f32 v103, v103
    v_mul_f32 v96, v96, v136
    v_mul_f32 v97, v97, v137
    v_mul_f32 v98, v98, v138
    v_mul_f32 v99, v99, v139
    v_mul_f32 v100, v100, v140
    v_mul_f32 v101, v101, v141
    v_mul_f32 v102, v102, v142
    v_mul_f32 v103, v103, v143
    v_cvt_pk_bf16_f32 v80, v96, v97
    v_cvt_pk_bf16_f32 v81, v98, v99
    v_cvt_pk_bf16_f32 v82, v100, v101
    v_cvt_pk_bf16_f32 v83, v102, v103
    buffer_store_dwordx4 v[80:83], v1, s[4:7], s30 offen sc1
    s_add_u32 s30, s30, s50
    v_cvt_pk_bf16_f32 v84, v144, v145
    v_cvt_pk_bf16_f32 v85, v146, v147
    v_cvt_pk_bf16_f32 v86, v148, v149
    v_cvt_pk_bf16_f32 v87, v150, v151
    v_lshlrev_b32 v104, 16, v84
    v_and_b32 v105, 0xffff0000, v84
    v_lshlrev_b32 v106, 16, v85
    v_and_b32 v107, 0xffff0000, v85
    v_lshlrev_b32 v108, 16, v86
    v_and_b32 v109, 0xffff0000, v86
    v_lshlrev_b32 v110, 16, v87
    v_and_b32 v111, 0xffff0000, v87
    v_mul_f32 v104, s54, v104
    v_mul_f32 v105, s54, v105
    v_mul_f32 v106, s54, v106
    v_mul_f32 v107, s54, v107
    v_mul_f32 v108, s54, v108
    v_mul_f32 v109, s54, v109
    v_mul_f32 v110, s54, v110
    v_mul_f32 v111, s54, v111
    v_exp_f32 v104, v104
    v_exp_f32 v105, v105
    v_exp_f32 v106, v106
    v_exp_f32 v107, v107
    v_exp_f32 v108, v108
    v_exp_f32 v109, v109
    v_exp_f32 v110, v110
    v_exp_f32 v111, v111
    v_add_f32 v104, 1.0, v104
    v_add_f32 v105, 1.0, v105
    v_add_f32 v106, 1.0, v106
    v_add_f32 v107, 1.0, v107
    v_add_f32 v108, 1.0, v108
    v_add_f32 v109, 1.0, v109
    v_add_f32 v110, 1.0, v110
    v_add_f32 v111, 1.0, v111
    v_rcp_f32 v104, v104
    v_rcp_f32 v105, v105
    v_rcp_f32 v106, v106
    v_rcp_f32 v107, v107
    v_rcp_f32 v108, v108
    v_rcp_f32 v109, v109
    v_rcp_f32 v110, v110
    v_rcp_f32 v111, v111
    v_mul_f32 v104, v104, v152
    v_mul_f32 v105, v105, v153
    v_mul_f32 v106, v106, v154
    v_mul_f32 v107, v107, v155
    v_mul_f32 v108, v108, v156
    v_mul_f32 v109, v109, v157
    v_mul_f32 v110, v110, v158
    v_mul_f32 v111, v111, v159
    v_cvt_pk_bf16_f32 v84, v104, v105
    v_cvt_pk_bf16_f32 v85, v106, v107
    v_cvt_pk_bf16_f32 v86, v108, v109
    v_cvt_pk_bf16_f32 v87, v110, v111
    buffer_store_dwordx4 v[84:87], v1, s[4:7], s30 offen sc1
    s_add_u32 s30, s30, s50
    v_cvt_pk_bf16_f32 v88, v160, v161
    v_cvt_pk_bf16_f32 v89, v162, v163
    v_cvt_pk_bf16_f32 v90, v164, v165
    v_cvt_pk_bf16_f32 v91, v166, v167
    v_lshlrev_b32 v96, 16, v88
    v_and_b32 v97, 0xffff0000, v88
    v_lshlrev_b32 v98, 16, v89
    v_and_b32 v99, 0xffff0000, v89
    v_lshlrev_b32 v100, 16, v90
    v_and_b32 v101, 0xffff0000, v90
    v_lshlrev_b32 v102, 16, v91
    v_and_b32 v103, 0xffff0000, v91
    v_mul_f32 v96, s54, v96
    v_mul_f32 v97, s54, v97
    v_mul_f32 v98, s54, v98
    v_mul_f32 v99, s54, v99
    v_mul_f32 v100, s54, v100
    v_mul_f32 v101, s54, v101
    v_mul_f32 v102, s54, v102
    v_mul_f32 v103, s54, v103
    v_exp_f32 v96, v96
    v_exp_f32 v97, v97
    v_exp_f32 v98, v98
    v_exp_f32 v99, v99
    v_exp_f32 v100, v100
    v_exp_f32 v101, v101
    v_exp_f32 v102, v102
    v_exp_f32 v103, v103
    v_add_f32 v96, 1.0, v96
    v_add_f32 v97, 1.0, v97
    v_add_f32 v98, 1.0, v98
    v_add_f32 v99, 1.0, v99
    v_add_f32 v100, 1.0, v100
    v_add_f32 v101, 1.0, v101
    v_add_f32 v102, 1.0, v102
    v_add_f32 v103, 1.0, v103
    v_rcp_f32 v96, v96
    v_rcp_f32 v97, v97
    v_rcp_f32 v98, v98
    v_rcp_f32 v99, v99
    v_rcp_f32 v100, v100
    v_rcp_f32 v101, v101
    v_rcp_f32 v102, v102
    v_rcp_f32 v103, v103
    v_mul_f32 v96, v96, v168
    v_mul_f32 v97, v97, v169
    v_mul_f32 v98, v98, v170
    v_mul_f32 v99, v99, v171
    v_mul_f32 v100, v100, v172
    v_mul_f32 v101, v101, v173
    v_mul_f32 v102, v102, v174
    v_mul_f32 v103, v103, v175
    v_cvt_pk_bf16_f32 v88, v96, v97
    v_cvt_pk_bf16_f32 v89, v98, v99
    v_cvt_pk_bf16_f32 v90, v100, v101
    v_cvt_pk_bf16_f32 v91, v102, v103
    buffer_store_dwordx4 v[88:91], v1, s[4:7], s30 offen sc1
    s_add_u32 s30, s30, s50
    v_cvt_pk_bf16_f32 v92, v176, v177
    v_cvt_pk_bf16_f32 v93, v178, v179
    v_cvt_pk_bf16_f32 v94, v180, v181
    v_cvt_pk_bf16_f32 v95, v182, v183
    v_lshlrev_b32 v104, 16, v92
    v_and_b32 v105, 0xffff0000, v92
    v_lshlrev_b32 v106, 16, v93
    v_and_b32 v107, 0xffff0000, v93
    v_lshlrev_b32 v108, 16, v94
    v_and_b32 v109, 0xffff0000, v94
    v_lshlrev_b32 v110, 16, v95
    v_and_b32 v111, 0xffff0000, v95
    v_mul_f32 v104, s54, v104
    v_mul_f32 v105, s54, v105
    v_mul_f32 v106, s54, v106
    v_mul_f32 v107, s54, v107
    v_mul_f32 v108, s54, v108
    v_mul_f32 v109, s54, v109
    v_mul_f32 v110, s54, v110
    v_mul_f32 v111, s54, v111
    v_exp_f32 v104, v104
    v_exp_f32 v105, v105
    v_exp_f32 v106, v106
    v_exp_f32 v107, v107
    v_exp_f32 v108, v108
    v_exp_f32 v109, v109
    v_exp_f32 v110, v110
    v_exp_f32 v111, v111
    v_add_f32 v104, 1.0, v104
    v_add_f32 v105, 1.0, v105
    v_add_f32 v106, 1.0, v106
    v_add_f32 v107, 1.0, v107
    v_add_f32 v108, 1.0, v108
    v_add_f32 v109, 1.0, v109
    v_add_f32 v110, 1.0, v110
    v_add_f32 v111, 1.0, v111
    v_rcp_f32 v104, v104
    v_rcp_f32 v105, v105
    v_rcp_f32 v106, v106
    v_rcp_f32 v107, v107
    v_rcp_f32 v108, v108
    v_rcp_f32 v109, v109
    v_rcp_f32 v110, v110
    v_rcp_f32 v111, v111
    v_mul_f32 v104, v104, v184
    v_mul_f32 v105, v105, v185
    v_mul_f32 v106, v106, v186
    v_mul_f32 v107, v107, v187
    v_mul_f32 v108, v108, v188
    v_mul_f32 v109, v109, v189
    v_mul_f32 v110, v110, v190
    v_mul_f32 v111, v111, v191
    v_cvt_pk_bf16_f32 v92, v104, v105
    v_cvt_pk_bf16_f32 v93, v106, v107
    v_cvt_pk_bf16_f32 v94, v108, v109
    v_cvt_pk_bf16_f32 v95, v110, v111
    buffer_store_dwordx4 v[92:95], v1, s[4:7], s30 offen sc1
    s_add_u32 s30, s30, s50
    v_cvt_pk_bf16_f32 v80, v192, v193
    v_cvt_pk_bf16_f32 v81, v194, v195
    v_cvt_pk_bf16_f32 v82, v196, v197
    v_cvt_pk_bf16_f32 v83, v198, v199
    v_lshlrev_b32 v96, 16, v80
    v_and_b32 v97, 0xffff0000, v80
    v_lshlrev_b32 v98, 16, v81
    v_and_b32 v99, 0xffff0000, v81
    v_lshlrev_b32 v100, 16, v82
    v_and_b32 v101, 0xffff0000, v82
    v_lshlrev_b32 v102, 16, v83
    v_and_b32 v103, 0xffff0000, v83
    v_mul_f32 v96, s54, v96
    v_mul_f32 v97, s54, v97
    v_mul_f32 v98, s54, v98
    v_mul_f32 v99, s54, v99
    v_mul_f32 v100, s54, v100
    v_mul_f32 v101, s54, v101
    v_mul_f32 v102, s54, v102
    v_mul_f32 v103, s54, v103
    v_exp_f32 v96, v96
    v_exp_f32 v97, v97
    v_exp_f32 v98, v98
    v_exp_f32 v99, v99
    v_exp_f32 v100, v100
    v_exp_f32 v101, v101
    v_exp_f32 v102, v102
    v_exp_f32 v103, v103
    v_add_f32 v96, 1.0, v96
    v_add_f32 v97, 1.0, v97
    v_add_f32 v98, 1.0, v98
    v_add_f32 v99, 1.0, v99
    v_add_f32 v100, 1.0, v100
    v_add_f32 v101, 1.0, v101
    v_add_f32 v102, 1.0, v102
    v_add_f32 v103, 1.0, v103
    v_rcp_f32 v96, v96
    v_rcp_f32 v97, v97
    v_rcp_f32 v98, v98
    v_rcp_f32 v99, v99
    v_rcp_f32 v100, v100
    v_rcp_f32 v101, v101
    v_rcp_f32 v102, v102
    v_rcp_f32 v103, v103
    v_mul_f32 v96, v96, v200
    v_mul_f32 v97, v97, v201
    v_mul_f32 v98, v98, v202
    v_mul_f32 v99, v99, v203
    v_mul_f32 v100, v100, v204
    v_mul_f32 v101, v101, v205
    v_mul_f32 v102, v102, v206
    v_mul_f32 v103, v103, v207
    v_cvt_pk_bf16_f32 v80, v96, v97
    v_cvt_pk_bf16_f32 v81, v98, v99
    v_cvt_pk_bf16_f32 v82, v100, v101
    v_cvt_pk_bf16_f32 v83, v102, v103
    buffer_store_dwordx4 v[80:83], v1, s[4:7], s30 offen sc1
    s_add_u32 s30, s30, s50
    v_cvt_pk_bf16_f32 v84, v208, v209
    v_cvt_pk_bf16_f32 v85, v210, v211
    v_cvt_pk_bf16_f32 v86, v212, v213
    v_cvt_pk_bf16_f32 v87, v214, v215
    v_lshlrev_b32 v104, 16, v84
    v_and_b32 v105, 0xffff0000, v84
    v_lshlrev_b32 v106, 16, v85
    v_and_b32 v107, 0xffff0000, v85
    v_lshlrev_b32 v108, 16, v86
    v_and_b32 v109, 0xffff0000, v86
    v_lshlrev_b32 v110, 16, v87
    v_and_b32 v111, 0xffff0000, v87
    v_mul_f32 v104, s54, v104
    v_mul_f32 v105, s54, v105
    v_mul_f32 v106, s54, v106
    v_mul_f32 v107, s54, v107
    v_mul_f32 v108, s54, v108
    v_mul_f32 v109, s54, v109
    v_mul_f32 v110, s54, v110
    v_mul_f32 v111, s54, v111
    v_exp_f32 v104, v104
    v_exp_f32 v105, v105
    v_exp_f32 v106, v106
    v_exp_f32 v107, v107
    v_exp_f32 v108, v108
    v_exp_f32 v109, v109
    v_exp_f32 v110, v110
    v_exp_f32 v111, v111
    v_add_f32 v104, 1.0, v104
    v_add_f32 v105, 1.0, v105
    v_add_f32 v106, 1.0, v106
    v_add_f32 v107, 1.0, v107
    v_add_f32 v108, 1.0, v108
    v_add_f32 v109, 1.0, v109
    v_add_f32 v110, 1.0, v110
    v_add_f32 v111, 1.0, v111
    v_rcp_f32 v104, v104
    v_rcp_f32 v105, v105
    v_rcp_f32 v106, v106
    v_rcp_f32 v107, v107
    v_rcp_f32 v108, v108
    v_rcp_f32 v109, v109
    v_rcp_f32 v110, v110
    v_rcp_f32 v111, v111
    v_mul_f32 v104, v104, v216
    v_mul_f32 v105, v105, v217
    v_mul_f32 v106, v106, v218
    v_mul_f32 v107, v107, v219
    v_mul_f32 v108, v108, v220
    v_mul_f32 v109, v109, v221
    v_mul_f32 v110, v110, v222
    v_mul_f32 v111, v111, v223
    v_cvt_pk_bf16_f32 v84, v104, v105
    v_cvt_pk_bf16_f32 v85, v106, v107
    v_cvt_pk_bf16_f32 v86, v108, v109
    v_cvt_pk_bf16_f32 v87, v110, v111
    buffer_store_dwordx4 v[84:87], v1, s[4:7], s30 offen sc1
    s_add_u32 s30, s30, s50
    v_cvt_pk_bf16_f32 v88, v224, v225
    v_cvt_pk_bf16_f32 v89, v226, v227
    v_cvt_pk_bf16_f32 v90, v228, v229
    v_cvt_pk_bf16_f32 v91, v230, v231
    v_lshlrev_b32 v96, 16, v88
    v_and_b32 v97, 0xffff0000, v88
    v_lshlrev_b32 v98, 16, v89
    v_and_b32 v99, 0xffff0000, v89
    v_lshlrev_b32 v100, 16, v90
    v_and_b32 v101, 0xffff0000, v90
    v_lshlrev_b32 v102, 16, v91
    v_and_b32 v103, 0xffff0000, v91
    v_mul_f32 v96, s54, v96
    v_mul_f32 v97, s54, v97
    v_mul_f32 v98, s54, v98
    v_mul_f32 v99, s54, v99
    v_mul_f32 v100, s54, v100
    v_mul_f32 v101, s54, v101
    v_mul_f32 v102, s54, v102
    v_mul_f32 v103, s54, v103
    v_exp_f32 v96, v96
    v_exp_f32 v97, v97
    v_exp_f32 v98, v98
    v_exp_f32 v99, v99
    v_exp_f32 v100, v100
    v_exp_f32 v101, v101
    v_exp_f32 v102, v102
    v_exp_f32 v103, v103
    v_add_f32 v96, 1.0, v96
    v_add_f32 v97, 1.0, v97
    v_add_f32 v98, 1.0, v98
    v_add_f32 v99, 1.0, v99
    v_add_f32 v100, 1.0, v100
    v_add_f32 v101, 1.0, v101
    v_add_f32 v102, 1.0, v102
    v_add_f32 v103, 1.0, v103
    v_rcp_f32 v96, v96
    v_rcp_f32 v97, v97
    v_rcp_f32 v98, v98
    v_rcp_f32 v99, v99
    v_rcp_f32 v100, v100
    v_rcp_f32 v101, v101
    v_rcp_f32 v102, v102
    v_rcp_f32 v103, v103
    v_mul_f32 v96, v96, v232
    v_mul_f32 v97, v97, v233
    v_mul_f32 v98, v98, v234
    v_mul_f32 v99, v99, v235
    v_mul_f32 v100, v100, v236
    v_mul_f32 v101, v101, v237
    v_mul_f32 v102, v102, v238
    v_mul_f32 v103, v103, v239
    v_cvt_pk_bf16_f32 v88, v96, v97
    v_cvt_pk_bf16_f32 v89, v98, v99
    v_cvt_pk_bf16_f32 v90, v100, v101
    v_cvt_pk_bf16_f32 v91, v102, v103
    buffer_store_dwordx4 v[88:91], v1, s[4:7], s30 offen sc1
    s_add_u32 s30, s30, s50
    v_cvt_pk_bf16_f32 v92, v240, v241
    v_cvt_pk_bf16_f32 v93, v242, v243
    v_cvt_pk_bf16_f32 v94, v244, v245
    v_cvt_pk_bf16_f32 v95, v246, v247
    v_lshlrev_b32 v104, 16, v92
    v_and_b32 v105, 0xffff0000, v92
    v_lshlrev_b32 v106, 16, v93
    v_and_b32 v107, 0xffff0000, v93
    v_lshlrev_b32 v108, 16, v94
    v_and_b32 v109, 0xffff0000, v94
    v_lshlrev_b32 v110, 16, v95
    v_and_b32 v111, 0xffff0000, v95
    v_mul_f32 v104, s54, v104
    v_mul_f32 v105, s54, v105
    v_mul_f32 v106, s54, v106
    v_mul_f32 v107, s54, v107
    v_mul_f32 v108, s54, v108
    v_mul_f32 v109, s54, v109
    v_mul_f32 v110, s54, v110
    v_mul_f32 v111, s54, v111
    v_exp_f32 v104, v104
    v_exp_f32 v105, v105
    v_exp_f32 v106, v106
    v_exp_f32 v107, v107
    v_exp_f32 v108, v108
    v_exp_f32 v109, v109
    v_exp_f32 v110, v110
    v_exp_f32 v111, v111
    v_add_f32 v104, 1.0, v104
    v_add_f32 v105, 1.0, v105
    v_add_f32 v106, 1.0, v106
    v_add_f32 v107, 1.0, v107
    v_add_f32 v108, 1.0, v108
    v_add_f32 v109, 1.0, v109
    v_add_f32 v110, 1.0, v110
    v_add_f32 v111, 1.0, v111
    v_rcp_f32 v104, v104
    v_rcp_f32 v105, v105
    v_rcp_f32 v106, v106
    v_rcp_f32 v107, v107
    v_rcp_f32 v108, v108
    v_rcp_f32 v109, v109
    v_rcp_f32 v110, v110
    v_rcp_f32 v111, v111
    v_mul_f32 v104, v104, v248
    v_mul_f32 v105, v105, v249
    v_mul_f32 v106, v106, v250
    v_mul_f32 v107, v107, v251
    v_mul_f32 v108, v108, v252
    v_mul_f32 v109, v109, v253
    v_mul_f32 v110, v110, v254
    v_mul_f32 v111, v111, v255
    v_cvt_pk_bf16_f32 v92, v104, v105
    v_cvt_pk_bf16_f32 v93, v106, v107
    v_cvt_pk_bf16_f32 v94, v108, v109
    v_cvt_pk_bf16_f32 v95, v110, v111
    buffer_store_dwordx4 v[92:95], v1, s[4:7], s30 offen sc1
    s_waitcnt lgkmcnt(0)
    v_or3_b32 v24, v24, v25, v26
    v_or3_b32 v28, v28, v29, v30
    v_or3_b32 v24, v24, v27, v31
    v_or_b32 v24, v24, v28
    s_mov_b32 s28, s51
    s_mov_b32 s57, s53
    v_readfirstlane_b32 s30, v24
    s_cmp_lg_u32 s30, 0
    s_cbranch_scc1 w_drain
    s_mov_b32 s48, s32
    s_cmp_ge_u32 s32, 4
    s_cselect_b32 s30, 2, 3
    s_lshl_b32 s30, s26, s30
    s_mul_i32 s30, s30, s43
    s_add_u32 s49, s42, s30
    s_mov_b32 s50, s43
    s_mov_b32 s51, s46
    s_mov_b32 s23, s41
    s_mov_b32 s53, s47
    s_nop 0
    s_load_dwordx16 s[32:47], s[24:25], 0
    s_add_u32 s24, s24, 64
    s_addc_u32 s25, s25, 0
    s_branch w_first8
w_epi_silu:
    s_lshl_b32 s30, s27, 10
    s_add_u32 s30, s30, s49
    s_mov_b32 s54, 0xbfb8aa3b
    s_nop 7
    v_cvt_pk_bf16_f32 v80, v128, v129
    v_cvt_pk_bf16_f32 v81, v130, v131
    v_cvt_pk_bf16_f32 v82, v132, v133
    v_cvt_pk_bf16_f32 v83, v134, v135
    v_lshlrev_b32 v128, 16, v80
    v_and_b32 v129, 0xffff0000, v80
    v_lshlrev_b32 v130, 16, v81
    v_and_b32 v131, 0xffff0000, v81
    v_lshlrev_b32 v132, 16, v82
    v_and_b32 v133, 0xffff0000, v82
    v_lshlrev_b32 v134, 16, v83
    v_and_b32 v135, 0xffff0000, v83
    v_mul_f32 v104, s54, v128
    v_mul_f32 v105, s54, v129
    v_mul_f32 v106, s54, v130
    v_mul_f32 v107, s54, v131
    v_mul_f32 v108, s54, v132
    v_mul_f32 v109, s54, v133
    v_mul_f32 v110, s54, v134
    v_mul_f32 v111, s54, v135
    v_exp_f32 v104, v104
    v_exp_f32 v105, v105
    v_exp_f32 v106, v106
    v_exp_f32 v107, v107
    v_exp_f32 v108, v108
    v_exp_f32 v109, v109
    v_exp_f32 v110, v110
    v_exp_f32 v111, v111
    v_add_f32 v104, 1.0, v104
    v_add_f32 v105, 1.0, v105
    v_add_f32 v106, 1.0, v106
    v_add_f32 v107, 1.0, v107
    v_add_f32 v108, 1.0, v108
    v_add_f32 v109, 1.0, v109
    v_add_f32 v110, 1.0, v110
    v_add_f32 v111, 1.0, v111
    v_rcp_f32 v104, v104
    v_rcp_f32 v105, v105
    v_rcp_f32 v106, v106
    v_rcp_f32 v107, v107
    v_rcp_f32 v108, v108
    v_rcp_f32 v109, v109
    v_rcp_f32 v110, v110
    v_rcp_f32 v111, v111
    v_mul_f32 v128, v128, v104
    v_mul_f32 v129, v129, v105
    v_mul_f32 v130, v130, v106
    v_mul_f32 v131, v131, v107
    v_mul_f32 v132, v132, v108
    v_mul_f32 v133, v133, v109
    v_mul_f32 v134, v134, v110
    v_mul_f32 v135, v135, v111
    v_cvt_pk_bf16_f32 v80, v128, v129
    v_cvt_pk_bf16_f32 v81, v130, v131
    v_cvt_pk_bf16_f32 v82, v132, v133
    v_cvt_pk_bf16_f32 v83, v134, v135
    buffer_store_dwordx4 v[80:83], v1, s[4:7], s30 offen sc1
    v_cvt_pk_bf16_f32 v84, v136, v137
    v_cvt_pk_bf16_f32 v85, v138, v139
    v_cvt_pk_bf16_f32 v86, v140, v141
    v_cvt_pk_bf16_f32 v87, v142, v143
    v_lshlrev_b32 v136, 16, v84
    v_and_b32 v137, 0xffff0000, v84
    v_lshlrev_b32 v138, 16, v85
    v_and_b32 v139, 0xffff0000, v85
    v_lshlrev_b32 v140, 16, v86
    v_and_b32 v141, 0xffff0000, v86
    v_lshlrev_b32 v142, 16, v87
    v_and_b32 v143, 0xffff0000, v87
    v_mul_f32 v96, s54, v136
    v_mul_f32 v97, s54, v137
    v_mul_f32 v98, s54, v138
    v_mul_f32 v99, s54, v139
    v_mul_f32 v100, s54, v140
    v_mul_f32 v101, s54, v141
    v_mul_f32 v102, s54, v142
    v_mul_f32 v103, s54, v143
    v_exp_f32 v96, v96
    v_exp_f32 v97, v97
    v_exp_f32 v98, v98
    v_exp_f32 v99, v99
    v_exp_f32 v100, v100
    v_exp_f32 v101, v101
    v_exp_f32 v102, v102
    v_exp_f32 v103, v103
    v_add_f32 v96, 1.0, v96
    v_add_f32 v97, 1.0, v97
    v_add_f32 v98, 1.0, v98
    v_add_f32 v99, 1.0, v99
    v_add_f32 v100, 1.0, v100
    v_add_f32 v101, 1.0, v101
    v_add_f32 v102, 1.0, v102
    v_add_f32 v103, 1.0, v103
    v_rcp_f32 v96, v96
    v_rcp_f32 v97, v97
    v_rcp_f32 v98, v98
    v_rcp_f32 v99, v99
    v_rcp_f32 v100, v100
    v_rcp_f32 v101, v101
    v_rcp_f32 v102, v102
    v_rcp_f32 v103, v103
    v_mul_f32 v136, v136, v96
    v_mul_f32 v137, v137, v97
    v_mul_f32 v138, v138, v98
    v_mul_f32 v139, v139, v99
    v_mul_f32 v140, v140, v100
    v_mul_f32 v141, v141, v101
    v_mul_f32 v142, v142, v102
    v_mul_f32 v143, v143, v103
    v_cvt_pk_bf16_f32 v84, v136, v137
    v_cvt_pk_bf16_f32 v85, v138, v139
    v_cvt_pk_bf16_f32 v86, v140, v141
    v_cvt_pk_bf16_f32 v87, v142, v143
    buffer_store_dwordx4 v[84:87], v19, s[4:7], s30 offen sc1
    s_add_u32 s30, s30, s50
    v_cvt_pk_bf16_f32 v88, v144, v145
    v_cvt_pk_bf16_f32 v89, v146, v147
    v_cvt_pk_bf16_f32 v90, v148, v149
    v_cvt_pk_bf16_f32 v91, v150, v151
    v_lshlrev_b32 v144, 16, v88
    v_and_b32 v145, 0xffff0000, v88
    v_lshlrev_b32 v146, 16, v89
    v_and_b32 v147, 0xffff0000, v89
    v_lshlrev_b32 v148, 16, v90
    v_and_b32 v149, 0xffff0000, v90
    v_lshlrev_b32 v150, 16, v91
    v_and_b32 v151, 0xffff0000, v91
    v_mul_f32 v104, s54, v144
    v_mul_f32 v105, s54, v145
    v_mul_f32 v106, s54, v146
    v_mul_f32 v107, s54, v147
    v_mul_f32 v108, s54, v148
    v_mul_f32 v109, s54, v149
    v_mul_f32 v110, s54, v150
    v_mul_f32 v111, s54, v151
    v_exp_f32 v104, v104
    v_exp_f32 v105, v105
    v_exp_f32 v106, v106
    v_exp_f32 v107, v107
    v_exp_f32 v108, v108
    v_exp_f32 v109, v109
    v_exp_f32 v110, v110
    v_exp_f32 v111, v111
    v_add_f32 v104, 1.0, v104
    v_add_f32 v105, 1.0, v105
    v_add_f32 v106, 1.0, v106
    v_add_f32 v107, 1.0, v107
    v_add_f32 v108, 1.0, v108
    v_add_f32 v109, 1.0, v109
    v_add_f32 v110, 1.0, v110
    v_add_f32 v111, 1.0, v111
    v_rcp_f32 v104, v104
    v_rcp_f32 v105, v105
    v_rcp_f32 v106, v106
    v_rcp_f32 v107, v107
    v_rcp_f32 v108, v108
    v_rcp_f32 v109, v109
    v_rcp_f32 v110, v110
    v_rcp_f32 v111, v111
    v_mul_f32 v144, v144, v104
    v_mul_f32 v145, v145, v105
    v_mul_f32 v146, v146, v106
    v_mul_f32 v147, v147, v107
    v_mul_f32 v148, v148, v108
    v_mul_f32 v149, v149, v109
    v_mul_f32 v150, v150, v110
    v_mul_f32 v151, v151, v111
    v_cvt_pk_bf16_f32 v88, v144, v145
    v_cvt_pk_bf16_f32 v89, v146, v147
    v_cvt_pk_bf16_f32 v90, v148, v149
    v_cvt_pk_bf16_f32 v91, v150, v151
    buffer_store_dwordx4 v[88:91], v1, s[4:7], s30 offen sc1
    v_cvt_pk_bf16_f32 v92, v152, v153
    v_cvt_pk_bf16_f32 v93, v154, v155
    v_cvt_pk_bf16_f32 v94, v156, v157
    v_cvt_pk_bf16_f32 v95, v158, v159
    v_lshlrev_b32 v152, 16, v92
    v_and_b32 v153, 0xffff0000, v92
    v_lshlrev_b32 v154, 16, v93
    v_and_b32 v155, 0xffff0000, v93
    v_lshlrev_b32 v156, 16, v94
    v_and_b32 v157, 0xffff0000, v94
    v_lshlrev_b32 v158, 16, v95
    v_and_b32 v159, 0xffff0000, v95
    v_mul_f32 v96, s54, v152
    v_mul_f32 v97, s54, v153
    v_mul_f32 v98, s54, v154
    v_mul_f32 v99, s54, v155
    v_mul_f32 v100, s54, v156
    v_mul_f32 v101, s54, v157
    v_mul_f32 v102, s54, v158
    v_mul_f32 v103, s54, v159
    v_exp_f32 v96, v96
    v_exp_f32 v97, v97
    v_exp_f32 v98, v98
    v_exp_f32 v99, v99
    v_exp_f32 v100, v100
    v_exp_f32 v101, v101
    v_exp_f32 v102, v102
    v_exp_f32 v103, v103
    v_add_f32 v96, 1.0, v96
    v_add_f32 v97, 1.0, v97
    v_add_f32 v98, 1.0, v98
    v_add_f32 v99, 1.0, v99
    v_add_f32 v100, 1.0, v100
    v_add_f32 v101, 1.0, v101
    v_add_f32 v102, 1.0, v102
    v_add_f32 v103, 1.0, v103
    v_rcp_f32 v96, v96
    v_rcp_f32 v97, v97
    v_rcp_f32 v98, v98
    v_rcp_f32 v99, v99
    v_rcp_f32 v100, v100
    v_rcp_f32 v101, v101
    v_rcp_f32 v102, v102
    v_rcp_f32 v103, v103
    v_mul_f32 v152, v152, v96
    v_mul_f32 v153, v153, v97
    v_mul_f32 v154, v154, v98
    v_mul_f32 v155, v155, v99
    v_mul_f32 v156, v156, v100
    v_mul_f32 v157, v157, v101
    v_mul_f32 v158, v158, v102
    v_mul_f32 v159, v159, v103
    v_cvt_pk_bf16_f32 v92, v152, v153
    v_cvt_pk_bf16_f32 v93, v154, v155
    v_cvt_pk_bf16_f32 v94, v156, v157
    v_cvt_pk_bf16_f32 v95, v158, v159
    buffer_store_dwordx4 v[92:95], v19, s[4:7], s30 offen sc1
    s_add_u32 s30, s30, s50
    v_cvt_pk_bf16_f32 v80, v160, v161
    v_cvt_pk_bf16_f32 v81, v162, v163
    v_cvt_pk_bf16_f32 v82, v164, v165
    v_cvt_pk_bf16_f32 v83, v166, v167
    v_lshlrev_b32 v160, 16, v80
    v_and_b32 v161, 0xffff0000, v80
    v_lshlrev_b32 v162, 16, v81
    v_and_b32 v163, 0xffff0000, v81
    v_lshlrev_b32 v164, 16, v82
    v_and_b32 v165, 0xffff0000, v82
    v_lshlrev_b32 v166, 16, v83
    v_and_b32 v167, 0xffff0000, v83
    v_mul_f32 v104, s54, v160
    v_mul_f32 v105, s54, v161
    v_mul_f32 v106, s54, v162
    v_mul_f32 v107, s54, v163
    v_mul_f32 v108, s54, v164
    v_mul_f32 v109, s54, v165
    v_mul_f32 v110, s54, v166
    v_mul_f32 v111, s54, v167
    v_exp_f32 v104, v104
    v_exp_f32 v105, v105
    v_exp_f32 v106, v106
    v_exp_f32 v107, v107
    v_exp_f32 v108, v108
    v_exp_f32 v109, v109
    v_exp_f32 v110, v110
    v_exp_f32 v111, v111
    v_add_f32 v104, 1.0, v104
    v_add_f32 v105, 1.0, v105
    v_add_f32 v106, 1.0, v106
    v_add_f32 v107, 1.0, v107
    v_add_f32 v108, 1.0, v108
    v_add_f32 v109, 1.0, v109
    v_add_f32 v110, 1.0, v110
    v_add_f32 v111, 1.0, v111
    v_rcp_f32 v104, v104
    v_rcp_f32 v105, v105
    v_rcp_f32 v106, v106
    v_rcp_f32 v107, v107
    v_rcp_f32 v108, v108
    v_rcp_f32 v109, v109
    v_rcp_f32 v110, v110
    v_rcp_f32 v111, v111
    v_mul_f32 v160, v160, v104
    v_mul_f32 v161, v161, v105
    v_mul_f32 v162, v162, v106
    v_mul_f32 v163, v163, v107
    v_mul_f32 v164, v164, v108
    v_mul_f32 v165, v165, v109
    v_mul_f32 v166, v166, v110
    v_mul_f32 v167, v167, v111
    v_cvt_pk_bf16_f32 v80, v160, v161
    v_cvt_pk_bf16_f32 v81, v162, v163
    v_cvt_pk_bf16_f32 v82, v164, v165
    v_cvt_pk_bf16_f32 v83, v166, v167
    buffer_store_dwordx4 v[80:83], v1, s[4:7], s30 offen sc1
    v_cvt_pk_bf16_f32 v84, v168, v169
    v_cvt_pk_bf16_f32 v85, v170, v171
    v_cvt_pk_bf16_f32 v86, v172, v173
    v_cvt_pk_bf16_f32 v87, v174, v175
    v_lshlrev_b32 v168, 16, v84
    v_and_b32 v169, 0xffff0000, v84
    v_lshlrev_b32 v170, 16, v85
    v_and_b32 v171, 0xffff0000, v85
    v_lshlrev_b32 v172, 16, v86
    v_and_b32 v173, 0xffff0000, v86
    v_lshlrev_b32 v174, 16, v87
    v_and_b32 v175, 0xffff0000, v87
    v_mul_f32 v96, s54, v168
    v_mul_f32 v97, s54, v169
    v_mul_f32 v98, s54, v170
    v_mul_f32 v99, s54, v171
    v_mul_f32 v100, s54, v172
    v_mul_f32 v101, s54, v173
    v_mul_f32 v102, s54, v174
    v_mul_f32 v103, s54, v175
    v_exp_f32 v96, v96
    v_exp_f32 v97, v97
    v_exp_f32 v98, v98
    v_exp_f32 v99, v99
    v_exp_f32 v100, v100
    v_exp_f32 v101, v101
    v_exp_f32 v102, v102
    v_exp_f32 v103, v103
    v_add_f32 v96, 1.0, v96
    v_add_f32 v97, 1.0, v97
    v_add_f32 v98, 1.0, v98
    v_add_f32 v99, 1.0, v99
    v_add_f32 v100, 1.0, v100
    v_add_f32 v101, 1.0, v101
    v_add_f32 v102, 1.0, v102
    v_add_f32 v103, 1.0, v103
    v_rcp_f32 v96, v96
    v_rcp_f32 v97, v97
    v_rcp_f32 v98, v98
    v_rcp_f32 v99, v99
    v_rcp_f32 v100, v100
    v_rcp_f32 v101, v101
    v_rcp_f32 v102, v102
    v_rcp_f32 v103, v103
    v_mul_f32 v168, v168, v96
    v_mul_f32 v169, v169, v97
    v_mul_f32 v170, v170, v98
    v_mul_f32 v171, v171, v99
    v_mul_f32 v172, v172, v100
    v_mul_f32 v173, v173, v101
    v_mul_f32 v174, v174, v102
    v_mul_f32 v175, v175, v103
    v_cvt_pk_bf16_f32 v84, v168, v169
    v_cvt_pk_bf16_f32 v85, v170, v171
    v_cvt_pk_bf16_f32 v86, v172, v173
    v_cvt_pk_bf16_f32 v87, v174, v175
    buffer_store_dwordx4 v[84:87], v19, s[4:7], s30 offen sc1
    s_add_u32 s30, s30, s50
    v_cvt_pk_bf16_f32 v88, v176, v177
    v_cvt_pk_bf16_f32 v89, v178, v179
    v_cvt_pk_bf16_f32 v90, v180, v181
    v_cvt_pk_bf16_f32 v91, v182, v183
    v_lshlrev_b32 v176, 16, v88
    v_and_b32 v177, 0xffff0000, v88
    v_lshlrev_b32 v178, 16, v89
    v_and_b32 v179, 0xffff0000, v89
    v_lshlrev_b32 v180, 16, v90
    v_and_b32 v181, 0xffff0000, v90
    v_lshlrev_b32 v182, 16, v91
    v_and_b32 v183, 0xffff0000, v91
    v_mul_f32 v104, s54, v176
    v_mul_f32 v105, s54, v177
    v_mul_f32 v106, s54, v178
    v_mul_f32 v107, s54, v179
    v_mul_f32 v108, s54, v180
    v_mul_f32 v109, s54, v181
    v_mul_f32 v110, s54, v182
    v_mul_f32 v111, s54, v183
    v_exp_f32 v104, v104
    v_exp_f32 v105, v105
    v_exp_f32 v106, v106
    v_exp_f32 v107, v107
    v_exp_f32 v108, v108
    v_exp_f32 v109, v109
    v_exp_f32 v110, v110
    v_exp_f32 v111, v111
    v_add_f32 v104, 1.0, v104
    v_add_f32 v105, 1.0, v105
    v_add_f32 v106, 1.0, v106
    v_add_f32 v107, 1.0, v107
    v_add_f32 v108, 1.0, v108
    v_add_f32 v109, 1.0, v109
    v_add_f32 v110, 1.0, v110
    v_add_f32 v111, 1.0, v111
    v_rcp_f32 v104, v104
    v_rcp_f32 v105, v105
    v_rcp_f32 v106, v106
    v_rcp_f32 v107, v107
    v_rcp_f32 v108, v108
    v_rcp_f32 v109, v109
    v_rcp_f32 v110, v110
    v_rcp_f32 v111, v111
    v_mul_f32 v176, v176, v104
    v_mul_f32 v177, v177, v105
    v_mul_f32 v178, v178, v106
    v_mul_f32 v179, v179, v107
    v_mul_f32 v180, v180, v108
    v_mul_f32 v181, v181, v109
    v_mul_f32 v182, v182, v110
    v_mul_f32 v183, v183, v111
    v_cvt_pk_bf16_f32 v88, v176, v177
    v_cvt_pk_bf16_f32 v89, v178, v179
    v_cvt_pk_bf16_f32 v90, v180, v181
    v_cvt_pk_bf16_f32 v91, v182, v183
    buffer_store_dwordx4 v[88:91], v1, s[4:7], s30 offen sc1
    v_cvt_pk_bf16_f32 v92, v184, v185
    v_cvt_pk_bf16_f32 v93, v186, v187
    v_cvt_pk_bf16_f32 v94, v188, v189
    v_cvt_pk_bf16_f32 v95, v190, v191
    v_lshlrev_b32 v184, 16, v92
    v_and_b32 v185, 0xffff0000, v92
    v_lshlrev_b32 v186, 16, v93
    v_and_b32 v187, 0xffff0000, v93
    v_lshlrev_b32 v188, 16, v94
    v_and_b32 v189, 0xffff0000, v94
    v_lshlrev_b32 v190, 16, v95
    v_and_b32 v191, 0xffff0000, v95
    v_mul_f32 v96, s54, v184
    v_mul_f32 v97, s54, v185
    v_mul_f32 v98, s54, v186
    v_mul_f32 v99, s54, v187
    v_mul_f32 v100, s54, v188
    v_mul_f32 v101, s54, v189
    v_mul_f32 v102, s54, v190
    v_mul_f32 v103, s54, v191
    v_exp_f32 v96, v96
    v_exp_f32 v97, v97
    v_exp_f32 v98, v98
    v_exp_f32 v99, v99
    v_exp_f32 v100, v100
    v_exp_f32 v101, v101
    v_exp_f32 v102, v102
    v_exp_f32 v103, v103
    v_add_f32 v96, 1.0, v96
    v_add_f32 v97, 1.0, v97
    v_add_f32 v98, 1.0, v98
    v_add_f32 v99, 1.0, v99
    v_add_f32 v100, 1.0, v100
    v_add_f32 v101, 1.0, v101
    v_add_f32 v102, 1.0, v102
    v_add_f32 v103, 1.0, v103
    v_rcp_f32 v96, v96
    v_rcp_f32 v97, v97
    v_rcp_f32 v98, v98
    v_rcp_f32 v99, v99
    v_rcp_f32 v100, v100
    v_rcp_f32 v101, v101
    v_rcp_f32 v102, v102
    v_rcp_f32 v103, v103
    v_mul_f32 v184, v184, v96
    v_mul_f32 v185, v185, v97
    v_mul_f32 v186, v186, v98
    v_mul_f32 v187, v187, v99
    v_mul_f32 v188, v188, v100
    v_mul_f32 v189, v189, v101
    v_mul_f32 v190, v190, v102
    v_mul_f32 v191, v191, v103
    v_cvt_pk_bf16_f32 v92, v184, v185
    v_cvt_pk_bf16_f32 v93, v186, v187
    v_cvt_pk_bf16_f32 v94, v188, v189
    v_cvt_pk_bf16_f32 v95, v190, v191
    buffer_store_dwordx4 v[92:95], v19, s[4:7], s30 offen sc1
    s_add_u32 s30, s30, s50
    v_cvt_pk_bf16_f32 v80, v192, v193
    v_cvt_pk_bf16_f32 v81, v194, v195
    v_cvt_pk_bf16_f32 v82, v196, v197
    v_cvt_pk_bf16_f32 v83, v198, v199
    v_lshlrev_b32 v192, 16, v80
    v_and_b32 v193, 0xffff0000, v80
    v_lshlrev_b32 v194, 16, v81
    v_and_b32 v195, 0xffff0000, v81
    v_lshlrev_b32 v196, 16, v82
    v_and_b32 v197, 0xffff0000, v82
    v_lshlrev_b32 v198, 16, v83
    v_and_b32 v199, 0xffff0000, v83
    v_mul_f32 v104, s54, v192
    v_mul_f32 v105, s54, v193
    v_mul_f32 v106, s54, v194
    v_mul_f32 v107, s54, v195
    v_mul_f32 v108, s54, v196
    v_mul_f32 v109, s54, v197
    v_mul_f32 v110, s54, v198
    v_mul_f32 v111, s54, v199
    v_exp_f32 v104, v104
    v_exp_f32 v105, v105
    v_exp_f32 v106, v106
    v_exp_f32 v107, v107
    v_exp_f32 v108, v108
    v_exp_f32 v109, v109
    v_exp_f32 v110, v110
    v_exp_f32 v111, v111
    v_add_f32 v104, 1.0, v104
    v_add_f32 v105, 1.0, v105
    v_add_f32 v106, 1.0, v106
    v_add_f32 v107, 1.0, v107
    v_add_f32 v108, 1.0, v108
    v_add_f32 v109, 1.0, v109
    v_add_f32 v110, 1.0, v110
    v_add_f32 v111, 1.0, v111
    v_rcp_f32 v104, v104
    v_rcp_f32 v105, v105
    v_rcp_f32 v106, v106
    v_rcp_f32 v107, v107
    v_rcp_f32 v108, v108
    v_rcp_f32 v109, v109
    v_rcp_f32 v110, v110
    v_rcp_f32 v111, v111
    v_mul_f32 v192, v192, v104
    v_mul_f32 v193, v193, v105
    v_mul_f32 v194, v194, v106
    v_mul_f32 v195, v195, v107
    v_mul_f32 v196, v196, v108
    v_mul_f32 v197, v197, v109
    v_mul_f32 v198, v198, v110
    v_mul_f32 v199, v199, v111
    v_cvt_pk_bf16_f32 v80, v192, v193
    v_cvt_pk_bf16_f32 v81, v194, v195
    v_cvt_pk_bf16_f32 v82, v196, v197
    v_cvt_pk_bf16_f32 v83, v198, v199
    buffer_store_dwordx4 v[80:83], v1, s[4:7], s30 offen sc1
    v_cvt_pk_bf16_f32 v84, v200, v201
    v_cvt_pk_bf16_f32 v85, v202, v203
    v_cvt_pk_bf16_f32 v86, v204, v205
    v_cvt_pk_bf16_f32 v87, v206, v207
    v_lshlrev_b32 v200, 16, v84
    v_and_b32 v201, 0xffff0000, v84
    v_lshlrev_b32 v202, 16, v85
    v_and_b32 v203, 0xffff0000, v85
    v_lshlrev_b32 v204, 16, v86
    v_and_b32 v205, 0xffff0000, v86
    v_lshlrev_b32 v206, 16, v87
    v_and_b32 v207, 0xffff0000, v87
    v_mul_f32 v96, s54, v200
    v_mul_f32 v97, s54, v201
    v_mul_f32 v98, s54, v202
    v_mul_f32 v99, s54, v203
    v_mul_f32 v100, s54, v204
    v_mul_f32 v101, s54, v205
    v_mul_f32 v102, s54, v206
    v_mul_f32 v103, s54, v207
    v_exp_f32 v96, v96
    v_exp_f32 v97, v97
    v_exp_f32 v98, v98
    v_exp_f32 v99, v99
    v_exp_f32 v100, v100
    v_exp_f32 v101, v101
    v_exp_f32 v102, v102
    v_exp_f32 v103, v103
    v_add_f32 v96, 1.0, v96
    v_add_f32 v97, 1.0, v97
    v_add_f32 v98, 1.0, v98
    v_add_f32 v99, 1.0, v99
    v_add_f32 v100, 1.0, v100
    v_add_f32 v101, 1.0, v101
    v_add_f32 v102, 1.0, v102
    v_add_f32 v103, 1.0, v103
    v_rcp_f32 v96, v96
    v_rcp_f32 v97, v97
    v_rcp_f32 v98, v98
    v_rcp_f32 v99, v99
    v_rcp_f32 v100, v100
    v_rcp_f32 v101, v101
    v_rcp_f32 v102, v102
    v_rcp_f32 v103, v103
    v_mul_f32 v200, v200, v96
    v_mul_f32 v201, v201, v97
    v_mul_f32 v202, v202, v98
    v_mul_f32 v203, v203, v99
    v_mul_f32 v204, v204, v100
    v_mul_f32 v205, v205, v101
    v_mul_f32 v206, v206, v102
    v_mul_f32 v207, v207, v103
    v_cvt_pk_bf16_f32 v84, v200, v201
    v_cvt_pk_bf16_f32 v85, v202, v203
    v_cvt_pk_bf16_f32 v86, v204, v205
    v_cvt_pk_bf16_f32 v87, v206, v207
    buffer_store_dwordx4 v[84:87], v19, s[4:7], s30 offen sc1
    s_add_u32 s30, s30, s50
    v_cvt_pk_bf16_f32 v88, v208, v209
    v_cvt_pk_bf16_f32 v89, v210, v211
    v_cvt_pk_bf16_f32 v90, v212, v213
    v_cvt_pk_bf16_f32 v91, v214, v215
    v_lshlrev_b32 v208, 16, v88
    v_and_b32 v209, 0xffff0000, v88
    v_lshlrev_b32 v210, 16, v89
    v_and_b32 v211, 0xffff0000, v89
    v_lshlrev_b32 v212, 16, v90
    v_and_b32 v213, 0xffff0000, v90
    v_lshlrev_b32 v214, 16, v91
    v_and_b32 v215, 0xffff0000, v91
    v_mul_f32 v104, s54, v208
    v_mul_f32 v105, s54, v209
    v_mul_f32 v106, s54, v210
    v_mul_f32 v107, s54, v211
    v_mul_f32 v108, s54, v212
    v_mul_f32 v109, s54, v213
    v_mul_f32 v110, s54, v214
    v_mul_f32 v111, s54, v215
    v_exp_f32 v104, v104
    v_exp_f32 v105, v105
    v_exp_f32 v106, v106
    v_exp_f32 v107, v107
    v_exp_f32 v108, v108
    v_exp_f32 v109, v109
    v_exp_f32 v110, v110
    v_exp_f32 v111, v111
    v_add_f32 v104, 1.0, v104
    v_add_f32 v105, 1.0, v105
    v_add_f32 v106, 1.0, v106
    v_add_f32 v107, 1.0, v107
    v_add_f32 v108, 1.0, v108
    v_add_f32 v109, 1.0, v109
    v_add_f32 v110, 1.0, v110
    v_add_f32 v111, 1.0, v111
    v_rcp_f32 v104, v104
    v_rcp_f32 v105, v105
    v_rcp_f32 v106, v106
    v_rcp_f32 v107, v107
    v_rcp_f32 v108, v108
    v_rcp_f32 v109, v109
    v_rcp_f32 v110, v110
    v_rcp_f32 v111, v111
    v_mul_f32 v208, v208, v104
    v_mul_f32 v209, v209, v105
    v_mul_f32 v210, v210, v106
    v_mul_f32 v211, v211, v107
    v_mul_f32 v212, v212, v108
    v_mul_f32 v213, v213, v109
    v_mul_f32 v214, v214, v110
    v_mul_f32 v215, v215, v111
    v_cvt_pk_bf16_f32 v88, v208, v209
    v_cvt_pk_bf16_f32 v89, v210, v211
    v_cvt_pk_bf16_f32 v90, v212, v213
    v_cvt_pk_bf16_f32 v91, v214, v215
    buffer_store_dwordx4 v[88:91], v1, s[4:7], s30 offen sc1
    v_cvt_pk_bf16_f32 v92, v216, v217
    v_cvt_pk_bf16_f32 v93, v218, v219
    v_cvt_pk_bf16_f32 v94, v220, v221
    v_cvt_pk_bf16_f32 v95, v222, v223
    v_lshlrev_b32 v216, 16, v92
    v_and_b32 v217, 0xffff0000, v92
    v_lshlrev_b32 v218, 16, v93
    v_and_b32 v219, 0xffff0000, v93
    v_lshlrev_b32 v220, 16, v94
    v_and_b32 v221, 0xffff0000, v94
    v_lshlrev_b32 v222, 16, v95
    v_and_b32 v223, 0xffff0000, v95
    v_mul_f32 v96, s54, v216
    v_mul_f32 v97, s54, v217
    v_mul_f32 v98, s54, v218
    v_mul_f32 v99, s54, v219
    v_mul_f32 v100, s54, v220
    v_mul_f32 v101, s54, v221
    v_mul_f32 v102, s54, v222
    v_mul_f32 v103, s54, v223
    v_exp_f32 v96, v96
    v_exp_f32 v97, v97
    v_exp_f32 v98, v98
    v_exp_f32 v99, v99
    v_exp_f32 v100, v100
    v_exp_f32 v101, v101
    v_exp_f32 v102, v102
    v_exp_f32 v103, v103
    v_add_f32 v96, 1.0, v96
    v_add_f32 v97, 1.0, v97
    v_add_f32 v98, 1.0, v98
    v_add_f32 v99, 1.0, v99
    v_add_f32 v100, 1.0, v100
    v_add_f32 v101, 1.0, v101
    v_add_f32 v102, 1.0, v102
    v_add_f32 v103, 1.0, v103
    v_rcp_f32 v96, v96
    v_rcp_f32 v97, v97
    v_rcp_f32 v98, v98
    v_rcp_f32 v99, v99
    v_rcp_f32 v100, v100
    v_rcp_f32 v101, v101
    v_rcp_f32 v102, v102
    v_rcp_f32 v103, v103
    v_mul_f32 v216, v216, v96
    v_mul_f32 v217, v217, v97
    v_mul_f32 v218, v218, v98
    v_mul_f32 v219, v219, v99
    v_mul_f32 v220, v220, v100
    v_mul_f32 v221, v221, v101
    v_mul_f32 v222, v222, v102
    v_mul_f32 v223, v223, v103
    v_cvt_pk_bf16_f32 v92, v216, v217
    v_cvt_pk_bf16_f32 v93, v218, v219
    v_cvt_pk_bf16_f32 v94, v220, v221
    v_cvt_pk_bf16_f32 v95, v222, v223
    buffer_store_dwordx4 v[92:95], v19, s[4:7], s30 offen sc1
    s_add_u32 s30, s30, s50
    v_cvt_pk_bf16_f32 v80, v224, v225
    v_cvt_pk_bf16_f32 v81, v226, v227
    v_cvt_pk_bf16_f32 v82, v228, v229
    v_cvt_pk_bf16_f32 v83, v230, v231
    v_lshlrev_b32 v224, 16, v80
    v_and_b32 v225, 0xffff0000, v80
    v_lshlrev_b32 v226, 16, v81
    v_and_b32 v227, 0xffff0000, v81
    v_lshlrev_b32 v228, 16, v82
    v_and_b32 v229, 0xffff0000, v82
    v_lshlrev_b32 v230, 16, v83
    v_and_b32 v231, 0xffff0000, v83
    v_mul_f32 v104, s54, v224
    v_mul_f32 v105, s54, v225
    v_mul_f32 v106, s54, v226
    v_mul_f32 v107, s54, v227
    v_mul_f32 v108, s54, v228
    v_mul_f32 v109, s54, v229
    v_mul_f32 v110, s54, v230
    v_mul_f32 v111, s54, v231
    v_exp_f32 v104, v104
    v_exp_f32 v105, v105
    v_exp_f32 v106, v106
    v_exp_f32 v107, v107
    v_exp_f32 v108, v108
    v_exp_f32 v109, v109
    v_exp_f32 v110, v110
    v_exp_f32 v111, v111
    v_add_f32 v104, 1.0, v104
    v_add_f32 v105, 1.0, v105
    v_add_f32 v106, 1.0, v106
    v_add_f32 v107, 1.0, v107
    v_add_f32 v108, 1.0, v108
    v_add_f32 v109, 1.0, v109
    v_add_f32 v110, 1.0, v110
    v_add_f32 v111, 1.0, v111
    v_rcp_f32 v104, v104
    v_rcp_f32 v105, v105
    v_rcp_f32 v106, v106
    v_rcp_f32 v107, v107
    v_rcp_f32 v108, v108
    v_rcp_f32 v109, v109
    v_rcp_f32 v110, v110
    v_rcp_f32 v111, v111
    v_mul_f32 v224, v224, v104
    v_mul_f32 v225, v225, v105
    v_mul_f32 v226, v226, v106
    v_mul_f32 v227, v227, v107
    v_mul_f32 v228, v228, v108
    v_mul_f32 v229, v229, v109
    v_mul_f32 v230, v230, v110
    v_mul_f32 v231, v231, v111
    v_cvt_pk_bf16_f32 v80, v224, v225
    v_cvt_pk_bf16_f32 v81, v226, v227
    v_cvt_pk_bf16_f32 v82, v228, v229
    v_cvt_pk_bf16_f32 v83, v230, v231
    buffer_store_dwordx4 v[80:83], v1, s[4:7], s30 offen sc1
    v_cvt_pk_bf16_f32 v84, v232, v233
    v_cvt_pk_bf16_f32 v85, v234, v235
    v_cvt_pk_bf16_f32 v86, v236, v237
    v_cvt_pk_bf16_f32 v87, v238, v239
    v_lshlrev_b32 v232, 16, v84
    v_and_b32 v233, 0xffff0000, v84
    v_lshlrev_b32 v234, 16, v85
    v_and_b32 v235, 0xffff0000, v85
    v_lshlrev_b32 v236, 16, v86
    v_and_b32 v237, 0xffff0000, v86
    v_lshlrev_b32 v238, 16, v87
    v_and_b32 v239, 0xffff0000, v87
    v_mul_f32 v96, s54, v232
    v_mul_f32 v97, s54, v233
    v_mul_f32 v98, s54, v234
    v_mul_f32 v99, s54, v235
    v_mul_f32 v100, s54, v236
    v_mul_f32 v101, s54, v237
    v_mul_f32 v102, s54, v238
    v_mul_f32 v103, s54, v239
    v_exp_f32 v96, v96
    v_exp_f32 v97, v97
    v_exp_f32 v98, v98
    v_exp_f32 v99, v99
    v_exp_f32 v100, v100
    v_exp_f32 v101, v101
    v_exp_f32 v102, v102
    v_exp_f32 v103, v103
    v_add_f32 v96, 1.0, v96
    v_add_f32 v97, 1.0, v97
    v_add_f32 v98, 1.0, v98
    v_add_f32 v99, 1.0, v99
    v_add_f32 v100, 1.0, v100
    v_add_f32 v101, 1.0, v101
    v_add_f32 v102, 1.0, v102
    v_add_f32 v103, 1.0, v103
    v_rcp_f32 v96, v96
    v_rcp_f32 v97, v97
    v_rcp_f32 v98, v98
    v_rcp_f32 v99, v99
    v_rcp_f32 v100, v100
    v_rcp_f32 v101, v101
    v_rcp_f32 v102, v102
    v_rcp_f32 v103, v103
    v_mul_f32 v232, v232, v96
    v_mul_f32 v233, v233, v97
    v_mul_f32 v234, v234, v98
    v_mul_f32 v235, v235, v99
    v_mul_f32 v236, v236, v100
    v_mul_f32 v237, v237, v101
    v_mul_f32 v238, v238, v102
    v_mul_f32 v239, v239, v103
    v_cvt_pk_bf16_f32 v84, v232, v233
    v_cvt_pk_bf16_f32 v85, v234, v235
    v_cvt_pk_bf16_f32 v86, v236, v237
    v_cvt_pk_bf16_f32 v87, v238, v239
    buffer_store_dwordx4 v[84:87], v19, s[4:7], s30 offen sc1
    s_add_u32 s30, s30, s50
    v_cvt_pk_bf16_f32 v88, v240, v241
    v_cvt_pk_bf16_f32 v89, v242, v243
    v_cvt_pk_bf16_f32 v90, v244, v245
    v_cvt_pk_bf16_f32 v91, v246, v247
    v_lshlrev_b32 v240, 16, v88
    v_and_b32 v241, 0xffff0000, v88
    v_lshlrev_b32 v242, 16, v89
    v_and_b32 v243, 0xffff0000, v89
    v_lshlrev_b32 v244, 16, v90
    v_and_b32 v245, 0xffff0000, v90
    v_lshlrev_b32 v246, 16, v91
    v_and_b32 v247, 0xffff0000, v91
    v_mul_f32 v104, s54, v240
    v_mul_f32 v105, s54, v241
    v_mul_f32 v106, s54, v242
    v_mul_f32 v107, s54, v243
    v_mul_f32 v108, s54, v244
    v_mul_f32 v109, s54, v245
    v_mul_f32 v110, s54, v246
    v_mul_f32 v111, s54, v247
    v_exp_f32 v104, v104
    v_exp_f32 v105, v105
    v_exp_f32 v106, v106
    v_exp_f32 v107, v107
    v_exp_f32 v108, v108
    v_exp_f32 v109, v109
    v_exp_f32 v110, v110
    v_exp_f32 v111, v111
    v_add_f32 v104, 1.0, v104
    v_add_f32 v105, 1.0, v105
    v_add_f32 v106, 1.0, v106
    v_add_f32 v107, 1.0, v107
    v_add_f32 v108, 1.0, v108
    v_add_f32 v109, 1.0, v109
    v_add_f32 v110, 1.0, v110
    v_add_f32 v111, 1.0, v111
    v_rcp_f32 v104, v104
    v_rcp_f32 v105, v105
    v_rcp_f32 v106, v106
    v_rcp_f32 v107, v107
    v_rcp_f32 v108, v108
    v_rcp_f32 v109, v109
    v_rcp_f32 v110, v110
    v_rcp_f32 v111, v111
    v_mul_f32 v240, v240, v104
    v_mul_f32 v241, v241, v105
    v_mul_f32 v242, v242, v106
    v_mul_f32 v243, v243, v107
    v_mul_f32 v244, v244, v108
    v_mul_f32 v245, v245, v109
    v_mul_f32 v246, v246, v110
    v_mul_f32 v247, v247, v111
    v_cvt_pk_bf16_f32 v88, v240, v241
    v_cvt_pk_bf16_f32 v89, v242, v243
    v_cvt_pk_bf16_f32 v90, v244, v245
    v_cvt_pk_bf16_f32 v91, v246, v247
    buffer_store_dwordx4 v[88:91], v1, s[4:7], s30 offen sc1
    v_cvt_pk_bf16_f32 v92, v248, v249
    v_cvt_pk_bf16_f32 v93, v250, v251
    v_cvt_pk_bf16_f32 v94, v252, v253
    v_cvt_pk_bf16_f32 v95, v254, v255
    v_lshlrev_b32 v248, 16, v92
    v_and_b32 v249, 0xffff0000, v92
    v_lshlrev_b32 v250, 16, v93
    v_and_b32 v251, 0xffff0000, v93
    v_lshlrev_b32 v252, 16, v94
    v_and_b32 v253, 0xffff0000, v94
    v_lshlrev_b32 v254, 16, v95
    v_and_b32 v255, 0xffff0000, v95
    v_mul_f32 v96, s54, v248
    v_mul_f32 v97, s54, v249
    v_mul_f32 v98, s54, v250
    v_mul_f32 v99, s54, v251
    v_mul_f32 v100, s54, v252
    v_mul_f32 v101, s54, v253
    v_mul_f32 v102, s54, v254
    v_mul_f32 v103, s54, v255
    v_exp_f32 v96, v96
    v_exp_f32 v97, v97
    v_exp_f32 v98, v98
    v_exp_f32 v99, v99
    v_exp_f32 v100, v100
    v_exp_f32 v101, v101
    v_exp_f32 v102, v102
    v_exp_f32 v103, v103
    v_add_f32 v96, 1.0, v96
    v_add_f32 v97, 1.0, v97
    v_add_f32 v98, 1.0, v98
    v_add_f32 v99, 1.0, v99
    v_add_f32 v100, 1.0, v100
    v_add_f32 v101, 1.0, v101
    v_add_f32 v102, 1.0, v102
    v_add_f32 v103, 1.0, v103
    v_rcp_f32 v96, v96
    v_rcp_f32 v97, v97
    v_rcp_f32 v98, v98
    v_rcp_f32 v99, v99
    v_rcp_f32 v100, v100
    v_rcp_f32 v101, v101
    v_rcp_f32 v102, v102
    v_rcp_f32 v103, v103
    v_mul_f32 v248, v248, v96
    v_mul_f32 v249, v249, v97
    v_mul_f32 v250, v250, v98
    v_mul_f32 v251, v251, v99
    v_mul_f32 v252, v252, v100
    v_mul_f32 v253, v253, v101
    v_mul_f32 v254, v254, v102
    v_mul_f32 v255, v255, v103
    v_cvt_pk_bf16_f32 v92, v248, v249
    v_cvt_pk_bf16_f32 v93, v250, v251
    v_cvt_pk_bf16_f32 v94, v252, v253
    v_cvt_pk_bf16_f32 v95, v254, v255
    buffer_store_dwordx4 v[92:95], v19, s[4:7], s30 offen sc1
    s_waitcnt lgkmcnt(0)
    v_or3_b32 v24, v24, v25, v26
    v_or3_b32 v28, v28, v29, v30
    v_or3_b32 v24, v24, v27, v31
    v_or_b32 v24, v24, v28
    s_mov_b32 s28, s51
    s_mov_b32 s57, s53
    v_readfirstlane_b32 s30, v24
    s_cmp_lg_u32 s30, 0
    s_cbranch_scc1 w_drain
    s_mov_b32 s48, s32
    s_cmp_ge_u32 s32, 4
    s_cselect_b32 s30, 2, 3
    s_lshl_b32 s30, s26, s30
    s_mul_i32 s30, s30, s43
    s_add_u32 s49, s42, s30
    s_mov_b32 s50, s43
    s_mov_b32 s51, s46
    s_mov_b32 s23, s41
    s_mov_b32 s53, s47
    s_nop 0
    s_load_dwordx16 s[32:47], s[24:25], 0
    s_add_u32 s24, s24, 64
    s_addc_u32 s25, s25, 0
    s_branch w_first16
w_firstH:
    s_waitcnt vmcnt(8)
    s_barrier
    s_add_u32 m0, s21, 0
    s_nop 0
    buffer_load_dwordx4 v1, s[4:7], s16 offen sc1 lds
    s_add_u32 s16, s16, s62
    s_add_u32 m0, s21, 1024
    s_nop 0
    buffer_load_dwordx4 v1, s[4:7], s17 offen sc1 lds
    s_add_u32 s17, s17, s62
    s_add_u32 m0, s22, 0
    s_nop 0
    buffer_load_dwordx4 v2, s[8:11], s18 offen lds
    s_add_u32 s18, s18, s20
    s_add_u32 m0, s22, 8192
    s_nop 0
    buffer_load_dwordx4 v2, s[12:15], s19 offen lds
    s_add_u32 s19, s19, s20
    v_mfma_f32_16x16x32_bf16 v[128:131], v[64:67], v[32:35], 0
    ds_read_b64_tr_b16 v[112:113], v8 offset:49152
    v_mfma_f32_16x16x32_bf16 v[132:135], v[68:71], v[32:35], 0
    ds_read_b64_tr_b16 v[114:115], v9 offset:49152
    v_mfma_f32_16x16x32_bf16 v[144:147], v[64:67], v[40:43], 0
    ds_read_b64_tr_b16 v[116:117], v10 offset:49152
    v_mfma_f32_16x16x32_bf16 v[148:151], v[68:71], v[40:43], 0
    ds_read_b64_tr_b16 v[118:119], v11 offset:49152
    v_mfma_f32_16x16x32_bf16 v[160:163], v[64:67], v[48:51], 0
    ds_read_b64_tr_b16 v[120:121], v8 offset:57344
    v_mfma_f32_16x16x32_bf16 v[164:167], v[68:71], v[48:51], 0
    ds_read_b64_tr_b16 v[122:123], v9 offset:57344
    v_mfma_f32_16x16x32_bf16 v[176:179], v[64:67], v[56:59], 0
    ds_read_b64_tr_b16 v[124:125], v10 offset:57344
    v_mfma_f32_16x16x32_bf16 v[180:183], v[68:71], v[56:59], 0
    ds_read_b64_tr_b16 v[126:127], v11 offset:57344
    v_mfma_f32_16x16x32_bf16 v[128:131], v[72:75], v[36:39], v[128:131]
    ds_read_b128 v[80:83], v5 offset:32768
    v_mfma_f32_16x16x32_bf16 v[132:135], v[76:79], v[36:39], v[132:135]
    ds_read_b128 v[84:87], v5 offset:33792
    v_mfma_f32_16x16x32_bf16 v[144:147], v[72:75], v[44:47], v[144:147]
    ds_read_b128 v[88:91], v5 offset:34816
    v_mfma_f32_16x16x32_bf16 v[148:151], v[76:79], v[44:47], v[148:151]
    ds_read_b128 v[92:95], v5 offset:35840
    v_mfma_f32_16x16x32_bf16 v[160:163], v[72:75], v[52:55], v[160:163]
    ds_read_b128 v[96:99], v5 offset:36864
    v_mfma_f32_16x16x32_bf16 v[164:167], v[76:79], v[52:55], v[164:167]
    ds_read_b128 v[100:103], v5 offset:37888
    v_mfma_f32_16x16x32_bf16 v[176:179], v[72:75], v[60:63], v[176:179]
    ds_read_b128 v[104:107], v5 offset:38912
    v_mfma_f32_16x16x32_bf16 v[180:183], v[76:79], v[60:63], v[180:183]
    ds_read_b128 v[108:111], v5 offset:39936
    s_waitcnt lgkmcnt(0)
    s_waitcnt vmcnt(8)
    s_barrier
    s_add_u32 m0, s21, 32768
    s_nop 0
    buffer_load_dwordx4 v1, s[4:7], s16 offen sc1 lds
    s_add_u32 s16, s16, s62
    s_add_u32 m0, s21, 33792
    s_nop 0
    buffer_load_dwordx4 v1, s[4:7], s17 offen sc1 lds
    s_add_u32 s17, s17, s62
    s_add_u32 m0, s22, 32768
    s_nop 0
    buffer_load_dwordx4 v2, s[8:11], s18 offen lds
    s_add_u32 s18, s18, s20
    s_add_u32 m0, s22, 40960
    s_nop 0
    buffer_load_dwordx4 v2, s[12:15], s19 offen lds
    s_add_u32 s19, s19, s20
    v_mfma_f32_16x16x32_bf16 v[128:131], v[112:115], v[80:83], v[128:131]
    ds_read_b64_tr_b16 v[64:65], v12 offset:16384
    v_mfma_f32_16x16x32_bf16 v[132:135], v[116:119], v[80:83], v[132:135]
    ds_read_b64_tr_b16 v[66:67], v13 offset:16384
    v_mfma_f32_16x16x32_bf16 v[144:147], v[112:115], v[88:91], v[144:147]
    ds_read_b64_tr_b16 v[68:69], v14 offset:16384
    v_mfma_f32_16x16x32_bf16 v[148:151], v[116:119], v[88:91], v[148:151]
    ds_read_b64_tr_b16 v[70:71], v15 offset:16384
    v_mfma_f32_16x16x32_bf16 v[160:163], v[112:115], v[96:99], v[160:163]
    ds_read_b64_tr_b16 v[72:73], v12 offset:24576
    v_mfma_f32_16x16x32_bf16 v[164:167], v[116:119], v[96:99], v[164:167]
    ds_read_b64_tr_b16 v[74:75], v13 offset:24576
    v_mfma_f32_16x16x32_bf16 v[176:179], v[112:115], v[104:107], v[176:179]
    ds_read_b64_tr_b16 v[76:77], v14 offset:24576
    v_mfma_f32_16x16x32_bf16 v[180:183], v[116:119], v[104:107], v[180:183]
    ds_read_b64_tr_b16 v[78:79], v15 offset:24576
    v_mfma_f32_16x16x32_bf16 v[128:131], v[120:123], v[84:87], v[128:131]
    ds_read_b128 v[32:35], v6 offset:0
    v_mfma_f32_16x16x32_bf16 v[132:135], v[124:127], v[84:87], v[132:135]
    ds_read_b128 v[36:39], v6 offset:1024
    v_mfma_f32_16x16x32_bf16 v[144:147], v[120:123], v[92:95], v[144:147]
    ds_read_b128 v[40:43], v6 offset:2048
    v_mfma_f32_16x16x32_bf16 v[148:151], v[124:127], v[92:95], v[148:151]
    ds_read_b128 v[44:47], v6 offset:3072
    v_mfma_f32_16x16x32_bf16 v[160:163], v[120:123], v[100:103], v[160:163]
    ds_read_b128 v[48:51], v6 offset:4096
    v_mfma_f32_16x16x32_bf16 v[164:167], v[124:127], v[100:103], v[164:167]
    ds_read_b128 v[52:55], v6 offset:5120
    v_mfma_f32_16x16x32_bf16 v[176:179], v[120:123], v[108:111], v[176:179]
    ds_read_b128 v[56:59], v6 offset:6144
    v_mfma_f32_16x16x32_bf16 v[180:183], v[124:127], v[108:111], v[180:183]
    ds_read_b128 v[60:63], v6 offset:7168
    s_waitcnt lgkmcnt(0)
    s_waitcnt vmcnt(8)
    s_barrier
    s_add_u32 m0, s21, 65536
    s_nop 0
    buffer_load_dwordx4 v1, s[4:7], s16 offen sc1 lds
    s_add_u32 s16, s16, s62
    s_add_u32 m0, s21, 66560
    s_nop 0
    buffer_load_dwordx4 v1, s[4:7], s17 offen sc1 lds
    s_add_u32 s17, s17, s62
    s_add_u32 m0, s22, 65536
    s_nop 0
    buffer_load_dwordx4 v2, s[8:11], s18 offen lds
    s_add_u32 s18, s18, s20
    s_add_u32 m0, s22, 73728
    s_nop 0
    buffer_load_dwordx4 v2, s[12:15], s19 offen lds
    s_add_u32 s19, s19, s20
    v_mfma_f32_16x16x32_bf16 v[128:131], v[64:67], v[32:35], v[128:131]
    ds_read_b64_tr_b16 v[112:113], v12 offset:49152
    v_mfma_f32_16x16x32_bf16 v[132:135], v[68:71], v[32:35], v[132:135]
    ds_read_b64_tr_b16 v[114:115], v13 offset:49152
    v_mfma_f32_16x16x32_bf16 v[144:147], v[64:67], v[40:43], v[144:147]
    ds_read_b64_tr_b16 v[116:117], v14 offset:49152
    v_mfma_f32_16x16x32_bf16 v[148:151], v[68:71], v[40:43], v[148:151]
    ds_read_b64_tr_b16 v[118:119], v15 offset:49152
    v_mfma_f32_16x16x32_bf16 v[160:163], v[64:67], v[48:51], v[160:163]
    ds_read_b64_tr_b16 v[120:121], v12 offset:57344
    v_mfma_f32_16x16x32_bf16 v[164:167], v[68:71], v[48:51], v[164:167]
    ds_read_b64_tr_b16 v[122:123], v13 offset:57344
    v_mfma_f32_16x16x32_bf16 v[176:179], v[64:67], v[56:59], v[176:179]
    ds_read_b64_tr_b16 v[124:125], v14 offset:57344
    v_mfma_f32_16x16x32_bf16 v[180:183], v[68:71], v[56:59], v[180:183]
    ds_read_b64_tr_b16 v[126:127], v15 offset:57344
    v_mfma_f32_16x16x32_bf16 v[128:131], v[72:75], v[36:39], v[128:131]
    ds_read_b128 v[80:83], v6 offset:32768
    v_mfma_f32_16x16x32_bf16 v[132:135], v[76:79], v[36:39], v[132:135]
    ds_read_b128 v[84:87], v6 offset:33792
    v_mfma_f32_16x16x32_bf16 v[144:147], v[72:75], v[44:47], v[144:147]
    ds_read_b128 v[88:91], v6 offset:34816
    v_mfma_f32_16x16x32_bf16 v[148:151], v[76:79], v[44:47], v[148:151]
    ds_read_b128 v[92:95], v6 offset:35840
    v_mfma_f32_16x16x32_bf16 v[160:163], v[72:75], v[52:55], v[160:163]
    ds_read_b128 v[96:99], v6 offset:36864
    v_mfma_f32_16x16x32_bf16 v[164:167], v[76:79], v[52:55], v[164:167]
    ds_read_b128 v[100:103], v6 offset:37888
    v_mfma_f32_16x16x32_bf16 v[176:179], v[72:75], v[60:63], v[176:179]
    ds_read_b128 v[104:107], v6 offset:38912
    v_mfma_f32_16x16x32_bf16 v[180:183], v[76:79], v[60:63], v[180:183]
    ds_read_b128 v[108:111], v6 offset:39936
    s_waitcnt lgkmcnt(0)
    s_waitcnt vmcnt(8)
    s_barrier
    s_add_u32 m0, s21, 98304
    s_nop 0
    buffer_load_dwordx4 v1, s[4:7], s16 offen sc1 lds
    s_add_u32 s16, s16, s62
    s_add_u32 m0, s21, 99328
    s_nop 0
    buffer_load_dwordx4 v1, s[4:7], s17 offen sc1 lds
    s_add_u32 s17, s17, s62
    s_add_u32 m0, s22, 98304
    s_nop 0
    buffer_load_dwordx4 v2, s[8:11], s18 offen lds
    s_add_u32 s18, s18, s20
    s_add_u32 m0, s22, 106496
    s_nop 0
    buffer_load_dwordx4 v2, s[12:15], s19 offen lds
    s_add_u32 s19, s19, s20
    v_mfma_f32_16x16x32_bf16 v[128:131], v[112:115], v[80:83], v[128:131]
    ds_read_b64_tr_b16 v[64:65], v8 offset:16384
    v_mfma_f32_16x16x32_bf16 v[132:135], v[116:119], v[80:83], v[132:135]
    ds_read_b64_tr_b16 v[66:67], v9 offset:16384
    v_mfma_f32_16x16x32_bf16 v[144:147], v[112:115], v[88:91], v[144:147]
    ds_read_b64_tr_b16 v[68:69], v10 offset:16384
    v_mfma_f32_16x16x32_bf16 v[148:151], v[116:119], v[88:91], v[148:151]
    ds_read_b64_tr_b16 v[70:71], v11 offset:16384
    v_mfma_f32_16x16x32_bf16 v[160:163], v[112:115], v[96:99], v[160:163]
    ds_read_b64_tr_b16 v[72:73], v8 offset:24576
    v_mfma_f32_16x16x32_bf16 v[164:167], v[116:119], v[96:99], v[164:167]
    ds_read_b64_tr_b16 v[74:75], v9 offset:24576
    v_mfma_f32_16x16x32_bf16 v[176:179], v[112:115], v[104:107], v[176:179]
    ds_read_b64_tr_b16 v[76:77], v10 offset:24576
    v_mfma_f32_16x16x32_bf16 v[180:183], v[116:119], v[104:107], v[180:183]
    ds_read_b64_tr_b16 v[78:79], v11 offset:24576
    v_mfma_f32_16x16x32_bf16 v[128:131], v[120:123], v[84:87], v[128:131]
    ds_read_b128 v[32:35], v5 offset:0
    v_mfma_f32_16x16x32_bf16 v[132:135], v[124:127], v[84:87], v[132:135]
    ds_read_b128 v[36:39], v5 offset:1024
    v_mfma_f32_16x16x32_bf16 v[144:147], v[120:123], v[92:95], v[144:147]
    ds_read_b128 v[40:43], v5 offset:2048
    v_mfma_f32_16x16x32_bf16 v[148:151], v[124:127], v[92:95], v[148:151]
    ds_read_b128 v[44:47], v5 offset:3072
    v_mfma_f32_16x16x32_bf16 v[160:163], v[120:123], v[100:103], v[160:163]
    ds_read_b128 v[48:51], v5 offset:4096
    v_mfma_f32_16x16x32_bf16 v[164:167], v[124:127], v[100:103], v[164:167]
    ds_read_b128 v[52:55], v5 offset:5120
    v_mfma_f32_16x16x32_bf16 v[176:179], v[120:123], v[108:111], v[176:179]
    ds_read_b128 v[56:59], v5 offset:6144
    v_mfma_f32_16x16x32_bf16 v[180:183], v[124:127], v[108:111], v[180:183]
    ds_read_b128 v[60:63], v5 offset:7168
    s_waitcnt lgkmcnt(0)
w_loop_chkH:
    s_sub_u32 s23, s23, 1
w_loopH:
    s_cmp_lg_u32 s23, 1
    s_cbranch_scc1 w_bodyH
    buffer_load_dword v22, off, s[64:67], 0 sc1
    v_readfirstlane_b32 s30, v16
    s_cmp_ge_u32 s30, s45
    s_cselect_b32 s30, 0, 1
    s_or_b32 s30, s30, s70
    s_cmp_ge_u32 s32, 4
    s_cselect_b32 s30, 1, s30
    s_cmp_eq_u32 s32, 0
    s_cselect_b32 s30, 1, s30
    v_mov_b32 v20, s30
    ds_write_b32 v7, v20
    s_cbranch_scc1 w_ndH
    s_cmp_ge_u32 s32, 4
    s_cbranch_scc1 w_ndH
    s_cmp_lg_u32 s70, 0
    s_cbranch_scc1 w_ndH
    s_load_dwordx2 s[8:9], s[0:1], s33
    s_load_dwordx2 s[12:13], s[0:1], s34
    s_mov_b32 s10, s38
    s_mov_b32 s14, s38
    s_cmp_ge_u32 s32, 4
    s_cselect_b32 s31, 0, 1
    s_lshl_b32 s30, s3, s31
    s_mul_i32 s30, s30, s40
    s_add_u32 s16, s39, s30
    s_cmp_eq_u32 s32, 4
    s_cselect_b32 s30, 1024, s40
    s_cselect_b32 s31, 6, 5
    s_lshl_b32 s62, 32, s31
    s_add_u32 s17, s16, s30
    s_lshl_b32 s30, s3, 2
    s_mul_i32 s30, s30, s35
    s_add_u32 s18, s36, s30
    s_add_u32 s19, s37, s30
    s_lshl_b32 s20, s35, s31
    v_mul_u32_u24 v2, s35, v4
    v_add_u32 v2, v2, v3
    s_waitcnt lgkmcnt(0)
w_bodyH:
    s_waitcnt vmcnt(8)
    s_barrier
    s_add_u32 m0, s21, 0
    s_nop 0
    buffer_load_dwordx4 v1, s[4:7], s16 offen sc1 lds
    s_add_u32 s16, s16, s62
    s_add_u32 m0, s21, 1024
    s_nop 0
    buffer_load_dwordx4 v1, s[4:7], s17 offen sc1 lds
    s_add_u32 s17, s17, s62
    s_add_u32 m0, s22, 0
    s_nop 0
    buffer_load_dwordx4 v2, s[8:11], s18 offen lds
    s_add_u32 s18, s18, s20
    s_add_u32 m0, s22, 8192
    s_nop 0
    buffer_load_dwordx4 v2, s[12:15], s19 offen lds
    s_add_u32 s19, s19, s20
    v_mfma_f32_16x16x32_bf16 v[128:131], v[64:67], v[32:35], v[128:131]
    ds_read_b64_tr_b16 v[112:113], v8 offset:49152
    v_mfma_f32_16x16x32_bf16 v[132:135], v[68:71], v[32:35], v[132:135]
    ds_read_b64_tr_b16 v[114:115], v9 offset:49152
    v_mfma_f32_16x16x32_bf16 v[144:147], v[64:67], v[40:43], v[144:147]
    ds_read_b64_tr_b16 v[116:117], v10 offset:49152
    v_mfma_f32_16x16x32_bf16 v[148:151], v[68:71], v[40:43], v[148:151]
    ds_read_b64_tr_b16 v[118:119], v11 offset:49152
    v_mfma_f32_16x16x32_bf16 v[160:163], v[64:67], v[48:51], v[160:163]
    ds_read_b64_tr_b16 v[120:121], v8 offset:57344
    v_mfma_f32_16x16x32_bf16 v[164:167], v[68:71], v[48:51], v[164:167]
    ds_read_b64_tr_b16 v[122:123], v9 offset:57344
    v_mfma_f32_16x16x32_bf16 v[176:179], v[64:67], v[56:59], v[176:179]
    ds_read_b64_tr_b16 v[124:125], v10 offset:57344
    v_mfma_f32_16x16x32_bf16 v[180:183], v[68:71], v[56:59], v[180:183]
    ds_read_b64_tr_b16 v[126:127], v11 offset:57344
    v_mfma_f32_16x16x32_bf16 v[128:131], v[72:75], v[36:39], v[128:131]
    ds_read_b128 v[80:83], v5 offset:32768
    v_mfma_f32_16x16x32_bf16 v[132:135], v[76:79], v[36:39], v[132:135]
    ds_read_b128 v[84:87], v5 offset:33792
    v_mfma_f32_16x16x32_bf16 v[144:147], v[72:75], v[44:47], v[144:147]
    ds_read_b128 v[88:91], v5 offset:34816
    v_mfma_f32_16x16x32_bf16 v[148:151], v[76:79], v[44:47], v[148:151]
    ds_read_b128 v[92:95], v5 offset:35840
    v_mfma_f32_16x16x32_bf16 v[160:163], v[72:75], v[52:55], v[160:163]
    ds_read_b128 v[96:99], v5 offset:36864
    v_mfma_f32_16x16x32_bf16 v[164:167], v[76:79], v[52:55], v[164:167]
    ds_read_b128 v[100:103], v5 offset:37888
    v_mfma_f32_16x16x32_bf16 v[176:179], v[72:75], v[60:63], v[176:179]
    ds_read_b128 v[104:107], v5 offset:38912
    v_mfma_f32_16x16x32_bf16 v[180:183], v[76:79], v[60:63], v[180:183]
    ds_read_b128 v[108:111], v5 offset:39936
    buffer_load_dword v16, v17, s[4:7], s44 offen sc1
    s_waitcnt lgkmcnt(0)
    s_waitcnt vmcnt(8)
    s_barrier
    s_add_u32 m0, s21, 32768
    s_nop 0
    buffer_load_dwordx4 v1, s[4:7], s16 offen sc1 lds
    s_add_u32 s16, s16, s62
    s_add_u32 m0, s21, 33792
    s_nop 0
    buffer_load_dwordx4 v1, s[4:7], s17 offen sc1 lds
    s_add_u32 s17, s17, s62
    s_add_u32 m0, s22, 32768
    s_nop 0
    buffer_load_dwordx4 v2, s[8:11], s18 offen lds
    s_add_u32 s18, s18, s20
    s_add_u32 m0, s22, 40960
    s_nop 0
    buffer_load_dwordx4 v2, s[12:15], s19 offen lds
    s_add_u32 s19, s19, s20
    v_mfma_f32_16x16x32_bf16 v[128:131], v[112:115], v[80:83], v[128:131]
    ds_read_b64_tr_b16 v[64:65], v12 offset:16384
    v_mfma_f32_16x16x32_bf16 v[132:135], v[116:119], v[80:83], v[132:135]
    ds_read_b64_tr_b16 v[66:67], v13 offset:16384
    v_mfma_f32_16x16x32_bf16 v[144:147], v[112:115], v[88:91], v[144:147]
    ds_read_b64_tr_b16 v[68:69], v14 offset:16384
    v_mfma_f32_16x16x32_bf16 v[148:151], v[116:119], v[88:91], v[148:151]
    ds_read_b64_tr_b16 v[70:71], v15 offset:16384
    v_mfma_f32_16x16x32_bf16 v[160:163], v[112:115], v[96:99], v[160:163]
    ds_read_b64_tr_b16 v[72:73], v12 offset:24576
    v_mfma_f32_16x16x32_bf16 v[164:167], v[116:119], v[96:99], v[164:167]
    ds_read_b64_tr_b16 v[74:75], v13 offset:24576
    v_mfma_f32_16x16x32_bf16 v[176:179], v[112:115], v[104:107], v[176:179]
    ds_read_b64_tr_b16 v[76:77], v14 offset:24576
    v_mfma_f32_16x16x32_bf16 v[180:183], v[116:119], v[104:107], v[180:183]
    ds_read_b64_tr_b16 v[78:79], v15 offset:24576
    v_mfma_f32_16x16x32_bf16 v[128:131], v[120:123], v[84:87], v[128:131]
    ds_read_b128 v[32:35], v6 offset:0
    v_mfma_f32_16x16x32_bf16 v[132:135], v[124:127], v[84:87], v[132:135]
    ds_read_b128 v[36:39], v6 offset:1024
    v_mfma_f32_16x16x32_bf16 v[144:147], v[120:123], v[92:95], v[144:147]
    ds_read_b128 v[40:43], v6 offset:2048
    v_mfma_f32_16x16x32_bf16 v[148:151], v[124:127], v[92:95], v[148:151]
    ds_read_b128 v[44:47], v6 offset:3072
    v_mfma_f32_16x16x32_bf16 v[160:163], v[120:123], v[100:103], v[160:163]
    ds_read_b128 v[48:51], v6 offset:4096
    v_mfma_f32_16x16x32_bf16 v[164:167], v[124:127], v[100:103], v[164:167]
    ds_read_b128 v[52:55], v6 offset:5120
    v_mfma_f32_16x16x32_bf16 v[176:179], v[120:123], v[108:111], v[176:179]
    ds_read_b128 v[56:59], v6 offset:6144
    v_mfma_f32_16x16x32_bf16 v[180:183], v[124:127], v[108:111], v[180:183]
    ds_read_b128 v[60:63], v6 offset:7168
    s_waitcnt lgkmcnt(0)
    s_waitcnt vmcnt(8)
    s_barrier
    s_add_u32 m0, s21, 65536
    s_nop 0
    buffer_load_dwordx4 v1, s[4:7], s16 offen sc1 lds
    s_add_u32 s16, s16, s62
    s_add_u32 m0, s21, 66560
    s_nop 0
    buffer_load_dwordx4 v1, s[4:7], s17 offen sc1 lds
    s_add_u32 s17, s17, s62
    s_add_u32 m0, s22, 65536
    s_nop 0
    buffer_load_dwordx4 v2, s[8:11], s18 offen lds
    s_add_u32 s18, s18, s20
    s_add_u32 m0, s22, 73728
    s_nop 0
    buffer_load_dwordx4 v2, s[12:15], s19 offen lds
    s_add_u32 s19, s19, s20
    v_mfma_f32_16x16x32_bf16 v[128:131], v[64:67], v[32:35], v[128:131]
    ds_read_b64_tr_b16 v[112:113], v12 offset:49152
    v_mfma_f32_16x16x32_bf16 v[132:135], v[68:71], v[32:35], v[132:135]
    ds_read_b64_tr_b16 v[114:115], v13 offset:49152
    v_mfma_f32_16x16x32_bf16 v[144:147], v[64:67], v[40:43], v[144:147]
    ds_read_b64_tr_b16 v[116:117], v14 offset:49152
    v_mfma_f32_16x16x32_bf16 v[148:151], v[68:71], v[40:43], v[148:151]
    ds_read_b64_tr_b16 v[118:119], v15 offset:49152
    v_mfma_f32_16x16x32_bf16 v[160:163], v[64:67], v[48:51], v[160:163]
    ds_read_b64_tr_b16 v[120:121], v12 offset:57344
    v_mfma_f32_16x16x32_bf16 v[164:167], v[68:71], v[48:51], v[164:167]
    ds_read_b64_tr_b16 v[122:123], v13 offset:57344
    v_mfma_f32_16x16x32_bf16 v[176:179], v[64:67], v[56:59], v[176:179]
    ds_read_b64_tr_b16 v[124:125], v14 offset:57344
    v_mfma_f32_16x16x32_bf16 v[180:183], v[68:71], v[56:59], v[180:183]
    ds_read_b64_tr_b16 v[126:127], v15 offset:57344
    v_mfma_f32_16x16x32_bf16 v[128:131], v[72:75], v[36:39], v[128:131]
    ds_read_b128 v[80:83], v6 offset:32768
    v_mfma_f32_16x16x32_bf16 v[132:135], v[76:79], v[36:39], v[132:135]
    ds_read_b128 v[84:87], v6 offset:33792
    v_mfma_f32_16x16x32_bf16 v[144:147], v[72:75], v[44:47], v[144:147]
    ds_read_b128 v[88:91], v6 offset:34816
    v_mfma_f32_16x16x32_bf16 v[148:151], v[76:79], v[44:47], v[148:151]
    ds_read_b128 v[92:95], v6 offset:35840
    v_mfma_f32_16x16x32_bf16 v[160:163], v[72:75], v[52:55], v[160:163]
    ds_read_b128 v[96:99], v6 offset:36864
    v_mfma_f32_16x16x32_bf16 v[164:167], v[76:79], v[52:55], v[164:167]
    ds_read_b128 v[100:103], v6 offset:37888
    v_mfma_f32_16x16x32_bf16 v[176:179], v[72:75], v[60:63], v[176:179]
    ds_read_b128 v[104:107], v6 offset:38912
    v_mfma_f32_16x16x32_bf16 v[180:183], v[76:79], v[60:63], v[180:183]
    ds_read_b128 v[108:111], v6 offset:39936
    s_waitcnt lgkmcnt(0)
    s_waitcnt vmcnt(8)
    s_barrier
    s_add_u32 m0, s21, 98304
    s_nop 0
    buffer_load_dwordx4 v1, s[4:7], s16 offen sc1 lds
    s_add_u32 s16, s16, s62
    s_add_u32 m0, s21, 99328
    s_nop 0
    buffer_load_dwordx4 v1, s[4:7], s17 offen sc1 lds
    s_add_u32 s17, s17, s62
    s_add_u32 m0, s22, 98304
    s_nop 0
    buffer_load_dwordx4 v2, s[8:11], s18 offen lds
    s_add_u32 s18, s18, s20
    s_add_u32 m0, s22, 106496
    s_nop 0
    buffer_load_dwordx4 v2, s[12:15], s19 offen lds
    s_add_u32 s19, s19, s20
    v_mfma_f32_16x16x32_bf16 v[128:131], v[112:115], v[80:83], v[128:131]
    ds_read_b64_tr_b16 v[64:65], v8 offset:16384
    v_mfma_f32_16x16x32_bf16 v[132:135], v[116:119], v[80:83], v[132:135]
    ds_read_b64_tr_b16 v[66:67], v9 offset:16384
    v_mfma_f32_16x16x32_bf16 v[144:147], v[112:115], v[88:91], v[144:147]
    ds_read_b64_tr_b16 v[68:69], v10 offset:16384
    v_mfma_f32_16x16x32_bf16 v[148:151], v[116:119], v[88:91], v[148:151]
    ds_read_b64_tr_b16 v[70:71], v11 offset:16384
    v_mfma_f32_16x16x32_bf16 v[160:163], v[112:115], v[96:99], v[160:163]
    ds_read_b64_tr_b16 v[72:73], v8 offset:24576
    v_mfma_f32_16x16x32_bf16 v[164:167], v[116:119], v[96:99], v[164:167]
    ds_read_b64_tr_b16 v[74:75], v9 offset:24576
    v_mfma_f32_16x16x32_bf16 v[176:179], v[112:115], v[104:107], v[176:179]
    ds_read_b64_tr_b16 v[76:77], v10 offset:24576
    v_mfma_f32_16x16x32_bf16 v[180:183], v[116:119], v[104:107], v[180:183]
    ds_read_b64_tr_b16 v[78:79], v11 offset:24576
    v_mfma_f32_16x16x32_bf16 v[128:131], v[120:123], v[84:87], v[128:131]
    ds_read_b128 v[32:35], v5 offset:0
    v_mfma_f32_16x16x32_bf16 v[132:135], v[124:127], v[84:87], v[132:135]
    ds_read_b128 v[36:39], v5 offset:1024
    v_mfma_f32_16x16x32_bf16 v[144:147], v[120:123], v[92:95], v[144:147]
    ds_read_b128 v[40:43], v5 offset:2048
    v_mfma_f32_16x16x32_bf16 v[148:151], v[124:127], v[92:95], v[148:151]
    ds_read_b128 v[44:47], v5 offset:3072
    v_mfma_f32_16x16x32_bf16 v[160:163], v[120:123], v[100:103], v[160:163]
    ds_read_b128 v[48:51], v5 offset:4096
    v_mfma_f32_16x16x32_bf16 v[164:167], v[124:127], v[100:103], v[164:167]
    ds_read_b128 v[52:55], v5 offset:5120
    v_mfma_f32_16x16x32_bf16 v[176:179], v[120:123], v[108:111], v[176:179]
    ds_read_b128 v[56:59], v5 offset:6144
    v_mfma_f32_16x16x32_bf16 v[180:183], v[124:127], v[108:111], v[180:183]
    ds_read_b128 v[60:63], v5 offset:7168
    s_waitcnt lgkmcnt(0)
    s_sub_u32 s23, s23, 1
    s_cmp_lg_u32 s23, 0
    s_cbranch_scc1 w_loopH
    s_branch w_endH
w_ndH:
    s_waitcnt vmcnt(8)
    s_barrier
    v_mfma_f32_16x16x32_bf16 v[128:131], v[64:67], v[32:35], v[128:131]
    ds_read_b64_tr_b16 v[112:113], v8 offset:49152
    v_mfma_f32_16x16x32_bf16 v[132:135], v[68:71], v[32:35], v[132:135]
    ds_read_b64_tr_b16 v[114:115], v9 offset:49152
    v_mfma_f32_16x16x32_bf16 v[144:147], v[64:67], v[40:43], v[144:147]
    ds_read_b64_tr_b16 v[116:117], v10 offset:49152
    v_mfma_f32_16x16x32_bf16 v[148:151], v[68:71], v[40:43], v[148:151]
    ds_read_b64_tr_b16 v[118:119], v11 offset:49152
    v_mfma_f32_16x16x32_bf16 v[160:163], v[64:67], v[48:51], v[160:163]
    ds_read_b64_tr_b16 v[120:121], v8 offset:57344
    v_mfma_f32_16x16x32_bf16 v[164:167], v[68:71], v[48:51], v[164:167]
    ds_read_b64_tr_b16 v[122:123], v9 offset:57344
    v_mfma_f32_16x16x32_bf16 v[176:179], v[64:67], v[56:59], v[176:179]
    ds_read_b64_tr_b16 v[124:125], v10 offset:57344
    v_mfma_f32_16x16x32_bf16 v[180:183], v[68:71], v[56:59], v[180:183]
    ds_read_b64_tr_b16 v[126:127], v11 offset:57344
    v_mfma_f32_16x16x32_bf16 v[128:131], v[72:75], v[36:39], v[128:131]
    ds_read_b128 v[80:83], v5 offset:32768
    v_mfma_f32_16x16x32_bf16 v[132:135], v[76:79], v[36:39], v[132:135]
    ds_read_b128 v[84:87], v5 offset:33792
    v_mfma_f32_16x16x32_bf16 v[144:147], v[72:75], v[44:47], v[144:147]
    ds_read_b128 v[88:91], v5 offset:34816
    v_mfma_f32_16x16x32_bf16 v[148:151], v[76:79], v[44:47], v[148:151]
    ds_read_b128 v[92:95], v5 offset:35840
    v_mfma_f32_16x16x32_bf16 v[160:163], v[72:75], v[52:55], v[160:163]
    ds_read_b128 v[96:99], v5 offset:36864
    v_mfma_f32_16x16x32_bf16 v[164:167], v[76:79], v[52:55], v[164:167]
    ds_read_b128 v[100:103], v5 offset:37888
    v_mfma_f32_16x16x32_bf16 v[176:179], v[72:75], v[60:63], v[176:179]
    ds_read_b128 v[104:107], v5 offset:38912
    v_mfma_f32_16x16x32_bf16 v[180:183], v[76:79], v[60:63], v[180:183]
    ds_read_b128 v[108:111], v5 offset:39936
    s_waitcnt lgkmcnt(0)
    s_waitcnt vmcnt(4)
    s_barrier
    v_mfma_f32_16x16x32_bf16 v[128:131], v[112:115], v[80:83], v[128:131]
    ds_read_b64_tr_b16 v[64:65], v12 offset:16384
    v_mfma_f32_16x16x32_bf16 v[132:135], v[116:119], v[80:83], v[132:135]
    ds_read_b64_tr_b16 v[66:67], v13 offset:16384
    v_mfma_f32_16x16x32_bf16 v[144:147], v[112:115], v[88:91], v[144:147]
    ds_read_b64_tr_b16 v[68:69], v14 offset:16384
    v_mfma_f32_16x16x32_bf16 v[148:151], v[116:119], v[88:91], v[148:151]
    ds_read_b64_tr_b16 v[70:71], v15 offset:16384
    v_mfma_f32_16x16x32_bf16 v[160:163], v[112:115], v[96:99], v[160:163]
    ds_read_b64_tr_b16 v[72:73], v12 offset:24576
    v_mfma_f32_16x16x32_bf16 v[164:167], v[116:119], v[96:99], v[164:167]
    ds_read_b64_tr_b16 v[74:75], v13 offset:24576
    v_mfma_f32_16x16x32_bf16 v[176:179], v[112:115], v[104:107], v[176:179]
    ds_read_b64_tr_b16 v[76:77], v14 offset:24576
    v_mfma_f32_16x16x32_bf16 v[180:183], v[116:119], v[104:107], v[180:183]
    ds_read_b64_tr_b16 v[78:79], v15 offset:24576
    v_mfma_f32_16x16x32_bf16 v[128:131], v[120:123], v[84:87], v[128:131]
    ds_read_b128 v[32:35], v6 offset:0
    v_mfma_f32_16x16x32_bf16 v[132:135], v[124:127], v[84:87], v[132:135]
    ds_read_b128 v[36:39], v6 offset:1024
    v_mfma_f32_16x16x32_bf16 v[144:147], v[120:123], v[92:95], v[144:147]
    ds_read_b128 v[40:43], v6 offset:2048
    v_mfma_f32_16x16x32_bf16 v[148:151], v[124:127], v[92:95], v[148:151]
    ds_read_b128 v[44:47], v6 offset:3072
    v_mfma_f32_16x16x32_bf16 v[160:163], v[120:123], v[100:103], v[160:163]
    ds_read_b128 v[48:51], v6 offset:4096
    v_mfma_f32_16x16x32_bf16 v[164:167], v[124:127], v[100:103], v[164:167]
    ds_read_b128 v[52:55], v6 offset:5120
    v_mfma_f32_16x16x32_bf16 v[176:179], v[120:123], v[108:111], v[176:179]
    ds_read_b128 v[56:59], v6 offset:6144
    v_mfma_f32_16x16x32_bf16 v[180:183], v[124:127], v[108:111], v[180:183]
    ds_read_b128 v[60:63], v6 offset:7168
    s_waitcnt lgkmcnt(0)
    s_waitcnt vmcnt(0)
    s_barrier
    v_mfma_f32_16x16x32_bf16 v[128:131], v[64:67], v[32:35], v[128:131]
    ds_read_b64_tr_b16 v[112:113], v12 offset:49152
    v_mfma_f32_16x16x32_bf16 v[132:135], v[68:71], v[32:35], v[132:135]
    ds_read_b64_tr_b16 v[114:115], v13 offset:49152
    v_mfma_f32_16x16x32_bf16 v[144:147], v[64:67], v[40:43], v[144:147]
    ds_read_b64_tr_b16 v[116:117], v14 offset:49152
    v_mfma_f32_16x16x32_bf16 v[148:151], v[68:71], v[40:43], v[148:151]
    ds_read_b64_tr_b16 v[118:119], v15 offset:49152
    v_mfma_f32_16x16x32_bf16 v[160:163], v[64:67], v[48:51], v[160:163]
    ds_read_b64_tr_b16 v[120:121], v12 offset:57344
    v_mfma_f32_16x16x32_bf16 v[164:167], v[68:71], v[48:51], v[164:167]
    ds_read_b64_tr_b16 v[122:123], v13 offset:57344
    v_mfma_f32_16x16x32_bf16 v[176:179], v[64:67], v[56:59], v[176:179]
    ds_read_b64_tr_b16 v[124:125], v14 offset:57344
    v_mfma_f32_16x16x32_bf16 v[180:183], v[68:71], v[56:59], v[180:183]
    ds_read_b64_tr_b16 v[126:127], v15 offset:57344
    v_mfma_f32_16x16x32_bf16 v[128:131], v[72:75], v[36:39], v[128:131]
    ds_read_b128 v[80:83], v6 offset:32768
    v_mfma_f32_16x16x32_bf16 v[132:135], v[76:79], v[36:39], v[132:135]
    ds_read_b128 v[84:87], v6 offset:33792
    v_mfma_f32_16x16x32_bf16 v[144:147], v[72:75], v[44:47], v[144:147]
    ds_read_b128 v[88:91], v6 offset:34816
    v_mfma_f32_16x16x32_bf16 v[148:151], v[76:79], v[44:47], v[148:151]
    ds_read_b128 v[92:95], v6 offset:35840
    v_mfma_f32_16x16x32_bf16 v[160:163], v[72:75], v[52:55], v[160:163]
    ds_read_b128 v[96:99], v6 offset:36864
    v_mfma_f32_16x16x32_bf16 v[164:167], v[76:79], v[52:55], v[164:167]
    ds_read_b128 v[100:103], v6 offset:37888
    v_mfma_f32_16x16x32_bf16 v[176:179], v[72:75], v[60:63], v[176:179]
    ds_read_b128 v[104:107], v6 offset:38912
    v_mfma_f32_16x16x32_bf16 v[180:183], v[76:79], v[60:63], v[180:183]
    ds_read_b128 v[108:111], v6 offset:39936
    s_waitcnt lgkmcnt(0)
    s_waitcnt vmcnt(0)
    s_barrier
    v_mfma_f32_16x16x32_bf16 v[128:131], v[112:115], v[80:83], v[128:131]
    ds_read_b64_tr_b16 v[64:65], v8 offset:16384
    v_mfma_f32_16x16x32_bf16 v[132:135], v[116:119], v[80:83], v[132:135]
    ds_read_b64_tr_b16 v[66:67], v9 offset:16384
    v_mfma_f32_16x16x32_bf16 v[144:147], v[112:115], v[88:91], v[144:147]
    ds_read_b64_tr_b16 v[68:69], v10 offset:16384
    v_mfma_f32_16x16x32_bf16 v[148:151], v[116:119], v[88:91], v[148:151]
    ds_read_b64_tr_b16 v[70:71], v11 offset:16384
    v_mfma_f32_16x16x32_bf16 v[160:163], v[112:115], v[96:99], v[160:163]
    ds_read_b64_tr_b16 v[72:73], v8 offset:24576
    v_mfma_f32_16x16x32_bf16 v[164:167], v[116:119], v[96:99], v[164:167]
    ds_read_b64_tr_b16 v[74:75], v9 offset:24576
    v_mfma_f32_16x16x32_bf16 v[176:179], v[112:115], v[104:107], v[176:179]
    ds_read_b64_tr_b16 v[76:77], v10 offset:24576
    v_mfma_f32_16x16x32_bf16 v[180:183], v[116:119], v[104:107], v[180:183]
    ds_read_b64_tr_b16 v[78:79], v11 offset:24576
    v_mfma_f32_16x16x32_bf16 v[128:131], v[120:123], v[84:87], v[128:131]
    ds_read_b128 v[32:35], v5 offset:0
    v_mfma_f32_16x16x32_bf16 v[132:135], v[124:127], v[84:87], v[132:135]
    ds_read_b128 v[36:39], v5 offset:1024
    v_mfma_f32_16x16x32_bf16 v[144:147], v[120:123], v[92:95], v[144:147]
    ds_read_b128 v[40:43], v5 offset:2048
    v_mfma_f32_16x16x32_bf16 v[148:151], v[124:127], v[92:95], v[148:151]
    ds_read_b128 v[44:47], v5 offset:3072
    v_mfma_f32_16x16x32_bf16 v[160:163], v[120:123], v[100:103], v[160:163]
    ds_read_b128 v[48:51], v5 offset:4096
    v_mfma_f32_16x16x32_bf16 v[164:167], v[124:127], v[100:103], v[164:167]
    ds_read_b128 v[52:55], v5 offset:5120
    v_mfma_f32_16x16x32_bf16 v[176:179], v[120:123], v[108:111], v[176:179]
    ds_read_b128 v[56:59], v5 offset:6144
    v_mfma_f32_16x16x32_bf16 v[180:183], v[124:127], v[108:111], v[180:183]
    ds_read_b128 v[60:63], v5 offset:7168
    s_waitcnt lgkmcnt(0)
w_endH:
    v_mov_b32 v20, 131072
    ds_read_b128 v[24:27], v20
    ds_read_b128 v[28:31], v20 offset:16
    s_cmp_lg_u32 s53, s53
    s_cbranch_scc1 w_epi_siluH
    s_lshl_b32 s30, s27, 10
    s_add_u32 s30, s30, s49
    s_nop 7
    v_cvt_pk_bf16_f32 v80, v128, v129
    v_cvt_pk_bf16_f32 v81, v130, v131
    v_cvt_pk_bf16_f32 v82, v132, v133
    v_cvt_pk_bf16_f32 v83, v134, v135
    buffer_store_dwordx4 v[80:83], v1, s[4:7], s30 offen sc1
    s_add_u32 s30, s30, s50
    v_cvt_pk_bf16_f32 v84, v144, v145
    v_cvt_pk_bf16_f32 v85, v146, v147
    v_cvt_pk_bf16_f32 v86, v148, v149
    v_cvt_pk_bf16_f32 v87, v150, v151
    buffer_store_dwordx4 v[84:87], v1, s[4:7], s30 offen sc1
    s_add_u32 s30, s30, s50
    v_cvt_pk_bf16_f32 v88, v160, v161
    v_cvt_pk_bf16_f32 v89, v162, v163
    v_cvt_pk_bf16_f32 v90, v164, v165
    v_cvt_pk_bf16_f32 v91, v166, v167
    buffer_store_dwordx4 v[88:91], v1, s[4:7], s30 offen sc1
    s_add_u32 s30, s30, s50
    v_cvt_pk_bf16_f32 v92, v176, v177
    v_cvt_pk_bf16_f32 v93, v178, v179
    v_cvt_pk_bf16_f32 v94, v180, v181
    v_cvt_pk_bf16_f32 v95, v182, v183
    buffer_store_dwordx4 v[92:95], v1, s[4:7], s30 offen sc1
    s_add_u32 s30, s30, s50
    s_waitcnt lgkmcnt(0)
    v_or3_b32 v24, v24, v25, v26
    v_or3_b32 v28, v28, v29, v30
    v_or3_b32 v24, v24, v27, v31
    v_or_b32 v24, v24, v28
    s_mov_b32 s28, s51
    s_mov_b32 s57, s53
    v_readfirstlane_b32 s30, v24
    s_cmp_lg_u32 s30, 0
    s_cbranch_scc1 w_drain
    s_mov_b32 s48, s32
    s_cmp_ge_u32 s32, 4
    s_cselect_b32 s30, 2, 3
    s_lshl_b32 s30, s26, s30
    s_mul_i32 s30, s30, s43
    s_add_u32 s49, s42, s30
    s_mov_b32 s50, s43
    s_mov_b32 s51, s46
    s_mov_b32 s23, s41
    s_mov_b32 s53, s47
    s_nop 0
    s_load_dwordx16 s[32:47], s[24:25], 0
    s_add_u32 s24, s24, 64
    s_addc_u32 s25, s25, 0
    s_branch w_first4
w_epi_siluH:
    s_lshl_b32 s30, s27, 10
    s_add_u32 s30, s30, s49
    s_mov_b32 s54, 0xbfb8aa3b
    s_nop 7
    v_cvt_pk_bf16_f32 v80, v128, v129
    v_cvt_pk_bf16_f32 v81, v130, v131
    v_cvt_pk_bf16_f32 v82, v132, v133
    v_cvt_pk_bf16_f32 v83, v134, v135
    v_lshlrev_b32 v128, 16, v80
    v_and_b32 v129, 0xffff0000, v80
    v_lshlrev_b32 v130, 16, v81
    v_and_b32 v131, 0xffff0000, v81
    v_lshlrev_b32 v132, 16, v82
    v_and_b32 v133, 0xffff0000, v82
    v_lshlrev_b32 v134, 16, v83
    v_and_b32 v135, 0xffff0000, v83
    v_mul_f32 v104, s54, v128
    v_mul_f32 v105, s54, v129
    v_mul_f32 v106, s54, v130
    v_mul_f32 v107, s54, v131
    v_mul_f32 v108, s54, v132
    v_mul_f32 v109, s54, v133
    v_mul_f32 v110, s54, v134
    v_mul_f32 v111, s54, v135
    v_exp_f32 v104, v104
    v_exp_f32 v105, v105
    v_exp_f32 v106, v106
    v_exp_f32 v107, v107
    v_exp_f32 v108, v108
    v_exp_f32 v109, v109
    v_exp_f32 v110, v110
    v_exp_f32 v111, v111
    v_add_f32 v104, 1.0, v104
    v_add_f32 v105, 1.0, v105
    v_add_f32 v106, 1.0, v106
    v_add_f32 v107, 1.0, v107
    v_add_f32 v108, 1.0, v108
    v_add_f32 v109, 1.0, v109
    v_add_f32 v110, 1.0, v110
    v_add_f32 v111, 1.0, v111
    v_rcp_f32 v104, v104
    v_rcp_f32 v105, v105
    v_rcp_f32 v106, v106
    v_rcp_f32 v107, v107
    v_rcp_f32 v108, v108
    v_rcp_f32 v109, v109
    v_rcp_f32 v110, v110
    v_rcp_f32 v111, v111
    v_mul_f32 v128, v128, v104
    v_mul_f32 v129, v129, v105
    v_mul_f32 v130, v130, v106
    v_mul_f32 v131, v131, v107
    v_mul_f32 v132, v132, v108
    v_mul_f32 v133, v133, v109
    v_mul_f32 v134, v134, v110
    v_mul_f32 v135, v135, v111
    v_cvt_pk_bf16_f32 v80, v128, v129
    v_cvt_pk_bf16_f32 v81, v130, v131
    v_cvt_pk_bf16_f32 v82, v132, v133
    v_cvt_pk_bf16_f32 v83, v134, v135
    buffer_store_dwordx4 v[80:83], v1, s[4:7], s30 offen sc1
    s_add_u32 s30, s30, s50
    v_cvt_pk_bf16_f32 v84, v144, v145
    v_cvt_pk_bf16_f32 v85, v146, v147
    v_cvt_pk_bf16_f32 v86, v148, v149
    v_cvt_pk_bf16_f32 v87, v150, v151
    v_lshlrev_b32 v144, 16, v84
    v_and_b32 v145, 0xffff0000, v84
    v_lshlrev_b32 v146, 16, v85
    v_and_b32 v147, 0xffff0000, v85
    v_lshlrev_b32 v148, 16, v86
    v_and_b32 v149, 0xffff0000, v86
    v_lshlrev_b32 v150, 16, v87
    v_and_b32 v151, 0xffff0000, v87
    v_mul_f32 v96, s54, v144
    v_mul_f32 v97, s54, v145
    v_mul_f32 v98, s54, v146
    v_mul_f32 v99, s54, v147
    v_mul_f32 v100, s54, v148
    v_mul_f32 v101, s54, v149
    v_mul_f32 v102, s54, v150
    v_mul_f32 v103, s54, v151
    v_exp_f32 v96, v96
    v_exp_f32 v97, v97
    v_exp_f32 v98, v98
    v_exp_f32 v99, v99
    v_exp_f32 v100, v100
    v_exp_f32 v101, v101
    v_exp_f32 v102, v102
    v_exp_f32 v103, v103
    v_add_f32 v96, 1.0, v96
    v_add_f32 v97, 1.0, v97
    v_add_f32 v98, 1.0, v98
    v_add_f32 v99, 1.0, v99
    v_add_f32 v100, 1.0, v100
    v_add_f32 v101, 1.0, v101
    v_add_f32 v102, 1.0, v102
    v_add_f32 v103, 1.0, v103
    v_rcp_f32 v96, v96
    v_rcp_f32 v97, v97
    v_rcp_f32 v98, v98
    v_rcp_f32 v99, v99
    v_rcp_f32 v100, v100
    v_rcp_f32 v101, v101
    v_rcp_f32 v102, v102
    v_rcp_f32 v103, v103
    v_mul_f32 v144, v144, v96
    v_mul_f32 v145, v145, v97
    v_mul_f32 v146, v146, v98
    v_mul_f32 v147, v147, v99
    v_mul_f32 v148, v148, v100
    v_mul_f32 v149, v149, v101
    v_mul_f32 v150, v150, v102
    v_mul_f32 v151, v151, v103
    v_cvt_pk_bf16_f32 v84, v144, v145
    v_cvt_pk_bf16_f32 v85, v146, v147
    v_cvt_pk_bf16_f32 v86, v148, v149
    v_cvt_pk_bf16_f32 v87, v150, v151
    buffer_store_dwordx4 v[84:87], v1, s[4:7], s30 offen sc1
    s_add_u32 s30, s30, s50
    v_cvt_pk_bf16_f32 v88, v160, v161
    v_cvt_pk_bf16_f32 v89, v162, v163
    v_cvt_pk_bf16_f32 v90, v164, v165
    v_cvt_pk_bf16_f32 v91, v166, v167
    v_lshlrev_b32 v160, 16, v88
    v_and_b32 v161, 0xffff0000, v88
    v_lshlrev_b32 v162, 16, v89
    v_and_b32 v163, 0xffff0000, v89
    v_lshlrev_b32 v164, 16, v90
    v_and_b32 v165, 0xffff0000, v90
    v_lshlrev_b32 v166, 16, v91
    v_and_b32 v167, 0xffff0000, v91
    v_mul_f32 v104, s54, v160
    v_mul_f32 v105, s54, v161
    v_mul_f32 v106, s54, v162
    v_mul_f32 v107, s54, v163
    v_mul_f32 v108, s54, v164
    v_mul_f32 v109, s54, v165
    v_mul_f32 v110, s54, v166
    v_mul_f32 v111, s54, v167
    v_exp_f32 v104, v104
    v_exp_f32 v105, v105
    v_exp_f32 v106, v106
    v_exp_f32 v107, v107
    v_exp_f32 v108, v108
    v_exp_f32 v109, v109
    v_exp_f32 v110, v110
    v_exp_f32 v111, v111
    v_add_f32 v104, 1.0, v104
    v_add_f32 v105, 1.0, v105
    v_add_f32 v106, 1.0, v106
    v_add_f32 v107, 1.0, v107
    v_add_f32 v108, 1.0, v108
    v_add_f32 v109, 1.0, v109
    v_add_f32 v110, 1.0, v110
    v_add_f32 v111, 1.0, v111
    v_rcp_f32 v104, v104
    v_rcp_f32 v105, v105
    v_rcp_f32 v106, v106
    v_rcp_f32 v107, v107
    v_rcp_f32 v108, v108
    v_rcp_f32 v109, v109
    v_rcp_f32 v110, v110
    v_rcp_f32 v111, v111
    v_mul_f32 v160, v160, v104
    v_mul_f32 v161, v161, v105
    v_mul_f32 v162, v162, v106
    v_mul_f32 v163, v163, v107
    v_mul_f32 v164, v164, v108
    v_mul_f32 v165, v165, v109
    v_mul_f32 v166, v166, v110
    v_mul_f32 v167, v167, v111
    v_cvt_pk_bf16_f32 v88, v160, v161
    v_cvt_pk_bf16_f32 v89, v162, v163
    v_cvt_pk_bf16_f32 v90, v164, v165
    v_cvt_pk_bf16_f32 v91, v166, v167
    buffer_store_dwordx4 v[88:91], v1, s[4:7], s30 offen sc1
    s_add_u32 s30, s30, s50
    v_cvt_pk_bf16_f32 v92, v176, v177
    v_cvt_pk_bf16_f32 v93, v178, v179
    v_cvt_pk_bf16_f32 v94, v180, v181
    v_cvt_pk_bf16_f32 v95, v182, v183
    v_lshlrev_b32 v176, 16, v92
    v_and_b32 v177, 0xffff0000, v92
    v_lshlrev_b32 v178, 16, v93
    v_and_b32 v179, 0xffff0000, v93
    v_lshlrev_b32 v180, 16, v94
    v_and_b32 v181, 0xffff0000, v94
    v_lshlrev_b32 v182, 16, v95
    v_and_b32 v183, 0xffff0000, v95
    v_mul_f32 v96, s54, v176
    v_mul_f32 v97, s54, v177
    v_mul_f32 v98, s54, v178
    v_mul_f32 v99, s54, v179
    v_mul_f32 v100, s54, v180
    v_mul_f32 v101, s54, v181
    v_mul_f32 v102, s54, v182
    v_mul_f32 v103, s54, v183
    v_exp_f32 v96, v96
    v_exp_f32 v97, v97
    v_exp_f32 v98, v98
    v_exp_f32 v99, v99
    v_exp_f32 v100, v100
    v_exp_f32 v101, v101
    v_exp_f32 v102, v102
    v_exp_f32 v103, v103
    v_add_f32 v96, 1.0, v96
    v_add_f32 v97, 1.0, v97
    v_add_f32 v98, 1.0, v98
    v_add_f32 v99, 1.0, v99
    v_add_f32 v100, 1.0, v100
    v_add_f32 v101, 1.0, v101
    v_add_f32 v102, 1.0, v102
    v_add_f32 v103, 1.0, v103
    v_rcp_f32 v96, v96
    v_rcp_f32 v97, v97
    v_rcp_f32 v98, v98
    v_rcp_f32 v99, v99
    v_rcp_f32 v100, v100
    v_rcp_f32 v101, v101
    v_rcp_f32 v102, v102
    v_rcp_f32 v103, v103
    v_mul_f32 v176, v176, v96
    v_mul_f32 v177, v177, v97
    v_mul_f32 v178, v178, v98
    v_mul_f32 v179, v179, v99
    v_mul_f32 v180, v180, v100
    v_mul_f32 v181, v181, v101
    v_mul_f32 v182, v182, v102
    v_mul_f32 v183, v183, v103
    v_cvt_pk_bf16_f32 v92, v176, v177
    v_cvt_pk_bf16_f32 v93, v178, v179
    v_cvt_pk_bf16_f32 v94, v180, v181
    v_cvt_pk_bf16_f32 v95, v182, v183
    buffer_store_dwordx4 v[92:95], v1, s[4:7], s30 offen sc1
    s_add_u32 s30, s30, s50
    s_waitcnt lgkmcnt(0)
    v_or3_b32 v24, v24, v25, v26
    v_or3_b32 v28, v28, v29, v30
    v_or3_b32 v24, v24, v27, v31
    v_or_b32 v24, v24, v28
    s_mov_b32 s28, s51
    s_mov_b32 s57, s53
    v_readfirstlane_b32 s30, v24
    s_cmp_lg_u32 s30, 0
    s_cbranch_scc1 w_drain
    s_mov_b32 s48, s32
    s_cmp_ge_u32 s32, 4
    s_cselect_b32 s30, 2, 3
    s_lshl_b32 s30, s26, s30
    s_mul_i32 s30, s30, s43
    s_add_u32 s49, s42, s30
    s_mov_b32 s50, s43
    s_mov_b32 s51, s46
    s_mov_b32 s23, s41
    s_mov_b32 s53, s47
    s_nop 0
    s_load_dwordx16 s[32:47], s[24:25], 0
    s_add_u32 s24, s24, 64
    s_addc_u32 s25, s25, 0
    s_branch w_first4
w_firstX:
    s_waitcnt vmcnt(0)
    s_barrier
    v_bfe_u32 v20, v1, 4, 3
    v_xor_b32 v21, v4, v20
    v_lshlrev_b32 v21, 4, v21
    v_lshl_add_u32 v21, v20, 7, v21
    v_bfe_u32 v20, v1, 7, 1
    v_lshl_add_u32 v21, v20, 10, v21
    s_lshl_b32 s30, s26, 13
    v_add_u32 v24, s30, v21
    v_xor_b32 v25, 64, v24
    v_add_u32 v26, 0x10000, v24
    v_add_u32 v27, 0x10000, v25
    v_add_u32 v28, s22, v1
    v_add_u32 v29, 0x10000, v28
    ds_read_b64_tr_b16 v[64:65], v8 offset:16384
    ds_read_b64_tr_b16 v[66:67], v9 offset:16384
    ds_read_b64_tr_b16 v[68:69], v10 offset:16384
    ds_read_b64_tr_b16 v[70:71], v11 offset:16384
    ds_read_b64_tr_b16 v[72:73], v8 offset:24576
    ds_read_b64_tr_b16 v[74:75], v9 offset:24576
    ds_read_b64_tr_b16 v[76:77], v10 offset:24576
    ds_read_b64_tr_b16 v[78:79], v11 offset:24576
    ds_read_b128 v[32:35], v24 offset:0
    ds_read_b128 v[36:39], v25 offset:0
    ds_read_b128 v[40:43], v24 offset:2048
    ds_read_b128 v[44:47], v25 offset:2048
    ds_read_b128 v[48:51], v24 offset:4096
    ds_read_b128 v[52:55], v25 offset:4096
    ds_read_b128 v[56:59], v24 offset:6144
    ds_read_b128 v[60:63], v25 offset:6144
    v_mov_b32 v208, 0x3f803f80
    v_mov_b32 v209, 0x3f803f80
    v_mov_b32 v210, 0x3f803f80
    v_mov_b32 v211, 0x3f803f80
    s_waitcnt lgkmcnt(0)
    s_waitcnt vmcnt(8)
    s_barrier
    s_add_u32 m0, s21, 0
    s_nop 0
    buffer_load_dwordx4 v23, s[88:91], s16 offen lds
    s_add_u32 s16, s16, s62
    s_add_u32 m0, s21, 1024
    s_nop 0
    buffer_load_dwordx4 v23, s[88:91], s17 offen lds
    s_add_u32 s17, s17, s62
    s_cmp_ge_u32 s16, s92
    s_cselect_b32 s94, 2048, 0
    s_sub_u32 s16, s16, s94
    s_sub_u32 s17, s17, s94
    s_add_u32 m0, s22, 0
    s_nop 0
    buffer_load_dwordx4 v2, s[8:11], s18 offen lds
    s_add_u32 s18, s18, s20
    s_add_u32 m0, s22, 8192
    s_nop 0
    buffer_load_dwordx4 v2, s[12:15], s19 offen lds
    s_add_u32 s19, s19, s20
    s_cmp_ge_u32 s18, s95
    s_cselect_b32 s94, s93, 0
    s_sub_u32 s18, s18, s94
    s_sub_u32 s19, s19, s94
    v_mfma_f32_16x16x32_bf16 v[128:131], v[64:67], v[32:35], 0
    ds_read_b64_tr_b16 v[112:113], v8 offset:49152
    v_mfma_f32_16x16x32_bf16 v[132:135], v[68:71], v[32:35], 0
    ds_read_b64_tr_b16 v[114:115], v9 offset:49152
    v_mfma_f32_16x16x32_bf16 v[144:147], v[64:67], v[40:43], 0
    ds_read_b64_tr_b16 v[116:117], v10 offset:49152
    v_mfma_f32_16x16x32_bf16 v[148:151], v[68:71], v[40:43], 0
    ds_read_b64_tr_b16 v[118:119], v11 offset:49152
    v_mfma_f32_16x16x32_bf16 v[160:163], v[64:67], v[48:51], 0
    ds_read_b64_tr_b16 v[120:121], v8 offset:57344
    v_mfma_f32_16x16x32_bf16 v[164:167], v[68:71], v[48:51], 0
    ds_read_b64_tr_b16 v[122:123], v9 offset:57344
    v_mfma_f32_16x16x32_bf16 v[176:179], v[64:67], v[56:59], 0
    ds_read_b64_tr_b16 v[124:125], v10 offset:57344
    v_mfma_f32_16x16x32_bf16 v[180:183], v[68:71], v[56:59], 0
    ds_read_b64_tr_b16 v[126:127], v11 offset:57344
    v_mfma_f32_16x16x32_bf16 v[192:195], v[64:67], v[208:211], 0
    ds_read_b128 v[80:83], v24 offset:32768
    v_mfma_f32_16x16x32_bf16 v[196:199], v[68:71], v[208:211], 0
    ds_read_b128 v[84:87], v25 offset:32768
    v_mfma_f32_16x16x32_bf16 v[128:131], v[72:75], v[36:39], v[128:131]
    ds_read_b128 v[88:91], v24 offset:34816
    v_mfma_f32_16x16x32_bf16 v[132:135], v[76:79], v[36:39], v[132:135]
    ds_read_b128 v[92:95], v25 offset:34816
    v_mfma_f32_16x16x32_bf16 v[144:147], v[72:75], v[44:47], v[144:147]
    ds_read_b128 v[96:99], v24 offset:36864
    v_mfma_f32_16x16x32_bf16 v[148:151], v[76:79], v[44:47], v[148:151]
    ds_read_b128 v[100:103], v25 offset:36864
    v_mfma_f32_16x16x32_bf16 v[160:163], v[72:75], v[52:55], v[160:163]
    ds_read_b128 v[104:107], v24 offset:38912
    v_mfma_f32_16x16x32_bf16 v[164:167], v[76:79], v[52:55], v[164:167]
    ds_read_b128 v[108:111], v25 offset:38912
    v_mfma_f32_16x16x32_bf16 v[176:179], v[72:75], v[60:63], v[176:179]
    v_mfma_f32_16x16x32_bf16 v[180:183], v[76:79], v[60:63], v[180:183]
    v_mfma_f32_16x16x32_bf16 v[192:195], v[72:75], v[208:211], v[192:195]
    v_mfma_f32_16x16x32_bf16 v[196:199], v[76:79], v[208:211], v[196:199]
    s_waitcnt lgkmcnt(0)
    s_waitcnt vmcnt(8)
    s_barrier
    s_add_u32 m0, s21, 32768
    s_nop 0
    buffer_load_dwordx4 v23, s[88:91], s16 offen lds
    s_add_u32 s16, s16, s62
    s_add_u32 m0, s21, 33792
    s_nop 0
    buffer_load_dwordx4 v23, s[88:91], s17 offen lds
    s_add_u32 s17, s17, s62
    s_cmp_ge_u32 s16, s92
    s_cselect_b32 s94, 2048, 0
    s_sub_u32 s16, s16, s94
    s_sub_u32 s17, s17, s94
    s_add_u32 m0, s22, 32768
    s_nop 0
    buffer_load_dwordx4 v2, s[8:11], s18 offen lds
    s_add_u32 s18, s18, s20
    s_add_u32 m0, s22, 40960
    s_nop 0
    buffer_load_dwordx4 v2, s[12:15], s19 offen lds
    s_add_u32 s19, s19, s20
    s_cmp_ge_u32 s18, s95
    s_cselect_b32 s94, s93, 0
    s_sub_u32 s18, s18, s94
    s_sub_u32 s19, s19, s94
    v_mfma_f32_16x16x32_bf16 v[128:131], v[112:115], v[80:83], v[128:131]
    ds_read_b64_tr_b16 v[64:65], v12 offset:16384
    v_mfma_f32_16x16x32_bf16 v[132:135], v[116:119], v[80:83], v[132:135]
    ds_read_b64_tr_b16 v[66:67], v13 offset:16384
    v_mfma_f32_16x16x32_bf16 v[144:147], v[112:115], v[88:91], v[144:147]
    ds_read_b64_tr_b16 v[68:69], v14 offset:16384
    v_mfma_f32_16x16x32_bf16 v[148:151], v[116:119], v[88:91], v[148:151]
    ds_read_b64_tr_b16 v[70:71], v15 offset:16384
    v_mfma_f32_16x16x32_bf16 v[160:163], v[112:115], v[96:99], v[160:163]
    ds_read_b64_tr_b16 v[72:73], v12 offset:24576
    v_mfma_f32_16x16x32_bf16 v[164:167], v[116:119], v[96:99], v[164:167]
    ds_read_b64_tr_b16 v[74:75], v13 offset:24576
    v_mfma_f32_16x16x32_bf16 v[176:179], v[112:115], v[104:107], v[176:179]
    ds_read_b64_tr_b16 v[76:77], v14 offset:24576
    v_mfma_f32_16x16x32_bf16 v[180:183], v[116:119], v[104:107], v[180:183]
    ds_read_b64_tr_b16 v[78:79], v15 offset:24576
    v_mfma_f32_16x16x32_bf16 v[192:195], v[112:115], v[208:211], v[192:195]
    ds_read_b128 v[32:35], v26 offset:0
    v_mfma_f32_16x16x32_bf16 v[196:199], v[116:119], v[208:211], v[196:199]
    ds_read_b128 v[36:39], v27 offset:0
    v_mfma_f32_16x16x32_bf16 v[128:131], v[120:123], v[84:87], v[128:131]
    ds_read_b128 v[40:43], v26 offset:2048
    v_mfma_f32_16x16x32_bf16 v[132:135], v[124:127], v[84:87], v[132:135]
    ds_read_b128 v[44:47], v27 offset:2048
    v_mfma_f32_16x16x32_bf16 v[144:147], v[120:123], v[92:95], v[144:147]
    ds_read_b128 v[48:51], v26 offset:4096
    v_mfma_f32_16x16x32_bf16 v[148:151], v[124:127], v[92:95], v[148:151]
    ds_read_b128 v[52:55], v27 offset:4096
    v_mfma_f32_16x16x32_bf16 v[160:163], v[120:123], v[100:103], v[160:163]
    ds_read_b128 v[56:59], v26 offset:6144
    v_mfma_f32_16x16x32_bf16 v[164:167], v[124:127], v[100:103], v[164:167]
    ds_read_b128 v[60:63], v27 offset:6144
    v_mfma_f32_16x16x32_bf16 v[176:179], v[120:123], v[108:111], v[176:179]
    v_mfma_f32_16x16x32_bf16 v[180:183], v[124:127], v[108:111], v[180:183]
    v_mfma_f32_16x16x32_bf16 v[192:195], v[120:123], v[208:211], v[192:195]
    v_mfma_f32_16x16x32_bf16 v[196:199], v[124:127], v[208:211], v[196:199]
    s_waitcnt lgkmcnt(0)
    s_waitcnt vmcnt(8)
    s_barrier
    s_add_u32 m0, s21, 65536
    s_nop 0
    buffer_load_dwordx4 v23, s[88:91], s16 offen lds
    s_add_u32 s16, s16, s62
    s_add_u32 m0, s21, 66560
    s_nop 0
    buffer_load_dwordx4 v23, s[88:91], s17 offen lds
    s_add_u32 s17, s17, s62
    s_cmp_ge_u32 s16, s92
    s_cselect_b32 s94, 2048, 0
    s_sub_u32 s16, s16, s94
    s_sub_u32 s17, s17, s94
    s_add_u32 m0, s22, 65536
    s_nop 0
    buffer_load_dwordx4 v2, s[8:11], s18 offen lds
    s_add_u32 s18, s18, s20
    s_add_u32 m0, s22, 73728
    s_nop 0
    buffer_load_dwordx4 v2, s[12:15], s19 offen lds
    s_add_u32 s19, s19, s20
    s_cmp_ge_u32 s18, s95
    s_cselect_b32 s94, s93, 0
    s_sub_u32 s18, s18, s94
    s_sub_u32 s19, s19, s94
    v_mfma_f32_16x16x32_bf16 v[128:131], v[64:67], v[32:35], v[128:131]
    ds_read_b64_tr_b16 v[112:113], v12 offset:49152
    v_mfma_f32_16x16x32_bf16 v[132:135], v[68:71], v[32:35], v[132:135]
    ds_read_b64_tr_b16 v[114:115], v13 offset:49152
    v_mfma_f32_16x16x32_bf16 v[144:147], v[64:67], v[40:43], v[144:147]
    ds_read_b64_tr_b16 v[116:117], v14 offset:49152
    v_mfma_f32_16x16x32_bf16 v[148:151], v[68:71], v[40:43], v[148:151]
    ds_read_b64_tr_b16 v[118:119], v15 offset:49152
    v_mfma_f32_16x16x32_bf16 v[160:163], v[64:67], v[48:51], v[160:163]
    ds_read_b64_tr_b16 v[120:121], v12 offset:57344
    v_mfma_f32_16x16x32_bf16 v[164:167], v[68:71], v[48:51], v[164:167]
    ds_read_b64_tr_b16 v[122:123], v13 offset:57344
    v_mfma_f32_16x16x32_bf16 v[176:179], v[64:67], v[56:59], v[176:179]
    ds_read_b64_tr_b16 v[124:125], v14 offset:57344
    v_mfma_f32_16x16x32_bf16 v[180:183], v[68:71], v[56:59], v[180:183]
    ds_read_b64_tr_b16 v[126:127], v15 offset:57344
    v_mfma_f32_16x16x32_bf16 v[192:195], v[64:67], v[208:211], v[192:195]
    ds_read_b128 v[80:83], v26 offset:32768
    v_mfma_f32_16x16x32_bf16 v[196:199], v[68:71], v[208:211], v[196:199]
    ds_read_b128 v[84:87], v27 offset:32768
    v_mfma_f32_16x16x32_bf16 v[128:131], v[72:75], v[36:39], v[128:131]
    ds_read_b128 v[88:91], v26 offset:34816
    v_mfma_f32_16x16x32_bf16 v[132:135], v[76:79], v[36:39], v[132:135]
    ds_read_b128 v[92:95], v27 offset:34816
    v_mfma_f32_16x16x32_bf16 v[144:147], v[72:75], v[44:47], v[144:147]
    ds_read_b128 v[96:99], v26 offset:36864
    v_mfma_f32_16x16x32_bf16 v[148:151], v[76:79], v[44:47], v[148:151]
    ds_read_b128 v[100:103], v27 offset:36864
    v_mfma_f32_16x16x32_bf16 v[160:163], v[72:75], v[52:55], v[160:163]
    ds_read_b128 v[104:107], v26 offset:38912
    v_mfma_f32_16x16x32_bf16 v[164:167], v[76:79], v[52:55], v[164:167]
    ds_read_b128 v[108:111], v27 offset:38912
    v_mfma_f32_16x16x32_bf16 v[176:179], v[72:75], v[60:63], v[176:179]
    v_mfma_f32_16x16x32_bf16 v[180:183], v[76:79], v[60:63], v[180:183]
    v_mfma_f32_16x16x32_bf16 v[192:195], v[72:75], v[208:211], v[192:195]
    v_mfma_f32_16x16x32_bf16 v[196:199], v[76:79], v[208:211], v[196:199]
    s_waitcnt lgkmcnt(0)
    s_waitcnt vmcnt(8)
    s_barrier
    s_add_u32 m0, s21, 98304
    s_nop 0
    buffer_load_dwordx4 v23, s[88:91], s16 offen lds
    s_add_u32 s16, s16, s62
    s_add_u32 m0, s21, 99328
    s_nop 0
    buffer_load_dwordx4 v23, s[88:91], s17 offen lds
    s_add_u32 s17, s17, s62
    s_cmp_ge_u32 s16, s92
    s_cselect_b32 s94, 2048, 0
    s_sub_u32 s16, s16, s94
    s_sub_u32 s17, s17, s94
    s_add_u32 m0, s22, 98304
    s_nop 0
    buffer_load_dwordx4 v2, s[8:11], s18 offen lds
    s_add_u32 s18, s18, s20
    s_add_u32 m0, s22, 106496
    s_nop 0
    buffer_load_dwordx4 v2, s[12:15], s19 offen lds
    s_add_u32 s19, s19, s20
    s_cmp_ge_u32 s18, s95
    s_cselect_b32 s94, s93, 0
    s_sub_u32 s18, s18, s94
    s_sub_u32 s19, s19, s94
    v_mfma_f32_16x16x32_bf16 v[128:131], v[112:115], v[80:83], v[128:131]
    ds_read_b64_tr_b16 v[64:65], v8 offset:16384
    v_mfma_f32_16x16x32_bf16 v[132:135], v[116:119], v[80:83], v[132:135]
    ds_read_b64_tr_b16 v[66:67], v9 offset:16384
    v_mfma_f32_16x16x32_bf16 v[144:147], v[112:115], v[88:91], v[144:147]
    ds_read_b64_tr_b16 v[68:69], v10 offset:16384
    v_mfma_f32_16x16x32_bf16 v[148:151], v[116:119], v[88:91], v[148:151]
    ds_read_b64_tr_b16 v[70:71], v11 offset:16384
    v_mfma_f32_16x16x32_bf16 v[160:163], v[112:115], v[96:99], v[160:163]
    ds_read_b64_tr_b16 v[72:73], v8 offset:24576
    v_mfma_f32_16x16x32_bf16 v[164:167], v[116:119], v[96:99], v[164:167]
    ds_read_b64_tr_b16 v[74:75], v9 offset:24576
    v_mfma_f32_16x16x32_bf16 v[176:179], v[112:115], v[104:107], v[176:179]
    ds_read_b64_tr_b16 v[76:77], v10 offset:24576
    v_mfma_f32_16x16x32_bf16 v[180:183], v[116:119], v[104:107], v[180:183]
    ds_read_b64_tr_b16 v[78:79], v11 offset:24576
    v_mfma_f32_16x16x32_bf16 v[192:195], v[112:115], v[208:211], v[192:195]
    ds_read_b128 v[32:35], v24 offset:0
    v_mfma_f32_16x16x32_bf16 v[196:199], v[116:119], v[208:211], v[196:199]
    ds_read_b128 v[36:39], v25 offset:0
    v_mfma_f32_16x16x32_bf16 v[128:131], v[120:123], v[84:87], v[128:131]
    ds_read_b128 v[40:43], v24 offset:2048
    v_mfma_f32_16x16x32_bf16 v[132:135], v[124:127], v[84:87], v[132:135]
    ds_read_b128 v[44:47], v25 offset:2048
    v_mfma_f32_16x16x32_bf16 v[144:147], v[120:123], v[92:95], v[144:147]
    ds_read_b128 v[48:51], v24 offset:4096
    v_mfma_f32_16x16x32_bf16 v[148:151], v[124:127], v[92:95], v[148:151]
    ds_read_b128 v[52:55], v25 offset:4096
    v_mfma_f32_16x16x32_bf16 v[160:163], v[120:123], v[100:103], v[160:163]
    ds_read_b128 v[56:59], v24 offset:6144
    v_mfma_f32_16x16x32_bf16 v[164:167], v[124:127], v[100:103], v[164:167]
    ds_read_b128 v[60:63], v25 offset:6144
    v_mfma_f32_16x16x32_bf16 v[176:179], v[120:123], v[108:111], v[176:179]
    v_mfma_f32_16x16x32_bf16 v[180:183], v[124:127], v[108:111], v[180:183]
    v_mfma_f32_16x16x32_bf16 v[192:195], v[120:123], v[208:211], v[192:195]
    v_mfma_f32_16x16x32_bf16 v[196:199], v[124:127], v[208:211], v[196:199]
    s_waitcnt lgkmcnt(0)
    s_waitcnt vmcnt(8)
    s_barrier
    s_add_u32 m0, s21, 0
    s_nop 0
    buffer_load_dwordx4 v23, s[88:91], s16 offen lds
    s_add_u32 s16, s16, s62
    s_add_u32 m0, s21, 1024
    s_nop 0
    buffer_load_dwordx4 v23, s[88:91], s17 offen lds
    s_add_u32 s17, s17, s62
    s_cmp_ge_u32 s16, s92
    s_cselect_b32 s94, 2048, 0
    s_sub_u32 s16, s16, s94
    s_sub_u32 s17, s17, s94
    s_add_u32 m0, s22, 0
    s_nop 0
    buffer_load_dwordx4 v2, s[8:11], s18 offen lds
    s_add_u32 s18, s18, s20
    s_add_u32 m0, s22, 8192
    s_nop 0
    buffer_load_dwordx4 v2, s[12:15], s19 offen lds
    s_add_u32 s19, s19, s20
    s_cmp_ge_u32 s18, s95
    s_cselect_b32 s94, s93, 0
    s_sub_u32 s18, s18, s94
    s_sub_u32 s19, s19, s94
    v_mfma_f32_16x16x32_bf16 v[128:131], v[64:67], v[32:35], v[128:131]
    ds_read_b64_tr_b16 v[112:113], v8 offset:49152
    v_mfma_f32_16x16x32_bf16 v[132:135], v[68:71], v[32:35], v[132:135]
    ds_read_b64_tr_b16 v[114:115], v9 offset:49152
    v_mfma_f32_16x16x32_bf16 v[144:147], v[64:67], v[40:43], v[144:147]
    ds_read_b64_tr_b16 v[116:117], v10 offset:49152
    v_mfma_f32_16x16x32_bf16 v[148:151], v[68:71], v[40:43], v[148:151]
    ds_read_b64_tr_b16 v[118:119], v11 offset:49152
    v_mfma_f32_16x16x32_bf16 v[160:163], v[64:67], v[48:51], v[160:163]
    ds_read_b64_tr_b16 v[120:121], v8 offset:57344
    v_mfma_f32_16x16x32_bf16 v[164:167], v[68:71], v[48:51], v[164:167]
    ds_read_b64_tr_b16 v[122:123], v9 offset:57344
    v_mfma_f32_16x16x32_bf16 v[176:179], v[64:67], v[56:59], v[176:179]
    ds_read_b64_tr_b16 v[124:125], v10 offset:57344
    v_mfma_f32_16x16x32_bf16 v[180:183], v[68:71], v[56:59], v[180:183]
    ds_read_b64_tr_b16 v[126:127], v11 offset:57344
    v_mfma_f32_16x16x32_bf16 v[192:195], v[64:67], v[208:211], v[192:195]
    ds_read_b128 v[80:83], v24 offset:32768
    v_mfma_f32_16x16x32_bf16 v[196:199], v[68:71], v[208:211], v[196:199]
    ds_read_b128 v[84:87], v25 offset:32768
    v_mfma_f32_16x16x32_bf16 v[128:131], v[72:75], v[36:39], v[128:131]
    ds_read_b128 v[88:91], v24 offset:34816
    v_mfma_f32_16x16x32_bf16 v[132:135], v[76:79], v[36:39], v[132:135]
    ds_read_b128 v[92:95], v25 offset:34816
    v_mfma_f32_16x16x32_bf16 v[144:147], v[72:75], v[44:47], v[144:147]
    ds_read_b128 v[96:99], v24 offset:36864
    v_mfma_f32_16x16x32_bf16 v[148:151], v[76:79], v[44:47], v[148:151]
    ds_read_b128 v[100:103], v25 offset:36864
    v_mfma_f32_16x16x32_bf16 v[160:163], v[72:75], v[52:55], v[160:163]
    ds_read_b128 v[104:107], v24 offset:38912
    v_mfma_f32_16x16x32_bf16 v[164:167], v[76:79], v[52:55], v[164:167]
    ds_read_b128 v[108:111], v25 offset:38912
    v_mfma_f32_16x16x32_bf16 v[176:179], v[72:75], v[60:63], v[176:179]
    v_mfma_f32_16x16x32_bf16 v[180:183], v[76:79], v[60:63], v[180:183]
    v_mfma_f32_16x16x32_bf16 v[192:195], v[72:75], v[208:211], v[192:195]
    v_mfma_f32_16x16x32_bf16 v[196:199], v[76:79], v[208:211], v[196:199]
    s_waitcnt lgkmcnt(0)
    s_waitcnt vmcnt(8)
    s_barrier
    s_add_u32 m0, s21, 32768
    s_nop 0
    buffer_load_dwordx4 v23, s[88:91], s16 offen lds
    s_add_u32 s16, s16, s62
    s_add_u32 m0, s21, 33792
    s_nop 0
    buffer_load_dwordx4 v23, s[88:91], s17 offen lds
    s_add_u32 s17, s17, s62
    s_cmp_ge_u32 s16, s92
    s_cselect_b32 s94, 2048, 0
    s_sub_u32 s16, s16, s94
    s_sub_u32 s17, s17, s94
    s_add_u32 m0, s22, 32768
    s_nop 0
    buffer_load_dwordx4 v2, s[8:11], s18 offen lds
    s_add_u32 s18, s18, s20
    s_add_u32 m0, s22, 40960
    s_nop 0
    buffer_load_dwordx4 v2, s[12:15], s19 offen lds
    s_add_u32 s19, s19, s20
    s_cmp_ge_u32 s18, s95
    s_cselect_b32 s94, s93, 0
    s_sub_u32 s18, s18, s94
    s_sub_u32 s19, s19, s94
    v_mfma_f32_16x16x32_bf16 v[128:131], v[112:115], v[80:83], v[128:131]
    ds_read_b64_tr_b16 v[64:65], v12 offset:16384
    v_mfma_f32_16x16x32_bf16 v[132:135], v[116:119], v[80:83], v[132:135]
    ds_read_b64_tr_b16 v[66:67], v13 offset:16384
    v_mfma_f32_16x16x32_bf16 v[144:147], v[112:115], v[88:91], v[144:147]
    ds_read_b64_tr_b16 v[68:69], v14 offset:16384
    v_mfma_f32_16x16x32_bf16 v[148:151], v[116:119], v[88:91], v[148:151]
    ds_read_b64_tr_b16 v[70:71], v15 offset:16384
    v_mfma_f32_16x16x32_bf16 v[160:163], v[112:115], v[96:99], v[160:163]
    ds_read_b64_tr_b16 v[72:73], v12 offset:24576
    v_mfma_f32_16x16x32_bf16 v[164:167], v[116:119], v[96:99], v[164:167]
    ds_read_b64_tr_b16 v[74:75], v13 offset:24576
    v_mfma_f32_16x16x32_bf16 v[176:179], v[112:115], v[104:107], v[176:179]
    ds_read_b64_tr_b16 v[76:77], v14 offset:24576
    v_mfma_f32_16x16x32_bf16 v[180:183], v[116:119], v[104:107], v[180:183]
    ds_read_b64_tr_b16 v[78:79], v15 offset:24576
    v_mfma_f32_16x16x32_bf16 v[192:195], v[112:115], v[208:211], v[192:195]
    ds_read_b128 v[32:35], v26 offset:0
    v_mfma_f32_16x16x32_bf16 v[196:199], v[116:119], v[208:211], v[196:199]
    ds_read_b128 v[36:39], v27 offset:0
    v_mfma_f32_16x16x32_bf16 v[128:131], v[120:123], v[84:87], v[128:131]
    ds_read_b128 v[40:43], v26 offset:2048
    v_mfma_f32_16x16x32_bf16 v[132:135], v[124:127], v[84:87], v[132:135]
    ds_read_b128 v[44:47], v27 offset:2048
    v_mfma_f32_16x16x32_bf16 v[144:147], v[120:123], v[92:95], v[144:147]
    ds_read_b128 v[48:51], v26 offset:4096
    v_mfma_f32_16x16x32_bf16 v[148:151], v[124:127], v[92:95], v[148:151]
    ds_read_b128 v[52:55], v27 offset:4096
    v_mfma_f32_16x16x32_bf16 v[160:163], v[120:123], v[100:103], v[160:163]
    ds_read_b128 v[56:59], v26 offset:6144
    v_mfma_f32_16x16x32_bf16 v[164:167], v[124:127], v[100:103], v[164:167]
    ds_read_b128 v[60:63], v27 offset:6144
    v_mfma_f32_16x16x32_bf16 v[176:179], v[120:123], v[108:111], v[176:179]
    v_mfma_f32_16x16x32_bf16 v[180:183], v[124:127], v[108:111], v[180:183]
    v_mfma_f32_16x16x32_bf16 v[192:195], v[120:123], v[208:211], v[192:195]
    v_mfma_f32_16x16x32_bf16 v[196:199], v[124:127], v[208:211], v[196:199]
    s_waitcnt lgkmcnt(0)
    s_waitcnt vmcnt(8)
    s_barrier
    s_add_u32 m0, s21, 65536
    s_nop 0
    buffer_load_dwordx4 v23, s[88:91], s16 offen lds
    s_add_u32 s16, s16, s62
    s_add_u32 m0, s21, 66560
    s_nop 0
    buffer_load_dwordx4 v23, s[88:91], s17 offen lds
    s_add_u32 s17, s17, s62
    s_cmp_ge_u32 s16, s92
    s_cselect_b32 s94, 2048, 0
    s_sub_u32 s16, s16, s94
    s_sub_u32 s17, s17, s94
    s_add_u32 m0, s22, 65536
    s_nop 0
    buffer_load_dwordx4 v2, s[8:11], s18 offen lds
    s_add_u32 s18, s18, s20
    s_add_u32 m0, s22, 73728
    s_nop 0
    buffer_load_dwordx4 v2, s[12:15], s19 offen lds
    s_add_u32 s19, s19, s20
    s_cmp_ge_u32 s18, s95
    s_cselect_b32 s94, s93, 0
    s_sub_u32 s18, s18, s94
    s_sub_u32 s19, s19, s94
    v_mfma_f32_16x16x32_bf16 v[128:131], v[64:67], v[32:35], v[128:131]
    ds_read_b64_tr_b16 v[112:113], v12 offset:49152
    v_mfma_f32_16x16x32_bf16 v[132:135], v[68:71], v[32:35], v[132:135]
    ds_read_b64_tr_b16 v[114:115], v13 offset:49152
    v_mfma_f32_16x16x32_bf16 v[144:147], v[64:67], v[40:43], v[144:147]
    ds_read_b64_tr_b16 v[116:117], v14 offset:49152
    v_mfma_f32_16x16x32_bf16 v[148:151], v[68:71], v[40:43], v[148:151]
    ds_read_b64_tr_b16 v[118:119], v15 offset:49152
    v_mfma_f32_16x16x32_bf16 v[160:163], v[64:67], v[48:51], v[160:163]
    ds_read_b64_tr_b16 v[120:121], v12 offset:57344
    v_mfma_f32_16x16x32_bf16 v[164:167], v[68:71], v[48:51], v[164:167]
    ds_read_b64_tr_b16 v[122:123], v13 offset:57344
    v_mfma_f32_16x16x32_bf16 v[176:179], v[64:67], v[56:59], v[176:179]
    ds_read_b64_tr_b16 v[124:125], v14 offset:57344
    v_mfma_f32_16x16x32_bf16 v[180:183], v[68:71], v[56:59], v[180:183]
    ds_read_b64_tr_b16 v[126:127], v15 offset:57344
    v_mfma_f32_16x16x32_bf16 v[192:195], v[64:67], v[208:211], v[192:195]
    ds_read_b128 v[80:83], v26 offset:32768
    v_mfma_f32_16x16x32_bf16 v[196:199], v[68:71], v[208:211], v[196:199]
    ds_read_b128 v[84:87], v27 offset:32768
    v_mfma_f32_16x16x32_bf16 v[128:131], v[72:75], v[36:39], v[128:131]
    ds_read_b128 v[88:91], v26 offset:34816
    v_mfma_f32_16x16x32_bf16 v[132:135], v[76:79], v[36:39], v[132:135]
    ds_read_b128 v[92:95], v27 offset:34816
    v_mfma_f32_16x16x32_bf16 v[144:147], v[72:75], v[44:47], v[144:147]
    ds_read_b128 v[96:99], v26 offset:36864
    v_mfma_f32_16x16x32_bf16 v[148:151], v[76:79], v[44:47], v[148:151]
    ds_read_b128 v[100:103], v27 offset:36864
    v_mfma_f32_16x16x32_bf16 v[160:163], v[72:75], v[52:55], v[160:163]
    ds_read_b128 v[104:107], v26 offset:38912
    v_mfma_f32_16x16x32_bf16 v[164:167], v[76:79], v[52:55], v[164:167]
    ds_read_b128 v[108:111], v27 offset:38912
    v_mfma_f32_16x16x32_bf16 v[176:179], v[72:75], v[60:63], v[176:179]
    v_mfma_f32_16x16x32_bf16 v[180:183], v[76:79], v[60:63], v[180:183]
    v_mfma_f32_16x16x32_bf16 v[192:195], v[72:75], v[208:211], v[192:195]
    v_mfma_f32_16x16x32_bf16 v[196:199], v[76:79], v[208:211], v[196:199]
    s_waitcnt lgkmcnt(0)
    s_waitcnt vmcnt(8)
    s_barrier
    s_add_u32 m0, s21, 98304
    s_nop 0
    buffer_load_dwordx4 v23, s[88:91], s16 offen lds
    s_add_u32 s16, s16, s62
    s_add_u32 m0, s21, 99328
    s_nop 0
    buffer_load_dwordx4 v23, s[88:91], s17 offen lds
    s_add_u32 s17, s17, s62
    s_cmp_ge_u32 s16, s92
    s_cselect_b32 s94, 2048, 0
    s_sub_u32 s16, s16, s94
    s_sub_u32 s17, s17, s94
    s_add_u32 m0, s22, 98304
    s_nop 0
    buffer_load_dwordx4 v2, s[8:11], s18 offen lds
    s_add_u32 s18, s18, s20
    s_add_u32 m0, s22, 106496
    s_nop 0
    buffer_load_dwordx4 v2, s[12:15], s19 offen lds
    s_add_u32 s19, s19, s20
    s_cmp_ge_u32 s18, s95
    s_cselect_b32 s94, s93, 0
    s_sub_u32 s18, s18, s94
    s_sub_u32 s19, s19, s94
    v_mfma_f32_16x16x32_bf16 v[128:131], v[112:115], v[80:83], v[128:131]
    ds_read_b64_tr_b16 v[64:65], v8 offset:16384
    v_mfma_f32_16x16x32_bf16 v[132:135], v[116:119], v[80:83], v[132:135]
    ds_read_b64_tr_b16 v[66:67], v9 offset:16384
    v_mfma_f32_16x16x32_bf16 v[144:147], v[112:115], v[88:91], v[144:147]
    ds_read_b64_tr_b16 v[68:69], v10 offset:16384
    v_mfma_f32_16x16x32_bf16 v[148:151], v[116:119], v[88:91], v[148:151]
    ds_read_b64_tr_b16 v[70:71], v11 offset:16384
    v_mfma_f32_16x16x32_bf16 v[160:163], v[112:115], v[96:99], v[160:163]
    ds_read_b64_tr_b16 v[72:73], v8 offset:24576
    v_mfma_f32_16x16x32_bf16 v[164:167], v[116:119], v[96:99], v[164:167]
    ds_read_b64_tr_b16 v[74:75], v9 offset:24576
    v_mfma_f32_16x16x32_bf16 v[176:179], v[112:115], v[104:107], v[176:179]
    ds_read_b64_tr_b16 v[76:77], v10 offset:24576
    v_mfma_f32_16x16x32_bf16 v[180:183], v[116:119], v[104:107], v[180:183]
    ds_read_b64_tr_b16 v[78:79], v11 offset:24576
    v_mfma_f32_16x16x32_bf16 v[192:195], v[112:115], v[208:211], v[192:195]
    ds_read_b128 v[32:35], v24 offset:0
    v_mfma_f32_16x16x32_bf16 v[196:199], v[116:119], v[208:211], v[196:199]
    ds_read_b128 v[36:39], v25 offset:0
    v_mfma_f32_16x16x32_bf16 v[128:131], v[120:123], v[84:87], v[128:131]
    ds_read_b128 v[40:43], v24 offset:2048
    v_mfma_f32_16x16x32_bf16 v[132:135], v[124:127], v[84:87], v[132:135]
    ds_read_b128 v[44:47], v25 offset:2048
    v_mfma_f32_16x16x32_bf16 v[144:147], v[120:123], v[92:95], v[144:147]
    ds_read_b128 v[48:51], v24 offset:4096
    v_mfma_f32_16x16x32_bf16 v[148:151], v[124:127], v[92:95], v[148:151]
    ds_read_b128 v[52:55], v25 offset:4096
    v_mfma_f32_16x16x32_bf16 v[160:163], v[120:123], v[100:103], v[160:163]
    ds_read_b128 v[56:59], v24 offset:6144
    v_mfma_f32_16x16x32_bf16 v[164:167], v[124:127], v[100:103], v[164:167]
    ds_read_b128 v[60:63], v25 offset:6144
    v_mfma_f32_16x16x32_bf16 v[176:179], v[120:123], v[108:111], v[176:179]
    v_mfma_f32_16x16x32_bf16 v[180:183], v[124:127], v[108:111], v[180:183]
    v_mfma_f32_16x16x32_bf16 v[192:195], v[120:123], v[208:211], v[192:195]
    v_mfma_f32_16x16x32_bf16 v[196:199], v[124:127], v[208:211], v[196:199]
    s_waitcnt lgkmcnt(0)
    s_waitcnt vmcnt(8)
    s_barrier
    s_add_u32 m0, s21, 0
    s_nop 0
    buffer_load_dwordx4 v23, s[88:91], s16 offen lds
    s_add_u32 s16, s16, s62
    s_add_u32 m0, s21, 1024
    s_nop 0
    buffer_load_dwordx4 v23, s[88:91], s17 offen lds
    s_add_u32 s17, s17, s62
    s_cmp_ge_u32 s16, s92
    s_cselect_b32 s94, 2048, 0
    s_sub_u32 s16, s16, s94
    s_sub_u32 s17, s17, s94
    s_add_u32 m0, s22, 0
    s_nop 0
    buffer_load_dwordx4 v2, s[8:11], s18 offen lds
    s_add_u32 s18, s18, s20
    s_add_u32 m0, s22, 8192
    s_nop 0
    buffer_load_dwordx4 v2, s[12:15], s19 offen lds
    s_add_u32 s19, s19, s20
    s_cmp_ge_u32 s18, s95
    s_cselect_b32 s94, s93, 0
    s_sub_u32 s18, s18, s94
    s_sub_u32 s19, s19, s94
    v_mfma_f32_16x16x32_bf16 v[128:131], v[64:67], v[32:35], v[128:131]
    ds_read_b64_tr_b16 v[112:113], v8 offset:49152
    v_mfma_f32_16x16x32_bf16 v[132:135], v[68:71], v[32:35], v[132:135]
    ds_read_b64_tr_b16 v[114:115], v9 offset:49152
    v_mfma_f32_16x16x32_bf16 v[144:147], v[64:67], v[40:43], v[144:147]
    ds_read_b64_tr_b16 v[116:117], v10 offset:49152
    v_mfma_f32_16x16x32_bf16 v[148:151], v[68:71], v[40:43], v[148:151]
    ds_read_b64_tr_b16 v[118:119], v11 offset:49152
    v_mfma_f32_16x16x32_bf16 v[160:163], v[64:67], v[48:51], v[160:163]
    ds_read_b64_tr_b16 v[120:121], v8 offset:57344
    v_mfma_f32_16x16x32_bf16 v[164:167], v[68:71], v[48:51], v[164:167]
    ds_read_b64_tr_b16 v[122:123], v9 offset:57344
    v_mfma_f32_16x16x32_bf16 v[176:179], v[64:67], v[56:59], v[176:179]
    ds_read_b64_tr_b16 v[124:125], v10 offset:57344
    v_mfma_f32_16x16x32_bf16 v[180:183], v[68:71], v[56:59], v[180:183]
    ds_read_b64_tr_b16 v[126:127], v11 offset:57344
    v_mfma_f32_16x16x32_bf16 v[192:195], v[64:67], v[208:211], v[192:195]
    ds_read_b128 v[80:83], v24 offset:32768
    v_mfma_f32_16x16x32_bf16 v[196:199], v[68:71], v[208:211], v[196:199]
    ds_read_b128 v[84:87], v25 offset:32768
    v_mfma_f32_16x16x32_bf16 v[128:131], v[72:75], v[36:39], v[128:131]
    ds_read_b128 v[88:91], v24 offset:34816
    v_mfma_f32_16x16x32_bf16 v[132:135], v[76:79], v[36:39], v[132:135]
    ds_read_b128 v[92:95], v25 offset:34816
    v_mfma_f32_16x16x32_bf16 v[144:147], v[72:75], v[44:47], v[144:147]
    ds_read_b128 v[96:99], v24 offset:36864
    v_mfma_f32_16x16x32_bf16 v[148:151], v[76:79], v[44:47], v[148:151]
    ds_read_b128 v[100:103], v25 offset:36864
    v_mfma_f32_16x16x32_bf16 v[160:163], v[72:75], v[52:55], v[160:163]
    ds_read_b128 v[104:107], v24 offset:38912
    v_mfma_f32_16x16x32_bf16 v[164:167], v[76:79], v[52:55], v[164:167]
    ds_read_b128 v[108:111], v25 offset:38912
    v_mfma_f32_16x16x32_bf16 v[176:179], v[72:75], v[60:63], v[176:179]
    v_mfma_f32_16x16x32_bf16 v[180:183], v[76:79], v[60:63], v[180:183]
    v_mfma_f32_16x16x32_bf16 v[192:195], v[72:75], v[208:211], v[192:195]
    v_mfma_f32_16x16x32_bf16 v[196:199], v[76:79], v[208:211], v[196:199]
    s_waitcnt lgkmcnt(0)
    s_waitcnt vmcnt(8)
    s_barrier
    s_add_u32 m0, s21, 32768
    s_nop 0
    buffer_load_dwordx4 v23, s[88:91], s16 offen lds
    s_add_u32 s16, s16, s62
    s_add_u32 m0, s21, 33792
    s_nop 0
    buffer_load_dwordx4 v23, s[88:91], s17 offen lds
    s_add_u32 s17, s17, s62
    s_cmp_ge_u32 s16, s92
    s_cselect_b32 s94, 2048, 0
    s_sub_u32 s16, s16, s94
    s_sub_u32 s17, s17, s94
    s_add_u32 m0, s22, 32768
    s_nop 0
    buffer_load_dwordx4 v2, s[8:11], s18 offen lds
    s_add_u32 s18, s18, s20
    s_add_u32 m0, s22, 40960
    s_nop 0
    buffer_load_dwordx4 v2, s[12:15], s19 offen lds
    s_add_u32 s19, s19, s20
    s_cmp_ge_u32 s18, s95
    s_cselect_b32 s94, s93, 0
    s_sub_u32 s18, s18, s94
    s_sub_u32 s19, s19, s94
    v_mfma_f32_16x16x32_bf16 v[128:131], v[112:115], v[80:83], v[128:131]
    ds_read_b64_tr_b16 v[64:65], v12 offset:16384
    v_mfma_f32_16x16x32_bf16 v[132:135], v[116:119], v[80:83], v[132:135]
    ds_read_b64_tr_b16 v[66:67], v13 offset:16384
    v_mfma_f32_16x16x32_bf16 v[144:147], v[112:115], v[88:91], v[144:147]
    ds_read_b64_tr_b16 v[68:69], v14 offset:16384
    v_mfma_f32_16x16x32_bf16 v[148:151], v[116:119], v[88:91], v[148:151]
    ds_read_b64_tr_b16 v[70:71], v15 offset:16384
    v_mfma_f32_16x16x32_bf16 v[160:163], v[112:115], v[96:99], v[160:163]
    ds_read_b64_tr_b16 v[72:73], v12 offset:24576
    v_mfma_f32_16x16x32_bf16 v[164:167], v[116:119], v[96:99], v[164:167]
    ds_read_b64_tr_b16 v[74:75], v13 offset:24576
    v_mfma_f32_16x16x32_bf16 v[176:179], v[112:115], v[104:107], v[176:179]
    ds_read_b64_tr_b16 v[76:77], v14 offset:24576
    v_mfma_f32_16x16x32_bf16 v[180:183], v[116:119], v[104:107], v[180:183]
    ds_read_b64_tr_b16 v[78:79], v15 offset:24576
    v_mfma_f32_16x16x32_bf16 v[192:195], v[112:115], v[208:211], v[192:195]
    ds_read_b128 v[32:35], v26 offset:0
    v_mfma_f32_16x16x32_bf16 v[196:199], v[116:119], v[208:211], v[196:199]
    ds_read_b128 v[36:39], v27 offset:0
    v_mfma_f32_16x16x32_bf16 v[128:131], v[120:123], v[84:87], v[128:131]
    ds_read_b128 v[40:43], v26 offset:2048
    v_mfma_f32_16x16x32_bf16 v[132:135], v[124:127], v[84:87], v[132:135]
    ds_read_b128 v[44:47], v27 offset:2048
    v_mfma_f32_16x16x32_bf16 v[144:147], v[120:123], v[92:95], v[144:147]
    ds_read_b128 v[48:51], v26 offset:4096
    v_mfma_f32_16x16x32_bf16 v[148:151], v[124:127], v[92:95], v[148:151]
    ds_read_b128 v[52:55], v27 offset:4096
    v_mfma_f32_16x16x32_bf16 v[160:163], v[120:123], v[100:103], v[160:163]
    ds_read_b128 v[56:59], v26 offset:6144
    v_mfma_f32_16x16x32_bf16 v[164:167], v[124:127], v[100:103], v[164:167]
    ds_read_b128 v[60:63], v27 offset:6144
    v_mfma_f32_16x16x32_bf16 v[176:179], v[120:123], v[108:111], v[176:179]
    v_mfma_f32_16x16x32_bf16 v[180:183], v[124:127], v[108:111], v[180:183]
    v_mfma_f32_16x16x32_bf16 v[192:195], v[120:123], v[208:211], v[192:195]
    v_mfma_f32_16x16x32_bf16 v[196:199], v[124:127], v[208:211], v[196:199]
    s_waitcnt lgkmcnt(0)
    s_waitcnt vmcnt(8)
    s_barrier
    s_add_u32 m0, s21, 65536
    s_nop 0
    buffer_load_dwordx4 v23, s[88:91], s16 offen lds
    s_add_u32 s16, s16, s62
    s_add_u32 m0, s21, 66560
    s_nop 0
    buffer_load_dwordx4 v23, s[88:91], s17 offen lds
    s_add_u32 s17, s17, s62
    s_cmp_ge_u32 s16, s92
    s_cselect_b32 s94, 2048, 0
    s_sub_u32 s16, s16, s94
    s_sub_u32 s17, s17, s94
    s_add_u32 m0, s22, 65536
    s_nop 0
    buffer_load_dwordx4 v2, s[8:11], s18 offen lds
    s_add_u32 s18, s18, s20
    s_add_u32 m0, s22, 73728
    s_nop 0
    buffer_load_dwordx4 v2, s[12:15], s19 offen lds
    s_add_u32 s19, s19, s20
    s_cmp_ge_u32 s18, s95
    s_cselect_b32 s94, s93, 0
    s_sub_u32 s18, s18, s94
    s_sub_u32 s19, s19, s94
    v_mfma_f32_16x16x32_bf16 v[128:131], v[64:67], v[32:35], v[128:131]
    ds_read_b64_tr_b16 v[112:113], v12 offset:49152
    v_mfma_f32_16x16x32_bf16 v[132:135], v[68:71], v[32:35], v[132:135]
    ds_read_b64_tr_b16 v[114:115], v13 offset:49152
    v_mfma_f32_16x16x32_bf16 v[144:147], v[64:67], v[40:43], v[144:147]
    ds_read_b64_tr_b16 v[116:117], v14 offset:49152
    v_mfma_f32_16x16x32_bf16 v[148:151], v[68:71], v[40:43], v[148:151]
    ds_read_b64_tr_b16 v[118:119], v15 offset:49152
    v_mfma_f32_16x16x32_bf16 v[160:163], v[64:67], v[48:51], v[160:163]
    ds_read_b64_tr_b16 v[120:121], v12 offset:57344
    v_mfma_f32_16x16x32_bf16 v[164:167], v[68:71], v[48:51], v[164:167]
    ds_read_b64_tr_b16 v[122:123], v13 offset:57344
    v_mfma_f32_16x16x32_bf16 v[176:179], v[64:67], v[56:59], v[176:179]
    ds_read_b64_tr_b16 v[124:125], v14 offset:57344
    v_mfma_f32_16x16x32_bf16 v[180:183], v[68:71], v[56:59], v[180:183]
    ds_read_b64_tr_b16 v[126:127], v15 offset:57344
    v_mfma_f32_16x16x32_bf16 v[192:195], v[64:67], v[208:211], v[192:195]
    ds_read_b128 v[80:83], v26 offset:32768
    v_mfma_f32_16x16x32_bf16 v[196:199], v[68:71], v[208:211], v[196:199]
    ds_read_b128 v[84:87], v27 offset:32768
    v_mfma_f32_16x16x32_bf16 v[128:131], v[72:75], v[36:39], v[128:131]
    ds_read_b128 v[88:91], v26 offset:34816
    v_mfma_f32_16x16x32_bf16 v[132:135], v[76:79], v[36:39], v[132:135]
    ds_read_b128 v[92:95], v27 offset:34816
    v_mfma_f32_16x16x32_bf16 v[144:147], v[72:75], v[44:47], v[144:147]
    ds_read_b128 v[96:99], v26 offset:36864
    v_mfma_f32_16x16x32_bf16 v[148:151], v[76:79], v[44:47], v[148:151]
    ds_read_b128 v[100:103], v27 offset:36864
    v_mfma_f32_16x16x32_bf16 v[160:163], v[72:75], v[52:55], v[160:163]
    ds_read_b128 v[104:107], v26 offset:38912
    v_mfma_f32_16x16x32_bf16 v[164:167], v[76:79], v[52:55], v[164:167]
    ds_read_b128 v[108:111], v27 offset:38912
    v_mfma_f32_16x16x32_bf16 v[176:179], v[72:75], v[60:63], v[176:179]
    v_mfma_f32_16x16x32_bf16 v[180:183], v[76:79], v[60:63], v[180:183]
    v_mfma_f32_16x16x32_bf16 v[192:195], v[72:75], v[208:211], v[192:195]
    v_mfma_f32_16x16x32_bf16 v[196:199], v[76:79], v[208:211], v[196:199]
    s_waitcnt lgkmcnt(0)
    s_waitcnt vmcnt(8)
    s_barrier
    s_add_u32 m0, s21, 98304
    s_nop 0
    buffer_load_dwordx4 v23, s[88:91], s16 offen lds
    s_add_u32 s16, s16, s62
    s_add_u32 m0, s21, 99328
    s_nop 0
    buffer_load_dwordx4 v23, s[88:91], s17 offen lds
    s_add_u32 s17, s17, s62
    s_cmp_ge_u32 s16, s92
    s_cselect_b32 s94, 2048, 0
    s_sub_u32 s16, s16, s94
    s_sub_u32 s17, s17, s94
    s_add_u32 m0, s22, 98304
    s_nop 0
    buffer_load_dwordx4 v2, s[8:11], s18 offen lds
    s_add_u32 s18, s18, s20
    s_add_u32 m0, s22, 106496
    s_nop 0
    buffer_load_dwordx4 v2, s[12:15], s19 offen lds
    s_add_u32 s19, s19, s20
    s_cmp_ge_u32 s18, s95
    s_cselect_b32 s94, s93, 0
    s_sub_u32 s18, s18, s94
    s_sub_u32 s19, s19, s94
    v_mfma_f32_16x16x32_bf16 v[128:131], v[112:115], v[80:83], v[128:131]
    ds_read_b64_tr_b16 v[64:65], v8 offset:16384
    v_mfma_f32_16x16x32_bf16 v[132:135], v[116:119], v[80:83], v[132:135]
    ds_read_b64_tr_b16 v[66:67], v9 offset:16384
    v_mfma_f32_16x16x32_bf16 v[144:147], v[112:115], v[88:91], v[144:147]
    ds_read_b64_tr_b16 v[68:69], v10 offset:16384
    v_mfma_f32_16x16x32_bf16 v[148:151], v[116:119], v[88:91], v[148:151]
    ds_read_b64_tr_b16 v[70:71], v11 offset:16384
    v_mfma_f32_16x16x32_bf16 v[160:163], v[112:115], v[96:99], v[160:163]
    ds_read_b64_tr_b16 v[72:73], v8 offset:24576
    v_mfma_f32_16x16x32_bf16 v[164:167], v[116:119], v[96:99], v[164:167]
    ds_read_b64_tr_b16 v[74:75], v9 offset:24576
    v_mfma_f32_16x16x32_bf16 v[176:179], v[112:115], v[104:107], v[176:179]
    ds_read_b64_tr_b16 v[76:77], v10 offset:24576
    v_mfma_f32_16x16x32_bf16 v[180:183], v[116:119], v[104:107], v[180:183]
    ds_read_b64_tr_b16 v[78:79], v11 offset:24576
    v_mfma_f32_16x16x32_bf16 v[192:195], v[112:115], v[208:211], v[192:195]
    ds_read_b128 v[32:35], v24 offset:0
    v_mfma_f32_16x16x32_bf16 v[196:199], v[116:119], v[208:211], v[196:199]
    ds_read_b128 v[36:39], v25 offset:0
    v_mfma_f32_16x16x32_bf16 v[128:131], v[120:123], v[84:87], v[128:131]
    ds_read_b128 v[40:43], v24 offset:2048
    v_mfma_f32_16x16x32_bf16 v[132:135], v[124:127], v[84:87], v[132:135]
    ds_read_b128 v[44:47], v25 offset:2048
    v_mfma_f32_16x16x32_bf16 v[144:147], v[120:123], v[92:95], v[144:147]
    ds_read_b128 v[48:51], v24 offset:4096
    v_mfma_f32_16x16x32_bf16 v[148:151], v[124:127], v[92:95], v[148:151]
    ds_read_b128 v[52:55], v25 offset:4096
    v_mfma_f32_16x16x32_bf16 v[160:163], v[120:123], v[100:103], v[160:163]
    ds_read_b128 v[56:59], v24 offset:6144
    v_mfma_f32_16x16x32_bf16 v[164:167], v[124:127], v[100:103], v[164:167]
    ds_read_b128 v[60:63], v25 offset:6144
    v_mfma_f32_16x16x32_bf16 v[176:179], v[120:123], v[108:111], v[176:179]
    v_mfma_f32_16x16x32_bf16 v[180:183], v[124:127], v[108:111], v[180:183]
    v_mfma_f32_16x16x32_bf16 v[192:195], v[120:123], v[208:211], v[192:195]
    v_mfma_f32_16x16x32_bf16 v[196:199], v[124:127], v[208:211], v[196:199]
    s_waitcnt lgkmcnt(0)
    s_waitcnt vmcnt(8)
    s_barrier
    v_mfma_f32_16x16x32_bf16 v[128:131], v[64:67], v[32:35], v[128:131]
    ds_read_b64_tr_b16 v[112:113], v8 offset:49152
    v_mfma_f32_16x16x32_bf16 v[132:135], v[68:71], v[32:35], v[132:135]
    ds_read_b64_tr_b16 v[114:115], v9 offset:49152
    v_mfma_f32_16x16x32_bf16 v[144:147], v[64:67], v[40:43], v[144:147]
    ds_read_b64_tr_b16 v[116:117], v10 offset:49152
    v_mfma_f32_16x16x32_bf16 v[148:151], v[68:71], v[40:43], v[148:151]
    ds_read_b64_tr_b16 v[118:119], v11 offset:49152
    v_mfma_f32_16x16x32_bf16 v[160:163], v[64:67], v[48:51], v[160:163]
    ds_read_b64_tr_b16 v[120:121], v8 offset:57344
    v_mfma_f32_16x16x32_bf16 v[164:167], v[68:71], v[48:51], v[164:167]
    ds_read_b64_tr_b16 v[122:123], v9 offset:57344
    v_mfma_f32_16x16x32_bf16 v[176:179], v[64:67], v[56:59], v[176:179]
    ds_read_b64_tr_b16 v[124:125], v10 offset:57344
    v_mfma_f32_16x16x32_bf16 v[180:183], v[68:71], v[56:59], v[180:183]
    ds_read_b64_tr_b16 v[126:127], v11 offset:57344
    v_mfma_f32_16x16x32_bf16 v[192:195], v[64:67], v[208:211], v[192:195]
    ds_read_b128 v[80:83], v24 offset:32768
    v_mfma_f32_16x16x32_bf16 v[196:199], v[68:71], v[208:211], v[196:199]
    ds_read_b128 v[84:87], v25 offset:32768
    v_mfma_f32_16x16x32_bf16 v[128:131], v[72:75], v[36:39], v[128:131]
    ds_read_b128 v[88:91], v24 offset:34816
    v_mfma_f32_16x16x32_bf16 v[132:135], v[76:79], v[36:39], v[132:135]
    ds_read_b128 v[92:95], v25 offset:34816
    v_mfma_f32_16x16x32_bf16 v[144:147], v[72:75], v[44:47], v[144:147]
    ds_read_b128 v[96:99], v24 offset:36864
    v_mfma_f32_16x16x32_bf16 v[148:151], v[76:79], v[44:47], v[148:151]
    ds_read_b128 v[100:103], v25 offset:36864
    v_mfma_f32_16x16x32_bf16 v[160:163], v[72:75], v[52:55], v[160:163]
    ds_read_b128 v[104:107], v24 offset:38912
    v_mfma_f32_16x16x32_bf16 v[164:167], v[76:79], v[52:55], v[164:167]
    ds_read_b128 v[108:111], v25 offset:38912
    v_mfma_f32_16x16x32_bf16 v[176:179], v[72:75], v[60:63], v[176:179]
    v_mfma_f32_16x16x32_bf16 v[180:183], v[76:79], v[60:63], v[180:183]
    v_mfma_f32_16x16x32_bf16 v[192:195], v[72:75], v[208:211], v[192:195]
    v_mfma_f32_16x16x32_bf16 v[196:199], v[76:79], v[208:211], v[196:199]
    s_waitcnt lgkmcnt(0)
    s_waitcnt vmcnt(4)
    s_barrier
    v_mfma_f32_16x16x32_bf16 v[128:131], v[112:115], v[80:83], v[128:131]
    ds_read_b64_tr_b16 v[64:65], v12 offset:16384
    v_mfma_f32_16x16x32_bf16 v[132:135], v[116:119], v[80:83], v[132:135]
    ds_read_b64_tr_b16 v[66:67], v13 offset:16384
    v_mfma_f32_16x16x32_bf16 v[144:147], v[112:115], v[88:91], v[144:147]
    ds_read_b64_tr_b16 v[68:69], v14 offset:16384
    v_mfma_f32_16x16x32_bf16 v[148:151], v[116:119], v[88:91], v[148:151]
    ds_read_b64_tr_b16 v[70:71], v15 offset:16384
    v_mfma_f32_16x16x32_bf16 v[160:163], v[112:115], v[96:99], v[160:163]
    ds_read_b64_tr_b16 v[72:73], v12 offset:24576
    v_mfma_f32_16x16x32_bf16 v[164:167], v[116:119], v[96:99], v[164:167]
    ds_read_b64_tr_b16 v[74:75], v13 offset:24576
    v_mfma_f32_16x16x32_bf16 v[176:179], v[112:115], v[104:107], v[176:179]
    ds_read_b64_tr_b16 v[76:77], v14 offset:24576
    v_mfma_f32_16x16x32_bf16 v[180:183], v[116:119], v[104:107], v[180:183]
    ds_read_b64_tr_b16 v[78:79], v15 offset:24576
    v_mfma_f32_16x16x32_bf16 v[192:195], v[112:115], v[208:211], v[192:195]
    ds_read_b128 v[32:35], v26 offset:0
    v_mfma_f32_16x16x32_bf16 v[196:199], v[116:119], v[208:211], v[196:199]
    ds_read_b128 v[36:39], v27 offset:0
    v_mfma_f32_16x16x32_bf16 v[128:131], v[120:123], v[84:87], v[128:131]
    ds_read_b128 v[40:43], v26 offset:2048
    v_mfma_f32_16x16x32_bf16 v[132:135], v[124:127], v[84:87], v[132:135]
    ds_read_b128 v[44:47], v27 offset:2048
    v_mfma_f32_16x16x32_bf16 v[144:147], v[120:123], v[92:95], v[144:147]
    ds_read_b128 v[48:51], v26 offset:4096
    v_mfma_f32_16x16x32_bf16 v[148:151], v[124:127], v[92:95], v[148:151]
    ds_read_b128 v[52:55], v27 offset:4096
    v_mfma_f32_16x16x32_bf16 v[160:163], v[120:123], v[100:103], v[160:163]
    ds_read_b128 v[56:59], v26 offset:6144
    v_mfma_f32_16x16x32_bf16 v[164:167], v[124:127], v[100:103], v[164:167]
    ds_read_b128 v[60:63], v27 offset:6144
    v_mfma_f32_16x16x32_bf16 v[176:179], v[120:123], v[108:111], v[176:179]
    v_mfma_f32_16x16x32_bf16 v[180:183], v[124:127], v[108:111], v[180:183]
    v_mfma_f32_16x16x32_bf16 v[192:195], v[120:123], v[208:211], v[192:195]
    v_mfma_f32_16x16x32_bf16 v[196:199], v[124:127], v[208:211], v[196:199]
    s_waitcnt lgkmcnt(0)
    s_waitcnt vmcnt(0)
    s_barrier
    v_mfma_f32_16x16x32_bf16 v[128:131], v[64:67], v[32:35], v[128:131]
    ds_read_b64_tr_b16 v[112:113], v12 offset:49152
    v_mfma_f32_16x16x32_bf16 v[132:135], v[68:71], v[32:35], v[132:135]
    ds_read_b64_tr_b16 v[114:115], v13 offset:49152
    v_mfma_f32_16x16x32_bf16 v[144:147], v[64:67], v[40:43], v[144:147]
    ds_read_b64_tr_b16 v[116:117], v14 offset:49152
    v_mfma_f32_16x16x32_bf16 v[148:151], v[68:71], v[40:43], v[148:151]
    ds_read_b64_tr_b16 v[118:119], v15 offset:49152
    v_mfma_f32_16x16x32_bf16 v[160:163], v[64:67], v[48:51], v[160:163]
    ds_read_b64_tr_b16 v[120:121], v12 offset:57344
    v_mfma_f32_16x16x32_bf16 v[164:167], v[68:71], v[48:51], v[164:167]
    ds_read_b64_tr_b16 v[122:123], v13 offset:57344
    v_mfma_f32_16x16x32_bf16 v[176:179], v[64:67], v[56:59], v[176:179]
    ds_read_b64_tr_b16 v[124:125], v14 offset:57344
    v_mfma_f32_16x16x32_bf16 v[180:183], v[68:71], v[56:59], v[180:183]
    ds_read_b64_tr_b16 v[126:127], v15 offset:57344
    v_mfma_f32_16x16x32_bf16 v[192:195], v[64:67], v[208:211], v[192:195]
    ds_read_b128 v[80:83], v26 offset:32768
    v_mfma_f32_16x16x32_bf16 v[196:199], v[68:71], v[208:211], v[196:199]
    ds_read_b128 v[84:87], v27 offset:32768
    v_mfma_f32_16x16x32_bf16 v[128:131], v[72:75], v[36:39], v[128:131]
    ds_read_b128 v[88:91], v26 offset:34816
    v_mfma_f32_16x16x32_bf16 v[132:135], v[76:79], v[36:39], v[132:135]
    ds_read_b128 v[92:95], v27 offset:34816
    v_mfma_f32_16x16x32_bf16 v[144:147], v[72:75], v[44:47], v[144:147]
    ds_read_b128 v[96:99], v26 offset:36864
    v_mfma_f32_16x16x32_bf16 v[148:151], v[76:79], v[44:47], v[148:151]
    ds_read_b128 v[100:103], v27 offset:36864
    v_mfma_f32_16x16x32_bf16 v[160:163], v[72:75], v[52:55], v[160:163]
    ds_read_b128 v[104:107], v26 offset:38912
    v_mfma_f32_16x16x32_bf16 v[164:167], v[76:79], v[52:55], v[164:167]
    ds_read_b128 v[108:111], v27 offset:38912
    v_mfma_f32_16x16x32_bf16 v[176:179], v[72:75], v[60:63], v[176:179]
    v_mfma_f32_16x16x32_bf16 v[180:183], v[76:79], v[60:63], v[180:183]
    v_mfma_f32_16x16x32_bf16 v[192:195], v[72:75], v[208:211], v[192:195]
    v_mfma_f32_16x16x32_bf16 v[196:199], v[76:79], v[208:211], v[196:199]
    s_waitcnt lgkmcnt(0)
    s_waitcnt vmcnt(0)
    s_barrier
    v_mfma_f32_16x16x32_bf16 v[128:131], v[112:115], v[80:83], v[128:131]
    ds_read_b64_tr_b16 v[64:65], v8 offset:16384
    v_mfma_f32_16x16x32_bf16 v[132:135], v[116:119], v[80:83], v[132:135]
    ds_read_b64_tr_b16 v[66:67], v9 offset:16384
    v_mfma_f32_16x16x32_bf16 v[144:147], v[112:115], v[88:91], v[144:147]
    ds_read_b64_tr_b16 v[68:69], v10 offset:16384
    v_mfma_f32_16x16x32_bf16 v[148:151], v[116:119], v[88:91], v[148:151]
    ds_read_b64_tr_b16 v[70:71], v11 offset:16384
    v_mfma_f32_16x16x32_bf16 v[160:163], v[112:115], v[96:99], v[160:163]
    ds_read_b64_tr_b16 v[72:73], v8 offset:24576
    v_mfma_f32_16x16x32_bf16 v[164:167], v[116:119], v[96:99], v[164:167]
    ds_read_b64_tr_b16 v[74:75], v9 offset:24576
    v_mfma_f32_16x16x32_bf16 v[176:179], v[112:115], v[104:107], v[176:179]
    ds_read_b64_tr_b16 v[76:77], v10 offset:24576
    v_mfma_f32_16x16x32_bf16 v[180:183], v[116:119], v[104:107], v[180:183]
    ds_read_b64_tr_b16 v[78:79], v11 offset:24576
    v_mfma_f32_16x16x32_bf16 v[192:195], v[112:115], v[208:211], v[192:195]
    ds_read_b128 v[32:35], v24 offset:0
    v_mfma_f32_16x16x32_bf16 v[196:199], v[116:119], v[208:211], v[196:199]
    ds_read_b128 v[36:39], v25 offset:0
    v_mfma_f32_16x16x32_bf16 v[128:131], v[120:123], v[84:87], v[128:131]
    ds_read_b128 v[40:43], v24 offset:2048
    v_mfma_f32_16x16x32_bf16 v[132:135], v[124:127], v[84:87], v[132:135]
    ds_read_b128 v[44:47], v25 offset:2048
    v_mfma_f32_16x16x32_bf16 v[144:147], v[120:123], v[92:95], v[144:147]
    ds_read_b128 v[48:51], v24 offset:4096
    v_mfma_f32_16x16x32_bf16 v[148:151], v[124:127], v[92:95], v[148:151]
    ds_read_b128 v[52:55], v25 offset:4096
    v_mfma_f32_16x16x32_bf16 v[160:163], v[120:123], v[100:103], v[160:163]
    ds_read_b128 v[56:59], v24 offset:6144
    v_mfma_f32_16x16x32_bf16 v[164:167], v[124:127], v[100:103], v[164:167]
    ds_read_b128 v[60:63], v25 offset:6144
    v_mfma_f32_16x16x32_bf16 v[176:179], v[120:123], v[108:111], v[176:179]
    v_mfma_f32_16x16x32_bf16 v[180:183], v[124:127], v[108:111], v[180:183]
    v_mfma_f32_16x16x32_bf16 v[192:195], v[120:123], v[208:211], v[192:195]
    v_mfma_f32_16x16x32_bf16 v[196:199], v[124:127], v[208:211], v[196:199]
    s_waitcnt lgkmcnt(0)
    v_and_b32 v20, 0xf0, v1
    v_lshrrev_b32 v20, 1, v20
    s_lshl_b32 s30, s26, 9
    s_add_u32 s30, s30, 188743680
    s_mov_b32 s31, 0x40000
    v_and_b32 v21, 1, v4
    v_lshlrev_b32 v21, 10, v21
    v_xor_b32 v8, v21, v8
    v_xor_b32 v9, v21, v9
    v_xor_b32 v10, v21, v10
    v_xor_b32 v11, v21, v11
    v_xor_b32 v12, v21, v12
    v_xor_b32 v13, v21, v13
    v_xor_b32 v14, v21, v14
    v_xor_b32 v15, v21, v15
w_stX:
    buffer_load_dword v22, off, s[64:67], 0 offset:192 sc1
    buffer_load_dwordx2 v[24:25], v20, s[4:7], s30 offen offset:0 sc1
    buffer_load_dwordx2 v[26:27], v20, s[4:7], s30 offen offset:128 sc1
    buffer_load_dwordx2 v[28:29], v20, s[4:7], s30 offen offset:256 sc1
    buffer_load_dwordx2 v[30:31], v20, s[4:7], s30 offen offset:384 sc1
    s_waitcnt vmcnt(0)
    v_readfirstlane_b32 s29, v22
    s_cmp_ge_u32 s29, 32
    s_cbranch_scc1 w_stXok
    s_sleep 4
    s_sub_u32 s31, s31, 1
    s_cbranch_scc0 w_stX
w_stXok:
    buffer_load_dword v22, off, s[64:67], 0 sc1
    v_fma_f32 v128, -v24, v192, v128
    v_fma_f32 v129, -v24, v193, v129
    v_fma_f32 v130, -v24, v194, v130
    v_fma_f32 v131, -v24, v195, v131
    v_fma_f32 v132, -v24, v196, v132
    v_fma_f32 v133, -v24, v197, v133
    v_fma_f32 v134, -v24, v198, v134
    v_fma_f32 v135, -v24, v199, v135
    v_mul_f32 v128, v128, v25
    v_mul_f32 v129, v129, v25
    v_mul_f32 v130, v130, v25
    v_mul_f32 v131, v131, v25
    v_mul_f32 v132, v132, v25
    v_mul_f32 v133, v133, v25
    v_mul_f32 v134, v134, v25
    v_mul_f32 v135, v135, v25
    v_fma_f32 v144, -v26, v192, v144
    v_fma_f32 v145, -v26, v193, v145
    v_fma_f32 v146, -v26, v194, v146
    v_fma_f32 v147, -v26, v195, v147
    v_fma_f32 v148, -v26, v196, v148
    v_fma_f32 v149, -v26, v197, v149
    v_fma_f32 v150, -v26, v198, v150
    v_fma_f32 v151, -v26, v199, v151
    v_mul_f32 v144, v144, v27
    v_mul_f32 v145, v145, v27
    v_mul_f32 v146, v146, v27
    v_mul_f32 v147, v147, v27
    v_mul_f32 v148, v148, v27
    v_mul_f32 v149, v149, v27
    v_mul_f32 v150, v150, v27
    v_mul_f32 v151, v151, v27
    v_fma_f32 v160, -v28, v192, v160
    v_fma_f32 v161, -v28, v193, v161
    v_fma_f32 v162, -v28, v194, v162
    v_fma_f32 v163, -v28, v195, v163
    v_fma_f32 v164, -v28, v196, v164
    v_fma_f32 v165, -v28, v197, v165
    v_fma_f32 v166, -v28, v198, v166
    v_fma_f32 v167, -v28, v199, v167
    v_mul_f32 v160, v160, v29
    v_mul_f32 v161, v161, v29
    v_mul_f32 v162, v162, v29
    v_mul_f32 v163, v163, v29
    v_mul_f32 v164, v164, v29
    v_mul_f32 v165, v165, v29
    v_mul_f32 v166, v166, v29
    v_mul_f32 v167, v167, v29
    v_fma_f32 v176, -v30, v192, v176
    v_fma_f32 v177, -v30, v193, v177
    v_fma_f32 v178, -v30, v194, v178
    v_fma_f32 v179, -v30, v195, v179
    v_fma_f32 v180, -v30, v196, v180
    v_fma_f32 v181, -v30, v197, v181
    v_fma_f32 v182, -v30, v198, v182
    v_fma_f32 v183, -v30, v199, v183
    v_mul_f32 v176, v176, v31
    v_mul_f32 v177, v177, v31
    v_mul_f32 v178, v178, v31
    v_mul_f32 v179, v179, v31
    v_mul_f32 v180, v180, v31
    v_mul_f32 v181, v181, v31
    v_mul_f32 v182, v182, v31
    v_mul_f32 v183, v183, v31
    s_lshl_b32 s30, s27, 10
    s_add_u32 s30, s30, s49
    s_nop 7
    v_cvt_pk_bf16_f32 v80, v128, v129
    v_cvt_pk_bf16_f32 v81, v130, v131
    v_cvt_pk_bf16_f32 v82, v132, v133
    v_cvt_pk_bf16_f32 v83, v134, v135
    buffer_store_dwordx4 v[80:83], v1, s[4:7], s30 offen sc1
    s_add_u32 s30, s30, s50
    v_cvt_pk_bf16_f32 v84, v144, v145
    v_cvt_pk_bf16_f32 v85, v146, v147
    v_cvt_pk_bf16_f32 v86, v148, v149
    v_cvt_pk_bf16_f32 v87, v150, v151
    buffer_store_dwordx4 v[84:87], v1, s[4:7], s30 offen sc1
    s_add_u32 s30, s30, s50
    v_cvt_pk_bf16_f32 v88, v160, v161
    v_cvt_pk_bf16_f32 v89, v162, v163
    v_cvt_pk_bf16_f32 v90, v164, v165
    v_cvt_pk_bf16_f32 v91, v166, v167
    buffer_store_dwordx4 v[88:91], v1, s[4:7], s30 offen sc1
    s_add_u32 s30, s30, s50
    v_cvt_pk_bf16_f32 v92, v176, v177
    v_cvt_pk_bf16_f32 v93, v178, v179
    v_cvt_pk_bf16_f32 v94, v180, v181
    v_cvt_pk_bf16_f32 v95, v182, v183
    buffer_store_dwordx4 v[92:95], v1, s[4:7], s30 offen sc1
    s_add_u32 s30, s30, s50
    s_mov_b32 s28, s51
    s_mov_b32 s57, s53
    s_branch w_drain
w_firstM:
    s_waitcnt vmcnt(6)
    s_barrier
    s_add_u32 m0, s21, 0
    s_nop 0
    buffer_load_dwordx4 v1, s[4:7], s16 offen sc1 lds
    s_add_u32 s16, s16, s62
    s_add_u32 m0, s22, 0
    s_nop 0
    buffer_load_dwordx4 v2, s[8:11], s18 offen lds
    s_add_u32 s18, s18, s20
    s_add_u32 m0, s22, 8192
    s_nop 0
    buffer_load_dwordx4 v2, s[12:15], s19 offen lds
    s_add_u32 s19, s19, s20
    v_mfma_f32_16x16x32_bf16 v[128:131], v[64:67], v[32:35], 0
    ds_read_b64_tr_b16 v[112:113], v8 offset:49152
    v_mfma_f32_16x16x32_bf16 v[132:135], v[68:71], v[32:35], 0
    ds_read_b64_tr_b16 v[114:115], v9 offset:49152
    v_mfma_f32_16x16x32_bf16 v[136:139], v[72:75], v[32:35], 0
    ds_read_b64_tr_b16 v[116:117], v10 offset:49152
    v_mfma_f32_16x16x32_bf16 v[140:143], v[76:79], v[32:35], 0
    ds_read_b64_tr_b16 v[118:119], v11 offset:49152
    v_mfma_f32_16x16x32_bf16 v[144:147], v[64:67], v[40:43], 0
    ds_read_b64_tr_b16 v[120:121], v8 offset:57344
    v_mfma_f32_16x16x32_bf16 v[148:151], v[68:71], v[40:43], 0
    ds_read_b64_tr_b16 v[122:123], v9 offset:57344
    v_mfma_f32_16x16x32_bf16 v[152:155], v[72:75], v[40:43], 0
    ds_read_b64_tr_b16 v[124:125], v10 offset:57344
    v_mfma_f32_16x16x32_bf16 v[156:159], v[76:79], v[40:43], 0
    ds_read_b64_tr_b16 v[126:127], v11 offset:57344
    v_mfma_f32_16x16x32_bf16 v[160:163], v[64:67], v[48:51], 0
    ds_read_b128 v[80:83], v5 offset:32768
    v_mfma_f32_16x16x32_bf16 v[164:167], v[68:71], v[48:51], 0
    ds_read_b128 v[88:91], v5 offset:34816
    v_mfma_f32_16x16x32_bf16 v[168:171], v[72:75], v[48:51], 0
    ds_read_b128 v[96:99], v5 offset:36864
    v_mfma_f32_16x16x32_bf16 v[172:175], v[76:79], v[48:51], 0
    ds_read_b128 v[104:107], v5 offset:38912
    v_mfma_f32_16x16x32_bf16 v[176:179], v[64:67], v[56:59], 0
    v_mfma_f32_16x16x32_bf16 v[180:183], v[68:71], v[56:59], 0
    v_mfma_f32_16x16x32_bf16 v[184:187], v[72:75], v[56:59], 0
    v_mfma_f32_16x16x32_bf16 v[188:191], v[76:79], v[56:59], 0
    s_waitcnt lgkmcnt(0)
    s_waitcnt vmcnt(6)
    s_barrier
    s_add_u32 m0, s21, 32768
    s_nop 0
    buffer_load_dwordx4 v1, s[4:7], s16 offen sc1 lds
    s_add_u32 s16, s16, s62
    s_add_u32 m0, s22, 32768
    s_nop 0
    buffer_load_dwordx4 v2, s[8:11], s18 offen lds
    s_add_u32 s18, s18, s20
    s_add_u32 m0, s22, 40960
    s_nop 0
    buffer_load_dwordx4 v2, s[12:15], s19 offen lds
    s_add_u32 s19, s19, s20
    v_mfma_f32_16x16x32_bf16 v[128:131], v[112:115], v[80:83], v[128:131]
    ds_read_b64_tr_b16 v[64:65], v12 offset:16384
    v_mfma_f32_16x16x32_bf16 v[132:135], v[116:119], v[80:83], v[132:135]
    ds_read_b64_tr_b16 v[66:67], v13 offset:16384
    v_mfma_f32_16x16x32_bf16 v[136:139], v[120:123], v[80:83], v[136:139]
    ds_read_b64_tr_b16 v[68:69], v14 offset:16384
    v_mfma_f32_16x16x32_bf16 v[140:143], v[124:127], v[80:83], v[140:143]
    ds_read_b64_tr_b16 v[70:71], v15 offset:16384
    v_mfma_f32_16x16x32_bf16 v[144:147], v[112:115], v[88:91], v[144:147]
    ds_read_b64_tr_b16 v[72:73], v12 offset:24576
    v_mfma_f32_16x16x32_bf16 v[148:151], v[116:119], v[88:91], v[148:151]
    ds_read_b64_tr_b16 v[74:75], v13 offset:24576
    v_mfma_f32_16x16x32_bf16 v[152:155], v[120:123], v[88:91], v[152:155]
    ds_read_b64_tr_b16 v[76:77], v14 offset:24576
    v_mfma_f32_16x16x32_bf16 v[156:159], v[124:127], v[88:91], v[156:159]
    ds_read_b64_tr_b16 v[78:79], v15 offset:24576
    v_mfma_f32_16x16x32_bf16 v[160:163], v[112:115], v[96:99], v[160:163]
    ds_read_b128 v[32:35], v6 offset:0
    v_mfma_f32_16x16x32_bf16 v[164:167], v[116:119], v[96:99], v[164:167]
    ds_read_b128 v[40:43], v6 offset:2048
    v_mfma_f32_16x16x32_bf16 v[168:171], v[120:123], v[96:99], v[168:171]
    ds_read_b128 v[48:51], v6 offset:4096
    v_mfma_f32_16x16x32_bf16 v[172:175], v[124:127], v[96:99], v[172:175]
    ds_read_b128 v[56:59], v6 offset:6144
    v_mfma_f32_16x16x32_bf16 v[176:179], v[112:115], v[104:107], v[176:179]
    v_mfma_f32_16x16x32_bf16 v[180:183], v[116:119], v[104:107], v[180:183]
    v_mfma_f32_16x16x32_bf16 v[184:187], v[120:123], v[104:107], v[184:187]
    v_mfma_f32_16x16x32_bf16 v[188:191], v[124:127], v[104:107], v[188:191]
    s_waitcnt lgkmcnt(0)
    s_waitcnt vmcnt(6)
    s_barrier
    s_add_u32 m0, s21, 65536
    s_nop 0
    buffer_load_dwordx4 v1, s[4:7], s16 offen sc1 lds
    s_add_u32 s16, s16, s62
    s_add_u32 m0, s22, 65536
    s_nop 0
    buffer_load_dwordx4 v2, s[8:11], s18 offen lds
    s_add_u32 s18, s18, s20
    s_add_u32 m0, s22, 73728
    s_nop 0
    buffer_load_dwordx4 v2, s[12:15], s19 offen lds
    s_add_u32 s19, s19, s20
    v_mfma_f32_16x16x32_bf16 v[128:131], v[64:67], v[32:35], v[128:131]
    ds_read_b64_tr_b16 v[112:113], v12 offset:49152
    v_mfma_f32_16x16x32_bf16 v[132:135], v[68:71], v[32:35], v[132:135]
    ds_read_b64_tr_b16 v[114:115], v13 offset:49152
    v_mfma_f32_16x16x32_bf16 v[136:139], v[72:75], v[32:35], v[136:139]
    ds_read_b64_tr_b16 v[116:117], v14 offset:49152
    v_mfma_f32_16x16x32_bf16 v[140:143], v[76:79], v[32:35], v[140:143]
    ds_read_b64_tr_b16 v[118:119], v15 offset:49152
    v_mfma_f32_16x16x32_bf16 v[144:147], v[64:67], v[40:43], v[144:147]
    ds_read_b64_tr_b16 v[120:121], v12 offset:57344
    v_mfma_f32_16x16x32_bf16 v[148:151], v[68:71], v[40:43], v[148:151]
    ds_read_b64_tr_b16 v[122:123], v13 offset:57344
    v_mfma_f32_16x16x32_bf16 v[152:155], v[72:75], v[40:43], v[152:155]
    ds_read_b64_tr_b16 v[124:125], v14 offset:57344
    v_mfma_f32_16x16x32_bf16 v[156:159], v[76:79], v[40:43], v[156:159]
    ds_read_b64_tr_b16 v[126:127], v15 offset:57344
    v_mfma_f32_16x16x32_bf16 v[160:163], v[64:67], v[48:51], v[160:163]
    ds_read_b128 v[80:83], v6 offset:32768
    v_mfma_f32_16x16x32_bf16 v[164:167], v[68:71], v[48:51], v[164:167]
    ds_read_b128 v[88:91], v6 offset:34816
    v_mfma_f32_16x16x32_bf16 v[168:171], v[72:75], v[48:51], v[168:171]
    ds_read_b128 v[96:99], v6 offset:36864
    v_mfma_f32_16x16x32_bf16 v[172:175], v[76:79], v[48:51], v[172:175]
    ds_read_b128 v[104:107], v6 offset:38912
    v_mfma_f32_16x16x32_bf16 v[176:179], v[64:67], v[56:59], v[176:179]
    v_mfma_f32_16x16x32_bf16 v[180:183], v[68:71], v[56:59], v[180:183]
    v_mfma_f32_16x16x32_bf16 v[184:187], v[72:75], v[56:59], v[184:187]
    v_mfma_f32_16x16x32_bf16 v[188:191], v[76:79], v[56:59], v[188:191]
    s_waitcnt lgkmcnt(0)
    s_waitcnt vmcnt(6)
    s_barrier
    s_add_u32 m0, s21, 98304
    s_nop 0
    buffer_load_dwordx4 v1, s[4:7], s16 offen sc1 lds
    s_add_u32 s16, s16, s62
    s_add_u32 m0, s22, 98304
    s_nop 0
    buffer_load_dwordx4 v2, s[8:11], s18 offen lds
    s_add_u32 s18, s18, s20
    s_add_u32 m0, s22, 106496
    s_nop 0
    buffer_load_dwordx4 v2, s[12:15], s19 offen lds
    s_add_u32 s19, s19, s20
    v_mfma_f32_16x16x32_bf16 v[128:131], v[112:115], v[80:83], v[128:131]
    ds_read_b64_tr_b16 v[64:65], v8 offset:16384
    v_mfma_f32_16x16x32_bf16 v[132:135], v[116:119], v[80:83], v[132:135]
    ds_read_b64_tr_b16 v[66:67], v9 offset:16384
    v_mfma_f32_16x16x32_bf16 v[136:139], v[120:123], v[80:83], v[136:139]
    ds_read_b64_tr_b16 v[68:69], v10 offset:16384
    v_mfma_f32_16x16x32_bf16 v[140:143], v[124:127], v[80:83], v[140:143]
    ds_read_b64_tr_b16 v[70:71], v11 offset:16384
    v_mfma_f32_16x16x32_bf16 v[144:147], v[112:115], v[88:91], v[144:147]
    ds_read_b64_tr_b16 v[72:73], v8 offset:24576
    v_mfma_f32_16x16x32_bf16 v[148:151], v[116:119], v[88:91], v[148:151]
    ds_read_b64_tr_b16 v[74:75], v9 offset:24576
    v_mfma_f32_16x16x32_bf16 v[152:155], v[120:123], v[88:91], v[152:155]
    ds_read_b64_tr_b16 v[76:77], v10 offset:24576
    v_mfma_f32_16x16x32_bf16 v[156:159], v[124:127], v[88:91], v[156:159]
    ds_read_b64_tr_b16 v[78:79], v11 offset:24576
    v_mfma_f32_16x16x32_bf16 v[160:163], v[112:115], v[96:99], v[160:163]
    ds_read_b128 v[32:35], v5 offset:0
    v_mfma_f32_16x16x32_bf16 v[164:167], v[116:119], v[96:99], v[164:167]
    ds_read_b128 v[40:43], v5 offset:2048
    v_mfma_f32_16x16x32_bf16 v[168:171], v[120:123], v[96:99], v[168:171]
    ds_read_b128 v[48:51], v5 offset:4096
    v_mfma_f32_16x16x32_bf16 v[172:175], v[124:127], v[96:99], v[172:175]
    ds_read_b128 v[56:59], v5 offset:6144
    v_mfma_f32_16x16x32_bf16 v[176:179], v[112:115], v[104:107], v[176:179]
    v_mfma_f32_16x16x32_bf16 v[180:183], v[116:119], v[104:107], v[180:183]
    v_mfma_f32_16x16x32_bf16 v[184:187], v[120:123], v[104:107], v[184:187]
    v_mfma_f32_16x16x32_bf16 v[188:191], v[124:127], v[104:107], v[188:191]
    s_waitcnt lgkmcnt(0)
w_loop_chkM:
    s_sub_u32 s23, s23, 1
w_loopM:
    s_cmp_lg_u32 s23, 1
    s_cbranch_scc1 w_bodyM
    v_readfirstlane_b32 s68, v22
    s_cmp_ge_u32 s68, 128
    s_cselect_b32 s70, 0, s70
    v_readfirstlane_b32 s30, v16
    s_cmp_ge_u32 s30, s45
    s_cselect_b32 s30, 0, 1
    s_or_b32 s30, s30, s70
    s_cmp_ge_u32 s32, 4
    s_cselect_b32 s30, 1, s30
    s_cmp_eq_u32 s32, 0
    s_cselect_b32 s30, 1, s30
    v_mov_b32 v20, s30
    ds_write_b32 v7, v20
    s_cbranch_scc1 w_bodyM
    s_load_dwordx2 s[8:9], s[0:1], s33
    s_load_dwordx2 s[12:13], s[0:1], s34
    s_mov_b32 s10, s38
    s_mov_b32 s14, s38
    s_cmp_ge_u32 s32, 4
    s_cselect_b32 s31, 0, 1
    s_lshl_b32 s30, s3, s31
    s_mul_i32 s30, s30, s40
    s_add_u32 s16, s39, s30
    s_cmp_eq_u32 s32, 4
    s_cselect_b32 s30, 1024, s40
    s_cselect_b32 s31, 6, 5
    s_lshl_b32 s62, 32, s31
    s_add_u32 s17, s16, s30
    s_lshl_b32 s30, s3, 2
    s_mul_i32 s30, s30, s35
    s_add_u32 s18, s36, s30
    s_add_u32 s19, s37, s30
    s_lshl_b32 s20, s35, s31
    v_mul_u32_u24 v2, s35, v4
    v_add_u32 v2, v2, v3
    s_waitcnt lgkmcnt(0)
    s_waitcnt vmcnt(6)
    s_barrier
    s_add_u32 m0, s21, 0
    s_nop 0
    buffer_load_dwordx4 v1, s[4:7], s16 offen sc1 lds
    s_add_u32 s16, s16, s62
    s_add_u32 m0, s21, 1024
    s_nop 0
    buffer_load_dwordx4 v1, s[4:7], s17 offen sc1 lds
    s_add_u32 s17, s17, s62
    s_add_u32 m0, s22, 0
    s_nop 0
    buffer_load_dwordx4 v2, s[8:11], s18 offen lds
    s_add_u32 s18, s18, s20
    s_add_u32 m0, s22, 8192
    s_nop 0
    buffer_load_dwordx4 v2, s[12:15], s19 offen lds
    s_add_u32 s19, s19, s20
    v_mfma_f32_16x16x32_bf16 v[128:131], v[64:67], v[32:35], v[128:131]
    ds_read_b64_tr_b16 v[112:113], v8 offset:49152
    v_mfma_f32_16x16x32_bf16 v[132:135], v[68:71], v[32:35], v[132:135]
    ds_read_b64_tr_b16 v[114:115], v9 offset:49152
    v_mfma_f32_16x16x32_bf16 v[136:139], v[72:75], v[32:35], v[136:139]
    ds_read_b64_tr_b16 v[116:117], v10 offset:49152
    v_mfma_f32_16x16x32_bf16 v[140:143], v[76:79], v[32:35], v[140:143]
    ds_read_b64_tr_b16 v[118:119], v11 offset:49152
    v_mfma_f32_16x16x32_bf16 v[144:147], v[64:67], v[40:43], v[144:147]
    ds_read_b64_tr_b16 v[120:121], v8 offset:57344
    v_mfma_f32_16x16x32_bf16 v[148:151], v[68:71], v[40:43], v[148:151]
    ds_read_b64_tr_b16 v[122:123], v9 offset:57344
    v_mfma_f32_16x16x32_bf16 v[152:155], v[72:75], v[40:43], v[152:155]
    ds_read_b64_tr_b16 v[124:125], v10 offset:57344
    v_mfma_f32_16x16x32_bf16 v[156:159], v[76:79], v[40:43], v[156:159]
    ds_read_b64_tr_b16 v[126:127], v11 offset:57344
    v_mfma_f32_16x16x32_bf16 v[160:163], v[64:67], v[48:51], v[160:163]
    ds_read_b128 v[80:83], v5 offset:32768
    v_mfma_f32_16x16x32_bf16 v[164:167], v[68:71], v[48:51], v[164:167]
    ds_read_b128 v[88:91], v5 offset:34816
    v_mfma_f32_16x16x32_bf16 v[168:171], v[72:75], v[48:51], v[168:171]
    ds_read_b128 v[96:99], v5 offset:36864
    v_mfma_f32_16x16x32_bf16 v[172:175], v[76:79], v[48:51], v[172:175]
    ds_read_b128 v[104:107], v5 offset:38912
    v_mfma_f32_16x16x32_bf16 v[176:179], v[64:67], v[56:59], v[176:179]
    v_mfma_f32_16x16x32_bf16 v[180:183], v[68:71], v[56:59], v[180:183]
    v_mfma_f32_16x16x32_bf16 v[184:187], v[72:75], v[56:59], v[184:187]
    v_mfma_f32_16x16x32_bf16 v[188:191], v[76:79], v[56:59], v[188:191]
    s_waitcnt lgkmcnt(0)
    s_waitcnt vmcnt(7)
    s_barrier
    s_add_u32 m0, s21, 32768
    s_nop 0
    buffer_load_dwordx4 v1, s[4:7], s16 offen sc1 lds
    s_add_u32 s16, s16, s62
    s_add_u32 m0, s21, 33792
    s_nop 0
    buffer_load_dwordx4 v1, s[4:7], s17 offen sc1 lds
    s_add_u32 s17, s17, s62
    s_add_u32 m0, s22, 32768
    s_nop 0
    buffer_load_dwordx4 v2, s[8:11], s18 offen lds
    s_add_u32 s18, s18, s20
    s_add_u32 m0, s22, 40960
    s_nop 0
    buffer_load_dwordx4 v2, s[12:15], s19 offen lds
    s_add_u32 s19, s19, s20
    v_mfma_f32_16x16x32_bf16 v[128:131], v[112:115], v[80:83], v[128:131]
    ds_read_b64_tr_b16 v[64:65], v12 offset:16384
    v_mfma_f32_16x16x32_bf16 v[132:135], v[116:119], v[80:83], v[132:135]
    ds_read_b64_tr_b16 v[66:67], v13 offset:16384
    v_mfma_f32_16x16x32_bf16 v[136:139], v[120:123], v[80:83], v[136:139]
    ds_read_b64_tr_b16 v[68:69], v14 offset:16384
    v_mfma_f32_16x16x32_bf16 v[140:143], v[124:127], v[80:83], v[140:143]
    ds_read_b64_tr_b16 v[70:71], v15 offset:16384
    v_mfma_f32_16x16x32_bf16 v[144:147], v[112:115], v[88:91], v[144:147]
    ds_read_b64_tr_b16 v[72:73], v12 offset:24576
    v_mfma_f32_16x16x32_bf16 v[148:151], v[116:119], v[88:91], v[148:151]
    ds_read_b64_tr_b16 v[74:75], v13 offset:24576
    v_mfma_f32_16x16x32_bf16 v[152:155], v[120:123], v[88:91], v[152:155]
    ds_read_b64_tr_b16 v[76:77], v14 offset:24576
    v_mfma_f32_16x16x32_bf16 v[156:159], v[124:127], v[88:91], v[156:159]
    ds_read_b64_tr_b16 v[78:79], v15 offset:24576
    v_mfma_f32_16x16x32_bf16 v[160:163], v[112:115], v[96:99], v[160:163]
    ds_read_b128 v[32:35], v6 offset:0
    v_mfma_f32_16x16x32_bf16 v[164:167], v[116:119], v[96:99], v[164:167]
    ds_read_b128 v[40:43], v6 offset:2048
    v_mfma_f32_16x16x32_bf16 v[168:171], v[120:123], v[96:99], v[168:171]
    ds_read_b128 v[48:51], v6 offset:4096
    v_mfma_f32_16x16x32_bf16 v[172:175], v[124:127], v[96:99], v[172:175]
    ds_read_b128 v[56:59], v6 offset:6144
    v_mfma_f32_16x16x32_bf16 v[176:179], v[112:115], v[104:107], v[176:179]
    v_mfma_f32_16x16x32_bf16 v[180:183], v[116:119], v[104:107], v[180:183]
    v_mfma_f32_16x16x32_bf16 v[184:187], v[120:123], v[104:107], v[184:187]
    v_mfma_f32_16x16x32_bf16 v[188:191], v[124:127], v[104:107], v[188:191]
    s_waitcnt lgkmcnt(0)
    s_waitcnt vmcnt(8)
    s_barrier
    s_add_u32 m0, s21, 65536
    s_nop 0
    buffer_load_dwordx4 v1, s[4:7], s16 offen sc1 lds
    s_add_u32 s16, s16, s62
    s_add_u32 m0, s21, 66560
    s_nop 0
    buffer_load_dwordx4 v1, s[4:7], s17 offen sc1 lds
    s_add_u32 s17, s17, s62
    s_add_u32 m0, s22, 65536
    s_nop 0
    buffer_load_dwordx4 v2, s[8:11], s18 offen lds
    s_add_u32 s18, s18, s20
    s_add_u32 m0, s22, 73728
    s_nop 0
    buffer_load_dwordx4 v2, s[12:15], s19 offen lds
    s_add_u32 s19, s19, s20
    v_mfma_f32_16x16x32_bf16 v[128:131], v[64:67], v[32:35], v[128:131]
    ds_read_b64_tr_b16 v[112:113], v12 offset:49152
    v_mfma_f32_16x16x32_bf16 v[132:135], v[68:71], v[32:35], v[132:135]
    ds_read_b64_tr_b16 v[114:115], v13 offset:49152
    v_mfma_f32_16x16x32_bf16 v[136:139], v[72:75], v[32:35], v[136:139]
    ds_read_b64_tr_b16 v[116:117], v14 offset:49152
    v_mfma_f32_16x16x32_bf16 v[140:143], v[76:79], v[32:35], v[140:143]
    ds_read_b64_tr_b16 v[118:119], v15 offset:49152
    v_mfma_f32_16x16x32_bf16 v[144:147], v[64:67], v[40:43], v[144:147]
    ds_read_b64_tr_b16 v[120:121], v12 offset:57344
    v_mfma_f32_16x16x32_bf16 v[148:151], v[68:71], v[40:43], v[148:151]
    ds_read_b64_tr_b16 v[122:123], v13 offset:57344
    v_mfma_f32_16x16x32_bf16 v[152:155], v[72:75], v[40:43], v[152:155]
    ds_read_b64_tr_b16 v[124:125], v14 offset:57344
    v_mfma_f32_16x16x32_bf16 v[156:159], v[76:79], v[40:43], v[156:159]
    ds_read_b64_tr_b16 v[126:127], v15 offset:57344
    v_mfma_f32_16x16x32_bf16 v[160:163], v[64:67], v[48:51], v[160:163]
    ds_read_b128 v[80:83], v6 offset:32768
    v_mfma_f32_16x16x32_bf16 v[164:167], v[68:71], v[48:51], v[164:167]
    ds_read_b128 v[88:91], v6 offset:34816
    v_mfma_f32_16x16x32_bf16 v[168:171], v[72:75], v[48:51], v[168:171]
    ds_read_b128 v[96:99], v6 offset:36864
    v_mfma_f32_16x16x32_bf16 v[172:175], v[76:79], v[48:51], v[172:175]
    ds_read_b128 v[104:107], v6 offset:38912
    v_mfma_f32_16x16x32_bf16 v[176:179], v[64:67], v[56:59], v[176:179]
    v_mfma_f32_16x16x32_bf16 v[180:183], v[68:71], v[56:59], v[180:183]
    v_mfma_f32_16x16x32_bf16 v[184:187], v[72:75], v[56:59], v[184:187]
    v_mfma_f32_16x16x32_bf16 v[188:191], v[76:79], v[56:59], v[188:191]
    s_waitcnt lgkmcnt(0)
    s_waitcnt vmcnt(8)
    s_barrier
    s_add_u32 m0, s21, 98304
    s_nop 0
    buffer_load_dwordx4 v1, s[4:7], s16 offen sc1 lds
    s_add_u32 s16, s16, s62
    s_add_u32 m0, s21, 99328
    s_nop 0
    buffer_load_dwordx4 v1, s[4:7], s17 offen sc1 lds
    s_add_u32 s17, s17, s62
    s_add_u32 m0, s22, 98304
    s_nop 0
    buffer_load_dwordx4 v2, s[8:11], s18 offen lds
    s_add_u32 s18, s18, s20
    s_add_u32 m0, s22, 106496
    s_nop 0
    buffer_load_dwordx4 v2, s[12:15], s19 offen lds
    s_add_u32 s19, s19, s20
    v_mfma_f32_16x16x32_bf16 v[128:131], v[112:115], v[80:83], v[128:131]
    ds_read_b64_tr_b16 v[64:65], v8 offset:16384
    v_mfma_f32_16x16x32_bf16 v[132:135], v[116:119], v[80:83], v[132:135]
    ds_read_b64_tr_b16 v[66:67], v9 offset:16384
    v_mfma_f32_16x16x32_bf16 v[136:139], v[120:123], v[80:83], v[136:139]
    ds_read_b64_tr_b16 v[68:69], v10 offset:16384
    v_mfma_f32_16x16x32_bf16 v[140:143], v[124:127], v[80:83], v[140:143]
    ds_read_b64_tr_b16 v[70:71], v11 offset:16384
    v_mfma_f32_16x16x32_bf16 v[144:147], v[112:115], v[88:91], v[144:147]
    ds_read_b64_tr_b16 v[72:73], v8 offset:24576
    v_mfma_f32_16x16x32_bf16 v[148:151], v[116:119], v[88:91], v[148:151]
    ds_read_b64_tr_b16 v[74:75], v9 offset:24576
    v_mfma_f32_16x16x32_bf16 v[152:155], v[120:123], v[88:91], v[152:155]
    ds_read_b64_tr_b16 v[76:77], v10 offset:24576
    v_mfma_f32_16x16x32_bf16 v[156:159], v[124:127], v[88:91], v[156:159]
    ds_read_b64_tr_b16 v[78:79], v11 offset:24576
    v_mfma_f32_16x16x32_bf16 v[160:163], v[112:115], v[96:99], v[160:163]
    ds_read_b128 v[32:35], v5 offset:0
    v_mfma_f32_16x16x32_bf16 v[164:167], v[116:119], v[96:99], v[164:167]
    ds_read_b128 v[36:39], v5 offset:1024
    v_mfma_f32_16x16x32_bf16 v[168:171], v[120:123], v[96:99], v[168:171]
    ds_read_b128 v[40:43], v5 offset:2048
    v_mfma_f32_16x16x32_bf16 v[172:175], v[124:127], v[96:99], v[172:175]
    ds_read_b128 v[44:47], v5 offset:3072
    v_mfma_f32_16x16x32_bf16 v[176:179], v[112:115], v[104:107], v[176:179]
    ds_read_b128 v[48:51], v5 offset:4096
    v_mfma_f32_16x16x32_bf16 v[180:183], v[116:119], v[104:107], v[180:183]
    ds_read_b128 v[52:55], v5 offset:5120
    v_mfma_f32_16x16x32_bf16 v[184:187], v[120:123], v[104:107], v[184:187]
    ds_read_b128 v[56:59], v5 offset:6144
    v_mfma_f32_16x16x32_bf16 v[188:191], v[124:127], v[104:107], v[188:191]
    ds_read_b128 v[60:63], v5 offset:7168
    s_waitcnt lgkmcnt(0)
    s_branch w_doneM
w_bodyM:
    buffer_load_dword v22, off, s[64:67], 0 sc1
    s_waitcnt vmcnt(6)
    s_barrier
    s_add_u32 m0, s21, 0
    s_nop 0
    buffer_load_dwordx4 v1, s[4:7], s16 offen sc1 lds
    s_add_u32 s16, s16, s62
    s_add_u32 m0, s22, 0
    s_nop 0
    buffer_load_dwordx4 v2, s[8:11], s18 offen lds
    s_add_u32 s18, s18, s20
    s_add_u32 m0, s22, 8192
    s_nop 0
    buffer_load_dwordx4 v2, s[12:15], s19 offen lds
    s_add_u32 s19, s19, s20
    v_mfma_f32_16x16x32_bf16 v[128:131], v[64:67], v[32:35], v[128:131]
    ds_read_b64_tr_b16 v[112:113], v8 offset:49152
    v_mfma_f32_16x16x32_bf16 v[132:135], v[68:71], v[32:35], v[132:135]
    ds_read_b64_tr_b16 v[114:115], v9 offset:49152
    v_mfma_f32_16x16x32_bf16 v[136:139], v[72:75], v[32:35], v[136:139]
    ds_read_b64_tr_b16 v[116:117], v10 offset:49152
    v_mfma_f32_16x16x32_bf16 v[140:143], v[76:79], v[32:35], v[140:143]
    ds_read_b64_tr_b16 v[118:119], v11 offset:49152
    v_mfma_f32_16x16x32_bf16 v[144:147], v[64:67], v[40:43], v[144:147]
    ds_read_b64_tr_b16 v[120:121], v8 offset:57344
    v_mfma_f32_16x16x32_bf16 v[148:151], v[68:71], v[40:43], v[148:151]
    ds_read_b64_tr_b16 v[122:123], v9 offset:57344
    v_mfma_f32_16x16x32_bf16 v[152:155], v[72:75], v[40:43], v[152:155]
    ds_read_b64_tr_b16 v[124:125], v10 offset:57344
    v_mfma_f32_16x16x32_bf16 v[156:159], v[76:79], v[40:43], v[156:159]
    ds_read_b64_tr_b16 v[126:127], v11 offset:57344
    v_mfma_f32_16x16x32_bf16 v[160:163], v[64:67], v[48:51], v[160:163]
    ds_read_b128 v[80:83], v5 offset:32768
    v_mfma_f32_16x16x32_bf16 v[164:167], v[68:71], v[48:51], v[164:167]
    ds_read_b128 v[88:91], v5 offset:34816
    v_mfma_f32_16x16x32_bf16 v[168:171], v[72:75], v[48:51], v[168:171]
    ds_read_b128 v[96:99], v5 offset:36864
    v_mfma_f32_16x16x32_bf16 v[172:175], v[76:79], v[48:51], v[172:175]
    ds_read_b128 v[104:107], v5 offset:38912
    v_mfma_f32_16x16x32_bf16 v[176:179], v[64:67], v[56:59], v[176:179]
    v_mfma_f32_16x16x32_bf16 v[180:183], v[68:71], v[56:59], v[180:183]
    v_mfma_f32_16x16x32_bf16 v[184:187], v[72:75], v[56:59], v[184:187]
    v_mfma_f32_16x16x32_bf16 v[188:191], v[76:79], v[56:59], v[188:191]
    buffer_load_dword v16, v17, s[4:7], s44 offen sc1
    s_waitcnt lgkmcnt(0)
    s_waitcnt vmcnt(6)
    s_barrier
    s_add_u32 m0, s21, 32768
    s_nop 0
    buffer_load_dwordx4 v1, s[4:7], s16 offen sc1 lds
    s_add_u32 s16, s16, s62
    s_add_u32 m0, s22, 32768
    s_nop 0
    buffer_load_dwordx4 v2, s[8:11], s18 offen lds
    s_add_u32 s18, s18, s20
    s_add_u32 m0, s22, 40960
    s_nop 0
    buffer_load_dwordx4 v2, s[12:15], s19 offen lds
    s_add_u32 s19, s19, s20
    v_mfma_f32_16x16x32_bf16 v[128:131], v[112:115], v[80:83], v[128:131]
    ds_read_b64_tr_b16 v[64:65], v12 offset:16384
    v_mfma_f32_16x16x32_bf16 v[132:135], v[116:119], v[80:83], v[132:135]
    ds_read_b64_tr_b16 v[66:67], v13 offset:16384
    v_mfma_f32_16x16x32_bf16 v[136:139], v[120:123], v[80:83], v[136:139]
    ds_read_b64_tr_b16 v[68:69], v14 offset:16384
    v_mfma_f32_16x16x32_bf16 v[140:143], v[124:127], v[80:83], v[140:143]
    ds_read_b64_tr_b16 v[70:71], v15 offset:16384
    v_mfma_f32_16x16x32_bf16 v[144:147], v[112:115], v[88:91], v[144:147]
    ds_read_b64_tr_b16 v[72:73], v12 offset:24576
    v_mfma_f32_16x16x32_bf16 v[148:151], v[116:119], v[88:91], v[148:151]
    ds_read_b64_tr_b16 v[74:75], v13 offset:24576
    v_mfma_f32_16x16x32_bf16 v[152:155], v[120:123], v[88:91], v[152:155]
    ds_read_b64_tr_b16 v[76:77], v14 offset:24576
    v_mfma_f32_16x16x32_bf16 v[156:159], v[124:127], v[88:91], v[156:159]
    ds_read_b64_tr_b16 v[78:79], v15 offset:24576
    v_mfma_f32_16x16x32_bf16 v[160:163], v[112:115], v[96:99], v[160:163]
    ds_read_b128 v[32:35], v6 offset:0
    v_mfma_f32_16x16x32_bf16 v[164:167], v[116:119], v[96:99], v[164:167]
    ds_read_b128 v[40:43], v6 offset:2048
    v_mfma_f32_16x16x32_bf16 v[168:171], v[120:123], v[96:99], v[168:171]
    ds_read_b128 v[48:51], v6 offset:4096
    v_mfma_f32_16x16x32_bf16 v[172:175], v[124:127], v[96:99], v[172:175]
    ds_read_b128 v[56:59], v6 offset:6144
    v_mfma_f32_16x16x32_bf16 v[176:179], v[112:115], v[104:107], v[176:179]
    v_mfma_f32_16x16x32_bf16 v[180:183], v[116:119], v[104:107], v[180:183]
    v_mfma_f32_16x16x32_bf16 v[184:187], v[120:123], v[104:107], v[184:187]
    v_mfma_f32_16x16x32_bf16 v[188:191], v[124:127], v[104:107], v[188:191]
    s_waitcnt lgkmcnt(0)
    s_waitcnt vmcnt(6)
    s_barrier
    s_add_u32 m0, s21, 65536
    s_nop 0
    buffer_load_dwordx4 v1, s[4:7], s16 offen sc1 lds
    s_add_u32 s16, s16, s62
    s_add_u32 m0, s22, 65536
    s_nop 0
    buffer_load_dwordx4 v2, s[8:11], s18 offen lds
    s_add_u32 s18, s18, s20
    s_add_u32 m0, s22, 73728
    s_nop 0
    buffer_load_dwordx4 v2, s[12:15], s19 offen lds
    s_add_u32 s19, s19, s20
    v_mfma_f32_16x16x32_bf16 v[128:131], v[64:67], v[32:35], v[128:131]
    ds_read_b64_tr_b16 v[112:113], v12 offset:49152
    v_mfma_f32_16x16x32_bf16 v[132:135], v[68:71], v[32:35], v[132:135]
    ds_read_b64_tr_b16 v[114:115], v13 offset:49152
    v_mfma_f32_16x16x32_bf16 v[136:139], v[72:75], v[32:35], v[136:139]
    ds_read_b64_tr_b16 v[116:117], v14 offset:49152
    v_mfma_f32_16x16x32_bf16 v[140:143], v[76:79], v[32:35], v[140:143]
    ds_read_b64_tr_b16 v[118:119], v15 offset:49152
    v_mfma_f32_16x16x32_bf16 v[144:147], v[64:67], v[40:43], v[144:147]
    ds_read_b64_tr_b16 v[120:121], v12 offset:57344
    v_mfma_f32_16x16x32_bf16 v[148:151], v[68:71], v[40:43], v[148:151]
    ds_read_b64_tr_b16 v[122:123], v13 offset:57344
    v_mfma_f32_16x16x32_bf16 v[152:155], v[72:75], v[40:43], v[152:155]
    ds_read_b64_tr_b16 v[124:125], v14 offset:57344
    v_mfma_f32_16x16x32_bf16 v[156:159], v[76:79], v[40:43], v[156:159]
    ds_read_b64_tr_b16 v[126:127], v15 offset:57344
    v_mfma_f32_16x16x32_bf16 v[160:163], v[64:67], v[48:51], v[160:163]
    ds_read_b128 v[80:83], v6 offset:32768
    v_mfma_f32_16x16x32_bf16 v[164:167], v[68:71], v[48:51], v[164:167]
    ds_read_b128 v[88:91], v6 offset:34816
    v_mfma_f32_16x16x32_bf16 v[168:171], v[72:75], v[48:51], v[168:171]
    ds_read_b128 v[96:99], v6 offset:36864
    v_mfma_f32_16x16x32_bf16 v[172:175], v[76:79], v[48:51], v[172:175]
    ds_read_b128 v[104:107], v6 offset:38912
    v_mfma_f32_16x16x32_bf16 v[176:179], v[64:67], v[56:59], v[176:179]
    v_mfma_f32_16x16x32_bf16 v[180:183], v[68:71], v[56:59], v[180:183]
    v_mfma_f32_16x16x32_bf16 v[184:187], v[72:75], v[56:59], v[184:187]
    v_mfma_f32_16x16x32_bf16 v[188:191], v[76:79], v[56:59], v[188:191]
    s_waitcnt lgkmcnt(0)
    s_waitcnt vmcnt(6)
    s_barrier
    s_add_u32 m0, s21, 98304
    s_nop 0
    buffer_load_dwordx4 v1, s[4:7], s16 offen sc1 lds
    s_add_u32 s16, s16, s62
    s_add_u32 m0, s22, 98304
    s_nop 0
    buffer_load_dwordx4 v2, s[8:11], s18 offen lds
    s_add_u32 s18, s18, s20
    s_add_u32 m0, s22, 106496
    s_nop 0
    buffer_load_dwordx4 v2, s[12:15], s19 offen lds
    s_add_u32 s19, s19, s20
    v_mfma_f32_16x16x32_bf16 v[128:131], v[112:115], v[80:83], v[128:131]
    ds_read_b64_tr_b16 v[64:65], v8 offset:16384
    v_mfma_f32_16x16x32_bf16 v[132:135], v[116:119], v[80:83], v[132:135]
    ds_read_b64_tr_b16 v[66:67], v9 offset:16384
    v_mfma_f32_16x16x32_bf16 v[136:139], v[120:123], v[80:83], v[136:139]
    ds_read_b64_tr_b16 v[68:69], v10 offset:16384
    v_mfma_f32_16x16x32_bf16 v[140:143], v[124:127], v[80:83], v[140:143]
    ds_read_b64_tr_b16 v[70:71], v11 offset:16384
    v_mfma_f32_16x16x32_bf16 v[144:147], v[112:115], v[88:91], v[144:147]
    ds_read_b64_tr_b16 v[72:73], v8 offset:24576
    v_mfma_f32_16x16x32_bf16 v[148:151], v[116:119], v[88:91], v[148:151]
    ds_read_b64_tr_b16 v[74:75], v9 offset:24576
    v_mfma_f32_16x16x32_bf16 v[152:155], v[120:123], v[88:91], v[152:155]
    ds_read_b64_tr_b16 v[76:77], v10 offset:24576
    v_mfma_f32_16x16x32_bf16 v[156:159], v[124:127], v[88:91], v[156:159]
    ds_read_b64_tr_b16 v[78:79], v11 offset:24576
    v_mfma_f32_16x16x32_bf16 v[160:163], v[112:115], v[96:99], v[160:163]
    ds_read_b128 v[32:35], v5 offset:0
    v_mfma_f32_16x16x32_bf16 v[164:167], v[116:119], v[96:99], v[164:167]
    ds_read_b128 v[40:43], v5 offset:2048
    v_mfma_f32_16x16x32_bf16 v[168:171], v[120:123], v[96:99], v[168:171]
    ds_read_b128 v[48:51], v5 offset:4096
    v_mfma_f32_16x16x32_bf16 v[172:175], v[124:127], v[96:99], v[172:175]
    ds_read_b128 v[56:59], v5 offset:6144
    v_mfma_f32_16x16x32_bf16 v[176:179], v[112:115], v[104:107], v[176:179]
    v_mfma_f32_16x16x32_bf16 v[180:183], v[116:119], v[104:107], v[180:183]
    v_mfma_f32_16x16x32_bf16 v[184:187], v[120:123], v[104:107], v[184:187]
    v_mfma_f32_16x16x32_bf16 v[188:191], v[124:127], v[104:107], v[188:191]
    s_waitcnt lgkmcnt(0)
    s_sub_u32 s23, s23, 1
    s_cmp_lg_u32 s23, 0
    s_cbranch_scc1 w_loopM
w_doneM:
    v_mov_b32 v20, 131072
    ds_read_b128 v[24:27], v20
    ds_read_b128 v[28:31], v20 offset:16
    s_lshl_b32 s30, s27, 10
    s_add_u32 s30, s30, s49
    s_nop 7
    v_cvt_pk_bf16_f32 v80, v128, v129
    v_cvt_pk_bf16_f32 v81, v130, v131
    v_cvt_pk_bf16_f32 v82, v132, v133
    v_cvt_pk_bf16_f32 v83, v134, v135
    buffer_store_dwordx4 v[80:83], v1, s[4:7], s30 offen sc1
    v_cvt_pk_bf16_f32 v84, v136, v137
    v_cvt_pk_bf16_f32 v85, v138, v139
    v_cvt_pk_bf16_f32 v86, v140, v141
    v_cvt_pk_bf16_f32 v87, v142, v143
    buffer_store_dwordx4 v[84:87], v19, s[4:7], s30 offen sc1
    s_add_u32 s30, s30, s50
    v_cvt_pk_bf16_f32 v88, v144, v145
    v_cvt_pk_bf16_f32 v89, v146, v147
    v_cvt_pk_bf16_f32 v90, v148, v149
    v_cvt_pk_bf16_f32 v91, v150, v151
    buffer_store_dwordx4 v[88:91], v1, s[4:7], s30 offen sc1
    v_cvt_pk_bf16_f32 v92, v152, v153
    v_cvt_pk_bf16_f32 v93, v154, v155
    v_cvt_pk_bf16_f32 v94, v156, v157
    v_cvt_pk_bf16_f32 v95, v158, v159
    buffer_store_dwordx4 v[92:95], v19, s[4:7], s30 offen sc1
    s_add_u32 s30, s30, s50
    v_cvt_pk_bf16_f32 v80, v160, v161
    v_cvt_pk_bf16_f32 v81, v162, v163
    v_cvt_pk_bf16_f32 v82, v164, v165
    v_cvt_pk_bf16_f32 v83, v166, v167
    buffer_store_dwordx4 v[80:83], v1, s[4:7], s30 offen sc1
    v_cvt_pk_bf16_f32 v84, v168, v169
    v_cvt_pk_bf16_f32 v85, v170, v171
    v_cvt_pk_bf16_f32 v86, v172, v173
    v_cvt_pk_bf16_f32 v87, v174, v175
    buffer_store_dwordx4 v[84:87], v19, s[4:7], s30 offen sc1
    s_add_u32 s30, s30, s50
    v_cvt_pk_bf16_f32 v88, v176, v177
    v_cvt_pk_bf16_f32 v89, v178, v179
    v_cvt_pk_bf16_f32 v90, v180, v181
    v_cvt_pk_bf16_f32 v91, v182, v183
    buffer_store_dwordx4 v[88:91], v1, s[4:7], s30 offen sc1
    v_cvt_pk_bf16_f32 v92, v184, v185
    v_cvt_pk_bf16_f32 v93, v186, v187
    v_cvt_pk_bf16_f32 v94, v188, v189
    v_cvt_pk_bf16_f32 v95, v190, v191
    buffer_store_dwordx4 v[92:95], v19, s[4:7], s30 offen sc1
    s_add_u32 s30, s30, s50
    s_waitcnt lgkmcnt(0)
    v_or3_b32 v24, v24, v25, v26
    v_or3_b32 v28, v28, v29, v30
    v_or3_b32 v24, v24, v27, v31
    v_or_b32 v24, v24, v28
    s_mov_b32 s28, s51
    s_mov_b32 s57, s53
    v_readfirstlane_b32 s30, v24
    s_cmp_lg_u32 s30, 0
    s_cbranch_scc1 w_drain
    s_mov_b32 s48, s32
    s_cmp_ge_u32 s32, 4
    s_cselect_b32 s30, 2, 3
    s_lshl_b32 s30, s26, s30
    s_mul_i32 s30, s30, s43
    s_add_u32 s49, s42, s30
    s_mov_b32 s50, s43
    s_mov_b32 s51, s46
    s_mov_b32 s23, s41
    s_mov_b32 s53, s47
    s_nop 0
    s_load_dwordx16 s[32:47], s[24:25], 0
    s_add_u32 s24, s24, 64
    s_addc_u32 s25, s25, 0
    s_branch w_first8
w_drain:
    s_waitcnt vmcnt(0)
    s_barrier
    s_cmp_eq_u32 s28, 0
    s_cbranch_scc1 sig_5
    s_cmp_lg_u32 s3, 0
    s_cbranch_scc1 sig_5
    s_mov_b64 exec, 1
    v_mov_b32 v18, s57
    buffer_atomic_add v18, v17, s[4:7], s28 offen sc1
    s_mov_b64 exec, -1
sig_5:
    s_mov_b32 s28, 0
    s_cmp_eq_u32 s98, 3
    s_cselect_b32 s98, 1, s98
    s_cmp_eq_u32 s98, 5
    s_cselect_b32 s98, 3, s98
    s_cmp_lg_u32 s98, 1
    s_cbranch_scc1 w_hook
    s_cmp_lt_u32 s39, 1048576
    s_cbranch_scc1 w_hook
    s_mov_b32 s98, 4
    s_branch ln_entry
w_hook:
    s_cmp_eq_u32 s70, 0
    s_cbranch_scc1 drw_ok
    s_cmp_lt_u32 s39, 1048576
    s_cbranch_scc1 drw_ok
    s_mov_b32 s70, 0
    s_cmp_lg_u32 s3, 0
    s_cbranch_scc1 drw_ok
    v_readfirstlane_b32 s68, v22
    s_cmp_ge_u32 s68, 128
    s_cbranch_scc1 drw_ok
    s_mov_b32 s69, 65536
drw:
    buffer_load_dword v20, off, s[64:67], 0 offset:0 sc1
    s_waitcnt vmcnt(0)
    v_readfirstlane_b32 s68, v20
    s_cmp_ge_u32 s68, 128
    s_cbranch_scc1 drw_ok
    s_sleep 8
    s_sub_u32 s69, s69, 1
    s_cbranch_scc0 drw
drw_ok:
    s_branch w_cold
fin_entry:
    s_load_dwordx2 s[8:9], s[0:1], 0
    s_load_dwordx2 s[12:13], s[0:1], 88
    v_mbcnt_lo_u32_b32 v1, -1, 0
    v_mbcnt_hi_u32_b32 v1, -1, v1
    s_mov_b32 s10, 4194304
    s_mov_b32 s11, 131072
    s_mov_b32 s14, 4194304
    s_mov_b32 s15, 131072
    v_lshlrev_b32 v3, 4, v1
    v_and_b32 v4, 15, v1
    v_lshrrev_b32 v5, 4, v1
    v_lshlrev_b32 v4, 11, v4
    v_lshl_add_u32 v4, v5, 4, v4
    v_and_b32 v5, 1, v5
    v_cmp_eq_u32 s[20:21], 1, v5
    v_and_b32 v6, 7, v1
    v_lshlrev_b32 v6, 7, v6
    s_lshr_b32 s24, s63, 2
    s_and_b32 s25, s63, 3
    s_lshl_b32 s25, s25, 2
    s_and_b32 s26, s3, 3
    s_add_u32 s25, s25, s26
    s_lshr_b32 s26, s3, 2
    s_mov_b32 s28, 65536
    s_waitcnt lgkmcnt(0)
fin_job:
    s_lshl_b32 s16, s24, 1
    s_add_u32 s16, s16, s26
    s_lshl_b32 s18, s16, 15
    s_lshl_b32 s17, s25, 11
    s_add_u32 s17, s17, s18
    s_lshl_b32 s19, s25, 7
    s_add_u32 s18, s18, s19
    s_add_u32 s22, s17, 167772160
    s_add_u32 s23, s17, 75497472
    s_lshr_b32 s27, s24, 3
    s_lshl_b32 s27, s27, 6
    s_add_u32 s27, s27, 218106368
    s_cmp_ge_u32 s24, 64
    s_cselect_b32 s29, 16, 16
    s_mov_b32 s30, 218112000
    s_add_u32 s32, s24, 1
    s_mov_b32 s33, 0
    s_mov_b32 s34, 255
    s_cmp_lt_u32 s24, 62
    s_cbranch_scc1 fin_tg
    s_mov_b32 s32, 16
    s_add_u32 s30, s30, 4
    s_sub_u32 s33, s24, 62
    s_lshl_b32 s33, s33, 3
fin_tg:
    s_mul_i32 s35, s24, 3
    s_lshr_b32 s35, s35, 4
    s_add_u32 s35, s35, 49
    s_min_u32 s35, s35, 61
    s_max_u32 s32, s32, s35
    buffer_load_dwordx4 v[88:91], v4, s[8:11], s18 offen offset:0
    buffer_load_dwordx4 v[92:95], v4, s[8:11], s18 offen offset:64
    s_cmp_lg_u32 s3, 0
    s_cbranch_scc1 fin_ws_ok
fin_wd:
    buffer_load_dword v7, off, s[4:7], s27 sc1
    s_waitcnt vmcnt(0)
    v_readfirstlane_b32 s31, v7
    s_cmp_ge_u32 s31, s29
    s_cbranch_scc1 fin_wd_ok
    s_sleep 127
    s_sub_u32 s28, s28, 1
    s_cbranch_scc0 fin_wd
    s_mov_b32 s28, 0
fin_wd_ok:
fin_ws:
    buffer_load_dword v7, v6, s[4:7], s30 offen sc1
    s_waitcnt vmcnt(0)
    v_lshrrev_b32 v7, s33, v7
    v_and_b32 v7, s34, v7
    v_cmp_gt_u32 vcc, s32, v7
    s_cbranch_vccz fin_ws_ok
    s_sleep 12
    v_add_u32 v7, 1, v7
    v_cmp_gt_u32 vcc, s32, v7
    s_cbranch_vccz fin_ws_f
    s_sleep 48
    v_add_u32 v7, 3, v7
    v_cmp_gt_u32 vcc, s32, v7
    s_cbranch_vccz fin_ws_f
    s_sleep 127
    s_sleep 127
fin_ws_f:
    s_sub_u32 s28, s28, 1
    s_cbranch_scc0 fin_ws
    s_mov_b32 s28, 0
fin_ws_ok:
    s_barrier
    buffer_load_dwordx4 v[144:147], v3, s[4:7], s22 offen offset:0 sc1
    buffer_load_dwordx4 v[160:163], v3, s[4:7], s22 offen offset:1024 sc1
    s_add_u32 s22, s22, 4194304
    buffer_load_dwordx4 v[148:151], v3, s[4:7], s22 offen offset:0 sc1
    buffer_load_dwordx4 v[164:167], v3, s[4:7], s22 offen offset:1024 sc1
    s_add_u32 s22, s22, 4194304
    buffer_load_dwordx4 v[152:155], v3, s[4:7], s22 offen offset:0 sc1
    buffer_load_dwordx4 v[168:171], v3, s[4:7], s22 offen offset:1024 sc1
    s_add_u32 s22, s22, 4194304
    buffer_load_dwordx4 v[156:159], v3, s[4:7], s22 offen offset:0 sc1
    buffer_load_dwordx4 v[172:175], v3, s[4:7], s22 offen offset:1024 sc1
    buffer_load_dwordx4 v[16:19], v3, s[4:7], s23 offen offset:0 sc1
    buffer_load_dwordx4 v[48:51], v3, s[4:7], s23 offen offset:1024 sc1
    s_add_u32 s23, s23, 4194304
    buffer_load_dwordx4 v[20:23], v3, s[4:7], s23 offen offset:0 sc1
    buffer_load_dwordx4 v[52:55], v3, s[4:7], s23 offen offset:1024 sc1
    s_add_u32 s23, s23, 4194304
    buffer_load_dwordx4 v[24:27], v3, s[4:7], s23 offen offset:0 sc1
    buffer_load_dwordx4 v[56:59], v3, s[4:7], s23 offen offset:1024 sc1
    s_add_u32 s23, s23, 4194304
    buffer_load_dwordx4 v[28:31], v3, s[4:7], s23 offen offset:0 sc1
    buffer_load_dwordx4 v[60:63], v3, s[4:7], s23 offen offset:1024 sc1
    s_add_u32 s23, s23, 4194304
    buffer_load_dwordx4 v[32:35], v3, s[4:7], s23 offen offset:0 sc1
    buffer_load_dwordx4 v[64:67], v3, s[4:7], s23 offen offset:1024 sc1
    s_add_u32 s23, s23, 4194304
    buffer_load_dwordx4 v[36:39], v3, s[4:7], s23 offen offset:0 sc1
    buffer_load_dwordx4 v[68:71], v3, s[4:7], s23 offen offset:1024 sc1
    s_add_u32 s23, s23, 4194304
    buffer_load_dwordx4 v[40:43], v3, s[4:7], s23 offen offset:0 sc1
    buffer_load_dwordx4 v[72:75], v3, s[4:7], s23 offen offset:1024 sc1
    s_add_u32 s23, s23, 4194304
    buffer_load_dwordx4 v[44:47], v3, s[4:7], s23 offen offset:0 sc1
    buffer_load_dwordx4 v[76:79], v3, s[4:7], s23 offen offset:1024 sc1
    s_add_u32 s23, s23, 4194304
    s_waitcnt vmcnt(16)
    v_lshlrev_b32 v96, 16, v144
    v_and_b32 v97, 0xffff0000, v144
    v_lshlrev_b32 v98, 16, v145
    v_and_b32 v99, 0xffff0000, v145
    v_lshlrev_b32 v100, 16, v146
    v_and_b32 v101, 0xffff0000, v146
    v_lshlrev_b32 v102, 16, v147
    v_and_b32 v103, 0xffff0000, v147
    v_lshlrev_b32 v120, 16, v148
    v_and_b32 v121, 0xffff0000, v148
    v_lshlrev_b32 v122, 16, v149
    v_and_b32 v123, 0xffff0000, v149
    v_lshlrev_b32 v124, 16, v150
    v_and_b32 v125, 0xffff0000, v150
    v_lshlrev_b32 v126, 16, v151
    v_and_b32 v127, 0xffff0000, v151
    v_add_f32 v96, v96, v120
    v_add_f32 v97, v97, v121
    v_add_f32 v98, v98, v122
    v_add_f32 v99, v99, v123
    v_add_f32 v100, v100, v124
    v_add_f32 v101, v101, v125
    v_add_f32 v102, v102, v126
    v_add_f32 v103, v103, v127
    v_lshlrev_b32 v120, 16, v152
    v_and_b32 v121, 0xffff0000, v152
    v_lshlrev_b32 v122, 16, v153
    v_and_b32 v123, 0xffff0000, v153
    v_lshlrev_b32 v124, 16, v154
    v_and_b32 v125, 0xffff0000, v154
    v_lshlrev_b32 v126, 16, v155
    v_and_b32 v127, 0xffff0000, v155
    v_add_f32 v96, v96, v120
    v_add_f32 v97, v97, v121
    v_add_f32 v98, v98, v122
    v_add_f32 v99, v99, v123
    v_add_f32 v100, v100, v124
    v_add_f32 v101, v101, v125
    v_add_f32 v102, v102, v126
    v_add_f32 v103, v103, v127
    v_lshlrev_b32 v120, 16, v156
    v_and_b32 v121, 0xffff0000, v156
    v_lshlrev_b32 v122, 16, v157
    v_and_b32 v123, 0xffff0000, v157
    v_lshlrev_b32 v124, 16, v158
    v_and_b32 v125, 0xffff0000, v158
    v_lshlrev_b32 v126, 16, v159
    v_and_b32 v127, 0xffff0000, v159
    v_add_f32 v96, v96, v120
    v_add_f32 v97, v97, v121
    v_add_f32 v98, v98, v122
    v_add_f32 v99, v99, v123
    v_add_f32 v100, v100, v124
    v_add_f32 v101, v101, v125
    v_add_f32 v102, v102, v126
    v_add_f32 v103, v103, v127
    v_cvt_pk_bf16_f32 v120, v96, v97
    v_cvt_pk_bf16_f32 v121, v98, v99
    v_cvt_pk_bf16_f32 v122, v100, v101
    v_cvt_pk_bf16_f32 v123, v102, v103
    v_lshlrev_b32 v96, 16, v120
    v_and_b32 v97, 0xffff0000, v120
    v_lshlrev_b32 v98, 16, v121
    v_and_b32 v99, 0xffff0000, v121
    v_lshlrev_b32 v100, 16, v122
    v_and_b32 v101, 0xffff0000, v122
    v_lshlrev_b32 v102, 16, v123
    v_and_b32 v103, 0xffff0000, v123
    v_mul_f32 v104, 0xbfb8aa3b, v96
    v_mul_f32 v105, 0xbfb8aa3b, v97
    v_mul_f32 v106, 0xbfb8aa3b, v98
    v_mul_f32 v107, 0xbfb8aa3b, v99
    v_mul_f32 v108, 0xbfb8aa3b, v100
    v_mul_f32 v109, 0xbfb8aa3b, v101
    v_mul_f32 v110, 0xbfb8aa3b, v102
    v_mul_f32 v111, 0xbfb8aa3b, v103
    v_exp_f32 v104, v104
    v_exp_f32 v105, v105
    v_exp_f32 v106, v106
    v_exp_f32 v107, v107
    v_exp_f32 v108, v108
    v_exp_f32 v109, v109
    v_exp_f32 v110, v110
    v_exp_f32 v111, v111
    v_add_f32 v104, 1.0, v104
    v_add_f32 v105, 1.0, v105
    v_add_f32 v106, 1.0, v106
    v_add_f32 v107, 1.0, v107
    v_add_f32 v108, 1.0, v108
    v_add_f32 v109, 1.0, v109
    v_add_f32 v110, 1.0, v110
    v_add_f32 v111, 1.0, v111
    v_rcp_f32 v104, v104
    v_rcp_f32 v105, v105
    v_rcp_f32 v106, v106
    v_rcp_f32 v107, v107
    v_rcp_f32 v108, v108
    v_rcp_f32 v109, v109
    v_rcp_f32 v110, v110
    v_rcp_f32 v111, v111
    v_mul_f32 v96, v96, v104
    v_mul_f32 v97, v97, v105
    v_mul_f32 v98, v98, v106
    v_mul_f32 v99, v99, v107
    v_mul_f32 v100, v100, v108
    v_mul_f32 v101, v101, v109
    v_mul_f32 v102, v102, v110
    v_mul_f32 v103, v103, v111
    v_cvt_pk_bf16_f32 v80, v96, v97
    v_cvt_pk_bf16_f32 v81, v98, v99
    v_cvt_pk_bf16_f32 v82, v100, v101
    v_cvt_pk_bf16_f32 v83, v102, v103
    v_lshlrev_b32 v96, 16, v160
    v_and_b32 v97, 0xffff0000, v160
    v_lshlrev_b32 v98, 16, v161
    v_and_b32 v99, 0xffff0000, v161
    v_lshlrev_b32 v100, 16, v162
    v_and_b32 v101, 0xffff0000, v162
    v_lshlrev_b32 v102, 16, v163
    v_and_b32 v103, 0xffff0000, v163
    v_lshlrev_b32 v120, 16, v164
    v_and_b32 v121, 0xffff0000, v164
    v_lshlrev_b32 v122, 16, v165
    v_and_b32 v123, 0xffff0000, v165
    v_lshlrev_b32 v124, 16, v166
    v_and_b32 v125, 0xffff0000, v166
    v_lshlrev_b32 v126, 16, v167
    v_and_b32 v127, 0xffff0000, v167
    v_add_f32 v96, v96, v120
    v_add_f32 v97, v97, v121
    v_add_f32 v98, v98, v122
    v_add_f32 v99, v99, v123
    v_add_f32 v100, v100, v124
    v_add_f32 v101, v101, v125
    v_add_f32 v102, v102, v126
    v_add_f32 v103, v103, v127
    v_lshlrev_b32 v120, 16, v168
    v_and_b32 v121, 0xffff0000, v168
    v_lshlrev_b32 v122, 16, v169
    v_and_b32 v123, 0xffff0000, v169
    v_lshlrev_b32 v124, 16, v170
    v_and_b32 v125, 0xffff0000, v170
    v_lshlrev_b32 v126, 16, v171
    v_and_b32 v127, 0xffff0000, v171
    v_add_f32 v96, v96, v120
    v_add_f32 v97, v97, v121
    v_add_f32 v98, v98, v122
    v_add_f32 v99, v99, v123
    v_add_f32 v100, v100, v124
    v_add_f32 v101, v101, v125
    v_add_f32 v102, v102, v126
    v_add_f32 v103, v103, v127
    v_lshlrev_b32 v120, 16, v172
    v_and_b32 v121, 0xffff0000, v172
    v_lshlrev_b32 v122, 16, v173
    v_and_b32 v123, 0xffff0000, v173
    v_lshlrev_b32 v124, 16, v174
    v_and_b32 v125, 0xffff0000, v174
    v_lshlrev_b32 v126, 16, v175
    v_and_b32 v127, 0xffff0000, v175
    v_add_f32 v96, v96, v120
    v_add_f32 v97, v97, v121
    v_add_f32 v98, v98, v122
    v_add_f32 v99, v99, v123
    v_add_f32 v100, v100, v124
    v_add_f32 v101, v101, v125
    v_add_f32 v102, v102, v126
    v_add_f32 v103, v103, v127
    v_cvt_pk_bf16_f32 v120, v96, v97
    v_cvt_pk_bf16_f32 v121, v98, v99
    v_cvt_pk_bf16_f32 v122, v100, v101
    v_cvt_pk_bf16_f32 v123, v102, v103
    v_lshlrev_b32 v96, 16, v120
    v_and_b32 v97, 0xffff0000, v120
    v_lshlrev_b32 v98, 16, v121
    v_and_b32 v99, 0xffff0000, v121
    v_lshlrev_b32 v100, 16, v122
    v_and_b32 v101, 0xffff0000, v122
    v_lshlrev_b32 v102, 16, v123
    v_and_b32 v103, 0xffff0000, v123
    v_mul_f32 v104, 0xbfb8aa3b, v96
    v_mul_f32 v105, 0xbfb8aa3b, v97
    v_mul_f32 v106, 0xbfb8aa3b, v98
    v_mul_f32 v107, 0xbfb8aa3b, v99
    v_mul_f32 v108, 0xbfb8aa3b, v100
    v_mul_f32 v109, 0xbfb8aa3b, v101
    v_mul_f32 v110, 0xbfb8aa3b, v102
    v_mul_f32 v111, 0xbfb8aa3b, v103
    v_exp_f32 v104, v104
    v_exp_f32 v105, v105
    v_exp_f32 v106, v106
    v_exp_f32 v107, v107
    v_exp_f32 v108, v108
    v_exp_f32 v109, v109
    v_exp_f32 v110, v110
    v_exp_f32 v111, v111
    v_add_f32 v104, 1.0, v104
    v_add_f32 v105, 1.0, v105
    v_add_f32 v106, 1.0, v106
    v_add_f32 v107, 1.0, v107
    v_add_f32 v108, 1.0, v108
    v_add_f32 v109, 1.0, v109
    v_add_f32 v110, 1.0, v110
    v_add_f32 v111, 1.0, v111
    v_rcp_f32 v104, v104
    v_rcp_f32 v105, v105
    v_rcp_f32 v106, v106
    v_rcp_f32 v107, v107
    v_rcp_f32 v108, v108
    v_rcp_f32 v109, v109
    v_rcp_f32 v110, v110
    v_rcp_f32 v111, v111
    v_mul_f32 v96, v96, v104
    v_mul_f32 v97, v97, v105
    v_mul_f32 v98, v98, v106
    v_mul_f32 v99, v99, v107
    v_mul_f32 v100, v100, v108
    v_mul_f32 v101, v101, v109
    v_mul_f32 v102, v102, v110
    v_mul_f32 v103, v103, v111
    v_cvt_pk_bf16_f32 v84, v96, v97
    v_cvt_pk_bf16_f32 v85, v98, v99
    v_cvt_pk_bf16_f32 v86, v100, v101
    v_cvt_pk_bf16_f32 v87, v102, v103
    s_waitcnt vmcnt(0)
    v_lshlrev_b32 v96, 16, v16
    v_and_b32 v97, 0xffff0000, v16
    v_lshlrev_b32 v98, 16, v17
    v_and_b32 v99, 0xffff0000, v17
    v_lshlrev_b32 v100, 16, v18
    v_and_b32 v101, 0xffff0000, v18
    v_lshlrev_b32 v102, 16, v19
    v_and_b32 v103, 0xffff0000, v19
    v_lshlrev_b32 v120, 16, v20
    v_and_b32 v121, 0xffff0000, v20
    v_lshlrev_b32 v122, 16, v21
    v_and_b32 v123, 0xffff0000, v21
    v_lshlrev_b32 v124, 16, v22
    v_and_b32 v125, 0xffff0000, v22
    v_lshlrev_b32 v126, 16, v23
    v_and_b32 v127, 0xffff0000, v23
    v_add_f32 v96, v96, v120
    v_add_f32 v97, v97, v121
    v_add_f32 v98, v98, v122
    v_add_f32 v99, v99, v123
    v_add_f32 v100, v100, v124
    v_add_f32 v101, v101, v125
    v_add_f32 v102, v102, v126
    v_add_f32 v103, v103, v127
    v_lshlrev_b32 v120, 16, v24
    v_and_b32 v121, 0xffff0000, v24
    v_lshlrev_b32 v122, 16, v25
    v_and_b32 v123, 0xffff0000, v25
    v_lshlrev_b32 v124, 16, v26
    v_and_b32 v125, 0xffff0000, v26
    v_lshlrev_b32 v126, 16, v27
    v_and_b32 v127, 0xffff0000, v27
    v_add_f32 v96, v96, v120
    v_add_f32 v97, v97, v121
    v_add_f32 v98, v98, v122
    v_add_f32 v99, v99, v123
    v_add_f32 v100, v100, v124
    v_add_f32 v101, v101, v125
    v_add_f32 v102, v102, v126
    v_add_f32 v103, v103, v127
    v_lshlrev_b32 v120, 16, v28
    v_and_b32 v121, 0xffff0000, v28
    v_lshlrev_b32 v122, 16, v29
    v_and_b32 v123, 0xffff0000, v29
    v_lshlrev_b32 v124, 16, v30
    v_and_b32 v125, 0xffff0000, v30
    v_lshlrev_b32 v126, 16, v31
    v_and_b32 v127, 0xffff0000, v31
    v_add_f32 v96, v96, v120
    v_add_f32 v97, v97, v121
    v_add_f32 v98, v98, v122
    v_add_f32 v99, v99, v123
    v_add_f32 v100, v100, v124
    v_add_f32 v101, v101, v125
    v_add_f32 v102, v102, v126
    v_add_f32 v103, v103, v127
    v_lshlrev_b32 v120, 16, v32
    v_and_b32 v121, 0xffff0000, v32
    v_lshlrev_b32 v122, 16, v33
    v_and_b32 v123, 0xffff0000, v33
    v_lshlrev_b32 v124, 16, v34
    v_and_b32 v125, 0xffff0000, v34
    v_lshlrev_b32 v126, 16, v35
    v_and_b32 v127, 0xffff0000, v35
    v_add_f32 v96, v96, v120
    v_add_f32 v97, v97, v121
    v_add_f32 v98, v98, v122
    v_add_f32 v99, v99, v123
    v_add_f32 v100, v100, v124
    v_add_f32 v101, v101, v125
    v_add_f32 v102, v102, v126
    v_add_f32 v103, v103, v127
    v_lshlrev_b32 v120, 16, v36
    v_and_b32 v121, 0xffff0000, v36
    v_lshlrev_b32 v122, 16, v37
    v_and_b32 v123, 0xffff0000, v37
    v_lshlrev_b32 v124, 16, v38
    v_and_b32 v125, 0xffff0000, v38
    v_lshlrev_b32 v126, 16, v39
    v_and_b32 v127, 0xffff0000, v39
    v_add_f32 v96, v96, v120
    v_add_f32 v97, v97, v121
    v_add_f32 v98, v98, v122
    v_add_f32 v99, v99, v123
    v_add_f32 v100, v100, v124
    v_add_f32 v101, v101, v125
    v_add_f32 v102, v102, v126
    v_add_f32 v103, v103, v127
    v_lshlrev_b32 v120, 16, v40
    v_and_b32 v121, 0xffff0000, v40
    v_lshlrev_b32 v122, 16, v41
    v_and_b32 v123, 0xffff0000, v41
    v_lshlrev_b32 v124, 16, v42
    v_and_b32 v125, 0xffff0000, v42
    v_lshlrev_b32 v126, 16, v43
    v_and_b32 v127, 0xffff0000, v43
    v_add_f32 v96, v96, v120
    v_add_f32 v97, v97, v121
    v_add_f32 v98, v98, v122
    v_add_f32 v99, v99, v123
    v_add_f32 v100, v100, v124
    v_add_f32 v101, v101, v125
    v_add_f32 v102, v102, v126
    v_add_f32 v103, v103, v127
    v_lshlrev_b32 v120, 16, v44
    v_and_b32 v121, 0xffff0000, v44
    v_lshlrev_b32 v122, 16, v45
    v_and_b32 v123, 0xffff0000, v45
    v_lshlrev_b32 v124, 16, v46
    v_and_b32 v125, 0xffff0000, v46
    v_lshlrev_b32 v126, 16, v47
    v_and_b32 v127, 0xffff0000, v47
    v_add_f32 v96, v96, v120
    v_add_f32 v97, v97, v121
    v_add_f32 v98, v98, v122
    v_add_f32 v99, v99, v123
    v_add_f32 v100, v100, v124
    v_add_f32 v101, v101, v125
    v_add_f32 v102, v102, v126
    v_add_f32 v103, v103, v127
    v_cndmask_b32 v108, v88, v90, s[20:21]
    v_cndmask_b32 v109, v89, v91, s[20:21]
    v_cndmask_b32 v110, v90, v88, s[20:21]
    v_cndmask_b32 v111, v91, v89, s[20:21]
    v_cvt_pk_bf16_f32 v104, v96, v97
    v_lshlrev_b32 v96, 16, v104
    v_and_b32 v97, 0xffff0000, v104
    v_lshlrev_b32 v104, 16, v80
    v_and_b32 v105, 0xffff0000, v80
    v_mul_f32 v96, v96, v104
    v_mul_f32 v97, v97, v105
    v_cvt_pk_bf16_f32 v104, v96, v97
    v_lshlrev_b32 v96, 16, v104
    v_and_b32 v97, 0xffff0000, v104
    v_lshlrev_b32 v104, 16, v108
    v_and_b32 v105, 0xffff0000, v108
    v_add_f32 v96, v96, v104
    v_add_f32 v97, v97, v105
    v_cvt_pk_bf16_f32 v112, v96, v97
    v_cvt_pk_bf16_f32 v104, v98, v99
    v_lshlrev_b32 v98, 16, v104
    v_and_b32 v99, 0xffff0000, v104
    v_lshlrev_b32 v104, 16, v81
    v_and_b32 v105, 0xffff0000, v81
    v_mul_f32 v98, v98, v104
    v_mul_f32 v99, v99, v105
    v_cvt_pk_bf16_f32 v104, v98, v99
    v_lshlrev_b32 v98, 16, v104
    v_and_b32 v99, 0xffff0000, v104
    v_lshlrev_b32 v104, 16, v109
    v_and_b32 v105, 0xffff0000, v109
    v_add_f32 v98, v98, v104
    v_add_f32 v99, v99, v105
    v_cvt_pk_bf16_f32 v113, v98, v99
    v_cvt_pk_bf16_f32 v104, v100, v101
    v_lshlrev_b32 v100, 16, v104
    v_and_b32 v101, 0xffff0000, v104
    v_lshlrev_b32 v104, 16, v82
    v_and_b32 v105, 0xffff0000, v82
    v_mul_f32 v100, v100, v104
    v_mul_f32 v101, v101, v105
    v_cvt_pk_bf16_f32 v104, v100, v101
    v_lshlrev_b32 v100, 16, v104
    v_and_b32 v101, 0xffff0000, v104
    v_lshlrev_b32 v104, 16, v110
    v_and_b32 v105, 0xffff0000, v110
    v_add_f32 v100, v100, v104
    v_add_f32 v101, v101, v105
    v_cvt_pk_bf16_f32 v114, v100, v101
    v_cvt_pk_bf16_f32 v104, v102, v103
    v_lshlrev_b32 v102, 16, v104
    v_and_b32 v103, 0xffff0000, v104
    v_lshlrev_b32 v104, 16, v83
    v_and_b32 v105, 0xffff0000, v83
    v_mul_f32 v102, v102, v104
    v_mul_f32 v103, v103, v105
    v_cvt_pk_bf16_f32 v104, v102, v103
    v_lshlrev_b32 v102, 16, v104
    v_and_b32 v103, 0xffff0000, v104
    v_lshlrev_b32 v104, 16, v111
    v_and_b32 v105, 0xffff0000, v111
    v_add_f32 v102, v102, v104
    v_add_f32 v103, v103, v105
    v_cvt_pk_bf16_f32 v115, v102, v103
    v_cndmask_b32 v128, v112, v114, s[20:21]
    v_cndmask_b32 v129, v113, v115, s[20:21]
    v_cndmask_b32 v130, v114, v112, s[20:21]
    v_cndmask_b32 v131, v115, v113, s[20:21]
    buffer_store_dwordx4 v[128:131], v4, s[12:15], s18 offen offset:0
    v_lshlrev_b32 v96, 16, v48
    v_and_b32 v97, 0xffff0000, v48
    v_lshlrev_b32 v98, 16, v49
    v_and_b32 v99, 0xffff0000, v49
    v_lshlrev_b32 v100, 16, v50
    v_and_b32 v101, 0xffff0000, v50
    v_lshlrev_b32 v102, 16, v51
    v_and_b32 v103, 0xffff0000, v51
    v_lshlrev_b32 v120, 16, v52
    v_and_b32 v121, 0xffff0000, v52
    v_lshlrev_b32 v122, 16, v53
    v_and_b32 v123, 0xffff0000, v53
    v_lshlrev_b32 v124, 16, v54
    v_and_b32 v125, 0xffff0000, v54
    v_lshlrev_b32 v126, 16, v55
    v_and_b32 v127, 0xffff0000, v55
    v_add_f32 v96, v96, v120
    v_add_f32 v97, v97, v121
    v_add_f32 v98, v98, v122
    v_add_f32 v99, v99, v123
    v_add_f32 v100, v100, v124
    v_add_f32 v101, v101, v125
    v_add_f32 v102, v102, v126
    v_add_f32 v103, v103, v127
    v_lshlrev_b32 v120, 16, v56
    v_and_b32 v121, 0xffff0000, v56
    v_lshlrev_b32 v122, 16, v57
    v_and_b32 v123, 0xffff0000, v57
    v_lshlrev_b32 v124, 16, v58
    v_and_b32 v125, 0xffff0000, v58
    v_lshlrev_b32 v126, 16, v59
    v_and_b32 v127, 0xffff0000, v59
    v_add_f32 v96, v96, v120
    v_add_f32 v97, v97, v121
    v_add_f32 v98, v98, v122
    v_add_f32 v99, v99, v123
    v_add_f32 v100, v100, v124
    v_add_f32 v101, v101, v125
    v_add_f32 v102, v102, v126
    v_add_f32 v103, v103, v127
    v_lshlrev_b32 v120, 16, v60
    v_and_b32 v121, 0xffff0000, v60
    v_lshlrev_b32 v122, 16, v61
    v_and_b32 v123, 0xffff0000, v61
    v_lshlrev_b32 v124, 16, v62
    v_and_b32 v125, 0xffff0000, v62
    v_lshlrev_b32 v126, 16, v63
    v_and_b32 v127, 0xffff0000, v63
    v_add_f32 v96, v96, v120
    v_add_f32 v97, v97, v121
    v_add_f32 v98, v98, v122
    v_add_f32 v99, v99, v123
    v_add_f32 v100, v100, v124
    v_add_f32 v101, v101, v125
    v_add_f32 v102, v102, v126
    v_add_f32 v103, v103, v127
    v_lshlrev_b32 v120, 16, v64
    v_and_b32 v121, 0xffff0000, v64
    v_lshlrev_b32 v122, 16, v65
    v_and_b32 v123, 0xffff0000, v65
    v_lshlrev_b32 v124, 16, v66
    v_and_b32 v125, 0xffff0000, v66
    v_lshlrev_b32 v126, 16, v67
    v_and_b32 v127, 0xffff0000, v67
    v_add_f32 v96, v96, v120
    v_add_f32 v97, v97, v121
    v_add_f32 v98, v98, v122
    v_add_f32 v99, v99, v123
    v_add_f32 v100, v100, v124
    v_add_f32 v101, v101, v125
    v_add_f32 v102, v102, v126
    v_add_f32 v103, v103, v127
    v_lshlrev_b32 v120, 16, v68
    v_and_b32 v121, 0xffff0000, v68
    v_lshlrev_b32 v122, 16, v69
    v_and_b32 v123, 0xffff0000, v69
    v_lshlrev_b32 v124, 16, v70
    v_and_b32 v125, 0xffff0000, v70
    v_lshlrev_b32 v126, 16, v71
    v_and_b32 v127, 0xffff0000, v71
    v_add_f32 v96, v96, v120
    v_add_f32 v97, v97, v121
    v_add_f32 v98, v98, v122
    v_add_f32 v99, v99, v123
    v_add_f32 v100, v100, v124
    v_add_f32 v101, v101, v125
    v_add_f32 v102, v102, v126
    v_add_f32 v103, v103, v127
    v_lshlrev_b32 v120, 16, v72
    v_and_b32 v121, 0xffff0000, v72
    v_lshlrev_b32 v122, 16, v73
    v_and_b32 v123, 0xffff0000, v73
    v_lshlrev_b32 v124, 16, v74
    v_and_b32 v125, 0xffff0000, v74
    v_lshlrev_b32 v126, 16, v75
    v_and_b32 v127, 0xffff0000, v75
    v_add_f32 v96, v96, v120
    v_add_f32 v97, v97, v121
    v_add_f32 v98, v98, v122
    v_add_f32 v99, v99, v123
    v_add_f32 v100, v100, v124
    v_add_f32 v101, v101, v125
    v_add_f32 v102, v102, v126
    v_add_f32 v103, v103, v127
    v_lshlrev_b32 v120, 16, v76
    v_and_b32 v121, 0xffff0000, v76
    v_lshlrev_b32 v122, 16, v77
    v_and_b32 v123, 0xffff0000, v77
    v_lshlrev_b32 v124, 16, v78
    v_and_b32 v125, 0xffff0000, v78
    v_lshlrev_b32 v126, 16, v79
    v_and_b32 v127, 0xffff0000, v79
    v_add_f32 v96, v96, v120
    v_add_f32 v97, v97, v121
    v_add_f32 v98, v98, v122
    v_add_f32 v99, v99, v123
    v_add_f32 v100, v100, v124
    v_add_f32 v101, v101, v125
    v_add_f32 v102, v102, v126
    v_add_f32 v103, v103, v127
    v_cndmask_b32 v108, v92, v94, s[20:21]
    v_cndmask_b32 v109, v93, v95, s[20:21]
    v_cndmask_b32 v110, v94, v92, s[20:21]
    v_cndmask_b32 v111, v95, v93, s[20:21]
    v_cvt_pk_bf16_f32 v104, v96, v97
    v_lshlrev_b32 v96, 16, v104
    v_and_b32 v97, 0xffff0000, v104
    v_lshlrev_b32 v104, 16, v84
    v_and_b32 v105, 0xffff0000, v84
    v_mul_f32 v96, v96, v104
    v_mul_f32 v97, v97, v105
    v_cvt_pk_bf16_f32 v104, v96, v97
    v_lshlrev_b32 v96, 16, v104
    v_and_b32 v97, 0xffff0000, v104
    v_lshlrev_b32 v104, 16, v108
    v_and_b32 v105, 0xffff0000, v108
    v_add_f32 v96, v96, v104
    v_add_f32 v97, v97, v105
    v_cvt_pk_bf16_f32 v112, v96, v97
    v_cvt_pk_bf16_f32 v104, v98, v99
    v_lshlrev_b32 v98, 16, v104
    v_and_b32 v99, 0xffff0000, v104
    v_lshlrev_b32 v104, 16, v85
    v_and_b32 v105, 0xffff0000, v85
    v_mul_f32 v98, v98, v104
    v_mul_f32 v99, v99, v105
    v_cvt_pk_bf16_f32 v104, v98, v99
    v_lshlrev_b32 v98, 16, v104
    v_and_b32 v99, 0xffff0000, v104
    v_lshlrev_b32 v104, 16, v109
    v_and_b32 v105, 0xffff0000, v109
    v_add_f32 v98, v98, v104
    v_add_f32 v99, v99, v105
    v_cvt_pk_bf16_f32 v113, v98, v99
    v_cvt_pk_bf16_f32 v104, v100, v101
    v_lshlrev_b32 v100, 16, v104
    v_and_b32 v101, 0xffff0000, v104
    v_lshlrev_b32 v104, 16, v86
    v_and_b32 v105, 0xffff0000, v86
    v_mul_f32 v100, v100, v104
    v_mul_f32 v101, v101, v105
    v_cvt_pk_bf16_f32 v104, v100, v101
    v_lshlrev_b32 v100, 16, v104
    v_and_b32 v101, 0xffff0000, v104
    v_lshlrev_b32 v104, 16, v110
    v_and_b32 v105, 0xffff0000, v110
    v_add_f32 v100, v100, v104
    v_add_f32 v101, v101, v105
    v_cvt_pk_bf16_f32 v114, v100, v101
    v_cvt_pk_bf16_f32 v104, v102, v103
    v_lshlrev_b32 v102, 16, v104
    v_and_b32 v103, 0xffff0000, v104
    v_lshlrev_b32 v104, 16, v87
    v_and_b32 v105, 0xffff0000, v87
    v_mul_f32 v102, v102, v104
    v_mul_f32 v103, v103, v105
    v_cvt_pk_bf16_f32 v104, v102, v103
    v_lshlrev_b32 v102, 16, v104
    v_and_b32 v103, 0xffff0000, v104
    v_lshlrev_b32 v104, 16, v111
    v_and_b32 v105, 0xffff0000, v111
    v_add_f32 v102, v102, v104
    v_add_f32 v103, v103, v105
    v_cvt_pk_bf16_f32 v115, v102, v103
    v_cndmask_b32 v132, v112, v114, s[20:21]
    v_cndmask_b32 v133, v113, v115, s[20:21]
    v_cndmask_b32 v134, v114, v112, s[20:21]
    v_cndmask_b32 v135, v115, v113, s[20:21]
    buffer_store_dwordx4 v[132:135], v4, s[12:15], s18 offen offset:64
    s_add_u32 s24, s24, 32
    s_cmp_lt_u32 s24, 61
    s_cbranch_scc1 fin_job
    s_cmp_ge_u32 s63, 48
    s_cbranch_scc1 k_end
    s_lshr_b32 s24, s63, 4
    s_sub_u32 s24, 63, s24
    s_and_b32 s25, s63, 15
    s_lshl_b32 s25, s25, 2
    s_and_b32 s26, s3, 3
    s_add_u32 s25, s25, s26
    s_lshr_b32 s26, s25, 5
    s_and_b32 s25, s25, 31
    s_lshl_b32 s16, s24, 1
    s_add_u32 s16, s16, s26
    s_lshl_b32 s18, s16, 15
    s_lshl_b32 s17, s25, 10
    s_add_u32 s17, s17, s18
    s_lshl_b32 s19, s25, 6
    s_add_u32 s18, s18, s19
    s_add_u32 s22, s17, 167772160
    s_add_u32 s23, s17, 75497472
    s_mov_b32 s27, 218106816
    s_mov_b32 s30, 218112000
    s_mov_b32 s28, 65536
    v_and_b32 v8, 7, v1
    v_lshlrev_b32 v8, 22, v8
    s_cmp_lg_u32 s3, 0
    s_cbranch_scc1 ft_ok
ft_wd:
    buffer_load_dword v7, off, s[4:7], s27 sc1
    s_waitcnt vmcnt(0)
    v_readfirstlane_b32 s31, v7
    s_cmp_ge_u32 s31, 16
    s_cbranch_scc1 ft_ws
    s_sleep 127
    s_sub_u32 s28, s28, 1
    s_cbranch_scc0 ft_wd
    s_mov_b32 s28, 0
ft_ws:
    buffer_load_dword v7, v6, s[4:7], s30 offen sc1
    s_waitcnt vmcnt(0)
    v_cmp_gt_u32 vcc, 61, v7
    s_cbranch_vccz ft_ok
    s_sleep 12
    v_cmp_gt_u32 vcc, 59, v7
    s_cbranch_vccz ft_wsf
    s_sleep 64
    v_cmp_gt_u32 vcc, 56, v7
    s_cbranch_vccz ft_wsf
    s_sleep 127
    s_sleep 127
ft_wsf:
    s_sub_u32 s28, s28, 1
    s_cbranch_scc0 ft_ws
    s_mov_b32 s28, 0
ft_ok:
    s_barrier
    s_cmp_ge_u32 s3, 4
    s_cbranch_scc1 k_end
    buffer_load_dwordx4 v[88:91], v4, s[8:11], s18 offen
    buffer_load_dwordx4 v[144:147], v3, s[4:7], s22 offen offset:0 sc1
    s_add_u32 s22, s22, 4194304
    buffer_load_dwordx4 v[148:151], v3, s[4:7], s22 offen offset:0 sc1
    s_add_u32 s22, s22, 4194304
    buffer_load_dwordx4 v[152:155], v3, s[4:7], s22 offen offset:0 sc1
    s_add_u32 s22, s22, 4194304
    buffer_load_dwordx4 v[156:159], v3, s[4:7], s22 offen offset:0 sc1
    s_waitcnt vmcnt(0)
    v_lshlrev_b32 v96, 16, v144
    v_and_b32 v97, 0xffff0000, v144
    v_lshlrev_b32 v98, 16, v145
    v_and_b32 v99, 0xffff0000, v145
    v_lshlrev_b32 v100, 16, v146
    v_and_b32 v101, 0xffff0000, v146
    v_lshlrev_b32 v102, 16, v147
    v_and_b32 v103, 0xffff0000, v147
    v_lshlrev_b32 v120, 16, v148
    v_and_b32 v121, 0xffff0000, v148
    v_lshlrev_b32 v122, 16, v149
    v_and_b32 v123, 0xffff0000, v149
    v_lshlrev_b32 v124, 16, v150
    v_and_b32 v125, 0xffff0000, v150
    v_lshlrev_b32 v126, 16, v151
    v_and_b32 v127, 0xffff0000, v151
    v_add_f32 v96, v96, v120
    v_add_f32 v97, v97, v121
    v_add_f32 v98, v98, v122
    v_add_f32 v99, v99, v123
    v_add_f32 v100, v100, v124
    v_add_f32 v101, v101, v125
    v_add_f32 v102, v102, v126
    v_add_f32 v103, v103, v127
    v_lshlrev_b32 v120, 16, v152
    v_and_b32 v121, 0xffff0000, v152
    v_lshlrev_b32 v122, 16, v153
    v_and_b32 v123, 0xffff0000, v153
    v_lshlrev_b32 v124, 16, v154
    v_and_b32 v125, 0xffff0000, v154
    v_lshlrev_b32 v126, 16, v155
    v_and_b32 v127, 0xffff0000, v155
    v_add_f32 v96, v96, v120
    v_add_f32 v97, v97, v121
    v_add_f32 v98, v98, v122
    v_add_f32 v99, v99, v123
    v_add_f32 v100, v100, v124
    v_add_f32 v101, v101, v125
    v_add_f32 v102, v102, v126
    v_add_f32 v103, v103, v127
    v_lshlrev_b32 v120, 16, v156
    v_and_b32 v121, 0xffff0000, v156
    v_lshlrev_b32 v122, 16, v157
    v_and_b32 v123, 0xffff0000, v157
    v_lshlrev_b32 v124, 16, v158
    v_and_b32 v125, 0xffff0000, v158
    v_lshlrev_b32 v126, 16, v159
    v_and_b32 v127, 0xffff0000, v159
    v_add_f32 v96, v96, v120
    v_add_f32 v97, v97, v121
    v_add_f32 v98, v98, v122
    v_add_f32 v99, v99, v123
    v_add_f32 v100, v100, v124
    v_add_f32 v101, v101, v125
    v_add_f32 v102, v102, v126
    v_add_f32 v103, v103, v127
    v_cvt_pk_bf16_f32 v120, v96, v97
    v_cvt_pk_bf16_f32 v121, v98, v99
    v_cvt_pk_bf16_f32 v122, v100, v101
    v_cvt_pk_bf16_f32 v123, v102, v103
    v_lshlrev_b32 v96, 16, v120
    v_and_b32 v97, 0xffff0000, v120
    v_lshlrev_b32 v98, 16, v121
    v_and_b32 v99, 0xffff0000, v121
    v_lshlrev_b32 v100, 16, v122
    v_and_b32 v101, 0xffff0000, v122
    v_lshlrev_b32 v102, 16, v123
    v_and_b32 v103, 0xffff0000, v123
    v_mul_f32 v104, 0xbfb8aa3b, v96
    v_mul_f32 v105, 0xbfb8aa3b, v97
    v_mul_f32 v106, 0xbfb8aa3b, v98
    v_mul_f32 v107, 0xbfb8aa3b, v99
    v_mul_f32 v108, 0xbfb8aa3b, v100
    v_mul_f32 v109, 0xbfb8aa3b, v101
    v_mul_f32 v110, 0xbfb8aa3b, v102
    v_mul_f32 v111, 0xbfb8aa3b, v103
    v_exp_f32 v104, v104
    v_exp_f32 v105, v105
    v_exp_f32 v106, v106
    v_exp_f32 v107, v107
    v_exp_f32 v108, v108
    v_exp_f32 v109, v109
    v_exp_f32 v110, v110
    v_exp_f32 v111, v111
    v_add_f32 v104, 1.0, v104
    v_add_f32 v105, 1.0, v105
    v_add_f32 v106, 1.0, v106
    v_add_f32 v107, 1.0, v107
    v_add_f32 v108, 1.0, v108
    v_add_f32 v109, 1.0, v109
    v_add_f32 v110, 1.0, v110
    v_add_f32 v111, 1.0, v111
    v_rcp_f32 v104, v104
    v_rcp_f32 v105, v105
    v_rcp_f32 v106, v106
    v_rcp_f32 v107, v107
    v_rcp_f32 v108, v108
    v_rcp_f32 v109, v109
    v_rcp_f32 v110, v110
    v_rcp_f32 v111, v111
    v_mul_f32 v96, v96, v104
    v_mul_f32 v97, v97, v105
    v_mul_f32 v98, v98, v106
    v_mul_f32 v99, v99, v107
    v_mul_f32 v100, v100, v108
    v_mul_f32 v101, v101, v109
    v_mul_f32 v102, v102, v110
    v_mul_f32 v103, v103, v111
    v_cvt_pk_bf16_f32 v80, v96, v97
    v_cvt_pk_bf16_f32 v81, v98, v99
    v_cvt_pk_bf16_f32 v82, v100, v101
    v_cvt_pk_bf16_f32 v83, v102, v103
    s_cmp_eq_u32 s24, 63
    s_cbranch_scc1 ft_p63
ft_p:
    buffer_load_dword v7, v8, s[4:7], s23 offen offset:1020 sc1
    s_waitcnt vmcnt(0)
    v_cmp_eq_u32 vcc, -1, v7
    s_cbranch_vccz ft_l
    s_sleep 4
    s_sub_u32 s28, s28, 1
    s_cbranch_scc0 ft_p
    s_mov_b32 s28, 0
ft_l:
    s_mov_b32 s31, s23
    buffer_load_dwordx4 v[16:19], v3, s[4:7], s31 offen sc1
    s_add_u32 s31, s31, 4194304
    buffer_load_dwordx4 v[20:23], v3, s[4:7], s31 offen sc1
    s_add_u32 s31, s31, 4194304
    buffer_load_dwordx4 v[24:27], v3, s[4:7], s31 offen sc1
    s_add_u32 s31, s31, 4194304
    buffer_load_dwordx4 v[28:31], v3, s[4:7], s31 offen sc1
    s_add_u32 s31, s31, 4194304
    buffer_load_dwordx4 v[32:35], v3, s[4:7], s31 offen sc1
    s_add_u32 s31, s31, 4194304
    buffer_load_dwordx4 v[36:39], v3, s[4:7], s31 offen sc1
    s_add_u32 s31, s31, 4194304
    buffer_load_dwordx4 v[40:43], v3, s[4:7], s31 offen sc1
    s_add_u32 s31, s31, 4194304
    buffer_load_dwordx4 v[44:47], v3, s[4:7], s31 offen sc1
    s_waitcnt vmcnt(0)
    v_max3_u32 v7, v16, v17, v18
    v_max3_u32 v7, v7, v19, v20
    v_max3_u32 v7, v7, v21, v22
    v_max3_u32 v7, v7, v23, v24
    v_max3_u32 v7, v7, v25, v26
    v_max3_u32 v7, v7, v27, v28
    v_max3_u32 v7, v7, v29, v30
    v_max3_u32 v7, v7, v31, v32
    v_max3_u32 v7, v7, v33, v34
    v_max3_u32 v7, v7, v35, v36
    v_max3_u32 v7, v7, v37, v38
    v_max3_u32 v7, v7, v39, v40
    v_max3_u32 v7, v7, v41, v42
    v_max3_u32 v7, v7, v43, v44
    v_max3_u32 v7, v7, v45, v46
    v_max_u32 v7, v7, v47
    v_cmp_eq_u32 vcc, -1, v7
    s_cbranch_vccz ft_go
    s_sleep 2
    s_sub_u32 s28, s28, 1
    s_cbranch_scc0 ft_l
    s_branch ft_go
ft_p63:
    s_sub_u32 s31, s23, 65536
    buffer_load_dword v7, v8, s[4:7], s31 offen offset:1020 sc1
    s_waitcnt vmcnt(0)
    v_cmp_eq_u32 vcc, -1, v7
    s_cbranch_vccz ft_l
    s_sleep 4
    s_sub_u32 s28, s28, 1
    s_cbranch_scc0 ft_p63
    s_mov_b32 s28, 0
    s_branch ft_l
ft_go:
    v_lshlrev_b32 v96, 16, v16
    v_and_b32 v97, 0xffff0000, v16
    v_lshlrev_b32 v98, 16, v17
    v_and_b32 v99, 0xffff0000, v17
    v_lshlrev_b32 v100, 16, v18
    v_and_b32 v101, 0xffff0000, v18
    v_lshlrev_b32 v102, 16, v19
    v_and_b32 v103, 0xffff0000, v19
    v_lshlrev_b32 v120, 16, v20
    v_and_b32 v121, 0xffff0000, v20
    v_lshlrev_b32 v122, 16, v21
    v_and_b32 v123, 0xffff0000, v21
    v_lshlrev_b32 v124, 16, v22
    v_and_b32 v125, 0xffff0000, v22
    v_lshlrev_b32 v126, 16, v23
    v_and_b32 v127, 0xffff0000, v23
    v_add_f32 v96, v96, v120
    v_add_f32 v97, v97, v121
    v_add_f32 v98, v98, v122
    v_add_f32 v99, v99, v123
    v_add_f32 v100, v100, v124
    v_add_f32 v101, v101, v125
    v_add_f32 v102, v102, v126
    v_add_f32 v103, v103, v127
    v_lshlrev_b32 v120, 16, v24
    v_and_b32 v121, 0xffff0000, v24
    v_lshlrev_b32 v122, 16, v25
    v_and_b32 v123, 0xffff0000, v25
    v_lshlrev_b32 v124, 16, v26
    v_and_b32 v125, 0xffff0000, v26
    v_lshlrev_b32 v126, 16, v27
    v_and_b32 v127, 0xffff0000, v27
    v_add_f32 v96, v96, v120
    v_add_f32 v97, v97, v121
    v_add_f32 v98, v98, v122
    v_add_f32 v99, v99, v123
    v_add_f32 v100, v100, v124
    v_add_f32 v101, v101, v125
    v_add_f32 v102, v102, v126
    v_add_f32 v103, v103, v127
    v_lshlrev_b32 v120, 16, v28
    v_and_b32 v121, 0xffff0000, v28
    v_lshlrev_b32 v122, 16, v29
    v_and_b32 v123, 0xffff0000, v29
    v_lshlrev_b32 v124, 16, v30
    v_and_b32 v125, 0xffff0000, v30
    v_lshlrev_b32 v126, 16, v31
    v_and_b32 v127, 0xffff0000, v31
    v_add_f32 v96, v96, v120
    v_add_f32 v97, v97, v121
    v_add_f32 v98, v98, v122
    v_add_f32 v99, v99, v123
    v_add_f32 v100, v100, v124
    v_add_f32 v101, v101, v125
    v_add_f32 v102, v102, v126
    v_add_f32 v103, v103, v127
    v_lshlrev_b32 v120, 16, v32
    v_and_b32 v121, 0xffff0000, v32
    v_lshlrev_b32 v122, 16, v33
    v_and_b32 v123, 0xffff0000, v33
    v_lshlrev_b32 v124, 16, v34
    v_and_b32 v125, 0xffff0000, v34
    v_lshlrev_b32 v126, 16, v35
    v_and_b32 v127, 0xffff0000, v35
    v_add_f32 v96, v96, v120
    v_add_f32 v97, v97, v121
    v_add_f32 v98, v98, v122
    v_add_f32 v99, v99, v123
    v_add_f32 v100, v100, v124
    v_add_f32 v101, v101, v125
    v_add_f32 v102, v102, v126
    v_add_f32 v103, v103, v127
    v_lshlrev_b32 v120, 16, v36
    v_and_b32 v121, 0xffff0000, v36
    v_lshlrev_b32 v122, 16, v37
    v_and_b32 v123, 0xffff0000, v37
    v_lshlrev_b32 v124, 16, v38
    v_and_b32 v125, 0xffff0000, v38
    v_lshlrev_b32 v126, 16, v39
    v_and_b32 v127, 0xffff0000, v39
    v_add_f32 v96, v96, v120
    v_add_f32 v97, v97, v121
    v_add_f32 v98, v98, v122
    v_add_f32 v99, v99, v123
    v_add_f32 v100, v100, v124
    v_add_f32 v101, v101, v125
    v_add_f32 v102, v102, v126
    v_add_f32 v103, v103, v127
    v_lshlrev_b32 v120, 16, v40
    v_and_b32 v121, 0xffff0000, v40
    v_lshlrev_b32 v122, 16, v41
    v_and_b32 v123, 0xffff0000, v41
    v_lshlrev_b32 v124, 16, v42
    v_and_b32 v125, 0xffff0000, v42
    v_lshlrev_b32 v126, 16, v43
    v_and_b32 v127, 0xffff0000, v43
    v_add_f32 v96, v96, v120
    v_add_f32 v97, v97, v121
    v_add_f32 v98, v98, v122
    v_add_f32 v99, v99, v123
    v_add_f32 v100, v100, v124
    v_add_f32 v101, v101, v125
    v_add_f32 v102, v102, v126
    v_add_f32 v103, v103, v127
    v_lshlrev_b32 v120, 16, v44
    v_and_b32 v121, 0xffff0000, v44
    v_lshlrev_b32 v122, 16, v45
    v_and_b32 v123, 0xffff0000, v45
    v_lshlrev_b32 v124, 16, v46
    v_and_b32 v125, 0xffff0000, v46
    v_lshlrev_b32 v126, 16, v47
    v_and_b32 v127, 0xffff0000, v47
    v_add_f32 v96, v96, v120
    v_add_f32 v97, v97, v121
    v_add_f32 v98, v98, v122
    v_add_f32 v99, v99, v123
    v_add_f32 v100, v100, v124
    v_add_f32 v101, v101, v125
    v_add_f32 v102, v102, v126
    v_add_f32 v103, v103, v127
    v_cndmask_b32 v108, v88, v90, s[20:21]
    v_cndmask_b32 v109, v89, v91, s[20:21]
    v_cndmask_b32 v110, v90, v88, s[20:21]
    v_cndmask_b32 v111, v91, v89, s[20:21]
    v_cvt_pk_bf16_f32 v104, v96, v97
    v_lshlrev_b32 v96, 16, v104
    v_and_b32 v97, 0xffff0000, v104
    v_lshlrev_b32 v104, 16, v80
    v_and_b32 v105, 0xffff0000, v80
    v_mul_f32 v96, v96, v104
    v_mul_f32 v97, v97, v105
    v_cvt_pk_bf16_f32 v104, v96, v97
    v_lshlrev_b32 v96, 16, v104
    v_and_b32 v97, 0xffff0000, v104
    v_lshlrev_b32 v104, 16, v108
    v_and_b32 v105, 0xffff0000, v108
    v_add_f32 v96, v96, v104
    v_add_f32 v97, v97, v105
    v_cvt_pk_bf16_f32 v112, v96, v97
    v_cvt_pk_bf16_f32 v104, v98, v99
    v_lshlrev_b32 v98, 16, v104
    v_and_b32 v99, 0xffff0000, v104
    v_lshlrev_b32 v104, 16, v81
    v_and_b32 v105, 0xffff0000, v81
    v_mul_f32 v98, v98, v104
    v_mul_f32 v99, v99, v105
    v_cvt_pk_bf16_f32 v104, v98, v99
    v_lshlrev_b32 v98, 16, v104
    v_and_b32 v99, 0xffff0000, v104
    v_lshlrev_b32 v104, 16, v109
    v_and_b32 v105, 0xffff0000, v109
    v_add_f32 v98, v98, v104
    v_add_f32 v99, v99, v105
    v_cvt_pk_bf16_f32 v113, v98, v99
    v_cvt_pk_bf16_f32 v104, v100, v101
    v_lshlrev_b32 v100, 16, v104
    v_and_b32 v101, 0xffff0000, v104
    v_lshlrev_b32 v104, 16, v82
    v_and_b32 v105, 0xffff0000, v82
    v_mul_f32 v100, v100, v104
    v_mul_f32 v101, v101, v105
    v_cvt_pk_bf16_f32 v104, v100, v101
    v_lshlrev_b32 v100, 16, v104
    v_and_b32 v101, 0xffff0000, v104
    v_lshlrev_b32 v104, 16, v110
    v_and_b32 v105, 0xffff0000, v110
    v_add_f32 v100, v100, v104
    v_add_f32 v101, v101, v105
    v_cvt_pk_bf16_f32 v114, v100, v101
    v_cvt_pk_bf16_f32 v104, v102, v103
    v_lshlrev_b32 v102, 16, v104
    v_and_b32 v103, 0xffff0000, v104
    v_lshlrev_b32 v104, 16, v83
    v_and_b32 v105, 0xffff0000, v83
    v_mul_f32 v102, v102, v104
    v_mul_f32 v103, v103, v105
    v_cvt_pk_bf16_f32 v104, v102, v103
    v_lshlrev_b32 v102, 16, v104
    v_and_b32 v103, 0xffff0000, v104
    v_lshlrev_b32 v104, 16, v111
    v_and_b32 v105, 0xffff0000, v111
    v_add_f32 v102, v102, v104
    v_add_f32 v103, v103, v105
    v_cvt_pk_bf16_f32 v115, v102, v103
    v_cndmask_b32 v128, v112, v114, s[20:21]
    v_cndmask_b32 v129, v113, v115, s[20:21]
    v_cndmask_b32 v130, v114, v112, s[20:21]
    v_cndmask_b32 v131, v115, v113, s[20:21]
    buffer_store_dwordx4 v[128:131], v4, s[12:15], s18 offen offset:0
    s_branch k_end
chain_map:
    s_and_b32 s14, s12, 1
    s_lshl_b32 s13, s13, 1
    s_lshr_b32 s15, s12, 1
    s_add_u32 s12, s13, s14
    s_mov_b32 s13, s15
    s_lshl_b32 s2, s13, 3
    s_add_u32 s2, s2, s12
    s_lshr_b32 s14, s13, 2
    s_and_b32 s15, s13, 3
    s_mov_b32 s16, 0
    s_mov_b32 s17, 209715200
    s_mov_b32 s18, 209977344
    s_mov_b32 s19, 210239488
    s_mov_b32 s20, 210501632
    s_mov_b32 s26, 131072
    s_mov_b32 s68, 0
    s_getreg_b32 s29, hwreg(HW_REG_XCC_ID)
    s_and_b32 s29, s29, 15
    s_mul_i32 s23, s29, s29
    s_lshl_b32 s23, s23, 18
    s_lshl_b32 s29, s29, 8
    s_add_u32 s29, s29, s23
    s_add_u32 s29, s29, 1
    s_lshr_b32 s28, s12, 1
    s_lshl_b32 s28, s28, 2
    s_add_u32 s28, s28, 128
    s_cmp_ge_u32 s3, 4
    s_cbranch_scc1 ch_a_pro
    s_lshl_b32 s32, s12, 15
    s_lshl_b32 s21, s14, 13
    s_add_u32 s32, s32, s21
    s_lshl_b32 s21, s15, 10
    s_add_u32 s32, s32, s21
    s_add_u32 s32, s32, 2097152
    s_lshr_b32 s33, s12, 1
    s_lshl_b32 s33, s33, 14
    s_add_u32 s33, s33, 1048576
    s_lshl_b32 s21, s13, 10
    s_add_u32 s36, s33, s21
    s_lshl_b32 s21, s3, 12
    s_add_u32 s33, s33, s21
    s_lshl_b32 s34, s13, 14
    s_lshl_b32 s21, s12, 10
    s_add_u32 s35, s34, s21
    s_lshl_b32 s37, s12, 22
    s_lshl_b32 s21, s13, 11
    s_add_u32 s37, s37, s21
    s_and_b32 s21, s3, 1
    s_lshl_b32 s21, s21, 15
    s_add_u32 s37, s37, s21
    s_lshr_b32 s21, s3, 1
    s_lshl_b32 s21, s21, 10
    s_add_u32 s37, s37, s21
    s_add_u32 s37, s37, 75497472
    v_and_b32 v20, 63, v0
    v_lshlrev_b32 v1, 4, v20
    v_mov_b32 v10, -1
    v_mov_b32 v11, -1
    v_lshrrev_b32 v21, 2, v20
    v_and_b32 v22, 3, v20
    v_lshlrev_b32 v21, 13, v21
    v_lshl_add_u32 v21, v22, 4, v21
    s_lshl_b32 s21, s3, 21
    s_lshl_b32 s22, s12, 10
    s_add_u32 s21, s21, s22
    s_lshl_b32 s23, s3, 15
    s_mov_b32 s10, 8388608
    s_mov_b32 s11, 131072
    v_lshrrev_b32 v24, 4, v20
    v_bfe_u32 v25, v20, 2, 2
    v_lshl_add_u32 v24, v24, 4, v25
    v_lshlrev_b32 v24, 6, v24
    v_lshl_add_u32 v24, v22, 3, v24
    v_add_u32 v24, s23, v24
    s_and_b32 s70, s13, 1
    s_lshl_b32 s71, s12, 4
    s_add_u32 s71, s71, s13
    s_cmp_eq_u32 s71, 127
    s_cselect_b32 s70, 1, 0
    s_cmp_eq_u32 s13, 7
    s_cselect_b32 s70, 1, s70
    s_lshl_b32 s72, s70, 20
    s_lshl_b32 s73, s70, 21
    s_lshl_b32 s70, s70, 13
    s_sub_u32 s71, s23, s70
    s_add_u32 s70, s23, s70
    s_load_dwordx2 s[8:9], s[0:1], 16
    s_lshl_b32 s25, s13, 6
    s_add_u32 s24, s21, s25
    s_add_u32 s24, s24, s72
    s_waitcnt lgkmcnt(0)
    s_add_u32 m0, s70, 0
    s_nop 0
    buffer_load_dwordx4 v21, s[8:11], s24 offen lds
    s_add_u32 s24, s24, 131072
    s_add_u32 m0, s70, 1024
    s_nop 0
    buffer_load_dwordx4 v21, s[8:11], s24 offen lds
    s_add_u32 s24, s24, 131072
    s_add_u32 m0, s70, 2048
    s_nop 0
    buffer_load_dwordx4 v21, s[8:11], s24 offen lds
    s_add_u32 s24, s24, 131072
    s_add_u32 m0, s70, 3072
    s_nop 0
    buffer_load_dwordx4 v21, s[8:11], s24 offen lds
    s_add_u32 s24, s24, 131072
    s_add_u32 m0, s70, 4096
    s_nop 0
    buffer_load_dwordx4 v21, s[8:11], s24 offen lds
    s_add_u32 s24, s24, 131072
    s_add_u32 m0, s70, 5120
    s_nop 0
    buffer_load_dwordx4 v21, s[8:11], s24 offen lds
    s_add_u32 s24, s24, 131072
    s_add_u32 m0, s70, 6144
    s_nop 0
    buffer_load_dwordx4 v21, s[8:11], s24 offen lds
    s_add_u32 s24, s24, 131072
    s_add_u32 m0, s70, 7168
    s_nop 0
    buffer_load_dwordx4 v21, s[8:11], s24 offen lds
    s_add_u32 s24, s24, 131072
    s_sub_u32 s24, s24, s73
    s_add_u32 m0, s71, 8192
    s_nop 0
    buffer_load_dwordx4 v21, s[8:11], s24 offen lds
    s_add_u32 s24, s24, 131072
    s_add_u32 m0, s71, 9216
    s_nop 0
    buffer_load_dwordx4 v21, s[8:11], s24 offen lds
    s_add_u32 s24, s24, 131072
    s_add_u32 m0, s71, 10240
    s_nop 0
    buffer_load_dwordx4 v21, s[8:11], s24 offen lds
    s_add_u32 s24, s24, 131072
    s_add_u32 m0, s71, 11264
    s_nop 0
    buffer_load_dwordx4 v21, s[8:11], s24 offen lds
    s_add_u32 s24, s24, 131072
    s_add_u32 m0, s71, 12288
    s_nop 0
    buffer_load_dwordx4 v21, s[8:11], s24 offen lds
    s_add_u32 s24, s24, 131072
    s_add_u32 m0, s71, 13312
    s_nop 0
    buffer_load_dwordx4 v21, s[8:11], s24 offen lds
    s_add_u32 s24, s24, 131072
    s_add_u32 m0, s71, 14336
    s_nop 0
    buffer_load_dwordx4 v21, s[8:11], s24 offen lds
    s_add_u32 s24, s24, 131072
    s_add_u32 m0, s71, 15360
    s_nop 0
    buffer_load_dwordx4 v21, s[8:11], s24 offen lds
    s_add_u32 s24, s24, 131072
    s_load_dwordx2 s[8:9], s[0:1], 24
    s_lshl_b32 s25, s13, 6
    s_add_u32 s24, s21, s25
    s_add_u32 s24, s24, s72
    s_waitcnt lgkmcnt(0)
    s_add_u32 m0, s70, 16384
    s_nop 0
    buffer_load_dwordx4 v21, s[8:11], s24 offen lds
    s_add_u32 s24, s24, 131072
    s_add_u32 m0, s70, 17408
    s_nop 0
    buffer_load_dwordx4 v21, s[8:11], s24 offen lds
    s_add_u32 s24, s24, 131072
    s_add_u32 m0, s70, 18432
    s_nop 0
    buffer_load_dwordx4 v21, s[8:11], s24 offen lds
    s_add_u32 s24, s24, 131072
    s_add_u32 m0, s70, 19456
    s_nop 0
    buffer_load_dwordx4 v21, s[8:11], s24 offen lds
    s_add_u32 s24, s24, 131072
    s_add_u32 m0, s70, 20480
    s_nop 0
    buffer_load_dwordx4 v21, s[8:11], s24 offen lds
    s_add_u32 s24, s24, 131072
    s_add_u32 m0, s70, 21504
    s_nop 0
    buffer_load_dwordx4 v21, s[8:11], s24 offen lds
    s_add_u32 s24, s24, 131072
    s_add_u32 m0, s70, 22528
    s_nop 0
    buffer_load_dwordx4 v21, s[8:11], s24 offen lds
    s_add_u32 s24, s24, 131072
    s_add_u32 m0, s70, 23552
    s_nop 0
    buffer_load_dwordx4 v21, s[8:11], s24 offen lds
    s_add_u32 s24, s24, 131072
    s_sub_u32 s24, s24, s73
    s_add_u32 m0, s71, 24576
    s_nop 0
    buffer_load_dwordx4 v21, s[8:11], s24 offen lds
    s_add_u32 s24, s24, 131072
    s_add_u32 m0, s71, 25600
    s_nop 0
    buffer_load_dwordx4 v21, s[8:11], s24 offen lds
    s_add_u32 s24, s24, 131072
    s_add_u32 m0, s71, 26624
    s_nop 0
    buffer_load_dwordx4 v21, s[8:11], s24 offen lds
    s_add_u32 s24, s24, 131072
    s_add_u32 m0, s71, 27648
    s_nop 0
    buffer_load_dwordx4 v21, s[8:11], s24 offen lds
    s_add_u32 s24, s24, 131072
    s_add_u32 m0, s71, 28672
    s_nop 0
    buffer_load_dwordx4 v21, s[8:11], s24 offen lds
    s_add_u32 s24, s24, 131072
    s_add_u32 m0, s71, 29696
    s_nop 0
    buffer_load_dwordx4 v21, s[8:11], s24 offen lds
    s_add_u32 s24, s24, 131072
    s_add_u32 m0, s71, 30720
    s_nop 0
    buffer_load_dwordx4 v21, s[8:11], s24 offen lds
    s_add_u32 s24, s24, 131072
    s_add_u32 m0, s71, 31744
    s_nop 0
    buffer_load_dwordx4 v21, s[8:11], s24 offen lds
    s_add_u32 s24, s24, 131072
    s_load_dwordx2 s[8:9], s[0:1], 32
    s_lshl_b32 s25, s13, 6
    s_add_u32 s24, s21, s25
    s_add_u32 s24, s24, s72
    s_waitcnt lgkmcnt(0)
    buffer_load_dwordx4 v[96:99], v21, s[8:11], s24 offen
    s_add_u32 s24, s24, 131072
    buffer_load_dwordx4 v[100:103], v21, s[8:11], s24 offen
    s_add_u32 s24, s24, 131072
    buffer_load_dwordx4 v[104:107], v21, s[8:11], s24 offen
    s_add_u32 s24, s24, 131072
    buffer_load_dwordx4 v[108:111], v21, s[8:11], s24 offen
    s_add_u32 s24, s24, 131072
    buffer_load_dwordx4 v[144:147], v21, s[8:11], s24 offen
    s_add_u32 s24, s24, 131072
    buffer_load_dwordx4 v[148:151], v21, s[8:11], s24 offen
    s_add_u32 s24, s24, 131072
    buffer_load_dwordx4 v[152:155], v21, s[8:11], s24 offen
    s_add_u32 s24, s24, 131072
    buffer_load_dwordx4 v[156:159], v21, s[8:11], s24 offen
    s_add_u32 s24, s24, 131072
    s_sub_u32 s24, s24, s73
    buffer_load_dwordx4 v[192:195], v21, s[8:11], s24 offen
    s_add_u32 s24, s24, 131072
    buffer_load_dwordx4 v[196:199], v21, s[8:11], s24 offen
    s_add_u32 s24, s24, 131072
    buffer_load_dwordx4 v[200:203], v21, s[8:11], s24 offen
    s_add_u32 s24, s24, 131072
    buffer_load_dwordx4 v[204:207], v21, s[8:11], s24 offen
    s_add_u32 s24, s24, 131072
    buffer_load_dwordx4 v[240:243], v21, s[8:11], s24 offen
    s_add_u32 s24, s24, 131072
    buffer_load_dwordx4 v[244:247], v21, s[8:11], s24 offen
    s_add_u32 s24, s24, 131072
    buffer_load_dwordx4 v[248:251], v21, s[8:11], s24 offen
    s_add_u32 s24, s24, 131072
    buffer_load_dwordx4 v[252:255], v21, s[8:11], s24 offen
    s_add_u32 s24, s24, 131072
    s_load_dwordx2 s[8:9], s[0:1], 8
    s_mov_b32 s10, 16384
    v_bfe_u32 v57, v20, 4, 1
    v_lshrrev_b32 v58, 5, v20
    v_and_b32 v59, 1, v20
    v_bfe_u32 v60, v20, 1, 3
    v_lshlrev_b32 v60, 11, v60
    v_lshl_add_u32 v60, v57, 6, v60
    v_lshl_add_u32 v60, v58, 4, v60
    v_lshl_add_u32 v15, v59, 2, v60
    s_lshl_b32 s24, s3, 9
    s_waitcnt lgkmcnt(0)
    buffer_load_dword v32, v15, s[8:11], s24 offen offset:0
    buffer_load_dword v33, v15, s[8:11], s24 offen offset:8
    buffer_load_dword v34, v15, s[8:11], s24 offen offset:32
    buffer_load_dword v35, v15, s[8:11], s24 offen offset:40
    buffer_load_dword v36, v15, s[8:11], s24 offen offset:128
    buffer_load_dword v37, v15, s[8:11], s24 offen offset:136
    buffer_load_dword v38, v15, s[8:11], s24 offen offset:160
    buffer_load_dword v39, v15, s[8:11], s24 offen offset:168
    buffer_load_dword v40, v15, s[8:11], s24 offen offset:256
    buffer_load_dword v41, v15, s[8:11], s24 offen offset:264
    buffer_load_dword v42, v15, s[8:11], s24 offen offset:288
    buffer_load_dword v43, v15, s[8:11], s24 offen offset:296
    buffer_load_dword v44, v15, s[8:11], s24 offen offset:384
    buffer_load_dword v45, v15, s[8:11], s24 offen offset:392
    buffer_load_dword v46, v15, s[8:11], s24 offen offset:416
    buffer_load_dword v47, v15, s[8:11], s24 offen offset:424
    s_barrier
    v_add_u32 v56, s70, v1
    s_add_u32 s71, s71, 8192
    v_add_u32 v26, s71, v1
    s_waitcnt vmcnt(48)
    ds_read_b64_tr_b16 v[64:65], v24 offset:0
    ds_read_b64_tr_b16 v[66:67], v24 offset:256
    ds_read_b64_tr_b16 v[68:69], v24 offset:512
    ds_read_b64_tr_b16 v[70:71], v24 offset:768
    ds_read_b64_tr_b16 v[72:73], v24 offset:32
    ds_read_b64_tr_b16 v[74:75], v24 offset:288
    ds_read_b64_tr_b16 v[76:77], v24 offset:544
    ds_read_b64_tr_b16 v[78:79], v24 offset:800
    s_waitcnt lgkmcnt(0)
    ds_read_b64_tr_b16 v[112:113], v24 offset:4096
    ds_read_b64_tr_b16 v[114:115], v24 offset:4352
    ds_read_b64_tr_b16 v[116:117], v24 offset:4608
    ds_read_b64_tr_b16 v[118:119], v24 offset:4864
    ds_read_b64_tr_b16 v[120:121], v24 offset:4128
    ds_read_b64_tr_b16 v[122:123], v24 offset:4384
    ds_read_b64_tr_b16 v[124:125], v24 offset:4640
    ds_read_b64_tr_b16 v[126:127], v24 offset:4896
    s_waitcnt lgkmcnt(0)
    ds_read_b64_tr_b16 v[160:161], v24 offset:8192
    ds_read_b64_tr_b16 v[162:163], v24 offset:8448
    ds_read_b64_tr_b16 v[164:165], v24 offset:8704
    ds_read_b64_tr_b16 v[166:167], v24 offset:8960
    ds_read_b64_tr_b16 v[168:169], v24 offset:8224
    ds_read_b64_tr_b16 v[170:171], v24 offset:8480
    ds_read_b64_tr_b16 v[172:173], v24 offset:8736
    ds_read_b64_tr_b16 v[174:175], v24 offset:8992
    s_waitcnt lgkmcnt(0)
    ds_read_b64_tr_b16 v[208:209], v24 offset:12288
    ds_read_b64_tr_b16 v[210:211], v24 offset:12544
    ds_read_b64_tr_b16 v[212:213], v24 offset:12800
    ds_read_b64_tr_b16 v[214:215], v24 offset:13056
    ds_read_b64_tr_b16 v[216:217], v24 offset:12320
    ds_read_b64_tr_b16 v[218:219], v24 offset:12576
    ds_read_b64_tr_b16 v[220:221], v24 offset:12832
    ds_read_b64_tr_b16 v[222:223], v24 offset:13088
    s_waitcnt lgkmcnt(0)
    s_waitcnt vmcnt(32)
    ds_read_b64_tr_b16 v[80:81], v24 offset:16384
    ds_read_b64_tr_b16 v[82:83], v24 offset:16640
    ds_read_b64_tr_b16 v[84:85], v24 offset:16896
    ds_read_b64_tr_b16 v[86:87], v24 offset:17152
    ds_read_b64_tr_b16 v[88:89], v24 offset:16416
    ds_read_b64_tr_b16 v[90:91], v24 offset:16672
    ds_read_b64_tr_b16 v[92:93], v24 offset:16928
    ds_read_b64_tr_b16 v[94:95], v24 offset:17184
    s_waitcnt lgkmcnt(0)
    ds_read_b64_tr_b16 v[128:129], v24 offset:20480
    ds_read_b64_tr_b16 v[130:131], v24 offset:20736
    ds_read_b64_tr_b16 v[132:133], v24 offset:20992
    ds_read_b64_tr_b16 v[134:135], v24 offset:21248
    ds_read_b64_tr_b16 v[136:137], v24 offset:20512
    ds_read_b64_tr_b16 v[138:139], v24 offset:20768
    ds_read_b64_tr_b16 v[140:141], v24 offset:21024
    ds_read_b64_tr_b16 v[142:143], v24 offset:21280
    s_waitcnt lgkmcnt(0)
    ds_read_b64_tr_b16 v[176:177], v24 offset:24576
    ds_read_b64_tr_b16 v[178:179], v24 offset:24832
    ds_read_b64_tr_b16 v[180:181], v24 offset:25088
    ds_read_b64_tr_b16 v[182:183], v24 offset:25344
    ds_read_b64_tr_b16 v[184:185], v24 offset:24608
    ds_read_b64_tr_b16 v[186:187], v24 offset:24864
    ds_read_b64_tr_b16 v[188:189], v24 offset:25120
    ds_read_b64_tr_b16 v[190:191], v24 offset:25376
    s_waitcnt lgkmcnt(0)
    ds_read_b64_tr_b16 v[224:225], v24 offset:28672
    ds_read_b64_tr_b16 v[226:227], v24 offset:28928
    ds_read_b64_tr_b16 v[228:229], v24 offset:29184
    ds_read_b64_tr_b16 v[230:231], v24 offset:29440
    ds_read_b64_tr_b16 v[232:233], v24 offset:28704
    ds_read_b64_tr_b16 v[234:235], v24 offset:28960
    ds_read_b64_tr_b16 v[236:237], v24 offset:29216
    ds_read_b64_tr_b16 v[238:239], v24 offset:29472
    s_waitcnt lgkmcnt(0)
    s_waitcnt vmcnt(16)
    ds_write_b128 v56, v[96:99] offset:0
    ds_write_b128 v56, v[100:103] offset:1024
    ds_write_b128 v56, v[104:107] offset:2048
    ds_write_b128 v56, v[108:111] offset:3072
    ds_write_b128 v56, v[144:147] offset:4096
    ds_write_b128 v56, v[148:151] offset:5120
    ds_write_b128 v56, v[152:155] offset:6144
    ds_write_b128 v56, v[156:159] offset:7168
    ds_write_b128 v26, v[192:195] offset:0
    ds_write_b128 v26, v[196:199] offset:1024
    ds_write_b128 v26, v[200:203] offset:2048
    ds_write_b128 v26, v[204:207] offset:3072
    ds_write_b128 v26, v[240:243] offset:4096
    ds_write_b128 v26, v[244:247] offset:5120
    ds_write_b128 v26, v[248:251] offset:6144
    ds_write_b128 v26, v[252:255] offset:7168
    s_waitcnt lgkmcnt(0)
    ds_read_b64_tr_b16 v[96:97], v24 offset:0
    ds_read_b64_tr_b16 v[98:99], v24 offset:256
    ds_read_b64_tr_b16 v[100:101], v24 offset:512
    ds_read_b64_tr_b16 v[102:103], v24 offset:768
    ds_read_b64_tr_b16 v[104:105], v24 offset:32
    ds_read_b64_tr_b16 v[106:107], v24 offset:288
    ds_read_b64_tr_b16 v[108:109], v24 offset:544
    ds_read_b64_tr_b16 v[110:111], v24 offset:800
    s_waitcnt lgkmcnt(0)
    ds_read_b64_tr_b16 v[144:145], v24 offset:4096
    ds_read_b64_tr_b16 v[146:147], v24 offset:4352
    ds_read_b64_tr_b16 v[148:149], v24 offset:4608
    ds_read_b64_tr_b16 v[150:151], v24 offset:4864
    ds_read_b64_tr_b16 v[152:153], v24 offset:4128
    ds_read_b64_tr_b16 v[154:155], v24 offset:4384
    ds_read_b64_tr_b16 v[156:157], v24 offset:4640
    ds_read_b64_tr_b16 v[158:159], v24 offset:4896
    s_waitcnt lgkmcnt(0)
    ds_read_b64_tr_b16 v[192:193], v24 offset:8192
    ds_read_b64_tr_b16 v[194:195], v24 offset:8448
    ds_read_b64_tr_b16 v[196:197], v24 offset:8704
    ds_read_b64_tr_b16 v[198:199], v24 offset:8960
    ds_read_b64_tr_b16 v[200:201], v24 offset:8224
    ds_read_b64_tr_b16 v[202:203], v24 offset:8480
    ds_read_b64_tr_b16 v[204:205], v24 offset:8736
    ds_read_b64_tr_b16 v[206:207], v24 offset:8992
    s_waitcnt lgkmcnt(0)
    ds_read_b64_tr_b16 v[240:241], v24 offset:12288
    ds_read_b64_tr_b16 v[242:243], v24 offset:12544
    ds_read_b64_tr_b16 v[244:245], v24 offset:12800
    ds_read_b64_tr_b16 v[246:247], v24 offset:13056
    ds_read_b64_tr_b16 v[248:249], v24 offset:12320
    ds_read_b64_tr_b16 v[250:251], v24 offset:12576
    ds_read_b64_tr_b16 v[252:253], v24 offset:12832
    ds_read_b64_tr_b16 v[254:255], v24 offset:13088
    s_waitcnt lgkmcnt(0)
    v_mov_b32 v21, 0x44444444
    v_mov_b32 v22, 0xeeeeeeee
    v_and_b32 v23, 1, v20
    v_cmp_eq_u32 vcc, 0, v23
    v_and_b32 v27, 255, v0
    v_lshlrev_b32 v2, 2, v27
    v_cndmask_b32 v62, v22, v21, vcc
    s_lshr_b32 s21, s15, 1
    s_sub_u32 s21, s21, s15
    s_add_u32 s21, s21, 4
    s_lshl_b32 s21, s21, 10
    s_and_b32 s22, s15, 1
    s_lshl_b32 s22, s22, 9
    s_add_u32 s21, s21, s22
    s_mov_b32 s28, s21
    s_and_b32 s62, s12, 1
    s_lshl_b32 s62, s62, 9
    s_add_u32 s62, s62, s36
    s_sub_u32 s62, s62, 512
    s_lshl_b32 s22, s3, 7
    s_add_u32 s21, s21, s22
    v_and_b32 v21, 31, v20
    v_lshlrev_b32 v21, 2, v21
    v_add_u32 v3, s21, v21
    v_lshrrev_b32 v21, 4, v20
    v_and_b32 v22, 15, v20
    v_mul_u32_u24 v21, 208, v21
    v_add_lshl_u32 v21, v21, v22, 2
    s_mul_i32 s21, s3, 3328
    v_add_u32 v4, s21, v21
    v_lshrrev_b32 v21, 4, v20
    v_bfe_u32 v22, v20, 2, 1
    v_lshl_add_u32 v21, v21, 1, v22
    v_mul_u32_u24 v21, 104, v21
    v_bfe_u32 v22, v20, 3, 1
    v_xor_b32 v22, 1, v22
    v_lshl_add_u32 v21, v22, 5, v21
    v_and_b32 v22, 3, v20
    v_lshlrev_b32 v22, 1, v22
    s_and_b32 s21, s3, 1
    s_lshl_b32 s21, s21, 2
    v_xor_b32 v22, s21, v22
    v_add_u32 v21, v21, v22
    s_lshl_b32 s21, s3, 3
    v_add_u32 v21, s21, v21
    v_lshlrev_b32 v5, 2, v21
    s_and_b32 s21, s3, 1
    s_lshl_b32 s21, s21, 2
    v_bfe_u32 v21, v20, 3, 2
    v_add_u32 v21, s21, v21
    v_mul_u32_u24 v21, 104, v21
    v_bfe_u32 v22, v20, 1, 1
    v_lshl_add_u32 v21, v22, 3, v21
    v_and_b32 v23, 1, v20
    v_xor_b32 v22, v22, v23
    v_lshl_add_u32 v21, v22, 2, v21
    v_bfe_u32 v22, v20, 2, 1
    v_lshl_add_u32 v21, v22, 1, v21
    s_lshr_b32 s21, s3, 1
    s_lshl_b32 s21, s21, 4
    s_add_u32 s21, s21, 64
    v_add_u32 v21, s21, v21
    v_lshlrev_b32 v6, 2, v21
    v_lshrrev_b32 v21, 6, v27
    v_bfe_u32 v22, v27, 1, 1
    v_lshrrev_b32 v23, 1, v21
    v_lshl_add_u32 v22, v22, 1, v23
    v_xor_b32 v23, v27, v22
    v_and_b32 v23, 1, v23
    v_and_b32 v21, 1, v21
    v_lshl_add_u32 v21, v21, 1, v23
    v_mul_u32_u24 v21, 544, v21
    v_lshl_add_u32 v21, v22, 5, v21
    v_bfe_u32 v23, v27, 4, 2
    v_mul_u32_u24 v23, 136, v23
    v_add_u32 v21, v21, v23
    v_bfe_u32 v24, v27, 3, 1
    v_lshl_add_u32 v21, v24, 2, v21
    v_bfe_u32 v24, v27, 2, 1
    v_lshl_add_u32 v21, v24, 4, v21
    v_add_u32 v7, 16384, v21
    v_lshlrev_b32 v8, 2, v20
    s_and_b32 s21, s12, 1
    s_lshl_b32 s21, s21, 9
    s_lshl_b32 s22, s3, 7
    s_add_u32 s21, s21, s22
    v_and_b32 v21, 7, v20
    v_lshlrev_b32 v21, 4, v21
    v_add_u32 v21, s21, v21
    v_lshrrev_b32 v22, 3, v20
    v_lshl_add_u32 v12, v22, 10, v21
    v_bfe_u32 v22, v20, 4, 1
    v_lshl_add_u32 v13, v22, 3, v21
    s_and_b32 s21, s3, 1
    s_lshl_b32 s21, s21, 12
    s_lshr_b32 s22, s3, 1
    s_lshl_b32 s22, s22, 11
    s_add_u32 s21, s21, s22
    s_add_u32 s21, s21, 18560
    v_add_u32 v61, s21, v1
    s_lshl_b32 s21, s3, 2
    s_add_u32 s21, s21, 13312
    v_mov_b32 v14, s21
    v_and_b32 v21, 15, v20
    v_and_b32 v22, 1, v20
    v_lshlrev_b32 v22, 4, v22
    v_mov_b32 v23, 0x3f80
    v_lshlrev_b32 v22, v22, v23
    v_lshrrev_b32 v21, 1, v21
    v_cmp_eq_u32 vcc, 0, v21
    s_nop 1
    v_cndmask_b32 v56, 0, v22, vcc
    v_cmp_eq_u32 vcc, 1, v21
    s_nop 1
    v_cndmask_b32 v57, 0, v22, vcc
    v_cmp_eq_u32 vcc, 2, v21
    s_nop 1
    v_cndmask_b32 v58, 0, v22, vcc
    v_cmp_eq_u32 vcc, 3, v21
    s_nop 1
    v_cndmask_b32 v59, 0, v22, vcc
    v_and_b32 v21, 7, v20
    v_lshlrev_b32 v21, 7, v21
    v_bfe_u32 v22, v20, 3, 1
    v_lshl_add_u32 v21, v22, 17, v21
    s_lshl_b32 s21, s12, 14
    s_lshl_b32 s22, s13, 10
    s_add_u32 s21, s21, s22
    s_add_u32 s21, s21, 4718592
    v_lshrrev_b32 v22, 4, v20
    v_lshl_add_u32 v21, v22, 24, v21
    v_add_u32 v63, s21, v21
    s_mov_b32 s47, 0x3e0293ee
    s_lshl_b32 s14, s12, 2
    s_add_u32 s14, s14, s3
    s_lshl_b32 s61, s14, 13
    s_add_u32 s61, s61, 2097152
    s_lshl_b32 s14, s14, 12
    s_and_b32 s22, s13, 1
    s_lshl_b32 s69, s22, 17
    s_add_u32 s69, s69, s14
    s_add_u32 s69, s69, 4194304
    s_add_u32 s52, s14, 20971520
    s_lshl_b32 s21, s22, 11
    s_add_u32 s14, s14, s21
    s_add_u32 s14, s14, 1179648
    s_lshr_b32 s21, s13, 1
    s_sub_u32 s21, s21, 0
    s_cmp_eq_u32 s21, s3
    s_cselect_b32 s15, 1, 0
    s_add_u32 s8, s21, 2
    s_and_b32 s8, s8, 3
    s_add_u32 s23, s3, 3
    s_and_b32 s23, s23, 3
    s_cmp_eq_u32 s21, s23
    s_cselect_b32 s31, 1, 0
    s_and_b32 s24, s23, 1
    s_and_b32 s25, s3, 1
    s_sub_i32 s24, s24, s25
    s_lshr_b32 s23, s23, 1
    s_lshr_b32 s25, s3, 1
    s_sub_i32 s23, s23, s25
    s_mul_i32 s46, s24, 4096
    s_mul_i32 s25, s23, 2048
    s_add_i32 s46, s46, s25
    s_mul_i32 s27, s24, 32768
    s_mul_i32 s25, s23, 1024
    s_add_i32 s27, s27, s25
    v_lshrrev_b32 v21, 4, v20
    v_and_b32 v23, 15, v20
    v_lshlrev_b32 v21, 2, v21
    v_add_u32 v24, 0, v21
    v_cmp_gt_u32 vcc, v24, v23
    s_cmp_eq_u32 s22, 0
    s_cselect_b64 s[38:39], vcc, 0
    s_cselect_b64 s[48:49], -1, vcc
    v_add_u32 v24, 1, v21
    v_cmp_gt_u32 vcc, v24, v23
    s_cmp_eq_u32 s22, 0
    s_cselect_b64 s[40:41], vcc, 0
    s_cselect_b64 s[50:51], -1, vcc
    v_add_u32 v24, 2, v21
    v_cmp_gt_u32 vcc, v24, v23
    s_cmp_eq_u32 s22, 0
    s_cselect_b64 s[42:43], vcc, 0
    s_cselect_b64 s[54:55], -1, vcc
    v_add_u32 v24, 3, v21
    v_cmp_gt_u32 vcc, v24, v23
    s_cmp_eq_u32 s22, 0
    s_cselect_b64 s[44:45], vcc, 0
    s_cselect_b64 s[56:57], -1, vcc
    s_waitcnt vmcnt(0)
    v_mov_b32 v16, v32
    v_mov_b32 v17, v33
    v_mov_b32 v18, v34
    v_mov_b32 v19, v35
    v_mov_b32 v20, v36
    v_mov_b32 v21, v37
    v_mov_b32 v22, v38
    v_mov_b32 v23, v39
    v_mov_b32 v24, v40
    v_mov_b32 v25, v41
    v_mov_b32 v26, v42
    v_mov_b32 v27, v43
    v_mov_b32 v28, v44
    v_mov_b32 v29, v45
    v_mov_b32 v30, v46
    v_mov_b32 v31, v47
    v_mov_b32 v32, -1
    v_mov_b32 v33, -1
    v_mov_b32 v34, -1
    v_mov_b32 v35, -1
    s_add_u32 s21, s37, 3997696
    buffer_store_dwordx4 v[32:35], v1, s[4:7], s21 offen sc1
    s_add_u32 s21, s37, 4063232
    buffer_store_dwordx4 v[32:35], v1, s[4:7], s21 offen sc1
    s_add_u32 s21, s37, 4128768
    buffer_store_dwordx4 v[32:35], v1, s[4:7], s21 offen sc1
    s_lshl_b32 s29, s29, 5
    s_barrier
    ds_write_b32 v14, v10
    ds_write_b32 v14, v10 offset:16
    ds_write_b32 v14, v10 offset:32
    s_lshl_b32 s53, s3, 13
    s_add_u32 s53, s53, 92160
    v_add_u32 v32, 14336, v1
    ds_write_b128 v32, v[56:59]
    s_lshl_b32 s60, s12, 4
    s_add_u32 s60, s60, 218104320
    v_mov_b32 v15, 0
    s_add_u32 s25, s16, 0
    s_min_u32 s25, s25, 63
    s_cmp_lt_u32 s25, 8
    s_cselect_b32 s59, 12, 24
    s_cselect_b32 s58, -4, -8
    s_and_b32 s25, s25, s58
    s_lshl_b32 s25, s25, 5
    s_add_u32 s58, s25, s60
    v_mov_b32 v32, 131072
    s_waitcnt vmcnt(0) lgkmcnt(0)
    s_barrier
    ds_read_b64 v[32:33], v32
    s_waitcnt lgkmcnt(0)
    v_cmp_ne_u32 vcc, s29, v32
    s_setprio 3
    v_readfirstlane_b32 s63, v33
    s_add_u32 s35, s35, s63
    s_add_u32 s34, s34, s63
    s_cbranch_vccnz ch_p_slow
    v_mov_b32 v32, 0
    v_mov_b32 v33, 0
    v_mov_b32 v34, 0
    v_mov_b32 v35, 0
    v_mov_b32 v36, 0
    v_mov_b32 v37, 0
    v_mov_b32 v38, 0
    v_mov_b32 v39, 0
    v_mov_b32 v40, 0
    v_mov_b32 v41, 0
    v_mov_b32 v42, 0
    v_mov_b32 v43, 0
    v_mov_b32 v44, 0
    v_mov_b32 v45, 0
    v_mov_b32 v46, 0
    v_mov_b32 v47, 0
    v_mov_b32 v48, 0
    v_mov_b32 v49, 0
    v_mov_b32 v50, 0
    v_mov_b32 v51, 0
    v_mov_b32 v52, 0
    v_mov_b32 v53, 0
    v_mov_b32 v54, 0
    v_mov_b32 v55, 0
    v_mov_b32 v0, 1.0
    s_mov_b32 exec_lo, 0xff00ff00
    s_mov_b32 exec_hi, 0xff00ff00
    v_mov_b32 v0, s47
    s_mov_b64 exec, -1
    v_mov_b32 v60, s16
    v_smfmac_f32_16x16x64_bf16 v[32:35], v[16:19], v[64:71], v62
    v_smfmac_f32_16x16x64_bf16 v[36:39], v[16:19], v[72:79], v62
    v_smfmac_f32_16x16x64_bf16 v[40:43], v[16:19], v[80:87], v62
    v_smfmac_f32_16x16x64_bf16 v[44:47], v[16:19], v[88:95], v62
    v_smfmac_f32_16x16x64_bf16 v[48:51], v[16:19], v[96:103], v62
    v_smfmac_f32_16x16x64_bf16 v[52:55], v[16:19], v[104:111], v62
    v_smfmac_f32_16x16x64_bf16 v[32:35], v[20:23], v[112:119], v62
    v_smfmac_f32_16x16x64_bf16 v[36:39], v[20:23], v[120:127], v62
    v_smfmac_f32_16x16x64_bf16 v[40:43], v[20:23], v[128:135], v62
    v_smfmac_f32_16x16x64_bf16 v[44:47], v[20:23], v[136:143], v62
    v_smfmac_f32_16x16x64_bf16 v[48:51], v[20:23], v[144:151], v62
    v_smfmac_f32_16x16x64_bf16 v[52:55], v[20:23], v[152:159], v62
    v_smfmac_f32_16x16x64_bf16 v[32:35], v[24:27], v[160:167], v62
    v_smfmac_f32_16x16x64_bf16 v[36:39], v[24:27], v[168:175], v62
    v_smfmac_f32_16x16x64_bf16 v[40:43], v[24:27], v[176:183], v62
    v_smfmac_f32_16x16x64_bf16 v[44:47], v[24:27], v[184:191], v62
    v_smfmac_f32_16x16x64_bf16 v[48:51], v[24:27], v[192:199], v62
    v_smfmac_f32_16x16x64_bf16 v[52:55], v[24:27], v[200:207], v62
    v_smfmac_f32_16x16x64_bf16 v[32:35], v[28:31], v[208:215], v62
    ds_write_b32 v14, v60
    v_smfmac_f32_16x16x64_bf16 v[36:39], v[28:31], v[216:223], v62
    v_smfmac_f32_16x16x64_bf16 v[40:43], v[28:31], v[224:231], v62
    v_smfmac_f32_16x16x64_bf16 v[44:47], v[28:31], v[232:239], v62
    v_add_f32 v32, v32, v33
    v_add_f32 v34, v34, v35
    v_smfmac_f32_16x16x64_bf16 v[48:51], v[28:31], v[240:247], v62
    v_add_f32 v36, v36, v37
    v_add_f32 v38, v38, v39
    ds_write2_b32 v4, v32, v34 offset0:0 offset1:104
    v_smfmac_f32_16x16x64_bf16 v[52:55], v[28:31], v[248:255], v62
    v_add_f32 v40, v40, v41
    v_add_f32 v42, v42, v43
    ds_write2_b32 v4, v36, v38 offset0:16 offset1:120
    v_add_f32 v44, v44, v45
    v_add_f32 v46, v46, v47
    ds_write2_b32 v4, v40, v42 offset0:32 offset1:136
    v_add_f32 v48, v48, v49
    v_add_f32 v50, v50, v51
    ds_write2_b32 v4, v44, v46 offset0:48 offset1:152
    v_add_f32 v52, v52, v53
    v_add_f32 v54, v54, v55
    ds_write2_b32 v4, v48, v50 offset0:64 offset1:168
    ds_write2_b32 v4, v52, v54 offset0:80 offset1:184
    s_waitcnt vmcnt(0)
    s_branch pnc_7_done
.p2align 6
    s_nop 0
    s_nop 0
    s_nop 0
    s_nop 0
    s_nop 0
    s_nop 0
    s_nop 0
    s_nop 0
ploop_6:
    s_add_u32 s21, s17, s33
    s_nop 15
    s_nop 5
    buffer_load_dwordx4 v[16:19], v1, s[4:7], s21 offen offset:0 sc1
    s_nop 7
    buffer_load_dwordx4 v[20:23], v1, s[4:7], s21 offen offset:1024 sc1
    s_nop 7
    buffer_load_dwordx4 v[24:27], v1, s[4:7], s21 offen offset:2048 sc1
    s_nop 7
    buffer_load_dwordx4 v[28:31], v1, s[4:7], s21 offen offset:3072 sc1
    s_waitcnt vmcnt(3)
    v_max3_u32 v9, v16, v17, v18
    v_max_u32 v9, v9, v19
    v_cmp_eq_u32 vcc, -1, v9
    s_cbranch_vccnz prm_9_0
prm_9_0ok:
    v_smfmac_f32_16x16x64_bf16 v[32:35], v[16:19], v[64:71], v62
    v_smfmac_f32_16x16x64_bf16 v[36:39], v[16:19], v[72:79], v62
    v_smfmac_f32_16x16x64_bf16 v[40:43], v[16:19], v[80:87], v62
    s_waitcnt vmcnt(2)
    v_max3_u32 v9, v20, v21, v22
    v_max_u32 v9, v9, v23
    v_cmp_eq_u32 vcc, -1, v9
    v_smfmac_f32_16x16x64_bf16 v[44:47], v[16:19], v[88:95], v62
    v_smfmac_f32_16x16x64_bf16 v[48:51], v[16:19], v[96:103], v62
    v_smfmac_f32_16x16x64_bf16 v[52:55], v[16:19], v[104:111], v62
    s_cbranch_vccnz prm_9_1
prm_9_1ok:
    v_smfmac_f32_16x16x64_bf16 v[32:35], v[20:23], v[112:119], v62
    v_readfirstlane_b32 s23, v15
    v_smfmac_f32_16x16x64_bf16 v[36:39], v[20:23], v[120:127], v62
    v_smfmac_f32_16x16x64_bf16 v[40:43], v[20:23], v[128:135], v62
    s_waitcnt vmcnt(1)
    v_max3_u32 v9, v24, v25, v26
    v_max_u32 v9, v9, v27
    v_cmp_eq_u32 vcc, -1, v9
    v_smfmac_f32_16x16x64_bf16 v[44:47], v[20:23], v[136:143], v62
    v_smfmac_f32_16x16x64_bf16 v[48:51], v[20:23], v[144:151], v62
    v_smfmac_f32_16x16x64_bf16 v[52:55], v[20:23], v[152:159], v62
    s_cbranch_vccnz prm_9_2
prm_9_2ok:
    v_smfmac_f32_16x16x64_bf16 v[32:35], v[24:27], v[160:167], v62
    v_smfmac_f32_16x16x64_bf16 v[36:39], v[24:27], v[168:175], v62
    v_smfmac_f32_16x16x64_bf16 v[40:43], v[24:27], v[176:183], v62
    s_waitcnt vmcnt(0)
    v_max3_u32 v9, v28, v29, v30
    v_max_u32 v9, v9, v31
    v_cmp_eq_u32 vcc, -1, v9
    v_smfmac_f32_16x16x64_bf16 v[44:47], v[24:27], v[184:191], v62
    v_smfmac_f32_16x16x64_bf16 v[48:51], v[24:27], v[192:199], v62
    v_smfmac_f32_16x16x64_bf16 v[52:55], v[24:27], v[200:207], v62
    s_cbranch_vccnz prm_9_3
prm_9_3ok:
    v_smfmac_f32_16x16x64_bf16 v[32:35], v[28:31], v[208:215], v62
    s_cmp_lt_u32 s23, s59
    s_cbranch_scc1 prm_9_gt
prm_9_gtb:
    ds_write_b32 v14, v60
    v_smfmac_f32_16x16x64_bf16 v[36:39], v[28:31], v[216:223], v62
    v_smfmac_f32_16x16x64_bf16 v[40:43], v[28:31], v[224:231], v62
    v_smfmac_f32_16x16x64_bf16 v[44:47], v[28:31], v[232:239], v62
    v_add_f32 v32, v32, v33
    v_add_f32 v34, v34, v35
    v_smfmac_f32_16x16x64_bf16 v[48:51], v[28:31], v[240:247], v62
    v_add_f32 v36, v36, v37
    v_add_f32 v38, v38, v39
    ds_write2_b32 v4, v32, v34 offset0:0 offset1:104
    v_smfmac_f32_16x16x64_bf16 v[52:55], v[28:31], v[248:255], v62
    v_add_f32 v40, v40, v41
    v_add_f32 v42, v42, v43
    ds_write2_b32 v4, v36, v38 offset0:16 offset1:120
    v_add_f32 v44, v44, v45
    v_add_f32 v46, v46, v47
    ds_write2_b32 v4, v40, v42 offset0:32 offset1:136
    v_add_f32 v48, v48, v49
    v_add_f32 v50, v50, v51
    ds_write2_b32 v4, v44, v46 offset0:48 offset1:152
    v_add_f32 v52, v52, v53
    v_add_f32 v54, v54, v55
    ds_write2_b32 v4, v48, v50 offset0:64 offset1:168
    ds_write2_b32 v4, v52, v54 offset0:80 offset1:184
pnc_7_done:
    s_add_u32 s21, s17, s32
    s_add_u32 s22, s19, s32
    s_add_u32 s24, s19, s35
    s_waitcnt lgkmcnt(0)
    s_barrier
    ds_read_b64 v[32:33], v5 offset:0
    ds_read_b64 v[34:35], v5 offset:3328
    ds_read_b64 v[36:37], v5 offset:6656
    ds_read_b64 v[38:39], v5 offset:9984
    ds_read_b64 v[40:41], v6 offset:0
    ds_read_b64 v[42:43], v6 offset:3328
    ds_read_b64 v[44:45], v6 offset:6656
    ds_read_b64 v[46:47], v6 offset:9984
    s_waitcnt lgkmcnt(6)
    v_add_f32 v32, v32, v34
    v_add_f32 v33, v33, v35
    v_mul_f32 v32, v32, v0
    v_mul_f32 v33, v33, v0
    s_waitcnt lgkmcnt(4)
    v_add_f32 v36, v36, v38
    v_add_f32 v37, v37, v39
    v_fma_f32 v32, v36, v0, v32
    v_fma_f32 v33, v37, v0, v33
    v_cvt_pk_bf16_f32 v32, v32, v33
    v_min_u32 v32, -2, v32
    buffer_store_dword v32, v2, s[4:7], s21 offen
    s_waitcnt lgkmcnt(2)
    v_add_f32 v40, v40, v42
    v_add_f32 v41, v41, v43
    s_waitcnt lgkmcnt(0)
    v_add_f32 v44, v44, v46
    v_add_f32 v45, v45, v47
    v_add_f32 v40, v40, v44
    v_add_f32 v41, v41, v45
    v_cvt_pk_bf16_f32 v40, v40, v41
    v_min_u32 v40, -2, v40
    s_mov_b32 exec_hi, 0
    buffer_store_dword v40, v3, s[4:7], s21 offen
    s_setprio 0
    s_mov_b64 exec, -1
    s_add_u32 s21, s17, s35
    s_add_u32 s30, s17, s34
    s_add_u32 s23, s18, s36
    s_cmp_lg_u32 s16, 0
    s_cbranch_scc1 ploop_6_n0
gate_11:
    v_readfirstlane_b32 s25, v15
    s_cmp_ge_u32 s25, s59
    s_cbranch_scc1 gate_11_ok
    s_sleep 8
    buffer_load_dword v15, off, s[4:7], s58 sc1
    s_waitcnt vmcnt(0)
    s_sub_u32 s26, s26, 1
    s_cbranch_scc0 gate_11
    s_mov_b32 s26, 0
gate_11_ok:
    s_cmp_eq_u32 s15, 0
    s_cbranch_scc1 ploop_6_st_nk
    s_add_u32 m0, s53, 0
    s_add_u32 s22, s52, 0
    buffer_load_dwordx4 v1, s[4:7], s22 offen offset:0 sc1 lds
    buffer_load_dwordx4 v1, s[4:7], s22 offen offset:1024 sc1 lds
    buffer_load_dwordx4 v1, s[4:7], s22 offen offset:2048 sc1 lds
    buffer_load_dwordx4 v1, s[4:7], s22 offen offset:3072 sc1 lds
    s_add_u32 m0, s53, 4096
    s_add_u32 s22, s52, 131072
    buffer_load_dwordx4 v1, s[4:7], s22 offen offset:0 sc1 lds
    buffer_load_dwordx4 v1, s[4:7], s22 offen offset:1024 sc1 lds
    buffer_load_dwordx4 v1, s[4:7], s22 offen offset:2048 sc1 lds
    buffer_load_dwordx4 v1, s[4:7], s22 offen offset:3072 sc1 lds
    s_add_u32 s52, s52, 262144
    s_sub_u32 s52, s52, 262144
ploop_6_st_nk:
    s_add_u32 s52, s52, 262144
    s_cmp_lg_u32 s3, 2
    s_cbranch_scc1 ploop_6_st_npf
    v_subrev_u32 v32, 524288, v63
    s_mov_b32 exec_hi, 0xffff
    s_mov_b32 s22, 262144
    buffer_load_dword v33, v32, s[4:7], s22 offen sc1
    s_mov_b32 exec_hi, -1
    s_waitcnt vmcnt(0)
ploop_6_st_npf:
    s_cmp_eq_u32 s15, 0
    s_cbranch_scc1 ploop_6_st_p_nd
    s_mov_b32 m0, 124928
    s_nop 0
    buffer_load_dwordx4 v1, s[4:7], s69 offen offset:0 sc1 lds
    buffer_load_dwordx4 v1, s[4:7], s69 offen offset:1024 sc1 lds
    buffer_load_dwordx4 v1, s[4:7], s69 offen offset:2048 sc1 lds
    buffer_load_dwordx4 v1, s[4:7], s69 offen offset:3072 sc1 lds
    s_add_u32 s69, s69, 262144
    s_waitcnt vmcnt(0)
ploop_6_st_p_nd:
ploop_6_n0:
    s_add_u32 s25, s16, 2
    s_min_u32 s25, s25, 63
    s_cmp_lt_u32 s25, 8
    s_cselect_b32 s59, 12, 24
    s_cselect_b32 s58, -4, -8
    s_and_b32 s25, s25, s58
    s_lshl_b32 s25, s25, 5
    s_add_u32 s58, s25, s60
    s_cmp_eq_u32 s15, 0
    s_cbranch_scc1 ploop_6_nd
    v_add_u32 v9, s53, v1
    v_add_u32 v0, 124928, v1
    ds_read_b128 v[16:19], v0 offset:0
    ds_read_b128 v[32:35], v9 offset:0
    ds_read_b128 v[20:23], v0 offset:1024
    ds_read_b128 v[36:39], v9 offset:1024
    ds_read_b128 v[24:27], v0 offset:2048
    ds_read_b128 v[40:43], v9 offset:2048
    ds_read_b128 v[28:31], v0 offset:3072
    ds_read_b128 v[44:47], v9 offset:3072
    s_add_u32 s22, s17, s61
    s_waitcnt lgkmcnt(6)
    v_mfma_f32_16x16x32_bf16 v[48:51], v[32:35], v[16:19], 0
    ds_read_b128 v[32:35], v9 offset:4096
    s_waitcnt lgkmcnt(5)
    v_mfma_f32_16x16x32_bf16 v[48:51], v[36:39], v[20:23], v[48:51]
    ds_read_b128 v[36:39], v9 offset:5120
    s_waitcnt lgkmcnt(4)
    v_mfma_f32_16x16x32_bf16 v[48:51], v[40:43], v[24:27], v[48:51]
    ds_read_b128 v[40:43], v9 offset:6144
    s_waitcnt lgkmcnt(3)
    v_mfma_f32_16x16x32_bf16 v[48:51], v[44:47], v[28:31], v[48:51]
    ds_read_b128 v[44:47], v9 offset:7168
    s_waitcnt lgkmcnt(3)
    v_mfma_f32_16x16x32_bf16 v[52:55], v[32:35], v[16:19], 0
    s_waitcnt lgkmcnt(2)
    v_mfma_f32_16x16x32_bf16 v[52:55], v[36:39], v[20:23], v[52:55]
    s_waitcnt lgkmcnt(1)
    v_mfma_f32_16x16x32_bf16 v[52:55], v[40:43], v[24:27], v[52:55]
    s_waitcnt lgkmcnt(0)
    v_mfma_f32_16x16x32_bf16 v[52:55], v[44:47], v[28:31], v[52:55]
    buffer_load_dwordx4 v[32:35], v1, s[4:7], s22 offen offset:0 sc1
    buffer_load_dwordx4 v[36:39], v1, s[4:7], s22 offen offset:1024 sc1
    buffer_load_dwordx4 v[40:43], v1, s[4:7], s22 offen offset:2048 sc1
    buffer_load_dwordx4 v[44:47], v1, s[4:7], s22 offen offset:3072 sc1
    v_mov_b32 v60, 0xff61b1e6
    s_nop 2
    v_cndmask_b32 v48, v48, v60, s[38:39]
    v_cndmask_b32 v49, v49, v60, s[40:41]
    v_cndmask_b32 v50, v50, v60, s[42:43]
    v_cndmask_b32 v51, v51, v60, s[44:45]
    v_cndmask_b32 v52, v52, v60, s[48:49]
    v_cndmask_b32 v53, v53, v60, s[50:51]
    v_cndmask_b32 v54, v54, v60, s[54:55]
    v_cndmask_b32 v55, v55, v60, s[56:57]
    v_max3_f32 v0, v48, v49, v50
    v_max3_f32 v9, v51, v52, v53
    v_max3_f32 v0, v0, v54, v55
    v_max_f32 v0, v0, v9
    v_mov_b32 v9, v0
    s_nop 1
    v_permlane16_swap_b32 v9, v0
    v_max_f32 v0, v0, v9
    v_mov_b32 v9, v0
    s_nop 1
    v_permlane32_swap_b32 v9, v0
    v_max_f32 v0, v0, v9
    v_mul_f32 v0, s47, v0
    v_fma_f32 v48, v48, s47, -v0
    v_fma_f32 v49, v49, s47, -v0
    v_fma_f32 v50, v50, s47, -v0
    v_fma_f32 v51, v51, s47, -v0
    v_fma_f32 v52, v52, s47, -v0
    v_fma_f32 v53, v53, s47, -v0
    v_fma_f32 v54, v54, s47, -v0
    v_fma_f32 v55, v55, s47, -v0
    v_exp_f32 v48, v48
    v_exp_f32 v49, v49
    v_exp_f32 v50, v50
    v_exp_f32 v51, v51
    v_exp_f32 v52, v52
    v_exp_f32 v53, v53
    v_exp_f32 v54, v54
    v_exp_f32 v55, v55
    v_add_f32 v15, v48, v49
    v_add_f32 v15, v15, v50
    v_add_f32 v15, v15, v51
    v_add_f32 v15, v15, v52
    v_add_f32 v15, v15, v53
    v_add_f32 v15, v15, v54
    v_add_f32 v15, v15, v55
ploop_6_za:
    s_waitcnt vmcnt(0)
    v_max3_u32 v9, v32, v33, v34
    v_max3_u32 v9, v9, v35, v36
    v_max3_u32 v9, v9, v37, v38
    v_max3_u32 v9, v9, v39, v40
    v_max3_u32 v9, v9, v41, v42
    v_max3_u32 v9, v9, v43, v44
    v_max3_u32 v9, v9, v45, v46
    v_max_u32 v9, v9, v47
    v_cmp_eq_u32 vcc, -1, v9
    s_cbranch_vccnz ploop_6_zr
ploop_6_zok:
    s_setprio 1
    v_mfma_f32_16x16x32_bf16 v[56:59], v[32:35], v[16:19], 0
    v_mfma_f32_16x16x32_bf16 v[56:59], v[36:39], v[20:23], v[56:59]
    v_mfma_f32_16x16x32_bf16 v[56:59], v[40:43], v[24:27], v[56:59]
    v_mfma_f32_16x16x32_bf16 v[56:59], v[44:47], v[28:31], v[56:59]
    s_add_u32 s22, s17, s14
    s_nop 6
    v_max_f32 v60, v56, v57
    v_mov_b32 v9, v60
    s_nop 1
    v_permlane16_swap_b32 v9, v60
    v_max_f32 v60, v60, v9
    v_mov_b32 v9, v60
    s_nop 1
    v_permlane32_swap_b32 v9, v60
    v_max_f32 v60, v60, v9
    v_mul_f32 v60, s47, v60
    v_max_f32 v58, v60, v0
    v_sub_f32 v60, v0, v58
    v_fma_f32 v56, v56, s47, -v58
    v_fma_f32 v57, v57, s47, -v58
    v_exp_f32 v60, v60
    v_exp_f32 v56, v56
    v_exp_f32 v57, v57
    v_fma_f32 v15, v15, v60, v56
    v_add_f32 v15, v15, v57
    v_mov_b32 v9, v15
    s_nop 1
    v_permlane16_swap_b32 v9, v15
    v_add_f32 v15, v15, v9
    v_mov_b32 v9, v15
    s_nop 1
    v_permlane32_swap_b32 v9, v15
    v_add_f32 v15, v15, v9
    v_rcp_f32 v15, v15
    s_add_u32 s25, s19, s14
    v_mul_f32 v56, v56, v15
    v_mul_f32 v57, v57, v15
    v_mul_f32 v60, v60, v15
    v_mul_f32 v48, v48, v60
    v_mul_f32 v49, v49, v60
    v_mul_f32 v50, v50, v60
    v_mul_f32 v51, v51, v60
    v_mul_f32 v52, v52, v60
    v_mul_f32 v53, v53, v60
    v_mul_f32 v54, v54, v60
    v_mul_f32 v55, v55, v60
    v_cvt_pk_bf16_f32 v48, v48, v49
    v_cvt_pk_bf16_f32 v49, v50, v51
    v_cvt_pk_bf16_f32 v50, v52, v53
    v_cvt_pk_bf16_f32 v51, v54, v55
    v_min_u32 v48, -2, v48
    v_min_u32 v49, -2, v49
    v_min_u32 v50, -2, v50
    v_min_u32 v51, -2, v51
    v_lshlrev_b32 v54, 1, v8
    v_add_u32 v55, 14336, v1
    v_mov_b32 v53, 1.0
    v_cvt_pk_bf16_f32 v52, v56, v57
    v_min_u32 v53, -2, v53
    v_min_u32 v52, -2, v52
    buffer_store_dwordx4 v[48:51], v1, s[4:7], s22 offen
    buffer_store_dwordx2 v[52:53], v54, s[4:7], s22 offen offset:1024
    ds_read_b128 v[56:59], v55
    s_branch ploop_6_nd2
ploop_6_nd:
    s_cmp_eq_u32 s16, 0
    s_cbranch_scc1 ploop_6_ns
    s_cmp_eq_u32 s31, 0
    s_cbranch_scc1 ploop_6_n2
    s_add_u32 s25, s68, s46
    v_add_u32 v55, s25, v61
    ds_read_b128 v[24:27], v55 offset:0
    ds_read_b128 v[28:31], v55 offset:1024
    ds_read_b128 v[32:35], v55 offset:18560
    ds_read_b128 v[36:39], v55 offset:19584
    ds_read_b128 v[40:43], v55 offset:37120
    ds_read_b128 v[44:47], v55 offset:38144
    ds_read_b128 v[48:51], v55 offset:55680
    ds_read_b128 v[52:55], v55 offset:56704
    s_waitcnt lgkmcnt(4)
    v_add_f32 v24, v24, v32
    v_add_f32 v25, v25, v33
    v_add_f32 v26, v26, v34
    v_add_f32 v27, v27, v35
    v_add_f32 v28, v28, v36
    v_add_f32 v29, v29, v37
    v_add_f32 v30, v30, v38
    v_add_f32 v31, v31, v39
    s_waitcnt lgkmcnt(0)
    v_add_f32 v40, v40, v48
    v_add_f32 v41, v41, v49
    v_add_f32 v42, v42, v50
    v_add_f32 v43, v43, v51
    v_add_f32 v44, v44, v52
    v_add_f32 v45, v45, v53
    v_add_f32 v46, v46, v54
    v_add_f32 v47, v47, v55
    v_add_f32 v24, v24, v40
    v_add_f32 v25, v25, v41
    v_add_f32 v26, v26, v42
    v_add_f32 v27, v27, v43
    v_add_f32 v28, v28, v44
    v_add_f32 v29, v29, v45
    v_add_f32 v30, v30, v46
    v_add_f32 v31, v31, v47
    v_cvt_pk_bf16_f32 v24, v24, v25
    v_cvt_pk_bf16_f32 v25, v26, v27
    v_cvt_pk_bf16_f32 v26, v28, v29
    v_cvt_pk_bf16_f32 v27, v30, v31
    v_min_u32 v24, -2, v24
    v_min_u32 v25, -2, v25
    v_min_u32 v26, -2, v26
    v_min_u32 v27, -2, v27
    v_mov_b32 v16, v24
    v_mov_b32 v17, v25
    v_mov_b32 v18, v26
    v_mov_b32 v19, v27
ploop_6_n2:
    v_add_u32 v55, s68, v61
    ds_read_b128 v[24:27], v55 offset:0
    ds_read_b128 v[28:31], v55 offset:1024
    ds_read_b128 v[32:35], v55 offset:18560
    ds_read_b128 v[36:39], v55 offset:19584
    ds_read_b128 v[40:43], v55 offset:37120
    ds_read_b128 v[44:47], v55 offset:38144
    ds_read_b128 v[48:51], v55 offset:55680
    ds_read_b128 v[52:55], v55 offset:56704
    s_waitcnt lgkmcnt(4)
    v_add_f32 v24, v24, v32
    v_add_f32 v25, v25, v33
    v_add_f32 v26, v26, v34
    v_add_f32 v27, v27, v35
    v_add_f32 v28, v28, v36
    v_add_f32 v29, v29, v37
    v_add_f32 v30, v30, v38
    v_add_f32 v31, v31, v39
    s_waitcnt lgkmcnt(0)
    v_add_f32 v40, v40, v48
    v_add_f32 v41, v41, v49
    v_add_f32 v42, v42, v50
    v_add_f32 v43, v43, v51
    v_add_f32 v44, v44, v52
    v_add_f32 v45, v45, v53
    v_add_f32 v46, v46, v54
    v_add_f32 v47, v47, v55
    v_add_f32 v24, v24, v40
    v_add_f32 v25, v25, v41
    v_add_f32 v26, v26, v42
    v_add_f32 v27, v27, v43
    v_add_f32 v28, v28, v44
    v_add_f32 v29, v29, v45
    v_add_f32 v30, v30, v46
    v_add_f32 v31, v31, v47
    v_cvt_pk_bf16_f32 v24, v24, v25
    v_cvt_pk_bf16_f32 v25, v26, v27
    v_cvt_pk_bf16_f32 v26, v28, v29
    v_cvt_pk_bf16_f32 v27, v30, v31
    v_min_u32 v24, -2, v24
    v_min_u32 v25, -2, v25
    v_min_u32 v26, -2, v26
    v_min_u32 v27, -2, v27
ploop_6_ns:
ploop_6_flag:
    ds_read_b32 v9, v14 offset:16
    s_waitcnt lgkmcnt(0)
    v_readfirstlane_b32 s25, v9
    s_cmp_eq_u32 s25, s16
    s_cbranch_scc0 ploop_6_flag
    s_add_u32 m0, s53, 0
    s_add_u32 s22, s52, 0
    buffer_load_dwordx4 v1, s[4:7], s22 offen offset:0 sc1 lds
    buffer_load_dwordx4 v1, s[4:7], s22 offen offset:1024 sc1 lds
    buffer_load_dwordx4 v1, s[4:7], s22 offen offset:2048 sc1 lds
    buffer_load_dwordx4 v1, s[4:7], s22 offen offset:3072 sc1 lds
    s_add_u32 m0, s53, 4096
    s_add_u32 s22, s52, 131072
    buffer_load_dwordx4 v1, s[4:7], s22 offen offset:0 sc1 lds
    buffer_load_dwordx4 v1, s[4:7], s22 offen offset:1024 sc1 lds
    buffer_load_dwordx4 v1, s[4:7], s22 offen offset:2048 sc1 lds
    buffer_load_dwordx4 v1, s[4:7], s22 offen offset:3072 sc1 lds
    s_add_u32 s52, s52, 262144
ploop_6_nk:
    s_cmp_eq_u32 s16, 0
    s_cbranch_scc1 ploop_6_nd2
    buffer_store_dwordx4 v[24:27], v1, s[4:7], s37 offen sc1
    s_cmp_eq_u32 s31, 0
    s_cbranch_scc1 ploop_6_nd2
    s_add_u32 s25, s37, s27
    buffer_store_dwordx4 v[16:19], v1, s[4:7], s25 offen sc1
ploop_6_nd2:
    s_cmp_eq_u32 s16, 0
    s_cbranch_scc1 ploop_6_nn
    s_add_u32 s37, s37, 65536
    s_xor_b32 s68, s68, 8192
ploop_6_nn:
    s_cmp_lg_u32 s3, s8
    s_cbranch_scc1 ppf_12
    s_lshl_b32 s22, s16, 18
    s_mov_b32 exec_hi, 0xffff
    buffer_load_dword v9, v63, s[4:7], s22 offen sc1
    s_mov_b32 exec_hi, -1
ppf_12:
    v_add_u32 v24, 18560, v7
    v_add_u32 v25, 37120, v7
    v_add_u32 v26, 55680, v7
    s_cmp_eq_u32 s16, 63
    s_setprio 3
    s_barrier
    s_cbranch_scc1 ptail_8
    ds_read2_b32 v[16:17], v7 offset0:0 offset1:2
    ds_read2_b32 v[18:19], v24 offset0:0 offset1:2
    ds_read2_b32 v[20:21], v25 offset0:0 offset1:2
    ds_read2_b32 v[22:23], v26 offset0:0 offset1:2
    s_waitcnt lgkmcnt(2)
    v_add_f32 v16, v16, v18
    v_add_f32 v17, v17, v19
    s_waitcnt lgkmcnt(0)
    v_add_f32 v20, v20, v22
    v_add_f32 v21, v21, v23
    v_add_f32 v16, v16, v20
    v_add_f32 v17, v17, v21
    v_cvt_pk_bf16_f32 v16, v16, v17
    v_min_u32 v16, -2, v16
    buffer_store_dword v16, v2, s[4:7], s21 offen sc1
    buffer_store_dword v10, v2, s[4:7], s24 offen sc1
    s_cmp_eq_u32 s15, 0
    s_cbranch_scc1 ploop_6_pnd
    s_sleep 6
    s_nop 8
    buffer_load_dwordx4 v[16:19], v12, s[4:7], s30 offen sc1
    buffer_load_dword v15, off, s[4:7], s58 sc1
    s_add_u32 s25, s19, s14
    v_mov_b32 v20, -1
    v_mov_b32 v21, -1
    v_mov_b32 v22, -1
    v_mov_b32 v23, -1
    buffer_store_dwordx4 v[20:23], v1, s[4:7], s25 offen
    buffer_store_dwordx2 v[20:21], v54, s[4:7], s25 offen offset:1024
    s_mov_b32 m0, 124928
    s_nop 0
    buffer_load_dwordx4 v1, s[4:7], s69 offen offset:0 sc1 lds
    buffer_load_dwordx4 v1, s[4:7], s69 offen offset:1024 sc1 lds
    buffer_load_dwordx4 v1, s[4:7], s69 offen offset:2048 sc1 lds
    buffer_load_dwordx4 v1, s[4:7], s69 offen offset:3072 sc1 lds
    s_add_u32 s69, s69, 262144
    s_add_u32 m0, s53, 0
    s_add_u32 s22, s52, 0
    buffer_load_dwordx4 v1, s[4:7], s22 offen offset:0 sc1 lds
    buffer_load_dwordx4 v1, s[4:7], s22 offen offset:1024 sc1 lds
    buffer_load_dwordx4 v1, s[4:7], s22 offen offset:2048 sc1 lds
    buffer_load_dwordx4 v1, s[4:7], s22 offen offset:3072 sc1 lds
    s_add_u32 m0, s53, 4096
    s_add_u32 s22, s52, 131072
    buffer_load_dwordx4 v1, s[4:7], s22 offen offset:0 sc1 lds
    buffer_load_dwordx4 v1, s[4:7], s22 offen offset:1024 sc1 lds
    buffer_load_dwordx4 v1, s[4:7], s22 offen offset:2048 sc1 lds
    buffer_load_dwordx4 v1, s[4:7], s22 offen offset:3072 sc1 lds
    s_add_u32 s52, s52, 262144
    s_add_u32 s22, s16, 1
    v_mov_b32 v60, s22
    v_mov_b32 v32, 0
    v_mov_b32 v33, 0
    v_mov_b32 v34, 0
    v_mov_b32 v35, 0
    v_mov_b32 v36, 0
    v_mov_b32 v37, 0
    v_mov_b32 v38, 0
    v_mov_b32 v39, 0
    v_mov_b32 v40, 0
    v_mov_b32 v41, 0
    v_mov_b32 v42, 0
    v_mov_b32 v43, 0
    v_mov_b32 v44, 0
    v_mov_b32 v45, 0
    v_mov_b32 v46, 0
    v_mov_b32 v47, 0
    v_mov_b32 v48, 0
    v_mov_b32 v49, 0
    v_mov_b32 v50, 0
    v_mov_b32 v51, 0
    v_mov_b32 v52, 0
    v_mov_b32 v53, 0
    v_mov_b32 v54, 0
    v_mov_b32 v55, 0
    v_mov_b32 v0, 1.0
    s_mov_b32 exec_lo, 0xff00ff00
    s_mov_b32 exec_hi, 0xff00ff00
    v_mov_b32 v0, s47
    s_mov_b64 exec, -1
    s_waitcnt vmcnt(15) lgkmcnt(0)
    v_mfma_f32_16x16x32_bf16 v[20:23], v[56:59], v[16:19], 0
    v_max3_u32 v9, v16, v17, v18
    v_max_u32 v9, v9, v19
    v_cmp_eq_u32 vcc, -1, v9
    s_cbranch_vccnz prp_10
    s_nop 3
    v_add_f32_dpp v20, v20, v20 row_ror:8 row_mask:0xf bank_mask:0xf
    v_add_f32_dpp v21, v21, v21 row_ror:8 row_mask:0xf bank_mask:0xf
    v_add_f32_dpp v22, v22, v22 row_ror:8 row_mask:0xf bank_mask:0xf
    v_add_f32_dpp v23, v23, v23 row_ror:8 row_mask:0xf bank_mask:0xf
    v_cvt_pk_bf16_f32 v20, v20, v21
    v_cvt_pk_bf16_f32 v21, v22, v23
    s_mov_b32 exec_hi, 0
    v_min_u32 v20, -2, v20
    v_min_u32 v21, -2, v21
    s_mov_b32 exec_lo, 0x00ff00ff
    buffer_store_dwordx2 v[20:21], v13, s[4:7], s23 offen
    s_mov_b64 exec, -1
    s_branch ploop_6_pst
ploop_6_pnd:
    s_sleep 6
    s_nop 8
    buffer_load_dwordx4 v[16:19], v12, s[4:7], s30 offen sc1
    buffer_load_dword v15, off, s[4:7], s58 sc1
    s_add_u32 s22, s16, 1
    v_mov_b32 v60, s22
    v_mov_b32 v32, 0
    v_mov_b32 v33, 0
    v_mov_b32 v34, 0
    v_mov_b32 v35, 0
    v_mov_b32 v36, 0
    v_mov_b32 v37, 0
    v_mov_b32 v38, 0
    v_mov_b32 v39, 0
    v_mov_b32 v40, 0
    v_mov_b32 v41, 0
    v_mov_b32 v42, 0
    v_mov_b32 v43, 0
    v_mov_b32 v44, 0
    v_mov_b32 v45, 0
    v_mov_b32 v46, 0
    v_mov_b32 v47, 0
    v_mov_b32 v48, 0
    v_mov_b32 v49, 0
    v_mov_b32 v50, 0
    v_mov_b32 v51, 0
    v_mov_b32 v52, 0
    v_mov_b32 v53, 0
    v_mov_b32 v54, 0
    v_mov_b32 v55, 0
    v_mov_b32 v0, 1.0
    s_mov_b32 exec_lo, 0xff00ff00
    s_mov_b32 exec_hi, 0xff00ff00
    v_mov_b32 v0, s47
    s_mov_b64 exec, -1
ploop_6_pagain:
    s_waitcnt vmcnt(1) lgkmcnt(0)
    v_mfma_f32_16x16x32_bf16 v[20:23], v[56:59], v[16:19], 0
    v_max3_u32 v9, v16, v17, v18
    v_max_u32 v9, v9, v19
    v_cmp_eq_u32 vcc, -1, v9
    s_cbranch_vccnz prp_10
ploop_6_pgo:
    s_nop 3
    v_add_f32_dpp v20, v20, v20 row_ror:8 row_mask:0xf bank_mask:0xf
    v_add_f32_dpp v21, v21, v21 row_ror:8 row_mask:0xf bank_mask:0xf
    v_add_f32_dpp v22, v22, v22 row_ror:8 row_mask:0xf bank_mask:0xf
    v_add_f32_dpp v23, v23, v23 row_ror:8 row_mask:0xf bank_mask:0xf
    v_cvt_pk_bf16_f32 v20, v20, v21
    v_cvt_pk_bf16_f32 v21, v22, v23
    s_mov_b32 exec_hi, 0
    v_min_u32 v20, -2, v20
    v_min_u32 v21, -2, v21
    s_mov_b32 exec_lo, 0x00ff00ff
    buffer_store_dwordx2 v[20:21], v13, s[4:7], s23 offen
    s_mov_b64 exec, -1
ploop_6_pst:
    s_add_u32 s22, s19, s32
    s_add_u32 s25, s20, s36
    buffer_store_dword v10, v2, s[4:7], s22 offen
    s_mov_b32 exec_hi, 0
    buffer_store_dword v10, v3, s[4:7], s22 offen
    s_mov_b32 exec_lo, 0x00ff00ff
    buffer_store_dwordx2 v[10:11], v13, s[4:7], s25 offen
    s_mov_b64 exec, -1
    s_add_u32 s16, s16, 1
    s_mov_b32 s17, s18
    s_mov_b32 s18, s19
    s_mov_b32 s19, s20
    s_add_u32 s20, s20, 262144
    s_cmp_eq_u32 s20, 210763776
    s_cselect_b32 s20, 209715200, s20
    s_branch ploop_6
prm_9_gt:
gate_13:
    v_readfirstlane_b32 s25, v15
    s_cmp_ge_u32 s25, s59
    s_cbranch_scc1 gate_13_ok
    s_sleep 8
    buffer_load_dword v15, off, s[4:7], s58 sc1
    s_waitcnt vmcnt(0)
    s_sub_u32 s26, s26, 1
    s_cbranch_scc0 gate_13
    s_mov_b32 s26, 0
gate_13_ok:
    s_branch prm_9_gtb
prm_9_0:
    s_sub_u32 s26, s26, 1
    s_cbranch_scc1 prm_9_0_g
    buffer_load_dwordx4 v[16:19], v1, s[4:7], s21 offen offset:0 sc1
    buffer_load_dwordx4 v[20:23], v1, s[4:7], s21 offen offset:1024 sc1
    buffer_load_dwordx4 v[24:27], v1, s[4:7], s21 offen offset:2048 sc1
    buffer_load_dwordx4 v[28:31], v1, s[4:7], s21 offen offset:3072 sc1
    s_waitcnt vmcnt(3)
    v_max3_u32 v9, v16, v17, v18
    v_max_u32 v9, v9, v19
    v_cmp_eq_u32 vcc, -1, v9
    s_cbranch_vccnz prm_9_0
    s_branch prm_9_0ok
prm_9_0_g:
    s_mov_b32 s26, 0
    s_waitcnt vmcnt(0)
    s_branch prm_9_0ok
prm_9_1:
    s_sub_u32 s26, s26, 1
    s_cbranch_scc1 prm_9_1_g
    buffer_load_dwordx4 v[20:23], v1, s[4:7], s21 offen offset:1024 sc1
    buffer_load_dwordx4 v[24:27], v1, s[4:7], s21 offen offset:2048 sc1
    buffer_load_dwordx4 v[28:31], v1, s[4:7], s21 offen offset:3072 sc1
    s_waitcnt vmcnt(2)
    v_max3_u32 v9, v20, v21, v22
    v_max_u32 v9, v9, v23
    v_cmp_eq_u32 vcc, -1, v9
    s_cbranch_vccnz prm_9_1
    s_branch prm_9_1ok
prm_9_1_g:
    s_mov_b32 s26, 0
    s_waitcnt vmcnt(0)
    s_branch prm_9_1ok
prm_9_2:
    s_sub_u32 s26, s26, 1
    s_cbranch_scc1 prm_9_2_g
    buffer_load_dwordx4 v[24:27], v1, s[4:7], s21 offen offset:2048 sc1
    buffer_load_dwordx4 v[28:31], v1, s[4:7], s21 offen offset:3072 sc1
    s_waitcnt vmcnt(1)
    v_max3_u32 v9, v24, v25, v26
    v_max_u32 v9, v9, v27
    v_cmp_eq_u32 vcc, -1, v9
    s_cbranch_vccnz prm_9_2
    s_branch prm_9_2ok
prm_9_2_g:
    s_mov_b32 s26, 0
    s_waitcnt vmcnt(0)
    s_branch prm_9_2ok
prm_9_3:
    s_sub_u32 s26, s26, 1
    s_cbranch_scc1 prm_9_3_g
    buffer_load_dwordx4 v[28:31], v1, s[4:7], s21 offen offset:3072 sc1
    s_waitcnt vmcnt(0)
    v_max3_u32 v9, v28, v29, v30
    v_max_u32 v9, v9, v31
    v_cmp_eq_u32 vcc, -1, v9
    s_cbranch_vccnz prm_9_3
    s_branch prm_9_3ok
prm_9_3_g:
    s_mov_b32 s26, 0
    s_waitcnt vmcnt(0)
    s_branch prm_9_3ok
prm_9_d:
gate_14:
    v_readfirstlane_b32 s25, v15
    s_cmp_ge_u32 s25, s59
    s_cbranch_scc1 gate_14_ok
    s_sleep 8
    buffer_load_dword v15, off, s[4:7], s58 sc1
    s_waitcnt vmcnt(0)
    s_sub_u32 s26, s26, 1
    s_cbranch_scc0 gate_14
    s_mov_b32 s26, 0
gate_14_ok:
    ds_write_b32 v14, v60
    v_add_f32 v32, v32, v33
    v_add_f32 v34, v34, v35
    ds_write2_b32 v4, v32, v34 offset0:0 offset1:104
    v_add_f32 v36, v36, v37
    v_add_f32 v38, v38, v39
    ds_write2_b32 v4, v36, v38 offset0:16 offset1:120
    v_add_f32 v40, v40, v41
    v_add_f32 v42, v42, v43
    ds_write2_b32 v4, v40, v42 offset0:32 offset1:136
    v_add_f32 v44, v44, v45
    v_add_f32 v46, v46, v47
    ds_write2_b32 v4, v44, v46 offset0:48 offset1:152
    v_add_f32 v48, v48, v49
    v_add_f32 v50, v50, v51
    ds_write2_b32 v4, v48, v50 offset0:64 offset1:168
    v_add_f32 v52, v52, v53
    v_add_f32 v54, v54, v55
    ds_write2_b32 v4, v52, v54 offset0:80 offset1:184
    s_branch pnc_7_done
prp_10:
    s_sub_u32 s26, s26, 1
    s_nop 3
    s_cbranch_scc1 prp_10_g
    buffer_load_dwordx4 v[16:19], v12, s[4:7], s30 offen sc1
    buffer_load_dword v15, off, s[4:7], s58 sc1
    s_branch ploop_6_pagain
prp_10_g:
    s_mov_b32 s26, 0
    s_branch ploop_6_pgo
ploop_6_zr:
    s_sub_u32 s26, s26, 1
    s_cbranch_scc1 ploop_6_zg
    buffer_load_dwordx4 v[32:35], v1, s[4:7], s22 offen offset:0 sc1
    buffer_load_dwordx4 v[36:39], v1, s[4:7], s22 offen offset:1024 sc1
    buffer_load_dwordx4 v[40:43], v1, s[4:7], s22 offen offset:2048 sc1
    buffer_load_dwordx4 v[44:47], v1, s[4:7], s22 offen offset:3072 sc1
    s_branch ploop_6_za
ploop_6_zg:
    s_mov_b32 s26, 0
    s_branch ploop_6_zok
ptail_8:
    s_cmp_eq_u32 s15, 0
    s_cbranch_scc1 ptail_8_nd
    s_nop 0
ptail_8_nd:
    s_barrier
    v_add_u32 v55, s68, v61
    ds_read_b128 v[24:27], v55 offset:0
    ds_read_b128 v[28:31], v55 offset:1024
    ds_read_b128 v[32:35], v55 offset:18560
    ds_read_b128 v[36:39], v55 offset:19584
    ds_read_b128 v[40:43], v55 offset:37120
    ds_read_b128 v[44:47], v55 offset:38144
    ds_read_b128 v[48:51], v55 offset:55680
    ds_read_b128 v[52:55], v55 offset:56704
    s_waitcnt lgkmcnt(4)
    v_add_f32 v24, v24, v32
    v_add_f32 v25, v25, v33
    v_add_f32 v26, v26, v34
    v_add_f32 v27, v27, v35
    v_add_f32 v28, v28, v36
    v_add_f32 v29, v29, v37
    v_add_f32 v30, v30, v38
    v_add_f32 v31, v31, v39
    s_waitcnt lgkmcnt(0)
    v_add_f32 v40, v40, v48
    v_add_f32 v41, v41, v49
    v_add_f32 v42, v42, v50
    v_add_f32 v43, v43, v51
    v_add_f32 v44, v44, v52
    v_add_f32 v45, v45, v53
    v_add_f32 v46, v46, v54
    v_add_f32 v47, v47, v55
    v_add_f32 v24, v24, v40
    v_add_f32 v25, v25, v41
    v_add_f32 v26, v26, v42
    v_add_f32 v27, v27, v43
    v_add_f32 v28, v28, v44
    v_add_f32 v29, v29, v45
    v_add_f32 v30, v30, v46
    v_add_f32 v31, v31, v47
    v_cvt_pk_bf16_f32 v24, v24, v25
    v_cvt_pk_bf16_f32 v25, v26, v27
    v_cvt_pk_bf16_f32 v26, v28, v29
    v_cvt_pk_bf16_f32 v27, v30, v31
    v_min_u32 v24, -2, v24
    v_min_u32 v25, -2, v25
    v_min_u32 v26, -2, v26
    v_min_u32 v27, -2, v27
    buffer_store_dwordx4 v[24:27], v1, s[4:7], s37 offen sc1
    s_branch k_end
ch_p_slow:
    v_mov_b32 v32, 0
    v_mov_b32 v33, 0
    v_mov_b32 v34, 0
    v_mov_b32 v35, 0
    v_mov_b32 v36, 0
    v_mov_b32 v37, 0
    v_mov_b32 v38, 0
    v_mov_b32 v39, 0
    v_mov_b32 v40, 0
    v_mov_b32 v41, 0
    v_mov_b32 v42, 0
    v_mov_b32 v43, 0
    v_mov_b32 v44, 0
    v_mov_b32 v45, 0
    v_mov_b32 v46, 0
    v_mov_b32 v47, 0
    v_mov_b32 v48, 0
    v_mov_b32 v49, 0
    v_mov_b32 v50, 0
    v_mov_b32 v51, 0
    v_mov_b32 v52, 0
    v_mov_b32 v53, 0
    v_mov_b32 v54, 0
    v_mov_b32 v55, 0
    v_mov_b32 v0, 1.0
    s_mov_b32 exec_lo, 0xff00ff00
    s_mov_b32 exec_hi, 0xff00ff00
    v_mov_b32 v0, s47
    s_mov_b64 exec, -1
    v_mov_b32 v60, s16
    v_smfmac_f32_16x16x64_bf16 v[32:35], v[16:19], v[64:71], v62
    v_smfmac_f32_16x16x64_bf16 v[36:39], v[16:19], v[72:79], v62
    v_smfmac_f32_16x16x64_bf16 v[40:43], v[16:19], v[80:87], v62
    v_smfmac_f32_16x16x64_bf16 v[44:47], v[16:19], v[88:95], v62
    v_smfmac_f32_16x16x64_bf16 v[48:51], v[16:19], v[96:103], v62
    v_smfmac_f32_16x16x64_bf16 v[52:55], v[16:19], v[104:111], v62
    v_smfmac_f32_16x16x64_bf16 v[32:35], v[20:23], v[112:119], v62
    v_smfmac_f32_16x16x64_bf16 v[36:39], v[20:23], v[120:127], v62
    v_smfmac_f32_16x16x64_bf16 v[40:43], v[20:23], v[128:135], v62
    v_smfmac_f32_16x16x64_bf16 v[44:47], v[20:23], v[136:143], v62
    v_smfmac_f32_16x16x64_bf16 v[48:51], v[20:23], v[144:151], v62
    v_smfmac_f32_16x16x64_bf16 v[52:55], v[20:23], v[152:159], v62
    v_smfmac_f32_16x16x64_bf16 v[32:35], v[24:27], v[160:167], v62
    v_smfmac_f32_16x16x64_bf16 v[36:39], v[24:27], v[168:175], v62
    v_smfmac_f32_16x16x64_bf16 v[40:43], v[24:27], v[176:183], v62
    v_smfmac_f32_16x16x64_bf16 v[44:47], v[24:27], v[184:191], v62
    v_smfmac_f32_16x16x64_bf16 v[48:51], v[24:27], v[192:199], v62
    v_smfmac_f32_16x16x64_bf16 v[52:55], v[24:27], v[200:207], v62
    v_smfmac_f32_16x16x64_bf16 v[32:35], v[28:31], v[208:215], v62
    ds_write_b32 v14, v60
    v_smfmac_f32_16x16x64_bf16 v[36:39], v[28:31], v[216:223], v62
    v_smfmac_f32_16x16x64_bf16 v[40:43], v[28:31], v[224:231], v62
    v_smfmac_f32_16x16x64_bf16 v[44:47], v[28:31], v[232:239], v62
    v_add_f32 v32, v32, v33
    v_add_f32 v34, v34, v35
    v_smfmac_f32_16x16x64_bf16 v[48:51], v[28:31], v[240:247], v62
    v_add_f32 v36, v36, v37
    v_add_f32 v38, v38, v39
    ds_write2_b32 v4, v32, v34 offset0:0 offset1:104
    v_smfmac_f32_16x16x64_bf16 v[52:55], v[28:31], v[248:255], v62
    v_add_f32 v40, v40, v41
    v_add_f32 v42, v42, v43
    ds_write2_b32 v4, v36, v38 offset0:16 offset1:120
    v_add_f32 v44, v44, v45
    v_add_f32 v46, v46, v47
    ds_write2_b32 v4, v40, v42 offset0:32 offset1:136
    v_add_f32 v48, v48, v49
    v_add_f32 v50, v50, v51
    ds_write2_b32 v4, v44, v46 offset0:48 offset1:152
    v_add_f32 v52, v52, v53
    v_add_f32 v54, v54, v55
    ds_write2_b32 v4, v48, v50 offset0:64 offset1:168
    ds_write2_b32 v4, v52, v54 offset0:80 offset1:184
    s_waitcnt vmcnt(0)
    s_branch pnc_16_done
.p2align 6
    s_nop 0
    s_nop 0
    s_nop 0
    s_nop 0
    s_nop 0
    s_nop 0
    s_nop 0
    s_nop 0
ploop_15:
    s_add_u32 s21, s17, s33
    s_nop 15
    s_nop 5
    buffer_load_dwordx4 v[16:19], v1, s[4:7], s21 offen offset:0 sc1
    s_nop 7
    buffer_load_dwordx4 v[20:23], v1, s[4:7], s21 offen offset:1024 sc1
    s_nop 7
    buffer_load_dwordx4 v[24:27], v1, s[4:7], s21 offen offset:2048 sc1
    s_nop 7
    buffer_load_dwordx4 v[28:31], v1, s[4:7], s21 offen offset:3072 sc1
    s_waitcnt vmcnt(3)
    v_max3_u32 v9, v16, v17, v18
    v_max_u32 v9, v9, v19
    v_cmp_eq_u32 vcc, -1, v9
    s_cbranch_vccnz prm_18_0
prm_18_0ok:
    v_smfmac_f32_16x16x64_bf16 v[32:35], v[16:19], v[64:71], v62
    v_smfmac_f32_16x16x64_bf16 v[36:39], v[16:19], v[72:79], v62
    v_smfmac_f32_16x16x64_bf16 v[40:43], v[16:19], v[80:87], v62
    s_waitcnt vmcnt(2)
    v_max3_u32 v9, v20, v21, v22
    v_max_u32 v9, v9, v23
    v_cmp_eq_u32 vcc, -1, v9
    v_smfmac_f32_16x16x64_bf16 v[44:47], v[16:19], v[88:95], v62
    v_smfmac_f32_16x16x64_bf16 v[48:51], v[16:19], v[96:103], v62
    v_smfmac_f32_16x16x64_bf16 v[52:55], v[16:19], v[104:111], v62
    s_cbranch_vccnz prm_18_1
prm_18_1ok:
    v_smfmac_f32_16x16x64_bf16 v[32:35], v[20:23], v[112:119], v62
    v_readfirstlane_b32 s23, v15
    v_smfmac_f32_16x16x64_bf16 v[36:39], v[20:23], v[120:127], v62
    v_smfmac_f32_16x16x64_bf16 v[40:43], v[20:23], v[128:135], v62
    s_waitcnt vmcnt(1)
    v_max3_u32 v9, v24, v25, v26
    v_max_u32 v9, v9, v27
    v_cmp_eq_u32 vcc, -1, v9
    v_smfmac_f32_16x16x64_bf16 v[44:47], v[20:23], v[136:143], v62
    v_smfmac_f32_16x16x64_bf16 v[48:51], v[20:23], v[144:151], v62
    v_smfmac_f32_16x16x64_bf16 v[52:55], v[20:23], v[152:159], v62
    s_cbranch_vccnz prm_18_2
prm_18_2ok:
    v_smfmac_f32_16x16x64_bf16 v[32:35], v[24:27], v[160:167], v62
    v_smfmac_f32_16x16x64_bf16 v[36:39], v[24:27], v[168:175], v62
    v_smfmac_f32_16x16x64_bf16 v[40:43], v[24:27], v[176:183], v62
    s_waitcnt vmcnt(0)
    v_max3_u32 v9, v28, v29, v30
    v_max_u32 v9, v9, v31
    v_cmp_eq_u32 vcc, -1, v9
    v_smfmac_f32_16x16x64_bf16 v[44:47], v[24:27], v[184:191], v62
    v_smfmac_f32_16x16x64_bf16 v[48:51], v[24:27], v[192:199], v62
    v_smfmac_f32_16x16x64_bf16 v[52:55], v[24:27], v[200:207], v62
    s_cbranch_vccnz prm_18_3
prm_18_3ok:
    v_smfmac_f32_16x16x64_bf16 v[32:35], v[28:31], v[208:215], v62
    s_cmp_lt_u32 s23, s59
    s_cbranch_scc1 prm_18_gt
prm_18_gtb:
    ds_write_b32 v14, v60
    v_smfmac_f32_16x16x64_bf16 v[36:39], v[28:31], v[216:223], v62
    v_smfmac_f32_16x16x64_bf16 v[40:43], v[28:31], v[224:231], v62
    v_smfmac_f32_16x16x64_bf16 v[44:47], v[28:31], v[232:239], v62
    v_add_f32 v32, v32, v33
    v_add_f32 v34, v34, v35
    v_smfmac_f32_16x16x64_bf16 v[48:51], v[28:31], v[240:247], v62
    v_add_f32 v36, v36, v37
    v_add_f32 v38, v38, v39
    ds_write2_b32 v4, v32, v34 offset0:0 offset1:104
    v_smfmac_f32_16x16x64_bf16 v[52:55], v[28:31], v[248:255], v62
    v_add_f32 v40, v40, v41
    v_add_f32 v42, v42, v43
    ds_write2_b32 v4, v36, v38 offset0:16 offset1:120
    v_add_f32 v44, v44, v45
    v_add_f32 v46, v46, v47
    ds_write2_b32 v4, v40, v42 offset0:32 offset1:136
    v_add_f32 v48, v48, v49
    v_add_f32 v50, v50, v51
    ds_write2_b32 v4, v44, v46 offset0:48 offset1:152
    v_add_f32 v52, v52, v53
    v_add_f32 v54, v54, v55
    ds_write2_b32 v4, v48, v50 offset0:64 offset1:168
    ds_write2_b32 v4, v52, v54 offset0:80 offset1:184
pnc_16_done:
    s_add_u32 s21, s17, s32
    s_add_u32 s22, s19, s32
    s_add_u32 s24, s19, s35
    s_waitcnt lgkmcnt(0)
    s_barrier
    ds_read_b64 v[32:33], v5 offset:0
    ds_read_b64 v[34:35], v5 offset:3328
    ds_read_b64 v[36:37], v5 offset:6656
    ds_read_b64 v[38:39], v5 offset:9984
    ds_read_b64 v[40:41], v6 offset:0
    ds_read_b64 v[42:43], v6 offset:3328
    ds_read_b64 v[44:45], v6 offset:6656
    ds_read_b64 v[46:47], v6 offset:9984
    s_waitcnt lgkmcnt(6)
    v_add_f32 v32, v32, v34
    v_add_f32 v33, v33, v35
    v_mul_f32 v32, v32, v0
    v_mul_f32 v33, v33, v0
    s_waitcnt lgkmcnt(4)
    v_add_f32 v36, v36, v38
    v_add_f32 v37, v37, v39
    v_fma_f32 v32, v36, v0, v32
    v_fma_f32 v33, v37, v0, v33
    v_cvt_pk_bf16_f32 v32, v32, v33
    v_min_u32 v32, -2, v32
    buffer_store_dword v32, v2, s[4:7], s21 offen sc1
    s_waitcnt lgkmcnt(2)
    v_add_f32 v40, v40, v42
    v_add_f32 v41, v41, v43
    s_waitcnt lgkmcnt(0)
    v_add_f32 v44, v44, v46
    v_add_f32 v45, v45, v47
    v_add_f32 v40, v40, v44
    v_add_f32 v41, v41, v45
    v_cvt_pk_bf16_f32 v40, v40, v41
    v_min_u32 v40, -2, v40
    s_mov_b32 exec_hi, 0
    buffer_store_dword v40, v3, s[4:7], s21 offen sc1
    s_setprio 0
    s_mov_b64 exec, -1
    s_add_u32 s21, s17, s35
    s_add_u32 s30, s17, s34
    s_add_u32 s23, s18, s36
    s_cmp_lg_u32 s16, 0
    s_cbranch_scc1 ploop_15_n0
gate_20:
    v_readfirstlane_b32 s25, v15
    s_cmp_ge_u32 s25, s59
    s_cbranch_scc1 gate_20_ok
    s_sleep 8
    buffer_load_dword v15, off, s[4:7], s58 sc1
    s_waitcnt vmcnt(0)
    s_sub_u32 s26, s26, 1
    s_cbranch_scc0 gate_20
    s_mov_b32 s26, 0
gate_20_ok:
    s_cmp_eq_u32 s15, 0
    s_cbranch_scc1 ploop_15_st_nk
    s_add_u32 m0, s53, 0
    s_add_u32 s22, s52, 0
    buffer_load_dwordx4 v1, s[4:7], s22 offen offset:0 sc1 lds
    buffer_load_dwordx4 v1, s[4:7], s22 offen offset:1024 sc1 lds
    buffer_load_dwordx4 v1, s[4:7], s22 offen offset:2048 sc1 lds
    buffer_load_dwordx4 v1, s[4:7], s22 offen offset:3072 sc1 lds
    s_add_u32 m0, s53, 4096
    s_add_u32 s22, s52, 131072
    buffer_load_dwordx4 v1, s[4:7], s22 offen offset:0 sc1 lds
    buffer_load_dwordx4 v1, s[4:7], s22 offen offset:1024 sc1 lds
    buffer_load_dwordx4 v1, s[4:7], s22 offen offset:2048 sc1 lds
    buffer_load_dwordx4 v1, s[4:7], s22 offen offset:3072 sc1 lds
    s_add_u32 s52, s52, 262144
    s_sub_u32 s52, s52, 262144
ploop_15_st_nk:
    s_add_u32 s52, s52, 262144
    s_cmp_lg_u32 s3, 2
    s_cbranch_scc1 ploop_15_st_npf
    v_subrev_u32 v32, 524288, v63
    s_mov_b32 exec_hi, 0xffff
    s_mov_b32 s22, 262144
    buffer_load_dword v33, v32, s[4:7], s22 offen sc1
    s_mov_b32 exec_hi, -1
    s_waitcnt vmcnt(0)
ploop_15_st_npf:
    s_cmp_eq_u32 s15, 0
    s_cbranch_scc1 ploop_15_st_p_nd
    s_mov_b32 m0, 124928
    s_nop 0
    buffer_load_dwordx4 v1, s[4:7], s69 offen offset:0 sc1 lds
    buffer_load_dwordx4 v1, s[4:7], s69 offen offset:1024 sc1 lds
    buffer_load_dwordx4 v1, s[4:7], s69 offen offset:2048 sc1 lds
    buffer_load_dwordx4 v1, s[4:7], s69 offen offset:3072 sc1 lds
    s_add_u32 s69, s69, 262144
    s_waitcnt vmcnt(0)
ploop_15_st_p_nd:
ploop_15_n0:
    s_add_u32 s25, s16, 2
    s_min_u32 s25, s25, 63
    s_cmp_lt_u32 s25, 8
    s_cselect_b32 s59, 12, 24
    s_cselect_b32 s58, -4, -8
    s_and_b32 s25, s25, s58
    s_lshl_b32 s25, s25, 5
    s_add_u32 s58, s25, s60
    s_cmp_eq_u32 s15, 0
    s_cbranch_scc1 ploop_15_nd
    v_add_u32 v9, s53, v1
    v_add_u32 v0, 124928, v1
    ds_read_b128 v[16:19], v0 offset:0
    ds_read_b128 v[32:35], v9 offset:0
    ds_read_b128 v[20:23], v0 offset:1024
    ds_read_b128 v[36:39], v9 offset:1024
    ds_read_b128 v[24:27], v0 offset:2048
    ds_read_b128 v[40:43], v9 offset:2048
    ds_read_b128 v[28:31], v0 offset:3072
    ds_read_b128 v[44:47], v9 offset:3072
    s_add_u32 s22, s17, s61
    s_waitcnt lgkmcnt(6)
    v_mfma_f32_16x16x32_bf16 v[48:51], v[32:35], v[16:19], 0
    ds_read_b128 v[32:35], v9 offset:4096
    s_waitcnt lgkmcnt(5)
    v_mfma_f32_16x16x32_bf16 v[48:51], v[36:39], v[20:23], v[48:51]
    ds_read_b128 v[36:39], v9 offset:5120
    s_waitcnt lgkmcnt(4)
    v_mfma_f32_16x16x32_bf16 v[48:51], v[40:43], v[24:27], v[48:51]
    ds_read_b128 v[40:43], v9 offset:6144
    s_waitcnt lgkmcnt(3)
    v_mfma_f32_16x16x32_bf16 v[48:51], v[44:47], v[28:31], v[48:51]
    ds_read_b128 v[44:47], v9 offset:7168
    s_waitcnt lgkmcnt(3)
    v_mfma_f32_16x16x32_bf16 v[52:55], v[32:35], v[16:19], 0
    s_waitcnt lgkmcnt(2)
    v_mfma_f32_16x16x32_bf16 v[52:55], v[36:39], v[20:23], v[52:55]
    s_waitcnt lgkmcnt(1)
    v_mfma_f32_16x16x32_bf16 v[52:55], v[40:43], v[24:27], v[52:55]
    s_waitcnt lgkmcnt(0)
    v_mfma_f32_16x16x32_bf16 v[52:55], v[44:47], v[28:31], v[52:55]
    buffer_load_dwordx4 v[32:35], v1, s[4:7], s22 offen offset:0 sc1
    buffer_load_dwordx4 v[36:39], v1, s[4:7], s22 offen offset:1024 sc1
    buffer_load_dwordx4 v[40:43], v1, s[4:7], s22 offen offset:2048 sc1
    buffer_load_dwordx4 v[44:47], v1, s[4:7], s22 offen offset:3072 sc1
    v_mov_b32 v60, 0xff61b1e6
    s_nop 2
    v_cndmask_b32 v48, v48, v60, s[38:39]
    v_cndmask_b32 v49, v49, v60, s[40:41]
    v_cndmask_b32 v50, v50, v60, s[42:43]
    v_cndmask_b32 v51, v51, v60, s[44:45]
    v_cndmask_b32 v52, v52, v60, s[48:49]
    v_cndmask_b32 v53, v53, v60, s[50:51]
    v_cndmask_b32 v54, v54, v60, s[54:55]
    v_cndmask_b32 v55, v55, v60, s[56:57]
    v_max3_f32 v0, v48, v49, v50
    v_max3_f32 v9, v51, v52, v53
    v_max3_f32 v0, v0, v54, v55
    v_max_f32 v0, v0, v9
    v_mov_b32 v9, v0
    s_nop 1
    v_permlane16_swap_b32 v9, v0
    v_max_f32 v0, v0, v9
    v_mov_b32 v9, v0
    s_nop 1
    v_permlane32_swap_b32 v9, v0
    v_max_f32 v0, v0, v9
    v_mul_f32 v0, s47, v0
    v_fma_f32 v48, v48, s47, -v0
    v_fma_f32 v49, v49, s47, -v0
    v_fma_f32 v50, v50, s47, -v0
    v_fma_f32 v51, v51, s47, -v0
    v_fma_f32 v52, v52, s47, -v0
    v_fma_f32 v53, v53, s47, -v0
    v_fma_f32 v54, v54, s47, -v0
    v_fma_f32 v55, v55, s47, -v0
    v_exp_f32 v48, v48
    v_exp_f32 v49, v49
    v_exp_f32 v50, v50
    v_exp_f32 v51, v51
    v_exp_f32 v52, v52
    v_exp_f32 v53, v53
    v_exp_f32 v54, v54
    v_exp_f32 v55, v55
    v_add_f32 v15, v48, v49
    v_add_f32 v15, v15, v50
    v_add_f32 v15, v15, v51
    v_add_f32 v15, v15, v52
    v_add_f32 v15, v15, v53
    v_add_f32 v15, v15, v54
    v_add_f32 v15, v15, v55
ploop_15_za:
    s_waitcnt vmcnt(0)
    v_max3_u32 v9, v32, v33, v34
    v_max3_u32 v9, v9, v35, v36
    v_max3_u32 v9, v9, v37, v38
    v_max3_u32 v9, v9, v39, v40
    v_max3_u32 v9, v9, v41, v42
    v_max3_u32 v9, v9, v43, v44
    v_max3_u32 v9, v9, v45, v46
    v_max_u32 v9, v9, v47
    v_cmp_eq_u32 vcc, -1, v9
    s_cbranch_vccnz ploop_15_zr
ploop_15_zok:
    s_setprio 1
    v_mfma_f32_16x16x32_bf16 v[56:59], v[32:35], v[16:19], 0
    v_mfma_f32_16x16x32_bf16 v[56:59], v[36:39], v[20:23], v[56:59]
    v_mfma_f32_16x16x32_bf16 v[56:59], v[40:43], v[24:27], v[56:59]
    v_mfma_f32_16x16x32_bf16 v[56:59], v[44:47], v[28:31], v[56:59]
    s_add_u32 s22, s17, s14
    s_nop 6
    v_max_f32 v60, v56, v57
    v_mov_b32 v9, v60
    s_nop 1
    v_permlane16_swap_b32 v9, v60
    v_max_f32 v60, v60, v9
    v_mov_b32 v9, v60
    s_nop 1
    v_permlane32_swap_b32 v9, v60
    v_max_f32 v60, v60, v9
    v_mul_f32 v60, s47, v60
    v_max_f32 v58, v60, v0
    v_sub_f32 v60, v0, v58
    v_fma_f32 v56, v56, s47, -v58
    v_fma_f32 v57, v57, s47, -v58
    v_exp_f32 v60, v60
    v_exp_f32 v56, v56
    v_exp_f32 v57, v57
    v_fma_f32 v15, v15, v60, v56
    v_add_f32 v15, v15, v57
    v_mov_b32 v9, v15
    s_nop 1
    v_permlane16_swap_b32 v9, v15
    v_add_f32 v15, v15, v9
    v_mov_b32 v9, v15
    s_nop 1
    v_permlane32_swap_b32 v9, v15
    v_add_f32 v15, v15, v9
    v_rcp_f32 v15, v15
    s_add_u32 s25, s19, s14
    v_mul_f32 v56, v56, v15
    v_mul_f32 v57, v57, v15
    v_mul_f32 v60, v60, v15
    v_mul_f32 v48, v48, v60
    v_mul_f32 v49, v49, v60
    v_mul_f32 v50, v50, v60
    v_mul_f32 v51, v51, v60
    v_mul_f32 v52, v52, v60
    v_mul_f32 v53, v53, v60
    v_mul_f32 v54, v54, v60
    v_mul_f32 v55, v55, v60
    v_cvt_pk_bf16_f32 v48, v48, v49
    v_cvt_pk_bf16_f32 v49, v50, v51
    v_cvt_pk_bf16_f32 v50, v52, v53
    v_cvt_pk_bf16_f32 v51, v54, v55
    v_min_u32 v48, -2, v48
    v_min_u32 v49, -2, v49
    v_min_u32 v50, -2, v50
    v_min_u32 v51, -2, v51
    v_lshlrev_b32 v54, 1, v8
    v_add_u32 v55, 14336, v1
    v_mov_b32 v53, 1.0
    v_cvt_pk_bf16_f32 v52, v56, v57
    v_min_u32 v53, -2, v53
    v_min_u32 v52, -2, v52
    buffer_store_dwordx4 v[48:51], v1, s[4:7], s22 offen sc1
    buffer_store_dwordx2 v[52:53], v54, s[4:7], s22 offen offset:1024 sc1
    ds_read_b128 v[56:59], v55
    s_branch ploop_15_nd2
ploop_15_nd:
    s_cmp_eq_u32 s16, 0
    s_cbranch_scc1 ploop_15_ns
    s_cmp_eq_u32 s31, 0
    s_cbranch_scc1 ploop_15_n2
    s_add_u32 s25, s68, s46
    v_add_u32 v55, s25, v61
    ds_read_b128 v[24:27], v55 offset:0
    ds_read_b128 v[28:31], v55 offset:1024
    ds_read_b128 v[32:35], v55 offset:18560
    ds_read_b128 v[36:39], v55 offset:19584
    ds_read_b128 v[40:43], v55 offset:37120
    ds_read_b128 v[44:47], v55 offset:38144
    ds_read_b128 v[48:51], v55 offset:55680
    ds_read_b128 v[52:55], v55 offset:56704
    s_waitcnt lgkmcnt(4)
    v_add_f32 v24, v24, v32
    v_add_f32 v25, v25, v33
    v_add_f32 v26, v26, v34
    v_add_f32 v27, v27, v35
    v_add_f32 v28, v28, v36
    v_add_f32 v29, v29, v37
    v_add_f32 v30, v30, v38
    v_add_f32 v31, v31, v39
    s_waitcnt lgkmcnt(0)
    v_add_f32 v40, v40, v48
    v_add_f32 v41, v41, v49
    v_add_f32 v42, v42, v50
    v_add_f32 v43, v43, v51
    v_add_f32 v44, v44, v52
    v_add_f32 v45, v45, v53
    v_add_f32 v46, v46, v54
    v_add_f32 v47, v47, v55
    v_add_f32 v24, v24, v40
    v_add_f32 v25, v25, v41
    v_add_f32 v26, v26, v42
    v_add_f32 v27, v27, v43
    v_add_f32 v28, v28, v44
    v_add_f32 v29, v29, v45
    v_add_f32 v30, v30, v46
    v_add_f32 v31, v31, v47
    v_cvt_pk_bf16_f32 v24, v24, v25
    v_cvt_pk_bf16_f32 v25, v26, v27
    v_cvt_pk_bf16_f32 v26, v28, v29
    v_cvt_pk_bf16_f32 v27, v30, v31
    v_min_u32 v24, -2, v24
    v_min_u32 v25, -2, v25
    v_min_u32 v26, -2, v26
    v_min_u32 v27, -2, v27
    v_mov_b32 v16, v24
    v_mov_b32 v17, v25
    v_mov_b32 v18, v26
    v_mov_b32 v19, v27
ploop_15_n2:
    v_add_u32 v55, s68, v61
    ds_read_b128 v[24:27], v55 offset:0
    ds_read_b128 v[28:31], v55 offset:1024
    ds_read_b128 v[32:35], v55 offset:18560
    ds_read_b128 v[36:39], v55 offset:19584
    ds_read_b128 v[40:43], v55 offset:37120
    ds_read_b128 v[44:47], v55 offset:38144
    ds_read_b128 v[48:51], v55 offset:55680
    ds_read_b128 v[52:55], v55 offset:56704
    s_waitcnt lgkmcnt(4)
    v_add_f32 v24, v24, v32
    v_add_f32 v25, v25, v33
    v_add_f32 v26, v26, v34
    v_add_f32 v27, v27, v35
    v_add_f32 v28, v28, v36
    v_add_f32 v29, v29, v37
    v_add_f32 v30, v30, v38
    v_add_f32 v31, v31, v39
    s_waitcnt lgkmcnt(0)
    v_add_f32 v40, v40, v48
    v_add_f32 v41, v41, v49
    v_add_f32 v42, v42, v50
    v_add_f32 v43, v43, v51
    v_add_f32 v44, v44, v52
    v_add_f32 v45, v45, v53
    v_add_f32 v46, v46, v54
    v_add_f32 v47, v47, v55
    v_add_f32 v24, v24, v40
    v_add_f32 v25, v25, v41
    v_add_f32 v26, v26, v42
    v_add_f32 v27, v27, v43
    v_add_f32 v28, v28, v44
    v_add_f32 v29, v29, v45
    v_add_f32 v30, v30, v46
    v_add_f32 v31, v31, v47
    v_cvt_pk_bf16_f32 v24, v24, v25
    v_cvt_pk_bf16_f32 v25, v26, v27
    v_cvt_pk_bf16_f32 v26, v28, v29
    v_cvt_pk_bf16_f32 v27, v30, v31
    v_min_u32 v24, -2, v24
    v_min_u32 v25, -2, v25
    v_min_u32 v26, -2, v26
    v_min_u32 v27, -2, v27
ploop_15_ns:
ploop_15_flag:
    ds_read_b32 v9, v14 offset:16
    s_waitcnt lgkmcnt(0)
    v_readfirstlane_b32 s25, v9
    s_cmp_eq_u32 s25, s16
    s_cbranch_scc0 ploop_15_flag
    s_add_u32 m0, s53, 0
    s_add_u32 s22, s52, 0
    buffer_load_dwordx4 v1, s[4:7], s22 offen offset:0 sc1 lds
    buffer_load_dwordx4 v1, s[4:7], s22 offen offset:1024 sc1 lds
    buffer_load_dwordx4 v1, s[4:7], s22 offen offset:2048 sc1 lds
    buffer_load_dwordx4 v1, s[4:7], s22 offen offset:3072 sc1 lds
    s_add_u32 m0, s53, 4096
    s_add_u32 s22, s52, 131072
    buffer_load_dwordx4 v1, s[4:7], s22 offen offset:0 sc1 lds
    buffer_load_dwordx4 v1, s[4:7], s22 offen offset:1024 sc1 lds
    buffer_load_dwordx4 v1, s[4:7], s22 offen offset:2048 sc1 lds
    buffer_load_dwordx4 v1, s[4:7], s22 offen offset:3072 sc1 lds
    s_add_u32 s52, s52, 262144
ploop_15_nk:
    s_cmp_eq_u32 s16, 0
    s_cbranch_scc1 ploop_15_nd2
    buffer_store_dwordx4 v[24:27], v1, s[4:7], s37 offen sc1
    s_cmp_eq_u32 s31, 0
    s_cbranch_scc1 ploop_15_nd2
    s_add_u32 s25, s37, s27
    buffer_store_dwordx4 v[16:19], v1, s[4:7], s25 offen sc1
ploop_15_nd2:
    s_cmp_eq_u32 s16, 0
    s_cbranch_scc1 ploop_15_nn
    s_add_u32 s37, s37, 65536
    s_xor_b32 s68, s68, 8192
ploop_15_nn:
    s_cmp_lg_u32 s3, s8
    s_cbranch_scc1 ppf_21
    s_lshl_b32 s22, s16, 18
    s_mov_b32 exec_hi, 0xffff
    buffer_load_dword v9, v63, s[4:7], s22 offen sc1
    s_mov_b32 exec_hi, -1
ppf_21:
    v_add_u32 v24, 18560, v7
    v_add_u32 v25, 37120, v7
    v_add_u32 v26, 55680, v7
    s_cmp_eq_u32 s16, 63
    s_setprio 3
    s_barrier
    s_cbranch_scc1 ptail_17
    ds_read2_b32 v[16:17], v7 offset0:0 offset1:2
    ds_read2_b32 v[18:19], v24 offset0:0 offset1:2
    ds_read2_b32 v[20:21], v25 offset0:0 offset1:2
    ds_read2_b32 v[22:23], v26 offset0:0 offset1:2
    s_waitcnt lgkmcnt(2)
    v_add_f32 v16, v16, v18
    v_add_f32 v17, v17, v19
    s_waitcnt lgkmcnt(0)
    v_add_f32 v20, v20, v22
    v_add_f32 v21, v21, v23
    v_add_f32 v16, v16, v20
    v_add_f32 v17, v17, v21
    v_cvt_pk_bf16_f32 v16, v16, v17
    v_min_u32 v16, -2, v16
    buffer_store_dword v16, v2, s[4:7], s21 offen sc1
    buffer_store_dword v10, v2, s[4:7], s24 offen sc1
    s_cmp_eq_u32 s15, 0
    s_cbranch_scc1 ploop_15_pnd
    s_sleep 6
    s_nop 8
    buffer_load_dwordx4 v[16:19], v12, s[4:7], s30 offen sc1
    buffer_load_dword v15, off, s[4:7], s58 sc1
    s_add_u32 s25, s19, s14
    v_mov_b32 v20, -1
    v_mov_b32 v21, -1
    v_mov_b32 v22, -1
    v_mov_b32 v23, -1
    buffer_store_dwordx4 v[20:23], v1, s[4:7], s25 offen sc1
    buffer_store_dwordx2 v[20:21], v54, s[4:7], s25 offen offset:1024 sc1
    s_mov_b32 m0, 124928
    s_nop 0
    buffer_load_dwordx4 v1, s[4:7], s69 offen offset:0 sc1 lds
    buffer_load_dwordx4 v1, s[4:7], s69 offen offset:1024 sc1 lds
    buffer_load_dwordx4 v1, s[4:7], s69 offen offset:2048 sc1 lds
    buffer_load_dwordx4 v1, s[4:7], s69 offen offset:3072 sc1 lds
    s_add_u32 s69, s69, 262144
    s_add_u32 m0, s53, 0
    s_add_u32 s22, s52, 0
    buffer_load_dwordx4 v1, s[4:7], s22 offen offset:0 sc1 lds
    buffer_load_dwordx4 v1, s[4:7], s22 offen offset:1024 sc1 lds
    buffer_load_dwordx4 v1, s[4:7], s22 offen offset:2048 sc1 lds
    buffer_load_dwordx4 v1, s[4:7], s22 offen offset:3072 sc1 lds
    s_add_u32 m0, s53, 4096
    s_add_u32 s22, s52, 131072
    buffer_load_dwordx4 v1, s[4:7], s22 offen offset:0 sc1 lds
    buffer_load_dwordx4 v1, s[4:7], s22 offen offset:1024 sc1 lds
    buffer_load_dwordx4 v1, s[4:7], s22 offen offset:2048 sc1 lds
    buffer_load_dwordx4 v1, s[4:7], s22 offen offset:3072 sc1 lds
    s_add_u32 s52, s52, 262144
    s_add_u32 s22, s16, 1
    v_mov_b32 v60, s22
    v_mov_b32 v32, 0
    v_mov_b32 v33, 0
    v_mov_b32 v34, 0
    v_mov_b32 v35, 0
    v_mov_b32 v36, 0
    v_mov_b32 v37, 0
    v_mov_b32 v38, 0
    v_mov_b32 v39, 0
    v_mov_b32 v40, 0
    v_mov_b32 v41, 0
    v_mov_b32 v42, 0
    v_mov_b32 v43, 0
    v_mov_b32 v44, 0
    v_mov_b32 v45, 0
    v_mov_b32 v46, 0
    v_mov_b32 v47, 0
    v_mov_b32 v48, 0
    v_mov_b32 v49, 0
    v_mov_b32 v50, 0
    v_mov_b32 v51, 0
    v_mov_b32 v52, 0
    v_mov_b32 v53, 0
    v_mov_b32 v54, 0
    v_mov_b32 v55, 0
    v_mov_b32 v0, 1.0
    s_mov_b32 exec_lo, 0xff00ff00
    s_mov_b32 exec_hi, 0xff00ff00
    v_mov_b32 v0, s47
    s_mov_b64 exec, -1
    s_waitcnt vmcnt(15) lgkmcnt(0)
    v_mfma_f32_16x16x32_bf16 v[20:23], v[56:59], v[16:19], 0
    v_max3_u32 v9, v16, v17, v18
    v_max_u32 v9, v9, v19
    v_cmp_eq_u32 vcc, -1, v9
    s_cbranch_vccnz prp_19
    s_nop 3
    v_add_f32_dpp v20, v20, v20 row_ror:8 row_mask:0xf bank_mask:0xf
    v_add_f32_dpp v21, v21, v21 row_ror:8 row_mask:0xf bank_mask:0xf
    v_add_f32_dpp v22, v22, v22 row_ror:8 row_mask:0xf bank_mask:0xf
    v_add_f32_dpp v23, v23, v23 row_ror:8 row_mask:0xf bank_mask:0xf
    v_cvt_pk_bf16_f32 v20, v20, v21
    v_cvt_pk_bf16_f32 v21, v22, v23
    s_mov_b32 exec_hi, 0
    v_min_u32 v20, -2, v20
    v_min_u32 v21, -2, v21
    s_mov_b32 exec_lo, 0x00ff00ff
    buffer_store_dwordx2 v[20:21], v13, s[4:7], s23 offen sc1
    s_mov_b64 exec, -1
    s_branch ploop_15_pst
ploop_15_pnd:
    s_sleep 6
    s_nop 8
    buffer_load_dwordx4 v[16:19], v12, s[4:7], s30 offen sc1
    buffer_load_dword v15, off, s[4:7], s58 sc1
    s_add_u32 s22, s16, 1
    v_mov_b32 v60, s22
    v_mov_b32 v32, 0
    v_mov_b32 v33, 0
    v_mov_b32 v34, 0
    v_mov_b32 v35, 0
    v_mov_b32 v36, 0
    v_mov_b32 v37, 0
    v_mov_b32 v38, 0
    v_mov_b32 v39, 0
    v_mov_b32 v40, 0
    v_mov_b32 v41, 0
    v_mov_b32 v42, 0
    v_mov_b32 v43, 0
    v_mov_b32 v44, 0
    v_mov_b32 v45, 0
    v_mov_b32 v46, 0
    v_mov_b32 v47, 0
    v_mov_b32 v48, 0
    v_mov_b32 v49, 0
    v_mov_b32 v50, 0
    v_mov_b32 v51, 0
    v_mov_b32 v52, 0
    v_mov_b32 v53, 0
    v_mov_b32 v54, 0
    v_mov_b32 v55, 0
    v_mov_b32 v0, 1.0
    s_mov_b32 exec_lo, 0xff00ff00
    s_mov_b32 exec_hi, 0xff00ff00
    v_mov_b32 v0, s47
    s_mov_b64 exec, -1
ploop_15_pagain:
    s_waitcnt vmcnt(1) lgkmcnt(0)
    v_mfma_f32_16x16x32_bf16 v[20:23], v[56:59], v[16:19], 0
    v_max3_u32 v9, v16, v17, v18
    v_max_u32 v9, v9, v19
    v_cmp_eq_u32 vcc, -1, v9
    s_cbranch_vccnz prp_19
ploop_15_pgo:
    s_nop 3
    v_add_f32_dpp v20, v20, v20 row_ror:8 row_mask:0xf bank_mask:0xf
    v_add_f32_dpp v21, v21, v21 row_ror:8 row_mask:0xf bank_mask:0xf
    v_add_f32_dpp v22, v22, v22 row_ror:8 row_mask:0xf bank_mask:0xf
    v_add_f32_dpp v23, v23, v23 row_ror:8 row_mask:0xf bank_mask:0xf
    v_cvt_pk_bf16_f32 v20, v20, v21
    v_cvt_pk_bf16_f32 v21, v22, v23
    s_mov_b32 exec_hi, 0
    v_min_u32 v20, -2, v20
    v_min_u32 v21, -2, v21
    s_mov_b32 exec_lo, 0x00ff00ff
    buffer_store_dwordx2 v[20:21], v13, s[4:7], s23 offen sc1
    s_mov_b64 exec, -1
ploop_15_pst:
    s_add_u32 s22, s19, s32
    s_add_u32 s25, s20, s36
    buffer_store_dword v10, v2, s[4:7], s22 offen sc1
    s_mov_b32 exec_hi, 0
    buffer_store_dword v10, v3, s[4:7], s22 offen sc1
    s_mov_b32 exec_lo, 0x00ff00ff
    buffer_store_dwordx2 v[10:11], v13, s[4:7], s25 offen sc1
    s_mov_b64 exec, -1
    s_add_u32 s16, s16, 1
    s_mov_b32 s17, s18
    s_mov_b32 s18, s19
    s_mov_b32 s19, s20
    s_add_u32 s20, s20, 262144
    s_cmp_eq_u32 s20, 210763776
    s_cselect_b32 s20, 209715200, s20
    s_branch ploop_15
prm_18_gt:
gate_22:
    v_readfirstlane_b32 s25, v15
    s_cmp_ge_u32 s25, s59
    s_cbranch_scc1 gate_22_ok
    s_sleep 8
    buffer_load_dword v15, off, s[4:7], s58 sc1
    s_waitcnt vmcnt(0)
    s_sub_u32 s26, s26, 1
    s_cbranch_scc0 gate_22
    s_mov_b32 s26, 0
gate_22_ok:
    s_branch prm_18_gtb
prm_18_0:
    s_sub_u32 s26, s26, 1
    s_cbranch_scc1 prm_18_0_g
    buffer_load_dwordx4 v[16:19], v1, s[4:7], s21 offen offset:0 sc1
    buffer_load_dwordx4 v[20:23], v1, s[4:7], s21 offen offset:1024 sc1
    buffer_load_dwordx4 v[24:27], v1, s[4:7], s21 offen offset:2048 sc1
    buffer_load_dwordx4 v[28:31], v1, s[4:7], s21 offen offset:3072 sc1
    s_waitcnt vmcnt(3)
    v_max3_u32 v9, v16, v17, v18
    v_max_u32 v9, v9, v19
    v_cmp_eq_u32 vcc, -1, v9
    s_cbranch_vccnz prm_18_0
    s_branch prm_18_0ok
prm_18_0_g:
    s_mov_b32 s26, 0
    s_waitcnt vmcnt(0)
    s_branch prm_18_0ok
prm_18_1:
    s_sub_u32 s26, s26, 1
    s_cbranch_scc1 prm_18_1_g
    buffer_load_dwordx4 v[20:23], v1, s[4:7], s21 offen offset:1024 sc1
    buffer_load_dwordx4 v[24:27], v1, s[4:7], s21 offen offset:2048 sc1
    buffer_load_dwordx4 v[28:31], v1, s[4:7], s21 offen offset:3072 sc1
    s_waitcnt vmcnt(2)
    v_max3_u32 v9, v20, v21, v22
    v_max_u32 v9, v9, v23
    v_cmp_eq_u32 vcc, -1, v9
    s_cbranch_vccnz prm_18_1
    s_branch prm_18_1ok
prm_18_1_g:
    s_mov_b32 s26, 0
    s_waitcnt vmcnt(0)
    s_branch prm_18_1ok
prm_18_2:
    s_sub_u32 s26, s26, 1
    s_cbranch_scc1 prm_18_2_g
    buffer_load_dwordx4 v[24:27], v1, s[4:7], s21 offen offset:2048 sc1
    buffer_load_dwordx4 v[28:31], v1, s[4:7], s21 offen offset:3072 sc1
    s_waitcnt vmcnt(1)
    v_max3_u32 v9, v24, v25, v26
    v_max_u32 v9, v9, v27
    v_cmp_eq_u32 vcc, -1, v9
    s_cbranch_vccnz prm_18_2
    s_branch prm_18_2ok
prm_18_2_g:
    s_mov_b32 s26, 0
    s_waitcnt vmcnt(0)
    s_branch prm_18_2ok
prm_18_3:
    s_sub_u32 s26, s26, 1
    s_cbranch_scc1 prm_18_3_g
    buffer_load_dwordx4 v[28:31], v1, s[4:7], s21 offen offset:3072 sc1
    s_waitcnt vmcnt(0)
    v_max3_u32 v9, v28, v29, v30
    v_max_u32 v9, v9, v31
    v_cmp_eq_u32 vcc, -1, v9
    s_cbranch_vccnz prm_18_3
    s_branch prm_18_3ok
prm_18_3_g:
    s_mov_b32 s26, 0
    s_waitcnt vmcnt(0)
    s_branch prm_18_3ok
prm_18_d:
gate_23:
    v_readfirstlane_b32 s25, v15
    s_cmp_ge_u32 s25, s59
    s_cbranch_scc1 gate_23_ok
    s_sleep 8
    buffer_load_dword v15, off, s[4:7], s58 sc1
    s_waitcnt vmcnt(0)
    s_sub_u32 s26, s26, 1
    s_cbranch_scc0 gate_23
    s_mov_b32 s26, 0
gate_23_ok:
    ds_write_b32 v14, v60
    v_add_f32 v32, v32, v33
    v_add_f32 v34, v34, v35
    ds_write2_b32 v4, v32, v34 offset0:0 offset1:104
    v_add_f32 v36, v36, v37
    v_add_f32 v38, v38, v39
    ds_write2_b32 v4, v36, v38 offset0:16 offset1:120
    v_add_f32 v40, v40, v41
    v_add_f32 v42, v42, v43
    ds_write2_b32 v4, v40, v42 offset0:32 offset1:136
    v_add_f32 v44, v44, v45
    v_add_f32 v46, v46, v47
    ds_write2_b32 v4, v44, v46 offset0:48 offset1:152
    v_add_f32 v48, v48, v49
    v_add_f32 v50, v50, v51
    ds_write2_b32 v4, v48, v50 offset0:64 offset1:168
    v_add_f32 v52, v52, v53
    v_add_f32 v54, v54, v55
    ds_write2_b32 v4, v52, v54 offset0:80 offset1:184
    s_branch pnc_16_done
prp_19:
    s_sub_u32 s26, s26, 1
    s_nop 3
    s_cbranch_scc1 prp_19_g
    buffer_load_dwordx4 v[16:19], v12, s[4:7], s30 offen sc1
    buffer_load_dword v15, off, s[4:7], s58 sc1
    s_branch ploop_15_pagain
prp_19_g:
    s_mov_b32 s26, 0
    s_branch ploop_15_pgo
ploop_15_zr:
    s_sub_u32 s26, s26, 1
    s_cbranch_scc1 ploop_15_zg
    buffer_load_dwordx4 v[32:35], v1, s[4:7], s22 offen offset:0 sc1
    buffer_load_dwordx4 v[36:39], v1, s[4:7], s22 offen offset:1024 sc1
    buffer_load_dwordx4 v[40:43], v1, s[4:7], s22 offen offset:2048 sc1
    buffer_load_dwordx4 v[44:47], v1, s[4:7], s22 offen offset:3072 sc1
    s_branch ploop_15_za
ploop_15_zg:
    s_mov_b32 s26, 0
    s_branch ploop_15_zok
ptail_17:
    s_cmp_eq_u32 s15, 0
    s_cbranch_scc1 ptail_17_nd
    s_nop 0
ptail_17_nd:
    s_barrier
    v_add_u32 v55, s68, v61
    ds_read_b128 v[24:27], v55 offset:0
    ds_read_b128 v[28:31], v55 offset:1024
    ds_read_b128 v[32:35], v55 offset:18560
    ds_read_b128 v[36:39], v55 offset:19584
    ds_read_b128 v[40:43], v55 offset:37120
    ds_read_b128 v[44:47], v55 offset:38144
    ds_read_b128 v[48:51], v55 offset:55680
    ds_read_b128 v[52:55], v55 offset:56704
    s_waitcnt lgkmcnt(4)
    v_add_f32 v24, v24, v32
    v_add_f32 v25, v25, v33
    v_add_f32 v26, v26, v34
    v_add_f32 v27, v27, v35
    v_add_f32 v28, v28, v36
    v_add_f32 v29, v29, v37
    v_add_f32 v30, v30, v38
    v_add_f32 v31, v31, v39
    s_waitcnt lgkmcnt(0)
    v_add_f32 v40, v40, v48
    v_add_f32 v41, v41, v49
    v_add_f32 v42, v42, v50
    v_add_f32 v43, v43, v51
    v_add_f32 v44, v44, v52
    v_add_f32 v45, v45, v53
    v_add_f32 v46, v46, v54
    v_add_f32 v47, v47, v55
    v_add_f32 v24, v24, v40
    v_add_f32 v25, v25, v41
    v_add_f32 v26, v26, v42
    v_add_f32 v27, v27, v43
    v_add_f32 v28, v28, v44
    v_add_f32 v29, v29, v45
    v_add_f32 v30, v30, v46
    v_add_f32 v31, v31, v47
    v_cvt_pk_bf16_f32 v24, v24, v25
    v_cvt_pk_bf16_f32 v25, v26, v27
    v_cvt_pk_bf16_f32 v26, v28, v29
    v_cvt_pk_bf16_f32 v27, v30, v31
    v_min_u32 v24, -2, v24
    v_min_u32 v25, -2, v25
    v_min_u32 v26, -2, v26
    v_min_u32 v27, -2, v27
    buffer_store_dwordx4 v[24:27], v1, s[4:7], s37 offen sc1
    s_branch k_end
ch_a_pro:
    s_mul_i32 s21, s2, 24576
    s_add_u32 s21, s21, 209711104
    v_lshlrev_b32 v1, 4, v0
    v_mov_b32 v4, -1
    v_mov_b32 v5, -1
    v_mov_b32 v6, -1
    v_mov_b32 v7, -1
    buffer_store_dwordx4 v[4:7], v1, s[4:7], s21 offen sc1
    s_add_u32 s21, s21, 4096
    buffer_store_dwordx4 v[4:7], v1, s[4:7], s21 offen sc1
    s_add_u32 s21, s21, 4096
    buffer_store_dwordx4 v[4:7], v1, s[4:7], s21 offen sc1
    s_add_u32 s21, s21, 4096
    buffer_store_dwordx4 v[4:7], v1, s[4:7], s21 offen sc1
    s_add_u32 s21, s21, 4096
    buffer_store_dwordx4 v[4:7], v1, s[4:7], s21 offen sc1
    s_add_u32 s21, s21, 4096
    buffer_store_dwordx4 v[4:7], v1, s[4:7], s21 offen sc1
    s_add_u32 s21, s21, 4096
    v_mov_b32 v2, s29
    s_waitcnt vmcnt(0)
    s_barrier
    s_cmp_lg_u32 s3, 4
    s_cbranch_scc1 ch_nox
    s_mov_b64 exec, 1
    buffer_atomic_add v2, off, s[64:67], s28 sc1
    s_mov_b64 exec, -1
ch_nox:
    v_and_b32 v20, 63, v0
    v_lshlrev_b32 v0, 4, v20
    s_sub_u32 s25, s3, 4
    s_lshl_b32 s46, s12, 2
    s_add_u32 s46, s46, s25
    s_lshl_b32 s21, s46, 18
    s_lshl_b32 s22, s13, 7
    s_add_u32 s21, s21, s22
    s_lshl_b32 s46, s46, 12
    s_lshl_b32 s23, s25, 13
    s_add_u32 s23, s23, 131072
    s_load_dwordx2 s[8:9], s[0:1], 40
    s_mov_b32 s10, 8388608
    s_mov_b32 s11, 131072
    v_lshrrev_b32 v21, 3, v20
    v_and_b32 v22, 7, v20
    v_lshlrev_b32 v21, 11, v21
    v_lshl_add_u32 v21, v22, 4, v21
    v_lshrrev_b32 v28, 4, v20
    v_and_b32 v29, 1, v28
    v_xor_b32 v29, 0, v29
    v_lshlrev_b32 v29, 2, v29
    v_lshl_add_u32 v29, v28, 3, v29
    v_bfe_u32 v28, v20, 2, 2
    v_add_u32 v29, v29, v28
    v_lshlrev_b32 v29, 7, v29
    v_and_b32 v28, 3, v20
    v_lshl_add_u32 v29, v28, 4, v29
    v_and_b32 v28, 1, v28
    v_xor_b32 v28, 0, v28
    v_lshl_add_u32 v24, v28, 3, v29
    v_add_u32 v24, s23, v24
    v_lshrrev_b32 v28, 4, v20
    v_and_b32 v29, 1, v28
    v_xor_b32 v29, 1, v29
    v_lshlrev_b32 v29, 2, v29
    v_lshl_add_u32 v29, v28, 3, v29
    v_bfe_u32 v28, v20, 2, 2
    v_add_u32 v29, v29, v28
    v_lshlrev_b32 v29, 7, v29
    v_and_b32 v28, 3, v20
    v_lshl_add_u32 v29, v28, 4, v29
    v_and_b32 v28, 1, v28
    v_xor_b32 v28, 0, v28
    v_lshl_add_u32 v25, v28, 3, v29
    v_add_u32 v25, s23, v25
    v_lshrrev_b32 v28, 4, v20
    v_and_b32 v29, 1, v28
    v_xor_b32 v29, 0, v29
    v_lshlrev_b32 v29, 2, v29
    v_lshl_add_u32 v29, v28, 3, v29
    v_bfe_u32 v28, v20, 2, 2
    v_add_u32 v29, v29, v28
    v_lshlrev_b32 v29, 7, v29
    v_and_b32 v28, 3, v20
    v_lshl_add_u32 v29, v28, 4, v29
    v_and_b32 v28, 1, v28
    v_xor_b32 v28, 1, v28
    v_lshl_add_u32 v26, v28, 3, v29
    v_add_u32 v26, s23, v26
    v_lshrrev_b32 v28, 4, v20
    v_and_b32 v29, 1, v28
    v_xor_b32 v29, 1, v29
    v_lshlrev_b32 v29, 2, v29
    v_lshl_add_u32 v29, v28, 3, v29
    v_bfe_u32 v28, v20, 2, 2
    v_add_u32 v29, v29, v28
    v_lshlrev_b32 v29, 7, v29
    v_and_b32 v28, 3, v20
    v_lshl_add_u32 v29, v28, 4, v29
    v_and_b32 v28, 1, v28
    v_xor_b32 v28, 1, v28
    v_lshl_add_u32 v27, v28, 3, v29
    v_add_u32 v27, s23, v27
    s_waitcnt lgkmcnt(0)
    s_add_u32 m0, s23, 0
    s_nop 0
    buffer_load_dwordx4 v21, s[8:11], s21 offen lds
    s_add_u32 s21, s21, 16384
    s_add_u32 m0, s23, 1024
    s_nop 0
    buffer_load_dwordx4 v21, s[8:11], s21 offen lds
    s_add_u32 s21, s21, 16384
    s_add_u32 m0, s23, 2048
    s_nop 0
    buffer_load_dwordx4 v21, s[8:11], s21 offen lds
    s_add_u32 s21, s21, 16384
    s_add_u32 m0, s23, 3072
    s_nop 0
    buffer_load_dwordx4 v21, s[8:11], s21 offen lds
    s_add_u32 s21, s21, 16384
    s_add_u32 m0, s23, 4096
    s_nop 0
    buffer_load_dwordx4 v21, s[8:11], s21 offen lds
    s_add_u32 s21, s21, 16384
    s_add_u32 m0, s23, 5120
    s_nop 0
    buffer_load_dwordx4 v21, s[8:11], s21 offen lds
    s_add_u32 s21, s21, 16384
    s_add_u32 m0, s23, 6144
    s_nop 0
    buffer_load_dwordx4 v21, s[8:11], s21 offen lds
    s_add_u32 s21, s21, 16384
    s_add_u32 m0, s23, 7168
    s_nop 0
    buffer_load_dwordx4 v21, s[8:11], s21 offen lds
    s_add_u32 s21, s21, 16384
    buffer_load_dwordx4 v[98:101], v21, s[8:11], s21 offen
    s_add_u32 s21, s21, 16384
    buffer_load_dwordx4 v[102:105], v21, s[8:11], s21 offen
    s_add_u32 s21, s21, 16384
    buffer_load_dwordx4 v[106:109], v21, s[8:11], s21 offen
    s_add_u32 s21, s21, 16384
    buffer_load_dwordx4 v[110:113], v21, s[8:11], s21 offen
    s_add_u32 s21, s21, 16384
    buffer_load_dwordx4 v[114:117], v21, s[8:11], s21 offen
    s_add_u32 s21, s21, 16384
    buffer_load_dwordx4 v[118:121], v21, s[8:11], s21 offen
    s_add_u32 s21, s21, 16384
    buffer_load_dwordx4 v[122:125], v21, s[8:11], s21 offen
    s_add_u32 s21, s21, 16384
    buffer_load_dwordx4 v[126:129], v21, s[8:11], s21 offen
    s_add_u32 s21, s21, 16384
    v_add_u32 v30, s23, v0
    s_waitcnt vmcnt(8)
    ds_read_b64_tr_b16 v[192:193], v24 offset:0
    ds_read_b64_tr_b16 v[194:195], v25 offset:0
    ds_read_b64_tr_b16 v[200:201], v26 offset:0
    ds_read_b64_tr_b16 v[202:203], v27 offset:0
    ds_read_b64_tr_b16 v[208:209], v24 offset:64
    ds_read_b64_tr_b16 v[210:211], v25 offset:64
    ds_read_b64_tr_b16 v[216:217], v26 offset:64
    ds_read_b64_tr_b16 v[218:219], v27 offset:64
    s_waitcnt lgkmcnt(0)
    ds_read_b64_tr_b16 v[196:197], v24 offset:4096
    ds_read_b64_tr_b16 v[198:199], v25 offset:4096
    ds_read_b64_tr_b16 v[204:205], v26 offset:4096
    ds_read_b64_tr_b16 v[206:207], v27 offset:4096
    ds_read_b64_tr_b16 v[212:213], v24 offset:4160
    ds_read_b64_tr_b16 v[214:215], v25 offset:4160
    ds_read_b64_tr_b16 v[220:221], v26 offset:4160
    ds_read_b64_tr_b16 v[222:223], v27 offset:4160
    s_waitcnt lgkmcnt(0)
    s_waitcnt vmcnt(0)
    ds_write_b128 v30, v[98:101] offset:0
    ds_write_b128 v30, v[102:105] offset:1024
    ds_write_b128 v30, v[106:109] offset:2048
    ds_write_b128 v30, v[110:113] offset:3072
    ds_write_b128 v30, v[114:117] offset:4096
    ds_write_b128 v30, v[118:121] offset:5120
    ds_write_b128 v30, v[122:125] offset:6144
    ds_write_b128 v30, v[126:129] offset:7168
    s_waitcnt lgkmcnt(0)
    ds_read_b64_tr_b16 v[224:225], v24 offset:0
    ds_read_b64_tr_b16 v[226:227], v25 offset:0
    ds_read_b64_tr_b16 v[232:233], v26 offset:0
    ds_read_b64_tr_b16 v[234:235], v27 offset:0
    ds_read_b64_tr_b16 v[240:241], v24 offset:64
    ds_read_b64_tr_b16 v[242:243], v25 offset:64
    ds_read_b64_tr_b16 v[248:249], v26 offset:64
    ds_read_b64_tr_b16 v[250:251], v27 offset:64
    s_waitcnt lgkmcnt(0)
    ds_read_b64_tr_b16 v[228:229], v24 offset:4096
    ds_read_b64_tr_b16 v[230:231], v25 offset:4096
    ds_read_b64_tr_b16 v[236:237], v26 offset:4096
    ds_read_b64_tr_b16 v[238:239], v27 offset:4096
    ds_read_b64_tr_b16 v[244:245], v24 offset:4160
    ds_read_b64_tr_b16 v[246:247], v25 offset:4160
    ds_read_b64_tr_b16 v[252:253], v26 offset:4160
    ds_read_b64_tr_b16 v[254:255], v27 offset:4160
    s_waitcnt lgkmcnt(0)
    v_lshrrev_b32 v21, 4, v20
    s_mul_i32 s21, s25, 18560
    s_add_u32 s21, s21, 16384
    v_add_u32 v1, s21, v0
    v_and_b32 v23, 15, v20
    v_mul_u32_u24 v21, 136, v21
    v_lshl_add_u32 v21, v23, 3, v21
    v_add_u32 v45, s21, v21
    s_lshl_b32 s53, s25, 13
    s_add_u32 s53, s53, 92160
    v_add_u32 v49, s53, v0
    v_mov_b32 v48, 0
    v_mov_b32 v4, 0x3f803f80
    v_mov_b32 v5, 0x3f803f80
    v_mov_b32 v6, 0x3f803f80
    v_mov_b32 v7, 0x3f803f80
    v_mov_b32 v8, 0
    v_mov_b32 v9, 0
    v_mov_b32 v10, 0
    v_mov_b32 v11, 0
    v_lshlrev_b32 v43, 2, v20
    v_mov_b32 v26, 0x44444444
    v_mov_b32 v27, 0xeeeeeeee
    v_and_b32 v28, 1, v20
    v_cmp_eq_u32 vcc, 0, v28
    s_mov_b32 s47, 0x3e0293ee
    s_lshl_b32 s32, s12, 15
    v_cndmask_b32 v41, v27, v26, vcc
    s_lshl_b32 s21, s25, 13
    s_add_u32 s32, s32, s21
    s_add_u32 s32, s32, 2097152
    s_lshl_b32 s21, s25, 2
    s_add_u32 s21, s21, 13312
    v_mov_b32 v47, s21
    s_lshl_b32 s27, s13, 2
    s_add_u32 s27, s27, s25
    s_lshl_b32 s62, s12, 7
    s_add_u32 s62, s62, 218112000
    s_lshl_b32 s33, s12, 14
    s_lshl_b32 s21, s25, 12
    s_add_u32 s33, s33, s21
    s_add_u32 s33, s33, 1179648
    v_mov_b32 v139, 0
    v_mov_b32 v140, 0
    v_mov_b32 v141, 0
    v_mov_b32 v143, 0
    v_mov_b32 v144, 0
    v_mov_b32 v145, 0
    v_mov_b32 v40, 0
    v_mov_b32 v42, 0
    v_mov_b32 v44, 0
    v_mov_b32 v46, 0
    v_mov_b32 v158, 0x7f800000
    s_mov_b32 exec_lo, 0xcccccccc
    s_mov_b32 exec_hi, 0xcccccccc
    v_mov_b32 v158, 0x42700000
    s_mov_b64 exec, -1
    s_cmp_lg_u32 s3, 4
    s_cbranch_scc1 ch_xcc_skip
    v_add_u32 v56, 128, v43
    s_movk_i32 s21, 192
    v_writelane_b32 v56, s21, 4
    v_mov_b32 v59, 63
    v_writelane_b32 v59, -1, 4
    v_mov_b32 v60, 32
    s_mov_b64 exec, 0x1f
ch_xcc:
    buffer_load_dword v57, v56, s[64:67], 0 offen sc1
    s_waitcnt vmcnt(0)
    v_and_b32 v62, v59, v57
    v_cmp_ne_u32 vcc, v62, v60
    s_cbranch_vccz ch_xcc_ok
    s_sleep 16
    s_sub_u32 s26, s26, 1
    s_cbranch_scc0 ch_xcc
    s_mov_b32 s26, 0
ch_xcc_ok:
    s_lshr_b32 s22, s12, 1
    v_readlane_b32 s23, v57, 0
    s_nop 2
    v_readlane_b32 s21, v57, s22
    s_mov_b64 exec, -1
    v_mov_b32 v58, 131072
    v_mov_b32 v57, s21
    ds_write_b32 v58, v57
    s_bfe_u32 s23, s23, 0x1000f
    v_and_b32 v60, 0x70, v0
    v_lshlrev_b32 v60, 3, v60
    s_mov_b32 s22, 218112000
ch_pgv:
    buffer_load_dword v61, v60, s[4:7], s22 offen offset:8 sc1
    s_waitcnt vmcnt(0) lgkmcnt(0)
    v_and_b32 v62, 1, v61
    v_cmp_eq_u32 vcc, 0, v62
    s_cbranch_vccz ch_pgvok
    s_sleep 8
    s_sub_u32 s26, s26, 1
    s_cbranch_scc0 ch_pgv
    s_mov_b32 s26, 0
ch_pgvok:
    v_bfe_u32 v62, v61, 1, 1
    v_ashrrev_i32 v61, 8, v61
    v_sub_u32 v59, 0, v61
    v_cmp_eq_u32 vcc, s23, v62
    s_mov_b32 s21, 0
    s_nop 1
    v_cndmask_b32 v61, v59, v61, vcc
    s_nop 1
    v_readlane_b32 s22, v61, 0
    s_add_i32 s21, s21, s22
    v_readlane_b32 s22, v61, 1
    s_add_i32 s21, s21, s22
    v_readlane_b32 s22, v61, 2
    s_add_i32 s21, s21, s22
    v_readlane_b32 s22, v61, 3
    s_add_i32 s21, s21, s22
    v_readlane_b32 s22, v61, 4
    s_add_i32 s21, s21, s22
    v_readlane_b32 s22, v61, 5
    s_add_i32 s21, s21, s22
    v_readlane_b32 s22, v61, 6
    s_add_i32 s21, s21, s22
    v_readlane_b32 s22, v61, 7
    s_add_i32 s21, s21, s22
    s_cmp_gt_i32 s21, 0
    s_cselect_b32 s21, 0x2000, 0
    v_mov_b32 v59, s21
    ds_write_b32 v58, v59 offset:4
    s_waitcnt lgkmcnt(0)
ch_xcc_skip:
    s_barrier
    s_barrier
    s_lshl_b32 s60, s12, 4
    s_add_u32 s60, s60, 218104320
    s_barrier
ch_g0:
    buffer_load_dword v57, off, s[4:7], s60 sc1
    s_waitcnt vmcnt(0)
    v_readfirstlane_b32 s21, v57
    s_cmp_ge_u32 s21, 12
    s_cbranch_scc1 ch_g0b
    s_sleep 8
    s_sub_u32 s26, s26, 1
    s_cbranch_scc0 ch_g0
    s_mov_b32 s26, 0
ch_g0b:
    s_add_u32 s21, s16, 0
    s_lshl_b32 s21, s21, 18
    s_add_u32 s21, s21, s46
    s_add_u32 s21, s21, 37748736
    s_add_u32 s22, s21, 131072
    buffer_load_dwordx4 v[160:163], v0, s[4:7], s21 offen offset:0 sc1
    buffer_load_dwordx4 v[164:167], v0, s[4:7], s21 offen offset:1024 sc1
    buffer_load_dwordx4 v[168:171], v0, s[4:7], s21 offen offset:2048 sc1
    buffer_load_dwordx4 v[172:175], v0, s[4:7], s21 offen offset:3072 sc1
    buffer_load_dwordx4 v[176:179], v0, s[4:7], s22 offen offset:0 sc1
    buffer_load_dwordx4 v[180:183], v0, s[4:7], s22 offen offset:1024 sc1
    buffer_load_dwordx4 v[184:187], v0, s[4:7], s22 offen offset:2048 sc1
    buffer_load_dwordx4 v[188:191], v0, s[4:7], s22 offen offset:3072 sc1
    s_add_u32 s21, s16, 0
    s_lshl_b32 s21, s21, 18
    s_add_u32 s21, s21, s46
    s_add_u32 s21, s21, 20971520
    s_add_u32 s22, s21, 131072
    buffer_load_dwordx4 v[98:101], v0, s[4:7], s21 offen offset:0 sc1
    buffer_load_dwordx4 v[102:105], v0, s[4:7], s21 offen offset:1024 sc1
    buffer_load_dwordx4 v[106:109], v0, s[4:7], s21 offen offset:2048 sc1
    buffer_load_dwordx4 v[110:113], v0, s[4:7], s21 offen offset:3072 sc1
    buffer_load_dwordx4 v[114:117], v0, s[4:7], s22 offen offset:0 sc1
    buffer_load_dwordx4 v[118:121], v0, s[4:7], s22 offen offset:1024 sc1
    buffer_load_dwordx4 v[122:125], v0, s[4:7], s22 offen offset:2048 sc1
    buffer_load_dwordx4 v[126:129], v0, s[4:7], s22 offen offset:3072 sc1
    s_waitcnt vmcnt(8)
    v_mfma_f32_16x16x32_bf16 v[50:53], v[160:163], v[192:195], 0
    v_mfma_f32_16x16x32_bf16 v[54:57], v[160:163], v[200:203], 0
    v_mfma_f32_16x16x32_bf16 v[58:61], v[160:163], v[208:211], 0
    v_mfma_f32_16x16x32_bf16 v[62:65], v[160:163], v[216:219], 0
    v_mfma_f32_16x16x32_bf16 v[66:69], v[176:179], v[192:195], 0
    v_mfma_f32_16x16x32_bf16 v[70:73], v[176:179], v[200:203], 0
    v_mfma_f32_16x16x32_bf16 v[74:77], v[176:179], v[208:211], 0
    v_mfma_f32_16x16x32_bf16 v[78:81], v[176:179], v[216:219], 0
    v_mfma_f32_16x16x32_bf16 v[50:53], v[164:167], v[196:199], v[50:53]
    v_mfma_f32_16x16x32_bf16 v[54:57], v[164:167], v[204:207], v[54:57]
    v_mfma_f32_16x16x32_bf16 v[58:61], v[164:167], v[212:215], v[58:61]
    v_mfma_f32_16x16x32_bf16 v[62:65], v[164:167], v[220:223], v[62:65]
    v_mfma_f32_16x16x32_bf16 v[66:69], v[180:183], v[196:199], v[66:69]
    v_mfma_f32_16x16x32_bf16 v[70:73], v[180:183], v[204:207], v[70:73]
    v_mfma_f32_16x16x32_bf16 v[74:77], v[180:183], v[212:215], v[74:77]
    v_mfma_f32_16x16x32_bf16 v[78:81], v[180:183], v[220:223], v[78:81]
    v_mfma_f32_16x16x32_bf16 v[50:53], v[168:171], v[224:227], v[50:53]
    v_mfma_f32_16x16x32_bf16 v[54:57], v[168:171], v[232:235], v[54:57]
    v_mfma_f32_16x16x32_bf16 v[58:61], v[168:171], v[240:243], v[58:61]
    v_mfma_f32_16x16x32_bf16 v[62:65], v[168:171], v[248:251], v[62:65]
    v_mfma_f32_16x16x32_bf16 v[66:69], v[184:187], v[224:227], v[66:69]
    v_mfma_f32_16x16x32_bf16 v[70:73], v[184:187], v[232:235], v[70:73]
    v_mfma_f32_16x16x32_bf16 v[74:77], v[184:187], v[240:243], v[74:77]
    v_mfma_f32_16x16x32_bf16 v[78:81], v[184:187], v[248:251], v[78:81]
    v_mfma_f32_16x16x32_bf16 v[50:53], v[172:175], v[228:231], v[50:53]
    v_mfma_f32_16x16x32_bf16 v[54:57], v[172:175], v[236:239], v[54:57]
    v_mfma_f32_16x16x32_bf16 v[58:61], v[172:175], v[244:247], v[58:61]
    v_mfma_f32_16x16x32_bf16 v[62:65], v[172:175], v[252:255], v[62:65]
    v_mfma_f32_16x16x32_bf16 v[66:69], v[188:191], v[228:231], v[66:69]
    v_mfma_f32_16x16x32_bf16 v[70:73], v[188:191], v[236:239], v[70:73]
    v_mfma_f32_16x16x32_bf16 v[74:77], v[188:191], v[244:247], v[74:77]
    v_mfma_f32_16x16x32_bf16 v[78:81], v[188:191], v[252:255], v[78:81]
    s_add_u32 s21, s16, 1
    s_lshl_b32 s21, s21, 18
    s_add_u32 s21, s21, s46
    s_add_u32 s21, s21, 37748736
    s_add_u32 s22, s21, 131072
    buffer_load_dwordx4 v[160:163], v0, s[4:7], s21 offen offset:0 sc1
    buffer_load_dwordx4 v[164:167], v0, s[4:7], s21 offen offset:1024 sc1
    buffer_load_dwordx4 v[168:171], v0, s[4:7], s21 offen offset:2048 sc1
    buffer_load_dwordx4 v[172:175], v0, s[4:7], s21 offen offset:3072 sc1
    buffer_load_dwordx4 v[176:179], v0, s[4:7], s22 offen offset:0 sc1
    buffer_load_dwordx4 v[180:183], v0, s[4:7], s22 offen offset:1024 sc1
    buffer_load_dwordx4 v[184:187], v0, s[4:7], s22 offen offset:2048 sc1
    buffer_load_dwordx4 v[188:191], v0, s[4:7], s22 offen offset:3072 sc1
    s_mov_b32 s34, 1
    s_nop 7
    v_cvt_pk_bf16_f32 v82, v50, v51
    v_cvt_pk_bf16_f32 v83, v52, v53
    v_cvt_pk_bf16_f32 v84, v66, v67
    v_cvt_pk_bf16_f32 v85, v68, v69
    v_cvt_pk_bf16_f32 v86, v54, v55
    v_cvt_pk_bf16_f32 v87, v56, v57
    v_cvt_pk_bf16_f32 v88, v70, v71
    v_cvt_pk_bf16_f32 v89, v72, v73
    v_cvt_pk_bf16_f32 v90, v58, v59
    v_cvt_pk_bf16_f32 v91, v60, v61
    v_cvt_pk_bf16_f32 v92, v74, v75
    v_cvt_pk_bf16_f32 v93, v76, v77
    v_cvt_pk_bf16_f32 v94, v62, v63
    v_cvt_pk_bf16_f32 v95, v64, v65
    v_cvt_pk_bf16_f32 v96, v78, v79
    v_cvt_pk_bf16_f32 v97, v80, v81
    v_mov_b32 v74, 0
    v_mov_b32 v75, 0
    v_mov_b32 v76, 0
    v_mov_b32 v77, 0
    v_mov_b32 v78, 0
    v_mov_b32 v79, 0
    v_mov_b32 v80, 0
    v_mov_b32 v81, 0
    v_mov_b32 v146, 0
    v_mov_b32 v147, 0
    v_mov_b32 v148, 0
    v_mov_b32 v149, 0
    v_mov_b32 v150, 0
    v_mov_b32 v151, 0
    v_mov_b32 v152, 0
    v_mov_b32 v153, 0
    v_mov_b32 v12, 0
    v_mov_b32 v13, 0
    v_mov_b32 v14, 0
    v_mov_b32 v15, 0
    v_mov_b32 v16, 0
    v_mov_b32 v17, 0
    v_mov_b32 v18, 0
    v_mov_b32 v19, 0
    v_mov_b32 v20, 0
    v_mov_b32 v21, 0
    v_mov_b32 v22, 0
    v_mov_b32 v23, 0
    v_mov_b32 v2, 0
    s_add_u32 s21, s17, s32
    s_add_u32 s22, s21, 4096
    s_setprio 2
    s_branch a_zl
.p2align 6
    s_nop 0
    s_nop 0
    s_nop 0
    s_nop 0
    s_nop 0
    s_nop 0
    s_nop 0
    s_nop 0
aloop_24:
    s_add_u32 s21, s17, s32
    s_add_u32 s22, s21, 4096
    v_mov_b32 v74, 0
    v_mov_b32 v75, 0
    v_mov_b32 v76, 0
    v_mov_b32 v77, 0
    v_mov_b32 v78, 0
    v_mov_b32 v79, 0
    v_mov_b32 v80, 0
    v_mov_b32 v81, 0
    v_mov_b32 v146, 0
    v_mov_b32 v147, 0
    v_mov_b32 v148, 0
    v_mov_b32 v149, 0
    v_mov_b32 v150, 0
    v_mov_b32 v151, 0
    v_mov_b32 v152, 0
    v_mov_b32 v153, 0
    s_add_u32 s30, s16, 1
    s_lshl_b32 s30, s30, 18
    s_add_u32 s30, s30, s46
    s_add_u32 s30, s30, 37748736
    s_add_u32 s31, s30, 131072
aloop_24_wm:
    ds_read_b32 v3, v47
    s_waitcnt lgkmcnt(0)
    v_readfirstlane_b32 s23, v3
    s_cmp_eq_u32 s23, s16
    s_cbranch_scc1 aloop_24_wmok
    s_sleep 1
    s_branch aloop_24_wm
aloop_24_wmok:
    buffer_load_dwordx4 v[160:163], v0, s[4:7], s30 offen offset:0 sc1
    buffer_load_dwordx4 v[164:167], v0, s[4:7], s30 offen offset:1024 sc1
    buffer_load_dwordx4 v[168:171], v0, s[4:7], s30 offen offset:2048 sc1
    buffer_load_dwordx4 v[172:175], v0, s[4:7], s30 offen offset:3072 sc1
    buffer_load_dwordx4 v[176:179], v0, s[4:7], s31 offen offset:0 sc1
    buffer_load_dwordx4 v[180:183], v0, s[4:7], s31 offen offset:1024 sc1
    buffer_load_dwordx4 v[184:187], v0, s[4:7], s31 offen offset:2048 sc1
    buffer_load_dwordx4 v[188:191], v0, s[4:7], s31 offen offset:3072 sc1
aloop_24_nv:
    s_setprio 2
    v_mov_b32 v2, s16
    s_barrier
    s_nop 15
    s_nop 13
    ds_read_b128 v[98:101], v49 offset:0
    ds_read_b128 v[102:105], v49 offset:1024
    ds_read_b128 v[106:109], v49 offset:2048
    ds_read_b128 v[110:113], v49 offset:3072
    ds_read_b128 v[114:117], v49 offset:4096
    ds_read_b128 v[118:121], v49 offset:5120
    ds_read_b128 v[122:125], v49 offset:6144
    ds_read_b128 v[126:129], v49 offset:7168
    v_mov_b32 v12, 0
    v_mov_b32 v13, 0
    v_mov_b32 v14, 0
    v_mov_b32 v15, 0
    v_mov_b32 v16, 0
    v_mov_b32 v17, 0
    v_mov_b32 v18, 0
    v_mov_b32 v19, 0
    v_mov_b32 v20, 0
    v_mov_b32 v21, 0
    v_mov_b32 v22, 0
    v_mov_b32 v23, 0
    s_sleep 3
    s_nop 13
a_zl:
    buffer_load_dwordx4 v[50:53], v0, s[4:7], s21 offen offset:0 sc1
    s_nop 7
    buffer_load_dwordx4 v[54:57], v0, s[4:7], s21 offen offset:1024 sc1
    s_nop 7
    buffer_load_dwordx4 v[58:61], v0, s[4:7], s21 offen offset:2048 sc1
    s_nop 7
    buffer_load_dwordx4 v[62:65], v0, s[4:7], s21 offen offset:3072 sc1
    s_nop 7
    buffer_load_dwordx4 v[66:69], v0, s[4:7], s22 offen offset:0 sc1
    s_nop 7
    buffer_load_dwordx4 v[70:73], v0, s[4:7], s22 offen offset:1024 sc1
    s_waitcnt lgkmcnt(0)
    s_waitcnt vmcnt(5)
    v_max3_u32 v3, v50, v51, v52
    v_max_u32 v3, v3, v53
    v_cmp_eq_u32 vcc, -1, v3
    s_cbranch_vccnz arq_25_0
arq_25_0ok:
    v_mfma_f32_16x16x32_bf16 v[12:15], v[98:101], v[50:53], v[12:15]
    v_mfma_f32_16x16x32_bf16 v[16:19], v[114:117], v[50:53], v[16:19]
    s_waitcnt vmcnt(4)
    v_max3_u32 v3, v54, v55, v56
    v_max_u32 v3, v3, v57
    v_cmp_eq_u32 vcc, -1, v3
    v_mfma_f32_16x16x32_bf16 v[20:23], v[50:53], v[50:53], v[20:23]
    s_cbranch_vccnz arq_25_1
arq_25_1ok:
    v_mfma_f32_16x16x32_bf16 v[12:15], v[102:105], v[54:57], v[12:15]
    v_mfma_f32_16x16x32_bf16 v[16:19], v[118:121], v[54:57], v[16:19]
    s_waitcnt vmcnt(3)
    v_max3_u32 v3, v58, v59, v60
    v_max_u32 v3, v3, v61
    v_cmp_eq_u32 vcc, -1, v3
    v_mfma_f32_16x16x32_bf16 v[20:23], v[54:57], v[54:57], v[20:23]
    s_cbranch_vccnz arq_25_2
arq_25_2ok:
    v_mfma_f32_16x16x32_bf16 v[12:15], v[106:109], v[58:61], v[12:15]
    v_mfma_f32_16x16x32_bf16 v[16:19], v[122:125], v[58:61], v[16:19]
    s_waitcnt vmcnt(2)
    v_max3_u32 v3, v62, v63, v64
    v_max_u32 v3, v3, v65
    v_cmp_eq_u32 vcc, -1, v3
    v_mfma_f32_16x16x32_bf16 v[20:23], v[58:61], v[58:61], v[20:23]
    s_cbranch_vccnz arq_25_3
arq_25_3ok:
    v_mfma_f32_16x16x32_bf16 v[12:15], v[110:113], v[62:65], v[12:15]
    ds_write_b32 v47, v2 offset:16
    v_mfma_f32_16x16x32_bf16 v[16:19], v[126:129], v[62:65], v[16:19]
    v_mfma_f32_16x16x32_bf16 v[20:23], v[62:65], v[62:65], v[20:23]
aloop_24_sdone:
    s_nop 0
    s_cmp_eq_u32 s16, 63
    s_cbranch_scc1 aloop_24_lsk
    s_nop 1
    v_exp_f32 v54, v12
    v_exp_f32 v55, v13
    s_waitcnt vmcnt(0)
    v_max3_u32 v24, v66, v67, v68
    v_max3_u32 v24, v24, v69, v70
    v_max3_u32 v24, v24, v71, v72
    v_max_u32 v24, v24, v73
    v_cmp_eq_u32 vcc, -1, v24
    s_cbranch_vccnz arq_25_v
    v_smfmac_f32_16x16x64_bf16 v[74:77], v[66:69], v[192:199], v41
    v_exp_f32 v56, v14
    v_smfmac_f32_16x16x64_bf16 v[78:81], v[66:69], v[200:207], v41
    v_exp_f32 v57, v15
    v_smfmac_f32_16x16x64_bf16 v[146:149], v[66:69], v[208:215], v41
    v_exp_f32 v58, v16
    v_smfmac_f32_16x16x64_bf16 v[150:153], v[66:69], v[216:223], v41
    v_exp_f32 v59, v17
    v_smfmac_f32_16x16x64_bf16 v[74:77], v[70:73], v[224:231], v41
    v_exp_f32 v60, v18
    v_smfmac_f32_16x16x64_bf16 v[78:81], v[70:73], v[232:239], v41
    v_exp_f32 v61, v19
    v_smfmac_f32_16x16x64_bf16 v[146:149], v[70:73], v[240:247], v41
    v_exp_f32 v62, v20
    v_smfmac_f32_16x16x64_bf16 v[150:153], v[70:73], v[248:255], v41
    v_exp_f32 v63, v21
    v_cvt_pk_bf16_f32 v154, v54, v55
    v_cvt_pk_bf16_f32 v155, v56, v57
    v_cvt_pk_bf16_f32 v156, v58, v59
    v_cvt_pk_bf16_f32 v157, v60, v61
    v_cvt_pk_bf16_f32 v8, v62, v63
    v_max3_f32 v2, |v12|, |v13|, |v14|
    v_mfma_f32_16x16x32_bf16 v[50:53], v[154:157], v[4:7], 0
    v_max3_f32 v3, |v15|, |v16|, |v17|
    v_add_f32 v74, v74, v75
    v_mfma_f32_16x16x32_bf16 v[50:53], v[8:11], v[4:7], v[50:53]
    v_add_f32 v76, v76, v77
    v_cvt_pk_bf16_f32 v40, v74, v76
    v_mfma_f32_16x16x32_bf16 v[24:27], v[154:157], v[82:85], 0
    v_add_f32 v78, v78, v79
    v_add_f32 v80, v80, v81
    v_mfma_f32_16x16x32_bf16 v[24:27], v[8:11], v[40:43], v[24:27]
    v_cvt_pk_bf16_f32 v42, v78, v80
    v_add_f32 v146, v146, v147
    v_mfma_f32_16x16x32_bf16 v[28:31], v[154:157], v[86:89], 0
    v_add_f32 v148, v148, v149
    v_cvt_pk_bf16_f32 v44, v146, v148
    v_mfma_f32_16x16x32_bf16 v[28:31], v[8:11], v[42:45], v[28:31]
    v_add_f32 v150, v150, v151
    v_add_f32 v152, v152, v153
    v_mfma_f32_16x16x32_bf16 v[32:35], v[154:157], v[90:93], 0
    v_cvt_pk_bf16_f32 v46, v150, v152
    v_rcp_f32 v52, v52
    v_mfma_f32_16x16x32_bf16 v[32:35], v[8:11], v[44:47], v[32:35]
    v_rcp_f32 v53, v53
    v_max3_f32 v2, v2, |v18|, |v19|
    v_mfma_f32_16x16x32_bf16 v[36:39], v[154:157], v[94:97], 0
    v_max3_f32 v3, v3, |v20|, |v21|
    v_max_f32 v2, v2, v3
    v_mfma_f32_16x16x32_bf16 v[36:39], v[8:11], v[46:49], v[36:39]
    v_cmp_nle_f32 vcc, v2, v158
    v_mul_f32 v26, v26, v52
    v_mul_f32 v27, v27, v53
    s_cbranch_vccnz aloop_24_tm
    v_mul_f32 v30, v30, v52
    v_mul_f32 v31, v31, v53
aloop_24_pvd:
    ds_write_b64 v45, v[26:27] offset:0
    v_mul_f32 v34, v34, v52
    v_mul_f32 v35, v35, v53
    ds_write_b64 v45, v[30:31] offset:544
    v_mul_f32 v38, v38, v52
    v_mul_f32 v39, v39, v53
    ds_write_b64 v45, v[34:35] offset:1088
    ds_write_b64 v45, v[38:39] offset:1632
aloop_24_lskb:
    s_waitcnt lgkmcnt(0)
    s_barrier
    s_setprio 0
    s_cmp_lg_u32 s27, 0
    s_cbranch_scc1 pg_26
    s_sub_u32 s25, s16, 1
    s_cbranch_scc1 pg_26
    v_mov_b32 v3, s25
    s_mov_b64 exec, 1
    buffer_store_dword v3, off, s[4:7], s62 sc1
    s_mov_b64 exec, -1
pg_26:
    s_add_u32 s21, s17, s33
    v_lshlrev_b32 v2, 1, v43
    s_cmp_eq_u32 s16, 63
    s_cbranch_scc1 aloop_24_nvw
    v_mfma_f32_16x16x32_bf16 v[50:53], v[160:163], v[192:195], 0
    v_mfma_f32_16x16x32_bf16 v[54:57], v[160:163], v[200:203], 0
    v_mfma_f32_16x16x32_bf16 v[58:61], v[160:163], v[208:211], 0
    v_mfma_f32_16x16x32_bf16 v[62:65], v[160:163], v[216:219], 0
    v_mfma_f32_16x16x32_bf16 v[66:69], v[176:179], v[192:195], 0
    v_mfma_f32_16x16x32_bf16 v[70:73], v[176:179], v[200:203], 0
    v_mfma_f32_16x16x32_bf16 v[74:77], v[176:179], v[208:211], 0
    v_mfma_f32_16x16x32_bf16 v[78:81], v[176:179], v[216:219], 0
    v_mfma_f32_16x16x32_bf16 v[50:53], v[164:167], v[196:199], v[50:53]
    v_mfma_f32_16x16x32_bf16 v[54:57], v[164:167], v[204:207], v[54:57]
    v_mfma_f32_16x16x32_bf16 v[58:61], v[164:167], v[212:215], v[58:61]
    v_mfma_f32_16x16x32_bf16 v[62:65], v[164:167], v[220:223], v[62:65]
    v_mfma_f32_16x16x32_bf16 v[66:69], v[180:183], v[196:199], v[66:69]
    v_mfma_f32_16x16x32_bf16 v[70:73], v[180:183], v[204:207], v[70:73]
    v_mfma_f32_16x16x32_bf16 v[74:77], v[180:183], v[212:215], v[74:77]
    v_mfma_f32_16x16x32_bf16 v[78:81], v[180:183], v[220:223], v[78:81]
    v_mfma_f32_16x16x32_bf16 v[50:53], v[168:171], v[224:227], v[50:53]
    v_mfma_f32_16x16x32_bf16 v[54:57], v[168:171], v[232:235], v[54:57]
    v_mfma_f32_16x16x32_bf16 v[58:61], v[168:171], v[240:243], v[58:61]
    v_mfma_f32_16x16x32_bf16 v[62:65], v[168:171], v[248:251], v[62:65]
    v_mfma_f32_16x16x32_bf16 v[66:69], v[184:187], v[224:227], v[66:69]
    v_mfma_f32_16x16x32_bf16 v[70:73], v[184:187], v[232:235], v[70:73]
    v_mfma_f32_16x16x32_bf16 v[74:77], v[184:187], v[240:243], v[74:77]
    v_mfma_f32_16x16x32_bf16 v[78:81], v[184:187], v[248:251], v[78:81]
    v_mfma_f32_16x16x32_bf16 v[50:53], v[172:175], v[228:231], v[50:53]
    v_mfma_f32_16x16x32_bf16 v[54:57], v[172:175], v[236:239], v[54:57]
    v_mfma_f32_16x16x32_bf16 v[58:61], v[172:175], v[244:247], v[58:61]
    v_mfma_f32_16x16x32_bf16 v[62:65], v[172:175], v[252:255], v[62:65]
    v_mfma_f32_16x16x32_bf16 v[66:69], v[188:191], v[228:231], v[66:69]
    v_mfma_f32_16x16x32_bf16 v[70:73], v[188:191], v[236:239], v[70:73]
    v_mfma_f32_16x16x32_bf16 v[74:77], v[188:191], v[244:247], v[74:77]
    v_mfma_f32_16x16x32_bf16 v[78:81], v[188:191], v[252:255], v[78:81]
    buffer_load_dwordx4 v[130:133], v0, s[4:7], s21 offen sc1
    buffer_load_dwordx2 v[146:147], v2, s[4:7], s21 offen offset:1024 sc1
    buffer_load_dwordx4 v[134:137], v0, s[4:7], s21 offen offset:2048 sc1
    buffer_load_dwordx2 v[148:149], v2, s[4:7], s21 offen offset:3072 sc1
    s_add_u32 s30, s16, 2
    s_lshl_b32 s30, s30, 18
    s_add_u32 s30, s30, s46
    s_add_u32 s30, s30, 37748736
    s_add_u32 s31, s30, 131072
    s_branch aloop_24_vwd
aloop_24_nvw:
    buffer_load_dwordx4 v[130:133], v0, s[4:7], s21 offen sc1
    buffer_load_dwordx2 v[146:147], v2, s[4:7], s21 offen offset:1024 sc1
    buffer_load_dwordx4 v[134:137], v0, s[4:7], s21 offen offset:2048 sc1
    buffer_load_dwordx2 v[148:149], v2, s[4:7], s21 offen offset:3072 sc1
aloop_24_vwd:
    v_add_u32 v48, s68, v1
    s_xor_b32 s68, s68, 8192
aloop_24_psa:
    s_waitcnt vmcnt(0)
    v_max3_u32 v3, v130, v131, v132
    v_max3_u32 v3, v3, v133, v134
    v_max3_u32 v3, v3, v135, v136
    v_max3_u32 v3, v3, v137, v146
    v_max3_u32 v3, v3, v147, v148
    v_max_u32 v3, v3, v149
    v_cmp_eq_u32 vcc, -1, v3
    s_cbranch_vccnz arq_25_ps
aloop_24_psok:
    v_mfma_f32_16x16x32_bf16 v[24:27], v[82:85], v[130:133], 0
    v_mfma_f32_16x16x32_bf16 v[28:31], v[86:89], v[130:133], 0
    v_mfma_f32_16x16x32_bf16 v[32:35], v[90:93], v[130:133], 0
    v_mfma_f32_16x16x32_bf16 v[36:39], v[94:97], v[130:133], 0
    v_mov_b32 v138, v146
    v_mfma_f32_16x16x32_bf16 v[12:15], v[82:85], v[134:137], 0
    v_mfma_f32_16x16x32_bf16 v[16:19], v[86:89], v[134:137], 0
    v_mfma_f32_16x16x32_bf16 v[20:23], v[90:93], v[134:137], 0
    v_mfma_f32_16x16x32_bf16 v[154:157], v[94:97], v[134:137], 0
    v_mov_b32 v142, v148
    v_mfma_f32_16x16x32_bf16 v[24:27], v[40:43], v[138:141], v[24:27]
    v_mfma_f32_16x16x32_bf16 v[28:31], v[42:45], v[138:141], v[28:31]
    v_mfma_f32_16x16x32_bf16 v[32:35], v[44:47], v[138:141], v[32:35]
    v_mfma_f32_16x16x32_bf16 v[36:39], v[46:49], v[138:141], v[36:39]
    v_mfma_f32_16x16x32_bf16 v[12:15], v[40:43], v[142:145], v[12:15]
    v_mfma_f32_16x16x32_bf16 v[16:19], v[42:45], v[142:145], v[16:19]
    v_mfma_f32_16x16x32_bf16 v[20:23], v[44:47], v[142:145], v[20:23]
    s_nop 1
    v_mfma_f32_16x16x32_bf16 v[154:157], v[46:49], v[142:145], v[154:157]
aloop_24_nev:
    ds_write_b128 v48, v[24:27] offset:2176
    v_cvt_pk_bf16_f32 v82, v50, v51
    v_cvt_pk_bf16_f32 v83, v52, v53
    ds_write_b128 v48, v[28:31] offset:3200
    v_cvt_pk_bf16_f32 v84, v66, v67
    v_cvt_pk_bf16_f32 v85, v68, v69
    ds_write_b128 v48, v[32:35] offset:4224
    v_cvt_pk_bf16_f32 v86, v54, v55
    v_cvt_pk_bf16_f32 v87, v56, v57
    ds_write_b128 v48, v[36:39] offset:5248
    v_cvt_pk_bf16_f32 v88, v70, v71
    v_cvt_pk_bf16_f32 v89, v72, v73
    ds_write_b128 v48, v[12:15] offset:6272
    v_cvt_pk_bf16_f32 v90, v58, v59
    v_cvt_pk_bf16_f32 v91, v60, v61
    ds_write_b128 v48, v[16:19] offset:7296
    v_cvt_pk_bf16_f32 v92, v74, v75
    v_cvt_pk_bf16_f32 v93, v76, v77
    ds_write_b128 v48, v[20:23] offset:8320
    v_cvt_pk_bf16_f32 v94, v62, v63
    v_cvt_pk_bf16_f32 v95, v64, v65
    ds_write_b128 v48, v[154:157] offset:9344
    v_cvt_pk_bf16_f32 v96, v78, v79
    v_cvt_pk_bf16_f32 v97, v80, v81
aloop_24_bgskip:
    s_waitcnt lgkmcnt(0)
    s_cmp_eq_u32 s16, 63
    s_cbranch_scc1 aloop_24_fin
    s_add_u32 s16, s16, 1
    s_mov_b32 s17, s18
    s_mov_b32 s18, s19
    s_mov_b32 s19, s20
    s_add_u32 s20, s20, 262144
    s_cmp_eq_u32 s20, 210763776
    s_cselect_b32 s20, 209715200, s20
    s_branch aloop_24
arq_25_0:
    s_sub_u32 s26, s26, 1
    s_cbranch_scc1 arq_25_0_g
    buffer_load_dwordx4 v[50:53], v0, s[4:7], s21 offen offset:0 sc1
    buffer_load_dwordx4 v[54:57], v0, s[4:7], s21 offen offset:1024 sc1
    buffer_load_dwordx4 v[58:61], v0, s[4:7], s21 offen offset:2048 sc1
    buffer_load_dwordx4 v[62:65], v0, s[4:7], s21 offen offset:3072 sc1
    buffer_load_dwordx4 v[66:69], v0, s[4:7], s22 offen offset:0 sc1
    buffer_load_dwordx4 v[70:73], v0, s[4:7], s22 offen offset:1024 sc1
    s_waitcnt vmcnt(5)
    v_max3_u32 v3, v50, v51, v52
    v_max_u32 v3, v3, v53
    v_cmp_eq_u32 vcc, -1, v3
    s_cbranch_vccnz arq_25_0
    s_branch arq_25_0ok
arq_25_0_g:
    s_mov_b32 s26, 0
    s_waitcnt vmcnt(0)
    s_branch arq_25_0ok
arq_25_1:
    s_sub_u32 s26, s26, 1
    s_cbranch_scc1 arq_25_1_g
    buffer_load_dwordx4 v[54:57], v0, s[4:7], s21 offen offset:1024 sc1
    buffer_load_dwordx4 v[58:61], v0, s[4:7], s21 offen offset:2048 sc1
    buffer_load_dwordx4 v[62:65], v0, s[4:7], s21 offen offset:3072 sc1
    buffer_load_dwordx4 v[66:69], v0, s[4:7], s22 offen offset:0 sc1
    buffer_load_dwordx4 v[70:73], v0, s[4:7], s22 offen offset:1024 sc1
    s_waitcnt vmcnt(4)
    v_max3_u32 v3, v54, v55, v56
    v_max_u32 v3, v3, v57
    v_cmp_eq_u32 vcc, -1, v3
    s_cbranch_vccnz arq_25_1
    s_branch arq_25_1ok
arq_25_1_g:
    s_mov_b32 s26, 0
    s_waitcnt vmcnt(0)
    s_branch arq_25_1ok
arq_25_2:
    s_sub_u32 s26, s26, 1
    s_cbranch_scc1 arq_25_2_g
    buffer_load_dwordx4 v[58:61], v0, s[4:7], s21 offen offset:2048 sc1
    buffer_load_dwordx4 v[62:65], v0, s[4:7], s21 offen offset:3072 sc1
    buffer_load_dwordx4 v[66:69], v0, s[4:7], s22 offen offset:0 sc1
    buffer_load_dwordx4 v[70:73], v0, s[4:7], s22 offen offset:1024 sc1
    s_waitcnt vmcnt(3)
    v_max3_u32 v3, v58, v59, v60
    v_max_u32 v3, v3, v61
    v_cmp_eq_u32 vcc, -1, v3
    s_cbranch_vccnz arq_25_2
    s_branch arq_25_2ok
arq_25_2_g:
    s_mov_b32 s26, 0
    s_waitcnt vmcnt(0)
    s_branch arq_25_2ok
arq_25_3:
    s_sub_u32 s26, s26, 1
    s_cbranch_scc1 arq_25_3_g
    buffer_load_dwordx4 v[62:65], v0, s[4:7], s21 offen offset:3072 sc1
    buffer_load_dwordx4 v[66:69], v0, s[4:7], s22 offen offset:0 sc1
    buffer_load_dwordx4 v[70:73], v0, s[4:7], s22 offen offset:1024 sc1
    s_waitcnt vmcnt(2)
    v_max3_u32 v3, v62, v63, v64
    v_max_u32 v3, v3, v65
    v_cmp_eq_u32 vcc, -1, v3
    s_cbranch_vccnz arq_25_3
    s_branch arq_25_3ok
arq_25_3_g:
    s_mov_b32 s26, 0
    s_waitcnt vmcnt(0)
    s_branch arq_25_3ok
arq_25_v:
    buffer_load_dwordx4 v[66:69], v0, s[4:7], s22 offen offset:0 sc1
    buffer_load_dwordx4 v[70:73], v0, s[4:7], s22 offen offset:1024 sc1
    v_max3_f32 v2, v12, v13, v14
    v_max3_f32 v3, v15, v16, v17
    v_max3_f32 v2, v2, v18, v19
    v_max3_f32 v3, v3, v20, v21
    v_max_f32 v2, v2, v3
    v_mov_b32 v3, v2
    s_nop 1
    v_permlane16_swap_b32 v3, v2
    v_max_f32 v2, v2, v3
    v_mov_b32 v3, v2
    s_nop 1
    v_permlane32_swap_b32 v3, v2
    v_max_f32 v2, v2, v3
    v_sub_f32 v12, v12, v2
    v_sub_f32 v13, v13, v2
    v_sub_f32 v14, v14, v2
    v_sub_f32 v15, v15, v2
    v_sub_f32 v16, v16, v2
    v_sub_f32 v17, v17, v2
    v_sub_f32 v18, v18, v2
    v_sub_f32 v19, v19, v2
    v_sub_f32 v20, v20, v2
    v_sub_f32 v21, v21, v2
    v_exp_f32 v54, v12
    v_exp_f32 v55, v13
    v_exp_f32 v56, v14
    v_exp_f32 v57, v15
    v_exp_f32 v58, v16
    v_exp_f32 v59, v17
    v_exp_f32 v60, v18
    v_exp_f32 v61, v19
    v_exp_f32 v62, v20
    v_exp_f32 v63, v21
    s_nop 0
    v_cvt_pk_bf16_f32 v154, v54, v55
    v_cvt_pk_bf16_f32 v155, v56, v57
    v_cvt_pk_bf16_f32 v156, v58, v59
    v_cvt_pk_bf16_f32 v157, v60, v61
    v_cvt_pk_bf16_f32 v8, v62, v63
    s_nop 0
    v_mfma_f32_16x16x32_bf16 v[50:53], v[154:157], v[4:7], 0
    v_mfma_f32_16x16x32_bf16 v[50:53], v[8:11], v[4:7], v[50:53]
    v_mfma_f32_16x16x32_bf16 v[24:27], v[154:157], v[82:85], 0
    v_mfma_f32_16x16x32_bf16 v[28:31], v[154:157], v[86:89], 0
    v_mfma_f32_16x16x32_bf16 v[32:35], v[154:157], v[90:93], 0
    v_mfma_f32_16x16x32_bf16 v[36:39], v[154:157], v[94:97], 0
arq_25_vs:
    s_waitcnt vmcnt(0)
    v_max3_u32 v3, v66, v67, v68
    v_max3_u32 v3, v3, v69, v70
    v_max3_u32 v3, v3, v71, v72
    v_max_u32 v3, v3, v73
    v_cmp_eq_u32 vcc, -1, v3
    s_cbranch_vccnz arq_25_vsr
    s_branch arq_25_vsok
arq_25_vsr:
    s_sub_u32 s26, s26, 1
    s_cbranch_scc1 arq_25_vsg
    buffer_load_dwordx4 v[66:69], v0, s[4:7], s22 offen offset:0 sc1
    buffer_load_dwordx4 v[70:73], v0, s[4:7], s22 offen offset:1024 sc1
    s_branch arq_25_vs
arq_25_vsg:
    s_mov_b32 s26, 0
arq_25_vsok:
    v_smfmac_f32_16x16x64_bf16 v[74:77], v[66:69], v[192:199], v41
    v_smfmac_f32_16x16x64_bf16 v[78:81], v[66:69], v[200:207], v41
    v_smfmac_f32_16x16x64_bf16 v[146:149], v[66:69], v[208:215], v41
    v_smfmac_f32_16x16x64_bf16 v[150:153], v[66:69], v[216:223], v41
    v_smfmac_f32_16x16x64_bf16 v[74:77], v[70:73], v[224:231], v41
    v_smfmac_f32_16x16x64_bf16 v[78:81], v[70:73], v[232:239], v41
    v_smfmac_f32_16x16x64_bf16 v[146:149], v[70:73], v[240:247], v41
    v_smfmac_f32_16x16x64_bf16 v[150:153], v[70:73], v[248:255], v41
    v_rcp_f32 v52, v52
    v_rcp_f32 v53, v53
    s_nop 2
    v_add_f32 v74, v74, v75
    v_add_f32 v76, v76, v77
    v_cvt_pk_bf16_f32 v40, v74, v76
    v_add_f32 v78, v78, v79
    v_add_f32 v80, v80, v81
    v_cvt_pk_bf16_f32 v42, v78, v80
    v_add_f32 v146, v146, v147
    v_add_f32 v148, v148, v149
    v_cvt_pk_bf16_f32 v44, v146, v148
    v_add_f32 v150, v150, v151
    v_add_f32 v152, v152, v153
    v_cvt_pk_bf16_f32 v46, v150, v152
    s_nop 1
    v_mfma_f32_16x16x32_bf16 v[24:27], v[8:11], v[40:43], v[24:27]
    v_mfma_f32_16x16x32_bf16 v[28:31], v[8:11], v[42:45], v[28:31]
    v_mfma_f32_16x16x32_bf16 v[32:35], v[8:11], v[44:47], v[32:35]
    v_mfma_f32_16x16x32_bf16 v[36:39], v[8:11], v[46:49], v[36:39]
    s_nop 4
    v_mul_f32 v26, v26, v52
    v_mul_f32 v27, v27, v53
    v_mul_f32 v30, v30, v52
    v_mul_f32 v31, v31, v53
    s_branch aloop_24_pvd
aloop_24_tm:
    s_nop 7
    v_max3_f32 v2, v12, v13, v14
    v_max3_f32 v3, v15, v16, v17
    v_max3_f32 v2, v2, v18, v19
    v_max3_f32 v3, v3, v20, v21
    v_max_f32 v2, v2, v3
    v_mov_b32 v3, v2
    s_nop 1
    v_permlane16_swap_b32 v3, v2
    v_max_f32 v2, v2, v3
    v_mov_b32 v3, v2
    s_nop 1
    v_permlane32_swap_b32 v3, v2
    v_max_f32 v2, v2, v3
    v_sub_f32 v12, v12, v2
    v_sub_f32 v13, v13, v2
    v_sub_f32 v14, v14, v2
    v_sub_f32 v15, v15, v2
    v_sub_f32 v16, v16, v2
    v_sub_f32 v17, v17, v2
    v_sub_f32 v18, v18, v2
    v_sub_f32 v19, v19, v2
    v_sub_f32 v20, v20, v2
    v_sub_f32 v21, v21, v2
    v_exp_f32 v54, v12
    v_exp_f32 v55, v13
    v_exp_f32 v56, v14
    v_exp_f32 v57, v15
    v_exp_f32 v58, v16
    v_exp_f32 v59, v17
    v_exp_f32 v60, v18
    v_exp_f32 v61, v19
    v_exp_f32 v62, v20
    v_exp_f32 v63, v21
    s_nop 0
    v_cvt_pk_bf16_f32 v154, v54, v55
    v_cvt_pk_bf16_f32 v155, v56, v57
    v_cvt_pk_bf16_f32 v156, v58, v59
    v_cvt_pk_bf16_f32 v157, v60, v61
    v_cvt_pk_bf16_f32 v8, v62, v63
    s_nop 0
    v_mfma_f32_16x16x32_bf16 v[50:53], v[154:157], v[4:7], 0
    v_mfma_f32_16x16x32_bf16 v[50:53], v[8:11], v[4:7], v[50:53]
    v_mfma_f32_16x16x32_bf16 v[24:27], v[154:157], v[82:85], 0
    v_mfma_f32_16x16x32_bf16 v[28:31], v[154:157], v[86:89], 0
    v_mfma_f32_16x16x32_bf16 v[32:35], v[154:157], v[90:93], 0
    v_mfma_f32_16x16x32_bf16 v[36:39], v[154:157], v[94:97], 0
    v_mfma_f32_16x16x32_bf16 v[24:27], v[8:11], v[40:43], v[24:27]
    v_mfma_f32_16x16x32_bf16 v[28:31], v[8:11], v[42:45], v[28:31]
    v_mfma_f32_16x16x32_bf16 v[32:35], v[8:11], v[44:47], v[32:35]
    v_mfma_f32_16x16x32_bf16 v[36:39], v[8:11], v[46:49], v[36:39]
    v_rcp_f32 v52, v52
    v_rcp_f32 v53, v53
    s_nop 4
    v_mul_f32 v26, v26, v52
    v_mul_f32 v27, v27, v53
    v_mul_f32 v30, v30, v52
    v_mul_f32 v31, v31, v53
    s_branch aloop_24_pvd
aloop_24_lz:
    buffer_load_dwordx4 v[66:69], v0, s[4:7], s22 offen offset:0 sc1
    buffer_load_dwordx4 v[70:73], v0, s[4:7], s22 offen offset:1024 sc1
    ds_write_b32 v47, v2 offset:16
aloop_24_lsk:
arq_25_vl:
    s_waitcnt vmcnt(0)
    v_max3_u32 v3, v66, v67, v68
    v_max3_u32 v3, v3, v69, v70
    v_max3_u32 v3, v3, v71, v72
    v_max_u32 v3, v3, v73
    v_cmp_eq_u32 vcc, -1, v3
    s_cbranch_vccnz arq_25_vlr
    s_branch arq_25_vlok
arq_25_vlr:
    s_sub_u32 s26, s26, 1
    s_cbranch_scc1 arq_25_vlg
    buffer_load_dwordx4 v[66:69], v0, s[4:7], s22 offen offset:0 sc1
    buffer_load_dwordx4 v[70:73], v0, s[4:7], s22 offen offset:1024 sc1
    s_branch arq_25_vl
arq_25_vlg:
    s_mov_b32 s26, 0
arq_25_vlok:
    v_smfmac_f32_16x16x64_bf16 v[74:77], v[66:69], v[192:199], v41
    v_smfmac_f32_16x16x64_bf16 v[78:81], v[66:69], v[200:207], v41
    v_smfmac_f32_16x16x64_bf16 v[146:149], v[66:69], v[208:215], v41
    v_smfmac_f32_16x16x64_bf16 v[150:153], v[66:69], v[216:223], v41
    v_smfmac_f32_16x16x64_bf16 v[74:77], v[70:73], v[224:231], v41
    v_smfmac_f32_16x16x64_bf16 v[78:81], v[70:73], v[232:239], v41
    v_smfmac_f32_16x16x64_bf16 v[146:149], v[70:73], v[240:247], v41
    v_smfmac_f32_16x16x64_bf16 v[150:153], v[70:73], v[248:255], v41
    s_nop 4
    v_add_f32 v74, v74, v75
    v_add_f32 v76, v76, v77
    v_cvt_pk_bf16_f32 v40, v74, v76
    v_add_f32 v78, v78, v79
    v_add_f32 v80, v80, v81
    v_cvt_pk_bf16_f32 v42, v78, v80
    v_add_f32 v146, v146, v147
    v_add_f32 v148, v148, v149
    v_cvt_pk_bf16_f32 v44, v146, v148
    v_add_f32 v150, v150, v151
    v_add_f32 v152, v152, v153
    v_cvt_pk_bf16_f32 v46, v150, v152
    s_branch aloop_24_lskb
arq_25_ps:
    s_sub_u32 s26, s26, 1
    s_cbranch_scc1 arq_25_psg
    s_sleep 2
    buffer_load_dwordx4 v[130:133], v0, s[4:7], s21 offen sc1
    buffer_load_dwordx2 v[146:147], v2, s[4:7], s21 offen offset:1024 sc1
    buffer_load_dwordx4 v[134:137], v0, s[4:7], s21 offen offset:2048 sc1
    buffer_load_dwordx2 v[148:149], v2, s[4:7], s21 offen offset:3072 sc1
    s_branch aloop_24_psa
arq_25_psg:
    s_mov_b32 s26, 0
    s_branch aloop_24_psok
aloop_24_fin:
    s_barrier
    s_branch k_end
k_end:
k_exit:
    s_endpgm
.section .rodata,"a"
.p2align 6
jobtab:
    .long 6, 24, 24, 8192, 0, 262144, 8388608, 0, 32768, 4, 20971520, 131072, 0, 0, 218104320, 1
    .long 4, 24, 24, 8192, 0, 262144, 8388608, 262144, 32768, 4, 22020096, 131072, 0, 0, 218104448, 1
    .long 1, 32, 32, 8192, 0, 256, 8388608, 1048576, 32768, 8, 41943040, 131072, 0, 0, 218104832, 4
    .long 1, 16, 16, 8192, 0, 256, 8388608, 2097152, 32768, 8, 12582912, 131072, 0, 0, 218105344, 4
    .long 1, 32, 32, 8192, 0, 256, 8388608, 3145728, 32768, 8, 50331648, 131072, 0, 0, 218105856, 4
    .long 1, 32, 32, 8192, 0, 256, 8388608, 3670016, 32768, 8, 52428800, 131072, 0, 0, 218106112, 4
    .long 1, 80, 80, 2048, 0, 256, 7340032, 54525952, 114688, 7, 167772160, 32768, 218103808, 7, 218106368, 1
    .long 0, 0, 0, 0, 0, 0, 0, 0, 0, 0, 0, 0, 0, 0, 0, 0
    .long 0, 0, 0, 0, 0, 0, 0, 0, 0, 0, 0, 0, 0, 0, 0, 0
    .long 0, 0, 0, 0, 0, 0, 0, 0, 0, 0, 0, 0, 0, 0, 0, 0
    .long 6, 24, 24, 8192, 2048, 264192, 8388608, 0, 32768, 4, 21004288, 131072, 0, 0, 218104352, 1
    .long 4, 24, 24, 8192, 2048, 264192, 8388608, 262144, 32768, 4, 22052864, 131072, 0, 0, 218104480, 1
    .long 1, 32, 32, 8192, 2048, 2304, 8388608, 1048576, 32768, 8, 41975808, 131072, 0, 0, 218104864, 4
    .long 1, 16, 16, 8192, 2048, 2304, 8388608, 2097152, 32768, 8, 12615680, 131072, 0, 0, 218105376, 4
    .long 1, 32, 32, 8192, 2048, 2304, 8388608, 3145728, 32768, 8, 50364416, 131072, 0, 0, 218105888, 4
    .long 1, 32, 32, 8192, 2048, 2304, 8388608, 3670016, 32768, 8, 52461568, 131072, 0, 0, 218106144, 4
    .long 1, 80, 80, 2048, 1835008, 1835264, 7340032, 54554624, 114688, 7, 171966464, 32768, 218103824, 7, 218106368, 1
    .long 0, 0, 0, 0, 0, 0, 0, 0, 0, 0, 0, 0, 0, 0, 0, 0
    .long 0, 0, 0, 0, 0, 0, 0, 0, 0, 0, 0, 0, 0, 0, 0, 0
    .long 0, 0, 0, 0, 0, 0, 0, 0, 0, 0, 0, 0, 0, 0, 0, 0
    .long 6, 24, 24, 8192, 4096, 266240, 8388608, 0, 32768, 4, 21037056, 131072, 0, 0, 218104384, 1
    .long 4, 24, 24, 8192, 4096, 266240, 8388608, 262144, 32768, 4, 22085632, 131072, 0, 0, 218104512, 1
    .long 1, 32, 32, 8192, 4096, 4352, 8388608, 1048576, 32768, 8, 42008576, 131072, 0, 0, 218104896, 4
    .long 1, 16, 16, 8192, 4096, 4352, 8388608, 2097152, 32768, 8, 12648448, 131072, 0, 0, 218105408, 4
    .long 1, 32, 32, 8192, 4096, 4352, 8388608, 3145728, 32768, 8, 50397184, 131072, 0, 0, 218105920, 4
    .long 1, 32, 32, 8192, 4096, 4352, 8388608, 3670016, 32768, 8, 52494336, 131072, 0, 0, 218106176, 4
    .long 1, 80, 80, 2048, 3670016, 3670272, 7340032, 54583296, 114688, 7, 176160768, 32768, 218103840, 7, 218106368, 1
    .long 0, 0, 0, 0, 0, 0, 0, 0, 0, 0, 0, 0, 0, 0, 0, 0
    .long 0, 0, 0, 0, 0, 0, 0, 0, 0, 0, 0, 0, 0, 0, 0, 0
    .long 0, 0, 0, 0, 0, 0, 0, 0, 0, 0, 0, 0, 0, 0, 0, 0
    .long 6, 24, 24, 8192, 6144, 268288, 8388608, 0, 32768, 4, 21069824, 131072, 0, 0, 218104416, 1
    .long 4, 24, 24, 8192, 6144, 268288, 8388608, 262144, 32768, 4, 22118400, 131072, 0, 0, 218104544, 1
    .long 1, 32, 32, 8192, 6144, 6400, 8388608, 1048576, 32768, 8, 42041344, 131072, 0, 0, 218104928, 4
    .long 1, 16, 16, 8192, 6144, 6400, 8388608, 2097152, 32768, 8, 12681216, 131072, 0, 0, 218105440, 4
    .long 1, 32, 32, 8192, 6144, 6400, 8388608, 3145728, 32768, 8, 50429952, 131072, 0, 0, 218105952, 4
    .long 1, 32, 32, 8192, 6144, 6400, 8388608, 3670016, 32768, 8, 52527104, 131072, 0, 0, 218106208, 4
    .long 1, 80, 80, 2048, 5505024, 5505280, 7340032, 54611968, 114688, 7, 180355072, 32768, 218103856, 7, 218106368, 1
    .long 0, 0, 0, 0, 0, 0, 0, 0, 0, 0, 0, 0, 0, 0, 0, 0
    .long 0, 0, 0, 0, 0, 0, 0, 0, 0, 0, 0, 0, 0, 0, 0, 0
    .long 0, 0, 0, 0, 0, 0, 0, 0, 0, 0, 0, 0, 0, 0, 0, 0
    .long 6, 24, 24, 8192, 256, 262400, 8388608, 0, 32768, 4, 20975616, 131072, 0, 0, 218104320, 1
    .long 4, 24, 24, 8192, 256, 262400, 8388608, 262144, 32768, 4, 22024192, 131072, 0, 0, 218104448, 1
    .long 1, 32, 32, 8192, 512, 768, 8388608, 1048576, 32768, 8, 41951232, 131072, 0, 0, 218104832, 4
    .long 1, 16, 16, 8192, 512, 768, 8388608, 2097152, 32768, 8, 12591104, 131072, 0, 0, 218105344, 4
    .long 1, 32, 32, 8192, 512, 768, 8388608, 3145728, 32768, 8, 50339840, 131072, 0, 0, 218105856, 4
    .long 1, 32, 32, 8192, 512, 768, 8388608, 3670016, 32768, 8, 52436992, 131072, 0, 0, 218106112, 4
    .long 1, 80, 80, 2048, 512, 768, 7340032, 54525952, 114688, 7, 167780352, 32768, 218103808, 7, 218106368, 1
    .long 0, 0, 0, 0, 0, 0, 0, 0, 0, 0, 0, 0, 0, 0, 0, 0
    .long 0, 0, 0, 0, 0, 0, 0, 0, 0, 0, 0, 0, 0, 0, 0, 0
    .long 0, 0, 0, 0, 0, 0, 0, 0, 0, 0, 0, 0, 0, 0, 0, 0
    .long 6, 24, 24, 8192, 2304, 264448, 8388608, 0, 32768, 4, 21008384, 131072, 0, 0, 218104352, 1
    .long 4, 24, 24, 8192, 2304, 264448, 8388608, 262144, 32768, 4, 22056960, 131072, 0, 0, 218104480, 1
    .long 1, 32, 32, 8192, 2560, 2816, 8388608, 1048576, 32768, 8, 41984000, 131072, 0, 0, 218104864, 4
    .long 1, 16, 16, 8192, 2560, 2816, 8388608, 2097152, 32768, 8, 12623872, 131072, 0, 0, 218105376, 4
    .long 1, 32, 32, 8192, 2560, 2816, 8388608, 3145728, 32768, 8, 50372608, 131072, 0, 0, 218105888, 4
    .long 1, 32, 32, 8192, 2560, 2816, 8388608, 3670016, 32768, 8, 52469760, 131072, 0, 0, 218106144, 4
    .long 1, 80, 80, 2048, 1835520, 1835776, 7340032, 54554624, 114688, 7, 171974656, 32768, 218103824, 7, 218106368, 1
    .long 0, 0, 0, 0, 0, 0, 0, 0, 0, 0, 0, 0, 0, 0, 0, 0
    .long 0, 0, 0, 0, 0, 0, 0, 0, 0, 0, 0, 0, 0, 0, 0, 0
    .long 0, 0, 0, 0, 0, 0, 0, 0, 0, 0, 0, 0, 0, 0, 0, 0
    .long 6, 24, 24, 8192, 4352, 266496, 8388608, 0, 32768, 4, 21041152, 131072, 0, 0, 218104384, 1
    .long 4, 24, 24, 8192, 4352, 266496, 8388608, 262144, 32768, 4, 22089728, 131072, 0, 0, 218104512, 1
    .long 1, 32, 32, 8192, 4608, 4864, 8388608, 1048576, 32768, 8, 42016768, 131072, 0, 0, 218104896, 4
    .long 1, 16, 16, 8192, 4608, 4864, 8388608, 2097152, 32768, 8, 12656640, 131072, 0, 0, 218105408, 4
    .long 1, 32, 32, 8192, 4608, 4864, 8388608, 3145728, 32768, 8, 50405376, 131072, 0, 0, 218105920, 4
    .long 1, 32, 32, 8192, 4608, 4864, 8388608, 3670016, 32768, 8, 52502528, 131072, 0, 0, 218106176, 4
    .long 1, 80, 80, 2048, 3670528, 3670784, 7340032, 54583296, 114688, 7, 176168960, 32768, 218103840, 7, 218106368, 1
    .long 0, 0, 0, 0, 0, 0, 0, 0, 0, 0, 0, 0, 0, 0, 0, 0
    .long 0, 0, 0, 0, 0, 0, 0, 0, 0, 0, 0, 0, 0, 0, 0, 0
    .long 0, 0, 0, 0, 0, 0, 0, 0, 0, 0, 0, 0, 0, 0, 0, 0
    .long 6, 24, 24, 8192, 6400, 268544, 8388608, 0, 32768, 4, 21073920, 131072, 0, 0, 218104416, 1
    .long 4, 24, 24, 8192, 6400, 268544, 8388608, 262144, 32768, 4, 22122496, 131072, 0, 0, 218104544, 1
    .long 1, 32, 32, 8192, 6656, 6912, 8388608, 1048576, 32768, 8, 42049536, 131072, 0, 0, 218104928, 4
    .long 1, 16, 16, 8192, 6656, 6912, 8388608, 2097152, 32768, 8, 12689408, 131072, 0, 0, 218105440, 4
    .long 1, 32, 32, 8192, 6656, 6912, 8388608, 3145728, 32768, 8, 50438144, 131072, 0, 0, 218105952, 4
    .long 1, 32, 32, 8192, 6656, 6912, 8388608, 3670016, 32768, 8, 52535296, 131072, 0, 0, 218106208, 4
    .long 1, 80, 80, 2048, 5505536, 5505792, 7340032, 54611968, 114688, 7, 180363264, 32768, 218103856, 7, 218106368, 1
    .long 0, 0, 0, 0, 0, 0, 0, 0, 0, 0, 0, 0, 0, 0, 0, 0
    .long 0, 0, 0, 0, 0, 0, 0, 0, 0, 0, 0, 0, 0, 0, 0, 0
    .long 0, 0, 0, 0, 0, 0, 0, 0, 0, 0, 0, 0, 0, 0, 0, 0
    .long 6, 24, 24, 8192, 512, 262656, 8388608, 0, 32768, 4, 20979712, 131072, 0, 0, 218104320, 1
    .long 4, 24, 24, 8192, 512, 262656, 8388608, 262144, 32768, 4, 22028288, 131072, 0, 0, 218104448, 1
    .long 1, 32, 32, 8192, 1024, 1280, 8388608, 1048576, 32768, 8, 41959424, 131072, 0, 0, 218104848, 4
    .long 1, 16, 16, 8192, 1024, 1280, 8388608, 2097152, 32768, 8, 12599296, 131072, 0, 0, 218105360, 4
    .long 1, 32, 32, 8192, 1024, 1280, 8388608, 3145728, 32768, 8, 50348032, 131072, 0, 0, 218105872, 4
    .long 1, 32, 32, 8192, 1024, 1280, 8388608, 3670016, 32768, 8, 52445184, 131072, 0, 0, 218106128, 4
    .long 1, 80, 80, 2048, 1024, 1280, 7340032, 54525952, 114688, 7, 167788544, 32768, 218103808, 7, 218106368, 1
    .long 0, 0, 0, 0, 0, 0, 0, 0, 0, 0, 0, 0, 0, 0, 0, 0
    .long 0, 0, 0, 0, 0, 0, 0, 0, 0, 0, 0, 0, 0, 0, 0, 0
    .long 0, 0, 0, 0, 0, 0, 0, 0, 0, 0, 0, 0, 0, 0, 0, 0
    .long 6, 24, 24, 8192, 2560, 264704, 8388608, 0, 32768, 4, 21012480, 131072, 0, 0, 218104352, 1
    .long 4, 24, 24, 8192, 2560, 264704, 8388608, 262144, 32768, 4, 22061056, 131072, 0, 0, 218104480, 1
    .long 1, 32, 32, 8192, 3072, 3328, 8388608, 1048576, 32768, 8, 41992192, 131072, 0, 0, 218104880, 4
    .long 1, 16, 16, 8192, 3072, 3328, 8388608, 2097152, 32768, 8, 12632064, 131072, 0, 0, 218105392, 4
    .long 1, 32, 32, 8192, 3072, 3328, 8388608, 3145728, 32768, 8, 50380800, 131072, 0, 0, 218105904, 4
    .long 1, 32, 32, 8192, 3072, 3328, 8388608, 3670016, 32768, 8, 52477952, 131072, 0, 0, 218106160, 4
    .long 1, 80, 80, 2048, 1836032, 1836288, 7340032, 54554624, 114688, 7, 171982848, 32768, 218103824, 7, 218106368, 1
    .long 0, 0, 0, 0, 0, 0, 0, 0, 0, 0, 0, 0, 0, 0, 0, 0
    .long 0, 0, 0, 0, 0, 0, 0, 0, 0, 0, 0, 0, 0, 0, 0, 0
    .long 0, 0, 0, 0, 0, 0, 0, 0, 0, 0, 0, 0, 0, 0, 0, 0
    .long 6, 24, 24, 8192, 4608, 266752, 8388608, 0, 32768, 4, 21045248, 131072, 0, 0, 218104384, 1
    .long 4, 24, 24, 8192, 4608, 266752, 8388608, 262144, 32768, 4, 22093824, 131072, 0, 0, 218104512, 1
    .long 1, 32, 32, 8192, 5120, 5376, 8388608, 1048576, 32768, 8, 42024960, 131072, 0, 0, 218104912, 4
    .long 1, 16, 16, 8192, 5120, 5376, 8388608, 2097152, 32768, 8, 12664832, 131072, 0, 0, 218105424, 4
    .long 1, 32, 32, 8192, 5120, 5376, 8388608, 3145728, 32768, 8, 50413568, 131072, 0, 0, 218105936, 4
    .long 1, 32, 32, 8192, 5120, 5376, 8388608, 3670016, 32768, 8, 52510720, 131072, 0, 0, 218106192, 4
    .long 1, 80, 80, 2048, 3671040, 3671296, 7340032, 54583296, 114688, 7, 176177152, 32768, 218103840, 7, 218106368, 1
    .long 0, 0, 0, 0, 0, 0, 0, 0, 0, 0, 0, 0, 0, 0, 0, 0
    .long 0, 0, 0, 0, 0, 0, 0, 0, 0, 0, 0, 0, 0, 0, 0, 0
    .long 0, 0, 0, 0, 0, 0, 0, 0, 0, 0, 0, 0, 0, 0, 0, 0
    .long 6, 24, 24, 8192, 6656, 268800, 8388608, 0, 32768, 4, 21078016, 131072, 0, 0, 218104416, 1
    .long 4, 24, 24, 8192, 6656, 268800, 8388608, 262144, 32768, 4, 22126592, 131072, 0, 0, 218104544, 1
    .long 1, 32, 32, 8192, 7168, 7424, 8388608, 1048576, 32768, 8, 42057728, 131072, 0, 0, 218104944, 4
    .long 1, 16, 16, 8192, 7168, 7424, 8388608, 2097152, 32768, 8, 12697600, 131072, 0, 0, 218105456, 4
    .long 1, 32, 32, 8192, 7168, 7424, 8388608, 3145728, 32768, 8, 50446336, 131072, 0, 0, 218105968, 4
    .long 1, 32, 32, 8192, 7168, 7424, 8388608, 3670016, 32768, 8, 52543488, 131072, 0, 0, 218106224, 4
    .long 1, 80, 80, 2048, 5506048, 5506304, 7340032, 54611968, 114688, 7, 180371456, 32768, 218103856, 7, 218106368, 1
    .long 0, 0, 0, 0, 0, 0, 0, 0, 0, 0, 0, 0, 0, 0, 0, 0
    .long 0, 0, 0, 0, 0, 0, 0, 0, 0, 0, 0, 0, 0, 0, 0, 0
    .long 0, 0, 0, 0, 0, 0, 0, 0, 0, 0, 0, 0, 0, 0, 0, 0
    .long 6, 24, 24, 8192, 768, 262912, 8388608, 0, 32768, 4, 20983808, 131072, 0, 0, 218104320, 1
    .long 4, 24, 24, 8192, 768, 262912, 8388608, 262144, 32768, 4, 22032384, 131072, 0, 0, 218104448, 1
    .long 1, 32, 32, 8192, 1536, 1792, 8388608, 1048576, 32768, 8, 41967616, 131072, 0, 0, 218104848, 4
    .long 1, 16, 16, 8192, 1536, 1792, 8388608, 2097152, 32768, 8, 12607488, 131072, 0, 0, 218105360, 4
    .long 1, 32, 32, 8192, 1536, 1792, 8388608, 3145728, 32768, 8, 50356224, 131072, 0, 0, 218105872, 4
    .long 1, 32, 32, 8192, 1536, 1792, 8388608, 3670016, 32768, 8, 52453376, 131072, 0, 0, 218106128, 4
    .long 1, 80, 80, 2048, 1536, 1792, 7340032, 54525952, 114688, 7, 167796736, 32768, 218103808, 7, 218106368, 1
    .long 0, 0, 0, 0, 0, 0, 0, 0, 0, 0, 0, 0, 0, 0, 0, 0
    .long 0, 0, 0, 0, 0, 0, 0, 0, 0, 0, 0, 0, 0, 0, 0, 0
    .long 0, 0, 0, 0, 0, 0, 0, 0, 0, 0, 0, 0, 0, 0, 0, 0
    .long 6, 24, 24, 8192, 2816, 264960, 8388608, 0, 32768, 4, 21016576, 131072, 0, 0, 218104352, 1
    .long 4, 24, 24, 8192, 2816, 264960, 8388608, 262144, 32768, 4, 22065152, 131072, 0, 0, 218104480, 1
    .long 1, 32, 32, 8192, 3584, 3840, 8388608, 1048576, 32768, 8, 42000384, 131072, 0, 0, 218104880, 4
    .long 1, 16, 16, 8192, 3584, 3840, 8388608, 2097152, 32768, 8, 12640256, 131072, 0, 0, 218105392, 4
    .long 1, 32, 32, 8192, 3584, 3840, 8388608, 3145728, 32768, 8, 50388992, 131072, 0, 0, 218105904, 4
    .long 1, 32, 32, 8192, 3584, 3840, 8388608, 3670016, 32768, 8, 52486144, 131072, 0, 0, 218106160, 4
    .long 1, 80, 80, 2048, 1836544, 1836800, 7340032, 54554624, 114688, 7, 171991040, 32768, 218103824, 7, 218106368, 1
    .long 0, 0, 0, 0, 0, 0, 0, 0, 0, 0, 0, 0, 0, 0, 0, 0
    .long 0, 0, 0, 0, 0, 0, 0, 0, 0, 0, 0, 0, 0, 0, 0, 0
    .long 0, 0, 0, 0, 0, 0, 0, 0, 0, 0, 0, 0, 0, 0, 0, 0
    .long 6, 24, 24, 8192, 4864, 267008, 8388608, 0, 32768, 4, 21049344, 131072, 0, 0, 218104384, 1
    .long 4, 24, 24, 8192, 4864, 267008, 8388608, 262144, 32768, 4, 22097920, 131072, 0, 0, 218104512, 1
    .long 1, 32, 32, 8192, 5632, 5888, 8388608, 1048576, 32768, 8, 42033152, 131072, 0, 0, 218104912, 4
    .long 1, 16, 16, 8192, 5632, 5888, 8388608, 2097152, 32768, 8, 12673024, 131072, 0, 0, 218105424, 4
    .long 1, 32, 32, 8192, 5632, 5888, 8388608, 3145728, 32768, 8, 50421760, 131072, 0, 0, 218105936, 4
    .long 1, 32, 32, 8192, 5632, 5888, 8388608, 3670016, 32768, 8, 52518912, 131072, 0, 0, 218106192, 4
    .long 1, 80, 80, 2048, 3671552, 3671808, 7340032, 54583296, 114688, 7, 176185344, 32768, 218103840, 7, 218106368, 1
    .long 0, 0, 0, 0, 0, 0, 0, 0, 0, 0, 0, 0, 0, 0, 0, 0
    .long 0, 0, 0, 0, 0, 0, 0, 0, 0, 0, 0, 0, 0, 0, 0, 0
    .long 0, 0, 0, 0, 0, 0, 0, 0, 0, 0, 0, 0, 0, 0, 0, 0
    .long 6, 24, 24, 8192, 6912, 269056, 8388608, 0, 32768, 4, 21082112, 131072, 0, 0, 218104416, 1
    .long 4, 24, 24, 8192, 6912, 269056, 8388608, 262144, 32768, 4, 22130688, 131072, 0, 0, 218104544, 1
    .long 1, 32, 32, 8192, 7680, 7936, 8388608, 1048576, 32768, 8, 42065920, 131072, 0, 0, 218104944, 4
    .long 1, 16, 16, 8192, 7680, 7936, 8388608, 2097152, 32768, 8, 12705792, 131072, 0, 0, 218105456, 4
    .long 1, 32, 32, 8192, 7680, 7936, 8388608, 3145728, 32768, 8, 50454528, 131072, 0, 0, 218105968, 4
    .long 1, 32, 32, 8192, 7680, 7936, 8388608, 3670016, 32768, 8, 52551680, 131072, 0, 0, 218106224, 4
    .long 1, 80, 80, 2048, 5506560, 5506816, 7340032, 54611968, 114688, 7, 180379648, 32768, 218103856, 7, 218106368, 1
    .long 0, 0, 0, 0, 0, 0, 0, 0, 0, 0, 0, 0, 0, 0, 0, 0
    .long 0, 0, 0, 0, 0, 0, 0, 0, 0, 0, 0, 0, 0, 0, 0, 0
    .long 0, 0, 0, 0, 0, 0, 0, 0, 0, 0, 0, 0, 0, 0, 0, 0
    .long 6, 24, 24, 8192, 1024, 263168, 8388608, 0, 32768, 4, 20987904, 131072, 0, 0, 218104336, 1
    .long 4, 24, 24, 8192, 1024, 263168, 8388608, 262144, 32768, 4, 22036480, 131072, 0, 0, 218104464, 1
    .long 1, 24, 24, 8192, 0, 256, 8388608, 1048576, 32768, 8, 25165824, 131072, 0, 0, 218104832, 4
    .long 1, 32, 32, 8192, 0, 256, 8388608, 2621440, 32768, 8, 48234496, 131072, 0, 0, 218105600, 4
    .long 1, 24, 24, 8192, 0, 256, 8388608, 3145728, 32768, 8, 33554432, 131072, 0, 0, 218105856, 4
    .long 1, 24, 24, 8192, 0, 256, 8388608, 3670016, 32768, 8, 35651584, 131072, 0, 0, 218106112, 4
    .long 1, 80, 80, 2048, 0, 256, 7340032, 56360960, 114688, 7, 168296448, 32768, 218103872, 7, 218106432, 1
    .long 0, 0, 0, 0, 0, 0, 0, 0, 0, 0, 0, 0, 0, 0, 0, 0
    .long 0, 0, 0, 0, 0, 0, 0, 0, 0, 0, 0, 0, 0, 0, 0, 0
    .long 0, 0, 0, 0, 0, 0, 0, 0, 0, 0, 0, 0, 0, 0, 0, 0
    .long 6, 24, 24, 8192, 3072, 265216, 8388608, 0, 32768, 4, 21020672, 131072, 0, 0, 218104368, 1
    .long 4, 24, 24, 8192, 3072, 265216, 8388608, 262144, 32768, 4, 22069248, 131072, 0, 0, 218104496, 1
    .long 1, 24, 24, 8192, 2048, 2304, 8388608, 1048576, 32768, 8, 25198592, 131072, 0, 0, 218104864, 4
    .long 1, 32, 32, 8192, 2048, 2304, 8388608, 2621440, 32768, 8, 48267264, 131072, 0, 0, 218105632, 4
    .long 1, 24, 24, 8192, 2048, 2304, 8388608, 3145728, 32768, 8, 33587200, 131072, 0, 0, 218105888, 4
    .long 1, 24, 24, 8192, 2048, 2304, 8388608, 3670016, 32768, 8, 35684352, 131072, 0, 0, 218106144, 4
    .long 1, 80, 80, 2048, 1835008, 1835264, 7340032, 56389632, 114688, 7, 172490752, 32768, 218103888, 7, 218106432, 1
    .long 0, 0, 0, 0, 0, 0, 0, 0, 0, 0, 0, 0, 0, 0, 0, 0
    .long 0, 0, 0, 0, 0, 0, 0, 0, 0, 0, 0, 0, 0, 0, 0, 0
    .long 0, 0, 0, 0, 0, 0, 0, 0, 0, 0, 0, 0, 0, 0, 0, 0
    .long 6, 24, 24, 8192, 5120, 267264, 8388608, 0, 32768, 4, 21053440, 131072, 0, 0, 218104400, 1
    .long 4, 24, 24, 8192, 5120, 267264, 8388608, 262144, 32768, 4, 22102016, 131072, 0, 0, 218104528, 1
    .long 1, 24, 24, 8192, 4096, 4352, 8388608, 1048576, 32768, 8, 25231360, 131072, 0, 0, 218104896, 4
    .long 1, 32, 32, 8192, 4096, 4352, 8388608, 2621440, 32768, 8, 48300032, 131072, 0, 0, 218105664, 4
    .long 1, 24, 24, 8192, 4096, 4352, 8388608, 3145728, 32768, 8, 33619968, 131072, 0, 0, 218105920, 4
    .long 1, 24, 24, 8192, 4096, 4352, 8388608, 3670016, 32768, 8, 35717120, 131072, 0, 0, 218106176, 4
    .long 1, 80, 80, 2048, 3670016, 3670272, 7340032, 56418304, 114688, 7, 176685056, 32768, 218103904, 7, 218106432, 1
    .long 0, 0, 0, 0, 0, 0, 0, 0, 0, 0, 0, 0, 0, 0, 0, 0
    .long 0, 0, 0, 0, 0, 0, 0, 0, 0, 0, 0, 0, 0, 0, 0, 0
    .long 0, 0, 0, 0, 0, 0, 0, 0, 0, 0, 0, 0, 0, 0, 0, 0
    .long 6, 24, 24, 8192, 7168, 269312, 8388608, 0, 32768, 4, 21086208, 131072, 0, 0, 218104432, 1
    .long 4, 24, 24, 8192, 7168, 269312, 8388608, 262144, 32768, 4, 22134784, 131072, 0, 0, 218104560, 1
    .long 1, 24, 24, 8192, 6144, 6400, 8388608, 1048576, 32768, 8, 25264128, 131072, 0, 0, 218104928, 4
    .long 1, 32, 32, 8192, 6144, 6400, 8388608, 2621440, 32768, 8, 48332800, 131072, 0, 0, 218105696, 4
    .long 1, 24, 24, 8192, 6144, 6400, 8388608, 3145728, 32768, 8, 33652736, 131072, 0, 0, 218105952, 4
    .long 1, 24, 24, 8192, 6144, 6400, 8388608, 3670016, 32768, 8, 35749888, 131072, 0, 0, 218106208, 4
    .long 1, 80, 80, 2048, 5505024, 5505280, 7340032, 56446976, 114688, 7, 180879360, 32768, 218103920, 7, 218106432, 1
    .long 0, 0, 0, 0, 0, 0, 0, 0, 0, 0, 0, 0, 0, 0, 0, 0
    .long 0, 0, 0, 0, 0, 0, 0, 0, 0, 0, 0, 0, 0, 0, 0, 0
    .long 0, 0, 0, 0, 0, 0, 0, 0, 0, 0, 0, 0, 0, 0, 0, 0
    .long 6, 24, 24, 8192, 1280, 263424, 8388608, 0, 32768, 4, 20992000, 131072, 0, 0, 218104336, 1
    .long 4, 24, 24, 8192, 1280, 263424, 8388608, 262144, 32768, 4, 22040576, 131072, 0, 0, 218104464, 1
    .long 1, 24, 24, 8192, 512, 768, 8388608, 1048576, 32768, 8, 25174016, 131072, 0, 0, 218104832, 4
    .long 1, 32, 32, 8192, 512, 768, 8388608, 2621440, 32768, 8, 48242688, 131072, 0, 0, 218105600, 4
    .long 1, 24, 24, 8192, 512, 768, 8388608, 3145728, 32768, 8, 33562624, 131072, 0, 0, 218105856, 4
    .long 1, 24, 24, 8192, 512, 768, 8388608, 3670016, 32768, 8, 35659776, 131072, 0, 0, 218106112, 4
    .long 1, 80, 80, 2048, 512, 768, 7340032, 56360960, 114688, 7, 168304640, 32768, 218103872, 7, 218106432, 1
    .long 0, 0, 0, 0, 0, 0, 0, 0, 0, 0, 0, 0, 0, 0, 0, 0
    .long 0, 0, 0, 0, 0, 0, 0, 0, 0, 0, 0, 0, 0, 0, 0, 0
    .long 0, 0, 0, 0, 0, 0, 0, 0, 0, 0, 0, 0, 0, 0, 0, 0
    .long 6, 24, 24, 8192, 3328, 265472, 8388608, 0, 32768, 4, 21024768, 131072, 0, 0, 218104368, 1
    .long 4, 24, 24, 8192, 3328, 265472, 8388608, 262144, 32768, 4, 22073344, 131072, 0, 0, 218104496, 1
    .long 1, 24, 24, 8192, 2560, 2816, 8388608, 1048576, 32768, 8, 25206784, 131072, 0, 0, 218104864, 4
    .long 1, 32, 32, 8192, 2560, 2816, 8388608, 2621440, 32768, 8, 48275456, 131072, 0, 0, 218105632, 4
    .long 1, 24, 24, 8192, 2560, 2816, 8388608, 3145728, 32768, 8, 33595392, 131072, 0, 0, 218105888, 4
    .long 1, 24, 24, 8192, 2560, 2816, 8388608, 3670016, 32768, 8, 35692544, 131072, 0, 0, 218106144, 4
    .long 1, 80, 80, 2048, 1835520, 1835776, 7340032, 56389632, 114688, 7, 172498944, 32768, 218103888, 7, 218106432, 1
    .long 0, 0, 0, 0, 0, 0, 0, 0, 0, 0, 0, 0, 0, 0, 0, 0
    .long 0, 0, 0, 0, 0, 0, 0, 0, 0, 0, 0, 0, 0, 0, 0, 0
    .long 0, 0, 0, 0, 0, 0, 0, 0, 0, 0, 0, 0, 0, 0, 0, 0
    .long 6, 24, 24, 8192, 5376, 267520, 8388608, 0, 32768, 4, 21057536, 131072, 0, 0, 218104400, 1
    .long 4, 24, 24, 8192, 5376, 267520, 8388608, 262144, 32768, 4, 22106112, 131072, 0, 0, 218104528, 1
    .long 1, 24, 24, 8192, 4608, 4864, 8388608, 1048576, 32768, 8, 25239552, 131072, 0, 0, 218104896, 4
    .long 1, 32, 32, 8192, 4608, 4864, 8388608, 2621440, 32768, 8, 48308224, 131072, 0, 0, 218105664, 4
    .long 1, 24, 24, 8192, 4608, 4864, 8388608, 3145728, 32768, 8, 33628160, 131072, 0, 0, 218105920, 4
    .long 1, 24, 24, 8192, 4608, 4864, 8388608, 3670016, 32768, 8, 35725312, 131072, 0, 0, 218106176, 4
    .long 1, 80, 80, 2048, 3670528, 3670784, 7340032, 56418304, 114688, 7, 176693248, 32768, 218103904, 7, 218106432, 1
    .long 0, 0, 0, 0, 0, 0, 0, 0, 0, 0, 0, 0, 0, 0, 0, 0
    .long 0, 0, 0, 0, 0, 0, 0, 0, 0, 0, 0, 0, 0, 0, 0, 0
    .long 0, 0, 0, 0, 0, 0, 0, 0, 0, 0, 0, 0, 0, 0, 0, 0
    .long 6, 24, 24, 8192, 7424, 269568, 8388608, 0, 32768, 4, 21090304, 131072, 0, 0, 218104432, 1
    .long 4, 24, 24, 8192, 7424, 269568, 8388608, 262144, 32768, 4, 22138880, 131072, 0, 0, 218104560, 1
    .long 1, 24, 24, 8192, 6656, 6912, 8388608, 1048576, 32768, 8, 25272320, 131072, 0, 0, 218104928, 4
    .long 1, 32, 32, 8192, 6656, 6912, 8388608, 2621440, 32768, 8, 48340992, 131072, 0, 0, 218105696, 4
    .long 1, 24, 24, 8192, 6656, 6912, 8388608, 3145728, 32768, 8, 33660928, 131072, 0, 0, 218105952, 4
    .long 1, 24, 24, 8192, 6656, 6912, 8388608, 3670016, 32768, 8, 35758080, 131072, 0, 0, 218106208, 4
    .long 1, 80, 80, 2048, 5505536, 5505792, 7340032, 56446976, 114688, 7, 180887552, 32768, 218103920, 7, 218106432, 1
    .long 0, 0, 0, 0, 0, 0, 0, 0, 0, 0, 0, 0, 0, 0, 0, 0
    .long 0, 0, 0, 0, 0, 0, 0, 0, 0, 0, 0, 0, 0, 0, 0, 0
    .long 0, 0, 0, 0, 0, 0, 0, 0, 0, 0, 0, 0, 0, 0, 0, 0
    .long 6, 24, 24, 8192, 1536, 263680, 8388608, 0, 32768, 4, 20996096, 131072, 0, 0, 218104336, 1
    .long 4, 24, 24, 8192, 1536, 263680, 8388608, 262144, 32768, 4, 22044672, 131072, 0, 0, 218104464, 1
    .long 1, 24, 24, 8192, 1024, 1280, 8388608, 1048576, 32768, 8, 25182208, 131072, 0, 0, 218104848, 4
    .long 1, 32, 32, 8192, 1024, 1280, 8388608, 2621440, 32768, 8, 48250880, 131072, 0, 0, 218105616, 4
    .long 1, 24, 24, 8192, 1024, 1280, 8388608, 3145728, 32768, 8, 33570816, 131072, 0, 0, 218105872, 4
    .long 1, 24, 24, 8192, 1024, 1280, 8388608, 3670016, 32768, 8, 35667968, 131072, 0, 0, 218106128, 4
    .long 1, 80, 80, 2048, 1024, 1280, 7340032, 56360960, 114688, 7, 168312832, 32768, 218103872, 7, 218106432, 1
    .long 0, 0, 0, 0, 0, 0, 0, 0, 0, 0, 0, 0, 0, 0, 0, 0
    .long 0, 0, 0, 0, 0, 0, 0, 0, 0, 0, 0, 0, 0, 0, 0, 0
    .long 0, 0, 0, 0, 0, 0, 0, 0, 0, 0, 0, 0, 0, 0, 0, 0
    .long 6, 24, 24, 8192, 3584, 265728, 8388608, 0, 32768, 4, 21028864, 131072, 0, 0, 218104368, 1
    .long 4, 24, 24, 8192, 3584, 265728, 8388608, 262144, 32768, 4, 22077440, 131072, 0, 0, 218104496, 1
    .long 1, 24, 24, 8192, 3072, 3328, 8388608, 1048576, 32768, 8, 25214976, 131072, 0, 0, 218104880, 4
    .long 1, 32, 32, 8192, 3072, 3328, 8388608, 2621440, 32768, 8, 48283648, 131072, 0, 0, 218105648, 4
    .long 1, 24, 24, 8192, 3072, 3328, 8388608, 3145728, 32768, 8, 33603584, 131072, 0, 0, 218105904, 4
    .long 1, 24, 24, 8192, 3072, 3328, 8388608, 3670016, 32768, 8, 35700736, 131072, 0, 0, 218106160, 4
    .long 1, 80, 80, 2048, 1836032, 1836288, 7340032, 56389632, 114688, 7, 172507136, 32768, 218103888, 7, 218106432, 1
    .long 0, 0, 0, 0, 0, 0, 0, 0, 0, 0, 0, 0, 0, 0, 0, 0
    .long 0, 0, 0, 0, 0, 0, 0, 0, 0, 0, 0, 0, 0, 0, 0, 0
    .long 0, 0, 0, 0, 0, 0, 0, 0, 0, 0, 0, 0, 0, 0, 0, 0
    .long 6, 24, 24, 8192, 5632, 267776, 8388608, 0, 32768, 4, 21061632, 131072, 0, 0, 218104400, 1
    .long 4, 24, 24, 8192, 5632, 267776, 8388608, 262144, 32768, 4, 22110208, 131072, 0, 0, 218104528, 1
    .long 1, 24, 24, 8192, 5120, 5376, 8388608, 1048576, 32768, 8, 25247744, 131072, 0, 0, 218104912, 4
    .long 1, 32, 32, 8192, 5120, 5376, 8388608, 2621440, 32768, 8, 48316416, 131072, 0, 0, 218105680, 4
    .long 1, 24, 24, 8192, 5120, 5376, 8388608, 3145728, 32768, 8, 33636352, 131072, 0, 0, 218105936, 4
    .long 1, 24, 24, 8192, 5120, 5376, 8388608, 3670016, 32768, 8, 35733504, 131072, 0, 0, 218106192, 4
    .long 1, 80, 80, 2048, 3671040, 3671296, 7340032, 56418304, 114688, 7, 176701440, 32768, 218103904, 7, 218106432, 1
    .long 0, 0, 0, 0, 0, 0, 0, 0, 0, 0, 0, 0, 0, 0, 0, 0
    .long 0, 0, 0, 0, 0, 0, 0, 0, 0, 0, 0, 0, 0, 0, 0, 0
    .long 0, 0, 0, 0, 0, 0, 0, 0, 0, 0, 0, 0, 0, 0, 0, 0
    .long 6, 24, 24, 8192, 7680, 269824, 8388608, 0, 32768, 4, 21094400, 131072, 0, 0, 218104432, 1
    .long 4, 24, 24, 8192, 7680, 269824, 8388608, 262144, 32768, 4, 22142976, 131072, 0, 0, 218104560, 1
    .long 1, 24, 24, 8192, 7168, 7424, 8388608, 1048576, 32768, 8, 25280512, 131072, 0, 0, 218104944, 4
    .long 1, 32, 32, 8192, 7168, 7424, 8388608, 2621440, 32768, 8, 48349184, 131072, 0, 0, 218105712, 4
    .long 1, 24, 24, 8192, 7168, 7424, 8388608, 3145728, 32768, 8, 33669120, 131072, 0, 0, 218105968, 4
    .long 1, 24, 24, 8192, 7168, 7424, 8388608, 3670016, 32768, 8, 35766272, 131072, 0, 0, 218106224, 4
    .long 1, 80, 80, 2048, 5506048, 5506304, 7340032, 56446976, 114688, 7, 180895744, 32768, 218103920, 7, 218106432, 1
    .long 0, 0, 0, 0, 0, 0, 0, 0, 0, 0, 0, 0, 0, 0, 0, 0
    .long 0, 0, 0, 0, 0, 0, 0, 0, 0, 0, 0, 0, 0, 0, 0, 0
    .long 0, 0, 0, 0, 0, 0, 0, 0, 0, 0, 0, 0, 0, 0, 0, 0
    .long 6, 24, 24, 8192, 1792, 263936, 8388608, 0, 32768, 4, 21000192, 131072, 0, 0, 218104336, 1
    .long 4, 24, 24, 8192, 1792, 263936, 8388608, 262144, 32768, 4, 22048768, 131072, 0, 0, 218104464, 1
    .long 1, 24, 24, 8192, 1536, 1792, 8388608, 1048576, 32768, 8, 25190400, 131072, 0, 0, 218104848, 4
    .long 1, 32, 32, 8192, 1536, 1792, 8388608, 2621440, 32768, 8, 48259072, 131072, 0, 0, 218105616, 4
    .long 1, 24, 24, 8192, 1536, 1792, 8388608, 3145728, 32768, 8, 33579008, 131072, 0, 0, 218105872, 4
    .long 1, 24, 24, 8192, 1536, 1792, 8388608, 3670016, 32768, 8, 35676160, 131072, 0, 0, 218106128, 4
    .long 1, 80, 80, 2048, 1536, 1792, 7340032, 56360960, 114688, 7, 168321024, 32768, 218103872, 7, 218106432, 1
    .long 0, 0, 0, 0, 0, 0, 0, 0, 0, 0, 0, 0, 0, 0, 0, 0
    .long 0, 0, 0, 0, 0, 0, 0, 0, 0, 0, 0, 0, 0, 0, 0, 0
    .long 0, 0, 0, 0, 0, 0, 0, 0, 0, 0, 0, 0, 0, 0, 0, 0
    .long 6, 24, 24, 8192, 3840, 265984, 8388608, 0, 32768, 4, 21032960, 131072, 0, 0, 218104368, 1
    .long 4, 24, 24, 8192, 3840, 265984, 8388608, 262144, 32768, 4, 22081536, 131072, 0, 0, 218104496, 1
    .long 1, 24, 24, 8192, 3584, 3840, 8388608, 1048576, 32768, 8, 25223168, 131072, 0, 0, 218104880, 4
    .long 1, 32, 32, 8192, 3584, 3840, 8388608, 2621440, 32768, 8, 48291840, 131072, 0, 0, 218105648, 4
    .long 1, 24, 24, 8192, 3584, 3840, 8388608, 3145728, 32768, 8, 33611776, 131072, 0, 0, 218105904, 4
    .long 1, 24, 24, 8192, 3584, 3840, 8388608, 3670016, 32768, 8, 35708928, 131072, 0, 0, 218106160, 4
    .long 1, 80, 80, 2048, 1836544, 1836800, 7340032, 56389632, 114688, 7, 172515328, 32768, 218103888, 7, 218106432, 1
    .long 0, 0, 0, 0, 0, 0, 0, 0, 0, 0, 0, 0, 0, 0, 0, 0
    .long 0, 0, 0, 0, 0, 0, 0, 0, 0, 0, 0, 0, 0, 0, 0, 0
    .long 0, 0, 0, 0, 0, 0, 0, 0, 0, 0, 0, 0, 0, 0, 0, 0
    .long 6, 24, 24, 8192, 5888, 268032, 8388608, 0, 32768, 4, 21065728, 131072, 0, 0, 218104400, 1
    .long 4, 24, 24, 8192, 5888, 268032, 8388608, 262144, 32768, 4, 22114304, 131072, 0, 0, 218104528, 1
    .long 1, 24, 24, 8192, 5632, 5888, 8388608, 1048576, 32768, 8, 25255936, 131072, 0, 0, 218104912, 4
    .long 1, 32, 32, 8192, 5632, 5888, 8388608, 2621440, 32768, 8, 48324608, 131072, 0, 0, 218105680, 4
    .long 1, 24, 24, 8192, 5632, 5888, 8388608, 3145728, 32768, 8, 33644544, 131072, 0, 0, 218105936, 4
    .long 1, 24, 24, 8192, 5632, 5888, 8388608, 3670016, 32768, 8, 35741696, 131072, 0, 0, 218106192, 4
    .long 1, 80, 80, 2048, 3671552, 3671808, 7340032, 56418304, 114688, 7, 176709632, 32768, 218103904, 7, 218106432, 1
    .long 0, 0, 0, 0, 0, 0, 0, 0, 0, 0, 0, 0, 0, 0, 0, 0
    .long 0, 0, 0, 0, 0, 0, 0, 0, 0, 0, 0, 0, 0, 0, 0, 0
    .long 0, 0, 0, 0, 0, 0, 0, 0, 0, 0, 0, 0, 0, 0, 0, 0
    .long 6, 24, 24, 8192, 7936, 270080, 8388608, 0, 32768, 4, 21098496, 131072, 0, 0, 218104432, 1
    .long 4, 24, 24, 8192, 7936, 270080, 8388608, 262144, 32768, 4, 22147072, 131072, 0, 0, 218104560, 1
    .long 1, 24, 24, 8192, 7680, 7936, 8388608, 1048576, 32768, 8, 25288704, 131072, 0, 0, 218104944, 4
    .long 1, 32, 32, 8192, 7680, 7936, 8388608, 2621440, 32768, 8, 48357376, 131072, 0, 0, 218105712, 4
    .long 1, 24, 24, 8192, 7680, 7936, 8388608, 3145728, 32768, 8, 33677312, 131072, 0, 0, 218105968, 4
    .long 1, 24, 24, 8192, 7680, 7936, 8388608, 3670016, 32768, 8, 35774464, 131072, 0, 0, 218106224, 4
    .long 1, 80, 80, 2048, 5506560, 5506816, 7340032, 56446976, 114688, 7, 180903936, 32768, 218103920, 7, 218106432, 1
    .long 0, 0, 0, 0, 0, 0, 0, 0, 0, 0, 0, 0, 0, 0, 0, 0
    .long 0, 0, 0, 0, 0, 0, 0, 0, 0, 0, 0, 0, 0, 0, 0, 0
    .long 0, 0, 0, 0, 0, 0, 0, 0, 0, 0, 0, 0, 0, 0, 0, 0
    .long 6, 32, 32, 8192, 0, 262144, 8388608, 0, 32768, 4, 37748736, 131072, 0, 0, 218104320, 1
    .long 4, 32, 32, 8192, 0, 262144, 8388608, 262144, 32768, 4, 38797312, 131072, 0, 0, 218104448, 1
    .long 4, 16, 16, 8192, 1792, 263936, 8388608, 786432, 32768, 4, 7368704, 131072, 0, 0, 218104592, 1
    .long 1, 24, 24, 8192, 0, 256, 8388608, 1572864, 32768, 8, 27262976, 131072, 0, 0, 218105088, 4
    .long 2, 64, 72, 7168, 0, 0, 7340032, 0, 32768, 8, 54525952, 114688, 0, 0, 218103808, 1
    .long 2, 64, 72, 7168, 6144, 6144, 7340032, 1048576, 32768, 8, 58294272, 114688, 0, 0, 218103984, 1
    .long 2, 64, 72, 7168, 5120, 5120, 7340032, 2621440, 32768, 8, 63782912, 114688, 0, 0, 218104160, 1
    .long 1, 80, 80, 2048, 0, 256, 7340032, 61865984, 114688, 7, 169869312, 32768, 218104064, 7, 218106624, 1
    .long 0, 0, 0, 0, 0, 0, 0, 0, 0, 0, 0, 0, 0, 0, 0, 0
    .long 0, 0, 0, 0, 0, 0, 0, 0, 0, 0, 0, 0, 0, 0, 0, 0
    .long 6, 32, 32, 8192, 2048, 264192, 8388608, 0, 32768, 4, 37781504, 131072, 0, 0, 218104352, 1
    .long 4, 32, 32, 8192, 2048, 264192, 8388608, 262144, 32768, 4, 38830080, 131072, 0, 0, 218104480, 1
    .long 4, 16, 16, 8192, 3840, 265984, 8388608, 786432, 32768, 4, 7401472, 131072, 0, 0, 218104624, 1
    .long 1, 24, 24, 8192, 2048, 2304, 8388608, 1572864, 32768, 8, 27295744, 131072, 0, 0, 218105120, 4
    .long 2, 64, 72, 7168, 256, 256, 7340032, 0, 32768, 8, 54530048, 114688, 0, 0, 218103808, 1
    .long 2, 64, 72, 7168, 6400, 6400, 7340032, 1048576, 32768, 8, 58298368, 114688, 0, 0, 218103984, 1
    .long 2, 64, 72, 7168, 5376, 5376, 7340032, 2621440, 32768, 8, 63787008, 114688, 0, 0, 218104176, 1
    .long 1, 80, 80, 2048, 1835008, 1835264, 7340032, 61894656, 114688, 7, 174063616, 32768, 218104080, 7, 218106624, 1
    .long 0, 0, 0, 0, 0, 0, 0, 0, 0, 0, 0, 0, 0, 0, 0, 0
    .long 0, 0, 0, 0, 0, 0, 0, 0, 0, 0, 0, 0, 0, 0, 0, 0
    .long 6, 32, 32, 8192, 4096, 266240, 8388608, 0, 32768, 4, 37814272, 131072, 0, 0, 218104384, 1
    .long 4, 32, 32, 8192, 4096, 266240, 8388608, 262144, 32768, 4, 38862848, 131072, 0, 0, 218104512, 1
    .long 4, 16, 16, 8192, 5888, 268032, 8388608, 786432, 32768, 4, 7434240, 131072, 0, 0, 218104656, 1
    .long 1, 24, 24, 8192, 4096, 4352, 8388608, 1572864, 32768, 8, 27328512, 131072, 0, 0, 218105152, 4
    .long 2, 64, 72, 7168, 512, 512, 7340032, 0, 32768, 8, 54534144, 114688, 0, 0, 218103808, 1
    .long 2, 64, 72, 7168, 6656, 6656, 7340032, 1048576, 32768, 8, 58302464, 114688, 0, 0, 218103984, 1
    .long 2, 64, 72, 7168, 5632, 5632, 7340032, 2621440, 32768, 8, 63791104, 114688, 0, 0, 218104176, 1
    .long 1, 80, 80, 2048, 3670016, 3670272, 7340032, 61923328, 114688, 7, 178257920, 32768, 218104096, 7, 218106624, 1
    .long 0, 0, 0, 0, 0, 0, 0, 0, 0, 0, 0, 0, 0, 0, 0, 0
    .long 0, 0, 0, 0, 0, 0, 0, 0, 0, 0, 0, 0, 0, 0, 0, 0
    .long 6, 32, 32, 8192, 6144, 268288, 8388608, 0, 32768, 4, 37847040, 131072, 0, 0, 218104416, 1
    .long 4, 32, 32, 8192, 6144, 268288, 8388608, 262144, 32768, 4, 38895616, 131072, 0, 0, 218104544, 1
    .long 4, 16, 16, 8192, 7936, 270080, 8388608, 786432, 32768, 4, 7467008, 131072, 0, 0, 218104688, 1
    .long 1, 24, 24, 8192, 6144, 6400, 8388608, 1572864, 32768, 8, 27361280, 131072, 0, 0, 218105184, 4
    .long 2, 64, 72, 7168, 768, 768, 7340032, 0, 32768, 8, 54538240, 114688, 0, 0, 218103808, 1
    .long 2, 64, 72, 7168, 6912, 6912, 7340032, 1048576, 32768, 8, 58306560, 114688, 0, 0, 218103984, 1
    .long 2, 64, 72, 7168, 5888, 5888, 7340032, 2621440, 32768, 8, 63795200, 114688, 0, 0, 218104176, 1
    .long 1, 80, 80, 2048, 5505024, 5505280, 7340032, 61952000, 114688, 7, 182452224, 32768, 218104112, 7, 218106624, 1
    .long 0, 0, 0, 0, 0, 0, 0, 0, 0, 0, 0, 0, 0, 0, 0, 0
    .long 0, 0, 0, 0, 0, 0, 0, 0, 0, 0, 0, 0, 0, 0, 0, 0
    .long 6, 32, 32, 8192, 256, 262400, 8388608, 0, 32768, 4, 37752832, 131072, 0, 0, 218104320, 1
    .long 4, 32, 32, 8192, 256, 262400, 8388608, 262144, 32768, 4, 38801408, 131072, 0, 0, 218104448, 1
    .long 4, 16, 16, 8192, 1792, 263936, 8388608, 524288, 32768, 4, 6320128, 131072, 0, 0, 218104592, 1
    .long 1, 24, 24, 8192, 512, 768, 8388608, 1572864, 32768, 8, 27271168, 131072, 0, 0, 218105088, 4
    .long 2, 64, 72, 7168, 1024, 1024, 7340032, 0, 32768, 8, 54542336, 114688, 0, 0, 218103808, 1
    .long 2, 64, 72, 7168, 0, 0, 7340032, 1572864, 32768, 8, 60030976, 114688, 0, 0, 218104000, 1
    .long 2, 64, 72, 7168, 6144, 6144, 7340032, 2621440, 32768, 8, 63799296, 114688, 0, 0, 218104176, 1
    .long 1, 80, 80, 2048, 512, 768, 7340032, 61865984, 114688, 7, 169877504, 32768, 218104064, 7, 218106624, 1
    .long 0, 0, 0, 0, 0, 0, 0, 0, 0, 0, 0, 0, 0, 0, 0, 0
    .long 0, 0, 0, 0, 0, 0, 0, 0, 0, 0, 0, 0, 0, 0, 0, 0
    .long 6, 32, 32, 8192, 2304, 264448, 8388608, 0, 32768, 4, 37785600, 131072, 0, 0, 218104352, 1
    .long 4, 32, 32, 8192, 2304, 264448, 8388608, 262144, 32768, 4, 38834176, 131072, 0, 0, 218104480, 1
    .long 4, 16, 16, 8192, 3840, 265984, 8388608, 524288, 32768, 4, 6352896, 131072, 0, 0, 218104624, 1
    .long 1, 24, 24, 8192, 2560, 2816, 8388608, 1572864, 32768, 8, 27303936, 131072, 0, 0, 218105120, 4
    .long 2, 64, 72, 7168, 1280, 1280, 7340032, 0, 32768, 8, 54546432, 114688, 0, 0, 218103808, 1
    .long 2, 64, 72, 7168, 256, 256, 7340032, 1572864, 32768, 8, 60035072, 114688, 0, 0, 218104000, 1
    .long 2, 64, 72, 7168, 6400, 6400, 7340032, 2621440, 32768, 8, 63803392, 114688, 0, 0, 218104176, 1
    .long 1, 80, 80, 2048, 1835520, 1835776, 7340032, 61894656, 114688, 7, 174071808, 32768, 218104080, 7, 218106624, 1
    .long 0, 0, 0, 0, 0, 0, 0, 0, 0, 0, 0, 0, 0, 0, 0, 0
    .long 0, 0, 0, 0, 0, 0, 0, 0, 0, 0, 0, 0, 0, 0, 0, 0
    .long 6, 32, 32, 8192, 4352, 266496, 8388608, 0, 32768, 4, 37818368, 131072, 0, 0, 218104384, 1
    .long 4, 32, 32, 8192, 4352, 266496, 8388608, 262144, 32768, 4, 38866944, 131072, 0, 0, 218104512, 1
    .long 4, 16, 16, 8192, 5888, 268032, 8388608, 524288, 32768, 4, 6385664, 131072, 0, 0, 218104656, 1
    .long 1, 24, 24, 8192, 4608, 4864, 8388608, 1572864, 32768, 8, 27336704, 131072, 0, 0, 218105152, 4
    .long 2, 64, 72, 7168, 1536, 1536, 7340032, 0, 32768, 8, 54550528, 114688, 0, 0, 218103808, 1
    .long 2, 64, 72, 7168, 512, 512, 7340032, 1572864, 32768, 8, 60039168, 114688, 0, 0, 218104000, 1
    .long 2, 64, 72, 7168, 6656, 6656, 7340032, 2621440, 32768, 8, 63807488, 114688, 0, 0, 218104176, 1
    .long 1, 80, 80, 2048, 3670528, 3670784, 7340032, 61923328, 114688, 7, 178266112, 32768, 218104096, 7, 218106624, 1
    .long 0, 0, 0, 0, 0, 0, 0, 0, 0, 0, 0, 0, 0, 0, 0, 0
    .long 0, 0, 0, 0, 0, 0, 0, 0, 0, 0, 0, 0, 0, 0, 0, 0
    .long 6, 32, 32, 8192, 6400, 268544, 8388608, 0, 32768, 4, 37851136, 131072, 0, 0, 218104416, 1
    .long 4, 32, 32, 8192, 6400, 268544, 8388608, 262144, 32768, 4, 38899712, 131072, 0, 0, 218104544, 1
    .long 4, 16, 16, 8192, 7936, 270080, 8388608, 524288, 32768, 4, 6418432, 131072, 0, 0, 218104688, 1
    .long 1, 24, 24, 8192, 6656, 6912, 8388608, 1572864, 32768, 8, 27369472, 131072, 0, 0, 218105184, 4
    .long 2, 64, 72, 7168, 1792, 1792, 7340032, 0, 32768, 8, 54554624, 114688, 0, 0, 218103824, 1
    .long 2, 64, 72, 7168, 768, 768, 7340032, 1572864, 32768, 8, 60043264, 114688, 0, 0, 218104000, 1
    .long 2, 64, 72, 7168, 6912, 6912, 7340032, 2621440, 32768, 8, 63811584, 114688, 0, 0, 218104176, 1
    .long 1, 80, 80, 2048, 5505536, 5505792, 7340032, 61952000, 114688, 7, 182460416, 32768, 218104112, 7, 218106624, 1
    .long 0, 0, 0, 0, 0, 0, 0, 0, 0, 0, 0, 0, 0, 0, 0, 0
    .long 0, 0, 0, 0, 0, 0, 0, 0, 0, 0, 0, 0, 0, 0, 0, 0
    .long 6, 32, 32, 8192, 512, 262656, 8388608, 0, 32768, 4, 37756928, 131072, 0, 0, 218104320, 1
    .long 4, 32, 32, 8192, 512, 262656, 8388608, 262144, 32768, 4, 38805504, 131072, 0, 0, 218104448, 1
    .long 4, 16, 16, 8192, 1536, 263680, 8388608, 786432, 32768, 4, 7364608, 131072, 0, 0, 218104592, 1
    .long 1, 24, 24, 8192, 1024, 1280, 8388608, 1572864, 32768, 8, 27279360, 131072, 0, 0, 218105104, 4
    .long 2, 64, 72, 7168, 2048, 2048, 7340032, 0, 32768, 8, 54558720, 114688, 0, 0, 218103824, 1
    .long 2, 64, 72, 7168, 1024, 1024, 7340032, 1572864, 32768, 8, 60047360, 114688, 0, 0, 218104000, 1
    .long 2, 64, 72, 7168, 0, 0, 7340032, 3145728, 32768, 8, 65536000, 114688, 0, 0, 218104192, 1
    .long 1, 80, 80, 2048, 1024, 1280, 7340032, 61865984, 114688, 7, 169885696, 32768, 218104064, 7, 218106624, 1
    .long 0, 0, 0, 0, 0, 0, 0, 0, 0, 0, 0, 0, 0, 0, 0, 0
    .long 0, 0, 0, 0, 0, 0, 0, 0, 0, 0, 0, 0, 0, 0, 0, 0
    .long 6, 32, 32, 8192, 2560, 264704, 8388608, 0, 32768, 4, 37789696, 131072, 0, 0, 218104352, 1
    .long 4, 32, 32, 8192, 2560, 264704, 8388608, 262144, 32768, 4, 38838272, 131072, 0, 0, 218104480, 1
    .long 4, 16, 16, 8192, 3584, 265728, 8388608, 786432, 32768, 4, 7397376, 131072, 0, 0, 218104624, 1
    .long 1, 24, 24, 8192, 3072, 3328, 8388608, 1572864, 32768, 8, 27312128, 131072, 0, 0, 218105136, 4
    .long 2, 64, 72, 7168, 2304, 2304, 7340032, 0, 32768, 8, 54562816, 114688, 0, 0, 218103824, 1
    .long 2, 64, 72, 7168, 1280, 1280, 7340032, 1572864, 32768, 8, 60051456, 114688, 0, 0, 218104000, 1
    .long 2, 64, 72, 7168, 256, 256, 7340032, 3145728, 32768, 8, 65540096, 114688, 0, 0, 218104192, 1
    .long 1, 80, 80, 2048, 1836032, 1836288, 7340032, 61894656, 114688, 7, 174080000, 32768, 218104080, 7, 218106624, 1
    .long 0, 0, 0, 0, 0, 0, 0, 0, 0, 0, 0, 0, 0, 0, 0, 0
    .long 0, 0, 0, 0, 0, 0, 0, 0, 0, 0, 0, 0, 0, 0, 0, 0
    .long 6, 32, 32, 8192, 4608, 266752, 8388608, 0, 32768, 4, 37822464, 131072, 0, 0, 218104384, 1
    .long 4, 32, 32, 8192, 4608, 266752, 8388608, 262144, 32768, 4, 38871040, 131072, 0, 0, 218104512, 1
    .long 4, 16, 16, 8192, 5632, 267776, 8388608, 786432, 32768, 4, 7430144, 131072, 0, 0, 218104656, 1
    .long 1, 24, 24, 8192, 5120, 5376, 8388608, 1572864, 32768, 8, 27344896, 131072, 0, 0, 218105168, 4
    .long 2, 64, 72, 7168, 2560, 2560, 7340032, 0, 32768, 8, 54566912, 114688, 0, 0, 218103824, 1
    .long 2, 64, 72, 7168, 1536, 1536, 7340032, 1572864, 32768, 8, 60055552, 114688, 0, 0, 218104000, 1
    .long 2, 64, 72, 7168, 512, 512, 7340032, 3145728, 32768, 8, 65544192, 114688, 0, 0, 218104192, 1
    .long 1, 80, 80, 2048, 3671040, 3671296, 7340032, 61923328, 114688, 7, 178274304, 32768, 218104096, 7, 218106624, 1
    .long 0, 0, 0, 0, 0, 0, 0, 0, 0, 0, 0, 0, 0, 0, 0, 0
    .long 0, 0, 0, 0, 0, 0, 0, 0, 0, 0, 0, 0, 0, 0, 0, 0
    .long 6, 32, 32, 8192, 6656, 268800, 8388608, 0, 32768, 4, 37855232, 131072, 0, 0, 218104416, 1
    .long 4, 32, 32, 8192, 6656, 268800, 8388608, 262144, 32768, 4, 38903808, 131072, 0, 0, 218104544, 1
    .long 4, 16, 16, 8192, 7680, 269824, 8388608, 786432, 32768, 4, 7462912, 131072, 0, 0, 218104688, 1
    .long 1, 24, 24, 8192, 7168, 7424, 8388608, 1572864, 32768, 8, 27377664, 131072, 0, 0, 218105200, 4
    .long 2, 64, 72, 7168, 2816, 2816, 7340032, 0, 32768, 8, 54571008, 114688, 0, 0, 218103824, 1
    .long 2, 64, 72, 7168, 1792, 1792, 7340032, 1572864, 32768, 8, 60059648, 114688, 0, 0, 218104016, 1
    .long 2, 64, 72, 7168, 768, 768, 7340032, 3145728, 32768, 8, 65548288, 114688, 0, 0, 218104192, 1
    .long 1, 80, 80, 2048, 5506048, 5506304, 7340032, 61952000, 114688, 7, 182468608, 32768, 218104112, 7, 218106624, 1
    .long 0, 0, 0, 0, 0, 0, 0, 0, 0, 0, 0, 0, 0, 0, 0, 0
    .long 0, 0, 0, 0, 0, 0, 0, 0, 0, 0, 0, 0, 0, 0, 0, 0
    .long 6, 32, 32, 8192, 768, 262912, 8388608, 0, 32768, 4, 37761024, 131072, 0, 0, 218104320, 1
    .long 4, 32, 32, 8192, 768, 262912, 8388608, 262144, 32768, 4, 38809600, 131072, 0, 0, 218104448, 1
    .long 4, 16, 16, 8192, 1536, 263680, 8388608, 524288, 32768, 4, 6316032, 131072, 0, 0, 218104592, 1
    .long 1, 24, 24, 8192, 1536, 1792, 8388608, 1572864, 32768, 8, 27287552, 131072, 0, 0, 218105104, 4
    .long 2, 64, 72, 7168, 3072, 3072, 7340032, 0, 32768, 8, 54575104, 114688, 0, 0, 218103824, 1
    .long 2, 64, 72, 7168, 2048, 2048, 7340032, 1572864, 32768, 8, 60063744, 114688, 0, 0, 218104016, 1
    .long 2, 64, 72, 7168, 1024, 1024, 7340032, 3145728, 32768, 8, 65552384, 114688, 0, 0, 218104192, 1
    .long 1, 80, 80, 2048, 1536, 1792, 7340032, 61865984, 114688, 7, 169893888, 32768, 218104064, 7, 218106624, 1
    .long 0, 0, 0, 0, 0, 0, 0, 0, 0, 0, 0, 0, 0, 0, 0, 0
    .long 0, 0, 0, 0, 0, 0, 0, 0, 0, 0, 0, 0, 0, 0, 0, 0
    .long 6, 32, 32, 8192, 2816, 264960, 8388608, 0, 32768, 4, 37793792, 131072, 0, 0, 218104352, 1
    .long 4, 32, 32, 8192, 2816, 264960, 8388608, 262144, 32768, 4, 38842368, 131072, 0, 0, 218104480, 1
    .long 4, 16, 16, 8192, 3584, 265728, 8388608, 524288, 32768, 4, 6348800, 131072, 0, 0, 218104624, 1
    .long 1, 24, 24, 8192, 3584, 3840, 8388608, 1572864, 32768, 8, 27320320, 131072, 0, 0, 218105136, 4
    .long 2, 64, 72, 7168, 3328, 3328, 7340032, 0, 32768, 8, 54579200, 114688, 0, 0, 218103824, 1
    .long 2, 64, 72, 7168, 2304, 2304, 7340032, 1572864, 32768, 8, 60067840, 114688, 0, 0, 218104016, 1
    .long 2, 64, 72, 7168, 1280, 1280, 7340032, 3145728, 32768, 8, 65556480, 114688, 0, 0, 218104192, 1
    .long 1, 80, 80, 2048, 1836544, 1836800, 7340032, 61894656, 114688, 7, 174088192, 32768, 218104080, 7, 218106624, 1
    .long 0, 0, 0, 0, 0, 0, 0, 0, 0, 0, 0, 0, 0, 0, 0, 0
    .long 0, 0, 0, 0, 0, 0, 0, 0, 0, 0, 0, 0, 0, 0, 0, 0
    .long 6, 32, 32, 8192, 4864, 267008, 8388608, 0, 32768, 4, 37826560, 131072, 0, 0, 218104384, 1
    .long 4, 32, 32, 8192, 4864, 267008, 8388608, 262144, 32768, 4, 38875136, 131072, 0, 0, 218104512, 1
    .long 4, 16, 16, 8192, 5632, 267776, 8388608, 524288, 32768, 4, 6381568, 131072, 0, 0, 218104656, 1
    .long 1, 24, 24, 8192, 5632, 5888, 8388608, 1572864, 32768, 8, 27353088, 131072, 0, 0, 218105168, 4
    .long 2, 64, 72, 7168, 3584, 3584, 7340032, 0, 32768, 8, 54583296, 114688, 0, 0, 218103840, 1
    .long 2, 64, 72, 7168, 2560, 2560, 7340032, 1572864, 32768, 8, 60071936, 114688, 0, 0, 218104016, 1
    .long 2, 64, 72, 7168, 1536, 1536, 7340032, 3145728, 32768, 8, 65560576, 114688, 0, 0, 218104192, 1
    .long 1, 80, 80, 2048, 3671552, 3671808, 7340032, 61923328, 114688, 7, 178282496, 32768, 218104096, 7, 218106624, 1
    .long 0, 0, 0, 0, 0, 0, 0, 0, 0, 0, 0, 0, 0, 0, 0, 0
    .long 0, 0, 0, 0, 0, 0, 0, 0, 0, 0, 0, 0, 0, 0, 0, 0
    .long 6, 32, 32, 8192, 6912, 269056, 8388608, 0, 32768, 4, 37859328, 131072, 0, 0, 218104416, 1
    .long 4, 32, 32, 8192, 6912, 269056, 8388608, 262144, 32768, 4, 38907904, 131072, 0, 0, 218104544, 1
    .long 4, 16, 16, 8192, 7680, 269824, 8388608, 524288, 32768, 4, 6414336, 131072, 0, 0, 218104688, 1
    .long 1, 24, 24, 8192, 7680, 7936, 8388608, 1572864, 32768, 8, 27385856, 131072, 0, 0, 218105200, 4
    .long 2, 64, 72, 7168, 3840, 3840, 7340032, 0, 32768, 8, 54587392, 114688, 0, 0, 218103840, 1
    .long 2, 64, 72, 7168, 2816, 2816, 7340032, 1572864, 32768, 8, 60076032, 114688, 0, 0, 218104016, 1
    .long 2, 64, 72, 7168, 1792, 1792, 7340032, 3145728, 32768, 8, 65564672, 114688, 0, 0, 218104208, 1
    .long 1, 80, 80, 2048, 5506560, 5506816, 7340032, 61952000, 114688, 7, 182476800, 32768, 218104112, 7, 218106624, 1
    .long 0, 0, 0, 0, 0, 0, 0, 0, 0, 0, 0, 0, 0, 0, 0, 0
    .long 0, 0, 0, 0, 0, 0, 0, 0, 0, 0, 0, 0, 0, 0, 0, 0
    .long 6, 32, 32, 8192, 1024, 263168, 8388608, 0, 32768, 4, 37765120, 131072, 0, 0, 218104336, 1
    .long 4, 32, 32, 8192, 1024, 263168, 8388608, 262144, 32768, 4, 38813696, 131072, 0, 0, 218104464, 1
    .long 4, 16, 16, 8192, 1280, 263424, 8388608, 786432, 32768, 4, 7360512, 131072, 0, 0, 218104592, 1
    .long 1, 16, 16, 8192, 0, 256, 8388608, 1572864, 32768, 8, 10485760, 131072, 0, 0, 218105088, 4
    .long 2, 64, 72, 7168, 4096, 4096, 7340032, 0, 32768, 8, 54591488, 114688, 0, 0, 218103840, 1
    .long 2, 64, 72, 7168, 3072, 3072, 7340032, 1572864, 32768, 8, 60080128, 114688, 0, 0, 218104016, 1
    .long 2, 64, 72, 7168, 2048, 2048, 7340032, 3145728, 32768, 8, 65568768, 114688, 0, 0, 218104208, 1
    .long 1, 80, 80, 2048, 0, 256, 7340032, 63700992, 114688, 7, 170393600, 32768, 218104128, 7, 218106688, 1
    .long 0, 0, 0, 0, 0, 0, 0, 0, 0, 0, 0, 0, 0, 0, 0, 0
    .long 0, 0, 0, 0, 0, 0, 0, 0, 0, 0, 0, 0, 0, 0, 0, 0
    .long 6, 32, 32, 8192, 3072, 265216, 8388608, 0, 32768, 4, 37797888, 131072, 0, 0, 218104368, 1
    .long 4, 32, 32, 8192, 3072, 265216, 8388608, 262144, 32768, 4, 38846464, 131072, 0, 0, 218104496, 1
    .long 4, 16, 16, 8192, 3328, 265472, 8388608, 786432, 32768, 4, 7393280, 131072, 0, 0, 218104624, 1
    .long 1, 16, 16, 8192, 2048, 2304, 8388608, 1572864, 32768, 8, 10518528, 131072, 0, 0, 218105120, 4
    .long 2, 64, 72, 7168, 4352, 4352, 7340032, 0, 32768, 8, 54595584, 114688, 0, 0, 218103840, 1
    .long 2, 64, 72, 7168, 3328, 3328, 7340032, 1572864, 32768, 8, 60084224, 114688, 0, 0, 218104016, 1
    .long 2, 64, 72, 7168, 2304, 2304, 7340032, 3145728, 32768, 8, 65572864, 114688, 0, 0, 218104208, 1
    .long 1, 80, 80, 2048, 1835008, 1835264, 7340032, 63729664, 114688, 7, 174587904, 32768, 218104144, 7, 218106688, 1
    .long 0, 0, 0, 0, 0, 0, 0, 0, 0, 0, 0, 0, 0, 0, 0, 0
    .long 0, 0, 0, 0, 0, 0, 0, 0, 0, 0, 0, 0, 0, 0, 0, 0
    .long 6, 32, 32, 8192, 5120, 267264, 8388608, 0, 32768, 4, 37830656, 131072, 0, 0, 218104400, 1
    .long 4, 32, 32, 8192, 5120, 267264, 8388608, 262144, 32768, 4, 38879232, 131072, 0, 0, 218104528, 1
    .long 4, 16, 16, 8192, 5376, 267520, 8388608, 786432, 32768, 4, 7426048, 131072, 0, 0, 218104656, 1
    .long 1, 16, 16, 8192, 4096, 4352, 8388608, 1572864, 32768, 8, 10551296, 131072, 0, 0, 218105152, 4
    .long 2, 64, 72, 7168, 4608, 4608, 7340032, 0, 32768, 8, 54599680, 114688, 0, 0, 218103840, 1
    .long 2, 64, 72, 7168, 3584, 3584, 7340032, 1572864, 32768, 8, 60088320, 114688, 0, 0, 218104032, 1
    .long 2, 64, 72, 7168, 2560, 2560, 7340032, 3145728, 32768, 8, 65576960, 114688, 0, 0, 218104208, 1
    .long 1, 80, 80, 2048, 3670016, 3670272, 7340032, 63758336, 114688, 7, 178782208, 32768, 218104160, 7, 218106688, 1
    .long 0, 0, 0, 0, 0, 0, 0, 0, 0, 0, 0, 0, 0, 0, 0, 0
    .long 0, 0, 0, 0, 0, 0, 0, 0, 0, 0, 0, 0, 0, 0, 0, 0
    .long 6, 32, 32, 8192, 7168, 269312, 8388608, 0, 32768, 4, 37863424, 131072, 0, 0, 218104432, 1
    .long 4, 32, 32, 8192, 7168, 269312, 8388608, 262144, 32768, 4, 38912000, 131072, 0, 0, 218104560, 1
    .long 4, 16, 16, 8192, 7424, 269568, 8388608, 786432, 32768, 4, 7458816, 131072, 0, 0, 218104688, 1
    .long 1, 16, 16, 8192, 6144, 6400, 8388608, 1572864, 32768, 8, 10584064, 131072, 0, 0, 218105184, 4
    .long 2, 64, 72, 7168, 4864, 4864, 7340032, 0, 32768, 8, 54603776, 114688, 0, 0, 218103840, 1
    .long 2, 64, 72, 7168, 3840, 3840, 7340032, 1572864, 32768, 8, 60092416, 114688, 0, 0, 218104032, 1
    .long 2, 64, 72, 7168, 2816, 2816, 7340032, 3145728, 32768, 8, 65581056, 114688, 0, 0, 218104208, 1
    .long 1, 80, 80, 2048, 5505024, 5505280, 7340032, 63787008, 114688, 7, 182976512, 32768, 218104176, 7, 218106688, 1
    .long 0, 0, 0, 0, 0, 0, 0, 0, 0, 0, 0, 0, 0, 0, 0, 0
    .long 0, 0, 0, 0, 0, 0, 0, 0, 0, 0, 0, 0, 0, 0, 0, 0
    .long 6, 32, 32, 8192, 1280, 263424, 8388608, 0, 32768, 4, 37769216, 131072, 0, 0, 218104336, 1
    .long 4, 32, 32, 8192, 1280, 263424, 8388608, 262144, 32768, 4, 38817792, 131072, 0, 0, 218104464, 1
    .long 4, 16, 16, 8192, 1280, 263424, 8388608, 524288, 32768, 4, 6311936, 131072, 0, 0, 218104592, 1
    .long 1, 16, 16, 8192, 512, 768, 8388608, 1572864, 32768, 8, 10493952, 131072, 0, 0, 218105088, 4
    .long 2, 64, 72, 7168, 5120, 5120, 7340032, 0, 32768, 8, 54607872, 114688, 0, 0, 218103840, 1
    .long 2, 64, 72, 7168, 4096, 4096, 7340032, 1572864, 32768, 8, 60096512, 114688, 0, 0, 218104032, 1
    .long 2, 64, 72, 7168, 3072, 3072, 7340032, 3145728, 32768, 8, 65585152, 114688, 0, 0, 218104208, 1
    .long 1, 80, 80, 2048, 512, 768, 7340032, 63700992, 114688, 7, 170401792, 32768, 218104128, 7, 218106688, 1
    .long 0, 0, 0, 0, 0, 0, 0, 0, 0, 0, 0, 0, 0, 0, 0, 0
    .long 0, 0, 0, 0, 0, 0, 0, 0, 0, 0, 0, 0, 0, 0, 0, 0
    .long 6, 32, 32, 8192, 3328, 265472, 8388608, 0, 32768, 4, 37801984, 131072, 0, 0, 218104368, 1
    .long 4, 32, 32, 8192, 3328, 265472, 8388608, 262144, 32768, 4, 38850560, 131072, 0, 0, 218104496, 1
    .long 4, 16, 16, 8192, 3328, 265472, 8388608, 524288, 32768, 4, 6344704, 131072, 0, 0, 218104624, 1
    .long 1, 16, 16, 8192, 2560, 2816, 8388608, 1572864, 32768, 8, 10526720, 131072, 0, 0, 218105120, 4
    .long 2, 64, 72, 7168, 5376, 5376, 7340032, 0, 32768, 8, 54611968, 114688, 0, 0, 218103856, 1
    .long 2, 64, 72, 7168, 4352, 4352, 7340032, 1572864, 32768, 8, 60100608, 114688, 0, 0, 218104032, 1
    .long 2, 64, 72, 7168, 3328, 3328, 7340032, 3145728, 32768, 8, 65589248, 114688, 0, 0, 218104208, 1
    .long 1, 80, 80, 2048, 1835520, 1835776, 7340032, 63729664, 114688, 7, 174596096, 32768, 218104144, 7, 218106688, 1
    .long 0, 0, 0, 0, 0, 0, 0, 0, 0, 0, 0, 0, 0, 0, 0, 0
    .long 0, 0, 0, 0, 0, 0, 0, 0, 0, 0, 0, 0, 0, 0, 0, 0
    .long 6, 32, 32, 8192, 5376, 267520, 8388608, 0, 32768, 4, 37834752, 131072, 0, 0, 218104400, 1
    .long 4, 32, 32, 8192, 5376, 267520, 8388608, 262144, 32768, 4, 38883328, 131072, 0, 0, 218104528, 1
    .long 4, 16, 16, 8192, 5376, 267520, 8388608, 524288, 32768, 4, 6377472, 131072, 0, 0, 218104656, 1
    .long 1, 16, 16, 8192, 4608, 4864, 8388608, 1572864, 32768, 8, 10559488, 131072, 0, 0, 218105152, 4
    .long 2, 64, 72, 7168, 5632, 5632, 7340032, 0, 32768, 8, 54616064, 114688, 0, 0, 218103856, 1
    .long 2, 64, 72, 7168, 4608, 4608, 7340032, 1572864, 32768, 8, 60104704, 114688, 0, 0, 218104032, 1
    .long 2, 64, 72, 7168, 3584, 3584, 7340032, 3145728, 32768, 8, 65593344, 114688, 0, 0, 218104224, 1
    .long 1, 80, 80, 2048, 3670528, 3670784, 7340032, 63758336, 114688, 7, 178790400, 32768, 218104160, 7, 218106688, 1
    .long 0, 0, 0, 0, 0, 0, 0, 0, 0, 0, 0, 0, 0, 0, 0, 0
    .long 0, 0, 0, 0, 0, 0, 0, 0, 0, 0, 0, 0, 0, 0, 0, 0
    .long 6, 32, 32, 8192, 7424, 269568, 8388608, 0, 32768, 4, 37867520, 131072, 0, 0, 218104432, 1
    .long 4, 32, 32, 8192, 7424, 269568, 8388608, 262144, 32768, 4, 38916096, 131072, 0, 0, 218104560, 1
    .long 4, 16, 16, 8192, 7424, 269568, 8388608, 524288, 32768, 4, 6410240, 131072, 0, 0, 218104688, 1
    .long 1, 16, 16, 8192, 6656, 6912, 8388608, 1572864, 32768, 8, 10592256, 131072, 0, 0, 218105184, 4
    .long 2, 64, 72, 7168, 5888, 5888, 7340032, 0, 32768, 8, 54620160, 114688, 0, 0, 218103856, 1
    .long 2, 64, 72, 7168, 4864, 4864, 7340032, 1572864, 32768, 8, 60108800, 114688, 0, 0, 218104032, 1
    .long 2, 64, 72, 7168, 3840, 3840, 7340032, 3145728, 32768, 8, 65597440, 114688, 0, 0, 218104224, 1
    .long 1, 80, 80, 2048, 5505536, 5505792, 7340032, 63787008, 114688, 7, 182984704, 32768, 218104176, 7, 218106688, 1
    .long 0, 0, 0, 0, 0, 0, 0, 0, 0, 0, 0, 0, 0, 0, 0, 0
    .long 0, 0, 0, 0, 0, 0, 0, 0, 0, 0, 0, 0, 0, 0, 0, 0
    .long 6, 32, 32, 8192, 1536, 263680, 8388608, 0, 32768, 4, 37773312, 131072, 0, 0, 218104336, 1
    .long 4, 32, 32, 8192, 1536, 263680, 8388608, 262144, 32768, 4, 38821888, 131072, 0, 0, 218104464, 1
    .long 4, 16, 16, 8192, 1024, 263168, 8388608, 786432, 32768, 4, 7356416, 131072, 0, 0, 218104592, 1
    .long 1, 16, 16, 8192, 1024, 1280, 8388608, 1572864, 32768, 8, 10502144, 131072, 0, 0, 218105104, 4
    .long 2, 64, 72, 7168, 6144, 6144, 7340032, 0, 32768, 8, 54624256, 114688, 0, 0, 218103856, 1
    .long 2, 64, 72, 7168, 5120, 5120, 7340032, 1572864, 32768, 8, 60112896, 114688, 0, 0, 218104032, 1
    .long 2, 64, 72, 7168, 4096, 4096, 7340032, 3145728, 32768, 8, 65601536, 114688, 0, 0, 218104224, 1
    .long 1, 80, 80, 2048, 1024, 1280, 7340032, 63700992, 114688, 7, 170409984, 32768, 218104128, 7, 218106688, 1
    .long 0, 0, 0, 0, 0, 0, 0, 0, 0, 0, 0, 0, 0, 0, 0, 0
    .long 0, 0, 0, 0, 0, 0, 0, 0, 0, 0, 0, 0, 0, 0, 0, 0
    .long 6, 32, 32, 8192, 3584, 265728, 8388608, 0, 32768, 4, 37806080, 131072, 0, 0, 218104368, 1
    .long 4, 32, 32, 8192, 3584, 265728, 8388608, 262144, 32768, 4, 38854656, 131072, 0, 0, 218104496, 1
    .long 4, 16, 16, 8192, 3072, 265216, 8388608, 786432, 32768, 4, 7389184, 131072, 0, 0, 218104624, 1
    .long 1, 16, 16, 8192, 3072, 3328, 8388608, 1572864, 32768, 8, 10534912, 131072, 0, 0, 218105136, 4
    .long 2, 64, 72, 7168, 6400, 6400, 7340032, 0, 32768, 8, 54628352, 114688, 0, 0, 218103856, 1
    .long 2, 64, 72, 7168, 5376, 5376, 7340032, 1572864, 32768, 8, 60116992, 114688, 0, 0, 218104048, 1
    .long 2, 64, 72, 7168, 4352, 4352, 7340032, 3145728, 32768, 8, 65605632, 114688, 0, 0, 218104224, 1
    .long 1, 80, 80, 2048, 1836032, 1836288, 7340032, 63729664, 114688, 7, 174604288, 32768, 218104144, 7, 218106688, 1
    .long 0, 0, 0, 0, 0, 0, 0, 0, 0, 0, 0, 0, 0, 0, 0, 0
    .long 0, 0, 0, 0, 0, 0, 0, 0, 0, 0, 0, 0, 0, 0, 0, 0
    .long 6, 32, 32, 8192, 5632, 267776, 8388608, 0, 32768, 4, 37838848, 131072, 0, 0, 218104400, 1
    .long 4, 32, 32, 8192, 5632, 267776, 8388608, 262144, 32768, 4, 38887424, 131072, 0, 0, 218104528, 1
    .long 4, 16, 16, 8192, 5120, 267264, 8388608, 786432, 32768, 4, 7421952, 131072, 0, 0, 218104656, 1
    .long 1, 16, 16, 8192, 5120, 5376, 8388608, 1572864, 32768, 8, 10567680, 131072, 0, 0, 218105168, 4
    .long 2, 64, 72, 7168, 6656, 6656, 7340032, 0, 32768, 8, 54632448, 114688, 0, 0, 218103856, 1
    .long 2, 64, 72, 7168, 5632, 5632, 7340032, 1572864, 32768, 8, 60121088, 114688, 0, 0, 218104048, 1
    .long 2, 64, 72, 7168, 4608, 4608, 7340032, 3145728, 32768, 8, 65609728, 114688, 0, 0, 218104224, 1
    .long 1, 80, 80, 2048, 3671040, 3671296, 7340032, 63758336, 114688, 7, 178798592, 32768, 218104160, 7, 218106688, 1
    .long 0, 0, 0, 0, 0, 0, 0, 0, 0, 0, 0, 0, 0, 0, 0, 0
    .long 0, 0, 0, 0, 0, 0, 0, 0, 0, 0, 0, 0, 0, 0, 0, 0
    .long 6, 32, 32, 8192, 7680, 269824, 8388608, 0, 32768, 4, 37871616, 131072, 0, 0, 218104432, 1
    .long 4, 32, 32, 8192, 7680, 269824, 8388608, 262144, 32768, 4, 38920192, 131072, 0, 0, 218104560, 1
    .long 4, 16, 16, 8192, 7168, 269312, 8388608, 786432, 32768, 4, 7454720, 131072, 0, 0, 218104688, 1
    .long 1, 16, 16, 8192, 7168, 7424, 8388608, 1572864, 32768, 8, 10600448, 131072, 0, 0, 218105200, 4
    .long 2, 64, 72, 7168, 6912, 6912, 7340032, 0, 32768, 8, 54636544, 114688, 0, 0, 218103856, 1
    .long 2, 64, 72, 7168, 5888, 5888, 7340032, 1572864, 32768, 8, 60125184, 114688, 0, 0, 218104048, 1
    .long 2, 64, 72, 7168, 4864, 4864, 7340032, 3145728, 32768, 8, 65613824, 114688, 0, 0, 218104224, 1
    .long 1, 80, 80, 2048, 5506048, 5506304, 7340032, 63787008, 114688, 7, 182992896, 32768, 218104176, 7, 218106688, 1
    .long 0, 0, 0, 0, 0, 0, 0, 0, 0, 0, 0, 0, 0, 0, 0, 0
    .long 0, 0, 0, 0, 0, 0, 0, 0, 0, 0, 0, 0, 0, 0, 0, 0
    .long 6, 32, 32, 8192, 1792, 263936, 8388608, 0, 32768, 4, 37777408, 131072, 0, 0, 218104336, 1
    .long 4, 32, 32, 8192, 1792, 263936, 8388608, 262144, 32768, 4, 38825984, 131072, 0, 0, 218104464, 1
    .long 4, 16, 16, 8192, 1024, 263168, 8388608, 524288, 32768, 4, 6307840, 131072, 0, 0, 218104592, 1
    .long 1, 16, 16, 8192, 1536, 1792, 8388608, 1572864, 32768, 8, 10510336, 131072, 0, 0, 218105104, 4
    .long 2, 64, 72, 7168, 0, 0, 7340032, 524288, 32768, 8, 56360960, 114688, 0, 0, 218103872, 1
    .long 2, 64, 72, 7168, 6144, 6144, 7340032, 1572864, 32768, 8, 60129280, 114688, 0, 0, 218104048, 1
    .long 2, 64, 72, 7168, 5120, 5120, 7340032, 3145728, 32768, 8, 65617920, 114688, 0, 0, 218104224, 1
    .long 1, 80, 80, 2048, 1536, 1792, 7340032, 63700992, 114688, 7, 170418176, 32768, 218104128, 7, 218106688, 1
    .long 0, 0, 0, 0, 0, 0, 0, 0, 0, 0, 0, 0, 0, 0, 0, 0
    .long 0, 0, 0, 0, 0, 0, 0, 0, 0, 0, 0, 0, 0, 0, 0, 0
    .long 6, 32, 32, 8192, 3840, 265984, 8388608, 0, 32768, 4, 37810176, 131072, 0, 0, 218104368, 1
    .long 4, 32, 32, 8192, 3840, 265984, 8388608, 262144, 32768, 4, 38858752, 131072, 0, 0, 218104496, 1
    .long 4, 16, 16, 8192, 3072, 265216, 8388608, 524288, 32768, 4, 6340608, 131072, 0, 0, 218104624, 1
    .long 1, 16, 16, 8192, 3584, 3840, 8388608, 1572864, 32768, 8, 10543104, 131072, 0, 0, 218105136, 4
    .long 2, 64, 72, 7168, 256, 256, 7340032, 524288, 32768, 8, 56365056, 114688, 0, 0, 218103872, 1
    .long 2, 64, 72, 7168, 6400, 6400, 7340032, 1572864, 32768, 8, 60133376, 114688, 0, 0, 218104048, 1
    .long 2, 64, 72, 7168, 5376, 5376, 7340032, 3145728, 32768, 8, 65622016, 114688, 0, 0, 218104240, 1
    .long 1, 80, 80, 2048, 1836544, 1836800, 7340032, 63729664, 114688, 7, 174612480, 32768, 218104144, 7, 218106688, 1
    .long 0, 0, 0, 0, 0, 0, 0, 0, 0, 0, 0, 0, 0, 0, 0, 0
    .long 0, 0, 0, 0, 0, 0, 0, 0, 0, 0, 0, 0, 0, 0, 0, 0
    .long 6, 32, 32, 8192, 5888, 268032, 8388608, 0, 32768, 4, 37842944, 131072, 0, 0, 218104400, 1
    .long 4, 32, 32, 8192, 5888, 268032, 8388608, 262144, 32768, 4, 38891520, 131072, 0, 0, 218104528, 1
    .long 4, 16, 16, 8192, 5120, 267264, 8388608, 524288, 32768, 4, 6373376, 131072, 0, 0, 218104656, 1
    .long 1, 16, 16, 8192, 5632, 5888, 8388608, 1572864, 32768, 8, 10575872, 131072, 0, 0, 218105168, 4
    .long 2, 64, 72, 7168, 512, 512, 7340032, 524288, 32768, 8, 56369152, 114688, 0, 0, 218103872, 1
    .long 2, 64, 72, 7168, 6656, 6656, 7340032, 1572864, 32768, 8, 60137472, 114688, 0, 0, 218104048, 1
    .long 2, 64, 72, 7168, 5632, 5632, 7340032, 3145728, 32768, 8, 65626112, 114688, 0, 0, 218104240, 1
    .long 1, 80, 80, 2048, 3671552, 3671808, 7340032, 63758336, 114688, 7, 178806784, 32768, 218104160, 7, 218106688, 1
    .long 0, 0, 0, 0, 0, 0, 0, 0, 0, 0, 0, 0, 0, 0, 0, 0
    .long 0, 0, 0, 0, 0, 0, 0, 0, 0, 0, 0, 0, 0, 0, 0, 0
    .long 6, 32, 32, 8192, 7936, 270080, 8388608, 0, 32768, 4, 37875712, 131072, 0, 0, 218104432, 1
    .long 4, 32, 32, 8192, 7936, 270080, 8388608, 262144, 32768, 4, 38924288, 131072, 0, 0, 218104560, 1
    .long 4, 16, 16, 8192, 7168, 269312, 8388608, 524288, 32768, 4, 6406144, 131072, 0, 0, 218104688, 1
    .long 1, 16, 16, 8192, 7680, 7936, 8388608, 1572864, 32768, 8, 10608640, 131072, 0, 0, 218105200, 4
    .long 2, 64, 72, 7168, 768, 768, 7340032, 524288, 32768, 8, 56373248, 114688, 0, 0, 218103872, 1
    .long 2, 64, 72, 7168, 6912, 6912, 7340032, 1572864, 32768, 8, 60141568, 114688, 0, 0, 218104048, 1
    .long 2, 64, 72, 7168, 5888, 5888, 7340032, 3145728, 32768, 8, 65630208, 114688, 0, 0, 218104240, 1
    .long 1, 80, 80, 2048, 5506560, 5506816, 7340032, 63787008, 114688, 7, 183001088, 32768, 218104176, 7, 218106688, 1
    .long 0, 0, 0, 0, 0, 0, 0, 0, 0, 0, 0, 0, 0, 0, 0, 0
    .long 0, 0, 0, 0, 0, 0, 0, 0, 0, 0, 0, 0, 0, 0, 0, 0
    .long 6, 16, 16, 8192, 0, 262144, 8388608, 0, 32768, 4, 4194304, 131072, 0, 0, 218104320, 1
    .long 4, 16, 16, 8192, 0, 262144, 8388608, 262144, 32768, 4, 5242880, 131072, 0, 0, 218104448, 1
    .long 4, 16, 16, 8192, 0, 262144, 8388608, 524288, 32768, 4, 6291456, 131072, 0, 0, 218104576, 1
    .long 1, 32, 32, 8192, 0, 256, 8388608, 2097152, 32768, 8, 46137344, 131072, 0, 0, 218105344, 4
    .long 2, 64, 72, 7168, 1024, 1024, 7340032, 524288, 32768, 8, 56377344, 114688, 0, 0, 218103872, 1
    .long 2, 64, 72, 7168, 0, 0, 7340032, 2097152, 32768, 8, 61865984, 114688, 0, 0, 218104064, 1
    .long 2, 64, 72, 7168, 6144, 6144, 7340032, 3145728, 32768, 8, 65634304, 114688, 0, 0, 218104240, 1
    .long 1, 80, 80, 2048, 0, 256, 7340032, 65536000, 114688, 7, 170917888, 32768, 218104192, 7, 218106752, 1
    .long 0, 0, 0, 0, 0, 0, 0, 0, 0, 0, 0, 0, 0, 0, 0, 0
    .long 0, 0, 0, 0, 0, 0, 0, 0, 0, 0, 0, 0, 0, 0, 0, 0
    .long 6, 16, 16, 8192, 2048, 264192, 8388608, 0, 32768, 4, 4227072, 131072, 0, 0, 218104352, 1
    .long 4, 16, 16, 8192, 2048, 264192, 8388608, 262144, 32768, 4, 5275648, 131072, 0, 0, 218104480, 1
    .long 4, 16, 16, 8192, 2048, 264192, 8388608, 524288, 32768, 4, 6324224, 131072, 0, 0, 218104608, 1
    .long 1, 32, 32, 8192, 2048, 2304, 8388608, 2097152, 32768, 8, 46170112, 131072, 0, 0, 218105376, 4
    .long 2, 64, 72, 7168, 1280, 1280, 7340032, 524288, 32768, 8, 56381440, 114688, 0, 0, 218103872, 1
    .long 2, 64, 72, 7168, 256, 256, 7340032, 2097152, 32768, 8, 61870080, 114688, 0, 0, 218104064, 1
    .long 2, 64, 72, 7168, 6400, 6400, 7340032, 3145728, 32768, 8, 65638400, 114688, 0, 0, 218104240, 1
    .long 1, 80, 80, 2048, 1835008, 1835264, 7340032, 65564672, 114688, 7, 175112192, 32768, 218104208, 7, 218106752, 1
    .long 0, 0, 0, 0, 0, 0, 0, 0, 0, 0, 0, 0, 0, 0, 0, 0
    .long 0, 0, 0, 0, 0, 0, 0, 0, 0, 0, 0, 0, 0, 0, 0, 0
    .long 6, 16, 16, 8192, 4096, 266240, 8388608, 0, 32768, 4, 4259840, 131072, 0, 0, 218104384, 1
    .long 4, 16, 16, 8192, 4096, 266240, 8388608, 262144, 32768, 4, 5308416, 131072, 0, 0, 218104512, 1
    .long 4, 16, 16, 8192, 4096, 266240, 8388608, 524288, 32768, 4, 6356992, 131072, 0, 0, 218104640, 1
    .long 1, 32, 32, 8192, 4096, 4352, 8388608, 2097152, 32768, 8, 46202880, 131072, 0, 0, 218105408, 4
    .long 2, 64, 72, 7168, 1536, 1536, 7340032, 524288, 32768, 8, 56385536, 114688, 0, 0, 218103872, 1
    .long 2, 64, 72, 7168, 512, 512, 7340032, 2097152, 32768, 8, 61874176, 114688, 0, 0, 218104064, 1
    .long 2, 64, 72, 7168, 6656, 6656, 7340032, 3145728, 32768, 8, 65642496, 114688, 0, 0, 218104240, 1
    .long 1, 80, 80, 2048, 3670016, 3670272, 7340032, 65593344, 114688, 7, 179306496, 32768, 218104224, 7, 218106752, 1
    .long 0, 0, 0, 0, 0, 0, 0, 0, 0, 0, 0, 0, 0, 0, 0, 0
    .long 0, 0, 0, 0, 0, 0, 0, 0, 0, 0, 0, 0, 0, 0, 0, 0
    .long 6, 16, 16, 8192, 6144, 268288, 8388608, 0, 32768, 4, 4292608, 131072, 0, 0, 218104416, 1
    .long 4, 16, 16, 8192, 6144, 268288, 8388608, 262144, 32768, 4, 5341184, 131072, 0, 0, 218104544, 1
    .long 4, 16, 16, 8192, 6144, 268288, 8388608, 524288, 32768, 4, 6389760, 131072, 0, 0, 218104672, 1
    .long 1, 32, 32, 8192, 6144, 6400, 8388608, 2097152, 32768, 8, 46235648, 131072, 0, 0, 218105440, 4
    .long 2, 64, 72, 7168, 1792, 1792, 7340032, 524288, 32768, 8, 56389632, 114688, 0, 0, 218103888, 1
    .long 2, 64, 72, 7168, 768, 768, 7340032, 2097152, 32768, 8, 61878272, 114688, 0, 0, 218104064, 1
    .long 2, 64, 72, 7168, 6912, 6912, 7340032, 3145728, 32768, 8, 65646592, 114688, 0, 0, 218104240, 1
    .long 1, 80, 80, 2048, 5505024, 5505280, 7340032, 65622016, 114688, 7, 183500800, 32768, 218104240, 7, 218106752, 1
    .long 0, 0, 0, 0, 0, 0, 0, 0, 0, 0, 0, 0, 0, 0, 0, 0
    .long 0, 0, 0, 0, 0, 0, 0, 0, 0, 0, 0, 0, 0, 0, 0, 0
    .long 6, 16, 16, 8192, 256, 262400, 8388608, 0, 32768, 4, 4198400, 131072, 0, 0, 218104320, 1
    .long 4, 16, 16, 8192, 256, 262400, 8388608, 262144, 32768, 4, 5246976, 131072, 0, 0, 218104448, 1
    .long 4, 16, 16, 8192, 256, 262400, 8388608, 524288, 32768, 4, 6295552, 131072, 0, 0, 218104576, 1
    .long 1, 32, 32, 8192, 512, 768, 8388608, 2097152, 32768, 8, 46145536, 131072, 0, 0, 218105344, 4
    .long 2, 64, 72, 7168, 2048, 2048, 7340032, 524288, 32768, 8, 56393728, 114688, 0, 0, 218103888, 1
    .long 2, 64, 72, 7168, 1024, 1024, 7340032, 2097152, 32768, 8, 61882368, 114688, 0, 0, 218104064, 1
    .long 2, 64, 72, 7168, 0, 0, 7340032, 3670016, 32768, 8, 67371008, 114688, 0, 0, 218104256, 1
    .long 1, 80, 80, 2048, 512, 768, 7340032, 65536000, 114688, 7, 170926080, 32768, 218104192, 7, 218106752, 1
    .long 0, 0, 0, 0, 0, 0, 0, 0, 0, 0, 0, 0, 0, 0, 0, 0
    .long 0, 0, 0, 0, 0, 0, 0, 0, 0, 0, 0, 0, 0, 0, 0, 0
    .long 6, 16, 16, 8192, 2304, 264448, 8388608, 0, 32768, 4, 4231168, 131072, 0, 0, 218104352, 1
    .long 4, 16, 16, 8192, 2304, 264448, 8388608, 262144, 32768, 4, 5279744, 131072, 0, 0, 218104480, 1
    .long 4, 16, 16, 8192, 2304, 264448, 8388608, 524288, 32768, 4, 6328320, 131072, 0, 0, 218104608, 1
    .long 1, 32, 32, 8192, 2560, 2816, 8388608, 2097152, 32768, 8, 46178304, 131072, 0, 0, 218105376, 4
    .long 2, 64, 72, 7168, 2304, 2304, 7340032, 524288, 32768, 8, 56397824, 114688, 0, 0, 218103888, 1
    .long 2, 64, 72, 7168, 1280, 1280, 7340032, 2097152, 32768, 8, 61886464, 114688, 0, 0, 218104064, 1
    .long 2, 64, 72, 7168, 256, 256, 7340032, 3670016, 32768, 8, 67375104, 114688, 0, 0, 218104256, 1
    .long 1, 80, 80, 2048, 1835520, 1835776, 7340032, 65564672, 114688, 7, 175120384, 32768, 218104208, 7, 218106752, 1
    .long 0, 0, 0, 0, 0, 0, 0, 0, 0, 0, 0, 0, 0, 0, 0, 0
    .long 0, 0, 0, 0, 0, 0, 0, 0, 0, 0, 0, 0, 0, 0, 0, 0
    .long 6, 16, 16, 8192, 4352, 266496, 8388608, 0, 32768, 4, 4263936, 131072, 0, 0, 218104384, 1
    .long 4, 16, 16, 8192, 4352, 266496, 8388608, 262144, 32768, 4, 5312512, 131072, 0, 0, 218104512, 1
    .long 4, 16, 16, 8192, 4352, 266496, 8388608, 524288, 32768, 4, 6361088, 131072, 0, 0, 218104640, 1
    .long 1, 32, 32, 8192, 4608, 4864, 8388608, 2097152, 32768, 8, 46211072, 131072, 0, 0, 218105408, 4
    .long 2, 64, 72, 7168, 2560, 2560, 7340032, 524288, 32768, 8, 56401920, 114688, 0, 0, 218103888, 1
    .long 2, 64, 72, 7168, 1536, 1536, 7340032, 2097152, 32768, 8, 61890560, 114688, 0, 0, 218104064, 1
    .long 2, 64, 72, 7168, 512, 512, 7340032, 3670016, 32768, 8, 67379200, 114688, 0, 0, 218104256, 1
    .long 1, 80, 80, 2048, 3670528, 3670784, 7340032, 65593344, 114688, 7, 179314688, 32768, 218104224, 7, 218106752, 1
    .long 0, 0, 0, 0, 0, 0, 0, 0, 0, 0, 0, 0, 0, 0, 0, 0
    .long 0, 0, 0, 0, 0, 0, 0, 0, 0, 0, 0, 0, 0, 0, 0, 0
    .long 6, 16, 16, 8192, 6400, 268544, 8388608, 0, 32768, 4, 4296704, 131072, 0, 0, 218104416, 1
    .long 4, 16, 16, 8192, 6400, 268544, 8388608, 262144, 32768, 4, 5345280, 131072, 0, 0, 218104544, 1
    .long 4, 16, 16, 8192, 6400, 268544, 8388608, 524288, 32768, 4, 6393856, 131072, 0, 0, 218104672, 1
    .long 1, 32, 32, 8192, 6656, 6912, 8388608, 2097152, 32768, 8, 46243840, 131072, 0, 0, 218105440, 4
    .long 2, 64, 72, 7168, 2816, 2816, 7340032, 524288, 32768, 8, 56406016, 114688, 0, 0, 218103888, 1
    .long 2, 64, 72, 7168, 1792, 1792, 7340032, 2097152, 32768, 8, 61894656, 114688, 0, 0, 218104080, 1
    .long 2, 64, 72, 7168, 768, 768, 7340032, 3670016, 32768, 8, 67383296, 114688, 0, 0, 218104256, 1
    .long 1, 80, 80, 2048, 5505536, 5505792, 7340032, 65622016, 114688, 7, 183508992, 32768, 218104240, 7, 218106752, 1
    .long 0, 0, 0, 0, 0, 0, 0, 0, 0, 0, 0, 0, 0, 0, 0, 0
    .long 0, 0, 0, 0, 0, 0, 0, 0, 0, 0, 0, 0, 0, 0, 0, 0
    .long 6, 16, 16, 8192, 512, 262656, 8388608, 0, 32768, 4, 4202496, 131072, 0, 0, 218104320, 1
    .long 4, 16, 16, 8192, 512, 262656, 8388608, 262144, 32768, 4, 5251072, 131072, 0, 0, 218104448, 1
    .long 4, 16, 16, 8192, 512, 262656, 8388608, 524288, 32768, 4, 6299648, 131072, 0, 0, 218104576, 1
    .long 1, 32, 32, 8192, 1024, 1280, 8388608, 2097152, 32768, 8, 46153728, 131072, 0, 0, 218105360, 4
    .long 2, 64, 72, 7168, 3072, 3072, 7340032, 524288, 32768, 8, 56410112, 114688, 0, 0, 218103888, 1
    .long 2, 64, 72, 7168, 2048, 2048, 7340032, 2097152, 32768, 8, 61898752, 114688, 0, 0, 218104080, 1
    .long 2, 64, 72, 7168, 1024, 1024, 7340032, 3670016, 32768, 8, 67387392, 114688, 0, 0, 218104256, 1
    .long 1, 80, 80, 2048, 1024, 1280, 7340032, 65536000, 114688, 7, 170934272, 32768, 218104192, 7, 218106752, 1
    .long 0, 0, 0, 0, 0, 0, 0, 0, 0, 0, 0, 0, 0, 0, 0, 0
    .long 0, 0, 0, 0, 0, 0, 0, 0, 0, 0, 0, 0, 0, 0, 0, 0
    .long 6, 16, 16, 8192, 2560, 264704, 8388608, 0, 32768, 4, 4235264, 131072, 0, 0, 218104352, 1
    .long 4, 16, 16, 8192, 2560, 264704, 8388608, 262144, 32768, 4, 5283840, 131072, 0, 0, 218104480, 1
    .long 4, 16, 16, 8192, 2560, 264704, 8388608, 524288, 32768, 4, 6332416, 131072, 0, 0, 218104608, 1
    .long 1, 32, 32, 8192, 3072, 3328, 8388608, 2097152, 32768, 8, 46186496, 131072, 0, 0, 218105392, 4
    .long 2, 64, 72, 7168, 3328, 3328, 7340032, 524288, 32768, 8, 56414208, 114688, 0, 0, 218103888, 1
    .long 2, 64, 72, 7168, 2304, 2304, 7340032, 2097152, 32768, 8, 61902848, 114688, 0, 0, 218104080, 1
    .long 2, 64, 72, 7168, 1280, 1280, 7340032, 3670016, 32768, 8, 67391488, 114688, 0, 0, 218104256, 1
    .long 1, 80, 80, 2048, 1836032, 1836288, 7340032, 65564672, 114688, 7, 175128576, 32768, 218104208, 7, 218106752, 1
    .long 0, 0, 0, 0, 0, 0, 0, 0, 0, 0, 0, 0, 0, 0, 0, 0
    .long 0, 0, 0, 0, 0, 0, 0, 0, 0, 0, 0, 0, 0, 0, 0, 0
    .long 6, 16, 16, 8192, 4608, 266752, 8388608, 0, 32768, 4, 4268032, 131072, 0, 0, 218104384, 1
    .long 4, 16, 16, 8192, 4608, 266752, 8388608, 262144, 32768, 4, 5316608, 131072, 0, 0, 218104512, 1
    .long 4, 16, 16, 8192, 4608, 266752, 8388608, 524288, 32768, 4, 6365184, 131072, 0, 0, 218104640, 1
    .long 1, 32, 32, 8192, 5120, 5376, 8388608, 2097152, 32768, 8, 46219264, 131072, 0, 0, 218105424, 4
    .long 2, 64, 72, 7168, 3584, 3584, 7340032, 524288, 32768, 8, 56418304, 114688, 0, 0, 218103904, 1
    .long 2, 64, 72, 7168, 2560, 2560, 7340032, 2097152, 32768, 8, 61906944, 114688, 0, 0, 218104080, 1
    .long 2, 64, 72, 7168, 1536, 1536, 7340032, 3670016, 32768, 8, 67395584, 114688, 0, 0, 218104256, 1
    .long 1, 80, 80, 2048, 3671040, 3671296, 7340032, 65593344, 114688, 7, 179322880, 32768, 218104224, 7, 218106752, 1
    .long 0, 0, 0, 0, 0, 0, 0, 0, 0, 0, 0, 0, 0, 0, 0, 0
    .long 0, 0, 0, 0, 0, 0, 0, 0, 0, 0, 0, 0, 0, 0, 0, 0
    .long 6, 16, 16, 8192, 6656, 268800, 8388608, 0, 32768, 4, 4300800, 131072, 0, 0, 218104416, 1
    .long 4, 16, 16, 8192, 6656, 268800, 8388608, 262144, 32768, 4, 5349376, 131072, 0, 0, 218104544, 1
    .long 4, 16, 16, 8192, 6656, 268800, 8388608, 524288, 32768, 4, 6397952, 131072, 0, 0, 218104672, 1
    .long 1, 32, 32, 8192, 7168, 7424, 8388608, 2097152, 32768, 8, 46252032, 131072, 0, 0, 218105456, 4
    .long 2, 64, 72, 7168, 3840, 3840, 7340032, 524288, 32768, 8, 56422400, 114688, 0, 0, 218103904, 1
    .long 2, 64, 72, 7168, 2816, 2816, 7340032, 2097152, 32768, 8, 61911040, 114688, 0, 0, 218104080, 1
    .long 2, 64, 72, 7168, 1792, 1792, 7340032, 3670016, 32768, 8, 67399680, 114688, 0, 0, 218104272, 1
    .long 1, 80, 80, 2048, 5506048, 5506304, 7340032, 65622016, 114688, 7, 183517184, 32768, 218104240, 7, 218106752, 1
    .long 0, 0, 0, 0, 0, 0, 0, 0, 0, 0, 0, 0, 0, 0, 0, 0
    .long 0, 0, 0, 0, 0, 0, 0, 0, 0, 0, 0, 0, 0, 0, 0, 0
    .long 6, 16, 16, 8192, 768, 262912, 8388608, 0, 32768, 4, 4206592, 131072, 0, 0, 218104320, 1
    .long 4, 16, 16, 8192, 768, 262912, 8388608, 262144, 32768, 4, 5255168, 131072, 0, 0, 218104448, 1
    .long 4, 16, 16, 8192, 768, 262912, 8388608, 524288, 32768, 4, 6303744, 131072, 0, 0, 218104576, 1
    .long 1, 32, 32, 8192, 1536, 1792, 8388608, 2097152, 32768, 8, 46161920, 131072, 0, 0, 218105360, 4
    .long 2, 64, 72, 7168, 4096, 4096, 7340032, 524288, 32768, 8, 56426496, 114688, 0, 0, 218103904, 1
    .long 2, 64, 72, 7168, 3072, 3072, 7340032, 2097152, 32768, 8, 61915136, 114688, 0, 0, 218104080, 1
    .long 2, 64, 72, 7168, 2048, 2048, 7340032, 3670016, 32768, 8, 67403776, 114688, 0, 0, 218104272, 1
    .long 1, 80, 80, 2048, 1536, 1792, 7340032, 65536000, 114688, 7, 170942464, 32768, 218104192, 7, 218106752, 1
    .long 0, 0, 0, 0, 0, 0, 0, 0, 0, 0, 0, 0, 0, 0, 0, 0
    .long 0, 0, 0, 0, 0, 0, 0, 0, 0, 0, 0, 0, 0, 0, 0, 0
    .long 6, 16, 16, 8192, 2816, 264960, 8388608, 0, 32768, 4, 4239360, 131072, 0, 0, 218104352, 1
    .long 4, 16, 16, 8192, 2816, 264960, 8388608, 262144, 32768, 4, 5287936, 131072, 0, 0, 218104480, 1
    .long 4, 16, 16, 8192, 2816, 264960, 8388608, 524288, 32768, 4, 6336512, 131072, 0, 0, 218104608, 1
    .long 1, 32, 32, 8192, 3584, 3840, 8388608, 2097152, 32768, 8, 46194688, 131072, 0, 0, 218105392, 4
    .long 2, 64, 72, 7168, 4352, 4352, 7340032, 524288, 32768, 8, 56430592, 114688, 0, 0, 218103904, 1
    .long 2, 64, 72, 7168, 3328, 3328, 7340032, 2097152, 32768, 8, 61919232, 114688, 0, 0, 218104080, 1
    .long 2, 64, 72, 7168, 2304, 2304, 7340032, 3670016, 32768, 8, 67407872, 114688, 0, 0, 218104272, 1
    .long 1, 80, 80, 2048, 1836544, 1836800, 7340032, 65564672, 114688, 7, 175136768, 32768, 218104208, 7, 218106752, 1
    .long 0, 0, 0, 0, 0, 0, 0, 0, 0, 0, 0, 0, 0, 0, 0, 0
    .long 0, 0, 0, 0, 0, 0, 0, 0, 0, 0, 0, 0, 0, 0, 0, 0
    .long 6, 16, 16, 8192, 4864, 267008, 8388608, 0, 32768, 4, 4272128, 131072, 0, 0, 218104384, 1
    .long 4, 16, 16, 8192, 4864, 267008, 8388608, 262144, 32768, 4, 5320704, 131072, 0, 0, 218104512, 1
    .long 4, 16, 16, 8192, 4864, 267008, 8388608, 524288, 32768, 4, 6369280, 131072, 0, 0, 218104640, 1
    .long 1, 32, 32, 8192, 5632, 5888, 8388608, 2097152, 32768, 8, 46227456, 131072, 0, 0, 218105424, 4
    .long 2, 64, 72, 7168, 4608, 4608, 7340032, 524288, 32768, 8, 56434688, 114688, 0, 0, 218103904, 1
    .long 2, 64, 72, 7168, 3584, 3584, 7340032, 2097152, 32768, 8, 61923328, 114688, 0, 0, 218104096, 1
    .long 2, 64, 72, 7168, 2560, 2560, 7340032, 3670016, 32768, 8, 67411968, 114688, 0, 0, 218104272, 1
    .long 1, 80, 80, 2048, 3671552, 3671808, 7340032, 65593344, 114688, 7, 179331072, 32768, 218104224, 7, 218106752, 1
    .long 0, 0, 0, 0, 0, 0, 0, 0, 0, 0, 0, 0, 0, 0, 0, 0
    .long 0, 0, 0, 0, 0, 0, 0, 0, 0, 0, 0, 0, 0, 0, 0, 0
    .long 6, 16, 16, 8192, 6912, 269056, 8388608, 0, 32768, 4, 4304896, 131072, 0, 0, 218104416, 1
    .long 4, 16, 16, 8192, 6912, 269056, 8388608, 262144, 32768, 4, 5353472, 131072, 0, 0, 218104544, 1
    .long 4, 16, 16, 8192, 6912, 269056, 8388608, 524288, 32768, 4, 6402048, 131072, 0, 0, 218104672, 1
    .long 1, 32, 32, 8192, 7680, 7936, 8388608, 2097152, 32768, 8, 46260224, 131072, 0, 0, 218105456, 4
    .long 2, 64, 72, 7168, 4864, 4864, 7340032, 524288, 32768, 8, 56438784, 114688, 0, 0, 218103904, 1
    .long 2, 64, 72, 7168, 3840, 3840, 7340032, 2097152, 32768, 8, 61927424, 114688, 0, 0, 218104096, 1
    .long 2, 64, 72, 7168, 2816, 2816, 7340032, 3670016, 32768, 8, 67416064, 114688, 0, 0, 218104272, 1
    .long 1, 80, 80, 2048, 5506560, 5506816, 7340032, 65622016, 114688, 7, 183525376, 32768, 218104240, 7, 218106752, 1
    .long 0, 0, 0, 0, 0, 0, 0, 0, 0, 0, 0, 0, 0, 0, 0, 0
    .long 0, 0, 0, 0, 0, 0, 0, 0, 0, 0, 0, 0, 0, 0, 0, 0
    .long 6, 16, 16, 8192, 1024, 263168, 8388608, 0, 32768, 4, 4210688, 131072, 0, 0, 218104336, 1
    .long 4, 16, 16, 8192, 1024, 263168, 8388608, 262144, 32768, 4, 5259264, 131072, 0, 0, 218104464, 1
    .long 4, 16, 16, 8192, 768, 262912, 8388608, 786432, 32768, 4, 7352320, 131072, 0, 0, 218104576, 1
    .long 1, 24, 24, 8192, 0, 256, 8388608, 2097152, 32768, 8, 29360128, 131072, 0, 0, 218105344, 4
    .long 2, 64, 72, 7168, 5120, 5120, 7340032, 524288, 32768, 8, 56442880, 114688, 0, 0, 218103904, 1
    .long 2, 64, 72, 7168, 4096, 4096, 7340032, 2097152, 32768, 8, 61931520, 114688, 0, 0, 218104096, 1
    .long 2, 64, 72, 7168, 3072, 3072, 7340032, 3670016, 32768, 8, 67420160, 114688, 0, 0, 218104272, 1
    .long 1, 80, 80, 2048, 0, 256, 7340032, 67371008, 114688, 7, 171442176, 32768, 218104256, 7, 218106816, 1
    .long 0, 0, 0, 0, 0, 0, 0, 0, 0, 0, 0, 0, 0, 0, 0, 0
    .long 0, 0, 0, 0, 0, 0, 0, 0, 0, 0, 0, 0, 0, 0, 0, 0
    .long 6, 16, 16, 8192, 3072, 265216, 8388608, 0, 32768, 4, 4243456, 131072, 0, 0, 218104368, 1
    .long 4, 16, 16, 8192, 3072, 265216, 8388608, 262144, 32768, 4, 5292032, 131072, 0, 0, 218104496, 1
    .long 4, 16, 16, 8192, 2816, 264960, 8388608, 786432, 32768, 4, 7385088, 131072, 0, 0, 218104608, 1
    .long 1, 24, 24, 8192, 2048, 2304, 8388608, 2097152, 32768, 8, 29392896, 131072, 0, 0, 218105376, 4
    .long 2, 64, 72, 7168, 5376, 5376, 7340032, 524288, 32768, 8, 56446976, 114688, 0, 0, 218103920, 1
    .long 2, 64, 72, 7168, 4352, 4352, 7340032, 2097152, 32768, 8, 61935616, 114688, 0, 0, 218104096, 1
    .long 2, 64, 72, 7168, 3328, 3328, 7340032, 3670016, 32768, 8, 67424256, 114688, 0, 0, 218104272, 1
    .long 1, 80, 80, 2048, 1835008, 1835264, 7340032, 67399680, 114688, 7, 175636480, 32768, 218104272, 7, 218106816, 1
    .long 0, 0, 0, 0, 0, 0, 0, 0, 0, 0, 0, 0, 0, 0, 0, 0
    .long 0, 0, 0, 0, 0, 0, 0, 0, 0, 0, 0, 0, 0, 0, 0, 0
    .long 6, 16, 16, 8192, 5120, 267264, 8388608, 0, 32768, 4, 4276224, 131072, 0, 0, 218104400, 1
    .long 4, 16, 16, 8192, 5120, 267264, 8388608, 262144, 32768, 4, 5324800, 131072, 0, 0, 218104528, 1
    .long 4, 16, 16, 8192, 4864, 267008, 8388608, 786432, 32768, 4, 7417856, 131072, 0, 0, 218104640, 1
    .long 1, 24, 24, 8192, 4096, 4352, 8388608, 2097152, 32768, 8, 29425664, 131072, 0, 0, 218105408, 4
    .long 2, 64, 72, 7168, 5632, 5632, 7340032, 524288, 32768, 8, 56451072, 114688, 0, 0, 218103920, 1
    .long 2, 64, 72, 7168, 4608, 4608, 7340032, 2097152, 32768, 8, 61939712, 114688, 0, 0, 218104096, 1
    .long 2, 64, 72, 7168, 3584, 3584, 7340032, 3670016, 32768, 8, 67428352, 114688, 0, 0, 218104288, 1
    .long 1, 80, 80, 2048, 3670016, 3670272, 7340032, 67428352, 114688, 7, 179830784, 32768, 218104288, 7, 218106816, 1
    .long 0, 0, 0, 0, 0, 0, 0, 0, 0, 0, 0, 0, 0, 0, 0, 0
    .long 0, 0, 0, 0, 0, 0, 0, 0, 0, 0, 0, 0, 0, 0, 0, 0
    .long 6, 16, 16, 8192, 7168, 269312, 8388608, 0, 32768, 4, 4308992, 131072, 0, 0, 218104432, 1
    .long 4, 16, 16, 8192, 7168, 269312, 8388608, 262144, 32768, 4, 5357568, 131072, 0, 0, 218104560, 1
    .long 4, 16, 16, 8192, 6912, 269056, 8388608, 786432, 32768, 4, 7450624, 131072, 0, 0, 218104672, 1
    .long 1, 24, 24, 8192, 6144, 6400, 8388608, 2097152, 32768, 8, 29458432, 131072, 0, 0, 218105440, 4
    .long 2, 64, 72, 7168, 5888, 5888, 7340032, 524288, 32768, 8, 56455168, 114688, 0, 0, 218103920, 1
    .long 2, 64, 72, 7168, 4864, 4864, 7340032, 2097152, 32768, 8, 61943808, 114688, 0, 0, 218104096, 1
    .long 2, 64, 72, 7168, 3840, 3840, 7340032, 3670016, 32768, 8, 67432448, 114688, 0, 0, 218104288, 1
    .long 1, 80, 80, 2048, 5505024, 5505280, 7340032, 67457024, 114688, 7, 184025088, 32768, 218104304, 7, 218106816, 1
    .long 0, 0, 0, 0, 0, 0, 0, 0, 0, 0, 0, 0, 0, 0, 0, 0
    .long 0, 0, 0, 0, 0, 0, 0, 0, 0, 0, 0, 0, 0, 0, 0, 0
    .long 6, 16, 16, 8192, 1280, 263424, 8388608, 0, 32768, 4, 4214784, 131072, 0, 0, 218104336, 1
    .long 4, 16, 16, 8192, 1280, 263424, 8388608, 262144, 32768, 4, 5263360, 131072, 0, 0, 218104464, 1
    .long 4, 16, 16, 8192, 512, 262656, 8388608, 786432, 32768, 4, 7348224, 131072, 0, 0, 218104576, 1
    .long 1, 24, 24, 8192, 512, 768, 8388608, 2097152, 32768, 8, 29368320, 131072, 0, 0, 218105344, 4
    .long 2, 64, 72, 7168, 6144, 6144, 7340032, 524288, 32768, 8, 56459264, 114688, 0, 0, 218103920, 1
    .long 2, 64, 72, 7168, 5120, 5120, 7340032, 2097152, 32768, 8, 61947904, 114688, 0, 0, 218104096, 1
    .long 2, 64, 72, 7168, 4096, 4096, 7340032, 3670016, 32768, 8, 67436544, 114688, 0, 0, 218104288, 1
    .long 1, 80, 80, 2048, 512, 768, 7340032, 67371008, 114688, 7, 171450368, 32768, 218104256, 7, 218106816, 1
    .long 0, 0, 0, 0, 0, 0, 0, 0, 0, 0, 0, 0, 0, 0, 0, 0
    .long 0, 0, 0, 0, 0, 0, 0, 0, 0, 0, 0, 0, 0, 0, 0, 0
    .long 6, 16, 16, 8192, 3328, 265472, 8388608, 0, 32768, 4, 4247552, 131072, 0, 0, 218104368, 1
    .long 4, 16, 16, 8192, 3328, 265472, 8388608, 262144, 32768, 4, 5296128, 131072, 0, 0, 218104496, 1
    .long 4, 16, 16, 8192, 2560, 264704, 8388608, 786432, 32768, 4, 7380992, 131072, 0, 0, 218104608, 1
    .long 1, 24, 24, 8192, 2560, 2816, 8388608, 2097152, 32768, 8, 29401088, 131072, 0, 0, 218105376, 4
    .long 2, 64, 72, 7168, 6400, 6400, 7340032, 524288, 32768, 8, 56463360, 114688, 0, 0, 218103920, 1
    .long 2, 64, 72, 7168, 5376, 5376, 7340032, 2097152, 32768, 8, 61952000, 114688, 0, 0, 218104112, 1
    .long 2, 64, 72, 7168, 4352, 4352, 7340032, 3670016, 32768, 8, 67440640, 114688, 0, 0, 218104288, 1
    .long 1, 80, 80, 2048, 1835520, 1835776, 7340032, 67399680, 114688, 7, 175644672, 32768, 218104272, 7, 218106816, 1
    .long 0, 0, 0, 0, 0, 0, 0, 0, 0, 0, 0, 0, 0, 0, 0, 0
    .long 0, 0, 0, 0, 0, 0, 0, 0, 0, 0, 0, 0, 0, 0, 0, 0
    .long 6, 16, 16, 8192, 5376, 267520, 8388608, 0, 32768, 4, 4280320, 131072, 0, 0, 218104400, 1
    .long 4, 16, 16, 8192, 5376, 267520, 8388608, 262144, 32768, 4, 5328896, 131072, 0, 0, 218104528, 1
    .long 4, 16, 16, 8192, 4608, 266752, 8388608, 786432, 32768, 4, 7413760, 131072, 0, 0, 218104640, 1
    .long 1, 24, 24, 8192, 4608, 4864, 8388608, 2097152, 32768, 8, 29433856, 131072, 0, 0, 218105408, 4
    .long 2, 64, 72, 7168, 6656, 6656, 7340032, 524288, 32768, 8, 56467456, 114688, 0, 0, 218103920, 1
    .long 2, 64, 72, 7168, 5632, 5632, 7340032, 2097152, 32768, 8, 61956096, 114688, 0, 0, 218104112, 1
    .long 2, 64, 72, 7168, 4608, 4608, 7340032, 3670016, 32768, 8, 67444736, 114688, 0, 0, 218104288, 1
    .long 1, 80, 80, 2048, 3670528, 3670784, 7340032, 67428352, 114688, 7, 179838976, 32768, 218104288, 7, 218106816, 1
    .long 0, 0, 0, 0, 0, 0, 0, 0, 0, 0, 0, 0, 0, 0, 0, 0
    .long 0, 0, 0, 0, 0, 0, 0, 0, 0, 0, 0, 0, 0, 0, 0, 0
    .long 6, 16, 16, 8192, 7424, 269568, 8388608, 0, 32768, 4, 4313088, 131072, 0, 0, 218104432, 1
    .long 4, 16, 16, 8192, 7424, 269568, 8388608, 262144, 32768, 4, 5361664, 131072, 0, 0, 218104560, 1
    .long 4, 16, 16, 8192, 6656, 268800, 8388608, 786432, 32768, 4, 7446528, 131072, 0, 0, 218104672, 1
    .long 1, 24, 24, 8192, 6656, 6912, 8388608, 2097152, 32768, 8, 29466624, 131072, 0, 0, 218105440, 4
    .long 2, 64, 72, 7168, 6912, 6912, 7340032, 524288, 32768, 8, 56471552, 114688, 0, 0, 218103920, 1
    .long 2, 64, 72, 7168, 5888, 5888, 7340032, 2097152, 32768, 8, 61960192, 114688, 0, 0, 218104112, 1
    .long 2, 64, 72, 7168, 4864, 4864, 7340032, 3670016, 32768, 8, 67448832, 114688, 0, 0, 218104288, 1
    .long 1, 80, 80, 2048, 5505536, 5505792, 7340032, 67457024, 114688, 7, 184033280, 32768, 218104304, 7, 218106816, 1
    .long 0, 0, 0, 0, 0, 0, 0, 0, 0, 0, 0, 0, 0, 0, 0, 0
    .long 0, 0, 0, 0, 0, 0, 0, 0, 0, 0, 0, 0, 0, 0, 0, 0
    .long 6, 16, 16, 8192, 1536, 263680, 8388608, 0, 32768, 4, 4218880, 131072, 0, 0, 218104336, 1
    .long 4, 16, 16, 8192, 1536, 263680, 8388608, 262144, 32768, 4, 5267456, 131072, 0, 0, 218104464, 1
    .long 4, 16, 16, 8192, 256, 262400, 8388608, 786432, 32768, 4, 7344128, 131072, 0, 0, 218104576, 1
    .long 1, 24, 24, 8192, 1024, 1280, 8388608, 2097152, 32768, 8, 29376512, 131072, 0, 0, 218105360, 4
    .long 2, 64, 72, 7168, 0, 0, 7340032, 1048576, 32768, 8, 58195968, 114688, 0, 0, 218103936, 1
    .long 2, 64, 72, 7168, 6144, 6144, 7340032, 2097152, 32768, 8, 61964288, 114688, 0, 0, 218104112, 1
    .long 2, 64, 72, 7168, 5120, 5120, 7340032, 3670016, 32768, 8, 67452928, 114688, 0, 0, 218104288, 1
    .long 1, 80, 80, 2048, 1024, 1280, 7340032, 67371008, 114688, 7, 171458560, 32768, 218104256, 7, 218106816, 1
    .long 0, 0, 0, 0, 0, 0, 0, 0, 0, 0, 0, 0, 0, 0, 0, 0
    .long 0, 0, 0, 0, 0, 0, 0, 0, 0, 0, 0, 0, 0, 0, 0, 0
    .long 6, 16, 16, 8192, 3584, 265728, 8388608, 0, 32768, 4, 4251648, 131072, 0, 0, 218104368, 1
    .long 4, 16, 16, 8192, 3584, 265728, 8388608, 262144, 32768, 4, 5300224, 131072, 0, 0, 218104496, 1
    .long 4, 16, 16, 8192, 2304, 264448, 8388608, 786432, 32768, 4, 7376896, 131072, 0, 0, 218104608, 1
    .long 1, 24, 24, 8192, 3072, 3328, 8388608, 2097152, 32768, 8, 29409280, 131072, 0, 0, 218105392, 4
    .long 2, 64, 72, 7168, 256, 256, 7340032, 1048576, 32768, 8, 58200064, 114688, 0, 0, 218103936, 1
    .long 2, 64, 72, 7168, 6400, 6400, 7340032, 2097152, 32768, 8, 61968384, 114688, 0, 0, 218104112, 1
    .long 2, 64, 72, 7168, 5376, 5376, 7340032, 3670016, 32768, 8, 67457024, 114688, 0, 0, 218104304, 1
    .long 1, 80, 80, 2048, 1836032, 1836288, 7340032, 67399680, 114688, 7, 175652864, 32768, 218104272, 7, 218106816, 1
    .long 0, 0, 0, 0, 0, 0, 0, 0, 0, 0, 0, 0, 0, 0, 0, 0
    .long 0, 0, 0, 0, 0, 0, 0, 0, 0, 0, 0, 0, 0, 0, 0, 0
    .long 6, 16, 16, 8192, 5632, 267776, 8388608, 0, 32768, 4, 4284416, 131072, 0, 0, 218104400, 1
    .long 4, 16, 16, 8192, 5632, 267776, 8388608, 262144, 32768, 4, 5332992, 131072, 0, 0, 218104528, 1
    .long 4, 16, 16, 8192, 4352, 266496, 8388608, 786432, 32768, 4, 7409664, 131072, 0, 0, 218104640, 1
    .long 1, 24, 24, 8192, 5120, 5376, 8388608, 2097152, 32768, 8, 29442048, 131072, 0, 0, 218105424, 4
    .long 2, 64, 72, 7168, 512, 512, 7340032, 1048576, 32768, 8, 58204160, 114688, 0, 0, 218103936, 1
    .long 2, 64, 72, 7168, 6656, 6656, 7340032, 2097152, 32768, 8, 61972480, 114688, 0, 0, 218104112, 1
    .long 2, 64, 72, 7168, 5632, 5632, 7340032, 3670016, 32768, 8, 67461120, 114688, 0, 0, 218104304, 1
    .long 1, 80, 80, 2048, 3671040, 3671296, 7340032, 67428352, 114688, 7, 179847168, 32768, 218104288, 7, 218106816, 1
    .long 0, 0, 0, 0, 0, 0, 0, 0, 0, 0, 0, 0, 0, 0, 0, 0
    .long 0, 0, 0, 0, 0, 0, 0, 0, 0, 0, 0, 0, 0, 0, 0, 0
    .long 6, 16, 16, 8192, 7680, 269824, 8388608, 0, 32768, 4, 4317184, 131072, 0, 0, 218104432, 1
    .long 4, 16, 16, 8192, 7680, 269824, 8388608, 262144, 32768, 4, 5365760, 131072, 0, 0, 218104560, 1
    .long 4, 16, 16, 8192, 6400, 268544, 8388608, 786432, 32768, 4, 7442432, 131072, 0, 0, 218104672, 1
    .long 1, 24, 24, 8192, 7168, 7424, 8388608, 2097152, 32768, 8, 29474816, 131072, 0, 0, 218105456, 4
    .long 2, 64, 72, 7168, 768, 768, 7340032, 1048576, 32768, 8, 58208256, 114688, 0, 0, 218103936, 1
    .long 2, 64, 72, 7168, 6912, 6912, 7340032, 2097152, 32768, 8, 61976576, 114688, 0, 0, 218104112, 1
    .long 2, 64, 72, 7168, 5888, 5888, 7340032, 3670016, 32768, 8, 67465216, 114688, 0, 0, 218104304, 1
    .long 1, 80, 80, 2048, 5506048, 5506304, 7340032, 67457024, 114688, 7, 184041472, 32768, 218104304, 7, 218106816, 1
    .long 0, 0, 0, 0, 0, 0, 0, 0, 0, 0, 0, 0, 0, 0, 0, 0
    .long 0, 0, 0, 0, 0, 0, 0, 0, 0, 0, 0, 0, 0, 0, 0, 0
    .long 6, 16, 16, 8192, 1792, 263936, 8388608, 0, 32768, 4, 4222976, 131072, 0, 0, 218104336, 1
    .long 4, 16, 16, 8192, 1792, 263936, 8388608, 262144, 32768, 4, 5271552, 131072, 0, 0, 218104464, 1
    .long 4, 16, 16, 8192, 0, 262144, 8388608, 786432, 32768, 4, 7340032, 131072, 0, 0, 218104576, 1
    .long 1, 24, 24, 8192, 1536, 1792, 8388608, 2097152, 32768, 8, 29384704, 131072, 0, 0, 218105360, 4
    .long 2, 64, 72, 7168, 1024, 1024, 7340032, 1048576, 32768, 8, 58212352, 114688, 0, 0, 218103936, 1
    .long 2, 64, 72, 7168, 0, 0, 7340032, 2621440, 32768, 8, 63700992, 114688, 0, 0, 218104128, 1
    .long 2, 64, 72, 7168, 6144, 6144, 7340032, 3670016, 32768, 8, 67469312, 114688, 0, 0, 218104304, 1
    .long 1, 80, 80, 2048, 1536, 1792, 7340032, 67371008, 114688, 7, 171466752, 32768, 218104256, 7, 218106816, 1
    .long 0, 0, 0, 0, 0, 0, 0, 0, 0, 0, 0, 0, 0, 0, 0, 0
    .long 0, 0, 0, 0, 0, 0, 0, 0, 0, 0, 0, 0, 0, 0, 0, 0
    .long 6, 16, 16, 8192, 3840, 265984, 8388608, 0, 32768, 4, 4255744, 131072, 0, 0, 218104368, 1
    .long 4, 16, 16, 8192, 3840, 265984, 8388608, 262144, 32768, 4, 5304320, 131072, 0, 0, 218104496, 1
    .long 4, 16, 16, 8192, 2048, 264192, 8388608, 786432, 32768, 4, 7372800, 131072, 0, 0, 218104608, 1
    .long 1, 24, 24, 8192, 3584, 3840, 8388608, 2097152, 32768, 8, 29417472, 131072, 0, 0, 218105392, 4
    .long 2, 64, 72, 7168, 1280, 1280, 7340032, 1048576, 32768, 8, 58216448, 114688, 0, 0, 218103936, 1
    .long 2, 64, 72, 7168, 256, 256, 7340032, 2621440, 32768, 8, 63705088, 114688, 0, 0, 218104128, 1
    .long 2, 64, 72, 7168, 6400, 6400, 7340032, 3670016, 32768, 8, 67473408, 114688, 0, 0, 218104304, 1
    .long 1, 80, 80, 2048, 1836544, 1836800, 7340032, 67399680, 114688, 7, 175661056, 32768, 218104272, 7, 218106816, 1
    .long 0, 0, 0, 0, 0, 0, 0, 0, 0, 0, 0, 0, 0, 0, 0, 0
    .long 0, 0, 0, 0, 0, 0, 0, 0, 0, 0, 0, 0, 0, 0, 0, 0
    .long 6, 16, 16, 8192, 5888, 268032, 8388608, 0, 32768, 4, 4288512, 131072, 0, 0, 218104400, 1
    .long 4, 16, 16, 8192, 5888, 268032, 8388608, 262144, 32768, 4, 5337088, 131072, 0, 0, 218104528, 1
    .long 4, 16, 16, 8192, 4096, 266240, 8388608, 786432, 32768, 4, 7405568, 131072, 0, 0, 218104640, 1
    .long 1, 24, 24, 8192, 5632, 5888, 8388608, 2097152, 32768, 8, 29450240, 131072, 0, 0, 218105424, 4
    .long 2, 64, 72, 7168, 1536, 1536, 7340032, 1048576, 32768, 8, 58220544, 114688, 0, 0, 218103936, 1
    .long 2, 64, 72, 7168, 512, 512, 7340032, 2621440, 32768, 8, 63709184, 114688, 0, 0, 218104128, 1
    .long 2, 64, 72, 7168, 6656, 6656, 7340032, 3670016, 32768, 8, 67477504, 114688, 0, 0, 218104304, 1
    .long 1, 80, 80, 2048, 3671552, 3671808, 7340032, 67428352, 114688, 7, 179855360, 32768, 218104288, 7, 218106816, 1
    .long 0, 0, 0, 0, 0, 0, 0, 0, 0, 0, 0, 0, 0, 0, 0, 0
    .long 0, 0, 0, 0, 0, 0, 0, 0, 0, 0, 0, 0, 0, 0, 0, 0
    .long 6, 16, 16, 8192, 7936, 270080, 8388608, 0, 32768, 4, 4321280, 131072, 0, 0, 218104432, 1
    .long 4, 16, 16, 8192, 7936, 270080, 8388608, 262144, 32768, 4, 5369856, 131072, 0, 0, 218104560, 1
    .long 4, 16, 16, 8192, 6144, 268288, 8388608, 786432, 32768, 4, 7438336, 131072, 0, 0, 218104672, 1
    .long 1, 24, 24, 8192, 7680, 7936, 8388608, 2097152, 32768, 8, 29483008, 131072, 0, 0, 218105456, 4
    .long 2, 64, 72, 7168, 1792, 1792, 7340032, 1048576, 32768, 8, 58224640, 114688, 0, 0, 218103952, 1
    .long 2, 64, 72, 7168, 768, 768, 7340032, 2621440, 32768, 8, 63713280, 114688, 0, 0, 218104128, 1
    .long 2, 64, 72, 7168, 6912, 6912, 7340032, 3670016, 32768, 8, 67481600, 114688, 0, 0, 218104304, 1
    .long 1, 80, 80, 2048, 5506560, 5506816, 7340032, 67457024, 114688, 7, 184049664, 32768, 218104304, 7, 218106816, 1
    .long 0, 0, 0, 0, 0, 0, 0, 0, 0, 0, 0, 0, 0, 0, 0, 0
    .long 0, 0, 0, 0, 0, 0, 0, 0, 0, 0, 0, 0, 0, 0, 0, 0
    .long 1, 32, 32, 8192, 0, 256, 8388608, 524288, 32768, 8, 39845888, 131072, 0, 0, 218104576, 4
    .long 1, 16, 16, 8192, 0, 256, 8388608, 1048576, 32768, 8, 8388608, 131072, 0, 0, 218104832, 4
    .long 1, 24, 24, 8192, 0, 256, 8388608, 2621440, 32768, 8, 31457280, 131072, 0, 0, 218105600, 4
    .long 1, 16, 16, 8192, 0, 256, 8388608, 3145728, 32768, 8, 16777216, 131072, 0, 0, 218105856, 4
    .long 1, 16, 16, 8192, 0, 256, 8388608, 3670016, 32768, 8, 18874368, 131072, 0, 0, 218106112, 4
    .long 1, 80, 80, 2048, 0, 256, 7340032, 58195968, 114688, 7, 168820736, 32768, 218103936, 7, 218106496, 1
    .long 0, 0, 0, 0, 0, 0, 0, 0, 0, 0, 0, 0, 0, 0, 0, 0
    .long 0, 0, 0, 0, 0, 0, 0, 0, 0, 0, 0, 0, 0, 0, 0, 0
    .long 0, 0, 0, 0, 0, 0, 0, 0, 0, 0, 0, 0, 0, 0, 0, 0
    .long 0, 0, 0, 0, 0, 0, 0, 0, 0, 0, 0, 0, 0, 0, 0, 0
    .long 1, 32, 32, 8192, 2048, 2304, 8388608, 524288, 32768, 8, 39878656, 131072, 0, 0, 218104608, 4
    .long 1, 16, 16, 8192, 2048, 2304, 8388608, 1048576, 32768, 8, 8421376, 131072, 0, 0, 218104864, 4
    .long 1, 24, 24, 8192, 2048, 2304, 8388608, 2621440, 32768, 8, 31490048, 131072, 0, 0, 218105632, 4
    .long 1, 16, 16, 8192, 2048, 2304, 8388608, 3145728, 32768, 8, 16809984, 131072, 0, 0, 218105888, 4
    .long 1, 16, 16, 8192, 2048, 2304, 8388608, 3670016, 32768, 8, 18907136, 131072, 0, 0, 218106144, 4
    .long 1, 80, 80, 2048, 1835008, 1835264, 7340032, 58224640, 114688, 7, 173015040, 32768, 218103952, 7, 218106496, 1
    .long 0, 0, 0, 0, 0, 0, 0, 0, 0, 0, 0, 0, 0, 0, 0, 0
    .long 0, 0, 0, 0, 0, 0, 0, 0, 0, 0, 0, 0, 0, 0, 0, 0
    .long 0, 0, 0, 0, 0, 0, 0, 0, 0, 0, 0, 0, 0, 0, 0, 0
    .long 0, 0, 0, 0, 0, 0, 0, 0, 0, 0, 0, 0, 0, 0, 0, 0
    .long 1, 32, 32, 8192, 4096, 4352, 8388608, 524288, 32768, 8, 39911424, 131072, 0, 0, 218104640, 4
    .long 1, 16, 16, 8192, 4096, 4352, 8388608, 1048576, 32768, 8, 8454144, 131072, 0, 0, 218104896, 4
    .long 1, 24, 24, 8192, 4096, 4352, 8388608, 2621440, 32768, 8, 31522816, 131072, 0, 0, 218105664, 4
    .long 1, 16, 16, 8192, 4096, 4352, 8388608, 3145728, 32768, 8, 16842752, 131072, 0, 0, 218105920, 4
    .long 1, 16, 16, 8192, 4096, 4352, 8388608, 3670016, 32768, 8, 18939904, 131072, 0, 0, 218106176, 4
    .long 1, 80, 80, 2048, 3670016, 3670272, 7340032, 58253312, 114688, 7, 177209344, 32768, 218103968, 7, 218106496, 1
    .long 0, 0, 0, 0, 0, 0, 0, 0, 0, 0, 0, 0, 0, 0, 0, 0
    .long 0, 0, 0, 0, 0, 0, 0, 0, 0, 0, 0, 0, 0, 0, 0, 0
    .long 0, 0, 0, 0, 0, 0, 0, 0, 0, 0, 0, 0, 0, 0, 0, 0
    .long 0, 0, 0, 0, 0, 0, 0, 0, 0, 0, 0, 0, 0, 0, 0, 0
    .long 1, 32, 32, 8192, 6144, 6400, 8388608, 524288, 32768, 8, 39944192, 131072, 0, 0, 218104672, 4
    .long 1, 16, 16, 8192, 6144, 6400, 8388608, 1048576, 32768, 8, 8486912, 131072, 0, 0, 218104928, 4
    .long 1, 24, 24, 8192, 6144, 6400, 8388608, 2621440, 32768, 8, 31555584, 131072, 0, 0, 218105696, 4
    .long 1, 16, 16, 8192, 6144, 6400, 8388608, 3145728, 32768, 8, 16875520, 131072, 0, 0, 218105952, 4
    .long 1, 16, 16, 8192, 6144, 6400, 8388608, 3670016, 32768, 8, 18972672, 131072, 0, 0, 218106208, 4
    .long 1, 80, 80, 2048, 5505024, 5505280, 7340032, 58281984, 114688, 7, 181403648, 32768, 218103984, 7, 218106496, 1
    .long 0, 0, 0, 0, 0, 0, 0, 0, 0, 0, 0, 0, 0, 0, 0, 0
    .long 0, 0, 0, 0, 0, 0, 0, 0, 0, 0, 0, 0, 0, 0, 0, 0
    .long 0, 0, 0, 0, 0, 0, 0, 0, 0, 0, 0, 0, 0, 0, 0, 0
    .long 0, 0, 0, 0, 0, 0, 0, 0, 0, 0, 0, 0, 0, 0, 0, 0
    .long 1, 32, 32, 8192, 512, 768, 8388608, 524288, 32768, 8, 39854080, 131072, 0, 0, 218104576, 4
    .long 1, 16, 16, 8192, 512, 768, 8388608, 1048576, 32768, 8, 8396800, 131072, 0, 0, 218104832, 4
    .long 1, 24, 24, 8192, 512, 768, 8388608, 2621440, 32768, 8, 31465472, 131072, 0, 0, 218105600, 4
    .long 1, 16, 16, 8192, 512, 768, 8388608, 3145728, 32768, 8, 16785408, 131072, 0, 0, 218105856, 4
    .long 1, 16, 16, 8192, 512, 768, 8388608, 3670016, 32768, 8, 18882560, 131072, 0, 0, 218106112, 4
    .long 1, 80, 80, 2048, 512, 768, 7340032, 58195968, 114688, 7, 168828928, 32768, 218103936, 7, 218106496, 1
    .long 0, 0, 0, 0, 0, 0, 0, 0, 0, 0, 0, 0, 0, 0, 0, 0
    .long 0, 0, 0, 0, 0, 0, 0, 0, 0, 0, 0, 0, 0, 0, 0, 0
    .long 0, 0, 0, 0, 0, 0, 0, 0, 0, 0, 0, 0, 0, 0, 0, 0
    .long 0, 0, 0, 0, 0, 0, 0, 0, 0, 0, 0, 0, 0, 0, 0, 0
    .long 1, 32, 32, 8192, 2560, 2816, 8388608, 524288, 32768, 8, 39886848, 131072, 0, 0, 218104608, 4
    .long 1, 16, 16, 8192, 2560, 2816, 8388608, 1048576, 32768, 8, 8429568, 131072, 0, 0, 218104864, 4
    .long 1, 24, 24, 8192, 2560, 2816, 8388608, 2621440, 32768, 8, 31498240, 131072, 0, 0, 218105632, 4
    .long 1, 16, 16, 8192, 2560, 2816, 8388608, 3145728, 32768, 8, 16818176, 131072, 0, 0, 218105888, 4
    .long 1, 16, 16, 8192, 2560, 2816, 8388608, 3670016, 32768, 8, 18915328, 131072, 0, 0, 218106144, 4
    .long 1, 80, 80, 2048, 1835520, 1835776, 7340032, 58224640, 114688, 7, 173023232, 32768, 218103952, 7, 218106496, 1
    .long 0, 0, 0, 0, 0, 0, 0, 0, 0, 0, 0, 0, 0, 0, 0, 0
    .long 0, 0, 0, 0, 0, 0, 0, 0, 0, 0, 0, 0, 0, 0, 0, 0
    .long 0, 0, 0, 0, 0, 0, 0, 0, 0, 0, 0, 0, 0, 0, 0, 0
    .long 0, 0, 0, 0, 0, 0, 0, 0, 0, 0, 0, 0, 0, 0, 0, 0
    .long 1, 32, 32, 8192, 4608, 4864, 8388608, 524288, 32768, 8, 39919616, 131072, 0, 0, 218104640, 4
    .long 1, 16, 16, 8192, 4608, 4864, 8388608, 1048576, 32768, 8, 8462336, 131072, 0, 0, 218104896, 4
    .long 1, 24, 24, 8192, 4608, 4864, 8388608, 2621440, 32768, 8, 31531008, 131072, 0, 0, 218105664, 4
    .long 1, 16, 16, 8192, 4608, 4864, 8388608, 3145728, 32768, 8, 16850944, 131072, 0, 0, 218105920, 4
    .long 1, 16, 16, 8192, 4608, 4864, 8388608, 3670016, 32768, 8, 18948096, 131072, 0, 0, 218106176, 4
    .long 1, 80, 80, 2048, 3670528, 3670784, 7340032, 58253312, 114688, 7, 177217536, 32768, 218103968, 7, 218106496, 1
    .long 0, 0, 0, 0, 0, 0, 0, 0, 0, 0, 0, 0, 0, 0, 0, 0
    .long 0, 0, 0, 0, 0, 0, 0, 0, 0, 0, 0, 0, 0, 0, 0, 0
    .long 0, 0, 0, 0, 0, 0, 0, 0, 0, 0, 0, 0, 0, 0, 0, 0
    .long 0, 0, 0, 0, 0, 0, 0, 0, 0, 0, 0, 0, 0, 0, 0, 0
    .long 1, 32, 32, 8192, 6656, 6912, 8388608, 524288, 32768, 8, 39952384, 131072, 0, 0, 218104672, 4
    .long 1, 16, 16, 8192, 6656, 6912, 8388608, 1048576, 32768, 8, 8495104, 131072, 0, 0, 218104928, 4
    .long 1, 24, 24, 8192, 6656, 6912, 8388608, 2621440, 32768, 8, 31563776, 131072, 0, 0, 218105696, 4
    .long 1, 16, 16, 8192, 6656, 6912, 8388608, 3145728, 32768, 8, 16883712, 131072, 0, 0, 218105952, 4
    .long 1, 16, 16, 8192, 6656, 6912, 8388608, 3670016, 32768, 8, 18980864, 131072, 0, 0, 218106208, 4
    .long 1, 80, 80, 2048, 5505536, 5505792, 7340032, 58281984, 114688, 7, 181411840, 32768, 218103984, 7, 218106496, 1
    .long 0, 0, 0, 0, 0, 0, 0, 0, 0, 0, 0, 0, 0, 0, 0, 0
    .long 0, 0, 0, 0, 0, 0, 0, 0, 0, 0, 0, 0, 0, 0, 0, 0
    .long 0, 0, 0, 0, 0, 0, 0, 0, 0, 0, 0, 0, 0, 0, 0, 0
    .long 0, 0, 0, 0, 0, 0, 0, 0, 0, 0, 0, 0, 0, 0, 0, 0
    .long 1, 32, 32, 8192, 1024, 1280, 8388608, 524288, 32768, 8, 39862272, 131072, 0, 0, 218104592, 4
    .long 1, 16, 16, 8192, 1024, 1280, 8388608, 1048576, 32768, 8, 8404992, 131072, 0, 0, 218104848, 4
    .long 1, 24, 24, 8192, 1024, 1280, 8388608, 2621440, 32768, 8, 31473664, 131072, 0, 0, 218105616, 4
    .long 1, 16, 16, 8192, 1024, 1280, 8388608, 3145728, 32768, 8, 16793600, 131072, 0, 0, 218105872, 4
    .long 1, 16, 16, 8192, 1024, 1280, 8388608, 3670016, 32768, 8, 18890752, 131072, 0, 0, 218106128, 4
    .long 1, 80, 80, 2048, 1024, 1280, 7340032, 58195968, 114688, 7, 168837120, 32768, 218103936, 7, 218106496, 1
    .long 0, 0, 0, 0, 0, 0, 0, 0, 0, 0, 0, 0, 0, 0, 0, 0
    .long 0, 0, 0, 0, 0, 0, 0, 0, 0, 0, 0, 0, 0, 0, 0, 0
    .long 0, 0, 0, 0, 0, 0, 0, 0, 0, 0, 0, 0, 0, 0, 0, 0
    .long 0, 0, 0, 0, 0, 0, 0, 0, 0, 0, 0, 0, 0, 0, 0, 0
    .long 1, 32, 32, 8192, 3072, 3328, 8388608, 524288, 32768, 8, 39895040, 131072, 0, 0, 218104624, 4
    .long 1, 16, 16, 8192, 3072, 3328, 8388608, 1048576, 32768, 8, 8437760, 131072, 0, 0, 218104880, 4
    .long 1, 24, 24, 8192, 3072, 3328, 8388608, 2621440, 32768, 8, 31506432, 131072, 0, 0, 218105648, 4
    .long 1, 16, 16, 8192, 3072, 3328, 8388608, 3145728, 32768, 8, 16826368, 131072, 0, 0, 218105904, 4
    .long 1, 16, 16, 8192, 3072, 3328, 8388608, 3670016, 32768, 8, 18923520, 131072, 0, 0, 218106160, 4
    .long 1, 80, 80, 2048, 1836032, 1836288, 7340032, 58224640, 114688, 7, 173031424, 32768, 218103952, 7, 218106496, 1
    .long 0, 0, 0, 0, 0, 0, 0, 0, 0, 0, 0, 0, 0, 0, 0, 0
    .long 0, 0, 0, 0, 0, 0, 0, 0, 0, 0, 0, 0, 0, 0, 0, 0
    .long 0, 0, 0, 0, 0, 0, 0, 0, 0, 0, 0, 0, 0, 0, 0, 0
    .long 0, 0, 0, 0, 0, 0, 0, 0, 0, 0, 0, 0, 0, 0, 0, 0
    .long 1, 32, 32, 8192, 5120, 5376, 8388608, 524288, 32768, 8, 39927808, 131072, 0, 0, 218104656, 4
    .long 1, 16, 16, 8192, 5120, 5376, 8388608, 1048576, 32768, 8, 8470528, 131072, 0, 0, 218104912, 4
    .long 1, 24, 24, 8192, 5120, 5376, 8388608, 2621440, 32768, 8, 31539200, 131072, 0, 0, 218105680, 4
    .long 1, 16, 16, 8192, 5120, 5376, 8388608, 3145728, 32768, 8, 16859136, 131072, 0, 0, 218105936, 4
    .long 1, 16, 16, 8192, 5120, 5376, 8388608, 3670016, 32768, 8, 18956288, 131072, 0, 0, 218106192, 4
    .long 1, 80, 80, 2048, 3671040, 3671296, 7340032, 58253312, 114688, 7, 177225728, 32768, 218103968, 7, 218106496, 1
    .long 0, 0, 0, 0, 0, 0, 0, 0, 0, 0, 0, 0, 0, 0, 0, 0
    .long 0, 0, 0, 0, 0, 0, 0, 0, 0, 0, 0, 0, 0, 0, 0, 0
    .long 0, 0, 0, 0, 0, 0, 0, 0, 0, 0, 0, 0, 0, 0, 0, 0
    .long 0, 0, 0, 0, 0, 0, 0, 0, 0, 0, 0, 0, 0, 0, 0, 0
    .long 1, 32, 32, 8192, 7168, 7424, 8388608, 524288, 32768, 8, 39960576, 131072, 0, 0, 218104688, 4
    .long 1, 16, 16, 8192, 7168, 7424, 8388608, 1048576, 32768, 8, 8503296, 131072, 0, 0, 218104944, 4
    .long 1, 24, 24, 8192, 7168, 7424, 8388608, 2621440, 32768, 8, 31571968, 131072, 0, 0, 218105712, 4
    .long 1, 16, 16, 8192, 7168, 7424, 8388608, 3145728, 32768, 8, 16891904, 131072, 0, 0, 218105968, 4
    .long 1, 16, 16, 8192, 7168, 7424, 8388608, 3670016, 32768, 8, 18989056, 131072, 0, 0, 218106224, 4
    .long 1, 80, 80, 2048, 5506048, 5506304, 7340032, 58281984, 114688, 7, 181420032, 32768, 218103984, 7, 218106496, 1
    .long 0, 0, 0, 0, 0, 0, 0, 0, 0, 0, 0, 0, 0, 0, 0, 0
    .long 0, 0, 0, 0, 0, 0, 0, 0, 0, 0, 0, 0, 0, 0, 0, 0
    .long 0, 0, 0, 0, 0, 0, 0, 0, 0, 0, 0, 0, 0, 0, 0, 0
    .long 0, 0, 0, 0, 0, 0, 0, 0, 0, 0, 0, 0, 0, 0, 0, 0
    .long 1, 32, 32, 8192, 1536, 1792, 8388608, 524288, 32768, 8, 39870464, 131072, 0, 0, 218104592, 4
    .long 1, 16, 16, 8192, 1536, 1792, 8388608, 1048576, 32768, 8, 8413184, 131072, 0, 0, 218104848, 4
    .long 1, 24, 24, 8192, 1536, 1792, 8388608, 2621440, 32768, 8, 31481856, 131072, 0, 0, 218105616, 4
    .long 1, 16, 16, 8192, 1536, 1792, 8388608, 3145728, 32768, 8, 16801792, 131072, 0, 0, 218105872, 4
    .long 1, 16, 16, 8192, 1536, 1792, 8388608, 3670016, 32768, 8, 18898944, 131072, 0, 0, 218106128, 4
    .long 1, 80, 80, 2048, 1536, 1792, 7340032, 58195968, 114688, 7, 168845312, 32768, 218103936, 7, 218106496, 1
    .long 0, 0, 0, 0, 0, 0, 0, 0, 0, 0, 0, 0, 0, 0, 0, 0
    .long 0, 0, 0, 0, 0, 0, 0, 0, 0, 0, 0, 0, 0, 0, 0, 0
    .long 0, 0, 0, 0, 0, 0, 0, 0, 0, 0, 0, 0, 0, 0, 0, 0
    .long 0, 0, 0, 0, 0, 0, 0, 0, 0, 0, 0, 0, 0, 0, 0, 0
    .long 1, 32, 32, 8192, 3584, 3840, 8388608, 524288, 32768, 8, 39903232, 131072, 0, 0, 218104624, 4
    .long 1, 16, 16, 8192, 3584, 3840, 8388608, 1048576, 32768, 8, 8445952, 131072, 0, 0, 218104880, 4
    .long 1, 24, 24, 8192, 3584, 3840, 8388608, 2621440, 32768, 8, 31514624, 131072, 0, 0, 218105648, 4
    .long 1, 16, 16, 8192, 3584, 3840, 8388608, 3145728, 32768, 8, 16834560, 131072, 0, 0, 218105904, 4
    .long 1, 16, 16, 8192, 3584, 3840, 8388608, 3670016, 32768, 8, 18931712, 131072, 0, 0, 218106160, 4
    .long 1, 80, 80, 2048, 1836544, 1836800, 7340032, 58224640, 114688, 7, 173039616, 32768, 218103952, 7, 218106496, 1
    .long 0, 0, 0, 0, 0, 0, 0, 0, 0, 0, 0, 0, 0, 0, 0, 0
    .long 0, 0, 0, 0, 0, 0, 0, 0, 0, 0, 0, 0, 0, 0, 0, 0
    .long 0, 0, 0, 0, 0, 0, 0, 0, 0, 0, 0, 0, 0, 0, 0, 0
    .long 0, 0, 0, 0, 0, 0, 0, 0, 0, 0, 0, 0, 0, 0, 0, 0
    .long 1, 32, 32, 8192, 5632, 5888, 8388608, 524288, 32768, 8, 39936000, 131072, 0, 0, 218104656, 4
    .long 1, 16, 16, 8192, 5632, 5888, 8388608, 1048576, 32768, 8, 8478720, 131072, 0, 0, 218104912, 4
    .long 1, 24, 24, 8192, 5632, 5888, 8388608, 2621440, 32768, 8, 31547392, 131072, 0, 0, 218105680, 4
    .long 1, 16, 16, 8192, 5632, 5888, 8388608, 3145728, 32768, 8, 16867328, 131072, 0, 0, 218105936, 4
    .long 1, 16, 16, 8192, 5632, 5888, 8388608, 3670016, 32768, 8, 18964480, 131072, 0, 0, 218106192, 4
    .long 1, 80, 80, 2048, 3671552, 3671808, 7340032, 58253312, 114688, 7, 177233920, 32768, 218103968, 7, 218106496, 1
    .long 0, 0, 0, 0, 0, 0, 0, 0, 0, 0, 0, 0, 0, 0, 0, 0
    .long 0, 0, 0, 0, 0, 0, 0, 0, 0, 0, 0, 0, 0, 0, 0, 0
    .long 0, 0, 0, 0, 0, 0, 0, 0, 0, 0, 0, 0, 0, 0, 0, 0
    .long 0, 0, 0, 0, 0, 0, 0, 0, 0, 0, 0, 0, 0, 0, 0, 0
    .long 1, 32, 32, 8192, 7680, 7936, 8388608, 524288, 32768, 8, 39968768, 131072, 0, 0, 218104688, 4
    .long 1, 16, 16, 8192, 7680, 7936, 8388608, 1048576, 32768, 8, 8511488, 131072, 0, 0, 218104944, 4
    .long 1, 24, 24, 8192, 7680, 7936, 8388608, 2621440, 32768, 8, 31580160, 131072, 0, 0, 218105712, 4
    .long 1, 16, 16, 8192, 7680, 7936, 8388608, 3145728, 32768, 8, 16900096, 131072, 0, 0, 218105968, 4
    .long 1, 16, 16, 8192, 7680, 7936, 8388608, 3670016, 32768, 8, 18997248, 131072, 0, 0, 218106224, 4
    .long 1, 80, 80, 2048, 5506560, 5506816, 7340032, 58281984, 114688, 7, 181428224, 32768, 218103984, 7, 218106496, 1
    .long 0, 0, 0, 0, 0, 0, 0, 0, 0, 0, 0, 0, 0, 0, 0, 0
    .long 0, 0, 0, 0, 0, 0, 0, 0, 0, 0, 0, 0, 0, 0, 0, 0
    .long 0, 0, 0, 0, 0, 0, 0, 0, 0, 0, 0, 0, 0, 0, 0, 0
    .long 0, 0, 0, 0, 0, 0, 0, 0, 0, 0, 0, 0, 0, 0, 0, 0
    .long 1, 24, 24, 8192, 0, 256, 8388608, 524288, 32768, 8, 23068672, 131072, 0, 0, 218104576, 4
    .long 1, 32, 32, 8192, 0, 256, 8388608, 1572864, 32768, 8, 44040192, 131072, 0, 0, 218105088, 4
    .long 1, 16, 16, 8192, 0, 256, 8388608, 2621440, 32768, 8, 14680064, 131072, 0, 0, 218105600, 4
    .long 2, 64, 72, 7168, 2048, 2048, 7340032, 1048576, 32768, 8, 58228736, 114688, 0, 0, 218103952, 1
    .long 2, 64, 72, 7168, 1024, 1024, 7340032, 2621440, 32768, 8, 63717376, 114688, 0, 0, 218104128, 1
    .long 1, 80, 80, 2048, 0, 256, 7340032, 60030976, 114688, 7, 169345024, 32768, 218104000, 7, 218106560, 1
    .long 0, 0, 0, 0, 0, 0, 0, 0, 0, 0, 0, 0, 0, 0, 0, 0
    .long 0, 0, 0, 0, 0, 0, 0, 0, 0, 0, 0, 0, 0, 0, 0, 0
    .long 0, 0, 0, 0, 0, 0, 0, 0, 0, 0, 0, 0, 0, 0, 0, 0
    .long 0, 0, 0, 0, 0, 0, 0, 0, 0, 0, 0, 0, 0, 0, 0, 0
    .long 1, 24, 24, 8192, 2048, 2304, 8388608, 524288, 32768, 8, 23101440, 131072, 0, 0, 218104608, 4
    .long 1, 32, 32, 8192, 2048, 2304, 8388608, 1572864, 32768, 8, 44072960, 131072, 0, 0, 218105120, 4
    .long 1, 16, 16, 8192, 2048, 2304, 8388608, 2621440, 32768, 8, 14712832, 131072, 0, 0, 218105632, 4
    .long 2, 64, 72, 7168, 2304, 2304, 7340032, 1048576, 32768, 8, 58232832, 114688, 0, 0, 218103952, 1
    .long 2, 64, 72, 7168, 1280, 1280, 7340032, 2621440, 32768, 8, 63721472, 114688, 0, 0, 218104128, 1
    .long 1, 80, 80, 2048, 1835008, 1835264, 7340032, 60059648, 114688, 7, 173539328, 32768, 218104016, 7, 218106560, 1
    .long 0, 0, 0, 0, 0, 0, 0, 0, 0, 0, 0, 0, 0, 0, 0, 0
    .long 0, 0, 0, 0, 0, 0, 0, 0, 0, 0, 0, 0, 0, 0, 0, 0
    .long 0, 0, 0, 0, 0, 0, 0, 0, 0, 0, 0, 0, 0, 0, 0, 0
    .long 0, 0, 0, 0, 0, 0, 0, 0, 0, 0, 0, 0, 0, 0, 0, 0
    .long 1, 24, 24, 8192, 4096, 4352, 8388608, 524288, 32768, 8, 23134208, 131072, 0, 0, 218104640, 4
    .long 1, 32, 32, 8192, 4096, 4352, 8388608, 1572864, 32768, 8, 44105728, 131072, 0, 0, 218105152, 4
    .long 1, 16, 16, 8192, 4096, 4352, 8388608, 2621440, 32768, 8, 14745600, 131072, 0, 0, 218105664, 4
    .long 2, 64, 72, 7168, 2560, 2560, 7340032, 1048576, 32768, 8, 58236928, 114688, 0, 0, 218103952, 1
    .long 2, 64, 72, 7168, 1536, 1536, 7340032, 2621440, 32768, 8, 63725568, 114688, 0, 0, 218104128, 1
    .long 1, 80, 80, 2048, 3670016, 3670272, 7340032, 60088320, 114688, 7, 177733632, 32768, 218104032, 7, 218106560, 1
    .long 0, 0, 0, 0, 0, 0, 0, 0, 0, 0, 0, 0, 0, 0, 0, 0
    .long 0, 0, 0, 0, 0, 0, 0, 0, 0, 0, 0, 0, 0, 0, 0, 0
    .long 0, 0, 0, 0, 0, 0, 0, 0, 0, 0, 0, 0, 0, 0, 0, 0
    .long 0, 0, 0, 0, 0, 0, 0, 0, 0, 0, 0, 0, 0, 0, 0, 0
    .long 1, 24, 24, 8192, 6144, 6400, 8388608, 524288, 32768, 8, 23166976, 131072, 0, 0, 218104672, 4
    .long 1, 32, 32, 8192, 6144, 6400, 8388608, 1572864, 32768, 8, 44138496, 131072, 0, 0, 218105184, 4
    .long 1, 16, 16, 8192, 6144, 6400, 8388608, 2621440, 32768, 8, 14778368, 131072, 0, 0, 218105696, 4
    .long 2, 64, 72, 7168, 2816, 2816, 7340032, 1048576, 32768, 8, 58241024, 114688, 0, 0, 218103952, 1
    .long 2, 64, 72, 7168, 1792, 1792, 7340032, 2621440, 32768, 8, 63729664, 114688, 0, 0, 218104144, 1
    .long 1, 80, 80, 2048, 5505024, 5505280, 7340032, 60116992, 114688, 7, 181927936, 32768, 218104048, 7, 218106560, 1
    .long 0, 0, 0, 0, 0, 0, 0, 0, 0, 0, 0, 0, 0, 0, 0, 0
    .long 0, 0, 0, 0, 0, 0, 0, 0, 0, 0, 0, 0, 0, 0, 0, 0
    .long 0, 0, 0, 0, 0, 0, 0, 0, 0, 0, 0, 0, 0, 0, 0, 0
    .long 0, 0, 0, 0, 0, 0, 0, 0, 0, 0, 0, 0, 0, 0, 0, 0
    .long 1, 24, 24, 8192, 512, 768, 8388608, 524288, 32768, 8, 23076864, 131072, 0, 0, 218104576, 4
    .long 1, 32, 32, 8192, 512, 768, 8388608, 1572864, 32768, 8, 44048384, 131072, 0, 0, 218105088, 4
    .long 1, 16, 16, 8192, 512, 768, 8388608, 2621440, 32768, 8, 14688256, 131072, 0, 0, 218105600, 4
    .long 2, 64, 72, 7168, 3072, 3072, 7340032, 1048576, 32768, 8, 58245120, 114688, 0, 0, 218103952, 1
    .long 2, 64, 72, 7168, 2048, 2048, 7340032, 2621440, 32768, 8, 63733760, 114688, 0, 0, 218104144, 1
    .long 1, 80, 80, 2048, 512, 768, 7340032, 60030976, 114688, 7, 169353216, 32768, 218104000, 7, 218106560, 1
    .long 0, 0, 0, 0, 0, 0, 0, 0, 0, 0, 0, 0, 0, 0, 0, 0
    .long 0, 0, 0, 0, 0, 0, 0, 0, 0, 0, 0, 0, 0, 0, 0, 0
    .long 0, 0, 0, 0, 0, 0, 0, 0, 0, 0, 0, 0, 0, 0, 0, 0
    .long 0, 0, 0, 0, 0, 0, 0, 0, 0, 0, 0, 0, 0, 0, 0, 0
    .long 1, 24, 24, 8192, 2560, 2816, 8388608, 524288, 32768, 8, 23109632, 131072, 0, 0, 218104608, 4
    .long 1, 32, 32, 8192, 2560, 2816, 8388608, 1572864, 32768, 8, 44081152, 131072, 0, 0, 218105120, 4
    .long 1, 16, 16, 8192, 2560, 2816, 8388608, 2621440, 32768, 8, 14721024, 131072, 0, 0, 218105632, 4
    .long 2, 64, 72, 7168, 3328, 3328, 7340032, 1048576, 32768, 8, 58249216, 114688, 0, 0, 218103952, 1
    .long 2, 64, 72, 7168, 2304, 2304, 7340032, 2621440, 32768, 8, 63737856, 114688, 0, 0, 218104144, 1
    .long 1, 80, 80, 2048, 1835520, 1835776, 7340032, 60059648, 114688, 7, 173547520, 32768, 218104016, 7, 218106560, 1
    .long 0, 0, 0, 0, 0, 0, 0, 0, 0, 0, 0, 0, 0, 0, 0, 0
    .long 0, 0, 0, 0, 0, 0, 0, 0, 0, 0, 0, 0, 0, 0, 0, 0
    .long 0, 0, 0, 0, 0, 0, 0, 0, 0, 0, 0, 0, 0, 0, 0, 0
    .long 0, 0, 0, 0, 0, 0, 0, 0, 0, 0, 0, 0, 0, 0, 0, 0
    .long 1, 24, 24, 8192, 4608, 4864, 8388608, 524288, 32768, 8, 23142400, 131072, 0, 0, 218104640, 4
    .long 1, 32, 32, 8192, 4608, 4864, 8388608, 1572864, 32768, 8, 44113920, 131072, 0, 0, 218105152, 4
    .long 1, 16, 16, 8192, 4608, 4864, 8388608, 2621440, 32768, 8, 14753792, 131072, 0, 0, 218105664, 4
    .long 2, 64, 72, 7168, 3584, 3584, 7340032, 1048576, 32768, 8, 58253312, 114688, 0, 0, 218103968, 1
    .long 2, 64, 72, 7168, 2560, 2560, 7340032, 2621440, 32768, 8, 63741952, 114688, 0, 0, 218104144, 1
    .long 1, 80, 80, 2048, 3670528, 3670784, 7340032, 60088320, 114688, 7, 177741824, 32768, 218104032, 7, 218106560, 1
    .long 0, 0, 0, 0, 0, 0, 0, 0, 0, 0, 0, 0, 0, 0, 0, 0
    .long 0, 0, 0, 0, 0, 0, 0, 0, 0, 0, 0, 0, 0, 0, 0, 0
    .long 0, 0, 0, 0, 0, 0, 0, 0, 0, 0, 0, 0, 0, 0, 0, 0
    .long 0, 0, 0, 0, 0, 0, 0, 0, 0, 0, 0, 0, 0, 0, 0, 0
    .long 1, 24, 24, 8192, 6656, 6912, 8388608, 524288, 32768, 8, 23175168, 131072, 0, 0, 218104672, 4
    .long 1, 32, 32, 8192, 6656, 6912, 8388608, 1572864, 32768, 8, 44146688, 131072, 0, 0, 218105184, 4
    .long 1, 16, 16, 8192, 6656, 6912, 8388608, 2621440, 32768, 8, 14786560, 131072, 0, 0, 218105696, 4
    .long 2, 64, 72, 7168, 3840, 3840, 7340032, 1048576, 32768, 8, 58257408, 114688, 0, 0, 218103968, 1
    .long 2, 64, 72, 7168, 2816, 2816, 7340032, 2621440, 32768, 8, 63746048, 114688, 0, 0, 218104144, 1
    .long 1, 80, 80, 2048, 5505536, 5505792, 7340032, 60116992, 114688, 7, 181936128, 32768, 218104048, 7, 218106560, 1
    .long 0, 0, 0, 0, 0, 0, 0, 0, 0, 0, 0, 0, 0, 0, 0, 0
    .long 0, 0, 0, 0, 0, 0, 0, 0, 0, 0, 0, 0, 0, 0, 0, 0
    .long 0, 0, 0, 0, 0, 0, 0, 0, 0, 0, 0, 0, 0, 0, 0, 0
    .long 0, 0, 0, 0, 0, 0, 0, 0, 0, 0, 0, 0, 0, 0, 0, 0
    .long 1, 24, 24, 8192, 1024, 1280, 8388608, 524288, 32768, 8, 23085056, 131072, 0, 0, 218104592, 4
    .long 1, 32, 32, 8192, 1024, 1280, 8388608, 1572864, 32768, 8, 44056576, 131072, 0, 0, 218105104, 4
    .long 1, 16, 16, 8192, 1024, 1280, 8388608, 2621440, 32768, 8, 14696448, 131072, 0, 0, 218105616, 4
    .long 2, 64, 72, 7168, 4096, 4096, 7340032, 1048576, 32768, 8, 58261504, 114688, 0, 0, 218103968, 1
    .long 2, 64, 72, 7168, 3072, 3072, 7340032, 2621440, 32768, 8, 63750144, 114688, 0, 0, 218104144, 1
    .long 1, 80, 80, 2048, 1024, 1280, 7340032, 60030976, 114688, 7, 169361408, 32768, 218104000, 7, 218106560, 1
    .long 0, 0, 0, 0, 0, 0, 0, 0, 0, 0, 0, 0, 0, 0, 0, 0
    .long 0, 0, 0, 0, 0, 0, 0, 0, 0, 0, 0, 0, 0, 0, 0, 0
    .long 0, 0, 0, 0, 0, 0, 0, 0, 0, 0, 0, 0, 0, 0, 0, 0
    .long 0, 0, 0, 0, 0, 0, 0, 0, 0, 0, 0, 0, 0, 0, 0, 0
    .long 1, 24, 24, 8192, 3072, 3328, 8388608, 524288, 32768, 8, 23117824, 131072, 0, 0, 218104624, 4
    .long 1, 32, 32, 8192, 3072, 3328, 8388608, 1572864, 32768, 8, 44089344, 131072, 0, 0, 218105136, 4
    .long 1, 16, 16, 8192, 3072, 3328, 8388608, 2621440, 32768, 8, 14729216, 131072, 0, 0, 218105648, 4
    .long 2, 64, 72, 7168, 4352, 4352, 7340032, 1048576, 32768, 8, 58265600, 114688, 0, 0, 218103968, 1
    .long 2, 64, 72, 7168, 3328, 3328, 7340032, 2621440, 32768, 8, 63754240, 114688, 0, 0, 218104144, 1
    .long 1, 80, 80, 2048, 1836032, 1836288, 7340032, 60059648, 114688, 7, 173555712, 32768, 218104016, 7, 218106560, 1
    .long 0, 0, 0, 0, 0, 0, 0, 0, 0, 0, 0, 0, 0, 0, 0, 0
    .long 0, 0, 0, 0, 0, 0, 0, 0, 0, 0, 0, 0, 0, 0, 0, 0
    .long 0, 0, 0, 0, 0, 0, 0, 0, 0, 0, 0, 0, 0, 0, 0, 0
    .long 0, 0, 0, 0, 0, 0, 0, 0, 0, 0, 0, 0, 0, 0, 0, 0
    .long 1, 24, 24, 8192, 5120, 5376, 8388608, 524288, 32768, 8, 23150592, 131072, 0, 0, 218104656, 4
    .long 1, 32, 32, 8192, 5120, 5376, 8388608, 1572864, 32768, 8, 44122112, 131072, 0, 0, 218105168, 4
    .long 1, 16, 16, 8192, 5120, 5376, 8388608, 2621440, 32768, 8, 14761984, 131072, 0, 0, 218105680, 4
    .long 2, 64, 72, 7168, 4608, 4608, 7340032, 1048576, 32768, 8, 58269696, 114688, 0, 0, 218103968, 1
    .long 2, 64, 72, 7168, 3584, 3584, 7340032, 2621440, 32768, 8, 63758336, 114688, 0, 0, 218104160, 1
    .long 1, 80, 80, 2048, 3671040, 3671296, 7340032, 60088320, 114688, 7, 177750016, 32768, 218104032, 7, 218106560, 1
    .long 0, 0, 0, 0, 0, 0, 0, 0, 0, 0, 0, 0, 0, 0, 0, 0
    .long 0, 0, 0, 0, 0, 0, 0, 0, 0, 0, 0, 0, 0, 0, 0, 0
    .long 0, 0, 0, 0, 0, 0, 0, 0, 0, 0, 0, 0, 0, 0, 0, 0
    .long 0, 0, 0, 0, 0, 0, 0, 0, 0, 0, 0, 0, 0, 0, 0, 0
    .long 1, 24, 24, 8192, 7168, 7424, 8388608, 524288, 32768, 8, 23183360, 131072, 0, 0, 218104688, 4
    .long 1, 32, 32, 8192, 7168, 7424, 8388608, 1572864, 32768, 8, 44154880, 131072, 0, 0, 218105200, 4
    .long 1, 16, 16, 8192, 7168, 7424, 8388608, 2621440, 32768, 8, 14794752, 131072, 0, 0, 218105712, 4
    .long 2, 64, 72, 7168, 4864, 4864, 7340032, 1048576, 32768, 8, 58273792, 114688, 0, 0, 218103968, 1
    .long 2, 64, 72, 7168, 3840, 3840, 7340032, 2621440, 32768, 8, 63762432, 114688, 0, 0, 218104160, 1
    .long 1, 80, 80, 2048, 5506048, 5506304, 7340032, 60116992, 114688, 7, 181944320, 32768, 218104048, 7, 218106560, 1
    .long 0, 0, 0, 0, 0, 0, 0, 0, 0, 0, 0, 0, 0, 0, 0, 0
    .long 0, 0, 0, 0, 0, 0, 0, 0, 0, 0, 0, 0, 0, 0, 0, 0
    .long 0, 0, 0, 0, 0, 0, 0, 0, 0, 0, 0, 0, 0, 0, 0, 0
    .long 0, 0, 0, 0, 0, 0, 0, 0, 0, 0, 0, 0, 0, 0, 0, 0
    .long 1, 24, 24, 8192, 1536, 1792, 8388608, 524288, 32768, 8, 23093248, 131072, 0, 0, 218104592, 4
    .long 1, 32, 32, 8192, 1536, 1792, 8388608, 1572864, 32768, 8, 44064768, 131072, 0, 0, 218105104, 4
    .long 1, 16, 16, 8192, 1536, 1792, 8388608, 2621440, 32768, 8, 14704640, 131072, 0, 0, 218105616, 4
    .long 2, 64, 72, 7168, 5120, 5120, 7340032, 1048576, 32768, 8, 58277888, 114688, 0, 0, 218103968, 1
    .long 2, 64, 72, 7168, 4096, 4096, 7340032, 2621440, 32768, 8, 63766528, 114688, 0, 0, 218104160, 1
    .long 1, 80, 80, 2048, 1536, 1792, 7340032, 60030976, 114688, 7, 169369600, 32768, 218104000, 7, 218106560, 1
    .long 0, 0, 0, 0, 0, 0, 0, 0, 0, 0, 0, 0, 0, 0, 0, 0
    .long 0, 0, 0, 0, 0, 0, 0, 0, 0, 0, 0, 0, 0, 0, 0, 0
    .long 0, 0, 0, 0, 0, 0, 0, 0, 0, 0, 0, 0, 0, 0, 0, 0
    .long 0, 0, 0, 0, 0, 0, 0, 0, 0, 0, 0, 0, 0, 0, 0, 0
    .long 1, 24, 24, 8192, 3584, 3840, 8388608, 524288, 32768, 8, 23126016, 131072, 0, 0, 218104624, 4
    .long 1, 32, 32, 8192, 3584, 3840, 8388608, 1572864, 32768, 8, 44097536, 131072, 0, 0, 218105136, 4
    .long 1, 16, 16, 8192, 3584, 3840, 8388608, 2621440, 32768, 8, 14737408, 131072, 0, 0, 218105648, 4
    .long 2, 64, 72, 7168, 5376, 5376, 7340032, 1048576, 32768, 8, 58281984, 114688, 0, 0, 218103984, 1
    .long 2, 64, 72, 7168, 4352, 4352, 7340032, 2621440, 32768, 8, 63770624, 114688, 0, 0, 218104160, 1
    .long 1, 80, 80, 2048, 1836544, 1836800, 7340032, 60059648, 114688, 7, 173563904, 32768, 218104016, 7, 218106560, 1
    .long 0, 0, 0, 0, 0, 0, 0, 0, 0, 0, 0, 0, 0, 0, 0, 0
    .long 0, 0, 0, 0, 0, 0, 0, 0, 0, 0, 0, 0, 0, 0, 0, 0
    .long 0, 0, 0, 0, 0, 0, 0, 0, 0, 0, 0, 0, 0, 0, 0, 0
    .long 0, 0, 0, 0, 0, 0, 0, 0, 0, 0, 0, 0, 0, 0, 0, 0
    .long 1, 24, 24, 8192, 5632, 5888, 8388608, 524288, 32768, 8, 23158784, 131072, 0, 0, 218104656, 4
    .long 1, 32, 32, 8192, 5632, 5888, 8388608, 1572864, 32768, 8, 44130304, 131072, 0, 0, 218105168, 4
    .long 1, 16, 16, 8192, 5632, 5888, 8388608, 2621440, 32768, 8, 14770176, 131072, 0, 0, 218105680, 4
    .long 2, 64, 72, 7168, 5632, 5632, 7340032, 1048576, 32768, 8, 58286080, 114688, 0, 0, 218103984, 1
    .long 2, 64, 72, 7168, 4608, 4608, 7340032, 2621440, 32768, 8, 63774720, 114688, 0, 0, 218104160, 1
    .long 1, 80, 80, 2048, 3671552, 3671808, 7340032, 60088320, 114688, 7, 177758208, 32768, 218104032, 7, 218106560, 1
    .long 0, 0, 0, 0, 0, 0, 0, 0, 0, 0, 0, 0, 0, 0, 0, 0
    .long 0, 0, 0, 0, 0, 0, 0, 0, 0, 0, 0, 0, 0, 0, 0, 0
    .long 0, 0, 0, 0, 0, 0, 0, 0, 0, 0, 0, 0, 0, 0, 0, 0
    .long 0, 0, 0, 0, 0, 0, 0, 0, 0, 0, 0, 0, 0, 0, 0, 0
    .long 1, 24, 24, 8192, 7680, 7936, 8388608, 524288, 32768, 8, 23191552, 131072, 0, 0, 218104688, 4
    .long 1, 32, 32, 8192, 7680, 7936, 8388608, 1572864, 32768, 8, 44163072, 131072, 0, 0, 218105200, 4
    .long 1, 16, 16, 8192, 7680, 7936, 8388608, 2621440, 32768, 8, 14802944, 131072, 0, 0, 218105712, 4
    .long 2, 64, 72, 7168, 5888, 5888, 7340032, 1048576, 32768, 8, 58290176, 114688, 0, 0, 218103984, 1
    .long 2, 64, 72, 7168, 4864, 4864, 7340032, 2621440, 32768, 8, 63778816, 114688, 0, 0, 218104160, 1
    .long 1, 80, 80, 2048, 5506560, 5506816, 7340032, 60116992, 114688, 7, 181952512, 32768, 218104048, 7, 218106560, 1
    .long 0, 0, 0, 0, 0, 0, 0, 0, 0, 0, 0, 0, 0, 0, 0, 0
    .long 0, 0, 0, 0, 0, 0, 0, 0, 0, 0, 0, 0, 0, 0, 0, 0
    .long 0, 0, 0, 0, 0, 0, 0, 0, 0, 0, 0, 0, 0, 0, 0, 0
    .long 0, 0, 0, 0, 0, 0, 0, 0, 0, 0, 0, 0, 0, 0, 0, 0
.p2align 6
.amdhsa_kernel recurrent_scan__memory_aug_recurrent_mem_tr__glu_gated_glu__prompt_kernel
  .amdhsa_next_free_vgpr 256
  .amdhsa_next_free_sgpr 102
  .amdhsa_accum_offset 256
  .amdhsa_group_segment_fixed_size 0
  .amdhsa_kernarg_size 112
  .amdhsa_user_sgpr_count 2
  .amdhsa_user_sgpr_kernarg_segment_ptr 1
  .amdhsa_system_sgpr_workgroup_id_x 1
  .amdhsa_float_denorm_mode_32 3
.end_amdhsa_kernel
```

```asm
; @launch grid=(256,1,1) block=(512,1,1) lds=163840
.amdgcn_target "amdgcn-amd-amdhsa--gfx950"
.text
.globl recurrent_scan__memory_aug_recurrent_mem_tr__glu_gated_glu__prompt_kernel
.p2align 8
.type recurrent_scan__memory_aug_recurrent_mem_tr__glu_gated_glu__prompt_kernel,@function
recurrent_scan__memory_aug_recurrent_mem_tr__glu_gated_glu__prompt_kernel:
    s_cmp_ge_u32 s2, 256
    s_cbranch_scc1 k_exit
    s_mov_b32 s99, s2
    s_load_dwordx2 s[4:5], s[0:1], 104
    s_load_dwordx2 s[64:65], s[0:1], 96
    v_lshrrev_b32 v2, 6, v0
    s_mov_b32 s6, 268435456
    s_mov_b32 s7, 131072
    s_mov_b32 s66, 256
    s_mov_b32 s67, 131072
    v_readfirstlane_b32 s3, v2
    s_lshr_b32 s12, s2, 3
    s_and_b32 s13, s2, 3
    s_waitcnt lgkmcnt(0)
    s_bitcmp0_b32 s2, 2
    s_cbranch_scc1 chain_map
    s_lshl_b32 s63, s12, 2
    s_add_u32 s63, s63, s13
    s_mov_b32 s29, s63
    v_and_b32 v20, 63, v0
    v_lshlrev_b32 v1, 4, v20
    v_add_u32 v19, 0x1000, v1
    v_lshrrev_b32 v4, 4, v20
    v_mov_b32 v17, 0
    v_mov_b32 v18, 1
    s_lshr_b32 s26, s3, 2
    s_and_b32 s27, s3, 3
    s_lshl_b32 s21, s3, 11
    s_lshl_b32 s22, s3, 10
    s_add_u32 s22, s22, 16384
    s_mov_b32 s11, 131072
    s_mov_b32 s15, 131072
    s_mov_b32 s28, 0
    v_and_b32 v21, 15, v20
    v_lshlrev_b32 v22, 2, v4
    v_xor_b32 v21, v21, v22
    s_lshr_b32 s30, s3, 1
    s_and_b32 s30, s30, 1
    v_xor_b32 v21, s30, v21
    v_lshlrev_b32 v3, 4, v21
    s_lshl_b32 s30, s26, 13
    v_add_u32 v5, s30, v1
    v_add_u32 v6, 0x10000, v5
    v_bfe_u32 v21, v20, 2, 2
    v_and_b32 v22, 3, v20
    v_and_b32 v23, 1, v4
    v_xor_b32 v24, s27, v21
    v_xor_b32 v25, v22, v23
    v_lshl_add_u32 v24, v24, 2, v25
    v_lshlrev_b32 v24, 4, v24
    v_lshl_add_u32 v25, v4, 3, v21
    v_lshl_add_u32 v24, v25, 8, v24
    v_and_b32 v22, 1, v22
    v_xor_b32 v25, 0, v23
    v_lshl_add_u32 v8, v25, 10, v24
    v_xor_b32 v25, 0, v22
    v_lshl_add_u32 v8, v25, 3, v8
    v_add_u32 v12, 0x10000, v8
    v_xor_b32 v25, 1, v23
    v_lshl_add_u32 v9, v25, 10, v24
    v_xor_b32 v25, 0, v22
    v_lshl_add_u32 v9, v25, 3, v9
    v_add_u32 v13, 0x10000, v9
    v_xor_b32 v25, 0, v23
    v_lshl_add_u32 v10, v25, 10, v24
    v_xor_b32 v25, 1, v22
    v_lshl_add_u32 v10, v25, 3, v10
    v_add_u32 v14, 0x10000, v10
    v_xor_b32 v25, 1, v23
    v_lshl_add_u32 v11, v25, 10, v24
    v_xor_b32 v25, 1, v22
    v_lshl_add_u32 v11, v25, 3, v11
    v_add_u32 v15, 0x10000, v11
    s_lshl_b32 s30, s3, 2
    s_add_u32 s30, s30, 131072
    v_mov_b32 v7, s30
    s_getpc_b64 s[24:25]
    s_add_u32 s24, s24, jobtab@rel32@lo+4
    s_addc_u32 s25, s25, jobtab@rel32@hi+12
    s_mul_i32 s30, s29, 640
    s_add_u32 s24, s24, s30
    s_addc_u32 s25, s25, 0
    s_load_dwordx16 s[32:47], s[24:25], 0
    s_add_u32 s24, s24, 64
    s_addc_u32 s25, s25, 0
    s_waitcnt lgkmcnt(0)
    s_mov_b32 s8, s4
    s_mov_b32 s9, s5
    s_mov_b32 s10, 0
    s_mov_b32 s12, s4
    s_mov_b32 s13, s5
    s_mov_b32 s14, 0
    s_load_dwordx2 s[88:89], s[0:1], 0
    s_mov_b32 s90, 4194304
    s_mov_b32 s91, 131072
    s_mov_b32 s98, 0
    v_mov_b32 v22, 0
    s_mov_b32 s70, 1
    v_and_b32 v245, 15, v0
    v_lshlrev_b32 v246, 11, v245
    v_lshl_add_u32 v246, v4, 4, v246
    s_add_u32 s71, s63, 32
    s_and_b32 s71, s71, 127
    s_lshl_b32 s72, s71, 15
    s_lshl_b32 s73, s3, 8
    s_add_u32 s72, s72, s73
    s_waitcnt lgkmcnt(0)
    buffer_load_dwordx4 v[228:231], v246, s[88:91], s72 offen offset:0
    buffer_load_dwordx4 v[232:235], v246, s[88:91], s72 offen offset:64
    buffer_load_dwordx4 v[236:239], v246, s[88:91], s72 offen offset:128
    buffer_load_dwordx4 v[240:243], v246, s[88:91], s72 offen offset:192
    s_cmp_lg_u32 s32, 6
    s_cbranch_scc1 ln_nx
    s_mov_b32 s98, 3
    s_cmp_lg_u32 s32, 6
    s_cbranch_scc1 xs_1
    s_load_dwordx2 s[8:9], s[0:1], s33
    s_load_dwordx2 s[12:13], s[0:1], s34
    s_mov_b32 s10, s38
    s_mov_b32 s14, s38
    s_cmp_ge_u32 s32, 4
    s_cselect_b32 s31, 0, 1
    s_lshl_b32 s30, s3, s31
    s_mul_i32 s30, s30, s40
    s_add_u32 s16, s39, s30
    s_cmp_eq_u32 s32, 4
    s_cselect_b32 s30, 1024, s40
    s_cselect_b32 s31, 6, 5
    s_lshl_b32 s62, 32, s31
    s_add_u32 s17, s16, s30
    s_lshl_b32 s30, s3, 2
    s_mul_i32 s30, s30, s35
    s_add_u32 s18, s36, s30
    s_add_u32 s19, s37, s30
    s_lshl_b32 s20, s35, s31
    v_mul_u32_u24 v2, s35, v4
    v_add_u32 v2, v2, v3
    s_waitcnt lgkmcnt(0)
    s_lshl_b32 s16, s3, 15
    s_add_u32 s16, s16, s39
    s_add_u32 s92, s16, 2048
    s_lshl_b32 s93, s35, 10
    s_lshr_b32 s94, s63, 2
    s_mul_i32 s94, s94, 1
    s_and_b32 s94, s94, 15
    s_lshl_b32 s95, s94, 7
    s_add_u32 s16, s16, s95
    s_lshl_b32 s95, s35, 6
    s_mul_i32 s94, s95, s94
    s_add_u32 s95, s18, s93
    s_add_u32 s18, s18, s94
    s_add_u32 s19, s19, s94
    s_add_u32 s17, s16, 16384
    s_mov_b32 s62, 128
    s_lshl_b32 s20, s35, 6
    v_lshrrev_b32 v21, 7, v1
    v_bfe_u32 v23, v1, 4, 3
    v_xor_b32 v23, v21, v23
    v_lshlrev_b32 v23, 4, v23
    v_lshl_add_u32 v23, v21, 11, v23
    s_add_u32 m0, s21, 0
    s_nop 0
    buffer_load_dwordx4 v23, s[88:91], s16 offen lds
    s_add_u32 s16, s16, s62
    s_add_u32 m0, s21, 1024
    s_nop 0
    buffer_load_dwordx4 v23, s[88:91], s17 offen lds
    s_add_u32 s17, s17, s62
    s_cmp_ge_u32 s16, s92
    s_cselect_b32 s94, 2048, 0
    s_sub_u32 s16, s16, s94
    s_sub_u32 s17, s17, s94
    s_add_u32 m0, s22, 0
    s_nop 0
    buffer_load_dwordx4 v2, s[8:11], s18 offen lds
    s_add_u32 s18, s18, s20
    s_add_u32 m0, s22, 8192
    s_nop 0
    buffer_load_dwordx4 v2, s[12:15], s19 offen lds
    s_add_u32 s19, s19, s20
    s_cmp_ge_u32 s18, s95
    s_cselect_b32 s94, s93, 0
    s_sub_u32 s18, s18, s94
    s_sub_u32 s19, s19, s94
    s_add_u32 m0, s21, 32768
    s_nop 0
    buffer_load_dwordx4 v23, s[88:91], s16 offen lds
    s_add_u32 s16, s16, s62
    s_add_u32 m0, s21, 33792
    s_nop 0
    buffer_load_dwordx4 v23, s[88:91], s17 offen lds
    s_add_u32 s17, s17, s62
    s_cmp_ge_u32 s16, s92
    s_cselect_b32 s94, 2048, 0
    s_sub_u32 s16, s16, s94
    s_sub_u32 s17, s17, s94
    s_add_u32 m0, s22, 32768
    s_nop 0
    buffer_load_dwordx4 v2, s[8:11], s18 offen lds
    s_add_u32 s18, s18, s20
    s_add_u32 m0, s22, 40960
    s_nop 0
    buffer_load_dwordx4 v2, s[12:15], s19 offen lds
    s_add_u32 s19, s19, s20
    s_cmp_ge_u32 s18, s95
    s_cselect_b32 s94, s93, 0
    s_sub_u32 s18, s18, s94
    s_sub_u32 s19, s19, s94
    s_add_u32 m0, s21, 65536
    s_nop 0
    buffer_load_dwordx4 v23, s[88:91], s16 offen lds
    s_add_u32 s16, s16, s62
    s_add_u32 m0, s21, 66560
    s_nop 0
    buffer_load_dwordx4 v23, s[88:91], s17 offen lds
    s_add_u32 s17, s17, s62
    s_cmp_ge_u32 s16, s92
    s_cselect_b32 s94, 2048, 0
    s_sub_u32 s16, s16, s94
    s_sub_u32 s17, s17, s94
    s_add_u32 m0, s22, 65536
    s_nop 0
    buffer_load_dwordx4 v2, s[8:11], s18 offen lds
    s_add_u32 s18, s18, s20
    s_add_u32 m0, s22, 73728
    s_nop 0
    buffer_load_dwordx4 v2, s[12:15], s19 offen lds
    s_add_u32 s19, s19, s20
    s_cmp_ge_u32 s18, s95
    s_cselect_b32 s94, s93, 0
    s_sub_u32 s18, s18, s94
    s_sub_u32 s19, s19, s94
    s_add_u32 m0, s21, 98304
    s_nop 0
    buffer_load_dwordx4 v23, s[88:91], s16 offen lds
    s_add_u32 s16, s16, s62
    s_add_u32 m0, s21, 99328
    s_nop 0
    buffer_load_dwordx4 v23, s[88:91], s17 offen lds
    s_add_u32 s17, s17, s62
    s_cmp_ge_u32 s16, s92
    s_cselect_b32 s94, 2048, 0
    s_sub_u32 s16, s16, s94
    s_sub_u32 s17, s17, s94
    s_add_u32 m0, s22, 98304
    s_nop 0
    buffer_load_dwordx4 v2, s[8:11], s18 offen lds
    s_add_u32 s18, s18, s20
    s_add_u32 m0, s22, 106496
    s_nop 0
    buffer_load_dwordx4 v2, s[12:15], s19 offen lds
    s_add_u32 s19, s19, s20
    s_cmp_ge_u32 s18, s95
    s_cselect_b32 s94, s93, 0
    s_sub_u32 s18, s18, s94
    s_sub_u32 s19, s19, s94
    v_and_b32 v21, 1, v4
    v_lshlrev_b32 v21, 10, v21
    v_xor_b32 v8, v21, v8
    v_xor_b32 v9, v21, v9
    v_xor_b32 v10, v21, v10
    v_xor_b32 v11, v21, v11
    v_xor_b32 v12, v21, v12
    v_xor_b32 v13, v21, v13
    v_xor_b32 v14, v21, v14
    v_xor_b32 v15, v21, v15
xs_1:
    s_branch w_adopt
ln_nx:
    s_lshl_b32 s73, s71, 9
    s_add_u32 s73, s73, 218103808
    v_lshlrev_b32 v252, 2, v0
    s_cmp_ge_u32 s71, 32
    s_cbranch_scc1 ln_nz
    s_cmp_ge_u32 s3, 2
    s_cbranch_scc1 ln_nz
    buffer_store_dword v17, v252, s[4:7], s73 offen sc1
ln_nz:
    s_waitcnt vmcnt(0)
ln_entry:
    v_lshlrev_b32 v247, 5, v245
    v_add_u32 v247, 135168, v247
    s_lshl_b32 s74, s3, 2
    v_add_u32 v248, s74, v247
    s_lshl_b32 s75, s71, 15
    s_lshl_b32 s76, s3, 12
    s_add_u32 s75, s75, s76
    v_and_b32 v249, 1, v4
    v_cmp_eq_u32 s[80:81], 1, v249
    v_lshlrev_b32 v56, 16, v228
    v_and_b32 v57, 0xffff0000, v228
    v_lshlrev_b32 v58, 16, v229
    v_and_b32 v59, 0xffff0000, v229
    v_lshlrev_b32 v60, 16, v230
    v_and_b32 v61, 0xffff0000, v230
    v_lshlrev_b32 v62, 16, v231
    v_and_b32 v63, 0xffff0000, v231
    v_lshlrev_b32 v64, 16, v232
    v_and_b32 v65, 0xffff0000, v232
    v_lshlrev_b32 v66, 16, v233
    v_and_b32 v67, 0xffff0000, v233
    v_lshlrev_b32 v68, 16, v234
    v_and_b32 v69, 0xffff0000, v234
    v_lshlrev_b32 v70, 16, v235
    v_and_b32 v71, 0xffff0000, v235
    v_lshlrev_b32 v72, 16, v236
    v_and_b32 v73, 0xffff0000, v236
    v_lshlrev_b32 v74, 16, v237
    v_and_b32 v75, 0xffff0000, v237
    v_lshlrev_b32 v76, 16, v238
    v_and_b32 v77, 0xffff0000, v238
    v_lshlrev_b32 v78, 16, v239
    v_and_b32 v79, 0xffff0000, v239
    v_lshlrev_b32 v80, 16, v240
    v_and_b32 v81, 0xffff0000, v240
    v_lshlrev_b32 v82, 16, v241
    v_and_b32 v83, 0xffff0000, v241
    v_lshlrev_b32 v84, 16, v242
    v_and_b32 v85, 0xffff0000, v242
    v_lshlrev_b32 v86, 16, v243
    v_and_b32 v87, 0xffff0000, v243
    v_add_f32 v120, v56, v72
    v_add_f32 v121, v57, v73
    v_add_f32 v122, v58, v74
    v_add_f32 v123, v59, v75
    v_add_f32 v124, v60, v76
    v_add_f32 v125, v61, v77
    v_add_f32 v126, v62, v78
    v_add_f32 v127, v63, v79
    v_add_f32 v128, v64, v80
    v_add_f32 v129, v65, v81
    v_add_f32 v130, v66, v82
    v_add_f32 v131, v67, v83
    v_add_f32 v132, v68, v84
    v_add_f32 v133, v69, v85
    v_add_f32 v134, v70, v86
    v_add_f32 v135, v71, v87
    v_add_f32 v120, v120, v128
    v_add_f32 v121, v121, v129
    v_add_f32 v122, v122, v130
    v_add_f32 v123, v123, v131
    v_add_f32 v124, v124, v132
    v_add_f32 v125, v125, v133
    v_add_f32 v126, v126, v134
    v_add_f32 v127, v127, v135
    v_add_f32 v120, v120, v124
    v_add_f32 v121, v121, v125
    v_add_f32 v122, v122, v126
    v_add_f32 v123, v123, v127
    v_add_f32 v120, v120, v122
    v_add_f32 v121, v121, v123
    v_add_f32 v120, v120, v121
    v_mov_b32 v121, v120
    s_nop 1
    v_permlane16_swap_b32 v121, v120
    v_add_f32 v120, v120, v121
    v_mov_b32 v121, v120
    s_nop 1
    v_permlane32_swap_b32 v121, v120
    v_add_f32 v120, v120, v121
    ds_write_b32 v248, v120 offset:0
    s_waitcnt lgkmcnt(0)
    s_barrier
    ds_read_b128 v[120:123], v247 offset:0
    ds_read_b128 v[124:127], v247 offset:16
    s_waitcnt lgkmcnt(0)
    v_add_f32 v120, v120, v124
    v_add_f32 v121, v121, v125
    v_add_f32 v122, v122, v126
    v_add_f32 v123, v123, v127
    v_add_f32 v120, v120, v122
    v_add_f32 v121, v121, v123
    v_add_f32 v120, v120, v121
    v_mul_f32 v250, 0x3a800000, v120
    v_sub_f32 v152, v56, v250
    v_sub_f32 v153, v57, v250
    v_sub_f32 v154, v58, v250
    v_sub_f32 v155, v59, v250
    v_sub_f32 v156, v60, v250
    v_sub_f32 v157, v61, v250
    v_sub_f32 v158, v62, v250
    v_sub_f32 v159, v63, v250
    v_sub_f32 v160, v64, v250
    v_sub_f32 v161, v65, v250
    v_sub_f32 v162, v66, v250
    v_sub_f32 v163, v67, v250
    v_sub_f32 v164, v68, v250
    v_sub_f32 v165, v69, v250
    v_sub_f32 v166, v70, v250
    v_sub_f32 v167, v71, v250
    v_sub_f32 v168, v72, v250
    v_sub_f32 v169, v73, v250
    v_sub_f32 v170, v74, v250
    v_sub_f32 v171, v75, v250
    v_sub_f32 v172, v76, v250
    v_sub_f32 v173, v77, v250
    v_sub_f32 v174, v78, v250
    v_sub_f32 v175, v79, v250
    v_sub_f32 v176, v80, v250
    v_sub_f32 v177, v81, v250
    v_sub_f32 v178, v82, v250
    v_sub_f32 v179, v83, v250
    v_sub_f32 v180, v84, v250
    v_sub_f32 v181, v85, v250
    v_sub_f32 v182, v86, v250
    v_sub_f32 v183, v87, v250
    v_mul_f32 v120, v152, v152
    v_fmac_f32 v120, v168, v168
    v_mul_f32 v121, v153, v153
    v_fmac_f32 v121, v169, v169
    v_mul_f32 v122, v154, v154
    v_fmac_f32 v122, v170, v170
    v_mul_f32 v123, v155, v155
    v_fmac_f32 v123, v171, v171
    v_mul_f32 v124, v156, v156
    v_fmac_f32 v124, v172, v172
    v_mul_f32 v125, v157, v157
    v_fmac_f32 v125, v173, v173
    v_mul_f32 v126, v158, v158
    v_fmac_f32 v126, v174, v174
    v_mul_f32 v127, v159, v159
    v_fmac_f32 v127, v175, v175
    v_mul_f32 v128, v160, v160
    v_fmac_f32 v128, v176, v176
    v_mul_f32 v129, v161, v161
    v_fmac_f32 v129, v177, v177
    v_mul_f32 v130, v162, v162
    v_fmac_f32 v130, v178, v178
    v_mul_f32 v131, v163, v163
    v_fmac_f32 v131, v179, v179
    v_mul_f32 v132, v164, v164
    v_fmac_f32 v132, v180, v180
    v_mul_f32 v133, v165, v165
    v_fmac_f32 v133, v181, v181
    v_mul_f32 v134, v166, v166
    v_fmac_f32 v134, v182, v182
    v_mul_f32 v135, v167, v167
    v_fmac_f32 v135, v183, v183
    v_add_f32 v120, v120, v128
    v_add_f32 v121, v121, v129
    v_add_f32 v122, v122, v130
    v_add_f32 v123, v123, v131
    v_add_f32 v124, v124, v132
    v_add_f32 v125, v125, v133
    v_add_f32 v126, v126, v134
    v_add_f32 v127, v127, v135
    v_add_f32 v120, v120, v124
    v_add_f32 v121, v121, v125
    v_add_f32 v122, v122, v126
    v_add_f32 v123, v123, v127
    v_add_f32 v120, v120, v122
    v_add_f32 v121, v121, v123
    v_add_f32 v120, v120, v121
    v_mov_b32 v121, v120
    s_nop 1
    v_permlane16_swap_b32 v121, v120
    v_add_f32 v120, v120, v121
    v_mov_b32 v121, v120
    s_nop 1
    v_permlane32_swap_b32 v121, v120
    v_add_f32 v120, v120, v121
    ds_write_b32 v248, v120 offset:512
    s_waitcnt lgkmcnt(0)
    s_barrier
    ds_read_b128 v[120:123], v247 offset:512
    ds_read_b128 v[124:127], v247 offset:528
    s_waitcnt lgkmcnt(0)
    v_add_f32 v120, v120, v124
    v_add_f32 v121, v121, v125
    v_add_f32 v122, v122, v126
    v_add_f32 v123, v123, v127
    v_add_f32 v120, v120, v122
    v_add_f32 v121, v121, v123
    v_add_f32 v120, v120, v121
    v_mul_f32 v251, 0x3a800000, v120
    v_cvt_pk_bf16_f32 v250, v250, v250
    v_lshlrev_b32 v250, 16, v250
    v_cvt_pk_bf16_f32 v251, v251, v251
    v_lshlrev_b32 v251, 16, v251
    v_add_f32 v251, 0x3727c5ac, v251
    v_cvt_pk_bf16_f32 v251, v251, v251
    v_lshlrev_b32 v251, 16, v251
    v_sqrt_f32 v251, v251
    s_nop 0
    v_cvt_pk_bf16_f32 v251, v251, v251
    v_lshlrev_b32 v251, 16, v251
    v_rcp_f32 v251, v251
    s_nop 0
    s_cmp_lg_u32 s3, 0
    s_cbranch_scc1 ln_nst
    s_lshl_b32 s77, s71, 7
    s_add_u32 s77, s77, 188743680
    v_lshlrev_b32 v249, 3, v245
    s_mov_b64 exec, 0xffff
    buffer_store_dwordx2 v[250:251], v249, s[4:7], s77 offen sc1
    s_mov_b64 exec, -1
ln_nst:
    v_sub_f32 v56, v56, v250
    v_sub_f32 v57, v57, v250
    v_cvt_pk_bf16_f32 v228, v56, v57
    v_lshlrev_b32 v56, 16, v228
    v_and_b32 v57, 0xffff0000, v228
    v_mul_f32 v56, v56, v251
    v_mul_f32 v57, v57, v251
    v_cvt_pk_bf16_f32 v228, v56, v57
    v_sub_f32 v58, v58, v250
    v_sub_f32 v59, v59, v250
    v_cvt_pk_bf16_f32 v229, v58, v59
    v_lshlrev_b32 v58, 16, v229
    v_and_b32 v59, 0xffff0000, v229
    v_mul_f32 v58, v58, v251
    v_mul_f32 v59, v59, v251
    v_cvt_pk_bf16_f32 v229, v58, v59
    v_sub_f32 v60, v60, v250
    v_sub_f32 v61, v61, v250
    v_cvt_pk_bf16_f32 v230, v60, v61
    v_lshlrev_b32 v60, 16, v230
    v_and_b32 v61, 0xffff0000, v230
    v_mul_f32 v60, v60, v251
    v_mul_f32 v61, v61, v251
    v_cvt_pk_bf16_f32 v230, v60, v61
    v_sub_f32 v62, v62, v250
    v_sub_f32 v63, v63, v250
    v_cvt_pk_bf16_f32 v231, v62, v63
    v_lshlrev_b32 v62, 16, v231
    v_and_b32 v63, 0xffff0000, v231
    v_mul_f32 v62, v62, v251
    v_mul_f32 v63, v63, v251
    v_cvt_pk_bf16_f32 v231, v62, v63
    v_cndmask_b32 v120, v228, v230, s[80:81]
    v_cndmask_b32 v121, v229, v231, s[80:81]
    v_cndmask_b32 v122, v230, v228, s[80:81]
    v_cndmask_b32 v123, v231, v229, s[80:81]
    buffer_store_dwordx4 v[120:123], v1, s[4:7], s75 offen offset:0 sc1
    v_sub_f32 v64, v64, v250
    v_sub_f32 v65, v65, v250
    v_cvt_pk_bf16_f32 v232, v64, v65
    v_lshlrev_b32 v64, 16, v232
    v_and_b32 v65, 0xffff0000, v232
    v_mul_f32 v64, v64, v251
    v_mul_f32 v65, v65, v251
    v_cvt_pk_bf16_f32 v232, v64, v65
    v_sub_f32 v66, v66, v250
    v_sub_f32 v67, v67, v250
    v_cvt_pk_bf16_f32 v233, v66, v67
    v_lshlrev_b32 v66, 16, v233
    v_and_b32 v67, 0xffff0000, v233
    v_mul_f32 v66, v66, v251
    v_mul_f32 v67, v67, v251
    v_cvt_pk_bf16_f32 v233, v66, v67
    v_sub_f32 v68, v68, v250
    v_sub_f32 v69, v69, v250
    v_cvt_pk_bf16_f32 v234, v68, v69
    v_lshlrev_b32 v68, 16, v234
    v_and_b32 v69, 0xffff0000, v234
    v_mul_f32 v68, v68, v251
    v_mul_f32 v69, v69, v251
    v_cvt_pk_bf16_f32 v234, v68, v69
    v_sub_f32 v70, v70, v250
    v_sub_f32 v71, v71, v250
    v_cvt_pk_bf16_f32 v235, v70, v71
    v_lshlrev_b32 v70, 16, v235
    v_and_b32 v71, 0xffff0000, v235
    v_mul_f32 v70, v70, v251
    v_mul_f32 v71, v71, v251
    v_cvt_pk_bf16_f32 v235, v70, v71
    v_cndmask_b32 v124, v232, v234, s[80:81]
    v_cndmask_b32 v125, v233, v235, s[80:81]
    v_cndmask_b32 v126, v234, v232, s[80:81]
    v_cndmask_b32 v127, v235, v233, s[80:81]
    buffer_store_dwordx4 v[124:127], v1, s[4:7], s75 offen offset:1024 sc1
    v_sub_f32 v72, v72, v250
    v_sub_f32 v73, v73, v250
    v_cvt_pk_bf16_f32 v236, v72, v73
    v_lshlrev_b32 v72, 16, v236
    v_and_b32 v73, 0xffff0000, v236
    v_mul_f32 v72, v72, v251
    v_mul_f32 v73, v73, v251
    v_cvt_pk_bf16_f32 v236, v72, v73
    v_sub_f32 v74, v74, v250
    v_sub_f32 v75, v75, v250
    v_cvt_pk_bf16_f32 v237, v74, v75
    v_lshlrev_b32 v74, 16, v237
    v_and_b32 v75, 0xffff0000, v237
    v_mul_f32 v74, v74, v251
    v_mul_f32 v75, v75, v251
    v_cvt_pk_bf16_f32 v237, v74, v75
    v_sub_f32 v76, v76, v250
    v_sub_f32 v77, v77, v250
    v_cvt_pk_bf16_f32 v238, v76, v77
    v_lshlrev_b32 v76, 16, v238
    v_and_b32 v77, 0xffff0000, v238
    v_mul_f32 v76, v76, v251
    v_mul_f32 v77, v77, v251
    v_cvt_pk_bf16_f32 v238, v76, v77
    v_sub_f32 v78, v78, v250
    v_sub_f32 v79, v79, v250
    v_cvt_pk_bf16_f32 v239, v78, v79
    v_lshlrev_b32 v78, 16, v239
    v_and_b32 v79, 0xffff0000, v239
    v_mul_f32 v78, v78, v251
    v_mul_f32 v79, v79, v251
    v_cvt_pk_bf16_f32 v239, v78, v79
    v_cndmask_b32 v128, v236, v238, s[80:81]
    v_cndmask_b32 v129, v237, v239, s[80:81]
    v_cndmask_b32 v130, v238, v236, s[80:81]
    v_cndmask_b32 v131, v239, v237, s[80:81]
    buffer_store_dwordx4 v[128:131], v1, s[4:7], s75 offen offset:2048 sc1
    v_sub_f32 v80, v80, v250
    v_sub_f32 v81, v81, v250
    v_cvt_pk_bf16_f32 v240, v80, v81
    v_lshlrev_b32 v80, 16, v240
    v_and_b32 v81, 0xffff0000, v240
    v_mul_f32 v80, v80, v251
    v_mul_f32 v81, v81, v251
    v_cvt_pk_bf16_f32 v240, v80, v81
    v_sub_f32 v82, v82, v250
    v_sub_f32 v83, v83, v250
    v_cvt_pk_bf16_f32 v241, v82, v83
    v_lshlrev_b32 v82, 16, v241
    v_and_b32 v83, 0xffff0000, v241
    v_mul_f32 v82, v82, v251
    v_mul_f32 v83, v83, v251
    v_cvt_pk_bf16_f32 v241, v82, v83
    v_sub_f32 v84, v84, v250
    v_sub_f32 v85, v85, v250
    v_cvt_pk_bf16_f32 v242, v84, v85
    v_lshlrev_b32 v84, 16, v242
    v_and_b32 v85, 0xffff0000, v242
    v_mul_f32 v84, v84, v251
    v_mul_f32 v85, v85, v251
    v_cvt_pk_bf16_f32 v242, v84, v85
    v_sub_f32 v86, v86, v250
    v_sub_f32 v87, v87, v250
    v_cvt_pk_bf16_f32 v243, v86, v87
    v_lshlrev_b32 v86, 16, v243
    v_and_b32 v87, 0xffff0000, v243
    v_mul_f32 v86, v86, v251
    v_mul_f32 v87, v87, v251
    v_cvt_pk_bf16_f32 v243, v86, v87
    v_cndmask_b32 v132, v240, v242, s[80:81]
    v_cndmask_b32 v133, v241, v243, s[80:81]
    v_cndmask_b32 v134, v242, v240, s[80:81]
    v_cndmask_b32 v135, v243, v241, s[80:81]
    buffer_store_dwordx4 v[132:135], v1, s[4:7], s75 offen offset:3072 sc1
    s_cmp_lg_u32 s98, 1
    s_cbranch_scc1 ln_now
    s_mov_b32 s98, 2
    s_branch w_adopt2
ln_now:
    v_mov_b32 v18, 1
    s_waitcnt vmcnt(0)
    s_barrier
    s_cmp_lg_u32 s3, 0
    s_cbranch_scc1 ln_sig
    s_mov_b64 exec, 1
    s_cmp_ge_u32 s71, 32
    s_cbranch_scc1 ln_sb
    buffer_atomic_add v18, off, s[64:67], 0 offset:192 sc1
ln_sb:
    buffer_atomic_add v18, off, s[64:67], 0 offset:0 sc1
    s_mov_b64 exec, -1
ln_sig:
    s_cmp_eq_u32 s98, 4
    s_cselect_b32 s98, 0, s98
    s_cbranch_scc1 w_hook
    s_cmp_lt_u32 s63, 120
    s_cbranch_scc1 prb_done
    s_cmp_lg_u32 s3, 0
    s_cbranch_scc1 prb_bar
    s_sub_u32 s82, s63, 120
    s_lshl_b32 s83, s82, 7
    s_add_u32 s83, s83, 218112000
    s_lshl_b32 s84, s82, 10
    s_add_u32 s84, s84, 209715200
    s_mov_b32 s80, -1
    s_mov_b32 s81, -1
    s_mov_b64 exec, 1
    s_memtime s[74:75]
    s_add_u32 s87, s84, 0
    s_waitcnt lgkmcnt(0)
    buffer_load_dword v20, off, s[4:7], s87 sc1
    s_waitcnt vmcnt(0)
    s_memtime s[76:77]
    s_waitcnt lgkmcnt(0)
    s_sub_u32 s87, s76, s74
    s_min_u32 s80, s80, s87
    s_memtime s[74:75]
    s_add_u32 s87, s84, 8192
    s_waitcnt lgkmcnt(0)
    buffer_load_dword v20, off, s[4:7], s87 sc1
    s_waitcnt vmcnt(0)
    s_memtime s[76:77]
    s_waitcnt lgkmcnt(0)
    s_sub_u32 s87, s76, s74
    s_min_u32 s81, s81, s87
    s_memtime s[74:75]
    s_add_u32 s87, s84, 16384
    s_waitcnt lgkmcnt(0)
    buffer_load_dword v20, off, s[4:7], s87 sc1
    s_waitcnt vmcnt(0)
    s_memtime s[76:77]
    s_waitcnt lgkmcnt(0)
    s_sub_u32 s87, s76, s74
    s_min_u32 s80, s80, s87
    s_memtime s[74:75]
    s_add_u32 s87, s84, 24576
    s_waitcnt lgkmcnt(0)
    buffer_load_dword v20, off, s[4:7], s87 sc1
    s_waitcnt vmcnt(0)
    s_memtime s[76:77]
    s_waitcnt lgkmcnt(0)
    s_sub_u32 s87, s76, s74
    s_min_u32 s81, s81, s87
    s_memtime s[74:75]
    s_add_u32 s87, s84, 32768
    s_waitcnt lgkmcnt(0)
    buffer_load_dword v20, off, s[4:7], s87 sc1
    s_waitcnt vmcnt(0)
    s_memtime s[76:77]
    s_waitcnt lgkmcnt(0)
    s_sub_u32 s87, s76, s74
    s_min_u32 s80, s80, s87
    s_memtime s[74:75]
    s_add_u32 s87, s84, 40960
    s_waitcnt lgkmcnt(0)
    buffer_load_dword v20, off, s[4:7], s87 sc1
    s_waitcnt vmcnt(0)
    s_memtime s[76:77]
    s_waitcnt lgkmcnt(0)
    s_sub_u32 s87, s76, s74
    s_min_u32 s81, s81, s87
    s_memtime s[74:75]
    s_add_u32 s87, s84, 49152
    s_waitcnt lgkmcnt(0)
    buffer_load_dword v20, off, s[4:7], s87 sc1
    s_waitcnt vmcnt(0)
    s_memtime s[76:77]
    s_waitcnt lgkmcnt(0)
    s_sub_u32 s87, s76, s74
    s_min_u32 s80, s80, s87
    s_memtime s[74:75]
    s_add_u32 s87, s84, 57344
    s_waitcnt lgkmcnt(0)
    buffer_load_dword v20, off, s[4:7], s87 sc1
    s_waitcnt vmcnt(0)
    s_memtime s[76:77]
    s_waitcnt lgkmcnt(0)
    s_sub_u32 s87, s76, s74
    s_min_u32 s81, s81, s87
    s_memtime s[74:75]
    s_add_u32 s87, s84, 65536
    s_waitcnt lgkmcnt(0)
    buffer_load_dword v20, off, s[4:7], s87 sc1
    s_waitcnt vmcnt(0)
    s_memtime s[76:77]
    s_waitcnt lgkmcnt(0)
    s_sub_u32 s87, s76, s74
    s_min_u32 s80, s80, s87
    s_memtime s[74:75]
    s_add_u32 s87, s84, 73728
    s_waitcnt lgkmcnt(0)
    buffer_load_dword v20, off, s[4:7], s87 sc1
    s_waitcnt vmcnt(0)
    s_memtime s[76:77]
    s_waitcnt lgkmcnt(0)
    s_sub_u32 s87, s76, s74
    s_min_u32 s81, s81, s87
    s_memtime s[74:75]
    s_add_u32 s87, s84, 81920
    s_waitcnt lgkmcnt(0)
    buffer_load_dword v20, off, s[4:7], s87 sc1
    s_waitcnt vmcnt(0)
    s_memtime s[76:77]
    s_waitcnt lgkmcnt(0)
    s_sub_u32 s87, s76, s74
    s_min_u32 s80, s80, s87
    s_memtime s[74:75]
    s_add_u32 s87, s84, 90112
    s_waitcnt lgkmcnt(0)
    buffer_load_dword v20, off, s[4:7], s87 sc1
    s_waitcnt vmcnt(0)
    s_memtime s[76:77]
    s_waitcnt lgkmcnt(0)
    s_sub_u32 s87, s76, s74
    s_min_u32 s81, s81, s87
    s_sub_i32 s85, s80, s81
    s_min_i32 s85, s85, 400
    s_max_i32 s85, s85, -400
    s_lshl_b32 s85, s85, 8
    s_getreg_b32 s86, hwreg(HW_REG_XCC_ID)
    s_bfe_u32 s86, s86, 0x10002
    s_lshl_b32 s86, s86, 1
    s_or_b32 s85, s85, s86
    s_or_b32 s85, s85, 1
    s_mov_b32 s86, 65536
prb_i:
    buffer_load_dword v20, off, s[64:67], 0 offset:192 sc1
    s_waitcnt vmcnt(0)
    v_readfirstlane_b32 s84, v20
    s_cmp_ge_u32 s84, 32
    s_cbranch_scc1 prb_i_ok
    s_sleep 8
    s_sub_u32 s86, s86, 1
    s_cbranch_scc0 prb_i
prb_i_ok:
    v_mov_b32 v20, s85
    buffer_store_dword v20, off, s[4:7], s83 offset:8 sc1
    s_mov_b64 exec, -1
prb_bar:
    s_barrier
prb_done:
    s_cmp_lt_u32 s32, 4
    s_cbranch_scc1 w_nopre
    s_load_dwordx2 s[8:9], s[0:1], s33
    s_load_dwordx2 s[12:13], s[0:1], s34
    s_mov_b32 s10, s38
    s_mov_b32 s14, s38
    s_cmp_ge_u32 s32, 4
    s_cselect_b32 s31, 0, 1
    s_lshl_b32 s30, s3, s31
    s_mul_i32 s30, s30, s40
    s_add_u32 s16, s39, s30
    s_cmp_eq_u32 s32, 4
    s_cselect_b32 s30, 1024, s40
    s_cselect_b32 s31, 6, 5
    s_lshl_b32 s62, 32, s31
    s_add_u32 s17, s16, s30
    s_lshl_b32 s30, s3, 2
    s_mul_i32 s30, s30, s35
    s_add_u32 s18, s36, s30
    s_add_u32 s19, s37, s30
    s_lshl_b32 s20, s35, s31
    v_mul_u32_u24 v2, s35, v4
    v_add_u32 v2, v2, v3
    s_waitcnt lgkmcnt(0)
    s_add_u32 m0, s22, 0
    s_nop 0
    buffer_load_dwordx4 v2, s[8:11], s18 offen lds
    s_add_u32 s18, s18, s20
    s_add_u32 m0, s22, 8192
    s_nop 0
    buffer_load_dwordx4 v2, s[12:15], s19 offen lds
    s_add_u32 s19, s19, s20
    s_add_u32 m0, s22, 32768
    s_nop 0
    buffer_load_dwordx4 v2, s[8:11], s18 offen lds
    s_add_u32 s18, s18, s20
    s_add_u32 m0, s22, 40960
    s_nop 0
    buffer_load_dwordx4 v2, s[12:15], s19 offen lds
    s_add_u32 s19, s19, s20
    s_add_u32 m0, s22, 65536
    s_nop 0
    buffer_load_dwordx4 v2, s[8:11], s18 offen lds
    s_add_u32 s18, s18, s20
    s_add_u32 m0, s22, 73728
    s_nop 0
    buffer_load_dwordx4 v2, s[12:15], s19 offen lds
    s_add_u32 s19, s19, s20
    s_add_u32 m0, s22, 98304
    s_nop 0
    buffer_load_dwordx4 v2, s[8:11], s18 offen lds
    s_add_u32 s18, s18, s20
    s_add_u32 m0, s22, 106496
    s_nop 0
    buffer_load_dwordx4 v2, s[12:15], s19 offen lds
    s_add_u32 s19, s19, s20
    s_mov_b32 s70, 1
    s_cmp_lt_u32 s39, 1048576
    s_cselect_b32 s70, s70, 0
    s_cmp_lg_u32 s3, 0
    s_cbranch_scc1 lnwp_ok
    s_cmp_eq_u32 s70, 0
    s_cbranch_scc1 lnwp_full
    s_mov_b32 s69, 65536
lnwap:
    buffer_load_dword v20, off, s[64:67], 0 offset:192 sc1
    s_waitcnt vmcnt(0)
    v_readfirstlane_b32 s68, v20
    s_cmp_ge_u32 s68, 32
    s_cbranch_scc1 lnwap_ok
    s_sleep 8
    s_sub_u32 s69, s69, 1
    s_cbranch_scc0 lnwap
lnwap_ok:
    s_branch lnwp_ok
lnwp_full:
    s_mov_b32 s69, 65536
lnwp:
    buffer_load_dword v20, off, s[64:67], 0 offset:0 sc1
    s_waitcnt vmcnt(0)
    v_readfirstlane_b32 s68, v20
    s_cmp_ge_u32 s68, 128
    s_cbranch_scc1 lnwp_ok
    s_sleep 8
    s_sub_u32 s69, s69, 1
    s_cbranch_scc0 lnwp
lnwp_ok:
    s_barrier
    s_add_u32 m0, s21, 0
    s_nop 0
    buffer_load_dwordx4 v1, s[4:7], s16 offen sc1 lds
    s_add_u32 s16, s16, s62
    s_add_u32 m0, s21, 1024
    s_nop 0
    buffer_load_dwordx4 v1, s[4:7], s17 offen sc1 lds
    s_add_u32 s17, s17, s62
    s_add_u32 m0, s21, 32768
    s_nop 0
    buffer_load_dwordx4 v1, s[4:7], s16 offen sc1 lds
    s_add_u32 s16, s16, s62
    s_add_u32 m0, s21, 33792
    s_nop 0
    buffer_load_dwordx4 v1, s[4:7], s17 offen sc1 lds
    s_add_u32 s17, s17, s62
    s_add_u32 m0, s21, 65536
    s_nop 0
    buffer_load_dwordx4 v1, s[4:7], s16 offen sc1 lds
    s_add_u32 s16, s16, s62
    s_add_u32 m0, s21, 66560
    s_nop 0
    buffer_load_dwordx4 v1, s[4:7], s17 offen sc1 lds
    s_add_u32 s17, s17, s62
    s_add_u32 m0, s21, 98304
    s_nop 0
    buffer_load_dwordx4 v1, s[4:7], s16 offen sc1 lds
    s_add_u32 s16, s16, s62
    s_add_u32 m0, s21, 99328
    s_nop 0
    buffer_load_dwordx4 v1, s[4:7], s17 offen sc1 lds
    s_add_u32 s17, s17, s62
    s_branch w_adopt
w_nopre:
    s_mov_b32 s70, 1
    s_cmp_lt_u32 s39, 1048576
    s_cselect_b32 s70, s70, 0
    s_cmp_lg_u32 s3, 0
    s_cbranch_scc1 lnw_ok
    s_cmp_eq_u32 s70, 0
    s_cbranch_scc1 lnw_full
    s_mov_b32 s69, 65536
lnwa:
    buffer_load_dword v20, off, s[64:67], 0 offset:192 sc1
    s_waitcnt vmcnt(0)
    v_readfirstlane_b32 s68, v20
    s_cmp_ge_u32 s68, 32
    s_cbranch_scc1 lnwa_ok
    s_sleep 8
    s_sub_u32 s69, s69, 1
    s_cbranch_scc0 lnwa
lnwa_ok:
    s_branch lnw_ok
lnw_full:
    s_mov_b32 s69, 65536
lnw:
    buffer_load_dword v20, off, s[64:67], 0 offset:0 sc1
    s_waitcnt vmcnt(0)
    v_readfirstlane_b32 s68, v20
    s_cmp_ge_u32 s68, 128
    s_cbranch_scc1 lnw_ok
    s_sleep 8
    s_sub_u32 s69, s69, 1
    s_cbranch_scc0 lnw
lnw_ok:
    s_barrier
w_cold:
    s_cmp_eq_u32 s32, 0
    s_cbranch_scc1 fin_entry
    s_cmp_lg_u32 s3, 0
    s_cbranch_scc1 w_depok
    s_cmp_eq_u32 s45, 0
    s_cbranch_scc1 w_depok
    s_mov_b32 s31, 0x40000
w_waitdep:
    buffer_load_dword v16, v17, s[4:7], s44 offen sc1
    s_waitcnt vmcnt(0)
    v_readfirstlane_b32 s30, v16
    s_cmp_ge_u32 s30, s45
    s_cbranch_scc1 w_depok
    s_sleep 16
    s_sub_u32 s31, s31, 1
    s_cbranch_scc0 w_waitdep
w_depok:
    s_load_dwordx2 s[8:9], s[0:1], s33
    s_load_dwordx2 s[12:13], s[0:1], s34
    s_mov_b32 s10, s38
    s_mov_b32 s14, s38
    s_cmp_ge_u32 s32, 4
    s_cselect_b32 s31, 0, 1
    s_lshl_b32 s30, s3, s31
    s_mul_i32 s30, s30, s40
    s_add_u32 s16, s39, s30
    s_cmp_eq_u32 s32, 4
    s_cselect_b32 s30, 1024, s40
    s_cselect_b32 s31, 6, 5
    s_lshl_b32 s62, 32, s31
    s_add_u32 s17, s16, s30
    s_lshl_b32 s30, s3, 2
    s_mul_i32 s30, s30, s35
    s_add_u32 s18, s36, s30
    s_add_u32 s19, s37, s30
    s_lshl_b32 s20, s35, s31
    v_mul_u32_u24 v2, s35, v4
    v_add_u32 v2, v2, v3
    s_waitcnt lgkmcnt(0)
    s_barrier
    s_add_u32 m0, s21, 0
    s_nop 0
    buffer_load_dwordx4 v1, s[4:7], s16 offen sc1 lds
    s_add_u32 s16, s16, s62
    s_add_u32 m0, s21, 1024
    s_nop 0
    buffer_load_dwordx4 v1, s[4:7], s17 offen sc1 lds
    s_add_u32 s17, s17, s62
    s_add_u32 m0, s22, 0
    s_nop 0
    buffer_load_dwordx4 v2, s[8:11], s18 offen lds
    s_add_u32 s18, s18, s20
    s_add_u32 m0, s22, 8192
    s_nop 0
    buffer_load_dwordx4 v2, s[12:15], s19 offen lds
    s_add_u32 s19, s19, s20
    s_add_u32 m0, s21, 32768
    s_nop 0
    buffer_load_dwordx4 v1, s[4:7], s16 offen sc1 lds
    s_add_u32 s16, s16, s62
    s_add_u32 m0, s21, 33792
    s_nop 0
    buffer_load_dwordx4 v1, s[4:7], s17 offen sc1 lds
    s_add_u32 s17, s17, s62
    s_add_u32 m0, s22, 32768
    s_nop 0
    buffer_load_dwordx4 v2, s[8:11], s18 offen lds
    s_add_u32 s18, s18, s20
    s_add_u32 m0, s22, 40960
    s_nop 0
    buffer_load_dwordx4 v2, s[12:15], s19 offen lds
    s_add_u32 s19, s19, s20
    s_add_u32 m0, s21, 65536
    s_nop 0
    buffer_load_dwordx4 v1, s[4:7], s16 offen sc1 lds
    s_add_u32 s16, s16, s62
    s_add_u32 m0, s21, 66560
    s_nop 0
    buffer_load_dwordx4 v1, s[4:7], s17 offen sc1 lds
    s_add_u32 s17, s17, s62
    s_add_u32 m0, s22, 65536
    s_nop 0
    buffer_load_dwordx4 v2, s[8:11], s18 offen lds
    s_add_u32 s18, s18, s20
    s_add_u32 m0, s22, 73728
    s_nop 0
    buffer_load_dwordx4 v2, s[12:15], s19 offen lds
    s_add_u32 s19, s19, s20
    s_add_u32 m0, s21, 98304
    s_nop 0
    buffer_load_dwordx4 v1, s[4:7], s16 offen sc1 lds
    s_add_u32 s16, s16, s62
    s_add_u32 m0, s21, 99328
    s_nop 0
    buffer_load_dwordx4 v1, s[4:7], s17 offen sc1 lds
    s_add_u32 s17, s17, s62
    s_add_u32 m0, s22, 98304
    s_nop 0
    buffer_load_dwordx4 v2, s[8:11], s18 offen lds
    s_add_u32 s18, s18, s20
    s_add_u32 m0, s22, 106496
    s_nop 0
    buffer_load_dwordx4 v2, s[12:15], s19 offen lds
    s_add_u32 s19, s19, s20
w_adopt:
    s_cmp_eq_u32 s98, 1
    s_cbranch_scc1 ln_entry
w_adopt2:
    s_mov_b32 s48, s32
    s_cmp_ge_u32 s32, 4
    s_cselect_b32 s30, 2, 3
    s_lshl_b32 s30, s26, s30
    s_mul_i32 s30, s30, s43
    s_add_u32 s49, s42, s30
    s_mov_b32 s50, s43
    s_mov_b32 s51, s46
    s_mov_b32 s23, s41
    s_mov_b32 s53, s47
    s_nop 0
    s_load_dwordx16 s[32:47], s[24:25], 0
    s_add_u32 s24, s24, 64
    s_addc_u32 s25, s25, 0
    s_cmp_eq_u32 s48, 6
    s_cbranch_scc1 w_firstX
    s_waitcnt vmcnt(0)
    s_barrier
    s_cmp_lg_u32 s98, 2
    s_cbranch_scc1 lls_done
    s_mov_b32 s98, 0
    s_cmp_lg_u32 s3, 0
    s_cbranch_scc1 lls_done
    v_mov_b32 v20, 1
    s_mov_b64 exec, 1
    buffer_atomic_add v20, off, s[64:67], 0 offset:0 sc1
    s_mov_b64 exec, -1
lls_done:
    ds_read_b64_tr_b16 v[64:65], v8 offset:16384
    ds_read_b64_tr_b16 v[66:67], v9 offset:16384
    ds_read_b64_tr_b16 v[68:69], v10 offset:16384
    ds_read_b64_tr_b16 v[70:71], v11 offset:16384
    ds_read_b64_tr_b16 v[72:73], v8 offset:24576
    ds_read_b64_tr_b16 v[74:75], v9 offset:24576
    ds_read_b64_tr_b16 v[76:77], v10 offset:24576
    ds_read_b64_tr_b16 v[78:79], v11 offset:24576
    ds_read_b128 v[32:35], v5 offset:0
    ds_read_b128 v[36:39], v5 offset:1024
    ds_read_b128 v[40:43], v5 offset:2048
    ds_read_b128 v[44:47], v5 offset:3072
    ds_read_b128 v[48:51], v5 offset:4096
    ds_read_b128 v[52:55], v5 offset:5120
    ds_read_b128 v[56:59], v5 offset:6144
    ds_read_b128 v[60:63], v5 offset:7168
    s_waitcnt lgkmcnt(0)
    s_cmp_eq_u32 s48, 4
    s_cbranch_scc1 w_firstH
    s_cmp_eq_u32 s48, 5
    s_cbranch_scc1 w_firstM
    s_branch w_first16
w_first4:
    s_waitcnt vmcnt(12)
    s_barrier
    v_mfma_f32_16x16x32_bf16 v[128:131], v[64:67], v[32:35], 0
    ds_read_b64_tr_b16 v[112:113], v8 offset:49152
    v_mfma_f32_16x16x32_bf16 v[132:135], v[68:71], v[32:35], 0
    ds_read_b64_tr_b16 v[114:115], v9 offset:49152
    v_mfma_f32_16x16x32_bf16 v[136:139], v[72:75], v[32:35], 0
    ds_read_b64_tr_b16 v[116:117], v10 offset:49152
    v_mfma_f32_16x16x32_bf16 v[140:143], v[76:79], v[32:35], 0
    ds_read_b64_tr_b16 v[118:119], v11 offset:49152
    v_mfma_f32_16x16x32_bf16 v[144:147], v[64:67], v[36:39], 0
    ds_read_b64_tr_b16 v[120:121], v8 offset:57344
    v_mfma_f32_16x16x32_bf16 v[148:151], v[68:71], v[36:39], 0
    ds_read_b64_tr_b16 v[122:123], v9 offset:57344
    v_mfma_f32_16x16x32_bf16 v[152:155], v[72:75], v[36:39], 0
    ds_read_b64_tr_b16 v[124:125], v10 offset:57344
    v_mfma_f32_16x16x32_bf16 v[156:159], v[76:79], v[36:39], 0
    ds_read_b64_tr_b16 v[126:127], v11 offset:57344
    v_mfma_f32_16x16x32_bf16 v[160:163], v[64:67], v[40:43], 0
    ds_read_b128 v[80:83], v5 offset:32768
    v_mfma_f32_16x16x32_bf16 v[164:167], v[68:71], v[40:43], 0
    ds_read_b128 v[84:87], v5 offset:33792
    v_mfma_f32_16x16x32_bf16 v[168:171], v[72:75], v[40:43], 0
    ds_read_b128 v[88:91], v5 offset:34816
    v_mfma_f32_16x16x32_bf16 v[172:175], v[76:79], v[40:43], 0
    ds_read_b128 v[92:95], v5 offset:35840
    v_mfma_f32_16x16x32_bf16 v[176:179], v[64:67], v[44:47], 0
    ds_read_b128 v[96:99], v5 offset:36864
    v_mfma_f32_16x16x32_bf16 v[180:183], v[68:71], v[44:47], 0
    ds_read_b128 v[100:103], v5 offset:37888
    v_mfma_f32_16x16x32_bf16 v[184:187], v[72:75], v[44:47], 0
    ds_read_b128 v[104:107], v5 offset:38912
    v_mfma_f32_16x16x32_bf16 v[188:191], v[76:79], v[44:47], 0
    ds_read_b128 v[108:111], v5 offset:39936
    v_mfma_f32_16x16x32_bf16 v[192:195], v[64:67], v[48:51], 0
    v_mfma_f32_16x16x32_bf16 v[196:199], v[68:71], v[48:51], 0
    s_add_u32 m0, s21, 0
    s_nop 0
    buffer_load_dwordx4 v1, s[4:7], s16 offen sc1 lds
    s_add_u32 s16, s16, s62
    v_mfma_f32_16x16x32_bf16 v[200:203], v[72:75], v[48:51], 0
    v_mfma_f32_16x16x32_bf16 v[204:207], v[76:79], v[48:51], 0
    v_mfma_f32_16x16x32_bf16 v[208:211], v[64:67], v[52:55], 0
    s_add_u32 m0, s21, 1024
    s_nop 0
    buffer_load_dwordx4 v1, s[4:7], s17 offen sc1 lds
    s_add_u32 s17, s17, s62
    v_mfma_f32_16x16x32_bf16 v[212:215], v[68:71], v[52:55], 0
    v_mfma_f32_16x16x32_bf16 v[216:219], v[72:75], v[52:55], 0
    v_mfma_f32_16x16x32_bf16 v[220:223], v[76:79], v[52:55], 0
    s_add_u32 m0, s22, 0
    s_nop 0
    buffer_load_dwordx4 v2, s[8:11], s18 offen lds
    s_add_u32 s18, s18, s20
    v_mfma_f32_16x16x32_bf16 v[224:227], v[64:67], v[56:59], 0
    v_mfma_f32_16x16x32_bf16 v[228:231], v[68:71], v[56:59], 0
    v_mfma_f32_16x16x32_bf16 v[232:235], v[72:75], v[56:59], 0
    s_add_u32 m0, s22, 8192
    s_nop 0
    buffer_load_dwordx4 v2, s[12:15], s19 offen lds
    s_add_u32 s19, s19, s20
    v_mfma_f32_16x16x32_bf16 v[236:239], v[76:79], v[56:59], 0
    v_mfma_f32_16x16x32_bf16 v[240:243], v[64:67], v[60:63], 0
    v_mfma_f32_16x16x32_bf16 v[244:247], v[68:71], v[60:63], 0
    v_mfma_f32_16x16x32_bf16 v[248:251], v[72:75], v[60:63], 0
    v_mfma_f32_16x16x32_bf16 v[252:255], v[76:79], v[60:63], 0
    s_waitcnt lgkmcnt(0)
    s_waitcnt vmcnt(12)
    s_barrier
    v_mfma_f32_16x16x32_bf16 v[128:131], v[112:115], v[80:83], v[128:131]
    ds_read_b64_tr_b16 v[64:65], v12 offset:16384
    v_mfma_f32_16x16x32_bf16 v[132:135], v[116:119], v[80:83], v[132:135]
    ds_read_b64_tr_b16 v[66:67], v13 offset:16384
    v_mfma_f32_16x16x32_bf16 v[136:139], v[120:123], v[80:83], v[136:139]
    ds_read_b64_tr_b16 v[68:69], v14 offset:16384
    v_mfma_f32_16x16x32_bf16 v[140:143], v[124:127], v[80:83], v[140:143]
    ds_read_b64_tr_b16 v[70:71], v15 offset:16384
    v_mfma_f32_16x16x32_bf16 v[144:147], v[112:115], v[84:87], v[144:147]
    ds_read_b64_tr_b16 v[72:73], v12 offset:24576
    v_mfma_f32_16x16x32_bf16 v[148:151], v[116:119], v[84:87], v[148:151]
    ds_read_b64_tr_b16 v[74:75], v13 offset:24576
    v_mfma_f32_16x16x32_bf16 v[152:155], v[120:123], v[84:87], v[152:155]
    ds_read_b64_tr_b16 v[76:77], v14 offset:24576
    v_mfma_f32_16x16x32_bf16 v[156:159], v[124:127], v[84:87], v[156:159]
    ds_read_b64_tr_b16 v[78:79], v15 offset:24576
    v_mfma_f32_16x16x32_bf16 v[160:163], v[112:115], v[88:91], v[160:163]
    ds_read_b128 v[32:35], v6 offset:0
    v_mfma_f32_16x16x32_bf16 v[164:167], v[116:119], v[88:91], v[164:167]
    ds_read_b128 v[36:39], v6 offset:1024
    v_mfma_f32_16x16x32_bf16 v[168:171], v[120:123], v[88:91], v[168:171]
    ds_read_b128 v[40:43], v6 offset:2048
    v_mfma_f32_16x16x32_bf16 v[172:175], v[124:127], v[88:91], v[172:175]
    ds_read_b128 v[44:47], v6 offset:3072
    v_mfma_f32_16x16x32_bf16 v[176:179], v[112:115], v[92:95], v[176:179]
    ds_read_b128 v[48:51], v6 offset:4096
    v_mfma_f32_16x16x32_bf16 v[180:183], v[116:119], v[92:95], v[180:183]
    ds_read_b128 v[52:55], v6 offset:5120
    v_mfma_f32_16x16x32_bf16 v[184:187], v[120:123], v[92:95], v[184:187]
    ds_read_b128 v[56:59], v6 offset:6144
    v_mfma_f32_16x16x32_bf16 v[188:191], v[124:127], v[92:95], v[188:191]
    ds_read_b128 v[60:63], v6 offset:7168
    v_mfma_f32_16x16x32_bf16 v[192:195], v[112:115], v[96:99], v[192:195]
    v_mfma_f32_16x16x32_bf16 v[196:199], v[116:119], v[96:99], v[196:199]
    s_add_u32 m0, s21, 32768
    s_nop 0
    buffer_load_dwordx4 v1, s[4:7], s16 offen sc1 lds
    s_add_u32 s16, s16, s62
    v_mfma_f32_16x16x32_bf16 v[200:203], v[120:123], v[96:99], v[200:203]
    v_mfma_f32_16x16x32_bf16 v[204:207], v[124:127], v[96:99], v[204:207]
    v_mfma_f32_16x16x32_bf16 v[208:211], v[112:115], v[100:103], v[208:211]
    s_add_u32 m0, s21, 33792
    s_nop 0
    buffer_load_dwordx4 v1, s[4:7], s17 offen sc1 lds
    s_add_u32 s17, s17, s62
    v_mfma_f32_16x16x32_bf16 v[212:215], v[116:119], v[100:103], v[212:215]
    v_mfma_f32_16x16x32_bf16 v[216:219], v[120:123], v[100:103], v[216:219]
    v_mfma_f32_16x16x32_bf16 v[220:223], v[124:127], v[100:103], v[220:223]
    s_add_u32 m0, s22, 32768
    s_nop 0
    buffer_load_dwordx4 v2, s[8:11], s18 offen lds
    s_add_u32 s18, s18, s20
    v_mfma_f32_16x16x32_bf16 v[224:227], v[112:115], v[104:107], v[224:227]
    v_mfma_f32_16x16x32_bf16 v[228:231], v[116:119], v[104:107], v[228:231]
    v_mfma_f32_16x16x32_bf16 v[232:235], v[120:123], v[104:107], v[232:235]
    s_add_u32 m0, s22, 40960
    s_nop 0
    buffer_load_dwordx4 v2, s[12:15], s19 offen lds
    s_add_u32 s19, s19, s20
    v_mfma_f32_16x16x32_bf16 v[236:239], v[124:127], v[104:107], v[236:239]
    v_mfma_f32_16x16x32_bf16 v[240:243], v[112:115], v[108:111], v[240:243]
    v_mfma_f32_16x16x32_bf16 v[244:247], v[116:119], v[108:111], v[244:247]
    v_mfma_f32_16x16x32_bf16 v[248:251], v[120:123], v[108:111], v[248:251]
    v_mfma_f32_16x16x32_bf16 v[252:255], v[124:127], v[108:111], v[252:255]
    s_waitcnt lgkmcnt(0)
    s_waitcnt vmcnt(12)
    s_barrier
    v_mfma_f32_16x16x32_bf16 v[128:131], v[64:67], v[32:35], v[128:131]
    ds_read_b64_tr_b16 v[112:113], v12 offset:49152
    v_mfma_f32_16x16x32_bf16 v[132:135], v[68:71], v[32:35], v[132:135]
    ds_read_b64_tr_b16 v[114:115], v13 offset:49152
    v_mfma_f32_16x16x32_bf16 v[136:139], v[72:75], v[32:35], v[136:139]
    ds_read_b64_tr_b16 v[116:117], v14 offset:49152
    v_mfma_f32_16x16x32_bf16 v[140:143], v[76:79], v[32:35], v[140:143]
    ds_read_b64_tr_b16 v[118:119], v15 offset:49152
    v_mfma_f32_16x16x32_bf16 v[144:147], v[64:67], v[36:39], v[144:147]
    ds_read_b64_tr_b16 v[120:121], v12 offset:57344
    v_mfma_f32_16x16x32_bf16 v[148:151], v[68:71], v[36:39], v[148:151]
    ds_read_b64_tr_b16 v[122:123], v13 offset:57344
    v_mfma_f32_16x16x32_bf16 v[152:155], v[72:75], v[36:39], v[152:155]
    ds_read_b64_tr_b16 v[124:125], v14 offset:57344
    v_mfma_f32_16x16x32_bf16 v[156:159], v[76:79], v[36:39], v[156:159]
    ds_read_b64_tr_b16 v[126:127], v15 offset:57344
    v_mfma_f32_16x16x32_bf16 v[160:163], v[64:67], v[40:43], v[160:163]
    ds_read_b128 v[80:83], v6 offset:32768
    v_mfma_f32_16x16x32_bf16 v[164:167], v[68:71], v[40:43], v[164:167]
    ds_read_b128 v[84:87], v6 offset:33792
    v_mfma_f32_16x16x32_bf16 v[168:171], v[72:75], v[40:43], v[168:171]
    ds_read_b128 v[88:91], v6 offset:34816
    v_mfma_f32_16x16x32_bf16 v[172:175], v[76:79], v[40:43], v[172:175]
    ds_read_b128 v[92:95], v6 offset:35840
    v_mfma_f32_16x16x32_bf16 v[176:179], v[64:67], v[44:47], v[176:179]
    ds_read_b128 v[96:99], v6 offset:36864
    v_mfma_f32_16x16x32_bf16 v[180:183], v[68:71], v[44:47], v[180:183]
    ds_read_b128 v[100:103], v6 offset:37888
    v_mfma_f32_16x16x32_bf16 v[184:187], v[72:75], v[44:47], v[184:187]
    ds_read_b128 v[104:107], v6 offset:38912
    v_mfma_f32_16x16x32_bf16 v[188:191], v[76:79], v[44:47], v[188:191]
    ds_read_b128 v[108:111], v6 offset:39936
    v_mfma_f32_16x16x32_bf16 v[192:195], v[64:67], v[48:51], v[192:195]
    v_mfma_f32_16x16x32_bf16 v[196:199], v[68:71], v[48:51], v[196:199]
    s_add_u32 m0, s21, 65536
    s_nop 0
    buffer_load_dwordx4 v1, s[4:7], s16 offen sc1 lds
    s_add_u32 s16, s16, s62
    v_mfma_f32_16x16x32_bf16 v[200:203], v[72:75], v[48:51], v[200:203]
    v_mfma_f32_16x16x32_bf16 v[204:207], v[76:79], v[48:51], v[204:207]
    v_mfma_f32_16x16x32_bf16 v[208:211], v[64:67], v[52:55], v[208:211]
    s_add_u32 m0, s21, 66560
    s_nop 0
    buffer_load_dwordx4 v1, s[4:7], s17 offen sc1 lds
    s_add_u32 s17, s17, s62
    v_mfma_f32_16x16x32_bf16 v[212:215], v[68:71], v[52:55], v[212:215]
    v_mfma_f32_16x16x32_bf16 v[216:219], v[72:75], v[52:55], v[216:219]
    v_mfma_f32_16x16x32_bf16 v[220:223], v[76:79], v[52:55], v[220:223]
    s_add_u32 m0, s22, 65536
    s_nop 0
    buffer_load_dwordx4 v2, s[8:11], s18 offen lds
    s_add_u32 s18, s18, s20
    v_mfma_f32_16x16x32_bf16 v[224:227], v[64:67], v[56:59], v[224:227]
    v_mfma_f32_16x16x32_bf16 v[228:231], v[68:71], v[56:59], v[228:231]
    v_mfma_f32_16x16x32_bf16 v[232:235], v[72:75], v[56:59], v[232:235]
    s_add_u32 m0, s22, 73728
    s_nop 0
    buffer_load_dwordx4 v2, s[12:15], s19 offen lds
    s_add_u32 s19, s19, s20
    v_mfma_f32_16x16x32_bf16 v[236:239], v[76:79], v[56:59], v[236:239]
    v_mfma_f32_16x16x32_bf16 v[240:243], v[64:67], v[60:63], v[240:243]
    v_mfma_f32_16x16x32_bf16 v[244:247], v[68:71], v[60:63], v[244:247]
    v_mfma_f32_16x16x32_bf16 v[248:251], v[72:75], v[60:63], v[248:251]
    v_mfma_f32_16x16x32_bf16 v[252:255], v[76:79], v[60:63], v[252:255]
    s_waitcnt lgkmcnt(0)
    s_waitcnt vmcnt(8)
    s_barrier
    s_cmp_eq_u32 s28, 0
    s_cbranch_scc1 sig_2
    s_cmp_lg_u32 s3, 0
    s_cbranch_scc1 sig_2
    s_mov_b64 exec, 1
    v_mov_b32 v18, s57
    buffer_atomic_add v18, v17, s[4:7], s28 offen sc1
    s_mov_b64 exec, -1
sig_2:
    s_mov_b32 s28, 0
    v_mfma_f32_16x16x32_bf16 v[128:131], v[112:115], v[80:83], v[128:131]
    ds_read_b64_tr_b16 v[64:65], v8 offset:16384
    v_mfma_f32_16x16x32_bf16 v[132:135], v[116:119], v[80:83], v[132:135]
    ds_read_b64_tr_b16 v[66:67], v9 offset:16384
    v_mfma_f32_16x16x32_bf16 v[136:139], v[120:123], v[80:83], v[136:139]
    ds_read_b64_tr_b16 v[68:69], v10 offset:16384
    v_mfma_f32_16x16x32_bf16 v[140:143], v[124:127], v[80:83], v[140:143]
    ds_read_b64_tr_b16 v[70:71], v11 offset:16384
    v_mfma_f32_16x16x32_bf16 v[144:147], v[112:115], v[84:87], v[144:147]
    ds_read_b64_tr_b16 v[72:73], v8 offset:24576
    v_mfma_f32_16x16x32_bf16 v[148:151], v[116:119], v[84:87], v[148:151]
    ds_read_b64_tr_b16 v[74:75], v9 offset:24576
    v_mfma_f32_16x16x32_bf16 v[152:155], v[120:123], v[84:87], v[152:155]
    ds_read_b64_tr_b16 v[76:77], v10 offset:24576
    v_mfma_f32_16x16x32_bf16 v[156:159], v[124:127], v[84:87], v[156:159]
    ds_read_b64_tr_b16 v[78:79], v11 offset:24576
    v_mfma_f32_16x16x32_bf16 v[160:163], v[112:115], v[88:91], v[160:163]
    ds_read_b128 v[32:35], v5 offset:0
    v_mfma_f32_16x16x32_bf16 v[164:167], v[116:119], v[88:91], v[164:167]
    ds_read_b128 v[36:39], v5 offset:1024
    v_mfma_f32_16x16x32_bf16 v[168:171], v[120:123], v[88:91], v[168:171]
    ds_read_b128 v[40:43], v5 offset:2048
    v_mfma_f32_16x16x32_bf16 v[172:175], v[124:127], v[88:91], v[172:175]
    ds_read_b128 v[44:47], v5 offset:3072
    v_mfma_f32_16x16x32_bf16 v[176:179], v[112:115], v[92:95], v[176:179]
    ds_read_b128 v[48:51], v5 offset:4096
    v_mfma_f32_16x16x32_bf16 v[180:183], v[116:119], v[92:95], v[180:183]
    ds_read_b128 v[52:55], v5 offset:5120
    v_mfma_f32_16x16x32_bf16 v[184:187], v[120:123], v[92:95], v[184:187]
    ds_read_b128 v[56:59], v5 offset:6144
    v_mfma_f32_16x16x32_bf16 v[188:191], v[124:127], v[92:95], v[188:191]
    ds_read_b128 v[60:63], v5 offset:7168
    v_mfma_f32_16x16x32_bf16 v[192:195], v[112:115], v[96:99], v[192:195]
    v_mfma_f32_16x16x32_bf16 v[196:199], v[116:119], v[96:99], v[196:199]
    s_add_u32 m0, s21, 98304
    s_nop 0
    buffer_load_dwordx4 v1, s[4:7], s16 offen sc1 lds
    s_add_u32 s16, s16, s62
    v_mfma_f32_16x16x32_bf16 v[200:203], v[120:123], v[96:99], v[200:203]
    v_mfma_f32_16x16x32_bf16 v[204:207], v[124:127], v[96:99], v[204:207]
    v_mfma_f32_16x16x32_bf16 v[208:211], v[112:115], v[100:103], v[208:211]
    s_add_u32 m0, s21, 99328
    s_nop 0
    buffer_load_dwordx4 v1, s[4:7], s17 offen sc1 lds
    s_add_u32 s17, s17, s62
    v_mfma_f32_16x16x32_bf16 v[212:215], v[116:119], v[100:103], v[212:215]
    v_mfma_f32_16x16x32_bf16 v[216:219], v[120:123], v[100:103], v[216:219]
    v_mfma_f32_16x16x32_bf16 v[220:223], v[124:127], v[100:103], v[220:223]
    s_add_u32 m0, s22, 98304
    s_nop 0
    buffer_load_dwordx4 v2, s[8:11], s18 offen lds
    s_add_u32 s18, s18, s20
    v_mfma_f32_16x16x32_bf16 v[224:227], v[112:115], v[104:107], v[224:227]
    v_mfma_f32_16x16x32_bf16 v[228:231], v[116:119], v[104:107], v[228:231]
    v_mfma_f32_16x16x32_bf16 v[232:235], v[120:123], v[104:107], v[232:235]
    s_add_u32 m0, s22, 106496
    s_nop 0
    buffer_load_dwordx4 v2, s[12:15], s19 offen lds
    s_add_u32 s19, s19, s20
    v_mfma_f32_16x16x32_bf16 v[236:239], v[124:127], v[104:107], v[236:239]
    v_mfma_f32_16x16x32_bf16 v[240:243], v[112:115], v[108:111], v[240:243]
    v_mfma_f32_16x16x32_bf16 v[244:247], v[116:119], v[108:111], v[244:247]
    v_mfma_f32_16x16x32_bf16 v[248:251], v[120:123], v[108:111], v[248:251]
    v_mfma_f32_16x16x32_bf16 v[252:255], v[124:127], v[108:111], v[252:255]
    s_waitcnt lgkmcnt(0)
    s_branch w_loop_chk
w_first8:
    s_waitcnt vmcnt(16)
    s_barrier
    v_mfma_f32_16x16x32_bf16 v[128:131], v[64:67], v[32:35], 0
    ds_read_b64_tr_b16 v[112:113], v8 offset:49152
    v_mfma_f32_16x16x32_bf16 v[132:135], v[68:71], v[32:35], 0
    ds_read_b64_tr_b16 v[114:115], v9 offset:49152
    v_mfma_f32_16x16x32_bf16 v[136:139], v[72:75], v[32:35], 0
    ds_read_b64_tr_b16 v[116:117], v10 offset:49152
    v_mfma_f32_16x16x32_bf16 v[140:143], v[76:79], v[32:35], 0
    ds_read_b64_tr_b16 v[118:119], v11 offset:49152
    v_mfma_f32_16x16x32_bf16 v[144:147], v[64:67], v[36:39], 0
    ds_read_b64_tr_b16 v[120:121], v8 offset:57344
    v_mfma_f32_16x16x32_bf16 v[148:151], v[68:71], v[36:39], 0
    ds_read_b64_tr_b16 v[122:123], v9 offset:57344
    v_mfma_f32_16x16x32_bf16 v[152:155], v[72:75], v[36:39], 0
    ds_read_b64_tr_b16 v[124:125], v10 offset:57344
    v_mfma_f32_16x16x32_bf16 v[156:159], v[76:79], v[36:39], 0
    ds_read_b64_tr_b16 v[126:127], v11 offset:57344
    v_mfma_f32_16x16x32_bf16 v[160:163], v[64:67], v[40:43], 0
    ds_read_b128 v[80:83], v5 offset:32768
    v_mfma_f32_16x16x32_bf16 v[164:167], v[68:71], v[40:43], 0
    ds_read_b128 v[84:87], v5 offset:33792
    v_mfma_f32_16x16x32_bf16 v[168:171], v[72:75], v[40:43], 0
    ds_read_b128 v[88:91], v5 offset:34816
    v_mfma_f32_16x16x32_bf16 v[172:175], v[76:79], v[40:43], 0
    ds_read_b128 v[92:95], v5 offset:35840
    v_mfma_f32_16x16x32_bf16 v[176:179], v[64:67], v[44:47], 0
    ds_read_b128 v[96:99], v5 offset:36864
    v_mfma_f32_16x16x32_bf16 v[180:183], v[68:71], v[44:47], 0
    ds_read_b128 v[100:103], v5 offset:37888
    v_mfma_f32_16x16x32_bf16 v[184:187], v[72:75], v[44:47], 0
    ds_read_b128 v[104:107], v5 offset:38912
    v_mfma_f32_16x16x32_bf16 v[188:191], v[76:79], v[44:47], 0
    ds_read_b128 v[108:111], v5 offset:39936
    v_mfma_f32_16x16x32_bf16 v[192:195], v[64:67], v[48:51], 0
    v_mfma_f32_16x16x32_bf16 v[196:199], v[68:71], v[48:51], 0
    s_add_u32 m0, s21, 0
    s_nop 0
    buffer_load_dwordx4 v1, s[4:7], s16 offen sc1 lds
    s_add_u32 s16, s16, s62
    v_mfma_f32_16x16x32_bf16 v[200:203], v[72:75], v[48:51], 0
    v_mfma_f32_16x16x32_bf16 v[204:207], v[76:79], v[48:51], 0
    v_mfma_f32_16x16x32_bf16 v[208:211], v[64:67], v[52:55], 0
    s_add_u32 m0, s21, 1024
    s_nop 0
    buffer_load_dwordx4 v1, s[4:7], s17 offen sc1 lds
    s_add_u32 s17, s17, s62
    v_mfma_f32_16x16x32_bf16 v[212:215], v[68:71], v[52:55], 0
    v_mfma_f32_16x16x32_bf16 v[216:219], v[72:75], v[52:55], 0
    v_mfma_f32_16x16x32_bf16 v[220:223], v[76:79], v[52:55], 0
    s_add_u32 m0, s22, 0
    s_nop 0
    buffer_load_dwordx4 v2, s[8:11], s18 offen lds
    s_add_u32 s18, s18, s20
    v_mfma_f32_16x16x32_bf16 v[224:227], v[64:67], v[56:59], 0
    v_mfma_f32_16x16x32_bf16 v[228:231], v[68:71], v[56:59], 0
    v_mfma_f32_16x16x32_bf16 v[232:235], v[72:75], v[56:59], 0
    s_add_u32 m0, s22, 8192
    s_nop 0
    buffer_load_dwordx4 v2, s[12:15], s19 offen lds
    s_add_u32 s19, s19, s20
    v_mfma_f32_16x16x32_bf16 v[236:239], v[76:79], v[56:59], 0
    v_mfma_f32_16x16x32_bf16 v[240:243], v[64:67], v[60:63], 0
    v_mfma_f32_16x16x32_bf16 v[244:247], v[68:71], v[60:63], 0
    v_mfma_f32_16x16x32_bf16 v[248:251], v[72:75], v[60:63], 0
    v_mfma_f32_16x16x32_bf16 v[252:255], v[76:79], v[60:63], 0
    s_waitcnt lgkmcnt(0)
    s_waitcnt vmcnt(16)
    s_barrier
    v_mfma_f32_16x16x32_bf16 v[128:131], v[112:115], v[80:83], v[128:131]
    ds_read_b64_tr_b16 v[64:65], v12 offset:16384
    v_mfma_f32_16x16x32_bf16 v[132:135], v[116:119], v[80:83], v[132:135]
    ds_read_b64_tr_b16 v[66:67], v13 offset:16384
    v_mfma_f32_16x16x32_bf16 v[136:139], v[120:123], v[80:83], v[136:139]
    ds_read_b64_tr_b16 v[68:69], v14 offset:16384
    v_mfma_f32_16x16x32_bf16 v[140:143], v[124:127], v[80:83], v[140:143]
    ds_read_b64_tr_b16 v[70:71], v15 offset:16384
    v_mfma_f32_16x16x32_bf16 v[144:147], v[112:115], v[84:87], v[144:147]
    ds_read_b64_tr_b16 v[72:73], v12 offset:24576
    v_mfma_f32_16x16x32_bf16 v[148:151], v[116:119], v[84:87], v[148:151]
    ds_read_b64_tr_b16 v[74:75], v13 offset:24576
    v_mfma_f32_16x16x32_bf16 v[152:155], v[120:123], v[84:87], v[152:155]
    ds_read_b64_tr_b16 v[76:77], v14 offset:24576
    v_mfma_f32_16x16x32_bf16 v[156:159], v[124:127], v[84:87], v[156:159]
    ds_read_b64_tr_b16 v[78:79], v15 offset:24576
    v_mfma_f32_16x16x32_bf16 v[160:163], v[112:115], v[88:91], v[160:163]
    ds_read_b128 v[32:35], v6 offset:0
    v_mfma_f32_16x16x32_bf16 v[164:167], v[116:119], v[88:91], v[164:167]
    ds_read_b128 v[36:39], v6 offset:1024
    v_mfma_f32_16x16x32_bf16 v[168:171], v[120:123], v[88:91], v[168:171]
    ds_read_b128 v[40:43], v6 offset:2048
    v_mfma_f32_16x16x32_bf16 v[172:175], v[124:127], v[88:91], v[172:175]
    ds_read_b128 v[44:47], v6 offset:3072
    v_mfma_f32_16x16x32_bf16 v[176:179], v[112:115], v[92:95], v[176:179]
    ds_read_b128 v[48:51], v6 offset:4096
    v_mfma_f32_16x16x32_bf16 v[180:183], v[116:119], v[92:95], v[180:183]
    ds_read_b128 v[52:55], v6 offset:5120
    v_mfma_f32_16x16x32_bf16 v[184:187], v[120:123], v[92:95], v[184:187]
    ds_read_b128 v[56:59], v6 offset:6144
    v_mfma_f32_16x16x32_bf16 v[188:191], v[124:127], v[92:95], v[188:191]
    ds_read_b128 v[60:63], v6 offset:7168
    v_mfma_f32_16x16x32_bf16 v[192:195], v[112:115], v[96:99], v[192:195]
    v_mfma_f32_16x16x32_bf16 v[196:199], v[116:119], v[96:99], v[196:199]
    s_add_u32 m0, s21, 32768
    s_nop 0
    buffer_load_dwordx4 v1, s[4:7], s16 offen sc1 lds
    s_add_u32 s16, s16, s62
    v_mfma_f32_16x16x32_bf16 v[200:203], v[120:123], v[96:99], v[200:203]
    v_mfma_f32_16x16x32_bf16 v[204:207], v[124:127], v[96:99], v[204:207]
    v_mfma_f32_16x16x32_bf16 v[208:211], v[112:115], v[100:103], v[208:211]
    s_add_u32 m0, s21, 33792
    s_nop 0
    buffer_load_dwordx4 v1, s[4:7], s17 offen sc1 lds
    s_add_u32 s17, s17, s62
    v_mfma_f32_16x16x32_bf16 v[212:215], v[116:119], v[100:103], v[212:215]
    v_mfma_f32_16x16x32_bf16 v[216:219], v[120:123], v[100:103], v[216:219]
    v_mfma_f32_16x16x32_bf16 v[220:223], v[124:127], v[100:103], v[220:223]
    s_add_u32 m0, s22, 32768
    s_nop 0
    buffer_load_dwordx4 v2, s[8:11], s18 offen lds
    s_add_u32 s18, s18, s20
    v_mfma_f32_16x16x32_bf16 v[224:227], v[112:115], v[104:107], v[224:227]
    v_mfma_f32_16x16x32_bf16 v[228:231], v[116:119], v[104:107], v[228:231]
    v_mfma_f32_16x16x32_bf16 v[232:235], v[120:123], v[104:107], v[232:235]
    s_add_u32 m0, s22, 40960
    s_nop 0
    buffer_load_dwordx4 v2, s[12:15], s19 offen lds
    s_add_u32 s19, s19, s20
    v_mfma_f32_16x16x32_bf16 v[236:239], v[124:127], v[104:107], v[236:239]
    v_mfma_f32_16x16x32_bf16 v[240:243], v[112:115], v[108:111], v[240:243]
    v_mfma_f32_16x16x32_bf16 v[244:247], v[116:119], v[108:111], v[244:247]
    v_mfma_f32_16x16x32_bf16 v[248:251], v[120:123], v[108:111], v[248:251]
    v_mfma_f32_16x16x32_bf16 v[252:255], v[124:127], v[108:111], v[252:255]
    s_waitcnt lgkmcnt(0)
    s_waitcnt vmcnt(16)
    s_barrier
    v_mfma_f32_16x16x32_bf16 v[128:131], v[64:67], v[32:35], v[128:131]
    ds_read_b64_tr_b16 v[112:113], v12 offset:49152
    v_mfma_f32_16x16x32_bf16 v[132:135], v[68:71], v[32:35], v[132:135]
    ds_read_b64_tr_b16 v[114:115], v13 offset:49152
    v_mfma_f32_16x16x32_bf16 v[136:139], v[72:75], v[32:35], v[136:139]
    ds_read_b64_tr_b16 v[116:117], v14 offset:49152
    v_mfma_f32_16x16x32_bf16 v[140:143], v[76:79], v[32:35], v[140:143]
    ds_read_b64_tr_b16 v[118:119], v15 offset:49152
    v_mfma_f32_16x16x32_bf16 v[144:147], v[64:67], v[36:39], v[144:147]
    ds_read_b64_tr_b16 v[120:121], v12 offset:57344
    v_mfma_f32_16x16x32_bf16 v[148:151], v[68:71], v[36:39], v[148:151]
    ds_read_b64_tr_b16 v[122:123], v13 offset:57344
    v_mfma_f32_16x16x32_bf16 v[152:155], v[72:75], v[36:39], v[152:155]
    ds_read_b64_tr_b16 v[124:125], v14 offset:57344
    v_mfma_f32_16x16x32_bf16 v[156:159], v[76:79], v[36:39], v[156:159]
    ds_read_b64_tr_b16 v[126:127], v15 offset:57344
    v_mfma_f32_16x16x32_bf16 v[160:163], v[64:67], v[40:43], v[160:163]
    ds_read_b128 v[80:83], v6 offset:32768
    v_mfma_f32_16x16x32_bf16 v[164:167], v[68:71], v[40:43], v[164:167]
    ds_read_b128 v[84:87], v6 offset:33792
    v_mfma_f32_16x16x32_bf16 v[168:171], v[72:75], v[40:43], v[168:171]
    ds_read_b128 v[88:91], v6 offset:34816
    v_mfma_f32_16x16x32_bf16 v[172:175], v[76:79], v[40:43], v[172:175]
    ds_read_b128 v[92:95], v6 offset:35840
    v_mfma_f32_16x16x32_bf16 v[176:179], v[64:67], v[44:47], v[176:179]
    ds_read_b128 v[96:99], v6 offset:36864
    v_mfma_f32_16x16x32_bf16 v[180:183], v[68:71], v[44:47], v[180:183]
    ds_read_b128 v[100:103], v6 offset:37888
    v_mfma_f32_16x16x32_bf16 v[184:187], v[72:75], v[44:47], v[184:187]
    ds_read_b128 v[104:107], v6 offset:38912
    v_mfma_f32_16x16x32_bf16 v[188:191], v[76:79], v[44:47], v[188:191]
    ds_read_b128 v[108:111], v6 offset:39936
    v_mfma_f32_16x16x32_bf16 v[192:195], v[64:67], v[48:51], v[192:195]
    v_mfma_f32_16x16x32_bf16 v[196:199], v[68:71], v[48:51], v[196:199]
    s_add_u32 m0, s21, 65536
    s_nop 0
    buffer_load_dwordx4 v1, s[4:7], s16 offen sc1 lds
    s_add_u32 s16, s16, s62
    v_mfma_f32_16x16x32_bf16 v[200:203], v[72:75], v[48:51], v[200:203]
    v_mfma_f32_16x16x32_bf16 v[204:207], v[76:79], v[48:51], v[204:207]
    v_mfma_f32_16x16x32_bf16 v[208:211], v[64:67], v[52:55], v[208:211]
    s_add_u32 m0, s21, 66560
    s_nop 0
    buffer_load_dwordx4 v1, s[4:7], s17 offen sc1 lds
    s_add_u32 s17, s17, s62
    v_mfma_f32_16x16x32_bf16 v[212:215], v[68:71], v[52:55], v[212:215]
    v_mfma_f32_16x16x32_bf16 v[216:219], v[72:75], v[52:55], v[216:219]
    v_mfma_f32_16x16x32_bf16 v[220:223], v[76:79], v[52:55], v[220:223]
    s_add_u32 m0, s22, 65536
    s_nop 0
    buffer_load_dwordx4 v2, s[8:11], s18 offen lds
    s_add_u32 s18, s18, s20
    v_mfma_f32_16x16x32_bf16 v[224:227], v[64:67], v[56:59], v[224:227]
    v_mfma_f32_16x16x32_bf16 v[228:231], v[68:71], v[56:59], v[228:231]
    v_mfma_f32_16x16x32_bf16 v[232:235], v[72:75], v[56:59], v[232:235]
    s_add_u32 m0, s22, 73728
    s_nop 0
    buffer_load_dwordx4 v2, s[12:15], s19 offen lds
    s_add_u32 s19, s19, s20
    v_mfma_f32_16x16x32_bf16 v[236:239], v[76:79], v[56:59], v[236:239]
    v_mfma_f32_16x16x32_bf16 v[240:243], v[64:67], v[60:63], v[240:243]
    v_mfma_f32_16x16x32_bf16 v[244:247], v[68:71], v[60:63], v[244:247]
    v_mfma_f32_16x16x32_bf16 v[248:251], v[72:75], v[60:63], v[248:251]
    v_mfma_f32_16x16x32_bf16 v[252:255], v[76:79], v[60:63], v[252:255]
    s_waitcnt lgkmcnt(0)
    s_waitcnt vmcnt(8)
    s_barrier
    s_cmp_eq_u32 s28, 0
    s_cbranch_scc1 sig_3
    s_cmp_lg_u32 s3, 0
    s_cbranch_scc1 sig_3
    s_mov_b64 exec, 1
    v_mov_b32 v18, s57
    buffer_atomic_add v18, v17, s[4:7], s28 offen sc1
    s_mov_b64 exec, -1
sig_3:
    s_mov_b32 s28, 0
    v_mfma_f32_16x16x32_bf16 v[128:131], v[112:115], v[80:83], v[128:131]
    ds_read_b64_tr_b16 v[64:65], v8 offset:16384
    v_mfma_f32_16x16x32_bf16 v[132:135], v[116:119], v[80:83], v[132:135]
    ds_read_b64_tr_b16 v[66:67], v9 offset:16384
    v_mfma_f32_16x16x32_bf16 v[136:139], v[120:123], v[80:83], v[136:139]
    ds_read_b64_tr_b16 v[68:69], v10 offset:16384
    v_mfma_f32_16x16x32_bf16 v[140:143], v[124:127], v[80:83], v[140:143]
    ds_read_b64_tr_b16 v[70:71], v11 offset:16384
    v_mfma_f32_16x16x32_bf16 v[144:147], v[112:115], v[84:87], v[144:147]
    ds_read_b64_tr_b16 v[72:73], v8 offset:24576
    v_mfma_f32_16x16x32_bf16 v[148:151], v[116:119], v[84:87], v[148:151]
    ds_read_b64_tr_b16 v[74:75], v9 offset:24576
    v_mfma_f32_16x16x32_bf16 v[152:155], v[120:123], v[84:87], v[152:155]
    ds_read_b64_tr_b16 v[76:77], v10 offset:24576
    v_mfma_f32_16x16x32_bf16 v[156:159], v[124:127], v[84:87], v[156:159]
    ds_read_b64_tr_b16 v[78:79], v11 offset:24576
    v_mfma_f32_16x16x32_bf16 v[160:163], v[112:115], v[88:91], v[160:163]
    ds_read_b128 v[32:35], v5 offset:0
    v_mfma_f32_16x16x32_bf16 v[164:167], v[116:119], v[88:91], v[164:167]
    ds_read_b128 v[36:39], v5 offset:1024
    v_mfma_f32_16x16x32_bf16 v[168:171], v[120:123], v[88:91], v[168:171]
    ds_read_b128 v[40:43], v5 offset:2048
    v_mfma_f32_16x16x32_bf16 v[172:175], v[124:127], v[88:91], v[172:175]
    ds_read_b128 v[44:47], v5 offset:3072
    v_mfma_f32_16x16x32_bf16 v[176:179], v[112:115], v[92:95], v[176:179]
    ds_read_b128 v[48:51], v5 offset:4096
    v_mfma_f32_16x16x32_bf16 v[180:183], v[116:119], v[92:95], v[180:183]
    ds_read_b128 v[52:55], v5 offset:5120
    v_mfma_f32_16x16x32_bf16 v[184:187], v[120:123], v[92:95], v[184:187]
    ds_read_b128 v[56:59], v5 offset:6144
    v_mfma_f32_16x16x32_bf16 v[188:191], v[124:127], v[92:95], v[188:191]
    ds_read_b128 v[60:63], v5 offset:7168
    v_mfma_f32_16x16x32_bf16 v[192:195], v[112:115], v[96:99], v[192:195]
    v_mfma_f32_16x16x32_bf16 v[196:199], v[116:119], v[96:99], v[196:199]
    s_add_u32 m0, s21, 98304
    s_nop 0
    buffer_load_dwordx4 v1, s[4:7], s16 offen sc1 lds
    s_add_u32 s16, s16, s62
    v_mfma_f32_16x16x32_bf16 v[200:203], v[120:123], v[96:99], v[200:203]
    v_mfma_f32_16x16x32_bf16 v[204:207], v[124:127], v[96:99], v[204:207]
    v_mfma_f32_16x16x32_bf16 v[208:211], v[112:115], v[100:103], v[208:211]
    s_add_u32 m0, s21, 99328
    s_nop 0
    buffer_load_dwordx4 v1, s[4:7], s17 offen sc1 lds
    s_add_u32 s17, s17, s62
    v_mfma_f32_16x16x32_bf16 v[212:215], v[116:119], v[100:103], v[212:215]
    v_mfma_f32_16x16x32_bf16 v[216:219], v[120:123], v[100:103], v[216:219]
    v_mfma_f32_16x16x32_bf16 v[220:223], v[124:127], v[100:103], v[220:223]
    s_add_u32 m0, s22, 98304
    s_nop 0
    buffer_load_dwordx4 v2, s[8:11], s18 offen lds
    s_add_u32 s18, s18, s20
    v_mfma_f32_16x16x32_bf16 v[224:227], v[112:115], v[104:107], v[224:227]
    v_mfma_f32_16x16x32_bf16 v[228:231], v[116:119], v[104:107], v[228:231]
    v_mfma_f32_16x16x32_bf16 v[232:235], v[120:123], v[104:107], v[232:235]
    s_add_u32 m0, s22, 106496
    s_nop 0
    buffer_load_dwordx4 v2, s[12:15], s19 offen lds
    s_add_u32 s19, s19, s20
    v_mfma_f32_16x16x32_bf16 v[236:239], v[124:127], v[104:107], v[236:239]
    v_mfma_f32_16x16x32_bf16 v[240:243], v[112:115], v[108:111], v[240:243]
    v_mfma_f32_16x16x32_bf16 v[244:247], v[116:119], v[108:111], v[244:247]
    v_mfma_f32_16x16x32_bf16 v[248:251], v[120:123], v[108:111], v[248:251]
    v_mfma_f32_16x16x32_bf16 v[252:255], v[124:127], v[108:111], v[252:255]
    s_waitcnt lgkmcnt(0)
    s_branch w_loop_chk
w_first16:
    s_waitcnt vmcnt(24)
    s_barrier
    v_mfma_f32_16x16x32_bf16 v[128:131], v[64:67], v[32:35], 0
    ds_read_b64_tr_b16 v[112:113], v8 offset:49152
    v_mfma_f32_16x16x32_bf16 v[132:135], v[68:71], v[32:35], 0
    ds_read_b64_tr_b16 v[114:115], v9 offset:49152
    v_mfma_f32_16x16x32_bf16 v[136:139], v[72:75], v[32:35], 0
    ds_read_b64_tr_b16 v[116:117], v10 offset:49152
    v_mfma_f32_16x16x32_bf16 v[140:143], v[76:79], v[32:35], 0
    ds_read_b64_tr_b16 v[118:119], v11 offset:49152
    v_mfma_f32_16x16x32_bf16 v[144:147], v[64:67], v[36:39], 0
    ds_read_b64_tr_b16 v[120:121], v8 offset:57344
    v_mfma_f32_16x16x32_bf16 v[148:151], v[68:71], v[36:39], 0
    ds_read_b64_tr_b16 v[122:123], v9 offset:57344
    v_mfma_f32_16x16x32_bf16 v[152:155], v[72:75], v[36:39], 0
    ds_read_b64_tr_b16 v[124:125], v10 offset:57344
    v_mfma_f32_16x16x32_bf16 v[156:159], v[76:79], v[36:39], 0
    ds_read_b64_tr_b16 v[126:127], v11 offset:57344
    v_mfma_f32_16x16x32_bf16 v[160:163], v[64:67], v[40:43], 0
    ds_read_b128 v[80:83], v5 offset:32768
    v_mfma_f32_16x16x32_bf16 v[164:167], v[68:71], v[40:43], 0
    ds_read_b128 v[84:87], v5 offset:33792
    v_mfma_f32_16x16x32_bf16 v[168:171], v[72:75], v[40:43], 0
    ds_read_b128 v[88:91], v5 offset:34816
    v_mfma_f32_16x16x32_bf16 v[172:175], v[76:79], v[40:43], 0
    ds_read_b128 v[92:95], v5 offset:35840
    v_mfma_f32_16x16x32_bf16 v[176:179], v[64:67], v[44:47], 0
    ds_read_b128 v[96:99], v5 offset:36864
    v_mfma_f32_16x16x32_bf16 v[180:183], v[68:71], v[44:47], 0
    ds_read_b128 v[100:103], v5 offset:37888
    v_mfma_f32_16x16x32_bf16 v[184:187], v[72:75], v[44:47], 0
    ds_read_b128 v[104:107], v5 offset:38912
    v_mfma_f32_16x16x32_bf16 v[188:191], v[76:79], v[44:47], 0
    ds_read_b128 v[108:111], v5 offset:39936
    v_mfma_f32_16x16x32_bf16 v[192:195], v[64:67], v[48:51], 0
    v_mfma_f32_16x16x32_bf16 v[196:199], v[68:71], v[48:51], 0
    s_add_u32 m0, s21, 0
    s_nop 0
    buffer_load_dwordx4 v1, s[4:7], s16 offen sc1 lds
    s_add_u32 s16, s16, s62
    v_mfma_f32_16x16x32_bf16 v[200:203], v[72:75], v[48:51], 0
    v_mfma_f32_16x16x32_bf16 v[204:207], v[76:79], v[48:51], 0
    v_mfma_f32_16x16x32_bf16 v[208:211], v[64:67], v[52:55], 0
    s_add_u32 m0, s21, 1024
    s_nop 0
    buffer_load_dwordx4 v1, s[4:7], s17 offen sc1 lds
    s_add_u32 s17, s17, s62
    v_mfma_f32_16x16x32_bf16 v[212:215], v[68:71], v[52:55], 0
    v_mfma_f32_16x16x32_bf16 v[216:219], v[72:75], v[52:55], 0
    v_mfma_f32_16x16x32_bf16 v[220:223], v[76:79], v[52:55], 0
    s_add_u32 m0, s22, 0
    s_nop 0
    buffer_load_dwordx4 v2, s[8:11], s18 offen lds
    s_add_u32 s18, s18, s20
    v_mfma_f32_16x16x32_bf16 v[224:227], v[64:67], v[56:59], 0
    v_mfma_f32_16x16x32_bf16 v[228:231], v[68:71], v[56:59], 0
    v_mfma_f32_16x16x32_bf16 v[232:235], v[72:75], v[56:59], 0
    s_add_u32 m0, s22, 8192
    s_nop 0
    buffer_load_dwordx4 v2, s[12:15], s19 offen lds
    s_add_u32 s19, s19, s20
    v_mfma_f32_16x16x32_bf16 v[236:239], v[76:79], v[56:59], 0
    v_mfma_f32_16x16x32_bf16 v[240:243], v[64:67], v[60:63], 0
    v_mfma_f32_16x16x32_bf16 v[244:247], v[68:71], v[60:63], 0
    v_mfma_f32_16x16x32_bf16 v[248:251], v[72:75], v[60:63], 0
    v_mfma_f32_16x16x32_bf16 v[252:255], v[76:79], v[60:63], 0
    s_waitcnt lgkmcnt(0)
    s_waitcnt vmcnt(24)
    s_barrier
    v_mfma_f32_16x16x32_bf16 v[128:131], v[112:115], v[80:83], v[128:131]
    ds_read_b64_tr_b16 v[64:65], v12 offset:16384
    v_mfma_f32_16x16x32_bf16 v[132:135], v[116:119], v[80:83], v[132:135]
    ds_read_b64_tr_b16 v[66:67], v13 offset:16384
    v_mfma_f32_16x16x32_bf16 v[136:139], v[120:123], v[80:83], v[136:139]
    ds_read_b64_tr_b16 v[68:69], v14 offset:16384
    v_mfma_f32_16x16x32_bf16 v[140:143], v[124:127], v[80:83], v[140:143]
    ds_read_b64_tr_b16 v[70:71], v15 offset:16384
    v_mfma_f32_16x16x32_bf16 v[144:147], v[112:115], v[84:87], v[144:147]
    ds_read_b64_tr_b16 v[72:73], v12 offset:24576
    v_mfma_f32_16x16x32_bf16 v[148:151], v[116:119], v[84:87], v[148:151]
    ds_read_b64_tr_b16 v[74:75], v13 offset:24576
    v_mfma_f32_16x16x32_bf16 v[152:155], v[120:123], v[84:87], v[152:155]
    ds_read_b64_tr_b16 v[76:77], v14 offset:24576
    v_mfma_f32_16x16x32_bf16 v[156:159], v[124:127], v[84:87], v[156:159]
    ds_read_b64_tr_b16 v[78:79], v15 offset:24576
    v_mfma_f32_16x16x32_bf16 v[160:163], v[112:115], v[88:91], v[160:163]
    ds_read_b128 v[32:35], v6 offset:0
    v_mfma_f32_16x16x32_bf16 v[164:167], v[116:119], v[88:91], v[164:167]
    ds_read_b128 v[36:39], v6 offset:1024
    v_mfma_f32_16x16x32_bf16 v[168:171], v[120:123], v[88:91], v[168:171]
    ds_read_b128 v[40:43], v6 offset:2048
    v_mfma_f32_16x16x32_bf16 v[172:175], v[124:127], v[88:91], v[172:175]
    ds_read_b128 v[44:47], v6 offset:3072
    v_mfma_f32_16x16x32_bf16 v[176:179], v[112:115], v[92:95], v[176:179]
    ds_read_b128 v[48:51], v6 offset:4096
    v_mfma_f32_16x16x32_bf16 v[180:183], v[116:119], v[92:95], v[180:183]
    ds_read_b128 v[52:55], v6 offset:5120
    v_mfma_f32_16x16x32_bf16 v[184:187], v[120:123], v[92:95], v[184:187]
    ds_read_b128 v[56:59], v6 offset:6144
    v_mfma_f32_16x16x32_bf16 v[188:191], v[124:127], v[92:95], v[188:191]
    ds_read_b128 v[60:63], v6 offset:7168
    v_mfma_f32_16x16x32_bf16 v[192:195], v[112:115], v[96:99], v[192:195]
    v_mfma_f32_16x16x32_bf16 v[196:199], v[116:119], v[96:99], v[196:199]
    s_add_u32 m0, s21, 32768
    s_nop 0
    buffer_load_dwordx4 v1, s[4:7], s16 offen sc1 lds
    s_add_u32 s16, s16, s62
    v_mfma_f32_16x16x32_bf16 v[200:203], v[120:123], v[96:99], v[200:203]
    v_mfma_f32_16x16x32_bf16 v[204:207], v[124:127], v[96:99], v[204:207]
    v_mfma_f32_16x16x32_bf16 v[208:211], v[112:115], v[100:103], v[208:211]
    s_add_u32 m0, s21, 33792
    s_nop 0
    buffer_load_dwordx4 v1, s[4:7], s17 offen sc1 lds
    s_add_u32 s17, s17, s62
    v_mfma_f32_16x16x32_bf16 v[212:215], v[116:119], v[100:103], v[212:215]
    v_mfma_f32_16x16x32_bf16 v[216:219], v[120:123], v[100:103], v[216:219]
    v_mfma_f32_16x16x32_bf16 v[220:223], v[124:127], v[100:103], v[220:223]
    s_add_u32 m0, s22, 32768
    s_nop 0
    buffer_load_dwordx4 v2, s[8:11], s18 offen lds
    s_add_u32 s18, s18, s20
    v_mfma_f32_16x16x32_bf16 v[224:227], v[112:115], v[104:107], v[224:227]
    v_mfma_f32_16x16x32_bf16 v[228:231], v[116:119], v[104:107], v[228:231]
    v_mfma_f32_16x16x32_bf16 v[232:235], v[120:123], v[104:107], v[232:235]
    s_add_u32 m0, s22, 40960
    s_nop 0
    buffer_load_dwordx4 v2, s[12:15], s19 offen lds
    s_add_u32 s19, s19, s20
    v_mfma_f32_16x16x32_bf16 v[236:239], v[124:127], v[104:107], v[236:239]
    v_mfma_f32_16x16x32_bf16 v[240:243], v[112:115], v[108:111], v[240:243]
    v_mfma_f32_16x16x32_bf16 v[244:247], v[116:119], v[108:111], v[244:247]
    v_mfma_f32_16x16x32_bf16 v[248:251], v[120:123], v[108:111], v[248:251]
    v_mfma_f32_16x16x32_bf16 v[252:255], v[124:127], v[108:111], v[252:255]
    s_waitcnt lgkmcnt(0)
    s_waitcnt vmcnt(24)
    s_barrier
    v_mfma_f32_16x16x32_bf16 v[128:131], v[64:67], v[32:35], v[128:131]
    ds_read_b64_tr_b16 v[112:113], v12 offset:49152
    v_mfma_f32_16x16x32_bf16 v[132:135], v[68:71], v[32:35], v[132:135]
    ds_read_b64_tr_b16 v[114:115], v13 offset:49152
    v_mfma_f32_16x16x32_bf16 v[136:139], v[72:75], v[32:35], v[136:139]
    ds_read_b64_tr_b16 v[116:117], v14 offset:49152
    v_mfma_f32_16x16x32_bf16 v[140:143], v[76:79], v[32:35], v[140:143]
    ds_read_b64_tr_b16 v[118:119], v15 offset:49152
    v_mfma_f32_16x16x32_bf16 v[144:147], v[64:67], v[36:39], v[144:147]
    ds_read_b64_tr_b16 v[120:121], v12 offset:57344
    v_mfma_f32_16x16x32_bf16 v[148:151], v[68:71], v[36:39], v[148:151]
    ds_read_b64_tr_b16 v[122:123], v13 offset:57344
    v_mfma_f32_16x16x32_bf16 v[152:155], v[72:75], v[36:39], v[152:155]
    ds_read_b64_tr_b16 v[124:125], v14 offset:57344
    v_mfma_f32_16x16x32_bf16 v[156:159], v[76:79], v[36:39], v[156:159]
    ds_read_b64_tr_b16 v[126:127], v15 offset:57344
    v_mfma_f32_16x16x32_bf16 v[160:163], v[64:67], v[40:43], v[160:163]
    ds_read_b128 v[80:83], v6 offset:32768
    v_mfma_f32_16x16x32_bf16 v[164:167], v[68:71], v[40:43], v[164:167]
    ds_read_b128 v[84:87], v6 offset:33792
    v_mfma_f32_16x16x32_bf16 v[168:171], v[72:75], v[40:43], v[168:171]
    ds_read_b128 v[88:91], v6 offset:34816
    v_mfma_f32_16x16x32_bf16 v[172:175], v[76:79], v[40:43], v[172:175]
    ds_read_b128 v[92:95], v6 offset:35840
    v_mfma_f32_16x16x32_bf16 v[176:179], v[64:67], v[44:47], v[176:179]
    ds_read_b128 v[96:99], v6 offset:36864
    v_mfma_f32_16x16x32_bf16 v[180:183], v[68:71], v[44:47], v[180:183]
    ds_read_b128 v[100:103], v6 offset:37888
    v_mfma_f32_16x16x32_bf16 v[184:187], v[72:75], v[44:47], v[184:187]
    ds_read_b128 v[104:107], v6 offset:38912
    v_mfma_f32_16x16x32_bf16 v[188:191], v[76:79], v[44:47], v[188:191]
    ds_read_b128 v[108:111], v6 offset:39936
    v_mfma_f32_16x16x32_bf16 v[192:195], v[64:67], v[48:51], v[192:195]
    v_mfma_f32_16x16x32_bf16 v[196:199], v[68:71], v[48:51], v[196:199]
    s_add_u32 m0, s21, 65536
    s_nop 0
    buffer_load_dwordx4 v1, s[4:7], s16 offen sc1 lds
    s_add_u32 s16, s16, s62
    v_mfma_f32_16x16x32_bf16 v[200:203], v[72:75], v[48:51], v[200:203]
    v_mfma_f32_16x16x32_bf16 v[204:207], v[76:79], v[48:51], v[204:207]
    v_mfma_f32_16x16x32_bf16 v[208:211], v[64:67], v[52:55], v[208:211]
    s_add_u32 m0, s21, 66560
    s_nop 0
    buffer_load_dwordx4 v1, s[4:7], s17 offen sc1 lds
    s_add_u32 s17, s17, s62
    v_mfma_f32_16x16x32_bf16 v[212:215], v[68:71], v[52:55], v[212:215]
    v_mfma_f32_16x16x32_bf16 v[216:219], v[72:75], v[52:55], v[216:219]
    v_mfma_f32_16x16x32_bf16 v[220:223], v[76:79], v[52:55], v[220:223]
    s_add_u32 m0, s22, 65536
    s_nop 0
    buffer_load_dwordx4 v2, s[8:11], s18 offen lds
    s_add_u32 s18, s18, s20
    v_mfma_f32_16x16x32_bf16 v[224:227], v[64:67], v[56:59], v[224:227]
    v_mfma_f32_16x16x32_bf16 v[228:231], v[68:71], v[56:59], v[228:231]
    v_mfma_f32_16x16x32_bf16 v[232:235], v[72:75], v[56:59], v[232:235]
    s_add_u32 m0, s22, 73728
    s_nop 0
    buffer_load_dwordx4 v2, s[12:15], s19 offen lds
    s_add_u32 s19, s19, s20
    v_mfma_f32_16x16x32_bf16 v[236:239], v[76:79], v[56:59], v[236:239]
    v_mfma_f32_16x16x32_bf16 v[240:243], v[64:67], v[60:63], v[240:243]
    v_mfma_f32_16x16x32_bf16 v[244:247], v[68:71], v[60:63], v[244:247]
    v_mfma_f32_16x16x32_bf16 v[248:251], v[72:75], v[60:63], v[248:251]
    v_mfma_f32_16x16x32_bf16 v[252:255], v[76:79], v[60:63], v[252:255]
    s_waitcnt lgkmcnt(0)
    s_waitcnt vmcnt(8)
    s_barrier
    s_cmp_eq_u32 s28, 0
    s_cbranch_scc1 sig_4
    s_cmp_lg_u32 s3, 0
    s_cbranch_scc1 sig_4
    s_mov_b64 exec, 1
    v_mov_b32 v18, s57
    buffer_atomic_add v18, v17, s[4:7], s28 offen sc1
    s_mov_b64 exec, -1
sig_4:
    s_mov_b32 s28, 0
    v_mfma_f32_16x16x32_bf16 v[128:131], v[112:115], v[80:83], v[128:131]
    ds_read_b64_tr_b16 v[64:65], v8 offset:16384
    v_mfma_f32_16x16x32_bf16 v[132:135], v[116:119], v[80:83], v[132:135]
    ds_read_b64_tr_b16 v[66:67], v9 offset:16384
    v_mfma_f32_16x16x32_bf16 v[136:139], v[120:123], v[80:83], v[136:139]
    ds_read_b64_tr_b16 v[68:69], v10 offset:16384
    v_mfma_f32_16x16x32_bf16 v[140:143], v[124:127], v[80:83], v[140:143]
    ds_read_b64_tr_b16 v[70:71], v11 offset:16384
    v_mfma_f32_16x16x32_bf16 v[144:147], v[112:115], v[84:87], v[144:147]
    ds_read_b64_tr_b16 v[72:73], v8 offset:24576
    v_mfma_f32_16x16x32_bf16 v[148:151], v[116:119], v[84:87], v[148:151]
    ds_read_b64_tr_b16 v[74:75], v9 offset:24576
    v_mfma_f32_16x16x32_bf16 v[152:155], v[120:123], v[84:87], v[152:155]
    ds_read_b64_tr_b16 v[76:77], v10 offset:24576
    v_mfma_f32_16x16x32_bf16 v[156:159], v[124:127], v[84:87], v[156:159]
    ds_read_b64_tr_b16 v[78:79], v11 offset:24576
    v_mfma_f32_16x16x32_bf16 v[160:163], v[112:115], v[88:91], v[160:163]
    ds_read_b128 v[32:35], v5 offset:0
    v_mfma_f32_16x16x32_bf16 v[164:167], v[116:119], v[88:91], v[164:167]
    ds_read_b128 v[36:39], v5 offset:1024
    v_mfma_f32_16x16x32_bf16 v[168:171], v[120:123], v[88:91], v[168:171]
    ds_read_b128 v[40:43], v5 offset:2048
    v_mfma_f32_16x16x32_bf16 v[172:175], v[124:127], v[88:91], v[172:175]
    ds_read_b128 v[44:47], v5 offset:3072
    v_mfma_f32_16x16x32_bf16 v[176:179], v[112:115], v[92:95], v[176:179]
    ds_read_b128 v[48:51], v5 offset:4096
    v_mfma_f32_16x16x32_bf16 v[180:183], v[116:119], v[92:95], v[180:183]
    ds_read_b128 v[52:55], v5 offset:5120
    v_mfma_f32_16x16x32_bf16 v[184:187], v[120:123], v[92:95], v[184:187]
    ds_read_b128 v[56:59], v5 offset:6144
    v_mfma_f32_16x16x32_bf16 v[188:191], v[124:127], v[92:95], v[188:191]
    ds_read_b128 v[60:63], v5 offset:7168
    v_mfma_f32_16x16x32_bf16 v[192:195], v[112:115], v[96:99], v[192:195]
    v_mfma_f32_16x16x32_bf16 v[196:199], v[116:119], v[96:99], v[196:199]
    s_add_u32 m0, s21, 98304
    s_nop 0
    buffer_load_dwordx4 v1, s[4:7], s16 offen sc1 lds
    s_add_u32 s16, s16, s62
    v_mfma_f32_16x16x32_bf16 v[200:203], v[120:123], v[96:99], v[200:203]
    v_mfma_f32_16x16x32_bf16 v[204:207], v[124:127], v[96:99], v[204:207]
    v_mfma_f32_16x16x32_bf16 v[208:211], v[112:115], v[100:103], v[208:211]
    s_add_u32 m0, s21, 99328
    s_nop 0
    buffer_load_dwordx4 v1, s[4:7], s17 offen sc1 lds
    s_add_u32 s17, s17, s62
    v_mfma_f32_16x16x32_bf16 v[212:215], v[116:119], v[100:103], v[212:215]
    v_mfma_f32_16x16x32_bf16 v[216:219], v[120:123], v[100:103], v[216:219]
    v_mfma_f32_16x16x32_bf16 v[220:223], v[124:127], v[100:103], v[220:223]
    s_add_u32 m0, s22, 98304
    s_nop 0
    buffer_load_dwordx4 v2, s[8:11], s18 offen lds
    s_add_u32 s18, s18, s20
    v_mfma_f32_16x16x32_bf16 v[224:227], v[112:115], v[104:107], v[224:227]
    v_mfma_f32_16x16x32_bf16 v[228:231], v[116:119], v[104:107], v[228:231]
    v_mfma_f32_16x16x32_bf16 v[232:235], v[120:123], v[104:107], v[232:235]
    s_add_u32 m0, s22, 106496
    s_nop 0
    buffer_load_dwordx4 v2, s[12:15], s19 offen lds
    s_add_u32 s19, s19, s20
    v_mfma_f32_16x16x32_bf16 v[236:239], v[124:127], v[104:107], v[236:239]
    v_mfma_f32_16x16x32_bf16 v[240:243], v[112:115], v[108:111], v[240:243]
    v_mfma_f32_16x16x32_bf16 v[244:247], v[116:119], v[108:111], v[244:247]
    v_mfma_f32_16x16x32_bf16 v[248:251], v[120:123], v[108:111], v[248:251]
    v_mfma_f32_16x16x32_bf16 v[252:255], v[124:127], v[108:111], v[252:255]
    s_waitcnt lgkmcnt(0)
w_loop_chk:
    s_sub_u32 s23, s23, 1
w_loop:
    s_cmp_lg_u32 s23, 1
    s_cbranch_scc1 w_body
    v_readfirstlane_b32 s30, v16
    s_cmp_ge_u32 s30, s45
    s_cselect_b32 s30, 0, 1
    s_or_b32 s30, s30, s70
    s_cmp_ge_u32 s32, 4
    s_cselect_b32 s30, 1, s30
    s_cmp_eq_u32 s32, 0
    s_cselect_b32 s30, 1, s30
    v_mov_b32 v20, s30
    ds_write_b32 v7, v20
    s_cbranch_scc1 w_nd
    s_cmp_ge_u32 s32, 4
    s_cbranch_scc1 w_nd
    s_cmp_lg_u32 s70, 0
    s_cbranch_scc1 w_nd
    s_load_dwordx2 s[8:9], s[0:1], s33
    s_load_dwordx2 s[12:13], s[0:1], s34
    s_mov_b32 s10, s38
    s_mov_b32 s14, s38
    s_cmp_ge_u32 s32, 4
    s_cselect_b32 s31, 0, 1
    s_lshl_b32 s30, s3, s31
    s_mul_i32 s30, s30, s40
    s_add_u32 s16, s39, s30
    s_cmp_eq_u32 s32, 4
    s_cselect_b32 s30, 1024, s40
    s_cselect_b32 s31, 6, 5
    s_lshl_b32 s62, 32, s31
    s_add_u32 s17, s16, s30
    s_lshl_b32 s30, s3, 2
    s_mul_i32 s30, s30, s35
    s_add_u32 s18, s36, s30
    s_add_u32 s19, s37, s30
    s_lshl_b32 s20, s35, s31
    v_mul_u32_u24 v2, s35, v4
    v_add_u32 v2, v2, v3
    s_waitcnt lgkmcnt(0)
w_body:
    s_waitcnt vmcnt(8)
    s_barrier
    v_mfma_f32_16x16x32_bf16 v[128:131], v[64:67], v[32:35], v[128:131]
    ds_read_b64_tr_b16 v[112:113], v8 offset:49152
    v_mfma_f32_16x16x32_bf16 v[132:135], v[68:71], v[32:35], v[132:135]
    ds_read_b64_tr_b16 v[114:115], v9 offset:49152
    v_mfma_f32_16x16x32_bf16 v[136:139], v[72:75], v[32:35], v[136:139]
    ds_read_b64_tr_b16 v[116:117], v10 offset:49152
    v_mfma_f32_16x16x32_bf16 v[140:143], v[76:79], v[32:35], v[140:143]
    ds_read_b64_tr_b16 v[118:119], v11 offset:49152
    v_mfma_f32_16x16x32_bf16 v[144:147], v[64:67], v[36:39], v[144:147]
    ds_read_b64_tr_b16 v[120:121], v8 offset:57344
    v_mfma_f32_16x16x32_bf16 v[148:151], v[68:71], v[36:39], v[148:151]
    ds_read_b64_tr_b16 v[122:123], v9 offset:57344
    v_mfma_f32_16x16x32_bf16 v[152:155], v[72:75], v[36:39], v[152:155]
    ds_read_b64_tr_b16 v[124:125], v10 offset:57344
    v_mfma_f32_16x16x32_bf16 v[156:159], v[76:79], v[36:39], v[156:159]
    ds_read_b64_tr_b16 v[126:127], v11 offset:57344
    v_mfma_f32_16x16x32_bf16 v[160:163], v[64:67], v[40:43], v[160:163]
    ds_read_b128 v[80:83], v5 offset:32768
    v_mfma_f32_16x16x32_bf16 v[164:167], v[68:71], v[40:43], v[164:167]
    ds_read_b128 v[84:87], v5 offset:33792
    v_mfma_f32_16x16x32_bf16 v[168:171], v[72:75], v[40:43], v[168:171]
    ds_read_b128 v[88:91], v5 offset:34816
    v_mfma_f32_16x16x32_bf16 v[172:175], v[76:79], v[40:43], v[172:175]
    ds_read_b128 v[92:95], v5 offset:35840
    v_mfma_f32_16x16x32_bf16 v[176:179], v[64:67], v[44:47], v[176:179]
    ds_read_b128 v[96:99], v5 offset:36864
    v_mfma_f32_16x16x32_bf16 v[180:183], v[68:71], v[44:47], v[180:183]
    ds_read_b128 v[100:103], v5 offset:37888
    v_mfma_f32_16x16x32_bf16 v[184:187], v[72:75], v[44:47], v[184:187]
    ds_read_b128 v[104:107], v5 offset:38912
    v_mfma_f32_16x16x32_bf16 v[188:191], v[76:79], v[44:47], v[188:191]
    ds_read_b128 v[108:111], v5 offset:39936
    v_mfma_f32_16x16x32_bf16 v[192:195], v[64:67], v[48:51], v[192:195]
    v_mfma_f32_16x16x32_bf16 v[196:199], v[68:71], v[48:51], v[196:199]
    s_add_u32 m0, s21, 0
    s_nop 0
    buffer_load_dwordx4 v1, s[4:7], s16 offen sc1 lds
    s_add_u32 s16, s16, s62
    v_mfma_f32_16x16x32_bf16 v[200:203], v[72:75], v[48:51], v[200:203]
    v_mfma_f32_16x16x32_bf16 v[204:207], v[76:79], v[48:51], v[204:207]
    v_mfma_f32_16x16x32_bf16 v[208:211], v[64:67], v[52:55], v[208:211]
    s_add_u32 m0, s21, 1024
    s_nop 0
    buffer_load_dwordx4 v1, s[4:7], s17 offen sc1 lds
    s_add_u32 s17, s17, s62
    v_mfma_f32_16x16x32_bf16 v[212:215], v[68:71], v[52:55], v[212:215]
    v_mfma_f32_16x16x32_bf16 v[216:219], v[72:75], v[52:55], v[216:219]
    v_mfma_f32_16x16x32_bf16 v[220:223], v[76:79], v[52:55], v[220:223]
    s_add_u32 m0, s22, 0
    s_nop 0
    buffer_load_dwordx4 v2, s[8:11], s18 offen lds
    s_add_u32 s18, s18, s20
    v_mfma_f32_16x16x32_bf16 v[224:227], v[64:67], v[56:59], v[224:227]
    v_mfma_f32_16x16x32_bf16 v[228:231], v[68:71], v[56:59], v[228:231]
    v_mfma_f32_16x16x32_bf16 v[232:235], v[72:75], v[56:59], v[232:235]
    s_add_u32 m0, s22, 8192
    s_nop 0
    buffer_load_dwordx4 v2, s[12:15], s19 offen lds
    s_add_u32 s19, s19, s20
    v_mfma_f32_16x16x32_bf16 v[236:239], v[76:79], v[56:59], v[236:239]
    v_mfma_f32_16x16x32_bf16 v[240:243], v[64:67], v[60:63], v[240:243]
    v_mfma_f32_16x16x32_bf16 v[244:247], v[68:71], v[60:63], v[244:247]
    buffer_load_dword v16, v17, s[4:7], s44 offen sc1
    v_mfma_f32_16x16x32_bf16 v[248:251], v[72:75], v[60:63], v[248:251]
    v_mfma_f32_16x16x32_bf16 v[252:255], v[76:79], v[60:63], v[252:255]
    s_waitcnt lgkmcnt(0)
    s_waitcnt vmcnt(8)
    s_barrier
    v_mfma_f32_16x16x32_bf16 v[128:131], v[112:115], v[80:83], v[128:131]
    ds_read_b64_tr_b16 v[64:65], v12 offset:16384
    v_mfma_f32_16x16x32_bf16 v[132:135], v[116:119], v[80:83], v[132:135]
    ds_read_b64_tr_b16 v[66:67], v13 offset:16384
    v_mfma_f32_16x16x32_bf16 v[136:139], v[120:123], v[80:83], v[136:139]
    ds_read_b64_tr_b16 v[68:69], v14 offset:16384
    v_mfma_f32_16x16x32_bf16 v[140:143], v[124:127], v[80:83], v[140:143]
    ds_read_b64_tr_b16 v[70:71], v15 offset:16384
    v_mfma_f32_16x16x32_bf16 v[144:147], v[112:115], v[84:87], v[144:147]
    ds_read_b64_tr_b16 v[72:73], v12 offset:24576
    v_mfma_f32_16x16x32_bf16 v[148:151], v[116:119], v[84:87], v[148:151]
    ds_read_b64_tr_b16 v[74:75], v13 offset:24576
    v_mfma_f32_16x16x32_bf16 v[152:155], v[120:123], v[84:87], v[152:155]
    ds_read_b64_tr_b16 v[76:77], v14 offset:24576
    v_mfma_f32_16x16x32_bf16 v[156:159], v[124:127], v[84:87], v[156:159]
    ds_read_b64_tr_b16 v[78:79], v15 offset:24576
    v_mfma_f32_16x16x32_bf16 v[160:163], v[112:115], v[88:91], v[160:163]
    ds_read_b128 v[32:35], v6 offset:0
    v_mfma_f32_16x16x32_bf16 v[164:167], v[116:119], v[88:91], v[164:167]
    ds_read_b128 v[36:39], v6 offset:1024
    v_mfma_f32_16x16x32_bf16 v[168:171], v[120:123], v[88:91], v[168:171]
    ds_read_b128 v[40:43], v6 offset:2048
    v_mfma_f32_16x16x32_bf16 v[172:175], v[124:127], v[88:91], v[172:175]
    ds_read_b128 v[44:47], v6 offset:3072
    v_mfma_f32_16x16x32_bf16 v[176:179], v[112:115], v[92:95], v[176:179]
    ds_read_b128 v[48:51], v6 offset:4096
    v_mfma_f32_16x16x32_bf16 v[180:183], v[116:119], v[92:95], v[180:183]
    ds_read_b128 v[52:55], v6 offset:5120
    v_mfma_f32_16x16x32_bf16 v[184:187], v[120:123], v[92:95], v[184:187]
    ds_read_b128 v[56:59], v6 offset:6144
    v_mfma_f32_16x16x32_bf16 v[188:191], v[124:127], v[92:95], v[188:191]
    ds_read_b128 v[60:63], v6 offset:7168
    v_mfma_f32_16x16x32_bf16 v[192:195], v[112:115], v[96:99], v[192:195]
    v_mfma_f32_16x16x32_bf16 v[196:199], v[116:119], v[96:99], v[196:199]
    s_add_u32 m0, s21, 32768
    s_nop 0
    buffer_load_dwordx4 v1, s[4:7], s16 offen sc1 lds
    s_add_u32 s16, s16, s62
    v_mfma_f32_16x16x32_bf16 v[200:203], v[120:123], v[96:99], v[200:203]
    v_mfma_f32_16x16x32_bf16 v[204:207], v[124:127], v[96:99], v[204:207]
    v_mfma_f32_16x16x32_bf16 v[208:211], v[112:115], v[100:103], v[208:211]
    s_add_u32 m0, s21, 33792
    s_nop 0
    buffer_load_dwordx4 v1, s[4:7], s17 offen sc1 lds
    s_add_u32 s17, s17, s62
    v_mfma_f32_16x16x32_bf16 v[212:215], v[116:119], v[100:103], v[212:215]
    v_mfma_f32_16x16x32_bf16 v[216:219], v[120:123], v[100:103], v[216:219]
    v_mfma_f32_16x16x32_bf16 v[220:223], v[124:127], v[100:103], v[220:223]
    s_add_u32 m0, s22, 32768
    s_nop 0
    buffer_load_dwordx4 v2, s[8:11], s18 offen lds
    s_add_u32 s18, s18, s20
    v_mfma_f32_16x16x32_bf16 v[224:227], v[112:115], v[104:107], v[224:227]
    v_mfma_f32_16x16x32_bf16 v[228:231], v[116:119], v[104:107], v[228:231]
    v_mfma_f32_16x16x32_bf16 v[232:235], v[120:123], v[104:107], v[232:235]
    s_add_u32 m0, s22, 40960
    s_nop 0
    buffer_load_dwordx4 v2, s[12:15], s19 offen lds
    s_add_u32 s19, s19, s20
    v_mfma_f32_16x16x32_bf16 v[236:239], v[124:127], v[104:107], v[236:239]
    v_mfma_f32_16x16x32_bf16 v[240:243], v[112:115], v[108:111], v[240:243]
    v_mfma_f32_16x16x32_bf16 v[244:247], v[116:119], v[108:111], v[244:247]
    v_mfma_f32_16x16x32_bf16 v[248:251], v[120:123], v[108:111], v[248:251]
    v_mfma_f32_16x16x32_bf16 v[252:255], v[124:127], v[108:111], v[252:255]
    s_waitcnt lgkmcnt(0)
    s_waitcnt vmcnt(8)
    s_barrier
    v_mfma_f32_16x16x32_bf16 v[128:131], v[64:67], v[32:35], v[128:131]
    ds_read_b64_tr_b16 v[112:113], v12 offset:49152
    v_mfma_f32_16x16x32_bf16 v[132:135], v[68:71], v[32:35], v[132:135]
    ds_read_b64_tr_b16 v[114:115], v13 offset:49152
    v_mfma_f32_16x16x32_bf16 v[136:139], v[72:75], v[32:35], v[136:139]
    ds_read_b64_tr_b16 v[116:117], v14 offset:49152
    v_mfma_f32_16x16x32_bf16 v[140:143], v[76:79], v[32:35], v[140:143]
    ds_read_b64_tr_b16 v[118:119], v15 offset:49152
    v_mfma_f32_16x16x32_bf16 v[144:147], v[64:67], v[36:39], v[144:147]
    ds_read_b64_tr_b16 v[120:121], v12 offset:57344
    v_mfma_f32_16x16x32_bf16 v[148:151], v[68:71], v[36:39], v[148:151]
    ds_read_b64_tr_b16 v[122:123], v13 offset:57344
    v_mfma_f32_16x16x32_bf16 v[152:155], v[72:75], v[36:39], v[152:155]
    ds_read_b64_tr_b16 v[124:125], v14 offset:57344
    v_mfma_f32_16x16x32_bf16 v[156:159], v[76:79], v[36:39], v[156:159]
    ds_read_b64_tr_b16 v[126:127], v15 offset:57344
    v_mfma_f32_16x16x32_bf16 v[160:163], v[64:67], v[40:43], v[160:163]
    ds_read_b128 v[80:83], v6 offset:32768
    v_mfma_f32_16x16x32_bf16 v[164:167], v[68:71], v[40:43], v[164:167]
    ds_read_b128 v[84:87], v6 offset:33792
    v_mfma_f32_16x16x32_bf16 v[168:171], v[72:75], v[40:43], v[168:171]
    ds_read_b128 v[88:91], v6 offset:34816
    v_mfma_f32_16x16x32_bf16 v[172:175], v[76:79], v[40:43], v[172:175]
    ds_read_b128 v[92:95], v6 offset:35840
    v_mfma_f32_16x16x32_bf16 v[176:179], v[64:67], v[44:47], v[176:179]
    ds_read_b128 v[96:99], v6 offset:36864
    v_mfma_f32_16x16x32_bf16 v[180:183], v[68:71], v[44:47], v[180:183]
    ds_read_b128 v[100:103], v6 offset:37888
    v_mfma_f32_16x16x32_bf16 v[184:187], v[72:75], v[44:47], v[184:187]
    ds_read_b128 v[104:107], v6 offset:38912
    v_mfma_f32_16x16x32_bf16 v[188:191], v[76:79], v[44:47], v[188:191]
    ds_read_b128 v[108:111], v6 offset:39936
    v_mfma_f32_16x16x32_bf16 v[192:195], v[64:67], v[48:51], v[192:195]
    v_mfma_f32_16x16x32_bf16 v[196:199], v[68:71], v[48:51], v[196:199]
    s_add_u32 m0, s21, 65536
    s_nop 0
    buffer_load_dwordx4 v1, s[4:7], s16 offen sc1 lds
    s_add_u32 s16, s16, s62
    v_mfma_f32_16x16x32_bf16 v[200:203], v[72:75], v[48:51], v[200:203]
    v_mfma_f32_16x16x32_bf16 v[204:207], v[76:79], v[48:51], v[204:207]
    v_mfma_f32_16x16x32_bf16 v[208:211], v[64:67], v[52:55], v[208:211]
    s_add_u32 m0, s21, 66560
    s_nop 0
    buffer_load_dwordx4 v1, s[4:7], s17 offen sc1 lds
    s_add_u32 s17, s17, s62
    v_mfma_f32_16x16x32_bf16 v[212:215], v[68:71], v[52:55], v[212:215]
    v_mfma_f32_16x16x32_bf16 v[216:219], v[72:75], v[52:55], v[216:219]
    v_mfma_f32_16x16x32_bf16 v[220:223], v[76:79], v[52:55], v[220:223]
    s_add_u32 m0, s22, 65536
    s_nop 0
    buffer_load_dwordx4 v2, s[8:11], s18 offen lds
    s_add_u32 s18, s18, s20
    v_mfma_f32_16x16x32_bf16 v[224:227], v[64:67], v[56:59], v[224:227]
    v_mfma_f32_16x16x32_bf16 v[228:231], v[68:71], v[56:59], v[228:231]
    v_mfma_f32_16x16x32_bf16 v[232:235], v[72:75], v[56:59], v[232:235]
    s_add_u32 m0, s22, 73728
    s_nop 0
    buffer_load_dwordx4 v2, s[12:15], s19 offen lds
    s_add_u32 s19, s19, s20
    v_mfma_f32_16x16x32_bf16 v[236:239], v[76:79], v[56:59], v[236:239]
    v_mfma_f32_16x16x32_bf16 v[240:243], v[64:67], v[60:63], v[240:243]
    v_mfma_f32_16x16x32_bf16 v[244:247], v[68:71], v[60:63], v[244:247]
    v_mfma_f32_16x16x32_bf16 v[248:251], v[72:75], v[60:63], v[248:251]
    v_mfma_f32_16x16x32_bf16 v[252:255], v[76:79], v[60:63], v[252:255]
    s_waitcnt lgkmcnt(0)
    s_waitcnt vmcnt(8)
    s_barrier
    v_mfma_f32_16x16x32_bf16 v[128:131], v[112:115], v[80:83], v[128:131]
    ds_read_b64_tr_b16 v[64:65], v8 offset:16384
    v_mfma_f32_16x16x32_bf16 v[132:135], v[116:119], v[80:83], v[132:135]
    ds_read_b64_tr_b16 v[66:67], v9 offset:16384
    v_mfma_f32_16x16x32_bf16 v[136:139], v[120:123], v[80:83], v[136:139]
    ds_read_b64_tr_b16 v[68:69], v10 offset:16384
    v_mfma_f32_16x16x32_bf16 v[140:143], v[124:127], v[80:83], v[140:143]
    ds_read_b64_tr_b16 v[70:71], v11 offset:16384
    v_mfma_f32_16x16x32_bf16 v[144:147], v[112:115], v[84:87], v[144:147]
    ds_read_b64_tr_b16 v[72:73], v8 offset:24576
    v_mfma_f32_16x16x32_bf16 v[148:151], v[116:119], v[84:87], v[148:151]
    ds_read_b64_tr_b16 v[74:75], v9 offset:24576
    v_mfma_f32_16x16x32_bf16 v[152:155], v[120:123], v[84:87], v[152:155]
    ds_read_b64_tr_b16 v[76:77], v10 offset:24576
    v_mfma_f32_16x16x32_bf16 v[156:159], v[124:127], v[84:87], v[156:159]
    ds_read_b64_tr_b16 v[78:79], v11 offset:24576
    v_mfma_f32_16x16x32_bf16 v[160:163], v[112:115], v[88:91], v[160:163]
    ds_read_b128 v[32:35], v5 offset:0
    v_mfma_f32_16x16x32_bf16 v[164:167], v[116:119], v[88:91], v[164:167]
    ds_read_b128 v[36:39], v5 offset:1024
    v_mfma_f32_16x16x32_bf16 v[168:171], v[120:123], v[88:91], v[168:171]
    ds_read_b128 v[40:43], v5 offset:2048
    v_mfma_f32_16x16x32_bf16 v[172:175], v[124:127], v[88:91], v[172:175]
    ds_read_b128 v[44:47], v5 offset:3072
    v_mfma_f32_16x16x32_bf16 v[176:179], v[112:115], v[92:95], v[176:179]
    ds_read_b128 v[48:51], v5 offset:4096
    v_mfma_f32_16x16x32_bf16 v[180:183], v[116:119], v[92:95], v[180:183]
    ds_read_b128 v[52:55], v5 offset:5120
    v_mfma_f32_16x16x32_bf16 v[184:187], v[120:123], v[92:95], v[184:187]
    ds_read_b128 v[56:59], v5 offset:6144
    v_mfma_f32_16x16x32_bf16 v[188:191], v[124:127], v[92:95], v[188:191]
    ds_read_b128 v[60:63], v5 offset:7168
    v_mfma_f32_16x16x32_bf16 v[192:195], v[112:115], v[96:99], v[192:195]
    v_mfma_f32_16x16x32_bf16 v[196:199], v[116:119], v[96:99], v[196:199]
    s_add_u32 m0, s21, 98304
    s_nop 0
    buffer_load_dwordx4 v1, s[4:7], s16 offen sc1 lds
    s_add_u32 s16, s16, s62
    v_mfma_f32_16x16x32_bf16 v[200:203], v[120:123], v[96:99], v[200:203]
    v_mfma_f32_16x16x32_bf16 v[204:207], v[124:127], v[96:99], v[204:207]
    v_mfma_f32_16x16x32_bf16 v[208:211], v[112:115], v[100:103], v[208:211]
    s_add_u32 m0, s21, 99328
    s_nop 0
    buffer_load_dwordx4 v1, s[4:7], s17 offen sc1 lds
    s_add_u32 s17, s17, s62
    v_mfma_f32_16x16x32_bf16 v[212:215], v[116:119], v[100:103], v[212:215]
    v_mfma_f32_16x16x32_bf16 v[216:219], v[120:123], v[100:103], v[216:219]
    v_mfma_f32_16x16x32_bf16 v[220:223], v[124:127], v[100:103], v[220:223]
    s_add_u32 m0, s22, 98304
    s_nop 0
    buffer_load_dwordx4 v2, s[8:11], s18 offen lds
    s_add_u32 s18, s18, s20
    v_mfma_f32_16x16x32_bf16 v[224:227], v[112:115], v[104:107], v[224:227]
    v_mfma_f32_16x16x32_bf16 v[228:231], v[116:119], v[104:107], v[228:231]
    v_mfma_f32_16x16x32_bf16 v[232:235], v[120:123], v[104:107], v[232:235]
    s_add_u32 m0, s22, 106496
    s_nop 0
    buffer_load_dwordx4 v2, s[12:15], s19 offen lds
    s_add_u32 s19, s19, s20
    v_mfma_f32_16x16x32_bf16 v[236:239], v[124:127], v[104:107], v[236:239]
    v_mfma_f32_16x16x32_bf16 v[240:243], v[112:115], v[108:111], v[240:243]
    v_mfma_f32_16x16x32_bf16 v[244:247], v[116:119], v[108:111], v[244:247]
    v_mfma_f32_16x16x32_bf16 v[248:251], v[120:123], v[108:111], v[248:251]
    v_mfma_f32_16x16x32_bf16 v[252:255], v[124:127], v[108:111], v[252:255]
    s_waitcnt lgkmcnt(0)
    s_sub_u32 s23, s23, 1
    s_cmp_lg_u32 s23, 0
    s_cbranch_scc1 w_loop
    s_branch w_end
w_nd:
    s_waitcnt vmcnt(8)
    s_barrier
    v_mfma_f32_16x16x32_bf16 v[128:131], v[64:67], v[32:35], v[128:131]
    ds_read_b64_tr_b16 v[112:113], v8 offset:49152
    v_mfma_f32_16x16x32_bf16 v[132:135], v[68:71], v[32:35], v[132:135]
    ds_read_b64_tr_b16 v[114:115], v9 offset:49152
    v_mfma_f32_16x16x32_bf16 v[136:139], v[72:75], v[32:35], v[136:139]
    ds_read_b64_tr_b16 v[116:117], v10 offset:49152
    v_mfma_f32_16x16x32_bf16 v[140:143], v[76:79], v[32:35], v[140:143]
    ds_read_b64_tr_b16 v[118:119], v11 offset:49152
    v_mfma_f32_16x16x32_bf16 v[144:147], v[64:67], v[36:39], v[144:147]
    ds_read_b64_tr_b16 v[120:121], v8 offset:57344
    v_mfma_f32_16x16x32_bf16 v[148:151], v[68:71], v[36:39], v[148:151]
    ds_read_b64_tr_b16 v[122:123], v9 offset:57344
    v_mfma_f32_16x16x32_bf16 v[152:155], v[72:75], v[36:39], v[152:155]
    ds_read_b64_tr_b16 v[124:125], v10 offset:57344
    v_mfma_f32_16x16x32_bf16 v[156:159], v[76:79], v[36:39], v[156:159]
    ds_read_b64_tr_b16 v[126:127], v11 offset:57344
    v_mfma_f32_16x16x32_bf16 v[160:163], v[64:67], v[40:43], v[160:163]
    ds_read_b128 v[80:83], v5 offset:32768
    v_mfma_f32_16x16x32_bf16 v[164:167], v[68:71], v[40:43], v[164:167]
    ds_read_b128 v[84:87], v5 offset:33792
    v_mfma_f32_16x16x32_bf16 v[168:171], v[72:75], v[40:43], v[168:171]
    ds_read_b128 v[88:91], v5 offset:34816
    v_mfma_f32_16x16x32_bf16 v[172:175], v[76:79], v[40:43], v[172:175]
    ds_read_b128 v[92:95], v5 offset:35840
    v_mfma_f32_16x16x32_bf16 v[176:179], v[64:67], v[44:47], v[176:179]
    ds_read_b128 v[96:99], v5 offset:36864
    v_mfma_f32_16x16x32_bf16 v[180:183], v[68:71], v[44:47], v[180:183]
    ds_read_b128 v[100:103], v5 offset:37888
    v_mfma_f32_16x16x32_bf16 v[184:187], v[72:75], v[44:47], v[184:187]
    ds_read_b128 v[104:107], v5 offset:38912
    v_mfma_f32_16x16x32_bf16 v[188:191], v[76:79], v[44:47], v[188:191]
    ds_read_b128 v[108:111], v5 offset:39936
    v_mfma_f32_16x16x32_bf16 v[192:195], v[64:67], v[48:51], v[192:195]
    v_mfma_f32_16x16x32_bf16 v[196:199], v[68:71], v[48:51], v[196:199]
    v_mfma_f32_16x16x32_bf16 v[200:203], v[72:75], v[48:51], v[200:203]
    v_mfma_f32_16x16x32_bf16 v[204:207], v[76:79], v[48:51], v[204:207]
    v_mfma_f32_16x16x32_bf16 v[208:211], v[64:67], v[52:55], v[208:211]
    v_mfma_f32_16x16x32_bf16 v[212:215], v[68:71], v[52:55], v[212:215]
    v_mfma_f32_16x16x32_bf16 v[216:219], v[72:75], v[52:55], v[216:219]
    v_mfma_f32_16x16x32_bf16 v[220:223], v[76:79], v[52:55], v[220:223]
    v_mfma_f32_16x16x32_bf16 v[224:227], v[64:67], v[56:59], v[224:227]
    v_mfma_f32_16x16x32_bf16 v[228:231], v[68:71], v[56:59], v[228:231]
    v_mfma_f32_16x16x32_bf16 v[232:235], v[72:75], v[56:59], v[232:235]
    v_mfma_f32_16x16x32_bf16 v[236:239], v[76:79], v[56:59], v[236:239]
    v_mfma_f32_16x16x32_bf16 v[240:243], v[64:67], v[60:63], v[240:243]
    v_mfma_f32_16x16x32_bf16 v[244:247], v[68:71], v[60:63], v[244:247]
    v_mfma_f32_16x16x32_bf16 v[248:251], v[72:75], v[60:63], v[248:251]
    v_mfma_f32_16x16x32_bf16 v[252:255], v[76:79], v[60:63], v[252:255]
    s_waitcnt lgkmcnt(0)
    s_waitcnt vmcnt(4)
    s_barrier
    v_mfma_f32_16x16x32_bf16 v[128:131], v[112:115], v[80:83], v[128:131]
    ds_read_b64_tr_b16 v[64:65], v12 offset:16384
    v_mfma_f32_16x16x32_bf16 v[132:135], v[116:119], v[80:83], v[132:135]
    ds_read_b64_tr_b16 v[66:67], v13 offset:16384
    v_mfma_f32_16x16x32_bf16 v[136:139], v[120:123], v[80:83], v[136:139]
    ds_read_b64_tr_b16 v[68:69], v14 offset:16384
    v_mfma_f32_16x16x32_bf16 v[140:143], v[124:127], v[80:83], v[140:143]
    ds_read_b64_tr_b16 v[70:71], v15 offset:16384
    v_mfma_f32_16x16x32_bf16 v[144:147], v[112:115], v[84:87], v[144:147]
    ds_read_b64_tr_b16 v[72:73], v12 offset:24576
    v_mfma_f32_16x16x32_bf16 v[148:151], v[116:119], v[84:87], v[148:151]
    ds_read_b64_tr_b16 v[74:75], v13 offset:24576
    v_mfma_f32_16x16x32_bf16 v[152:155], v[120:123], v[84:87], v[152:155]
    ds_read_b64_tr_b16 v[76:77], v14 offset:24576
    v_mfma_f32_16x16x32_bf16 v[156:159], v[124:127], v[84:87], v[156:159]
    ds_read_b64_tr_b16 v[78:79], v15 offset:24576
    v_mfma_f32_16x16x32_bf16 v[160:163], v[112:115], v[88:91], v[160:163]
    ds_read_b128 v[32:35], v6 offset:0
    v_mfma_f32_16x16x32_bf16 v[164:167], v[116:119], v[88:91], v[164:167]
    ds_read_b128 v[36:39], v6 offset:1024
    v_mfma_f32_16x16x32_bf16 v[168:171], v[120:123], v[88:91], v[168:171]
    ds_read_b128 v[40:43], v6 offset:2048
    v_mfma_f32_16x16x32_bf16 v[172:175], v[124:127], v[88:91], v[172:175]
    ds_read_b128 v[44:47], v6 offset:3072
    v_mfma_f32_16x16x32_bf16 v[176:179], v[112:115], v[92:95], v[176:179]
    ds_read_b128 v[48:51], v6 offset:4096
    v_mfma_f32_16x16x32_bf16 v[180:183], v[116:119], v[92:95], v[180:183]
    ds_read_b128 v[52:55], v6 offset:5120
    v_mfma_f32_16x16x32_bf16 v[184:187], v[120:123], v[92:95], v[184:187]
    ds_read_b128 v[56:59], v6 offset:6144
    v_mfma_f32_16x16x32_bf16 v[188:191], v[124:127], v[92:95], v[188:191]
    ds_read_b128 v[60:63], v6 offset:7168
    v_mfma_f32_16x16x32_bf16 v[192:195], v[112:115], v[96:99], v[192:195]
    v_mfma_f32_16x16x32_bf16 v[196:199], v[116:119], v[96:99], v[196:199]
    v_mfma_f32_16x16x32_bf16 v[200:203], v[120:123], v[96:99], v[200:203]
    v_mfma_f32_16x16x32_bf16 v[204:207], v[124:127], v[96:99], v[204:207]
    v_mfma_f32_16x16x32_bf16 v[208:211], v[112:115], v[100:103], v[208:211]
    v_mfma_f32_16x16x32_bf16 v[212:215], v[116:119], v[100:103], v[212:215]
    v_mfma_f32_16x16x32_bf16 v[216:219], v[120:123], v[100:103], v[216:219]
    v_mfma_f32_16x16x32_bf16 v[220:223], v[124:127], v[100:103], v[220:223]
    v_mfma_f32_16x16x32_bf16 v[224:227], v[112:115], v[104:107], v[224:227]
    v_mfma_f32_16x16x32_bf16 v[228:231], v[116:119], v[104:107], v[228:231]
    v_mfma_f32_16x16x32_bf16 v[232:235], v[120:123], v[104:107], v[232:235]
    v_mfma_f32_16x16x32_bf16 v[236:239], v[124:127], v[104:107], v[236:239]
    v_mfma_f32_16x16x32_bf16 v[240:243], v[112:115], v[108:111], v[240:243]
    v_mfma_f32_16x16x32_bf16 v[244:247], v[116:119], v[108:111], v[244:247]
    v_mfma_f32_16x16x32_bf16 v[248:251], v[120:123], v[108:111], v[248:251]
    v_mfma_f32_16x16x32_bf16 v[252:255], v[124:127], v[108:111], v[252:255]
    s_waitcnt lgkmcnt(0)
    s_waitcnt vmcnt(0)
    s_barrier
    v_mfma_f32_16x16x32_bf16 v[128:131], v[64:67], v[32:35], v[128:131]
    ds_read_b64_tr_b16 v[112:113], v12 offset:49152
    v_mfma_f32_16x16x32_bf16 v[132:135], v[68:71], v[32:35], v[132:135]
    ds_read_b64_tr_b16 v[114:115], v13 offset:49152
    v_mfma_f32_16x16x32_bf16 v[136:139], v[72:75], v[32:35], v[136:139]
    ds_read_b64_tr_b16 v[116:117], v14 offset:49152
    v_mfma_f32_16x16x32_bf16 v[140:143], v[76:79], v[32:35], v[140:143]
    ds_read_b64_tr_b16 v[118:119], v15 offset:49152
    v_mfma_f32_16x16x32_bf16 v[144:147], v[64:67], v[36:39], v[144:147]
    ds_read_b64_tr_b16 v[120:121], v12 offset:57344
    v_mfma_f32_16x16x32_bf16 v[148:151], v[68:71], v[36:39], v[148:151]
    ds_read_b64_tr_b16 v[122:123], v13 offset:57344
    v_mfma_f32_16x16x32_bf16 v[152:155], v[72:75], v[36:39], v[152:155]
    ds_read_b64_tr_b16 v[124:125], v14 offset:57344
    v_mfma_f32_16x16x32_bf16 v[156:159], v[76:79], v[36:39], v[156:159]
    ds_read_b64_tr_b16 v[126:127], v15 offset:57344
    v_mfma_f32_16x16x32_bf16 v[160:163], v[64:67], v[40:43], v[160:163]
    ds_read_b128 v[80:83], v6 offset:32768
    v_mfma_f32_16x16x32_bf16 v[164:167], v[68:71], v[40:43], v[164:167]
    ds_read_b128 v[84:87], v6 offset:33792
    v_mfma_f32_16x16x32_bf16 v[168:171], v[72:75], v[40:43], v[168:171]
    ds_read_b128 v[88:91], v6 offset:34816
    v_mfma_f32_16x16x32_bf16 v[172:175], v[76:79], v[40:43], v[172:175]
    ds_read_b128 v[92:95], v6 offset:35840
    v_mfma_f32_16x16x32_bf16 v[176:179], v[64:67], v[44:47], v[176:179]
    ds_read_b128 v[96:99], v6 offset:36864
    v_mfma_f32_16x16x32_bf16 v[180:183], v[68:71], v[44:47], v[180:183]
    ds_read_b128 v[100:103], v6 offset:37888
    v_mfma_f32_16x16x32_bf16 v[184:187], v[72:75], v[44:47], v[184:187]
    ds_read_b128 v[104:107], v6 offset:38912
    v_mfma_f32_16x16x32_bf16 v[188:191], v[76:79], v[44:47], v[188:191]
    ds_read_b128 v[108:111], v6 offset:39936
    v_mfma_f32_16x16x32_bf16 v[192:195], v[64:67], v[48:51], v[192:195]
    v_mfma_f32_16x16x32_bf16 v[196:199], v[68:71], v[48:51], v[196:199]
    v_mfma_f32_16x16x32_bf16 v[200:203], v[72:75], v[48:51], v[200:203]
    v_mfma_f32_16x16x32_bf16 v[204:207], v[76:79], v[48:51], v[204:207]
    v_mfma_f32_16x16x32_bf16 v[208:211], v[64:67], v[52:55], v[208:211]
    v_mfma_f32_16x16x32_bf16 v[212:215], v[68:71], v[52:55], v[212:215]
    v_mfma_f32_16x16x32_bf16 v[216:219], v[72:75], v[52:55], v[216:219]
    v_mfma_f32_16x16x32_bf16 v[220:223], v[76:79], v[52:55], v[220:223]
    v_mfma_f32_16x16x32_bf16 v[224:227], v[64:67], v[56:59], v[224:227]
    v_mfma_f32_16x16x32_bf16 v[228:231], v[68:71], v[56:59], v[228:231]
    v_mfma_f32_16x16x32_bf16 v[232:235], v[72:75], v[56:59], v[232:235]
    v_mfma_f32_16x16x32_bf16 v[236:239], v[76:79], v[56:59], v[236:239]
    v_mfma_f32_16x16x32_bf16 v[240:243], v[64:67], v[60:63], v[240:243]
    v_mfma_f32_16x16x32_bf16 v[244:247], v[68:71], v[60:63], v[244:247]
    v_mfma_f32_16x16x32_bf16 v[248:251], v[72:75], v[60:63], v[248:251]
    v_mfma_f32_16x16x32_bf16 v[252:255], v[76:79], v[60:63], v[252:255]
    s_waitcnt lgkmcnt(0)
    s_waitcnt vmcnt(0)
    s_barrier
    v_mfma_f32_16x16x32_bf16 v[128:131], v[112:115], v[80:83], v[128:131]
    ds_read_b64_tr_b16 v[64:65], v8 offset:16384
    v_mfma_f32_16x16x32_bf16 v[132:135], v[116:119], v[80:83], v[132:135]
    ds_read_b64_tr_b16 v[66:67], v9 offset:16384
    v_mfma_f32_16x16x32_bf16 v[136:139], v[120:123], v[80:83], v[136:139]
    ds_read_b64_tr_b16 v[68:69], v10 offset:16384
    v_mfma_f32_16x16x32_bf16 v[140:143], v[124:127], v[80:83], v[140:143]
    ds_read_b64_tr_b16 v[70:71], v11 offset:16384
    v_mfma_f32_16x16x32_bf16 v[144:147], v[112:115], v[84:87], v[144:147]
    ds_read_b64_tr_b16 v[72:73], v8 offset:24576
    v_mfma_f32_16x16x32_bf16 v[148:151], v[116:119], v[84:87], v[148:151]
    ds_read_b64_tr_b16 v[74:75], v9 offset:24576
    v_mfma_f32_16x16x32_bf16 v[152:155], v[120:123], v[84:87], v[152:155]
    ds_read_b64_tr_b16 v[76:77], v10 offset:24576
    v_mfma_f32_16x16x32_bf16 v[156:159], v[124:127], v[84:87], v[156:159]
    ds_read_b64_tr_b16 v[78:79], v11 offset:24576
    v_mfma_f32_16x16x32_bf16 v[160:163], v[112:115], v[88:91], v[160:163]
    ds_read_b128 v[32:35], v5 offset:0
    v_mfma_f32_16x16x32_bf16 v[164:167], v[116:119], v[88:91], v[164:167]
    ds_read_b128 v[36:39], v5 offset:1024
    v_mfma_f32_16x16x32_bf16 v[168:171], v[120:123], v[88:91], v[168:171]
    ds_read_b128 v[40:43], v5 offset:2048
    v_mfma_f32_16x16x32_bf16 v[172:175], v[124:127], v[88:91], v[172:175]
    ds_read_b128 v[44:47], v5 offset:3072
    v_mfma_f32_16x16x32_bf16 v[176:179], v[112:115], v[92:95], v[176:179]
    ds_read_b128 v[48:51], v5 offset:4096
    v_mfma_f32_16x16x32_bf16 v[180:183], v[116:119], v[92:95], v[180:183]
    ds_read_b128 v[52:55], v5 offset:5120
    v_mfma_f32_16x16x32_bf16 v[184:187], v[120:123], v[92:95], v[184:187]
    ds_read_b128 v[56:59], v5 offset:6144
    v_mfma_f32_16x16x32_bf16 v[188:191], v[124:127], v[92:95], v[188:191]
    ds_read_b128 v[60:63], v5 offset:7168
    v_mfma_f32_16x16x32_bf16 v[192:195], v[112:115], v[96:99], v[192:195]
    v_mfma_f32_16x16x32_bf16 v[196:199], v[116:119], v[96:99], v[196:199]
    v_mfma_f32_16x16x32_bf16 v[200:203], v[120:123], v[96:99], v[200:203]
    v_mfma_f32_16x16x32_bf16 v[204:207], v[124:127], v[96:99], v[204:207]
    v_mfma_f32_16x16x32_bf16 v[208:211], v[112:115], v[100:103], v[208:211]
    v_mfma_f32_16x16x32_bf16 v[212:215], v[116:119], v[100:103], v[212:215]
    v_mfma_f32_16x16x32_bf16 v[216:219], v[120:123], v[100:103], v[216:219]
    v_mfma_f32_16x16x32_bf16 v[220:223], v[124:127], v[100:103], v[220:223]
    v_mfma_f32_16x16x32_bf16 v[224:227], v[112:115], v[104:107], v[224:227]
    v_mfma_f32_16x16x32_bf16 v[228:231], v[116:119], v[104:107], v[228:231]
    v_mfma_f32_16x16x32_bf16 v[232:235], v[120:123], v[104:107], v[232:235]
    v_mfma_f32_16x16x32_bf16 v[236:239], v[124:127], v[104:107], v[236:239]
    v_mfma_f32_16x16x32_bf16 v[240:243], v[112:115], v[108:111], v[240:243]
    v_mfma_f32_16x16x32_bf16 v[244:247], v[116:119], v[108:111], v[244:247]
    v_mfma_f32_16x16x32_bf16 v[248:251], v[120:123], v[108:111], v[248:251]
    v_mfma_f32_16x16x32_bf16 v[252:255], v[124:127], v[108:111], v[252:255]
    s_waitcnt lgkmcnt(0)
w_end:
    v_mov_b32 v20, 131072
    ds_read_b128 v[24:27], v20
    ds_read_b128 v[28:31], v20 offset:16
    s_cmp_eq_u32 s48, 2
    s_cbranch_scc1 w_epi_glu
    s_cmp_eq_u32 s48, 3
    s_cbranch_scc1 w_epi_silu
    s_lshl_b32 s30, s27, 10
    s_add_u32 s30, s30, s49
    s_nop 7
    v_cvt_pk_bf16_f32 v80, v128, v129
    v_cvt_pk_bf16_f32 v81, v130, v131
    v_cvt_pk_bf16_f32 v82, v132, v133
    v_cvt_pk_bf16_f32 v83, v134, v135
    buffer_store_dwordx4 v[80:83], v1, s[4:7], s30 offen sc1
    v_cvt_pk_bf16_f32 v84, v136, v137
    v_cvt_pk_bf16_f32 v85, v138, v139
    v_cvt_pk_bf16_f32 v86, v140, v141
    v_cvt_pk_bf16_f32 v87, v142, v143
    buffer_store_dwordx4 v[84:87], v19, s[4:7], s30 offen sc1
    s_add_u32 s30, s30, s50
    v_cvt_pk_bf16_f32 v88, v144, v145
    v_cvt_pk_bf16_f32 v89, v146, v147
    v_cvt_pk_bf16_f32 v90, v148, v149
    v_cvt_pk_bf16_f32 v91, v150, v151
    buffer_store_dwordx4 v[88:91], v1, s[4:7], s30 offen sc1
    v_cvt_pk_bf16_f32 v92, v152, v153
    v_cvt_pk_bf16_f32 v93, v154, v155
    v_cvt_pk_bf16_f32 v94, v156, v157
    v_cvt_pk_bf16_f32 v95, v158, v159
    buffer_store_dwordx4 v[92:95], v19, s[4:7], s30 offen sc1
    s_add_u32 s30, s30, s50
    v_cvt_pk_bf16_f32 v80, v160, v161
    v_cvt_pk_bf16_f32 v81, v162, v163
    v_cvt_pk_bf16_f32 v82, v164, v165
    v_cvt_pk_bf16_f32 v83, v166, v167
    buffer_store_dwordx4 v[80:83], v1, s[4:7], s30 offen sc1
    v_cvt_pk_bf16_f32 v84, v168, v169
    v_cvt_pk_bf16_f32 v85, v170, v171
    v_cvt_pk_bf16_f32 v86, v172, v173
    v_cvt_pk_bf16_f32 v87, v174, v175
    buffer_store_dwordx4 v[84:87], v19, s[4:7], s30 offen sc1
    s_add_u32 s30, s30, s50
    v_cvt_pk_bf16_f32 v88, v176, v177
    v_cvt_pk_bf16_f32 v89, v178, v179
    v_cvt_pk_bf16_f32 v90, v180, v181
    v_cvt_pk_bf16_f32 v91, v182, v183
    buffer_store_dwordx4 v[88:91], v1, s[4:7], s30 offen sc1
    v_cvt_pk_bf16_f32 v92, v184, v185
    v_cvt_pk_bf16_f32 v93, v186, v187
    v_cvt_pk_bf16_f32 v94, v188, v189
    v_cvt_pk_bf16_f32 v95, v190, v191
    buffer_store_dwordx4 v[92:95], v19, s[4:7], s30 offen sc1
    s_add_u32 s30, s30, s50
    v_cvt_pk_bf16_f32 v80, v192, v193
    v_cvt_pk_bf16_f32 v81, v194, v195
    v_cvt_pk_bf16_f32 v82, v196, v197
    v_cvt_pk_bf16_f32 v83, v198, v199
    buffer_store_dwordx4 v[80:83], v1, s[4:7], s30 offen sc1
    v_cvt_pk_bf16_f32 v84, v200, v201
    v_cvt_pk_bf16_f32 v85, v202, v203
    v_cvt_pk_bf16_f32 v86, v204, v205
    v_cvt_pk_bf16_f32 v87, v206, v207
    buffer_store_dwordx4 v[84:87], v19, s[4:7], s30 offen sc1
    s_add_u32 s30, s30, s50
    v_cvt_pk_bf16_f32 v88, v208, v209
    v_cvt_pk_bf16_f32 v89, v210, v211
    v_cvt_pk_bf16_f32 v90, v212, v213
    v_cvt_pk_bf16_f32 v91, v214, v215
    buffer_store_dwordx4 v[88:91], v1, s[4:7], s30 offen sc1
    v_cvt_pk_bf16_f32 v92, v216, v217
    v_cvt_pk_bf16_f32 v93, v218, v219
    v_cvt_pk_bf16_f32 v94, v220, v221
    v_cvt_pk_bf16_f32 v95, v222, v223
    buffer_store_dwordx4 v[92:95], v19, s[4:7], s30 offen sc1
    s_add_u32 s30, s30, s50
    v_cvt_pk_bf16_f32 v80, v224, v225
    v_cvt_pk_bf16_f32 v81, v226, v227
    v_cvt_pk_bf16_f32 v82, v228, v229
    v_cvt_pk_bf16_f32 v83, v230, v231
    buffer_store_dwordx4 v[80:83], v1, s[4:7], s30 offen sc1
    v_cvt_pk_bf16_f32 v84, v232, v233
    v_cvt_pk_bf16_f32 v85, v234, v235
    v_cvt_pk_bf16_f32 v86, v236, v237
    v_cvt_pk_bf16_f32 v87, v238, v239
    buffer_store_dwordx4 v[84:87], v19, s[4:7], s30 offen sc1
    s_add_u32 s30, s30, s50
    v_cvt_pk_bf16_f32 v88, v240, v241
    v_cvt_pk_bf16_f32 v89, v242, v243
    v_cvt_pk_bf16_f32 v90, v244, v245
    v_cvt_pk_bf16_f32 v91, v246, v247
    buffer_store_dwordx4 v[88:91], v1, s[4:7], s30 offen sc1
    v_cvt_pk_bf16_f32 v92, v248, v249
    v_cvt_pk_bf16_f32 v93, v250, v251
    v_cvt_pk_bf16_f32 v94, v252, v253
    v_cvt_pk_bf16_f32 v95, v254, v255
    buffer_store_dwordx4 v[92:95], v19, s[4:7], s30 offen sc1
    s_waitcnt lgkmcnt(0)
    v_or3_b32 v24, v24, v25, v26
    v_or3_b32 v28, v28, v29, v30
    v_or3_b32 v24, v24, v27, v31
    v_or_b32 v24, v24, v28
    s_mov_b32 s28, s51
    s_mov_b32 s57, s53
    v_readfirstlane_b32 s30, v24
    s_cmp_lg_u32 s30, 0
    s_cbranch_scc1 w_drain
    s_mov_b32 s48, s32
    s_cmp_ge_u32 s32, 4
    s_cselect_b32 s30, 2, 3
    s_lshl_b32 s30, s26, s30
    s_mul_i32 s30, s30, s43
    s_add_u32 s49, s42, s30
    s_mov_b32 s50, s43
    s_mov_b32 s51, s46
    s_mov_b32 s23, s41
    s_mov_b32 s53, s47
    s_nop 0
    s_load_dwordx16 s[32:47], s[24:25], 0
    s_add_u32 s24, s24, 64
    s_addc_u32 s25, s25, 0
    s_branch w_first16
w_epi_glu:
    s_lshl_b32 s30, s27, 10
    s_add_u32 s30, s30, s49
    s_mov_b32 s54, 0xbfb8aa3b
    s_nop 7
    v_cvt_pk_bf16_f32 v80, v128, v129
    v_cvt_pk_bf16_f32 v81, v130, v131
    v_cvt_pk_bf16_f32 v82, v132, v133
    v_cvt_pk_bf16_f32 v83, v134, v135
    v_lshlrev_b32 v96, 16, v80
    v_and_b32 v97, 0xffff0000, v80
    v_lshlrev_b32 v98, 16, v81
    v_and_b32 v99, 0xffff0000, v81
    v_lshlrev_b32 v100, 16, v82
    v_and_b32 v101, 0xffff0000, v82
    v_lshlrev_b32 v102, 16, v83
    v_and_b32 v103, 0xffff0000, v83
    v_mul_f32 v96, s54, v96
    v_mul_f32 v97, s54, v97
    v_mul_f32 v98, s54, v98
    v_mul_f32 v99, s54, v99
    v_mul_f32 v100, s54, v100
    v_mul_f32 v101, s54, v101
    v_mul_f32 v102, s54, v102
    v_mul_f32 v103, s54, v103
    v_exp_f32 v96, v96
    v_exp_f32 v97, v97
    v_exp_f32 v98, v98
    v_exp_f32 v99, v99
    v_exp_f32 v100, v100
    v_exp_f32 v101, v101
    v_exp_f32 v102, v102
    v_exp_f32 v103, v103
    v_add_f32 v96, 1.0, v96
    v_add_f32 v97, 1.0, v97
    v_add_f32 v98, 1.0, v98
    v_add_f32 v99, 1.0, v99
    v_add_f32 v100, 1.0, v100
    v_add_f32 v101, 1.0, v101
    v_add_f32 v102, 1.0, v102
    v_add_f32 v103, 1.0, v103
    v_rcp_f32 v96, v96
    v_rcp_f32 v97, v97
    v_rcp_f32 v98, v98
    v_rcp_f32 v99, v99
    v_rcp_f32 v100, v100
    v_rcp_f32 v101, v101
    v_rcp_f32 v102, v102
    v_rcp_f32 v103, v103
    v_mul_f32 v96, v96, v136
    v_mul_f32 v97, v97, v137
    v_mul_f32 v98, v98, v138
    v_mul_f32 v99, v99, v139
    v_mul_f32 v100, v100, v140
    v_mul_f32 v101, v101, v141
    v_mul_f32 v102, v102, v142
    v_mul_f32 v103, v103, v143
    v_cvt_pk_bf16_f32 v80, v96, v97
    v_cvt_pk_bf16_f32 v81, v98, v99
    v_cvt_pk_bf16_f32 v82, v100, v101
    v_cvt_pk_bf16_f32 v83, v102, v103
    buffer_store_dwordx4 v[80:83], v1, s[4:7], s30 offen sc1
    s_add_u32 s30, s30, s50
    v_cvt_pk_bf16_f32 v84, v144, v145
    v_cvt_pk_bf16_f32 v85, v146, v147
    v_cvt_pk_bf16_f32 v86, v148, v149
    v_cvt_pk_bf16_f32 v87, v150, v151
    v_lshlrev_b32 v104, 16, v84
    v_and_b32 v105, 0xffff0000, v84
    v_lshlrev_b32 v106, 16, v85
    v_and_b32 v107, 0xffff0000, v85
    v_lshlrev_b32 v108, 16, v86
    v_and_b32 v109, 0xffff0000, v86
    v_lshlrev_b32 v110, 16, v87
    v_and_b32 v111, 0xffff0000, v87
    v_mul_f32 v104, s54, v104
    v_mul_f32 v105, s54, v105
    v_mul_f32 v106, s54, v106
    v_mul_f32 v107, s54, v107
    v_mul_f32 v108, s54, v108
    v_mul_f32 v109, s54, v109
    v_mul_f32 v110, s54, v110
    v_mul_f32 v111, s54, v111
    v_exp_f32 v104, v104
    v_exp_f32 v105, v105
    v_exp_f32 v106, v106
    v_exp_f32 v107, v107
    v_exp_f32 v108, v108
    v_exp_f32 v109, v109
    v_exp_f32 v110, v110
    v_exp_f32 v111, v111
    v_add_f32 v104, 1.0, v104
    v_add_f32 v105, 1.0, v105
    v_add_f32 v106, 1.0, v106
    v_add_f32 v107, 1.0, v107
    v_add_f32 v108, 1.0, v108
    v_add_f32 v109, 1.0, v109
    v_add_f32 v110, 1.0, v110
    v_add_f32 v111, 1.0, v111
    v_rcp_f32 v104, v104
    v_rcp_f32 v105, v105
    v_rcp_f32 v106, v106
    v_rcp_f32 v107, v107
    v_rcp_f32 v108, v108
    v_rcp_f32 v109, v109
    v_rcp_f32 v110, v110
    v_rcp_f32 v111, v111
    v_mul_f32 v104, v104, v152
    v_mul_f32 v105, v105, v153
    v_mul_f32 v106, v106, v154
    v_mul_f32 v107, v107, v155
    v_mul_f32 v108, v108, v156
    v_mul_f32 v109, v109, v157
    v_mul_f32 v110, v110, v158
    v_mul_f32 v111, v111, v159
    v_cvt_pk_bf16_f32 v84, v104, v105
    v_cvt_pk_bf16_f32 v85, v106, v107
    v_cvt_pk_bf16_f32 v86, v108, v109
    v_cvt_pk_bf16_f32 v87, v110, v111
    buffer_store_dwordx4 v[84:87], v1, s[4:7], s30 offen sc1
    s_add_u32 s30, s30, s50
    v_cvt_pk_bf16_f32 v88, v160, v161
    v_cvt_pk_bf16_f32 v89, v162, v163
    v_cvt_pk_bf16_f32 v90, v164, v165
    v_cvt_pk_bf16_f32 v91, v166, v167
    v_lshlrev_b32 v96, 16, v88
    v_and_b32 v97, 0xffff0000, v88
    v_lshlrev_b32 v98, 16, v89
    v_and_b32 v99, 0xffff0000, v89
    v_lshlrev_b32 v100, 16, v90
    v_and_b32 v101, 0xffff0000, v90
    v_lshlrev_b32 v102, 16, v91
    v_and_b32 v103, 0xffff0000, v91
    v_mul_f32 v96, s54, v96
    v_mul_f32 v97, s54, v97
    v_mul_f32 v98, s54, v98
    v_mul_f32 v99, s54, v99
    v_mul_f32 v100, s54, v100
    v_mul_f32 v101, s54, v101
    v_mul_f32 v102, s54, v102
    v_mul_f32 v103, s54, v103
    v_exp_f32 v96, v96
    v_exp_f32 v97, v97
    v_exp_f32 v98, v98
    v_exp_f32 v99, v99
    v_exp_f32 v100, v100
    v_exp_f32 v101, v101
    v_exp_f32 v102, v102
    v_exp_f32 v103, v103
    v_add_f32 v96, 1.0, v96
    v_add_f32 v97, 1.0, v97
    v_add_f32 v98, 1.0, v98
    v_add_f32 v99, 1.0, v99
    v_add_f32 v100, 1.0, v100
    v_add_f32 v101, 1.0, v101
    v_add_f32 v102, 1.0, v102
    v_add_f32 v103, 1.0, v103
    v_rcp_f32 v96, v96
    v_rcp_f32 v97, v97
    v_rcp_f32 v98, v98
    v_rcp_f32 v99, v99
    v_rcp_f32 v100, v100
    v_rcp_f32 v101, v101
    v_rcp_f32 v102, v102
    v_rcp_f32 v103, v103
    v_mul_f32 v96, v96, v168
    v_mul_f32 v97, v97, v169
    v_mul_f32 v98, v98, v170
    v_mul_f32 v99, v99, v171
    v_mul_f32 v100, v100, v172
    v_mul_f32 v101, v101, v173
    v_mul_f32 v102, v102, v174
    v_mul_f32 v103, v103, v175
    v_cvt_pk_bf16_f32 v88, v96, v97
    v_cvt_pk_bf16_f32 v89, v98, v99
    v_cvt_pk_bf16_f32 v90, v100, v101
    v_cvt_pk_bf16_f32 v91, v102, v103
    buffer_store_dwordx4 v[88:91], v1, s[4:7], s30 offen sc1
    s_add_u32 s30, s30, s50
    v_cvt_pk_bf16_f32 v92, v176, v177
    v_cvt_pk_bf16_f32 v93, v178, v179
    v_cvt_pk_bf16_f32 v94, v180, v181
    v_cvt_pk_bf16_f32 v95, v182, v183
    v_lshlrev_b32 v104, 16, v92
    v_and_b32 v105, 0xffff0000, v92
    v_lshlrev_b32 v106, 16, v93
    v_and_b32 v107, 0xffff0000, v93
    v_lshlrev_b32 v108, 16, v94
    v_and_b32 v109, 0xffff0000, v94
    v_lshlrev_b32 v110, 16, v95
    v_and_b32 v111, 0xffff0000, v95
    v_mul_f32 v104, s54, v104
    v_mul_f32 v105, s54, v105
    v_mul_f32 v106, s54, v106
    v_mul_f32 v107, s54, v107
    v_mul_f32 v108, s54, v108
    v_mul_f32 v109, s54, v109
    v_mul_f32 v110, s54, v110
    v_mul_f32 v111, s54, v111
    v_exp_f32 v104, v104
    v_exp_f32 v105, v105
    v_exp_f32 v106, v106
    v_exp_f32 v107, v107
    v_exp_f32 v108, v108
    v_exp_f32 v109, v109
    v_exp_f32 v110, v110
    v_exp_f32 v111, v111
    v_add_f32 v104, 1.0, v104
    v_add_f32 v105, 1.0, v105
    v_add_f32 v106, 1.0, v106
    v_add_f32 v107, 1.0, v107
    v_add_f32 v108, 1.0, v108
    v_add_f32 v109, 1.0, v109
    v_add_f32 v110, 1.0, v110
    v_add_f32 v111, 1.0, v111
    v_rcp_f32 v104, v104
    v_rcp_f32 v105, v105
    v_rcp_f32 v106, v106
    v_rcp_f32 v107, v107
    v_rcp_f32 v108, v108
    v_rcp_f32 v109, v109
    v_rcp_f32 v110, v110
    v_rcp_f32 v111, v111
    v_mul_f32 v104, v104, v184
    v_mul_f32 v105, v105, v185
    v_mul_f32 v106, v106, v186
    v_mul_f32 v107, v107, v187
    v_mul_f32 v108, v108, v188
    v_mul_f32 v109, v109, v189
    v_mul_f32 v110, v110, v190
    v_mul_f32 v111, v111, v191
    v_cvt_pk_bf16_f32 v92, v104, v105
    v_cvt_pk_bf16_f32 v93, v106, v107
    v_cvt_pk_bf16_f32 v94, v108, v109
    v_cvt_pk_bf16_f32 v95, v110, v111
    buffer_store_dwordx4 v[92:95], v1, s[4:7], s30 offen sc1
    s_add_u32 s30, s30, s50
    v_cvt_pk_bf16_f32 v80, v192, v193
    v_cvt_pk_bf16_f32 v81, v194, v195
    v_cvt_pk_bf16_f32 v82, v196, v197
    v_cvt_pk_bf16_f32 v83, v198, v199
    v_lshlrev_b32 v96, 16, v80
    v_and_b32 v97, 0xffff0000, v80
    v_lshlrev_b32 v98, 16, v81
    v_and_b32 v99, 0xffff0000, v81
    v_lshlrev_b32 v100, 16, v82
    v_and_b32 v101, 0xffff0000, v82
    v_lshlrev_b32 v102, 16, v83
    v_and_b32 v103, 0xffff0000, v83
    v_mul_f32 v96, s54, v96
    v_mul_f32 v97, s54, v97
    v_mul_f32 v98, s54, v98
    v_mul_f32 v99, s54, v99
    v_mul_f32 v100, s54, v100
    v_mul_f32 v101, s54, v101
    v_mul_f32 v102, s54, v102
    v_mul_f32 v103, s54, v103
    v_exp_f32 v96, v96
    v_exp_f32 v97, v97
    v_exp_f32 v98, v98
    v_exp_f32 v99, v99
    v_exp_f32 v100, v100
    v_exp_f32 v101, v101
    v_exp_f32 v102, v102
    v_exp_f32 v103, v103
    v_add_f32 v96, 1.0, v96
    v_add_f32 v97, 1.0, v97
    v_add_f32 v98, 1.0, v98
    v_add_f32 v99, 1.0, v99
    v_add_f32 v100, 1.0, v100
    v_add_f32 v101, 1.0, v101
    v_add_f32 v102, 1.0, v102
    v_add_f32 v103, 1.0, v103
    v_rcp_f32 v96, v96
    v_rcp_f32 v97, v97
    v_rcp_f32 v98, v98
    v_rcp_f32 v99, v99
    v_rcp_f32 v100, v100
    v_rcp_f32 v101, v101
    v_rcp_f32 v102, v102
    v_rcp_f32 v103, v103
    v_mul_f32 v96, v96, v200
    v_mul_f32 v97, v97, v201
    v_mul_f32 v98, v98, v202
    v_mul_f32 v99, v99, v203
    v_mul_f32 v100, v100, v204
    v_mul_f32 v101, v101, v205
    v_mul_f32 v102, v102, v206
    v_mul_f32 v103, v103, v207
    v_cvt_pk_bf16_f32 v80, v96, v97
    v_cvt_pk_bf16_f32 v81, v98, v99
    v_cvt_pk_bf16_f32 v82, v100, v101
    v_cvt_pk_bf16_f32 v83, v102, v103
    buffer_store_dwordx4 v[80:83], v1, s[4:7], s30 offen sc1
    s_add_u32 s30, s30, s50
    v_cvt_pk_bf16_f32 v84, v208, v209
    v_cvt_pk_bf16_f32 v85, v210, v211
    v_cvt_pk_bf16_f32 v86, v212, v213
    v_cvt_pk_bf16_f32 v87, v214, v215
    v_lshlrev_b32 v104, 16, v84
    v_and_b32 v105, 0xffff0000, v84
    v_lshlrev_b32 v106, 16, v85
    v_and_b32 v107, 0xffff0000, v85
    v_lshlrev_b32 v108, 16, v86
    v_and_b32 v109, 0xffff0000, v86
    v_lshlrev_b32 v110, 16, v87
    v_and_b32 v111, 0xffff0000, v87
    v_mul_f32 v104, s54, v104
    v_mul_f32 v105, s54, v105
    v_mul_f32 v106, s54, v106
    v_mul_f32 v107, s54, v107
    v_mul_f32 v108, s54, v108
    v_mul_f32 v109, s54, v109
    v_mul_f32 v110, s54, v110
    v_mul_f32 v111, s54, v111
    v_exp_f32 v104, v104
    v_exp_f32 v105, v105
    v_exp_f32 v106, v106
    v_exp_f32 v107, v107
    v_exp_f32 v108, v108
    v_exp_f32 v109, v109
    v_exp_f32 v110, v110
    v_exp_f32 v111, v111
    v_add_f32 v104, 1.0, v104
    v_add_f32 v105, 1.0, v105
    v_add_f32 v106, 1.0, v106
    v_add_f32 v107, 1.0, v107
    v_add_f32 v108, 1.0, v108
    v_add_f32 v109, 1.0, v109
    v_add_f32 v110, 1.0, v110
    v_add_f32 v111, 1.0, v111
    v_rcp_f32 v104, v104
    v_rcp_f32 v105, v105
    v_rcp_f32 v106, v106
    v_rcp_f32 v107, v107
    v_rcp_f32 v108, v108
    v_rcp_f32 v109, v109
    v_rcp_f32 v110, v110
    v_rcp_f32 v111, v111
    v_mul_f32 v104, v104, v216
    v_mul_f32 v105, v105, v217
    v_mul_f32 v106, v106, v218
    v_mul_f32 v107, v107, v219
    v_mul_f32 v108, v108, v220
    v_mul_f32 v109, v109, v221
    v_mul_f32 v110, v110, v222
    v_mul_f32 v111, v111, v223
    v_cvt_pk_bf16_f32 v84, v104, v105
    v_cvt_pk_bf16_f32 v85, v106, v107
    v_cvt_pk_bf16_f32 v86, v108, v109
    v_cvt_pk_bf16_f32 v87, v110, v111
    buffer_store_dwordx4 v[84:87], v1, s[4:7], s30 offen sc1
    s_add_u32 s30, s30, s50
    v_cvt_pk_bf16_f32 v88, v224, v225
    v_cvt_pk_bf16_f32 v89, v226, v227
    v_cvt_pk_bf16_f32 v90, v228, v229
    v_cvt_pk_bf16_f32 v91, v230, v231
    v_lshlrev_b32 v96, 16, v88
    v_and_b32 v97, 0xffff0000, v88
    v_lshlrev_b32 v98, 16, v89
    v_and_b32 v99, 0xffff0000, v89
    v_lshlrev_b32 v100, 16, v90
    v_and_b32 v101, 0xffff0000, v90
    v_lshlrev_b32 v102, 16, v91
    v_and_b32 v103, 0xffff0000, v91
    v_mul_f32 v96, s54, v96
    v_mul_f32 v97, s54, v97
    v_mul_f32 v98, s54, v98
    v_mul_f32 v99, s54, v99
    v_mul_f32 v100, s54, v100
    v_mul_f32 v101, s54, v101
    v_mul_f32 v102, s54, v102
    v_mul_f32 v103, s54, v103
    v_exp_f32 v96, v96
    v_exp_f32 v97, v97
    v_exp_f32 v98, v98
    v_exp_f32 v99, v99
    v_exp_f32 v100, v100
    v_exp_f32 v101, v101
    v_exp_f32 v102, v102
    v_exp_f32 v103, v103
    v_add_f32 v96, 1.0, v96
    v_add_f32 v97, 1.0, v97
    v_add_f32 v98, 1.0, v98
    v_add_f32 v99, 1.0, v99
    v_add_f32 v100, 1.0, v100
    v_add_f32 v101, 1.0, v101
    v_add_f32 v102, 1.0, v102
    v_add_f32 v103, 1.0, v103
    v_rcp_f32 v96, v96
    v_rcp_f32 v97, v97
    v_rcp_f32 v98, v98
    v_rcp_f32 v99, v99
    v_rcp_f32 v100, v100
    v_rcp_f32 v101, v101
    v_rcp_f32 v102, v102
    v_rcp_f32 v103, v103
    v_mul_f32 v96, v96, v232
    v_mul_f32 v97, v97, v233
    v_mul_f32 v98, v98, v234
    v_mul_f32 v99, v99, v235
    v_mul_f32 v100, v100, v236
    v_mul_f32 v101, v101, v237
    v_mul_f32 v102, v102, v238
    v_mul_f32 v103, v103, v239
    v_cvt_pk_bf16_f32 v88, v96, v97
    v_cvt_pk_bf16_f32 v89, v98, v99
    v_cvt_pk_bf16_f32 v90, v100, v101
    v_cvt_pk_bf16_f32 v91, v102, v103
    buffer_store_dwordx4 v[88:91], v1, s[4:7], s30 offen sc1
    s_add_u32 s30, s30, s50
    v_cvt_pk_bf16_f32 v92, v240, v241
    v_cvt_pk_bf16_f32 v93, v242, v243
    v_cvt_pk_bf16_f32 v94, v244, v245
    v_cvt_pk_bf16_f32 v95, v246, v247
    v_lshlrev_b32 v104, 16, v92
    v_and_b32 v105, 0xffff0000, v92
    v_lshlrev_b32 v106, 16, v93
    v_and_b32 v107, 0xffff0000, v93
    v_lshlrev_b32 v108, 16, v94
    v_and_b32 v109, 0xffff0000, v94
    v_lshlrev_b32 v110, 16, v95
    v_and_b32 v111, 0xffff0000, v95
    v_mul_f32 v104, s54, v104
    v_mul_f32 v105, s54, v105
    v_mul_f32 v106, s54, v106
    v_mul_f32 v107, s54, v107
    v_mul_f32 v108, s54, v108
    v_mul_f32 v109, s54, v109
    v_mul_f32 v110, s54, v110
    v_mul_f32 v111, s54, v111
    v_exp_f32 v104, v104
    v_exp_f32 v105, v105
    v_exp_f32 v106, v106
    v_exp_f32 v107, v107
    v_exp_f32 v108, v108
    v_exp_f32 v109, v109
    v_exp_f32 v110, v110
    v_exp_f32 v111, v111
    v_add_f32 v104, 1.0, v104
    v_add_f32 v105, 1.0, v105
    v_add_f32 v106, 1.0, v106
    v_add_f32 v107, 1.0, v107
    v_add_f32 v108, 1.0, v108
    v_add_f32 v109, 1.0, v109
    v_add_f32 v110, 1.0, v110
    v_add_f32 v111, 1.0, v111
    v_rcp_f32 v104, v104
    v_rcp_f32 v105, v105
    v_rcp_f32 v106, v106
    v_rcp_f32 v107, v107
    v_rcp_f32 v108, v108
    v_rcp_f32 v109, v109
    v_rcp_f32 v110, v110
    v_rcp_f32 v111, v111
    v_mul_f32 v104, v104, v248
    v_mul_f32 v105, v105, v249
    v_mul_f32 v106, v106, v250
    v_mul_f32 v107, v107, v251
    v_mul_f32 v108, v108, v252
    v_mul_f32 v109, v109, v253
    v_mul_f32 v110, v110, v254
    v_mul_f32 v111, v111, v255
    v_cvt_pk_bf16_f32 v92, v104, v105
    v_cvt_pk_bf16_f32 v93, v106, v107
    v_cvt_pk_bf16_f32 v94, v108, v109
    v_cvt_pk_bf16_f32 v95, v110, v111
    buffer_store_dwordx4 v[92:95], v1, s[4:7], s30 offen sc1
    s_waitcnt lgkmcnt(0)
    v_or3_b32 v24, v24, v25, v26
    v_or3_b32 v28, v28, v29, v30
    v_or3_b32 v24, v24, v27, v31
    v_or_b32 v24, v24, v28
    s_mov_b32 s28, s51
    s_mov_b32 s57, s53
    v_readfirstlane_b32 s30, v24
    s_cmp_lg_u32 s30, 0
    s_cbranch_scc1 w_drain
    s_mov_b32 s48, s32
    s_cmp_ge_u32 s32, 4
    s_cselect_b32 s30, 2, 3
    s_lshl_b32 s30, s26, s30
    s_mul_i32 s30, s30, s43
    s_add_u32 s49, s42, s30
    s_mov_b32 s50, s43
    s_mov_b32 s51, s46
    s_mov_b32 s23, s41
    s_mov_b32 s53, s47
    s_nop 0
    s_load_dwordx16 s[32:47], s[24:25], 0
    s_add_u32 s24, s24, 64
    s_addc_u32 s25, s25, 0
    s_branch w_first8
w_epi_silu:
    s_lshl_b32 s30, s27, 10
    s_add_u32 s30, s30, s49
    s_mov_b32 s54, 0xbfb8aa3b
    s_nop 7
    v_cvt_pk_bf16_f32 v80, v128, v129
    v_cvt_pk_bf16_f32 v81, v130, v131
    v_cvt_pk_bf16_f32 v82, v132, v133
    v_cvt_pk_bf16_f32 v83, v134, v135
    v_lshlrev_b32 v128, 16, v80
    v_and_b32 v129, 0xffff0000, v80
    v_lshlrev_b32 v130, 16, v81
    v_and_b32 v131, 0xffff0000, v81
    v_lshlrev_b32 v132, 16, v82
    v_and_b32 v133, 0xffff0000, v82
    v_lshlrev_b32 v134, 16, v83
    v_and_b32 v135, 0xffff0000, v83
    v_mul_f32 v104, s54, v128
    v_mul_f32 v105, s54, v129
    v_mul_f32 v106, s54, v130
    v_mul_f32 v107, s54, v131
    v_mul_f32 v108, s54, v132
    v_mul_f32 v109, s54, v133
    v_mul_f32 v110, s54, v134
    v_mul_f32 v111, s54, v135
    v_exp_f32 v104, v104
    v_exp_f32 v105, v105
    v_exp_f32 v106, v106
    v_exp_f32 v107, v107
    v_exp_f32 v108, v108
    v_exp_f32 v109, v109
    v_exp_f32 v110, v110
    v_exp_f32 v111, v111
    v_add_f32 v104, 1.0, v104
    v_add_f32 v105, 1.0, v105
    v_add_f32 v106, 1.0, v106
    v_add_f32 v107, 1.0, v107
    v_add_f32 v108, 1.0, v108
    v_add_f32 v109, 1.0, v109
    v_add_f32 v110, 1.0, v110
    v_add_f32 v111, 1.0, v111
    v_rcp_f32 v104, v104
    v_rcp_f32 v105, v105
    v_rcp_f32 v106, v106
    v_rcp_f32 v107, v107
    v_rcp_f32 v108, v108
    v_rcp_f32 v109, v109
    v_rcp_f32 v110, v110
    v_rcp_f32 v111, v111
    v_mul_f32 v128, v128, v104
    v_mul_f32 v129, v129, v105
    v_mul_f32 v130, v130, v106
    v_mul_f32 v131, v131, v107
    v_mul_f32 v132, v132, v108
    v_mul_f32 v133, v133, v109
    v_mul_f32 v134, v134, v110
    v_mul_f32 v135, v135, v111
    v_cvt_pk_bf16_f32 v80, v128, v129
    v_cvt_pk_bf16_f32 v81, v130, v131
    v_cvt_pk_bf16_f32 v82, v132, v133
    v_cvt_pk_bf16_f32 v83, v134, v135
    buffer_store_dwordx4 v[80:83], v1, s[4:7], s30 offen sc1
    v_cvt_pk_bf16_f32 v84, v136, v137
    v_cvt_pk_bf16_f32 v85, v138, v139
    v_cvt_pk_bf16_f32 v86, v140, v141
    v_cvt_pk_bf16_f32 v87, v142, v143
    v_lshlrev_b32 v136, 16, v84
    v_and_b32 v137, 0xffff0000, v84
    v_lshlrev_b32 v138, 16, v85
    v_and_b32 v139, 0xffff0000, v85
    v_lshlrev_b32 v140, 16, v86
    v_and_b32 v141, 0xffff0000, v86
    v_lshlrev_b32 v142, 16, v87
    v_and_b32 v143, 0xffff0000, v87
    v_mul_f32 v96, s54, v136
    v_mul_f32 v97, s54, v137
    v_mul_f32 v98, s54, v138
    v_mul_f32 v99, s54, v139
    v_mul_f32 v100, s54, v140
    v_mul_f32 v101, s54, v141
    v_mul_f32 v102, s54, v142
    v_mul_f32 v103, s54, v143
    v_exp_f32 v96, v96
    v_exp_f32 v97, v97
    v_exp_f32 v98, v98
    v_exp_f32 v99, v99
    v_exp_f32 v100, v100
    v_exp_f32 v101, v101
    v_exp_f32 v102, v102
    v_exp_f32 v103, v103
    v_add_f32 v96, 1.0, v96
    v_add_f32 v97, 1.0, v97
    v_add_f32 v98, 1.0, v98
    v_add_f32 v99, 1.0, v99
    v_add_f32 v100, 1.0, v100
    v_add_f32 v101, 1.0, v101
    v_add_f32 v102, 1.0, v102
    v_add_f32 v103, 1.0, v103
    v_rcp_f32 v96, v96
    v_rcp_f32 v97, v97
    v_rcp_f32 v98, v98
    v_rcp_f32 v99, v99
    v_rcp_f32 v100, v100
    v_rcp_f32 v101, v101
    v_rcp_f32 v102, v102
    v_rcp_f32 v103, v103
    v_mul_f32 v136, v136, v96
    v_mul_f32 v137, v137, v97
    v_mul_f32 v138, v138, v98
    v_mul_f32 v139, v139, v99
    v_mul_f32 v140, v140, v100
    v_mul_f32 v141, v141, v101
    v_mul_f32 v142, v142, v102
    v_mul_f32 v143, v143, v103
    v_cvt_pk_bf16_f32 v84, v136, v137
    v_cvt_pk_bf16_f32 v85, v138, v139
    v_cvt_pk_bf16_f32 v86, v140, v141
    v_cvt_pk_bf16_f32 v87, v142, v143
    buffer_store_dwordx4 v[84:87], v19, s[4:7], s30 offen sc1
    s_add_u32 s30, s30, s50
    v_cvt_pk_bf16_f32 v88, v144, v145
    v_cvt_pk_bf16_f32 v89, v146, v147
    v_cvt_pk_bf16_f32 v90, v148, v149
    v_cvt_pk_bf16_f32 v91, v150, v151
    v_lshlrev_b32 v144, 16, v88
    v_and_b32 v145, 0xffff0000, v88
    v_lshlrev_b32 v146, 16, v89
    v_and_b32 v147, 0xffff0000, v89
    v_lshlrev_b32 v148, 16, v90
    v_and_b32 v149, 0xffff0000, v90
    v_lshlrev_b32 v150, 16, v91
    v_and_b32 v151, 0xffff0000, v91
    v_mul_f32 v104, s54, v144
    v_mul_f32 v105, s54, v145
    v_mul_f32 v106, s54, v146
    v_mul_f32 v107, s54, v147
    v_mul_f32 v108, s54, v148
    v_mul_f32 v109, s54, v149
    v_mul_f32 v110, s54, v150
    v_mul_f32 v111, s54, v151
    v_exp_f32 v104, v104
    v_exp_f32 v105, v105
    v_exp_f32 v106, v106
    v_exp_f32 v107, v107
    v_exp_f32 v108, v108
    v_exp_f32 v109, v109
    v_exp_f32 v110, v110
    v_exp_f32 v111, v111
    v_add_f32 v104, 1.0, v104
    v_add_f32 v105, 1.0, v105
    v_add_f32 v106, 1.0, v106
    v_add_f32 v107, 1.0, v107
    v_add_f32 v108, 1.0, v108
    v_add_f32 v109, 1.0, v109
    v_add_f32 v110, 1.0, v110
    v_add_f32 v111, 1.0, v111
    v_rcp_f32 v104, v104
    v_rcp_f32 v105, v105
    v_rcp_f32 v106, v106
    v_rcp_f32 v107, v107
    v_rcp_f32 v108, v108
    v_rcp_f32 v109, v109
    v_rcp_f32 v110, v110
    v_rcp_f32 v111, v111
    v_mul_f32 v144, v144, v104
    v_mul_f32 v145, v145, v105
    v_mul_f32 v146, v146, v106
    v_mul_f32 v147, v147, v107
    v_mul_f32 v148, v148, v108
    v_mul_f32 v149, v149, v109
    v_mul_f32 v150, v150, v110
    v_mul_f32 v151, v151, v111
    v_cvt_pk_bf16_f32 v88, v144, v145
    v_cvt_pk_bf16_f32 v89, v146, v147
    v_cvt_pk_bf16_f32 v90, v148, v149
    v_cvt_pk_bf16_f32 v91, v150, v151
    buffer_store_dwordx4 v[88:91], v1, s[4:7], s30 offen sc1
    v_cvt_pk_bf16_f32 v92, v152, v153
    v_cvt_pk_bf16_f32 v93, v154, v155
    v_cvt_pk_bf16_f32 v94, v156, v157
    v_cvt_pk_bf16_f32 v95, v158, v159
    v_lshlrev_b32 v152, 16, v92
    v_and_b32 v153, 0xffff0000, v92
    v_lshlrev_b32 v154, 16, v93
    v_and_b32 v155, 0xffff0000, v93
    v_lshlrev_b32 v156, 16, v94
    v_and_b32 v157, 0xffff0000, v94
    v_lshlrev_b32 v158, 16, v95
    v_and_b32 v159, 0xffff0000, v95
    v_mul_f32 v96, s54, v152
    v_mul_f32 v97, s54, v153
    v_mul_f32 v98, s54, v154
    v_mul_f32 v99, s54, v155
    v_mul_f32 v100, s54, v156
    v_mul_f32 v101, s54, v157
    v_mul_f32 v102, s54, v158
    v_mul_f32 v103, s54, v159
    v_exp_f32 v96, v96
    v_exp_f32 v97, v97
    v_exp_f32 v98, v98
    v_exp_f32 v99, v99
    v_exp_f32 v100, v100
    v_exp_f32 v101, v101
    v_exp_f32 v102, v102
    v_exp_f32 v103, v103
    v_add_f32 v96, 1.0, v96
    v_add_f32 v97, 1.0, v97
    v_add_f32 v98, 1.0, v98
    v_add_f32 v99, 1.0, v99
    v_add_f32 v100, 1.0, v100
    v_add_f32 v101, 1.0, v101
    v_add_f32 v102, 1.0, v102
    v_add_f32 v103, 1.0, v103
    v_rcp_f32 v96, v96
    v_rcp_f32 v97, v97
    v_rcp_f32 v98, v98
    v_rcp_f32 v99, v99
    v_rcp_f32 v100, v100
    v_rcp_f32 v101, v101
    v_rcp_f32 v102, v102
    v_rcp_f32 v103, v103
    v_mul_f32 v152, v152, v96
    v_mul_f32 v153, v153, v97
    v_mul_f32 v154, v154, v98
    v_mul_f32 v155, v155, v99
    v_mul_f32 v156, v156, v100
    v_mul_f32 v157, v157, v101
    v_mul_f32 v158, v158, v102
    v_mul_f32 v159, v159, v103
    v_cvt_pk_bf16_f32 v92, v152, v153
    v_cvt_pk_bf16_f32 v93, v154, v155
    v_cvt_pk_bf16_f32 v94, v156, v157
    v_cvt_pk_bf16_f32 v95, v158, v159
    buffer_store_dwordx4 v[92:95], v19, s[4:7], s30 offen sc1
    s_add_u32 s30, s30, s50
    v_cvt_pk_bf16_f32 v80, v160, v161
    v_cvt_pk_bf16_f32 v81, v162, v163
    v_cvt_pk_bf16_f32 v82, v164, v165
    v_cvt_pk_bf16_f32 v83, v166, v167
    v_lshlrev_b32 v160, 16, v80
    v_and_b32 v161, 0xffff0000, v80
    v_lshlrev_b32 v162, 16, v81
    v_and_b32 v163, 0xffff0000, v81
    v_lshlrev_b32 v164, 16, v82
    v_and_b32 v165, 0xffff0000, v82
    v_lshlrev_b32 v166, 16, v83
    v_and_b32 v167, 0xffff0000, v83
    v_mul_f32 v104, s54, v160
    v_mul_f32 v105, s54, v161
    v_mul_f32 v106, s54, v162
    v_mul_f32 v107, s54, v163
    v_mul_f32 v108, s54, v164
    v_mul_f32 v109, s54, v165
    v_mul_f32 v110, s54, v166
    v_mul_f32 v111, s54, v167
    v_exp_f32 v104, v104
    v_exp_f32 v105, v105
    v_exp_f32 v106, v106
    v_exp_f32 v107, v107
    v_exp_f32 v108, v108
    v_exp_f32 v109, v109
    v_exp_f32 v110, v110
    v_exp_f32 v111, v111
    v_add_f32 v104, 1.0, v104
    v_add_f32 v105, 1.0, v105
    v_add_f32 v106, 1.0, v106
    v_add_f32 v107, 1.0, v107
    v_add_f32 v108, 1.0, v108
    v_add_f32 v109, 1.0, v109
    v_add_f32 v110, 1.0, v110
    v_add_f32 v111, 1.0, v111
    v_rcp_f32 v104, v104
    v_rcp_f32 v105, v105
    v_rcp_f32 v106, v106
    v_rcp_f32 v107, v107
    v_rcp_f32 v108, v108
    v_rcp_f32 v109, v109
    v_rcp_f32 v110, v110
    v_rcp_f32 v111, v111
    v_mul_f32 v160, v160, v104
    v_mul_f32 v161, v161, v105
    v_mul_f32 v162, v162, v106
    v_mul_f32 v163, v163, v107
    v_mul_f32 v164, v164, v108
    v_mul_f32 v165, v165, v109
    v_mul_f32 v166, v166, v110
    v_mul_f32 v167, v167, v111
    v_cvt_pk_bf16_f32 v80, v160, v161
    v_cvt_pk_bf16_f32 v81, v162, v163
    v_cvt_pk_bf16_f32 v82, v164, v165
    v_cvt_pk_bf16_f32 v83, v166, v167
    buffer_store_dwordx4 v[80:83], v1, s[4:7], s30 offen sc1
    v_cvt_pk_bf16_f32 v84, v168, v169
    v_cvt_pk_bf16_f32 v85, v170, v171
    v_cvt_pk_bf16_f32 v86, v172, v173
    v_cvt_pk_bf16_f32 v87, v174, v175
    v_lshlrev_b32 v168, 16, v84
    v_and_b32 v169, 0xffff0000, v84
    v_lshlrev_b32 v170, 16, v85
    v_and_b32 v171, 0xffff0000, v85
    v_lshlrev_b32 v172, 16, v86
    v_and_b32 v173, 0xffff0000, v86
    v_lshlrev_b32 v174, 16, v87
    v_and_b32 v175, 0xffff0000, v87
    v_mul_f32 v96, s54, v168
    v_mul_f32 v97, s54, v169
    v_mul_f32 v98, s54, v170
    v_mul_f32 v99, s54, v171
    v_mul_f32 v100, s54, v172
    v_mul_f32 v101, s54, v173
    v_mul_f32 v102, s54, v174
    v_mul_f32 v103, s54, v175
    v_exp_f32 v96, v96
    v_exp_f32 v97, v97
    v_exp_f32 v98, v98
    v_exp_f32 v99, v99
    v_exp_f32 v100, v100
    v_exp_f32 v101, v101
    v_exp_f32 v102, v102
    v_exp_f32 v103, v103
    v_add_f32 v96, 1.0, v96
    v_add_f32 v97, 1.0, v97
    v_add_f32 v98, 1.0, v98
    v_add_f32 v99, 1.0, v99
    v_add_f32 v100, 1.0, v100
    v_add_f32 v101, 1.0, v101
    v_add_f32 v102, 1.0, v102
    v_add_f32 v103, 1.0, v103
    v_rcp_f32 v96, v96
    v_rcp_f32 v97, v97
    v_rcp_f32 v98, v98
    v_rcp_f32 v99, v99
    v_rcp_f32 v100, v100
    v_rcp_f32 v101, v101
    v_rcp_f32 v102, v102
    v_rcp_f32 v103, v103
    v_mul_f32 v168, v168, v96
    v_mul_f32 v169, v169, v97
    v_mul_f32 v170, v170, v98
    v_mul_f32 v171, v171, v99
    v_mul_f32 v172, v172, v100
    v_mul_f32 v173, v173, v101
    v_mul_f32 v174, v174, v102
    v_mul_f32 v175, v175, v103
    v_cvt_pk_bf16_f32 v84, v168, v169
    v_cvt_pk_bf16_f32 v85, v170, v171
    v_cvt_pk_bf16_f32 v86, v172, v173
    v_cvt_pk_bf16_f32 v87, v174, v175
    buffer_store_dwordx4 v[84:87], v19, s[4:7], s30 offen sc1
    s_add_u32 s30, s30, s50
    v_cvt_pk_bf16_f32 v88, v176, v177
    v_cvt_pk_bf16_f32 v89, v178, v179
    v_cvt_pk_bf16_f32 v90, v180, v181
    v_cvt_pk_bf16_f32 v91, v182, v183
    v_lshlrev_b32 v176, 16, v88
    v_and_b32 v177, 0xffff0000, v88
    v_lshlrev_b32 v178, 16, v89
    v_and_b32 v179, 0xffff0000, v89
    v_lshlrev_b32 v180, 16, v90
    v_and_b32 v181, 0xffff0000, v90
    v_lshlrev_b32 v182, 16, v91
    v_and_b32 v183, 0xffff0000, v91
    v_mul_f32 v104, s54, v176
    v_mul_f32 v105, s54, v177
    v_mul_f32 v106, s54, v178
    v_mul_f32 v107, s54, v179
    v_mul_f32 v108, s54, v180
    v_mul_f32 v109, s54, v181
    v_mul_f32 v110, s54, v182
    v_mul_f32 v111, s54, v183
    v_exp_f32 v104, v104
    v_exp_f32 v105, v105
    v_exp_f32 v106, v106
    v_exp_f32 v107, v107
    v_exp_f32 v108, v108
    v_exp_f32 v109, v109
    v_exp_f32 v110, v110
    v_exp_f32 v111, v111
    v_add_f32 v104, 1.0, v104
    v_add_f32 v105, 1.0, v105
    v_add_f32 v106, 1.0, v106
    v_add_f32 v107, 1.0, v107
    v_add_f32 v108, 1.0, v108
    v_add_f32 v109, 1.0, v109
    v_add_f32 v110, 1.0, v110
    v_add_f32 v111, 1.0, v111
    v_rcp_f32 v104, v104
    v_rcp_f32 v105, v105
    v_rcp_f32 v106, v106
    v_rcp_f32 v107, v107
    v_rcp_f32 v108, v108
    v_rcp_f32 v109, v109
    v_rcp_f32 v110, v110
    v_rcp_f32 v111, v111
    v_mul_f32 v176, v176, v104
    v_mul_f32 v177, v177, v105
    v_mul_f32 v178, v178, v106
    v_mul_f32 v179, v179, v107
    v_mul_f32 v180, v180, v108
    v_mul_f32 v181, v181, v109
    v_mul_f32 v182, v182, v110
    v_mul_f32 v183, v183, v111
    v_cvt_pk_bf16_f32 v88, v176, v177
    v_cvt_pk_bf16_f32 v89, v178, v179
    v_cvt_pk_bf16_f32 v90, v180, v181
    v_cvt_pk_bf16_f32 v91, v182, v183
    buffer_store_dwordx4 v[88:91], v1, s[4:7], s30 offen sc1
    v_cvt_pk_bf16_f32 v92, v184, v185
    v_cvt_pk_bf16_f32 v93, v186, v187
    v_cvt_pk_bf16_f32 v94, v188, v189
    v_cvt_pk_bf16_f32 v95, v190, v191
    v_lshlrev_b32 v184, 16, v92
    v_and_b32 v185, 0xffff0000, v92
    v_lshlrev_b32 v186, 16, v93
    v_and_b32 v187, 0xffff0000, v93
    v_lshlrev_b32 v188, 16, v94
    v_and_b32 v189, 0xffff0000, v94
    v_lshlrev_b32 v190, 16, v95
    v_and_b32 v191, 0xffff0000, v95
    v_mul_f32 v96, s54, v184
    v_mul_f32 v97, s54, v185
    v_mul_f32 v98, s54, v186
    v_mul_f32 v99, s54, v187
    v_mul_f32 v100, s54, v188
    v_mul_f32 v101, s54, v189
    v_mul_f32 v102, s54, v190
    v_mul_f32 v103, s54, v191
    v_exp_f32 v96, v96
    v_exp_f32 v97, v97
    v_exp_f32 v98, v98
    v_exp_f32 v99, v99
    v_exp_f32 v100, v100
    v_exp_f32 v101, v101
    v_exp_f32 v102, v102
    v_exp_f32 v103, v103
    v_add_f32 v96, 1.0, v96
    v_add_f32 v97, 1.0, v97
    v_add_f32 v98, 1.0, v98
    v_add_f32 v99, 1.0, v99
    v_add_f32 v100, 1.0, v100
    v_add_f32 v101, 1.0, v101
    v_add_f32 v102, 1.0, v102
    v_add_f32 v103, 1.0, v103
    v_rcp_f32 v96, v96
    v_rcp_f32 v97, v97
    v_rcp_f32 v98, v98
    v_rcp_f32 v99, v99
    v_rcp_f32 v100, v100
    v_rcp_f32 v101, v101
    v_rcp_f32 v102, v102
    v_rcp_f32 v103, v103
    v_mul_f32 v184, v184, v96
    v_mul_f32 v185, v185, v97
    v_mul_f32 v186, v186, v98
    v_mul_f32 v187, v187, v99
    v_mul_f32 v188, v188, v100
    v_mul_f32 v189, v189, v101
    v_mul_f32 v190, v190, v102
    v_mul_f32 v191, v191, v103
    v_cvt_pk_bf16_f32 v92, v184, v185
    v_cvt_pk_bf16_f32 v93, v186, v187
    v_cvt_pk_bf16_f32 v94, v188, v189
    v_cvt_pk_bf16_f32 v95, v190, v191
    buffer_store_dwordx4 v[92:95], v19, s[4:7], s30 offen sc1
    s_add_u32 s30, s30, s50
    v_cvt_pk_bf16_f32 v80, v192, v193
    v_cvt_pk_bf16_f32 v81, v194, v195
    v_cvt_pk_bf16_f32 v82, v196, v197
    v_cvt_pk_bf16_f32 v83, v198, v199
    v_lshlrev_b32 v192, 16, v80
    v_and_b32 v193, 0xffff0000, v80
    v_lshlrev_b32 v194, 16, v81
    v_and_b32 v195, 0xffff0000, v81
    v_lshlrev_b32 v196, 16, v82
    v_and_b32 v197, 0xffff0000, v82
    v_lshlrev_b32 v198, 16, v83
    v_and_b32 v199, 0xffff0000, v83
    v_mul_f32 v104, s54, v192
    v_mul_f32 v105, s54, v193
    v_mul_f32 v106, s54, v194
    v_mul_f32 v107, s54, v195
    v_mul_f32 v108, s54, v196
    v_mul_f32 v109, s54, v197
    v_mul_f32 v110, s54, v198
    v_mul_f32 v111, s54, v199
    v_exp_f32 v104, v104
    v_exp_f32 v105, v105
    v_exp_f32 v106, v106
    v_exp_f32 v107, v107
    v_exp_f32 v108, v108
    v_exp_f32 v109, v109
    v_exp_f32 v110, v110
    v_exp_f32 v111, v111
    v_add_f32 v104, 1.0, v104
    v_add_f32 v105, 1.0, v105
    v_add_f32 v106, 1.0, v106
    v_add_f32 v107, 1.0, v107
    v_add_f32 v108, 1.0, v108
    v_add_f32 v109, 1.0, v109
    v_add_f32 v110, 1.0, v110
    v_add_f32 v111, 1.0, v111
    v_rcp_f32 v104, v104
    v_rcp_f32 v105, v105
    v_rcp_f32 v106, v106
    v_rcp_f32 v107, v107
    v_rcp_f32 v108, v108
    v_rcp_f32 v109, v109
    v_rcp_f32 v110, v110
    v_rcp_f32 v111, v111
    v_mul_f32 v192, v192, v104
    v_mul_f32 v193, v193, v105
    v_mul_f32 v194, v194, v106
    v_mul_f32 v195, v195, v107
    v_mul_f32 v196, v196, v108
    v_mul_f32 v197, v197, v109
    v_mul_f32 v198, v198, v110
    v_mul_f32 v199, v199, v111
    v_cvt_pk_bf16_f32 v80, v192, v193
    v_cvt_pk_bf16_f32 v81, v194, v195
    v_cvt_pk_bf16_f32 v82, v196, v197
    v_cvt_pk_bf16_f32 v83, v198, v199
    buffer_store_dwordx4 v[80:83], v1, s[4:7], s30 offen sc1
    v_cvt_pk_bf16_f32 v84, v200, v201
    v_cvt_pk_bf16_f32 v85, v202, v203
    v_cvt_pk_bf16_f32 v86, v204, v205
    v_cvt_pk_bf16_f32 v87, v206, v207
    v_lshlrev_b32 v200, 16, v84
    v_and_b32 v201, 0xffff0000, v84
    v_lshlrev_b32 v202, 16, v85
    v_and_b32 v203, 0xffff0000, v85
    v_lshlrev_b32 v204, 16, v86
    v_and_b32 v205, 0xffff0000, v86
    v_lshlrev_b32 v206, 16, v87
    v_and_b32 v207, 0xffff0000, v87
    v_mul_f32 v96, s54, v200
    v_mul_f32 v97, s54, v201
    v_mul_f32 v98, s54, v202
    v_mul_f32 v99, s54, v203
    v_mul_f32 v100, s54, v204
    v_mul_f32 v101, s54, v205
    v_mul_f32 v102, s54, v206
    v_mul_f32 v103, s54, v207
    v_exp_f32 v96, v96
    v_exp_f32 v97, v97
    v_exp_f32 v98, v98
    v_exp_f32 v99, v99
    v_exp_f32 v100, v100
    v_exp_f32 v101, v101
    v_exp_f32 v102, v102
    v_exp_f32 v103, v103
    v_add_f32 v96, 1.0, v96
    v_add_f32 v97, 1.0, v97
    v_add_f32 v98, 1.0, v98
    v_add_f32 v99, 1.0, v99
    v_add_f32 v100, 1.0, v100
    v_add_f32 v101, 1.0, v101
    v_add_f32 v102, 1.0, v102
    v_add_f32 v103, 1.0, v103
    v_rcp_f32 v96, v96
    v_rcp_f32 v97, v97
    v_rcp_f32 v98, v98
    v_rcp_f32 v99, v99
    v_rcp_f32 v100, v100
    v_rcp_f32 v101, v101
    v_rcp_f32 v102, v102
    v_rcp_f32 v103, v103
    v_mul_f32 v200, v200, v96
    v_mul_f32 v201, v201, v97
    v_mul_f32 v202, v202, v98
    v_mul_f32 v203, v203, v99
    v_mul_f32 v204, v204, v100
    v_mul_f32 v205, v205, v101
    v_mul_f32 v206, v206, v102
    v_mul_f32 v207, v207, v103
    v_cvt_pk_bf16_f32 v84, v200, v201
    v_cvt_pk_bf16_f32 v85, v202, v203
    v_cvt_pk_bf16_f32 v86, v204, v205
    v_cvt_pk_bf16_f32 v87, v206, v207
    buffer_store_dwordx4 v[84:87], v19, s[4:7], s30 offen sc1
    s_add_u32 s30, s30, s50
    v_cvt_pk_bf16_f32 v88, v208, v209
    v_cvt_pk_bf16_f32 v89, v210, v211
    v_cvt_pk_bf16_f32 v90, v212, v213
    v_cvt_pk_bf16_f32 v91, v214, v215
    v_lshlrev_b32 v208, 16, v88
    v_and_b32 v209, 0xffff0000, v88
    v_lshlrev_b32 v210, 16, v89
    v_and_b32 v211, 0xffff0000, v89
    v_lshlrev_b32 v212, 16, v90
    v_and_b32 v213, 0xffff0000, v90
    v_lshlrev_b32 v214, 16, v91
    v_and_b32 v215, 0xffff0000, v91
    v_mul_f32 v104, s54, v208
    v_mul_f32 v105, s54, v209
    v_mul_f32 v106, s54, v210
    v_mul_f32 v107, s54, v211
    v_mul_f32 v108, s54, v212
    v_mul_f32 v109, s54, v213
    v_mul_f32 v110, s54, v214
    v_mul_f32 v111, s54, v215
    v_exp_f32 v104, v104
    v_exp_f32 v105, v105
    v_exp_f32 v106, v106
    v_exp_f32 v107, v107
    v_exp_f32 v108, v108
    v_exp_f32 v109, v109
    v_exp_f32 v110, v110
    v_exp_f32 v111, v111
    v_add_f32 v104, 1.0, v104
    v_add_f32 v105, 1.0, v105
    v_add_f32 v106, 1.0, v106
    v_add_f32 v107, 1.0, v107
    v_add_f32 v108, 1.0, v108
    v_add_f32 v109, 1.0, v109
    v_add_f32 v110, 1.0, v110
    v_add_f32 v111, 1.0, v111
    v_rcp_f32 v104, v104
    v_rcp_f32 v105, v105
    v_rcp_f32 v106, v106
    v_rcp_f32 v107, v107
    v_rcp_f32 v108, v108
    v_rcp_f32 v109, v109
    v_rcp_f32 v110, v110
    v_rcp_f32 v111, v111
    v_mul_f32 v208, v208, v104
    v_mul_f32 v209, v209, v105
    v_mul_f32 v210, v210, v106
    v_mul_f32 v211, v211, v107
    v_mul_f32 v212, v212, v108
    v_mul_f32 v213, v213, v109
    v_mul_f32 v214, v214, v110
    v_mul_f32 v215, v215, v111
    v_cvt_pk_bf16_f32 v88, v208, v209
    v_cvt_pk_bf16_f32 v89, v210, v211
    v_cvt_pk_bf16_f32 v90, v212, v213
    v_cvt_pk_bf16_f32 v91, v214, v215
    buffer_store_dwordx4 v[88:91], v1, s[4:7], s30 offen sc1
    v_cvt_pk_bf16_f32 v92, v216, v217
    v_cvt_pk_bf16_f32 v93, v218, v219
    v_cvt_pk_bf16_f32 v94, v220, v221
    v_cvt_pk_bf16_f32 v95, v222, v223
    v_lshlrev_b32 v216, 16, v92
    v_and_b32 v217, 0xffff0000, v92
    v_lshlrev_b32 v218, 16, v93
    v_and_b32 v219, 0xffff0000, v93
    v_lshlrev_b32 v220, 16, v94
    v_and_b32 v221, 0xffff0000, v94
    v_lshlrev_b32 v222, 16, v95
    v_and_b32 v223, 0xffff0000, v95
    v_mul_f32 v96, s54, v216
    v_mul_f32 v97, s54, v217
    v_mul_f32 v98, s54, v218
    v_mul_f32 v99, s54, v219
    v_mul_f32 v100, s54, v220
    v_mul_f32 v101, s54, v221
    v_mul_f32 v102, s54, v222
    v_mul_f32 v103, s54, v223
    v_exp_f32 v96, v96
    v_exp_f32 v97, v97
    v_exp_f32 v98, v98
    v_exp_f32 v99, v99
    v_exp_f32 v100, v100
    v_exp_f32 v101, v101
    v_exp_f32 v102, v102
    v_exp_f32 v103, v103
    v_add_f32 v96, 1.0, v96
    v_add_f32 v97, 1.0, v97
    v_add_f32 v98, 1.0, v98
    v_add_f32 v99, 1.0, v99
    v_add_f32 v100, 1.0, v100
    v_add_f32 v101, 1.0, v101
    v_add_f32 v102, 1.0, v102
    v_add_f32 v103, 1.0, v103
    v_rcp_f32 v96, v96
    v_rcp_f32 v97, v97
    v_rcp_f32 v98, v98
    v_rcp_f32 v99, v99
    v_rcp_f32 v100, v100
    v_rcp_f32 v101, v101
    v_rcp_f32 v102, v102
    v_rcp_f32 v103, v103
    v_mul_f32 v216, v216, v96
    v_mul_f32 v217, v217, v97
    v_mul_f32 v218, v218, v98
    v_mul_f32 v219, v219, v99
    v_mul_f32 v220, v220, v100
    v_mul_f32 v221, v221, v101
    v_mul_f32 v222, v222, v102
    v_mul_f32 v223, v223, v103
    v_cvt_pk_bf16_f32 v92, v216, v217
    v_cvt_pk_bf16_f32 v93, v218, v219
    v_cvt_pk_bf16_f32 v94, v220, v221
    v_cvt_pk_bf16_f32 v95, v222, v223
    buffer_store_dwordx4 v[92:95], v19, s[4:7], s30 offen sc1
    s_add_u32 s30, s30, s50
    v_cvt_pk_bf16_f32 v80, v224, v225
    v_cvt_pk_bf16_f32 v81, v226, v227
    v_cvt_pk_bf16_f32 v82, v228, v229
    v_cvt_pk_bf16_f32 v83, v230, v231
    v_lshlrev_b32 v224, 16, v80
    v_and_b32 v225, 0xffff0000, v80
    v_lshlrev_b32 v226, 16, v81
    v_and_b32 v227, 0xffff0000, v81
    v_lshlrev_b32 v228, 16, v82
    v_and_b32 v229, 0xffff0000, v82
    v_lshlrev_b32 v230, 16, v83
    v_and_b32 v231, 0xffff0000, v83
    v_mul_f32 v104, s54, v224
    v_mul_f32 v105, s54, v225
    v_mul_f32 v106, s54, v226
    v_mul_f32 v107, s54, v227
    v_mul_f32 v108, s54, v228
    v_mul_f32 v109, s54, v229
    v_mul_f32 v110, s54, v230
    v_mul_f32 v111, s54, v231
    v_exp_f32 v104, v104
    v_exp_f32 v105, v105
    v_exp_f32 v106, v106
    v_exp_f32 v107, v107
    v_exp_f32 v108, v108
    v_exp_f32 v109, v109
    v_exp_f32 v110, v110
    v_exp_f32 v111, v111
    v_add_f32 v104, 1.0, v104
    v_add_f32 v105, 1.0, v105
    v_add_f32 v106, 1.0, v106
    v_add_f32 v107, 1.0, v107
    v_add_f32 v108, 1.0, v108
    v_add_f32 v109, 1.0, v109
    v_add_f32 v110, 1.0, v110
    v_add_f32 v111, 1.0, v111
    v_rcp_f32 v104, v104
    v_rcp_f32 v105, v105
    v_rcp_f32 v106, v106
    v_rcp_f32 v107, v107
    v_rcp_f32 v108, v108
    v_rcp_f32 v109, v109
    v_rcp_f32 v110, v110
    v_rcp_f32 v111, v111
    v_mul_f32 v224, v224, v104
    v_mul_f32 v225, v225, v105
    v_mul_f32 v226, v226, v106
    v_mul_f32 v227, v227, v107
    v_mul_f32 v228, v228, v108
    v_mul_f32 v229, v229, v109
    v_mul_f32 v230, v230, v110
    v_mul_f32 v231, v231, v111
    v_cvt_pk_bf16_f32 v80, v224, v225
    v_cvt_pk_bf16_f32 v81, v226, v227
    v_cvt_pk_bf16_f32 v82, v228, v229
    v_cvt_pk_bf16_f32 v83, v230, v231
    buffer_store_dwordx4 v[80:83], v1, s[4:7], s30 offen sc1
    v_cvt_pk_bf16_f32 v84, v232, v233
    v_cvt_pk_bf16_f32 v85, v234, v235
    v_cvt_pk_bf16_f32 v86, v236, v237
    v_cvt_pk_bf16_f32 v87, v238, v239
    v_lshlrev_b32 v232, 16, v84
    v_and_b32 v233, 0xffff0000, v84
    v_lshlrev_b32 v234, 16, v85
    v_and_b32 v235, 0xffff0000, v85
    v_lshlrev_b32 v236, 16, v86
    v_and_b32 v237, 0xffff0000, v86
    v_lshlrev_b32 v238, 16, v87
    v_and_b32 v239, 0xffff0000, v87
    v_mul_f32 v96, s54, v232
    v_mul_f32 v97, s54, v233
    v_mul_f32 v98, s54, v234
    v_mul_f32 v99, s54, v235
    v_mul_f32 v100, s54, v236
    v_mul_f32 v101, s54, v237
    v_mul_f32 v102, s54, v238
    v_mul_f32 v103, s54, v239
    v_exp_f32 v96, v96
    v_exp_f32 v97, v97
    v_exp_f32 v98, v98
    v_exp_f32 v99, v99
    v_exp_f32 v100, v100
    v_exp_f32 v101, v101
    v_exp_f32 v102, v102
    v_exp_f32 v103, v103
    v_add_f32 v96, 1.0, v96
    v_add_f32 v97, 1.0, v97
    v_add_f32 v98, 1.0, v98
    v_add_f32 v99, 1.0, v99
    v_add_f32 v100, 1.0, v100
    v_add_f32 v101, 1.0, v101
    v_add_f32 v102, 1.0, v102
    v_add_f32 v103, 1.0, v103
    v_rcp_f32 v96, v96
    v_rcp_f32 v97, v97
    v_rcp_f32 v98, v98
    v_rcp_f32 v99, v99
    v_rcp_f32 v100, v100
    v_rcp_f32 v101, v101
    v_rcp_f32 v102, v102
    v_rcp_f32 v103, v103
    v_mul_f32 v232, v232, v96
    v_mul_f32 v233, v233, v97
    v_mul_f32 v234, v234, v98
    v_mul_f32 v235, v235, v99
    v_mul_f32 v236, v236, v100
    v_mul_f32 v237, v237, v101
    v_mul_f32 v238, v238, v102
    v_mul_f32 v239, v239, v103
    v_cvt_pk_bf16_f32 v84, v232, v233
    v_cvt_pk_bf16_f32 v85, v234, v235
    v_cvt_pk_bf16_f32 v86, v236, v237
    v_cvt_pk_bf16_f32 v87, v238, v239
    buffer_store_dwordx4 v[84:87], v19, s[4:7], s30 offen sc1
    s_add_u32 s30, s30, s50
    v_cvt_pk_bf16_f32 v88, v240, v241
    v_cvt_pk_bf16_f32 v89, v242, v243
    v_cvt_pk_bf16_f32 v90, v244, v245
    v_cvt_pk_bf16_f32 v91, v246, v247
    v_lshlrev_b32 v240, 16, v88
    v_and_b32 v241, 0xffff0000, v88
    v_lshlrev_b32 v242, 16, v89
    v_and_b32 v243, 0xffff0000, v89
    v_lshlrev_b32 v244, 16, v90
    v_and_b32 v245, 0xffff0000, v90
    v_lshlrev_b32 v246, 16, v91
    v_and_b32 v247, 0xffff0000, v91
    v_mul_f32 v104, s54, v240
    v_mul_f32 v105, s54, v241
    v_mul_f32 v106, s54, v242
    v_mul_f32 v107, s54, v243
    v_mul_f32 v108, s54, v244
    v_mul_f32 v109, s54, v245
    v_mul_f32 v110, s54, v246
    v_mul_f32 v111, s54, v247
    v_exp_f32 v104, v104
    v_exp_f32 v105, v105
    v_exp_f32 v106, v106
    v_exp_f32 v107, v107
    v_exp_f32 v108, v108
    v_exp_f32 v109, v109
    v_exp_f32 v110, v110
    v_exp_f32 v111, v111
    v_add_f32 v104, 1.0, v104
    v_add_f32 v105, 1.0, v105
    v_add_f32 v106, 1.0, v106
    v_add_f32 v107, 1.0, v107
    v_add_f32 v108, 1.0, v108
    v_add_f32 v109, 1.0, v109
    v_add_f32 v110, 1.0, v110
    v_add_f32 v111, 1.0, v111
    v_rcp_f32 v104, v104
    v_rcp_f32 v105, v105
    v_rcp_f32 v106, v106
    v_rcp_f32 v107, v107
    v_rcp_f32 v108, v108
    v_rcp_f32 v109, v109
    v_rcp_f32 v110, v110
    v_rcp_f32 v111, v111
    v_mul_f32 v240, v240, v104
    v_mul_f32 v241, v241, v105
    v_mul_f32 v242, v242, v106
    v_mul_f32 v243, v243, v107
    v_mul_f32 v244, v244, v108
    v_mul_f32 v245, v245, v109
    v_mul_f32 v246, v246, v110
    v_mul_f32 v247, v247, v111
    v_cvt_pk_bf16_f32 v88, v240, v241
    v_cvt_pk_bf16_f32 v89, v242, v243
    v_cvt_pk_bf16_f32 v90, v244, v245
    v_cvt_pk_bf16_f32 v91, v246, v247
    buffer_store_dwordx4 v[88:91], v1, s[4:7], s30 offen sc1
    v_cvt_pk_bf16_f32 v92, v248, v249
    v_cvt_pk_bf16_f32 v93, v250, v251
    v_cvt_pk_bf16_f32 v94, v252, v253
    v_cvt_pk_bf16_f32 v95, v254, v255
    v_lshlrev_b32 v248, 16, v92
    v_and_b32 v249, 0xffff0000, v92
    v_lshlrev_b32 v250, 16, v93
    v_and_b32 v251, 0xffff0000, v93
    v_lshlrev_b32 v252, 16, v94
    v_and_b32 v253, 0xffff0000, v94
    v_lshlrev_b32 v254, 16, v95
    v_and_b32 v255, 0xffff0000, v95
    v_mul_f32 v96, s54, v248
    v_mul_f32 v97, s54, v249
    v_mul_f32 v98, s54, v250
    v_mul_f32 v99, s54, v251
    v_mul_f32 v100, s54, v252
    v_mul_f32 v101, s54, v253
    v_mul_f32 v102, s54, v254
    v_mul_f32 v103, s54, v255
    v_exp_f32 v96, v96
    v_exp_f32 v97, v97
    v_exp_f32 v98, v98
    v_exp_f32 v99, v99
    v_exp_f32 v100, v100
    v_exp_f32 v101, v101
    v_exp_f32 v102, v102
    v_exp_f32 v103, v103
    v_add_f32 v96, 1.0, v96
    v_add_f32 v97, 1.0, v97
    v_add_f32 v98, 1.0, v98
    v_add_f32 v99, 1.0, v99
    v_add_f32 v100, 1.0, v100
    v_add_f32 v101, 1.0, v101
    v_add_f32 v102, 1.0, v102
    v_add_f32 v103, 1.0, v103
    v_rcp_f32 v96, v96
    v_rcp_f32 v97, v97
    v_rcp_f32 v98, v98
    v_rcp_f32 v99, v99
    v_rcp_f32 v100, v100
    v_rcp_f32 v101, v101
    v_rcp_f32 v102, v102
    v_rcp_f32 v103, v103
    v_mul_f32 v248, v248, v96
    v_mul_f32 v249, v249, v97
    v_mul_f32 v250, v250, v98
    v_mul_f32 v251, v251, v99
    v_mul_f32 v252, v252, v100
    v_mul_f32 v253, v253, v101
    v_mul_f32 v254, v254, v102
    v_mul_f32 v255, v255, v103
    v_cvt_pk_bf16_f32 v92, v248, v249
    v_cvt_pk_bf16_f32 v93, v250, v251
    v_cvt_pk_bf16_f32 v94, v252, v253
    v_cvt_pk_bf16_f32 v95, v254, v255
    buffer_store_dwordx4 v[92:95], v19, s[4:7], s30 offen sc1
    s_waitcnt lgkmcnt(0)
    v_or3_b32 v24, v24, v25, v26
    v_or3_b32 v28, v28, v29, v30
    v_or3_b32 v24, v24, v27, v31
    v_or_b32 v24, v24, v28
    s_mov_b32 s28, s51
    s_mov_b32 s57, s53
    v_readfirstlane_b32 s30, v24
    s_cmp_lg_u32 s30, 0
    s_cbranch_scc1 w_drain
    s_mov_b32 s48, s32
    s_cmp_ge_u32 s32, 4
    s_cselect_b32 s30, 2, 3
    s_lshl_b32 s30, s26, s30
    s_mul_i32 s30, s30, s43
    s_add_u32 s49, s42, s30
    s_mov_b32 s50, s43
    s_mov_b32 s51, s46
    s_mov_b32 s23, s41
    s_mov_b32 s53, s47
    s_nop 0
    s_load_dwordx16 s[32:47], s[24:25], 0
    s_add_u32 s24, s24, 64
    s_addc_u32 s25, s25, 0
    s_branch w_first16
w_firstH:
    s_waitcnt vmcnt(8)
    s_barrier
    s_add_u32 m0, s21, 0
    s_nop 0
    buffer_load_dwordx4 v1, s[4:7], s16 offen sc1 lds
    s_add_u32 s16, s16, s62
    s_add_u32 m0, s21, 1024
    s_nop 0
    buffer_load_dwordx4 v1, s[4:7], s17 offen sc1 lds
    s_add_u32 s17, s17, s62
    s_add_u32 m0, s22, 0
    s_nop 0
    buffer_load_dwordx4 v2, s[8:11], s18 offen lds
    s_add_u32 s18, s18, s20
    s_add_u32 m0, s22, 8192
    s_nop 0
    buffer_load_dwordx4 v2, s[12:15], s19 offen lds
    s_add_u32 s19, s19, s20
    v_mfma_f32_16x16x32_bf16 v[128:131], v[64:67], v[32:35], 0
    ds_read_b64_tr_b16 v[112:113], v8 offset:49152
    v_mfma_f32_16x16x32_bf16 v[132:135], v[68:71], v[32:35], 0
    ds_read_b64_tr_b16 v[114:115], v9 offset:49152
    v_mfma_f32_16x16x32_bf16 v[144:147], v[64:67], v[40:43], 0
    ds_read_b64_tr_b16 v[116:117], v10 offset:49152
    v_mfma_f32_16x16x32_bf16 v[148:151], v[68:71], v[40:43], 0
    ds_read_b64_tr_b16 v[118:119], v11 offset:49152
    v_mfma_f32_16x16x32_bf16 v[160:163], v[64:67], v[48:51], 0
    ds_read_b64_tr_b16 v[120:121], v8 offset:57344
    v_mfma_f32_16x16x32_bf16 v[164:167], v[68:71], v[48:51], 0
    ds_read_b64_tr_b16 v[122:123], v9 offset:57344
    v_mfma_f32_16x16x32_bf16 v[176:179], v[64:67], v[56:59], 0
    ds_read_b64_tr_b16 v[124:125], v10 offset:57344
    v_mfma_f32_16x16x32_bf16 v[180:183], v[68:71], v[56:59], 0
    ds_read_b64_tr_b16 v[126:127], v11 offset:57344
    v_mfma_f32_16x16x32_bf16 v[128:131], v[72:75], v[36:39], v[128:131]
    ds_read_b128 v[80:83], v5 offset:32768
    v_mfma_f32_16x16x32_bf16 v[132:135], v[76:79], v[36:39], v[132:135]
    ds_read_b128 v[84:87], v5 offset:33792
    v_mfma_f32_16x16x32_bf16 v[144:147], v[72:75], v[44:47], v[144:147]
    ds_read_b128 v[88:91], v5 offset:34816
    v_mfma_f32_16x16x32_bf16 v[148:151], v[76:79], v[44:47], v[148:151]
    ds_read_b128 v[92:95], v5 offset:35840
    v_mfma_f32_16x16x32_bf16 v[160:163], v[72:75], v[52:55], v[160:163]
    ds_read_b128 v[96:99], v5 offset:36864
    v_mfma_f32_16x16x32_bf16 v[164:167], v[76:79], v[52:55], v[164:167]
    ds_read_b128 v[100:103], v5 offset:37888
    v_mfma_f32_16x16x32_bf16 v[176:179], v[72:75], v[60:63], v[176:179]
    ds_read_b128 v[104:107], v5 offset:38912
    v_mfma_f32_16x16x32_bf16 v[180:183], v[76:79], v[60:63], v[180:183]
    ds_read_b128 v[108:111], v5 offset:39936
    s_waitcnt lgkmcnt(0)
    s_waitcnt vmcnt(8)
    s_barrier
    s_add_u32 m0, s21, 32768
    s_nop 0
    buffer_load_dwordx4 v1, s[4:7], s16 offen sc1 lds
    s_add_u32 s16, s16, s62
    s_add_u32 m0, s21, 33792
    s_nop 0
    buffer_load_dwordx4 v1, s[4:7], s17 offen sc1 lds
    s_add_u32 s17, s17, s62
    s_add_u32 m0, s22, 32768
    s_nop 0
    buffer_load_dwordx4 v2, s[8:11], s18 offen lds
    s_add_u32 s18, s18, s20
    s_add_u32 m0, s22, 40960
    s_nop 0
    buffer_load_dwordx4 v2, s[12:15], s19 offen lds
    s_add_u32 s19, s19, s20
    v_mfma_f32_16x16x32_bf16 v[128:131], v[112:115], v[80:83], v[128:131]
    ds_read_b64_tr_b16 v[64:65], v12 offset:16384
    v_mfma_f32_16x16x32_bf16 v[132:135], v[116:119], v[80:83], v[132:135]
    ds_read_b64_tr_b16 v[66:67], v13 offset:16384
    v_mfma_f32_16x16x32_bf16 v[144:147], v[112:115], v[88:91], v[144:147]
    ds_read_b64_tr_b16 v[68:69], v14 offset:16384
    v_mfma_f32_16x16x32_bf16 v[148:151], v[116:119], v[88:91], v[148:151]
    ds_read_b64_tr_b16 v[70:71], v15 offset:16384
    v_mfma_f32_16x16x32_bf16 v[160:163], v[112:115], v[96:99], v[160:163]
    ds_read_b64_tr_b16 v[72:73], v12 offset:24576
    v_mfma_f32_16x16x32_bf16 v[164:167], v[116:119], v[96:99], v[164:167]
    ds_read_b64_tr_b16 v[74:75], v13 offset:24576
    v_mfma_f32_16x16x32_bf16 v[176:179], v[112:115], v[104:107], v[176:179]
    ds_read_b64_tr_b16 v[76:77], v14 offset:24576
    v_mfma_f32_16x16x32_bf16 v[180:183], v[116:119], v[104:107], v[180:183]
    ds_read_b64_tr_b16 v[78:79], v15 offset:24576
    v_mfma_f32_16x16x32_bf16 v[128:131], v[120:123], v[84:87], v[128:131]
    ds_read_b128 v[32:35], v6 offset:0
    v_mfma_f32_16x16x32_bf16 v[132:135], v[124:127], v[84:87], v[132:135]
    ds_read_b128 v[36:39], v6 offset:1024
    v_mfma_f32_16x16x32_bf16 v[144:147], v[120:123], v[92:95], v[144:147]
    ds_read_b128 v[40:43], v6 offset:2048
    v_mfma_f32_16x16x32_bf16 v[148:151], v[124:127], v[92:95], v[148:151]
    ds_read_b128 v[44:47], v6 offset:3072
    v_mfma_f32_16x16x32_bf16 v[160:163], v[120:123], v[100:103], v[160:163]
    ds_read_b128 v[48:51], v6 offset:4096
    v_mfma_f32_16x16x32_bf16 v[164:167], v[124:127], v[100:103], v[164:167]
    ds_read_b128 v[52:55], v6 offset:5120
    v_mfma_f32_16x16x32_bf16 v[176:179], v[120:123], v[108:111], v[176:179]
    ds_read_b128 v[56:59], v6 offset:6144
    v_mfma_f32_16x16x32_bf16 v[180:183], v[124:127], v[108:111], v[180:183]
    ds_read_b128 v[60:63], v6 offset:7168
    s_waitcnt lgkmcnt(0)
    s_waitcnt vmcnt(8)
    s_barrier
    s_add_u32 m0, s21, 65536
    s_nop 0
    buffer_load_dwordx4 v1, s[4:7], s16 offen sc1 lds
    s_add_u32 s16, s16, s62
    s_add_u32 m0, s21, 66560
    s_nop 0
    buffer_load_dwordx4 v1, s[4:7], s17 offen sc1 lds
    s_add_u32 s17, s17, s62
    s_add_u32 m0, s22, 65536
    s_nop 0
    buffer_load_dwordx4 v2, s[8:11], s18 offen lds
    s_add_u32 s18, s18, s20
    s_add_u32 m0, s22, 73728
    s_nop 0
    buffer_load_dwordx4 v2, s[12:15], s19 offen lds
    s_add_u32 s19, s19, s20
    v_mfma_f32_16x16x32_bf16 v[128:131], v[64:67], v[32:35], v[128:131]
    ds_read_b64_tr_b16 v[112:113], v12 offset:49152
    v_mfma_f32_16x16x32_bf16 v[132:135], v[68:71], v[32:35], v[132:135]
    ds_read_b64_tr_b16 v[114:115], v13 offset:49152
    v_mfma_f32_16x16x32_bf16 v[144:147], v[64:67], v[40:43], v[144:147]
    ds_read_b64_tr_b16 v[116:117], v14 offset:49152
    v_mfma_f32_16x16x32_bf16 v[148:151], v[68:71], v[40:43], v[148:151]
    ds_read_b64_tr_b16 v[118:119], v15 offset:49152
    v_mfma_f32_16x16x32_bf16 v[160:163], v[64:67], v[48:51], v[160:163]
    ds_read_b64_tr_b16 v[120:121], v12 offset:57344
    v_mfma_f32_16x16x32_bf16 v[164:167], v[68:71], v[48:51], v[164:167]
    ds_read_b64_tr_b16 v[122:123], v13 offset:57344
    v_mfma_f32_16x16x32_bf16 v[176:179], v[64:67], v[56:59], v[176:179]
    ds_read_b64_tr_b16 v[124:125], v14 offset:57344
    v_mfma_f32_16x16x32_bf16 v[180:183], v[68:71], v[56:59], v[180:183]
    ds_read_b64_tr_b16 v[126:127], v15 offset:57344
    v_mfma_f32_16x16x32_bf16 v[128:131], v[72:75], v[36:39], v[128:131]
    ds_read_b128 v[80:83], v6 offset:32768
    v_mfma_f32_16x16x32_bf16 v[132:135], v[76:79], v[36:39], v[132:135]
    ds_read_b128 v[84:87], v6 offset:33792
    v_mfma_f32_16x16x32_bf16 v[144:147], v[72:75], v[44:47], v[144:147]
    ds_read_b128 v[88:91], v6 offset:34816
    v_mfma_f32_16x16x32_bf16 v[148:151], v[76:79], v[44:47], v[148:151]
    ds_read_b128 v[92:95], v6 offset:35840
    v_mfma_f32_16x16x32_bf16 v[160:163], v[72:75], v[52:55], v[160:163]
    ds_read_b128 v[96:99], v6 offset:36864
    v_mfma_f32_16x16x32_bf16 v[164:167], v[76:79], v[52:55], v[164:167]
    ds_read_b128 v[100:103], v6 offset:37888
    v_mfma_f32_16x16x32_bf16 v[176:179], v[72:75], v[60:63], v[176:179]
    ds_read_b128 v[104:107], v6 offset:38912
    v_mfma_f32_16x16x32_bf16 v[180:183], v[76:79], v[60:63], v[180:183]
    ds_read_b128 v[108:111], v6 offset:39936
    s_waitcnt lgkmcnt(0)
    s_waitcnt vmcnt(8)
    s_barrier
    s_add_u32 m0, s21, 98304
    s_nop 0
    buffer_load_dwordx4 v1, s[4:7], s16 offen sc1 lds
    s_add_u32 s16, s16, s62
    s_add_u32 m0, s21, 99328
    s_nop 0
    buffer_load_dwordx4 v1, s[4:7], s17 offen sc1 lds
    s_add_u32 s17, s17, s62
    s_add_u32 m0, s22, 98304
    s_nop 0
    buffer_load_dwordx4 v2, s[8:11], s18 offen lds
    s_add_u32 s18, s18, s20
    s_add_u32 m0, s22, 106496
    s_nop 0
    buffer_load_dwordx4 v2, s[12:15], s19 offen lds
    s_add_u32 s19, s19, s20
    v_mfma_f32_16x16x32_bf16 v[128:131], v[112:115], v[80:83], v[128:131]
    ds_read_b64_tr_b16 v[64:65], v8 offset:16384
    v_mfma_f32_16x16x32_bf16 v[132:135], v[116:119], v[80:83], v[132:135]
    ds_read_b64_tr_b16 v[66:67], v9 offset:16384
    v_mfma_f32_16x16x32_bf16 v[144:147], v[112:115], v[88:91], v[144:147]
    ds_read_b64_tr_b16 v[68:69], v10 offset:16384
    v_mfma_f32_16x16x32_bf16 v[148:151], v[116:119], v[88:91], v[148:151]
    ds_read_b64_tr_b16 v[70:71], v11 offset:16384
    v_mfma_f32_16x16x32_bf16 v[160:163], v[112:115], v[96:99], v[160:163]
    ds_read_b64_tr_b16 v[72:73], v8 offset:24576
    v_mfma_f32_16x16x32_bf16 v[164:167], v[116:119], v[96:99], v[164:167]
    ds_read_b64_tr_b16 v[74:75], v9 offset:24576
    v_mfma_f32_16x16x32_bf16 v[176:179], v[112:115], v[104:107], v[176:179]
    ds_read_b64_tr_b16 v[76:77], v10 offset:24576
    v_mfma_f32_16x16x32_bf16 v[180:183], v[116:119], v[104:107], v[180:183]
    ds_read_b64_tr_b16 v[78:79], v11 offset:24576
    v_mfma_f32_16x16x32_bf16 v[128:131], v[120:123], v[84:87], v[128:131]
    ds_read_b128 v[32:35], v5 offset:0
    v_mfma_f32_16x16x32_bf16 v[132:135], v[124:127], v[84:87], v[132:135]
    ds_read_b128 v[36:39], v5 offset:1024
    v_mfma_f32_16x16x32_bf16 v[144:147], v[120:123], v[92:95], v[144:147]
    ds_read_b128 v[40:43], v5 offset:2048
    v_mfma_f32_16x16x32_bf16 v[148:151], v[124:127], v[92:95], v[148:151]
    ds_read_b128 v[44:47], v5 offset:3072
    v_mfma_f32_16x16x32_bf16 v[160:163], v[120:123], v[100:103], v[160:163]
    ds_read_b128 v[48:51], v5 offset:4096
    v_mfma_f32_16x16x32_bf16 v[164:167], v[124:127], v[100:103], v[164:167]
    ds_read_b128 v[52:55], v5 offset:5120
    v_mfma_f32_16x16x32_bf16 v[176:179], v[120:123], v[108:111], v[176:179]
    ds_read_b128 v[56:59], v5 offset:6144
    v_mfma_f32_16x16x32_bf16 v[180:183], v[124:127], v[108:111], v[180:183]
    ds_read_b128 v[60:63], v5 offset:7168
    s_waitcnt lgkmcnt(0)
w_loop_chkH:
    s_sub_u32 s23, s23, 1
w_loopH:
    s_cmp_lg_u32 s23, 1
    s_cbranch_scc1 w_bodyH
    buffer_load_dword v22, off, s[64:67], 0 sc1
    v_readfirstlane_b32 s30, v16
    s_cmp_ge_u32 s30, s45
    s_cselect_b32 s30, 0, 1
    s_or_b32 s30, s30, s70
    s_cmp_ge_u32 s32, 4
    s_cselect_b32 s30, 1, s30
    s_cmp_eq_u32 s32, 0
    s_cselect_b32 s30, 1, s30
    v_mov_b32 v20, s30
    ds_write_b32 v7, v20
    s_cbranch_scc1 w_ndH
    s_cmp_ge_u32 s32, 4
    s_cbranch_scc1 w_ndH
    s_cmp_lg_u32 s70, 0
    s_cbranch_scc1 w_ndH
    s_load_dwordx2 s[8:9], s[0:1], s33
    s_load_dwordx2 s[12:13], s[0:1], s34
    s_mov_b32 s10, s38
    s_mov_b32 s14, s38
    s_cmp_ge_u32 s32, 4
    s_cselect_b32 s31, 0, 1
    s_lshl_b32 s30, s3, s31
    s_mul_i32 s30, s30, s40
    s_add_u32 s16, s39, s30
    s_cmp_eq_u32 s32, 4
    s_cselect_b32 s30, 1024, s40
    s_cselect_b32 s31, 6, 5
    s_lshl_b32 s62, 32, s31
    s_add_u32 s17, s16, s30
    s_lshl_b32 s30, s3, 2
    s_mul_i32 s30, s30, s35
    s_add_u32 s18, s36, s30
    s_add_u32 s19, s37, s30
    s_lshl_b32 s20, s35, s31
    v_mul_u32_u24 v2, s35, v4
    v_add_u32 v2, v2, v3
    s_waitcnt lgkmcnt(0)
w_bodyH:
    s_waitcnt vmcnt(8)
    s_barrier
    s_add_u32 m0, s21, 0
    s_nop 0
    buffer_load_dwordx4 v1, s[4:7], s16 offen sc1 lds
    s_add_u32 s16, s16, s62
    s_add_u32 m0, s21, 1024
    s_nop 0
    buffer_load_dwordx4 v1, s[4:7], s17 offen sc1 lds
    s_add_u32 s17, s17, s62
    s_add_u32 m0, s22, 0
    s_nop 0
    buffer_load_dwordx4 v2, s[8:11], s18 offen lds
    s_add_u32 s18, s18, s20
    s_add_u32 m0, s22, 8192
    s_nop 0
    buffer_load_dwordx4 v2, s[12:15], s19 offen lds
    s_add_u32 s19, s19, s20
    v_mfma_f32_16x16x32_bf16 v[128:131], v[64:67], v[32:35], v[128:131]
    ds_read_b64_tr_b16 v[112:113], v8 offset:49152
    v_mfma_f32_16x16x32_bf16 v[132:135], v[68:71], v[32:35], v[132:135]
    ds_read_b64_tr_b16 v[114:115], v9 offset:49152
    v_mfma_f32_16x16x32_bf16 v[144:147], v[64:67], v[40:43], v[144:147]
    ds_read_b64_tr_b16 v[116:117], v10 offset:49152
    v_mfma_f32_16x16x32_bf16 v[148:151], v[68:71], v[40:43], v[148:151]
    ds_read_b64_tr_b16 v[118:119], v11 offset:49152
    v_mfma_f32_16x16x32_bf16 v[160:163], v[64:67], v[48:51], v[160:163]
    ds_read_b64_tr_b16 v[120:121], v8 offset:57344
    v_mfma_f32_16x16x32_bf16 v[164:167], v[68:71], v[48:51], v[164:167]
    ds_read_b64_tr_b16 v[122:123], v9 offset:57344
    v_mfma_f32_16x16x32_bf16 v[176:179], v[64:67], v[56:59], v[176:179]
    ds_read_b64_tr_b16 v[124:125], v10 offset:57344
    v_mfma_f32_16x16x32_bf16 v[180:183], v[68:71], v[56:59], v[180:183]
    ds_read_b64_tr_b16 v[126:127], v11 offset:57344
    v_mfma_f32_16x16x32_bf16 v[128:131], v[72:75], v[36:39], v[128:131]
    ds_read_b128 v[80:83], v5 offset:32768
    v_mfma_f32_16x16x32_bf16 v[132:135], v[76:79], v[36:39], v[132:135]
    ds_read_b128 v[84:87], v5 offset:33792
    v_mfma_f32_16x16x32_bf16 v[144:147], v[72:75], v[44:47], v[144:147]
    ds_read_b128 v[88:91], v5 offset:34816
    v_mfma_f32_16x16x32_bf16 v[148:151], v[76:79], v[44:47], v[148:151]
    ds_read_b128 v[92:95], v5 offset:35840
    v_mfma_f32_16x16x32_bf16 v[160:163], v[72:75], v[52:55], v[160:163]
    ds_read_b128 v[96:99], v5 offset:36864
    v_mfma_f32_16x16x32_bf16 v[164:167], v[76:79], v[52:55], v[164:167]
    ds_read_b128 v[100:103], v5 offset:37888
    v_mfma_f32_16x16x32_bf16 v[176:179], v[72:75], v[60:63], v[176:179]
    ds_read_b128 v[104:107], v5 offset:38912
    v_mfma_f32_16x16x32_bf16 v[180:183], v[76:79], v[60:63], v[180:183]
    ds_read_b128 v[108:111], v5 offset:39936
    buffer_load_dword v16, v17, s[4:7], s44 offen sc1
    s_waitcnt lgkmcnt(0)
    s_waitcnt vmcnt(8)
    s_barrier
    s_add_u32 m0, s21, 32768
    s_nop 0
    buffer_load_dwordx4 v1, s[4:7], s16 offen sc1 lds
    s_add_u32 s16, s16, s62
    s_add_u32 m0, s21, 33792
    s_nop 0
    buffer_load_dwordx4 v1, s[4:7], s17 offen sc1 lds
    s_add_u32 s17, s17, s62
    s_add_u32 m0, s22, 32768
    s_nop 0
    buffer_load_dwordx4 v2, s[8:11], s18 offen lds
    s_add_u32 s18, s18, s20
    s_add_u32 m0, s22, 40960
    s_nop 0
    buffer_load_dwordx4 v2, s[12:15], s19 offen lds
    s_add_u32 s19, s19, s20
    v_mfma_f32_16x16x32_bf16 v[128:131], v[112:115], v[80:83], v[128:131]
    ds_read_b64_tr_b16 v[64:65], v12 offset:16384
    v_mfma_f32_16x16x32_bf16 v[132:135], v[116:119], v[80:83], v[132:135]
    ds_read_b64_tr_b16 v[66:67], v13 offset:16384
    v_mfma_f32_16x16x32_bf16 v[144:147], v[112:115], v[88:91], v[144:147]
    ds_read_b64_tr_b16 v[68:69], v14 offset:16384
    v_mfma_f32_16x16x32_bf16 v[148:151], v[116:119], v[88:91], v[148:151]
    ds_read_b64_tr_b16 v[70:71], v15 offset:16384
    v_mfma_f32_16x16x32_bf16 v[160:163], v[112:115], v[96:99], v[160:163]
    ds_read_b64_tr_b16 v[72:73], v12 offset:24576
    v_mfma_f32_16x16x32_bf16 v[164:167], v[116:119], v[96:99], v[164:167]
    ds_read_b64_tr_b16 v[74:75], v13 offset:24576
    v_mfma_f32_16x16x32_bf16 v[176:179], v[112:115], v[104:107], v[176:179]
    ds_read_b64_tr_b16 v[76:77], v14 offset:24576
    v_mfma_f32_16x16x32_bf16 v[180:183], v[116:119], v[104:107], v[180:183]
    ds_read_b64_tr_b16 v[78:79], v15 offset:24576
    v_mfma_f32_16x16x32_bf16 v[128:131], v[120:123], v[84:87], v[128:131]
    ds_read_b128 v[32:35], v6 offset:0
    v_mfma_f32_16x16x32_bf16 v[132:135], v[124:127], v[84:87], v[132:135]
    ds_read_b128 v[36:39], v6 offset:1024
    v_mfma_f32_16x16x32_bf16 v[144:147], v[120:123], v[92:95], v[144:147]
    ds_read_b128 v[40:43], v6 offset:2048
    v_mfma_f32_16x16x32_bf16 v[148:151], v[124:127], v[92:95], v[148:151]
    ds_read_b128 v[44:47], v6 offset:3072
    v_mfma_f32_16x16x32_bf16 v[160:163], v[120:123], v[100:103], v[160:163]
    ds_read_b128 v[48:51], v6 offset:4096
    v_mfma_f32_16x16x32_bf16 v[164:167], v[124:127], v[100:103], v[164:167]
    ds_read_b128 v[52:55], v6 offset:5120
    v_mfma_f32_16x16x32_bf16 v[176:179], v[120:123], v[108:111], v[176:179]
    ds_read_b128 v[56:59], v6 offset:6144
    v_mfma_f32_16x16x32_bf16 v[180:183], v[124:127], v[108:111], v[180:183]
    ds_read_b128 v[60:63], v6 offset:7168
    s_waitcnt lgkmcnt(0)
    s_waitcnt vmcnt(8)
    s_barrier
    s_add_u32 m0, s21, 65536
    s_nop 0
    buffer_load_dwordx4 v1, s[4:7], s16 offen sc1 lds
    s_add_u32 s16, s16, s62
    s_add_u32 m0, s21, 66560
    s_nop 0
    buffer_load_dwordx4 v1, s[4:7], s17 offen sc1 lds
    s_add_u32 s17, s17, s62
    s_add_u32 m0, s22, 65536
    s_nop 0
    buffer_load_dwordx4 v2, s[8:11], s18 offen lds
    s_add_u32 s18, s18, s20
    s_add_u32 m0, s22, 73728
    s_nop 0
    buffer_load_dwordx4 v2, s[12:15], s19 offen lds
    s_add_u32 s19, s19, s20
    v_mfma_f32_16x16x32_bf16 v[128:131], v[64:67], v[32:35], v[128:131]
    ds_read_b64_tr_b16 v[112:113], v12 offset:49152
    v_mfma_f32_16x16x32_bf16 v[132:135], v[68:71], v[32:35], v[132:135]
    ds_read_b64_tr_b16 v[114:115], v13 offset:49152
    v_mfma_f32_16x16x32_bf16 v[144:147], v[64:67], v[40:43], v[144:147]
    ds_read_b64_tr_b16 v[116:117], v14 offset:49152
    v_mfma_f32_16x16x32_bf16 v[148:151], v[68:71], v[40:43], v[148:151]
    ds_read_b64_tr_b16 v[118:119], v15 offset:49152
    v_mfma_f32_16x16x32_bf16 v[160:163], v[64:67], v[48:51], v[160:163]
    ds_read_b64_tr_b16 v[120:121], v12 offset:57344
    v_mfma_f32_16x16x32_bf16 v[164:167], v[68:71], v[48:51], v[164:167]
    ds_read_b64_tr_b16 v[122:123], v13 offset:57344
    v_mfma_f32_16x16x32_bf16 v[176:179], v[64:67], v[56:59], v[176:179]
    ds_read_b64_tr_b16 v[124:125], v14 offset:57344
    v_mfma_f32_16x16x32_bf16 v[180:183], v[68:71], v[56:59], v[180:183]
    ds_read_b64_tr_b16 v[126:127], v15 offset:57344
    v_mfma_f32_16x16x32_bf16 v[128:131], v[72:75], v[36:39], v[128:131]
    ds_read_b128 v[80:83], v6 offset:32768
    v_mfma_f32_16x16x32_bf16 v[132:135], v[76:79], v[36:39], v[132:135]
    ds_read_b128 v[84:87], v6 offset:33792
    v_mfma_f32_16x16x32_bf16 v[144:147], v[72:75], v[44:47], v[144:147]
    ds_read_b128 v[88:91], v6 offset:34816
    v_mfma_f32_16x16x32_bf16 v[148:151], v[76:79], v[44:47], v[148:151]
    ds_read_b128 v[92:95], v6 offset:35840
    v_mfma_f32_16x16x32_bf16 v[160:163], v[72:75], v[52:55], v[160:163]
    ds_read_b128 v[96:99], v6 offset:36864
    v_mfma_f32_16x16x32_bf16 v[164:167], v[76:79], v[52:55], v[164:167]
    ds_read_b128 v[100:103], v6 offset:37888
    v_mfma_f32_16x16x32_bf16 v[176:179], v[72:75], v[60:63], v[176:179]
    ds_read_b128 v[104:107], v6 offset:38912
    v_mfma_f32_16x16x32_bf16 v[180:183], v[76:79], v[60:63], v[180:183]
    ds_read_b128 v[108:111], v6 offset:39936
    s_waitcnt lgkmcnt(0)
    s_waitcnt vmcnt(8)
    s_barrier
    s_add_u32 m0, s21, 98304
    s_nop 0
    buffer_load_dwordx4 v1, s[4:7], s16 offen sc1 lds
    s_add_u32 s16, s16, s62
    s_add_u32 m0, s21, 99328
    s_nop 0
    buffer_load_dwordx4 v1, s[4:7], s17 offen sc1 lds
    s_add_u32 s17, s17, s62
    s_add_u32 m0, s22, 98304
    s_nop 0
    buffer_load_dwordx4 v2, s[8:11], s18 offen lds
    s_add_u32 s18, s18, s20
    s_add_u32 m0, s22, 106496
    s_nop 0
    buffer_load_dwordx4 v2, s[12:15], s19 offen lds
    s_add_u32 s19, s19, s20
    v_mfma_f32_16x16x32_bf16 v[128:131], v[112:115], v[80:83], v[128:131]
    ds_read_b64_tr_b16 v[64:65], v8 offset:16384
    v_mfma_f32_16x16x32_bf16 v[132:135], v[116:119], v[80:83], v[132:135]
    ds_read_b64_tr_b16 v[66:67], v9 offset:16384
    v_mfma_f32_16x16x32_bf16 v[144:147], v[112:115], v[88:91], v[144:147]
    ds_read_b64_tr_b16 v[68:69], v10 offset:16384
    v_mfma_f32_16x16x32_bf16 v[148:151], v[116:119], v[88:91], v[148:151]
    ds_read_b64_tr_b16 v[70:71], v11 offset:16384
    v_mfma_f32_16x16x32_bf16 v[160:163], v[112:115], v[96:99], v[160:163]
    ds_read_b64_tr_b16 v[72:73], v8 offset:24576
    v_mfma_f32_16x16x32_bf16 v[164:167], v[116:119], v[96:99], v[164:167]
    ds_read_b64_tr_b16 v[74:75], v9 offset:24576
    v_mfma_f32_16x16x32_bf16 v[176:179], v[112:115], v[104:107], v[176:179]
    ds_read_b64_tr_b16 v[76:77], v10 offset:24576
    v_mfma_f32_16x16x32_bf16 v[180:183], v[116:119], v[104:107], v[180:183]
    ds_read_b64_tr_b16 v[78:79], v11 offset:24576
    v_mfma_f32_16x16x32_bf16 v[128:131], v[120:123], v[84:87], v[128:131]
    ds_read_b128 v[32:35], v5 offset:0
    v_mfma_f32_16x16x32_bf16 v[132:135], v[124:127], v[84:87], v[132:135]
    ds_read_b128 v[36:39], v5 offset:1024
    v_mfma_f32_16x16x32_bf16 v[144:147], v[120:123], v[92:95], v[144:147]
    ds_read_b128 v[40:43], v5 offset:2048
    v_mfma_f32_16x16x32_bf16 v[148:151], v[124:127], v[92:95], v[148:151]
    ds_read_b128 v[44:47], v5 offset:3072
    v_mfma_f32_16x16x32_bf16 v[160:163], v[120:123], v[100:103], v[160:163]
    ds_read_b128 v[48:51], v5 offset:4096
    v_mfma_f32_16x16x32_bf16 v[164:167], v[124:127], v[100:103], v[164:167]
    ds_read_b128 v[52:55], v5 offset:5120
    v_mfma_f32_16x16x32_bf16 v[176:179], v[120:123], v[108:111], v[176:179]
    ds_read_b128 v[56:59], v5 offset:6144
    v_mfma_f32_16x16x32_bf16 v[180:183], v[124:127], v[108:111], v[180:183]
    ds_read_b128 v[60:63], v5 offset:7168
    s_waitcnt lgkmcnt(0)
    s_sub_u32 s23, s23, 1
    s_cmp_lg_u32 s23, 0
    s_cbranch_scc1 w_loopH
    s_branch w_endH
w_ndH:
    s_waitcnt vmcnt(8)
    s_barrier
    v_mfma_f32_16x16x32_bf16 v[128:131], v[64:67], v[32:35], v[128:131]
    ds_read_b64_tr_b16 v[112:113], v8 offset:49152
    v_mfma_f32_16x16x32_bf16 v[132:135], v[68:71], v[32:35], v[132:135]
    ds_read_b64_tr_b16 v[114:115], v9 offset:49152
    v_mfma_f32_16x16x32_bf16 v[144:147], v[64:67], v[40:43], v[144:147]
    ds_read_b64_tr_b16 v[116:117], v10 offset:49152
    v_mfma_f32_16x16x32_bf16 v[148:151], v[68:71], v[40:43], v[148:151]
    ds_read_b64_tr_b16 v[118:119], v11 offset:49152
    v_mfma_f32_16x16x32_bf16 v[160:163], v[64:67], v[48:51], v[160:163]
    ds_read_b64_tr_b16 v[120:121], v8 offset:57344
    v_mfma_f32_16x16x32_bf16 v[164:167], v[68:71], v[48:51], v[164:167]
    ds_read_b64_tr_b16 v[122:123], v9 offset:57344
    v_mfma_f32_16x16x32_bf16 v[176:179], v[64:67], v[56:59], v[176:179]
    ds_read_b64_tr_b16 v[124:125], v10 offset:57344
    v_mfma_f32_16x16x32_bf16 v[180:183], v[68:71], v[56:59], v[180:183]
    ds_read_b64_tr_b16 v[126:127], v11 offset:57344
    v_mfma_f32_16x16x32_bf16 v[128:131], v[72:75], v[36:39], v[128:131]
    ds_read_b128 v[80:83], v5 offset:32768
    v_mfma_f32_16x16x32_bf16 v[132:135], v[76:79], v[36:39], v[132:135]
    ds_read_b128 v[84:87], v5 offset:33792
    v_mfma_f32_16x16x32_bf16 v[144:147], v[72:75], v[44:47], v[144:147]
    ds_read_b128 v[88:91], v5 offset:34816
    v_mfma_f32_16x16x32_bf16 v[148:151], v[76:79], v[44:47], v[148:151]
    ds_read_b128 v[92:95], v5 offset:35840
    v_mfma_f32_16x16x32_bf16 v[160:163], v[72:75], v[52:55], v[160:163]
    ds_read_b128 v[96:99], v5 offset:36864
    v_mfma_f32_16x16x32_bf16 v[164:167], v[76:79], v[52:55], v[164:167]
    ds_read_b128 v[100:103], v5 offset:37888
    v_mfma_f32_16x16x32_bf16 v[176:179], v[72:75], v[60:63], v[176:179]
    ds_read_b128 v[104:107], v5 offset:38912
    v_mfma_f32_16x16x32_bf16 v[180:183], v[76:79], v[60:63], v[180:183]
    ds_read_b128 v[108:111], v5 offset:39936
    s_waitcnt lgkmcnt(0)
    s_waitcnt vmcnt(4)
    s_barrier
    v_mfma_f32_16x16x32_bf16 v[128:131], v[112:115], v[80:83], v[128:131]
    ds_read_b64_tr_b16 v[64:65], v12 offset:16384
    v_mfma_f32_16x16x32_bf16 v[132:135], v[116:119], v[80:83], v[132:135]
    ds_read_b64_tr_b16 v[66:67], v13 offset:16384
    v_mfma_f32_16x16x32_bf16 v[144:147], v[112:115], v[88:91], v[144:147]
    ds_read_b64_tr_b16 v[68:69], v14 offset:16384
    v_mfma_f32_16x16x32_bf16 v[148:151], v[116:119], v[88:91], v[148:151]
    ds_read_b64_tr_b16 v[70:71], v15 offset:16384
    v_mfma_f32_16x16x32_bf16 v[160:163], v[112:115], v[96:99], v[160:163]
    ds_read_b64_tr_b16 v[72:73], v12 offset:24576
    v_mfma_f32_16x16x32_bf16 v[164:167], v[116:119], v[96:99], v[164:167]
    ds_read_b64_tr_b16 v[74:75], v13 offset:24576
    v_mfma_f32_16x16x32_bf16 v[176:179], v[112:115], v[104:107], v[176:179]
    ds_read_b64_tr_b16 v[76:77], v14 offset:24576
    v_mfma_f32_16x16x32_bf16 v[180:183], v[116:119], v[104:107], v[180:183]
    ds_read_b64_tr_b16 v[78:79], v15 offset:24576
    v_mfma_f32_16x16x32_bf16 v[128:131], v[120:123], v[84:87], v[128:131]
    ds_read_b128 v[32:35], v6 offset:0
    v_mfma_f32_16x16x32_bf16 v[132:135], v[124:127], v[84:87], v[132:135]
    ds_read_b128 v[36:39], v6 offset:1024
    v_mfma_f32_16x16x32_bf16 v[144:147], v[120:123], v[92:95], v[144:147]
    ds_read_b128 v[40:43], v6 offset:2048
    v_mfma_f32_16x16x32_bf16 v[148:151], v[124:127], v[92:95], v[148:151]
    ds_read_b128 v[44:47], v6 offset:3072
    v_mfma_f32_16x16x32_bf16 v[160:163], v[120:123], v[100:103], v[160:163]
    ds_read_b128 v[48:51], v6 offset:4096
    v_mfma_f32_16x16x32_bf16 v[164:167], v[124:127], v[100:103], v[164:167]
    ds_read_b128 v[52:55], v6 offset:5120
    v_mfma_f32_16x16x32_bf16 v[176:179], v[120:123], v[108:111], v[176:179]
    ds_read_b128 v[56:59], v6 offset:6144
    v_mfma_f32_16x16x32_bf16 v[180:183], v[124:127], v[108:111], v[180:183]
    ds_read_b128 v[60:63], v6 offset:7168
    s_waitcnt lgkmcnt(0)
    s_waitcnt vmcnt(0)
    s_barrier
    v_mfma_f32_16x16x32_bf16 v[128:131], v[64:67], v[32:35], v[128:131]
    ds_read_b64_tr_b16 v[112:113], v12 offset:49152
    v_mfma_f32_16x16x32_bf16 v[132:135], v[68:71], v[32:35], v[132:135]
    ds_read_b64_tr_b16 v[114:115], v13 offset:49152
    v_mfma_f32_16x16x32_bf16 v[144:147], v[64:67], v[40:43], v[144:147]
    ds_read_b64_tr_b16 v[116:117], v14 offset:49152
    v_mfma_f32_16x16x32_bf16 v[148:151], v[68:71], v[40:43], v[148:151]
    ds_read_b64_tr_b16 v[118:119], v15 offset:49152
    v_mfma_f32_16x16x32_bf16 v[160:163], v[64:67], v[48:51], v[160:163]
    ds_read_b64_tr_b16 v[120:121], v12 offset:57344
    v_mfma_f32_16x16x32_bf16 v[164:167], v[68:71], v[48:51], v[164:167]
    ds_read_b64_tr_b16 v[122:123], v13 offset:57344
    v_mfma_f32_16x16x32_bf16 v[176:179], v[64:67], v[56:59], v[176:179]
    ds_read_b64_tr_b16 v[124:125], v14 offset:57344
    v_mfma_f32_16x16x32_bf16 v[180:183], v[68:71], v[56:59], v[180:183]
    ds_read_b64_tr_b16 v[126:127], v15 offset:57344
    v_mfma_f32_16x16x32_bf16 v[128:131], v[72:75], v[36:39], v[128:131]
    ds_read_b128 v[80:83], v6 offset:32768
    v_mfma_f32_16x16x32_bf16 v[132:135], v[76:79], v[36:39], v[132:135]
    ds_read_b128 v[84:87], v6 offset:33792
    v_mfma_f32_16x16x32_bf16 v[144:147], v[72:75], v[44:47], v[144:147]
    ds_read_b128 v[88:91], v6 offset:34816
    v_mfma_f32_16x16x32_bf16 v[148:151], v[76:79], v[44:47], v[148:151]
    ds_read_b128 v[92:95], v6 offset:35840
    v_mfma_f32_16x16x32_bf16 v[160:163], v[72:75], v[52:55], v[160:163]
    ds_read_b128 v[96:99], v6 offset:36864
    v_mfma_f32_16x16x32_bf16 v[164:167], v[76:79], v[52:55], v[164:167]
    ds_read_b128 v[100:103], v6 offset:37888
    v_mfma_f32_16x16x32_bf16 v[176:179], v[72:75], v[60:63], v[176:179]
    ds_read_b128 v[104:107], v6 offset:38912
    v_mfma_f32_16x16x32_bf16 v[180:183], v[76:79], v[60:63], v[180:183]
    ds_read_b128 v[108:111], v6 offset:39936
    s_waitcnt lgkmcnt(0)
    s_waitcnt vmcnt(0)
    s_barrier
    v_mfma_f32_16x16x32_bf16 v[128:131], v[112:115], v[80:83], v[128:131]
    ds_read_b64_tr_b16 v[64:65], v8 offset:16384
    v_mfma_f32_16x16x32_bf16 v[132:135], v[116:119], v[80:83], v[132:135]
    ds_read_b64_tr_b16 v[66:67], v9 offset:16384
    v_mfma_f32_16x16x32_bf16 v[144:147], v[112:115], v[88:91], v[144:147]
    ds_read_b64_tr_b16 v[68:69], v10 offset:16384
    v_mfma_f32_16x16x32_bf16 v[148:151], v[116:119], v[88:91], v[148:151]
    ds_read_b64_tr_b16 v[70:71], v11 offset:16384
    v_mfma_f32_16x16x32_bf16 v[160:163], v[112:115], v[96:99], v[160:163]
    ds_read_b64_tr_b16 v[72:73], v8 offset:24576
    v_mfma_f32_16x16x32_bf16 v[164:167], v[116:119], v[96:99], v[164:167]
    ds_read_b64_tr_b16 v[74:75], v9 offset:24576
    v_mfma_f32_16x16x32_bf16 v[176:179], v[112:115], v[104:107], v[176:179]
    ds_read_b64_tr_b16 v[76:77], v10 offset:24576
    v_mfma_f32_16x16x32_bf16 v[180:183], v[116:119], v[104:107], v[180:183]
    ds_read_b64_tr_b16 v[78:79], v11 offset:24576
    v_mfma_f32_16x16x32_bf16 v[128:131], v[120:123], v[84:87], v[128:131]
    ds_read_b128 v[32:35], v5 offset:0
    v_mfma_f32_16x16x32_bf16 v[132:135], v[124:127], v[84:87], v[132:135]
    ds_read_b128 v[36:39], v5 offset:1024
    v_mfma_f32_16x16x32_bf16 v[144:147], v[120:123], v[92:95], v[144:147]
    ds_read_b128 v[40:43], v5 offset:2048
    v_mfma_f32_16x16x32_bf16 v[148:151], v[124:127], v[92:95], v[148:151]
    ds_read_b128 v[44:47], v5 offset:3072
    v_mfma_f32_16x16x32_bf16 v[160:163], v[120:123], v[100:103], v[160:163]
    ds_read_b128 v[48:51], v5 offset:4096
    v_mfma_f32_16x16x32_bf16 v[164:167], v[124:127], v[100:103], v[164:167]
    ds_read_b128 v[52:55], v5 offset:5120
    v_mfma_f32_16x16x32_bf16 v[176:179], v[120:123], v[108:111], v[176:179]
    ds_read_b128 v[56:59], v5 offset:6144
    v_mfma_f32_16x16x32_bf16 v[180:183], v[124:127], v[108:111], v[180:183]
    ds_read_b128 v[60:63], v5 offset:7168
    s_waitcnt lgkmcnt(0)
w_endH:
    v_mov_b32 v20, 131072
    ds_read_b128 v[24:27], v20
    ds_read_b128 v[28:31], v20 offset:16
    s_cmp_lg_u32 s53, s53
    s_cbranch_scc1 w_epi_siluH
    s_lshl_b32 s30, s27, 10
    s_add_u32 s30, s30, s49
    s_nop 7
    v_cvt_pk_bf16_f32 v80, v128, v129
    v_cvt_pk_bf16_f32 v81, v130, v131
    v_cvt_pk_bf16_f32 v82, v132, v133
    v_cvt_pk_bf16_f32 v83, v134, v135
    buffer_store_dwordx4 v[80:83], v1, s[4:7], s30 offen sc1
    s_add_u32 s30, s30, s50
    v_cvt_pk_bf16_f32 v84, v144, v145
    v_cvt_pk_bf16_f32 v85, v146, v147
    v_cvt_pk_bf16_f32 v86, v148, v149
    v_cvt_pk_bf16_f32 v87, v150, v151
    buffer_store_dwordx4 v[84:87], v1, s[4:7], s30 offen sc1
    s_add_u32 s30, s30, s50
    v_cvt_pk_bf16_f32 v88, v160, v161
    v_cvt_pk_bf16_f32 v89, v162, v163
    v_cvt_pk_bf16_f32 v90, v164, v165
    v_cvt_pk_bf16_f32 v91, v166, v167
    buffer_store_dwordx4 v[88:91], v1, s[4:7], s30 offen sc1
    s_add_u32 s30, s30, s50
    v_cvt_pk_bf16_f32 v92, v176, v177
    v_cvt_pk_bf16_f32 v93, v178, v179
    v_cvt_pk_bf16_f32 v94, v180, v181
    v_cvt_pk_bf16_f32 v95, v182, v183
    buffer_store_dwordx4 v[92:95], v1, s[4:7], s30 offen sc1
    s_add_u32 s30, s30, s50
    s_waitcnt lgkmcnt(0)
    v_or3_b32 v24, v24, v25, v26
    v_or3_b32 v28, v28, v29, v30
    v_or3_b32 v24, v24, v27, v31
    v_or_b32 v24, v24, v28
    s_mov_b32 s28, s51
    s_mov_b32 s57, s53
    v_readfirstlane_b32 s30, v24
    s_cmp_lg_u32 s30, 0
    s_cbranch_scc1 w_drain
    s_mov_b32 s48, s32
    s_cmp_ge_u32 s32, 4
    s_cselect_b32 s30, 2, 3
    s_lshl_b32 s30, s26, s30
    s_mul_i32 s30, s30, s43
    s_add_u32 s49, s42, s30
    s_mov_b32 s50, s43
    s_mov_b32 s51, s46
    s_mov_b32 s23, s41
    s_mov_b32 s53, s47
    s_nop 0
    s_load_dwordx16 s[32:47], s[24:25], 0
    s_add_u32 s24, s24, 64
    s_addc_u32 s25, s25, 0
    s_branch w_first4
w_epi_siluH:
    s_lshl_b32 s30, s27, 10
    s_add_u32 s30, s30, s49
    s_mov_b32 s54, 0xbfb8aa3b
    s_nop 7
    v_cvt_pk_bf16_f32 v80, v128, v129
    v_cvt_pk_bf16_f32 v81, v130, v131
    v_cvt_pk_bf16_f32 v82, v132, v133
    v_cvt_pk_bf16_f32 v83, v134, v135
    v_lshlrev_b32 v128, 16, v80
    v_and_b32 v129, 0xffff0000, v80
    v_lshlrev_b32 v130, 16, v81
    v_and_b32 v131, 0xffff0000, v81
    v_lshlrev_b32 v132, 16, v82
    v_and_b32 v133, 0xffff0000, v82
    v_lshlrev_b32 v134, 16, v83
    v_and_b32 v135, 0xffff0000, v83
    v_mul_f32 v104, s54, v128
    v_mul_f32 v105, s54, v129
    v_mul_f32 v106, s54, v130
    v_mul_f32 v107, s54, v131
    v_mul_f32 v108, s54, v132
    v_mul_f32 v109, s54, v133
    v_mul_f32 v110, s54, v134
    v_mul_f32 v111, s54, v135
    v_exp_f32 v104, v104
    v_exp_f32 v105, v105
    v_exp_f32 v106, v106
    v_exp_f32 v107, v107
    v_exp_f32 v108, v108
    v_exp_f32 v109, v109
    v_exp_f32 v110, v110
    v_exp_f32 v111, v111
    v_add_f32 v104, 1.0, v104
    v_add_f32 v105, 1.0, v105
    v_add_f32 v106, 1.0, v106
    v_add_f32 v107, 1.0, v107
    v_add_f32 v108, 1.0, v108
    v_add_f32 v109, 1.0, v109
    v_add_f32 v110, 1.0, v110
    v_add_f32 v111, 1.0, v111
    v_rcp_f32 v104, v104
    v_rcp_f32 v105, v105
    v_rcp_f32 v106, v106
    v_rcp_f32 v107, v107
    v_rcp_f32 v108, v108
    v_rcp_f32 v109, v109
    v_rcp_f32 v110, v110
    v_rcp_f32 v111, v111
    v_mul_f32 v128, v128, v104
    v_mul_f32 v129, v129, v105
    v_mul_f32 v130, v130, v106
    v_mul_f32 v131, v131, v107
    v_mul_f32 v132, v132, v108
    v_mul_f32 v133, v133, v109
    v_mul_f32 v134, v134, v110
    v_mul_f32 v135, v135, v111
    v_cvt_pk_bf16_f32 v80, v128, v129
    v_cvt_pk_bf16_f32 v81, v130, v131
    v_cvt_pk_bf16_f32 v82, v132, v133
    v_cvt_pk_bf16_f32 v83, v134, v135
    buffer_store_dwordx4 v[80:83], v1, s[4:7], s30 offen sc1
    s_add_u32 s30, s30, s50
    v_cvt_pk_bf16_f32 v84, v144, v145
    v_cvt_pk_bf16_f32 v85, v146, v147
    v_cvt_pk_bf16_f32 v86, v148, v149
    v_cvt_pk_bf16_f32 v87, v150, v151
    v_lshlrev_b32 v144, 16, v84
    v_and_b32 v145, 0xffff0000, v84
    v_lshlrev_b32 v146, 16, v85
    v_and_b32 v147, 0xffff0000, v85
    v_lshlrev_b32 v148, 16, v86
    v_and_b32 v149, 0xffff0000, v86
    v_lshlrev_b32 v150, 16, v87
    v_and_b32 v151, 0xffff0000, v87
    v_mul_f32 v96, s54, v144
    v_mul_f32 v97, s54, v145
    v_mul_f32 v98, s54, v146
    v_mul_f32 v99, s54, v147
    v_mul_f32 v100, s54, v148
    v_mul_f32 v101, s54, v149
    v_mul_f32 v102, s54, v150
    v_mul_f32 v103, s54, v151
    v_exp_f32 v96, v96
    v_exp_f32 v97, v97
    v_exp_f32 v98, v98
    v_exp_f32 v99, v99
    v_exp_f32 v100, v100
    v_exp_f32 v101, v101
    v_exp_f32 v102, v102
    v_exp_f32 v103, v103
    v_add_f32 v96, 1.0, v96
    v_add_f32 v97, 1.0, v97
    v_add_f32 v98, 1.0, v98
    v_add_f32 v99, 1.0, v99
    v_add_f32 v100, 1.0, v100
    v_add_f32 v101, 1.0, v101
    v_add_f32 v102, 1.0, v102
    v_add_f32 v103, 1.0, v103
    v_rcp_f32 v96, v96
    v_rcp_f32 v97, v97
    v_rcp_f32 v98, v98
    v_rcp_f32 v99, v99
    v_rcp_f32 v100, v100
    v_rcp_f32 v101, v101
    v_rcp_f32 v102, v102
    v_rcp_f32 v103, v103
    v_mul_f32 v144, v144, v96
    v_mul_f32 v145, v145, v97
    v_mul_f32 v146, v146, v98
    v_mul_f32 v147, v147, v99
    v_mul_f32 v148, v148, v100
    v_mul_f32 v149, v149, v101
    v_mul_f32 v150, v150, v102
    v_mul_f32 v151, v151, v103
    v_cvt_pk_bf16_f32 v84, v144, v145
    v_cvt_pk_bf16_f32 v85, v146, v147
    v_cvt_pk_bf16_f32 v86, v148, v149
    v_cvt_pk_bf16_f32 v87, v150, v151
    buffer_store_dwordx4 v[84:87], v1, s[4:7], s30 offen sc1
    s_add_u32 s30, s30, s50
    v_cvt_pk_bf16_f32 v88, v160, v161
    v_cvt_pk_bf16_f32 v89, v162, v163
    v_cvt_pk_bf16_f32 v90, v164, v165
    v_cvt_pk_bf16_f32 v91, v166, v167
    v_lshlrev_b32 v160, 16, v88
    v_and_b32 v161, 0xffff0000, v88
    v_lshlrev_b32 v162, 16, v89
    v_and_b32 v163, 0xffff0000, v89
    v_lshlrev_b32 v164, 16, v90
    v_and_b32 v165, 0xffff0000, v90
    v_lshlrev_b32 v166, 16, v91
    v_and_b32 v167, 0xffff0000, v91
    v_mul_f32 v104, s54, v160
    v_mul_f32 v105, s54, v161
    v_mul_f32 v106, s54, v162
    v_mul_f32 v107, s54, v163
    v_mul_f32 v108, s54, v164
    v_mul_f32 v109, s54, v165
    v_mul_f32 v110, s54, v166
    v_mul_f32 v111, s54, v167
    v_exp_f32 v104, v104
    v_exp_f32 v105, v105
    v_exp_f32 v106, v106
    v_exp_f32 v107, v107
    v_exp_f32 v108, v108
    v_exp_f32 v109, v109
    v_exp_f32 v110, v110
    v_exp_f32 v111, v111
    v_add_f32 v104, 1.0, v104
    v_add_f32 v105, 1.0, v105
    v_add_f32 v106, 1.0, v106
    v_add_f32 v107, 1.0, v107
    v_add_f32 v108, 1.0, v108
    v_add_f32 v109, 1.0, v109
    v_add_f32 v110, 1.0, v110
    v_add_f32 v111, 1.0, v111
    v_rcp_f32 v104, v104
    v_rcp_f32 v105, v105
    v_rcp_f32 v106, v106
    v_rcp_f32 v107, v107
    v_rcp_f32 v108, v108
    v_rcp_f32 v109, v109
    v_rcp_f32 v110, v110
    v_rcp_f32 v111, v111
    v_mul_f32 v160, v160, v104
    v_mul_f32 v161, v161, v105
    v_mul_f32 v162, v162, v106
    v_mul_f32 v163, v163, v107
    v_mul_f32 v164, v164, v108
    v_mul_f32 v165, v165, v109
    v_mul_f32 v166, v166, v110
    v_mul_f32 v167, v167, v111
    v_cvt_pk_bf16_f32 v88, v160, v161
    v_cvt_pk_bf16_f32 v89, v162, v163
    v_cvt_pk_bf16_f32 v90, v164, v165
    v_cvt_pk_bf16_f32 v91, v166, v167
    buffer_store_dwordx4 v[88:91], v1, s[4:7], s30 offen sc1
    s_add_u32 s30, s30, s50
    v_cvt_pk_bf16_f32 v92, v176, v177
    v_cvt_pk_bf16_f32 v93, v178, v179
    v_cvt_pk_bf16_f32 v94, v180, v181
    v_cvt_pk_bf16_f32 v95, v182, v183
    v_lshlrev_b32 v176, 16, v92
    v_and_b32 v177, 0xffff0000, v92
    v_lshlrev_b32 v178, 16, v93
    v_and_b32 v179, 0xffff0000, v93
    v_lshlrev_b32 v180, 16, v94
    v_and_b32 v181, 0xffff0000, v94
    v_lshlrev_b32 v182, 16, v95
    v_and_b32 v183, 0xffff0000, v95
    v_mul_f32 v96, s54, v176
    v_mul_f32 v97, s54, v177
    v_mul_f32 v98, s54, v178
    v_mul_f32 v99, s54, v179
    v_mul_f32 v100, s54, v180
    v_mul_f32 v101, s54, v181
    v_mul_f32 v102, s54, v182
    v_mul_f32 v103, s54, v183
    v_exp_f32 v96, v96
    v_exp_f32 v97, v97
    v_exp_f32 v98, v98
    v_exp_f32 v99, v99
    v_exp_f32 v100, v100
    v_exp_f32 v101, v101
    v_exp_f32 v102, v102
    v_exp_f32 v103, v103
    v_add_f32 v96, 1.0, v96
    v_add_f32 v97, 1.0, v97
    v_add_f32 v98, 1.0, v98
    v_add_f32 v99, 1.0, v99
    v_add_f32 v100, 1.0, v100
    v_add_f32 v101, 1.0, v101
    v_add_f32 v102, 1.0, v102
    v_add_f32 v103, 1.0, v103
    v_rcp_f32 v96, v96
    v_rcp_f32 v97, v97
    v_rcp_f32 v98, v98
    v_rcp_f32 v99, v99
    v_rcp_f32 v100, v100
    v_rcp_f32 v101, v101
    v_rcp_f32 v102, v102
    v_rcp_f32 v103, v103
    v_mul_f32 v176, v176, v96
    v_mul_f32 v177, v177, v97
    v_mul_f32 v178, v178, v98
    v_mul_f32 v179, v179, v99
    v_mul_f32 v180, v180, v100
    v_mul_f32 v181, v181, v101
    v_mul_f32 v182, v182, v102
    v_mul_f32 v183, v183, v103
    v_cvt_pk_bf16_f32 v92, v176, v177
    v_cvt_pk_bf16_f32 v93, v178, v179
    v_cvt_pk_bf16_f32 v94, v180, v181
    v_cvt_pk_bf16_f32 v95, v182, v183
    buffer_store_dwordx4 v[92:95], v1, s[4:7], s30 offen sc1
    s_add_u32 s30, s30, s50
    s_waitcnt lgkmcnt(0)
    v_or3_b32 v24, v24, v25, v26
    v_or3_b32 v28, v28, v29, v30
    v_or3_b32 v24, v24, v27, v31
    v_or_b32 v24, v24, v28
    s_mov_b32 s28, s51
    s_mov_b32 s57, s53
    v_readfirstlane_b32 s30, v24
    s_cmp_lg_u32 s30, 0
    s_cbranch_scc1 w_drain
    s_mov_b32 s48, s32
    s_cmp_ge_u32 s32, 4
    s_cselect_b32 s30, 2, 3
    s_lshl_b32 s30, s26, s30
    s_mul_i32 s30, s30, s43
    s_add_u32 s49, s42, s30
    s_mov_b32 s50, s43
    s_mov_b32 s51, s46
    s_mov_b32 s23, s41
    s_mov_b32 s53, s47
    s_nop 0
    s_load_dwordx16 s[32:47], s[24:25], 0
    s_add_u32 s24, s24, 64
    s_addc_u32 s25, s25, 0
    s_branch w_first4
w_firstX:
    s_waitcnt vmcnt(0)
    s_barrier
    v_bfe_u32 v20, v1, 4, 3
    v_xor_b32 v21, v4, v20
    v_lshlrev_b32 v21, 4, v21
    v_lshl_add_u32 v21, v20, 7, v21
    v_bfe_u32 v20, v1, 7, 1
    v_lshl_add_u32 v21, v20, 10, v21
    s_lshl_b32 s30, s26, 13
    v_add_u32 v24, s30, v21
    v_xor_b32 v25, 64, v24
    v_add_u32 v26, 0x10000, v24
    v_add_u32 v27, 0x10000, v25
    v_add_u32 v28, s22, v1
    v_add_u32 v29, 0x10000, v28
    ds_read_b64_tr_b16 v[64:65], v8 offset:16384
    ds_read_b64_tr_b16 v[66:67], v9 offset:16384
    ds_read_b64_tr_b16 v[68:69], v10 offset:16384
    ds_read_b64_tr_b16 v[70:71], v11 offset:16384
    ds_read_b64_tr_b16 v[72:73], v8 offset:24576
    ds_read_b64_tr_b16 v[74:75], v9 offset:24576
    ds_read_b64_tr_b16 v[76:77], v10 offset:24576
    ds_read_b64_tr_b16 v[78:79], v11 offset:24576
    ds_read_b128 v[32:35], v24 offset:0
    ds_read_b128 v[36:39], v25 offset:0
    ds_read_b128 v[40:43], v24 offset:2048
    ds_read_b128 v[44:47], v25 offset:2048
    ds_read_b128 v[48:51], v24 offset:4096
    ds_read_b128 v[52:55], v25 offset:4096
    ds_read_b128 v[56:59], v24 offset:6144
    ds_read_b128 v[60:63], v25 offset:6144
    v_mov_b32 v208, 0x3f803f80
    v_mov_b32 v209, 0x3f803f80
    v_mov_b32 v210, 0x3f803f80
    v_mov_b32 v211, 0x3f803f80
    s_waitcnt lgkmcnt(0)
    s_waitcnt vmcnt(8)
    s_barrier
    s_add_u32 m0, s21, 0
    s_nop 0
    buffer_load_dwordx4 v23, s[88:91], s16 offen lds
    s_add_u32 s16, s16, s62
    s_add_u32 m0, s21, 1024
    s_nop 0
    buffer_load_dwordx4 v23, s[88:91], s17 offen lds
    s_add_u32 s17, s17, s62
    s_cmp_ge_u32 s16, s92
    s_cselect_b32 s94, 2048, 0
    s_sub_u32 s16, s16, s94
    s_sub_u32 s17, s17, s94
    s_add_u32 m0, s22, 0
    s_nop 0
    buffer_load_dwordx4 v2, s[8:11], s18 offen lds
    s_add_u32 s18, s18, s20
    s_add_u32 m0, s22, 8192
    s_nop 0
    buffer_load_dwordx4 v2, s[12:15], s19 offen lds
    s_add_u32 s19, s19, s20
    s_cmp_ge_u32 s18, s95
    s_cselect_b32 s94, s93, 0
    s_sub_u32 s18, s18, s94
    s_sub_u32 s19, s19, s94
    v_mfma_f32_16x16x32_bf16 v[128:131], v[64:67], v[32:35], 0
    ds_read_b64_tr_b16 v[112:113], v8 offset:49152
    v_mfma_f32_16x16x32_bf16 v[132:135], v[68:71], v[32:35], 0
    ds_read_b64_tr_b16 v[114:115], v9 offset:49152
    v_mfma_f32_16x16x32_bf16 v[144:147], v[64:67], v[40:43], 0
    ds_read_b64_tr_b16 v[116:117], v10 offset:49152
    v_mfma_f32_16x16x32_bf16 v[148:151], v[68:71], v[40:43], 0
    ds_read_b64_tr_b16 v[118:119], v11 offset:49152
    v_mfma_f32_16x16x32_bf16 v[160:163], v[64:67], v[48:51], 0
    ds_read_b64_tr_b16 v[120:121], v8 offset:57344
    v_mfma_f32_16x16x32_bf16 v[164:167], v[68:71], v[48:51], 0
    ds_read_b64_tr_b16 v[122:123], v9 offset:57344
    v_mfma_f32_16x16x32_bf16 v[176:179], v[64:67], v[56:59], 0
    ds_read_b64_tr_b16 v[124:125], v10 offset:57344
    v_mfma_f32_16x16x32_bf16 v[180:183], v[68:71], v[56:59], 0
    ds_read_b64_tr_b16 v[126:127], v11 offset:57344
    v_mfma_f32_16x16x32_bf16 v[192:195], v[64:67], v[208:211], 0
    ds_read_b128 v[80:83], v24 offset:32768
    v_mfma_f32_16x16x32_bf16 v[196:199], v[68:71], v[208:211], 0
    ds_read_b128 v[84:87], v25 offset:32768
    v_mfma_f32_16x16x32_bf16 v[128:131], v[72:75], v[36:39], v[128:131]
    ds_read_b128 v[88:91], v24 offset:34816
    v_mfma_f32_16x16x32_bf16 v[132:135], v[76:79], v[36:39], v[132:135]
    ds_read_b128 v[92:95], v25 offset:34816
    v_mfma_f32_16x16x32_bf16 v[144:147], v[72:75], v[44:47], v[144:147]
    ds_read_b128 v[96:99], v24 offset:36864
    v_mfma_f32_16x16x32_bf16 v[148:151], v[76:79], v[44:47], v[148:151]
    ds_read_b128 v[100:103], v25 offset:36864
    v_mfma_f32_16x16x32_bf16 v[160:163], v[72:75], v[52:55], v[160:163]
    ds_read_b128 v[104:107], v24 offset:38912
    v_mfma_f32_16x16x32_bf16 v[164:167], v[76:79], v[52:55], v[164:167]
    ds_read_b128 v[108:111], v25 offset:38912
    v_mfma_f32_16x16x32_bf16 v[176:179], v[72:75], v[60:63], v[176:179]
    v_mfma_f32_16x16x32_bf16 v[180:183], v[76:79], v[60:63], v[180:183]
    v_mfma_f32_16x16x32_bf16 v[192:195], v[72:75], v[208:211], v[192:195]
    v_mfma_f32_16x16x32_bf16 v[196:199], v[76:79], v[208:211], v[196:199]
    s_waitcnt lgkmcnt(0)
    s_waitcnt vmcnt(8)
    s_barrier
    s_add_u32 m0, s21, 32768
    s_nop 0
    buffer_load_dwordx4 v23, s[88:91], s16 offen lds
    s_add_u32 s16, s16, s62
    s_add_u32 m0, s21, 33792
    s_nop 0
    buffer_load_dwordx4 v23, s[88:91], s17 offen lds
    s_add_u32 s17, s17, s62
    s_cmp_ge_u32 s16, s92
    s_cselect_b32 s94, 2048, 0
    s_sub_u32 s16, s16, s94
    s_sub_u32 s17, s17, s94
    s_add_u32 m0, s22, 32768
    s_nop 0
    buffer_load_dwordx4 v2, s[8:11], s18 offen lds
    s_add_u32 s18, s18, s20
    s_add_u32 m0, s22, 40960
    s_nop 0
    buffer_load_dwordx4 v2, s[12:15], s19 offen lds
    s_add_u32 s19, s19, s20
    s_cmp_ge_u32 s18, s95
    s_cselect_b32 s94, s93, 0
    s_sub_u32 s18, s18, s94
    s_sub_u32 s19, s19, s94
    v_mfma_f32_16x16x32_bf16 v[128:131], v[112:115], v[80:83], v[128:131]
    ds_read_b64_tr_b16 v[64:65], v12 offset:16384
    v_mfma_f32_16x16x32_bf16 v[132:135], v[116:119], v[80:83], v[132:135]
    ds_read_b64_tr_b16 v[66:67], v13 offset:16384
    v_mfma_f32_16x16x32_bf16 v[144:147], v[112:115], v[88:91], v[144:147]
    ds_read_b64_tr_b16 v[68:69], v14 offset:16384
    v_mfma_f32_16x16x32_bf16 v[148:151], v[116:119], v[88:91], v[148:151]
    ds_read_b64_tr_b16 v[70:71], v15 offset:16384
    v_mfma_f32_16x16x32_bf16 v[160:163], v[112:115], v[96:99], v[160:163]
    ds_read_b64_tr_b16 v[72:73], v12 offset:24576
    v_mfma_f32_16x16x32_bf16 v[164:167], v[116:119], v[96:99], v[164:167]
    ds_read_b64_tr_b16 v[74:75], v13 offset:24576
    v_mfma_f32_16x16x32_bf16 v[176:179], v[112:115], v[104:107], v[176:179]
    ds_read_b64_tr_b16 v[76:77], v14 offset:24576
    v_mfma_f32_16x16x32_bf16 v[180:183], v[116:119], v[104:107], v[180:183]
    ds_read_b64_tr_b16 v[78:79], v15 offset:24576
    v_mfma_f32_16x16x32_bf16 v[192:195], v[112:115], v[208:211], v[192:195]
    ds_read_b128 v[32:35], v26 offset:0
    v_mfma_f32_16x16x32_bf16 v[196:199], v[116:119], v[208:211], v[196:199]
    ds_read_b128 v[36:39], v27 offset:0
    v_mfma_f32_16x16x32_bf16 v[128:131], v[120:123], v[84:87], v[128:131]
    ds_read_b128 v[40:43], v26 offset:2048
    v_mfma_f32_16x16x32_bf16 v[132:135], v[124:127], v[84:87], v[132:135]
    ds_read_b128 v[44:47], v27 offset:2048
    v_mfma_f32_16x16x32_bf16 v[144:147], v[120:123], v[92:95], v[144:147]
    ds_read_b128 v[48:51], v26 offset:4096
    v_mfma_f32_16x16x32_bf16 v[148:151], v[124:127], v[92:95], v[148:151]
    ds_read_b128 v[52:55], v27 offset:4096
    v_mfma_f32_16x16x32_bf16 v[160:163], v[120:123], v[100:103], v[160:163]
    ds_read_b128 v[56:59], v26 offset:6144
    v_mfma_f32_16x16x32_bf16 v[164:167], v[124:127], v[100:103], v[164:167]
    ds_read_b128 v[60:63], v27 offset:6144
    v_mfma_f32_16x16x32_bf16 v[176:179], v[120:123], v[108:111], v[176:179]
    v_mfma_f32_16x16x32_bf16 v[180:183], v[124:127], v[108:111], v[180:183]
    v_mfma_f32_16x16x32_bf16 v[192:195], v[120:123], v[208:211], v[192:195]
    v_mfma_f32_16x16x32_bf16 v[196:199], v[124:127], v[208:211], v[196:199]
    s_waitcnt lgkmcnt(0)
    s_waitcnt vmcnt(8)
    s_barrier
    s_add_u32 m0, s21, 65536
    s_nop 0
    buffer_load_dwordx4 v23, s[88:91], s16 offen lds
    s_add_u32 s16, s16, s62
    s_add_u32 m0, s21, 66560
    s_nop 0
    buffer_load_dwordx4 v23, s[88:91], s17 offen lds
    s_add_u32 s17, s17, s62
    s_cmp_ge_u32 s16, s92
    s_cselect_b32 s94, 2048, 0
    s_sub_u32 s16, s16, s94
    s_sub_u32 s17, s17, s94
    s_add_u32 m0, s22, 65536
    s_nop 0
    buffer_load_dwordx4 v2, s[8:11], s18 offen lds
    s_add_u32 s18, s18, s20
    s_add_u32 m0, s22, 73728
    s_nop 0
    buffer_load_dwordx4 v2, s[12:15], s19 offen lds
    s_add_u32 s19, s19, s20
    s_cmp_ge_u32 s18, s95
    s_cselect_b32 s94, s93, 0
    s_sub_u32 s18, s18, s94
    s_sub_u32 s19, s19, s94
    v_mfma_f32_16x16x32_bf16 v[128:131], v[64:67], v[32:35], v[128:131]
    ds_read_b64_tr_b16 v[112:113], v12 offset:49152
    v_mfma_f32_16x16x32_bf16 v[132:135], v[68:71], v[32:35], v[132:135]
    ds_read_b64_tr_b16 v[114:115], v13 offset:49152
    v_mfma_f32_16x16x32_bf16 v[144:147], v[64:67], v[40:43], v[144:147]
    ds_read_b64_tr_b16 v[116:117], v14 offset:49152
    v_mfma_f32_16x16x32_bf16 v[148:151], v[68:71], v[40:43], v[148:151]
    ds_read_b64_tr_b16 v[118:119], v15 offset:49152
    v_mfma_f32_16x16x32_bf16 v[160:163], v[64:67], v[48:51], v[160:163]
    ds_read_b64_tr_b16 v[120:121], v12 offset:57344
    v_mfma_f32_16x16x32_bf16 v[164:167], v[68:71], v[48:51], v[164:167]
    ds_read_b64_tr_b16 v[122:123], v13 offset:57344
    v_mfma_f32_16x16x32_bf16 v[176:179], v[64:67], v[56:59], v[176:179]
    ds_read_b64_tr_b16 v[124:125], v14 offset:57344
    v_mfma_f32_16x16x32_bf16 v[180:183], v[68:71], v[56:59], v[180:183]
    ds_read_b64_tr_b16 v[126:127], v15 offset:57344
    v_mfma_f32_16x16x32_bf16 v[192:195], v[64:67], v[208:211], v[192:195]
    ds_read_b128 v[80:83], v26 offset:32768
    v_mfma_f32_16x16x32_bf16 v[196:199], v[68:71], v[208:211], v[196:199]
    ds_read_b128 v[84:87], v27 offset:32768
    v_mfma_f32_16x16x32_bf16 v[128:131], v[72:75], v[36:39], v[128:131]
    ds_read_b128 v[88:91], v26 offset:34816
    v_mfma_f32_16x16x32_bf16 v[132:135], v[76:79], v[36:39], v[132:135]
    ds_read_b128 v[92:95], v27 offset:34816
    v_mfma_f32_16x16x32_bf16 v[144:147], v[72:75], v[44:47], v[144:147]
    ds_read_b128 v[96:99], v26 offset:36864
    v_mfma_f32_16x16x32_bf16 v[148:151], v[76:79], v[44:47], v[148:151]
    ds_read_b128 v[100:103], v27 offset:36864
    v_mfma_f32_16x16x32_bf16 v[160:163], v[72:75], v[52:55], v[160:163]
    ds_read_b128 v[104:107], v26 offset:38912
    v_mfma_f32_16x16x32_bf16 v[164:167], v[76:79], v[52:55], v[164:167]
    ds_read_b128 v[108:111], v27 offset:38912
    v_mfma_f32_16x16x32_bf16 v[176:179], v[72:75], v[60:63], v[176:179]
    v_mfma_f32_16x16x32_bf16 v[180:183], v[76:79], v[60:63], v[180:183]
    v_mfma_f32_16x16x32_bf16 v[192:195], v[72:75], v[208:211], v[192:195]
    v_mfma_f32_16x16x32_bf16 v[196:199], v[76:79], v[208:211], v[196:199]
    s_waitcnt lgkmcnt(0)
    s_waitcnt vmcnt(8)
    s_barrier
    s_add_u32 m0, s21, 98304
    s_nop 0
    buffer_load_dwordx4 v23, s[88:91], s16 offen lds
    s_add_u32 s16, s16, s62
    s_add_u32 m0, s21, 99328
    s_nop 0
    buffer_load_dwordx4 v23, s[88:91], s17 offen lds
    s_add_u32 s17, s17, s62
    s_cmp_ge_u32 s16, s92
    s_cselect_b32 s94, 2048, 0
    s_sub_u32 s16, s16, s94
    s_sub_u32 s17, s17, s94
    s_add_u32 m0, s22, 98304
    s_nop 0
    buffer_load_dwordx4 v2, s[8:11], s18 offen lds
    s_add_u32 s18, s18, s20
    s_add_u32 m0, s22, 106496
    s_nop 0
    buffer_load_dwordx4 v2, s[12:15], s19 offen lds
    s_add_u32 s19, s19, s20
    s_cmp_ge_u32 s18, s95
    s_cselect_b32 s94, s93, 0
    s_sub_u32 s18, s18, s94
    s_sub_u32 s19, s19, s94
    v_mfma_f32_16x16x32_bf16 v[128:131], v[112:115], v[80:83], v[128:131]
    ds_read_b64_tr_b16 v[64:65], v8 offset:16384
    v_mfma_f32_16x16x32_bf16 v[132:135], v[116:119], v[80:83], v[132:135]
    ds_read_b64_tr_b16 v[66:67], v9 offset:16384
    v_mfma_f32_16x16x32_bf16 v[144:147], v[112:115], v[88:91], v[144:147]
    ds_read_b64_tr_b16 v[68:69], v10 offset:16384
    v_mfma_f32_16x16x32_bf16 v[148:151], v[116:119], v[88:91], v[148:151]
    ds_read_b64_tr_b16 v[70:71], v11 offset:16384
    v_mfma_f32_16x16x32_bf16 v[160:163], v[112:115], v[96:99], v[160:163]
    ds_read_b64_tr_b16 v[72:73], v8 offset:24576
    v_mfma_f32_16x16x32_bf16 v[164:167], v[116:119], v[96:99], v[164:167]
    ds_read_b64_tr_b16 v[74:75], v9 offset:24576
    v_mfma_f32_16x16x32_bf16 v[176:179], v[112:115], v[104:107], v[176:179]
    ds_read_b64_tr_b16 v[76:77], v10 offset:24576
    v_mfma_f32_16x16x32_bf16 v[180:183], v[116:119], v[104:107], v[180:183]
    ds_read_b64_tr_b16 v[78:79], v11 offset:24576
    v_mfma_f32_16x16x32_bf16 v[192:195], v[112:115], v[208:211], v[192:195]
    ds_read_b128 v[32:35], v24 offset:0
    v_mfma_f32_16x16x32_bf16 v[196:199], v[116:119], v[208:211], v[196:199]
    ds_read_b128 v[36:39], v25 offset:0
    v_mfma_f32_16x16x32_bf16 v[128:131], v[120:123], v[84:87], v[128:131]
    ds_read_b128 v[40:43], v24 offset:2048
    v_mfma_f32_16x16x32_bf16 v[132:135], v[124:127], v[84:87], v[132:135]
    ds_read_b128 v[44:47], v25 offset:2048
    v_mfma_f32_16x16x32_bf16 v[144:147], v[120:123], v[92:95], v[144:147]
    ds_read_b128 v[48:51], v24 offset:4096
    v_mfma_f32_16x16x32_bf16 v[148:151], v[124:127], v[92:95], v[148:151]
    ds_read_b128 v[52:55], v25 offset:4096
    v_mfma_f32_16x16x32_bf16 v[160:163], v[120:123], v[100:103], v[160:163]
    ds_read_b128 v[56:59], v24 offset:6144
    v_mfma_f32_16x16x32_bf16 v[164:167], v[124:127], v[100:103], v[164:167]
    ds_read_b128 v[60:63], v25 offset:6144
    v_mfma_f32_16x16x32_bf16 v[176:179], v[120:123], v[108:111], v[176:179]
    v_mfma_f32_16x16x32_bf16 v[180:183], v[124:127], v[108:111], v[180:183]
    v_mfma_f32_16x16x32_bf16 v[192:195], v[120:123], v[208:211], v[192:195]
    v_mfma_f32_16x16x32_bf16 v[196:199], v[124:127], v[208:211], v[196:199]
    s_waitcnt lgkmcnt(0)
    s_waitcnt vmcnt(8)
    s_barrier
    s_add_u32 m0, s21, 0
    s_nop 0
    buffer_load_dwordx4 v23, s[88:91], s16 offen lds
    s_add_u32 s16, s16, s62
    s_add_u32 m0, s21, 1024
    s_nop 0
    buffer_load_dwordx4 v23, s[88:91], s17 offen lds
    s_add_u32 s17, s17, s62
    s_cmp_ge_u32 s16, s92
    s_cselect_b32 s94, 2048, 0
    s_sub_u32 s16, s16, s94
    s_sub_u32 s17, s17, s94
    s_add_u32 m0, s22, 0
    s_nop 0
    buffer_load_dwordx4 v2, s[8:11], s18 offen lds
    s_add_u32 s18, s18, s20
    s_add_u32 m0, s22, 8192
    s_nop 0
    buffer_load_dwordx4 v2, s[12:15], s19 offen lds
    s_add_u32 s19, s19, s20
    s_cmp_ge_u32 s18, s95
    s_cselect_b32 s94, s93, 0
    s_sub_u32 s18, s18, s94
    s_sub_u32 s19, s19, s94
    v_mfma_f32_16x16x32_bf16 v[128:131], v[64:67], v[32:35], v[128:131]
    ds_read_b64_tr_b16 v[112:113], v8 offset:49152
    v_mfma_f32_16x16x32_bf16 v[132:135], v[68:71], v[32:35], v[132:135]
    ds_read_b64_tr_b16 v[114:115], v9 offset:49152
    v_mfma_f32_16x16x32_bf16 v[144:147], v[64:67], v[40:43], v[144:147]
    ds_read_b64_tr_b16 v[116:117], v10 offset:49152
    v_mfma_f32_16x16x32_bf16 v[148:151], v[68:71], v[40:43], v[148:151]
    ds_read_b64_tr_b16 v[118:119], v11 offset:49152
    v_mfma_f32_16x16x32_bf16 v[160:163], v[64:67], v[48:51], v[160:163]
    ds_read_b64_tr_b16 v[120:121], v8 offset:57344
    v_mfma_f32_16x16x32_bf16 v[164:167], v[68:71], v[48:51], v[164:167]
    ds_read_b64_tr_b16 v[122:123], v9 offset:57344
    v_mfma_f32_16x16x32_bf16 v[176:179], v[64:67], v[56:59], v[176:179]
    ds_read_b64_tr_b16 v[124:125], v10 offset:57344
    v_mfma_f32_16x16x32_bf16 v[180:183], v[68:71], v[56:59], v[180:183]
    ds_read_b64_tr_b16 v[126:127], v11 offset:57344
    v_mfma_f32_16x16x32_bf16 v[192:195], v[64:67], v[208:211], v[192:195]
    ds_read_b128 v[80:83], v24 offset:32768
    v_mfma_f32_16x16x32_bf16 v[196:199], v[68:71], v[208:211], v[196:199]
    ds_read_b128 v[84:87], v25 offset:32768
    v_mfma_f32_16x16x32_bf16 v[128:131], v[72:75], v[36:39], v[128:131]
    ds_read_b128 v[88:91], v24 offset:34816
    v_mfma_f32_16x16x32_bf16 v[132:135], v[76:79], v[36:39], v[132:135]
    ds_read_b128 v[92:95], v25 offset:34816
    v_mfma_f32_16x16x32_bf16 v[144:147], v[72:75], v[44:47], v[144:147]
    ds_read_b128 v[96:99], v24 offset:36864
    v_mfma_f32_16x16x32_bf16 v[148:151], v[76:79], v[44:47], v[148:151]
    ds_read_b128 v[100:103], v25 offset:36864
    v_mfma_f32_16x16x32_bf16 v[160:163], v[72:75], v[52:55], v[160:163]
    ds_read_b128 v[104:107], v24 offset:38912
    v_mfma_f32_16x16x32_bf16 v[164:167], v[76:79], v[52:55], v[164:167]
    ds_read_b128 v[108:111], v25 offset:38912
    v_mfma_f32_16x16x32_bf16 v[176:179], v[72:75], v[60:63], v[176:179]
    v_mfma_f32_16x16x32_bf16 v[180:183], v[76:79], v[60:63], v[180:183]
    v_mfma_f32_16x16x32_bf16 v[192:195], v[72:75], v[208:211], v[192:195]
    v_mfma_f32_16x16x32_bf16 v[196:199], v[76:79], v[208:211], v[196:199]
    s_waitcnt lgkmcnt(0)
    s_waitcnt vmcnt(8)
    s_barrier
    s_add_u32 m0, s21, 32768
    s_nop 0
    buffer_load_dwordx4 v23, s[88:91], s16 offen lds
    s_add_u32 s16, s16, s62
    s_add_u32 m0, s21, 33792
    s_nop 0
    buffer_load_dwordx4 v23, s[88:91], s17 offen lds
    s_add_u32 s17, s17, s62
    s_cmp_ge_u32 s16, s92
    s_cselect_b32 s94, 2048, 0
    s_sub_u32 s16, s16, s94
    s_sub_u32 s17, s17, s94
    s_add_u32 m0, s22, 32768
    s_nop 0
    buffer_load_dwordx4 v2, s[8:11], s18 offen lds
    s_add_u32 s18, s18, s20
    s_add_u32 m0, s22, 40960
    s_nop 0
    buffer_load_dwordx4 v2, s[12:15], s19 offen lds
    s_add_u32 s19, s19, s20
    s_cmp_ge_u32 s18, s95
    s_cselect_b32 s94, s93, 0
    s_sub_u32 s18, s18, s94
    s_sub_u32 s19, s19, s94
    v_mfma_f32_16x16x32_bf16 v[128:131], v[112:115], v[80:83], v[128:131]
    ds_read_b64_tr_b16 v[64:65], v12 offset:16384
    v_mfma_f32_16x16x32_bf16 v[132:135], v[116:119], v[80:83], v[132:135]
    ds_read_b64_tr_b16 v[66:67], v13 offset:16384
    v_mfma_f32_16x16x32_bf16 v[144:147], v[112:115], v[88:91], v[144:147]
    ds_read_b64_tr_b16 v[68:69], v14 offset:16384
    v_mfma_f32_16x16x32_bf16 v[148:151], v[116:119], v[88:91], v[148:151]
    ds_read_b64_tr_b16 v[70:71], v15 offset:16384
    v_mfma_f32_16x16x32_bf16 v[160:163], v[112:115], v[96:99], v[160:163]
    ds_read_b64_tr_b16 v[72:73], v12 offset:24576
    v_mfma_f32_16x16x32_bf16 v[164:167], v[116:119], v[96:99], v[164:167]
    ds_read_b64_tr_b16 v[74:75], v13 offset:24576
    v_mfma_f32_16x16x32_bf16 v[176:179], v[112:115], v[104:107], v[176:179]
    ds_read_b64_tr_b16 v[76:77], v14 offset:24576
    v_mfma_f32_16x16x32_bf16 v[180:183], v[116:119], v[104:107], v[180:183]
    ds_read_b64_tr_b16 v[78:79], v15 offset:24576
    v_mfma_f32_16x16x32_bf16 v[192:195], v[112:115], v[208:211], v[192:195]
    ds_read_b128 v[32:35], v26 offset:0
    v_mfma_f32_16x16x32_bf16 v[196:199], v[116:119], v[208:211], v[196:199]
    ds_read_b128 v[36:39], v27 offset:0
    v_mfma_f32_16x16x32_bf16 v[128:131], v[120:123], v[84:87], v[128:131]
    ds_read_b128 v[40:43], v26 offset:2048
    v_mfma_f32_16x16x32_bf16 v[132:135], v[124:127], v[84:87], v[132:135]
    ds_read_b128 v[44:47], v27 offset:2048
    v_mfma_f32_16x16x32_bf16 v[144:147], v[120:123], v[92:95], v[144:147]
    ds_read_b128 v[48:51], v26 offset:4096
    v_mfma_f32_16x16x32_bf16 v[148:151], v[124:127], v[92:95], v[148:151]
    ds_read_b128 v[52:55], v27 offset:4096
    v_mfma_f32_16x16x32_bf16 v[160:163], v[120:123], v[100:103], v[160:163]
    ds_read_b128 v[56:59], v26 offset:6144
    v_mfma_f32_16x16x32_bf16 v[164:167], v[124:127], v[100:103], v[164:167]
    ds_read_b128 v[60:63], v27 offset:6144
    v_mfma_f32_16x16x32_bf16 v[176:179], v[120:123], v[108:111], v[176:179]
    v_mfma_f32_16x16x32_bf16 v[180:183], v[124:127], v[108:111], v[180:183]
    v_mfma_f32_16x16x32_bf16 v[192:195], v[120:123], v[208:211], v[192:195]
    v_mfma_f32_16x16x32_bf16 v[196:199], v[124:127], v[208:211], v[196:199]
    s_waitcnt lgkmcnt(0)
    s_waitcnt vmcnt(8)
    s_barrier
    s_add_u32 m0, s21, 65536
    s_nop 0
    buffer_load_dwordx4 v23, s[88:91], s16 offen lds
    s_add_u32 s16, s16, s62
    s_add_u32 m0, s21, 66560
    s_nop 0
    buffer_load_dwordx4 v23, s[88:91], s17 offen lds
    s_add_u32 s17, s17, s62
    s_cmp_ge_u32 s16, s92
    s_cselect_b32 s94, 2048, 0
    s_sub_u32 s16, s16, s94
    s_sub_u32 s17, s17, s94
    s_add_u32 m0, s22, 65536
    s_nop 0
    buffer_load_dwordx4 v2, s[8:11], s18 offen lds
    s_add_u32 s18, s18, s20
    s_add_u32 m0, s22, 73728
    s_nop 0
    buffer_load_dwordx4 v2, s[12:15], s19 offen lds
    s_add_u32 s19, s19, s20
    s_cmp_ge_u32 s18, s95
    s_cselect_b32 s94, s93, 0
    s_sub_u32 s18, s18, s94
    s_sub_u32 s19, s19, s94
    v_mfma_f32_16x16x32_bf16 v[128:131], v[64:67], v[32:35], v[128:131]
    ds_read_b64_tr_b16 v[112:113], v12 offset:49152
    v_mfma_f32_16x16x32_bf16 v[132:135], v[68:71], v[32:35], v[132:135]
    ds_read_b64_tr_b16 v[114:115], v13 offset:49152
    v_mfma_f32_16x16x32_bf16 v[144:147], v[64:67], v[40:43], v[144:147]
    ds_read_b64_tr_b16 v[116:117], v14 offset:49152
    v_mfma_f32_16x16x32_bf16 v[148:151], v[68:71], v[40:43], v[148:151]
    ds_read_b64_tr_b16 v[118:119], v15 offset:49152
    v_mfma_f32_16x16x32_bf16 v[160:163], v[64:67], v[48:51], v[160:163]
    ds_read_b64_tr_b16 v[120:121], v12 offset:57344
    v_mfma_f32_16x16x32_bf16 v[164:167], v[68:71], v[48:51], v[164:167]
    ds_read_b64_tr_b16 v[122:123], v13 offset:57344
    v_mfma_f32_16x16x32_bf16 v[176:179], v[64:67], v[56:59], v[176:179]
    ds_read_b64_tr_b16 v[124:125], v14 offset:57344
    v_mfma_f32_16x16x32_bf16 v[180:183], v[68:71], v[56:59], v[180:183]
    ds_read_b64_tr_b16 v[126:127], v15 offset:57344
    v_mfma_f32_16x16x32_bf16 v[192:195], v[64:67], v[208:211], v[192:195]
    ds_read_b128 v[80:83], v26 offset:32768
    v_mfma_f32_16x16x32_bf16 v[196:199], v[68:71], v[208:211], v[196:199]
    ds_read_b128 v[84:87], v27 offset:32768
    v_mfma_f32_16x16x32_bf16 v[128:131], v[72:75], v[36:39], v[128:131]
    ds_read_b128 v[88:91], v26 offset:34816
    v_mfma_f32_16x16x32_bf16 v[132:135], v[76:79], v[36:39], v[132:135]
    ds_read_b128 v[92:95], v27 offset:34816
    v_mfma_f32_16x16x32_bf16 v[144:147], v[72:75], v[44:47], v[144:147]
    ds_read_b128 v[96:99], v26 offset:36864
    v_mfma_f32_16x16x32_bf16 v[148:151], v[76:79], v[44:47], v[148:151]
    ds_read_b128 v[100:103], v27 offset:36864
    v_mfma_f32_16x16x32_bf16 v[160:163], v[72:75], v[52:55], v[160:163]
    ds_read_b128 v[104:107], v26 offset:38912
    v_mfma_f32_16x16x32_bf16 v[164:167], v[76:79], v[52:55], v[164:167]
    ds_read_b128 v[108:111], v27 offset:38912
    v_mfma_f32_16x16x32_bf16 v[176:179], v[72:75], v[60:63], v[176:179]
    v_mfma_f32_16x16x32_bf16 v[180:183], v[76:79], v[60:63], v[180:183]
    v_mfma_f32_16x16x32_bf16 v[192:195], v[72:75], v[208:211], v[192:195]
    v_mfma_f32_16x16x32_bf16 v[196:199], v[76:79], v[208:211], v[196:199]
    s_waitcnt lgkmcnt(0)
    s_waitcnt vmcnt(8)
    s_barrier
    s_add_u32 m0, s21, 98304
    s_nop 0
    buffer_load_dwordx4 v23, s[88:91], s16 offen lds
    s_add_u32 s16, s16, s62
    s_add_u32 m0, s21, 99328
    s_nop 0
    buffer_load_dwordx4 v23, s[88:91], s17 offen lds
    s_add_u32 s17, s17, s62
    s_cmp_ge_u32 s16, s92
    s_cselect_b32 s94, 2048, 0
    s_sub_u32 s16, s16, s94
    s_sub_u32 s17, s17, s94
    s_add_u32 m0, s22, 98304
    s_nop 0
    buffer_load_dwordx4 v2, s[8:11], s18 offen lds
    s_add_u32 s18, s18, s20
    s_add_u32 m0, s22, 106496
    s_nop 0
    buffer_load_dwordx4 v2, s[12:15], s19 offen lds
    s_add_u32 s19, s19, s20
    s_cmp_ge_u32 s18, s95
    s_cselect_b32 s94, s93, 0
    s_sub_u32 s18, s18, s94
    s_sub_u32 s19, s19, s94
    v_mfma_f32_16x16x32_bf16 v[128:131], v[112:115], v[80:83], v[128:131]
    ds_read_b64_tr_b16 v[64:65], v8 offset:16384
    v_mfma_f32_16x16x32_bf16 v[132:135], v[116:119], v[80:83], v[132:135]
    ds_read_b64_tr_b16 v[66:67], v9 offset:16384
    v_mfma_f32_16x16x32_bf16 v[144:147], v[112:115], v[88:91], v[144:147]
    ds_read_b64_tr_b16 v[68:69], v10 offset:16384
    v_mfma_f32_16x16x32_bf16 v[148:151], v[116:119], v[88:91], v[148:151]
    ds_read_b64_tr_b16 v[70:71], v11 offset:16384
    v_mfma_f32_16x16x32_bf16 v[160:163], v[112:115], v[96:99], v[160:163]
    ds_read_b64_tr_b16 v[72:73], v8 offset:24576
    v_mfma_f32_16x16x32_bf16 v[164:167], v[116:119], v[96:99], v[164:167]
    ds_read_b64_tr_b16 v[74:75], v9 offset:24576
    v_mfma_f32_16x16x32_bf16 v[176:179], v[112:115], v[104:107], v[176:179]
    ds_read_b64_tr_b16 v[76:77], v10 offset:24576
    v_mfma_f32_16x16x32_bf16 v[180:183], v[116:119], v[104:107], v[180:183]
    ds_read_b64_tr_b16 v[78:79], v11 offset:24576
    v_mfma_f32_16x16x32_bf16 v[192:195], v[112:115], v[208:211], v[192:195]
    ds_read_b128 v[32:35], v24 offset:0
    v_mfma_f32_16x16x32_bf16 v[196:199], v[116:119], v[208:211], v[196:199]
    ds_read_b128 v[36:39], v25 offset:0
    v_mfma_f32_16x16x32_bf16 v[128:131], v[120:123], v[84:87], v[128:131]
    ds_read_b128 v[40:43], v24 offset:2048
    v_mfma_f32_16x16x32_bf16 v[132:135], v[124:127], v[84:87], v[132:135]
    ds_read_b128 v[44:47], v25 offset:2048
    v_mfma_f32_16x16x32_bf16 v[144:147], v[120:123], v[92:95], v[144:147]
    ds_read_b128 v[48:51], v24 offset:4096
    v_mfma_f32_16x16x32_bf16 v[148:151], v[124:127], v[92:95], v[148:151]
    ds_read_b128 v[52:55], v25 offset:4096
    v_mfma_f32_16x16x32_bf16 v[160:163], v[120:123], v[100:103], v[160:163]
    ds_read_b128 v[56:59], v24 offset:6144
    v_mfma_f32_16x16x32_bf16 v[164:167], v[124:127], v[100:103], v[164:167]
    ds_read_b128 v[60:63], v25 offset:6144
    v_mfma_f32_16x16x32_bf16 v[176:179], v[120:123], v[108:111], v[176:179]
    v_mfma_f32_16x16x32_bf16 v[180:183], v[124:127], v[108:111], v[180:183]
    v_mfma_f32_16x16x32_bf16 v[192:195], v[120:123], v[208:211], v[192:195]
    v_mfma_f32_16x16x32_bf16 v[196:199], v[124:127], v[208:211], v[196:199]
    s_waitcnt lgkmcnt(0)
    s_waitcnt vmcnt(8)
    s_barrier
    s_add_u32 m0, s21, 0
    s_nop 0
    buffer_load_dwordx4 v23, s[88:91], s16 offen lds
    s_add_u32 s16, s16, s62
    s_add_u32 m0, s21, 1024
    s_nop 0
    buffer_load_dwordx4 v23, s[88:91], s17 offen lds
    s_add_u32 s17, s17, s62
    s_cmp_ge_u32 s16, s92
    s_cselect_b32 s94, 2048, 0
    s_sub_u32 s16, s16, s94
    s_sub_u32 s17, s17, s94
    s_add_u32 m0, s22, 0
    s_nop 0
    buffer_load_dwordx4 v2, s[8:11], s18 offen lds
    s_add_u32 s18, s18, s20
    s_add_u32 m0, s22, 8192
    s_nop 0
    buffer_load_dwordx4 v2, s[12:15], s19 offen lds
    s_add_u32 s19, s19, s20
    s_cmp_ge_u32 s18, s95
    s_cselect_b32 s94, s93, 0
    s_sub_u32 s18, s18, s94
    s_sub_u32 s19, s19, s94
    v_mfma_f32_16x16x32_bf16 v[128:131], v[64:67], v[32:35], v[128:131]
    ds_read_b64_tr_b16 v[112:113], v8 offset:49152
    v_mfma_f32_16x16x32_bf16 v[132:135], v[68:71], v[32:35], v[132:135]
    ds_read_b64_tr_b16 v[114:115], v9 offset:49152
    v_mfma_f32_16x16x32_bf16 v[144:147], v[64:67], v[40:43], v[144:147]
    ds_read_b64_tr_b16 v[116:117], v10 offset:49152
    v_mfma_f32_16x16x32_bf16 v[148:151], v[68:71], v[40:43], v[148:151]
    ds_read_b64_tr_b16 v[118:119], v11 offset:49152
    v_mfma_f32_16x16x32_bf16 v[160:163], v[64:67], v[48:51], v[160:163]
    ds_read_b64_tr_b16 v[120:121], v8 offset:57344
    v_mfma_f32_16x16x32_bf16 v[164:167], v[68:71], v[48:51], v[164:167]
    ds_read_b64_tr_b16 v[122:123], v9 offset:57344
    v_mfma_f32_16x16x32_bf16 v[176:179], v[64:67], v[56:59], v[176:179]
    ds_read_b64_tr_b16 v[124:125], v10 offset:57344
    v_mfma_f32_16x16x32_bf16 v[180:183], v[68:71], v[56:59], v[180:183]
    ds_read_b64_tr_b16 v[126:127], v11 offset:57344
    v_mfma_f32_16x16x32_bf16 v[192:195], v[64:67], v[208:211], v[192:195]
    ds_read_b128 v[80:83], v24 offset:32768
    v_mfma_f32_16x16x32_bf16 v[196:199], v[68:71], v[208:211], v[196:199]
    ds_read_b128 v[84:87], v25 offset:32768
    v_mfma_f32_16x16x32_bf16 v[128:131], v[72:75], v[36:39], v[128:131]
    ds_read_b128 v[88:91], v24 offset:34816
    v_mfma_f32_16x16x32_bf16 v[132:135], v[76:79], v[36:39], v[132:135]
    ds_read_b128 v[92:95], v25 offset:34816
    v_mfma_f32_16x16x32_bf16 v[144:147], v[72:75], v[44:47], v[144:147]
    ds_read_b128 v[96:99], v24 offset:36864
    v_mfma_f32_16x16x32_bf16 v[148:151], v[76:79], v[44:47], v[148:151]
    ds_read_b128 v[100:103], v25 offset:36864
    v_mfma_f32_16x16x32_bf16 v[160:163], v[72:75], v[52:55], v[160:163]
    ds_read_b128 v[104:107], v24 offset:38912
    v_mfma_f32_16x16x32_bf16 v[164:167], v[76:79], v[52:55], v[164:167]
    ds_read_b128 v[108:111], v25 offset:38912
    v_mfma_f32_16x16x32_bf16 v[176:179], v[72:75], v[60:63], v[176:179]
    v_mfma_f32_16x16x32_bf16 v[180:183], v[76:79], v[60:63], v[180:183]
    v_mfma_f32_16x16x32_bf16 v[192:195], v[72:75], v[208:211], v[192:195]
    v_mfma_f32_16x16x32_bf16 v[196:199], v[76:79], v[208:211], v[196:199]
    s_waitcnt lgkmcnt(0)
    s_waitcnt vmcnt(8)
    s_barrier
    s_add_u32 m0, s21, 32768
    s_nop 0
    buffer_load_dwordx4 v23, s[88:91], s16 offen lds
    s_add_u32 s16, s16, s62
    s_add_u32 m0, s21, 33792
    s_nop 0
    buffer_load_dwordx4 v23, s[88:91], s17 offen lds
    s_add_u32 s17, s17, s62
    s_cmp_ge_u32 s16, s92
    s_cselect_b32 s94, 2048, 0
    s_sub_u32 s16, s16, s94
    s_sub_u32 s17, s17, s94
    s_add_u32 m0, s22, 32768
    s_nop 0
    buffer_load_dwordx4 v2, s[8:11], s18 offen lds
    s_add_u32 s18, s18, s20
    s_add_u32 m0, s22, 40960
    s_nop 0
    buffer_load_dwordx4 v2, s[12:15], s19 offen lds
    s_add_u32 s19, s19, s20
    s_cmp_ge_u32 s18, s95
    s_cselect_b32 s94, s93, 0
    s_sub_u32 s18, s18, s94
    s_sub_u32 s19, s19, s94
    v_mfma_f32_16x16x32_bf16 v[128:131], v[112:115], v[80:83], v[128:131]
    ds_read_b64_tr_b16 v[64:65], v12 offset:16384
    v_mfma_f32_16x16x32_bf16 v[132:135], v[116:119], v[80:83], v[132:135]
    ds_read_b64_tr_b16 v[66:67], v13 offset:16384
    v_mfma_f32_16x16x32_bf16 v[144:147], v[112:115], v[88:91], v[144:147]
    ds_read_b64_tr_b16 v[68:69], v14 offset:16384
    v_mfma_f32_16x16x32_bf16 v[148:151], v[116:119], v[88:91], v[148:151]
    ds_read_b64_tr_b16 v[70:71], v15 offset:16384
    v_mfma_f32_16x16x32_bf16 v[160:163], v[112:115], v[96:99], v[160:163]
    ds_read_b64_tr_b16 v[72:73], v12 offset:24576
    v_mfma_f32_16x16x32_bf16 v[164:167], v[116:119], v[96:99], v[164:167]
    ds_read_b64_tr_b16 v[74:75], v13 offset:24576
    v_mfma_f32_16x16x32_bf16 v[176:179], v[112:115], v[104:107], v[176:179]
    ds_read_b64_tr_b16 v[76:77], v14 offset:24576
    v_mfma_f32_16x16x32_bf16 v[180:183], v[116:119], v[104:107], v[180:183]
    ds_read_b64_tr_b16 v[78:79], v15 offset:24576
    v_mfma_f32_16x16x32_bf16 v[192:195], v[112:115], v[208:211], v[192:195]
    ds_read_b128 v[32:35], v26 offset:0
    v_mfma_f32_16x16x32_bf16 v[196:199], v[116:119], v[208:211], v[196:199]
    ds_read_b128 v[36:39], v27 offset:0
    v_mfma_f32_16x16x32_bf16 v[128:131], v[120:123], v[84:87], v[128:131]
    ds_read_b128 v[40:43], v26 offset:2048
    v_mfma_f32_16x16x32_bf16 v[132:135], v[124:127], v[84:87], v[132:135]
    ds_read_b128 v[44:47], v27 offset:2048
    v_mfma_f32_16x16x32_bf16 v[144:147], v[120:123], v[92:95], v[144:147]
    ds_read_b128 v[48:51], v26 offset:4096
    v_mfma_f32_16x16x32_bf16 v[148:151], v[124:127], v[92:95], v[148:151]
    ds_read_b128 v[52:55], v27 offset:4096
    v_mfma_f32_16x16x32_bf16 v[160:163], v[120:123], v[100:103], v[160:163]
    ds_read_b128 v[56:59], v26 offset:6144
    v_mfma_f32_16x16x32_bf16 v[164:167], v[124:127], v[100:103], v[164:167]
    ds_read_b128 v[60:63], v27 offset:6144
    v_mfma_f32_16x16x32_bf16 v[176:179], v[120:123], v[108:111], v[176:179]
    v_mfma_f32_16x16x32_bf16 v[180:183], v[124:127], v[108:111], v[180:183]
    v_mfma_f32_16x16x32_bf16 v[192:195], v[120:123], v[208:211], v[192:195]
    v_mfma_f32_16x16x32_bf16 v[196:199], v[124:127], v[208:211], v[196:199]
    s_waitcnt lgkmcnt(0)
    s_waitcnt vmcnt(8)
    s_barrier
    s_add_u32 m0, s21, 65536
    s_nop 0
    buffer_load_dwordx4 v23, s[88:91], s16 offen lds
    s_add_u32 s16, s16, s62
    s_add_u32 m0, s21, 66560
    s_nop 0
    buffer_load_dwordx4 v23, s[88:91], s17 offen lds
    s_add_u32 s17, s17, s62
    s_cmp_ge_u32 s16, s92
    s_cselect_b32 s94, 2048, 0
    s_sub_u32 s16, s16, s94
    s_sub_u32 s17, s17, s94
    s_add_u32 m0, s22, 65536
    s_nop 0
    buffer_load_dwordx4 v2, s[8:11], s18 offen lds
    s_add_u32 s18, s18, s20
    s_add_u32 m0, s22, 73728
    s_nop 0
    buffer_load_dwordx4 v2, s[12:15], s19 offen lds
    s_add_u32 s19, s19, s20
    s_cmp_ge_u32 s18, s95
    s_cselect_b32 s94, s93, 0
    s_sub_u32 s18, s18, s94
    s_sub_u32 s19, s19, s94
    v_mfma_f32_16x16x32_bf16 v[128:131], v[64:67], v[32:35], v[128:131]
    ds_read_b64_tr_b16 v[112:113], v12 offset:49152
    v_mfma_f32_16x16x32_bf16 v[132:135], v[68:71], v[32:35], v[132:135]
    ds_read_b64_tr_b16 v[114:115], v13 offset:49152
    v_mfma_f32_16x16x32_bf16 v[144:147], v[64:67], v[40:43], v[144:147]
    ds_read_b64_tr_b16 v[116:117], v14 offset:49152
    v_mfma_f32_16x16x32_bf16 v[148:151], v[68:71], v[40:43], v[148:151]
    ds_read_b64_tr_b16 v[118:119], v15 offset:49152
    v_mfma_f32_16x16x32_bf16 v[160:163], v[64:67], v[48:51], v[160:163]
    ds_read_b64_tr_b16 v[120:121], v12 offset:57344
    v_mfma_f32_16x16x32_bf16 v[164:167], v[68:71], v[48:51], v[164:167]
    ds_read_b64_tr_b16 v[122:123], v13 offset:57344
    v_mfma_f32_16x16x32_bf16 v[176:179], v[64:67], v[56:59], v[176:179]
    ds_read_b64_tr_b16 v[124:125], v14 offset:57344
    v_mfma_f32_16x16x32_bf16 v[180:183], v[68:71], v[56:59], v[180:183]
    ds_read_b64_tr_b16 v[126:127], v15 offset:57344
    v_mfma_f32_16x16x32_bf16 v[192:195], v[64:67], v[208:211], v[192:195]
    ds_read_b128 v[80:83], v26 offset:32768
    v_mfma_f32_16x16x32_bf16 v[196:199], v[68:71], v[208:211], v[196:199]
    ds_read_b128 v[84:87], v27 offset:32768
    v_mfma_f32_16x16x32_bf16 v[128:131], v[72:75], v[36:39], v[128:131]
    ds_read_b128 v[88:91], v26 offset:34816
    v_mfma_f32_16x16x32_bf16 v[132:135], v[76:79], v[36:39], v[132:135]
    ds_read_b128 v[92:95], v27 offset:34816
    v_mfma_f32_16x16x32_bf16 v[144:147], v[72:75], v[44:47], v[144:147]
    ds_read_b128 v[96:99], v26 offset:36864
    v_mfma_f32_16x16x32_bf16 v[148:151], v[76:79], v[44:47], v[148:151]
    ds_read_b128 v[100:103], v27 offset:36864
    v_mfma_f32_16x16x32_bf16 v[160:163], v[72:75], v[52:55], v[160:163]
    ds_read_b128 v[104:107], v26 offset:38912
    v_mfma_f32_16x16x32_bf16 v[164:167], v[76:79], v[52:55], v[164:167]
    ds_read_b128 v[108:111], v27 offset:38912
    v_mfma_f32_16x16x32_bf16 v[176:179], v[72:75], v[60:63], v[176:179]
    v_mfma_f32_16x16x32_bf16 v[180:183], v[76:79], v[60:63], v[180:183]
    v_mfma_f32_16x16x32_bf16 v[192:195], v[72:75], v[208:211], v[192:195]
    v_mfma_f32_16x16x32_bf16 v[196:199], v[76:79], v[208:211], v[196:199]
    s_waitcnt lgkmcnt(0)
    s_waitcnt vmcnt(8)
    s_barrier
    s_add_u32 m0, s21, 98304
    s_nop 0
    buffer_load_dwordx4 v23, s[88:91], s16 offen lds
    s_add_u32 s16, s16, s62
    s_add_u32 m0, s21, 99328
    s_nop 0
    buffer_load_dwordx4 v23, s[88:91], s17 offen lds
    s_add_u32 s17, s17, s62
    s_cmp_ge_u32 s16, s92
    s_cselect_b32 s94, 2048, 0
    s_sub_u32 s16, s16, s94
    s_sub_u32 s17, s17, s94
    s_add_u32 m0, s22, 98304
    s_nop 0
    buffer_load_dwordx4 v2, s[8:11], s18 offen lds
    s_add_u32 s18, s18, s20
    s_add_u32 m0, s22, 106496
    s_nop 0
    buffer_load_dwordx4 v2, s[12:15], s19 offen lds
    s_add_u32 s19, s19, s20
    s_cmp_ge_u32 s18, s95
    s_cselect_b32 s94, s93, 0
    s_sub_u32 s18, s18, s94
    s_sub_u32 s19, s19, s94
    v_mfma_f32_16x16x32_bf16 v[128:131], v[112:115], v[80:83], v[128:131]
    ds_read_b64_tr_b16 v[64:65], v8 offset:16384
    v_mfma_f32_16x16x32_bf16 v[132:135], v[116:119], v[80:83], v[132:135]
    ds_read_b64_tr_b16 v[66:67], v9 offset:16384
    v_mfma_f32_16x16x32_bf16 v[144:147], v[112:115], v[88:91], v[144:147]
    ds_read_b64_tr_b16 v[68:69], v10 offset:16384
    v_mfma_f32_16x16x32_bf16 v[148:151], v[116:119], v[88:91], v[148:151]
    ds_read_b64_tr_b16 v[70:71], v11 offset:16384
    v_mfma_f32_16x16x32_bf16 v[160:163], v[112:115], v[96:99], v[160:163]
    ds_read_b64_tr_b16 v[72:73], v8 offset:24576
    v_mfma_f32_16x16x32_bf16 v[164:167], v[116:119], v[96:99], v[164:167]
    ds_read_b64_tr_b16 v[74:75], v9 offset:24576
    v_mfma_f32_16x16x32_bf16 v[176:179], v[112:115], v[104:107], v[176:179]
    ds_read_b64_tr_b16 v[76:77], v10 offset:24576
    v_mfma_f32_16x16x32_bf16 v[180:183], v[116:119], v[104:107], v[180:183]
    ds_read_b64_tr_b16 v[78:79], v11 offset:24576
    v_mfma_f32_16x16x32_bf16 v[192:195], v[112:115], v[208:211], v[192:195]
    ds_read_b128 v[32:35], v24 offset:0
    v_mfma_f32_16x16x32_bf16 v[196:199], v[116:119], v[208:211], v[196:199]
    ds_read_b128 v[36:39], v25 offset:0
    v_mfma_f32_16x16x32_bf16 v[128:131], v[120:123], v[84:87], v[128:131]
    ds_read_b128 v[40:43], v24 offset:2048
    v_mfma_f32_16x16x32_bf16 v[132:135], v[124:127], v[84:87], v[132:135]
    ds_read_b128 v[44:47], v25 offset:2048
    v_mfma_f32_16x16x32_bf16 v[144:147], v[120:123], v[92:95], v[144:147]
    ds_read_b128 v[48:51], v24 offset:4096
    v_mfma_f32_16x16x32_bf16 v[148:151], v[124:127], v[92:95], v[148:151]
    ds_read_b128 v[52:55], v25 offset:4096
    v_mfma_f32_16x16x32_bf16 v[160:163], v[120:123], v[100:103], v[160:163]
    ds_read_b128 v[56:59], v24 offset:6144
    v_mfma_f32_16x16x32_bf16 v[164:167], v[124:127], v[100:103], v[164:167]
    ds_read_b128 v[60:63], v25 offset:6144
    v_mfma_f32_16x16x32_bf16 v[176:179], v[120:123], v[108:111], v[176:179]
    v_mfma_f32_16x16x32_bf16 v[180:183], v[124:127], v[108:111], v[180:183]
    v_mfma_f32_16x16x32_bf16 v[192:195], v[120:123], v[208:211], v[192:195]
    v_mfma_f32_16x16x32_bf16 v[196:199], v[124:127], v[208:211], v[196:199]
    s_waitcnt lgkmcnt(0)
    s_waitcnt vmcnt(8)
    s_barrier
    v_mfma_f32_16x16x32_bf16 v[128:131], v[64:67], v[32:35], v[128:131]
    ds_read_b64_tr_b16 v[112:113], v8 offset:49152
    v_mfma_f32_16x16x32_bf16 v[132:135], v[68:71], v[32:35], v[132:135]
    ds_read_b64_tr_b16 v[114:115], v9 offset:49152
    v_mfma_f32_16x16x32_bf16 v[144:147], v[64:67], v[40:43], v[144:147]
    ds_read_b64_tr_b16 v[116:117], v10 offset:49152
    v_mfma_f32_16x16x32_bf16 v[148:151], v[68:71], v[40:43], v[148:151]
    ds_read_b64_tr_b16 v[118:119], v11 offset:49152
    v_mfma_f32_16x16x32_bf16 v[160:163], v[64:67], v[48:51], v[160:163]
    ds_read_b64_tr_b16 v[120:121], v8 offset:57344
    v_mfma_f32_16x16x32_bf16 v[164:167], v[68:71], v[48:51], v[164:167]
    ds_read_b64_tr_b16 v[122:123], v9 offset:57344
    v_mfma_f32_16x16x32_bf16 v[176:179], v[64:67], v[56:59], v[176:179]
    ds_read_b64_tr_b16 v[124:125], v10 offset:57344
    v_mfma_f32_16x16x32_bf16 v[180:183], v[68:71], v[56:59], v[180:183]
    ds_read_b64_tr_b16 v[126:127], v11 offset:57344
    v_mfma_f32_16x16x32_bf16 v[192:195], v[64:67], v[208:211], v[192:195]
    ds_read_b128 v[80:83], v24 offset:32768
    v_mfma_f32_16x16x32_bf16 v[196:199], v[68:71], v[208:211], v[196:199]
    ds_read_b128 v[84:87], v25 offset:32768
    v_mfma_f32_16x16x32_bf16 v[128:131], v[72:75], v[36:39], v[128:131]
    ds_read_b128 v[88:91], v24 offset:34816
    v_mfma_f32_16x16x32_bf16 v[132:135], v[76:79], v[36:39], v[132:135]
    ds_read_b128 v[92:95], v25 offset:34816
    v_mfma_f32_16x16x32_bf16 v[144:147], v[72:75], v[44:47], v[144:147]
    ds_read_b128 v[96:99], v24 offset:36864
    v_mfma_f32_16x16x32_bf16 v[148:151], v[76:79], v[44:47], v[148:151]
    ds_read_b128 v[100:103], v25 offset:36864
    v_mfma_f32_16x16x32_bf16 v[160:163], v[72:75], v[52:55], v[160:163]
    ds_read_b128 v[104:107], v24 offset:38912
    v_mfma_f32_16x16x32_bf16 v[164:167], v[76:79], v[52:55], v[164:167]
    ds_read_b128 v[108:111], v25 offset:38912
    v_mfma_f32_16x16x32_bf16 v[176:179], v[72:75], v[60:63], v[176:179]
    v_mfma_f32_16x16x32_bf16 v[180:183], v[76:79], v[60:63], v[180:183]
    v_mfma_f32_16x16x32_bf16 v[192:195], v[72:75], v[208:211], v[192:195]
    v_mfma_f32_16x16x32_bf16 v[196:199], v[76:79], v[208:211], v[196:199]
    s_waitcnt lgkmcnt(0)
    s_waitcnt vmcnt(4)
    s_barrier
    v_mfma_f32_16x16x32_bf16 v[128:131], v[112:115], v[80:83], v[128:131]
    ds_read_b64_tr_b16 v[64:65], v12 offset:16384
    v_mfma_f32_16x16x32_bf16 v[132:135], v[116:119], v[80:83], v[132:135]
    ds_read_b64_tr_b16 v[66:67], v13 offset:16384
    v_mfma_f32_16x16x32_bf16 v[144:147], v[112:115], v[88:91], v[144:147]
    ds_read_b64_tr_b16 v[68:69], v14 offset:16384
    v_mfma_f32_16x16x32_bf16 v[148:151], v[116:119], v[88:91], v[148:151]
    ds_read_b64_tr_b16 v[70:71], v15 offset:16384
    v_mfma_f32_16x16x32_bf16 v[160:163], v[112:115], v[96:99], v[160:163]
    ds_read_b64_tr_b16 v[72:73], v12 offset:24576
    v_mfma_f32_16x16x32_bf16 v[164:167], v[116:119], v[96:99], v[164:167]
    ds_read_b64_tr_b16 v[74:75], v13 offset:24576
    v_mfma_f32_16x16x32_bf16 v[176:179], v[112:115], v[104:107], v[176:179]
    ds_read_b64_tr_b16 v[76:77], v14 offset:24576
    v_mfma_f32_16x16x32_bf16 v[180:183], v[116:119], v[104:107], v[180:183]
    ds_read_b64_tr_b16 v[78:79], v15 offset:24576
    v_mfma_f32_16x16x32_bf16 v[192:195], v[112:115], v[208:211], v[192:195]
    ds_read_b128 v[32:35], v26 offset:0
    v_mfma_f32_16x16x32_bf16 v[196:199], v[116:119], v[208:211], v[196:199]
    ds_read_b128 v[36:39], v27 offset:0
    v_mfma_f32_16x16x32_bf16 v[128:131], v[120:123], v[84:87], v[128:131]
    ds_read_b128 v[40:43], v26 offset:2048
    v_mfma_f32_16x16x32_bf16 v[132:135], v[124:127], v[84:87], v[132:135]
    ds_read_b128 v[44:47], v27 offset:2048
    v_mfma_f32_16x16x32_bf16 v[144:147], v[120:123], v[92:95], v[144:147]
    ds_read_b128 v[48:51], v26 offset:4096
    v_mfma_f32_16x16x32_bf16 v[148:151], v[124:127], v[92:95], v[148:151]
    ds_read_b128 v[52:55], v27 offset:4096
    v_mfma_f32_16x16x32_bf16 v[160:163], v[120:123], v[100:103], v[160:163]
    ds_read_b128 v[56:59], v26 offset:6144
    v_mfma_f32_16x16x32_bf16 v[164:167], v[124:127], v[100:103], v[164:167]
    ds_read_b128 v[60:63], v27 offset:6144
    v_mfma_f32_16x16x32_bf16 v[176:179], v[120:123], v[108:111], v[176:179]
    v_mfma_f32_16x16x32_bf16 v[180:183], v[124:127], v[108:111], v[180:183]
    v_mfma_f32_16x16x32_bf16 v[192:195], v[120:123], v[208:211], v[192:195]
    v_mfma_f32_16x16x32_bf16 v[196:199], v[124:127], v[208:211], v[196:199]
    s_waitcnt lgkmcnt(0)
    s_waitcnt vmcnt(0)
    s_barrier
    v_mfma_f32_16x16x32_bf16 v[128:131], v[64:67], v[32:35], v[128:131]
    ds_read_b64_tr_b16 v[112:113], v12 offset:49152
    v_mfma_f32_16x16x32_bf16 v[132:135], v[68:71], v[32:35], v[132:135]
    ds_read_b64_tr_b16 v[114:115], v13 offset:49152
    v_mfma_f32_16x16x32_bf16 v[144:147], v[64:67], v[40:43], v[144:147]
    ds_read_b64_tr_b16 v[116:117], v14 offset:49152
    v_mfma_f32_16x16x32_bf16 v[148:151], v[68:71], v[40:43], v[148:151]
    ds_read_b64_tr_b16 v[118:119], v15 offset:49152
    v_mfma_f32_16x16x32_bf16 v[160:163], v[64:67], v[48:51], v[160:163]
    ds_read_b64_tr_b16 v[120:121], v12 offset:57344
    v_mfma_f32_16x16x32_bf16 v[164:167], v[68:71], v[48:51], v[164:167]
    ds_read_b64_tr_b16 v[122:123], v13 offset:57344
    v_mfma_f32_16x16x32_bf16 v[176:179], v[64:67], v[56:59], v[176:179]
    ds_read_b64_tr_b16 v[124:125], v14 offset:57344
    v_mfma_f32_16x16x32_bf16 v[180:183], v[68:71], v[56:59], v[180:183]
    ds_read_b64_tr_b16 v[126:127], v15 offset:57344
    v_mfma_f32_16x16x32_bf16 v[192:195], v[64:67], v[208:211], v[192:195]
    ds_read_b128 v[80:83], v26 offset:32768
    v_mfma_f32_16x16x32_bf16 v[196:199], v[68:71], v[208:211], v[196:199]
    ds_read_b128 v[84:87], v27 offset:32768
    v_mfma_f32_16x16x32_bf16 v[128:131], v[72:75], v[36:39], v[128:131]
    ds_read_b128 v[88:91], v26 offset:34816
    v_mfma_f32_16x16x32_bf16 v[132:135], v[76:79], v[36:39], v[132:135]
    ds_read_b128 v[92:95], v27 offset:34816
    v_mfma_f32_16x16x32_bf16 v[144:147], v[72:75], v[44:47], v[144:147]
    ds_read_b128 v[96:99], v26 offset:36864
    v_mfma_f32_16x16x32_bf16 v[148:151], v[76:79], v[44:47], v[148:151]
    ds_read_b128 v[100:103], v27 offset:36864
    v_mfma_f32_16x16x32_bf16 v[160:163], v[72:75], v[52:55], v[160:163]
    ds_read_b128 v[104:107], v26 offset:38912
    v_mfma_f32_16x16x32_bf16 v[164:167], v[76:79], v[52:55], v[164:167]
    ds_read_b128 v[108:111], v27 offset:38912
    v_mfma_f32_16x16x32_bf16 v[176:179], v[72:75], v[60:63], v[176:179]
    v_mfma_f32_16x16x32_bf16 v[180:183], v[76:79], v[60:63], v[180:183]
    v_mfma_f32_16x16x32_bf16 v[192:195], v[72:75], v[208:211], v[192:195]
    v_mfma_f32_16x16x32_bf16 v[196:199], v[76:79], v[208:211], v[196:199]
    s_waitcnt lgkmcnt(0)
    s_waitcnt vmcnt(0)
    s_barrier
    v_mfma_f32_16x16x32_bf16 v[128:131], v[112:115], v[80:83], v[128:131]
    ds_read_b64_tr_b16 v[64:65], v8 offset:16384
    v_mfma_f32_16x16x32_bf16 v[132:135], v[116:119], v[80:83], v[132:135]
    ds_read_b64_tr_b16 v[66:67], v9 offset:16384
    v_mfma_f32_16x16x32_bf16 v[144:147], v[112:115], v[88:91], v[144:147]
    ds_read_b64_tr_b16 v[68:69], v10 offset:16384
    v_mfma_f32_16x16x32_bf16 v[148:151], v[116:119], v[88:91], v[148:151]
    ds_read_b64_tr_b16 v[70:71], v11 offset:16384
    v_mfma_f32_16x16x32_bf16 v[160:163], v[112:115], v[96:99], v[160:163]
    ds_read_b64_tr_b16 v[72:73], v8 offset:24576
    v_mfma_f32_16x16x32_bf16 v[164:167], v[116:119], v[96:99], v[164:167]
    ds_read_b64_tr_b16 v[74:75], v9 offset:24576
    v_mfma_f32_16x16x32_bf16 v[176:179], v[112:115], v[104:107], v[176:179]
    ds_read_b64_tr_b16 v[76:77], v10 offset:24576
    v_mfma_f32_16x16x32_bf16 v[180:183], v[116:119], v[104:107], v[180:183]
    ds_read_b64_tr_b16 v[78:79], v11 offset:24576
    v_mfma_f32_16x16x32_bf16 v[192:195], v[112:115], v[208:211], v[192:195]
    ds_read_b128 v[32:35], v24 offset:0
    v_mfma_f32_16x16x32_bf16 v[196:199], v[116:119], v[208:211], v[196:199]
    ds_read_b128 v[36:39], v25 offset:0
    v_mfma_f32_16x16x32_bf16 v[128:131], v[120:123], v[84:87], v[128:131]
    ds_read_b128 v[40:43], v24 offset:2048
    v_mfma_f32_16x16x32_bf16 v[132:135], v[124:127], v[84:87], v[132:135]
    ds_read_b128 v[44:47], v25 offset:2048
    v_mfma_f32_16x16x32_bf16 v[144:147], v[120:123], v[92:95], v[144:147]
    ds_read_b128 v[48:51], v24 offset:4096
    v_mfma_f32_16x16x32_bf16 v[148:151], v[124:127], v[92:95], v[148:151]
    ds_read_b128 v[52:55], v25 offset:4096
    v_mfma_f32_16x16x32_bf16 v[160:163], v[120:123], v[100:103], v[160:163]
    ds_read_b128 v[56:59], v24 offset:6144
    v_mfma_f32_16x16x32_bf16 v[164:167], v[124:127], v[100:103], v[164:167]
    ds_read_b128 v[60:63], v25 offset:6144
    v_mfma_f32_16x16x32_bf16 v[176:179], v[120:123], v[108:111], v[176:179]
    v_mfma_f32_16x16x32_bf16 v[180:183], v[124:127], v[108:111], v[180:183]
    v_mfma_f32_16x16x32_bf16 v[192:195], v[120:123], v[208:211], v[192:195]
    v_mfma_f32_16x16x32_bf16 v[196:199], v[124:127], v[208:211], v[196:199]
    s_waitcnt lgkmcnt(0)
    v_and_b32 v20, 0xf0, v1
    v_lshrrev_b32 v20, 1, v20
    s_lshl_b32 s30, s26, 9
    s_add_u32 s30, s30, 188743680
    s_mov_b32 s31, 0x40000
    v_and_b32 v21, 1, v4
    v_lshlrev_b32 v21, 10, v21
    v_xor_b32 v8, v21, v8
    v_xor_b32 v9, v21, v9
    v_xor_b32 v10, v21, v10
    v_xor_b32 v11, v21, v11
    v_xor_b32 v12, v21, v12
    v_xor_b32 v13, v21, v13
    v_xor_b32 v14, v21, v14
    v_xor_b32 v15, v21, v15
w_stX:
    buffer_load_dword v22, off, s[64:67], 0 offset:192 sc1
    buffer_load_dwordx2 v[24:25], v20, s[4:7], s30 offen offset:0 sc1
    buffer_load_dwordx2 v[26:27], v20, s[4:7], s30 offen offset:128 sc1
    buffer_load_dwordx2 v[28:29], v20, s[4:7], s30 offen offset:256 sc1
    buffer_load_dwordx2 v[30:31], v20, s[4:7], s30 offen offset:384 sc1
    s_waitcnt vmcnt(0)
    v_readfirstlane_b32 s29, v22
    s_cmp_ge_u32 s29, 32
    s_cbranch_scc1 w_stXok
    s_sleep 4
    s_sub_u32 s31, s31, 1
    s_cbranch_scc0 w_stX
w_stXok:
    buffer_load_dword v22, off, s[64:67], 0 sc1
    v_fma_f32 v128, -v24, v192, v128
    v_fma_f32 v129, -v24, v193, v129
    v_fma_f32 v130, -v24, v194, v130
    v_fma_f32 v131, -v24, v195, v131
    v_fma_f32 v132, -v24, v196, v132
    v_fma_f32 v133, -v24, v197, v133
    v_fma_f32 v134, -v24, v198, v134
    v_fma_f32 v135, -v24, v199, v135
    v_mul_f32 v128, v128, v25
    v_mul_f32 v129, v129, v25
    v_mul_f32 v130, v130, v25
    v_mul_f32 v131, v131, v25
    v_mul_f32 v132, v132, v25
    v_mul_f32 v133, v133, v25
    v_mul_f32 v134, v134, v25
    v_mul_f32 v135, v135, v25
    v_fma_f32 v144, -v26, v192, v144
    v_fma_f32 v145, -v26, v193, v145
    v_fma_f32 v146, -v26, v194, v146
    v_fma_f32 v147, -v26, v195, v147
    v_fma_f32 v148, -v26, v196, v148
    v_fma_f32 v149, -v26, v197, v149
    v_fma_f32 v150, -v26, v198, v150
    v_fma_f32 v151, -v26, v199, v151
    v_mul_f32 v144, v144, v27
    v_mul_f32 v145, v145, v27
    v_mul_f32 v146, v146, v27
    v_mul_f32 v147, v147, v27
    v_mul_f32 v148, v148, v27
    v_mul_f32 v149, v149, v27
    v_mul_f32 v150, v150, v27
    v_mul_f32 v151, v151, v27
    v_fma_f32 v160, -v28, v192, v160
    v_fma_f32 v161, -v28, v193, v161
    v_fma_f32 v162, -v28, v194, v162
    v_fma_f32 v163, -v28, v195, v163
    v_fma_f32 v164, -v28, v196, v164
    v_fma_f32 v165, -v28, v197, v165
    v_fma_f32 v166, -v28, v198, v166
    v_fma_f32 v167, -v28, v199, v167
    v_mul_f32 v160, v160, v29
    v_mul_f32 v161, v161, v29
    v_mul_f32 v162, v162, v29
    v_mul_f32 v163, v163, v29
    v_mul_f32 v164, v164, v29
    v_mul_f32 v165, v165, v29
    v_mul_f32 v166, v166, v29
    v_mul_f32 v167, v167, v29
    v_fma_f32 v176, -v30, v192, v176
    v_fma_f32 v177, -v30, v193, v177
    v_fma_f32 v178, -v30, v194, v178
    v_fma_f32 v179, -v30, v195, v179
    v_fma_f32 v180, -v30, v196, v180
    v_fma_f32 v181, -v30, v197, v181
    v_fma_f32 v182, -v30, v198, v182
    v_fma_f32 v183, -v30, v199, v183
    v_mul_f32 v176, v176, v31
    v_mul_f32 v177, v177, v31
    v_mul_f32 v178, v178, v31
    v_mul_f32 v179, v179, v31
    v_mul_f32 v180, v180, v31
    v_mul_f32 v181, v181, v31
    v_mul_f32 v182, v182, v31
    v_mul_f32 v183, v183, v31
    s_lshl_b32 s30, s27, 10
    s_add_u32 s30, s30, s49
    s_nop 7
    v_cvt_pk_bf16_f32 v80, v128, v129
    v_cvt_pk_bf16_f32 v81, v130, v131
    v_cvt_pk_bf16_f32 v82, v132, v133
    v_cvt_pk_bf16_f32 v83, v134, v135
    buffer_store_dwordx4 v[80:83], v1, s[4:7], s30 offen sc1
    s_add_u32 s30, s30, s50
    v_cvt_pk_bf16_f32 v84, v144, v145
    v_cvt_pk_bf16_f32 v85, v146, v147
    v_cvt_pk_bf16_f32 v86, v148, v149
    v_cvt_pk_bf16_f32 v87, v150, v151
    buffer_store_dwordx4 v[84:87], v1, s[4:7], s30 offen sc1
    s_add_u32 s30, s30, s50
    v_cvt_pk_bf16_f32 v88, v160, v161
    v_cvt_pk_bf16_f32 v89, v162, v163
    v_cvt_pk_bf16_f32 v90, v164, v165
    v_cvt_pk_bf16_f32 v91, v166, v167
    buffer_store_dwordx4 v[88:91], v1, s[4:7], s30 offen sc1
    s_add_u32 s30, s30, s50
    v_cvt_pk_bf16_f32 v92, v176, v177
    v_cvt_pk_bf16_f32 v93, v178, v179
    v_cvt_pk_bf16_f32 v94, v180, v181
    v_cvt_pk_bf16_f32 v95, v182, v183
    buffer_store_dwordx4 v[92:95], v1, s[4:7], s30 offen sc1
    s_add_u32 s30, s30, s50
    s_mov_b32 s28, s51
    s_mov_b32 s57, s53
    s_branch w_drain
w_firstM:
    s_waitcnt vmcnt(6)
    s_barrier
    s_add_u32 m0, s21, 0
    s_nop 0
    buffer_load_dwordx4 v1, s[4:7], s16 offen sc1 lds
    s_add_u32 s16, s16, s62
    s_add_u32 m0, s22, 0
    s_nop 0
    buffer_load_dwordx4 v2, s[8:11], s18 offen lds
    s_add_u32 s18, s18, s20
    s_add_u32 m0, s22, 8192
    s_nop 0
    buffer_load_dwordx4 v2, s[12:15], s19 offen lds
    s_add_u32 s19, s19, s20
    v_mfma_f32_16x16x32_bf16 v[128:131], v[64:67], v[32:35], 0
    ds_read_b64_tr_b16 v[112:113], v8 offset:49152
    v_mfma_f32_16x16x32_bf16 v[132:135], v[68:71], v[32:35], 0
    ds_read_b64_tr_b16 v[114:115], v9 offset:49152
    v_mfma_f32_16x16x32_bf16 v[136:139], v[72:75], v[32:35], 0
    ds_read_b64_tr_b16 v[116:117], v10 offset:49152
    v_mfma_f32_16x16x32_bf16 v[140:143], v[76:79], v[32:35], 0
    ds_read_b64_tr_b16 v[118:119], v11 offset:49152
    v_mfma_f32_16x16x32_bf16 v[144:147], v[64:67], v[40:43], 0
    ds_read_b64_tr_b16 v[120:121], v8 offset:57344
    v_mfma_f32_16x16x32_bf16 v[148:151], v[68:71], v[40:43], 0
    ds_read_b64_tr_b16 v[122:123], v9 offset:57344
    v_mfma_f32_16x16x32_bf16 v[152:155], v[72:75], v[40:43], 0
    ds_read_b64_tr_b16 v[124:125], v10 offset:57344
    v_mfma_f32_16x16x32_bf16 v[156:159], v[76:79], v[40:43], 0
    ds_read_b64_tr_b16 v[126:127], v11 offset:57344
    v_mfma_f32_16x16x32_bf16 v[160:163], v[64:67], v[48:51], 0
    ds_read_b128 v[80:83], v5 offset:32768
    v_mfma_f32_16x16x32_bf16 v[164:167], v[68:71], v[48:51], 0
    ds_read_b128 v[88:91], v5 offset:34816
    v_mfma_f32_16x16x32_bf16 v[168:171], v[72:75], v[48:51], 0
    ds_read_b128 v[96:99], v5 offset:36864
    v_mfma_f32_16x16x32_bf16 v[172:175], v[76:79], v[48:51], 0
    ds_read_b128 v[104:107], v5 offset:38912
    v_mfma_f32_16x16x32_bf16 v[176:179], v[64:67], v[56:59], 0
    v_mfma_f32_16x16x32_bf16 v[180:183], v[68:71], v[56:59], 0
    v_mfma_f32_16x16x32_bf16 v[184:187], v[72:75], v[56:59], 0
    v_mfma_f32_16x16x32_bf16 v[188:191], v[76:79], v[56:59], 0
    s_waitcnt lgkmcnt(0)
    s_waitcnt vmcnt(6)
    s_barrier
    s_add_u32 m0, s21, 32768
    s_nop 0
    buffer_load_dwordx4 v1, s[4:7], s16 offen sc1 lds
    s_add_u32 s16, s16, s62
    s_add_u32 m0, s22, 32768
    s_nop 0
    buffer_load_dwordx4 v2, s[8:11], s18 offen lds
    s_add_u32 s18, s18, s20
    s_add_u32 m0, s22, 40960
    s_nop 0
    buffer_load_dwordx4 v2, s[12:15], s19 offen lds
    s_add_u32 s19, s19, s20
    v_mfma_f32_16x16x32_bf16 v[128:131], v[112:115], v[80:83], v[128:131]
    ds_read_b64_tr_b16 v[64:65], v12 offset:16384
    v_mfma_f32_16x16x32_bf16 v[132:135], v[116:119], v[80:83], v[132:135]
    ds_read_b64_tr_b16 v[66:67], v13 offset:16384
    v_mfma_f32_16x16x32_bf16 v[136:139], v[120:123], v[80:83], v[136:139]
    ds_read_b64_tr_b16 v[68:69], v14 offset:16384
    v_mfma_f32_16x16x32_bf16 v[140:143], v[124:127], v[80:83], v[140:143]
    ds_read_b64_tr_b16 v[70:71], v15 offset:16384
    v_mfma_f32_16x16x32_bf16 v[144:147], v[112:115], v[88:91], v[144:147]
    ds_read_b64_tr_b16 v[72:73], v12 offset:24576
    v_mfma_f32_16x16x32_bf16 v[148:151], v[116:119], v[88:91], v[148:151]
    ds_read_b64_tr_b16 v[74:75], v13 offset:24576
    v_mfma_f32_16x16x32_bf16 v[152:155], v[120:123], v[88:91], v[152:155]
    ds_read_b64_tr_b16 v[76:77], v14 offset:24576
    v_mfma_f32_16x16x32_bf16 v[156:159], v[124:127], v[88:91], v[156:159]
    ds_read_b64_tr_b16 v[78:79], v15 offset:24576
    v_mfma_f32_16x16x32_bf16 v[160:163], v[112:115], v[96:99], v[160:163]
    ds_read_b128 v[32:35], v6 offset:0
    v_mfma_f32_16x16x32_bf16 v[164:167], v[116:119], v[96:99], v[164:167]
    ds_read_b128 v[40:43], v6 offset:2048
    v_mfma_f32_16x16x32_bf16 v[168:171], v[120:123], v[96:99], v[168:171]
    ds_read_b128 v[48:51], v6 offset:4096
    v_mfma_f32_16x16x32_bf16 v[172:175], v[124:127], v[96:99], v[172:175]
    ds_read_b128 v[56:59], v6 offset:6144
    v_mfma_f32_16x16x32_bf16 v[176:179], v[112:115], v[104:107], v[176:179]
    v_mfma_f32_16x16x32_bf16 v[180:183], v[116:119], v[104:107], v[180:183]
    v_mfma_f32_16x16x32_bf16 v[184:187], v[120:123], v[104:107], v[184:187]
    v_mfma_f32_16x16x32_bf16 v[188:191], v[124:127], v[104:107], v[188:191]
    s_waitcnt lgkmcnt(0)
    s_waitcnt vmcnt(6)
    s_barrier
    s_add_u32 m0, s21, 65536
    s_nop 0
    buffer_load_dwordx4 v1, s[4:7], s16 offen sc1 lds
    s_add_u32 s16, s16, s62
    s_add_u32 m0, s22, 65536
    s_nop 0
    buffer_load_dwordx4 v2, s[8:11], s18 offen lds
    s_add_u32 s18, s18, s20
    s_add_u32 m0, s22, 73728
    s_nop 0
    buffer_load_dwordx4 v2, s[12:15], s19 offen lds
    s_add_u32 s19, s19, s20
    v_mfma_f32_16x16x32_bf16 v[128:131], v[64:67], v[32:35], v[128:131]
    ds_read_b64_tr_b16 v[112:113], v12 offset:49152
    v_mfma_f32_16x16x32_bf16 v[132:135], v[68:71], v[32:35], v[132:135]
    ds_read_b64_tr_b16 v[114:115], v13 offset:49152
    v_mfma_f32_16x16x32_bf16 v[136:139], v[72:75], v[32:35], v[136:139]
    ds_read_b64_tr_b16 v[116:117], v14 offset:49152
    v_mfma_f32_16x16x32_bf16 v[140:143], v[76:79], v[32:35], v[140:143]
    ds_read_b64_tr_b16 v[118:119], v15 offset:49152
    v_mfma_f32_16x16x32_bf16 v[144:147], v[64:67], v[40:43], v[144:147]
    ds_read_b64_tr_b16 v[120:121], v12 offset:57344
    v_mfma_f32_16x16x32_bf16 v[148:151], v[68:71], v[40:43], v[148:151]
    ds_read_b64_tr_b16 v[122:123], v13 offset:57344
    v_mfma_f32_16x16x32_bf16 v[152:155], v[72:75], v[40:43], v[152:155]
    ds_read_b64_tr_b16 v[124:125], v14 offset:57344
    v_mfma_f32_16x16x32_bf16 v[156:159], v[76:79], v[40:43], v[156:159]
    ds_read_b64_tr_b16 v[126:127], v15 offset:57344
    v_mfma_f32_16x16x32_bf16 v[160:163], v[64:67], v[48:51], v[160:163]
    ds_read_b128 v[80:83], v6 offset:32768
    v_mfma_f32_16x16x32_bf16 v[164:167], v[68:71], v[48:51], v[164:167]
    ds_read_b128 v[88:91], v6 offset:34816
    v_mfma_f32_16x16x32_bf16 v[168:171], v[72:75], v[48:51], v[168:171]
    ds_read_b128 v[96:99], v6 offset:36864
    v_mfma_f32_16x16x32_bf16 v[172:175], v[76:79], v[48:51], v[172:175]
    ds_read_b128 v[104:107], v6 offset:38912
    v_mfma_f32_16x16x32_bf16 v[176:179], v[64:67], v[56:59], v[176:179]
    v_mfma_f32_16x16x32_bf16 v[180:183], v[68:71], v[56:59], v[180:183]
    v_mfma_f32_16x16x32_bf16 v[184:187], v[72:75], v[56:59], v[184:187]
    v_mfma_f32_16x16x32_bf16 v[188:191], v[76:79], v[56:59], v[188:191]
    s_waitcnt lgkmcnt(0)
    s_waitcnt vmcnt(6)
    s_barrier
    s_add_u32 m0, s21, 98304
    s_nop 0
    buffer_load_dwordx4 v1, s[4:7], s16 offen sc1 lds
    s_add_u32 s16, s16, s62
    s_add_u32 m0, s22, 98304
    s_nop 0
    buffer_load_dwordx4 v2, s[8:11], s18 offen lds
    s_add_u32 s18, s18, s20
    s_add_u32 m0, s22, 106496
    s_nop 0
    buffer_load_dwordx4 v2, s[12:15], s19 offen lds
    s_add_u32 s19, s19, s20
    v_mfma_f32_16x16x32_bf16 v[128:131], v[112:115], v[80:83], v[128:131]
    ds_read_b64_tr_b16 v[64:65], v8 offset:16384
    v_mfma_f32_16x16x32_bf16 v[132:135], v[116:119], v[80:83], v[132:135]
    ds_read_b64_tr_b16 v[66:67], v9 offset:16384
    v_mfma_f32_16x16x32_bf16 v[136:139], v[120:123], v[80:83], v[136:139]
    ds_read_b64_tr_b16 v[68:69], v10 offset:16384
    v_mfma_f32_16x16x32_bf16 v[140:143], v[124:127], v[80:83], v[140:143]
    ds_read_b64_tr_b16 v[70:71], v11 offset:16384
    v_mfma_f32_16x16x32_bf16 v[144:147], v[112:115], v[88:91], v[144:147]
    ds_read_b64_tr_b16 v[72:73], v8 offset:24576
    v_mfma_f32_16x16x32_bf16 v[148:151], v[116:119], v[88:91], v[148:151]
    ds_read_b64_tr_b16 v[74:75], v9 offset:24576
    v_mfma_f32_16x16x32_bf16 v[152:155], v[120:123], v[88:91], v[152:155]
    ds_read_b64_tr_b16 v[76:77], v10 offset:24576
    v_mfma_f32_16x16x32_bf16 v[156:159], v[124:127], v[88:91], v[156:159]
    ds_read_b64_tr_b16 v[78:79], v11 offset:24576
    v_mfma_f32_16x16x32_bf16 v[160:163], v[112:115], v[96:99], v[160:163]
    ds_read_b128 v[32:35], v5 offset:0
    v_mfma_f32_16x16x32_bf16 v[164:167], v[116:119], v[96:99], v[164:167]
    ds_read_b128 v[40:43], v5 offset:2048
    v_mfma_f32_16x16x32_bf16 v[168:171], v[120:123], v[96:99], v[168:171]
    ds_read_b128 v[48:51], v5 offset:4096
    v_mfma_f32_16x16x32_bf16 v[172:175], v[124:127], v[96:99], v[172:175]
    ds_read_b128 v[56:59], v5 offset:6144
    v_mfma_f32_16x16x32_bf16 v[176:179], v[112:115], v[104:107], v[176:179]
    v_mfma_f32_16x16x32_bf16 v[180:183], v[116:119], v[104:107], v[180:183]
    v_mfma_f32_16x16x32_bf16 v[184:187], v[120:123], v[104:107], v[184:187]
    v_mfma_f32_16x16x32_bf16 v[188:191], v[124:127], v[104:107], v[188:191]
    s_waitcnt lgkmcnt(0)
w_loop_chkM:
    s_sub_u32 s23, s23, 1
w_loopM:
    s_cmp_lg_u32 s23, 1
    s_cbranch_scc1 w_bodyM
    v_readfirstlane_b32 s68, v22
    s_cmp_ge_u32 s68, 128
    s_cselect_b32 s70, 0, s70
    v_readfirstlane_b32 s30, v16
    s_cmp_ge_u32 s30, s45
    s_cselect_b32 s30, 0, 1
    s_or_b32 s30, s30, s70
    s_cmp_ge_u32 s32, 4
    s_cselect_b32 s30, 1, s30
    s_cmp_eq_u32 s32, 0
    s_cselect_b32 s30, 1, s30
    v_mov_b32 v20, s30
    ds_write_b32 v7, v20
    s_cbranch_scc1 w_bodyM
    s_load_dwordx2 s[8:9], s[0:1], s33
    s_load_dwordx2 s[12:13], s[0:1], s34
    s_mov_b32 s10, s38
    s_mov_b32 s14, s38
    s_cmp_ge_u32 s32, 4
    s_cselect_b32 s31, 0, 1
    s_lshl_b32 s30, s3, s31
    s_mul_i32 s30, s30, s40
    s_add_u32 s16, s39, s30
    s_cmp_eq_u32 s32, 4
    s_cselect_b32 s30, 1024, s40
    s_cselect_b32 s31, 6, 5
    s_lshl_b32 s62, 32, s31
    s_add_u32 s17, s16, s30
    s_lshl_b32 s30, s3, 2
    s_mul_i32 s30, s30, s35
    s_add_u32 s18, s36, s30
    s_add_u32 s19, s37, s30
    s_lshl_b32 s20, s35, s31
    v_mul_u32_u24 v2, s35, v4
    v_add_u32 v2, v2, v3
    s_waitcnt lgkmcnt(0)
    s_waitcnt vmcnt(6)
    s_barrier
    s_add_u32 m0, s21, 0
    s_nop 0
    buffer_load_dwordx4 v1, s[4:7], s16 offen sc1 lds
    s_add_u32 s16, s16, s62
    s_add_u32 m0, s21, 1024
    s_nop 0
    buffer_load_dwordx4 v1, s[4:7], s17 offen sc1 lds
    s_add_u32 s17, s17, s62
    s_add_u32 m0, s22, 0
    s_nop 0
    buffer_load_dwordx4 v2, s[8:11], s18 offen lds
    s_add_u32 s18, s18, s20
    s_add_u32 m0, s22, 8192
    s_nop 0
    buffer_load_dwordx4 v2, s[12:15], s19 offen lds
    s_add_u32 s19, s19, s20
    v_mfma_f32_16x16x32_bf16 v[128:131], v[64:67], v[32:35], v[128:131]
    ds_read_b64_tr_b16 v[112:113], v8 offset:49152
    v_mfma_f32_16x16x32_bf16 v[132:135], v[68:71], v[32:35], v[132:135]
    ds_read_b64_tr_b16 v[114:115], v9 offset:49152
    v_mfma_f32_16x16x32_bf16 v[136:139], v[72:75], v[32:35], v[136:139]
    ds_read_b64_tr_b16 v[116:117], v10 offset:49152
    v_mfma_f32_16x16x32_bf16 v[140:143], v[76:79], v[32:35], v[140:143]
    ds_read_b64_tr_b16 v[118:119], v11 offset:49152
    v_mfma_f32_16x16x32_bf16 v[144:147], v[64:67], v[40:43], v[144:147]
    ds_read_b64_tr_b16 v[120:121], v8 offset:57344
    v_mfma_f32_16x16x32_bf16 v[148:151], v[68:71], v[40:43], v[148:151]
    ds_read_b64_tr_b16 v[122:123], v9 offset:57344
    v_mfma_f32_16x16x32_bf16 v[152:155], v[72:75], v[40:43], v[152:155]
    ds_read_b64_tr_b16 v[124:125], v10 offset:57344
    v_mfma_f32_16x16x32_bf16 v[156:159], v[76:79], v[40:43], v[156:159]
    ds_read_b64_tr_b16 v[126:127], v11 offset:57344
    v_mfma_f32_16x16x32_bf16 v[160:163], v[64:67], v[48:51], v[160:163]
    ds_read_b128 v[80:83], v5 offset:32768
    v_mfma_f32_16x16x32_bf16 v[164:167], v[68:71], v[48:51], v[164:167]
    ds_read_b128 v[88:91], v5 offset:34816
    v_mfma_f32_16x16x32_bf16 v[168:171], v[72:75], v[48:51], v[168:171]
    ds_read_b128 v[96:99], v5 offset:36864
    v_mfma_f32_16x16x32_bf16 v[172:175], v[76:79], v[48:51], v[172:175]
    ds_read_b128 v[104:107], v5 offset:38912
    v_mfma_f32_16x16x32_bf16 v[176:179], v[64:67], v[56:59], v[176:179]
    v_mfma_f32_16x16x32_bf16 v[180:183], v[68:71], v[56:59], v[180:183]
    v_mfma_f32_16x16x32_bf16 v[184:187], v[72:75], v[56:59], v[184:187]
    v_mfma_f32_16x16x32_bf16 v[188:191], v[76:79], v[56:59], v[188:191]
    s_waitcnt lgkmcnt(0)
    s_waitcnt vmcnt(7)
    s_barrier
    s_add_u32 m0, s21, 32768
    s_nop 0
    buffer_load_dwordx4 v1, s[4:7], s16 offen sc1 lds
    s_add_u32 s16, s16, s62
    s_add_u32 m0, s21, 33792
    s_nop 0
    buffer_load_dwordx4 v1, s[4:7], s17 offen sc1 lds
    s_add_u32 s17, s17, s62
    s_add_u32 m0, s22, 32768
    s_nop 0
    buffer_load_dwordx4 v2, s[8:11], s18 offen lds
    s_add_u32 s18, s18, s20
    s_add_u32 m0, s22, 40960
    s_nop 0
    buffer_load_dwordx4 v2, s[12:15], s19 offen lds
    s_add_u32 s19, s19, s20
    v_mfma_f32_16x16x32_bf16 v[128:131], v[112:115], v[80:83], v[128:131]
    ds_read_b64_tr_b16 v[64:65], v12 offset:16384
    v_mfma_f32_16x16x32_bf16 v[132:135], v[116:119], v[80:83], v[132:135]
    ds_read_b64_tr_b16 v[66:67], v13 offset:16384
    v_mfma_f32_16x16x32_bf16 v[136:139], v[120:123], v[80:83], v[136:139]
    ds_read_b64_tr_b16 v[68:69], v14 offset:16384
    v_mfma_f32_16x16x32_bf16 v[140:143], v[124:127], v[80:83], v[140:143]
    ds_read_b64_tr_b16 v[70:71], v15 offset:16384
    v_mfma_f32_16x16x32_bf16 v[144:147], v[112:115], v[88:91], v[144:147]
    ds_read_b64_tr_b16 v[72:73], v12 offset:24576
    v_mfma_f32_16x16x32_bf16 v[148:151], v[116:119], v[88:91], v[148:151]
    ds_read_b64_tr_b16 v[74:75], v13 offset:24576
    v_mfma_f32_16x16x32_bf16 v[152:155], v[120:123], v[88:91], v[152:155]
    ds_read_b64_tr_b16 v[76:77], v14 offset:24576
    v_mfma_f32_16x16x32_bf16 v[156:159], v[124:127], v[88:91], v[156:159]
    ds_read_b64_tr_b16 v[78:79], v15 offset:24576
    v_mfma_f32_16x16x32_bf16 v[160:163], v[112:115], v[96:99], v[160:163]
    ds_read_b128 v[32:35], v6 offset:0
    v_mfma_f32_16x16x32_bf16 v[164:167], v[116:119], v[96:99], v[164:167]
    ds_read_b128 v[40:43], v6 offset:2048
    v_mfma_f32_16x16x32_bf16 v[168:171], v[120:123], v[96:99], v[168:171]
    ds_read_b128 v[48:51], v6 offset:4096
    v_mfma_f32_16x16x32_bf16 v[172:175], v[124:127], v[96:99], v[172:175]
    ds_read_b128 v[56:59], v6 offset:6144
    v_mfma_f32_16x16x32_bf16 v[176:179], v[112:115], v[104:107], v[176:179]
    v_mfma_f32_16x16x32_bf16 v[180:183], v[116:119], v[104:107], v[180:183]
    v_mfma_f32_16x16x32_bf16 v[184:187], v[120:123], v[104:107], v[184:187]
    v_mfma_f32_16x16x32_bf16 v[188:191], v[124:127], v[104:107], v[188:191]
    s_waitcnt lgkmcnt(0)
    s_waitcnt vmcnt(8)
    s_barrier
    s_add_u32 m0, s21, 65536
    s_nop 0
    buffer_load_dwordx4 v1, s[4:7], s16 offen sc1 lds
    s_add_u32 s16, s16, s62
    s_add_u32 m0, s21, 66560
    s_nop 0
    buffer_load_dwordx4 v1, s[4:7], s17 offen sc1 lds
    s_add_u32 s17, s17, s62
    s_add_u32 m0, s22, 65536
    s_nop 0
    buffer_load_dwordx4 v2, s[8:11], s18 offen lds
    s_add_u32 s18, s18, s20
    s_add_u32 m0, s22, 73728
    s_nop 0
    buffer_load_dwordx4 v2, s[12:15], s19 offen lds
    s_add_u32 s19, s19, s20
    v_mfma_f32_16x16x32_bf16 v[128:131], v[64:67], v[32:35], v[128:131]
    ds_read_b64_tr_b16 v[112:113], v12 offset:49152
    v_mfma_f32_16x16x32_bf16 v[132:135], v[68:71], v[32:35], v[132:135]
    ds_read_b64_tr_b16 v[114:115], v13 offset:49152
    v_mfma_f32_16x16x32_bf16 v[136:139], v[72:75], v[32:35], v[136:139]
    ds_read_b64_tr_b16 v[116:117], v14 offset:49152
    v_mfma_f32_16x16x32_bf16 v[140:143], v[76:79], v[32:35], v[140:143]
    ds_read_b64_tr_b16 v[118:119], v15 offset:49152
    v_mfma_f32_16x16x32_bf16 v[144:147], v[64:67], v[40:43], v[144:147]
    ds_read_b64_tr_b16 v[120:121], v12 offset:57344
    v_mfma_f32_16x16x32_bf16 v[148:151], v[68:71], v[40:43], v[148:151]
    ds_read_b64_tr_b16 v[122:123], v13 offset:57344
    v_mfma_f32_16x16x32_bf16 v[152:155], v[72:75], v[40:43], v[152:155]
    ds_read_b64_tr_b16 v[124:125], v14 offset:57344
    v_mfma_f32_16x16x32_bf16 v[156:159], v[76:79], v[40:43], v[156:159]
    ds_read_b64_tr_b16 v[126:127], v15 offset:57344
    v_mfma_f32_16x16x32_bf16 v[160:163], v[64:67], v[48:51], v[160:163]
    ds_read_b128 v[80:83], v6 offset:32768
    v_mfma_f32_16x16x32_bf16 v[164:167], v[68:71], v[48:51], v[164:167]
    ds_read_b128 v[88:91], v6 offset:34816
    v_mfma_f32_16x16x32_bf16 v[168:171], v[72:75], v[48:51], v[168:171]
    ds_read_b128 v[96:99], v6 offset:36864
    v_mfma_f32_16x16x32_bf16 v[172:175], v[76:79], v[48:51], v[172:175]
    ds_read_b128 v[104:107], v6 offset:38912
    v_mfma_f32_16x16x32_bf16 v[176:179], v[64:67], v[56:59], v[176:179]
    v_mfma_f32_16x16x32_bf16 v[180:183], v[68:71], v[56:59], v[180:183]
    v_mfma_f32_16x16x32_bf16 v[184:187], v[72:75], v[56:59], v[184:187]
    v_mfma_f32_16x16x32_bf16 v[188:191], v[76:79], v[56:59], v[188:191]
    s_waitcnt lgkmcnt(0)
    s_waitcnt vmcnt(8)
    s_barrier
    s_add_u32 m0, s21, 98304
    s_nop 0
    buffer_load_dwordx4 v1, s[4:7], s16 offen sc1 lds
    s_add_u32 s16, s16, s62
    s_add_u32 m0, s21, 99328
    s_nop 0
    buffer_load_dwordx4 v1, s[4:7], s17 offen sc1 lds
    s_add_u32 s17, s17, s62
    s_add_u32 m0, s22, 98304
    s_nop 0
    buffer_load_dwordx4 v2, s[8:11], s18 offen lds
    s_add_u32 s18, s18, s20
    s_add_u32 m0, s22, 106496
    s_nop 0
    buffer_load_dwordx4 v2, s[12:15], s19 offen lds
    s_add_u32 s19, s19, s20
    v_mfma_f32_16x16x32_bf16 v[128:131], v[112:115], v[80:83], v[128:131]
    ds_read_b64_tr_b16 v[64:65], v8 offset:16384
    v_mfma_f32_16x16x32_bf16 v[132:135], v[116:119], v[80:83], v[132:135]
    ds_read_b64_tr_b16 v[66:67], v9 offset:16384
    v_mfma_f32_16x16x32_bf16 v[136:139], v[120:123], v[80:83], v[136:139]
    ds_read_b64_tr_b16 v[68:69], v10 offset:16384
    v_mfma_f32_16x16x32_bf16 v[140:143], v[124:127], v[80:83], v[140:143]
    ds_read_b64_tr_b16 v[70:71], v11 offset:16384
    v_mfma_f32_16x16x32_bf16 v[144:147], v[112:115], v[88:91], v[144:147]
    ds_read_b64_tr_b16 v[72:73], v8 offset:24576
    v_mfma_f32_16x16x32_bf16 v[148:151], v[116:119], v[88:91], v[148:151]
    ds_read_b64_tr_b16 v[74:75], v9 offset:24576
    v_mfma_f32_16x16x32_bf16 v[152:155], v[120:123], v[88:91], v[152:155]
    ds_read_b64_tr_b16 v[76:77], v10 offset:24576
    v_mfma_f32_16x16x32_bf16 v[156:159], v[124:127], v[88:91], v[156:159]
    ds_read_b64_tr_b16 v[78:79], v11 offset:24576
    v_mfma_f32_16x16x32_bf16 v[160:163], v[112:115], v[96:99], v[160:163]
    ds_read_b128 v[32:35], v5 offset:0
    v_mfma_f32_16x16x32_bf16 v[164:167], v[116:119], v[96:99], v[164:167]
    ds_read_b128 v[36:39], v5 offset:1024
    v_mfma_f32_16x16x32_bf16 v[168:171], v[120:123], v[96:99], v[168:171]
    ds_read_b128 v[40:43], v5 offset:2048
    v_mfma_f32_16x16x32_bf16 v[172:175], v[124:127], v[96:99], v[172:175]
    ds_read_b128 v[44:47], v5 offset:3072
    v_mfma_f32_16x16x32_bf16 v[176:179], v[112:115], v[104:107], v[176:179]
    ds_read_b128 v[48:51], v5 offset:4096
    v_mfma_f32_16x16x32_bf16 v[180:183], v[116:119], v[104:107], v[180:183]
    ds_read_b128 v[52:55], v5 offset:5120
    v_mfma_f32_16x16x32_bf16 v[184:187], v[120:123], v[104:107], v[184:187]
    ds_read_b128 v[56:59], v5 offset:6144
    v_mfma_f32_16x16x32_bf16 v[188:191], v[124:127], v[104:107], v[188:191]
    ds_read_b128 v[60:63], v5 offset:7168
    s_waitcnt lgkmcnt(0)
    s_branch w_doneM
w_bodyM:
    buffer_load_dword v22, off, s[64:67], 0 sc1
    s_waitcnt vmcnt(6)
    s_barrier
    s_add_u32 m0, s21, 0
    s_nop 0
    buffer_load_dwordx4 v1, s[4:7], s16 offen sc1 lds
    s_add_u32 s16, s16, s62
    s_add_u32 m0, s22, 0
    s_nop 0
    buffer_load_dwordx4 v2, s[8:11], s18 offen lds
    s_add_u32 s18, s18, s20
    s_add_u32 m0, s22, 8192
    s_nop 0
    buffer_load_dwordx4 v2, s[12:15], s19 offen lds
    s_add_u32 s19, s19, s20
    v_mfma_f32_16x16x32_bf16 v[128:131], v[64:67], v[32:35], v[128:131]
    ds_read_b64_tr_b16 v[112:113], v8 offset:49152
    v_mfma_f32_16x16x32_bf16 v[132:135], v[68:71], v[32:35], v[132:135]
    ds_read_b64_tr_b16 v[114:115], v9 offset:49152
    v_mfma_f32_16x16x32_bf16 v[136:139], v[72:75], v[32:35], v[136:139]
    ds_read_b64_tr_b16 v[116:117], v10 offset:49152
    v_mfma_f32_16x16x32_bf16 v[140:143], v[76:79], v[32:35], v[140:143]
    ds_read_b64_tr_b16 v[118:119], v11 offset:49152
    v_mfma_f32_16x16x32_bf16 v[144:147], v[64:67], v[40:43], v[144:147]
    ds_read_b64_tr_b16 v[120:121], v8 offset:57344
    v_mfma_f32_16x16x32_bf16 v[148:151], v[68:71], v[40:43], v[148:151]
    ds_read_b64_tr_b16 v[122:123], v9 offset:57344
    v_mfma_f32_16x16x32_bf16 v[152:155], v[72:75], v[40:43], v[152:155]
    ds_read_b64_tr_b16 v[124:125], v10 offset:57344
    v_mfma_f32_16x16x32_bf16 v[156:159], v[76:79], v[40:43], v[156:159]
    ds_read_b64_tr_b16 v[126:127], v11 offset:57344
    v_mfma_f32_16x16x32_bf16 v[160:163], v[64:67], v[48:51], v[160:163]
    ds_read_b128 v[80:83], v5 offset:32768
    v_mfma_f32_16x16x32_bf16 v[164:167], v[68:71], v[48:51], v[164:167]
    ds_read_b128 v[88:91], v5 offset:34816
    v_mfma_f32_16x16x32_bf16 v[168:171], v[72:75], v[48:51], v[168:171]
    ds_read_b128 v[96:99], v5 offset:36864
    v_mfma_f32_16x16x32_bf16 v[172:175], v[76:79], v[48:51], v[172:175]
    ds_read_b128 v[104:107], v5 offset:38912
    v_mfma_f32_16x16x32_bf16 v[176:179], v[64:67], v[56:59], v[176:179]
    v_mfma_f32_16x16x32_bf16 v[180:183], v[68:71], v[56:59], v[180:183]
    v_mfma_f32_16x16x32_bf16 v[184:187], v[72:75], v[56:59], v[184:187]
    v_mfma_f32_16x16x32_bf16 v[188:191], v[76:79], v[56:59], v[188:191]
    buffer_load_dword v16, v17, s[4:7], s44 offen sc1
    s_waitcnt lgkmcnt(0)
    s_waitcnt vmcnt(6)
    s_barrier
    s_add_u32 m0, s21, 32768
    s_nop 0
    buffer_load_dwordx4 v1, s[4:7], s16 offen sc1 lds
    s_add_u32 s16, s16, s62
    s_add_u32 m0, s22, 32768
    s_nop 0
    buffer_load_dwordx4 v2, s[8:11], s18 offen lds
    s_add_u32 s18, s18, s20
    s_add_u32 m0, s22, 40960
    s_nop 0
    buffer_load_dwordx4 v2, s[12:15], s19 offen lds
    s_add_u32 s19, s19, s20
    v_mfma_f32_16x16x32_bf16 v[128:131], v[112:115], v[80:83], v[128:131]
    ds_read_b64_tr_b16 v[64:65], v12 offset:16384
    v_mfma_f32_16x16x32_bf16 v[132:135], v[116:119], v[80:83], v[132:135]
    ds_read_b64_tr_b16 v[66:67], v13 offset:16384
    v_mfma_f32_16x16x32_bf16 v[136:139], v[120:123], v[80:83], v[136:139]
    ds_read_b64_tr_b16 v[68:69], v14 offset:16384
    v_mfma_f32_16x16x32_bf16 v[140:143], v[124:127], v[80:83], v[140:143]
    ds_read_b64_tr_b16 v[70:71], v15 offset:16384
    v_mfma_f32_16x16x32_bf16 v[144:147], v[112:115], v[88:91], v[144:147]
    ds_read_b64_tr_b16 v[72:73], v12 offset:24576
    v_mfma_f32_16x16x32_bf16 v[148:151], v[116:119], v[88:91], v[148:151]
    ds_read_b64_tr_b16 v[74:75], v13 offset:24576
    v_mfma_f32_16x16x32_bf16 v[152:155], v[120:123], v[88:91], v[152:155]
    ds_read_b64_tr_b16 v[76:77], v14 offset:24576
    v_mfma_f32_16x16x32_bf16 v[156:159], v[124:127], v[88:91], v[156:159]
    ds_read_b64_tr_b16 v[78:79], v15 offset:24576
    v_mfma_f32_16x16x32_bf16 v[160:163], v[112:115], v[96:99], v[160:163]
    ds_read_b128 v[32:35], v6 offset:0
    v_mfma_f32_16x16x32_bf16 v[164:167], v[116:119], v[96:99], v[164:167]
    ds_read_b128 v[40:43], v6 offset:2048
    v_mfma_f32_16x16x32_bf16 v[168:171], v[120:123], v[96:99], v[168:171]
    ds_read_b128 v[48:51], v6 offset:4096
    v_mfma_f32_16x16x32_bf16 v[172:175], v[124:127], v[96:99], v[172:175]
    ds_read_b128 v[56:59], v6 offset:6144
    v_mfma_f32_16x16x32_bf16 v[176:179], v[112:115], v[104:107], v[176:179]
    v_mfma_f32_16x16x32_bf16 v[180:183], v[116:119], v[104:107], v[180:183]
    v_mfma_f32_16x16x32_bf16 v[184:187], v[120:123], v[104:107], v[184:187]
    v_mfma_f32_16x16x32_bf16 v[188:191], v[124:127], v[104:107], v[188:191]
    s_waitcnt lgkmcnt(0)
    s_waitcnt vmcnt(6)
    s_barrier
    s_add_u32 m0, s21, 65536
    s_nop 0
    buffer_load_dwordx4 v1, s[4:7], s16 offen sc1 lds
    s_add_u32 s16, s16, s62
    s_add_u32 m0, s22, 65536
    s_nop 0
    buffer_load_dwordx4 v2, s[8:11], s18 offen lds
    s_add_u32 s18, s18, s20
    s_add_u32 m0, s22, 73728
    s_nop 0
    buffer_load_dwordx4 v2, s[12:15], s19 offen lds
    s_add_u32 s19, s19, s20
    v_mfma_f32_16x16x32_bf16 v[128:131], v[64:67], v[32:35], v[128:131]
    ds_read_b64_tr_b16 v[112:113], v12 offset:49152
    v_mfma_f32_16x16x32_bf16 v[132:135], v[68:71], v[32:35], v[132:135]
    ds_read_b64_tr_b16 v[114:115], v13 offset:49152
    v_mfma_f32_16x16x32_bf16 v[136:139], v[72:75], v[32:35], v[136:139]
    ds_read_b64_tr_b16 v[116:117], v14 offset:49152
    v_mfma_f32_16x16x32_bf16 v[140:143], v[76:79], v[32:35], v[140:143]
    ds_read_b64_tr_b16 v[118:119], v15 offset:49152
    v_mfma_f32_16x16x32_bf16 v[144:147], v[64:67], v[40:43], v[144:147]
    ds_read_b64_tr_b16 v[120:121], v12 offset:57344
    v_mfma_f32_16x16x32_bf16 v[148:151], v[68:71], v[40:43], v[148:151]
    ds_read_b64_tr_b16 v[122:123], v13 offset:57344
    v_mfma_f32_16x16x32_bf16 v[152:155], v[72:75], v[40:43], v[152:155]
    ds_read_b64_tr_b16 v[124:125], v14 offset:57344
    v_mfma_f32_16x16x32_bf16 v[156:159], v[76:79], v[40:43], v[156:159]
    ds_read_b64_tr_b16 v[126:127], v15 offset:57344
    v_mfma_f32_16x16x32_bf16 v[160:163], v[64:67], v[48:51], v[160:163]
    ds_read_b128 v[80:83], v6 offset:32768
    v_mfma_f32_16x16x32_bf16 v[164:167], v[68:71], v[48:51], v[164:167]
    ds_read_b128 v[88:91], v6 offset:34816
    v_mfma_f32_16x16x32_bf16 v[168:171], v[72:75], v[48:51], v[168:171]
    ds_read_b128 v[96:99], v6 offset:36864
    v_mfma_f32_16x16x32_bf16 v[172:175], v[76:79], v[48:51], v[172:175]
    ds_read_b128 v[104:107], v6 offset:38912
    v_mfma_f32_16x16x32_bf16 v[176:179], v[64:67], v[56:59], v[176:179]
    v_mfma_f32_16x16x32_bf16 v[180:183], v[68:71], v[56:59], v[180:183]
    v_mfma_f32_16x16x32_bf16 v[184:187], v[72:75], v[56:59], v[184:187]
    v_mfma_f32_16x16x32_bf16 v[188:191], v[76:79], v[56:59], v[188:191]
    s_waitcnt lgkmcnt(0)
    s_waitcnt vmcnt(6)
    s_barrier
    s_add_u32 m0, s21, 98304
    s_nop 0
    buffer_load_dwordx4 v1, s[4:7], s16 offen sc1 lds
    s_add_u32 s16, s16, s62
    s_add_u32 m0, s22, 98304
    s_nop 0
    buffer_load_dwordx4 v2, s[8:11], s18 offen lds
    s_add_u32 s18, s18, s20
    s_add_u32 m0, s22, 106496
    s_nop 0
    buffer_load_dwordx4 v2, s[12:15], s19 offen lds
    s_add_u32 s19, s19, s20
    v_mfma_f32_16x16x32_bf16 v[128:131], v[112:115], v[80:83], v[128:131]
    ds_read_b64_tr_b16 v[64:65], v8 offset:16384
    v_mfma_f32_16x16x32_bf16 v[132:135], v[116:119], v[80:83], v[132:135]
    ds_read_b64_tr_b16 v[66:67], v9 offset:16384
    v_mfma_f32_16x16x32_bf16 v[136:139], v[120:123], v[80:83], v[136:139]
    ds_read_b64_tr_b16 v[68:69], v10 offset:16384
    v_mfma_f32_16x16x32_bf16 v[140:143], v[124:127], v[80:83], v[140:143]
    ds_read_b64_tr_b16 v[70:71], v11 offset:16384
    v_mfma_f32_16x16x32_bf16 v[144:147], v[112:115], v[88:91], v[144:147]
    ds_read_b64_tr_b16 v[72:73], v8 offset:24576
    v_mfma_f32_16x16x32_bf16 v[148:151], v[116:119], v[88:91], v[148:151]
    ds_read_b64_tr_b16 v[74:75], v9 offset:24576
    v_mfma_f32_16x16x32_bf16 v[152:155], v[120:123], v[88:91], v[152:155]
    ds_read_b64_tr_b16 v[76:77], v10 offset:24576
    v_mfma_f32_16x16x32_bf16 v[156:159], v[124:127], v[88:91], v[156:159]
    ds_read_b64_tr_b16 v[78:79], v11 offset:24576
    v_mfma_f32_16x16x32_bf16 v[160:163], v[112:115], v[96:99], v[160:163]
    ds_read_b128 v[32:35], v5 offset:0
    v_mfma_f32_16x16x32_bf16 v[164:167], v[116:119], v[96:99], v[164:167]
    ds_read_b128 v[40:43], v5 offset:2048
    v_mfma_f32_16x16x32_bf16 v[168:171], v[120:123], v[96:99], v[168:171]
    ds_read_b128 v[48:51], v5 offset:4096
    v_mfma_f32_16x16x32_bf16 v[172:175], v[124:127], v[96:99], v[172:175]
    ds_read_b128 v[56:59], v5 offset:6144
    v_mfma_f32_16x16x32_bf16 v[176:179], v[112:115], v[104:107], v[176:179]
    v_mfma_f32_16x16x32_bf16 v[180:183], v[116:119], v[104:107], v[180:183]
    v_mfma_f32_16x16x32_bf16 v[184:187], v[120:123], v[104:107], v[184:187]
    v_mfma_f32_16x16x32_bf16 v[188:191], v[124:127], v[104:107], v[188:191]
    s_waitcnt lgkmcnt(0)
    s_sub_u32 s23, s23, 1
    s_cmp_lg_u32 s23, 0
    s_cbranch_scc1 w_loopM
w_doneM:
    v_mov_b32 v20, 131072
    ds_read_b128 v[24:27], v20
    ds_read_b128 v[28:31], v20 offset:16
    s_lshl_b32 s30, s27, 10
    s_add_u32 s30, s30, s49
    s_nop 7
    v_cvt_pk_bf16_f32 v80, v128, v129
    v_cvt_pk_bf16_f32 v81, v130, v131
    v_cvt_pk_bf16_f32 v82, v132, v133
    v_cvt_pk_bf16_f32 v83, v134, v135
    buffer_store_dwordx4 v[80:83], v1, s[4:7], s30 offen sc1
    v_cvt_pk_bf16_f32 v84, v136, v137
    v_cvt_pk_bf16_f32 v85, v138, v139
    v_cvt_pk_bf16_f32 v86, v140, v141
    v_cvt_pk_bf16_f32 v87, v142, v143
    buffer_store_dwordx4 v[84:87], v19, s[4:7], s30 offen sc1
    s_add_u32 s30, s30, s50
    v_cvt_pk_bf16_f32 v88, v144, v145
    v_cvt_pk_bf16_f32 v89, v146, v147
    v_cvt_pk_bf16_f32 v90, v148, v149
    v_cvt_pk_bf16_f32 v91, v150, v151
    buffer_store_dwordx4 v[88:91], v1, s[4:7], s30 offen sc1
    v_cvt_pk_bf16_f32 v92, v152, v153
    v_cvt_pk_bf16_f32 v93, v154, v155
    v_cvt_pk_bf16_f32 v94, v156, v157
    v_cvt_pk_bf16_f32 v95, v158, v159
    buffer_store_dwordx4 v[92:95], v19, s[4:7], s30 offen sc1
    s_add_u32 s30, s30, s50
    v_cvt_pk_bf16_f32 v80, v160, v161
    v_cvt_pk_bf16_f32 v81, v162, v163
    v_cvt_pk_bf16_f32 v82, v164, v165
    v_cvt_pk_bf16_f32 v83, v166, v167
    buffer_store_dwordx4 v[80:83], v1, s[4:7], s30 offen sc1
    v_cvt_pk_bf16_f32 v84, v168, v169
    v_cvt_pk_bf16_f32 v85, v170, v171
    v_cvt_pk_bf16_f32 v86, v172, v173
    v_cvt_pk_bf16_f32 v87, v174, v175
    buffer_store_dwordx4 v[84:87], v19, s[4:7], s30 offen sc1
    s_add_u32 s30, s30, s50
    v_cvt_pk_bf16_f32 v88, v176, v177
    v_cvt_pk_bf16_f32 v89, v178, v179
    v_cvt_pk_bf16_f32 v90, v180, v181
    v_cvt_pk_bf16_f32 v91, v182, v183
    buffer_store_dwordx4 v[88:91], v1, s[4:7], s30 offen sc1
    v_cvt_pk_bf16_f32 v92, v184, v185
    v_cvt_pk_bf16_f32 v93, v186, v187
    v_cvt_pk_bf16_f32 v94, v188, v189
    v_cvt_pk_bf16_f32 v95, v190, v191
    buffer_store_dwordx4 v[92:95], v19, s[4:7], s30 offen sc1
    s_add_u32 s30, s30, s50
    s_waitcnt lgkmcnt(0)
    v_or3_b32 v24, v24, v25, v26
    v_or3_b32 v28, v28, v29, v30
    v_or3_b32 v24, v24, v27, v31
    v_or_b32 v24, v24, v28
    s_mov_b32 s28, s51
    s_mov_b32 s57, s53
    v_readfirstlane_b32 s30, v24
    s_cmp_lg_u32 s30, 0
    s_cbranch_scc1 w_drain
    s_mov_b32 s48, s32
    s_cmp_ge_u32 s32, 4
    s_cselect_b32 s30, 2, 3
    s_lshl_b32 s30, s26, s30
    s_mul_i32 s30, s30, s43
    s_add_u32 s49, s42, s30
    s_mov_b32 s50, s43
    s_mov_b32 s51, s46
    s_mov_b32 s23, s41
    s_mov_b32 s53, s47
    s_nop 0
    s_load_dwordx16 s[32:47], s[24:25], 0
    s_add_u32 s24, s24, 64
    s_addc_u32 s25, s25, 0
    s_branch w_first8
w_drain:
    s_waitcnt vmcnt(0)
    s_barrier
    s_cmp_eq_u32 s28, 0
    s_cbranch_scc1 sig_5
    s_cmp_lg_u32 s3, 0
    s_cbranch_scc1 sig_5
    s_mov_b64 exec, 1
    v_mov_b32 v18, s57
    buffer_atomic_add v18, v17, s[4:7], s28 offen sc1
    s_mov_b64 exec, -1
sig_5:
    s_mov_b32 s28, 0
    s_cmp_eq_u32 s98, 3
    s_cselect_b32 s98, 1, s98
    s_cmp_eq_u32 s98, 5
    s_cselect_b32 s98, 3, s98
    s_cmp_lg_u32 s98, 1
    s_cbranch_scc1 w_hook
    s_cmp_lt_u32 s39, 1048576
    s_cbranch_scc1 w_hook
    s_mov_b32 s98, 4
    s_branch ln_entry
w_hook:
    s_cmp_eq_u32 s70, 0
    s_cbranch_scc1 drw_ok
    s_cmp_lt_u32 s39, 1048576
    s_cbranch_scc1 drw_ok
    s_mov_b32 s70, 0
    s_cmp_lg_u32 s3, 0
    s_cbranch_scc1 drw_ok
    v_readfirstlane_b32 s68, v22
    s_cmp_ge_u32 s68, 128
    s_cbranch_scc1 drw_ok
    s_mov_b32 s69, 65536
drw:
    buffer_load_dword v20, off, s[64:67], 0 offset:0 sc1
    s_waitcnt vmcnt(0)
    v_readfirstlane_b32 s68, v20
    s_cmp_ge_u32 s68, 128
    s_cbranch_scc1 drw_ok
    s_sleep 8
    s_sub_u32 s69, s69, 1
    s_cbranch_scc0 drw
drw_ok:
    s_branch w_cold
fin_entry:
    s_load_dwordx2 s[8:9], s[0:1], 0
    s_load_dwordx2 s[12:13], s[0:1], 88
    v_mbcnt_lo_u32_b32 v1, -1, 0
    v_mbcnt_hi_u32_b32 v1, -1, v1
    s_mov_b32 s10, 4194304
    s_mov_b32 s11, 131072
    s_mov_b32 s14, 4194304
    s_mov_b32 s15, 131072
    v_lshlrev_b32 v3, 4, v1
    v_and_b32 v4, 15, v1
    v_lshrrev_b32 v5, 4, v1
    v_lshlrev_b32 v4, 11, v4
    v_lshl_add_u32 v4, v5, 4, v4
    v_and_b32 v5, 1, v5
    v_cmp_eq_u32 s[20:21], 1, v5
    v_and_b32 v6, 7, v1
    v_lshlrev_b32 v6, 7, v6
    s_lshr_b32 s24, s63, 2
    s_and_b32 s25, s63, 3
    s_lshl_b32 s25, s25, 2
    s_and_b32 s26, s3, 3
    s_add_u32 s25, s25, s26
    s_lshr_b32 s26, s3, 2
    s_mov_b32 s28, 65536
    s_waitcnt lgkmcnt(0)
fin_job:
    s_lshl_b32 s16, s24, 1
    s_add_u32 s16, s16, s26
    s_lshl_b32 s18, s16, 15
    s_lshl_b32 s17, s25, 11
    s_add_u32 s17, s17, s18
    s_lshl_b32 s19, s25, 7
    s_add_u32 s18, s18, s19
    s_add_u32 s22, s17, 167772160
    s_add_u32 s23, s17, 75497472
    s_lshr_b32 s27, s24, 3
    s_lshl_b32 s27, s27, 6
    s_add_u32 s27, s27, 218106368
    s_cmp_ge_u32 s24, 64
    s_cselect_b32 s29, 16, 16
    s_mov_b32 s30, 218112000
    s_add_u32 s32, s24, 1
    s_mov_b32 s33, 0
    s_mov_b32 s34, 255
    s_cmp_lt_u32 s24, 62
    s_cbranch_scc1 fin_tg
    s_mov_b32 s32, 16
    s_add_u32 s30, s30, 4
    s_sub_u32 s33, s24, 62
    s_lshl_b32 s33, s33, 3
fin_tg:
    s_mul_i32 s35, s24, 3
    s_lshr_b32 s35, s35, 4
    s_add_u32 s35, s35, 49
    s_min_u32 s35, s35, 61
    s_max_u32 s32, s32, s35
    buffer_load_dwordx4 v[88:91], v4, s[8:11], s18 offen offset:0
    buffer_load_dwordx4 v[92:95], v4, s[8:11], s18 offen offset:64
    s_cmp_lg_u32 s3, 0
    s_cbranch_scc1 fin_ws_ok
fin_wd:
    buffer_load_dword v7, off, s[4:7], s27 sc1
    s_waitcnt vmcnt(0)
    v_readfirstlane_b32 s31, v7
    s_cmp_ge_u32 s31, s29
    s_cbranch_scc1 fin_wd_ok
    s_sleep 127
    s_sub_u32 s28, s28, 1
    s_cbranch_scc0 fin_wd
    s_mov_b32 s28, 0
fin_wd_ok:
fin_ws:
    buffer_load_dword v7, v6, s[4:7], s30 offen sc1
    s_waitcnt vmcnt(0)
    v_lshrrev_b32 v7, s33, v7
    v_and_b32 v7, s34, v7
    v_cmp_gt_u32 vcc, s32, v7
    s_cbranch_vccz fin_ws_ok
    s_sleep 12
    v_add_u32 v7, 1, v7
    v_cmp_gt_u32 vcc, s32, v7
    s_cbranch_vccz fin_ws_f
    s_sleep 48
    v_add_u32 v7, 3, v7
    v_cmp_gt_u32 vcc, s32, v7
    s_cbranch_vccz fin_ws_f
    s_sleep 127
    s_sleep 127
fin_ws_f:
    s_sub_u32 s28, s28, 1
    s_cbranch_scc0 fin_ws
    s_mov_b32 s28, 0
fin_ws_ok:
    s_barrier
    buffer_load_dwordx4 v[144:147], v3, s[4:7], s22 offen offset:0 sc1
    buffer_load_dwordx4 v[160:163], v3, s[4:7], s22 offen offset:1024 sc1
    s_add_u32 s22, s22, 4194304
    buffer_load_dwordx4 v[148:151], v3, s[4:7], s22 offen offset:0 sc1
    buffer_load_dwordx4 v[164:167], v3, s[4:7], s22 offen offset:1024 sc1
    s_add_u32 s22, s22, 4194304
    buffer_load_dwordx4 v[152:155], v3, s[4:7], s22 offen offset:0 sc1
    buffer_load_dwordx4 v[168:171], v3, s[4:7], s22 offen offset:1024 sc1
    s_add_u32 s22, s22, 4194304
    buffer_load_dwordx4 v[156:159], v3, s[4:7], s22 offen offset:0 sc1
    buffer_load_dwordx4 v[172:175], v3, s[4:7], s22 offen offset:1024 sc1
    buffer_load_dwordx4 v[16:19], v3, s[4:7], s23 offen offset:0 sc1
    buffer_load_dwordx4 v[48:51], v3, s[4:7], s23 offen offset:1024 sc1
    s_add_u32 s23, s23, 4194304
    buffer_load_dwordx4 v[20:23], v3, s[4:7], s23 offen offset:0 sc1
    buffer_load_dwordx4 v[52:55], v3, s[4:7], s23 offen offset:1024 sc1
    s_add_u32 s23, s23, 4194304
    buffer_load_dwordx4 v[24:27], v3, s[4:7], s23 offen offset:0 sc1
    buffer_load_dwordx4 v[56:59], v3, s[4:7], s23 offen offset:1024 sc1
    s_add_u32 s23, s23, 4194304
    buffer_load_dwordx4 v[28:31], v3, s[4:7], s23 offen offset:0 sc1
    buffer_load_dwordx4 v[60:63], v3, s[4:7], s23 offen offset:1024 sc1
    s_add_u32 s23, s23, 4194304
    buffer_load_dwordx4 v[32:35], v3, s[4:7], s23 offen offset:0 sc1
    buffer_load_dwordx4 v[64:67], v3, s[4:7], s23 offen offset:1024 sc1
    s_add_u32 s23, s23, 4194304
    buffer_load_dwordx4 v[36:39], v3, s[4:7], s23 offen offset:0 sc1
    buffer_load_dwordx4 v[68:71], v3, s[4:7], s23 offen offset:1024 sc1
    s_add_u32 s23, s23, 4194304
    buffer_load_dwordx4 v[40:43], v3, s[4:7], s23 offen offset:0 sc1
    buffer_load_dwordx4 v[72:75], v3, s[4:7], s23 offen offset:1024 sc1
    s_add_u32 s23, s23, 4194304
    buffer_load_dwordx4 v[44:47], v3, s[4:7], s23 offen offset:0 sc1
    buffer_load_dwordx4 v[76:79], v3, s[4:7], s23 offen offset:1024 sc1
    s_add_u32 s23, s23, 4194304
    s_waitcnt vmcnt(16)
    v_lshlrev_b32 v96, 16, v144
    v_and_b32 v97, 0xffff0000, v144
    v_lshlrev_b32 v98, 16, v145
    v_and_b32 v99, 0xffff0000, v145
    v_lshlrev_b32 v100, 16, v146
    v_and_b32 v101, 0xffff0000, v146
    v_lshlrev_b32 v102, 16, v147
    v_and_b32 v103, 0xffff0000, v147
    v_lshlrev_b32 v120, 16, v148
    v_and_b32 v121, 0xffff0000, v148
    v_lshlrev_b32 v122, 16, v149
    v_and_b32 v123, 0xffff0000, v149
    v_lshlrev_b32 v124, 16, v150
    v_and_b32 v125, 0xffff0000, v150
    v_lshlrev_b32 v126, 16, v151
    v_and_b32 v127, 0xffff0000, v151
    v_add_f32 v96, v96, v120
    v_add_f32 v97, v97, v121
    v_add_f32 v98, v98, v122
    v_add_f32 v99, v99, v123
    v_add_f32 v100, v100, v124
    v_add_f32 v101, v101, v125
    v_add_f32 v102, v102, v126
    v_add_f32 v103, v103, v127
    v_lshlrev_b32 v120, 16, v152
    v_and_b32 v121, 0xffff0000, v152
    v_lshlrev_b32 v122, 16, v153
    v_and_b32 v123, 0xffff0000, v153
    v_lshlrev_b32 v124, 16, v154
    v_and_b32 v125, 0xffff0000, v154
    v_lshlrev_b32 v126, 16, v155
    v_and_b32 v127, 0xffff0000, v155
    v_add_f32 v96, v96, v120
    v_add_f32 v97, v97, v121
    v_add_f32 v98, v98, v122
    v_add_f32 v99, v99, v123
    v_add_f32 v100, v100, v124
    v_add_f32 v101, v101, v125
    v_add_f32 v102, v102, v126
    v_add_f32 v103, v103, v127
    v_lshlrev_b32 v120, 16, v156
    v_and_b32 v121, 0xffff0000, v156
    v_lshlrev_b32 v122, 16, v157
    v_and_b32 v123, 0xffff0000, v157
    v_lshlrev_b32 v124, 16, v158
    v_and_b32 v125, 0xffff0000, v158
    v_lshlrev_b32 v126, 16, v159
    v_and_b32 v127, 0xffff0000, v159
    v_add_f32 v96, v96, v120
    v_add_f32 v97, v97, v121
    v_add_f32 v98, v98, v122
    v_add_f32 v99, v99, v123
    v_add_f32 v100, v100, v124
    v_add_f32 v101, v101, v125
    v_add_f32 v102, v102, v126
    v_add_f32 v103, v103, v127
    v_cvt_pk_bf16_f32 v120, v96, v97
    v_cvt_pk_bf16_f32 v121, v98, v99
    v_cvt_pk_bf16_f32 v122, v100, v101
    v_cvt_pk_bf16_f32 v123, v102, v103
    v_lshlrev_b32 v96, 16, v120
    v_and_b32 v97, 0xffff0000, v120
    v_lshlrev_b32 v98, 16, v121
    v_and_b32 v99, 0xffff0000, v121
    v_lshlrev_b32 v100, 16, v122
    v_and_b32 v101, 0xffff0000, v122
    v_lshlrev_b32 v102, 16, v123
    v_and_b32 v103, 0xffff0000, v123
    v_mul_f32 v104, 0xbfb8aa3b, v96
    v_mul_f32 v105, 0xbfb8aa3b, v97
    v_mul_f32 v106, 0xbfb8aa3b, v98
    v_mul_f32 v107, 0xbfb8aa3b, v99
    v_mul_f32 v108, 0xbfb8aa3b, v100
    v_mul_f32 v109, 0xbfb8aa3b, v101
    v_mul_f32 v110, 0xbfb8aa3b, v102
    v_mul_f32 v111, 0xbfb8aa3b, v103
    v_exp_f32 v104, v104
    v_exp_f32 v105, v105
    v_exp_f32 v106, v106
    v_exp_f32 v107, v107
    v_exp_f32 v108, v108
    v_exp_f32 v109, v109
    v_exp_f32 v110, v110
    v_exp_f32 v111, v111
    v_add_f32 v104, 1.0, v104
    v_add_f32 v105, 1.0, v105
    v_add_f32 v106, 1.0, v106
    v_add_f32 v107, 1.0, v107
    v_add_f32 v108, 1.0, v108
    v_add_f32 v109, 1.0, v109
    v_add_f32 v110, 1.0, v110
    v_add_f32 v111, 1.0, v111
    v_rcp_f32 v104, v104
    v_rcp_f32 v105, v105
    v_rcp_f32 v106, v106
    v_rcp_f32 v107, v107
    v_rcp_f32 v108, v108
    v_rcp_f32 v109, v109
    v_rcp_f32 v110, v110
    v_rcp_f32 v111, v111
    v_mul_f32 v96, v96, v104
    v_mul_f32 v97, v97, v105
    v_mul_f32 v98, v98, v106
    v_mul_f32 v99, v99, v107
    v_mul_f32 v100, v100, v108
    v_mul_f32 v101, v101, v109
    v_mul_f32 v102, v102, v110
    v_mul_f32 v103, v103, v111
    v_cvt_pk_bf16_f32 v80, v96, v97
    v_cvt_pk_bf16_f32 v81, v98, v99
    v_cvt_pk_bf16_f32 v82, v100, v101
    v_cvt_pk_bf16_f32 v83, v102, v103
    v_lshlrev_b32 v96, 16, v160
    v_and_b32 v97, 0xffff0000, v160
    v_lshlrev_b32 v98, 16, v161
    v_and_b32 v99, 0xffff0000, v161
    v_lshlrev_b32 v100, 16, v162
    v_and_b32 v101, 0xffff0000, v162
    v_lshlrev_b32 v102, 16, v163
    v_and_b32 v103, 0xffff0000, v163
    v_lshlrev_b32 v120, 16, v164
    v_and_b32 v121, 0xffff0000, v164
    v_lshlrev_b32 v122, 16, v165
    v_and_b32 v123, 0xffff0000, v165
    v_lshlrev_b32 v124, 16, v166
    v_and_b32 v125, 0xffff0000, v166
    v_lshlrev_b32 v126, 16, v167
    v_and_b32 v127, 0xffff0000, v167
    v_add_f32 v96, v96, v120
    v_add_f32 v97, v97, v121
    v_add_f32 v98, v98, v122
    v_add_f32 v99, v99, v123
    v_add_f32 v100, v100, v124
    v_add_f32 v101, v101, v125
    v_add_f32 v102, v102, v126
    v_add_f32 v103, v103, v127
    v_lshlrev_b32 v120, 16, v168
    v_and_b32 v121, 0xffff0000, v168
    v_lshlrev_b32 v122, 16, v169
    v_and_b32 v123, 0xffff0000, v169
    v_lshlrev_b32 v124, 16, v170
    v_and_b32 v125, 0xffff0000, v170
    v_lshlrev_b32 v126, 16, v171
    v_and_b32 v127, 0xffff0000, v171
    v_add_f32 v96, v96, v120
    v_add_f32 v97, v97, v121
    v_add_f32 v98, v98, v122
    v_add_f32 v99, v99, v123
    v_add_f32 v100, v100, v124
    v_add_f32 v101, v101, v125
    v_add_f32 v102, v102, v126
    v_add_f32 v103, v103, v127
    v_lshlrev_b32 v120, 16, v172
    v_and_b32 v121, 0xffff0000, v172
    v_lshlrev_b32 v122, 16, v173
    v_and_b32 v123, 0xffff0000, v173
    v_lshlrev_b32 v124, 16, v174
    v_and_b32 v125, 0xffff0000, v174
    v_lshlrev_b32 v126, 16, v175
    v_and_b32 v127, 0xffff0000, v175
    v_add_f32 v96, v96, v120
    v_add_f32 v97, v97, v121
    v_add_f32 v98, v98, v122
    v_add_f32 v99, v99, v123
    v_add_f32 v100, v100, v124
    v_add_f32 v101, v101, v125
    v_add_f32 v102, v102, v126
    v_add_f32 v103, v103, v127
    v_cvt_pk_bf16_f32 v120, v96, v97
    v_cvt_pk_bf16_f32 v121, v98, v99
    v_cvt_pk_bf16_f32 v122, v100, v101
    v_cvt_pk_bf16_f32 v123, v102, v103
    v_lshlrev_b32 v96, 16, v120
    v_and_b32 v97, 0xffff0000, v120
    v_lshlrev_b32 v98, 16, v121
    v_and_b32 v99, 0xffff0000, v121
    v_lshlrev_b32 v100, 16, v122
    v_and_b32 v101, 0xffff0000, v122
    v_lshlrev_b32 v102, 16, v123
    v_and_b32 v103, 0xffff0000, v123
    v_mul_f32 v104, 0xbfb8aa3b, v96
    v_mul_f32 v105, 0xbfb8aa3b, v97
    v_mul_f32 v106, 0xbfb8aa3b, v98
    v_mul_f32 v107, 0xbfb8aa3b, v99
    v_mul_f32 v108, 0xbfb8aa3b, v100
    v_mul_f32 v109, 0xbfb8aa3b, v101
    v_mul_f32 v110, 0xbfb8aa3b, v102
    v_mul_f32 v111, 0xbfb8aa3b, v103
    v_exp_f32 v104, v104
    v_exp_f32 v105, v105
    v_exp_f32 v106, v106
    v_exp_f32 v107, v107
    v_exp_f32 v108, v108
    v_exp_f32 v109, v109
    v_exp_f32 v110, v110
    v_exp_f32 v111, v111
    v_add_f32 v104, 1.0, v104
    v_add_f32 v105, 1.0, v105
    v_add_f32 v106, 1.0, v106
    v_add_f32 v107, 1.0, v107
    v_add_f32 v108, 1.0, v108
    v_add_f32 v109, 1.0, v109
    v_add_f32 v110, 1.0, v110
    v_add_f32 v111, 1.0, v111
    v_rcp_f32 v104, v104
    v_rcp_f32 v105, v105
    v_rcp_f32 v106, v106
    v_rcp_f32 v107, v107
    v_rcp_f32 v108, v108
    v_rcp_f32 v109, v109
    v_rcp_f32 v110, v110
    v_rcp_f32 v111, v111
    v_mul_f32 v96, v96, v104
    v_mul_f32 v97, v97, v105
    v_mul_f32 v98, v98, v106
    v_mul_f32 v99, v99, v107
    v_mul_f32 v100, v100, v108
    v_mul_f32 v101, v101, v109
    v_mul_f32 v102, v102, v110
    v_mul_f32 v103, v103, v111
    v_cvt_pk_bf16_f32 v84, v96, v97
    v_cvt_pk_bf16_f32 v85, v98, v99
    v_cvt_pk_bf16_f32 v86, v100, v101
    v_cvt_pk_bf16_f32 v87, v102, v103
    s_waitcnt vmcnt(0)
    v_lshlrev_b32 v96, 16, v16
    v_and_b32 v97, 0xffff0000, v16
    v_lshlrev_b32 v98, 16, v17
    v_and_b32 v99, 0xffff0000, v17
    v_lshlrev_b32 v100, 16, v18
    v_and_b32 v101, 0xffff0000, v18
    v_lshlrev_b32 v102, 16, v19
    v_and_b32 v103, 0xffff0000, v19
    v_lshlrev_b32 v120, 16, v20
    v_and_b32 v121, 0xffff0000, v20
    v_lshlrev_b32 v122, 16, v21
    v_and_b32 v123, 0xffff0000, v21
    v_lshlrev_b32 v124, 16, v22
    v_and_b32 v125, 0xffff0000, v22
    v_lshlrev_b32 v126, 16, v23
    v_and_b32 v127, 0xffff0000, v23
    v_add_f32 v96, v96, v120
    v_add_f32 v97, v97, v121
    v_add_f32 v98, v98, v122
    v_add_f32 v99, v99, v123
    v_add_f32 v100, v100, v124
    v_add_f32 v101, v101, v125
    v_add_f32 v102, v102, v126
    v_add_f32 v103, v103, v127
    v_lshlrev_b32 v120, 16, v24
    v_and_b32 v121, 0xffff0000, v24
    v_lshlrev_b32 v122, 16, v25
    v_and_b32 v123, 0xffff0000, v25
    v_lshlrev_b32 v124, 16, v26
    v_and_b32 v125, 0xffff0000, v26
    v_lshlrev_b32 v126, 16, v27
    v_and_b32 v127, 0xffff0000, v27
    v_add_f32 v96, v96, v120
    v_add_f32 v97, v97, v121
    v_add_f32 v98, v98, v122
    v_add_f32 v99, v99, v123
    v_add_f32 v100, v100, v124
    v_add_f32 v101, v101, v125
    v_add_f32 v102, v102, v126
    v_add_f32 v103, v103, v127
    v_lshlrev_b32 v120, 16, v28
    v_and_b32 v121, 0xffff0000, v28
    v_lshlrev_b32 v122, 16, v29
    v_and_b32 v123, 0xffff0000, v29
    v_lshlrev_b32 v124, 16, v30
    v_and_b32 v125, 0xffff0000, v30
    v_lshlrev_b32 v126, 16, v31
    v_and_b32 v127, 0xffff0000, v31
    v_add_f32 v96, v96, v120
    v_add_f32 v97, v97, v121
    v_add_f32 v98, v98, v122
    v_add_f32 v99, v99, v123
    v_add_f32 v100, v100, v124
    v_add_f32 v101, v101, v125
    v_add_f32 v102, v102, v126
    v_add_f32 v103, v103, v127
    v_lshlrev_b32 v120, 16, v32
    v_and_b32 v121, 0xffff0000, v32
    v_lshlrev_b32 v122, 16, v33
    v_and_b32 v123, 0xffff0000, v33
    v_lshlrev_b32 v124, 16, v34
    v_and_b32 v125, 0xffff0000, v34
    v_lshlrev_b32 v126, 16, v35
    v_and_b32 v127, 0xffff0000, v35
    v_add_f32 v96, v96, v120
    v_add_f32 v97, v97, v121
    v_add_f32 v98, v98, v122
    v_add_f32 v99, v99, v123
    v_add_f32 v100, v100, v124
    v_add_f32 v101, v101, v125
    v_add_f32 v102, v102, v126
    v_add_f32 v103, v103, v127
    v_lshlrev_b32 v120, 16, v36
    v_and_b32 v121, 0xffff0000, v36
    v_lshlrev_b32 v122, 16, v37
    v_and_b32 v123, 0xffff0000, v37
    v_lshlrev_b32 v124, 16, v38
    v_and_b32 v125, 0xffff0000, v38
    v_lshlrev_b32 v126, 16, v39
    v_and_b32 v127, 0xffff0000, v39
    v_add_f32 v96, v96, v120
    v_add_f32 v97, v97, v121
    v_add_f32 v98, v98, v122
    v_add_f32 v99, v99, v123
    v_add_f32 v100, v100, v124
    v_add_f32 v101, v101, v125
    v_add_f32 v102, v102, v126
    v_add_f32 v103, v103, v127
    v_lshlrev_b32 v120, 16, v40
    v_and_b32 v121, 0xffff0000, v40
    v_lshlrev_b32 v122, 16, v41
    v_and_b32 v123, 0xffff0000, v41
    v_lshlrev_b32 v124, 16, v42
    v_and_b32 v125, 0xffff0000, v42
    v_lshlrev_b32 v126, 16, v43
    v_and_b32 v127, 0xffff0000, v43
    v_add_f32 v96, v96, v120
    v_add_f32 v97, v97, v121
    v_add_f32 v98, v98, v122
    v_add_f32 v99, v99, v123
    v_add_f32 v100, v100, v124
    v_add_f32 v101, v101, v125
    v_add_f32 v102, v102, v126
    v_add_f32 v103, v103, v127
    v_lshlrev_b32 v120, 16, v44
    v_and_b32 v121, 0xffff0000, v44
    v_lshlrev_b32 v122, 16, v45
    v_and_b32 v123, 0xffff0000, v45
    v_lshlrev_b32 v124, 16, v46
    v_and_b32 v125, 0xffff0000, v46
    v_lshlrev_b32 v126, 16, v47
    v_and_b32 v127, 0xffff0000, v47
    v_add_f32 v96, v96, v120
    v_add_f32 v97, v97, v121
    v_add_f32 v98, v98, v122
    v_add_f32 v99, v99, v123
    v_add_f32 v100, v100, v124
    v_add_f32 v101, v101, v125
    v_add_f32 v102, v102, v126
    v_add_f32 v103, v103, v127
    v_cndmask_b32 v108, v88, v90, s[20:21]
    v_cndmask_b32 v109, v89, v91, s[20:21]
    v_cndmask_b32 v110, v90, v88, s[20:21]
    v_cndmask_b32 v111, v91, v89, s[20:21]
    v_cvt_pk_bf16_f32 v104, v96, v97
    v_lshlrev_b32 v96, 16, v104
    v_and_b32 v97, 0xffff0000, v104
    v_lshlrev_b32 v104, 16, v80
    v_and_b32 v105, 0xffff0000, v80
    v_mul_f32 v96, v96, v104
    v_mul_f32 v97, v97, v105
    v_cvt_pk_bf16_f32 v104, v96, v97
    v_lshlrev_b32 v96, 16, v104
    v_and_b32 v97, 0xffff0000, v104
    v_lshlrev_b32 v104, 16, v108
    v_and_b32 v105, 0xffff0000, v108
    v_add_f32 v96, v96, v104
    v_add_f32 v97, v97, v105
    v_cvt_pk_bf16_f32 v112, v96, v97
    v_cvt_pk_bf16_f32 v104, v98, v99
    v_lshlrev_b32 v98, 16, v104
    v_and_b32 v99, 0xffff0000, v104
    v_lshlrev_b32 v104, 16, v81
    v_and_b32 v105, 0xffff0000, v81
    v_mul_f32 v98, v98, v104
    v_mul_f32 v99, v99, v105
    v_cvt_pk_bf16_f32 v104, v98, v99
    v_lshlrev_b32 v98, 16, v104
    v_and_b32 v99, 0xffff0000, v104
    v_lshlrev_b32 v104, 16, v109
    v_and_b32 v105, 0xffff0000, v109
    v_add_f32 v98, v98, v104
    v_add_f32 v99, v99, v105
    v_cvt_pk_bf16_f32 v113, v98, v99
    v_cvt_pk_bf16_f32 v104, v100, v101
    v_lshlrev_b32 v100, 16, v104
    v_and_b32 v101, 0xffff0000, v104
    v_lshlrev_b32 v104, 16, v82
    v_and_b32 v105, 0xffff0000, v82
    v_mul_f32 v100, v100, v104
    v_mul_f32 v101, v101, v105
    v_cvt_pk_bf16_f32 v104, v100, v101
    v_lshlrev_b32 v100, 16, v104
    v_and_b32 v101, 0xffff0000, v104
    v_lshlrev_b32 v104, 16, v110
    v_and_b32 v105, 0xffff0000, v110
    v_add_f32 v100, v100, v104
    v_add_f32 v101, v101, v105
    v_cvt_pk_bf16_f32 v114, v100, v101
    v_cvt_pk_bf16_f32 v104, v102, v103
    v_lshlrev_b32 v102, 16, v104
    v_and_b32 v103, 0xffff0000, v104
    v_lshlrev_b32 v104, 16, v83
    v_and_b32 v105, 0xffff0000, v83
    v_mul_f32 v102, v102, v104
    v_mul_f32 v103, v103, v105
    v_cvt_pk_bf16_f32 v104, v102, v103
    v_lshlrev_b32 v102, 16, v104
    v_and_b32 v103, 0xffff0000, v104
    v_lshlrev_b32 v104, 16, v111
    v_and_b32 v105, 0xffff0000, v111
    v_add_f32 v102, v102, v104
    v_add_f32 v103, v103, v105
    v_cvt_pk_bf16_f32 v115, v102, v103
    v_cndmask_b32 v128, v112, v114, s[20:21]
    v_cndmask_b32 v129, v113, v115, s[20:21]
    v_cndmask_b32 v130, v114, v112, s[20:21]
    v_cndmask_b32 v131, v115, v113, s[20:21]
    buffer_store_dwordx4 v[128:131], v4, s[12:15], s18 offen offset:0
    v_lshlrev_b32 v96, 16, v48
    v_and_b32 v97, 0xffff0000, v48
    v_lshlrev_b32 v98, 16, v49
    v_and_b32 v99, 0xffff0000, v49
    v_lshlrev_b32 v100, 16, v50
    v_and_b32 v101, 0xffff0000, v50
    v_lshlrev_b32 v102, 16, v51
    v_and_b32 v103, 0xffff0000, v51
    v_lshlrev_b32 v120, 16, v52
    v_and_b32 v121, 0xffff0000, v52
    v_lshlrev_b32 v122, 16, v53
    v_and_b32 v123, 0xffff0000, v53
    v_lshlrev_b32 v124, 16, v54
    v_and_b32 v125, 0xffff0000, v54
    v_lshlrev_b32 v126, 16, v55
    v_and_b32 v127, 0xffff0000, v55
    v_add_f32 v96, v96, v120
    v_add_f32 v97, v97, v121
    v_add_f32 v98, v98, v122
    v_add_f32 v99, v99, v123
    v_add_f32 v100, v100, v124
    v_add_f32 v101, v101, v125
    v_add_f32 v102, v102, v126
    v_add_f32 v103, v103, v127
    v_lshlrev_b32 v120, 16, v56
    v_and_b32 v121, 0xffff0000, v56
    v_lshlrev_b32 v122, 16, v57
    v_and_b32 v123, 0xffff0000, v57
    v_lshlrev_b32 v124, 16, v58
    v_and_b32 v125, 0xffff0000, v58
    v_lshlrev_b32 v126, 16, v59
    v_and_b32 v127, 0xffff0000, v59
    v_add_f32 v96, v96, v120
    v_add_f32 v97, v97, v121
    v_add_f32 v98, v98, v122
    v_add_f32 v99, v99, v123
    v_add_f32 v100, v100, v124
    v_add_f32 v101, v101, v125
    v_add_f32 v102, v102, v126
    v_add_f32 v103, v103, v127
    v_lshlrev_b32 v120, 16, v60
    v_and_b32 v121, 0xffff0000, v60
    v_lshlrev_b32 v122, 16, v61
    v_and_b32 v123, 0xffff0000, v61
    v_lshlrev_b32 v124, 16, v62
    v_and_b32 v125, 0xffff0000, v62
    v_lshlrev_b32 v126, 16, v63
    v_and_b32 v127, 0xffff0000, v63
    v_add_f32 v96, v96, v120
    v_add_f32 v97, v97, v121
    v_add_f32 v98, v98, v122
    v_add_f32 v99, v99, v123
    v_add_f32 v100, v100, v124
    v_add_f32 v101, v101, v125
    v_add_f32 v102, v102, v126
    v_add_f32 v103, v103, v127
    v_lshlrev_b32 v120, 16, v64
    v_and_b32 v121, 0xffff0000, v64
    v_lshlrev_b32 v122, 16, v65
    v_and_b32 v123, 0xffff0000, v65
    v_lshlrev_b32 v124, 16, v66
    v_and_b32 v125, 0xffff0000, v66
    v_lshlrev_b32 v126, 16, v67
    v_and_b32 v127, 0xffff0000, v67
    v_add_f32 v96, v96, v120
    v_add_f32 v97, v97, v121
    v_add_f32 v98, v98, v122
    v_add_f32 v99, v99, v123
    v_add_f32 v100, v100, v124
    v_add_f32 v101, v101, v125
    v_add_f32 v102, v102, v126
    v_add_f32 v103, v103, v127
    v_lshlrev_b32 v120, 16, v68
    v_and_b32 v121, 0xffff0000, v68
    v_lshlrev_b32 v122, 16, v69
    v_and_b32 v123, 0xffff0000, v69
    v_lshlrev_b32 v124, 16, v70
    v_and_b32 v125, 0xffff0000, v70
    v_lshlrev_b32 v126, 16, v71
    v_and_b32 v127, 0xffff0000, v71
    v_add_f32 v96, v96, v120
    v_add_f32 v97, v97, v121
    v_add_f32 v98, v98, v122
    v_add_f32 v99, v99, v123
    v_add_f32 v100, v100, v124
    v_add_f32 v101, v101, v125
    v_add_f32 v102, v102, v126
    v_add_f32 v103, v103, v127
    v_lshlrev_b32 v120, 16, v72
    v_and_b32 v121, 0xffff0000, v72
    v_lshlrev_b32 v122, 16, v73
    v_and_b32 v123, 0xffff0000, v73
    v_lshlrev_b32 v124, 16, v74
    v_and_b32 v125, 0xffff0000, v74
    v_lshlrev_b32 v126, 16, v75
    v_and_b32 v127, 0xffff0000, v75
    v_add_f32 v96, v96, v120
    v_add_f32 v97, v97, v121
    v_add_f32 v98, v98, v122
    v_add_f32 v99, v99, v123
    v_add_f32 v100, v100, v124
    v_add_f32 v101, v101, v125
    v_add_f32 v102, v102, v126
    v_add_f32 v103, v103, v127
    v_lshlrev_b32 v120, 16, v76
    v_and_b32 v121, 0xffff0000, v76
    v_lshlrev_b32 v122, 16, v77
    v_and_b32 v123, 0xffff0000, v77
    v_lshlrev_b32 v124, 16, v78
    v_and_b32 v125, 0xffff0000, v78
    v_lshlrev_b32 v126, 16, v79
    v_and_b32 v127, 0xffff0000, v79
    v_add_f32 v96, v96, v120
    v_add_f32 v97, v97, v121
    v_add_f32 v98, v98, v122
    v_add_f32 v99, v99, v123
    v_add_f32 v100, v100, v124
    v_add_f32 v101, v101, v125
    v_add_f32 v102, v102, v126
    v_add_f32 v103, v103, v127
    v_cndmask_b32 v108, v92, v94, s[20:21]
    v_cndmask_b32 v109, v93, v95, s[20:21]
    v_cndmask_b32 v110, v94, v92, s[20:21]
    v_cndmask_b32 v111, v95, v93, s[20:21]
    v_cvt_pk_bf16_f32 v104, v96, v97
    v_lshlrev_b32 v96, 16, v104
    v_and_b32 v97, 0xffff0000, v104
    v_lshlrev_b32 v104, 16, v84
    v_and_b32 v105, 0xffff0000, v84
    v_mul_f32 v96, v96, v104
    v_mul_f32 v97, v97, v105
    v_cvt_pk_bf16_f32 v104, v96, v97
    v_lshlrev_b32 v96, 16, v104
    v_and_b32 v97, 0xffff0000, v104
    v_lshlrev_b32 v104, 16, v108
    v_and_b32 v105, 0xffff0000, v108
    v_add_f32 v96, v96, v104
    v_add_f32 v97, v97, v105
    v_cvt_pk_bf16_f32 v112, v96, v97
    v_cvt_pk_bf16_f32 v104, v98, v99
    v_lshlrev_b32 v98, 16, v104
    v_and_b32 v99, 0xffff0000, v104
    v_lshlrev_b32 v104, 16, v85
    v_and_b32 v105, 0xffff0000, v85
    v_mul_f32 v98, v98, v104
    v_mul_f32 v99, v99, v105
    v_cvt_pk_bf16_f32 v104, v98, v99
    v_lshlrev_b32 v98, 16, v104
    v_and_b32 v99, 0xffff0000, v104
    v_lshlrev_b32 v104, 16, v109
    v_and_b32 v105, 0xffff0000, v109
    v_add_f32 v98, v98, v104
    v_add_f32 v99, v99, v105
    v_cvt_pk_bf16_f32 v113, v98, v99
    v_cvt_pk_bf16_f32 v104, v100, v101
    v_lshlrev_b32 v100, 16, v104
    v_and_b32 v101, 0xffff0000, v104
    v_lshlrev_b32 v104, 16, v86
    v_and_b32 v105, 0xffff0000, v86
    v_mul_f32 v100, v100, v104
    v_mul_f32 v101, v101, v105
    v_cvt_pk_bf16_f32 v104, v100, v101
    v_lshlrev_b32 v100, 16, v104
    v_and_b32 v101, 0xffff0000, v104
    v_lshlrev_b32 v104, 16, v110
    v_and_b32 v105, 0xffff0000, v110
    v_add_f32 v100, v100, v104
    v_add_f32 v101, v101, v105
    v_cvt_pk_bf16_f32 v114, v100, v101
    v_cvt_pk_bf16_f32 v104, v102, v103
    v_lshlrev_b32 v102, 16, v104
    v_and_b32 v103, 0xffff0000, v104
    v_lshlrev_b32 v104, 16, v87
    v_and_b32 v105, 0xffff0000, v87
    v_mul_f32 v102, v102, v104
    v_mul_f32 v103, v103, v105
    v_cvt_pk_bf16_f32 v104, v102, v103
    v_lshlrev_b32 v102, 16, v104
    v_and_b32 v103, 0xffff0000, v104
    v_lshlrev_b32 v104, 16, v111
    v_and_b32 v105, 0xffff0000, v111
    v_add_f32 v102, v102, v104
    v_add_f32 v103, v103, v105
    v_cvt_pk_bf16_f32 v115, v102, v103
    v_cndmask_b32 v132, v112, v114, s[20:21]
    v_cndmask_b32 v133, v113, v115, s[20:21]
    v_cndmask_b32 v134, v114, v112, s[20:21]
    v_cndmask_b32 v135, v115, v113, s[20:21]
    buffer_store_dwordx4 v[132:135], v4, s[12:15], s18 offen offset:64
    s_add_u32 s24, s24, 32
    s_cmp_lt_u32 s24, 61
    s_cbranch_scc1 fin_job
    s_cmp_ge_u32 s63, 48
    s_cbranch_scc1 k_end
    s_lshr_b32 s24, s63, 4
    s_sub_u32 s24, 63, s24
    s_and_b32 s25, s63, 15
    s_lshl_b32 s25, s25, 2
    s_and_b32 s26, s3, 3
    s_add_u32 s25, s25, s26
    s_lshr_b32 s26, s25, 5
    s_and_b32 s25, s25, 31
    s_lshl_b32 s16, s24, 1
    s_add_u32 s16, s16, s26
    s_lshl_b32 s18, s16, 15
    s_lshl_b32 s17, s25, 10
    s_add_u32 s17, s17, s18
    s_lshl_b32 s19, s25, 6
    s_add_u32 s18, s18, s19
    s_add_u32 s22, s17, 167772160
    s_add_u32 s23, s17, 75497472
    s_mov_b32 s27, 218106816
    s_mov_b32 s30, 218112000
    s_mov_b32 s28, 65536
    v_and_b32 v8, 7, v1
    v_lshlrev_b32 v8, 22, v8
    s_cmp_lg_u32 s3, 0
    s_cbranch_scc1 ft_ok
ft_wd:
    buffer_load_dword v7, off, s[4:7], s27 sc1
    s_waitcnt vmcnt(0)
    v_readfirstlane_b32 s31, v7
    s_cmp_ge_u32 s31, 16
    s_cbranch_scc1 ft_ws
    s_sleep 127
    s_sub_u32 s28, s28, 1
    s_cbranch_scc0 ft_wd
    s_mov_b32 s28, 0
ft_ws:
    buffer_load_dword v7, v6, s[4:7], s30 offen sc1
    s_waitcnt vmcnt(0)
    v_cmp_gt_u32 vcc, 61, v7
    s_cbranch_vccz ft_ok
    s_sleep 12
    v_cmp_gt_u32 vcc, 59, v7
    s_cbranch_vccz ft_wsf
    s_sleep 64
    v_cmp_gt_u32 vcc, 56, v7
    s_cbranch_vccz ft_wsf
    s_sleep 127
    s_sleep 127
ft_wsf:
    s_sub_u32 s28, s28, 1
    s_cbranch_scc0 ft_ws
    s_mov_b32 s28, 0
ft_ok:
    s_barrier
    s_cmp_ge_u32 s3, 4
    s_cbranch_scc1 k_end
    buffer_load_dwordx4 v[88:91], v4, s[8:11], s18 offen
    buffer_load_dwordx4 v[144:147], v3, s[4:7], s22 offen offset:0 sc1
    s_add_u32 s22, s22, 4194304
    buffer_load_dwordx4 v[148:151], v3, s[4:7], s22 offen offset:0 sc1
    s_add_u32 s22, s22, 4194304
    buffer_load_dwordx4 v[152:155], v3, s[4:7], s22 offen offset:0 sc1
    s_add_u32 s22, s22, 4194304
    buffer_load_dwordx4 v[156:159], v3, s[4:7], s22 offen offset:0 sc1
    s_waitcnt vmcnt(0)
    v_lshlrev_b32 v96, 16, v144
    v_and_b32 v97, 0xffff0000, v144
    v_lshlrev_b32 v98, 16, v145
    v_and_b32 v99, 0xffff0000, v145
    v_lshlrev_b32 v100, 16, v146
    v_and_b32 v101, 0xffff0000, v146
    v_lshlrev_b32 v102, 16, v147
    v_and_b32 v103, 0xffff0000, v147
    v_lshlrev_b32 v120, 16, v148
    v_and_b32 v121, 0xffff0000, v148
    v_lshlrev_b32 v122, 16, v149
    v_and_b32 v123, 0xffff0000, v149
    v_lshlrev_b32 v124, 16, v150
    v_and_b32 v125, 0xffff0000, v150
    v_lshlrev_b32 v126, 16, v151
    v_and_b32 v127, 0xffff0000, v151
    v_add_f32 v96, v96, v120
    v_add_f32 v97, v97, v121
    v_add_f32 v98, v98, v122
    v_add_f32 v99, v99, v123
    v_add_f32 v100, v100, v124
    v_add_f32 v101, v101, v125
    v_add_f32 v102, v102, v126
    v_add_f32 v103, v103, v127
    v_lshlrev_b32 v120, 16, v152
    v_and_b32 v121, 0xffff0000, v152
    v_lshlrev_b32 v122, 16, v153
    v_and_b32 v123, 0xffff0000, v153
    v_lshlrev_b32 v124, 16, v154
    v_and_b32 v125, 0xffff0000, v154
    v_lshlrev_b32 v126, 16, v155
    v_and_b32 v127, 0xffff0000, v155
    v_add_f32 v96, v96, v120
    v_add_f32 v97, v97, v121
    v_add_f32 v98, v98, v122
    v_add_f32 v99, v99, v123
    v_add_f32 v100, v100, v124
    v_add_f32 v101, v101, v125
    v_add_f32 v102, v102, v126
    v_add_f32 v103, v103, v127
    v_lshlrev_b32 v120, 16, v156
    v_and_b32 v121, 0xffff0000, v156
    v_lshlrev_b32 v122, 16, v157
    v_and_b32 v123, 0xffff0000, v157
    v_lshlrev_b32 v124, 16, v158
    v_and_b32 v125, 0xffff0000, v158
    v_lshlrev_b32 v126, 16, v159
    v_and_b32 v127, 0xffff0000, v159
    v_add_f32 v96, v96, v120
    v_add_f32 v97, v97, v121
    v_add_f32 v98, v98, v122
    v_add_f32 v99, v99, v123
    v_add_f32 v100, v100, v124
    v_add_f32 v101, v101, v125
    v_add_f32 v102, v102, v126
    v_add_f32 v103, v103, v127
    v_cvt_pk_bf16_f32 v120, v96, v97
    v_cvt_pk_bf16_f32 v121, v98, v99
    v_cvt_pk_bf16_f32 v122, v100, v101
    v_cvt_pk_bf16_f32 v123, v102, v103
    v_lshlrev_b32 v96, 16, v120
    v_and_b32 v97, 0xffff0000, v120
    v_lshlrev_b32 v98, 16, v121
    v_and_b32 v99, 0xffff0000, v121
    v_lshlrev_b32 v100, 16, v122
    v_and_b32 v101, 0xffff0000, v122
    v_lshlrev_b32 v102, 16, v123
    v_and_b32 v103, 0xffff0000, v123
    v_mul_f32 v104, 0xbfb8aa3b, v96
    v_mul_f32 v105, 0xbfb8aa3b, v97
    v_mul_f32 v106, 0xbfb8aa3b, v98
    v_mul_f32 v107, 0xbfb8aa3b, v99
    v_mul_f32 v108, 0xbfb8aa3b, v100
    v_mul_f32 v109, 0xbfb8aa3b, v101
    v_mul_f32 v110, 0xbfb8aa3b, v102
    v_mul_f32 v111, 0xbfb8aa3b, v103
    v_exp_f32 v104, v104
    v_exp_f32 v105, v105
    v_exp_f32 v106, v106
    v_exp_f32 v107, v107
    v_exp_f32 v108, v108
    v_exp_f32 v109, v109
    v_exp_f32 v110, v110
    v_exp_f32 v111, v111
    v_add_f32 v104, 1.0, v104
    v_add_f32 v105, 1.0, v105
    v_add_f32 v106, 1.0, v106
    v_add_f32 v107, 1.0, v107
    v_add_f32 v108, 1.0, v108
    v_add_f32 v109, 1.0, v109
    v_add_f32 v110, 1.0, v110
    v_add_f32 v111, 1.0, v111
    v_rcp_f32 v104, v104
    v_rcp_f32 v105, v105
    v_rcp_f32 v106, v106
    v_rcp_f32 v107, v107
    v_rcp_f32 v108, v108
    v_rcp_f32 v109, v109
    v_rcp_f32 v110, v110
    v_rcp_f32 v111, v111
    v_mul_f32 v96, v96, v104
    v_mul_f32 v97, v97, v105
    v_mul_f32 v98, v98, v106
    v_mul_f32 v99, v99, v107
    v_mul_f32 v100, v100, v108
    v_mul_f32 v101, v101, v109
    v_mul_f32 v102, v102, v110
    v_mul_f32 v103, v103, v111
    v_cvt_pk_bf16_f32 v80, v96, v97
    v_cvt_pk_bf16_f32 v81, v98, v99
    v_cvt_pk_bf16_f32 v82, v100, v101
    v_cvt_pk_bf16_f32 v83, v102, v103
    s_cmp_eq_u32 s24, 63
    s_cbranch_scc1 ft_p63
ft_p:
    buffer_load_dword v7, v8, s[4:7], s23 offen offset:1020 sc1
    s_waitcnt vmcnt(0)
    v_cmp_eq_u32 vcc, -1, v7
    s_cbranch_vccz ft_l
    s_sleep 4
    s_sub_u32 s28, s28, 1
    s_cbranch_scc0 ft_p
    s_mov_b32 s28, 0
ft_l:
    s_mov_b32 s31, s23
    buffer_load_dwordx4 v[16:19], v3, s[4:7], s31 offen sc1
    s_add_u32 s31, s31, 4194304
    buffer_load_dwordx4 v[20:23], v3, s[4:7], s31 offen sc1
    s_add_u32 s31, s31, 4194304
    buffer_load_dwordx4 v[24:27], v3, s[4:7], s31 offen sc1
    s_add_u32 s31, s31, 4194304
    buffer_load_dwordx4 v[28:31], v3, s[4:7], s31 offen sc1
    s_add_u32 s31, s31, 4194304
    buffer_load_dwordx4 v[32:35], v3, s[4:7], s31 offen sc1
    s_add_u32 s31, s31, 4194304
    buffer_load_dwordx4 v[36:39], v3, s[4:7], s31 offen sc1
    s_add_u32 s31, s31, 4194304
    buffer_load_dwordx4 v[40:43], v3, s[4:7], s31 offen sc1
    s_add_u32 s31, s31, 4194304
    buffer_load_dwordx4 v[44:47], v3, s[4:7], s31 offen sc1
    s_waitcnt vmcnt(0)
    v_max3_u32 v7, v16, v17, v18
    v_max3_u32 v7, v7, v19, v20
    v_max3_u32 v7, v7, v21, v22
    v_max3_u32 v7, v7, v23, v24
    v_max3_u32 v7, v7, v25, v26
    v_max3_u32 v7, v7, v27, v28
    v_max3_u32 v7, v7, v29, v30
    v_max3_u32 v7, v7, v31, v32
    v_max3_u32 v7, v7, v33, v34
    v_max3_u32 v7, v7, v35, v36
    v_max3_u32 v7, v7, v37, v38
    v_max3_u32 v7, v7, v39, v40
    v_max3_u32 v7, v7, v41, v42
    v_max3_u32 v7, v7, v43, v44
    v_max3_u32 v7, v7, v45, v46
    v_max_u32 v7, v7, v47
    v_cmp_eq_u32 vcc, -1, v7
    s_cbranch_vccz ft_go
    s_sleep 2
    s_sub_u32 s28, s28, 1
    s_cbranch_scc0 ft_l
    s_branch ft_go
ft_p63:
    s_sub_u32 s31, s23, 65536
    buffer_load_dword v7, v8, s[4:7], s31 offen offset:1020 sc1
    s_waitcnt vmcnt(0)
    v_cmp_eq_u32 vcc, -1, v7
    s_cbranch_vccz ft_l
    s_sleep 4
    s_sub_u32 s28, s28, 1
    s_cbranch_scc0 ft_p63
    s_mov_b32 s28, 0
    s_branch ft_l
ft_go:
    v_lshlrev_b32 v96, 16, v16
    v_and_b32 v97, 0xffff0000, v16
    v_lshlrev_b32 v98, 16, v17
    v_and_b32 v99, 0xffff0000, v17
    v_lshlrev_b32 v100, 16, v18
    v_and_b32 v101, 0xffff0000, v18
    v_lshlrev_b32 v102, 16, v19
    v_and_b32 v103, 0xffff0000, v19
    v_lshlrev_b32 v120, 16, v20
    v_and_b32 v121, 0xffff0000, v20
    v_lshlrev_b32 v122, 16, v21
    v_and_b32 v123, 0xffff0000, v21
    v_lshlrev_b32 v124, 16, v22
    v_and_b32 v125, 0xffff0000, v22
    v_lshlrev_b32 v126, 16, v23
    v_and_b32 v127, 0xffff0000, v23
    v_add_f32 v96, v96, v120
    v_add_f32 v97, v97, v121
    v_add_f32 v98, v98, v122
    v_add_f32 v99, v99, v123
    v_add_f32 v100, v100, v124
    v_add_f32 v101, v101, v125
    v_add_f32 v102, v102, v126
    v_add_f32 v103, v103, v127
    v_lshlrev_b32 v120, 16, v24
    v_and_b32 v121, 0xffff0000, v24
    v_lshlrev_b32 v122, 16, v25
    v_and_b32 v123, 0xffff0000, v25
    v_lshlrev_b32 v124, 16, v26
    v_and_b32 v125, 0xffff0000, v26
    v_lshlrev_b32 v126, 16, v27
    v_and_b32 v127, 0xffff0000, v27
    v_add_f32 v96, v96, v120
    v_add_f32 v97, v97, v121
    v_add_f32 v98, v98, v122
    v_add_f32 v99, v99, v123
    v_add_f32 v100, v100, v124
    v_add_f32 v101, v101, v125
    v_add_f32 v102, v102, v126
    v_add_f32 v103, v103, v127
    v_lshlrev_b32 v120, 16, v28
    v_and_b32 v121, 0xffff0000, v28
    v_lshlrev_b32 v122, 16, v29
    v_and_b32 v123, 0xffff0000, v29
    v_lshlrev_b32 v124, 16, v30
    v_and_b32 v125, 0xffff0000, v30
    v_lshlrev_b32 v126, 16, v31
    v_and_b32 v127, 0xffff0000, v31
    v_add_f32 v96, v96, v120
    v_add_f32 v97, v97, v121
    v_add_f32 v98, v98, v122
    v_add_f32 v99, v99, v123
    v_add_f32 v100, v100, v124
    v_add_f32 v101, v101, v125
    v_add_f32 v102, v102, v126
    v_add_f32 v103, v103, v127
    v_lshlrev_b32 v120, 16, v32
    v_and_b32 v121, 0xffff0000, v32
    v_lshlrev_b32 v122, 16, v33
    v_and_b32 v123, 0xffff0000, v33
    v_lshlrev_b32 v124, 16, v34
    v_and_b32 v125, 0xffff0000, v34
    v_lshlrev_b32 v126, 16, v35
    v_and_b32 v127, 0xffff0000, v35
    v_add_f32 v96, v96, v120
    v_add_f32 v97, v97, v121
    v_add_f32 v98, v98, v122
    v_add_f32 v99, v99, v123
    v_add_f32 v100, v100, v124
    v_add_f32 v101, v101, v125
    v_add_f32 v102, v102, v126
    v_add_f32 v103, v103, v127
    v_lshlrev_b32 v120, 16, v36
    v_and_b32 v121, 0xffff0000, v36
    v_lshlrev_b32 v122, 16, v37
    v_and_b32 v123, 0xffff0000, v37
    v_lshlrev_b32 v124, 16, v38
    v_and_b32 v125, 0xffff0000, v38
    v_lshlrev_b32 v126, 16, v39
    v_and_b32 v127, 0xffff0000, v39
    v_add_f32 v96, v96, v120
    v_add_f32 v97, v97, v121
    v_add_f32 v98, v98, v122
    v_add_f32 v99, v99, v123
    v_add_f32 v100, v100, v124
    v_add_f32 v101, v101, v125
    v_add_f32 v102, v102, v126
    v_add_f32 v103, v103, v127
    v_lshlrev_b32 v120, 16, v40
    v_and_b32 v121, 0xffff0000, v40
    v_lshlrev_b32 v122, 16, v41
    v_and_b32 v123, 0xffff0000, v41
    v_lshlrev_b32 v124, 16, v42
    v_and_b32 v125, 0xffff0000, v42
    v_lshlrev_b32 v126, 16, v43
    v_and_b32 v127, 0xffff0000, v43
    v_add_f32 v96, v96, v120
    v_add_f32 v97, v97, v121
    v_add_f32 v98, v98, v122
    v_add_f32 v99, v99, v123
    v_add_f32 v100, v100, v124
    v_add_f32 v101, v101, v125
    v_add_f32 v102, v102, v126
    v_add_f32 v103, v103, v127
    v_lshlrev_b32 v120, 16, v44
    v_and_b32 v121, 0xffff0000, v44
    v_lshlrev_b32 v122, 16, v45
    v_and_b32 v123, 0xffff0000, v45
    v_lshlrev_b32 v124, 16, v46
    v_and_b32 v125, 0xffff0000, v46
    v_lshlrev_b32 v126, 16, v47
    v_and_b32 v127, 0xffff0000, v47
    v_add_f32 v96, v96, v120
    v_add_f32 v97, v97, v121
    v_add_f32 v98, v98, v122
    v_add_f32 v99, v99, v123
    v_add_f32 v100, v100, v124
    v_add_f32 v101, v101, v125
    v_add_f32 v102, v102, v126
    v_add_f32 v103, v103, v127
    v_cndmask_b32 v108, v88, v90, s[20:21]
    v_cndmask_b32 v109, v89, v91, s[20:21]
    v_cndmask_b32 v110, v90, v88, s[20:21]
    v_cndmask_b32 v111, v91, v89, s[20:21]
    v_cvt_pk_bf16_f32 v104, v96, v97
    v_lshlrev_b32 v96, 16, v104
    v_and_b32 v97, 0xffff0000, v104
    v_lshlrev_b32 v104, 16, v80
    v_and_b32 v105, 0xffff0000, v80
    v_mul_f32 v96, v96, v104
    v_mul_f32 v97, v97, v105
    v_cvt_pk_bf16_f32 v104, v96, v97
    v_lshlrev_b32 v96, 16, v104
    v_and_b32 v97, 0xffff0000, v104
    v_lshlrev_b32 v104, 16, v108
    v_and_b32 v105, 0xffff0000, v108
    v_add_f32 v96, v96, v104
    v_add_f32 v97, v97, v105
    v_cvt_pk_bf16_f32 v112, v96, v97
    v_cvt_pk_bf16_f32 v104, v98, v99
    v_lshlrev_b32 v98, 16, v104
    v_and_b32 v99, 0xffff0000, v104
    v_lshlrev_b32 v104, 16, v81
    v_and_b32 v105, 0xffff0000, v81
    v_mul_f32 v98, v98, v104
    v_mul_f32 v99, v99, v105
    v_cvt_pk_bf16_f32 v104, v98, v99
    v_lshlrev_b32 v98, 16, v104
    v_and_b32 v99, 0xffff0000, v104
    v_lshlrev_b32 v104, 16, v109
    v_and_b32 v105, 0xffff0000, v109
    v_add_f32 v98, v98, v104
    v_add_f32 v99, v99, v105
    v_cvt_pk_bf16_f32 v113, v98, v99
    v_cvt_pk_bf16_f32 v104, v100, v101
    v_lshlrev_b32 v100, 16, v104
    v_and_b32 v101, 0xffff0000, v104
    v_lshlrev_b32 v104, 16, v82
    v_and_b32 v105, 0xffff0000, v82
    v_mul_f32 v100, v100, v104
    v_mul_f32 v101, v101, v105
    v_cvt_pk_bf16_f32 v104, v100, v101
    v_lshlrev_b32 v100, 16, v104
    v_and_b32 v101, 0xffff0000, v104
    v_lshlrev_b32 v104, 16, v110
    v_and_b32 v105, 0xffff0000, v110
    v_add_f32 v100, v100, v104
    v_add_f32 v101, v101, v105
    v_cvt_pk_bf16_f32 v114, v100, v101
    v_cvt_pk_bf16_f32 v104, v102, v103
    v_lshlrev_b32 v102, 16, v104
    v_and_b32 v103, 0xffff0000, v104
    v_lshlrev_b32 v104, 16, v83
    v_and_b32 v105, 0xffff0000, v83
    v_mul_f32 v102, v102, v104
    v_mul_f32 v103, v103, v105
    v_cvt_pk_bf16_f32 v104, v102, v103
    v_lshlrev_b32 v102, 16, v104
    v_and_b32 v103, 0xffff0000, v104
    v_lshlrev_b32 v104, 16, v111
    v_and_b32 v105, 0xffff0000, v111
    v_add_f32 v102, v102, v104
    v_add_f32 v103, v103, v105
    v_cvt_pk_bf16_f32 v115, v102, v103
    v_cndmask_b32 v128, v112, v114, s[20:21]
    v_cndmask_b32 v129, v113, v115, s[20:21]
    v_cndmask_b32 v130, v114, v112, s[20:21]
    v_cndmask_b32 v131, v115, v113, s[20:21]
    buffer_store_dwordx4 v[128:131], v4, s[12:15], s18 offen offset:0
    s_branch k_end
chain_map:
    s_and_b32 s14, s12, 1
    s_lshl_b32 s13, s13, 1
    s_lshr_b32 s15, s12, 1
    s_add_u32 s12, s13, s14
    s_mov_b32 s13, s15
    s_lshl_b32 s2, s13, 3
    s_add_u32 s2, s2, s12
    s_lshr_b32 s14, s13, 2
    s_and_b32 s15, s13, 3
    s_mov_b32 s16, 0
    s_mov_b32 s17, 209715200
    s_mov_b32 s18, 209977344
    s_mov_b32 s19, 210239488
    s_mov_b32 s20, 210501632
    s_mov_b32 s26, 131072
    s_mov_b32 s68, 0
    s_getreg_b32 s29, hwreg(HW_REG_XCC_ID)
    s_and_b32 s29, s29, 15
    s_mul_i32 s23, s29, s29
    s_lshl_b32 s23, s23, 18
    s_lshl_b32 s29, s29, 8
    s_add_u32 s29, s29, s23
    s_add_u32 s29, s29, 1
    s_lshr_b32 s28, s12, 1
    s_lshl_b32 s28, s28, 2
    s_add_u32 s28, s28, 128
    s_cmp_ge_u32 s3, 4
    s_cbranch_scc1 ch_a_pro
    s_lshl_b32 s32, s12, 15
    s_lshl_b32 s21, s14, 13
    s_add_u32 s32, s32, s21
    s_lshl_b32 s21, s15, 10
    s_add_u32 s32, s32, s21
    s_add_u32 s32, s32, 2097152
    s_lshr_b32 s33, s12, 1
    s_lshl_b32 s33, s33, 14
    s_add_u32 s33, s33, 1048576
    s_lshl_b32 s21, s13, 10
    s_add_u32 s36, s33, s21
    s_lshl_b32 s21, s3, 12
    s_add_u32 s33, s33, s21
    s_lshl_b32 s34, s13, 14
    s_lshl_b32 s21, s12, 10
    s_add_u32 s35, s34, s21
    s_lshl_b32 s37, s12, 22
    s_lshl_b32 s21, s13, 11
    s_add_u32 s37, s37, s21
    s_and_b32 s21, s3, 1
    s_lshl_b32 s21, s21, 15
    s_add_u32 s37, s37, s21
    s_lshr_b32 s21, s3, 1
    s_lshl_b32 s21, s21, 10
    s_add_u32 s37, s37, s21
    s_add_u32 s37, s37, 75497472
    v_and_b32 v20, 63, v0
    v_lshlrev_b32 v1, 4, v20
    v_mov_b32 v10, -1
    v_mov_b32 v11, -1
    v_lshrrev_b32 v21, 2, v20
    v_and_b32 v22, 3, v20
    v_lshlrev_b32 v21, 13, v21
    v_lshl_add_u32 v21, v22, 4, v21
    s_lshl_b32 s21, s3, 21
    s_lshl_b32 s22, s12, 10
    s_add_u32 s21, s21, s22
    s_lshl_b32 s23, s3, 15
    s_mov_b32 s10, 8388608
    s_mov_b32 s11, 131072
    v_lshrrev_b32 v24, 4, v20
    v_bfe_u32 v25, v20, 2, 2
    v_lshl_add_u32 v24, v24, 4, v25
    v_lshlrev_b32 v24, 6, v24
    v_lshl_add_u32 v24, v22, 3, v24
    v_add_u32 v24, s23, v24
    s_and_b32 s70, s13, 1
    s_lshl_b32 s71, s12, 4
    s_add_u32 s71, s71, s13
    s_cmp_eq_u32 s71, 127
    s_cselect_b32 s70, 1, 0
    s_cmp_eq_u32 s13, 7
    s_cselect_b32 s70, 1, s70
    s_lshl_b32 s72, s70, 20
    s_lshl_b32 s73, s70, 21
    s_lshl_b32 s70, s70, 13
    s_sub_u32 s71, s23, s70
    s_add_u32 s70, s23, s70
    s_load_dwordx2 s[8:9], s[0:1], 16
    s_lshl_b32 s25, s13, 6
    s_add_u32 s24, s21, s25
    s_add_u32 s24, s24, s72
    s_waitcnt lgkmcnt(0)
    s_add_u32 m0, s70, 0
    s_nop 0
    buffer_load_dwordx4 v21, s[8:11], s24 offen lds
    s_add_u32 s24, s24, 131072
    s_add_u32 m0, s70, 1024
    s_nop 0
    buffer_load_dwordx4 v21, s[8:11], s24 offen lds
    s_add_u32 s24, s24, 131072
    s_add_u32 m0, s70, 2048
    s_nop 0
    buffer_load_dwordx4 v21, s[8:11], s24 offen lds
    s_add_u32 s24, s24, 131072
    s_add_u32 m0, s70, 3072
    s_nop 0
    buffer_load_dwordx4 v21, s[8:11], s24 offen lds
    s_add_u32 s24, s24, 131072
    s_add_u32 m0, s70, 4096
    s_nop 0
    buffer_load_dwordx4 v21, s[8:11], s24 offen lds
    s_add_u32 s24, s24, 131072
    s_add_u32 m0, s70, 5120
    s_nop 0
    buffer_load_dwordx4 v21, s[8:11], s24 offen lds
    s_add_u32 s24, s24, 131072
    s_add_u32 m0, s70, 6144
    s_nop 0
    buffer_load_dwordx4 v21, s[8:11], s24 offen lds
    s_add_u32 s24, s24, 131072
    s_add_u32 m0, s70, 7168
    s_nop 0
    buffer_load_dwordx4 v21, s[8:11], s24 offen lds
    s_add_u32 s24, s24, 131072
    s_sub_u32 s24, s24, s73
    s_add_u32 m0, s71, 8192
    s_nop 0
    buffer_load_dwordx4 v21, s[8:11], s24 offen lds
    s_add_u32 s24, s24, 131072
    s_add_u32 m0, s71, 9216
    s_nop 0
    buffer_load_dwordx4 v21, s[8:11], s24 offen lds
    s_add_u32 s24, s24, 131072
    s_add_u32 m0, s71, 10240
    s_nop 0
    buffer_load_dwordx4 v21, s[8:11], s24 offen lds
    s_add_u32 s24, s24, 131072
    s_add_u32 m0, s71, 11264
    s_nop 0
    buffer_load_dwordx4 v21, s[8:11], s24 offen lds
    s_add_u32 s24, s24, 131072
    s_add_u32 m0, s71, 12288
    s_nop 0
    buffer_load_dwordx4 v21, s[8:11], s24 offen lds
    s_add_u32 s24, s24, 131072
    s_add_u32 m0, s71, 13312
    s_nop 0
    buffer_load_dwordx4 v21, s[8:11], s24 offen lds
    s_add_u32 s24, s24, 131072
    s_add_u32 m0, s71, 14336
    s_nop 0
    buffer_load_dwordx4 v21, s[8:11], s24 offen lds
    s_add_u32 s24, s24, 131072
    s_add_u32 m0, s71, 15360
    s_nop 0
    buffer_load_dwordx4 v21, s[8:11], s24 offen lds
    s_add_u32 s24, s24, 131072
    s_load_dwordx2 s[8:9], s[0:1], 24
    s_lshl_b32 s25, s13, 6
    s_add_u32 s24, s21, s25
    s_add_u32 s24, s24, s72
    s_waitcnt lgkmcnt(0)
    s_add_u32 m0, s70, 16384
    s_nop 0
    buffer_load_dwordx4 v21, s[8:11], s24 offen lds
    s_add_u32 s24, s24, 131072
    s_add_u32 m0, s70, 17408
    s_nop 0
    buffer_load_dwordx4 v21, s[8:11], s24 offen lds
    s_add_u32 s24, s24, 131072
    s_add_u32 m0, s70, 18432
    s_nop 0
    buffer_load_dwordx4 v21, s[8:11], s24 offen lds
    s_add_u32 s24, s24, 131072
    s_add_u32 m0, s70, 19456
    s_nop 0
    buffer_load_dwordx4 v21, s[8:11], s24 offen lds
    s_add_u32 s24, s24, 131072
    s_add_u32 m0, s70, 20480
    s_nop 0
    buffer_load_dwordx4 v21, s[8:11], s24 offen lds
    s_add_u32 s24, s24, 131072
    s_add_u32 m0, s70, 21504
    s_nop 0
    buffer_load_dwordx4 v21, s[8:11], s24 offen lds
    s_add_u32 s24, s24, 131072
    s_add_u32 m0, s70, 22528
    s_nop 0
    buffer_load_dwordx4 v21, s[8:11], s24 offen lds
    s_add_u32 s24, s24, 131072
    s_add_u32 m0, s70, 23552
    s_nop 0
    buffer_load_dwordx4 v21, s[8:11], s24 offen lds
    s_add_u32 s24, s24, 131072
    s_sub_u32 s24, s24, s73
    s_add_u32 m0, s71, 24576
    s_nop 0
    buffer_load_dwordx4 v21, s[8:11], s24 offen lds
    s_add_u32 s24, s24, 131072
    s_add_u32 m0, s71, 25600
    s_nop 0
    buffer_load_dwordx4 v21, s[8:11], s24 offen lds
    s_add_u32 s24, s24, 131072
    s_add_u32 m0, s71, 26624
    s_nop 0
    buffer_load_dwordx4 v21, s[8:11], s24 offen lds
    s_add_u32 s24, s24, 131072
    s_add_u32 m0, s71, 27648
    s_nop 0
    buffer_load_dwordx4 v21, s[8:11], s24 offen lds
    s_add_u32 s24, s24, 131072
    s_add_u32 m0, s71, 28672
    s_nop 0
    buffer_load_dwordx4 v21, s[8:11], s24 offen lds
    s_add_u32 s24, s24, 131072
    s_add_u32 m0, s71, 29696
    s_nop 0
    buffer_load_dwordx4 v21, s[8:11], s24 offen lds
    s_add_u32 s24, s24, 131072
    s_add_u32 m0, s71, 30720
    s_nop 0
    buffer_load_dwordx4 v21, s[8:11], s24 offen lds
    s_add_u32 s24, s24, 131072
    s_add_u32 m0, s71, 31744
    s_nop 0
    buffer_load_dwordx4 v21, s[8:11], s24 offen lds
    s_add_u32 s24, s24, 131072
    s_load_dwordx2 s[8:9], s[0:1], 32
    s_lshl_b32 s25, s13, 6
    s_add_u32 s24, s21, s25
    s_add_u32 s24, s24, s72
    s_waitcnt lgkmcnt(0)
    buffer_load_dwordx4 v[96:99], v21, s[8:11], s24 offen
    s_add_u32 s24, s24, 131072
    buffer_load_dwordx4 v[100:103], v21, s[8:11], s24 offen
    s_add_u32 s24, s24, 131072
    buffer_load_dwordx4 v[104:107], v21, s[8:11], s24 offen
    s_add_u32 s24, s24, 131072
    buffer_load_dwordx4 v[108:111], v21, s[8:11], s24 offen
    s_add_u32 s24, s24, 131072
    buffer_load_dwordx4 v[144:147], v21, s[8:11], s24 offen
    s_add_u32 s24, s24, 131072
    buffer_load_dwordx4 v[148:151], v21, s[8:11], s24 offen
    s_add_u32 s24, s24, 131072
    buffer_load_dwordx4 v[152:155], v21, s[8:11], s24 offen
    s_add_u32 s24, s24, 131072
    buffer_load_dwordx4 v[156:159], v21, s[8:11], s24 offen
    s_add_u32 s24, s24, 131072
    s_sub_u32 s24, s24, s73
    buffer_load_dwordx4 v[192:195], v21, s[8:11], s24 offen
    s_add_u32 s24, s24, 131072
    buffer_load_dwordx4 v[196:199], v21, s[8:11], s24 offen
    s_add_u32 s24, s24, 131072
    buffer_load_dwordx4 v[200:203], v21, s[8:11], s24 offen
    s_add_u32 s24, s24, 131072
    buffer_load_dwordx4 v[204:207], v21, s[8:11], s24 offen
    s_add_u32 s24, s24, 131072
    buffer_load_dwordx4 v[240:243], v21, s[8:11], s24 offen
    s_add_u32 s24, s24, 131072
    buffer_load_dwordx4 v[244:247], v21, s[8:11], s24 offen
    s_add_u32 s24, s24, 131072
    buffer_load_dwordx4 v[248:251], v21, s[8:11], s24 offen
    s_add_u32 s24, s24, 131072
    buffer_load_dwordx4 v[252:255], v21, s[8:11], s24 offen
    s_add_u32 s24, s24, 131072
    s_load_dwordx2 s[8:9], s[0:1], 8
    s_mov_b32 s10, 16384
    v_bfe_u32 v57, v20, 4, 1
    v_lshrrev_b32 v58, 5, v20
    v_and_b32 v59, 1, v20
    v_bfe_u32 v60, v20, 1, 3
    v_lshlrev_b32 v60, 11, v60
    v_lshl_add_u32 v60, v57, 6, v60
    v_lshl_add_u32 v60, v58, 4, v60
    v_lshl_add_u32 v15, v59, 2, v60
    s_lshl_b32 s24, s3, 9
    s_waitcnt lgkmcnt(0)
    buffer_load_dword v32, v15, s[8:11], s24 offen offset:0
    buffer_load_dword v33, v15, s[8:11], s24 offen offset:8
    buffer_load_dword v34, v15, s[8:11], s24 offen offset:32
    buffer_load_dword v35, v15, s[8:11], s24 offen offset:40
    buffer_load_dword v36, v15, s[8:11], s24 offen offset:128
    buffer_load_dword v37, v15, s[8:11], s24 offen offset:136
    buffer_load_dword v38, v15, s[8:11], s24 offen offset:160
    buffer_load_dword v39, v15, s[8:11], s24 offen offset:168
    buffer_load_dword v40, v15, s[8:11], s24 offen offset:256
    buffer_load_dword v41, v15, s[8:11], s24 offen offset:264
    buffer_load_dword v42, v15, s[8:11], s24 offen offset:288
    buffer_load_dword v43, v15, s[8:11], s24 offen offset:296
    buffer_load_dword v44, v15, s[8:11], s24 offen offset:384
    buffer_load_dword v45, v15, s[8:11], s24 offen offset:392
    buffer_load_dword v46, v15, s[8:11], s24 offen offset:416
    buffer_load_dword v47, v15, s[8:11], s24 offen offset:424
    s_barrier
    v_add_u32 v56, s70, v1
    s_add_u32 s71, s71, 8192
    v_add_u32 v26, s71, v1
    s_waitcnt vmcnt(48)
    ds_read_b64_tr_b16 v[64:65], v24 offset:0
    ds_read_b64_tr_b16 v[66:67], v24 offset:256
    ds_read_b64_tr_b16 v[68:69], v24 offset:512
    ds_read_b64_tr_b16 v[70:71], v24 offset:768
    ds_read_b64_tr_b16 v[72:73], v24 offset:32
    ds_read_b64_tr_b16 v[74:75], v24 offset:288
    ds_read_b64_tr_b16 v[76:77], v24 offset:544
    ds_read_b64_tr_b16 v[78:79], v24 offset:800
    s_waitcnt lgkmcnt(0)
    ds_read_b64_tr_b16 v[112:113], v24 offset:4096
    ds_read_b64_tr_b16 v[114:115], v24 offset:4352
    ds_read_b64_tr_b16 v[116:117], v24 offset:4608
    ds_read_b64_tr_b16 v[118:119], v24 offset:4864
    ds_read_b64_tr_b16 v[120:121], v24 offset:4128
    ds_read_b64_tr_b16 v[122:123], v24 offset:4384
    ds_read_b64_tr_b16 v[124:125], v24 offset:4640
    ds_read_b64_tr_b16 v[126:127], v24 offset:4896
    s_waitcnt lgkmcnt(0)
    ds_read_b64_tr_b16 v[160:161], v24 offset:8192
    ds_read_b64_tr_b16 v[162:163], v24 offset:8448
    ds_read_b64_tr_b16 v[164:165], v24 offset:8704
    ds_read_b64_tr_b16 v[166:167], v24 offset:8960
    ds_read_b64_tr_b16 v[168:169], v24 offset:8224
    ds_read_b64_tr_b16 v[170:171], v24 offset:8480
    ds_read_b64_tr_b16 v[172:173], v24 offset:8736
    ds_read_b64_tr_b16 v[174:175], v24 offset:8992
    s_waitcnt lgkmcnt(0)
    ds_read_b64_tr_b16 v[208:209], v24 offset:12288
    ds_read_b64_tr_b16 v[210:211], v24 offset:12544
    ds_read_b64_tr_b16 v[212:213], v24 offset:12800
    ds_read_b64_tr_b16 v[214:215], v24 offset:13056
    ds_read_b64_tr_b16 v[216:217], v24 offset:12320
    ds_read_b64_tr_b16 v[218:219], v24 offset:12576
    ds_read_b64_tr_b16 v[220:221], v24 offset:12832
    ds_read_b64_tr_b16 v[222:223], v24 offset:13088
    s_waitcnt lgkmcnt(0)
    s_waitcnt vmcnt(32)
    ds_read_b64_tr_b16 v[80:81], v24 offset:16384
    ds_read_b64_tr_b16 v[82:83], v24 offset:16640
    ds_read_b64_tr_b16 v[84:85], v24 offset:16896
    ds_read_b64_tr_b16 v[86:87], v24 offset:17152
    ds_read_b64_tr_b16 v[88:89], v24 offset:16416
    ds_read_b64_tr_b16 v[90:91], v24 offset:16672
    ds_read_b64_tr_b16 v[92:93], v24 offset:16928
    ds_read_b64_tr_b16 v[94:95], v24 offset:17184
    s_waitcnt lgkmcnt(0)
    ds_read_b64_tr_b16 v[128:129], v24 offset:20480
    ds_read_b64_tr_b16 v[130:131], v24 offset:20736
    ds_read_b64_tr_b16 v[132:133], v24 offset:20992
    ds_read_b64_tr_b16 v[134:135], v24 offset:21248
    ds_read_b64_tr_b16 v[136:137], v24 offset:20512
    ds_read_b64_tr_b16 v[138:139], v24 offset:20768
    ds_read_b64_tr_b16 v[140:141], v24 offset:21024
    ds_read_b64_tr_b16 v[142:143], v24 offset:21280
    s_waitcnt lgkmcnt(0)
    ds_read_b64_tr_b16 v[176:177], v24 offset:24576
    ds_read_b64_tr_b16 v[178:179], v24 offset:24832
    ds_read_b64_tr_b16 v[180:181], v24 offset:25088
    ds_read_b64_tr_b16 v[182:183], v24 offset:25344
    ds_read_b64_tr_b16 v[184:185], v24 offset:24608
    ds_read_b64_tr_b16 v[186:187], v24 offset:24864
    ds_read_b64_tr_b16 v[188:189], v24 offset:25120
    ds_read_b64_tr_b16 v[190:191], v24 offset:25376
    s_waitcnt lgkmcnt(0)
    ds_read_b64_tr_b16 v[224:225], v24 offset:28672
    ds_read_b64_tr_b16 v[226:227], v24 offset:28928
    ds_read_b64_tr_b16 v[228:229], v24 offset:29184
    ds_read_b64_tr_b16 v[230:231], v24 offset:29440
    ds_read_b64_tr_b16 v[232:233], v24 offset:28704
    ds_read_b64_tr_b16 v[234:235], v24 offset:28960
    ds_read_b64_tr_b16 v[236:237], v24 offset:29216
    ds_read_b64_tr_b16 v[238:239], v24 offset:29472
    s_waitcnt lgkmcnt(0)
    s_waitcnt vmcnt(16)
    ds_write_b128 v56, v[96:99] offset:0
    ds_write_b128 v56, v[100:103] offset:1024
    ds_write_b128 v56, v[104:107] offset:2048
    ds_write_b128 v56, v[108:111] offset:3072
    ds_write_b128 v56, v[144:147] offset:4096
    ds_write_b128 v56, v[148:151] offset:5120
    ds_write_b128 v56, v[152:155] offset:6144
    ds_write_b128 v56, v[156:159] offset:7168
    ds_write_b128 v26, v[192:195] offset:0
    ds_write_b128 v26, v[196:199] offset:1024
    ds_write_b128 v26, v[200:203] offset:2048
    ds_write_b128 v26, v[204:207] offset:3072
    ds_write_b128 v26, v[240:243] offset:4096
    ds_write_b128 v26, v[244:247] offset:5120
    ds_write_b128 v26, v[248:251] offset:6144
    ds_write_b128 v26, v[252:255] offset:7168
    s_waitcnt lgkmcnt(0)
    ds_read_b64_tr_b16 v[96:97], v24 offset:0
    ds_read_b64_tr_b16 v[98:99], v24 offset:256
    ds_read_b64_tr_b16 v[100:101], v24 offset:512
    ds_read_b64_tr_b16 v[102:103], v24 offset:768
    ds_read_b64_tr_b16 v[104:105], v24 offset:32
    ds_read_b64_tr_b16 v[106:107], v24 offset:288
    ds_read_b64_tr_b16 v[108:109], v24 offset:544
    ds_read_b64_tr_b16 v[110:111], v24 offset:800
    s_waitcnt lgkmcnt(0)
    ds_read_b64_tr_b16 v[144:145], v24 offset:4096
    ds_read_b64_tr_b16 v[146:147], v24 offset:4352
    ds_read_b64_tr_b16 v[148:149], v24 offset:4608
    ds_read_b64_tr_b16 v[150:151], v24 offset:4864
    ds_read_b64_tr_b16 v[152:153], v24 offset:4128
    ds_read_b64_tr_b16 v[154:155], v24 offset:4384
    ds_read_b64_tr_b16 v[156:157], v24 offset:4640
    ds_read_b64_tr_b16 v[158:159], v24 offset:4896
    s_waitcnt lgkmcnt(0)
    ds_read_b64_tr_b16 v[192:193], v24 offset:8192
    ds_read_b64_tr_b16 v[194:195], v24 offset:8448
    ds_read_b64_tr_b16 v[196:197], v24 offset:8704
    ds_read_b64_tr_b16 v[198:199], v24 offset:8960
    ds_read_b64_tr_b16 v[200:201], v24 offset:8224
    ds_read_b64_tr_b16 v[202:203], v24 offset:8480
    ds_read_b64_tr_b16 v[204:205], v24 offset:8736
    ds_read_b64_tr_b16 v[206:207], v24 offset:8992
    s_waitcnt lgkmcnt(0)
    ds_read_b64_tr_b16 v[240:241], v24 offset:12288
    ds_read_b64_tr_b16 v[242:243], v24 offset:12544
    ds_read_b64_tr_b16 v[244:245], v24 offset:12800
    ds_read_b64_tr_b16 v[246:247], v24 offset:13056
    ds_read_b64_tr_b16 v[248:249], v24 offset:12320
    ds_read_b64_tr_b16 v[250:251], v24 offset:12576
    ds_read_b64_tr_b16 v[252:253], v24 offset:12832
    ds_read_b64_tr_b16 v[254:255], v24 offset:13088
    s_waitcnt lgkmcnt(0)
    v_mov_b32 v21, 0x44444444
    v_mov_b32 v22, 0xeeeeeeee
    v_and_b32 v23, 1, v20
    v_cmp_eq_u32 vcc, 0, v23
    v_and_b32 v27, 255, v0
    v_lshlrev_b32 v2, 2, v27
    v_cndmask_b32 v62, v22, v21, vcc
    s_lshr_b32 s21, s15, 1
    s_sub_u32 s21, s21, s15
    s_add_u32 s21, s21, 4
    s_lshl_b32 s21, s21, 10
    s_and_b32 s22, s15, 1
    s_lshl_b32 s22, s22, 9
    s_add_u32 s21, s21, s22
    s_mov_b32 s28, s21
    s_and_b32 s62, s12, 1
    s_lshl_b32 s62, s62, 9
    s_add_u32 s62, s62, s36
    s_sub_u32 s62, s62, 512
    s_lshl_b32 s22, s3, 7
    s_add_u32 s21, s21, s22
    v_and_b32 v21, 31, v20
    v_lshlrev_b32 v21, 2, v21
    v_add_u32 v3, s21, v21
    v_lshrrev_b32 v21, 4, v20
    v_and_b32 v22, 15, v20
    v_mul_u32_u24 v21, 208, v21
    v_add_lshl_u32 v21, v21, v22, 2
    s_mul_i32 s21, s3, 3328
    v_add_u32 v4, s21, v21
    v_lshrrev_b32 v21, 4, v20
    v_bfe_u32 v22, v20, 2, 1
    v_lshl_add_u32 v21, v21, 1, v22
    v_mul_u32_u24 v21, 104, v21
    v_bfe_u32 v22, v20, 3, 1
    v_xor_b32 v22, 1, v22
    v_lshl_add_u32 v21, v22, 5, v21
    v_and_b32 v22, 3, v20
    v_lshlrev_b32 v22, 1, v22
    s_and_b32 s21, s3, 1
    s_lshl_b32 s21, s21, 2
    v_xor_b32 v22, s21, v22
    v_add_u32 v21, v21, v22
    s_lshl_b32 s21, s3, 3
    v_add_u32 v21, s21, v21
    v_lshlrev_b32 v5, 2, v21
    s_and_b32 s21, s3, 1
    s_lshl_b32 s21, s21, 2
    v_bfe_u32 v21, v20, 3, 2
    v_add_u32 v21, s21, v21
    v_mul_u32_u24 v21, 104, v21
    v_bfe_u32 v22, v20, 1, 1
    v_lshl_add_u32 v21, v22, 3, v21
    v_and_b32 v23, 1, v20
    v_xor_b32 v22, v22, v23
    v_lshl_add_u32 v21, v22, 2, v21
    v_bfe_u32 v22, v20, 2, 1
    v_lshl_add_u32 v21, v22, 1, v21
    s_lshr_b32 s21, s3, 1
    s_lshl_b32 s21, s21, 4
    s_add_u32 s21, s21, 64
    v_add_u32 v21, s21, v21
    v_lshlrev_b32 v6, 2, v21
    v_lshrrev_b32 v21, 6, v27
    v_bfe_u32 v22, v27, 1, 1
    v_lshrrev_b32 v23, 1, v21
    v_lshl_add_u32 v22, v22, 1, v23
    v_xor_b32 v23, v27, v22
    v_and_b32 v23, 1, v23
    v_and_b32 v21, 1, v21
    v_lshl_add_u32 v21, v21, 1, v23
    v_mul_u32_u24 v21, 544, v21
    v_lshl_add_u32 v21, v22, 5, v21
    v_bfe_u32 v23, v27, 4, 2
    v_mul_u32_u24 v23, 136, v23
    v_add_u32 v21, v21, v23
    v_bfe_u32 v24, v27, 3, 1
    v_lshl_add_u32 v21, v24, 2, v21
    v_bfe_u32 v24, v27, 2, 1
    v_lshl_add_u32 v21, v24, 4, v21
    v_add_u32 v7, 16384, v21
    v_lshlrev_b32 v8, 2, v20
    s_and_b32 s21, s12, 1
    s_lshl_b32 s21, s21, 9
    s_lshl_b32 s22, s3, 7
    s_add_u32 s21, s21, s22
    v_and_b32 v21, 7, v20
    v_lshlrev_b32 v21, 4, v21
    v_add_u32 v21, s21, v21
    v_lshrrev_b32 v22, 3, v20
    v_lshl_add_u32 v12, v22, 10, v21
    v_bfe_u32 v22, v20, 4, 1
    v_lshl_add_u32 v13, v22, 3, v21
    s_and_b32 s21, s3, 1
    s_lshl_b32 s21, s21, 12
    s_lshr_b32 s22, s3, 1
    s_lshl_b32 s22, s22, 11
    s_add_u32 s21, s21, s22
    s_add_u32 s21, s21, 18560
    v_add_u32 v61, s21, v1
    s_lshl_b32 s21, s3, 2
    s_add_u32 s21, s21, 13312
    v_mov_b32 v14, s21
    v_and_b32 v21, 15, v20
    v_and_b32 v22, 1, v20
    v_lshlrev_b32 v22, 4, v22
    v_mov_b32 v23, 0x3f80
    v_lshlrev_b32 v22, v22, v23
    v_lshrrev_b32 v21, 1, v21
    v_cmp_eq_u32 vcc, 0, v21
    s_nop 1
    v_cndmask_b32 v56, 0, v22, vcc
    v_cmp_eq_u32 vcc, 1, v21
    s_nop 1
    v_cndmask_b32 v57, 0, v22, vcc
    v_cmp_eq_u32 vcc, 2, v21
    s_nop 1
    v_cndmask_b32 v58, 0, v22, vcc
    v_cmp_eq_u32 vcc, 3, v21
    s_nop 1
    v_cndmask_b32 v59, 0, v22, vcc
    v_and_b32 v21, 7, v20
    v_lshlrev_b32 v21, 7, v21
    v_bfe_u32 v22, v20, 3, 1
    v_lshl_add_u32 v21, v22, 17, v21
    s_lshl_b32 s21, s12, 14
    s_lshl_b32 s22, s13, 10
    s_add_u32 s21, s21, s22
    s_add_u32 s21, s21, 4718592
    v_lshrrev_b32 v22, 4, v20
    v_lshl_add_u32 v21, v22, 24, v21
    v_add_u32 v63, s21, v21
    s_mov_b32 s47, 0x3e0293ee
    s_lshl_b32 s14, s12, 2
    s_add_u32 s14, s14, s3
    s_lshl_b32 s61, s14, 13
    s_add_u32 s61, s61, 2097152
    s_lshl_b32 s14, s14, 12
    s_and_b32 s22, s13, 1
    s_lshl_b32 s69, s22, 17
    s_add_u32 s69, s69, s14
    s_add_u32 s69, s69, 4194304
    s_add_u32 s52, s14, 20971520
    s_lshl_b32 s21, s22, 11
    s_add_u32 s14, s14, s21
    s_add_u32 s14, s14, 1179648
    s_lshr_b32 s21, s13, 1
    s_sub_u32 s21, s21, 0
    s_cmp_eq_u32 s21, s3
    s_cselect_b32 s15, 1, 0
    s_add_u32 s8, s21, 2
    s_and_b32 s8, s8, 3
    s_add_u32 s23, s3, 3
    s_and_b32 s23, s23, 3
    s_cmp_eq_u32 s21, s23
    s_cselect_b32 s31, 1, 0
    s_and_b32 s24, s23, 1
    s_and_b32 s25, s3, 1
    s_sub_i32 s24, s24, s25
    s_lshr_b32 s23, s23, 1
    s_lshr_b32 s25, s3, 1
    s_sub_i32 s23, s23, s25
    s_mul_i32 s46, s24, 4096
    s_mul_i32 s25, s23, 2048
    s_add_i32 s46, s46, s25
    s_mul_i32 s27, s24, 32768
    s_mul_i32 s25, s23, 1024
    s_add_i32 s27, s27, s25
    v_lshrrev_b32 v21, 4, v20
    v_and_b32 v23, 15, v20
    v_lshlrev_b32 v21, 2, v21
    v_add_u32 v24, 0, v21
    v_cmp_gt_u32 vcc, v24, v23
    s_cmp_eq_u32 s22, 0
    s_cselect_b64 s[38:39], vcc, 0
    s_cselect_b64 s[48:49], -1, vcc
    v_add_u32 v24, 1, v21
    v_cmp_gt_u32 vcc, v24, v23
    s_cmp_eq_u32 s22, 0
    s_cselect_b64 s[40:41], vcc, 0
    s_cselect_b64 s[50:51], -1, vcc
    v_add_u32 v24, 2, v21
    v_cmp_gt_u32 vcc, v24, v23
    s_cmp_eq_u32 s22, 0
    s_cselect_b64 s[42:43], vcc, 0
    s_cselect_b64 s[54:55], -1, vcc
    v_add_u32 v24, 3, v21
    v_cmp_gt_u32 vcc, v24, v23
    s_cmp_eq_u32 s22, 0
    s_cselect_b64 s[44:45], vcc, 0
    s_cselect_b64 s[56:57], -1, vcc
    s_waitcnt vmcnt(0)
    v_mov_b32 v16, v32
    v_mov_b32 v17, v33
    v_mov_b32 v18, v34
    v_mov_b32 v19, v35
    v_mov_b32 v20, v36
    v_mov_b32 v21, v37
    v_mov_b32 v22, v38
    v_mov_b32 v23, v39
    v_mov_b32 v24, v40
    v_mov_b32 v25, v41
    v_mov_b32 v26, v42
    v_mov_b32 v27, v43
    v_mov_b32 v28, v44
    v_mov_b32 v29, v45
    v_mov_b32 v30, v46
    v_mov_b32 v31, v47
    v_mov_b32 v32, -1
    v_mov_b32 v33, -1
    v_mov_b32 v34, -1
    v_mov_b32 v35, -1
    s_add_u32 s21, s37, 3997696
    buffer_store_dwordx4 v[32:35], v1, s[4:7], s21 offen sc1
    s_add_u32 s21, s37, 4063232
    buffer_store_dwordx4 v[32:35], v1, s[4:7], s21 offen sc1
    s_add_u32 s21, s37, 4128768
    buffer_store_dwordx4 v[32:35], v1, s[4:7], s21 offen sc1
    s_lshl_b32 s29, s29, 5
    s_barrier
    ds_write_b32 v14, v10
    ds_write_b32 v14, v10 offset:16
    ds_write_b32 v14, v10 offset:32
    s_lshl_b32 s53, s3, 13
    s_add_u32 s53, s53, 92160
    v_add_u32 v32, 14336, v1
    ds_write_b128 v32, v[56:59]
    s_lshl_b32 s60, s12, 4
    s_add_u32 s60, s60, 218104320
    v_mov_b32 v15, 0
    s_add_u32 s25, s16, 0
    s_min_u32 s25, s25, 63
    s_cmp_lt_u32 s25, 8
    s_cselect_b32 s59, 12, 24
    s_cselect_b32 s58, -4, -8
    s_and_b32 s25, s25, s58
    s_lshl_b32 s25, s25, 5
    s_add_u32 s58, s25, s60
    v_mov_b32 v32, 131072
    s_waitcnt vmcnt(0) lgkmcnt(0)
    s_barrier
    ds_read_b64 v[32:33], v32
    s_waitcnt lgkmcnt(0)
    v_cmp_ne_u32 vcc, s29, v32
    s_setprio 3
    v_readfirstlane_b32 s63, v33
    s_add_u32 s35, s35, s63
    s_add_u32 s34, s34, s63
    s_cbranch_vccnz ch_p_slow
    v_mov_b32 v32, 0
    v_mov_b32 v33, 0
    v_mov_b32 v34, 0
    v_mov_b32 v35, 0
    v_mov_b32 v36, 0
    v_mov_b32 v37, 0
    v_mov_b32 v38, 0
    v_mov_b32 v39, 0
    v_mov_b32 v40, 0
    v_mov_b32 v41, 0
    v_mov_b32 v42, 0
    v_mov_b32 v43, 0
    v_mov_b32 v44, 0
    v_mov_b32 v45, 0
    v_mov_b32 v46, 0
    v_mov_b32 v47, 0
    v_mov_b32 v48, 0
    v_mov_b32 v49, 0
    v_mov_b32 v50, 0
    v_mov_b32 v51, 0
    v_mov_b32 v52, 0
    v_mov_b32 v53, 0
    v_mov_b32 v54, 0
    v_mov_b32 v55, 0
    v_mov_b32 v0, 1.0
    s_mov_b32 exec_lo, 0xff00ff00
    s_mov_b32 exec_hi, 0xff00ff00
    v_mov_b32 v0, s47
    s_mov_b64 exec, -1
    v_mov_b32 v60, s16
    v_smfmac_f32_16x16x64_bf16 v[32:35], v[16:19], v[64:71], v62
    v_smfmac_f32_16x16x64_bf16 v[36:39], v[16:19], v[72:79], v62
    v_smfmac_f32_16x16x64_bf16 v[40:43], v[16:19], v[80:87], v62
    v_smfmac_f32_16x16x64_bf16 v[44:47], v[16:19], v[88:95], v62
    v_smfmac_f32_16x16x64_bf16 v[48:51], v[16:19], v[96:103], v62
    v_smfmac_f32_16x16x64_bf16 v[52:55], v[16:19], v[104:111], v62
    v_smfmac_f32_16x16x64_bf16 v[32:35], v[20:23], v[112:119], v62
    v_smfmac_f32_16x16x64_bf16 v[36:39], v[20:23], v[120:127], v62
    v_smfmac_f32_16x16x64_bf16 v[40:43], v[20:23], v[128:135], v62
    v_smfmac_f32_16x16x64_bf16 v[44:47], v[20:23], v[136:143], v62
    v_smfmac_f32_16x16x64_bf16 v[48:51], v[20:23], v[144:151], v62
    v_smfmac_f32_16x16x64_bf16 v[52:55], v[20:23], v[152:159], v62
    v_smfmac_f32_16x16x64_bf16 v[32:35], v[24:27], v[160:167], v62
    v_smfmac_f32_16x16x64_bf16 v[36:39], v[24:27], v[168:175], v62
    v_smfmac_f32_16x16x64_bf16 v[40:43], v[24:27], v[176:183], v62
    v_smfmac_f32_16x16x64_bf16 v[44:47], v[24:27], v[184:191], v62
    v_smfmac_f32_16x16x64_bf16 v[48:51], v[24:27], v[192:199], v62
    v_smfmac_f32_16x16x64_bf16 v[52:55], v[24:27], v[200:207], v62
    v_smfmac_f32_16x16x64_bf16 v[32:35], v[28:31], v[208:215], v62
    ds_write_b32 v14, v60
    v_smfmac_f32_16x16x64_bf16 v[36:39], v[28:31], v[216:223], v62
    v_smfmac_f32_16x16x64_bf16 v[40:43], v[28:31], v[224:231], v62
    v_smfmac_f32_16x16x64_bf16 v[44:47], v[28:31], v[232:239], v62
    v_add_f32 v32, v32, v33
    v_add_f32 v34, v34, v35
    v_smfmac_f32_16x16x64_bf16 v[48:51], v[28:31], v[240:247], v62
    v_add_f32 v36, v36, v37
    v_add_f32 v38, v38, v39
    ds_write2_b32 v4, v32, v34 offset0:0 offset1:104
    v_smfmac_f32_16x16x64_bf16 v[52:55], v[28:31], v[248:255], v62
    v_add_f32 v40, v40, v41
    v_add_f32 v42, v42, v43
    ds_write2_b32 v4, v36, v38 offset0:16 offset1:120
    v_add_f32 v44, v44, v45
    v_add_f32 v46, v46, v47
    ds_write2_b32 v4, v40, v42 offset0:32 offset1:136
    v_add_f32 v48, v48, v49
    v_add_f32 v50, v50, v51
    ds_write2_b32 v4, v44, v46 offset0:48 offset1:152
    v_add_f32 v52, v52, v53
    v_add_f32 v54, v54, v55
    ds_write2_b32 v4, v48, v50 offset0:64 offset1:168
    ds_write2_b32 v4, v52, v54 offset0:80 offset1:184
    s_waitcnt vmcnt(0)
    s_branch pnc_7_done
.p2align 6
    s_nop 0
    s_nop 0
    s_nop 0
    s_nop 0
    s_nop 0
    s_nop 0
    s_nop 0
    s_nop 0
ploop_6:
    s_add_u32 s21, s17, s33
    s_nop 15
    s_nop 5
    buffer_load_dwordx4 v[16:19], v1, s[4:7], s21 offen offset:0 sc1
    s_nop 7
    buffer_load_dwordx4 v[20:23], v1, s[4:7], s21 offen offset:1024 sc1
    s_nop 7
    buffer_load_dwordx4 v[24:27], v1, s[4:7], s21 offen offset:2048 sc1
    s_nop 7
    buffer_load_dwordx4 v[28:31], v1, s[4:7], s21 offen offset:3072 sc1
    s_waitcnt vmcnt(3)
    v_max3_u32 v9, v16, v17, v18
    v_max_u32 v9, v9, v19
    v_cmp_eq_u32 vcc, -1, v9
    s_cbranch_vccnz prm_9_0
prm_9_0ok:
    v_smfmac_f32_16x16x64_bf16 v[32:35], v[16:19], v[64:71], v62
    v_smfmac_f32_16x16x64_bf16 v[36:39], v[16:19], v[72:79], v62
    v_smfmac_f32_16x16x64_bf16 v[40:43], v[16:19], v[80:87], v62
    s_waitcnt vmcnt(2)
    v_max3_u32 v9, v20, v21, v22
    v_max_u32 v9, v9, v23
    v_cmp_eq_u32 vcc, -1, v9
    v_smfmac_f32_16x16x64_bf16 v[44:47], v[16:19], v[88:95], v62
    v_smfmac_f32_16x16x64_bf16 v[48:51], v[16:19], v[96:103], v62
    v_smfmac_f32_16x16x64_bf16 v[52:55], v[16:19], v[104:111], v62
    s_cbranch_vccnz prm_9_1
prm_9_1ok:
    v_smfmac_f32_16x16x64_bf16 v[32:35], v[20:23], v[112:119], v62
    v_readfirstlane_b32 s23, v15
    v_smfmac_f32_16x16x64_bf16 v[36:39], v[20:23], v[120:127], v62
    v_smfmac_f32_16x16x64_bf16 v[40:43], v[20:23], v[128:135], v62
    s_waitcnt vmcnt(1)
    v_max3_u32 v9, v24, v25, v26
    v_max_u32 v9, v9, v27
    v_cmp_eq_u32 vcc, -1, v9
    v_smfmac_f32_16x16x64_bf16 v[44:47], v[20:23], v[136:143], v62
    v_smfmac_f32_16x16x64_bf16 v[48:51], v[20:23], v[144:151], v62
    v_smfmac_f32_16x16x64_bf16 v[52:55], v[20:23], v[152:159], v62
    s_cbranch_vccnz prm_9_2
prm_9_2ok:
    v_smfmac_f32_16x16x64_bf16 v[32:35], v[24:27], v[160:167], v62
    v_smfmac_f32_16x16x64_bf16 v[36:39], v[24:27], v[168:175], v62
    v_smfmac_f32_16x16x64_bf16 v[40:43], v[24:27], v[176:183], v62
    s_waitcnt vmcnt(0)
    v_max3_u32 v9, v28, v29, v30
    v_max_u32 v9, v9, v31
    v_cmp_eq_u32 vcc, -1, v9
    v_smfmac_f32_16x16x64_bf16 v[44:47], v[24:27], v[184:191], v62
    v_smfmac_f32_16x16x64_bf16 v[48:51], v[24:27], v[192:199], v62
    v_smfmac_f32_16x16x64_bf16 v[52:55], v[24:27], v[200:207], v62
    s_cbranch_vccnz prm_9_3
prm_9_3ok:
    v_smfmac_f32_16x16x64_bf16 v[32:35], v[28:31], v[208:215], v62
    s_cmp_lt_u32 s23, s59
    s_cbranch_scc1 prm_9_gt
prm_9_gtb:
    ds_write_b32 v14, v60
    v_smfmac_f32_16x16x64_bf16 v[36:39], v[28:31], v[216:223], v62
    v_smfmac_f32_16x16x64_bf16 v[40:43], v[28:31], v[224:231], v62
    v_smfmac_f32_16x16x64_bf16 v[44:47], v[28:31], v[232:239], v62
    v_add_f32 v32, v32, v33
    v_add_f32 v34, v34, v35
    v_smfmac_f32_16x16x64_bf16 v[48:51], v[28:31], v[240:247], v62
    v_add_f32 v36, v36, v37
    v_add_f32 v38, v38, v39
    ds_write2_b32 v4, v32, v34 offset0:0 offset1:104
    v_smfmac_f32_16x16x64_bf16 v[52:55], v[28:31], v[248:255], v62
    v_add_f32 v40, v40, v41
    v_add_f32 v42, v42, v43
    ds_write2_b32 v4, v36, v38 offset0:16 offset1:120
    v_add_f32 v44, v44, v45
    v_add_f32 v46, v46, v47
    ds_write2_b32 v4, v40, v42 offset0:32 offset1:136
    v_add_f32 v48, v48, v49
    v_add_f32 v50, v50, v51
    ds_write2_b32 v4, v44, v46 offset0:48 offset1:152
    v_add_f32 v52, v52, v53
    v_add_f32 v54, v54, v55
    ds_write2_b32 v4, v48, v50 offset0:64 offset1:168
    ds_write2_b32 v4, v52, v54 offset0:80 offset1:184
pnc_7_done:
    s_add_u32 s21, s17, s32
    s_add_u32 s22, s19, s32
    s_add_u32 s24, s19, s35
    s_waitcnt lgkmcnt(0)
    s_barrier
    ds_read_b64 v[32:33], v5 offset:0
    ds_read_b64 v[34:35], v5 offset:3328
    ds_read_b64 v[36:37], v5 offset:6656
    ds_read_b64 v[38:39], v5 offset:9984
    ds_read_b64 v[40:41], v6 offset:0
    ds_read_b64 v[42:43], v6 offset:3328
    ds_read_b64 v[44:45], v6 offset:6656
    ds_read_b64 v[46:47], v6 offset:9984
    s_waitcnt lgkmcnt(6)
    v_add_f32 v32, v32, v34
    v_add_f32 v33, v33, v35
    v_mul_f32 v32, v32, v0
    v_mul_f32 v33, v33, v0
    s_waitcnt lgkmcnt(4)
    v_add_f32 v36, v36, v38
    v_add_f32 v37, v37, v39
    v_fma_f32 v32, v36, v0, v32
    v_fma_f32 v33, v37, v0, v33
    v_cvt_pk_bf16_f32 v32, v32, v33
    v_min_u32 v32, -2, v32
    buffer_store_dword v32, v2, s[4:7], s21 offen
    s_waitcnt lgkmcnt(2)
    v_add_f32 v40, v40, v42
    v_add_f32 v41, v41, v43
    s_waitcnt lgkmcnt(0)
    v_add_f32 v44, v44, v46
    v_add_f32 v45, v45, v47
    v_add_f32 v40, v40, v44
    v_add_f32 v41, v41, v45
    v_cvt_pk_bf16_f32 v40, v40, v41
    v_min_u32 v40, -2, v40
    s_mov_b32 exec_hi, 0
    buffer_store_dword v40, v3, s[4:7], s21 offen
    s_setprio 0
    s_mov_b64 exec, -1
    s_add_u32 s21, s17, s35
    s_add_u32 s30, s17, s34
    s_add_u32 s23, s18, s36
    s_cmp_lg_u32 s16, 0
    s_cbranch_scc1 ploop_6_n0
gate_11:
    v_readfirstlane_b32 s25, v15
    s_cmp_ge_u32 s25, s59
    s_cbranch_scc1 gate_11_ok
    s_sleep 8
    buffer_load_dword v15, off, s[4:7], s58 sc1
    s_waitcnt vmcnt(0)
    s_sub_u32 s26, s26, 1
    s_cbranch_scc0 gate_11
    s_mov_b32 s26, 0
gate_11_ok:
    s_cmp_eq_u32 s15, 0
    s_cbranch_scc1 ploop_6_st_nk
    s_add_u32 m0, s53, 0
    s_add_u32 s22, s52, 0
    buffer_load_dwordx4 v1, s[4:7], s22 offen offset:0 sc1 lds
    buffer_load_dwordx4 v1, s[4:7], s22 offen offset:1024 sc1 lds
    buffer_load_dwordx4 v1, s[4:7], s22 offen offset:2048 sc1 lds
    buffer_load_dwordx4 v1, s[4:7], s22 offen offset:3072 sc1 lds
    s_add_u32 m0, s53, 4096
    s_add_u32 s22, s52, 131072
    buffer_load_dwordx4 v1, s[4:7], s22 offen offset:0 sc1 lds
    buffer_load_dwordx4 v1, s[4:7], s22 offen offset:1024 sc1 lds
    buffer_load_dwordx4 v1, s[4:7], s22 offen offset:2048 sc1 lds
    buffer_load_dwordx4 v1, s[4:7], s22 offen offset:3072 sc1 lds
    s_add_u32 s52, s52, 262144
    s_sub_u32 s52, s52, 262144
ploop_6_st_nk:
    s_add_u32 s52, s52, 262144
    s_cmp_lg_u32 s3, 2
    s_cbranch_scc1 ploop_6_st_npf
    v_subrev_u32 v32, 524288, v63
    s_mov_b32 exec_hi, 0xffff
    s_mov_b32 s22, 262144
    buffer_load_dword v33, v32, s[4:7], s22 offen sc1
    s_mov_b32 exec_hi, -1
    s_waitcnt vmcnt(0)
ploop_6_st_npf:
    s_cmp_eq_u32 s15, 0
    s_cbranch_scc1 ploop_6_st_p_nd
    s_mov_b32 m0, 124928
    s_nop 0
    buffer_load_dwordx4 v1, s[4:7], s69 offen offset:0 sc1 lds
    buffer_load_dwordx4 v1, s[4:7], s69 offen offset:1024 sc1 lds
    buffer_load_dwordx4 v1, s[4:7], s69 offen offset:2048 sc1 lds
    buffer_load_dwordx4 v1, s[4:7], s69 offen offset:3072 sc1 lds
    s_add_u32 s69, s69, 262144
    s_waitcnt vmcnt(0)
ploop_6_st_p_nd:
ploop_6_n0:
    s_add_u32 s25, s16, 2
    s_min_u32 s25, s25, 63
    s_cmp_lt_u32 s25, 8
    s_cselect_b32 s59, 12, 24
    s_cselect_b32 s58, -4, -8
    s_and_b32 s25, s25, s58
    s_lshl_b32 s25, s25, 5
    s_add_u32 s58, s25, s60
    s_cmp_eq_u32 s15, 0
    s_cbranch_scc1 ploop_6_nd
    v_add_u32 v9, s53, v1
    v_add_u32 v0, 124928, v1
    ds_read_b128 v[16:19], v0 offset:0
    ds_read_b128 v[32:35], v9 offset:0
    ds_read_b128 v[20:23], v0 offset:1024
    ds_read_b128 v[36:39], v9 offset:1024
    ds_read_b128 v[24:27], v0 offset:2048
    ds_read_b128 v[40:43], v9 offset:2048
    ds_read_b128 v[28:31], v0 offset:3072
    ds_read_b128 v[44:47], v9 offset:3072
    s_add_u32 s22, s17, s61
    s_waitcnt lgkmcnt(6)
    v_mfma_f32_16x16x32_bf16 v[48:51], v[32:35], v[16:19], 0
    ds_read_b128 v[32:35], v9 offset:4096
    s_waitcnt lgkmcnt(5)
    v_mfma_f32_16x16x32_bf16 v[48:51], v[36:39], v[20:23], v[48:51]
    ds_read_b128 v[36:39], v9 offset:5120
    s_waitcnt lgkmcnt(4)
    v_mfma_f32_16x16x32_bf16 v[48:51], v[40:43], v[24:27], v[48:51]
    ds_read_b128 v[40:43], v9 offset:6144
    s_waitcnt lgkmcnt(3)
    v_mfma_f32_16x16x32_bf16 v[48:51], v[44:47], v[28:31], v[48:51]
    ds_read_b128 v[44:47], v9 offset:7168
    s_waitcnt lgkmcnt(3)
    v_mfma_f32_16x16x32_bf16 v[52:55], v[32:35], v[16:19], 0
    s_waitcnt lgkmcnt(2)
    v_mfma_f32_16x16x32_bf16 v[52:55], v[36:39], v[20:23], v[52:55]
    s_waitcnt lgkmcnt(1)
    v_mfma_f32_16x16x32_bf16 v[52:55], v[40:43], v[24:27], v[52:55]
    s_waitcnt lgkmcnt(0)
    v_mfma_f32_16x16x32_bf16 v[52:55], v[44:47], v[28:31], v[52:55]
    buffer_load_dwordx4 v[32:35], v1, s[4:7], s22 offen offset:0 sc1
    buffer_load_dwordx4 v[36:39], v1, s[4:7], s22 offen offset:1024 sc1
    buffer_load_dwordx4 v[40:43], v1, s[4:7], s22 offen offset:2048 sc1
    buffer_load_dwordx4 v[44:47], v1, s[4:7], s22 offen offset:3072 sc1
    v_mov_b32 v60, 0xff61b1e6
    s_nop 2
    v_cndmask_b32 v48, v48, v60, s[38:39]
    v_cndmask_b32 v49, v49, v60, s[40:41]
    v_cndmask_b32 v50, v50, v60, s[42:43]
    v_cndmask_b32 v51, v51, v60, s[44:45]
    v_cndmask_b32 v52, v52, v60, s[48:49]
    v_cndmask_b32 v53, v53, v60, s[50:51]
    v_cndmask_b32 v54, v54, v60, s[54:55]
    v_cndmask_b32 v55, v55, v60, s[56:57]
    v_max3_f32 v0, v48, v49, v50
    v_max3_f32 v9, v51, v52, v53
    v_max3_f32 v0, v0, v54, v55
    v_max_f32 v0, v0, v9
    v_mov_b32 v9, v0
    s_nop 1
    v_permlane16_swap_b32 v9, v0
    v_max_f32 v0, v0, v9
    v_mov_b32 v9, v0
    s_nop 1
    v_permlane32_swap_b32 v9, v0
    v_max_f32 v0, v0, v9
    v_mul_f32 v0, s47, v0
    v_fma_f32 v48, v48, s47, -v0
    v_fma_f32 v49, v49, s47, -v0
    v_fma_f32 v50, v50, s47, -v0
    v_fma_f32 v51, v51, s47, -v0
    v_fma_f32 v52, v52, s47, -v0
    v_fma_f32 v53, v53, s47, -v0
    v_fma_f32 v54, v54, s47, -v0
    v_fma_f32 v55, v55, s47, -v0
    v_exp_f32 v48, v48
    v_exp_f32 v49, v49
    v_exp_f32 v50, v50
    v_exp_f32 v51, v51
    v_exp_f32 v52, v52
    v_exp_f32 v53, v53
    v_exp_f32 v54, v54
    v_exp_f32 v55, v55
    v_add_f32 v15, v48, v49
    v_add_f32 v15, v15, v50
    v_add_f32 v15, v15, v51
    v_add_f32 v15, v15, v52
    v_add_f32 v15, v15, v53
    v_add_f32 v15, v15, v54
    v_add_f32 v15, v15, v55
ploop_6_za:
    s_waitcnt vmcnt(0)
    v_max3_u32 v9, v32, v33, v34
    v_max3_u32 v9, v9, v35, v36
    v_max3_u32 v9, v9, v37, v38
    v_max3_u32 v9, v9, v39, v40
    v_max3_u32 v9, v9, v41, v42
    v_max3_u32 v9, v9, v43, v44
    v_max3_u32 v9, v9, v45, v46
    v_max_u32 v9, v9, v47
    v_cmp_eq_u32 vcc, -1, v9
    s_cbranch_vccnz ploop_6_zr
ploop_6_zok:
    s_setprio 1
    v_mfma_f32_16x16x32_bf16 v[56:59], v[32:35], v[16:19], 0
    v_mfma_f32_16x16x32_bf16 v[56:59], v[36:39], v[20:23], v[56:59]
    v_mfma_f32_16x16x32_bf16 v[56:59], v[40:43], v[24:27], v[56:59]
    v_mfma_f32_16x16x32_bf16 v[56:59], v[44:47], v[28:31], v[56:59]
    s_add_u32 s22, s17, s14
    s_nop 6
    v_max_f32 v60, v56, v57
    v_mov_b32 v9, v60
    s_nop 1
    v_permlane16_swap_b32 v9, v60
    v_max_f32 v60, v60, v9
    v_mov_b32 v9, v60
    s_nop 1
    v_permlane32_swap_b32 v9, v60
    v_max_f32 v60, v60, v9
    v_mul_f32 v60, s47, v60
    v_max_f32 v58, v60, v0
    v_sub_f32 v60, v0, v58
    v_fma_f32 v56, v56, s47, -v58
    v_fma_f32 v57, v57, s47, -v58
    v_exp_f32 v60, v60
    v_exp_f32 v56, v56
    v_exp_f32 v57, v57
    v_fma_f32 v15, v15, v60, v56
    v_add_f32 v15, v15, v57
    v_mov_b32 v9, v15
    s_nop 1
    v_permlane16_swap_b32 v9, v15
    v_add_f32 v15, v15, v9
    v_mov_b32 v9, v15
    s_nop 1
    v_permlane32_swap_b32 v9, v15
    v_add_f32 v15, v15, v9
    v_rcp_f32 v15, v15
    s_add_u32 s25, s19, s14
    v_mul_f32 v56, v56, v15
    v_mul_f32 v57, v57, v15
    v_mul_f32 v60, v60, v15
    v_mul_f32 v48, v48, v60
    v_mul_f32 v49, v49, v60
    v_mul_f32 v50, v50, v60
    v_mul_f32 v51, v51, v60
    v_mul_f32 v52, v52, v60
    v_mul_f32 v53, v53, v60
    v_mul_f32 v54, v54, v60
    v_mul_f32 v55, v55, v60
    v_cvt_pk_bf16_f32 v48, v48, v49
    v_cvt_pk_bf16_f32 v49, v50, v51
    v_cvt_pk_bf16_f32 v50, v52, v53
    v_cvt_pk_bf16_f32 v51, v54, v55
    v_min_u32 v48, -2, v48
    v_min_u32 v49, -2, v49
    v_min_u32 v50, -2, v50
    v_min_u32 v51, -2, v51
    v_lshlrev_b32 v54, 1, v8
    v_add_u32 v55, 14336, v1
    v_mov_b32 v53, 1.0
    v_cvt_pk_bf16_f32 v52, v56, v57
    v_min_u32 v53, -2, v53
    v_min_u32 v52, -2, v52
    buffer_store_dwordx4 v[48:51], v1, s[4:7], s22 offen
    buffer_store_dwordx2 v[52:53], v54, s[4:7], s22 offen offset:1024
    ds_read_b128 v[56:59], v55
    s_branch ploop_6_nd2
ploop_6_nd:
    s_cmp_eq_u32 s16, 0
    s_cbranch_scc1 ploop_6_ns
    s_cmp_eq_u32 s31, 0
    s_cbranch_scc1 ploop_6_n2
    s_add_u32 s25, s68, s46
    v_add_u32 v55, s25, v61
    ds_read_b128 v[24:27], v55 offset:0
    ds_read_b128 v[28:31], v55 offset:1024
    ds_read_b128 v[32:35], v55 offset:18560
    ds_read_b128 v[36:39], v55 offset:19584
    ds_read_b128 v[40:43], v55 offset:37120
    ds_read_b128 v[44:47], v55 offset:38144
    ds_read_b128 v[48:51], v55 offset:55680
    ds_read_b128 v[52:55], v55 offset:56704
    s_waitcnt lgkmcnt(4)
    v_add_f32 v24, v24, v32
    v_add_f32 v25, v25, v33
    v_add_f32 v26, v26, v34
    v_add_f32 v27, v27, v35
    v_add_f32 v28, v28, v36
    v_add_f32 v29, v29, v37
    v_add_f32 v30, v30, v38
    v_add_f32 v31, v31, v39
    s_waitcnt lgkmcnt(0)
    v_add_f32 v40, v40, v48
    v_add_f32 v41, v41, v49
    v_add_f32 v42, v42, v50
    v_add_f32 v43, v43, v51
    v_add_f32 v44, v44, v52
    v_add_f32 v45, v45, v53
    v_add_f32 v46, v46, v54
    v_add_f32 v47, v47, v55
    v_add_f32 v24, v24, v40
    v_add_f32 v25, v25, v41
    v_add_f32 v26, v26, v42
    v_add_f32 v27, v27, v43
    v_add_f32 v28, v28, v44
    v_add_f32 v29, v29, v45
    v_add_f32 v30, v30, v46
    v_add_f32 v31, v31, v47
    v_cvt_pk_bf16_f32 v24, v24, v25
    v_cvt_pk_bf16_f32 v25, v26, v27
    v_cvt_pk_bf16_f32 v26, v28, v29
    v_cvt_pk_bf16_f32 v27, v30, v31
    v_min_u32 v24, -2, v24
    v_min_u32 v25, -2, v25
    v_min_u32 v26, -2, v26
    v_min_u32 v27, -2, v27
    v_mov_b32 v16, v24
    v_mov_b32 v17, v25
    v_mov_b32 v18, v26
    v_mov_b32 v19, v27
ploop_6_n2:
    v_add_u32 v55, s68, v61
    ds_read_b128 v[24:27], v55 offset:0
    ds_read_b128 v[28:31], v55 offset:1024
    ds_read_b128 v[32:35], v55 offset:18560
    ds_read_b128 v[36:39], v55 offset:19584
    ds_read_b128 v[40:43], v55 offset:37120
    ds_read_b128 v[44:47], v55 offset:38144
    ds_read_b128 v[48:51], v55 offset:55680
    ds_read_b128 v[52:55], v55 offset:56704
    s_waitcnt lgkmcnt(4)
    v_add_f32 v24, v24, v32
    v_add_f32 v25, v25, v33
    v_add_f32 v26, v26, v34
    v_add_f32 v27, v27, v35
    v_add_f32 v28, v28, v36
    v_add_f32 v29, v29, v37
    v_add_f32 v30, v30, v38
    v_add_f32 v31, v31, v39
    s_waitcnt lgkmcnt(0)
    v_add_f32 v40, v40, v48
    v_add_f32 v41, v41, v49
    v_add_f32 v42, v42, v50
    v_add_f32 v43, v43, v51
    v_add_f32 v44, v44, v52
    v_add_f32 v45, v45, v53
    v_add_f32 v46, v46, v54
    v_add_f32 v47, v47, v55
    v_add_f32 v24, v24, v40
    v_add_f32 v25, v25, v41
    v_add_f32 v26, v26, v42
    v_add_f32 v27, v27, v43
    v_add_f32 v28, v28, v44
    v_add_f32 v29, v29, v45
    v_add_f32 v30, v30, v46
    v_add_f32 v31, v31, v47
    v_cvt_pk_bf16_f32 v24, v24, v25
    v_cvt_pk_bf16_f32 v25, v26, v27
    v_cvt_pk_bf16_f32 v26, v28, v29
    v_cvt_pk_bf16_f32 v27, v30, v31
    v_min_u32 v24, -2, v24
    v_min_u32 v25, -2, v25
    v_min_u32 v26, -2, v26
    v_min_u32 v27, -2, v27
ploop_6_ns:
ploop_6_flag:
    ds_read_b32 v9, v14 offset:16
    s_waitcnt lgkmcnt(0)
    v_readfirstlane_b32 s25, v9
    s_cmp_eq_u32 s25, s16
    s_cbranch_scc0 ploop_6_flag
    s_add_u32 m0, s53, 0
    s_add_u32 s22, s52, 0
    buffer_load_dwordx4 v1, s[4:7], s22 offen offset:0 sc1 lds
    buffer_load_dwordx4 v1, s[4:7], s22 offen offset:1024 sc1 lds
    buffer_load_dwordx4 v1, s[4:7], s22 offen offset:2048 sc1 lds
    buffer_load_dwordx4 v1, s[4:7], s22 offen offset:3072 sc1 lds
    s_add_u32 m0, s53, 4096
    s_add_u32 s22, s52, 131072
    buffer_load_dwordx4 v1, s[4:7], s22 offen offset:0 sc1 lds
    buffer_load_dwordx4 v1, s[4:7], s22 offen offset:1024 sc1 lds
    buffer_load_dwordx4 v1, s[4:7], s22 offen offset:2048 sc1 lds
    buffer_load_dwordx4 v1, s[4:7], s22 offen offset:3072 sc1 lds
    s_add_u32 s52, s52, 262144
ploop_6_nk:
    s_cmp_eq_u32 s16, 0
    s_cbranch_scc1 ploop_6_nd2
    buffer_store_dwordx4 v[24:27], v1, s[4:7], s37 offen sc1
    s_cmp_eq_u32 s31, 0
    s_cbranch_scc1 ploop_6_nd2
    s_add_u32 s25, s37, s27
    buffer_store_dwordx4 v[16:19], v1, s[4:7], s25 offen sc1
ploop_6_nd2:
    s_cmp_eq_u32 s16, 0
    s_cbranch_scc1 ploop_6_nn
    s_add_u32 s37, s37, 65536
    s_xor_b32 s68, s68, 8192
ploop_6_nn:
    s_cmp_lg_u32 s3, s8
    s_cbranch_scc1 ppf_12
    s_lshl_b32 s22, s16, 18
    s_mov_b32 exec_hi, 0xffff
    buffer_load_dword v9, v63, s[4:7], s22 offen sc1
    s_mov_b32 exec_hi, -1
ppf_12:
    v_add_u32 v24, 18560, v7
    v_add_u32 v25, 37120, v7
    v_add_u32 v26, 55680, v7
    s_cmp_eq_u32 s16, 63
    s_setprio 3
    s_barrier
    s_cbranch_scc1 ptail_8
    ds_read2_b32 v[16:17], v7 offset0:0 offset1:2
    ds_read2_b32 v[18:19], v24 offset0:0 offset1:2
    ds_read2_b32 v[20:21], v25 offset0:0 offset1:2
    ds_read2_b32 v[22:23], v26 offset0:0 offset1:2
    s_waitcnt lgkmcnt(2)
    v_add_f32 v16, v16, v18
    v_add_f32 v17, v17, v19
    s_waitcnt lgkmcnt(0)
    v_add_f32 v20, v20, v22
    v_add_f32 v21, v21, v23
    v_add_f32 v16, v16, v20
    v_add_f32 v17, v17, v21
    v_cvt_pk_bf16_f32 v16, v16, v17
    v_min_u32 v16, -2, v16
    buffer_store_dword v16, v2, s[4:7], s21 offen sc1
    buffer_store_dword v10, v2, s[4:7], s24 offen sc1
    s_cmp_eq_u32 s15, 0
    s_cbranch_scc1 ploop_6_pnd
    s_sleep 6
    s_nop 8
    buffer_load_dwordx4 v[16:19], v12, s[4:7], s30 offen sc1
    buffer_load_dword v15, off, s[4:7], s58 sc1
    s_add_u32 s25, s19, s14
    v_mov_b32 v20, -1
    v_mov_b32 v21, -1
    v_mov_b32 v22, -1
    v_mov_b32 v23, -1
    buffer_store_dwordx4 v[20:23], v1, s[4:7], s25 offen
    buffer_store_dwordx2 v[20:21], v54, s[4:7], s25 offen offset:1024
    s_mov_b32 m0, 124928
    s_nop 0
    buffer_load_dwordx4 v1, s[4:7], s69 offen offset:0 sc1 lds
    buffer_load_dwordx4 v1, s[4:7], s69 offen offset:1024 sc1 lds
    buffer_load_dwordx4 v1, s[4:7], s69 offen offset:2048 sc1 lds
    buffer_load_dwordx4 v1, s[4:7], s69 offen offset:3072 sc1 lds
    s_add_u32 s69, s69, 262144
    s_add_u32 m0, s53, 0
    s_add_u32 s22, s52, 0
    buffer_load_dwordx4 v1, s[4:7], s22 offen offset:0 sc1 lds
    buffer_load_dwordx4 v1, s[4:7], s22 offen offset:1024 sc1 lds
    buffer_load_dwordx4 v1, s[4:7], s22 offen offset:2048 sc1 lds
    buffer_load_dwordx4 v1, s[4:7], s22 offen offset:3072 sc1 lds
    s_add_u32 m0, s53, 4096
    s_add_u32 s22, s52, 131072
    buffer_load_dwordx4 v1, s[4:7], s22 offen offset:0 sc1 lds
    buffer_load_dwordx4 v1, s[4:7], s22 offen offset:1024 sc1 lds
    buffer_load_dwordx4 v1, s[4:7], s22 offen offset:2048 sc1 lds
    buffer_load_dwordx4 v1, s[4:7], s22 offen offset:3072 sc1 lds
    s_add_u32 s52, s52, 262144
    s_add_u32 s22, s16, 1
    v_mov_b32 v60, s22
    v_mov_b32 v32, 0
    v_mov_b32 v33, 0
    v_mov_b32 v34, 0
    v_mov_b32 v35, 0
    v_mov_b32 v36, 0
    v_mov_b32 v37, 0
    v_mov_b32 v38, 0
    v_mov_b32 v39, 0
    v_mov_b32 v40, 0
    v_mov_b32 v41, 0
    v_mov_b32 v42, 0
    v_mov_b32 v43, 0
    v_mov_b32 v44, 0
    v_mov_b32 v45, 0
    v_mov_b32 v46, 0
    v_mov_b32 v47, 0
    v_mov_b32 v48, 0
    v_mov_b32 v49, 0
    v_mov_b32 v50, 0
    v_mov_b32 v51, 0
    v_mov_b32 v52, 0
    v_mov_b32 v53, 0
    v_mov_b32 v54, 0
    v_mov_b32 v55, 0
    v_mov_b32 v0, 1.0
    s_mov_b32 exec_lo, 0xff00ff00
    s_mov_b32 exec_hi, 0xff00ff00
    v_mov_b32 v0, s47
    s_mov_b64 exec, -1
    s_waitcnt vmcnt(15) lgkmcnt(0)
    v_mfma_f32_16x16x32_bf16 v[20:23], v[56:59], v[16:19], 0
    v_max3_u32 v9, v16, v17, v18
    v_max_u32 v9, v9, v19
    v_cmp_eq_u32 vcc, -1, v9
    s_cbranch_vccnz prp_10
    s_nop 3
    v_add_f32_dpp v20, v20, v20 row_ror:8 row_mask:0xf bank_mask:0xf
    v_add_f32_dpp v21, v21, v21 row_ror:8 row_mask:0xf bank_mask:0xf
    v_add_f32_dpp v22, v22, v22 row_ror:8 row_mask:0xf bank_mask:0xf
    v_add_f32_dpp v23, v23, v23 row_ror:8 row_mask:0xf bank_mask:0xf
    v_cvt_pk_bf16_f32 v20, v20, v21
    v_cvt_pk_bf16_f32 v21, v22, v23
    s_mov_b32 exec_hi, 0
    v_min_u32 v20, -2, v20
    v_min_u32 v21, -2, v21
    s_mov_b32 exec_lo, 0x00ff00ff
    buffer_store_dwordx2 v[20:21], v13, s[4:7], s23 offen
    s_mov_b64 exec, -1
    s_branch ploop_6_pst
ploop_6_pnd:
    s_sleep 6
    s_nop 8
    buffer_load_dwordx4 v[16:19], v12, s[4:7], s30 offen sc1
    buffer_load_dword v15, off, s[4:7], s58 sc1
    s_add_u32 s22, s16, 1
    v_mov_b32 v60, s22
    v_mov_b32 v32, 0
    v_mov_b32 v33, 0
    v_mov_b32 v34, 0
    v_mov_b32 v35, 0
    v_mov_b32 v36, 0
    v_mov_b32 v37, 0
    v_mov_b32 v38, 0
    v_mov_b32 v39, 0
    v_mov_b32 v40, 0
    v_mov_b32 v41, 0
    v_mov_b32 v42, 0
    v_mov_b32 v43, 0
    v_mov_b32 v44, 0
    v_mov_b32 v45, 0
    v_mov_b32 v46, 0
    v_mov_b32 v47, 0
    v_mov_b32 v48, 0
    v_mov_b32 v49, 0
    v_mov_b32 v50, 0
    v_mov_b32 v51, 0
    v_mov_b32 v52, 0
    v_mov_b32 v53, 0
    v_mov_b32 v54, 0
    v_mov_b32 v55, 0
    v_mov_b32 v0, 1.0
    s_mov_b32 exec_lo, 0xff00ff00
    s_mov_b32 exec_hi, 0xff00ff00
    v_mov_b32 v0, s47
    s_mov_b64 exec, -1
ploop_6_pagain:
    s_waitcnt vmcnt(1) lgkmcnt(0)
    v_mfma_f32_16x16x32_bf16 v[20:23], v[56:59], v[16:19], 0
    v_max3_u32 v9, v16, v17, v18
    v_max_u32 v9, v9, v19
    v_cmp_eq_u32 vcc, -1, v9
    s_cbranch_vccnz prp_10
ploop_6_pgo:
    s_nop 3
    v_add_f32_dpp v20, v20, v20 row_ror:8 row_mask:0xf bank_mask:0xf
    v_add_f32_dpp v21, v21, v21 row_ror:8 row_mask:0xf bank_mask:0xf
    v_add_f32_dpp v22, v22, v22 row_ror:8 row_mask:0xf bank_mask:0xf
    v_add_f32_dpp v23, v23, v23 row_ror:8 row_mask:0xf bank_mask:0xf
    v_cvt_pk_bf16_f32 v20, v20, v21
    v_cvt_pk_bf16_f32 v21, v22, v23
    s_mov_b32 exec_hi, 0
    v_min_u32 v20, -2, v20
    v_min_u32 v21, -2, v21
    s_mov_b32 exec_lo, 0x00ff00ff
    buffer_store_dwordx2 v[20:21], v13, s[4:7], s23 offen
    s_mov_b64 exec, -1
ploop_6_pst:
    s_add_u32 s22, s19, s32
    s_add_u32 s25, s20, s36
    buffer_store_dword v10, v2, s[4:7], s22 offen
    s_mov_b32 exec_hi, 0
    buffer_store_dword v10, v3, s[4:7], s22 offen
    s_mov_b32 exec_lo, 0x00ff00ff
    buffer_store_dwordx2 v[10:11], v13, s[4:7], s25 offen
    s_mov_b64 exec, -1
    s_add_u32 s16, s16, 1
    s_mov_b32 s17, s18
    s_mov_b32 s18, s19
    s_mov_b32 s19, s20
    s_add_u32 s20, s20, 262144
    s_cmp_eq_u32 s20, 210763776
    s_cselect_b32 s20, 209715200, s20
    s_branch ploop_6
prm_9_gt:
gate_13:
    v_readfirstlane_b32 s25, v15
    s_cmp_ge_u32 s25, s59
    s_cbranch_scc1 gate_13_ok
    s_sleep 8
    buffer_load_dword v15, off, s[4:7], s58 sc1
    s_waitcnt vmcnt(0)
    s_sub_u32 s26, s26, 1
    s_cbranch_scc0 gate_13
    s_mov_b32 s26, 0
gate_13_ok:
    s_branch prm_9_gtb
prm_9_0:
    s_sub_u32 s26, s26, 1
    s_cbranch_scc1 prm_9_0_g
    buffer_load_dwordx4 v[16:19], v1, s[4:7], s21 offen offset:0 sc1
    buffer_load_dwordx4 v[20:23], v1, s[4:7], s21 offen offset:1024 sc1
    buffer_load_dwordx4 v[24:27], v1, s[4:7], s21 offen offset:2048 sc1
    buffer_load_dwordx4 v[28:31], v1, s[4:7], s21 offen offset:3072 sc1
    s_waitcnt vmcnt(3)
    v_max3_u32 v9, v16, v17, v18
    v_max_u32 v9, v9, v19
    v_cmp_eq_u32 vcc, -1, v9
    s_cbranch_vccnz prm_9_0
    s_branch prm_9_0ok
prm_9_0_g:
    s_mov_b32 s26, 0
    s_waitcnt vmcnt(0)
    s_branch prm_9_0ok
prm_9_1:
    s_sub_u32 s26, s26, 1
    s_cbranch_scc1 prm_9_1_g
    buffer_load_dwordx4 v[20:23], v1, s[4:7], s21 offen offset:1024 sc1
    buffer_load_dwordx4 v[24:27], v1, s[4:7], s21 offen offset:2048 sc1
    buffer_load_dwordx4 v[28:31], v1, s[4:7], s21 offen offset:3072 sc1
    s_waitcnt vmcnt(2)
    v_max3_u32 v9, v20, v21, v22
    v_max_u32 v9, v9, v23
    v_cmp_eq_u32 vcc, -1, v9
    s_cbranch_vccnz prm_9_1
    s_branch prm_9_1ok
prm_9_1_g:
    s_mov_b32 s26, 0
    s_waitcnt vmcnt(0)
    s_branch prm_9_1ok
prm_9_2:
    s_sub_u32 s26, s26, 1
    s_cbranch_scc1 prm_9_2_g
    buffer_load_dwordx4 v[24:27], v1, s[4:7], s21 offen offset:2048 sc1
    buffer_load_dwordx4 v[28:31], v1, s[4:7], s21 offen offset:3072 sc1
    s_waitcnt vmcnt(1)
    v_max3_u32 v9, v24, v25, v26
    v_max_u32 v9, v9, v27
    v_cmp_eq_u32 vcc, -1, v9
    s_cbranch_vccnz prm_9_2
    s_branch prm_9_2ok
prm_9_2_g:
    s_mov_b32 s26, 0
    s_waitcnt vmcnt(0)
    s_branch prm_9_2ok
prm_9_3:
    s_sub_u32 s26, s26, 1
    s_cbranch_scc1 prm_9_3_g
    buffer_load_dwordx4 v[28:31], v1, s[4:7], s21 offen offset:3072 sc1
    s_waitcnt vmcnt(0)
    v_max3_u32 v9, v28, v29, v30
    v_max_u32 v9, v9, v31
    v_cmp_eq_u32 vcc, -1, v9
    s_cbranch_vccnz prm_9_3
    s_branch prm_9_3ok
prm_9_3_g:
    s_mov_b32 s26, 0
    s_waitcnt vmcnt(0)
    s_branch prm_9_3ok
prm_9_d:
gate_14:
    v_readfirstlane_b32 s25, v15
    s_cmp_ge_u32 s25, s59
    s_cbranch_scc1 gate_14_ok
    s_sleep 8
    buffer_load_dword v15, off, s[4:7], s58 sc1
    s_waitcnt vmcnt(0)
    s_sub_u32 s26, s26, 1
    s_cbranch_scc0 gate_14
    s_mov_b32 s26, 0
gate_14_ok:
    ds_write_b32 v14, v60
    v_add_f32 v32, v32, v33
    v_add_f32 v34, v34, v35
    ds_write2_b32 v4, v32, v34 offset0:0 offset1:104
    v_add_f32 v36, v36, v37
    v_add_f32 v38, v38, v39
    ds_write2_b32 v4, v36, v38 offset0:16 offset1:120
    v_add_f32 v40, v40, v41
    v_add_f32 v42, v42, v43
    ds_write2_b32 v4, v40, v42 offset0:32 offset1:136
    v_add_f32 v44, v44, v45
    v_add_f32 v46, v46, v47
    ds_write2_b32 v4, v44, v46 offset0:48 offset1:152
    v_add_f32 v48, v48, v49
    v_add_f32 v50, v50, v51
    ds_write2_b32 v4, v48, v50 offset0:64 offset1:168
    v_add_f32 v52, v52, v53
    v_add_f32 v54, v54, v55
    ds_write2_b32 v4, v52, v54 offset0:80 offset1:184
    s_branch pnc_7_done
prp_10:
    s_sub_u32 s26, s26, 1
    s_nop 3
    s_cbranch_scc1 prp_10_g
    buffer_load_dwordx4 v[16:19], v12, s[4:7], s30 offen sc1
    buffer_load_dword v15, off, s[4:7], s58 sc1
    s_branch ploop_6_pagain
prp_10_g:
    s_mov_b32 s26, 0
    s_branch ploop_6_pgo
ploop_6_zr:
    s_sub_u32 s26, s26, 1
    s_cbranch_scc1 ploop_6_zg
    buffer_load_dwordx4 v[32:35], v1, s[4:7], s22 offen offset:0 sc1
    buffer_load_dwordx4 v[36:39], v1, s[4:7], s22 offen offset:1024 sc1
    buffer_load_dwordx4 v[40:43], v1, s[4:7], s22 offen offset:2048 sc1
    buffer_load_dwordx4 v[44:47], v1, s[4:7], s22 offen offset:3072 sc1
    s_branch ploop_6_za
ploop_6_zg:
    s_mov_b32 s26, 0
    s_branch ploop_6_zok
ptail_8:
    s_cmp_eq_u32 s15, 0
    s_cbranch_scc1 ptail_8_nd
    s_nop 0
ptail_8_nd:
    s_barrier
    v_add_u32 v55, s68, v61
    ds_read_b128 v[24:27], v55 offset:0
    ds_read_b128 v[28:31], v55 offset:1024
    ds_read_b128 v[32:35], v55 offset:18560
    ds_read_b128 v[36:39], v55 offset:19584
    ds_read_b128 v[40:43], v55 offset:37120
    ds_read_b128 v[44:47], v55 offset:38144
    ds_read_b128 v[48:51], v55 offset:55680
    ds_read_b128 v[52:55], v55 offset:56704
    s_waitcnt lgkmcnt(4)
    v_add_f32 v24, v24, v32
    v_add_f32 v25, v25, v33
    v_add_f32 v26, v26, v34
    v_add_f32 v27, v27, v35
    v_add_f32 v28, v28, v36
    v_add_f32 v29, v29, v37
    v_add_f32 v30, v30, v38
    v_add_f32 v31, v31, v39
    s_waitcnt lgkmcnt(0)
    v_add_f32 v40, v40, v48
    v_add_f32 v41, v41, v49
    v_add_f32 v42, v42, v50
    v_add_f32 v43, v43, v51
    v_add_f32 v44, v44, v52
    v_add_f32 v45, v45, v53
    v_add_f32 v46, v46, v54
    v_add_f32 v47, v47, v55
    v_add_f32 v24, v24, v40
    v_add_f32 v25, v25, v41
    v_add_f32 v26, v26, v42
    v_add_f32 v27, v27, v43
    v_add_f32 v28, v28, v44
    v_add_f32 v29, v29, v45
    v_add_f32 v30, v30, v46
    v_add_f32 v31, v31, v47
    v_cvt_pk_bf16_f32 v24, v24, v25
    v_cvt_pk_bf16_f32 v25, v26, v27
    v_cvt_pk_bf16_f32 v26, v28, v29
    v_cvt_pk_bf16_f32 v27, v30, v31
    v_min_u32 v24, -2, v24
    v_min_u32 v25, -2, v25
    v_min_u32 v26, -2, v26
    v_min_u32 v27, -2, v27
    buffer_store_dwordx4 v[24:27], v1, s[4:7], s37 offen sc1
    s_branch k_end
ch_p_slow:
    v_mov_b32 v32, 0
    v_mov_b32 v33, 0
    v_mov_b32 v34, 0
    v_mov_b32 v35, 0
    v_mov_b32 v36, 0
    v_mov_b32 v37, 0
    v_mov_b32 v38, 0
    v_mov_b32 v39, 0
    v_mov_b32 v40, 0
    v_mov_b32 v41, 0
    v_mov_b32 v42, 0
    v_mov_b32 v43, 0
    v_mov_b32 v44, 0
    v_mov_b32 v45, 0
    v_mov_b32 v46, 0
    v_mov_b32 v47, 0
    v_mov_b32 v48, 0
    v_mov_b32 v49, 0
    v_mov_b32 v50, 0
    v_mov_b32 v51, 0
    v_mov_b32 v52, 0
    v_mov_b32 v53, 0
    v_mov_b32 v54, 0
    v_mov_b32 v55, 0
    v_mov_b32 v0, 1.0
    s_mov_b32 exec_lo, 0xff00ff00
    s_mov_b32 exec_hi, 0xff00ff00
    v_mov_b32 v0, s47
    s_mov_b64 exec, -1
    v_mov_b32 v60, s16
    v_smfmac_f32_16x16x64_bf16 v[32:35], v[16:19], v[64:71], v62
    v_smfmac_f32_16x16x64_bf16 v[36:39], v[16:19], v[72:79], v62
    v_smfmac_f32_16x16x64_bf16 v[40:43], v[16:19], v[80:87], v62
    v_smfmac_f32_16x16x64_bf16 v[44:47], v[16:19], v[88:95], v62
    v_smfmac_f32_16x16x64_bf16 v[48:51], v[16:19], v[96:103], v62
    v_smfmac_f32_16x16x64_bf16 v[52:55], v[16:19], v[104:111], v62
    v_smfmac_f32_16x16x64_bf16 v[32:35], v[20:23], v[112:119], v62
    v_smfmac_f32_16x16x64_bf16 v[36:39], v[20:23], v[120:127], v62
    v_smfmac_f32_16x16x64_bf16 v[40:43], v[20:23], v[128:135], v62
    v_smfmac_f32_16x16x64_bf16 v[44:47], v[20:23], v[136:143], v62
    v_smfmac_f32_16x16x64_bf16 v[48:51], v[20:23], v[144:151], v62
    v_smfmac_f32_16x16x64_bf16 v[52:55], v[20:23], v[152:159], v62
    v_smfmac_f32_16x16x64_bf16 v[32:35], v[24:27], v[160:167], v62
    v_smfmac_f32_16x16x64_bf16 v[36:39], v[24:27], v[168:175], v62
    v_smfmac_f32_16x16x64_bf16 v[40:43], v[24:27], v[176:183], v62
    v_smfmac_f32_16x16x64_bf16 v[44:47], v[24:27], v[184:191], v62
    v_smfmac_f32_16x16x64_bf16 v[48:51], v[24:27], v[192:199], v62
    v_smfmac_f32_16x16x64_bf16 v[52:55], v[24:27], v[200:207], v62
    v_smfmac_f32_16x16x64_bf16 v[32:35], v[28:31], v[208:215], v62
    ds_write_b32 v14, v60
    v_smfmac_f32_16x16x64_bf16 v[36:39], v[28:31], v[216:223], v62
    v_smfmac_f32_16x16x64_bf16 v[40:43], v[28:31], v[224:231], v62
    v_smfmac_f32_16x16x64_bf16 v[44:47], v[28:31], v[232:239], v62
    v_add_f32 v32, v32, v33
    v_add_f32 v34, v34, v35
    v_smfmac_f32_16x16x64_bf16 v[48:51], v[28:31], v[240:247], v62
    v_add_f32 v36, v36, v37
    v_add_f32 v38, v38, v39
    ds_write2_b32 v4, v32, v34 offset0:0 offset1:104
    v_smfmac_f32_16x16x64_bf16 v[52:55], v[28:31], v[248:255], v62
    v_add_f32 v40, v40, v41
    v_add_f32 v42, v42, v43
    ds_write2_b32 v4, v36, v38 offset0:16 offset1:120
    v_add_f32 v44, v44, v45
    v_add_f32 v46, v46, v47
    ds_write2_b32 v4, v40, v42 offset0:32 offset1:136
    v_add_f32 v48, v48, v49
    v_add_f32 v50, v50, v51
    ds_write2_b32 v4, v44, v46 offset0:48 offset1:152
    v_add_f32 v52, v52, v53
    v_add_f32 v54, v54, v55
    ds_write2_b32 v4, v48, v50 offset0:64 offset1:168
    ds_write2_b32 v4, v52, v54 offset0:80 offset1:184
    s_waitcnt vmcnt(0)
    s_branch pnc_16_done
.p2align 6
    s_nop 0
    s_nop 0
    s_nop 0
    s_nop 0
    s_nop 0
    s_nop 0
    s_nop 0
    s_nop 0
ploop_15:
    s_add_u32 s21, s17, s33
    s_nop 15
    s_nop 5
    buffer_load_dwordx4 v[16:19], v1, s[4:7], s21 offen offset:0 sc1
    s_nop 7
    buffer_load_dwordx4 v[20:23], v1, s[4:7], s21 offen offset:1024 sc1
    s_nop 7
    buffer_load_dwordx4 v[24:27], v1, s[4:7], s21 offen offset:2048 sc1
    s_nop 7
    buffer_load_dwordx4 v[28:31], v1, s[4:7], s21 offen offset:3072 sc1
    s_waitcnt vmcnt(3)
    v_max3_u32 v9, v16, v17, v18
    v_max_u32 v9, v9, v19
    v_cmp_eq_u32 vcc, -1, v9
    s_cbranch_vccnz prm_18_0
prm_18_0ok:
    v_smfmac_f32_16x16x64_bf16 v[32:35], v[16:19], v[64:71], v62
    v_smfmac_f32_16x16x64_bf16 v[36:39], v[16:19], v[72:79], v62
    v_smfmac_f32_16x16x64_bf16 v[40:43], v[16:19], v[80:87], v62
    s_waitcnt vmcnt(2)
    v_max3_u32 v9, v20, v21, v22
    v_max_u32 v9, v9, v23
    v_cmp_eq_u32 vcc, -1, v9
    v_smfmac_f32_16x16x64_bf16 v[44:47], v[16:19], v[88:95], v62
    v_smfmac_f32_16x16x64_bf16 v[48:51], v[16:19], v[96:103], v62
    v_smfmac_f32_16x16x64_bf16 v[52:55], v[16:19], v[104:111], v62
    s_cbranch_vccnz prm_18_1
prm_18_1ok:
    v_smfmac_f32_16x16x64_bf16 v[32:35], v[20:23], v[112:119], v62
    v_readfirstlane_b32 s23, v15
    v_smfmac_f32_16x16x64_bf16 v[36:39], v[20:23], v[120:127], v62
    v_smfmac_f32_16x16x64_bf16 v[40:43], v[20:23], v[128:135], v62
    s_waitcnt vmcnt(1)
    v_max3_u32 v9, v24, v25, v26
    v_max_u32 v9, v9, v27
    v_cmp_eq_u32 vcc, -1, v9
    v_smfmac_f32_16x16x64_bf16 v[44:47], v[20:23], v[136:143], v62
    v_smfmac_f32_16x16x64_bf16 v[48:51], v[20:23], v[144:151], v62
    v_smfmac_f32_16x16x64_bf16 v[52:55], v[20:23], v[152:159], v62
    s_cbranch_vccnz prm_18_2
prm_18_2ok:
    v_smfmac_f32_16x16x64_bf16 v[32:35], v[24:27], v[160:167], v62
    v_smfmac_f32_16x16x64_bf16 v[36:39], v[24:27], v[168:175], v62
    v_smfmac_f32_16x16x64_bf16 v[40:43], v[24:27], v[176:183], v62
    s_waitcnt vmcnt(0)
    v_max3_u32 v9, v28, v29, v30
    v_max_u32 v9, v9, v31
    v_cmp_eq_u32 vcc, -1, v9
    v_smfmac_f32_16x16x64_bf16 v[44:47], v[24:27], v[184:191], v62
    v_smfmac_f32_16x16x64_bf16 v[48:51], v[24:27], v[192:199], v62
    v_smfmac_f32_16x16x64_bf16 v[52:55], v[24:27], v[200:207], v62
    s_cbranch_vccnz prm_18_3
prm_18_3ok:
    v_smfmac_f32_16x16x64_bf16 v[32:35], v[28:31], v[208:215], v62
    s_cmp_lt_u32 s23, s59
    s_cbranch_scc1 prm_18_gt
prm_18_gtb:
    ds_write_b32 v14, v60
    v_smfmac_f32_16x16x64_bf16 v[36:39], v[28:31], v[216:223], v62
    v_smfmac_f32_16x16x64_bf16 v[40:43], v[28:31], v[224:231], v62
    v_smfmac_f32_16x16x64_bf16 v[44:47], v[28:31], v[232:239], v62
    v_add_f32 v32, v32, v33
    v_add_f32 v34, v34, v35
    v_smfmac_f32_16x16x64_bf16 v[48:51], v[28:31], v[240:247], v62
    v_add_f32 v36, v36, v37
    v_add_f32 v38, v38, v39
    ds_write2_b32 v4, v32, v34 offset0:0 offset1:104
    v_smfmac_f32_16x16x64_bf16 v[52:55], v[28:31], v[248:255], v62
    v_add_f32 v40, v40, v41
    v_add_f32 v42, v42, v43
    ds_write2_b32 v4, v36, v38 offset0:16 offset1:120
    v_add_f32 v44, v44, v45
    v_add_f32 v46, v46, v47
    ds_write2_b32 v4, v40, v42 offset0:32 offset1:136
    v_add_f32 v48, v48, v49
    v_add_f32 v50, v50, v51
    ds_write2_b32 v4, v44, v46 offset0:48 offset1:152
    v_add_f32 v52, v52, v53
    v_add_f32 v54, v54, v55
    ds_write2_b32 v4, v48, v50 offset0:64 offset1:168
    ds_write2_b32 v4, v52, v54 offset0:80 offset1:184
pnc_16_done:
    s_add_u32 s21, s17, s32
    s_add_u32 s22, s19, s32
    s_add_u32 s24, s19, s35
    s_waitcnt lgkmcnt(0)
    s_barrier
    ds_read_b64 v[32:33], v5 offset:0
    ds_read_b64 v[34:35], v5 offset:3328
    ds_read_b64 v[36:37], v5 offset:6656
    ds_read_b64 v[38:39], v5 offset:9984
    ds_read_b64 v[40:41], v6 offset:0
    ds_read_b64 v[42:43], v6 offset:3328
    ds_read_b64 v[44:45], v6 offset:6656
    ds_read_b64 v[46:47], v6 offset:9984
    s_waitcnt lgkmcnt(6)
    v_add_f32 v32, v32, v34
    v_add_f32 v33, v33, v35
    v_mul_f32 v32, v32, v0
    v_mul_f32 v33, v33, v0
    s_waitcnt lgkmcnt(4)
    v_add_f32 v36, v36, v38
    v_add_f32 v37, v37, v39
    v_fma_f32 v32, v36, v0, v32
    v_fma_f32 v33, v37, v0, v33
    v_cvt_pk_bf16_f32 v32, v32, v33
    v_min_u32 v32, -2, v32
    buffer_store_dword v32, v2, s[4:7], s21 offen sc1
    s_waitcnt lgkmcnt(2)
    v_add_f32 v40, v40, v42
    v_add_f32 v41, v41, v43
    s_waitcnt lgkmcnt(0)
    v_add_f32 v44, v44, v46
    v_add_f32 v45, v45, v47
    v_add_f32 v40, v40, v44
    v_add_f32 v41, v41, v45
    v_cvt_pk_bf16_f32 v40, v40, v41
    v_min_u32 v40, -2, v40
    s_mov_b32 exec_hi, 0
    buffer_store_dword v40, v3, s[4:7], s21 offen sc1
    s_setprio 0
    s_mov_b64 exec, -1
    s_add_u32 s21, s17, s35
    s_add_u32 s30, s17, s34
    s_add_u32 s23, s18, s36
    s_cmp_lg_u32 s16, 0
    s_cbranch_scc1 ploop_15_n0
gate_20:
    v_readfirstlane_b32 s25, v15
    s_cmp_ge_u32 s25, s59
    s_cbranch_scc1 gate_20_ok
    s_sleep 8
    buffer_load_dword v15, off, s[4:7], s58 sc1
    s_waitcnt vmcnt(0)
    s_sub_u32 s26, s26, 1
    s_cbranch_scc0 gate_20
    s_mov_b32 s26, 0
gate_20_ok:
    s_cmp_eq_u32 s15, 0
    s_cbranch_scc1 ploop_15_st_nk
    s_add_u32 m0, s53, 0
    s_add_u32 s22, s52, 0
    buffer_load_dwordx4 v1, s[4:7], s22 offen offset:0 sc1 lds
    buffer_load_dwordx4 v1, s[4:7], s22 offen offset:1024 sc1 lds
    buffer_load_dwordx4 v1, s[4:7], s22 offen offset:2048 sc1 lds
    buffer_load_dwordx4 v1, s[4:7], s22 offen offset:3072 sc1 lds
    s_add_u32 m0, s53, 4096
    s_add_u32 s22, s52, 131072
    buffer_load_dwordx4 v1, s[4:7], s22 offen offset:0 sc1 lds
    buffer_load_dwordx4 v1, s[4:7], s22 offen offset:1024 sc1 lds
    buffer_load_dwordx4 v1, s[4:7], s22 offen offset:2048 sc1 lds
    buffer_load_dwordx4 v1, s[4:7], s22 offen offset:3072 sc1 lds
    s_add_u32 s52, s52, 262144
    s_sub_u32 s52, s52, 262144
ploop_15_st_nk:
    s_add_u32 s52, s52, 262144
    s_cmp_lg_u32 s3, 2
    s_cbranch_scc1 ploop_15_st_npf
    v_subrev_u32 v32, 524288, v63
    s_mov_b32 exec_hi, 0xffff
    s_mov_b32 s22, 262144
    buffer_load_dword v33, v32, s[4:7], s22 offen sc1
    s_mov_b32 exec_hi, -1
    s_waitcnt vmcnt(0)
ploop_15_st_npf:
    s_cmp_eq_u32 s15, 0
    s_cbranch_scc1 ploop_15_st_p_nd
    s_mov_b32 m0, 124928
    s_nop 0
    buffer_load_dwordx4 v1, s[4:7], s69 offen offset:0 sc1 lds
    buffer_load_dwordx4 v1, s[4:7], s69 offen offset:1024 sc1 lds
    buffer_load_dwordx4 v1, s[4:7], s69 offen offset:2048 sc1 lds
    buffer_load_dwordx4 v1, s[4:7], s69 offen offset:3072 sc1 lds
    s_add_u32 s69, s69, 262144
    s_waitcnt vmcnt(0)
ploop_15_st_p_nd:
ploop_15_n0:
    s_add_u32 s25, s16, 2
    s_min_u32 s25, s25, 63
    s_cmp_lt_u32 s25, 8
    s_cselect_b32 s59, 12, 24
    s_cselect_b32 s58, -4, -8
    s_and_b32 s25, s25, s58
    s_lshl_b32 s25, s25, 5
    s_add_u32 s58, s25, s60
    s_cmp_eq_u32 s15, 0
    s_cbranch_scc1 ploop_15_nd
    v_add_u32 v9, s53, v1
    v_add_u32 v0, 124928, v1
    ds_read_b128 v[16:19], v0 offset:0
    ds_read_b128 v[32:35], v9 offset:0
    ds_read_b128 v[20:23], v0 offset:1024
    ds_read_b128 v[36:39], v9 offset:1024
    ds_read_b128 v[24:27], v0 offset:2048
    ds_read_b128 v[40:43], v9 offset:2048
    ds_read_b128 v[28:31], v0 offset:3072
    ds_read_b128 v[44:47], v9 offset:3072
    s_add_u32 s22, s17, s61
    s_waitcnt lgkmcnt(6)
    v_mfma_f32_16x16x32_bf16 v[48:51], v[32:35], v[16:19], 0
    ds_read_b128 v[32:35], v9 offset:4096
    s_waitcnt lgkmcnt(5)
    v_mfma_f32_16x16x32_bf16 v[48:51], v[36:39], v[20:23], v[48:51]
    ds_read_b128 v[36:39], v9 offset:5120
    s_waitcnt lgkmcnt(4)
    v_mfma_f32_16x16x32_bf16 v[48:51], v[40:43], v[24:27], v[48:51]
    ds_read_b128 v[40:43], v9 offset:6144
    s_waitcnt lgkmcnt(3)
    v_mfma_f32_16x16x32_bf16 v[48:51], v[44:47], v[28:31], v[48:51]
    ds_read_b128 v[44:47], v9 offset:7168
    s_waitcnt lgkmcnt(3)
    v_mfma_f32_16x16x32_bf16 v[52:55], v[32:35], v[16:19], 0
    s_waitcnt lgkmcnt(2)
    v_mfma_f32_16x16x32_bf16 v[52:55], v[36:39], v[20:23], v[52:55]
    s_waitcnt lgkmcnt(1)
    v_mfma_f32_16x16x32_bf16 v[52:55], v[40:43], v[24:27], v[52:55]
    s_waitcnt lgkmcnt(0)
    v_mfma_f32_16x16x32_bf16 v[52:55], v[44:47], v[28:31], v[52:55]
    buffer_load_dwordx4 v[32:35], v1, s[4:7], s22 offen offset:0 sc1
    buffer_load_dwordx4 v[36:39], v1, s[4:7], s22 offen offset:1024 sc1
    buffer_load_dwordx4 v[40:43], v1, s[4:7], s22 offen offset:2048 sc1
    buffer_load_dwordx4 v[44:47], v1, s[4:7], s22 offen offset:3072 sc1
    v_mov_b32 v60, 0xff61b1e6
    s_nop 2
    v_cndmask_b32 v48, v48, v60, s[38:39]
    v_cndmask_b32 v49, v49, v60, s[40:41]
    v_cndmask_b32 v50, v50, v60, s[42:43]
    v_cndmask_b32 v51, v51, v60, s[44:45]
    v_cndmask_b32 v52, v52, v60, s[48:49]
    v_cndmask_b32 v53, v53, v60, s[50:51]
    v_cndmask_b32 v54, v54, v60, s[54:55]
    v_cndmask_b32 v55, v55, v60, s[56:57]
    v_max3_f32 v0, v48, v49, v50
    v_max3_f32 v9, v51, v52, v53
    v_max3_f32 v0, v0, v54, v55
    v_max_f32 v0, v0, v9
    v_mov_b32 v9, v0
    s_nop 1
    v_permlane16_swap_b32 v9, v0
    v_max_f32 v0, v0, v9
    v_mov_b32 v9, v0
    s_nop 1
    v_permlane32_swap_b32 v9, v0
    v_max_f32 v0, v0, v9
    v_mul_f32 v0, s47, v0
    v_fma_f32 v48, v48, s47, -v0
    v_fma_f32 v49, v49, s47, -v0
    v_fma_f32 v50, v50, s47, -v0
    v_fma_f32 v51, v51, s47, -v0
    v_fma_f32 v52, v52, s47, -v0
    v_fma_f32 v53, v53, s47, -v0
    v_fma_f32 v54, v54, s47, -v0
    v_fma_f32 v55, v55, s47, -v0
    v_exp_f32 v48, v48
    v_exp_f32 v49, v49
    v_exp_f32 v50, v50
    v_exp_f32 v51, v51
    v_exp_f32 v52, v52
    v_exp_f32 v53, v53
    v_exp_f32 v54, v54
    v_exp_f32 v55, v55
    v_add_f32 v15, v48, v49
    v_add_f32 v15, v15, v50
    v_add_f32 v15, v15, v51
    v_add_f32 v15, v15, v52
    v_add_f32 v15, v15, v53
    v_add_f32 v15, v15, v54
    v_add_f32 v15, v15, v55
ploop_15_za:
    s_waitcnt vmcnt(0)
    v_max3_u32 v9, v32, v33, v34
    v_max3_u32 v9, v9, v35, v36
    v_max3_u32 v9, v9, v37, v38
    v_max3_u32 v9, v9, v39, v40
    v_max3_u32 v9, v9, v41, v42
    v_max3_u32 v9, v9, v43, v44
    v_max3_u32 v9, v9, v45, v46
    v_max_u32 v9, v9, v47
    v_cmp_eq_u32 vcc, -1, v9
    s_cbranch_vccnz ploop_15_zr
ploop_15_zok:
    s_setprio 1
    v_mfma_f32_16x16x32_bf16 v[56:59], v[32:35], v[16:19], 0
    v_mfma_f32_16x16x32_bf16 v[56:59], v[36:39], v[20:23], v[56:59]
    v_mfma_f32_16x16x32_bf16 v[56:59], v[40:43], v[24:27], v[56:59]
    v_mfma_f32_16x16x32_bf16 v[56:59], v[44:47], v[28:31], v[56:59]
    s_add_u32 s22, s17, s14
    s_nop 6
    v_max_f32 v60, v56, v57
    v_mov_b32 v9, v60
    s_nop 1
    v_permlane16_swap_b32 v9, v60
    v_max_f32 v60, v60, v9
    v_mov_b32 v9, v60
    s_nop 1
    v_permlane32_swap_b32 v9, v60
    v_max_f32 v60, v60, v9
    v_mul_f32 v60, s47, v60
    v_max_f32 v58, v60, v0
    v_sub_f32 v60, v0, v58
    v_fma_f32 v56, v56, s47, -v58
    v_fma_f32 v57, v57, s47, -v58
    v_exp_f32 v60, v60
    v_exp_f32 v56, v56
    v_exp_f32 v57, v57
    v_fma_f32 v15, v15, v60, v56
    v_add_f32 v15, v15, v57
    v_mov_b32 v9, v15
    s_nop 1
    v_permlane16_swap_b32 v9, v15
    v_add_f32 v15, v15, v9
    v_mov_b32 v9, v15
    s_nop 1
    v_permlane32_swap_b32 v9, v15
    v_add_f32 v15, v15, v9
    v_rcp_f32 v15, v15
    s_add_u32 s25, s19, s14
    v_mul_f32 v56, v56, v15
    v_mul_f32 v57, v57, v15
    v_mul_f32 v60, v60, v15
    v_mul_f32 v48, v48, v60
    v_mul_f32 v49, v49, v60
    v_mul_f32 v50, v50, v60
    v_mul_f32 v51, v51, v60
    v_mul_f32 v52, v52, v60
    v_mul_f32 v53, v53, v60
    v_mul_f32 v54, v54, v60
    v_mul_f32 v55, v55, v60
    v_cvt_pk_bf16_f32 v48, v48, v49
    v_cvt_pk_bf16_f32 v49, v50, v51
    v_cvt_pk_bf16_f32 v50, v52, v53
    v_cvt_pk_bf16_f32 v51, v54, v55
    v_min_u32 v48, -2, v48
    v_min_u32 v49, -2, v49
    v_min_u32 v50, -2, v50
    v_min_u32 v51, -2, v51
    v_lshlrev_b32 v54, 1, v8
    v_add_u32 v55, 14336, v1
    v_mov_b32 v53, 1.0
    v_cvt_pk_bf16_f32 v52, v56, v57
    v_min_u32 v53, -2, v53
    v_min_u32 v52, -2, v52
    buffer_store_dwordx4 v[48:51], v1, s[4:7], s22 offen sc1
    buffer_store_dwordx2 v[52:53], v54, s[4:7], s22 offen offset:1024 sc1
    ds_read_b128 v[56:59], v55
    s_branch ploop_15_nd2
ploop_15_nd:
    s_cmp_eq_u32 s16, 0
    s_cbranch_scc1 ploop_15_ns
    s_cmp_eq_u32 s31, 0
    s_cbranch_scc1 ploop_15_n2
    s_add_u32 s25, s68, s46
    v_add_u32 v55, s25, v61
    ds_read_b128 v[24:27], v55 offset:0
    ds_read_b128 v[28:31], v55 offset:1024
    ds_read_b128 v[32:35], v55 offset:18560
    ds_read_b128 v[36:39], v55 offset:19584
    ds_read_b128 v[40:43], v55 offset:37120
    ds_read_b128 v[44:47], v55 offset:38144
    ds_read_b128 v[48:51], v55 offset:55680
    ds_read_b128 v[52:55], v55 offset:56704
    s_waitcnt lgkmcnt(4)
    v_add_f32 v24, v24, v32
    v_add_f32 v25, v25, v33
    v_add_f32 v26, v26, v34
    v_add_f32 v27, v27, v35
    v_add_f32 v28, v28, v36
    v_add_f32 v29, v29, v37
    v_add_f32 v30, v30, v38
    v_add_f32 v31, v31, v39
    s_waitcnt lgkmcnt(0)
    v_add_f32 v40, v40, v48
    v_add_f32 v41, v41, v49
    v_add_f32 v42, v42, v50
    v_add_f32 v43, v43, v51
    v_add_f32 v44, v44, v52
    v_add_f32 v45, v45, v53
    v_add_f32 v46, v46, v54
    v_add_f32 v47, v47, v55
    v_add_f32 v24, v24, v40
    v_add_f32 v25, v25, v41
    v_add_f32 v26, v26, v42
    v_add_f32 v27, v27, v43
    v_add_f32 v28, v28, v44
    v_add_f32 v29, v29, v45
    v_add_f32 v30, v30, v46
    v_add_f32 v31, v31, v47
    v_cvt_pk_bf16_f32 v24, v24, v25
    v_cvt_pk_bf16_f32 v25, v26, v27
    v_cvt_pk_bf16_f32 v26, v28, v29
    v_cvt_pk_bf16_f32 v27, v30, v31
    v_min_u32 v24, -2, v24
    v_min_u32 v25, -2, v25
    v_min_u32 v26, -2, v26
    v_min_u32 v27, -2, v27
    v_mov_b32 v16, v24
    v_mov_b32 v17, v25
    v_mov_b32 v18, v26
    v_mov_b32 v19, v27
ploop_15_n2:
    v_add_u32 v55, s68, v61
    ds_read_b128 v[24:27], v55 offset:0
    ds_read_b128 v[28:31], v55 offset:1024
    ds_read_b128 v[32:35], v55 offset:18560
    ds_read_b128 v[36:39], v55 offset:19584
    ds_read_b128 v[40:43], v55 offset:37120
    ds_read_b128 v[44:47], v55 offset:38144
    ds_read_b128 v[48:51], v55 offset:55680
    ds_read_b128 v[52:55], v55 offset:56704
    s_waitcnt lgkmcnt(4)
    v_add_f32 v24, v24, v32
    v_add_f32 v25, v25, v33
    v_add_f32 v26, v26, v34
    v_add_f32 v27, v27, v35
    v_add_f32 v28, v28, v36
    v_add_f32 v29, v29, v37
    v_add_f32 v30, v30, v38
    v_add_f32 v31, v31, v39
    s_waitcnt lgkmcnt(0)
    v_add_f32 v40, v40, v48
    v_add_f32 v41, v41, v49
    v_add_f32 v42, v42, v50
    v_add_f32 v43, v43, v51
    v_add_f32 v44, v44, v52
    v_add_f32 v45, v45, v53
    v_add_f32 v46, v46, v54
    v_add_f32 v47, v47, v55
    v_add_f32 v24, v24, v40
    v_add_f32 v25, v25, v41
    v_add_f32 v26, v26, v42
    v_add_f32 v27, v27, v43
    v_add_f32 v28, v28, v44
    v_add_f32 v29, v29, v45
    v_add_f32 v30, v30, v46
    v_add_f32 v31, v31, v47
    v_cvt_pk_bf16_f32 v24, v24, v25
    v_cvt_pk_bf16_f32 v25, v26, v27
    v_cvt_pk_bf16_f32 v26, v28, v29
    v_cvt_pk_bf16_f32 v27, v30, v31
    v_min_u32 v24, -2, v24
    v_min_u32 v25, -2, v25
    v_min_u32 v26, -2, v26
    v_min_u32 v27, -2, v27
ploop_15_ns:
ploop_15_flag:
    ds_read_b32 v9, v14 offset:16
    s_waitcnt lgkmcnt(0)
    v_readfirstlane_b32 s25, v9
    s_cmp_eq_u32 s25, s16
    s_cbranch_scc0 ploop_15_flag
    s_add_u32 m0, s53, 0
    s_add_u32 s22, s52, 0
    buffer_load_dwordx4 v1, s[4:7], s22 offen offset:0 sc1 lds
    buffer_load_dwordx4 v1, s[4:7], s22 offen offset:1024 sc1 lds
    buffer_load_dwordx4 v1, s[4:7], s22 offen offset:2048 sc1 lds
    buffer_load_dwordx4 v1, s[4:7], s22 offen offset:3072 sc1 lds
    s_add_u32 m0, s53, 4096
    s_add_u32 s22, s52, 131072
    buffer_load_dwordx4 v1, s[4:7], s22 offen offset:0 sc1 lds
    buffer_load_dwordx4 v1, s[4:7], s22 offen offset:1024 sc1 lds
    buffer_load_dwordx4 v1, s[4:7], s22 offen offset:2048 sc1 lds
    buffer_load_dwordx4 v1, s[4:7], s22 offen offset:3072 sc1 lds
    s_add_u32 s52, s52, 262144
ploop_15_nk:
    s_cmp_eq_u32 s16, 0
    s_cbranch_scc1 ploop_15_nd2
    buffer_store_dwordx4 v[24:27], v1, s[4:7], s37 offen sc1
    s_cmp_eq_u32 s31, 0
    s_cbranch_scc1 ploop_15_nd2
    s_add_u32 s25, s37, s27
    buffer_store_dwordx4 v[16:19], v1, s[4:7], s25 offen sc1
ploop_15_nd2:
    s_cmp_eq_u32 s16, 0
    s_cbranch_scc1 ploop_15_nn
    s_add_u32 s37, s37, 65536
    s_xor_b32 s68, s68, 8192
ploop_15_nn:
    s_cmp_lg_u32 s3, s8
    s_cbranch_scc1 ppf_21
    s_lshl_b32 s22, s16, 18
    s_mov_b32 exec_hi, 0xffff
    buffer_load_dword v9, v63, s[4:7], s22 offen sc1
    s_mov_b32 exec_hi, -1
ppf_21:
    v_add_u32 v24, 18560, v7
    v_add_u32 v25, 37120, v7
    v_add_u32 v26, 55680, v7
    s_cmp_eq_u32 s16, 63
    s_setprio 3
    s_barrier
    s_cbranch_scc1 ptail_17
    ds_read2_b32 v[16:17], v7 offset0:0 offset1:2
    ds_read2_b32 v[18:19], v24 offset0:0 offset1:2
    ds_read2_b32 v[20:21], v25 offset0:0 offset1:2
    ds_read2_b32 v[22:23], v26 offset0:0 offset1:2
    s_waitcnt lgkmcnt(2)
    v_add_f32 v16, v16, v18
    v_add_f32 v17, v17, v19
    s_waitcnt lgkmcnt(0)
    v_add_f32 v20, v20, v22
    v_add_f32 v21, v21, v23
    v_add_f32 v16, v16, v20
    v_add_f32 v17, v17, v21
    v_cvt_pk_bf16_f32 v16, v16, v17
    v_min_u32 v16, -2, v16
    buffer_store_dword v16, v2, s[4:7], s21 offen sc1
    buffer_store_dword v10, v2, s[4:7], s24 offen sc1
    s_cmp_eq_u32 s15, 0
    s_cbranch_scc1 ploop_15_pnd
    s_sleep 6
    s_nop 8
    buffer_load_dwordx4 v[16:19], v12, s[4:7], s30 offen sc1
    buffer_load_dword v15, off, s[4:7], s58 sc1
    s_add_u32 s25, s19, s14
    v_mov_b32 v20, -1
    v_mov_b32 v21, -1
    v_mov_b32 v22, -1
    v_mov_b32 v23, -1
    buffer_store_dwordx4 v[20:23], v1, s[4:7], s25 offen sc1
    buffer_store_dwordx2 v[20:21], v54, s[4:7], s25 offen offset:1024 sc1
    s_mov_b32 m0, 124928
    s_nop 0
    buffer_load_dwordx4 v1, s[4:7], s69 offen offset:0 sc1 lds
    buffer_load_dwordx4 v1, s[4:7], s69 offen offset:1024 sc1 lds
    buffer_load_dwordx4 v1, s[4:7], s69 offen offset:2048 sc1 lds
    buffer_load_dwordx4 v1, s[4:7], s69 offen offset:3072 sc1 lds
    s_add_u32 s69, s69, 262144
    s_add_u32 m0, s53, 0
    s_add_u32 s22, s52, 0
    buffer_load_dwordx4 v1, s[4:7], s22 offen offset:0 sc1 lds
    buffer_load_dwordx4 v1, s[4:7], s22 offen offset:1024 sc1 lds
    buffer_load_dwordx4 v1, s[4:7], s22 offen offset:2048 sc1 lds
    buffer_load_dwordx4 v1, s[4:7], s22 offen offset:3072 sc1 lds
    s_add_u32 m0, s53, 4096
    s_add_u32 s22, s52, 131072
    buffer_load_dwordx4 v1, s[4:7], s22 offen offset:0 sc1 lds
    buffer_load_dwordx4 v1, s[4:7], s22 offen offset:1024 sc1 lds
    buffer_load_dwordx4 v1, s[4:7], s22 offen offset:2048 sc1 lds
    buffer_load_dwordx4 v1, s[4:7], s22 offen offset:3072 sc1 lds
    s_add_u32 s52, s52, 262144
    s_add_u32 s22, s16, 1
    v_mov_b32 v60, s22
    v_mov_b32 v32, 0
    v_mov_b32 v33, 0
    v_mov_b32 v34, 0
    v_mov_b32 v35, 0
    v_mov_b32 v36, 0
    v_mov_b32 v37, 0
    v_mov_b32 v38, 0
    v_mov_b32 v39, 0
    v_mov_b32 v40, 0
    v_mov_b32 v41, 0
    v_mov_b32 v42, 0
    v_mov_b32 v43, 0
    v_mov_b32 v44, 0
    v_mov_b32 v45, 0
    v_mov_b32 v46, 0
    v_mov_b32 v47, 0
    v_mov_b32 v48, 0
    v_mov_b32 v49, 0
    v_mov_b32 v50, 0
    v_mov_b32 v51, 0
    v_mov_b32 v52, 0
    v_mov_b32 v53, 0
    v_mov_b32 v54, 0
    v_mov_b32 v55, 0
    v_mov_b32 v0, 1.0
    s_mov_b32 exec_lo, 0xff00ff00
    s_mov_b32 exec_hi, 0xff00ff00
    v_mov_b32 v0, s47
    s_mov_b64 exec, -1
    s_waitcnt vmcnt(15) lgkmcnt(0)
    v_mfma_f32_16x16x32_bf16 v[20:23], v[56:59], v[16:19], 0
    v_max3_u32 v9, v16, v17, v18
    v_max_u32 v9, v9, v19
    v_cmp_eq_u32 vcc, -1, v9
    s_cbranch_vccnz prp_19
    s_nop 3
    v_add_f32_dpp v20, v20, v20 row_ror:8 row_mask:0xf bank_mask:0xf
    v_add_f32_dpp v21, v21, v21 row_ror:8 row_mask:0xf bank_mask:0xf
    v_add_f32_dpp v22, v22, v22 row_ror:8 row_mask:0xf bank_mask:0xf
    v_add_f32_dpp v23, v23, v23 row_ror:8 row_mask:0xf bank_mask:0xf
    v_cvt_pk_bf16_f32 v20, v20, v21
    v_cvt_pk_bf16_f32 v21, v22, v23
    s_mov_b32 exec_hi, 0
    v_min_u32 v20, -2, v20
    v_min_u32 v21, -2, v21
    s_mov_b32 exec_lo, 0x00ff00ff
    buffer_store_dwordx2 v[20:21], v13, s[4:7], s23 offen sc1
    s_mov_b64 exec, -1
    s_branch ploop_15_pst
ploop_15_pnd:
    s_sleep 6
    s_nop 8
    buffer_load_dwordx4 v[16:19], v12, s[4:7], s30 offen sc1
    buffer_load_dword v15, off, s[4:7], s58 sc1
    s_add_u32 s22, s16, 1
    v_mov_b32 v60, s22
    v_mov_b32 v32, 0
    v_mov_b32 v33, 0
    v_mov_b32 v34, 0
    v_mov_b32 v35, 0
    v_mov_b32 v36, 0
    v_mov_b32 v37, 0
    v_mov_b32 v38, 0
    v_mov_b32 v39, 0
    v_mov_b32 v40, 0
    v_mov_b32 v41, 0
    v_mov_b32 v42, 0
    v_mov_b32 v43, 0
    v_mov_b32 v44, 0
    v_mov_b32 v45, 0
    v_mov_b32 v46, 0
    v_mov_b32 v47, 0
    v_mov_b32 v48, 0
    v_mov_b32 v49, 0
    v_mov_b32 v50, 0
    v_mov_b32 v51, 0
    v_mov_b32 v52, 0
    v_mov_b32 v53, 0
    v_mov_b32 v54, 0
    v_mov_b32 v55, 0
    v_mov_b32 v0, 1.0
    s_mov_b32 exec_lo, 0xff00ff00
    s_mov_b32 exec_hi, 0xff00ff00
    v_mov_b32 v0, s47
    s_mov_b64 exec, -1
ploop_15_pagain:
    s_waitcnt vmcnt(1) lgkmcnt(0)
    v_mfma_f32_16x16x32_bf16 v[20:23], v[56:59], v[16:19], 0
    v_max3_u32 v9, v16, v17, v18
    v_max_u32 v9, v9, v19
    v_cmp_eq_u32 vcc, -1, v9
    s_cbranch_vccnz prp_19
ploop_15_pgo:
    s_nop 3
    v_add_f32_dpp v20, v20, v20 row_ror:8 row_mask:0xf bank_mask:0xf
    v_add_f32_dpp v21, v21, v21 row_ror:8 row_mask:0xf bank_mask:0xf
    v_add_f32_dpp v22, v22, v22 row_ror:8 row_mask:0xf bank_mask:0xf
    v_add_f32_dpp v23, v23, v23 row_ror:8 row_mask:0xf bank_mask:0xf
    v_cvt_pk_bf16_f32 v20, v20, v21
    v_cvt_pk_bf16_f32 v21, v22, v23
    s_mov_b32 exec_hi, 0
    v_min_u32 v20, -2, v20
    v_min_u32 v21, -2, v21
    s_mov_b32 exec_lo, 0x00ff00ff
    buffer_store_dwordx2 v[20:21], v13, s[4:7], s23 offen sc1
    s_mov_b64 exec, -1
ploop_15_pst:
    s_add_u32 s22, s19, s32
    s_add_u32 s25, s20, s36
    buffer_store_dword v10, v2, s[4:7], s22 offen sc1
    s_mov_b32 exec_hi, 0
    buffer_store_dword v10, v3, s[4:7], s22 offen sc1
    s_mov_b32 exec_lo, 0x00ff00ff
    buffer_store_dwordx2 v[10:11], v13, s[4:7], s25 offen sc1
    s_mov_b64 exec, -1
    s_add_u32 s16, s16, 1
    s_mov_b32 s17, s18
    s_mov_b32 s18, s19
    s_mov_b32 s19, s20
    s_add_u32 s20, s20, 262144
    s_cmp_eq_u32 s20, 210763776
    s_cselect_b32 s20, 209715200, s20
    s_branch ploop_15
prm_18_gt:
gate_22:
    v_readfirstlane_b32 s25, v15
    s_cmp_ge_u32 s25, s59
    s_cbranch_scc1 gate_22_ok
    s_sleep 8
    buffer_load_dword v15, off, s[4:7], s58 sc1
    s_waitcnt vmcnt(0)
    s_sub_u32 s26, s26, 1
    s_cbranch_scc0 gate_22
    s_mov_b32 s26, 0
gate_22_ok:
    s_branch prm_18_gtb
prm_18_0:
    s_sub_u32 s26, s26, 1
    s_cbranch_scc1 prm_18_0_g
    buffer_load_dwordx4 v[16:19], v1, s[4:7], s21 offen offset:0 sc1
    buffer_load_dwordx4 v[20:23], v1, s[4:7], s21 offen offset:1024 sc1
    buffer_load_dwordx4 v[24:27], v1, s[4:7], s21 offen offset:2048 sc1
    buffer_load_dwordx4 v[28:31], v1, s[4:7], s21 offen offset:3072 sc1
    s_waitcnt vmcnt(3)
    v_max3_u32 v9, v16, v17, v18
    v_max_u32 v9, v9, v19
    v_cmp_eq_u32 vcc, -1, v9
    s_cbranch_vccnz prm_18_0
    s_branch prm_18_0ok
prm_18_0_g:
    s_mov_b32 s26, 0
    s_waitcnt vmcnt(0)
    s_branch prm_18_0ok
prm_18_1:
    s_sub_u32 s26, s26, 1
    s_cbranch_scc1 prm_18_1_g
    buffer_load_dwordx4 v[20:23], v1, s[4:7], s21 offen offset:1024 sc1
    buffer_load_dwordx4 v[24:27], v1, s[4:7], s21 offen offset:2048 sc1
    buffer_load_dwordx4 v[28:31], v1, s[4:7], s21 offen offset:3072 sc1
    s_waitcnt vmcnt(2)
    v_max3_u32 v9, v20, v21, v22
    v_max_u32 v9, v9, v23
    v_cmp_eq_u32 vcc, -1, v9
    s_cbranch_vccnz prm_18_1
    s_branch prm_18_1ok
prm_18_1_g:
    s_mov_b32 s26, 0
    s_waitcnt vmcnt(0)
    s_branch prm_18_1ok
prm_18_2:
    s_sub_u32 s26, s26, 1
    s_cbranch_scc1 prm_18_2_g
    buffer_load_dwordx4 v[24:27], v1, s[4:7], s21 offen offset:2048 sc1
    buffer_load_dwordx4 v[28:31], v1, s[4:7], s21 offen offset:3072 sc1
    s_waitcnt vmcnt(1)
    v_max3_u32 v9, v24, v25, v26
    v_max_u32 v9, v9, v27
    v_cmp_eq_u32 vcc, -1, v9
    s_cbranch_vccnz prm_18_2
    s_branch prm_18_2ok
prm_18_2_g:
    s_mov_b32 s26, 0
    s_waitcnt vmcnt(0)
    s_branch prm_18_2ok
prm_18_3:
    s_sub_u32 s26, s26, 1
    s_cbranch_scc1 prm_18_3_g
    buffer_load_dwordx4 v[28:31], v1, s[4:7], s21 offen offset:3072 sc1
    s_waitcnt vmcnt(0)
    v_max3_u32 v9, v28, v29, v30
    v_max_u32 v9, v9, v31
    v_cmp_eq_u32 vcc, -1, v9
    s_cbranch_vccnz prm_18_3
    s_branch prm_18_3ok
prm_18_3_g:
    s_mov_b32 s26, 0
    s_waitcnt vmcnt(0)
    s_branch prm_18_3ok
prm_18_d:
gate_23:
    v_readfirstlane_b32 s25, v15
    s_cmp_ge_u32 s25, s59
    s_cbranch_scc1 gate_23_ok
    s_sleep 8
    buffer_load_dword v15, off, s[4:7], s58 sc1
    s_waitcnt vmcnt(0)
    s_sub_u32 s26, s26, 1
    s_cbranch_scc0 gate_23
    s_mov_b32 s26, 0
gate_23_ok:
    ds_write_b32 v14, v60
    v_add_f32 v32, v32, v33
    v_add_f32 v34, v34, v35
    ds_write2_b32 v4, v32, v34 offset0:0 offset1:104
    v_add_f32 v36, v36, v37
    v_add_f32 v38, v38, v39
    ds_write2_b32 v4, v36, v38 offset0:16 offset1:120
    v_add_f32 v40, v40, v41
    v_add_f32 v42, v42, v43
    ds_write2_b32 v4, v40, v42 offset0:32 offset1:136
    v_add_f32 v44, v44, v45
    v_add_f32 v46, v46, v47
    ds_write2_b32 v4, v44, v46 offset0:48 offset1:152
    v_add_f32 v48, v48, v49
    v_add_f32 v50, v50, v51
    ds_write2_b32 v4, v48, v50 offset0:64 offset1:168
    v_add_f32 v52, v52, v53
    v_add_f32 v54, v54, v55
    ds_write2_b32 v4, v52, v54 offset0:80 offset1:184
    s_branch pnc_16_done
prp_19:
    s_sub_u32 s26, s26, 1
    s_nop 3
    s_cbranch_scc1 prp_19_g
    buffer_load_dwordx4 v[16:19], v12, s[4:7], s30 offen sc1
    buffer_load_dword v15, off, s[4:7], s58 sc1
    s_branch ploop_15_pagain
prp_19_g:
    s_mov_b32 s26, 0
    s_branch ploop_15_pgo
ploop_15_zr:
    s_sub_u32 s26, s26, 1
    s_cbranch_scc1 ploop_15_zg
    buffer_load_dwordx4 v[32:35], v1, s[4:7], s22 offen offset:0 sc1
    buffer_load_dwordx4 v[36:39], v1, s[4:7], s22 offen offset:1024 sc1
    buffer_load_dwordx4 v[40:43], v1, s[4:7], s22 offen offset:2048 sc1
    buffer_load_dwordx4 v[44:47], v1, s[4:7], s22 offen offset:3072 sc1
    s_branch ploop_15_za
ploop_15_zg:
    s_mov_b32 s26, 0
    s_branch ploop_15_zok
ptail_17:
    s_cmp_eq_u32 s15, 0
    s_cbranch_scc1 ptail_17_nd
    s_nop 0
ptail_17_nd:
    s_barrier
    v_add_u32 v55, s68, v61
    ds_read_b128 v[24:27], v55 offset:0
    ds_read_b128 v[28:31], v55 offset:1024
    ds_read_b128 v[32:35], v55 offset:18560
    ds_read_b128 v[36:39], v55 offset:19584
    ds_read_b128 v[40:43], v55 offset:37120
    ds_read_b128 v[44:47], v55 offset:38144
    ds_read_b128 v[48:51], v55 offset:55680
    ds_read_b128 v[52:55], v55 offset:56704
    s_waitcnt lgkmcnt(4)
    v_add_f32 v24, v24, v32
    v_add_f32 v25, v25, v33
    v_add_f32 v26, v26, v34
    v_add_f32 v27, v27, v35
    v_add_f32 v28, v28, v36
    v_add_f32 v29, v29, v37
    v_add_f32 v30, v30, v38
    v_add_f32 v31, v31, v39
    s_waitcnt lgkmcnt(0)
    v_add_f32 v40, v40, v48
    v_add_f32 v41, v41, v49
    v_add_f32 v42, v42, v50
    v_add_f32 v43, v43, v51
    v_add_f32 v44, v44, v52
    v_add_f32 v45, v45, v53
    v_add_f32 v46, v46, v54
    v_add_f32 v47, v47, v55
    v_add_f32 v24, v24, v40
    v_add_f32 v25, v25, v41
    v_add_f32 v26, v26, v42
    v_add_f32 v27, v27, v43
    v_add_f32 v28, v28, v44
    v_add_f32 v29, v29, v45
    v_add_f32 v30, v30, v46
    v_add_f32 v31, v31, v47
    v_cvt_pk_bf16_f32 v24, v24, v25
    v_cvt_pk_bf16_f32 v25, v26, v27
    v_cvt_pk_bf16_f32 v26, v28, v29
    v_cvt_pk_bf16_f32 v27, v30, v31
    v_min_u32 v24, -2, v24
    v_min_u32 v25, -2, v25
    v_min_u32 v26, -2, v26
    v_min_u32 v27, -2, v27
    buffer_store_dwordx4 v[24:27], v1, s[4:7], s37 offen sc1
    s_branch k_end
ch_a_pro:
    s_mul_i32 s21, s2, 24576
    s_add_u32 s21, s21, 209711104
    v_lshlrev_b32 v1, 4, v0
    v_mov_b32 v4, -1
    v_mov_b32 v5, -1
    v_mov_b32 v6, -1
    v_mov_b32 v7, -1
    buffer_store_dwordx4 v[4:7], v1, s[4:7], s21 offen sc1
    s_add_u32 s21, s21, 4096
    buffer_store_dwordx4 v[4:7], v1, s[4:7], s21 offen sc1
    s_add_u32 s21, s21, 4096
    buffer_store_dwordx4 v[4:7], v1, s[4:7], s21 offen sc1
    s_add_u32 s21, s21, 4096
    buffer_store_dwordx4 v[4:7], v1, s[4:7], s21 offen sc1
    s_add_u32 s21, s21, 4096
    buffer_store_dwordx4 v[4:7], v1, s[4:7], s21 offen sc1
    s_add_u32 s21, s21, 4096
    buffer_store_dwordx4 v[4:7], v1, s[4:7], s21 offen sc1
    s_add_u32 s21, s21, 4096
    v_mov_b32 v2, s29
    s_waitcnt vmcnt(0)
    s_barrier
    s_cmp_lg_u32 s3, 4
    s_cbranch_scc1 ch_nox
    s_mov_b64 exec, 1
    buffer_atomic_add v2, off, s[64:67], s28 sc1
    s_mov_b64 exec, -1
ch_nox:
    v_and_b32 v20, 63, v0
    v_lshlrev_b32 v0, 4, v20
    s_sub_u32 s25, s3, 4
    s_lshl_b32 s46, s12, 2
    s_add_u32 s46, s46, s25
    s_lshl_b32 s21, s46, 18
    s_lshl_b32 s22, s13, 7
    s_add_u32 s21, s21, s22
    s_lshl_b32 s46, s46, 12
    s_lshl_b32 s23, s25, 13
    s_add_u32 s23, s23, 131072
    s_load_dwordx2 s[8:9], s[0:1], 40
    s_mov_b32 s10, 8388608
    s_mov_b32 s11, 131072
    v_lshrrev_b32 v21, 3, v20
    v_and_b32 v22, 7, v20
    v_lshlrev_b32 v21, 11, v21
    v_lshl_add_u32 v21, v22, 4, v21
    v_lshrrev_b32 v28, 4, v20
    v_and_b32 v29, 1, v28
    v_xor_b32 v29, 0, v29
    v_lshlrev_b32 v29, 2, v29
    v_lshl_add_u32 v29, v28, 3, v29
    v_bfe_u32 v28, v20, 2, 2
    v_add_u32 v29, v29, v28
    v_lshlrev_b32 v29, 7, v29
    v_and_b32 v28, 3, v20
    v_lshl_add_u32 v29, v28, 4, v29
    v_and_b32 v28, 1, v28
    v_xor_b32 v28, 0, v28
    v_lshl_add_u32 v24, v28, 3, v29
    v_add_u32 v24, s23, v24
    v_lshrrev_b32 v28, 4, v20
    v_and_b32 v29, 1, v28
    v_xor_b32 v29, 1, v29
    v_lshlrev_b32 v29, 2, v29
    v_lshl_add_u32 v29, v28, 3, v29
    v_bfe_u32 v28, v20, 2, 2
    v_add_u32 v29, v29, v28
    v_lshlrev_b32 v29, 7, v29
    v_and_b32 v28, 3, v20
    v_lshl_add_u32 v29, v28, 4, v29
    v_and_b32 v28, 1, v28
    v_xor_b32 v28, 0, v28
    v_lshl_add_u32 v25, v28, 3, v29
    v_add_u32 v25, s23, v25
    v_lshrrev_b32 v28, 4, v20
    v_and_b32 v29, 1, v28
    v_xor_b32 v29, 0, v29
    v_lshlrev_b32 v29, 2, v29
    v_lshl_add_u32 v29, v28, 3, v29
    v_bfe_u32 v28, v20, 2, 2
    v_add_u32 v29, v29, v28
    v_lshlrev_b32 v29, 7, v29
    v_and_b32 v28, 3, v20
    v_lshl_add_u32 v29, v28, 4, v29
    v_and_b32 v28, 1, v28
    v_xor_b32 v28, 1, v28
    v_lshl_add_u32 v26, v28, 3, v29
    v_add_u32 v26, s23, v26
    v_lshrrev_b32 v28, 4, v20
    v_and_b32 v29, 1, v28
    v_xor_b32 v29, 1, v29
    v_lshlrev_b32 v29, 2, v29
    v_lshl_add_u32 v29, v28, 3, v29
    v_bfe_u32 v28, v20, 2, 2
    v_add_u32 v29, v29, v28
    v_lshlrev_b32 v29, 7, v29
    v_and_b32 v28, 3, v20
    v_lshl_add_u32 v29, v28, 4, v29
    v_and_b32 v28, 1, v28
    v_xor_b32 v28, 1, v28
    v_lshl_add_u32 v27, v28, 3, v29
    v_add_u32 v27, s23, v27
    s_waitcnt lgkmcnt(0)
    s_add_u32 m0, s23, 0
    s_nop 0
    buffer_load_dwordx4 v21, s[8:11], s21 offen lds
    s_add_u32 s21, s21, 16384
    s_add_u32 m0, s23, 1024
    s_nop 0
    buffer_load_dwordx4 v21, s[8:11], s21 offen lds
    s_add_u32 s21, s21, 16384
    s_add_u32 m0, s23, 2048
    s_nop 0
    buffer_load_dwordx4 v21, s[8:11], s21 offen lds
    s_add_u32 s21, s21, 16384
    s_add_u32 m0, s23, 3072
    s_nop 0
    buffer_load_dwordx4 v21, s[8:11], s21 offen lds
    s_add_u32 s21, s21, 16384
    s_add_u32 m0, s23, 4096
    s_nop 0
    buffer_load_dwordx4 v21, s[8:11], s21 offen lds
    s_add_u32 s21, s21, 16384
    s_add_u32 m0, s23, 5120
    s_nop 0
    buffer_load_dwordx4 v21, s[8:11], s21 offen lds
    s_add_u32 s21, s21, 16384
    s_add_u32 m0, s23, 6144
    s_nop 0
    buffer_load_dwordx4 v21, s[8:11], s21 offen lds
    s_add_u32 s21, s21, 16384
    s_add_u32 m0, s23, 7168
    s_nop 0
    buffer_load_dwordx4 v21, s[8:11], s21 offen lds
    s_add_u32 s21, s21, 16384
    buffer_load_dwordx4 v[98:101], v21, s[8:11], s21 offen
    s_add_u32 s21, s21, 16384
    buffer_load_dwordx4 v[102:105], v21, s[8:11], s21 offen
    s_add_u32 s21, s21, 16384
    buffer_load_dwordx4 v[106:109], v21, s[8:11], s21 offen
    s_add_u32 s21, s21, 16384
    buffer_load_dwordx4 v[110:113], v21, s[8:11], s21 offen
    s_add_u32 s21, s21, 16384
    buffer_load_dwordx4 v[114:117], v21, s[8:11], s21 offen
    s_add_u32 s21, s21, 16384
    buffer_load_dwordx4 v[118:121], v21, s[8:11], s21 offen
    s_add_u32 s21, s21, 16384
    buffer_load_dwordx4 v[122:125], v21, s[8:11], s21 offen
    s_add_u32 s21, s21, 16384
    buffer_load_dwordx4 v[126:129], v21, s[8:11], s21 offen
    s_add_u32 s21, s21, 16384
    v_add_u32 v30, s23, v0
    s_waitcnt vmcnt(8)
    ds_read_b64_tr_b16 v[192:193], v24 offset:0
    ds_read_b64_tr_b16 v[194:195], v25 offset:0
    ds_read_b64_tr_b16 v[200:201], v26 offset:0
    ds_read_b64_tr_b16 v[202:203], v27 offset:0
    ds_read_b64_tr_b16 v[208:209], v24 offset:64
    ds_read_b64_tr_b16 v[210:211], v25 offset:64
    ds_read_b64_tr_b16 v[216:217], v26 offset:64
    ds_read_b64_tr_b16 v[218:219], v27 offset:64
    s_waitcnt lgkmcnt(0)
    ds_read_b64_tr_b16 v[196:197], v24 offset:4096
    ds_read_b64_tr_b16 v[198:199], v25 offset:4096
    ds_read_b64_tr_b16 v[204:205], v26 offset:4096
    ds_read_b64_tr_b16 v[206:207], v27 offset:4096
    ds_read_b64_tr_b16 v[212:213], v24 offset:4160
    ds_read_b64_tr_b16 v[214:215], v25 offset:4160
    ds_read_b64_tr_b16 v[220:221], v26 offset:4160
    ds_read_b64_tr_b16 v[222:223], v27 offset:4160
    s_waitcnt lgkmcnt(0)
    s_waitcnt vmcnt(0)
    ds_write_b128 v30, v[98:101] offset:0
    ds_write_b128 v30, v[102:105] offset:1024
    ds_write_b128 v30, v[106:109] offset:2048
    ds_write_b128 v30, v[110:113] offset:3072
    ds_write_b128 v30, v[114:117] offset:4096
    ds_write_b128 v30, v[118:121] offset:5120
    ds_write_b128 v30, v[122:125] offset:6144
    ds_write_b128 v30, v[126:129] offset:7168
    s_waitcnt lgkmcnt(0)
    ds_read_b64_tr_b16 v[224:225], v24 offset:0
    ds_read_b64_tr_b16 v[226:227], v25 offset:0
    ds_read_b64_tr_b16 v[232:233], v26 offset:0
    ds_read_b64_tr_b16 v[234:235], v27 offset:0
    ds_read_b64_tr_b16 v[240:241], v24 offset:64
    ds_read_b64_tr_b16 v[242:243], v25 offset:64
    ds_read_b64_tr_b16 v[248:249], v26 offset:64
    ds_read_b64_tr_b16 v[250:251], v27 offset:64
    s_waitcnt lgkmcnt(0)
    ds_read_b64_tr_b16 v[228:229], v24 offset:4096
    ds_read_b64_tr_b16 v[230:231], v25 offset:4096
    ds_read_b64_tr_b16 v[236:237], v26 offset:4096
    ds_read_b64_tr_b16 v[238:239], v27 offset:4096
    ds_read_b64_tr_b16 v[244:245], v24 offset:4160
    ds_read_b64_tr_b16 v[246:247], v25 offset:4160
    ds_read_b64_tr_b16 v[252:253], v26 offset:4160
    ds_read_b64_tr_b16 v[254:255], v27 offset:4160
    s_waitcnt lgkmcnt(0)
    v_lshrrev_b32 v21, 4, v20
    s_mul_i32 s21, s25, 18560
    s_add_u32 s21, s21, 16384
    v_add_u32 v1, s21, v0
    v_and_b32 v23, 15, v20
    v_mul_u32_u24 v21, 136, v21
    v_lshl_add_u32 v21, v23, 3, v21
    v_add_u32 v45, s21, v21
    s_lshl_b32 s53, s25, 13
    s_add_u32 s53, s53, 92160
    v_add_u32 v49, s53, v0
    v_mov_b32 v48, 0
    v_mov_b32 v4, 0x3f803f80
    v_mov_b32 v5, 0x3f803f80
    v_mov_b32 v6, 0x3f803f80
    v_mov_b32 v7, 0x3f803f80
    v_mov_b32 v8, 0
    v_mov_b32 v9, 0
    v_mov_b32 v10, 0
    v_mov_b32 v11, 0
    v_lshlrev_b32 v43, 2, v20
    v_mov_b32 v26, 0x44444444
    v_mov_b32 v27, 0xeeeeeeee
    v_and_b32 v28, 1, v20
    v_cmp_eq_u32 vcc, 0, v28
    s_mov_b32 s47, 0x3e0293ee
    s_lshl_b32 s32, s12, 15
    v_cndmask_b32 v41, v27, v26, vcc
    s_lshl_b32 s21, s25, 13
    s_add_u32 s32, s32, s21
    s_add_u32 s32, s32, 2097152
    s_lshl_b32 s21, s25, 2
    s_add_u32 s21, s21, 13312
    v_mov_b32 v47, s21
    s_lshl_b32 s27, s13, 2
    s_add_u32 s27, s27, s25
    s_lshl_b32 s62, s12, 7
    s_add_u32 s62, s62, 218112000
    s_lshl_b32 s33, s12, 14
    s_lshl_b32 s21, s25, 12
    s_add_u32 s33, s33, s21
    s_add_u32 s33, s33, 1179648
    v_mov_b32 v139, 0
    v_mov_b32 v140, 0
    v_mov_b32 v141, 0
    v_mov_b32 v143, 0
    v_mov_b32 v144, 0
    v_mov_b32 v145, 0
    v_mov_b32 v40, 0
    v_mov_b32 v42, 0
    v_mov_b32 v44, 0
    v_mov_b32 v46, 0
    v_mov_b32 v158, 0x7f800000
    s_mov_b32 exec_lo, 0xcccccccc
    s_mov_b32 exec_hi, 0xcccccccc
    v_mov_b32 v158, 0x42700000
    s_mov_b64 exec, -1
    s_cmp_lg_u32 s3, 4
    s_cbranch_scc1 ch_xcc_skip
    v_add_u32 v56, 128, v43
    s_movk_i32 s21, 192
    v_writelane_b32 v56, s21, 4
    v_mov_b32 v59, 63
    v_writelane_b32 v59, -1, 4
    v_mov_b32 v60, 32
    s_mov_b64 exec, 0x1f
ch_xcc:
    buffer_load_dword v57, v56, s[64:67], 0 offen sc1
    s_waitcnt vmcnt(0)
    v_and_b32 v62, v59, v57
    v_cmp_ne_u32 vcc, v62, v60
    s_cbranch_vccz ch_xcc_ok
    s_sleep 16
    s_sub_u32 s26, s26, 1
    s_cbranch_scc0 ch_xcc
    s_mov_b32 s26, 0
ch_xcc_ok:
    s_lshr_b32 s22, s12, 1
    v_readlane_b32 s23, v57, 0
    s_nop 2
    v_readlane_b32 s21, v57, s22
    s_mov_b64 exec, -1
    v_mov_b32 v58, 131072
    v_mov_b32 v57, s21
    ds_write_b32 v58, v57
    s_bfe_u32 s23, s23, 0x1000f
    v_and_b32 v60, 0x70, v0
    v_lshlrev_b32 v60, 3, v60
    s_mov_b32 s22, 218112000
ch_pgv:
    buffer_load_dword v61, v60, s[4:7], s22 offen offset:8 sc1
    s_waitcnt vmcnt(0) lgkmcnt(0)
    v_and_b32 v62, 1, v61
    v_cmp_eq_u32 vcc, 0, v62
    s_cbranch_vccz ch_pgvok
    s_sleep 8
    s_sub_u32 s26, s26, 1
    s_cbranch_scc0 ch_pgv
    s_mov_b32 s26, 0
ch_pgvok:
    v_bfe_u32 v62, v61, 1, 1
    v_ashrrev_i32 v61, 8, v61
    v_sub_u32 v59, 0, v61
    v_cmp_eq_u32 vcc, s23, v62
    s_mov_b32 s21, 0
    s_nop 1
    v_cndmask_b32 v61, v59, v61, vcc
    s_nop 1
    v_readlane_b32 s22, v61, 0
    s_add_i32 s21, s21, s22
    v_readlane_b32 s22, v61, 1
    s_add_i32 s21, s21, s22
    v_readlane_b32 s22, v61, 2
    s_add_i32 s21, s21, s22
    v_readlane_b32 s22, v61, 3
    s_add_i32 s21, s21, s22
    v_readlane_b32 s22, v61, 4
    s_add_i32 s21, s21, s22
    v_readlane_b32 s22, v61, 5
    s_add_i32 s21, s21, s22
    v_readlane_b32 s22, v61, 6
    s_add_i32 s21, s21, s22
    v_readlane_b32 s22, v61, 7
    s_add_i32 s21, s21, s22
    s_cmp_gt_i32 s21, 0
    s_cselect_b32 s21, 0x2000, 0
    v_mov_b32 v59, s21
    ds_write_b32 v58, v59 offset:4
    s_waitcnt lgkmcnt(0)
ch_xcc_skip:
    s_barrier
    s_barrier
    s_lshl_b32 s60, s12, 4
    s_add_u32 s60, s60, 218104320
    s_barrier
ch_g0:
    buffer_load_dword v57, off, s[4:7], s60 sc1
    s_waitcnt vmcnt(0)
    v_readfirstlane_b32 s21, v57
    s_cmp_ge_u32 s21, 12
    s_cbranch_scc1 ch_g0b
    s_sleep 8
    s_sub_u32 s26, s26, 1
    s_cbranch_scc0 ch_g0
    s_mov_b32 s26, 0
ch_g0b:
    s_add_u32 s21, s16, 0
    s_lshl_b32 s21, s21, 18
    s_add_u32 s21, s21, s46
    s_add_u32 s21, s21, 37748736
    s_add_u32 s22, s21, 131072
    buffer_load_dwordx4 v[160:163], v0, s[4:7], s21 offen offset:0 sc1
    buffer_load_dwordx4 v[164:167], v0, s[4:7], s21 offen offset:1024 sc1
    buffer_load_dwordx4 v[168:171], v0, s[4:7], s21 offen offset:2048 sc1
    buffer_load_dwordx4 v[172:175], v0, s[4:7], s21 offen offset:3072 sc1
    buffer_load_dwordx4 v[176:179], v0, s[4:7], s22 offen offset:0 sc1
    buffer_load_dwordx4 v[180:183], v0, s[4:7], s22 offen offset:1024 sc1
    buffer_load_dwordx4 v[184:187], v0, s[4:7], s22 offen offset:2048 sc1
    buffer_load_dwordx4 v[188:191], v0, s[4:7], s22 offen offset:3072 sc1
    s_add_u32 s21, s16, 0
    s_lshl_b32 s21, s21, 18
    s_add_u32 s21, s21, s46
    s_add_u32 s21, s21, 20971520
    s_add_u32 s22, s21, 131072
    buffer_load_dwordx4 v[98:101], v0, s[4:7], s21 offen offset:0 sc1
    buffer_load_dwordx4 v[102:105], v0, s[4:7], s21 offen offset:1024 sc1
    buffer_load_dwordx4 v[106:109], v0, s[4:7], s21 offen offset:2048 sc1
    buffer_load_dwordx4 v[110:113], v0, s[4:7], s21 offen offset:3072 sc1
    buffer_load_dwordx4 v[114:117], v0, s[4:7], s22 offen offset:0 sc1
    buffer_load_dwordx4 v[118:121], v0, s[4:7], s22 offen offset:1024 sc1
    buffer_load_dwordx4 v[122:125], v0, s[4:7], s22 offen offset:2048 sc1
    buffer_load_dwordx4 v[126:129], v0, s[4:7], s22 offen offset:3072 sc1
    s_waitcnt vmcnt(8)
    v_mfma_f32_16x16x32_bf16 v[50:53], v[160:163], v[192:195], 0
    v_mfma_f32_16x16x32_bf16 v[54:57], v[160:163], v[200:203], 0
    v_mfma_f32_16x16x32_bf16 v[58:61], v[160:163], v[208:211], 0
    v_mfma_f32_16x16x32_bf16 v[62:65], v[160:163], v[216:219], 0
    v_mfma_f32_16x16x32_bf16 v[66:69], v[176:179], v[192:195], 0
    v_mfma_f32_16x16x32_bf16 v[70:73], v[176:179], v[200:203], 0
    v_mfma_f32_16x16x32_bf16 v[74:77], v[176:179], v[208:211], 0
    v_mfma_f32_16x16x32_bf16 v[78:81], v[176:179], v[216:219], 0
    v_mfma_f32_16x16x32_bf16 v[50:53], v[164:167], v[196:199], v[50:53]
    v_mfma_f32_16x16x32_bf16 v[54:57], v[164:167], v[204:207], v[54:57]
    v_mfma_f32_16x16x32_bf16 v[58:61], v[164:167], v[212:215], v[58:61]
    v_mfma_f32_16x16x32_bf16 v[62:65], v[164:167], v[220:223], v[62:65]
    v_mfma_f32_16x16x32_bf16 v[66:69], v[180:183], v[196:199], v[66:69]
    v_mfma_f32_16x16x32_bf16 v[70:73], v[180:183], v[204:207], v[70:73]
    v_mfma_f32_16x16x32_bf16 v[74:77], v[180:183], v[212:215], v[74:77]
    v_mfma_f32_16x16x32_bf16 v[78:81], v[180:183], v[220:223], v[78:81]
    v_mfma_f32_16x16x32_bf16 v[50:53], v[168:171], v[224:227], v[50:53]
    v_mfma_f32_16x16x32_bf16 v[54:57], v[168:171], v[232:235], v[54:57]
    v_mfma_f32_16x16x32_bf16 v[58:61], v[168:171], v[240:243], v[58:61]
    v_mfma_f32_16x16x32_bf16 v[62:65], v[168:171], v[248:251], v[62:65]
    v_mfma_f32_16x16x32_bf16 v[66:69], v[184:187], v[224:227], v[66:69]
    v_mfma_f32_16x16x32_bf16 v[70:73], v[184:187], v[232:235], v[70:73]
    v_mfma_f32_16x16x32_bf16 v[74:77], v[184:187], v[240:243], v[74:77]
    v_mfma_f32_16x16x32_bf16 v[78:81], v[184:187], v[248:251], v[78:81]
    v_mfma_f32_16x16x32_bf16 v[50:53], v[172:175], v[228:231], v[50:53]
    v_mfma_f32_16x16x32_bf16 v[54:57], v[172:175], v[236:239], v[54:57]
    v_mfma_f32_16x16x32_bf16 v[58:61], v[172:175], v[244:247], v[58:61]
    v_mfma_f32_16x16x32_bf16 v[62:65], v[172:175], v[252:255], v[62:65]
    v_mfma_f32_16x16x32_bf16 v[66:69], v[188:191], v[228:231], v[66:69]
    v_mfma_f32_16x16x32_bf16 v[70:73], v[188:191], v[236:239], v[70:73]
    v_mfma_f32_16x16x32_bf16 v[74:77], v[188:191], v[244:247], v[74:77]
    v_mfma_f32_16x16x32_bf16 v[78:81], v[188:191], v[252:255], v[78:81]
    s_add_u32 s21, s16, 1
    s_lshl_b32 s21, s21, 18
    s_add_u32 s21, s21, s46
    s_add_u32 s21, s21, 37748736
    s_add_u32 s22, s21, 131072
    buffer_load_dwordx4 v[160:163], v0, s[4:7], s21 offen offset:0 sc1
    buffer_load_dwordx4 v[164:167], v0, s[4:7], s21 offen offset:1024 sc1
    buffer_load_dwordx4 v[168:171], v0, s[4:7], s21 offen offset:2048 sc1
    buffer_load_dwordx4 v[172:175], v0, s[4:7], s21 offen offset:3072 sc1
    buffer_load_dwordx4 v[176:179], v0, s[4:7], s22 offen offset:0 sc1
    buffer_load_dwordx4 v[180:183], v0, s[4:7], s22 offen offset:1024 sc1
    buffer_load_dwordx4 v[184:187], v0, s[4:7], s22 offen offset:2048 sc1
    buffer_load_dwordx4 v[188:191], v0, s[4:7], s22 offen offset:3072 sc1
    s_mov_b32 s34, 1
    s_nop 7
    v_cvt_pk_bf16_f32 v82, v50, v51
    v_cvt_pk_bf16_f32 v83, v52, v53
    v_cvt_pk_bf16_f32 v84, v66, v67
    v_cvt_pk_bf16_f32 v85, v68, v69
    v_cvt_pk_bf16_f32 v86, v54, v55
    v_cvt_pk_bf16_f32 v87, v56, v57
    v_cvt_pk_bf16_f32 v88, v70, v71
    v_cvt_pk_bf16_f32 v89, v72, v73
    v_cvt_pk_bf16_f32 v90, v58, v59
    v_cvt_pk_bf16_f32 v91, v60, v61
    v_cvt_pk_bf16_f32 v92, v74, v75
    v_cvt_pk_bf16_f32 v93, v76, v77
    v_cvt_pk_bf16_f32 v94, v62, v63
    v_cvt_pk_bf16_f32 v95, v64, v65
    v_cvt_pk_bf16_f32 v96, v78, v79
    v_cvt_pk_bf16_f32 v97, v80, v81
    v_mov_b32 v74, 0
    v_mov_b32 v75, 0
    v_mov_b32 v76, 0
    v_mov_b32 v77, 0
    v_mov_b32 v78, 0
    v_mov_b32 v79, 0
    v_mov_b32 v80, 0
    v_mov_b32 v81, 0
    v_mov_b32 v146, 0
    v_mov_b32 v147, 0
    v_mov_b32 v148, 0
    v_mov_b32 v149, 0
    v_mov_b32 v150, 0
    v_mov_b32 v151, 0
    v_mov_b32 v152, 0
    v_mov_b32 v153, 0
    v_mov_b32 v12, 0
    v_mov_b32 v13, 0
    v_mov_b32 v14, 0
    v_mov_b32 v15, 0
    v_mov_b32 v16, 0
    v_mov_b32 v17, 0
    v_mov_b32 v18, 0
    v_mov_b32 v19, 0
    v_mov_b32 v20, 0
    v_mov_b32 v21, 0
    v_mov_b32 v22, 0
    v_mov_b32 v23, 0
    v_mov_b32 v2, 0
    s_add_u32 s21, s17, s32
    s_add_u32 s22, s21, 4096
    s_setprio 2
    s_branch a_zl
.p2align 6
    s_nop 0
    s_nop 0
    s_nop 0
    s_nop 0
    s_nop 0
    s_nop 0
    s_nop 0
    s_nop 0
aloop_24:
    s_add_u32 s21, s17, s32
    s_add_u32 s22, s21, 4096
    v_mov_b32 v74, 0
    v_mov_b32 v75, 0
    v_mov_b32 v76, 0
    v_mov_b32 v77, 0
    v_mov_b32 v78, 0
    v_mov_b32 v79, 0
    v_mov_b32 v80, 0
    v_mov_b32 v81, 0
    v_mov_b32 v146, 0
    v_mov_b32 v147, 0
    v_mov_b32 v148, 0
    v_mov_b32 v149, 0
    v_mov_b32 v150, 0
    v_mov_b32 v151, 0
    v_mov_b32 v152, 0
    v_mov_b32 v153, 0
    s_add_u32 s30, s16, 1
    s_lshl_b32 s30, s30, 18
    s_add_u32 s30, s30, s46
    s_add_u32 s30, s30, 37748736
    s_add_u32 s31, s30, 131072
aloop_24_wm:
    ds_read_b32 v3, v47
    s_waitcnt lgkmcnt(0)
    v_readfirstlane_b32 s23, v3
    s_cmp_eq_u32 s23, s16
    s_cbranch_scc1 aloop_24_wmok
    s_sleep 1
    s_branch aloop_24_wm
aloop_24_wmok:
    buffer_load_dwordx4 v[160:163], v0, s[4:7], s30 offen offset:0 sc1
    buffer_load_dwordx4 v[164:167], v0, s[4:7], s30 offen offset:1024 sc1
    buffer_load_dwordx4 v[168:171], v0, s[4:7], s30 offen offset:2048 sc1
    buffer_load_dwordx4 v[172:175], v0, s[4:7], s30 offen offset:3072 sc1
    buffer_load_dwordx4 v[176:179], v0, s[4:7], s31 offen offset:0 sc1
    buffer_load_dwordx4 v[180:183], v0, s[4:7], s31 offen offset:1024 sc1
    buffer_load_dwordx4 v[184:187], v0, s[4:7], s31 offen offset:2048 sc1
    buffer_load_dwordx4 v[188:191], v0, s[4:7], s31 offen offset:3072 sc1
aloop_24_nv:
    s_setprio 2
    v_mov_b32 v2, s16
    s_barrier
    s_nop 15
    s_nop 13
    ds_read_b128 v[98:101], v49 offset:0
    ds_read_b128 v[102:105], v49 offset:1024
    ds_read_b128 v[106:109], v49 offset:2048
    ds_read_b128 v[110:113], v49 offset:3072
    ds_read_b128 v[114:117], v49 offset:4096
    ds_read_b128 v[118:121], v49 offset:5120
    ds_read_b128 v[122:125], v49 offset:6144
    ds_read_b128 v[126:129], v49 offset:7168
    v_mov_b32 v12, 0
    v_mov_b32 v13, 0
    v_mov_b32 v14, 0
    v_mov_b32 v15, 0
    v_mov_b32 v16, 0
    v_mov_b32 v17, 0
    v_mov_b32 v18, 0
    v_mov_b32 v19, 0
    v_mov_b32 v20, 0
    v_mov_b32 v21, 0
    v_mov_b32 v22, 0
    v_mov_b32 v23, 0
    s_sleep 3
    s_nop 13
a_zl:
    buffer_load_dwordx4 v[50:53], v0, s[4:7], s21 offen offset:0 sc1
    s_nop 7
    buffer_load_dwordx4 v[54:57], v0, s[4:7], s21 offen offset:1024 sc1
    s_nop 7
    buffer_load_dwordx4 v[58:61], v0, s[4:7], s21 offen offset:2048 sc1
    s_nop 7
    buffer_load_dwordx4 v[62:65], v0, s[4:7], s21 offen offset:3072 sc1
    s_nop 7
    buffer_load_dwordx4 v[66:69], v0, s[4:7], s22 offen offset:0 sc1
    s_nop 7
    buffer_load_dwordx4 v[70:73], v0, s[4:7], s22 offen offset:1024 sc1
    s_waitcnt lgkmcnt(0)
    s_waitcnt vmcnt(5)
    v_max3_u32 v3, v50, v51, v52
    v_max_u32 v3, v3, v53
    v_cmp_eq_u32 vcc, -1, v3
    s_cbranch_vccnz arq_25_0
arq_25_0ok:
    v_mfma_f32_16x16x32_bf16 v[12:15], v[98:101], v[50:53], v[12:15]
    v_mfma_f32_16x16x32_bf16 v[16:19], v[114:117], v[50:53], v[16:19]
    s_waitcnt vmcnt(4)
    v_max3_u32 v3, v54, v55, v56
    v_max_u32 v3, v3, v57
    v_cmp_eq_u32 vcc, -1, v3
    v_mfma_f32_16x16x32_bf16 v[20:23], v[50:53], v[50:53], v[20:23]
    s_cbranch_vccnz arq_25_1
arq_25_1ok:
    v_mfma_f32_16x16x32_bf16 v[12:15], v[102:105], v[54:57], v[12:15]
    v_mfma_f32_16x16x32_bf16 v[16:19], v[118:121], v[54:57], v[16:19]
    s_waitcnt vmcnt(3)
    v_max3_u32 v3, v58, v59, v60
    v_max_u32 v3, v3, v61
    v_cmp_eq_u32 vcc, -1, v3
    v_mfma_f32_16x16x32_bf16 v[20:23], v[54:57], v[54:57], v[20:23]
    s_cbranch_vccnz arq_25_2
arq_25_2ok:
    v_mfma_f32_16x16x32_bf16 v[12:15], v[106:109], v[58:61], v[12:15]
    v_mfma_f32_16x16x32_bf16 v[16:19], v[122:125], v[58:61], v[16:19]
    s_waitcnt vmcnt(2)
    v_max3_u32 v3, v62, v63, v64
    v_max_u32 v3, v3, v65
    v_cmp_eq_u32 vcc, -1, v3
    v_mfma_f32_16x16x32_bf16 v[20:23], v[58:61], v[58:61], v[20:23]
    s_cbranch_vccnz arq_25_3
arq_25_3ok:
    v_mfma_f32_16x16x32_bf16 v[12:15], v[110:113], v[62:65], v[12:15]
    ds_write_b32 v47, v2 offset:16
    v_mfma_f32_16x16x32_bf16 v[16:19], v[126:129], v[62:65], v[16:19]
    v_mfma_f32_16x16x32_bf16 v[20:23], v[62:65], v[62:65], v[20:23]
aloop_24_sdone:
    s_nop 0
    s_cmp_eq_u32 s16, 63
    s_cbranch_scc1 aloop_24_lsk
    s_nop 1
    v_max3_f32 v2, v12, v13, v14
    v_max3_f32 v3, v15, v16, v17
    v_max3_f32 v2, v2, v18, v19
    s_nop 0
    v_max3_f32 v3, v3, v20, v21
    v_max_f32 v2, v2, v3
    v_mov_b32 v3, v2
    s_nop 1
    v_permlane16_swap_b32 v3, v2
    v_max_f32 v2, v2, v3
    v_mov_b32 v3, v2
    s_waitcnt vmcnt(0)
    v_max3_u32 v24, v66, v67, v68
    v_permlane32_swap_b32 v3, v2
    v_max3_u32 v24, v24, v69, v70
    v_max_f32 v2, v2, v3
    v_max3_u32 v24, v24, v71, v72
    v_sub_f32 v54, v12, v2
    v_max_u32 v24, v24, v73
    v_sub_f32 v55, v13, v2
    v_cmp_eq_u32 vcc, -1, v24
    s_cbranch_vccnz arq_25_v
    v_sub_f32 v56, v14, v2
    v_smfmac_f32_16x16x64_bf16 v[74:77], v[66:69], v[192:199], v41
    v_exp_f32 v54, v54
    v_sub_f32 v57, v15, v2
    v_smfmac_f32_16x16x64_bf16 v[78:81], v[66:69], v[200:207], v41
    v_exp_f32 v55, v55
    v_sub_f32 v58, v16, v2
    v_smfmac_f32_16x16x64_bf16 v[146:149], v[66:69], v[208:215], v41
    v_exp_f32 v56, v56
    v_sub_f32 v59, v17, v2
    v_smfmac_f32_16x16x64_bf16 v[150:153], v[66:69], v[216:223], v41
    v_exp_f32 v57, v57
    v_sub_f32 v60, v18, v2
    v_smfmac_f32_16x16x64_bf16 v[74:77], v[70:73], v[224:231], v41
    v_exp_f32 v58, v58
    v_sub_f32 v61, v19, v2
    v_smfmac_f32_16x16x64_bf16 v[78:81], v[70:73], v[232:239], v41
    v_exp_f32 v59, v59
    v_sub_f32 v62, v20, v2
    v_smfmac_f32_16x16x64_bf16 v[146:149], v[70:73], v[240:247], v41
    v_exp_f32 v60, v60
    v_sub_f32 v63, v21, v2
    v_smfmac_f32_16x16x64_bf16 v[150:153], v[70:73], v[248:255], v41
    v_exp_f32 v61, v61
    v_exp_f32 v62, v62
    v_exp_f32 v63, v63
    v_cvt_pk_bf16_f32 v154, v54, v55
    v_cvt_pk_bf16_f32 v155, v56, v57
    v_cvt_pk_bf16_f32 v156, v58, v59
    v_cvt_pk_bf16_f32 v157, v60, v61
    v_cvt_pk_bf16_f32 v8, v62, v63
    v_add_f32 v74, v74, v75
    v_mfma_f32_16x16x32_bf16 v[50:53], v[154:157], v[4:7], 0
    v_add_f32 v76, v76, v77
    v_mfma_f32_16x16x32_bf16 v[50:53], v[8:11], v[4:7], v[50:53]
    v_cvt_pk_bf16_f32 v40, v74, v76
    v_mfma_f32_16x16x32_bf16 v[24:27], v[154:157], v[82:85], 0
    v_add_f32 v78, v78, v79
    v_add_f32 v80, v80, v81
    v_mfma_f32_16x16x32_bf16 v[24:27], v[8:11], v[40:43], v[24:27]
    v_cvt_pk_bf16_f32 v42, v78, v80
    v_add_f32 v146, v146, v147
    v_mfma_f32_16x16x32_bf16 v[28:31], v[154:157], v[86:89], 0
    v_add_f32 v148, v148, v149
    v_cvt_pk_bf16_f32 v44, v146, v148
    v_mfma_f32_16x16x32_bf16 v[28:31], v[8:11], v[42:45], v[28:31]
    v_add_f32 v150, v150, v151
    v_add_f32 v152, v152, v153
    v_mfma_f32_16x16x32_bf16 v[32:35], v[154:157], v[90:93], 0
    v_cvt_pk_bf16_f32 v46, v150, v152
    v_rcp_f32 v52, v52
    v_mfma_f32_16x16x32_bf16 v[32:35], v[8:11], v[44:47], v[32:35]
    v_rcp_f32 v53, v53
    v_mfma_f32_16x16x32_bf16 v[36:39], v[154:157], v[94:97], 0
    v_mul_f32 v26, v26, v52
    v_mul_f32 v27, v27, v53
    v_mfma_f32_16x16x32_bf16 v[36:39], v[8:11], v[46:49], v[36:39]
    v_mul_f32 v30, v30, v52
    v_mul_f32 v31, v31, v53
aloop_24_pvd:
    ds_write_b64 v45, v[26:27] offset:0
    v_mul_f32 v34, v34, v52
    v_mul_f32 v35, v35, v53
    ds_write_b64 v45, v[30:31] offset:544
    s_nop 1
    v_mul_f32 v38, v38, v52
    v_mul_f32 v39, v39, v53
    ds_write_b64 v45, v[34:35] offset:1088
    ds_write_b64 v45, v[38:39] offset:1632
aloop_24_lskb:
    s_waitcnt lgkmcnt(0)
    s_barrier
    s_setprio 0
    s_cmp_lg_u32 s27, 0
    s_cbranch_scc1 pg_26
    s_sub_u32 s25, s16, 1
    s_cbranch_scc1 pg_26
    v_mov_b32 v3, s25
    s_mov_b64 exec, 1
    buffer_store_dword v3, off, s[4:7], s62 sc1
    s_mov_b64 exec, -1
pg_26:
    s_add_u32 s21, s17, s33
    v_lshlrev_b32 v2, 1, v43
    s_cmp_eq_u32 s16, 63
    s_cbranch_scc1 aloop_24_nvw
    v_mfma_f32_16x16x32_bf16 v[50:53], v[160:163], v[192:195], 0
    v_mfma_f32_16x16x32_bf16 v[54:57], v[160:163], v[200:203], 0
    v_mfma_f32_16x16x32_bf16 v[58:61], v[160:163], v[208:211], 0
    v_mfma_f32_16x16x32_bf16 v[62:65], v[160:163], v[216:219], 0
    v_mfma_f32_16x16x32_bf16 v[66:69], v[176:179], v[192:195], 0
    v_mfma_f32_16x16x32_bf16 v[70:73], v[176:179], v[200:203], 0
    v_mfma_f32_16x16x32_bf16 v[74:77], v[176:179], v[208:211], 0
    v_mfma_f32_16x16x32_bf16 v[78:81], v[176:179], v[216:219], 0
    v_mfma_f32_16x16x32_bf16 v[50:53], v[164:167], v[196:199], v[50:53]
    v_mfma_f32_16x16x32_bf16 v[54:57], v[164:167], v[204:207], v[54:57]
    v_mfma_f32_16x16x32_bf16 v[58:61], v[164:167], v[212:215], v[58:61]
    v_mfma_f32_16x16x32_bf16 v[62:65], v[164:167], v[220:223], v[62:65]
    v_mfma_f32_16x16x32_bf16 v[66:69], v[180:183], v[196:199], v[66:69]
    v_mfma_f32_16x16x32_bf16 v[70:73], v[180:183], v[204:207], v[70:73]
    v_mfma_f32_16x16x32_bf16 v[74:77], v[180:183], v[212:215], v[74:77]
    v_mfma_f32_16x16x32_bf16 v[78:81], v[180:183], v[220:223], v[78:81]
    v_mfma_f32_16x16x32_bf16 v[50:53], v[168:171], v[224:227], v[50:53]
    v_mfma_f32_16x16x32_bf16 v[54:57], v[168:171], v[232:235], v[54:57]
    v_mfma_f32_16x16x32_bf16 v[58:61], v[168:171], v[240:243], v[58:61]
    v_mfma_f32_16x16x32_bf16 v[62:65], v[168:171], v[248:251], v[62:65]
    v_mfma_f32_16x16x32_bf16 v[66:69], v[184:187], v[224:227], v[66:69]
    v_mfma_f32_16x16x32_bf16 v[70:73], v[184:187], v[232:235], v[70:73]
    v_mfma_f32_16x16x32_bf16 v[74:77], v[184:187], v[240:243], v[74:77]
    v_mfma_f32_16x16x32_bf16 v[78:81], v[184:187], v[248:251], v[78:81]
    v_mfma_f32_16x16x32_bf16 v[50:53], v[172:175], v[228:231], v[50:53]
    v_mfma_f32_16x16x32_bf16 v[54:57], v[172:175], v[236:239], v[54:57]
    v_mfma_f32_16x16x32_bf16 v[58:61], v[172:175], v[244:247], v[58:61]
    v_mfma_f32_16x16x32_bf16 v[62:65], v[172:175], v[252:255], v[62:65]
    v_mfma_f32_16x16x32_bf16 v[66:69], v[188:191], v[228:231], v[66:69]
    v_mfma_f32_16x16x32_bf16 v[70:73], v[188:191], v[236:239], v[70:73]
    v_mfma_f32_16x16x32_bf16 v[74:77], v[188:191], v[244:247], v[74:77]
    v_mfma_f32_16x16x32_bf16 v[78:81], v[188:191], v[252:255], v[78:81]
    buffer_load_dwordx4 v[130:133], v0, s[4:7], s21 offen sc1
    buffer_load_dwordx2 v[146:147], v2, s[4:7], s21 offen offset:1024 sc1
    buffer_load_dwordx4 v[134:137], v0, s[4:7], s21 offen offset:2048 sc1
    buffer_load_dwordx2 v[148:149], v2, s[4:7], s21 offen offset:3072 sc1
    s_add_u32 s30, s16, 2
    s_lshl_b32 s30, s30, 18
    s_add_u32 s30, s30, s46
    s_add_u32 s30, s30, 37748736
    s_add_u32 s31, s30, 131072
    s_branch aloop_24_vwd
aloop_24_nvw:
    buffer_load_dwordx4 v[130:133], v0, s[4:7], s21 offen sc1
    buffer_load_dwordx2 v[146:147], v2, s[4:7], s21 offen offset:1024 sc1
    buffer_load_dwordx4 v[134:137], v0, s[4:7], s21 offen offset:2048 sc1
    buffer_load_dwordx2 v[148:149], v2, s[4:7], s21 offen offset:3072 sc1
aloop_24_vwd:
    v_add_u32 v48, s68, v1
    s_xor_b32 s68, s68, 8192
aloop_24_psa:
    s_waitcnt vmcnt(0)
    v_max3_u32 v3, v130, v131, v132
    v_max3_u32 v3, v3, v133, v134
    v_max3_u32 v3, v3, v135, v136
    v_max3_u32 v3, v3, v137, v146
    v_max3_u32 v3, v3, v147, v148
    v_max_u32 v3, v3, v149
    v_cmp_eq_u32 vcc, -1, v3
    s_cbranch_vccnz arq_25_ps
aloop_24_psok:
    v_mfma_f32_16x16x32_bf16 v[24:27], v[82:85], v[130:133], 0
    v_mfma_f32_16x16x32_bf16 v[28:31], v[86:89], v[130:133], 0
    v_mfma_f32_16x16x32_bf16 v[32:35], v[90:93], v[130:133], 0
    v_mfma_f32_16x16x32_bf16 v[36:39], v[94:97], v[130:133], 0
    v_mov_b32 v138, v146
    v_mfma_f32_16x16x32_bf16 v[12:15], v[82:85], v[134:137], 0
    v_mfma_f32_16x16x32_bf16 v[16:19], v[86:89], v[134:137], 0
    v_mfma_f32_16x16x32_bf16 v[20:23], v[90:93], v[134:137], 0
    v_mfma_f32_16x16x32_bf16 v[154:157], v[94:97], v[134:137], 0
    v_mov_b32 v142, v148
    v_mfma_f32_16x16x32_bf16 v[24:27], v[40:43], v[138:141], v[24:27]
    v_mfma_f32_16x16x32_bf16 v[28:31], v[42:45], v[138:141], v[28:31]
    v_mfma_f32_16x16x32_bf16 v[32:35], v[44:47], v[138:141], v[32:35]
    v_mfma_f32_16x16x32_bf16 v[36:39], v[46:49], v[138:141], v[36:39]
    v_mfma_f32_16x16x32_bf16 v[12:15], v[40:43], v[142:145], v[12:15]
    v_mfma_f32_16x16x32_bf16 v[16:19], v[42:45], v[142:145], v[16:19]
    v_mfma_f32_16x16x32_bf16 v[20:23], v[44:47], v[142:145], v[20:23]
    s_nop 1
    v_mfma_f32_16x16x32_bf16 v[154:157], v[46:49], v[142:145], v[154:157]
aloop_24_nev:
    ds_write_b128 v48, v[24:27] offset:2176
    v_cvt_pk_bf16_f32 v82, v50, v51
    v_cvt_pk_bf16_f32 v83, v52, v53
    ds_write_b128 v48, v[28:31] offset:3200
    v_cvt_pk_bf16_f32 v84, v66, v67
    v_cvt_pk_bf16_f32 v85, v68, v69
    ds_write_b128 v48, v[32:35] offset:4224
    v_cvt_pk_bf16_f32 v86, v54, v55
    v_cvt_pk_bf16_f32 v87, v56, v57
    ds_write_b128 v48, v[36:39] offset:5248
    v_cvt_pk_bf16_f32 v88, v70, v71
    v_cvt_pk_bf16_f32 v89, v72, v73
    ds_write_b128 v48, v[12:15] offset:6272
    v_cvt_pk_bf16_f32 v90, v58, v59
    v_cvt_pk_bf16_f32 v91, v60, v61
    ds_write_b128 v48, v[16:19] offset:7296
    v_cvt_pk_bf16_f32 v92, v74, v75
    v_cvt_pk_bf16_f32 v93, v76, v77
    ds_write_b128 v48, v[20:23] offset:8320
    v_cvt_pk_bf16_f32 v94, v62, v63
    v_cvt_pk_bf16_f32 v95, v64, v65
    ds_write_b128 v48, v[154:157] offset:9344
    v_cvt_pk_bf16_f32 v96, v78, v79
    v_cvt_pk_bf16_f32 v97, v80, v81
aloop_24_bgskip:
    s_waitcnt lgkmcnt(0)
    s_cmp_eq_u32 s16, 63
    s_cbranch_scc1 aloop_24_fin
    s_add_u32 s16, s16, 1
    s_mov_b32 s17, s18
    s_mov_b32 s18, s19
    s_mov_b32 s19, s20
    s_add_u32 s20, s20, 262144
    s_cmp_eq_u32 s20, 210763776
    s_cselect_b32 s20, 209715200, s20
    s_branch aloop_24
arq_25_0:
    s_sub_u32 s26, s26, 1
    s_cbranch_scc1 arq_25_0_g
    buffer_load_dwordx4 v[50:53], v0, s[4:7], s21 offen offset:0 sc1
    buffer_load_dwordx4 v[54:57], v0, s[4:7], s21 offen offset:1024 sc1
    buffer_load_dwordx4 v[58:61], v0, s[4:7], s21 offen offset:2048 sc1
    buffer_load_dwordx4 v[62:65], v0, s[4:7], s21 offen offset:3072 sc1
    buffer_load_dwordx4 v[66:69], v0, s[4:7], s22 offen offset:0 sc1
    buffer_load_dwordx4 v[70:73], v0, s[4:7], s22 offen offset:1024 sc1
    s_waitcnt vmcnt(5)
    v_max3_u32 v3, v50, v51, v52
    v_max_u32 v3, v3, v53
    v_cmp_eq_u32 vcc, -1, v3
    s_cbranch_vccnz arq_25_0
    s_branch arq_25_0ok
arq_25_0_g:
    s_mov_b32 s26, 0
    s_waitcnt vmcnt(0)
    s_branch arq_25_0ok
arq_25_1:
    s_sub_u32 s26, s26, 1
    s_cbranch_scc1 arq_25_1_g
    buffer_load_dwordx4 v[54:57], v0, s[4:7], s21 offen offset:1024 sc1
    buffer_load_dwordx4 v[58:61], v0, s[4:7], s21 offen offset:2048 sc1
    buffer_load_dwordx4 v[62:65], v0, s[4:7], s21 offen offset:3072 sc1
    buffer_load_dwordx4 v[66:69], v0, s[4:7], s22 offen offset:0 sc1
    buffer_load_dwordx4 v[70:73], v0, s[4:7], s22 offen offset:1024 sc1
    s_waitcnt vmcnt(4)
    v_max3_u32 v3, v54, v55, v56
    v_max_u32 v3, v3, v57
    v_cmp_eq_u32 vcc, -1, v3
    s_cbranch_vccnz arq_25_1
    s_branch arq_25_1ok
arq_25_1_g:
    s_mov_b32 s26, 0
    s_waitcnt vmcnt(0)
    s_branch arq_25_1ok
arq_25_2:
    s_sub_u32 s26, s26, 1
    s_cbranch_scc1 arq_25_2_g
    buffer_load_dwordx4 v[58:61], v0, s[4:7], s21 offen offset:2048 sc1
    buffer_load_dwordx4 v[62:65], v0, s[4:7], s21 offen offset:3072 sc1
    buffer_load_dwordx4 v[66:69], v0, s[4:7], s22 offen offset:0 sc1
    buffer_load_dwordx4 v[70:73], v0, s[4:7], s22 offen offset:1024 sc1
    s_waitcnt vmcnt(3)
    v_max3_u32 v3, v58, v59, v60
    v_max_u32 v3, v3, v61
    v_cmp_eq_u32 vcc, -1, v3
    s_cbranch_vccnz arq_25_2
    s_branch arq_25_2ok
arq_25_2_g:
    s_mov_b32 s26, 0
    s_waitcnt vmcnt(0)
    s_branch arq_25_2ok
arq_25_3:
    s_sub_u32 s26, s26, 1
    s_cbranch_scc1 arq_25_3_g
    buffer_load_dwordx4 v[62:65], v0, s[4:7], s21 offen offset:3072 sc1
    buffer_load_dwordx4 v[66:69], v0, s[4:7], s22 offen offset:0 sc1
    buffer_load_dwordx4 v[70:73], v0, s[4:7], s22 offen offset:1024 sc1
    s_waitcnt vmcnt(2)
    v_max3_u32 v3, v62, v63, v64
    v_max_u32 v3, v3, v65
    v_cmp_eq_u32 vcc, -1, v3
    s_cbranch_vccnz arq_25_3
    s_branch arq_25_3ok
arq_25_3_g:
    s_mov_b32 s26, 0
    s_waitcnt vmcnt(0)
    s_branch arq_25_3ok
arq_25_v:
    buffer_load_dwordx4 v[66:69], v0, s[4:7], s22 offen offset:0 sc1
    buffer_load_dwordx4 v[70:73], v0, s[4:7], s22 offen offset:1024 sc1
    v_max3_f32 v2, v12, v13, v14
    v_max3_f32 v3, v15, v16, v17
    v_max3_f32 v2, v2, v18, v19
    v_max3_f32 v3, v3, v20, v21
    v_max_f32 v2, v2, v3
    v_mov_b32 v3, v2
    s_nop 1
    v_permlane16_swap_b32 v3, v2
    v_max_f32 v2, v2, v3
    v_mov_b32 v3, v2
    s_nop 1
    v_permlane32_swap_b32 v3, v2
    v_max_f32 v2, v2, v3
    v_sub_f32 v12, v12, v2
    v_sub_f32 v13, v13, v2
    v_sub_f32 v14, v14, v2
    v_sub_f32 v15, v15, v2
    v_sub_f32 v16, v16, v2
    v_sub_f32 v17, v17, v2
    v_sub_f32 v18, v18, v2
    v_sub_f32 v19, v19, v2
    v_sub_f32 v20, v20, v2
    v_sub_f32 v21, v21, v2
    v_exp_f32 v54, v12
    v_exp_f32 v55, v13
    v_exp_f32 v56, v14
    v_exp_f32 v57, v15
    v_exp_f32 v58, v16
    v_exp_f32 v59, v17
    v_exp_f32 v60, v18
    v_exp_f32 v61, v19
    v_exp_f32 v62, v20
    v_exp_f32 v63, v21
    s_nop 0
    v_cvt_pk_bf16_f32 v154, v54, v55
    v_cvt_pk_bf16_f32 v155, v56, v57
    v_cvt_pk_bf16_f32 v156, v58, v59
    v_cvt_pk_bf16_f32 v157, v60, v61
    v_cvt_pk_bf16_f32 v8, v62, v63
    s_nop 0
    v_mfma_f32_16x16x32_bf16 v[50:53], v[154:157], v[4:7], 0
    v_mfma_f32_16x16x32_bf16 v[50:53], v[8:11], v[4:7], v[50:53]
    v_mfma_f32_16x16x32_bf16 v[24:27], v[154:157], v[82:85], 0
    v_mfma_f32_16x16x32_bf16 v[28:31], v[154:157], v[86:89], 0
    v_mfma_f32_16x16x32_bf16 v[32:35], v[154:157], v[90:93], 0
    v_mfma_f32_16x16x32_bf16 v[36:39], v[154:157], v[94:97], 0
arq_25_vs:
    s_waitcnt vmcnt(0)
    v_max3_u32 v3, v66, v67, v68
    v_max3_u32 v3, v3, v69, v70
    v_max3_u32 v3, v3, v71, v72
    v_max_u32 v3, v3, v73
    v_cmp_eq_u32 vcc, -1, v3
    s_cbranch_vccnz arq_25_vsr
    s_branch arq_25_vsok
arq_25_vsr:
    s_sub_u32 s26, s26, 1
    s_cbranch_scc1 arq_25_vsg
    buffer_load_dwordx4 v[66:69], v0, s[4:7], s22 offen offset:0 sc1
    buffer_load_dwordx4 v[70:73], v0, s[4:7], s22 offen offset:1024 sc1
    s_branch arq_25_vs
arq_25_vsg:
    s_mov_b32 s26, 0
arq_25_vsok:
    v_smfmac_f32_16x16x64_bf16 v[74:77], v[66:69], v[192:199], v41
    v_smfmac_f32_16x16x64_bf16 v[78:81], v[66:69], v[200:207], v41
    v_smfmac_f32_16x16x64_bf16 v[146:149], v[66:69], v[208:215], v41
    v_smfmac_f32_16x16x64_bf16 v[150:153], v[66:69], v[216:223], v41
    v_smfmac_f32_16x16x64_bf16 v[74:77], v[70:73], v[224:231], v41
    v_smfmac_f32_16x16x64_bf16 v[78:81], v[70:73], v[232:239], v41
    v_smfmac_f32_16x16x64_bf16 v[146:149], v[70:73], v[240:247], v41
    v_smfmac_f32_16x16x64_bf16 v[150:153], v[70:73], v[248:255], v41
    v_rcp_f32 v52, v52
    v_rcp_f32 v53, v53
    s_nop 2
    v_add_f32 v74, v74, v75
    v_add_f32 v76, v76, v77
    v_cvt_pk_bf16_f32 v40, v74, v76
    v_add_f32 v78, v78, v79
    v_add_f32 v80, v80, v81
    v_cvt_pk_bf16_f32 v42, v78, v80
    v_add_f32 v146, v146, v147
    v_add_f32 v148, v148, v149
    v_cvt_pk_bf16_f32 v44, v146, v148
    v_add_f32 v150, v150, v151
    v_add_f32 v152, v152, v153
    v_cvt_pk_bf16_f32 v46, v150, v152
    s_nop 1
    v_mfma_f32_16x16x32_bf16 v[24:27], v[8:11], v[40:43], v[24:27]
    v_mfma_f32_16x16x32_bf16 v[28:31], v[8:11], v[42:45], v[28:31]
    v_mfma_f32_16x16x32_bf16 v[32:35], v[8:11], v[44:47], v[32:35]
    v_mfma_f32_16x16x32_bf16 v[36:39], v[8:11], v[46:49], v[36:39]
    s_nop 4
    v_mul_f32 v26, v26, v52
    v_mul_f32 v27, v27, v53
    v_mul_f32 v30, v30, v52
    v_mul_f32 v31, v31, v53
    s_branch aloop_24_pvd
aloop_24_tm:
    s_nop 7
    v_max3_f32 v2, v12, v13, v14
    v_max3_f32 v3, v15, v16, v17
    v_max3_f32 v2, v2, v18, v19
    v_max3_f32 v3, v3, v20, v21
    v_max_f32 v2, v2, v3
    v_mov_b32 v3, v2
    s_nop 1
    v_permlane16_swap_b32 v3, v2
    v_max_f32 v2, v2, v3
    v_mov_b32 v3, v2
    s_nop 1
    v_permlane32_swap_b32 v3, v2
    v_max_f32 v2, v2, v3
    v_sub_f32 v12, v12, v2
    v_sub_f32 v13, v13, v2
    v_sub_f32 v14, v14, v2
    v_sub_f32 v15, v15, v2
    v_sub_f32 v16, v16, v2
    v_sub_f32 v17, v17, v2
    v_sub_f32 v18, v18, v2
    v_sub_f32 v19, v19, v2
    v_sub_f32 v20, v20, v2
    v_sub_f32 v21, v21, v2
    v_exp_f32 v54, v12
    v_exp_f32 v55, v13
    v_exp_f32 v56, v14
    v_exp_f32 v57, v15
    v_exp_f32 v58, v16
    v_exp_f32 v59, v17
    v_exp_f32 v60, v18
    v_exp_f32 v61, v19
    v_exp_f32 v62, v20
    v_exp_f32 v63, v21
    s_nop 0
    v_cvt_pk_bf16_f32 v154, v54, v55
    v_cvt_pk_bf16_f32 v155, v56, v57
    v_cvt_pk_bf16_f32 v156, v58, v59
    v_cvt_pk_bf16_f32 v157, v60, v61
    v_cvt_pk_bf16_f32 v8, v62, v63
    s_nop 0
    v_mfma_f32_16x16x32_bf16 v[50:53], v[154:157], v[4:7], 0
    v_mfma_f32_16x16x32_bf16 v[50:53], v[8:11], v[4:7], v[50:53]
    v_mfma_f32_16x16x32_bf16 v[24:27], v[154:157], v[82:85], 0
    v_mfma_f32_16x16x32_bf16 v[28:31], v[154:157], v[86:89], 0
    v_mfma_f32_16x16x32_bf16 v[32:35], v[154:157], v[90:93], 0
    v_mfma_f32_16x16x32_bf16 v[36:39], v[154:157], v[94:97], 0
    v_mfma_f32_16x16x32_bf16 v[24:27], v[8:11], v[40:43], v[24:27]
    v_mfma_f32_16x16x32_bf16 v[28:31], v[8:11], v[42:45], v[28:31]
    v_mfma_f32_16x16x32_bf16 v[32:35], v[8:11], v[44:47], v[32:35]
    v_mfma_f32_16x16x32_bf16 v[36:39], v[8:11], v[46:49], v[36:39]
    v_rcp_f32 v52, v52
    v_rcp_f32 v53, v53
    s_nop 4
    v_mul_f32 v26, v26, v52
    v_mul_f32 v27, v27, v53
    v_mul_f32 v30, v30, v52
    v_mul_f32 v31, v31, v53
    s_branch aloop_24_pvd
aloop_24_lz:
    buffer_load_dwordx4 v[66:69], v0, s[4:7], s22 offen offset:0 sc1
    buffer_load_dwordx4 v[70:73], v0, s[4:7], s22 offen offset:1024 sc1
    ds_write_b32 v47, v2 offset:16
aloop_24_lsk:
arq_25_vl:
    s_waitcnt vmcnt(0)
    v_max3_u32 v3, v66, v67, v68
    v_max3_u32 v3, v3, v69, v70
    v_max3_u32 v3, v3, v71, v72
    v_max_u32 v3, v3, v73
    v_cmp_eq_u32 vcc, -1, v3
    s_cbranch_vccnz arq_25_vlr
    s_branch arq_25_vlok
arq_25_vlr:
    s_sub_u32 s26, s26, 1
    s_cbranch_scc1 arq_25_vlg
    buffer_load_dwordx4 v[66:69], v0, s[4:7], s22 offen offset:0 sc1
    buffer_load_dwordx4 v[70:73], v0, s[4:7], s22 offen offset:1024 sc1
    s_branch arq_25_vl
arq_25_vlg:
    s_mov_b32 s26, 0
arq_25_vlok:
    v_smfmac_f32_16x16x64_bf16 v[74:77], v[66:69], v[192:199], v41
    v_smfmac_f32_16x16x64_bf16 v[78:81], v[66:69], v[200:207], v41
    v_smfmac_f32_16x16x64_bf16 v[146:149], v[66:69], v[208:215], v41
    v_smfmac_f32_16x16x64_bf16 v[150:153], v[66:69], v[216:223], v41
    v_smfmac_f32_16x16x64_bf16 v[74:77], v[70:73], v[224:231], v41
    v_smfmac_f32_16x16x64_bf16 v[78:81], v[70:73], v[232:239], v41
    v_smfmac_f32_16x16x64_bf16 v[146:149], v[70:73], v[240:247], v41
    v_smfmac_f32_16x16x64_bf16 v[150:153], v[70:73], v[248:255], v41
    s_nop 4
    v_add_f32 v74, v74, v75
    v_add_f32 v76, v76, v77
    v_cvt_pk_bf16_f32 v40, v74, v76
    v_add_f32 v78, v78, v79
    v_add_f32 v80, v80, v81
    v_cvt_pk_bf16_f32 v42, v78, v80
    v_add_f32 v146, v146, v147
    v_add_f32 v148, v148, v149
    v_cvt_pk_bf16_f32 v44, v146, v148
    v_add_f32 v150, v150, v151
    v_add_f32 v152, v152, v153
    v_cvt_pk_bf16_f32 v46, v150, v152
    s_branch aloop_24_lskb
arq_25_ps:
    s_sub_u32 s26, s26, 1
    s_cbranch_scc1 arq_25_psg
    s_sleep 2
    buffer_load_dwordx4 v[130:133], v0, s[4:7], s21 offen sc1
    buffer_load_dwordx2 v[146:147], v2, s[4:7], s21 offen offset:1024 sc1
    buffer_load_dwordx4 v[134:137], v0, s[4:7], s21 offen offset:2048 sc1
    buffer_load_dwordx2 v[148:149], v2, s[4:7], s21 offen offset:3072 sc1
    s_branch aloop_24_psa
arq_25_psg:
    s_mov_b32 s26, 0
    s_branch aloop_24_psok
aloop_24_fin:
    s_barrier
    s_branch k_end
k_end:
k_exit:
    s_endpgm
.section .rodata,"a"
.p2align 6
jobtab:
    .long 6, 24, 24, 8192, 0, 262144, 8388608, 0, 32768, 4, 20971520, 131072, 0, 0, 218104320, 1
    .long 4, 24, 24, 8192, 0, 262144, 8388608, 262144, 32768, 4, 22020096, 131072, 0, 0, 218104448, 1
    .long 1, 32, 32, 8192, 0, 256, 8388608, 1048576, 32768, 8, 41943040, 131072, 0, 0, 218104832, 4
    .long 1, 16, 16, 8192, 0, 256, 8388608, 2097152, 32768, 8, 12582912, 131072, 0, 0, 218105344, 4
    .long 1, 32, 32, 8192, 0, 256, 8388608, 3145728, 32768, 8, 50331648, 131072, 0, 0, 218105856, 4
    .long 1, 32, 32, 8192, 0, 256, 8388608, 3670016, 32768, 8, 52428800, 131072, 0, 0, 218106112, 4
    .long 1, 80, 80, 2048, 0, 256, 7340032, 54525952, 114688, 7, 167772160, 32768, 218103808, 7, 218106368, 1
    .long 0, 0, 0, 0, 0, 0, 0, 0, 0, 0, 0, 0, 0, 0, 0, 0
    .long 0, 0, 0, 0, 0, 0, 0, 0, 0, 0, 0, 0, 0, 0, 0, 0
    .long 0, 0, 0, 0, 0, 0, 0, 0, 0, 0, 0, 0, 0, 0, 0, 0
    .long 6, 24, 24, 8192, 2048, 264192, 8388608, 0, 32768, 4, 21004288, 131072, 0, 0, 218104352, 1
    .long 4, 24, 24, 8192, 2048, 264192, 8388608, 262144, 32768, 4, 22052864, 131072, 0, 0, 218104480, 1
    .long 1, 32, 32, 8192, 2048, 2304, 8388608, 1048576, 32768, 8, 41975808, 131072, 0, 0, 218104864, 4
    .long 1, 16, 16, 8192, 2048, 2304, 8388608, 2097152, 32768, 8, 12615680, 131072, 0, 0, 218105376, 4
    .long 1, 32, 32, 8192, 2048, 2304, 8388608, 3145728, 32768, 8, 50364416, 131072, 0, 0, 218105888, 4
    .long 1, 32, 32, 8192, 2048, 2304, 8388608, 3670016, 32768, 8, 52461568, 131072, 0, 0, 218106144, 4
    .long 1, 80, 80, 2048, 1835008, 1835264, 7340032, 54554624, 114688, 7, 171966464, 32768, 218103824, 7, 218106368, 1
    .long 0, 0, 0, 0, 0, 0, 0, 0, 0, 0, 0, 0, 0, 0, 0, 0
    .long 0, 0, 0, 0, 0, 0, 0, 0, 0, 0, 0, 0, 0, 0, 0, 0
    .long 0, 0, 0, 0, 0, 0, 0, 0, 0, 0, 0, 0, 0, 0, 0, 0
    .long 6, 24, 24, 8192, 4096, 266240, 8388608, 0, 32768, 4, 21037056, 131072, 0, 0, 218104384, 1
    .long 4, 24, 24, 8192, 4096, 266240, 8388608, 262144, 32768, 4, 22085632, 131072, 0, 0, 218104512, 1
    .long 1, 32, 32, 8192, 4096, 4352, 8388608, 1048576, 32768, 8, 42008576, 131072, 0, 0, 218104896, 4
    .long 1, 16, 16, 8192, 4096, 4352, 8388608, 2097152, 32768, 8, 12648448, 131072, 0, 0, 218105408, 4
    .long 1, 32, 32, 8192, 4096, 4352, 8388608, 3145728, 32768, 8, 50397184, 131072, 0, 0, 218105920, 4
    .long 1, 32, 32, 8192, 4096, 4352, 8388608, 3670016, 32768, 8, 52494336, 131072, 0, 0, 218106176, 4
    .long 1, 80, 80, 2048, 3670016, 3670272, 7340032, 54583296, 114688, 7, 176160768, 32768, 218103840, 7, 218106368, 1
    .long 0, 0, 0, 0, 0, 0, 0, 0, 0, 0, 0, 0, 0, 0, 0, 0
    .long 0, 0, 0, 0, 0, 0, 0, 0, 0, 0, 0, 0, 0, 0, 0, 0
    .long 0, 0, 0, 0, 0, 0, 0, 0, 0, 0, 0, 0, 0, 0, 0, 0
    .long 6, 24, 24, 8192, 6144, 268288, 8388608, 0, 32768, 4, 21069824, 131072, 0, 0, 218104416, 1
    .long 4, 24, 24, 8192, 6144, 268288, 8388608, 262144, 32768, 4, 22118400, 131072, 0, 0, 218104544, 1
    .long 1, 32, 32, 8192, 6144, 6400, 8388608, 1048576, 32768, 8, 42041344, 131072, 0, 0, 218104928, 4
    .long 1, 16, 16, 8192, 6144, 6400, 8388608, 2097152, 32768, 8, 12681216, 131072, 0, 0, 218105440, 4
    .long 1, 32, 32, 8192, 6144, 6400, 8388608, 3145728, 32768, 8, 50429952, 131072, 0, 0, 218105952, 4
    .long 1, 32, 32, 8192, 6144, 6400, 8388608, 3670016, 32768, 8, 52527104, 131072, 0, 0, 218106208, 4
    .long 1, 80, 80, 2048, 5505024, 5505280, 7340032, 54611968, 114688, 7, 180355072, 32768, 218103856, 7, 218106368, 1
    .long 0, 0, 0, 0, 0, 0, 0, 0, 0, 0, 0, 0, 0, 0, 0, 0
    .long 0, 0, 0, 0, 0, 0, 0, 0, 0, 0, 0, 0, 0, 0, 0, 0
    .long 0, 0, 0, 0, 0, 0, 0, 0, 0, 0, 0, 0, 0, 0, 0, 0
    .long 6, 24, 24, 8192, 256, 262400, 8388608, 0, 32768, 4, 20975616, 131072, 0, 0, 218104320, 1
    .long 4, 24, 24, 8192, 256, 262400, 8388608, 262144, 32768, 4, 22024192, 131072, 0, 0, 218104448, 1
    .long 1, 32, 32, 8192, 512, 768, 8388608, 1048576, 32768, 8, 41951232, 131072, 0, 0, 218104832, 4
    .long 1, 16, 16, 8192, 512, 768, 8388608, 2097152, 32768, 8, 12591104, 131072, 0, 0, 218105344, 4
    .long 1, 32, 32, 8192, 512, 768, 8388608, 3145728, 32768, 8, 50339840, 131072, 0, 0, 218105856, 4
    .long 1, 32, 32, 8192, 512, 768, 8388608, 3670016, 32768, 8, 52436992, 131072, 0, 0, 218106112, 4
    .long 1, 80, 80, 2048, 512, 768, 7340032, 54525952, 114688, 7, 167780352, 32768, 218103808, 7, 218106368, 1
    .long 0, 0, 0, 0, 0, 0, 0, 0, 0, 0, 0, 0, 0, 0, 0, 0
    .long 0, 0, 0, 0, 0, 0, 0, 0, 0, 0, 0, 0, 0, 0, 0, 0
    .long 0, 0, 0, 0, 0, 0, 0, 0, 0, 0, 0, 0, 0, 0, 0, 0
    .long 6, 24, 24, 8192, 2304, 264448, 8388608, 0, 32768, 4, 21008384, 131072, 0, 0, 218104352, 1
    .long 4, 24, 24, 8192, 2304, 264448, 8388608, 262144, 32768, 4, 22056960, 131072, 0, 0, 218104480, 1
    .long 1, 32, 32, 8192, 2560, 2816, 8388608, 1048576, 32768, 8, 41984000, 131072, 0, 0, 218104864, 4
    .long 1, 16, 16, 8192, 2560, 2816, 8388608, 2097152, 32768, 8, 12623872, 131072, 0, 0, 218105376, 4
    .long 1, 32, 32, 8192, 2560, 2816, 8388608, 3145728, 32768, 8, 50372608, 131072, 0, 0, 218105888, 4
    .long 1, 32, 32, 8192, 2560, 2816, 8388608, 3670016, 32768, 8, 52469760, 131072, 0, 0, 218106144, 4
    .long 1, 80, 80, 2048, 1835520, 1835776, 7340032, 54554624, 114688, 7, 171974656, 32768, 218103824, 7, 218106368, 1
    .long 0, 0, 0, 0, 0, 0, 0, 0, 0, 0, 0, 0, 0, 0, 0, 0
    .long 0, 0, 0, 0, 0, 0, 0, 0, 0, 0, 0, 0, 0, 0, 0, 0
    .long 0, 0, 0, 0, 0, 0, 0, 0, 0, 0, 0, 0, 0, 0, 0, 0
    .long 6, 24, 24, 8192, 4352, 266496, 8388608, 0, 32768, 4, 21041152, 131072, 0, 0, 218104384, 1
    .long 4, 24, 24, 8192, 4352, 266496, 8388608, 262144, 32768, 4, 22089728, 131072, 0, 0, 218104512, 1
    .long 1, 32, 32, 8192, 4608, 4864, 8388608, 1048576, 32768, 8, 42016768, 131072, 0, 0, 218104896, 4
    .long 1, 16, 16, 8192, 4608, 4864, 8388608, 2097152, 32768, 8, 12656640, 131072, 0, 0, 218105408, 4
    .long 1, 32, 32, 8192, 4608, 4864, 8388608, 3145728, 32768, 8, 50405376, 131072, 0, 0, 218105920, 4
    .long 1, 32, 32, 8192, 4608, 4864, 8388608, 3670016, 32768, 8, 52502528, 131072, 0, 0, 218106176, 4
    .long 1, 80, 80, 2048, 3670528, 3670784, 7340032, 54583296, 114688, 7, 176168960, 32768, 218103840, 7, 218106368, 1
    .long 0, 0, 0, 0, 0, 0, 0, 0, 0, 0, 0, 0, 0, 0, 0, 0
    .long 0, 0, 0, 0, 0, 0, 0, 0, 0, 0, 0, 0, 0, 0, 0, 0
    .long 0, 0, 0, 0, 0, 0, 0, 0, 0, 0, 0, 0, 0, 0, 0, 0
    .long 6, 24, 24, 8192, 6400, 268544, 8388608, 0, 32768, 4, 21073920, 131072, 0, 0, 218104416, 1
    .long 4, 24, 24, 8192, 6400, 268544, 8388608, 262144, 32768, 4, 22122496, 131072, 0, 0, 218104544, 1
    .long 1, 32, 32, 8192, 6656, 6912, 8388608, 1048576, 32768, 8, 42049536, 131072, 0, 0, 218104928, 4
    .long 1, 16, 16, 8192, 6656, 6912, 8388608, 2097152, 32768, 8, 12689408, 131072, 0, 0, 218105440, 4
    .long 1, 32, 32, 8192, 6656, 6912, 8388608, 3145728, 32768, 8, 50438144, 131072, 0, 0, 218105952, 4
    .long 1, 32, 32, 8192, 6656, 6912, 8388608, 3670016, 32768, 8, 52535296, 131072, 0, 0, 218106208, 4
    .long 1, 80, 80, 2048, 5505536, 5505792, 7340032, 54611968, 114688, 7, 180363264, 32768, 218103856, 7, 218106368, 1
    .long 0, 0, 0, 0, 0, 0, 0, 0, 0, 0, 0, 0, 0, 0, 0, 0
    .long 0, 0, 0, 0, 0, 0, 0, 0, 0, 0, 0, 0, 0, 0, 0, 0
    .long 0, 0, 0, 0, 0, 0, 0, 0, 0, 0, 0, 0, 0, 0, 0, 0
    .long 6, 24, 24, 8192, 512, 262656, 8388608, 0, 32768, 4, 20979712, 131072, 0, 0, 218104320, 1
    .long 4, 24, 24, 8192, 512, 262656, 8388608, 262144, 32768, 4, 22028288, 131072, 0, 0, 218104448, 1
    .long 1, 32, 32, 8192, 1024, 1280, 8388608, 1048576, 32768, 8, 41959424, 131072, 0, 0, 218104848, 4
    .long 1, 16, 16, 8192, 1024, 1280, 8388608, 2097152, 32768, 8, 12599296, 131072, 0, 0, 218105360, 4
    .long 1, 32, 32, 8192, 1024, 1280, 8388608, 3145728, 32768, 8, 50348032, 131072, 0, 0, 218105872, 4
    .long 1, 32, 32, 8192, 1024, 1280, 8388608, 3670016, 32768, 8, 52445184, 131072, 0, 0, 218106128, 4
    .long 1, 80, 80, 2048, 1024, 1280, 7340032, 54525952, 114688, 7, 167788544, 32768, 218103808, 7, 218106368, 1
    .long 0, 0, 0, 0, 0, 0, 0, 0, 0, 0, 0, 0, 0, 0, 0, 0
    .long 0, 0, 0, 0, 0, 0, 0, 0, 0, 0, 0, 0, 0, 0, 0, 0
    .long 0, 0, 0, 0, 0, 0, 0, 0, 0, 0, 0, 0, 0, 0, 0, 0
    .long 6, 24, 24, 8192, 2560, 264704, 8388608, 0, 32768, 4, 21012480, 131072, 0, 0, 218104352, 1
    .long 4, 24, 24, 8192, 2560, 264704, 8388608, 262144, 32768, 4, 22061056, 131072, 0, 0, 218104480, 1
    .long 1, 32, 32, 8192, 3072, 3328, 8388608, 1048576, 32768, 8, 41992192, 131072, 0, 0, 218104880, 4
    .long 1, 16, 16, 8192, 3072, 3328, 8388608, 2097152, 32768, 8, 12632064, 131072, 0, 0, 218105392, 4
    .long 1, 32, 32, 8192, 3072, 3328, 8388608, 3145728, 32768, 8, 50380800, 131072, 0, 0, 218105904, 4
    .long 1, 32, 32, 8192, 3072, 3328, 8388608, 3670016, 32768, 8, 52477952, 131072, 0, 0, 218106160, 4
    .long 1, 80, 80, 2048, 1836032, 1836288, 7340032, 54554624, 114688, 7, 171982848, 32768, 218103824, 7, 218106368, 1
    .long 0, 0, 0, 0, 0, 0, 0, 0, 0, 0, 0, 0, 0, 0, 0, 0
    .long 0, 0, 0, 0, 0, 0, 0, 0, 0, 0, 0, 0, 0, 0, 0, 0
    .long 0, 0, 0, 0, 0, 0, 0, 0, 0, 0, 0, 0, 0, 0, 0, 0
    .long 6, 24, 24, 8192, 4608, 266752, 8388608, 0, 32768, 4, 21045248, 131072, 0, 0, 218104384, 1
    .long 4, 24, 24, 8192, 4608, 266752, 8388608, 262144, 32768, 4, 22093824, 131072, 0, 0, 218104512, 1
    .long 1, 32, 32, 8192, 5120, 5376, 8388608, 1048576, 32768, 8, 42024960, 131072, 0, 0, 218104912, 4
    .long 1, 16, 16, 8192, 5120, 5376, 8388608, 2097152, 32768, 8, 12664832, 131072, 0, 0, 218105424, 4
    .long 1, 32, 32, 8192, 5120, 5376, 8388608, 3145728, 32768, 8, 50413568, 131072, 0, 0, 218105936, 4
    .long 1, 32, 32, 8192, 5120, 5376, 8388608, 3670016, 32768, 8, 52510720, 131072, 0, 0, 218106192, 4
    .long 1, 80, 80, 2048, 3671040, 3671296, 7340032, 54583296, 114688, 7, 176177152, 32768, 218103840, 7, 218106368, 1
    .long 0, 0, 0, 0, 0, 0, 0, 0, 0, 0, 0, 0, 0, 0, 0, 0
    .long 0, 0, 0, 0, 0, 0, 0, 0, 0, 0, 0, 0, 0, 0, 0, 0
    .long 0, 0, 0, 0, 0, 0, 0, 0, 0, 0, 0, 0, 0, 0, 0, 0
    .long 6, 24, 24, 8192, 6656, 268800, 8388608, 0, 32768, 4, 21078016, 131072, 0, 0, 218104416, 1
    .long 4, 24, 24, 8192, 6656, 268800, 8388608, 262144, 32768, 4, 22126592, 131072, 0, 0, 218104544, 1
    .long 1, 32, 32, 8192, 7168, 7424, 8388608, 1048576, 32768, 8, 42057728, 131072, 0, 0, 218104944, 4
    .long 1, 16, 16, 8192, 7168, 7424, 8388608, 2097152, 32768, 8, 12697600, 131072, 0, 0, 218105456, 4
    .long 1, 32, 32, 8192, 7168, 7424, 8388608, 3145728, 32768, 8, 50446336, 131072, 0, 0, 218105968, 4
    .long 1, 32, 32, 8192, 7168, 7424, 8388608, 3670016, 32768, 8, 52543488, 131072, 0, 0, 218106224, 4
    .long 1, 80, 80, 2048, 5506048, 5506304, 7340032, 54611968, 114688, 7, 180371456, 32768, 218103856, 7, 218106368, 1
    .long 0, 0, 0, 0, 0, 0, 0, 0, 0, 0, 0, 0, 0, 0, 0, 0
    .long 0, 0, 0, 0, 0, 0, 0, 0, 0, 0, 0, 0, 0, 0, 0, 0
    .long 0, 0, 0, 0, 0, 0, 0, 0, 0, 0, 0, 0, 0, 0, 0, 0
    .long 6, 24, 24, 8192, 768, 262912, 8388608, 0, 32768, 4, 20983808, 131072, 0, 0, 218104320, 1
    .long 4, 24, 24, 8192, 768, 262912, 8388608, 262144, 32768, 4, 22032384, 131072, 0, 0, 218104448, 1
    .long 1, 32, 32, 8192, 1536, 1792, 8388608, 1048576, 32768, 8, 41967616, 131072, 0, 0, 218104848, 4
    .long 1, 16, 16, 8192, 1536, 1792, 8388608, 2097152, 32768, 8, 12607488, 131072, 0, 0, 218105360, 4
    .long 1, 32, 32, 8192, 1536, 1792, 8388608, 3145728, 32768, 8, 50356224, 131072, 0, 0, 218105872, 4
    .long 1, 32, 32, 8192, 1536, 1792, 8388608, 3670016, 32768, 8, 52453376, 131072, 0, 0, 218106128, 4
    .long 1, 80, 80, 2048, 1536, 1792, 7340032, 54525952, 114688, 7, 167796736, 32768, 218103808, 7, 218106368, 1
    .long 0, 0, 0, 0, 0, 0, 0, 0, 0, 0, 0, 0, 0, 0, 0, 0
    .long 0, 0, 0, 0, 0, 0, 0, 0, 0, 0, 0, 0, 0, 0, 0, 0
    .long 0, 0, 0, 0, 0, 0, 0, 0, 0, 0, 0, 0, 0, 0, 0, 0
    .long 6, 24, 24, 8192, 2816, 264960, 8388608, 0, 32768, 4, 21016576, 131072, 0, 0, 218104352, 1
    .long 4, 24, 24, 8192, 2816, 264960, 8388608, 262144, 32768, 4, 22065152, 131072, 0, 0, 218104480, 1
    .long 1, 32, 32, 8192, 3584, 3840, 8388608, 1048576, 32768, 8, 42000384, 131072, 0, 0, 218104880, 4
    .long 1, 16, 16, 8192, 3584, 3840, 8388608, 2097152, 32768, 8, 12640256, 131072, 0, 0, 218105392, 4
    .long 1, 32, 32, 8192, 3584, 3840, 8388608, 3145728, 32768, 8, 50388992, 131072, 0, 0, 218105904, 4
    .long 1, 32, 32, 8192, 3584, 3840, 8388608, 3670016, 32768, 8, 52486144, 131072, 0, 0, 218106160, 4
    .long 1, 80, 80, 2048, 1836544, 1836800, 7340032, 54554624, 114688, 7, 171991040, 32768, 218103824, 7, 218106368, 1
    .long 0, 0, 0, 0, 0, 0, 0, 0, 0, 0, 0, 0, 0, 0, 0, 0
    .long 0, 0, 0, 0, 0, 0, 0, 0, 0, 0, 0, 0, 0, 0, 0, 0
    .long 0, 0, 0, 0, 0, 0, 0, 0, 0, 0, 0, 0, 0, 0, 0, 0
    .long 6, 24, 24, 8192, 4864, 267008, 8388608, 0, 32768, 4, 21049344, 131072, 0, 0, 218104384, 1
    .long 4, 24, 24, 8192, 4864, 267008, 8388608, 262144, 32768, 4, 22097920, 131072, 0, 0, 218104512, 1
    .long 1, 32, 32, 8192, 5632, 5888, 8388608, 1048576, 32768, 8, 42033152, 131072, 0, 0, 218104912, 4
    .long 1, 16, 16, 8192, 5632, 5888, 8388608, 2097152, 32768, 8, 12673024, 131072, 0, 0, 218105424, 4
    .long 1, 32, 32, 8192, 5632, 5888, 8388608, 3145728, 32768, 8, 50421760, 131072, 0, 0, 218105936, 4
    .long 1, 32, 32, 8192, 5632, 5888, 8388608, 3670016, 32768, 8, 52518912, 131072, 0, 0, 218106192, 4
    .long 1, 80, 80, 2048, 3671552, 3671808, 7340032, 54583296, 114688, 7, 176185344, 32768, 218103840, 7, 218106368, 1
    .long 0, 0, 0, 0, 0, 0, 0, 0, 0, 0, 0, 0, 0, 0, 0, 0
    .long 0, 0, 0, 0, 0, 0, 0, 0, 0, 0, 0, 0, 0, 0, 0, 0
    .long 0, 0, 0, 0, 0, 0, 0, 0, 0, 0, 0, 0, 0, 0, 0, 0
    .long 6, 24, 24, 8192, 6912, 269056, 8388608, 0, 32768, 4, 21082112, 131072, 0, 0, 218104416, 1
    .long 4, 24, 24, 8192, 6912, 269056, 8388608, 262144, 32768, 4, 22130688, 131072, 0, 0, 218104544, 1
    .long 1, 32, 32, 8192, 7680, 7936, 8388608, 1048576, 32768, 8, 42065920, 131072, 0, 0, 218104944, 4
    .long 1, 16, 16, 8192, 7680, 7936, 8388608, 2097152, 32768, 8, 12705792, 131072, 0, 0, 218105456, 4
    .long 1, 32, 32, 8192, 7680, 7936, 8388608, 3145728, 32768, 8, 50454528, 131072, 0, 0, 218105968, 4
    .long 1, 32, 32, 8192, 7680, 7936, 8388608, 3670016, 32768, 8, 52551680, 131072, 0, 0, 218106224, 4
    .long 1, 80, 80, 2048, 5506560, 5506816, 7340032, 54611968, 114688, 7, 180379648, 32768, 218103856, 7, 218106368, 1
    .long 0, 0, 0, 0, 0, 0, 0, 0, 0, 0, 0, 0, 0, 0, 0, 0
    .long 0, 0, 0, 0, 0, 0, 0, 0, 0, 0, 0, 0, 0, 0, 0, 0
    .long 0, 0, 0, 0, 0, 0, 0, 0, 0, 0, 0, 0, 0, 0, 0, 0
    .long 6, 24, 24, 8192, 1024, 263168, 8388608, 0, 32768, 4, 20987904, 131072, 0, 0, 218104336, 1
    .long 4, 24, 24, 8192, 1024, 263168, 8388608, 262144, 32768, 4, 22036480, 131072, 0, 0, 218104464, 1
    .long 1, 24, 24, 8192, 0, 256, 8388608, 1048576, 32768, 8, 25165824, 131072, 0, 0, 218104832, 4
    .long 1, 32, 32, 8192, 0, 256, 8388608, 2621440, 32768, 8, 48234496, 131072, 0, 0, 218105600, 4
    .long 1, 24, 24, 8192, 0, 256, 8388608, 3145728, 32768, 8, 33554432, 131072, 0, 0, 218105856, 4
    .long 1, 24, 24, 8192, 0, 256, 8388608, 3670016, 32768, 8, 35651584, 131072, 0, 0, 218106112, 4
    .long 1, 80, 80, 2048, 0, 256, 7340032, 56360960, 114688, 7, 168296448, 32768, 218103872, 7, 218106432, 1
    .long 0, 0, 0, 0, 0, 0, 0, 0, 0, 0, 0, 0, 0, 0, 0, 0
    .long 0, 0, 0, 0, 0, 0, 0, 0, 0, 0, 0, 0, 0, 0, 0, 0
    .long 0, 0, 0, 0, 0, 0, 0, 0, 0, 0, 0, 0, 0, 0, 0, 0
    .long 6, 24, 24, 8192, 3072, 265216, 8388608, 0, 32768, 4, 21020672, 131072, 0, 0, 218104368, 1
    .long 4, 24, 24, 8192, 3072, 265216, 8388608, 262144, 32768, 4, 22069248, 131072, 0, 0, 218104496, 1
    .long 1, 24, 24, 8192, 2048, 2304, 8388608, 1048576, 32768, 8, 25198592, 131072, 0, 0, 218104864, 4
    .long 1, 32, 32, 8192, 2048, 2304, 8388608, 2621440, 32768, 8, 48267264, 131072, 0, 0, 218105632, 4
    .long 1, 24, 24, 8192, 2048, 2304, 8388608, 3145728, 32768, 8, 33587200, 131072, 0, 0, 218105888, 4
    .long 1, 24, 24, 8192, 2048, 2304, 8388608, 3670016, 32768, 8, 35684352, 131072, 0, 0, 218106144, 4
    .long 1, 80, 80, 2048, 1835008, 1835264, 7340032, 56389632, 114688, 7, 172490752, 32768, 218103888, 7, 218106432, 1
    .long 0, 0, 0, 0, 0, 0, 0, 0, 0, 0, 0, 0, 0, 0, 0, 0
    .long 0, 0, 0, 0, 0, 0, 0, 0, 0, 0, 0, 0, 0, 0, 0, 0
    .long 0, 0, 0, 0, 0, 0, 0, 0, 0, 0, 0, 0, 0, 0, 0, 0
    .long 6, 24, 24, 8192, 5120, 267264, 8388608, 0, 32768, 4, 21053440, 131072, 0, 0, 218104400, 1
    .long 4, 24, 24, 8192, 5120, 267264, 8388608, 262144, 32768, 4, 22102016, 131072, 0, 0, 218104528, 1
    .long 1, 24, 24, 8192, 4096, 4352, 8388608, 1048576, 32768, 8, 25231360, 131072, 0, 0, 218104896, 4
    .long 1, 32, 32, 8192, 4096, 4352, 8388608, 2621440, 32768, 8, 48300032, 131072, 0, 0, 218105664, 4
    .long 1, 24, 24, 8192, 4096, 4352, 8388608, 3145728, 32768, 8, 33619968, 131072, 0, 0, 218105920, 4
    .long 1, 24, 24, 8192, 4096, 4352, 8388608, 3670016, 32768, 8, 35717120, 131072, 0, 0, 218106176, 4
    .long 1, 80, 80, 2048, 3670016, 3670272, 7340032, 56418304, 114688, 7, 176685056, 32768, 218103904, 7, 218106432, 1
    .long 0, 0, 0, 0, 0, 0, 0, 0, 0, 0, 0, 0, 0, 0, 0, 0
    .long 0, 0, 0, 0, 0, 0, 0, 0, 0, 0, 0, 0, 0, 0, 0, 0
    .long 0, 0, 0, 0, 0, 0, 0, 0, 0, 0, 0, 0, 0, 0, 0, 0
    .long 6, 24, 24, 8192, 7168, 269312, 8388608, 0, 32768, 4, 21086208, 131072, 0, 0, 218104432, 1
    .long 4, 24, 24, 8192, 7168, 269312, 8388608, 262144, 32768, 4, 22134784, 131072, 0, 0, 218104560, 1
    .long 1, 24, 24, 8192, 6144, 6400, 8388608, 1048576, 32768, 8, 25264128, 131072, 0, 0, 218104928, 4
    .long 1, 32, 32, 8192, 6144, 6400, 8388608, 2621440, 32768, 8, 48332800, 131072, 0, 0, 218105696, 4
    .long 1, 24, 24, 8192, 6144, 6400, 8388608, 3145728, 32768, 8, 33652736, 131072, 0, 0, 218105952, 4
    .long 1, 24, 24, 8192, 6144, 6400, 8388608, 3670016, 32768, 8, 35749888, 131072, 0, 0, 218106208, 4
    .long 1, 80, 80, 2048, 5505024, 5505280, 7340032, 56446976, 114688, 7, 180879360, 32768, 218103920, 7, 218106432, 1
    .long 0, 0, 0, 0, 0, 0, 0, 0, 0, 0, 0, 0, 0, 0, 0, 0
    .long 0, 0, 0, 0, 0, 0, 0, 0, 0, 0, 0, 0, 0, 0, 0, 0
    .long 0, 0, 0, 0, 0, 0, 0, 0, 0, 0, 0, 0, 0, 0, 0, 0
    .long 6, 24, 24, 8192, 1280, 263424, 8388608, 0, 32768, 4, 20992000, 131072, 0, 0, 218104336, 1
    .long 4, 24, 24, 8192, 1280, 263424, 8388608, 262144, 32768, 4, 22040576, 131072, 0, 0, 218104464, 1
    .long 1, 24, 24, 8192, 512, 768, 8388608, 1048576, 32768, 8, 25174016, 131072, 0, 0, 218104832, 4
    .long 1, 32, 32, 8192, 512, 768, 8388608, 2621440, 32768, 8, 48242688, 131072, 0, 0, 218105600, 4
    .long 1, 24, 24, 8192, 512, 768, 8388608, 3145728, 32768, 8, 33562624, 131072, 0, 0, 218105856, 4
    .long 1, 24, 24, 8192, 512, 768, 8388608, 3670016, 32768, 8, 35659776, 131072, 0, 0, 218106112, 4
    .long 1, 80, 80, 2048, 512, 768, 7340032, 56360960, 114688, 7, 168304640, 32768, 218103872, 7, 218106432, 1
    .long 0, 0, 0, 0, 0, 0, 0, 0, 0, 0, 0, 0, 0, 0, 0, 0
    .long 0, 0, 0, 0, 0, 0, 0, 0, 0, 0, 0, 0, 0, 0, 0, 0
    .long 0, 0, 0, 0, 0, 0, 0, 0, 0, 0, 0, 0, 0, 0, 0, 0
    .long 6, 24, 24, 8192, 3328, 265472, 8388608, 0, 32768, 4, 21024768, 131072, 0, 0, 218104368, 1
    .long 4, 24, 24, 8192, 3328, 265472, 8388608, 262144, 32768, 4, 22073344, 131072, 0, 0, 218104496, 1
    .long 1, 24, 24, 8192, 2560, 2816, 8388608, 1048576, 32768, 8, 25206784, 131072, 0, 0, 218104864, 4
    .long 1, 32, 32, 8192, 2560, 2816, 8388608, 2621440, 32768, 8, 48275456, 131072, 0, 0, 218105632, 4
    .long 1, 24, 24, 8192, 2560, 2816, 8388608, 3145728, 32768, 8, 33595392, 131072, 0, 0, 218105888, 4
    .long 1, 24, 24, 8192, 2560, 2816, 8388608, 3670016, 32768, 8, 35692544, 131072, 0, 0, 218106144, 4
    .long 1, 80, 80, 2048, 1835520, 1835776, 7340032, 56389632, 114688, 7, 172498944, 32768, 218103888, 7, 218106432, 1
    .long 0, 0, 0, 0, 0, 0, 0, 0, 0, 0, 0, 0, 0, 0, 0, 0
    .long 0, 0, 0, 0, 0, 0, 0, 0, 0, 0, 0, 0, 0, 0, 0, 0
    .long 0, 0, 0, 0, 0, 0, 0, 0, 0, 0, 0, 0, 0, 0, 0, 0
    .long 6, 24, 24, 8192, 5376, 267520, 8388608, 0, 32768, 4, 21057536, 131072, 0, 0, 218104400, 1
    .long 4, 24, 24, 8192, 5376, 267520, 8388608, 262144, 32768, 4, 22106112, 131072, 0, 0, 218104528, 1
    .long 1, 24, 24, 8192, 4608, 4864, 8388608, 1048576, 32768, 8, 25239552, 131072, 0, 0, 218104896, 4
    .long 1, 32, 32, 8192, 4608, 4864, 8388608, 2621440, 32768, 8, 48308224, 131072, 0, 0, 218105664, 4
    .long 1, 24, 24, 8192, 4608, 4864, 8388608, 3145728, 32768, 8, 33628160, 131072, 0, 0, 218105920, 4
    .long 1, 24, 24, 8192, 4608, 4864, 8388608, 3670016, 32768, 8, 35725312, 131072, 0, 0, 218106176, 4
    .long 1, 80, 80, 2048, 3670528, 3670784, 7340032, 56418304, 114688, 7, 176693248, 32768, 218103904, 7, 218106432, 1
    .long 0, 0, 0, 0, 0, 0, 0, 0, 0, 0, 0, 0, 0, 0, 0, 0
    .long 0, 0, 0, 0, 0, 0, 0, 0, 0, 0, 0, 0, 0, 0, 0, 0
    .long 0, 0, 0, 0, 0, 0, 0, 0, 0, 0, 0, 0, 0, 0, 0, 0
    .long 6, 24, 24, 8192, 7424, 269568, 8388608, 0, 32768, 4, 21090304, 131072, 0, 0, 218104432, 1
    .long 4, 24, 24, 8192, 7424, 269568, 8388608, 262144, 32768, 4, 22138880, 131072, 0, 0, 218104560, 1
    .long 1, 24, 24, 8192, 6656, 6912, 8388608, 1048576, 32768, 8, 25272320, 131072, 0, 0, 218104928, 4
    .long 1, 32, 32, 8192, 6656, 6912, 8388608, 2621440, 32768, 8, 48340992, 131072, 0, 0, 218105696, 4
    .long 1, 24, 24, 8192, 6656, 6912, 8388608, 3145728, 32768, 8, 33660928, 131072, 0, 0, 218105952, 4
    .long 1, 24, 24, 8192, 6656, 6912, 8388608, 3670016, 32768, 8, 35758080, 131072, 0, 0, 218106208, 4
    .long 1, 80, 80, 2048, 5505536, 5505792, 7340032, 56446976, 114688, 7, 180887552, 32768, 218103920, 7, 218106432, 1
    .long 0, 0, 0, 0, 0, 0, 0, 0, 0, 0, 0, 0, 0, 0, 0, 0
    .long 0, 0, 0, 0, 0, 0, 0, 0, 0, 0, 0, 0, 0, 0, 0, 0
    .long 0, 0, 0, 0, 0, 0, 0, 0, 0, 0, 0, 0, 0, 0, 0, 0
    .long 6, 24, 24, 8192, 1536, 263680, 8388608, 0, 32768, 4, 20996096, 131072, 0, 0, 218104336, 1
    .long 4, 24, 24, 8192, 1536, 263680, 8388608, 262144, 32768, 4, 22044672, 131072, 0, 0, 218104464, 1
    .long 1, 24, 24, 8192, 1024, 1280, 8388608, 1048576, 32768, 8, 25182208, 131072, 0, 0, 218104848, 4
    .long 1, 32, 32, 8192, 1024, 1280, 8388608, 2621440, 32768, 8, 48250880, 131072, 0, 0, 218105616, 4
    .long 1, 24, 24, 8192, 1024, 1280, 8388608, 3145728, 32768, 8, 33570816, 131072, 0, 0, 218105872, 4
    .long 1, 24, 24, 8192, 1024, 1280, 8388608, 3670016, 32768, 8, 35667968, 131072, 0, 0, 218106128, 4
    .long 1, 80, 80, 2048, 1024, 1280, 7340032, 56360960, 114688, 7, 168312832, 32768, 218103872, 7, 218106432, 1
    .long 0, 0, 0, 0, 0, 0, 0, 0, 0, 0, 0, 0, 0, 0, 0, 0
    .long 0, 0, 0, 0, 0, 0, 0, 0, 0, 0, 0, 0, 0, 0, 0, 0
    .long 0, 0, 0, 0, 0, 0, 0, 0, 0, 0, 0, 0, 0, 0, 0, 0
    .long 6, 24, 24, 8192, 3584, 265728, 8388608, 0, 32768, 4, 21028864, 131072, 0, 0, 218104368, 1
    .long 4, 24, 24, 8192, 3584, 265728, 8388608, 262144, 32768, 4, 22077440, 131072, 0, 0, 218104496, 1
    .long 1, 24, 24, 8192, 3072, 3328, 8388608, 1048576, 32768, 8, 25214976, 131072, 0, 0, 218104880, 4
    .long 1, 32, 32, 8192, 3072, 3328, 8388608, 2621440, 32768, 8, 48283648, 131072, 0, 0, 218105648, 4
    .long 1, 24, 24, 8192, 3072, 3328, 8388608, 3145728, 32768, 8, 33603584, 131072, 0, 0, 218105904, 4
    .long 1, 24, 24, 8192, 3072, 3328, 8388608, 3670016, 32768, 8, 35700736, 131072, 0, 0, 218106160, 4
    .long 1, 80, 80, 2048, 1836032, 1836288, 7340032, 56389632, 114688, 7, 172507136, 32768, 218103888, 7, 218106432, 1
    .long 0, 0, 0, 0, 0, 0, 0, 0, 0, 0, 0, 0, 0, 0, 0, 0
    .long 0, 0, 0, 0, 0, 0, 0, 0, 0, 0, 0, 0, 0, 0, 0, 0
    .long 0, 0, 0, 0, 0, 0, 0, 0, 0, 0, 0, 0, 0, 0, 0, 0
    .long 6, 24, 24, 8192, 5632, 267776, 8388608, 0, 32768, 4, 21061632, 131072, 0, 0, 218104400, 1
    .long 4, 24, 24, 8192, 5632, 267776, 8388608, 262144, 32768, 4, 22110208, 131072, 0, 0, 218104528, 1
    .long 1, 24, 24, 8192, 5120, 5376, 8388608, 1048576, 32768, 8, 25247744, 131072, 0, 0, 218104912, 4
    .long 1, 32, 32, 8192, 5120, 5376, 8388608, 2621440, 32768, 8, 48316416, 131072, 0, 0, 218105680, 4
    .long 1, 24, 24, 8192, 5120, 5376, 8388608, 3145728, 32768, 8, 33636352, 131072, 0, 0, 218105936, 4
    .long 1, 24, 24, 8192, 5120, 5376, 8388608, 3670016, 32768, 8, 35733504, 131072, 0, 0, 218106192, 4
    .long 1, 80, 80, 2048, 3671040, 3671296, 7340032, 56418304, 114688, 7, 176701440, 32768, 218103904, 7, 218106432, 1
    .long 0, 0, 0, 0, 0, 0, 0, 0, 0, 0, 0, 0, 0, 0, 0, 0
    .long 0, 0, 0, 0, 0, 0, 0, 0, 0, 0, 0, 0, 0, 0, 0, 0
    .long 0, 0, 0, 0, 0, 0, 0, 0, 0, 0, 0, 0, 0, 0, 0, 0
    .long 6, 24, 24, 8192, 7680, 269824, 8388608, 0, 32768, 4, 21094400, 131072, 0, 0, 218104432, 1
    .long 4, 24, 24, 8192, 7680, 269824, 8388608, 262144, 32768, 4, 22142976, 131072, 0, 0, 218104560, 1
    .long 1, 24, 24, 8192, 7168, 7424, 8388608, 1048576, 32768, 8, 25280512, 131072, 0, 0, 218104944, 4
    .long 1, 32, 32, 8192, 7168, 7424, 8388608, 2621440, 32768, 8, 48349184, 131072, 0, 0, 218105712, 4
    .long 1, 24, 24, 8192, 7168, 7424, 8388608, 3145728, 32768, 8, 33669120, 131072, 0, 0, 218105968, 4
    .long 1, 24, 24, 8192, 7168, 7424, 8388608, 3670016, 32768, 8, 35766272, 131072, 0, 0, 218106224, 4
    .long 1, 80, 80, 2048, 5506048, 5506304, 7340032, 56446976, 114688, 7, 180895744, 32768, 218103920, 7, 218106432, 1
    .long 0, 0, 0, 0, 0, 0, 0, 0, 0, 0, 0, 0, 0, 0, 0, 0
    .long 0, 0, 0, 0, 0, 0, 0, 0, 0, 0, 0, 0, 0, 0, 0, 0
    .long 0, 0, 0, 0, 0, 0, 0, 0, 0, 0, 0, 0, 0, 0, 0, 0
    .long 6, 24, 24, 8192, 1792, 263936, 8388608, 0, 32768, 4, 21000192, 131072, 0, 0, 218104336, 1
    .long 4, 24, 24, 8192, 1792, 263936, 8388608, 262144, 32768, 4, 22048768, 131072, 0, 0, 218104464, 1
    .long 1, 24, 24, 8192, 1536, 1792, 8388608, 1048576, 32768, 8, 25190400, 131072, 0, 0, 218104848, 4
    .long 1, 32, 32, 8192, 1536, 1792, 8388608, 2621440, 32768, 8, 48259072, 131072, 0, 0, 218105616, 4
    .long 1, 24, 24, 8192, 1536, 1792, 8388608, 3145728, 32768, 8, 33579008, 131072, 0, 0, 218105872, 4
    .long 1, 24, 24, 8192, 1536, 1792, 8388608, 3670016, 32768, 8, 35676160, 131072, 0, 0, 218106128, 4
    .long 1, 80, 80, 2048, 1536, 1792, 7340032, 56360960, 114688, 7, 168321024, 32768, 218103872, 7, 218106432, 1
    .long 0, 0, 0, 0, 0, 0, 0, 0, 0, 0, 0, 0, 0, 0, 0, 0
    .long 0, 0, 0, 0, 0, 0, 0, 0, 0, 0, 0, 0, 0, 0, 0, 0
    .long 0, 0, 0, 0, 0, 0, 0, 0, 0, 0, 0, 0, 0, 0, 0, 0
    .long 6, 24, 24, 8192, 3840, 265984, 8388608, 0, 32768, 4, 21032960, 131072, 0, 0, 218104368, 1
    .long 4, 24, 24, 8192, 3840, 265984, 8388608, 262144, 32768, 4, 22081536, 131072, 0, 0, 218104496, 1
    .long 1, 24, 24, 8192, 3584, 3840, 8388608, 1048576, 32768, 8, 25223168, 131072, 0, 0, 218104880, 4
    .long 1, 32, 32, 8192, 3584, 3840, 8388608, 2621440, 32768, 8, 48291840, 131072, 0, 0, 218105648, 4
    .long 1, 24, 24, 8192, 3584, 3840, 8388608, 3145728, 32768, 8, 33611776, 131072, 0, 0, 218105904, 4
    .long 1, 24, 24, 8192, 3584, 3840, 8388608, 3670016, 32768, 8, 35708928, 131072, 0, 0, 218106160, 4
    .long 1, 80, 80, 2048, 1836544, 1836800, 7340032, 56389632, 114688, 7, 172515328, 32768, 218103888, 7, 218106432, 1
    .long 0, 0, 0, 0, 0, 0, 0, 0, 0, 0, 0, 0, 0, 0, 0, 0
    .long 0, 0, 0, 0, 0, 0, 0, 0, 0, 0, 0, 0, 0, 0, 0, 0
    .long 0, 0, 0, 0, 0, 0, 0, 0, 0, 0, 0, 0, 0, 0, 0, 0
    .long 6, 24, 24, 8192, 5888, 268032, 8388608, 0, 32768, 4, 21065728, 131072, 0, 0, 218104400, 1
    .long 4, 24, 24, 8192, 5888, 268032, 8388608, 262144, 32768, 4, 22114304, 131072, 0, 0, 218104528, 1
    .long 1, 24, 24, 8192, 5632, 5888, 8388608, 1048576, 32768, 8, 25255936, 131072, 0, 0, 218104912, 4
    .long 1, 32, 32, 8192, 5632, 5888, 8388608, 2621440, 32768, 8, 48324608, 131072, 0, 0, 218105680, 4
    .long 1, 24, 24, 8192, 5632, 5888, 8388608, 3145728, 32768, 8, 33644544, 131072, 0, 0, 218105936, 4
    .long 1, 24, 24, 8192, 5632, 5888, 8388608, 3670016, 32768, 8, 35741696, 131072, 0, 0, 218106192, 4
    .long 1, 80, 80, 2048, 3671552, 3671808, 7340032, 56418304, 114688, 7, 176709632, 32768, 218103904, 7, 218106432, 1
    .long 0, 0, 0, 0, 0, 0, 0, 0, 0, 0, 0, 0, 0, 0, 0, 0
    .long 0, 0, 0, 0, 0, 0, 0, 0, 0, 0, 0, 0, 0, 0, 0, 0
    .long 0, 0, 0, 0, 0, 0, 0, 0, 0, 0, 0, 0, 0, 0, 0, 0
    .long 6, 24, 24, 8192, 7936, 270080, 8388608, 0, 32768, 4, 21098496, 131072, 0, 0, 218104432, 1
    .long 4, 24, 24, 8192, 7936, 270080, 8388608, 262144, 32768, 4, 22147072, 131072, 0, 0, 218104560, 1
    .long 1, 24, 24, 8192, 7680, 7936, 8388608, 1048576, 32768, 8, 25288704, 131072, 0, 0, 218104944, 4
    .long 1, 32, 32, 8192, 7680, 7936, 8388608, 2621440, 32768, 8, 48357376, 131072, 0, 0, 218105712, 4
    .long 1, 24, 24, 8192, 7680, 7936, 8388608, 3145728, 32768, 8, 33677312, 131072, 0, 0, 218105968, 4
    .long 1, 24, 24, 8192, 7680, 7936, 8388608, 3670016, 32768, 8, 35774464, 131072, 0, 0, 218106224, 4
    .long 1, 80, 80, 2048, 5506560, 5506816, 7340032, 56446976, 114688, 7, 180903936, 32768, 218103920, 7, 218106432, 1
    .long 0, 0, 0, 0, 0, 0, 0, 0, 0, 0, 0, 0, 0, 0, 0, 0
    .long 0, 0, 0, 0, 0, 0, 0, 0, 0, 0, 0, 0, 0, 0, 0, 0
    .long 0, 0, 0, 0, 0, 0, 0, 0, 0, 0, 0, 0, 0, 0, 0, 0
    .long 6, 32, 32, 8192, 0, 262144, 8388608, 0, 32768, 4, 37748736, 131072, 0, 0, 218104320, 1
    .long 4, 32, 32, 8192, 0, 262144, 8388608, 262144, 32768, 4, 38797312, 131072, 0, 0, 218104448, 1
    .long 4, 16, 16, 8192, 1792, 263936, 8388608, 786432, 32768, 4, 7368704, 131072, 0, 0, 218104592, 1
    .long 1, 24, 24, 8192, 0, 256, 8388608, 1572864, 32768, 8, 27262976, 131072, 0, 0, 218105088, 4
    .long 2, 64, 72, 7168, 0, 0, 7340032, 0, 32768, 8, 54525952, 114688, 0, 0, 218103808, 1
    .long 2, 64, 72, 7168, 6144, 6144, 7340032, 1048576, 32768, 8, 58294272, 114688, 0, 0, 218103984, 1
    .long 2, 64, 72, 7168, 5120, 5120, 7340032, 2621440, 32768, 8, 63782912, 114688, 0, 0, 218104160, 1
    .long 1, 80, 80, 2048, 0, 256, 7340032, 61865984, 114688, 7, 169869312, 32768, 218104064, 7, 218106624, 1
    .long 0, 0, 0, 0, 0, 0, 0, 0, 0, 0, 0, 0, 0, 0, 0, 0
    .long 0, 0, 0, 0, 0, 0, 0, 0, 0, 0, 0, 0, 0, 0, 0, 0
    .long 6, 32, 32, 8192, 2048, 264192, 8388608, 0, 32768, 4, 37781504, 131072, 0, 0, 218104352, 1
    .long 4, 32, 32, 8192, 2048, 264192, 8388608, 262144, 32768, 4, 38830080, 131072, 0, 0, 218104480, 1
    .long 4, 16, 16, 8192, 3840, 265984, 8388608, 786432, 32768, 4, 7401472, 131072, 0, 0, 218104624, 1
    .long 1, 24, 24, 8192, 2048, 2304, 8388608, 1572864, 32768, 8, 27295744, 131072, 0, 0, 218105120, 4
    .long 2, 64, 72, 7168, 256, 256, 7340032, 0, 32768, 8, 54530048, 114688, 0, 0, 218103808, 1
    .long 2, 64, 72, 7168, 6400, 6400, 7340032, 1048576, 32768, 8, 58298368, 114688, 0, 0, 218103984, 1
    .long 2, 64, 72, 7168, 5376, 5376, 7340032, 2621440, 32768, 8, 63787008, 114688, 0, 0, 218104176, 1
    .long 1, 80, 80, 2048, 1835008, 1835264, 7340032, 61894656, 114688, 7, 174063616, 32768, 218104080, 7, 218106624, 1
    .long 0, 0, 0, 0, 0, 0, 0, 0, 0, 0, 0, 0, 0, 0, 0, 0
    .long 0, 0, 0, 0, 0, 0, 0, 0, 0, 0, 0, 0, 0, 0, 0, 0
    .long 6, 32, 32, 8192, 4096, 266240, 8388608, 0, 32768, 4, 37814272, 131072, 0, 0, 218104384, 1
    .long 4, 32, 32, 8192, 4096, 266240, 8388608, 262144, 32768, 4, 38862848, 131072, 0, 0, 218104512, 1
    .long 4, 16, 16, 8192, 5888, 268032, 8388608, 786432, 32768, 4, 7434240, 131072, 0, 0, 218104656, 1
    .long 1, 24, 24, 8192, 4096, 4352, 8388608, 1572864, 32768, 8, 27328512, 131072, 0, 0, 218105152, 4
    .long 2, 64, 72, 7168, 512, 512, 7340032, 0, 32768, 8, 54534144, 114688, 0, 0, 218103808, 1
    .long 2, 64, 72, 7168, 6656, 6656, 7340032, 1048576, 32768, 8, 58302464, 114688, 0, 0, 218103984, 1
    .long 2, 64, 72, 7168, 5632, 5632, 7340032, 2621440, 32768, 8, 63791104, 114688, 0, 0, 218104176, 1
    .long 1, 80, 80, 2048, 3670016, 3670272, 7340032, 61923328, 114688, 7, 178257920, 32768, 218104096, 7, 218106624, 1
    .long 0, 0, 0, 0, 0, 0, 0, 0, 0, 0, 0, 0, 0, 0, 0, 0
    .long 0, 0, 0, 0, 0, 0, 0, 0, 0, 0, 0, 0, 0, 0, 0, 0
    .long 6, 32, 32, 8192, 6144, 268288, 8388608, 0, 32768, 4, 37847040, 131072, 0, 0, 218104416, 1
    .long 4, 32, 32, 8192, 6144, 268288, 8388608, 262144, 32768, 4, 38895616, 131072, 0, 0, 218104544, 1
    .long 4, 16, 16, 8192, 7936, 270080, 8388608, 786432, 32768, 4, 7467008, 131072, 0, 0, 218104688, 1
    .long 1, 24, 24, 8192, 6144, 6400, 8388608, 1572864, 32768, 8, 27361280, 131072, 0, 0, 218105184, 4
    .long 2, 64, 72, 7168, 768, 768, 7340032, 0, 32768, 8, 54538240, 114688, 0, 0, 218103808, 1
    .long 2, 64, 72, 7168, 6912, 6912, 7340032, 1048576, 32768, 8, 58306560, 114688, 0, 0, 218103984, 1
    .long 2, 64, 72, 7168, 5888, 5888, 7340032, 2621440, 32768, 8, 63795200, 114688, 0, 0, 218104176, 1
    .long 1, 80, 80, 2048, 5505024, 5505280, 7340032, 61952000, 114688, 7, 182452224, 32768, 218104112, 7, 218106624, 1
    .long 0, 0, 0, 0, 0, 0, 0, 0, 0, 0, 0, 0, 0, 0, 0, 0
    .long 0, 0, 0, 0, 0, 0, 0, 0, 0, 0, 0, 0, 0, 0, 0, 0
    .long 6, 32, 32, 8192, 256, 262400, 8388608, 0, 32768, 4, 37752832, 131072, 0, 0, 218104320, 1
    .long 4, 32, 32, 8192, 256, 262400, 8388608, 262144, 32768, 4, 38801408, 131072, 0, 0, 218104448, 1
    .long 4, 16, 16, 8192, 1792, 263936, 8388608, 524288, 32768, 4, 6320128, 131072, 0, 0, 218104592, 1
    .long 1, 24, 24, 8192, 512, 768, 8388608, 1572864, 32768, 8, 27271168, 131072, 0, 0, 218105088, 4
    .long 2, 64, 72, 7168, 1024, 1024, 7340032, 0, 32768, 8, 54542336, 114688, 0, 0, 218103808, 1
    .long 2, 64, 72, 7168, 0, 0, 7340032, 1572864, 32768, 8, 60030976, 114688, 0, 0, 218104000, 1
    .long 2, 64, 72, 7168, 6144, 6144, 7340032, 2621440, 32768, 8, 63799296, 114688, 0, 0, 218104176, 1
    .long 1, 80, 80, 2048, 512, 768, 7340032, 61865984, 114688, 7, 169877504, 32768, 218104064, 7, 218106624, 1
    .long 0, 0, 0, 0, 0, 0, 0, 0, 0, 0, 0, 0, 0, 0, 0, 0
    .long 0, 0, 0, 0, 0, 0, 0, 0, 0, 0, 0, 0, 0, 0, 0, 0
    .long 6, 32, 32, 8192, 2304, 264448, 8388608, 0, 32768, 4, 37785600, 131072, 0, 0, 218104352, 1
    .long 4, 32, 32, 8192, 2304, 264448, 8388608, 262144, 32768, 4, 38834176, 131072, 0, 0, 218104480, 1
    .long 4, 16, 16, 8192, 3840, 265984, 8388608, 524288, 32768, 4, 6352896, 131072, 0, 0, 218104624, 1
    .long 1, 24, 24, 8192, 2560, 2816, 8388608, 1572864, 32768, 8, 27303936, 131072, 0, 0, 218105120, 4
    .long 2, 64, 72, 7168, 1280, 1280, 7340032, 0, 32768, 8, 54546432, 114688, 0, 0, 218103808, 1
    .long 2, 64, 72, 7168, 256, 256, 7340032, 1572864, 32768, 8, 60035072, 114688, 0, 0, 218104000, 1
    .long 2, 64, 72, 7168, 6400, 6400, 7340032, 2621440, 32768, 8, 63803392, 114688, 0, 0, 218104176, 1
    .long 1, 80, 80, 2048, 1835520, 1835776, 7340032, 61894656, 114688, 7, 174071808, 32768, 218104080, 7, 218106624, 1
    .long 0, 0, 0, 0, 0, 0, 0, 0, 0, 0, 0, 0, 0, 0, 0, 0
    .long 0, 0, 0, 0, 0, 0, 0, 0, 0, 0, 0, 0, 0, 0, 0, 0
    .long 6, 32, 32, 8192, 4352, 266496, 8388608, 0, 32768, 4, 37818368, 131072, 0, 0, 218104384, 1
    .long 4, 32, 32, 8192, 4352, 266496, 8388608, 262144, 32768, 4, 38866944, 131072, 0, 0, 218104512, 1
    .long 4, 16, 16, 8192, 5888, 268032, 8388608, 524288, 32768, 4, 6385664, 131072, 0, 0, 218104656, 1
    .long 1, 24, 24, 8192, 4608, 4864, 8388608, 1572864, 32768, 8, 27336704, 131072, 0, 0, 218105152, 4
    .long 2, 64, 72, 7168, 1536, 1536, 7340032, 0, 32768, 8, 54550528, 114688, 0, 0, 218103808, 1
    .long 2, 64, 72, 7168, 512, 512, 7340032, 1572864, 32768, 8, 60039168, 114688, 0, 0, 218104000, 1
    .long 2, 64, 72, 7168, 6656, 6656, 7340032, 2621440, 32768, 8, 63807488, 114688, 0, 0, 218104176, 1
    .long 1, 80, 80, 2048, 3670528, 3670784, 7340032, 61923328, 114688, 7, 178266112, 32768, 218104096, 7, 218106624, 1
    .long 0, 0, 0, 0, 0, 0, 0, 0, 0, 0, 0, 0, 0, 0, 0, 0
    .long 0, 0, 0, 0, 0, 0, 0, 0, 0, 0, 0, 0, 0, 0, 0, 0
    .long 6, 32, 32, 8192, 6400, 268544, 8388608, 0, 32768, 4, 37851136, 131072, 0, 0, 218104416, 1
    .long 4, 32, 32, 8192, 6400, 268544, 8388608, 262144, 32768, 4, 38899712, 131072, 0, 0, 218104544, 1
    .long 4, 16, 16, 8192, 7936, 270080, 8388608, 524288, 32768, 4, 6418432, 131072, 0, 0, 218104688, 1
    .long 1, 24, 24, 8192, 6656, 6912, 8388608, 1572864, 32768, 8, 27369472, 131072, 0, 0, 218105184, 4
    .long 2, 64, 72, 7168, 1792, 1792, 7340032, 0, 32768, 8, 54554624, 114688, 0, 0, 218103824, 1
    .long 2, 64, 72, 7168, 768, 768, 7340032, 1572864, 32768, 8, 60043264, 114688, 0, 0, 218104000, 1
    .long 2, 64, 72, 7168, 6912, 6912, 7340032, 2621440, 32768, 8, 63811584, 114688, 0, 0, 218104176, 1
    .long 1, 80, 80, 2048, 5505536, 5505792, 7340032, 61952000, 114688, 7, 182460416, 32768, 218104112, 7, 218106624, 1
    .long 0, 0, 0, 0, 0, 0, 0, 0, 0, 0, 0, 0, 0, 0, 0, 0
    .long 0, 0, 0, 0, 0, 0, 0, 0, 0, 0, 0, 0, 0, 0, 0, 0
    .long 6, 32, 32, 8192, 512, 262656, 8388608, 0, 32768, 4, 37756928, 131072, 0, 0, 218104320, 1
    .long 4, 32, 32, 8192, 512, 262656, 8388608, 262144, 32768, 4, 38805504, 131072, 0, 0, 218104448, 1
    .long 4, 16, 16, 8192, 1536, 263680, 8388608, 786432, 32768, 4, 7364608, 131072, 0, 0, 218104592, 1
    .long 1, 24, 24, 8192, 1024, 1280, 8388608, 1572864, 32768, 8, 27279360, 131072, 0, 0, 218105104, 4
    .long 2, 64, 72, 7168, 2048, 2048, 7340032, 0, 32768, 8, 54558720, 114688, 0, 0, 218103824, 1
    .long 2, 64, 72, 7168, 1024, 1024, 7340032, 1572864, 32768, 8, 60047360, 114688, 0, 0, 218104000, 1
    .long 2, 64, 72, 7168, 0, 0, 7340032, 3145728, 32768, 8, 65536000, 114688, 0, 0, 218104192, 1
    .long 1, 80, 80, 2048, 1024, 1280, 7340032, 61865984, 114688, 7, 169885696, 32768, 218104064, 7, 218106624, 1
    .long 0, 0, 0, 0, 0, 0, 0, 0, 0, 0, 0, 0, 0, 0, 0, 0
    .long 0, 0, 0, 0, 0, 0, 0, 0, 0, 0, 0, 0, 0, 0, 0, 0
    .long 6, 32, 32, 8192, 2560, 264704, 8388608, 0, 32768, 4, 37789696, 131072, 0, 0, 218104352, 1
    .long 4, 32, 32, 8192, 2560, 264704, 8388608, 262144, 32768, 4, 38838272, 131072, 0, 0, 218104480, 1
    .long 4, 16, 16, 8192, 3584, 265728, 8388608, 786432, 32768, 4, 7397376, 131072, 0, 0, 218104624, 1
    .long 1, 24, 24, 8192, 3072, 3328, 8388608, 1572864, 32768, 8, 27312128, 131072, 0, 0, 218105136, 4
    .long 2, 64, 72, 7168, 2304, 2304, 7340032, 0, 32768, 8, 54562816, 114688, 0, 0, 218103824, 1
    .long 2, 64, 72, 7168, 1280, 1280, 7340032, 1572864, 32768, 8, 60051456, 114688, 0, 0, 218104000, 1
    .long 2, 64, 72, 7168, 256, 256, 7340032, 3145728, 32768, 8, 65540096, 114688, 0, 0, 218104192, 1
    .long 1, 80, 80, 2048, 1836032, 1836288, 7340032, 61894656, 114688, 7, 174080000, 32768, 218104080, 7, 218106624, 1
    .long 0, 0, 0, 0, 0, 0, 0, 0, 0, 0, 0, 0, 0, 0, 0, 0
    .long 0, 0, 0, 0, 0, 0, 0, 0, 0, 0, 0, 0, 0, 0, 0, 0
    .long 6, 32, 32, 8192, 4608, 266752, 8388608, 0, 32768, 4, 37822464, 131072, 0, 0, 218104384, 1
    .long 4, 32, 32, 8192, 4608, 266752, 8388608, 262144, 32768, 4, 38871040, 131072, 0, 0, 218104512, 1
    .long 4, 16, 16, 8192, 5632, 267776, 8388608, 786432, 32768, 4, 7430144, 131072, 0, 0, 218104656, 1
    .long 1, 24, 24, 8192, 5120, 5376, 8388608, 1572864, 32768, 8, 27344896, 131072, 0, 0, 218105168, 4
    .long 2, 64, 72, 7168, 2560, 2560, 7340032, 0, 32768, 8, 54566912, 114688, 0, 0, 218103824, 1
    .long 2, 64, 72, 7168, 1536, 1536, 7340032, 1572864, 32768, 8, 60055552, 114688, 0, 0, 218104000, 1
    .long 2, 64, 72, 7168, 512, 512, 7340032, 3145728, 32768, 8, 65544192, 114688, 0, 0, 218104192, 1
    .long 1, 80, 80, 2048, 3671040, 3671296, 7340032, 61923328, 114688, 7, 178274304, 32768, 218104096, 7, 218106624, 1
    .long 0, 0, 0, 0, 0, 0, 0, 0, 0, 0, 0, 0, 0, 0, 0, 0
    .long 0, 0, 0, 0, 0, 0, 0, 0, 0, 0, 0, 0, 0, 0, 0, 0
    .long 6, 32, 32, 8192, 6656, 268800, 8388608, 0, 32768, 4, 37855232, 131072, 0, 0, 218104416, 1
    .long 4, 32, 32, 8192, 6656, 268800, 8388608, 262144, 32768, 4, 38903808, 131072, 0, 0, 218104544, 1
    .long 4, 16, 16, 8192, 7680, 269824, 8388608, 786432, 32768, 4, 7462912, 131072, 0, 0, 218104688, 1
    .long 1, 24, 24, 8192, 7168, 7424, 8388608, 1572864, 32768, 8, 27377664, 131072, 0, 0, 218105200, 4
    .long 2, 64, 72, 7168, 2816, 2816, 7340032, 0, 32768, 8, 54571008, 114688, 0, 0, 218103824, 1
    .long 2, 64, 72, 7168, 1792, 1792, 7340032, 1572864, 32768, 8, 60059648, 114688, 0, 0, 218104016, 1
    .long 2, 64, 72, 7168, 768, 768, 7340032, 3145728, 32768, 8, 65548288, 114688, 0, 0, 218104192, 1
    .long 1, 80, 80, 2048, 5506048, 5506304, 7340032, 61952000, 114688, 7, 182468608, 32768, 218104112, 7, 218106624, 1
    .long 0, 0, 0, 0, 0, 0, 0, 0, 0, 0, 0, 0, 0, 0, 0, 0
    .long 0, 0, 0, 0, 0, 0, 0, 0, 0, 0, 0, 0, 0, 0, 0, 0
    .long 6, 32, 32, 8192, 768, 262912, 8388608, 0, 32768, 4, 37761024, 131072, 0, 0, 218104320, 1
    .long 4, 32, 32, 8192, 768, 262912, 8388608, 262144, 32768, 4, 38809600, 131072, 0, 0, 218104448, 1
    .long 4, 16, 16, 8192, 1536, 263680, 8388608, 524288, 32768, 4, 6316032, 131072, 0, 0, 218104592, 1
    .long 1, 24, 24, 8192, 1536, 1792, 8388608, 1572864, 32768, 8, 27287552, 131072, 0, 0, 218105104, 4
    .long 2, 64, 72, 7168, 3072, 3072, 7340032, 0, 32768, 8, 54575104, 114688, 0, 0, 218103824, 1
    .long 2, 64, 72, 7168, 2048, 2048, 7340032, 1572864, 32768, 8, 60063744, 114688, 0, 0, 218104016, 1
    .long 2, 64, 72, 7168, 1024, 1024, 7340032, 3145728, 32768, 8, 65552384, 114688, 0, 0, 218104192, 1
    .long 1, 80, 80, 2048, 1536, 1792, 7340032, 61865984, 114688, 7, 169893888, 32768, 218104064, 7, 218106624, 1
    .long 0, 0, 0, 0, 0, 0, 0, 0, 0, 0, 0, 0, 0, 0, 0, 0
    .long 0, 0, 0, 0, 0, 0, 0, 0, 0, 0, 0, 0, 0, 0, 0, 0
    .long 6, 32, 32, 8192, 2816, 264960, 8388608, 0, 32768, 4, 37793792, 131072, 0, 0, 218104352, 1
    .long 4, 32, 32, 8192, 2816, 264960, 8388608, 262144, 32768, 4, 38842368, 131072, 0, 0, 218104480, 1
    .long 4, 16, 16, 8192, 3584, 265728, 8388608, 524288, 32768, 4, 6348800, 131072, 0, 0, 218104624, 1
    .long 1, 24, 24, 8192, 3584, 3840, 8388608, 1572864, 32768, 8, 27320320, 131072, 0, 0, 218105136, 4
    .long 2, 64, 72, 7168, 3328, 3328, 7340032, 0, 32768, 8, 54579200, 114688, 0, 0, 218103824, 1
    .long 2, 64, 72, 7168, 2304, 2304, 7340032, 1572864, 32768, 8, 60067840, 114688, 0, 0, 218104016, 1
    .long 2, 64, 72, 7168, 1280, 1280, 7340032, 3145728, 32768, 8, 65556480, 114688, 0, 0, 218104192, 1
    .long 1, 80, 80, 2048, 1836544, 1836800, 7340032, 61894656, 114688, 7, 174088192, 32768, 218104080, 7, 218106624, 1
    .long 0, 0, 0, 0, 0, 0, 0, 0, 0, 0, 0, 0, 0, 0, 0, 0
    .long 0, 0, 0, 0, 0, 0, 0, 0, 0, 0, 0, 0, 0, 0, 0, 0
    .long 6, 32, 32, 8192, 4864, 267008, 8388608, 0, 32768, 4, 37826560, 131072, 0, 0, 218104384, 1
    .long 4, 32, 32, 8192, 4864, 267008, 8388608, 262144, 32768, 4, 38875136, 131072, 0, 0, 218104512, 1
    .long 4, 16, 16, 8192, 5632, 267776, 8388608, 524288, 32768, 4, 6381568, 131072, 0, 0, 218104656, 1
    .long 1, 24, 24, 8192, 5632, 5888, 8388608, 1572864, 32768, 8, 27353088, 131072, 0, 0, 218105168, 4
    .long 2, 64, 72, 7168, 3584, 3584, 7340032, 0, 32768, 8, 54583296, 114688, 0, 0, 218103840, 1
    .long 2, 64, 72, 7168, 2560, 2560, 7340032, 1572864, 32768, 8, 60071936, 114688, 0, 0, 218104016, 1
    .long 2, 64, 72, 7168, 1536, 1536, 7340032, 3145728, 32768, 8, 65560576, 114688, 0, 0, 218104192, 1
    .long 1, 80, 80, 2048, 3671552, 3671808, 7340032, 61923328, 114688, 7, 178282496, 32768, 218104096, 7, 218106624, 1
    .long 0, 0, 0, 0, 0, 0, 0, 0, 0, 0, 0, 0, 0, 0, 0, 0
    .long 0, 0, 0, 0, 0, 0, 0, 0, 0, 0, 0, 0, 0, 0, 0, 0
    .long 6, 32, 32, 8192, 6912, 269056, 8388608, 0, 32768, 4, 37859328, 131072, 0, 0, 218104416, 1
    .long 4, 32, 32, 8192, 6912, 269056, 8388608, 262144, 32768, 4, 38907904, 131072, 0, 0, 218104544, 1
    .long 4, 16, 16, 8192, 7680, 269824, 8388608, 524288, 32768, 4, 6414336, 131072, 0, 0, 218104688, 1
    .long 1, 24, 24, 8192, 7680, 7936, 8388608, 1572864, 32768, 8, 27385856, 131072, 0, 0, 218105200, 4
    .long 2, 64, 72, 7168, 3840, 3840, 7340032, 0, 32768, 8, 54587392, 114688, 0, 0, 218103840, 1
    .long 2, 64, 72, 7168, 2816, 2816, 7340032, 1572864, 32768, 8, 60076032, 114688, 0, 0, 218104016, 1
    .long 2, 64, 72, 7168, 1792, 1792, 7340032, 3145728, 32768, 8, 65564672, 114688, 0, 0, 218104208, 1
    .long 1, 80, 80, 2048, 5506560, 5506816, 7340032, 61952000, 114688, 7, 182476800, 32768, 218104112, 7, 218106624, 1
    .long 0, 0, 0, 0, 0, 0, 0, 0, 0, 0, 0, 0, 0, 0, 0, 0
    .long 0, 0, 0, 0, 0, 0, 0, 0, 0, 0, 0, 0, 0, 0, 0, 0
    .long 6, 32, 32, 8192, 1024, 263168, 8388608, 0, 32768, 4, 37765120, 131072, 0, 0, 218104336, 1
    .long 4, 32, 32, 8192, 1024, 263168, 8388608, 262144, 32768, 4, 38813696, 131072, 0, 0, 218104464, 1
    .long 4, 16, 16, 8192, 1280, 263424, 8388608, 786432, 32768, 4, 7360512, 131072, 0, 0, 218104592, 1
    .long 1, 16, 16, 8192, 0, 256, 8388608, 1572864, 32768, 8, 10485760, 131072, 0, 0, 218105088, 4
    .long 2, 64, 72, 7168, 4096, 4096, 7340032, 0, 32768, 8, 54591488, 114688, 0, 0, 218103840, 1
    .long 2, 64, 72, 7168, 3072, 3072, 7340032, 1572864, 32768, 8, 60080128, 114688, 0, 0, 218104016, 1
    .long 2, 64, 72, 7168, 2048, 2048, 7340032, 3145728, 32768, 8, 65568768, 114688, 0, 0, 218104208, 1
    .long 1, 80, 80, 2048, 0, 256, 7340032, 63700992, 114688, 7, 170393600, 32768, 218104128, 7, 218106688, 1
    .long 0, 0, 0, 0, 0, 0, 0, 0, 0, 0, 0, 0, 0, 0, 0, 0
    .long 0, 0, 0, 0, 0, 0, 0, 0, 0, 0, 0, 0, 0, 0, 0, 0
    .long 6, 32, 32, 8192, 3072, 265216, 8388608, 0, 32768, 4, 37797888, 131072, 0, 0, 218104368, 1
    .long 4, 32, 32, 8192, 3072, 265216, 8388608, 262144, 32768, 4, 38846464, 131072, 0, 0, 218104496, 1
    .long 4, 16, 16, 8192, 3328, 265472, 8388608, 786432, 32768, 4, 7393280, 131072, 0, 0, 218104624, 1
    .long 1, 16, 16, 8192, 2048, 2304, 8388608, 1572864, 32768, 8, 10518528, 131072, 0, 0, 218105120, 4
    .long 2, 64, 72, 7168, 4352, 4352, 7340032, 0, 32768, 8, 54595584, 114688, 0, 0, 218103840, 1
    .long 2, 64, 72, 7168, 3328, 3328, 7340032, 1572864, 32768, 8, 60084224, 114688, 0, 0, 218104016, 1
    .long 2, 64, 72, 7168, 2304, 2304, 7340032, 3145728, 32768, 8, 65572864, 114688, 0, 0, 218104208, 1
    .long 1, 80, 80, 2048, 1835008, 1835264, 7340032, 63729664, 114688, 7, 174587904, 32768, 218104144, 7, 218106688, 1
    .long 0, 0, 0, 0, 0, 0, 0, 0, 0, 0, 0, 0, 0, 0, 0, 0
    .long 0, 0, 0, 0, 0, 0, 0, 0, 0, 0, 0, 0, 0, 0, 0, 0
    .long 6, 32, 32, 8192, 5120, 267264, 8388608, 0, 32768, 4, 37830656, 131072, 0, 0, 218104400, 1
    .long 4, 32, 32, 8192, 5120, 267264, 8388608, 262144, 32768, 4, 38879232, 131072, 0, 0, 218104528, 1
    .long 4, 16, 16, 8192, 5376, 267520, 8388608, 786432, 32768, 4, 7426048, 131072, 0, 0, 218104656, 1
    .long 1, 16, 16, 8192, 4096, 4352, 8388608, 1572864, 32768, 8, 10551296, 131072, 0, 0, 218105152, 4
    .long 2, 64, 72, 7168, 4608, 4608, 7340032, 0, 32768, 8, 54599680, 114688, 0, 0, 218103840, 1
    .long 2, 64, 72, 7168, 3584, 3584, 7340032, 1572864, 32768, 8, 60088320, 114688, 0, 0, 218104032, 1
    .long 2, 64, 72, 7168, 2560, 2560, 7340032, 3145728, 32768, 8, 65576960, 114688, 0, 0, 218104208, 1
    .long 1, 80, 80, 2048, 3670016, 3670272, 7340032, 63758336, 114688, 7, 178782208, 32768, 218104160, 7, 218106688, 1
    .long 0, 0, 0, 0, 0, 0, 0, 0, 0, 0, 0, 0, 0, 0, 0, 0
    .long 0, 0, 0, 0, 0, 0, 0, 0, 0, 0, 0, 0, 0, 0, 0, 0
    .long 6, 32, 32, 8192, 7168, 269312, 8388608, 0, 32768, 4, 37863424, 131072, 0, 0, 218104432, 1
    .long 4, 32, 32, 8192, 7168, 269312, 8388608, 262144, 32768, 4, 38912000, 131072, 0, 0, 218104560, 1
    .long 4, 16, 16, 8192, 7424, 269568, 8388608, 786432, 32768, 4, 7458816, 131072, 0, 0, 218104688, 1
    .long 1, 16, 16, 8192, 6144, 6400, 8388608, 1572864, 32768, 8, 10584064, 131072, 0, 0, 218105184, 4
    .long 2, 64, 72, 7168, 4864, 4864, 7340032, 0, 32768, 8, 54603776, 114688, 0, 0, 218103840, 1
    .long 2, 64, 72, 7168, 3840, 3840, 7340032, 1572864, 32768, 8, 60092416, 114688, 0, 0, 218104032, 1
    .long 2, 64, 72, 7168, 2816, 2816, 7340032, 3145728, 32768, 8, 65581056, 114688, 0, 0, 218104208, 1
    .long 1, 80, 80, 2048, 5505024, 5505280, 7340032, 63787008, 114688, 7, 182976512, 32768, 218104176, 7, 218106688, 1
    .long 0, 0, 0, 0, 0, 0, 0, 0, 0, 0, 0, 0, 0, 0, 0, 0
    .long 0, 0, 0, 0, 0, 0, 0, 0, 0, 0, 0, 0, 0, 0, 0, 0
    .long 6, 32, 32, 8192, 1280, 263424, 8388608, 0, 32768, 4, 37769216, 131072, 0, 0, 218104336, 1
    .long 4, 32, 32, 8192, 1280, 263424, 8388608, 262144, 32768, 4, 38817792, 131072, 0, 0, 218104464, 1
    .long 4, 16, 16, 8192, 1280, 263424, 8388608, 524288, 32768, 4, 6311936, 131072, 0, 0, 218104592, 1
    .long 1, 16, 16, 8192, 512, 768, 8388608, 1572864, 32768, 8, 10493952, 131072, 0, 0, 218105088, 4
    .long 2, 64, 72, 7168, 5120, 5120, 7340032, 0, 32768, 8, 54607872, 114688, 0, 0, 218103840, 1
    .long 2, 64, 72, 7168, 4096, 4096, 7340032, 1572864, 32768, 8, 60096512, 114688, 0, 0, 218104032, 1
    .long 2, 64, 72, 7168, 3072, 3072, 7340032, 3145728, 32768, 8, 65585152, 114688, 0, 0, 218104208, 1
    .long 1, 80, 80, 2048, 512, 768, 7340032, 63700992, 114688, 7, 170401792, 32768, 218104128, 7, 218106688, 1
    .long 0, 0, 0, 0, 0, 0, 0, 0, 0, 0, 0, 0, 0, 0, 0, 0
    .long 0, 0, 0, 0, 0, 0, 0, 0, 0, 0, 0, 0, 0, 0, 0, 0
    .long 6, 32, 32, 8192, 3328, 265472, 8388608, 0, 32768, 4, 37801984, 131072, 0, 0, 218104368, 1
    .long 4, 32, 32, 8192, 3328, 265472, 8388608, 262144, 32768, 4, 38850560, 131072, 0, 0, 218104496, 1
    .long 4, 16, 16, 8192, 3328, 265472, 8388608, 524288, 32768, 4, 6344704, 131072, 0, 0, 218104624, 1
    .long 1, 16, 16, 8192, 2560, 2816, 8388608, 1572864, 32768, 8, 10526720, 131072, 0, 0, 218105120, 4
    .long 2, 64, 72, 7168, 5376, 5376, 7340032, 0, 32768, 8, 54611968, 114688, 0, 0, 218103856, 1
    .long 2, 64, 72, 7168, 4352, 4352, 7340032, 1572864, 32768, 8, 60100608, 114688, 0, 0, 218104032, 1
    .long 2, 64, 72, 7168, 3328, 3328, 7340032, 3145728, 32768, 8, 65589248, 114688, 0, 0, 218104208, 1
    .long 1, 80, 80, 2048, 1835520, 1835776, 7340032, 63729664, 114688, 7, 174596096, 32768, 218104144, 7, 218106688, 1
    .long 0, 0, 0, 0, 0, 0, 0, 0, 0, 0, 0, 0, 0, 0, 0, 0
    .long 0, 0, 0, 0, 0, 0, 0, 0, 0, 0, 0, 0, 0, 0, 0, 0
    .long 6, 32, 32, 8192, 5376, 267520, 8388608, 0, 32768, 4, 37834752, 131072, 0, 0, 218104400, 1
    .long 4, 32, 32, 8192, 5376, 267520, 8388608, 262144, 32768, 4, 38883328, 131072, 0, 0, 218104528, 1
    .long 4, 16, 16, 8192, 5376, 267520, 8388608, 524288, 32768, 4, 6377472, 131072, 0, 0, 218104656, 1
    .long 1, 16, 16, 8192, 4608, 4864, 8388608, 1572864, 32768, 8, 10559488, 131072, 0, 0, 218105152, 4
    .long 2, 64, 72, 7168, 5632, 5632, 7340032, 0, 32768, 8, 54616064, 114688, 0, 0, 218103856, 1
    .long 2, 64, 72, 7168, 4608, 4608, 7340032, 1572864, 32768, 8, 60104704, 114688, 0, 0, 218104032, 1
    .long 2, 64, 72, 7168, 3584, 3584, 7340032, 3145728, 32768, 8, 65593344, 114688, 0, 0, 218104224, 1
    .long 1, 80, 80, 2048, 3670528, 3670784, 7340032, 63758336, 114688, 7, 178790400, 32768, 218104160, 7, 218106688, 1
    .long 0, 0, 0, 0, 0, 0, 0, 0, 0, 0, 0, 0, 0, 0, 0, 0
    .long 0, 0, 0, 0, 0, 0, 0, 0, 0, 0, 0, 0, 0, 0, 0, 0
    .long 6, 32, 32, 8192, 7424, 269568, 8388608, 0, 32768, 4, 37867520, 131072, 0, 0, 218104432, 1
    .long 4, 32, 32, 8192, 7424, 269568, 8388608, 262144, 32768, 4, 38916096, 131072, 0, 0, 218104560, 1
    .long 4, 16, 16, 8192, 7424, 269568, 8388608, 524288, 32768, 4, 6410240, 131072, 0, 0, 218104688, 1
    .long 1, 16, 16, 8192, 6656, 6912, 8388608, 1572864, 32768, 8, 10592256, 131072, 0, 0, 218105184, 4
    .long 2, 64, 72, 7168, 5888, 5888, 7340032, 0, 32768, 8, 54620160, 114688, 0, 0, 218103856, 1
    .long 2, 64, 72, 7168, 4864, 4864, 7340032, 1572864, 32768, 8, 60108800, 114688, 0, 0, 218104032, 1
    .long 2, 64, 72, 7168, 3840, 3840, 7340032, 3145728, 32768, 8, 65597440, 114688, 0, 0, 218104224, 1
    .long 1, 80, 80, 2048, 5505536, 5505792, 7340032, 63787008, 114688, 7, 182984704, 32768, 218104176, 7, 218106688, 1
    .long 0, 0, 0, 0, 0, 0, 0, 0, 0, 0, 0, 0, 0, 0, 0, 0
    .long 0, 0, 0, 0, 0, 0, 0, 0, 0, 0, 0, 0, 0, 0, 0, 0
    .long 6, 32, 32, 8192, 1536, 263680, 8388608, 0, 32768, 4, 37773312, 131072, 0, 0, 218104336, 1
    .long 4, 32, 32, 8192, 1536, 263680, 8388608, 262144, 32768, 4, 38821888, 131072, 0, 0, 218104464, 1
    .long 4, 16, 16, 8192, 1024, 263168, 8388608, 786432, 32768, 4, 7356416, 131072, 0, 0, 218104592, 1
    .long 1, 16, 16, 8192, 1024, 1280, 8388608, 1572864, 32768, 8, 10502144, 131072, 0, 0, 218105104, 4
    .long 2, 64, 72, 7168, 6144, 6144, 7340032, 0, 32768, 8, 54624256, 114688, 0, 0, 218103856, 1
    .long 2, 64, 72, 7168, 5120, 5120, 7340032, 1572864, 32768, 8, 60112896, 114688, 0, 0, 218104032, 1
    .long 2, 64, 72, 7168, 4096, 4096, 7340032, 3145728, 32768, 8, 65601536, 114688, 0, 0, 218104224, 1
    .long 1, 80, 80, 2048, 1024, 1280, 7340032, 63700992, 114688, 7, 170409984, 32768, 218104128, 7, 218106688, 1
    .long 0, 0, 0, 0, 0, 0, 0, 0, 0, 0, 0, 0, 0, 0, 0, 0
    .long 0, 0, 0, 0, 0, 0, 0, 0, 0, 0, 0, 0, 0, 0, 0, 0
    .long 6, 32, 32, 8192, 3584, 265728, 8388608, 0, 32768, 4, 37806080, 131072, 0, 0, 218104368, 1
    .long 4, 32, 32, 8192, 3584, 265728, 8388608, 262144, 32768, 4, 38854656, 131072, 0, 0, 218104496, 1
    .long 4, 16, 16, 8192, 3072, 265216, 8388608, 786432, 32768, 4, 7389184, 131072, 0, 0, 218104624, 1
    .long 1, 16, 16, 8192, 3072, 3328, 8388608, 1572864, 32768, 8, 10534912, 131072, 0, 0, 218105136, 4
    .long 2, 64, 72, 7168, 6400, 6400, 7340032, 0, 32768, 8, 54628352, 114688, 0, 0, 218103856, 1
    .long 2, 64, 72, 7168, 5376, 5376, 7340032, 1572864, 32768, 8, 60116992, 114688, 0, 0, 218104048, 1
    .long 2, 64, 72, 7168, 4352, 4352, 7340032, 3145728, 32768, 8, 65605632, 114688, 0, 0, 218104224, 1
    .long 1, 80, 80, 2048, 1836032, 1836288, 7340032, 63729664, 114688, 7, 174604288, 32768, 218104144, 7, 218106688, 1
    .long 0, 0, 0, 0, 0, 0, 0, 0, 0, 0, 0, 0, 0, 0, 0, 0
    .long 0, 0, 0, 0, 0, 0, 0, 0, 0, 0, 0, 0, 0, 0, 0, 0
    .long 6, 32, 32, 8192, 5632, 267776, 8388608, 0, 32768, 4, 37838848, 131072, 0, 0, 218104400, 1
    .long 4, 32, 32, 8192, 5632, 267776, 8388608, 262144, 32768, 4, 38887424, 131072, 0, 0, 218104528, 1
    .long 4, 16, 16, 8192, 5120, 267264, 8388608, 786432, 32768, 4, 7421952, 131072, 0, 0, 218104656, 1
    .long 1, 16, 16, 8192, 5120, 5376, 8388608, 1572864, 32768, 8, 10567680, 131072, 0, 0, 218105168, 4
    .long 2, 64, 72, 7168, 6656, 6656, 7340032, 0, 32768, 8, 54632448, 114688, 0, 0, 218103856, 1
    .long 2, 64, 72, 7168, 5632, 5632, 7340032, 1572864, 32768, 8, 60121088, 114688, 0, 0, 218104048, 1
    .long 2, 64, 72, 7168, 4608, 4608, 7340032, 3145728, 32768, 8, 65609728, 114688, 0, 0, 218104224, 1
    .long 1, 80, 80, 2048, 3671040, 3671296, 7340032, 63758336, 114688, 7, 178798592, 32768, 218104160, 7, 218106688, 1
    .long 0, 0, 0, 0, 0, 0, 0, 0, 0, 0, 0, 0, 0, 0, 0, 0
    .long 0, 0, 0, 0, 0, 0, 0, 0, 0, 0, 0, 0, 0, 0, 0, 0
    .long 6, 32, 32, 8192, 7680, 269824, 8388608, 0, 32768, 4, 37871616, 131072, 0, 0, 218104432, 1
    .long 4, 32, 32, 8192, 7680, 269824, 8388608, 262144, 32768, 4, 38920192, 131072, 0, 0, 218104560, 1
    .long 4, 16, 16, 8192, 7168, 269312, 8388608, 786432, 32768, 4, 7454720, 131072, 0, 0, 218104688, 1
    .long 1, 16, 16, 8192, 7168, 7424, 8388608, 1572864, 32768, 8, 10600448, 131072, 0, 0, 218105200, 4
    .long 2, 64, 72, 7168, 6912, 6912, 7340032, 0, 32768, 8, 54636544, 114688, 0, 0, 218103856, 1
    .long 2, 64, 72, 7168, 5888, 5888, 7340032, 1572864, 32768, 8, 60125184, 114688, 0, 0, 218104048, 1
    .long 2, 64, 72, 7168, 4864, 4864, 7340032, 3145728, 32768, 8, 65613824, 114688, 0, 0, 218104224, 1
    .long 1, 80, 80, 2048, 5506048, 5506304, 7340032, 63787008, 114688, 7, 182992896, 32768, 218104176, 7, 218106688, 1
    .long 0, 0, 0, 0, 0, 0, 0, 0, 0, 0, 0, 0, 0, 0, 0, 0
    .long 0, 0, 0, 0, 0, 0, 0, 0, 0, 0, 0, 0, 0, 0, 0, 0
    .long 6, 32, 32, 8192, 1792, 263936, 8388608, 0, 32768, 4, 37777408, 131072, 0, 0, 218104336, 1
    .long 4, 32, 32, 8192, 1792, 263936, 8388608, 262144, 32768, 4, 38825984, 131072, 0, 0, 218104464, 1
    .long 4, 16, 16, 8192, 1024, 263168, 8388608, 524288, 32768, 4, 6307840, 131072, 0, 0, 218104592, 1
    .long 1, 16, 16, 8192, 1536, 1792, 8388608, 1572864, 32768, 8, 10510336, 131072, 0, 0, 218105104, 4
    .long 2, 64, 72, 7168, 0, 0, 7340032, 524288, 32768, 8, 56360960, 114688, 0, 0, 218103872, 1
    .long 2, 64, 72, 7168, 6144, 6144, 7340032, 1572864, 32768, 8, 60129280, 114688, 0, 0, 218104048, 1
    .long 2, 64, 72, 7168, 5120, 5120, 7340032, 3145728, 32768, 8, 65617920, 114688, 0, 0, 218104224, 1
    .long 1, 80, 80, 2048, 1536, 1792, 7340032, 63700992, 114688, 7, 170418176, 32768, 218104128, 7, 218106688, 1
    .long 0, 0, 0, 0, 0, 0, 0, 0, 0, 0, 0, 0, 0, 0, 0, 0
    .long 0, 0, 0, 0, 0, 0, 0, 0, 0, 0, 0, 0, 0, 0, 0, 0
    .long 6, 32, 32, 8192, 3840, 265984, 8388608, 0, 32768, 4, 37810176, 131072, 0, 0, 218104368, 1
    .long 4, 32, 32, 8192, 3840, 265984, 8388608, 262144, 32768, 4, 38858752, 131072, 0, 0, 218104496, 1
    .long 4, 16, 16, 8192, 3072, 265216, 8388608, 524288, 32768, 4, 6340608, 131072, 0, 0, 218104624, 1
    .long 1, 16, 16, 8192, 3584, 3840, 8388608, 1572864, 32768, 8, 10543104, 131072, 0, 0, 218105136, 4
    .long 2, 64, 72, 7168, 256, 256, 7340032, 524288, 32768, 8, 56365056, 114688, 0, 0, 218103872, 1
    .long 2, 64, 72, 7168, 6400, 6400, 7340032, 1572864, 32768, 8, 60133376, 114688, 0, 0, 218104048, 1
    .long 2, 64, 72, 7168, 5376, 5376, 7340032, 3145728, 32768, 8, 65622016, 114688, 0, 0, 218104240, 1
    .long 1, 80, 80, 2048, 1836544, 1836800, 7340032, 63729664, 114688, 7, 174612480, 32768, 218104144, 7, 218106688, 1
    .long 0, 0, 0, 0, 0, 0, 0, 0, 0, 0, 0, 0, 0, 0, 0, 0
    .long 0, 0, 0, 0, 0, 0, 0, 0, 0, 0, 0, 0, 0, 0, 0, 0
    .long 6, 32, 32, 8192, 5888, 268032, 8388608, 0, 32768, 4, 37842944, 131072, 0, 0, 218104400, 1
    .long 4, 32, 32, 8192, 5888, 268032, 8388608, 262144, 32768, 4, 38891520, 131072, 0, 0, 218104528, 1
    .long 4, 16, 16, 8192, 5120, 267264, 8388608, 524288, 32768, 4, 6373376, 131072, 0, 0, 218104656, 1
    .long 1, 16, 16, 8192, 5632, 5888, 8388608, 1572864, 32768, 8, 10575872, 131072, 0, 0, 218105168, 4
    .long 2, 64, 72, 7168, 512, 512, 7340032, 524288, 32768, 8, 56369152, 114688, 0, 0, 218103872, 1
    .long 2, 64, 72, 7168, 6656, 6656, 7340032, 1572864, 32768, 8, 60137472, 114688, 0, 0, 218104048, 1
    .long 2, 64, 72, 7168, 5632, 5632, 7340032, 3145728, 32768, 8, 65626112, 114688, 0, 0, 218104240, 1
    .long 1, 80, 80, 2048, 3671552, 3671808, 7340032, 63758336, 114688, 7, 178806784, 32768, 218104160, 7, 218106688, 1
    .long 0, 0, 0, 0, 0, 0, 0, 0, 0, 0, 0, 0, 0, 0, 0, 0
    .long 0, 0, 0, 0, 0, 0, 0, 0, 0, 0, 0, 0, 0, 0, 0, 0
    .long 6, 32, 32, 8192, 7936, 270080, 8388608, 0, 32768, 4, 37875712, 131072, 0, 0, 218104432, 1
    .long 4, 32, 32, 8192, 7936, 270080, 8388608, 262144, 32768, 4, 38924288, 131072, 0, 0, 218104560, 1
    .long 4, 16, 16, 8192, 7168, 269312, 8388608, 524288, 32768, 4, 6406144, 131072, 0, 0, 218104688, 1
    .long 1, 16, 16, 8192, 7680, 7936, 8388608, 1572864, 32768, 8, 10608640, 131072, 0, 0, 218105200, 4
    .long 2, 64, 72, 7168, 768, 768, 7340032, 524288, 32768, 8, 56373248, 114688, 0, 0, 218103872, 1
    .long 2, 64, 72, 7168, 6912, 6912, 7340032, 1572864, 32768, 8, 60141568, 114688, 0, 0, 218104048, 1
    .long 2, 64, 72, 7168, 5888, 5888, 7340032, 3145728, 32768, 8, 65630208, 114688, 0, 0, 218104240, 1
    .long 1, 80, 80, 2048, 5506560, 5506816, 7340032, 63787008, 114688, 7, 183001088, 32768, 218104176, 7, 218106688, 1
    .long 0, 0, 0, 0, 0, 0, 0, 0, 0, 0, 0, 0, 0, 0, 0, 0
    .long 0, 0, 0, 0, 0, 0, 0, 0, 0, 0, 0, 0, 0, 0, 0, 0
    .long 6, 16, 16, 8192, 0, 262144, 8388608, 0, 32768, 4, 4194304, 131072, 0, 0, 218104320, 1
    .long 4, 16, 16, 8192, 0, 262144, 8388608, 262144, 32768, 4, 5242880, 131072, 0, 0, 218104448, 1
    .long 4, 16, 16, 8192, 0, 262144, 8388608, 524288, 32768, 4, 6291456, 131072, 0, 0, 218104576, 1
    .long 1, 32, 32, 8192, 0, 256, 8388608, 2097152, 32768, 8, 46137344, 131072, 0, 0, 218105344, 4
    .long 2, 64, 72, 7168, 1024, 1024, 7340032, 524288, 32768, 8, 56377344, 114688, 0, 0, 218103872, 1
    .long 2, 64, 72, 7168, 0, 0, 7340032, 2097152, 32768, 8, 61865984, 114688, 0, 0, 218104064, 1
    .long 2, 64, 72, 7168, 6144, 6144, 7340032, 3145728, 32768, 8, 65634304, 114688, 0, 0, 218104240, 1
    .long 1, 80, 80, 2048, 0, 256, 7340032, 65536000, 114688, 7, 170917888, 32768, 218104192, 7, 218106752, 1
    .long 0, 0, 0, 0, 0, 0, 0, 0, 0, 0, 0, 0, 0, 0, 0, 0
    .long 0, 0, 0, 0, 0, 0, 0, 0, 0, 0, 0, 0, 0, 0, 0, 0
    .long 6, 16, 16, 8192, 2048, 264192, 8388608, 0, 32768, 4, 4227072, 131072, 0, 0, 218104352, 1
    .long 4, 16, 16, 8192, 2048, 264192, 8388608, 262144, 32768, 4, 5275648, 131072, 0, 0, 218104480, 1
    .long 4, 16, 16, 8192, 2048, 264192, 8388608, 524288, 32768, 4, 6324224, 131072, 0, 0, 218104608, 1
    .long 1, 32, 32, 8192, 2048, 2304, 8388608, 2097152, 32768, 8, 46170112, 131072, 0, 0, 218105376, 4
    .long 2, 64, 72, 7168, 1280, 1280, 7340032, 524288, 32768, 8, 56381440, 114688, 0, 0, 218103872, 1
    .long 2, 64, 72, 7168, 256, 256, 7340032, 2097152, 32768, 8, 61870080, 114688, 0, 0, 218104064, 1
    .long 2, 64, 72, 7168, 6400, 6400, 7340032, 3145728, 32768, 8, 65638400, 114688, 0, 0, 218104240, 1
    .long 1, 80, 80, 2048, 1835008, 1835264, 7340032, 65564672, 114688, 7, 175112192, 32768, 218104208, 7, 218106752, 1
    .long 0, 0, 0, 0, 0, 0, 0, 0, 0, 0, 0, 0, 0, 0, 0, 0
    .long 0, 0, 0, 0, 0, 0, 0, 0, 0, 0, 0, 0, 0, 0, 0, 0
    .long 6, 16, 16, 8192, 4096, 266240, 8388608, 0, 32768, 4, 4259840, 131072, 0, 0, 218104384, 1
    .long 4, 16, 16, 8192, 4096, 266240, 8388608, 262144, 32768, 4, 5308416, 131072, 0, 0, 218104512, 1
    .long 4, 16, 16, 8192, 4096, 266240, 8388608, 524288, 32768, 4, 6356992, 131072, 0, 0, 218104640, 1
    .long 1, 32, 32, 8192, 4096, 4352, 8388608, 2097152, 32768, 8, 46202880, 131072, 0, 0, 218105408, 4
    .long 2, 64, 72, 7168, 1536, 1536, 7340032, 524288, 32768, 8, 56385536, 114688, 0, 0, 218103872, 1
    .long 2, 64, 72, 7168, 512, 512, 7340032, 2097152, 32768, 8, 61874176, 114688, 0, 0, 218104064, 1
    .long 2, 64, 72, 7168, 6656, 6656, 7340032, 3145728, 32768, 8, 65642496, 114688, 0, 0, 218104240, 1
    .long 1, 80, 80, 2048, 3670016, 3670272, 7340032, 65593344, 114688, 7, 179306496, 32768, 218104224, 7, 218106752, 1
    .long 0, 0, 0, 0, 0, 0, 0, 0, 0, 0, 0, 0, 0, 0, 0, 0
    .long 0, 0, 0, 0, 0, 0, 0, 0, 0, 0, 0, 0, 0, 0, 0, 0
    .long 6, 16, 16, 8192, 6144, 268288, 8388608, 0, 32768, 4, 4292608, 131072, 0, 0, 218104416, 1
    .long 4, 16, 16, 8192, 6144, 268288, 8388608, 262144, 32768, 4, 5341184, 131072, 0, 0, 218104544, 1
    .long 4, 16, 16, 8192, 6144, 268288, 8388608, 524288, 32768, 4, 6389760, 131072, 0, 0, 218104672, 1
    .long 1, 32, 32, 8192, 6144, 6400, 8388608, 2097152, 32768, 8, 46235648, 131072, 0, 0, 218105440, 4
    .long 2, 64, 72, 7168, 1792, 1792, 7340032, 524288, 32768, 8, 56389632, 114688, 0, 0, 218103888, 1
    .long 2, 64, 72, 7168, 768, 768, 7340032, 2097152, 32768, 8, 61878272, 114688, 0, 0, 218104064, 1
    .long 2, 64, 72, 7168, 6912, 6912, 7340032, 3145728, 32768, 8, 65646592, 114688, 0, 0, 218104240, 1
    .long 1, 80, 80, 2048, 5505024, 5505280, 7340032, 65622016, 114688, 7, 183500800, 32768, 218104240, 7, 218106752, 1
    .long 0, 0, 0, 0, 0, 0, 0, 0, 0, 0, 0, 0, 0, 0, 0, 0
    .long 0, 0, 0, 0, 0, 0, 0, 0, 0, 0, 0, 0, 0, 0, 0, 0
    .long 6, 16, 16, 8192, 256, 262400, 8388608, 0, 32768, 4, 4198400, 131072, 0, 0, 218104320, 1
    .long 4, 16, 16, 8192, 256, 262400, 8388608, 262144, 32768, 4, 5246976, 131072, 0, 0, 218104448, 1
    .long 4, 16, 16, 8192, 256, 262400, 8388608, 524288, 32768, 4, 6295552, 131072, 0, 0, 218104576, 1
    .long 1, 32, 32, 8192, 512, 768, 8388608, 2097152, 32768, 8, 46145536, 131072, 0, 0, 218105344, 4
    .long 2, 64, 72, 7168, 2048, 2048, 7340032, 524288, 32768, 8, 56393728, 114688, 0, 0, 218103888, 1
    .long 2, 64, 72, 7168, 1024, 1024, 7340032, 2097152, 32768, 8, 61882368, 114688, 0, 0, 218104064, 1
    .long 2, 64, 72, 7168, 0, 0, 7340032, 3670016, 32768, 8, 67371008, 114688, 0, 0, 218104256, 1
    .long 1, 80, 80, 2048, 512, 768, 7340032, 65536000, 114688, 7, 170926080, 32768, 218104192, 7, 218106752, 1
    .long 0, 0, 0, 0, 0, 0, 0, 0, 0, 0, 0, 0, 0, 0, 0, 0
    .long 0, 0, 0, 0, 0, 0, 0, 0, 0, 0, 0, 0, 0, 0, 0, 0
    .long 6, 16, 16, 8192, 2304, 264448, 8388608, 0, 32768, 4, 4231168, 131072, 0, 0, 218104352, 1
    .long 4, 16, 16, 8192, 2304, 264448, 8388608, 262144, 32768, 4, 5279744, 131072, 0, 0, 218104480, 1
    .long 4, 16, 16, 8192, 2304, 264448, 8388608, 524288, 32768, 4, 6328320, 131072, 0, 0, 218104608, 1
    .long 1, 32, 32, 8192, 2560, 2816, 8388608, 2097152, 32768, 8, 46178304, 131072, 0, 0, 218105376, 4
    .long 2, 64, 72, 7168, 2304, 2304, 7340032, 524288, 32768, 8, 56397824, 114688, 0, 0, 218103888, 1
    .long 2, 64, 72, 7168, 1280, 1280, 7340032, 2097152, 32768, 8, 61886464, 114688, 0, 0, 218104064, 1
    .long 2, 64, 72, 7168, 256, 256, 7340032, 3670016, 32768, 8, 67375104, 114688, 0, 0, 218104256, 1
    .long 1, 80, 80, 2048, 1835520, 1835776, 7340032, 65564672, 114688, 7, 175120384, 32768, 218104208, 7, 218106752, 1
    .long 0, 0, 0, 0, 0, 0, 0, 0, 0, 0, 0, 0, 0, 0, 0, 0
    .long 0, 0, 0, 0, 0, 0, 0, 0, 0, 0, 0, 0, 0, 0, 0, 0
    .long 6, 16, 16, 8192, 4352, 266496, 8388608, 0, 32768, 4, 4263936, 131072, 0, 0, 218104384, 1
    .long 4, 16, 16, 8192, 4352, 266496, 8388608, 262144, 32768, 4, 5312512, 131072, 0, 0, 218104512, 1
    .long 4, 16, 16, 8192, 4352, 266496, 8388608, 524288, 32768, 4, 6361088, 131072, 0, 0, 218104640, 1
    .long 1, 32, 32, 8192, 4608, 4864, 8388608, 2097152, 32768, 8, 46211072, 131072, 0, 0, 218105408, 4
    .long 2, 64, 72, 7168, 2560, 2560, 7340032, 524288, 32768, 8, 56401920, 114688, 0, 0, 218103888, 1
    .long 2, 64, 72, 7168, 1536, 1536, 7340032, 2097152, 32768, 8, 61890560, 114688, 0, 0, 218104064, 1
    .long 2, 64, 72, 7168, 512, 512, 7340032, 3670016, 32768, 8, 67379200, 114688, 0, 0, 218104256, 1
    .long 1, 80, 80, 2048, 3670528, 3670784, 7340032, 65593344, 114688, 7, 179314688, 32768, 218104224, 7, 218106752, 1
    .long 0, 0, 0, 0, 0, 0, 0, 0, 0, 0, 0, 0, 0, 0, 0, 0
    .long 0, 0, 0, 0, 0, 0, 0, 0, 0, 0, 0, 0, 0, 0, 0, 0
    .long 6, 16, 16, 8192, 6400, 268544, 8388608, 0, 32768, 4, 4296704, 131072, 0, 0, 218104416, 1
    .long 4, 16, 16, 8192, 6400, 268544, 8388608, 262144, 32768, 4, 5345280, 131072, 0, 0, 218104544, 1
    .long 4, 16, 16, 8192, 6400, 268544, 8388608, 524288, 32768, 4, 6393856, 131072, 0, 0, 218104672, 1
    .long 1, 32, 32, 8192, 6656, 6912, 8388608, 2097152, 32768, 8, 46243840, 131072, 0, 0, 218105440, 4
    .long 2, 64, 72, 7168, 2816, 2816, 7340032, 524288, 32768, 8, 56406016, 114688, 0, 0, 218103888, 1
    .long 2, 64, 72, 7168, 1792, 1792, 7340032, 2097152, 32768, 8, 61894656, 114688, 0, 0, 218104080, 1
    .long 2, 64, 72, 7168, 768, 768, 7340032, 3670016, 32768, 8, 67383296, 114688, 0, 0, 218104256, 1
    .long 1, 80, 80, 2048, 5505536, 5505792, 7340032, 65622016, 114688, 7, 183508992, 32768, 218104240, 7, 218106752, 1
    .long 0, 0, 0, 0, 0, 0, 0, 0, 0, 0, 0, 0, 0, 0, 0, 0
    .long 0, 0, 0, 0, 0, 0, 0, 0, 0, 0, 0, 0, 0, 0, 0, 0
    .long 6, 16, 16, 8192, 512, 262656, 8388608, 0, 32768, 4, 4202496, 131072, 0, 0, 218104320, 1
    .long 4, 16, 16, 8192, 512, 262656, 8388608, 262144, 32768, 4, 5251072, 131072, 0, 0, 218104448, 1
    .long 4, 16, 16, 8192, 512, 262656, 8388608, 524288, 32768, 4, 6299648, 131072, 0, 0, 218104576, 1
    .long 1, 32, 32, 8192, 1024, 1280, 8388608, 2097152, 32768, 8, 46153728, 131072, 0, 0, 218105360, 4
    .long 2, 64, 72, 7168, 3072, 3072, 7340032, 524288, 32768, 8, 56410112, 114688, 0, 0, 218103888, 1
    .long 2, 64, 72, 7168, 2048, 2048, 7340032, 2097152, 32768, 8, 61898752, 114688, 0, 0, 218104080, 1
    .long 2, 64, 72, 7168, 1024, 1024, 7340032, 3670016, 32768, 8, 67387392, 114688, 0, 0, 218104256, 1
    .long 1, 80, 80, 2048, 1024, 1280, 7340032, 65536000, 114688, 7, 170934272, 32768, 218104192, 7, 218106752, 1
    .long 0, 0, 0, 0, 0, 0, 0, 0, 0, 0, 0, 0, 0, 0, 0, 0
    .long 0, 0, 0, 0, 0, 0, 0, 0, 0, 0, 0, 0, 0, 0, 0, 0
    .long 6, 16, 16, 8192, 2560, 264704, 8388608, 0, 32768, 4, 4235264, 131072, 0, 0, 218104352, 1
    .long 4, 16, 16, 8192, 2560, 264704, 8388608, 262144, 32768, 4, 5283840, 131072, 0, 0, 218104480, 1
    .long 4, 16, 16, 8192, 2560, 264704, 8388608, 524288, 32768, 4, 6332416, 131072, 0, 0, 218104608, 1
    .long 1, 32, 32, 8192, 3072, 3328, 8388608, 2097152, 32768, 8, 46186496, 131072, 0, 0, 218105392, 4
    .long 2, 64, 72, 7168, 3328, 3328, 7340032, 524288, 32768, 8, 56414208, 114688, 0, 0, 218103888, 1
    .long 2, 64, 72, 7168, 2304, 2304, 7340032, 2097152, 32768, 8, 61902848, 114688, 0, 0, 218104080, 1
    .long 2, 64, 72, 7168, 1280, 1280, 7340032, 3670016, 32768, 8, 67391488, 114688, 0, 0, 218104256, 1
    .long 1, 80, 80, 2048, 1836032, 1836288, 7340032, 65564672, 114688, 7, 175128576, 32768, 218104208, 7, 218106752, 1
    .long 0, 0, 0, 0, 0, 0, 0, 0, 0, 0, 0, 0, 0, 0, 0, 0
    .long 0, 0, 0, 0, 0, 0, 0, 0, 0, 0, 0, 0, 0, 0, 0, 0
    .long 6, 16, 16, 8192, 4608, 266752, 8388608, 0, 32768, 4, 4268032, 131072, 0, 0, 218104384, 1
    .long 4, 16, 16, 8192, 4608, 266752, 8388608, 262144, 32768, 4, 5316608, 131072, 0, 0, 218104512, 1
    .long 4, 16, 16, 8192, 4608, 266752, 8388608, 524288, 32768, 4, 6365184, 131072, 0, 0, 218104640, 1
    .long 1, 32, 32, 8192, 5120, 5376, 8388608, 2097152, 32768, 8, 46219264, 131072, 0, 0, 218105424, 4
    .long 2, 64, 72, 7168, 3584, 3584, 7340032, 524288, 32768, 8, 56418304, 114688, 0, 0, 218103904, 1
    .long 2, 64, 72, 7168, 2560, 2560, 7340032, 2097152, 32768, 8, 61906944, 114688, 0, 0, 218104080, 1
    .long 2, 64, 72, 7168, 1536, 1536, 7340032, 3670016, 32768, 8, 67395584, 114688, 0, 0, 218104256, 1
    .long 1, 80, 80, 2048, 3671040, 3671296, 7340032, 65593344, 114688, 7, 179322880, 32768, 218104224, 7, 218106752, 1
    .long 0, 0, 0, 0, 0, 0, 0, 0, 0, 0, 0, 0, 0, 0, 0, 0
    .long 0, 0, 0, 0, 0, 0, 0, 0, 0, 0, 0, 0, 0, 0, 0, 0
    .long 6, 16, 16, 8192, 6656, 268800, 8388608, 0, 32768, 4, 4300800, 131072, 0, 0, 218104416, 1
    .long 4, 16, 16, 8192, 6656, 268800, 8388608, 262144, 32768, 4, 5349376, 131072, 0, 0, 218104544, 1
    .long 4, 16, 16, 8192, 6656, 268800, 8388608, 524288, 32768, 4, 6397952, 131072, 0, 0, 218104672, 1
    .long 1, 32, 32, 8192, 7168, 7424, 8388608, 2097152, 32768, 8, 46252032, 131072, 0, 0, 218105456, 4
    .long 2, 64, 72, 7168, 3840, 3840, 7340032, 524288, 32768, 8, 56422400, 114688, 0, 0, 218103904, 1
    .long 2, 64, 72, 7168, 2816, 2816, 7340032, 2097152, 32768, 8, 61911040, 114688, 0, 0, 218104080, 1
    .long 2, 64, 72, 7168, 1792, 1792, 7340032, 3670016, 32768, 8, 67399680, 114688, 0, 0, 218104272, 1
    .long 1, 80, 80, 2048, 5506048, 5506304, 7340032, 65622016, 114688, 7, 183517184, 32768, 218104240, 7, 218106752, 1
    .long 0, 0, 0, 0, 0, 0, 0, 0, 0, 0, 0, 0, 0, 0, 0, 0
    .long 0, 0, 0, 0, 0, 0, 0, 0, 0, 0, 0, 0, 0, 0, 0, 0
    .long 6, 16, 16, 8192, 768, 262912, 8388608, 0, 32768, 4, 4206592, 131072, 0, 0, 218104320, 1
    .long 4, 16, 16, 8192, 768, 262912, 8388608, 262144, 32768, 4, 5255168, 131072, 0, 0, 218104448, 1
    .long 4, 16, 16, 8192, 768, 262912, 8388608, 524288, 32768, 4, 6303744, 131072, 0, 0, 218104576, 1
    .long 1, 32, 32, 8192, 1536, 1792, 8388608, 2097152, 32768, 8, 46161920, 131072, 0, 0, 218105360, 4
    .long 2, 64, 72, 7168, 4096, 4096, 7340032, 524288, 32768, 8, 56426496, 114688, 0, 0, 218103904, 1
    .long 2, 64, 72, 7168, 3072, 3072, 7340032, 2097152, 32768, 8, 61915136, 114688, 0, 0, 218104080, 1
    .long 2, 64, 72, 7168, 2048, 2048, 7340032, 3670016, 32768, 8, 67403776, 114688, 0, 0, 218104272, 1
    .long 1, 80, 80, 2048, 1536, 1792, 7340032, 65536000, 114688, 7, 170942464, 32768, 218104192, 7, 218106752, 1
    .long 0, 0, 0, 0, 0, 0, 0, 0, 0, 0, 0, 0, 0, 0, 0, 0
    .long 0, 0, 0, 0, 0, 0, 0, 0, 0, 0, 0, 0, 0, 0, 0, 0
    .long 6, 16, 16, 8192, 2816, 264960, 8388608, 0, 32768, 4, 4239360, 131072, 0, 0, 218104352, 1
    .long 4, 16, 16, 8192, 2816, 264960, 8388608, 262144, 32768, 4, 5287936, 131072, 0, 0, 218104480, 1
    .long 4, 16, 16, 8192, 2816, 264960, 8388608, 524288, 32768, 4, 6336512, 131072, 0, 0, 218104608, 1
    .long 1, 32, 32, 8192, 3584, 3840, 8388608, 2097152, 32768, 8, 46194688, 131072, 0, 0, 218105392, 4
    .long 2, 64, 72, 7168, 4352, 4352, 7340032, 524288, 32768, 8, 56430592, 114688, 0, 0, 218103904, 1
    .long 2, 64, 72, 7168, 3328, 3328, 7340032, 2097152, 32768, 8, 61919232, 114688, 0, 0, 218104080, 1
    .long 2, 64, 72, 7168, 2304, 2304, 7340032, 3670016, 32768, 8, 67407872, 114688, 0, 0, 218104272, 1
    .long 1, 80, 80, 2048, 1836544, 1836800, 7340032, 65564672, 114688, 7, 175136768, 32768, 218104208, 7, 218106752, 1
    .long 0, 0, 0, 0, 0, 0, 0, 0, 0, 0, 0, 0, 0, 0, 0, 0
    .long 0, 0, 0, 0, 0, 0, 0, 0, 0, 0, 0, 0, 0, 0, 0, 0
    .long 6, 16, 16, 8192, 4864, 267008, 8388608, 0, 32768, 4, 4272128, 131072, 0, 0, 218104384, 1
    .long 4, 16, 16, 8192, 4864, 267008, 8388608, 262144, 32768, 4, 5320704, 131072, 0, 0, 218104512, 1
    .long 4, 16, 16, 8192, 4864, 267008, 8388608, 524288, 32768, 4, 6369280, 131072, 0, 0, 218104640, 1
    .long 1, 32, 32, 8192, 5632, 5888, 8388608, 2097152, 32768, 8, 46227456, 131072, 0, 0, 218105424, 4
    .long 2, 64, 72, 7168, 4608, 4608, 7340032, 524288, 32768, 8, 56434688, 114688, 0, 0, 218103904, 1
    .long 2, 64, 72, 7168, 3584, 3584, 7340032, 2097152, 32768, 8, 61923328, 114688, 0, 0, 218104096, 1
    .long 2, 64, 72, 7168, 2560, 2560, 7340032, 3670016, 32768, 8, 67411968, 114688, 0, 0, 218104272, 1
    .long 1, 80, 80, 2048, 3671552, 3671808, 7340032, 65593344, 114688, 7, 179331072, 32768, 218104224, 7, 218106752, 1
    .long 0, 0, 0, 0, 0, 0, 0, 0, 0, 0, 0, 0, 0, 0, 0, 0
    .long 0, 0, 0, 0, 0, 0, 0, 0, 0, 0, 0, 0, 0, 0, 0, 0
    .long 6, 16, 16, 8192, 6912, 269056, 8388608, 0, 32768, 4, 4304896, 131072, 0, 0, 218104416, 1
    .long 4, 16, 16, 8192, 6912, 269056, 8388608, 262144, 32768, 4, 5353472, 131072, 0, 0, 218104544, 1
    .long 4, 16, 16, 8192, 6912, 269056, 8388608, 524288, 32768, 4, 6402048, 131072, 0, 0, 218104672, 1
    .long 1, 32, 32, 8192, 7680, 7936, 8388608, 2097152, 32768, 8, 46260224, 131072, 0, 0, 218105456, 4
    .long 2, 64, 72, 7168, 4864, 4864, 7340032, 524288, 32768, 8, 56438784, 114688, 0, 0, 218103904, 1
    .long 2, 64, 72, 7168, 3840, 3840, 7340032, 2097152, 32768, 8, 61927424, 114688, 0, 0, 218104096, 1
    .long 2, 64, 72, 7168, 2816, 2816, 7340032, 3670016, 32768, 8, 67416064, 114688, 0, 0, 218104272, 1
    .long 1, 80, 80, 2048, 5506560, 5506816, 7340032, 65622016, 114688, 7, 183525376, 32768, 218104240, 7, 218106752, 1
    .long 0, 0, 0, 0, 0, 0, 0, 0, 0, 0, 0, 0, 0, 0, 0, 0
    .long 0, 0, 0, 0, 0, 0, 0, 0, 0, 0, 0, 0, 0, 0, 0, 0
    .long 6, 16, 16, 8192, 1024, 263168, 8388608, 0, 32768, 4, 4210688, 131072, 0, 0, 218104336, 1
    .long 4, 16, 16, 8192, 1024, 263168, 8388608, 262144, 32768, 4, 5259264, 131072, 0, 0, 218104464, 1
    .long 4, 16, 16, 8192, 768, 262912, 8388608, 786432, 32768, 4, 7352320, 131072, 0, 0, 218104576, 1
    .long 1, 24, 24, 8192, 0, 256, 8388608, 2097152, 32768, 8, 29360128, 131072, 0, 0, 218105344, 4
    .long 2, 64, 72, 7168, 5120, 5120, 7340032, 524288, 32768, 8, 56442880, 114688, 0, 0, 218103904, 1
    .long 2, 64, 72, 7168, 4096, 4096, 7340032, 2097152, 32768, 8, 61931520, 114688, 0, 0, 218104096, 1
    .long 2, 64, 72, 7168, 3072, 3072, 7340032, 3670016, 32768, 8, 67420160, 114688, 0, 0, 218104272, 1
    .long 1, 80, 80, 2048, 0, 256, 7340032, 67371008, 114688, 7, 171442176, 32768, 218104256, 7, 218106816, 1
    .long 0, 0, 0, 0, 0, 0, 0, 0, 0, 0, 0, 0, 0, 0, 0, 0
    .long 0, 0, 0, 0, 0, 0, 0, 0, 0, 0, 0, 0, 0, 0, 0, 0
    .long 6, 16, 16, 8192, 3072, 265216, 8388608, 0, 32768, 4, 4243456, 131072, 0, 0, 218104368, 1
    .long 4, 16, 16, 8192, 3072, 265216, 8388608, 262144, 32768, 4, 5292032, 131072, 0, 0, 218104496, 1
    .long 4, 16, 16, 8192, 2816, 264960, 8388608, 786432, 32768, 4, 7385088, 131072, 0, 0, 218104608, 1
    .long 1, 24, 24, 8192, 2048, 2304, 8388608, 2097152, 32768, 8, 29392896, 131072, 0, 0, 218105376, 4
    .long 2, 64, 72, 7168, 5376, 5376, 7340032, 524288, 32768, 8, 56446976, 114688, 0, 0, 218103920, 1
    .long 2, 64, 72, 7168, 4352, 4352, 7340032, 2097152, 32768, 8, 61935616, 114688, 0, 0, 218104096, 1
    .long 2, 64, 72, 7168, 3328, 3328, 7340032, 3670016, 32768, 8, 67424256, 114688, 0, 0, 218104272, 1
    .long 1, 80, 80, 2048, 1835008, 1835264, 7340032, 67399680, 114688, 7, 175636480, 32768, 218104272, 7, 218106816, 1
    .long 0, 0, 0, 0, 0, 0, 0, 0, 0, 0, 0, 0, 0, 0, 0, 0
    .long 0, 0, 0, 0, 0, 0, 0, 0, 0, 0, 0, 0, 0, 0, 0, 0
    .long 6, 16, 16, 8192, 5120, 267264, 8388608, 0, 32768, 4, 4276224, 131072, 0, 0, 218104400, 1
    .long 4, 16, 16, 8192, 5120, 267264, 8388608, 262144, 32768, 4, 5324800, 131072, 0, 0, 218104528, 1
    .long 4, 16, 16, 8192, 4864, 267008, 8388608, 786432, 32768, 4, 7417856, 131072, 0, 0, 218104640, 1
    .long 1, 24, 24, 8192, 4096, 4352, 8388608, 2097152, 32768, 8, 29425664, 131072, 0, 0, 218105408, 4
    .long 2, 64, 72, 7168, 5632, 5632, 7340032, 524288, 32768, 8, 56451072, 114688, 0, 0, 218103920, 1
    .long 2, 64, 72, 7168, 4608, 4608, 7340032, 2097152, 32768, 8, 61939712, 114688, 0, 0, 218104096, 1
    .long 2, 64, 72, 7168, 3584, 3584, 7340032, 3670016, 32768, 8, 67428352, 114688, 0, 0, 218104288, 1
    .long 1, 80, 80, 2048, 3670016, 3670272, 7340032, 67428352, 114688, 7, 179830784, 32768, 218104288, 7, 218106816, 1
    .long 0, 0, 0, 0, 0, 0, 0, 0, 0, 0, 0, 0, 0, 0, 0, 0
    .long 0, 0, 0, 0, 0, 0, 0, 0, 0, 0, 0, 0, 0, 0, 0, 0
    .long 6, 16, 16, 8192, 7168, 269312, 8388608, 0, 32768, 4, 4308992, 131072, 0, 0, 218104432, 1
    .long 4, 16, 16, 8192, 7168, 269312, 8388608, 262144, 32768, 4, 5357568, 131072, 0, 0, 218104560, 1
    .long 4, 16, 16, 8192, 6912, 269056, 8388608, 786432, 32768, 4, 7450624, 131072, 0, 0, 218104672, 1
    .long 1, 24, 24, 8192, 6144, 6400, 8388608, 2097152, 32768, 8, 29458432, 131072, 0, 0, 218105440, 4
    .long 2, 64, 72, 7168, 5888, 5888, 7340032, 524288, 32768, 8, 56455168, 114688, 0, 0, 218103920, 1
    .long 2, 64, 72, 7168, 4864, 4864, 7340032, 2097152, 32768, 8, 61943808, 114688, 0, 0, 218104096, 1
    .long 2, 64, 72, 7168, 3840, 3840, 7340032, 3670016, 32768, 8, 67432448, 114688, 0, 0, 218104288, 1
    .long 1, 80, 80, 2048, 5505024, 5505280, 7340032, 67457024, 114688, 7, 184025088, 32768, 218104304, 7, 218106816, 1
    .long 0, 0, 0, 0, 0, 0, 0, 0, 0, 0, 0, 0, 0, 0, 0, 0
    .long 0, 0, 0, 0, 0, 0, 0, 0, 0, 0, 0, 0, 0, 0, 0, 0
    .long 6, 16, 16, 8192, 1280, 263424, 8388608, 0, 32768, 4, 4214784, 131072, 0, 0, 218104336, 1
    .long 4, 16, 16, 8192, 1280, 263424, 8388608, 262144, 32768, 4, 5263360, 131072, 0, 0, 218104464, 1
    .long 4, 16, 16, 8192, 512, 262656, 8388608, 786432, 32768, 4, 7348224, 131072, 0, 0, 218104576, 1
    .long 1, 24, 24, 8192, 512, 768, 8388608, 2097152, 32768, 8, 29368320, 131072, 0, 0, 218105344, 4
    .long 2, 64, 72, 7168, 6144, 6144, 7340032, 524288, 32768, 8, 56459264, 114688, 0, 0, 218103920, 1
    .long 2, 64, 72, 7168, 5120, 5120, 7340032, 2097152, 32768, 8, 61947904, 114688, 0, 0, 218104096, 1
    .long 2, 64, 72, 7168, 4096, 4096, 7340032, 3670016, 32768, 8, 67436544, 114688, 0, 0, 218104288, 1
    .long 1, 80, 80, 2048, 512, 768, 7340032, 67371008, 114688, 7, 171450368, 32768, 218104256, 7, 218106816, 1
    .long 0, 0, 0, 0, 0, 0, 0, 0, 0, 0, 0, 0, 0, 0, 0, 0
    .long 0, 0, 0, 0, 0, 0, 0, 0, 0, 0, 0, 0, 0, 0, 0, 0
    .long 6, 16, 16, 8192, 3328, 265472, 8388608, 0, 32768, 4, 4247552, 131072, 0, 0, 218104368, 1
    .long 4, 16, 16, 8192, 3328, 265472, 8388608, 262144, 32768, 4, 5296128, 131072, 0, 0, 218104496, 1
    .long 4, 16, 16, 8192, 2560, 264704, 8388608, 786432, 32768, 4, 7380992, 131072, 0, 0, 218104608, 1
    .long 1, 24, 24, 8192, 2560, 2816, 8388608, 2097152, 32768, 8, 29401088, 131072, 0, 0, 218105376, 4
    .long 2, 64, 72, 7168, 6400, 6400, 7340032, 524288, 32768, 8, 56463360, 114688, 0, 0, 218103920, 1
    .long 2, 64, 72, 7168, 5376, 5376, 7340032, 2097152, 32768, 8, 61952000, 114688, 0, 0, 218104112, 1
    .long 2, 64, 72, 7168, 4352, 4352, 7340032, 3670016, 32768, 8, 67440640, 114688, 0, 0, 218104288, 1
    .long 1, 80, 80, 2048, 1835520, 1835776, 7340032, 67399680, 114688, 7, 175644672, 32768, 218104272, 7, 218106816, 1
    .long 0, 0, 0, 0, 0, 0, 0, 0, 0, 0, 0, 0, 0, 0, 0, 0
    .long 0, 0, 0, 0, 0, 0, 0, 0, 0, 0, 0, 0, 0, 0, 0, 0
    .long 6, 16, 16, 8192, 5376, 267520, 8388608, 0, 32768, 4, 4280320, 131072, 0, 0, 218104400, 1
    .long 4, 16, 16, 8192, 5376, 267520, 8388608, 262144, 32768, 4, 5328896, 131072, 0, 0, 218104528, 1
    .long 4, 16, 16, 8192, 4608, 266752, 8388608, 786432, 32768, 4, 7413760, 131072, 0, 0, 218104640, 1
    .long 1, 24, 24, 8192, 4608, 4864, 8388608, 2097152, 32768, 8, 29433856, 131072, 0, 0, 218105408, 4
    .long 2, 64, 72, 7168, 6656, 6656, 7340032, 524288, 32768, 8, 56467456, 114688, 0, 0, 218103920, 1
    .long 2, 64, 72, 7168, 5632, 5632, 7340032, 2097152, 32768, 8, 61956096, 114688, 0, 0, 218104112, 1
    .long 2, 64, 72, 7168, 4608, 4608, 7340032, 3670016, 32768, 8, 67444736, 114688, 0, 0, 218104288, 1
    .long 1, 80, 80, 2048, 3670528, 3670784, 7340032, 67428352, 114688, 7, 179838976, 32768, 218104288, 7, 218106816, 1
    .long 0, 0, 0, 0, 0, 0, 0, 0, 0, 0, 0, 0, 0, 0, 0, 0
    .long 0, 0, 0, 0, 0, 0, 0, 0, 0, 0, 0, 0, 0, 0, 0, 0
    .long 6, 16, 16, 8192, 7424, 269568, 8388608, 0, 32768, 4, 4313088, 131072, 0, 0, 218104432, 1
    .long 4, 16, 16, 8192, 7424, 269568, 8388608, 262144, 32768, 4, 5361664, 131072, 0, 0, 218104560, 1
    .long 4, 16, 16, 8192, 6656, 268800, 8388608, 786432, 32768, 4, 7446528, 131072, 0, 0, 218104672, 1
    .long 1, 24, 24, 8192, 6656, 6912, 8388608, 2097152, 32768, 8, 29466624, 131072, 0, 0, 218105440, 4
    .long 2, 64, 72, 7168, 6912, 6912, 7340032, 524288, 32768, 8, 56471552, 114688, 0, 0, 218103920, 1
    .long 2, 64, 72, 7168, 5888, 5888, 7340032, 2097152, 32768, 8, 61960192, 114688, 0, 0, 218104112, 1
    .long 2, 64, 72, 7168, 4864, 4864, 7340032, 3670016, 32768, 8, 67448832, 114688, 0, 0, 218104288, 1
    .long 1, 80, 80, 2048, 5505536, 5505792, 7340032, 67457024, 114688, 7, 184033280, 32768, 218104304, 7, 218106816, 1
    .long 0, 0, 0, 0, 0, 0, 0, 0, 0, 0, 0, 0, 0, 0, 0, 0
    .long 0, 0, 0, 0, 0, 0, 0, 0, 0, 0, 0, 0, 0, 0, 0, 0
    .long 6, 16, 16, 8192, 1536, 263680, 8388608, 0, 32768, 4, 4218880, 131072, 0, 0, 218104336, 1
    .long 4, 16, 16, 8192, 1536, 263680, 8388608, 262144, 32768, 4, 5267456, 131072, 0, 0, 218104464, 1
    .long 4, 16, 16, 8192, 256, 262400, 8388608, 786432, 32768, 4, 7344128, 131072, 0, 0, 218104576, 1
    .long 1, 24, 24, 8192, 1024, 1280, 8388608, 2097152, 32768, 8, 29376512, 131072, 0, 0, 218105360, 4
    .long 2, 64, 72, 7168, 0, 0, 7340032, 1048576, 32768, 8, 58195968, 114688, 0, 0, 218103936, 1
    .long 2, 64, 72, 7168, 6144, 6144, 7340032, 2097152, 32768, 8, 61964288, 114688, 0, 0, 218104112, 1
    .long 2, 64, 72, 7168, 5120, 5120, 7340032, 3670016, 32768, 8, 67452928, 114688, 0, 0, 218104288, 1
    .long 1, 80, 80, 2048, 1024, 1280, 7340032, 67371008, 114688, 7, 171458560, 32768, 218104256, 7, 218106816, 1
    .long 0, 0, 0, 0, 0, 0, 0, 0, 0, 0, 0, 0, 0, 0, 0, 0
    .long 0, 0, 0, 0, 0, 0, 0, 0, 0, 0, 0, 0, 0, 0, 0, 0
    .long 6, 16, 16, 8192, 3584, 265728, 8388608, 0, 32768, 4, 4251648, 131072, 0, 0, 218104368, 1
    .long 4, 16, 16, 8192, 3584, 265728, 8388608, 262144, 32768, 4, 5300224, 131072, 0, 0, 218104496, 1
    .long 4, 16, 16, 8192, 2304, 264448, 8388608, 786432, 32768, 4, 7376896, 131072, 0, 0, 218104608, 1
    .long 1, 24, 24, 8192, 3072, 3328, 8388608, 2097152, 32768, 8, 29409280, 131072, 0, 0, 218105392, 4
    .long 2, 64, 72, 7168, 256, 256, 7340032, 1048576, 32768, 8, 58200064, 114688, 0, 0, 218103936, 1
    .long 2, 64, 72, 7168, 6400, 6400, 7340032, 2097152, 32768, 8, 61968384, 114688, 0, 0, 218104112, 1
    .long 2, 64, 72, 7168, 5376, 5376, 7340032, 3670016, 32768, 8, 67457024, 114688, 0, 0, 218104304, 1
    .long 1, 80, 80, 2048, 1836032, 1836288, 7340032, 67399680, 114688, 7, 175652864, 32768, 218104272, 7, 218106816, 1
    .long 0, 0, 0, 0, 0, 0, 0, 0, 0, 0, 0, 0, 0, 0, 0, 0
    .long 0, 0, 0, 0, 0, 0, 0, 0, 0, 0, 0, 0, 0, 0, 0, 0
    .long 6, 16, 16, 8192, 5632, 267776, 8388608, 0, 32768, 4, 4284416, 131072, 0, 0, 218104400, 1
    .long 4, 16, 16, 8192, 5632, 267776, 8388608, 262144, 32768, 4, 5332992, 131072, 0, 0, 218104528, 1
    .long 4, 16, 16, 8192, 4352, 266496, 8388608, 786432, 32768, 4, 7409664, 131072, 0, 0, 218104640, 1
    .long 1, 24, 24, 8192, 5120, 5376, 8388608, 2097152, 32768, 8, 29442048, 131072, 0, 0, 218105424, 4
    .long 2, 64, 72, 7168, 512, 512, 7340032, 1048576, 32768, 8, 58204160, 114688, 0, 0, 218103936, 1
    .long 2, 64, 72, 7168, 6656, 6656, 7340032, 2097152, 32768, 8, 61972480, 114688, 0, 0, 218104112, 1
    .long 2, 64, 72, 7168, 5632, 5632, 7340032, 3670016, 32768, 8, 67461120, 114688, 0, 0, 218104304, 1
    .long 1, 80, 80, 2048, 3671040, 3671296, 7340032, 67428352, 114688, 7, 179847168, 32768, 218104288, 7, 218106816, 1
    .long 0, 0, 0, 0, 0, 0, 0, 0, 0, 0, 0, 0, 0, 0, 0, 0
    .long 0, 0, 0, 0, 0, 0, 0, 0, 0, 0, 0, 0, 0, 0, 0, 0
    .long 6, 16, 16, 8192, 7680, 269824, 8388608, 0, 32768, 4, 4317184, 131072, 0, 0, 218104432, 1
    .long 4, 16, 16, 8192, 7680, 269824, 8388608, 262144, 32768, 4, 5365760, 131072, 0, 0, 218104560, 1
    .long 4, 16, 16, 8192, 6400, 268544, 8388608, 786432, 32768, 4, 7442432, 131072, 0, 0, 218104672, 1
    .long 1, 24, 24, 8192, 7168, 7424, 8388608, 2097152, 32768, 8, 29474816, 131072, 0, 0, 218105456, 4
    .long 2, 64, 72, 7168, 768, 768, 7340032, 1048576, 32768, 8, 58208256, 114688, 0, 0, 218103936, 1
    .long 2, 64, 72, 7168, 6912, 6912, 7340032, 2097152, 32768, 8, 61976576, 114688, 0, 0, 218104112, 1
    .long 2, 64, 72, 7168, 5888, 5888, 7340032, 3670016, 32768, 8, 67465216, 114688, 0, 0, 218104304, 1
    .long 1, 80, 80, 2048, 5506048, 5506304, 7340032, 67457024, 114688, 7, 184041472, 32768, 218104304, 7, 218106816, 1
    .long 0, 0, 0, 0, 0, 0, 0, 0, 0, 0, 0, 0, 0, 0, 0, 0
    .long 0, 0, 0, 0, 0, 0, 0, 0, 0, 0, 0, 0, 0, 0, 0, 0
    .long 6, 16, 16, 8192, 1792, 263936, 8388608, 0, 32768, 4, 4222976, 131072, 0, 0, 218104336, 1
    .long 4, 16, 16, 8192, 1792, 263936, 8388608, 262144, 32768, 4, 5271552, 131072, 0, 0, 218104464, 1
    .long 4, 16, 16, 8192, 0, 262144, 8388608, 786432, 32768, 4, 7340032, 131072, 0, 0, 218104576, 1
    .long 1, 24, 24, 8192, 1536, 1792, 8388608, 2097152, 32768, 8, 29384704, 131072, 0, 0, 218105360, 4
    .long 2, 64, 72, 7168, 1024, 1024, 7340032, 1048576, 32768, 8, 58212352, 114688, 0, 0, 218103936, 1
    .long 2, 64, 72, 7168, 0, 0, 7340032, 2621440, 32768, 8, 63700992, 114688, 0, 0, 218104128, 1
    .long 2, 64, 72, 7168, 6144, 6144, 7340032, 3670016, 32768, 8, 67469312, 114688, 0, 0, 218104304, 1
    .long 1, 80, 80, 2048, 1536, 1792, 7340032, 67371008, 114688, 7, 171466752, 32768, 218104256, 7, 218106816, 1
    .long 0, 0, 0, 0, 0, 0, 0, 0, 0, 0, 0, 0, 0, 0, 0, 0
    .long 0, 0, 0, 0, 0, 0, 0, 0, 0, 0, 0, 0, 0, 0, 0, 0
    .long 6, 16, 16, 8192, 3840, 265984, 8388608, 0, 32768, 4, 4255744, 131072, 0, 0, 218104368, 1
    .long 4, 16, 16, 8192, 3840, 265984, 8388608, 262144, 32768, 4, 5304320, 131072, 0, 0, 218104496, 1
    .long 4, 16, 16, 8192, 2048, 264192, 8388608, 786432, 32768, 4, 7372800, 131072, 0, 0, 218104608, 1
    .long 1, 24, 24, 8192, 3584, 3840, 8388608, 2097152, 32768, 8, 29417472, 131072, 0, 0, 218105392, 4
    .long 2, 64, 72, 7168, 1280, 1280, 7340032, 1048576, 32768, 8, 58216448, 114688, 0, 0, 218103936, 1
    .long 2, 64, 72, 7168, 256, 256, 7340032, 2621440, 32768, 8, 63705088, 114688, 0, 0, 218104128, 1
    .long 2, 64, 72, 7168, 6400, 6400, 7340032, 3670016, 32768, 8, 67473408, 114688, 0, 0, 218104304, 1
    .long 1, 80, 80, 2048, 1836544, 1836800, 7340032, 67399680, 114688, 7, 175661056, 32768, 218104272, 7, 218106816, 1
    .long 0, 0, 0, 0, 0, 0, 0, 0, 0, 0, 0, 0, 0, 0, 0, 0
    .long 0, 0, 0, 0, 0, 0, 0, 0, 0, 0, 0, 0, 0, 0, 0, 0
    .long 6, 16, 16, 8192, 5888, 268032, 8388608, 0, 32768, 4, 4288512, 131072, 0, 0, 218104400, 1
    .long 4, 16, 16, 8192, 5888, 268032, 8388608, 262144, 32768, 4, 5337088, 131072, 0, 0, 218104528, 1
    .long 4, 16, 16, 8192, 4096, 266240, 8388608, 786432, 32768, 4, 7405568, 131072, 0, 0, 218104640, 1
    .long 1, 24, 24, 8192, 5632, 5888, 8388608, 2097152, 32768, 8, 29450240, 131072, 0, 0, 218105424, 4
    .long 2, 64, 72, 7168, 1536, 1536, 7340032, 1048576, 32768, 8, 58220544, 114688, 0, 0, 218103936, 1
    .long 2, 64, 72, 7168, 512, 512, 7340032, 2621440, 32768, 8, 63709184, 114688, 0, 0, 218104128, 1
    .long 2, 64, 72, 7168, 6656, 6656, 7340032, 3670016, 32768, 8, 67477504, 114688, 0, 0, 218104304, 1
    .long 1, 80, 80, 2048, 3671552, 3671808, 7340032, 67428352, 114688, 7, 179855360, 32768, 218104288, 7, 218106816, 1
    .long 0, 0, 0, 0, 0, 0, 0, 0, 0, 0, 0, 0, 0, 0, 0, 0
    .long 0, 0, 0, 0, 0, 0, 0, 0, 0, 0, 0, 0, 0, 0, 0, 0
    .long 6, 16, 16, 8192, 7936, 270080, 8388608, 0, 32768, 4, 4321280, 131072, 0, 0, 218104432, 1
    .long 4, 16, 16, 8192, 7936, 270080, 8388608, 262144, 32768, 4, 5369856, 131072, 0, 0, 218104560, 1
    .long 4, 16, 16, 8192, 6144, 268288, 8388608, 786432, 32768, 4, 7438336, 131072, 0, 0, 218104672, 1
    .long 1, 24, 24, 8192, 7680, 7936, 8388608, 2097152, 32768, 8, 29483008, 131072, 0, 0, 218105456, 4
    .long 2, 64, 72, 7168, 1792, 1792, 7340032, 1048576, 32768, 8, 58224640, 114688, 0, 0, 218103952, 1
    .long 2, 64, 72, 7168, 768, 768, 7340032, 2621440, 32768, 8, 63713280, 114688, 0, 0, 218104128, 1
    .long 2, 64, 72, 7168, 6912, 6912, 7340032, 3670016, 32768, 8, 67481600, 114688, 0, 0, 218104304, 1
    .long 1, 80, 80, 2048, 5506560, 5506816, 7340032, 67457024, 114688, 7, 184049664, 32768, 218104304, 7, 218106816, 1
    .long 0, 0, 0, 0, 0, 0, 0, 0, 0, 0, 0, 0, 0, 0, 0, 0
    .long 0, 0, 0, 0, 0, 0, 0, 0, 0, 0, 0, 0, 0, 0, 0, 0
    .long 1, 32, 32, 8192, 0, 256, 8388608, 524288, 32768, 8, 39845888, 131072, 0, 0, 218104576, 4
    .long 1, 16, 16, 8192, 0, 256, 8388608, 1048576, 32768, 8, 8388608, 131072, 0, 0, 218104832, 4
    .long 1, 24, 24, 8192, 0, 256, 8388608, 2621440, 32768, 8, 31457280, 131072, 0, 0, 218105600, 4
    .long 1, 16, 16, 8192, 0, 256, 8388608, 3145728, 32768, 8, 16777216, 131072, 0, 0, 218105856, 4
    .long 1, 16, 16, 8192, 0, 256, 8388608, 3670016, 32768, 8, 18874368, 131072, 0, 0, 218106112, 4
    .long 1, 80, 80, 2048, 0, 256, 7340032, 58195968, 114688, 7, 168820736, 32768, 218103936, 7, 218106496, 1
    .long 0, 0, 0, 0, 0, 0, 0, 0, 0, 0, 0, 0, 0, 0, 0, 0
    .long 0, 0, 0, 0, 0, 0, 0, 0, 0, 0, 0, 0, 0, 0, 0, 0
    .long 0, 0, 0, 0, 0, 0, 0, 0, 0, 0, 0, 0, 0, 0, 0, 0
    .long 0, 0, 0, 0, 0, 0, 0, 0, 0, 0, 0, 0, 0, 0, 0, 0
    .long 1, 32, 32, 8192, 2048, 2304, 8388608, 524288, 32768, 8, 39878656, 131072, 0, 0, 218104608, 4
    .long 1, 16, 16, 8192, 2048, 2304, 8388608, 1048576, 32768, 8, 8421376, 131072, 0, 0, 218104864, 4
    .long 1, 24, 24, 8192, 2048, 2304, 8388608, 2621440, 32768, 8, 31490048, 131072, 0, 0, 218105632, 4
    .long 1, 16, 16, 8192, 2048, 2304, 8388608, 3145728, 32768, 8, 16809984, 131072, 0, 0, 218105888, 4
    .long 1, 16, 16, 8192, 2048, 2304, 8388608, 3670016, 32768, 8, 18907136, 131072, 0, 0, 218106144, 4
    .long 1, 80, 80, 2048, 1835008, 1835264, 7340032, 58224640, 114688, 7, 173015040, 32768, 218103952, 7, 218106496, 1
    .long 0, 0, 0, 0, 0, 0, 0, 0, 0, 0, 0, 0, 0, 0, 0, 0
    .long 0, 0, 0, 0, 0, 0, 0, 0, 0, 0, 0, 0, 0, 0, 0, 0
    .long 0, 0, 0, 0, 0, 0, 0, 0, 0, 0, 0, 0, 0, 0, 0, 0
    .long 0, 0, 0, 0, 0, 0, 0, 0, 0, 0, 0, 0, 0, 0, 0, 0
    .long 1, 32, 32, 8192, 4096, 4352, 8388608, 524288, 32768, 8, 39911424, 131072, 0, 0, 218104640, 4
    .long 1, 16, 16, 8192, 4096, 4352, 8388608, 1048576, 32768, 8, 8454144, 131072, 0, 0, 218104896, 4
    .long 1, 24, 24, 8192, 4096, 4352, 8388608, 2621440, 32768, 8, 31522816, 131072, 0, 0, 218105664, 4
    .long 1, 16, 16, 8192, 4096, 4352, 8388608, 3145728, 32768, 8, 16842752, 131072, 0, 0, 218105920, 4
    .long 1, 16, 16, 8192, 4096, 4352, 8388608, 3670016, 32768, 8, 18939904, 131072, 0, 0, 218106176, 4
    .long 1, 80, 80, 2048, 3670016, 3670272, 7340032, 58253312, 114688, 7, 177209344, 32768, 218103968, 7, 218106496, 1
    .long 0, 0, 0, 0, 0, 0, 0, 0, 0, 0, 0, 0, 0, 0, 0, 0
    .long 0, 0, 0, 0, 0, 0, 0, 0, 0, 0, 0, 0, 0, 0, 0, 0
    .long 0, 0, 0, 0, 0, 0, 0, 0, 0, 0, 0, 0, 0, 0, 0, 0
    .long 0, 0, 0, 0, 0, 0, 0, 0, 0, 0, 0, 0, 0, 0, 0, 0
    .long 1, 32, 32, 8192, 6144, 6400, 8388608, 524288, 32768, 8, 39944192, 131072, 0, 0, 218104672, 4
    .long 1, 16, 16, 8192, 6144, 6400, 8388608, 1048576, 32768, 8, 8486912, 131072, 0, 0, 218104928, 4
    .long 1, 24, 24, 8192, 6144, 6400, 8388608, 2621440, 32768, 8, 31555584, 131072, 0, 0, 218105696, 4
    .long 1, 16, 16, 8192, 6144, 6400, 8388608, 3145728, 32768, 8, 16875520, 131072, 0, 0, 218105952, 4
    .long 1, 16, 16, 8192, 6144, 6400, 8388608, 3670016, 32768, 8, 18972672, 131072, 0, 0, 218106208, 4
    .long 1, 80, 80, 2048, 5505024, 5505280, 7340032, 58281984, 114688, 7, 181403648, 32768, 218103984, 7, 218106496, 1
    .long 0, 0, 0, 0, 0, 0, 0, 0, 0, 0, 0, 0, 0, 0, 0, 0
    .long 0, 0, 0, 0, 0, 0, 0, 0, 0, 0, 0, 0, 0, 0, 0, 0
    .long 0, 0, 0, 0, 0, 0, 0, 0, 0, 0, 0, 0, 0, 0, 0, 0
    .long 0, 0, 0, 0, 0, 0, 0, 0, 0, 0, 0, 0, 0, 0, 0, 0
    .long 1, 32, 32, 8192, 512, 768, 8388608, 524288, 32768, 8, 39854080, 131072, 0, 0, 218104576, 4
    .long 1, 16, 16, 8192, 512, 768, 8388608, 1048576, 32768, 8, 8396800, 131072, 0, 0, 218104832, 4
    .long 1, 24, 24, 8192, 512, 768, 8388608, 2621440, 32768, 8, 31465472, 131072, 0, 0, 218105600, 4
    .long 1, 16, 16, 8192, 512, 768, 8388608, 3145728, 32768, 8, 16785408, 131072, 0, 0, 218105856, 4
    .long 1, 16, 16, 8192, 512, 768, 8388608, 3670016, 32768, 8, 18882560, 131072, 0, 0, 218106112, 4
    .long 1, 80, 80, 2048, 512, 768, 7340032, 58195968, 114688, 7, 168828928, 32768, 218103936, 7, 218106496, 1
    .long 0, 0, 0, 0, 0, 0, 0, 0, 0, 0, 0, 0, 0, 0, 0, 0
    .long 0, 0, 0, 0, 0, 0, 0, 0, 0, 0, 0, 0, 0, 0, 0, 0
    .long 0, 0, 0, 0, 0, 0, 0, 0, 0, 0, 0, 0, 0, 0, 0, 0
    .long 0, 0, 0, 0, 0, 0, 0, 0, 0, 0, 0, 0, 0, 0, 0, 0
    .long 1, 32, 32, 8192, 2560, 2816, 8388608, 524288, 32768, 8, 39886848, 131072, 0, 0, 218104608, 4
    .long 1, 16, 16, 8192, 2560, 2816, 8388608, 1048576, 32768, 8, 8429568, 131072, 0, 0, 218104864, 4
    .long 1, 24, 24, 8192, 2560, 2816, 8388608, 2621440, 32768, 8, 31498240, 131072, 0, 0, 218105632, 4
    .long 1, 16, 16, 8192, 2560, 2816, 8388608, 3145728, 32768, 8, 16818176, 131072, 0, 0, 218105888, 4
    .long 1, 16, 16, 8192, 2560, 2816, 8388608, 3670016, 32768, 8, 18915328, 131072, 0, 0, 218106144, 4
    .long 1, 80, 80, 2048, 1835520, 1835776, 7340032, 58224640, 114688, 7, 173023232, 32768, 218103952, 7, 218106496, 1
    .long 0, 0, 0, 0, 0, 0, 0, 0, 0, 0, 0, 0, 0, 0, 0, 0
    .long 0, 0, 0, 0, 0, 0, 0, 0, 0, 0, 0, 0, 0, 0, 0, 0
    .long 0, 0, 0, 0, 0, 0, 0, 0, 0, 0, 0, 0, 0, 0, 0, 0
    .long 0, 0, 0, 0, 0, 0, 0, 0, 0, 0, 0, 0, 0, 0, 0, 0
    .long 1, 32, 32, 8192, 4608, 4864, 8388608, 524288, 32768, 8, 39919616, 131072, 0, 0, 218104640, 4
    .long 1, 16, 16, 8192, 4608, 4864, 8388608, 1048576, 32768, 8, 8462336, 131072, 0, 0, 218104896, 4
    .long 1, 24, 24, 8192, 4608, 4864, 8388608, 2621440, 32768, 8, 31531008, 131072, 0, 0, 218105664, 4
    .long 1, 16, 16, 8192, 4608, 4864, 8388608, 3145728, 32768, 8, 16850944, 131072, 0, 0, 218105920, 4
    .long 1, 16, 16, 8192, 4608, 4864, 8388608, 3670016, 32768, 8, 18948096, 131072, 0, 0, 218106176, 4
    .long 1, 80, 80, 2048, 3670528, 3670784, 7340032, 58253312, 114688, 7, 177217536, 32768, 218103968, 7, 218106496, 1
    .long 0, 0, 0, 0, 0, 0, 0, 0, 0, 0, 0, 0, 0, 0, 0, 0
    .long 0, 0, 0, 0, 0, 0, 0, 0, 0, 0, 0, 0, 0, 0, 0, 0
    .long 0, 0, 0, 0, 0, 0, 0, 0, 0, 0, 0, 0, 0, 0, 0, 0
    .long 0, 0, 0, 0, 0, 0, 0, 0, 0, 0, 0, 0, 0, 0, 0, 0
    .long 1, 32, 32, 8192, 6656, 6912, 8388608, 524288, 32768, 8, 39952384, 131072, 0, 0, 218104672, 4
    .long 1, 16, 16, 8192, 6656, 6912, 8388608, 1048576, 32768, 8, 8495104, 131072, 0, 0, 218104928, 4
    .long 1, 24, 24, 8192, 6656, 6912, 8388608, 2621440, 32768, 8, 31563776, 131072, 0, 0, 218105696, 4
    .long 1, 16, 16, 8192, 6656, 6912, 8388608, 3145728, 32768, 8, 16883712, 131072, 0, 0, 218105952, 4
    .long 1, 16, 16, 8192, 6656, 6912, 8388608, 3670016, 32768, 8, 18980864, 131072, 0, 0, 218106208, 4
    .long 1, 80, 80, 2048, 5505536, 5505792, 7340032, 58281984, 114688, 7, 181411840, 32768, 218103984, 7, 218106496, 1
    .long 0, 0, 0, 0, 0, 0, 0, 0, 0, 0, 0, 0, 0, 0, 0, 0
    .long 0, 0, 0, 0, 0, 0, 0, 0, 0, 0, 0, 0, 0, 0, 0, 0
    .long 0, 0, 0, 0, 0, 0, 0, 0, 0, 0, 0, 0, 0, 0, 0, 0
    .long 0, 0, 0, 0, 0, 0, 0, 0, 0, 0, 0, 0, 0, 0, 0, 0
    .long 1, 32, 32, 8192, 1024, 1280, 8388608, 524288, 32768, 8, 39862272, 131072, 0, 0, 218104592, 4
    .long 1, 16, 16, 8192, 1024, 1280, 8388608, 1048576, 32768, 8, 8404992, 131072, 0, 0, 218104848, 4
    .long 1, 24, 24, 8192, 1024, 1280, 8388608, 2621440, 32768, 8, 31473664, 131072, 0, 0, 218105616, 4
    .long 1, 16, 16, 8192, 1024, 1280, 8388608, 3145728, 32768, 8, 16793600, 131072, 0, 0, 218105872, 4
    .long 1, 16, 16, 8192, 1024, 1280, 8388608, 3670016, 32768, 8, 18890752, 131072, 0, 0, 218106128, 4
    .long 1, 80, 80, 2048, 1024, 1280, 7340032, 58195968, 114688, 7, 168837120, 32768, 218103936, 7, 218106496, 1
    .long 0, 0, 0, 0, 0, 0, 0, 0, 0, 0, 0, 0, 0, 0, 0, 0
    .long 0, 0, 0, 0, 0, 0, 0, 0, 0, 0, 0, 0, 0, 0, 0, 0
    .long 0, 0, 0, 0, 0, 0, 0, 0, 0, 0, 0, 0, 0, 0, 0, 0
    .long 0, 0, 0, 0, 0, 0, 0, 0, 0, 0, 0, 0, 0, 0, 0, 0
    .long 1, 32, 32, 8192, 3072, 3328, 8388608, 524288, 32768, 8, 39895040, 131072, 0, 0, 218104624, 4
    .long 1, 16, 16, 8192, 3072, 3328, 8388608, 1048576, 32768, 8, 8437760, 131072, 0, 0, 218104880, 4
    .long 1, 24, 24, 8192, 3072, 3328, 8388608, 2621440, 32768, 8, 31506432, 131072, 0, 0, 218105648, 4
    .long 1, 16, 16, 8192, 3072, 3328, 8388608, 3145728, 32768, 8, 16826368, 131072, 0, 0, 218105904, 4
    .long 1, 16, 16, 8192, 3072, 3328, 8388608, 3670016, 32768, 8, 18923520, 131072, 0, 0, 218106160, 4
    .long 1, 80, 80, 2048, 1836032, 1836288, 7340032, 58224640, 114688, 7, 173031424, 32768, 218103952, 7, 218106496, 1
    .long 0, 0, 0, 0, 0, 0, 0, 0, 0, 0, 0, 0, 0, 0, 0, 0
    .long 0, 0, 0, 0, 0, 0, 0, 0, 0, 0, 0, 0, 0, 0, 0, 0
    .long 0, 0, 0, 0, 0, 0, 0, 0, 0, 0, 0, 0, 0, 0, 0, 0
    .long 0, 0, 0, 0, 0, 0, 0, 0, 0, 0, 0, 0, 0, 0, 0, 0
    .long 1, 32, 32, 8192, 5120, 5376, 8388608, 524288, 32768, 8, 39927808, 131072, 0, 0, 218104656, 4
    .long 1, 16, 16, 8192, 5120, 5376, 8388608, 1048576, 32768, 8, 8470528, 131072, 0, 0, 218104912, 4
    .long 1, 24, 24, 8192, 5120, 5376, 8388608, 2621440, 32768, 8, 31539200, 131072, 0, 0, 218105680, 4
    .long 1, 16, 16, 8192, 5120, 5376, 8388608, 3145728, 32768, 8, 16859136, 131072, 0, 0, 218105936, 4
    .long 1, 16, 16, 8192, 5120, 5376, 8388608, 3670016, 32768, 8, 18956288, 131072, 0, 0, 218106192, 4
    .long 1, 80, 80, 2048, 3671040, 3671296, 7340032, 58253312, 114688, 7, 177225728, 32768, 218103968, 7, 218106496, 1
    .long 0, 0, 0, 0, 0, 0, 0, 0, 0, 0, 0, 0, 0, 0, 0, 0
    .long 0, 0, 0, 0, 0, 0, 0, 0, 0, 0, 0, 0, 0, 0, 0, 0
    .long 0, 0, 0, 0, 0, 0, 0, 0, 0, 0, 0, 0, 0, 0, 0, 0
    .long 0, 0, 0, 0, 0, 0, 0, 0, 0, 0, 0, 0, 0, 0, 0, 0
    .long 1, 32, 32, 8192, 7168, 7424, 8388608, 524288, 32768, 8, 39960576, 131072, 0, 0, 218104688, 4
    .long 1, 16, 16, 8192, 7168, 7424, 8388608, 1048576, 32768, 8, 8503296, 131072, 0, 0, 218104944, 4
    .long 1, 24, 24, 8192, 7168, 7424, 8388608, 2621440, 32768, 8, 31571968, 131072, 0, 0, 218105712, 4
    .long 1, 16, 16, 8192, 7168, 7424, 8388608, 3145728, 32768, 8, 16891904, 131072, 0, 0, 218105968, 4
    .long 1, 16, 16, 8192, 7168, 7424, 8388608, 3670016, 32768, 8, 18989056, 131072, 0, 0, 218106224, 4
    .long 1, 80, 80, 2048, 5506048, 5506304, 7340032, 58281984, 114688, 7, 181420032, 32768, 218103984, 7, 218106496, 1
    .long 0, 0, 0, 0, 0, 0, 0, 0, 0, 0, 0, 0, 0, 0, 0, 0
    .long 0, 0, 0, 0, 0, 0, 0, 0, 0, 0, 0, 0, 0, 0, 0, 0
    .long 0, 0, 0, 0, 0, 0, 0, 0, 0, 0, 0, 0, 0, 0, 0, 0
    .long 0, 0, 0, 0, 0, 0, 0, 0, 0, 0, 0, 0, 0, 0, 0, 0
    .long 1, 32, 32, 8192, 1536, 1792, 8388608, 524288, 32768, 8, 39870464, 131072, 0, 0, 218104592, 4
    .long 1, 16, 16, 8192, 1536, 1792, 8388608, 1048576, 32768, 8, 8413184, 131072, 0, 0, 218104848, 4
    .long 1, 24, 24, 8192, 1536, 1792, 8388608, 2621440, 32768, 8, 31481856, 131072, 0, 0, 218105616, 4
    .long 1, 16, 16, 8192, 1536, 1792, 8388608, 3145728, 32768, 8, 16801792, 131072, 0, 0, 218105872, 4
    .long 1, 16, 16, 8192, 1536, 1792, 8388608, 3670016, 32768, 8, 18898944, 131072, 0, 0, 218106128, 4
    .long 1, 80, 80, 2048, 1536, 1792, 7340032, 58195968, 114688, 7, 168845312, 32768, 218103936, 7, 218106496, 1
    .long 0, 0, 0, 0, 0, 0, 0, 0, 0, 0, 0, 0, 0, 0, 0, 0
    .long 0, 0, 0, 0, 0, 0, 0, 0, 0, 0, 0, 0, 0, 0, 0, 0
    .long 0, 0, 0, 0, 0, 0, 0, 0, 0, 0, 0, 0, 0, 0, 0, 0
    .long 0, 0, 0, 0, 0, 0, 0, 0, 0, 0, 0, 0, 0, 0, 0, 0
    .long 1, 32, 32, 8192, 3584, 3840, 8388608, 524288, 32768, 8, 39903232, 131072, 0, 0, 218104624, 4
    .long 1, 16, 16, 8192, 3584, 3840, 8388608, 1048576, 32768, 8, 8445952, 131072, 0, 0, 218104880, 4
    .long 1, 24, 24, 8192, 3584, 3840, 8388608, 2621440, 32768, 8, 31514624, 131072, 0, 0, 218105648, 4
    .long 1, 16, 16, 8192, 3584, 3840, 8388608, 3145728, 32768, 8, 16834560, 131072, 0, 0, 218105904, 4
    .long 1, 16, 16, 8192, 3584, 3840, 8388608, 3670016, 32768, 8, 18931712, 131072, 0, 0, 218106160, 4
    .long 1, 80, 80, 2048, 1836544, 1836800, 7340032, 58224640, 114688, 7, 173039616, 32768, 218103952, 7, 218106496, 1
    .long 0, 0, 0, 0, 0, 0, 0, 0, 0, 0, 0, 0, 0, 0, 0, 0
    .long 0, 0, 0, 0, 0, 0, 0, 0, 0, 0, 0, 0, 0, 0, 0, 0
    .long 0, 0, 0, 0, 0, 0, 0, 0, 0, 0, 0, 0, 0, 0, 0, 0
    .long 0, 0, 0, 0, 0, 0, 0, 0, 0, 0, 0, 0, 0, 0, 0, 0
    .long 1, 32, 32, 8192, 5632, 5888, 8388608, 524288, 32768, 8, 39936000, 131072, 0, 0, 218104656, 4
    .long 1, 16, 16, 8192, 5632, 5888, 8388608, 1048576, 32768, 8, 8478720, 131072, 0, 0, 218104912, 4
    .long 1, 24, 24, 8192, 5632, 5888, 8388608, 2621440, 32768, 8, 31547392, 131072, 0, 0, 218105680, 4
    .long 1, 16, 16, 8192, 5632, 5888, 8388608, 3145728, 32768, 8, 16867328, 131072, 0, 0, 218105936, 4
    .long 1, 16, 16, 8192, 5632, 5888, 8388608, 3670016, 32768, 8, 18964480, 131072, 0, 0, 218106192, 4
    .long 1, 80, 80, 2048, 3671552, 3671808, 7340032, 58253312, 114688, 7, 177233920, 32768, 218103968, 7, 218106496, 1
    .long 0, 0, 0, 0, 0, 0, 0, 0, 0, 0, 0, 0, 0, 0, 0, 0
    .long 0, 0, 0, 0, 0, 0, 0, 0, 0, 0, 0, 0, 0, 0, 0, 0
    .long 0, 0, 0, 0, 0, 0, 0, 0, 0, 0, 0, 0, 0, 0, 0, 0
    .long 0, 0, 0, 0, 0, 0, 0, 0, 0, 0, 0, 0, 0, 0, 0, 0
    .long 1, 32, 32, 8192, 7680, 7936, 8388608, 524288, 32768, 8, 39968768, 131072, 0, 0, 218104688, 4
    .long 1, 16, 16, 8192, 7680, 7936, 8388608, 1048576, 32768, 8, 8511488, 131072, 0, 0, 218104944, 4
    .long 1, 24, 24, 8192, 7680, 7936, 8388608, 2621440, 32768, 8, 31580160, 131072, 0, 0, 218105712, 4
    .long 1, 16, 16, 8192, 7680, 7936, 8388608, 3145728, 32768, 8, 16900096, 131072, 0, 0, 218105968, 4
    .long 1, 16, 16, 8192, 7680, 7936, 8388608, 3670016, 32768, 8, 18997248, 131072, 0, 0, 218106224, 4
    .long 1, 80, 80, 2048, 5506560, 5506816, 7340032, 58281984, 114688, 7, 181428224, 32768, 218103984, 7, 218106496, 1
    .long 0, 0, 0, 0, 0, 0, 0, 0, 0, 0, 0, 0, 0, 0, 0, 0
    .long 0, 0, 0, 0, 0, 0, 0, 0, 0, 0, 0, 0, 0, 0, 0, 0
    .long 0, 0, 0, 0, 0, 0, 0, 0, 0, 0, 0, 0, 0, 0, 0, 0
    .long 0, 0, 0, 0, 0, 0, 0, 0, 0, 0, 0, 0, 0, 0, 0, 0
    .long 1, 24, 24, 8192, 0, 256, 8388608, 524288, 32768, 8, 23068672, 131072, 0, 0, 218104576, 4
    .long 1, 32, 32, 8192, 0, 256, 8388608, 1572864, 32768, 8, 44040192, 131072, 0, 0, 218105088, 4
    .long 1, 16, 16, 8192, 0, 256, 8388608, 2621440, 32768, 8, 14680064, 131072, 0, 0, 218105600, 4
    .long 2, 64, 72, 7168, 2048, 2048, 7340032, 1048576, 32768, 8, 58228736, 114688, 0, 0, 218103952, 1
    .long 2, 64, 72, 7168, 1024, 1024, 7340032, 2621440, 32768, 8, 63717376, 114688, 0, 0, 218104128, 1
    .long 1, 80, 80, 2048, 0, 256, 7340032, 60030976, 114688, 7, 169345024, 32768, 218104000, 7, 218106560, 1
    .long 0, 0, 0, 0, 0, 0, 0, 0, 0, 0, 0, 0, 0, 0, 0, 0
    .long 0, 0, 0, 0, 0, 0, 0, 0, 0, 0, 0, 0, 0, 0, 0, 0
    .long 0, 0, 0, 0, 0, 0, 0, 0, 0, 0, 0, 0, 0, 0, 0, 0
    .long 0, 0, 0, 0, 0, 0, 0, 0, 0, 0, 0, 0, 0, 0, 0, 0
    .long 1, 24, 24, 8192, 2048, 2304, 8388608, 524288, 32768, 8, 23101440, 131072, 0, 0, 218104608, 4
    .long 1, 32, 32, 8192, 2048, 2304, 8388608, 1572864, 32768, 8, 44072960, 131072, 0, 0, 218105120, 4
    .long 1, 16, 16, 8192, 2048, 2304, 8388608, 2621440, 32768, 8, 14712832, 131072, 0, 0, 218105632, 4
    .long 2, 64, 72, 7168, 2304, 2304, 7340032, 1048576, 32768, 8, 58232832, 114688, 0, 0, 218103952, 1
    .long 2, 64, 72, 7168, 1280, 1280, 7340032, 2621440, 32768, 8, 63721472, 114688, 0, 0, 218104128, 1
    .long 1, 80, 80, 2048, 1835008, 1835264, 7340032, 60059648, 114688, 7, 173539328, 32768, 218104016, 7, 218106560, 1
    .long 0, 0, 0, 0, 0, 0, 0, 0, 0, 0, 0, 0, 0, 0, 0, 0
    .long 0, 0, 0, 0, 0, 0, 0, 0, 0, 0, 0, 0, 0, 0, 0, 0
    .long 0, 0, 0, 0, 0, 0, 0, 0, 0, 0, 0, 0, 0, 0, 0, 0
    .long 0, 0, 0, 0, 0, 0, 0, 0, 0, 0, 0, 0, 0, 0, 0, 0
    .long 1, 24, 24, 8192, 4096, 4352, 8388608, 524288, 32768, 8, 23134208, 131072, 0, 0, 218104640, 4
    .long 1, 32, 32, 8192, 4096, 4352, 8388608, 1572864, 32768, 8, 44105728, 131072, 0, 0, 218105152, 4
    .long 1, 16, 16, 8192, 4096, 4352, 8388608, 2621440, 32768, 8, 14745600, 131072, 0, 0, 218105664, 4
    .long 2, 64, 72, 7168, 2560, 2560, 7340032, 1048576, 32768, 8, 58236928, 114688, 0, 0, 218103952, 1
    .long 2, 64, 72, 7168, 1536, 1536, 7340032, 2621440, 32768, 8, 63725568, 114688, 0, 0, 218104128, 1
    .long 1, 80, 80, 2048, 3670016, 3670272, 7340032, 60088320, 114688, 7, 177733632, 32768, 218104032, 7, 218106560, 1
    .long 0, 0, 0, 0, 0, 0, 0, 0, 0, 0, 0, 0, 0, 0, 0, 0
    .long 0, 0, 0, 0, 0, 0, 0, 0, 0, 0, 0, 0, 0, 0, 0, 0
    .long 0, 0, 0, 0, 0, 0, 0, 0, 0, 0, 0, 0, 0, 0, 0, 0
    .long 0, 0, 0, 0, 0, 0, 0, 0, 0, 0, 0, 0, 0, 0, 0, 0
    .long 1, 24, 24, 8192, 6144, 6400, 8388608, 524288, 32768, 8, 23166976, 131072, 0, 0, 218104672, 4
    .long 1, 32, 32, 8192, 6144, 6400, 8388608, 1572864, 32768, 8, 44138496, 131072, 0, 0, 218105184, 4
    .long 1, 16, 16, 8192, 6144, 6400, 8388608, 2621440, 32768, 8, 14778368, 131072, 0, 0, 218105696, 4
    .long 2, 64, 72, 7168, 2816, 2816, 7340032, 1048576, 32768, 8, 58241024, 114688, 0, 0, 218103952, 1
    .long 2, 64, 72, 7168, 1792, 1792, 7340032, 2621440, 32768, 8, 63729664, 114688, 0, 0, 218104144, 1
    .long 1, 80, 80, 2048, 5505024, 5505280, 7340032, 60116992, 114688, 7, 181927936, 32768, 218104048, 7, 218106560, 1
    .long 0, 0, 0, 0, 0, 0, 0, 0, 0, 0, 0, 0, 0, 0, 0, 0
    .long 0, 0, 0, 0, 0, 0, 0, 0, 0, 0, 0, 0, 0, 0, 0, 0
    .long 0, 0, 0, 0, 0, 0, 0, 0, 0, 0, 0, 0, 0, 0, 0, 0
    .long 0, 0, 0, 0, 0, 0, 0, 0, 0, 0, 0, 0, 0, 0, 0, 0
    .long 1, 24, 24, 8192, 512, 768, 8388608, 524288, 32768, 8, 23076864, 131072, 0, 0, 218104576, 4
    .long 1, 32, 32, 8192, 512, 768, 8388608, 1572864, 32768, 8, 44048384, 131072, 0, 0, 218105088, 4
    .long 1, 16, 16, 8192, 512, 768, 8388608, 2621440, 32768, 8, 14688256, 131072, 0, 0, 218105600, 4
    .long 2, 64, 72, 7168, 3072, 3072, 7340032, 1048576, 32768, 8, 58245120, 114688, 0, 0, 218103952, 1
    .long 2, 64, 72, 7168, 2048, 2048, 7340032, 2621440, 32768, 8, 63733760, 114688, 0, 0, 218104144, 1
    .long 1, 80, 80, 2048, 512, 768, 7340032, 60030976, 114688, 7, 169353216, 32768, 218104000, 7, 218106560, 1
    .long 0, 0, 0, 0, 0, 0, 0, 0, 0, 0, 0, 0, 0, 0, 0, 0
    .long 0, 0, 0, 0, 0, 0, 0, 0, 0, 0, 0, 0, 0, 0, 0, 0
    .long 0, 0, 0, 0, 0, 0, 0, 0, 0, 0, 0, 0, 0, 0, 0, 0
    .long 0, 0, 0, 0, 0, 0, 0, 0, 0, 0, 0, 0, 0, 0, 0, 0
    .long 1, 24, 24, 8192, 2560, 2816, 8388608, 524288, 32768, 8, 23109632, 131072, 0, 0, 218104608, 4
    .long 1, 32, 32, 8192, 2560, 2816, 8388608, 1572864, 32768, 8, 44081152, 131072, 0, 0, 218105120, 4
    .long 1, 16, 16, 8192, 2560, 2816, 8388608, 2621440, 32768, 8, 14721024, 131072, 0, 0, 218105632, 4
    .long 2, 64, 72, 7168, 3328, 3328, 7340032, 1048576, 32768, 8, 58249216, 114688, 0, 0, 218103952, 1
    .long 2, 64, 72, 7168, 2304, 2304, 7340032, 2621440, 32768, 8, 63737856, 114688, 0, 0, 218104144, 1
    .long 1, 80, 80, 2048, 1835520, 1835776, 7340032, 60059648, 114688, 7, 173547520, 32768, 218104016, 7, 218106560, 1
    .long 0, 0, 0, 0, 0, 0, 0, 0, 0, 0, 0, 0, 0, 0, 0, 0
    .long 0, 0, 0, 0, 0, 0, 0, 0, 0, 0, 0, 0, 0, 0, 0, 0
    .long 0, 0, 0, 0, 0, 0, 0, 0, 0, 0, 0, 0, 0, 0, 0, 0
    .long 0, 0, 0, 0, 0, 0, 0, 0, 0, 0, 0, 0, 0, 0, 0, 0
    .long 1, 24, 24, 8192, 4608, 4864, 8388608, 524288, 32768, 8, 23142400, 131072, 0, 0, 218104640, 4
    .long 1, 32, 32, 8192, 4608, 4864, 8388608, 1572864, 32768, 8, 44113920, 131072, 0, 0, 218105152, 4
    .long 1, 16, 16, 8192, 4608, 4864, 8388608, 2621440, 32768, 8, 14753792, 131072, 0, 0, 218105664, 4
    .long 2, 64, 72, 7168, 3584, 3584, 7340032, 1048576, 32768, 8, 58253312, 114688, 0, 0, 218103968, 1
    .long 2, 64, 72, 7168, 2560, 2560, 7340032, 2621440, 32768, 8, 63741952, 114688, 0, 0, 218104144, 1
    .long 1, 80, 80, 2048, 3670528, 3670784, 7340032, 60088320, 114688, 7, 177741824, 32768, 218104032, 7, 218106560, 1
    .long 0, 0, 0, 0, 0, 0, 0, 0, 0, 0, 0, 0, 0, 0, 0, 0
    .long 0, 0, 0, 0, 0, 0, 0, 0, 0, 0, 0, 0, 0, 0, 0, 0
    .long 0, 0, 0, 0, 0, 0, 0, 0, 0, 0, 0, 0, 0, 0, 0, 0
    .long 0, 0, 0, 0, 0, 0, 0, 0, 0, 0, 0, 0, 0, 0, 0, 0
    .long 1, 24, 24, 8192, 6656, 6912, 8388608, 524288, 32768, 8, 23175168, 131072, 0, 0, 218104672, 4
    .long 1, 32, 32, 8192, 6656, 6912, 8388608, 1572864, 32768, 8, 44146688, 131072, 0, 0, 218105184, 4
    .long 1, 16, 16, 8192, 6656, 6912, 8388608, 2621440, 32768, 8, 14786560, 131072, 0, 0, 218105696, 4
    .long 2, 64, 72, 7168, 3840, 3840, 7340032, 1048576, 32768, 8, 58257408, 114688, 0, 0, 218103968, 1
    .long 2, 64, 72, 7168, 2816, 2816, 7340032, 2621440, 32768, 8, 63746048, 114688, 0, 0, 218104144, 1
    .long 1, 80, 80, 2048, 5505536, 5505792, 7340032, 60116992, 114688, 7, 181936128, 32768, 218104048, 7, 218106560, 1
    .long 0, 0, 0, 0, 0, 0, 0, 0, 0, 0, 0, 0, 0, 0, 0, 0
    .long 0, 0, 0, 0, 0, 0, 0, 0, 0, 0, 0, 0, 0, 0, 0, 0
    .long 0, 0, 0, 0, 0, 0, 0, 0, 0, 0, 0, 0, 0, 0, 0, 0
    .long 0, 0, 0, 0, 0, 0, 0, 0, 0, 0, 0, 0, 0, 0, 0, 0
    .long 1, 24, 24, 8192, 1024, 1280, 8388608, 524288, 32768, 8, 23085056, 131072, 0, 0, 218104592, 4
    .long 1, 32, 32, 8192, 1024, 1280, 8388608, 1572864, 32768, 8, 44056576, 131072, 0, 0, 218105104, 4
    .long 1, 16, 16, 8192, 1024, 1280, 8388608, 2621440, 32768, 8, 14696448, 131072, 0, 0, 218105616, 4
    .long 2, 64, 72, 7168, 4096, 4096, 7340032, 1048576, 32768, 8, 58261504, 114688, 0, 0, 218103968, 1
    .long 2, 64, 72, 7168, 3072, 3072, 7340032, 2621440, 32768, 8, 63750144, 114688, 0, 0, 218104144, 1
    .long 1, 80, 80, 2048, 1024, 1280, 7340032, 60030976, 114688, 7, 169361408, 32768, 218104000, 7, 218106560, 1
    .long 0, 0, 0, 0, 0, 0, 0, 0, 0, 0, 0, 0, 0, 0, 0, 0
    .long 0, 0, 0, 0, 0, 0, 0, 0, 0, 0, 0, 0, 0, 0, 0, 0
    .long 0, 0, 0, 0, 0, 0, 0, 0, 0, 0, 0, 0, 0, 0, 0, 0
    .long 0, 0, 0, 0, 0, 0, 0, 0, 0, 0, 0, 0, 0, 0, 0, 0
    .long 1, 24, 24, 8192, 3072, 3328, 8388608, 524288, 32768, 8, 23117824, 131072, 0, 0, 218104624, 4
    .long 1, 32, 32, 8192, 3072, 3328, 8388608, 1572864, 32768, 8, 44089344, 131072, 0, 0, 218105136, 4
    .long 1, 16, 16, 8192, 3072, 3328, 8388608, 2621440, 32768, 8, 14729216, 131072, 0, 0, 218105648, 4
    .long 2, 64, 72, 7168, 4352, 4352, 7340032, 1048576, 32768, 8, 58265600, 114688, 0, 0, 218103968, 1
    .long 2, 64, 72, 7168, 3328, 3328, 7340032, 2621440, 32768, 8, 63754240, 114688, 0, 0, 218104144, 1
    .long 1, 80, 80, 2048, 1836032, 1836288, 7340032, 60059648, 114688, 7, 173555712, 32768, 218104016, 7, 218106560, 1
    .long 0, 0, 0, 0, 0, 0, 0, 0, 0, 0, 0, 0, 0, 0, 0, 0
    .long 0, 0, 0, 0, 0, 0, 0, 0, 0, 0, 0, 0, 0, 0, 0, 0
    .long 0, 0, 0, 0, 0, 0, 0, 0, 0, 0, 0, 0, 0, 0, 0, 0
    .long 0, 0, 0, 0, 0, 0, 0, 0, 0, 0, 0, 0, 0, 0, 0, 0
    .long 1, 24, 24, 8192, 5120, 5376, 8388608, 524288, 32768, 8, 23150592, 131072, 0, 0, 218104656, 4
    .long 1, 32, 32, 8192, 5120, 5376, 8388608, 1572864, 32768, 8, 44122112, 131072, 0, 0, 218105168, 4
    .long 1, 16, 16, 8192, 5120, 5376, 8388608, 2621440, 32768, 8, 14761984, 131072, 0, 0, 218105680, 4
    .long 2, 64, 72, 7168, 4608, 4608, 7340032, 1048576, 32768, 8, 58269696, 114688, 0, 0, 218103968, 1
    .long 2, 64, 72, 7168, 3584, 3584, 7340032, 2621440, 32768, 8, 63758336, 114688, 0, 0, 218104160, 1
    .long 1, 80, 80, 2048, 3671040, 3671296, 7340032, 60088320, 114688, 7, 177750016, 32768, 218104032, 7, 218106560, 1
    .long 0, 0, 0, 0, 0, 0, 0, 0, 0, 0, 0, 0, 0, 0, 0, 0
    .long 0, 0, 0, 0, 0, 0, 0, 0, 0, 0, 0, 0, 0, 0, 0, 0
    .long 0, 0, 0, 0, 0, 0, 0, 0, 0, 0, 0, 0, 0, 0, 0, 0
    .long 0, 0, 0, 0, 0, 0, 0, 0, 0, 0, 0, 0, 0, 0, 0, 0
    .long 1, 24, 24, 8192, 7168, 7424, 8388608, 524288, 32768, 8, 23183360, 131072, 0, 0, 218104688, 4
    .long 1, 32, 32, 8192, 7168, 7424, 8388608, 1572864, 32768, 8, 44154880, 131072, 0, 0, 218105200, 4
    .long 1, 16, 16, 8192, 7168, 7424, 8388608, 2621440, 32768, 8, 14794752, 131072, 0, 0, 218105712, 4
    .long 2, 64, 72, 7168, 4864, 4864, 7340032, 1048576, 32768, 8, 58273792, 114688, 0, 0, 218103968, 1
    .long 2, 64, 72, 7168, 3840, 3840, 7340032, 2621440, 32768, 8, 63762432, 114688, 0, 0, 218104160, 1
    .long 1, 80, 80, 2048, 5506048, 5506304, 7340032, 60116992, 114688, 7, 181944320, 32768, 218104048, 7, 218106560, 1
    .long 0, 0, 0, 0, 0, 0, 0, 0, 0, 0, 0, 0, 0, 0, 0, 0
    .long 0, 0, 0, 0, 0, 0, 0, 0, 0, 0, 0, 0, 0, 0, 0, 0
    .long 0, 0, 0, 0, 0, 0, 0, 0, 0, 0, 0, 0, 0, 0, 0, 0
    .long 0, 0, 0, 0, 0, 0, 0, 0, 0, 0, 0, 0, 0, 0, 0, 0
    .long 1, 24, 24, 8192, 1536, 1792, 8388608, 524288, 32768, 8, 23093248, 131072, 0, 0, 218104592, 4
    .long 1, 32, 32, 8192, 1536, 1792, 8388608, 1572864, 32768, 8, 44064768, 131072, 0, 0, 218105104, 4
    .long 1, 16, 16, 8192, 1536, 1792, 8388608, 2621440, 32768, 8, 14704640, 131072, 0, 0, 218105616, 4
    .long 2, 64, 72, 7168, 5120, 5120, 7340032, 1048576, 32768, 8, 58277888, 114688, 0, 0, 218103968, 1
    .long 2, 64, 72, 7168, 4096, 4096, 7340032, 2621440, 32768, 8, 63766528, 114688, 0, 0, 218104160, 1
    .long 1, 80, 80, 2048, 1536, 1792, 7340032, 60030976, 114688, 7, 169369600, 32768, 218104000, 7, 218106560, 1
    .long 0, 0, 0, 0, 0, 0, 0, 0, 0, 0, 0, 0, 0, 0, 0, 0
    .long 0, 0, 0, 0, 0, 0, 0, 0, 0, 0, 0, 0, 0, 0, 0, 0
    .long 0, 0, 0, 0, 0, 0, 0, 0, 0, 0, 0, 0, 0, 0, 0, 0
    .long 0, 0, 0, 0, 0, 0, 0, 0, 0, 0, 0, 0, 0, 0, 0, 0
    .long 1, 24, 24, 8192, 3584, 3840, 8388608, 524288, 32768, 8, 23126016, 131072, 0, 0, 218104624, 4
    .long 1, 32, 32, 8192, 3584, 3840, 8388608, 1572864, 32768, 8, 44097536, 131072, 0, 0, 218105136, 4
    .long 1, 16, 16, 8192, 3584, 3840, 8388608, 2621440, 32768, 8, 14737408, 131072, 0, 0, 218105648, 4
    .long 2, 64, 72, 7168, 5376, 5376, 7340032, 1048576, 32768, 8, 58281984, 114688, 0, 0, 218103984, 1
    .long 2, 64, 72, 7168, 4352, 4352, 7340032, 2621440, 32768, 8, 63770624, 114688, 0, 0, 218104160, 1
    .long 1, 80, 80, 2048, 1836544, 1836800, 7340032, 60059648, 114688, 7, 173563904, 32768, 218104016, 7, 218106560, 1
    .long 0, 0, 0, 0, 0, 0, 0, 0, 0, 0, 0, 0, 0, 0, 0, 0
    .long 0, 0, 0, 0, 0, 0, 0, 0, 0, 0, 0, 0, 0, 0, 0, 0
    .long 0, 0, 0, 0, 0, 0, 0, 0, 0, 0, 0, 0, 0, 0, 0, 0
    .long 0, 0, 0, 0, 0, 0, 0, 0, 0, 0, 0, 0, 0, 0, 0, 0
    .long 1, 24, 24, 8192, 5632, 5888, 8388608, 524288, 32768, 8, 23158784, 131072, 0, 0, 218104656, 4
    .long 1, 32, 32, 8192, 5632, 5888, 8388608, 1572864, 32768, 8, 44130304, 131072, 0, 0, 218105168, 4
    .long 1, 16, 16, 8192, 5632, 5888, 8388608, 2621440, 32768, 8, 14770176, 131072, 0, 0, 218105680, 4
    .long 2, 64, 72, 7168, 5632, 5632, 7340032, 1048576, 32768, 8, 58286080, 114688, 0, 0, 218103984, 1
    .long 2, 64, 72, 7168, 4608, 4608, 7340032, 2621440, 32768, 8, 63774720, 114688, 0, 0, 218104160, 1
    .long 1, 80, 80, 2048, 3671552, 3671808, 7340032, 60088320, 114688, 7, 177758208, 32768, 218104032, 7, 218106560, 1
    .long 0, 0, 0, 0, 0, 0, 0, 0, 0, 0, 0, 0, 0, 0, 0, 0
    .long 0, 0, 0, 0, 0, 0, 0, 0, 0, 0, 0, 0, 0, 0, 0, 0
    .long 0, 0, 0, 0, 0, 0, 0, 0, 0, 0, 0, 0, 0, 0, 0, 0
    .long 0, 0, 0, 0, 0, 0, 0, 0, 0, 0, 0, 0, 0, 0, 0, 0
    .long 1, 24, 24, 8192, 7680, 7936, 8388608, 524288, 32768, 8, 23191552, 131072, 0, 0, 218104688, 4
    .long 1, 32, 32, 8192, 7680, 7936, 8388608, 1572864, 32768, 8, 44163072, 131072, 0, 0, 218105200, 4
    .long 1, 16, 16, 8192, 7680, 7936, 8388608, 2621440, 32768, 8, 14802944, 131072, 0, 0, 218105712, 4
    .long 2, 64, 72, 7168, 5888, 5888, 7340032, 1048576, 32768, 8, 58290176, 114688, 0, 0, 218103984, 1
    .long 2, 64, 72, 7168, 4864, 4864, 7340032, 2621440, 32768, 8, 63778816, 114688, 0, 0, 218104160, 1
    .long 1, 80, 80, 2048, 5506560, 5506816, 7340032, 60116992, 114688, 7, 181952512, 32768, 218104048, 7, 218106560, 1
    .long 0, 0, 0, 0, 0, 0, 0, 0, 0, 0, 0, 0, 0, 0, 0, 0
    .long 0, 0, 0, 0, 0, 0, 0, 0, 0, 0, 0, 0, 0, 0, 0, 0
    .long 0, 0, 0, 0, 0, 0, 0, 0, 0, 0, 0, 0, 0, 0, 0, 0
    .long 0, 0, 0, 0, 0, 0, 0, 0, 0, 0, 0, 0, 0, 0, 0, 0
.p2align 6
.amdhsa_kernel recurrent_scan__memory_aug_recurrent_mem_tr__glu_gated_glu__prompt_kernel
  .amdhsa_next_free_vgpr 256
  .amdhsa_next_free_sgpr 102
  .amdhsa_accum_offset 256
  .amdhsa_group_segment_fixed_size 0
  .amdhsa_kernarg_size 112
  .amdhsa_user_sgpr_count 2
  .amdhsa_user_sgpr_kernarg_segment_ptr 1
  .amdhsa_system_sgpr_workgroup_id_x 1
  .amdhsa_float_denorm_mode_32 3
.end_amdhsa_kernel
```
